```python
import torch

def _softmax(x, axis=-1):
    return torch.softmax(x, dim=axis)

def _gelu(x):
    return torch.nn.functional.gelu(x, approximate='tanh')

def _silu(x):
    return torch.nn.functional.silu(x)

def _sigmoid(x):
    return torch.sigmoid(x)

def _layernorm(x, axis=-1, eps=1e-05):
    m = x.mean(dim=axis, keepdim=True)
    v = x.var(dim=axis, keepdim=True, unbiased=False)
    return (x - m) / torch.sqrt(v + eps)

def _scatter_add(tgt, idx, src, axis=0):
    return tgt.clone().index_add_(axis, idx, src)

def _segment_sum(src, seg, n):
    out = torch.zeros((n,) + src.shape[1:], dtype=src.dtype)
    return out.index_add_(0, seg, src)

def _pad(x, pw):
    flat = tuple((v for pair in reversed(pw) for v in pair))
    return torch.nn.functional.pad(x, flat)
kernel_name = 'interleave_layers__linear_attn_block__memory_aug_recurrent_mem_tr__prompt'

def setup_inputs():

    _w = lambda a: (lambda t: t.to(torch.bfloat16) if t.is_floating_point() else t)(torch.as_tensor(a))

    def _A_setup():
        B, S, D = (1, 2048, 640)
        return {'x': _w((lambda *s: torch.randn(*s, dtype=torch.bfloat16) * 0.05)(B, S, D)), 'wqkv': _w((lambda *s: torch.randn(*s, dtype=torch.bfloat16) * 0.05)(D, 3 * D)), 'wo': _w((lambda *s: torch.randn(*s, dtype=torch.bfloat16) * 0.05)(D, D))}
    _A_in = _A_setup()

    def _B_setup():
        B, S, Dm = (1, 2048, 640)
        H, Dh = (32, 192)
        M, seg = (8, 32)
        seg = min(seg, S)
        S = S // seg * seg
        return {'x': _w((lambda *s: torch.randn(*s, dtype=torch.bfloat16) * 0.05)(B, S, Dm)), 'mem0': _w((lambda *s: torch.randn(*s, dtype=torch.bfloat16) * 0.8)(B, M, Dm)), 'Wq': _w((lambda *s: torch.randn(*s, dtype=torch.bfloat16) * 1.6)(Dm, H, Dh) * Dm ** (-0.5)), 'Wk': _w((lambda *s: torch.randn(*s, dtype=torch.bfloat16) * 1.6)(Dm, H, Dh) * Dm ** (-0.5)), 'Wv': _w((lambda *s: torch.randn(*s, dtype=torch.bfloat16) * 0.8)(Dm, H, Dh) * Dm ** (-0.5)), 'Wo': _w((lambda *s: torch.randn(*s, dtype=torch.bfloat16) * 0.8)(H, Dh, Dm) * (H * Dh) ** (-0.5)), 'seg_len': seg}
    _B_in = _B_setup()
    return {'A_x': _A_in['x'], 'A_wqkv': _A_in['wqkv'], 'A_wo': _A_in['wo'], 'B_x': _B_in['x'], 'B_mem0': _B_in['mem0'], 'B_Wq': _B_in['Wq'], 'B_Wk': _B_in['Wk'], 'B_Wv': _B_in['Wv'], 'B_Wo': _B_in['Wo'], 'B_seg_len': _B_in['seg_len']}

def reference(A_x, A_wqkv, A_wo, B_x, B_mem0, B_Wq, B_Wk, B_Wv, B_Wo, B_seg_len):

    def _A_ref(x, wqkv, wo):
        B, S, D = x.shape
        H = 32
        Dh = D // H
        qkv = (lambda x, *d: x.permute(*d))((x @ wqkv).reshape(B, S, 3, H, Dh), 2, 0, 3, 1, 4)
        q, k, v = (qkv[0], qkv[1], qkv[2])
        phi = lambda t: torch.where(t > 0, t + 1, torch.exp(t)) + 1e-06
        pq, pk = (phi(q), phi(k))
        kv = torch.einsum('bhsd,bhse->bhde', pk, v)
        z = torch.einsum('bhsd->bhd', pk)
        num = torch.einsum('bhqd,bhde->bhqe', pq, kv)
        den = torch.einsum('bhqd,bhd->bhq', pq, z)[..., None] + 1e-06
        o = num / den
        return (lambda x, *d: x.permute(*d))(o, 0, 2, 1, 3).reshape(B, S, D) @ wo

    def _B_ref(x, mem0, Wq, Wk, Wv, Wo, seg_len):
        B, S, Dm = x.shape
        H, Dh = (Wq.shape[1], Wq.shape[2])
        M = mem0.shape[1]
        scale = Dh ** (-0.5)
        n_seg = S // seg_len
        L = M + seg_len
        idx = torch.arange(L)
        mask = (idx[:, None] < M) | (idx[:, None] >= idx[None, :])
        mem = mem0
        outs = []
        for s in range(n_seg):
            xs = x[:, s * seg_len:(s + 1) * seg_len, :].clone()
            h = torch.concatenate([mem, xs], axis=1)
            q = torch.einsum('btd,dhe->bhte', h, Wq)
            k = torch.einsum('btd,dhe->bhte', h, Wk)
            v = torch.einsum('btd,dhe->bhte', h, Wv)
            scores = torch.einsum('bhqe,bhke->bhqk', q, k) * scale
            scores = torch.where(mask[None, None], scores, -1000000000.0)
            p = _softmax(scores, axis=-1)
            o = torch.einsum('bhqk,bhke->bhqe', p, v)
            o = torch.einsum('bhte,hed->btd', o, Wo)
            mem = o[:, :M, :].clone()
            outs.append(o[:, M:, :])
        return torch.concatenate(outs, axis=1)
    x = A_x
    x = x + _A_ref(_layernorm(x, axis=-1), A_wqkv, A_wo)
    x = x + _B_ref(_layernorm(x, axis=-1), B_mem0, B_Wq, B_Wk, B_Wv, B_Wo, B_seg_len)
    x = x + _A_ref(_layernorm(x, axis=-1), A_wqkv, A_wo)
    x = x + _B_ref(_layernorm(x, axis=-1), B_mem0, B_Wq, B_Wk, B_Wv, B_Wo, B_seg_len)
    return x
```

```asm
; @launch kernel=pack_kernel grid=(9840,1,1) block=(256,1,1) lds=0
; @launch kernel=ln_a1_kernel grid=(512,1,1) block=(256,1,1) lds=0
; @launch kernel=qkv_a_kernel grid=(192,1,1) block=(256,1,1) lds=0
; @launch kernel=kvz_a1_kernel grid=(128,1,1) block=(256,1,1) lds=0
; @launch kernel=attn_a1_kernel grid=(256,1,1) block=(256,1,1) lds=86016
; @launch kernel=wo_a1_kernel grid=(128,1,1) block=(256,1,1) lds=0
; @launch kernel=ln_b1_kernel grid=(512,1,1) block=(256,1,1) lds=0
; @launch kernel=qkv_b_kernel grid=(768,1,1) block=(256,1,1) lds=0
; @launch kernel=vvo_kernel grid=(256,1,1) block=(256,1,1) lds=0
; @launch kernel=clr_kernel grid=(880,1,1) block=(256,1,1) lds=0
; @launch kernel=chainz_kernel grid=(104,1,1) block=(256,1,1) lds=135168
; @launch kernel=attn_b_kernel grid=(512,1,1) block=(256,1,1) lds=0
; @launch kernel=wo_b1_kernel grid=(256,1,1) block=(256,1,1) lds=61440
; @launch kernel=ln_a2_kernel grid=(512,1,1) block=(256,1,1) lds=0
; @launch kernel=qkv_a_kernel grid=(192,1,1) block=(256,1,1) lds=0
; @launch kernel=kvz_a2_kernel grid=(128,1,1) block=(256,1,1) lds=0
; @launch kernel=attn_a2_kernel grid=(256,1,1) block=(256,1,1) lds=86016
; @launch kernel=wo_a2_kernel grid=(128,1,1) block=(256,1,1) lds=0
; @launch kernel=ln_b1_kernel grid=(512,1,1) block=(256,1,1) lds=0
; @launch kernel=qkv_b_kernel grid=(768,1,1) block=(256,1,1) lds=0
; @launch kernel=vvo_kernel grid=(256,1,1) block=(256,1,1) lds=0
; @launch kernel=clr_kernel grid=(880,1,1) block=(256,1,1) lds=0
; @launch kernel=chainz_kernel grid=(104,1,1) block=(256,1,1) lds=135168
; @launch kernel=attn_b_kernel grid=(512,1,1) block=(256,1,1) lds=0
; @launch kernel=wo_b2_kernel grid=(256,1,1) block=(256,1,1) lds=61440
.amdgcn_target "amdgcn-amd-amdhsa--gfx950"
.text
.globl pack_kernel
.p2align 8
.type pack_kernel,@function
pack_kernel:
    v_lshrrev_b32 v1, 6, v0
    v_and_b32 v2, 63, v0
    s_nop 0
    v_readfirstlane_b32 s3, v1
    s_lshl_b32 s4, s2, 2
    s_add_u32 s4, s4, s3
    s_load_dwordx2 s[6:7], s[0:1], 96
    s_waitcnt lgkmcnt(0)
    s_mov_b32 s8, s6
    s_mov_b32 s9, s7
    s_mov_b32 s10, 268435456
    s_mov_b32 s11, 0x00020000
    s_cmp_lt_u32 s4, 33920
    s_cbranch_scc1 pack_kernel_pk
    s_cmp_ge_u32 s4, 39360
    s_cbranch_scc1 pack_kernel_end
    s_sub_u32 s4, s4, 33920
    s_lshl_b32 s5, s4, 10
    v_lshlrev_b32 v3, 4, v2
    v_add_u32 v3, s5, v3
    v_add_u32 v4, 218103808, v3
    s_cmp_lt_u32 s5, 5308416
    s_cbranch_scc1 pack_kernel_clr
    v_add_u32 v4, 17760256, v3
pack_kernel_clr:
    v_mov_b32 v8, 0
    v_mov_b32 v9, 0
    v_mov_b32 v10, 0
    v_mov_b32 v11, 0
    buffer_store_dwordx4 v[8:11], v4, s[8:11], 0 offen
    s_branch pack_kernel_end
pack_kernel_pk:
    s_cmp_lt_u32 s4, 2400
    s_cbranch_scc0 pack_kernel_nx0
    s_sub_u32 s4, s4, 0
    s_load_dwordx2 s[12:13], s[0:1], 8
    s_mov_b32 s20, 1920
    s_mov_b32 s21, 20
    s_mov_b32 s22, 25165824
    s_mov_b32 s23, 2457600
    s_mul_i32 s24, s4, 1639
    s_lshr_b32 s24, s24, 15
    s_branch pack_kernel_go
pack_kernel_nx0:
    s_cmp_lt_u32 s4, 3200
    s_cbranch_scc0 pack_kernel_nx1
    s_sub_u32 s4, s4, 2400
    s_load_dwordx2 s[12:13], s[0:1], 16
    s_mov_b32 s20, 640
    s_mov_b32 s21, 20
    s_mov_b32 s22, 29360128
    s_mov_b32 s23, 819200
    s_mul_i32 s24, s4, 205
    s_lshr_b32 s24, s24, 12
    s_branch pack_kernel_go
pack_kernel_nx1:
    s_cmp_lt_u32 s4, 10880
    s_cbranch_scc0 pack_kernel_nx2
    s_sub_u32 s4, s4, 3200
    s_load_dwordx2 s[12:13], s[0:1], 40
    s_mov_b32 s20, 6144
    s_mov_b32 s21, 20
    s_mov_b32 s22, 33554432
    s_mov_b32 s23, 7864320
    s_mul_i32 s24, s4, 3277
    s_lshr_b32 s24, s24, 16
    s_branch pack_kernel_go
pack_kernel_nx2:
    s_cmp_lt_u32 s4, 18560
    s_cbranch_scc0 pack_kernel_nx3
    s_sub_u32 s4, s4, 10880
    s_load_dwordx2 s[12:13], s[0:1], 48
    s_mov_b32 s20, 6144
    s_mov_b32 s21, 20
    s_mov_b32 s22, 41418752
    s_mov_b32 s23, 7864320
    s_mul_i32 s24, s4, 3277
    s_lshr_b32 s24, s24, 16
    s_branch pack_kernel_go
pack_kernel_nx3:
    s_cmp_lt_u32 s4, 26240
    s_cbranch_scc0 pack_kernel_nx4
    s_sub_u32 s4, s4, 18560
    s_load_dwordx2 s[12:13], s[0:1], 56
    s_mov_b32 s20, 6144
    s_mov_b32 s21, 20
    s_mov_b32 s22, 49283072
    s_mov_b32 s23, 7864320
    s_mul_i32 s24, s4, 3277
    s_lshr_b32 s24, s24, 16
    s_branch pack_kernel_go
pack_kernel_nx4:
    s_cmp_lt_u32 s4, 33920
    s_cbranch_scc0 pack_kernel_nx5
    s_sub_u32 s4, s4, 26240
    s_load_dwordx2 s[12:13], s[0:1], 64
    s_mov_b32 s20, 640
    s_mov_b32 s21, 192
    s_mov_b32 s22, 58720256
    s_mov_b32 s23, 7864320
    s_mul_i32 s24, s4, 2731
    s_lshr_b32 s24, s24, 19
    s_branch pack_kernel_go
pack_kernel_nx5:
    s_branch pack_kernel_end
pack_kernel_go:
    s_waitcnt lgkmcnt(0)
    s_mov_b32 s16, s12
    s_mov_b32 s17, s13
    s_mov_b32 s18, s23
    s_mov_b32 s19, 0x00020000
    s_mul_i32 s25, s24, s21
    s_sub_u32 s25, s4, s25
    v_lshrrev_b32 v3, 4, v2
    v_lshlrev_b32 v3, 3, v3
    s_lshl_b32 s26, s25, 5
    v_add_u32 v3, s26, v3
    v_mul_lo_u32 v3, v3, s20
    v_and_b32 v4, 15, v2
    s_lshl_b32 s27, s24, 4
    v_add3_u32 v3, v3, v4, s27
    v_lshlrev_b32 v3, 1, v3
    s_lshl_b32 s28, s20, 1
    s_mov_b32 s29, 0
    buffer_load_ushort v12, v3, s[16:19], s29 offen
    s_add_u32 s29, s29, s28
    buffer_load_ushort v13, v3, s[16:19], s29 offen
    s_add_u32 s29, s29, s28
    buffer_load_ushort v14, v3, s[16:19], s29 offen
    s_add_u32 s29, s29, s28
    buffer_load_ushort v15, v3, s[16:19], s29 offen
    s_add_u32 s29, s29, s28
    buffer_load_ushort v16, v3, s[16:19], s29 offen
    s_add_u32 s29, s29, s28
    buffer_load_ushort v17, v3, s[16:19], s29 offen
    s_add_u32 s29, s29, s28
    buffer_load_ushort v18, v3, s[16:19], s29 offen
    s_add_u32 s29, s29, s28
    buffer_load_ushort v19, v3, s[16:19], s29 offen
    s_lshl_b32 s5, s4, 10
    s_add_u32 s5, s5, s22
    v_lshlrev_b32 v5, 4, v2
    v_add_u32 v5, s5, v5
    s_waitcnt vmcnt(0)
    v_lshl_or_b32 v8, v13, 16, v12
    v_lshl_or_b32 v9, v15, 16, v14
    v_lshl_or_b32 v10, v17, 16, v16
    v_lshl_or_b32 v11, v19, 16, v18
    buffer_store_dwordx4 v[8:11], v5, s[8:11], 0 offen
pack_kernel_end:
    s_endpgm
.section .rodata,"a"
.p2align 6
.amdhsa_kernel pack_kernel
  .amdhsa_next_free_vgpr 24
  .amdhsa_next_free_sgpr 40
  .amdhsa_accum_offset 24
  .amdhsa_group_segment_fixed_size 0
  .amdhsa_kernarg_size 104
  .amdhsa_user_sgpr_count 2
  .amdhsa_user_sgpr_kernarg_segment_ptr 1
  .amdhsa_system_sgpr_workgroup_id_x 1
.end_amdhsa_kernel
.text
.globl ln_a1_kernel
.p2align 8
.type ln_a1_kernel,@function
ln_a1_kernel:
    v_lshrrev_b32 v1, 6, v0
    v_and_b32 v2, 63, v0
    s_nop 0
    v_readfirstlane_b32 s3, v1
    s_lshl_b32 s4, s2, 2
    s_add_u32 s4, s4, s3
    s_cmp_ge_u32 s4, 2048
    s_cbranch_scc1 ln_a1_kernel_end
    s_load_dwordx2 s[6:7], s[0:1], 0
    s_load_dwordx2 s[12:13], s[0:1], 96
    s_waitcnt lgkmcnt(0)
    s_mov_b32 s8, s6
    s_mov_b32 s9, s7
    s_mov_b32 s10, 2621440
    s_mov_b32 s11, 0x00020000
    s_mov_b32 s16, s12
    s_mov_b32 s17, s13
    s_mov_b32 s18, 2621440
    s_mov_b32 s19, 0x00020000
    s_mul_i32 s5, s4, 1280
    v_lshlrev_b32 v3, 2, v2
    v_add_u32 v3, s5, v3
    buffer_load_dword v4, v3, s[8:11], 0 offen offset:0
    buffer_load_dword v5, v3, s[8:11], 0 offen offset:256
    buffer_load_dword v6, v3, s[8:11], 0 offen offset:512
    buffer_load_dword v7, v3, s[8:11], 0 offen offset:768
    buffer_load_dword v8, v3, s[8:11], 0 offen offset:1024
    s_waitcnt vmcnt(0)
    v_lshlrev_b32 v10, 16, v4
    v_and_b32 v11, 0xffff0000, v4
    v_lshlrev_b32 v12, 16, v5
    v_and_b32 v13, 0xffff0000, v5
    v_lshlrev_b32 v14, 16, v6
    v_and_b32 v15, 0xffff0000, v6
    v_lshlrev_b32 v16, 16, v7
    v_and_b32 v17, 0xffff0000, v7
    v_lshlrev_b32 v18, 16, v8
    v_and_b32 v19, 0xffff0000, v8
    v_add_f32 v20, v10, v11
    v_add_f32 v20, v20, v12
    v_add_f32 v20, v20, v13
    v_add_f32 v20, v20, v14
    v_add_f32 v20, v20, v15
    v_add_f32 v20, v20, v16
    v_add_f32 v20, v20, v17
    v_add_f32 v20, v20, v18
    v_add_f32 v20, v20, v19
    s_nop 1
    v_add_f32 v21, v20, v20 quad_perm:[1,0,3,2] row_mask:0xf bank_mask:0xf
    s_nop 1
    v_add_f32 v21, v21, v21 quad_perm:[2,3,0,1] row_mask:0xf bank_mask:0xf
    s_nop 1
    v_add_f32 v21, v21, v21 row_half_mirror row_mask:0xf bank_mask:0xf
    s_nop 1
    v_add_f32 v21, v21, v21 row_mirror row_mask:0xf bank_mask:0xf
    s_nop 1
    v_readlane_b32 s24, v21, 0
    v_readlane_b32 s25, v21, 16
    v_readlane_b32 s26, v21, 32
    v_readlane_b32 s27, v21, 48
    s_nop 1
    v_mov_b32 v20, s24
    v_add_f32 v20, s25, v20
    v_add_f32 v20, s26, v20
    v_add_f32 v20, s27, v20
    v_mul_f32 v20, 0.0015625, v20
    v_sub_f32 v10, v10, v20
    v_sub_f32 v11, v11, v20
    v_sub_f32 v12, v12, v20
    v_sub_f32 v13, v13, v20
    v_sub_f32 v14, v14, v20
    v_sub_f32 v15, v15, v20
    v_sub_f32 v16, v16, v20
    v_sub_f32 v17, v17, v20
    v_sub_f32 v18, v18, v20
    v_sub_f32 v19, v19, v20
    v_mul_f32 v21, v10, v10
    v_fmac_f32 v21, v11, v11
    v_fmac_f32 v21, v12, v12
    v_fmac_f32 v21, v13, v13
    v_fmac_f32 v21, v14, v14
    v_fmac_f32 v21, v15, v15
    v_fmac_f32 v21, v16, v16
    v_fmac_f32 v21, v17, v17
    v_fmac_f32 v21, v18, v18
    v_fmac_f32 v21, v19, v19
    s_nop 1
    v_add_f32 v22, v21, v21 quad_perm:[1,0,3,2] row_mask:0xf bank_mask:0xf
    s_nop 1
    v_add_f32 v22, v22, v22 quad_perm:[2,3,0,1] row_mask:0xf bank_mask:0xf
    s_nop 1
    v_add_f32 v22, v22, v22 row_half_mirror row_mask:0xf bank_mask:0xf
    s_nop 1
    v_add_f32 v22, v22, v22 row_mirror row_mask:0xf bank_mask:0xf
    s_nop 1
    v_readlane_b32 s24, v22, 0
    v_readlane_b32 s25, v22, 16
    v_readlane_b32 s26, v22, 32
    v_readlane_b32 s27, v22, 48
    s_nop 1
    v_mov_b32 v21, s24
    v_add_f32 v21, s25, v21
    v_add_f32 v21, s26, v21
    v_add_f32 v21, s27, v21
    v_mov_b32 v22, 0x3727c5ac
    v_fmac_f32 v22, 0.0015625, v21
    v_rsq_f32 v22, v22
    s_nop 0
    v_mul_f32 v10, v10, v22
    v_mul_f32 v11, v11, v22
    v_mul_f32 v12, v12, v22
    v_mul_f32 v13, v13, v22
    v_mul_f32 v14, v14, v22
    v_mul_f32 v15, v15, v22
    v_mul_f32 v16, v16, v22
    v_mul_f32 v17, v17, v22
    v_mul_f32 v18, v18, v22
    v_mul_f32 v19, v19, v22
    v_cvt_pk_bf16_f32 v4, v10, v11
    v_cvt_pk_bf16_f32 v5, v12, v13
    v_cvt_pk_bf16_f32 v6, v14, v15
    v_cvt_pk_bf16_f32 v7, v16, v17
    v_cvt_pk_bf16_f32 v8, v18, v19
    buffer_store_dword v4, v3, s[16:19], 0 offen offset:0
    buffer_store_dword v5, v3, s[16:19], 0 offen offset:256
    buffer_store_dword v6, v3, s[16:19], 0 offen offset:512
    buffer_store_dword v7, v3, s[16:19], 0 offen offset:768
    buffer_store_dword v8, v3, s[16:19], 0 offen offset:1024
ln_a1_kernel_end:
    s_endpgm
.section .rodata,"a"
.p2align 6
.amdhsa_kernel ln_a1_kernel
  .amdhsa_next_free_vgpr 32
  .amdhsa_next_free_sgpr 40
  .amdhsa_accum_offset 32
  .amdhsa_group_segment_fixed_size 0
  .amdhsa_kernarg_size 104
  .amdhsa_user_sgpr_count 2
  .amdhsa_user_sgpr_kernarg_segment_ptr 1
  .amdhsa_system_sgpr_workgroup_id_x 1
.end_amdhsa_kernel
.text
.globl qkv_a_kernel
.p2align 8
.type qkv_a_kernel,@function
qkv_a_kernel:
    v_lshrrev_b32 v1, 6, v0
    v_and_b32 v2, 63, v0
    s_nop 0
    v_readfirstlane_b32 s3, v1
    s_cmp_ge_u32 s2, 192
    s_cbranch_scc1 qkv_a_kernel_end
    s_load_dwordx2 s[4:5], s[0:1], 96
    s_load_dwordx2 s[6:7], s[0:1], 80
    s_mul_i32 s20, s2, 171
    s_lshr_b32 s20, s20, 12
    s_mul_i32 s21, s20, 24
    s_sub_u32 s21, s2, s21
    s_lshl_b32 s20, s20, 2
    s_add_u32 s20, s20, s3
    s_mul_i32 s22, s20, 64
    s_mul_i32 s23, s21, 80
    s_waitcnt lgkmcnt(0)
    s_mov_b32 s8, s4
    s_mov_b32 s9, s5
    s_mov_b32 s10, 268435456
    s_mov_b32 s11, 0x00020000
    v_and_b32 v3, 15, v2
    v_lshrrev_b32 v4, 4, v2
    s_mov_b32 s24, 1280
    v_add_u32 v5, s22, v3
    v_mul_lo_u32 v5, v5, s24
    v_lshlrev_b32 v6, 4, v4
    v_add_u32 v5, v5, v6
    v_add_u32 v5, 0, v5
    v_mov_b32 v8, v5
    v_add_u32 v9, 20480, v5
    v_add_u32 v10, 40960, v5
    v_add_u32 v11, 61440, v5
    v_lshlrev_b32 v7, 4, v2
    s_mov_b32 s25, 0
    s_mov_b32 s26, 0
    s_mul_i32 s27, s21, 102400
    s_add_u32 s27, s27, s26
    s_add_u32 s27, s27, 25165824
    s_add_u32 s32, s27, 0
    s_add_u32 s33, s27, 20480
    s_add_u32 s34, s27, 40960
    s_add_u32 s35, s27, 61440
    s_add_u32 s36, s27, 81920
    v_accvgpr_write_b32 a0, 0
    v_accvgpr_write_b32 a1, 0
    v_accvgpr_write_b32 a2, 0
    v_accvgpr_write_b32 a3, 0
    v_accvgpr_write_b32 a4, 0
    v_accvgpr_write_b32 a5, 0
    v_accvgpr_write_b32 a6, 0
    v_accvgpr_write_b32 a7, 0
    v_accvgpr_write_b32 a8, 0
    v_accvgpr_write_b32 a9, 0
    v_accvgpr_write_b32 a10, 0
    v_accvgpr_write_b32 a11, 0
    v_accvgpr_write_b32 a12, 0
    v_accvgpr_write_b32 a13, 0
    v_accvgpr_write_b32 a14, 0
    v_accvgpr_write_b32 a15, 0
    v_accvgpr_write_b32 a16, 0
    v_accvgpr_write_b32 a17, 0
    v_accvgpr_write_b32 a18, 0
    v_accvgpr_write_b32 a19, 0
    v_accvgpr_write_b32 a20, 0
    v_accvgpr_write_b32 a21, 0
    v_accvgpr_write_b32 a22, 0
    v_accvgpr_write_b32 a23, 0
    v_accvgpr_write_b32 a24, 0
    v_accvgpr_write_b32 a25, 0
    v_accvgpr_write_b32 a26, 0
    v_accvgpr_write_b32 a27, 0
    v_accvgpr_write_b32 a28, 0
    v_accvgpr_write_b32 a29, 0
    v_accvgpr_write_b32 a30, 0
    v_accvgpr_write_b32 a31, 0
    v_accvgpr_write_b32 a32, 0
    v_accvgpr_write_b32 a33, 0
    v_accvgpr_write_b32 a34, 0
    v_accvgpr_write_b32 a35, 0
    v_accvgpr_write_b32 a36, 0
    v_accvgpr_write_b32 a37, 0
    v_accvgpr_write_b32 a38, 0
    v_accvgpr_write_b32 a39, 0
    v_accvgpr_write_b32 a40, 0
    v_accvgpr_write_b32 a41, 0
    v_accvgpr_write_b32 a42, 0
    v_accvgpr_write_b32 a43, 0
    v_accvgpr_write_b32 a44, 0
    v_accvgpr_write_b32 a45, 0
    v_accvgpr_write_b32 a46, 0
    v_accvgpr_write_b32 a47, 0
    v_accvgpr_write_b32 a48, 0
    v_accvgpr_write_b32 a49, 0
    v_accvgpr_write_b32 a50, 0
    v_accvgpr_write_b32 a51, 0
    v_accvgpr_write_b32 a52, 0
    v_accvgpr_write_b32 a53, 0
    v_accvgpr_write_b32 a54, 0
    v_accvgpr_write_b32 a55, 0
    v_accvgpr_write_b32 a56, 0
    v_accvgpr_write_b32 a57, 0
    v_accvgpr_write_b32 a58, 0
    v_accvgpr_write_b32 a59, 0
    v_accvgpr_write_b32 a60, 0
    v_accvgpr_write_b32 a61, 0
    v_accvgpr_write_b32 a62, 0
    v_accvgpr_write_b32 a63, 0
    v_accvgpr_write_b32 a64, 0
    v_accvgpr_write_b32 a65, 0
    v_accvgpr_write_b32 a66, 0
    v_accvgpr_write_b32 a67, 0
    v_accvgpr_write_b32 a68, 0
    v_accvgpr_write_b32 a69, 0
    v_accvgpr_write_b32 a70, 0
    v_accvgpr_write_b32 a71, 0
    v_accvgpr_write_b32 a72, 0
    v_accvgpr_write_b32 a73, 0
    v_accvgpr_write_b32 a74, 0
    v_accvgpr_write_b32 a75, 0
    v_accvgpr_write_b32 a76, 0
    v_accvgpr_write_b32 a77, 0
    v_accvgpr_write_b32 a78, 0
    v_accvgpr_write_b32 a79, 0
    s_cmp_ge_u32 s23, 640
    s_cbranch_scc1 qkv_a_kernel_nrm
    buffer_load_dwordx4 v[16:19], v8, s[8:11], s25 offen
    buffer_load_dwordx4 v[20:23], v9, s[8:11], s25 offen
    buffer_load_dwordx4 v[24:27], v10, s[8:11], s25 offen
    buffer_load_dwordx4 v[28:31], v11, s[8:11], s25 offen
    buffer_load_dwordx4 v[32:35], v7, s[8:11], s32 offen
    buffer_load_dwordx4 v[36:39], v7, s[8:11], s33 offen
    buffer_load_dwordx4 v[40:43], v7, s[8:11], s34 offen
    buffer_load_dwordx4 v[44:47], v7, s[8:11], s35 offen
    buffer_load_dwordx4 v[48:51], v7, s[8:11], s36 offen
    s_mov_b32 s28, 10
qkv_a_kernel_loop0:
    s_add_u32 s25, s25, 64
    s_add_u32 s32, s32, 1024
    s_add_u32 s33, s33, 1024
    s_add_u32 s34, s34, 1024
    s_add_u32 s35, s35, 1024
    s_add_u32 s36, s36, 1024
    buffer_load_dwordx4 v[52:55], v8, s[8:11], s25 offen
    buffer_load_dwordx4 v[56:59], v9, s[8:11], s25 offen
    buffer_load_dwordx4 v[60:63], v10, s[8:11], s25 offen
    buffer_load_dwordx4 v[64:67], v11, s[8:11], s25 offen
    buffer_load_dwordx4 v[68:71], v7, s[8:11], s32 offen
    buffer_load_dwordx4 v[72:75], v7, s[8:11], s33 offen
    buffer_load_dwordx4 v[76:79], v7, s[8:11], s34 offen
    buffer_load_dwordx4 v[80:83], v7, s[8:11], s35 offen
    buffer_load_dwordx4 v[84:87], v7, s[8:11], s36 offen
    s_waitcnt vmcnt(9)
    v_mfma_f32_16x16x32_bf16 a[0:3], v[32:35], v[16:19], a[0:3]
    v_mfma_f32_16x16x32_bf16 a[20:23], v[32:35], v[20:23], a[20:23]
    v_mfma_f32_16x16x32_bf16 a[40:43], v[32:35], v[24:27], a[40:43]
    v_mfma_f32_16x16x32_bf16 a[60:63], v[32:35], v[28:31], a[60:63]
    v_mfma_f32_16x16x32_bf16 a[4:7], v[36:39], v[16:19], a[4:7]
    v_mfma_f32_16x16x32_bf16 a[24:27], v[36:39], v[20:23], a[24:27]
    v_mfma_f32_16x16x32_bf16 a[44:47], v[36:39], v[24:27], a[44:47]
    v_mfma_f32_16x16x32_bf16 a[64:67], v[36:39], v[28:31], a[64:67]
    v_mfma_f32_16x16x32_bf16 a[8:11], v[40:43], v[16:19], a[8:11]
    v_mfma_f32_16x16x32_bf16 a[28:31], v[40:43], v[20:23], a[28:31]
    v_mfma_f32_16x16x32_bf16 a[48:51], v[40:43], v[24:27], a[48:51]
    v_mfma_f32_16x16x32_bf16 a[68:71], v[40:43], v[28:31], a[68:71]
    v_mfma_f32_16x16x32_bf16 a[12:15], v[44:47], v[16:19], a[12:15]
    v_mfma_f32_16x16x32_bf16 a[32:35], v[44:47], v[20:23], a[32:35]
    v_mfma_f32_16x16x32_bf16 a[52:55], v[44:47], v[24:27], a[52:55]
    v_mfma_f32_16x16x32_bf16 a[72:75], v[44:47], v[28:31], a[72:75]
    v_mfma_f32_16x16x32_bf16 a[16:19], v[48:51], v[16:19], a[16:19]
    v_mfma_f32_16x16x32_bf16 a[36:39], v[48:51], v[20:23], a[36:39]
    v_mfma_f32_16x16x32_bf16 a[56:59], v[48:51], v[24:27], a[56:59]
    v_mfma_f32_16x16x32_bf16 a[76:79], v[48:51], v[28:31], a[76:79]
    s_sub_u32 s28, s28, 1
    s_cmp_eq_u32 s28, 0
    s_cbranch_scc1 qkv_a_kernel_loop0_last
    s_add_u32 s25, s25, 64
    s_add_u32 s32, s32, 1024
    s_add_u32 s33, s33, 1024
    s_add_u32 s34, s34, 1024
    s_add_u32 s35, s35, 1024
    s_add_u32 s36, s36, 1024
    buffer_load_dwordx4 v[16:19], v8, s[8:11], s25 offen
    buffer_load_dwordx4 v[20:23], v9, s[8:11], s25 offen
    buffer_load_dwordx4 v[24:27], v10, s[8:11], s25 offen
    buffer_load_dwordx4 v[28:31], v11, s[8:11], s25 offen
    buffer_load_dwordx4 v[32:35], v7, s[8:11], s32 offen
    buffer_load_dwordx4 v[36:39], v7, s[8:11], s33 offen
    buffer_load_dwordx4 v[40:43], v7, s[8:11], s34 offen
    buffer_load_dwordx4 v[44:47], v7, s[8:11], s35 offen
    buffer_load_dwordx4 v[48:51], v7, s[8:11], s36 offen
    s_waitcnt vmcnt(9)
    v_mfma_f32_16x16x32_bf16 a[0:3], v[68:71], v[52:55], a[0:3]
    v_mfma_f32_16x16x32_bf16 a[20:23], v[68:71], v[56:59], a[20:23]
    v_mfma_f32_16x16x32_bf16 a[40:43], v[68:71], v[60:63], a[40:43]
    v_mfma_f32_16x16x32_bf16 a[60:63], v[68:71], v[64:67], a[60:63]
    v_mfma_f32_16x16x32_bf16 a[4:7], v[72:75], v[52:55], a[4:7]
    v_mfma_f32_16x16x32_bf16 a[24:27], v[72:75], v[56:59], a[24:27]
    v_mfma_f32_16x16x32_bf16 a[44:47], v[72:75], v[60:63], a[44:47]
    v_mfma_f32_16x16x32_bf16 a[64:67], v[72:75], v[64:67], a[64:67]
    v_mfma_f32_16x16x32_bf16 a[8:11], v[76:79], v[52:55], a[8:11]
    v_mfma_f32_16x16x32_bf16 a[28:31], v[76:79], v[56:59], a[28:31]
    v_mfma_f32_16x16x32_bf16 a[48:51], v[76:79], v[60:63], a[48:51]
    v_mfma_f32_16x16x32_bf16 a[68:71], v[76:79], v[64:67], a[68:71]
    v_mfma_f32_16x16x32_bf16 a[12:15], v[80:83], v[52:55], a[12:15]
    v_mfma_f32_16x16x32_bf16 a[32:35], v[80:83], v[56:59], a[32:35]
    v_mfma_f32_16x16x32_bf16 a[52:55], v[80:83], v[60:63], a[52:55]
    v_mfma_f32_16x16x32_bf16 a[72:75], v[80:83], v[64:67], a[72:75]
    v_mfma_f32_16x16x32_bf16 a[16:19], v[84:87], v[52:55], a[16:19]
    v_mfma_f32_16x16x32_bf16 a[36:39], v[84:87], v[56:59], a[36:39]
    v_mfma_f32_16x16x32_bf16 a[56:59], v[84:87], v[60:63], a[56:59]
    v_mfma_f32_16x16x32_bf16 a[76:79], v[84:87], v[64:67], a[76:79]
    s_branch qkv_a_kernel_loop0
qkv_a_kernel_loop0_last:
    s_waitcnt vmcnt(0)
    v_mfma_f32_16x16x32_bf16 a[0:3], v[68:71], v[52:55], a[0:3]
    v_mfma_f32_16x16x32_bf16 a[20:23], v[68:71], v[56:59], a[20:23]
    v_mfma_f32_16x16x32_bf16 a[40:43], v[68:71], v[60:63], a[40:43]
    v_mfma_f32_16x16x32_bf16 a[60:63], v[68:71], v[64:67], a[60:63]
    v_mfma_f32_16x16x32_bf16 a[4:7], v[72:75], v[52:55], a[4:7]
    v_mfma_f32_16x16x32_bf16 a[24:27], v[72:75], v[56:59], a[24:27]
    v_mfma_f32_16x16x32_bf16 a[44:47], v[72:75], v[60:63], a[44:47]
    v_mfma_f32_16x16x32_bf16 a[64:67], v[72:75], v[64:67], a[64:67]
    v_mfma_f32_16x16x32_bf16 a[8:11], v[76:79], v[52:55], a[8:11]
    v_mfma_f32_16x16x32_bf16 a[28:31], v[76:79], v[56:59], a[28:31]
    v_mfma_f32_16x16x32_bf16 a[48:51], v[76:79], v[60:63], a[48:51]
    v_mfma_f32_16x16x32_bf16 a[68:71], v[76:79], v[64:67], a[68:71]
    v_mfma_f32_16x16x32_bf16 a[12:15], v[80:83], v[52:55], a[12:15]
    v_mfma_f32_16x16x32_bf16 a[32:35], v[80:83], v[56:59], a[32:35]
    v_mfma_f32_16x16x32_bf16 a[52:55], v[80:83], v[60:63], a[52:55]
    v_mfma_f32_16x16x32_bf16 a[72:75], v[80:83], v[64:67], a[72:75]
    v_mfma_f32_16x16x32_bf16 a[16:19], v[84:87], v[52:55], a[16:19]
    v_mfma_f32_16x16x32_bf16 a[36:39], v[84:87], v[56:59], a[36:39]
    v_mfma_f32_16x16x32_bf16 a[56:59], v[84:87], v[60:63], a[56:59]
    v_mfma_f32_16x16x32_bf16 a[76:79], v[84:87], v[64:67], a[76:79]
    s_nop 7
    s_nop 7
    s_mov_b32 s24, 1280
    s_lshl_b32 s29, s23, 1
    s_add_u32 s29, s29, 8388608
    v_add_u32 v5, s22, v3
    v_mul_lo_u32 v5, v5, s24
    v_lshlrev_b32 v6, 3, v4
    v_add3_u32 v5, v5, v6, s29
    v_accvgpr_read_b32 v92, a0
    v_accvgpr_read_b32 v93, a1
    v_accvgpr_read_b32 v94, a2
    v_accvgpr_read_b32 v95, a3
    v_cvt_pk_bf16_f32 v96, v92, v93
    v_cvt_pk_bf16_f32 v97, v94, v95
    v_add_u32 v6, 0, v5
    buffer_store_dwordx2 v[96:97], v6, s[8:11], 0 offen
    v_accvgpr_read_b32 v92, a4
    v_accvgpr_read_b32 v93, a5
    v_accvgpr_read_b32 v94, a6
    v_accvgpr_read_b32 v95, a7
    v_cvt_pk_bf16_f32 v96, v92, v93
    v_cvt_pk_bf16_f32 v97, v94, v95
    v_add_u32 v6, 32, v5
    buffer_store_dwordx2 v[96:97], v6, s[8:11], 0 offen
    v_accvgpr_read_b32 v92, a8
    v_accvgpr_read_b32 v93, a9
    v_accvgpr_read_b32 v94, a10
    v_accvgpr_read_b32 v95, a11
    v_cvt_pk_bf16_f32 v96, v92, v93
    v_cvt_pk_bf16_f32 v97, v94, v95
    v_add_u32 v6, 64, v5
    buffer_store_dwordx2 v[96:97], v6, s[8:11], 0 offen
    v_accvgpr_read_b32 v92, a12
    v_accvgpr_read_b32 v93, a13
    v_accvgpr_read_b32 v94, a14
    v_accvgpr_read_b32 v95, a15
    v_cvt_pk_bf16_f32 v96, v92, v93
    v_cvt_pk_bf16_f32 v97, v94, v95
    v_add_u32 v6, 96, v5
    buffer_store_dwordx2 v[96:97], v6, s[8:11], 0 offen
    v_accvgpr_read_b32 v92, a16
    v_accvgpr_read_b32 v93, a17
    v_accvgpr_read_b32 v94, a18
    v_accvgpr_read_b32 v95, a19
    v_cvt_pk_bf16_f32 v96, v92, v93
    v_cvt_pk_bf16_f32 v97, v94, v95
    v_add_u32 v6, 128, v5
    buffer_store_dwordx2 v[96:97], v6, s[8:11], 0 offen
    v_accvgpr_read_b32 v92, a20
    v_accvgpr_read_b32 v93, a21
    v_accvgpr_read_b32 v94, a22
    v_accvgpr_read_b32 v95, a23
    v_cvt_pk_bf16_f32 v96, v92, v93
    v_cvt_pk_bf16_f32 v97, v94, v95
    v_add_u32 v6, 20480, v5
    buffer_store_dwordx2 v[96:97], v6, s[8:11], 0 offen
    v_accvgpr_read_b32 v92, a24
    v_accvgpr_read_b32 v93, a25
    v_accvgpr_read_b32 v94, a26
    v_accvgpr_read_b32 v95, a27
    v_cvt_pk_bf16_f32 v96, v92, v93
    v_cvt_pk_bf16_f32 v97, v94, v95
    v_add_u32 v6, 20512, v5
    buffer_store_dwordx2 v[96:97], v6, s[8:11], 0 offen
    v_accvgpr_read_b32 v92, a28
    v_accvgpr_read_b32 v93, a29
    v_accvgpr_read_b32 v94, a30
    v_accvgpr_read_b32 v95, a31
    v_cvt_pk_bf16_f32 v96, v92, v93
    v_cvt_pk_bf16_f32 v97, v94, v95
    v_add_u32 v6, 20544, v5
    buffer_store_dwordx2 v[96:97], v6, s[8:11], 0 offen
    v_accvgpr_read_b32 v92, a32
    v_accvgpr_read_b32 v93, a33
    v_accvgpr_read_b32 v94, a34
    v_accvgpr_read_b32 v95, a35
    v_cvt_pk_bf16_f32 v96, v92, v93
    v_cvt_pk_bf16_f32 v97, v94, v95
    v_add_u32 v6, 20576, v5
    buffer_store_dwordx2 v[96:97], v6, s[8:11], 0 offen
    v_accvgpr_read_b32 v92, a36
    v_accvgpr_read_b32 v93, a37
    v_accvgpr_read_b32 v94, a38
    v_accvgpr_read_b32 v95, a39
    v_cvt_pk_bf16_f32 v96, v92, v93
    v_cvt_pk_bf16_f32 v97, v94, v95
    v_add_u32 v6, 20608, v5
    buffer_store_dwordx2 v[96:97], v6, s[8:11], 0 offen
    v_accvgpr_read_b32 v92, a40
    v_accvgpr_read_b32 v93, a41
    v_accvgpr_read_b32 v94, a42
    v_accvgpr_read_b32 v95, a43
    v_cvt_pk_bf16_f32 v96, v92, v93
    v_cvt_pk_bf16_f32 v97, v94, v95
    v_add_u32 v6, 40960, v5
    buffer_store_dwordx2 v[96:97], v6, s[8:11], 0 offen
    v_accvgpr_read_b32 v92, a44
    v_accvgpr_read_b32 v93, a45
    v_accvgpr_read_b32 v94, a46
    v_accvgpr_read_b32 v95, a47
    v_cvt_pk_bf16_f32 v96, v92, v93
    v_cvt_pk_bf16_f32 v97, v94, v95
    v_add_u32 v6, 40992, v5
    buffer_store_dwordx2 v[96:97], v6, s[8:11], 0 offen
    v_accvgpr_read_b32 v92, a48
    v_accvgpr_read_b32 v93, a49
    v_accvgpr_read_b32 v94, a50
    v_accvgpr_read_b32 v95, a51
    v_cvt_pk_bf16_f32 v96, v92, v93
    v_cvt_pk_bf16_f32 v97, v94, v95
    v_add_u32 v6, 41024, v5
    buffer_store_dwordx2 v[96:97], v6, s[8:11], 0 offen
    v_accvgpr_read_b32 v92, a52
    v_accvgpr_read_b32 v93, a53
    v_accvgpr_read_b32 v94, a54
    v_accvgpr_read_b32 v95, a55
    v_cvt_pk_bf16_f32 v96, v92, v93
    v_cvt_pk_bf16_f32 v97, v94, v95
    v_add_u32 v6, 41056, v5
    buffer_store_dwordx2 v[96:97], v6, s[8:11], 0 offen
    v_accvgpr_read_b32 v92, a56
    v_accvgpr_read_b32 v93, a57
    v_accvgpr_read_b32 v94, a58
    v_accvgpr_read_b32 v95, a59
    v_cvt_pk_bf16_f32 v96, v92, v93
    v_cvt_pk_bf16_f32 v97, v94, v95
    v_add_u32 v6, 41088, v5
    buffer_store_dwordx2 v[96:97], v6, s[8:11], 0 offen
    v_accvgpr_read_b32 v92, a60
    v_accvgpr_read_b32 v93, a61
    v_accvgpr_read_b32 v94, a62
    v_accvgpr_read_b32 v95, a63
    v_cvt_pk_bf16_f32 v96, v92, v93
    v_cvt_pk_bf16_f32 v97, v94, v95
    v_add_u32 v6, 61440, v5
    buffer_store_dwordx2 v[96:97], v6, s[8:11], 0 offen
    v_accvgpr_read_b32 v92, a64
    v_accvgpr_read_b32 v93, a65
    v_accvgpr_read_b32 v94, a66
    v_accvgpr_read_b32 v95, a67
    v_cvt_pk_bf16_f32 v96, v92, v93
    v_cvt_pk_bf16_f32 v97, v94, v95
    v_add_u32 v6, 61472, v5
    buffer_store_dwordx2 v[96:97], v6, s[8:11], 0 offen
    v_accvgpr_read_b32 v92, a68
    v_accvgpr_read_b32 v93, a69
    v_accvgpr_read_b32 v94, a70
    v_accvgpr_read_b32 v95, a71
    v_cvt_pk_bf16_f32 v96, v92, v93
    v_cvt_pk_bf16_f32 v97, v94, v95
    v_add_u32 v6, 61504, v5
    buffer_store_dwordx2 v[96:97], v6, s[8:11], 0 offen
    v_accvgpr_read_b32 v92, a72
    v_accvgpr_read_b32 v93, a73
    v_accvgpr_read_b32 v94, a74
    v_accvgpr_read_b32 v95, a75
    v_cvt_pk_bf16_f32 v96, v92, v93
    v_cvt_pk_bf16_f32 v97, v94, v95
    v_add_u32 v6, 61536, v5
    buffer_store_dwordx2 v[96:97], v6, s[8:11], 0 offen
    v_accvgpr_read_b32 v92, a76
    v_accvgpr_read_b32 v93, a77
    v_accvgpr_read_b32 v94, a78
    v_accvgpr_read_b32 v95, a79
    v_cvt_pk_bf16_f32 v96, v92, v93
    v_cvt_pk_bf16_f32 v97, v94, v95
    v_add_u32 v6, 61568, v5
    buffer_store_dwordx2 v[96:97], v6, s[8:11], 0 offen
    s_branch qkv_a_kernel_end
qkv_a_kernel_nrm:
    buffer_load_dwordx4 v[16:19], v8, s[8:11], s25 offen
    buffer_load_dwordx4 v[20:23], v9, s[8:11], s25 offen
    buffer_load_dwordx4 v[24:27], v10, s[8:11], s25 offen
    buffer_load_dwordx4 v[28:31], v11, s[8:11], s25 offen
    buffer_load_dwordx4 v[32:35], v7, s[8:11], s32 offen
    buffer_load_dwordx4 v[36:39], v7, s[8:11], s33 offen
    buffer_load_dwordx4 v[40:43], v7, s[8:11], s34 offen
    buffer_load_dwordx4 v[44:47], v7, s[8:11], s35 offen
    buffer_load_dwordx4 v[48:51], v7, s[8:11], s36 offen
    s_mov_b32 s28, 10
qkv_a_kernel_loop1:
    s_add_u32 s25, s25, 64
    s_add_u32 s32, s32, 1024
    s_add_u32 s33, s33, 1024
    s_add_u32 s34, s34, 1024
    s_add_u32 s35, s35, 1024
    s_add_u32 s36, s36, 1024
    buffer_load_dwordx4 v[52:55], v8, s[8:11], s25 offen
    buffer_load_dwordx4 v[56:59], v9, s[8:11], s25 offen
    buffer_load_dwordx4 v[60:63], v10, s[8:11], s25 offen
    buffer_load_dwordx4 v[64:67], v11, s[8:11], s25 offen
    buffer_load_dwordx4 v[68:71], v7, s[8:11], s32 offen
    buffer_load_dwordx4 v[72:75], v7, s[8:11], s33 offen
    buffer_load_dwordx4 v[76:79], v7, s[8:11], s34 offen
    buffer_load_dwordx4 v[80:83], v7, s[8:11], s35 offen
    buffer_load_dwordx4 v[84:87], v7, s[8:11], s36 offen
    s_waitcnt vmcnt(9)
    v_mfma_f32_16x16x32_bf16 a[0:3], v[16:19], v[32:35], a[0:3]
    v_mfma_f32_16x16x32_bf16 a[20:23], v[20:23], v[32:35], a[20:23]
    v_mfma_f32_16x16x32_bf16 a[40:43], v[24:27], v[32:35], a[40:43]
    v_mfma_f32_16x16x32_bf16 a[60:63], v[28:31], v[32:35], a[60:63]
    v_mfma_f32_16x16x32_bf16 a[4:7], v[16:19], v[36:39], a[4:7]
    v_mfma_f32_16x16x32_bf16 a[24:27], v[20:23], v[36:39], a[24:27]
    v_mfma_f32_16x16x32_bf16 a[44:47], v[24:27], v[36:39], a[44:47]
    v_mfma_f32_16x16x32_bf16 a[64:67], v[28:31], v[36:39], a[64:67]
    v_mfma_f32_16x16x32_bf16 a[8:11], v[16:19], v[40:43], a[8:11]
    v_mfma_f32_16x16x32_bf16 a[28:31], v[20:23], v[40:43], a[28:31]
    v_mfma_f32_16x16x32_bf16 a[48:51], v[24:27], v[40:43], a[48:51]
    v_mfma_f32_16x16x32_bf16 a[68:71], v[28:31], v[40:43], a[68:71]
    v_mfma_f32_16x16x32_bf16 a[12:15], v[16:19], v[44:47], a[12:15]
    v_mfma_f32_16x16x32_bf16 a[32:35], v[20:23], v[44:47], a[32:35]
    v_mfma_f32_16x16x32_bf16 a[52:55], v[24:27], v[44:47], a[52:55]
    v_mfma_f32_16x16x32_bf16 a[72:75], v[28:31], v[44:47], a[72:75]
    v_mfma_f32_16x16x32_bf16 a[16:19], v[16:19], v[48:51], a[16:19]
    v_mfma_f32_16x16x32_bf16 a[36:39], v[20:23], v[48:51], a[36:39]
    v_mfma_f32_16x16x32_bf16 a[56:59], v[24:27], v[48:51], a[56:59]
    v_mfma_f32_16x16x32_bf16 a[76:79], v[28:31], v[48:51], a[76:79]
    s_sub_u32 s28, s28, 1
    s_cmp_eq_u32 s28, 0
    s_cbranch_scc1 qkv_a_kernel_loop1_last
    s_add_u32 s25, s25, 64
    s_add_u32 s32, s32, 1024
    s_add_u32 s33, s33, 1024
    s_add_u32 s34, s34, 1024
    s_add_u32 s35, s35, 1024
    s_add_u32 s36, s36, 1024
    buffer_load_dwordx4 v[16:19], v8, s[8:11], s25 offen
    buffer_load_dwordx4 v[20:23], v9, s[8:11], s25 offen
    buffer_load_dwordx4 v[24:27], v10, s[8:11], s25 offen
    buffer_load_dwordx4 v[28:31], v11, s[8:11], s25 offen
    buffer_load_dwordx4 v[32:35], v7, s[8:11], s32 offen
    buffer_load_dwordx4 v[36:39], v7, s[8:11], s33 offen
    buffer_load_dwordx4 v[40:43], v7, s[8:11], s34 offen
    buffer_load_dwordx4 v[44:47], v7, s[8:11], s35 offen
    buffer_load_dwordx4 v[48:51], v7, s[8:11], s36 offen
    s_waitcnt vmcnt(9)
    v_mfma_f32_16x16x32_bf16 a[0:3], v[52:55], v[68:71], a[0:3]
    v_mfma_f32_16x16x32_bf16 a[20:23], v[56:59], v[68:71], a[20:23]
    v_mfma_f32_16x16x32_bf16 a[40:43], v[60:63], v[68:71], a[40:43]
    v_mfma_f32_16x16x32_bf16 a[60:63], v[64:67], v[68:71], a[60:63]
    v_mfma_f32_16x16x32_bf16 a[4:7], v[52:55], v[72:75], a[4:7]
    v_mfma_f32_16x16x32_bf16 a[24:27], v[56:59], v[72:75], a[24:27]
    v_mfma_f32_16x16x32_bf16 a[44:47], v[60:63], v[72:75], a[44:47]
    v_mfma_f32_16x16x32_bf16 a[64:67], v[64:67], v[72:75], a[64:67]
    v_mfma_f32_16x16x32_bf16 a[8:11], v[52:55], v[76:79], a[8:11]
    v_mfma_f32_16x16x32_bf16 a[28:31], v[56:59], v[76:79], a[28:31]
    v_mfma_f32_16x16x32_bf16 a[48:51], v[60:63], v[76:79], a[48:51]
    v_mfma_f32_16x16x32_bf16 a[68:71], v[64:67], v[76:79], a[68:71]
    v_mfma_f32_16x16x32_bf16 a[12:15], v[52:55], v[80:83], a[12:15]
    v_mfma_f32_16x16x32_bf16 a[32:35], v[56:59], v[80:83], a[32:35]
    v_mfma_f32_16x16x32_bf16 a[52:55], v[60:63], v[80:83], a[52:55]
    v_mfma_f32_16x16x32_bf16 a[72:75], v[64:67], v[80:83], a[72:75]
    v_mfma_f32_16x16x32_bf16 a[16:19], v[52:55], v[84:87], a[16:19]
    v_mfma_f32_16x16x32_bf16 a[36:39], v[56:59], v[84:87], a[36:39]
    v_mfma_f32_16x16x32_bf16 a[56:59], v[60:63], v[84:87], a[56:59]
    v_mfma_f32_16x16x32_bf16 a[76:79], v[64:67], v[84:87], a[76:79]
    s_branch qkv_a_kernel_loop1
qkv_a_kernel_loop1_last:
    s_waitcnt vmcnt(0)
    v_mfma_f32_16x16x32_bf16 a[0:3], v[52:55], v[68:71], a[0:3]
    v_mfma_f32_16x16x32_bf16 a[20:23], v[56:59], v[68:71], a[20:23]
    v_mfma_f32_16x16x32_bf16 a[40:43], v[60:63], v[68:71], a[40:43]
    v_mfma_f32_16x16x32_bf16 a[60:63], v[64:67], v[68:71], a[60:63]
    v_mfma_f32_16x16x32_bf16 a[4:7], v[52:55], v[72:75], a[4:7]
    v_mfma_f32_16x16x32_bf16 a[24:27], v[56:59], v[72:75], a[24:27]
    v_mfma_f32_16x16x32_bf16 a[44:47], v[60:63], v[72:75], a[44:47]
    v_mfma_f32_16x16x32_bf16 a[64:67], v[64:67], v[72:75], a[64:67]
    v_mfma_f32_16x16x32_bf16 a[8:11], v[52:55], v[76:79], a[8:11]
    v_mfma_f32_16x16x32_bf16 a[28:31], v[56:59], v[76:79], a[28:31]
    v_mfma_f32_16x16x32_bf16 a[48:51], v[60:63], v[76:79], a[48:51]
    v_mfma_f32_16x16x32_bf16 a[68:71], v[64:67], v[76:79], a[68:71]
    v_mfma_f32_16x16x32_bf16 a[12:15], v[52:55], v[80:83], a[12:15]
    v_mfma_f32_16x16x32_bf16 a[32:35], v[56:59], v[80:83], a[32:35]
    v_mfma_f32_16x16x32_bf16 a[52:55], v[60:63], v[80:83], a[52:55]
    v_mfma_f32_16x16x32_bf16 a[72:75], v[64:67], v[80:83], a[72:75]
    v_mfma_f32_16x16x32_bf16 a[16:19], v[52:55], v[84:87], a[16:19]
    v_mfma_f32_16x16x32_bf16 a[36:39], v[56:59], v[84:87], a[36:39]
    v_mfma_f32_16x16x32_bf16 a[56:59], v[60:63], v[84:87], a[56:59]
    v_mfma_f32_16x16x32_bf16 a[76:79], v[64:67], v[84:87], a[76:79]
    s_nop 7
    s_nop 7
    s_sub_u32 s29, s23, 640
    v_add_u32 v5, s29, v3
    v_lshlrev_b32 v5, 11, v5
    v_lshlrev_b32 v6, 2, v4
    v_add3_u32 v5, v5, v6, s22
    v_lshlrev_b32 v5, 1, v5
    v_add_u32 v5, 12582912, v5
    v_accvgpr_read_b32 v92, a0
    v_accvgpr_read_b32 v93, a1
    v_accvgpr_read_b32 v94, a2
    v_accvgpr_read_b32 v95, a3
    v_cvt_pk_bf16_f32 v96, v92, v93
    v_cvt_pk_bf16_f32 v97, v94, v95
    v_add_u32 v6, 0, v5
    buffer_store_dwordx2 v[96:97], v6, s[8:11], 0 offen
    v_accvgpr_read_b32 v92, a4
    v_accvgpr_read_b32 v93, a5
    v_accvgpr_read_b32 v94, a6
    v_accvgpr_read_b32 v95, a7
    v_cvt_pk_bf16_f32 v96, v92, v93
    v_cvt_pk_bf16_f32 v97, v94, v95
    v_add_u32 v6, 65536, v5
    buffer_store_dwordx2 v[96:97], v6, s[8:11], 0 offen
    v_accvgpr_read_b32 v92, a8
    v_accvgpr_read_b32 v93, a9
    v_accvgpr_read_b32 v94, a10
    v_accvgpr_read_b32 v95, a11
    v_cvt_pk_bf16_f32 v96, v92, v93
    v_cvt_pk_bf16_f32 v97, v94, v95
    v_add_u32 v6, 131072, v5
    buffer_store_dwordx2 v[96:97], v6, s[8:11], 0 offen
    v_accvgpr_read_b32 v92, a12
    v_accvgpr_read_b32 v93, a13
    v_accvgpr_read_b32 v94, a14
    v_accvgpr_read_b32 v95, a15
    v_cvt_pk_bf16_f32 v96, v92, v93
    v_cvt_pk_bf16_f32 v97, v94, v95
    v_add_u32 v6, 196608, v5
    buffer_store_dwordx2 v[96:97], v6, s[8:11], 0 offen
    v_accvgpr_read_b32 v92, a16
    v_accvgpr_read_b32 v93, a17
    v_accvgpr_read_b32 v94, a18
    v_accvgpr_read_b32 v95, a19
    v_cvt_pk_bf16_f32 v96, v92, v93
    v_cvt_pk_bf16_f32 v97, v94, v95
    v_add_u32 v6, 262144, v5
    buffer_store_dwordx2 v[96:97], v6, s[8:11], 0 offen
    v_accvgpr_read_b32 v92, a20
    v_accvgpr_read_b32 v93, a21
    v_accvgpr_read_b32 v94, a22
    v_accvgpr_read_b32 v95, a23
    v_cvt_pk_bf16_f32 v96, v92, v93
    v_cvt_pk_bf16_f32 v97, v94, v95
    v_add_u32 v6, 32, v5
    buffer_store_dwordx2 v[96:97], v6, s[8:11], 0 offen
    v_accvgpr_read_b32 v92, a24
    v_accvgpr_read_b32 v93, a25
    v_accvgpr_read_b32 v94, a26
    v_accvgpr_read_b32 v95, a27
    v_cvt_pk_bf16_f32 v96, v92, v93
    v_cvt_pk_bf16_f32 v97, v94, v95
    v_add_u32 v6, 65568, v5
    buffer_store_dwordx2 v[96:97], v6, s[8:11], 0 offen
    v_accvgpr_read_b32 v92, a28
    v_accvgpr_read_b32 v93, a29
    v_accvgpr_read_b32 v94, a30
    v_accvgpr_read_b32 v95, a31
    v_cvt_pk_bf16_f32 v96, v92, v93
    v_cvt_pk_bf16_f32 v97, v94, v95
    v_add_u32 v6, 131104, v5
    buffer_store_dwordx2 v[96:97], v6, s[8:11], 0 offen
    v_accvgpr_read_b32 v92, a32
    v_accvgpr_read_b32 v93, a33
    v_accvgpr_read_b32 v94, a34
    v_accvgpr_read_b32 v95, a35
    v_cvt_pk_bf16_f32 v96, v92, v93
    v_cvt_pk_bf16_f32 v97, v94, v95
    v_add_u32 v6, 196640, v5
    buffer_store_dwordx2 v[96:97], v6, s[8:11], 0 offen
    v_accvgpr_read_b32 v92, a36
    v_accvgpr_read_b32 v93, a37
    v_accvgpr_read_b32 v94, a38
    v_accvgpr_read_b32 v95, a39
    v_cvt_pk_bf16_f32 v96, v92, v93
    v_cvt_pk_bf16_f32 v97, v94, v95
    v_add_u32 v6, 262176, v5
    buffer_store_dwordx2 v[96:97], v6, s[8:11], 0 offen
    v_accvgpr_read_b32 v92, a40
    v_accvgpr_read_b32 v93, a41
    v_accvgpr_read_b32 v94, a42
    v_accvgpr_read_b32 v95, a43
    v_cvt_pk_bf16_f32 v96, v92, v93
    v_cvt_pk_bf16_f32 v97, v94, v95
    v_add_u32 v6, 64, v5
    buffer_store_dwordx2 v[96:97], v6, s[8:11], 0 offen
    v_accvgpr_read_b32 v92, a44
    v_accvgpr_read_b32 v93, a45
    v_accvgpr_read_b32 v94, a46
    v_accvgpr_read_b32 v95, a47
    v_cvt_pk_bf16_f32 v96, v92, v93
    v_cvt_pk_bf16_f32 v97, v94, v95
    v_add_u32 v6, 65600, v5
    buffer_store_dwordx2 v[96:97], v6, s[8:11], 0 offen
    v_accvgpr_read_b32 v92, a48
    v_accvgpr_read_b32 v93, a49
    v_accvgpr_read_b32 v94, a50
    v_accvgpr_read_b32 v95, a51
    v_cvt_pk_bf16_f32 v96, v92, v93
    v_cvt_pk_bf16_f32 v97, v94, v95
    v_add_u32 v6, 131136, v5
    buffer_store_dwordx2 v[96:97], v6, s[8:11], 0 offen
    v_accvgpr_read_b32 v92, a52
    v_accvgpr_read_b32 v93, a53
    v_accvgpr_read_b32 v94, a54
    v_accvgpr_read_b32 v95, a55
    v_cvt_pk_bf16_f32 v96, v92, v93
    v_cvt_pk_bf16_f32 v97, v94, v95
    v_add_u32 v6, 196672, v5
    buffer_store_dwordx2 v[96:97], v6, s[8:11], 0 offen
    v_accvgpr_read_b32 v92, a56
    v_accvgpr_read_b32 v93, a57
    v_accvgpr_read_b32 v94, a58
    v_accvgpr_read_b32 v95, a59
    v_cvt_pk_bf16_f32 v96, v92, v93
    v_cvt_pk_bf16_f32 v97, v94, v95
    v_add_u32 v6, 262208, v5
    buffer_store_dwordx2 v[96:97], v6, s[8:11], 0 offen
    v_accvgpr_read_b32 v92, a60
    v_accvgpr_read_b32 v93, a61
    v_accvgpr_read_b32 v94, a62
    v_accvgpr_read_b32 v95, a63
    v_cvt_pk_bf16_f32 v96, v92, v93
    v_cvt_pk_bf16_f32 v97, v94, v95
    v_add_u32 v6, 96, v5
    buffer_store_dwordx2 v[96:97], v6, s[8:11], 0 offen
    v_accvgpr_read_b32 v92, a64
    v_accvgpr_read_b32 v93, a65
    v_accvgpr_read_b32 v94, a66
    v_accvgpr_read_b32 v95, a67
    v_cvt_pk_bf16_f32 v96, v92, v93
    v_cvt_pk_bf16_f32 v97, v94, v95
    v_add_u32 v6, 65632, v5
    buffer_store_dwordx2 v[96:97], v6, s[8:11], 0 offen
    v_accvgpr_read_b32 v92, a68
    v_accvgpr_read_b32 v93, a69
    v_accvgpr_read_b32 v94, a70
    v_accvgpr_read_b32 v95, a71
    v_cvt_pk_bf16_f32 v96, v92, v93
    v_cvt_pk_bf16_f32 v97, v94, v95
    v_add_u32 v6, 131168, v5
    buffer_store_dwordx2 v[96:97], v6, s[8:11], 0 offen
    v_accvgpr_read_b32 v92, a72
    v_accvgpr_read_b32 v93, a73
    v_accvgpr_read_b32 v94, a74
    v_accvgpr_read_b32 v95, a75
    v_cvt_pk_bf16_f32 v96, v92, v93
    v_cvt_pk_bf16_f32 v97, v94, v95
    v_add_u32 v6, 196704, v5
    buffer_store_dwordx2 v[96:97], v6, s[8:11], 0 offen
    v_accvgpr_read_b32 v92, a76
    v_accvgpr_read_b32 v93, a77
    v_accvgpr_read_b32 v94, a78
    v_accvgpr_read_b32 v95, a79
    v_cvt_pk_bf16_f32 v96, v92, v93
    v_cvt_pk_bf16_f32 v97, v94, v95
    v_add_u32 v6, 262240, v5
    buffer_store_dwordx2 v[96:97], v6, s[8:11], 0 offen
qkv_a_kernel_end:
    s_endpgm
.section .rodata,"a"
.p2align 6
.amdhsa_kernel qkv_a_kernel
  .amdhsa_next_free_vgpr 192
  .amdhsa_next_free_sgpr 64
  .amdhsa_accum_offset 112
  .amdhsa_group_segment_fixed_size 0
  .amdhsa_kernarg_size 104
  .amdhsa_user_sgpr_count 2
  .amdhsa_user_sgpr_kernarg_segment_ptr 1
  .amdhsa_system_sgpr_workgroup_id_x 1
.end_amdhsa_kernel
.text
.globl kvz_a1_kernel
.p2align 8
.type kvz_a1_kernel,@function
kvz_a1_kernel:
    v_lshrrev_b32 v1, 6, v0
    v_and_b32 v2, 63, v0
    s_nop 0
    v_readfirstlane_b32 s3, v1
    s_lshl_b32 s4, s2, 2
    s_add_u32 s4, s4, s3
    s_cmp_ge_u32 s4, 512
    s_cbranch_scc1 kvz_a1_kernel_end
    s_load_dwordx2 s[6:7], s[0:1], 96
    s_waitcnt lgkmcnt(0)
    s_mov_b32 s8, s6
    s_mov_b32 s9, s7
    s_mov_b32 s10, 268435456
    s_mov_b32 s11, 0x00020000
    s_lshr_b32 s5, s4, 4
    s_and_b32 s12, s4, 15
    s_mul_i32 s13, s5, 20
    v_and_b32 v3, 15, v2
    v_lshrrev_b32 v4, 4, v2
    s_lshl_b32 s14, s12, 7
    v_lshlrev_b32 v5, 3, v4
    v_add_u32 v5, s14, v5
    v_add_u32 v6, 0, v3
    v_min_u32 v8, 19, v6
    v_add_u32 v8, s13, v8
    v_lshlrev_b32 v8, 11, v8
    v_add_u32 v8, v8, v5
    v_lshlrev_b32 v8, 1, v8
    v_add_u32 v8, 12582912, v8
    v_add_u32 v10, 2621440, v8
    v_add_u32 v7, 16, v3
    v_min_u32 v9, 19, v7
    v_add_u32 v9, s13, v9
    v_lshlrev_b32 v9, 11, v9
    v_add_u32 v9, v9, v5
    v_lshlrev_b32 v9, 1, v9
    v_add_u32 v9, 12582912, v9
    v_add_u32 v11, 2621440, v9
    v_accvgpr_write_b32 a0, 0
    v_accvgpr_write_b32 a1, 0
    v_accvgpr_write_b32 a2, 0
    v_accvgpr_write_b32 a3, 0
    v_accvgpr_write_b32 a4, 0
    v_accvgpr_write_b32 a5, 0
    v_accvgpr_write_b32 a6, 0
    v_accvgpr_write_b32 a7, 0
    v_accvgpr_write_b32 a8, 0
    v_accvgpr_write_b32 a9, 0
    v_accvgpr_write_b32 a10, 0
    v_accvgpr_write_b32 a11, 0
    v_accvgpr_write_b32 a12, 0
    v_accvgpr_write_b32 a13, 0
    v_accvgpr_write_b32 a14, 0
    v_accvgpr_write_b32 a15, 0
    v_cmp_gt_u32 s[16:17], 20, v7
    v_cmp_eq_u32 s[18:19], 20, v7
    buffer_load_dwordx4 v[16:19], v8, s[8:11], 0 offen offset:0
    buffer_load_dwordx4 v[24:27], v10, s[8:11], 0 offen offset:0
    buffer_load_dwordx4 v[20:23], v9, s[8:11], 0 offen offset:0
    buffer_load_dwordx4 v[28:31], v11, s[8:11], 0 offen offset:0
    s_waitcnt vmcnt(0)
    v_lshlrev_b32 v32, 16, v16
    v_and_b32 v33, 0xffff0000, v16
    v_mul_f32 v36, 1.4426950408889634, v32
    v_exp_f32 v36, v36
    v_add_f32 v34, 1.0, v32
    v_cmp_lt_f32 vcc, 0, v32
    s_nop 1
    v_cndmask_b32 v34, v36, v34, vcc
    v_add_f32 v34, 0x358637bd, v34
    v_mul_f32 v36, 1.4426950408889634, v33
    v_exp_f32 v36, v36
    v_add_f32 v35, 1.0, v33
    v_cmp_lt_f32 vcc, 0, v33
    s_nop 1
    v_cndmask_b32 v35, v36, v35, vcc
    v_add_f32 v35, 0x358637bd, v35
    v_cvt_pk_bf16_f32 v16, v34, v35
    v_lshlrev_b32 v32, 16, v17
    v_and_b32 v33, 0xffff0000, v17
    v_mul_f32 v36, 1.4426950408889634, v32
    v_exp_f32 v36, v36
    v_add_f32 v34, 1.0, v32
    v_cmp_lt_f32 vcc, 0, v32
    s_nop 1
    v_cndmask_b32 v34, v36, v34, vcc
    v_add_f32 v34, 0x358637bd, v34
    v_mul_f32 v36, 1.4426950408889634, v33
    v_exp_f32 v36, v36
    v_add_f32 v35, 1.0, v33
    v_cmp_lt_f32 vcc, 0, v33
    s_nop 1
    v_cndmask_b32 v35, v36, v35, vcc
    v_add_f32 v35, 0x358637bd, v35
    v_cvt_pk_bf16_f32 v17, v34, v35
    v_lshlrev_b32 v32, 16, v18
    v_and_b32 v33, 0xffff0000, v18
    v_mul_f32 v36, 1.4426950408889634, v32
    v_exp_f32 v36, v36
    v_add_f32 v34, 1.0, v32
    v_cmp_lt_f32 vcc, 0, v32
    s_nop 1
    v_cndmask_b32 v34, v36, v34, vcc
    v_add_f32 v34, 0x358637bd, v34
    v_mul_f32 v36, 1.4426950408889634, v33
    v_exp_f32 v36, v36
    v_add_f32 v35, 1.0, v33
    v_cmp_lt_f32 vcc, 0, v33
    s_nop 1
    v_cndmask_b32 v35, v36, v35, vcc
    v_add_f32 v35, 0x358637bd, v35
    v_cvt_pk_bf16_f32 v18, v34, v35
    v_lshlrev_b32 v32, 16, v19
    v_and_b32 v33, 0xffff0000, v19
    v_mul_f32 v36, 1.4426950408889634, v32
    v_exp_f32 v36, v36
    v_add_f32 v34, 1.0, v32
    v_cmp_lt_f32 vcc, 0, v32
    s_nop 1
    v_cndmask_b32 v34, v36, v34, vcc
    v_add_f32 v34, 0x358637bd, v34
    v_mul_f32 v36, 1.4426950408889634, v33
    v_exp_f32 v36, v36
    v_add_f32 v35, 1.0, v33
    v_cmp_lt_f32 vcc, 0, v33
    s_nop 1
    v_cndmask_b32 v35, v36, v35, vcc
    v_add_f32 v35, 0x358637bd, v35
    v_cvt_pk_bf16_f32 v19, v34, v35
    v_lshlrev_b32 v32, 16, v20
    v_and_b32 v33, 0xffff0000, v20
    v_mul_f32 v36, 1.4426950408889634, v32
    v_exp_f32 v36, v36
    v_add_f32 v34, 1.0, v32
    v_cmp_lt_f32 vcc, 0, v32
    s_nop 1
    v_cndmask_b32 v34, v36, v34, vcc
    v_add_f32 v34, 0x358637bd, v34
    v_mul_f32 v36, 1.4426950408889634, v33
    v_exp_f32 v36, v36
    v_add_f32 v35, 1.0, v33
    v_cmp_lt_f32 vcc, 0, v33
    s_nop 1
    v_cndmask_b32 v35, v36, v35, vcc
    v_add_f32 v35, 0x358637bd, v35
    v_cvt_pk_bf16_f32 v20, v34, v35
    v_lshlrev_b32 v32, 16, v21
    v_and_b32 v33, 0xffff0000, v21
    v_mul_f32 v36, 1.4426950408889634, v32
    v_exp_f32 v36, v36
    v_add_f32 v34, 1.0, v32
    v_cmp_lt_f32 vcc, 0, v32
    s_nop 1
    v_cndmask_b32 v34, v36, v34, vcc
    v_add_f32 v34, 0x358637bd, v34
    v_mul_f32 v36, 1.4426950408889634, v33
    v_exp_f32 v36, v36
    v_add_f32 v35, 1.0, v33
    v_cmp_lt_f32 vcc, 0, v33
    s_nop 1
    v_cndmask_b32 v35, v36, v35, vcc
    v_add_f32 v35, 0x358637bd, v35
    v_cvt_pk_bf16_f32 v21, v34, v35
    v_lshlrev_b32 v32, 16, v22
    v_and_b32 v33, 0xffff0000, v22
    v_mul_f32 v36, 1.4426950408889634, v32
    v_exp_f32 v36, v36
    v_add_f32 v34, 1.0, v32
    v_cmp_lt_f32 vcc, 0, v32
    s_nop 1
    v_cndmask_b32 v34, v36, v34, vcc
    v_add_f32 v34, 0x358637bd, v34
    v_mul_f32 v36, 1.4426950408889634, v33
    v_exp_f32 v36, v36
    v_add_f32 v35, 1.0, v33
    v_cmp_lt_f32 vcc, 0, v33
    s_nop 1
    v_cndmask_b32 v35, v36, v35, vcc
    v_add_f32 v35, 0x358637bd, v35
    v_cvt_pk_bf16_f32 v22, v34, v35
    v_lshlrev_b32 v32, 16, v23
    v_and_b32 v33, 0xffff0000, v23
    v_mul_f32 v36, 1.4426950408889634, v32
    v_exp_f32 v36, v36
    v_add_f32 v34, 1.0, v32
    v_cmp_lt_f32 vcc, 0, v32
    s_nop 1
    v_cndmask_b32 v34, v36, v34, vcc
    v_add_f32 v34, 0x358637bd, v34
    v_mul_f32 v36, 1.4426950408889634, v33
    v_exp_f32 v36, v36
    v_add_f32 v35, 1.0, v33
    v_cmp_lt_f32 vcc, 0, v33
    s_nop 1
    v_cndmask_b32 v35, v36, v35, vcc
    v_add_f32 v35, 0x358637bd, v35
    v_cvt_pk_bf16_f32 v23, v34, v35
    v_mov_b32 v37, 0x3f803f80
    v_cndmask_b32 v20, 0, v20, s[16:17]
    v_cndmask_b32 v28, 0, v28, s[16:17]
    v_cndmask_b32 v28, v28, v37, s[18:19]
    v_cndmask_b32 v21, 0, v21, s[16:17]
    v_cndmask_b32 v29, 0, v29, s[16:17]
    v_cndmask_b32 v29, v29, v37, s[18:19]
    v_cndmask_b32 v22, 0, v22, s[16:17]
    v_cndmask_b32 v30, 0, v30, s[16:17]
    v_cndmask_b32 v30, v30, v37, s[18:19]
    v_cndmask_b32 v23, 0, v23, s[16:17]
    v_cndmask_b32 v31, 0, v31, s[16:17]
    v_cndmask_b32 v31, v31, v37, s[18:19]
    s_nop 1
    v_mfma_f32_16x16x32_bf16 a[0:3], v[24:27], v[16:19], a[0:3]
    v_mfma_f32_16x16x32_bf16 a[4:7], v[24:27], v[20:23], a[4:7]
    v_mfma_f32_16x16x32_bf16 a[8:11], v[28:31], v[16:19], a[8:11]
    v_mfma_f32_16x16x32_bf16 a[12:15], v[28:31], v[20:23], a[12:15]
    buffer_load_dwordx4 v[16:19], v8, s[8:11], 0 offen offset:64
    buffer_load_dwordx4 v[24:27], v10, s[8:11], 0 offen offset:64
    buffer_load_dwordx4 v[20:23], v9, s[8:11], 0 offen offset:64
    buffer_load_dwordx4 v[28:31], v11, s[8:11], 0 offen offset:64
    s_waitcnt vmcnt(0)
    v_lshlrev_b32 v32, 16, v16
    v_and_b32 v33, 0xffff0000, v16
    v_mul_f32 v36, 1.4426950408889634, v32
    v_exp_f32 v36, v36
    v_add_f32 v34, 1.0, v32
    v_cmp_lt_f32 vcc, 0, v32
    s_nop 1
    v_cndmask_b32 v34, v36, v34, vcc
    v_add_f32 v34, 0x358637bd, v34
    v_mul_f32 v36, 1.4426950408889634, v33
    v_exp_f32 v36, v36
    v_add_f32 v35, 1.0, v33
    v_cmp_lt_f32 vcc, 0, v33
    s_nop 1
    v_cndmask_b32 v35, v36, v35, vcc
    v_add_f32 v35, 0x358637bd, v35
    v_cvt_pk_bf16_f32 v16, v34, v35
    v_lshlrev_b32 v32, 16, v17
    v_and_b32 v33, 0xffff0000, v17
    v_mul_f32 v36, 1.4426950408889634, v32
    v_exp_f32 v36, v36
    v_add_f32 v34, 1.0, v32
    v_cmp_lt_f32 vcc, 0, v32
    s_nop 1
    v_cndmask_b32 v34, v36, v34, vcc
    v_add_f32 v34, 0x358637bd, v34
    v_mul_f32 v36, 1.4426950408889634, v33
    v_exp_f32 v36, v36
    v_add_f32 v35, 1.0, v33
    v_cmp_lt_f32 vcc, 0, v33
    s_nop 1
    v_cndmask_b32 v35, v36, v35, vcc
    v_add_f32 v35, 0x358637bd, v35
    v_cvt_pk_bf16_f32 v17, v34, v35
    v_lshlrev_b32 v32, 16, v18
    v_and_b32 v33, 0xffff0000, v18
    v_mul_f32 v36, 1.4426950408889634, v32
    v_exp_f32 v36, v36
    v_add_f32 v34, 1.0, v32
    v_cmp_lt_f32 vcc, 0, v32
    s_nop 1
    v_cndmask_b32 v34, v36, v34, vcc
    v_add_f32 v34, 0x358637bd, v34
    v_mul_f32 v36, 1.4426950408889634, v33
    v_exp_f32 v36, v36
    v_add_f32 v35, 1.0, v33
    v_cmp_lt_f32 vcc, 0, v33
    s_nop 1
    v_cndmask_b32 v35, v36, v35, vcc
    v_add_f32 v35, 0x358637bd, v35
    v_cvt_pk_bf16_f32 v18, v34, v35
    v_lshlrev_b32 v32, 16, v19
    v_and_b32 v33, 0xffff0000, v19
    v_mul_f32 v36, 1.4426950408889634, v32
    v_exp_f32 v36, v36
    v_add_f32 v34, 1.0, v32
    v_cmp_lt_f32 vcc, 0, v32
    s_nop 1
    v_cndmask_b32 v34, v36, v34, vcc
    v_add_f32 v34, 0x358637bd, v34
    v_mul_f32 v36, 1.4426950408889634, v33
    v_exp_f32 v36, v36
    v_add_f32 v35, 1.0, v33
    v_cmp_lt_f32 vcc, 0, v33
    s_nop 1
    v_cndmask_b32 v35, v36, v35, vcc
    v_add_f32 v35, 0x358637bd, v35
    v_cvt_pk_bf16_f32 v19, v34, v35
    v_lshlrev_b32 v32, 16, v20
    v_and_b32 v33, 0xffff0000, v20
    v_mul_f32 v36, 1.4426950408889634, v32
    v_exp_f32 v36, v36
    v_add_f32 v34, 1.0, v32
    v_cmp_lt_f32 vcc, 0, v32
    s_nop 1
    v_cndmask_b32 v34, v36, v34, vcc
    v_add_f32 v34, 0x358637bd, v34
    v_mul_f32 v36, 1.4426950408889634, v33
    v_exp_f32 v36, v36
    v_add_f32 v35, 1.0, v33
    v_cmp_lt_f32 vcc, 0, v33
    s_nop 1
    v_cndmask_b32 v35, v36, v35, vcc
    v_add_f32 v35, 0x358637bd, v35
    v_cvt_pk_bf16_f32 v20, v34, v35
    v_lshlrev_b32 v32, 16, v21
    v_and_b32 v33, 0xffff0000, v21
    v_mul_f32 v36, 1.4426950408889634, v32
    v_exp_f32 v36, v36
    v_add_f32 v34, 1.0, v32
    v_cmp_lt_f32 vcc, 0, v32
    s_nop 1
    v_cndmask_b32 v34, v36, v34, vcc
    v_add_f32 v34, 0x358637bd, v34
    v_mul_f32 v36, 1.4426950408889634, v33
    v_exp_f32 v36, v36
    v_add_f32 v35, 1.0, v33
    v_cmp_lt_f32 vcc, 0, v33
    s_nop 1
    v_cndmask_b32 v35, v36, v35, vcc
    v_add_f32 v35, 0x358637bd, v35
    v_cvt_pk_bf16_f32 v21, v34, v35
    v_lshlrev_b32 v32, 16, v22
    v_and_b32 v33, 0xffff0000, v22
    v_mul_f32 v36, 1.4426950408889634, v32
    v_exp_f32 v36, v36
    v_add_f32 v34, 1.0, v32
    v_cmp_lt_f32 vcc, 0, v32
    s_nop 1
    v_cndmask_b32 v34, v36, v34, vcc
    v_add_f32 v34, 0x358637bd, v34
    v_mul_f32 v36, 1.4426950408889634, v33
    v_exp_f32 v36, v36
    v_add_f32 v35, 1.0, v33
    v_cmp_lt_f32 vcc, 0, v33
    s_nop 1
    v_cndmask_b32 v35, v36, v35, vcc
    v_add_f32 v35, 0x358637bd, v35
    v_cvt_pk_bf16_f32 v22, v34, v35
    v_lshlrev_b32 v32, 16, v23
    v_and_b32 v33, 0xffff0000, v23
    v_mul_f32 v36, 1.4426950408889634, v32
    v_exp_f32 v36, v36
    v_add_f32 v34, 1.0, v32
    v_cmp_lt_f32 vcc, 0, v32
    s_nop 1
    v_cndmask_b32 v34, v36, v34, vcc
    v_add_f32 v34, 0x358637bd, v34
    v_mul_f32 v36, 1.4426950408889634, v33
    v_exp_f32 v36, v36
    v_add_f32 v35, 1.0, v33
    v_cmp_lt_f32 vcc, 0, v33
    s_nop 1
    v_cndmask_b32 v35, v36, v35, vcc
    v_add_f32 v35, 0x358637bd, v35
    v_cvt_pk_bf16_f32 v23, v34, v35
    v_mov_b32 v37, 0x3f803f80
    v_cndmask_b32 v20, 0, v20, s[16:17]
    v_cndmask_b32 v28, 0, v28, s[16:17]
    v_cndmask_b32 v28, v28, v37, s[18:19]
    v_cndmask_b32 v21, 0, v21, s[16:17]
    v_cndmask_b32 v29, 0, v29, s[16:17]
    v_cndmask_b32 v29, v29, v37, s[18:19]
    v_cndmask_b32 v22, 0, v22, s[16:17]
    v_cndmask_b32 v30, 0, v30, s[16:17]
    v_cndmask_b32 v30, v30, v37, s[18:19]
    v_cndmask_b32 v23, 0, v23, s[16:17]
    v_cndmask_b32 v31, 0, v31, s[16:17]
    v_cndmask_b32 v31, v31, v37, s[18:19]
    s_nop 1
    v_mfma_f32_16x16x32_bf16 a[0:3], v[24:27], v[16:19], a[0:3]
    v_mfma_f32_16x16x32_bf16 a[4:7], v[24:27], v[20:23], a[4:7]
    v_mfma_f32_16x16x32_bf16 a[8:11], v[28:31], v[16:19], a[8:11]
    v_mfma_f32_16x16x32_bf16 a[12:15], v[28:31], v[20:23], a[12:15]
    buffer_load_dwordx4 v[16:19], v8, s[8:11], 0 offen offset:128
    buffer_load_dwordx4 v[24:27], v10, s[8:11], 0 offen offset:128
    buffer_load_dwordx4 v[20:23], v9, s[8:11], 0 offen offset:128
    buffer_load_dwordx4 v[28:31], v11, s[8:11], 0 offen offset:128
    s_waitcnt vmcnt(0)
    v_lshlrev_b32 v32, 16, v16
    v_and_b32 v33, 0xffff0000, v16
    v_mul_f32 v36, 1.4426950408889634, v32
    v_exp_f32 v36, v36
    v_add_f32 v34, 1.0, v32
    v_cmp_lt_f32 vcc, 0, v32
    s_nop 1
    v_cndmask_b32 v34, v36, v34, vcc
    v_add_f32 v34, 0x358637bd, v34
    v_mul_f32 v36, 1.4426950408889634, v33
    v_exp_f32 v36, v36
    v_add_f32 v35, 1.0, v33
    v_cmp_lt_f32 vcc, 0, v33
    s_nop 1
    v_cndmask_b32 v35, v36, v35, vcc
    v_add_f32 v35, 0x358637bd, v35
    v_cvt_pk_bf16_f32 v16, v34, v35
    v_lshlrev_b32 v32, 16, v17
    v_and_b32 v33, 0xffff0000, v17
    v_mul_f32 v36, 1.4426950408889634, v32
    v_exp_f32 v36, v36
    v_add_f32 v34, 1.0, v32
    v_cmp_lt_f32 vcc, 0, v32
    s_nop 1
    v_cndmask_b32 v34, v36, v34, vcc
    v_add_f32 v34, 0x358637bd, v34
    v_mul_f32 v36, 1.4426950408889634, v33
    v_exp_f32 v36, v36
    v_add_f32 v35, 1.0, v33
    v_cmp_lt_f32 vcc, 0, v33
    s_nop 1
    v_cndmask_b32 v35, v36, v35, vcc
    v_add_f32 v35, 0x358637bd, v35
    v_cvt_pk_bf16_f32 v17, v34, v35
    v_lshlrev_b32 v32, 16, v18
    v_and_b32 v33, 0xffff0000, v18
    v_mul_f32 v36, 1.4426950408889634, v32
    v_exp_f32 v36, v36
    v_add_f32 v34, 1.0, v32
    v_cmp_lt_f32 vcc, 0, v32
    s_nop 1
    v_cndmask_b32 v34, v36, v34, vcc
    v_add_f32 v34, 0x358637bd, v34
    v_mul_f32 v36, 1.4426950408889634, v33
    v_exp_f32 v36, v36
    v_add_f32 v35, 1.0, v33
    v_cmp_lt_f32 vcc, 0, v33
    s_nop 1
    v_cndmask_b32 v35, v36, v35, vcc
    v_add_f32 v35, 0x358637bd, v35
    v_cvt_pk_bf16_f32 v18, v34, v35
    v_lshlrev_b32 v32, 16, v19
    v_and_b32 v33, 0xffff0000, v19
    v_mul_f32 v36, 1.4426950408889634, v32
    v_exp_f32 v36, v36
    v_add_f32 v34, 1.0, v32
    v_cmp_lt_f32 vcc, 0, v32
    s_nop 1
    v_cndmask_b32 v34, v36, v34, vcc
    v_add_f32 v34, 0x358637bd, v34
    v_mul_f32 v36, 1.4426950408889634, v33
    v_exp_f32 v36, v36
    v_add_f32 v35, 1.0, v33
    v_cmp_lt_f32 vcc, 0, v33
    s_nop 1
    v_cndmask_b32 v35, v36, v35, vcc
    v_add_f32 v35, 0x358637bd, v35
    v_cvt_pk_bf16_f32 v19, v34, v35
    v_lshlrev_b32 v32, 16, v20
    v_and_b32 v33, 0xffff0000, v20
    v_mul_f32 v36, 1.4426950408889634, v32
    v_exp_f32 v36, v36
    v_add_f32 v34, 1.0, v32
    v_cmp_lt_f32 vcc, 0, v32
    s_nop 1
    v_cndmask_b32 v34, v36, v34, vcc
    v_add_f32 v34, 0x358637bd, v34
    v_mul_f32 v36, 1.4426950408889634, v33
    v_exp_f32 v36, v36
    v_add_f32 v35, 1.0, v33
    v_cmp_lt_f32 vcc, 0, v33
    s_nop 1
    v_cndmask_b32 v35, v36, v35, vcc
    v_add_f32 v35, 0x358637bd, v35
    v_cvt_pk_bf16_f32 v20, v34, v35
    v_lshlrev_b32 v32, 16, v21
    v_and_b32 v33, 0xffff0000, v21
    v_mul_f32 v36, 1.4426950408889634, v32
    v_exp_f32 v36, v36
    v_add_f32 v34, 1.0, v32
    v_cmp_lt_f32 vcc, 0, v32
    s_nop 1
    v_cndmask_b32 v34, v36, v34, vcc
    v_add_f32 v34, 0x358637bd, v34
    v_mul_f32 v36, 1.4426950408889634, v33
    v_exp_f32 v36, v36
    v_add_f32 v35, 1.0, v33
    v_cmp_lt_f32 vcc, 0, v33
    s_nop 1
    v_cndmask_b32 v35, v36, v35, vcc
    v_add_f32 v35, 0x358637bd, v35
    v_cvt_pk_bf16_f32 v21, v34, v35
    v_lshlrev_b32 v32, 16, v22
    v_and_b32 v33, 0xffff0000, v22
    v_mul_f32 v36, 1.4426950408889634, v32
    v_exp_f32 v36, v36
    v_add_f32 v34, 1.0, v32
    v_cmp_lt_f32 vcc, 0, v32
    s_nop 1
    v_cndmask_b32 v34, v36, v34, vcc
    v_add_f32 v34, 0x358637bd, v34
    v_mul_f32 v36, 1.4426950408889634, v33
    v_exp_f32 v36, v36
    v_add_f32 v35, 1.0, v33
    v_cmp_lt_f32 vcc, 0, v33
    s_nop 1
    v_cndmask_b32 v35, v36, v35, vcc
    v_add_f32 v35, 0x358637bd, v35
    v_cvt_pk_bf16_f32 v22, v34, v35
    v_lshlrev_b32 v32, 16, v23
    v_and_b32 v33, 0xffff0000, v23
    v_mul_f32 v36, 1.4426950408889634, v32
    v_exp_f32 v36, v36
    v_add_f32 v34, 1.0, v32
    v_cmp_lt_f32 vcc, 0, v32
    s_nop 1
    v_cndmask_b32 v34, v36, v34, vcc
    v_add_f32 v34, 0x358637bd, v34
    v_mul_f32 v36, 1.4426950408889634, v33
    v_exp_f32 v36, v36
    v_add_f32 v35, 1.0, v33
    v_cmp_lt_f32 vcc, 0, v33
    s_nop 1
    v_cndmask_b32 v35, v36, v35, vcc
    v_add_f32 v35, 0x358637bd, v35
    v_cvt_pk_bf16_f32 v23, v34, v35
    v_mov_b32 v37, 0x3f803f80
    v_cndmask_b32 v20, 0, v20, s[16:17]
    v_cndmask_b32 v28, 0, v28, s[16:17]
    v_cndmask_b32 v28, v28, v37, s[18:19]
    v_cndmask_b32 v21, 0, v21, s[16:17]
    v_cndmask_b32 v29, 0, v29, s[16:17]
    v_cndmask_b32 v29, v29, v37, s[18:19]
    v_cndmask_b32 v22, 0, v22, s[16:17]
    v_cndmask_b32 v30, 0, v30, s[16:17]
    v_cndmask_b32 v30, v30, v37, s[18:19]
    v_cndmask_b32 v23, 0, v23, s[16:17]
    v_cndmask_b32 v31, 0, v31, s[16:17]
    v_cndmask_b32 v31, v31, v37, s[18:19]
    s_nop 1
    v_mfma_f32_16x16x32_bf16 a[0:3], v[24:27], v[16:19], a[0:3]
    v_mfma_f32_16x16x32_bf16 a[4:7], v[24:27], v[20:23], a[4:7]
    v_mfma_f32_16x16x32_bf16 a[8:11], v[28:31], v[16:19], a[8:11]
    v_mfma_f32_16x16x32_bf16 a[12:15], v[28:31], v[20:23], a[12:15]
    buffer_load_dwordx4 v[16:19], v8, s[8:11], 0 offen offset:192
    buffer_load_dwordx4 v[24:27], v10, s[8:11], 0 offen offset:192
    buffer_load_dwordx4 v[20:23], v9, s[8:11], 0 offen offset:192
    buffer_load_dwordx4 v[28:31], v11, s[8:11], 0 offen offset:192
    s_waitcnt vmcnt(0)
    v_lshlrev_b32 v32, 16, v16
    v_and_b32 v33, 0xffff0000, v16
    v_mul_f32 v36, 1.4426950408889634, v32
    v_exp_f32 v36, v36
    v_add_f32 v34, 1.0, v32
    v_cmp_lt_f32 vcc, 0, v32
    s_nop 1
    v_cndmask_b32 v34, v36, v34, vcc
    v_add_f32 v34, 0x358637bd, v34
    v_mul_f32 v36, 1.4426950408889634, v33
    v_exp_f32 v36, v36
    v_add_f32 v35, 1.0, v33
    v_cmp_lt_f32 vcc, 0, v33
    s_nop 1
    v_cndmask_b32 v35, v36, v35, vcc
    v_add_f32 v35, 0x358637bd, v35
    v_cvt_pk_bf16_f32 v16, v34, v35
    v_lshlrev_b32 v32, 16, v17
    v_and_b32 v33, 0xffff0000, v17
    v_mul_f32 v36, 1.4426950408889634, v32
    v_exp_f32 v36, v36
    v_add_f32 v34, 1.0, v32
    v_cmp_lt_f32 vcc, 0, v32
    s_nop 1
    v_cndmask_b32 v34, v36, v34, vcc
    v_add_f32 v34, 0x358637bd, v34
    v_mul_f32 v36, 1.4426950408889634, v33
    v_exp_f32 v36, v36
    v_add_f32 v35, 1.0, v33
    v_cmp_lt_f32 vcc, 0, v33
    s_nop 1
    v_cndmask_b32 v35, v36, v35, vcc
    v_add_f32 v35, 0x358637bd, v35
    v_cvt_pk_bf16_f32 v17, v34, v35
    v_lshlrev_b32 v32, 16, v18
    v_and_b32 v33, 0xffff0000, v18
    v_mul_f32 v36, 1.4426950408889634, v32
    v_exp_f32 v36, v36
    v_add_f32 v34, 1.0, v32
    v_cmp_lt_f32 vcc, 0, v32
    s_nop 1
    v_cndmask_b32 v34, v36, v34, vcc
    v_add_f32 v34, 0x358637bd, v34
    v_mul_f32 v36, 1.4426950408889634, v33
    v_exp_f32 v36, v36
    v_add_f32 v35, 1.0, v33
    v_cmp_lt_f32 vcc, 0, v33
    s_nop 1
    v_cndmask_b32 v35, v36, v35, vcc
    v_add_f32 v35, 0x358637bd, v35
    v_cvt_pk_bf16_f32 v18, v34, v35
    v_lshlrev_b32 v32, 16, v19
    v_and_b32 v33, 0xffff0000, v19
    v_mul_f32 v36, 1.4426950408889634, v32
    v_exp_f32 v36, v36
    v_add_f32 v34, 1.0, v32
    v_cmp_lt_f32 vcc, 0, v32
    s_nop 1
    v_cndmask_b32 v34, v36, v34, vcc
    v_add_f32 v34, 0x358637bd, v34
    v_mul_f32 v36, 1.4426950408889634, v33
    v_exp_f32 v36, v36
    v_add_f32 v35, 1.0, v33
    v_cmp_lt_f32 vcc, 0, v33
    s_nop 1
    v_cndmask_b32 v35, v36, v35, vcc
    v_add_f32 v35, 0x358637bd, v35
    v_cvt_pk_bf16_f32 v19, v34, v35
    v_lshlrev_b32 v32, 16, v20
    v_and_b32 v33, 0xffff0000, v20
    v_mul_f32 v36, 1.4426950408889634, v32
    v_exp_f32 v36, v36
    v_add_f32 v34, 1.0, v32
    v_cmp_lt_f32 vcc, 0, v32
    s_nop 1
    v_cndmask_b32 v34, v36, v34, vcc
    v_add_f32 v34, 0x358637bd, v34
    v_mul_f32 v36, 1.4426950408889634, v33
    v_exp_f32 v36, v36
    v_add_f32 v35, 1.0, v33
    v_cmp_lt_f32 vcc, 0, v33
    s_nop 1
    v_cndmask_b32 v35, v36, v35, vcc
    v_add_f32 v35, 0x358637bd, v35
    v_cvt_pk_bf16_f32 v20, v34, v35
    v_lshlrev_b32 v32, 16, v21
    v_and_b32 v33, 0xffff0000, v21
    v_mul_f32 v36, 1.4426950408889634, v32
    v_exp_f32 v36, v36
    v_add_f32 v34, 1.0, v32
    v_cmp_lt_f32 vcc, 0, v32
    s_nop 1
    v_cndmask_b32 v34, v36, v34, vcc
    v_add_f32 v34, 0x358637bd, v34
    v_mul_f32 v36, 1.4426950408889634, v33
    v_exp_f32 v36, v36
    v_add_f32 v35, 1.0, v33
    v_cmp_lt_f32 vcc, 0, v33
    s_nop 1
    v_cndmask_b32 v35, v36, v35, vcc
    v_add_f32 v35, 0x358637bd, v35
    v_cvt_pk_bf16_f32 v21, v34, v35
    v_lshlrev_b32 v32, 16, v22
    v_and_b32 v33, 0xffff0000, v22
    v_mul_f32 v36, 1.4426950408889634, v32
    v_exp_f32 v36, v36
    v_add_f32 v34, 1.0, v32
    v_cmp_lt_f32 vcc, 0, v32
    s_nop 1
    v_cndmask_b32 v34, v36, v34, vcc
    v_add_f32 v34, 0x358637bd, v34
    v_mul_f32 v36, 1.4426950408889634, v33
    v_exp_f32 v36, v36
    v_add_f32 v35, 1.0, v33
    v_cmp_lt_f32 vcc, 0, v33
    s_nop 1
    v_cndmask_b32 v35, v36, v35, vcc
    v_add_f32 v35, 0x358637bd, v35
    v_cvt_pk_bf16_f32 v22, v34, v35
    v_lshlrev_b32 v32, 16, v23
    v_and_b32 v33, 0xffff0000, v23
    v_mul_f32 v36, 1.4426950408889634, v32
    v_exp_f32 v36, v36
    v_add_f32 v34, 1.0, v32
    v_cmp_lt_f32 vcc, 0, v32
    s_nop 1
    v_cndmask_b32 v34, v36, v34, vcc
    v_add_f32 v34, 0x358637bd, v34
    v_mul_f32 v36, 1.4426950408889634, v33
    v_exp_f32 v36, v36
    v_add_f32 v35, 1.0, v33
    v_cmp_lt_f32 vcc, 0, v33
    s_nop 1
    v_cndmask_b32 v35, v36, v35, vcc
    v_add_f32 v35, 0x358637bd, v35
    v_cvt_pk_bf16_f32 v23, v34, v35
    v_mov_b32 v37, 0x3f803f80
    v_cndmask_b32 v20, 0, v20, s[16:17]
    v_cndmask_b32 v28, 0, v28, s[16:17]
    v_cndmask_b32 v28, v28, v37, s[18:19]
    v_cndmask_b32 v21, 0, v21, s[16:17]
    v_cndmask_b32 v29, 0, v29, s[16:17]
    v_cndmask_b32 v29, v29, v37, s[18:19]
    v_cndmask_b32 v22, 0, v22, s[16:17]
    v_cndmask_b32 v30, 0, v30, s[16:17]
    v_cndmask_b32 v30, v30, v37, s[18:19]
    v_cndmask_b32 v23, 0, v23, s[16:17]
    v_cndmask_b32 v31, 0, v31, s[16:17]
    v_cndmask_b32 v31, v31, v37, s[18:19]
    s_nop 1
    v_mfma_f32_16x16x32_bf16 a[0:3], v[24:27], v[16:19], a[0:3]
    v_mfma_f32_16x16x32_bf16 a[4:7], v[24:27], v[20:23], a[4:7]
    v_mfma_f32_16x16x32_bf16 a[8:11], v[28:31], v[16:19], a[8:11]
    v_mfma_f32_16x16x32_bf16 a[12:15], v[28:31], v[20:23], a[12:15]
    s_nop 7
    s_nop 7
    v_lshlrev_b32 v5, 2, v4
    v_lshlrev_b32 v5, 5, v5
    v_add_u32 v5, v5, v3
    v_lshlrev_b32 v5, 2, v5
    s_lshl_b32 s14, s5, 12
    s_add_u32 s14, s14, 23068672
    v_add_u32 v5, s14, v5
    v_accvgpr_read_b32 v40, a0
    v_accvgpr_read_b32 v41, a1
    v_accvgpr_read_b32 v42, a2
    v_accvgpr_read_b32 v43, a3
    buffer_atomic_add_f32 v40, v5, s[8:11], 0 offen offset:0
    buffer_atomic_add_f32 v41, v5, s[8:11], 0 offen offset:128
    buffer_atomic_add_f32 v42, v5, s[8:11], 0 offen offset:256
    buffer_atomic_add_f32 v43, v5, s[8:11], 0 offen offset:384
    v_accvgpr_read_b32 v40, a4
    v_accvgpr_read_b32 v41, a5
    v_accvgpr_read_b32 v42, a6
    v_accvgpr_read_b32 v43, a7
    buffer_atomic_add_f32 v40, v5, s[8:11], 0 offen offset:64
    buffer_atomic_add_f32 v41, v5, s[8:11], 0 offen offset:192
    buffer_atomic_add_f32 v42, v5, s[8:11], 0 offen offset:320
    buffer_atomic_add_f32 v43, v5, s[8:11], 0 offen offset:448
    v_accvgpr_read_b32 v40, a8
    v_accvgpr_read_b32 v41, a9
    v_accvgpr_read_b32 v42, a10
    v_accvgpr_read_b32 v43, a11
    buffer_atomic_add_f32 v40, v5, s[8:11], 0 offen offset:2048
    buffer_atomic_add_f32 v41, v5, s[8:11], 0 offen offset:2176
    buffer_atomic_add_f32 v42, v5, s[8:11], 0 offen offset:2304
    buffer_atomic_add_f32 v43, v5, s[8:11], 0 offen offset:2432
    v_accvgpr_read_b32 v40, a12
    v_accvgpr_read_b32 v41, a13
    v_accvgpr_read_b32 v42, a14
    v_accvgpr_read_b32 v43, a15
    buffer_atomic_add_f32 v40, v5, s[8:11], 0 offen offset:2112
    buffer_atomic_add_f32 v41, v5, s[8:11], 0 offen offset:2240
    buffer_atomic_add_f32 v42, v5, s[8:11], 0 offen offset:2368
    buffer_atomic_add_f32 v43, v5, s[8:11], 0 offen offset:2496
kvz_a1_kernel_end:
    s_endpgm
.section .rodata,"a"
.p2align 6
.amdhsa_kernel kvz_a1_kernel
  .amdhsa_next_free_vgpr 80
  .amdhsa_next_free_sgpr 40
  .amdhsa_accum_offset 64
  .amdhsa_group_segment_fixed_size 0
  .amdhsa_kernarg_size 104
  .amdhsa_user_sgpr_count 2
  .amdhsa_user_sgpr_kernarg_segment_ptr 1
  .amdhsa_system_sgpr_workgroup_id_x 1
.end_amdhsa_kernel
.text
.globl attn_a1_kernel
.p2align 8
.type attn_a1_kernel,@function
attn_a1_kernel:
    s_cmp_ge_u32 s2, 256
    s_cbranch_scc1 attn_a1_kernel_end
    s_load_dwordx2 s[6:7], s[0:1], 96
    s_waitcnt lgkmcnt(0)
    s_mov_b32 s8, s6
    s_mov_b32 s9, s7
    s_mov_b32 s10, 268435456
    s_mov_b32 s11, 0x00020000
    v_mov_b32 v1, v0
    v_add_u32 v2, 0, v1
    s_mov_b32 s12, 3121
    v_mul_lo_u32 v3, v2, s12
    v_lshrrev_b32 v3, 19, v3
    v_mul_u32_u24 v4, 168, v3
    v_sub_u32 v4, v2, v4
    v_lshlrev_b32 v5, 12, v3
    v_lshlrev_b32 v6, 4, v4
    v_add_u32 v5, v5, v6
    v_add_u32 v5, 23068672, v5
    buffer_load_dwordx4 v[8:11], v5, s[8:11], 0 offen
    v_mul_u32_u24 v7, 2688, v3
    v_add_u32 v7, v7, v6
    s_waitcnt vmcnt(0)
    ds_write_b128 v7, v[8:11]
    v_add_u32 v2, 256, v1
    s_mov_b32 s12, 3121
    v_mul_lo_u32 v3, v2, s12
    v_lshrrev_b32 v3, 19, v3
    v_mul_u32_u24 v4, 168, v3
    v_sub_u32 v4, v2, v4
    v_lshlrev_b32 v5, 12, v3
    v_lshlrev_b32 v6, 4, v4
    v_add_u32 v5, v5, v6
    v_add_u32 v5, 23068672, v5
    buffer_load_dwordx4 v[8:11], v5, s[8:11], 0 offen
    v_mul_u32_u24 v7, 2688, v3
    v_add_u32 v7, v7, v6
    s_waitcnt vmcnt(0)
    ds_write_b128 v7, v[8:11]
    v_add_u32 v2, 512, v1
    s_mov_b32 s12, 3121
    v_mul_lo_u32 v3, v2, s12
    v_lshrrev_b32 v3, 19, v3
    v_mul_u32_u24 v4, 168, v3
    v_sub_u32 v4, v2, v4
    v_lshlrev_b32 v5, 12, v3
    v_lshlrev_b32 v6, 4, v4
    v_add_u32 v5, v5, v6
    v_add_u32 v5, 23068672, v5
    buffer_load_dwordx4 v[8:11], v5, s[8:11], 0 offen
    v_mul_u32_u24 v7, 2688, v3
    v_add_u32 v7, v7, v6
    s_waitcnt vmcnt(0)
    ds_write_b128 v7, v[8:11]
    v_add_u32 v2, 768, v1
    s_mov_b32 s12, 3121
    v_mul_lo_u32 v3, v2, s12
    v_lshrrev_b32 v3, 19, v3
    v_mul_u32_u24 v4, 168, v3
    v_sub_u32 v4, v2, v4
    v_lshlrev_b32 v5, 12, v3
    v_lshlrev_b32 v6, 4, v4
    v_add_u32 v5, v5, v6
    v_add_u32 v5, 23068672, v5
    buffer_load_dwordx4 v[8:11], v5, s[8:11], 0 offen
    v_mul_u32_u24 v7, 2688, v3
    v_add_u32 v7, v7, v6
    s_waitcnt vmcnt(0)
    ds_write_b128 v7, v[8:11]
    v_add_u32 v2, 1024, v1
    s_mov_b32 s12, 3121
    v_mul_lo_u32 v3, v2, s12
    v_lshrrev_b32 v3, 19, v3
    v_mul_u32_u24 v4, 168, v3
    v_sub_u32 v4, v2, v4
    v_lshlrev_b32 v5, 12, v3
    v_lshlrev_b32 v6, 4, v4
    v_add_u32 v5, v5, v6
    v_add_u32 v5, 23068672, v5
    buffer_load_dwordx4 v[8:11], v5, s[8:11], 0 offen
    v_mul_u32_u24 v7, 2688, v3
    v_add_u32 v7, v7, v6
    s_waitcnt vmcnt(0)
    ds_write_b128 v7, v[8:11]
    v_add_u32 v2, 1280, v1
    s_mov_b32 s12, 3121
    v_mul_lo_u32 v3, v2, s12
    v_lshrrev_b32 v3, 19, v3
    v_mul_u32_u24 v4, 168, v3
    v_sub_u32 v4, v2, v4
    v_lshlrev_b32 v5, 12, v3
    v_lshlrev_b32 v6, 4, v4
    v_add_u32 v5, v5, v6
    v_add_u32 v5, 23068672, v5
    buffer_load_dwordx4 v[8:11], v5, s[8:11], 0 offen
    v_mul_u32_u24 v7, 2688, v3
    v_add_u32 v7, v7, v6
    s_waitcnt vmcnt(0)
    ds_write_b128 v7, v[8:11]
    v_add_u32 v2, 1536, v1
    s_mov_b32 s12, 3121
    v_mul_lo_u32 v3, v2, s12
    v_lshrrev_b32 v3, 19, v3
    v_mul_u32_u24 v4, 168, v3
    v_sub_u32 v4, v2, v4
    v_lshlrev_b32 v5, 12, v3
    v_lshlrev_b32 v6, 4, v4
    v_add_u32 v5, v5, v6
    v_add_u32 v5, 23068672, v5
    buffer_load_dwordx4 v[8:11], v5, s[8:11], 0 offen
    v_mul_u32_u24 v7, 2688, v3
    v_add_u32 v7, v7, v6
    s_waitcnt vmcnt(0)
    ds_write_b128 v7, v[8:11]
    v_add_u32 v2, 1792, v1
    s_mov_b32 s12, 3121
    v_mul_lo_u32 v3, v2, s12
    v_lshrrev_b32 v3, 19, v3
    v_mul_u32_u24 v4, 168, v3
    v_sub_u32 v4, v2, v4
    v_lshlrev_b32 v5, 12, v3
    v_lshlrev_b32 v6, 4, v4
    v_add_u32 v5, v5, v6
    v_add_u32 v5, 23068672, v5
    buffer_load_dwordx4 v[8:11], v5, s[8:11], 0 offen
    v_mul_u32_u24 v7, 2688, v3
    v_add_u32 v7, v7, v6
    s_waitcnt vmcnt(0)
    ds_write_b128 v7, v[8:11]
    v_add_u32 v2, 2048, v1
    s_mov_b32 s12, 3121
    v_mul_lo_u32 v3, v2, s12
    v_lshrrev_b32 v3, 19, v3
    v_mul_u32_u24 v4, 168, v3
    v_sub_u32 v4, v2, v4
    v_lshlrev_b32 v5, 12, v3
    v_lshlrev_b32 v6, 4, v4
    v_add_u32 v5, v5, v6
    v_add_u32 v5, 23068672, v5
    buffer_load_dwordx4 v[8:11], v5, s[8:11], 0 offen
    v_mul_u32_u24 v7, 2688, v3
    v_add_u32 v7, v7, v6
    s_waitcnt vmcnt(0)
    ds_write_b128 v7, v[8:11]
    v_add_u32 v2, 2304, v1
    s_mov_b32 s12, 3121
    v_mul_lo_u32 v3, v2, s12
    v_lshrrev_b32 v3, 19, v3
    v_mul_u32_u24 v4, 168, v3
    v_sub_u32 v4, v2, v4
    v_lshlrev_b32 v5, 12, v3
    v_lshlrev_b32 v6, 4, v4
    v_add_u32 v5, v5, v6
    v_add_u32 v5, 23068672, v5
    buffer_load_dwordx4 v[8:11], v5, s[8:11], 0 offen
    v_mul_u32_u24 v7, 2688, v3
    v_add_u32 v7, v7, v6
    s_waitcnt vmcnt(0)
    ds_write_b128 v7, v[8:11]
    v_add_u32 v2, 2560, v1
    s_mov_b32 s12, 3121
    v_mul_lo_u32 v3, v2, s12
    v_lshrrev_b32 v3, 19, v3
    v_mul_u32_u24 v4, 168, v3
    v_sub_u32 v4, v2, v4
    v_lshlrev_b32 v5, 12, v3
    v_lshlrev_b32 v6, 4, v4
    v_add_u32 v5, v5, v6
    v_add_u32 v5, 23068672, v5
    buffer_load_dwordx4 v[8:11], v5, s[8:11], 0 offen
    v_mul_u32_u24 v7, 2688, v3
    v_add_u32 v7, v7, v6
    s_waitcnt vmcnt(0)
    ds_write_b128 v7, v[8:11]
    v_add_u32 v2, 2816, v1
    s_mov_b32 s12, 3121
    v_mul_lo_u32 v3, v2, s12
    v_lshrrev_b32 v3, 19, v3
    v_mul_u32_u24 v4, 168, v3
    v_sub_u32 v4, v2, v4
    v_lshlrev_b32 v5, 12, v3
    v_lshlrev_b32 v6, 4, v4
    v_add_u32 v5, v5, v6
    v_add_u32 v5, 23068672, v5
    buffer_load_dwordx4 v[8:11], v5, s[8:11], 0 offen
    v_mul_u32_u24 v7, 2688, v3
    v_add_u32 v7, v7, v6
    s_waitcnt vmcnt(0)
    ds_write_b128 v7, v[8:11]
    v_add_u32 v2, 3072, v1
    s_mov_b32 s12, 3121
    v_mul_lo_u32 v3, v2, s12
    v_lshrrev_b32 v3, 19, v3
    v_mul_u32_u24 v4, 168, v3
    v_sub_u32 v4, v2, v4
    v_lshlrev_b32 v5, 12, v3
    v_lshlrev_b32 v6, 4, v4
    v_add_u32 v5, v5, v6
    v_add_u32 v5, 23068672, v5
    buffer_load_dwordx4 v[8:11], v5, s[8:11], 0 offen
    v_mul_u32_u24 v7, 2688, v3
    v_add_u32 v7, v7, v6
    s_waitcnt vmcnt(0)
    ds_write_b128 v7, v[8:11]
    v_add_u32 v2, 3328, v1
    s_mov_b32 s12, 3121
    v_mul_lo_u32 v3, v2, s12
    v_lshrrev_b32 v3, 19, v3
    v_mul_u32_u24 v4, 168, v3
    v_sub_u32 v4, v2, v4
    v_lshlrev_b32 v5, 12, v3
    v_lshlrev_b32 v6, 4, v4
    v_add_u32 v5, v5, v6
    v_add_u32 v5, 23068672, v5
    buffer_load_dwordx4 v[8:11], v5, s[8:11], 0 offen
    v_mul_u32_u24 v7, 2688, v3
    v_add_u32 v7, v7, v6
    s_waitcnt vmcnt(0)
    ds_write_b128 v7, v[8:11]
    v_add_u32 v2, 3584, v1
    s_mov_b32 s12, 3121
    v_mul_lo_u32 v3, v2, s12
    v_lshrrev_b32 v3, 19, v3
    v_mul_u32_u24 v4, 168, v3
    v_sub_u32 v4, v2, v4
    v_lshlrev_b32 v5, 12, v3
    v_lshlrev_b32 v6, 4, v4
    v_add_u32 v5, v5, v6
    v_add_u32 v5, 23068672, v5
    buffer_load_dwordx4 v[8:11], v5, s[8:11], 0 offen
    v_mul_u32_u24 v7, 2688, v3
    v_add_u32 v7, v7, v6
    s_waitcnt vmcnt(0)
    ds_write_b128 v7, v[8:11]
    v_add_u32 v2, 3840, v1
    s_mov_b32 s12, 3121
    v_mul_lo_u32 v3, v2, s12
    v_lshrrev_b32 v3, 19, v3
    v_mul_u32_u24 v4, 168, v3
    v_sub_u32 v4, v2, v4
    v_lshlrev_b32 v5, 12, v3
    v_lshlrev_b32 v6, 4, v4
    v_add_u32 v5, v5, v6
    v_add_u32 v5, 23068672, v5
    buffer_load_dwordx4 v[8:11], v5, s[8:11], 0 offen
    v_mul_u32_u24 v7, 2688, v3
    v_add_u32 v7, v7, v6
    s_waitcnt vmcnt(0)
    ds_write_b128 v7, v[8:11]
    v_add_u32 v2, 4096, v1
    s_mov_b32 s12, 3121
    v_mul_lo_u32 v3, v2, s12
    v_lshrrev_b32 v3, 19, v3
    v_mul_u32_u24 v4, 168, v3
    v_sub_u32 v4, v2, v4
    v_lshlrev_b32 v5, 12, v3
    v_lshlrev_b32 v6, 4, v4
    v_add_u32 v5, v5, v6
    v_add_u32 v5, 23068672, v5
    buffer_load_dwordx4 v[8:11], v5, s[8:11], 0 offen
    v_mul_u32_u24 v7, 2688, v3
    v_add_u32 v7, v7, v6
    s_waitcnt vmcnt(0)
    ds_write_b128 v7, v[8:11]
    v_add_u32 v2, 4352, v1
    s_mov_b32 s12, 3121
    v_mul_lo_u32 v3, v2, s12
    v_lshrrev_b32 v3, 19, v3
    v_mul_u32_u24 v4, 168, v3
    v_sub_u32 v4, v2, v4
    v_lshlrev_b32 v5, 12, v3
    v_lshlrev_b32 v6, 4, v4
    v_add_u32 v5, v5, v6
    v_add_u32 v5, 23068672, v5
    buffer_load_dwordx4 v[8:11], v5, s[8:11], 0 offen
    v_mul_u32_u24 v7, 2688, v3
    v_add_u32 v7, v7, v6
    s_waitcnt vmcnt(0)
    ds_write_b128 v7, v[8:11]
    v_add_u32 v2, 4608, v1
    s_mov_b32 s12, 3121
    v_mul_lo_u32 v3, v2, s12
    v_lshrrev_b32 v3, 19, v3
    v_mul_u32_u24 v4, 168, v3
    v_sub_u32 v4, v2, v4
    v_lshlrev_b32 v5, 12, v3
    v_lshlrev_b32 v6, 4, v4
    v_add_u32 v5, v5, v6
    v_add_u32 v5, 23068672, v5
    buffer_load_dwordx4 v[8:11], v5, s[8:11], 0 offen
    v_mul_u32_u24 v7, 2688, v3
    v_add_u32 v7, v7, v6
    s_waitcnt vmcnt(0)
    ds_write_b128 v7, v[8:11]
    v_add_u32 v2, 4864, v1
    s_mov_b32 s12, 3121
    v_mul_lo_u32 v3, v2, s12
    v_lshrrev_b32 v3, 19, v3
    v_mul_u32_u24 v4, 168, v3
    v_sub_u32 v4, v2, v4
    v_lshlrev_b32 v5, 12, v3
    v_lshlrev_b32 v6, 4, v4
    v_add_u32 v5, v5, v6
    v_add_u32 v5, 23068672, v5
    buffer_load_dwordx4 v[8:11], v5, s[8:11], 0 offen
    v_mul_u32_u24 v7, 2688, v3
    v_add_u32 v7, v7, v6
    s_waitcnt vmcnt(0)
    ds_write_b128 v7, v[8:11]
    v_add_u32 v2, 5120, v1
    s_mov_b32 s12, 3121
    v_mul_lo_u32 v3, v2, s12
    v_lshrrev_b32 v3, 19, v3
    v_mul_u32_u24 v4, 168, v3
    v_sub_u32 v4, v2, v4
    v_lshlrev_b32 v5, 12, v3
    v_lshlrev_b32 v6, 4, v4
    v_add_u32 v5, v5, v6
    v_add_u32 v5, 23068672, v5
    buffer_load_dwordx4 v[8:11], v5, s[8:11], 0 offen
    v_mul_u32_u24 v7, 2688, v3
    v_add_u32 v7, v7, v6
    s_waitcnt vmcnt(0)
    ds_write_b128 v7, v[8:11]
    s_waitcnt lgkmcnt(0)
    s_barrier
    v_and_b32 v2, 31, v0
    v_lshrrev_b32 v3, 5, v0
    s_lshl_b32 s12, s2, 3
    v_add_u32 v3, s12, v3
    v_mul_u32_u24 v4, 1280, v3
    v_mul_u32_u24 v5, 40, v2
    v_add_u32 v4, v4, v5
    v_add_u32 v6, 8388608, v4
    buffer_load_dwordx2 v[8:9], v6, s[8:11], 0 offen offset:0
    buffer_load_dwordx2 v[10:11], v6, s[8:11], 0 offen offset:8
    buffer_load_dwordx2 v[12:13], v6, s[8:11], 0 offen offset:16
    buffer_load_dwordx2 v[14:15], v6, s[8:11], 0 offen offset:24
    buffer_load_dwordx2 v[16:17], v6, s[8:11], 0 offen offset:32
    s_waitcnt vmcnt(0)
    v_lshlrev_b32 v40, 16, v8
    v_and_b32 v41, 0xffff0000, v8
    v_mul_f32 v44, 1.4426950408889634, v40
    v_exp_f32 v44, v44
    v_add_f32 v42, 1.0, v40
    v_cmp_lt_f32 vcc, 0, v40
    s_nop 1
    v_cndmask_b32 v42, v44, v42, vcc
    v_add_f32 v42, 0x358637bd, v42
    v_mul_f32 v44, 1.4426950408889634, v41
    v_exp_f32 v44, v44
    v_add_f32 v43, 1.0, v41
    v_cmp_lt_f32 vcc, 0, v41
    s_nop 1
    v_cndmask_b32 v43, v44, v43, vcc
    v_add_f32 v43, 0x358637bd, v43
    v_cvt_pk_bf16_f32 v45, v42, v43
    v_lshlrev_b32 v20, 16, v45
    v_and_b32 v21, 0xffff0000, v45
    v_lshlrev_b32 v40, 16, v9
    v_and_b32 v41, 0xffff0000, v9
    v_mul_f32 v44, 1.4426950408889634, v40
    v_exp_f32 v44, v44
    v_add_f32 v42, 1.0, v40
    v_cmp_lt_f32 vcc, 0, v40
    s_nop 1
    v_cndmask_b32 v42, v44, v42, vcc
    v_add_f32 v42, 0x358637bd, v42
    v_mul_f32 v44, 1.4426950408889634, v41
    v_exp_f32 v44, v44
    v_add_f32 v43, 1.0, v41
    v_cmp_lt_f32 vcc, 0, v41
    s_nop 1
    v_cndmask_b32 v43, v44, v43, vcc
    v_add_f32 v43, 0x358637bd, v43
    v_cvt_pk_bf16_f32 v45, v42, v43
    v_lshlrev_b32 v22, 16, v45
    v_and_b32 v23, 0xffff0000, v45
    v_lshlrev_b32 v40, 16, v10
    v_and_b32 v41, 0xffff0000, v10
    v_mul_f32 v44, 1.4426950408889634, v40
    v_exp_f32 v44, v44
    v_add_f32 v42, 1.0, v40
    v_cmp_lt_f32 vcc, 0, v40
    s_nop 1
    v_cndmask_b32 v42, v44, v42, vcc
    v_add_f32 v42, 0x358637bd, v42
    v_mul_f32 v44, 1.4426950408889634, v41
    v_exp_f32 v44, v44
    v_add_f32 v43, 1.0, v41
    v_cmp_lt_f32 vcc, 0, v41
    s_nop 1
    v_cndmask_b32 v43, v44, v43, vcc
    v_add_f32 v43, 0x358637bd, v43
    v_cvt_pk_bf16_f32 v45, v42, v43
    v_lshlrev_b32 v24, 16, v45
    v_and_b32 v25, 0xffff0000, v45
    v_lshlrev_b32 v40, 16, v11
    v_and_b32 v41, 0xffff0000, v11
    v_mul_f32 v44, 1.4426950408889634, v40
    v_exp_f32 v44, v44
    v_add_f32 v42, 1.0, v40
    v_cmp_lt_f32 vcc, 0, v40
    s_nop 1
    v_cndmask_b32 v42, v44, v42, vcc
    v_add_f32 v42, 0x358637bd, v42
    v_mul_f32 v44, 1.4426950408889634, v41
    v_exp_f32 v44, v44
    v_add_f32 v43, 1.0, v41
    v_cmp_lt_f32 vcc, 0, v41
    s_nop 1
    v_cndmask_b32 v43, v44, v43, vcc
    v_add_f32 v43, 0x358637bd, v43
    v_cvt_pk_bf16_f32 v45, v42, v43
    v_lshlrev_b32 v26, 16, v45
    v_and_b32 v27, 0xffff0000, v45
    v_lshlrev_b32 v40, 16, v12
    v_and_b32 v41, 0xffff0000, v12
    v_mul_f32 v44, 1.4426950408889634, v40
    v_exp_f32 v44, v44
    v_add_f32 v42, 1.0, v40
    v_cmp_lt_f32 vcc, 0, v40
    s_nop 1
    v_cndmask_b32 v42, v44, v42, vcc
    v_add_f32 v42, 0x358637bd, v42
    v_mul_f32 v44, 1.4426950408889634, v41
    v_exp_f32 v44, v44
    v_add_f32 v43, 1.0, v41
    v_cmp_lt_f32 vcc, 0, v41
    s_nop 1
    v_cndmask_b32 v43, v44, v43, vcc
    v_add_f32 v43, 0x358637bd, v43
    v_cvt_pk_bf16_f32 v45, v42, v43
    v_lshlrev_b32 v28, 16, v45
    v_and_b32 v29, 0xffff0000, v45
    v_lshlrev_b32 v40, 16, v13
    v_and_b32 v41, 0xffff0000, v13
    v_mul_f32 v44, 1.4426950408889634, v40
    v_exp_f32 v44, v44
    v_add_f32 v42, 1.0, v40
    v_cmp_lt_f32 vcc, 0, v40
    s_nop 1
    v_cndmask_b32 v42, v44, v42, vcc
    v_add_f32 v42, 0x358637bd, v42
    v_mul_f32 v44, 1.4426950408889634, v41
    v_exp_f32 v44, v44
    v_add_f32 v43, 1.0, v41
    v_cmp_lt_f32 vcc, 0, v41
    s_nop 1
    v_cndmask_b32 v43, v44, v43, vcc
    v_add_f32 v43, 0x358637bd, v43
    v_cvt_pk_bf16_f32 v45, v42, v43
    v_lshlrev_b32 v30, 16, v45
    v_and_b32 v31, 0xffff0000, v45
    v_lshlrev_b32 v40, 16, v14
    v_and_b32 v41, 0xffff0000, v14
    v_mul_f32 v44, 1.4426950408889634, v40
    v_exp_f32 v44, v44
    v_add_f32 v42, 1.0, v40
    v_cmp_lt_f32 vcc, 0, v40
    s_nop 1
    v_cndmask_b32 v42, v44, v42, vcc
    v_add_f32 v42, 0x358637bd, v42
    v_mul_f32 v44, 1.4426950408889634, v41
    v_exp_f32 v44, v44
    v_add_f32 v43, 1.0, v41
    v_cmp_lt_f32 vcc, 0, v41
    s_nop 1
    v_cndmask_b32 v43, v44, v43, vcc
    v_add_f32 v43, 0x358637bd, v43
    v_cvt_pk_bf16_f32 v45, v42, v43
    v_lshlrev_b32 v32, 16, v45
    v_and_b32 v33, 0xffff0000, v45
    v_lshlrev_b32 v40, 16, v15
    v_and_b32 v41, 0xffff0000, v15
    v_mul_f32 v44, 1.4426950408889634, v40
    v_exp_f32 v44, v44
    v_add_f32 v42, 1.0, v40
    v_cmp_lt_f32 vcc, 0, v40
    s_nop 1
    v_cndmask_b32 v42, v44, v42, vcc
    v_add_f32 v42, 0x358637bd, v42
    v_mul_f32 v44, 1.4426950408889634, v41
    v_exp_f32 v44, v44
    v_add_f32 v43, 1.0, v41
    v_cmp_lt_f32 vcc, 0, v41
    s_nop 1
    v_cndmask_b32 v43, v44, v43, vcc
    v_add_f32 v43, 0x358637bd, v43
    v_cvt_pk_bf16_f32 v45, v42, v43
    v_lshlrev_b32 v34, 16, v45
    v_and_b32 v35, 0xffff0000, v45
    v_lshlrev_b32 v40, 16, v16
    v_and_b32 v41, 0xffff0000, v16
    v_mul_f32 v44, 1.4426950408889634, v40
    v_exp_f32 v44, v44
    v_add_f32 v42, 1.0, v40
    v_cmp_lt_f32 vcc, 0, v40
    s_nop 1
    v_cndmask_b32 v42, v44, v42, vcc
    v_add_f32 v42, 0x358637bd, v42
    v_mul_f32 v44, 1.4426950408889634, v41
    v_exp_f32 v44, v44
    v_add_f32 v43, 1.0, v41
    v_cmp_lt_f32 vcc, 0, v41
    s_nop 1
    v_cndmask_b32 v43, v44, v43, vcc
    v_add_f32 v43, 0x358637bd, v43
    v_cvt_pk_bf16_f32 v45, v42, v43
    v_lshlrev_b32 v36, 16, v45
    v_and_b32 v37, 0xffff0000, v45
    v_lshlrev_b32 v40, 16, v17
    v_and_b32 v41, 0xffff0000, v17
    v_mul_f32 v44, 1.4426950408889634, v40
    v_exp_f32 v44, v44
    v_add_f32 v42, 1.0, v40
    v_cmp_lt_f32 vcc, 0, v40
    s_nop 1
    v_cndmask_b32 v42, v44, v42, vcc
    v_add_f32 v42, 0x358637bd, v42
    v_mul_f32 v44, 1.4426950408889634, v41
    v_exp_f32 v44, v44
    v_add_f32 v43, 1.0, v41
    v_cmp_lt_f32 vcc, 0, v41
    s_nop 1
    v_cndmask_b32 v43, v44, v43, vcc
    v_add_f32 v43, 0x358637bd, v43
    v_cvt_pk_bf16_f32 v45, v42, v43
    v_lshlrev_b32 v38, 16, v45
    v_and_b32 v39, 0xffff0000, v45
    v_mul_u32_u24 v7, 2688, v2
    ds_read_b128 v[72:75], v7 offset:0
    ds_read_b128 v[76:79], v7 offset:16
    ds_read_b128 v[80:83], v7 offset:32
    ds_read_b128 v[84:87], v7 offset:48
    ds_read_b128 v[88:91], v7 offset:64
    s_waitcnt lgkmcnt(0)
    v_mul_f32 v50, v20, v72
    v_fmac_f32 v50, v21, v73
    v_fmac_f32 v50, v22, v74
    v_fmac_f32 v50, v23, v75
    v_fmac_f32 v50, v24, v76
    v_fmac_f32 v50, v25, v77
    v_fmac_f32 v50, v26, v78
    v_fmac_f32 v50, v27, v79
    v_fmac_f32 v50, v28, v80
    v_fmac_f32 v50, v29, v81
    v_fmac_f32 v50, v30, v82
    v_fmac_f32 v50, v31, v83
    v_fmac_f32 v50, v32, v84
    v_fmac_f32 v50, v33, v85
    v_fmac_f32 v50, v34, v86
    v_fmac_f32 v50, v35, v87
    v_fmac_f32 v50, v36, v88
    v_fmac_f32 v50, v37, v89
    v_fmac_f32 v50, v38, v90
    v_fmac_f32 v50, v39, v91
    ds_read_b128 v[72:75], v7 offset:128
    ds_read_b128 v[76:79], v7 offset:144
    ds_read_b128 v[80:83], v7 offset:160
    ds_read_b128 v[84:87], v7 offset:176
    ds_read_b128 v[88:91], v7 offset:192
    s_waitcnt lgkmcnt(0)
    v_mul_f32 v51, v20, v72
    v_fmac_f32 v51, v21, v73
    v_fmac_f32 v51, v22, v74
    v_fmac_f32 v51, v23, v75
    v_fmac_f32 v51, v24, v76
    v_fmac_f32 v51, v25, v77
    v_fmac_f32 v51, v26, v78
    v_fmac_f32 v51, v27, v79
    v_fmac_f32 v51, v28, v80
    v_fmac_f32 v51, v29, v81
    v_fmac_f32 v51, v30, v82
    v_fmac_f32 v51, v31, v83
    v_fmac_f32 v51, v32, v84
    v_fmac_f32 v51, v33, v85
    v_fmac_f32 v51, v34, v86
    v_fmac_f32 v51, v35, v87
    v_fmac_f32 v51, v36, v88
    v_fmac_f32 v51, v37, v89
    v_fmac_f32 v51, v38, v90
    v_fmac_f32 v51, v39, v91
    ds_read_b128 v[72:75], v7 offset:256
    ds_read_b128 v[76:79], v7 offset:272
    ds_read_b128 v[80:83], v7 offset:288
    ds_read_b128 v[84:87], v7 offset:304
    ds_read_b128 v[88:91], v7 offset:320
    s_waitcnt lgkmcnt(0)
    v_mul_f32 v52, v20, v72
    v_fmac_f32 v52, v21, v73
    v_fmac_f32 v52, v22, v74
    v_fmac_f32 v52, v23, v75
    v_fmac_f32 v52, v24, v76
    v_fmac_f32 v52, v25, v77
    v_fmac_f32 v52, v26, v78
    v_fmac_f32 v52, v27, v79
    v_fmac_f32 v52, v28, v80
    v_fmac_f32 v52, v29, v81
    v_fmac_f32 v52, v30, v82
    v_fmac_f32 v52, v31, v83
    v_fmac_f32 v52, v32, v84
    v_fmac_f32 v52, v33, v85
    v_fmac_f32 v52, v34, v86
    v_fmac_f32 v52, v35, v87
    v_fmac_f32 v52, v36, v88
    v_fmac_f32 v52, v37, v89
    v_fmac_f32 v52, v38, v90
    v_fmac_f32 v52, v39, v91
    ds_read_b128 v[72:75], v7 offset:384
    ds_read_b128 v[76:79], v7 offset:400
    ds_read_b128 v[80:83], v7 offset:416
    ds_read_b128 v[84:87], v7 offset:432
    ds_read_b128 v[88:91], v7 offset:448
    s_waitcnt lgkmcnt(0)
    v_mul_f32 v53, v20, v72
    v_fmac_f32 v53, v21, v73
    v_fmac_f32 v53, v22, v74
    v_fmac_f32 v53, v23, v75
    v_fmac_f32 v53, v24, v76
    v_fmac_f32 v53, v25, v77
    v_fmac_f32 v53, v26, v78
    v_fmac_f32 v53, v27, v79
    v_fmac_f32 v53, v28, v80
    v_fmac_f32 v53, v29, v81
    v_fmac_f32 v53, v30, v82
    v_fmac_f32 v53, v31, v83
    v_fmac_f32 v53, v32, v84
    v_fmac_f32 v53, v33, v85
    v_fmac_f32 v53, v34, v86
    v_fmac_f32 v53, v35, v87
    v_fmac_f32 v53, v36, v88
    v_fmac_f32 v53, v37, v89
    v_fmac_f32 v53, v38, v90
    v_fmac_f32 v53, v39, v91
    ds_read_b128 v[72:75], v7 offset:512
    ds_read_b128 v[76:79], v7 offset:528
    ds_read_b128 v[80:83], v7 offset:544
    ds_read_b128 v[84:87], v7 offset:560
    ds_read_b128 v[88:91], v7 offset:576
    s_waitcnt lgkmcnt(0)
    v_mul_f32 v54, v20, v72
    v_fmac_f32 v54, v21, v73
    v_fmac_f32 v54, v22, v74
    v_fmac_f32 v54, v23, v75
    v_fmac_f32 v54, v24, v76
    v_fmac_f32 v54, v25, v77
    v_fmac_f32 v54, v26, v78
    v_fmac_f32 v54, v27, v79
    v_fmac_f32 v54, v28, v80
    v_fmac_f32 v54, v29, v81
    v_fmac_f32 v54, v30, v82
    v_fmac_f32 v54, v31, v83
    v_fmac_f32 v54, v32, v84
    v_fmac_f32 v54, v33, v85
    v_fmac_f32 v54, v34, v86
    v_fmac_f32 v54, v35, v87
    v_fmac_f32 v54, v36, v88
    v_fmac_f32 v54, v37, v89
    v_fmac_f32 v54, v38, v90
    v_fmac_f32 v54, v39, v91
    ds_read_b128 v[72:75], v7 offset:640
    ds_read_b128 v[76:79], v7 offset:656
    ds_read_b128 v[80:83], v7 offset:672
    ds_read_b128 v[84:87], v7 offset:688
    ds_read_b128 v[88:91], v7 offset:704
    s_waitcnt lgkmcnt(0)
    v_mul_f32 v55, v20, v72
    v_fmac_f32 v55, v21, v73
    v_fmac_f32 v55, v22, v74
    v_fmac_f32 v55, v23, v75
    v_fmac_f32 v55, v24, v76
    v_fmac_f32 v55, v25, v77
    v_fmac_f32 v55, v26, v78
    v_fmac_f32 v55, v27, v79
    v_fmac_f32 v55, v28, v80
    v_fmac_f32 v55, v29, v81
    v_fmac_f32 v55, v30, v82
    v_fmac_f32 v55, v31, v83
    v_fmac_f32 v55, v32, v84
    v_fmac_f32 v55, v33, v85
    v_fmac_f32 v55, v34, v86
    v_fmac_f32 v55, v35, v87
    v_fmac_f32 v55, v36, v88
    v_fmac_f32 v55, v37, v89
    v_fmac_f32 v55, v38, v90
    v_fmac_f32 v55, v39, v91
    ds_read_b128 v[72:75], v7 offset:768
    ds_read_b128 v[76:79], v7 offset:784
    ds_read_b128 v[80:83], v7 offset:800
    ds_read_b128 v[84:87], v7 offset:816
    ds_read_b128 v[88:91], v7 offset:832
    s_waitcnt lgkmcnt(0)
    v_mul_f32 v56, v20, v72
    v_fmac_f32 v56, v21, v73
    v_fmac_f32 v56, v22, v74
    v_fmac_f32 v56, v23, v75
    v_fmac_f32 v56, v24, v76
    v_fmac_f32 v56, v25, v77
    v_fmac_f32 v56, v26, v78
    v_fmac_f32 v56, v27, v79
    v_fmac_f32 v56, v28, v80
    v_fmac_f32 v56, v29, v81
    v_fmac_f32 v56, v30, v82
    v_fmac_f32 v56, v31, v83
    v_fmac_f32 v56, v32, v84
    v_fmac_f32 v56, v33, v85
    v_fmac_f32 v56, v34, v86
    v_fmac_f32 v56, v35, v87
    v_fmac_f32 v56, v36, v88
    v_fmac_f32 v56, v37, v89
    v_fmac_f32 v56, v38, v90
    v_fmac_f32 v56, v39, v91
    ds_read_b128 v[72:75], v7 offset:896
    ds_read_b128 v[76:79], v7 offset:912
    ds_read_b128 v[80:83], v7 offset:928
    ds_read_b128 v[84:87], v7 offset:944
    ds_read_b128 v[88:91], v7 offset:960
    s_waitcnt lgkmcnt(0)
    v_mul_f32 v57, v20, v72
    v_fmac_f32 v57, v21, v73
    v_fmac_f32 v57, v22, v74
    v_fmac_f32 v57, v23, v75
    v_fmac_f32 v57, v24, v76
    v_fmac_f32 v57, v25, v77
    v_fmac_f32 v57, v26, v78
    v_fmac_f32 v57, v27, v79
    v_fmac_f32 v57, v28, v80
    v_fmac_f32 v57, v29, v81
    v_fmac_f32 v57, v30, v82
    v_fmac_f32 v57, v31, v83
    v_fmac_f32 v57, v32, v84
    v_fmac_f32 v57, v33, v85
    v_fmac_f32 v57, v34, v86
    v_fmac_f32 v57, v35, v87
    v_fmac_f32 v57, v36, v88
    v_fmac_f32 v57, v37, v89
    v_fmac_f32 v57, v38, v90
    v_fmac_f32 v57, v39, v91
    ds_read_b128 v[72:75], v7 offset:1024
    ds_read_b128 v[76:79], v7 offset:1040
    ds_read_b128 v[80:83], v7 offset:1056
    ds_read_b128 v[84:87], v7 offset:1072
    ds_read_b128 v[88:91], v7 offset:1088
    s_waitcnt lgkmcnt(0)
    v_mul_f32 v58, v20, v72
    v_fmac_f32 v58, v21, v73
    v_fmac_f32 v58, v22, v74
    v_fmac_f32 v58, v23, v75
    v_fmac_f32 v58, v24, v76
    v_fmac_f32 v58, v25, v77
    v_fmac_f32 v58, v26, v78
    v_fmac_f32 v58, v27, v79
    v_fmac_f32 v58, v28, v80
    v_fmac_f32 v58, v29, v81
    v_fmac_f32 v58, v30, v82
    v_fmac_f32 v58, v31, v83
    v_fmac_f32 v58, v32, v84
    v_fmac_f32 v58, v33, v85
    v_fmac_f32 v58, v34, v86
    v_fmac_f32 v58, v35, v87
    v_fmac_f32 v58, v36, v88
    v_fmac_f32 v58, v37, v89
    v_fmac_f32 v58, v38, v90
    v_fmac_f32 v58, v39, v91
    ds_read_b128 v[72:75], v7 offset:1152
    ds_read_b128 v[76:79], v7 offset:1168
    ds_read_b128 v[80:83], v7 offset:1184
    ds_read_b128 v[84:87], v7 offset:1200
    ds_read_b128 v[88:91], v7 offset:1216
    s_waitcnt lgkmcnt(0)
    v_mul_f32 v59, v20, v72
    v_fmac_f32 v59, v21, v73
    v_fmac_f32 v59, v22, v74
    v_fmac_f32 v59, v23, v75
    v_fmac_f32 v59, v24, v76
    v_fmac_f32 v59, v25, v77
    v_fmac_f32 v59, v26, v78
    v_fmac_f32 v59, v27, v79
    v_fmac_f32 v59, v28, v80
    v_fmac_f32 v59, v29, v81
    v_fmac_f32 v59, v30, v82
    v_fmac_f32 v59, v31, v83
    v_fmac_f32 v59, v32, v84
    v_fmac_f32 v59, v33, v85
    v_fmac_f32 v59, v34, v86
    v_fmac_f32 v59, v35, v87
    v_fmac_f32 v59, v36, v88
    v_fmac_f32 v59, v37, v89
    v_fmac_f32 v59, v38, v90
    v_fmac_f32 v59, v39, v91
    ds_read_b128 v[72:75], v7 offset:1280
    ds_read_b128 v[76:79], v7 offset:1296
    ds_read_b128 v[80:83], v7 offset:1312
    ds_read_b128 v[84:87], v7 offset:1328
    ds_read_b128 v[88:91], v7 offset:1344
    s_waitcnt lgkmcnt(0)
    v_mul_f32 v60, v20, v72
    v_fmac_f32 v60, v21, v73
    v_fmac_f32 v60, v22, v74
    v_fmac_f32 v60, v23, v75
    v_fmac_f32 v60, v24, v76
    v_fmac_f32 v60, v25, v77
    v_fmac_f32 v60, v26, v78
    v_fmac_f32 v60, v27, v79
    v_fmac_f32 v60, v28, v80
    v_fmac_f32 v60, v29, v81
    v_fmac_f32 v60, v30, v82
    v_fmac_f32 v60, v31, v83
    v_fmac_f32 v60, v32, v84
    v_fmac_f32 v60, v33, v85
    v_fmac_f32 v60, v34, v86
    v_fmac_f32 v60, v35, v87
    v_fmac_f32 v60, v36, v88
    v_fmac_f32 v60, v37, v89
    v_fmac_f32 v60, v38, v90
    v_fmac_f32 v60, v39, v91
    ds_read_b128 v[72:75], v7 offset:1408
    ds_read_b128 v[76:79], v7 offset:1424
    ds_read_b128 v[80:83], v7 offset:1440
    ds_read_b128 v[84:87], v7 offset:1456
    ds_read_b128 v[88:91], v7 offset:1472
    s_waitcnt lgkmcnt(0)
    v_mul_f32 v61, v20, v72
    v_fmac_f32 v61, v21, v73
    v_fmac_f32 v61, v22, v74
    v_fmac_f32 v61, v23, v75
    v_fmac_f32 v61, v24, v76
    v_fmac_f32 v61, v25, v77
    v_fmac_f32 v61, v26, v78
    v_fmac_f32 v61, v27, v79
    v_fmac_f32 v61, v28, v80
    v_fmac_f32 v61, v29, v81
    v_fmac_f32 v61, v30, v82
    v_fmac_f32 v61, v31, v83
    v_fmac_f32 v61, v32, v84
    v_fmac_f32 v61, v33, v85
    v_fmac_f32 v61, v34, v86
    v_fmac_f32 v61, v35, v87
    v_fmac_f32 v61, v36, v88
    v_fmac_f32 v61, v37, v89
    v_fmac_f32 v61, v38, v90
    v_fmac_f32 v61, v39, v91
    ds_read_b128 v[72:75], v7 offset:1536
    ds_read_b128 v[76:79], v7 offset:1552
    ds_read_b128 v[80:83], v7 offset:1568
    ds_read_b128 v[84:87], v7 offset:1584
    ds_read_b128 v[88:91], v7 offset:1600
    s_waitcnt lgkmcnt(0)
    v_mul_f32 v62, v20, v72
    v_fmac_f32 v62, v21, v73
    v_fmac_f32 v62, v22, v74
    v_fmac_f32 v62, v23, v75
    v_fmac_f32 v62, v24, v76
    v_fmac_f32 v62, v25, v77
    v_fmac_f32 v62, v26, v78
    v_fmac_f32 v62, v27, v79
    v_fmac_f32 v62, v28, v80
    v_fmac_f32 v62, v29, v81
    v_fmac_f32 v62, v30, v82
    v_fmac_f32 v62, v31, v83
    v_fmac_f32 v62, v32, v84
    v_fmac_f32 v62, v33, v85
    v_fmac_f32 v62, v34, v86
    v_fmac_f32 v62, v35, v87
    v_fmac_f32 v62, v36, v88
    v_fmac_f32 v62, v37, v89
    v_fmac_f32 v62, v38, v90
    v_fmac_f32 v62, v39, v91
    ds_read_b128 v[72:75], v7 offset:1664
    ds_read_b128 v[76:79], v7 offset:1680
    ds_read_b128 v[80:83], v7 offset:1696
    ds_read_b128 v[84:87], v7 offset:1712
    ds_read_b128 v[88:91], v7 offset:1728
    s_waitcnt lgkmcnt(0)
    v_mul_f32 v63, v20, v72
    v_fmac_f32 v63, v21, v73
    v_fmac_f32 v63, v22, v74
    v_fmac_f32 v63, v23, v75
    v_fmac_f32 v63, v24, v76
    v_fmac_f32 v63, v25, v77
    v_fmac_f32 v63, v26, v78
    v_fmac_f32 v63, v27, v79
    v_fmac_f32 v63, v28, v80
    v_fmac_f32 v63, v29, v81
    v_fmac_f32 v63, v30, v82
    v_fmac_f32 v63, v31, v83
    v_fmac_f32 v63, v32, v84
    v_fmac_f32 v63, v33, v85
    v_fmac_f32 v63, v34, v86
    v_fmac_f32 v63, v35, v87
    v_fmac_f32 v63, v36, v88
    v_fmac_f32 v63, v37, v89
    v_fmac_f32 v63, v38, v90
    v_fmac_f32 v63, v39, v91
    ds_read_b128 v[72:75], v7 offset:1792
    ds_read_b128 v[76:79], v7 offset:1808
    ds_read_b128 v[80:83], v7 offset:1824
    ds_read_b128 v[84:87], v7 offset:1840
    ds_read_b128 v[88:91], v7 offset:1856
    s_waitcnt lgkmcnt(0)
    v_mul_f32 v64, v20, v72
    v_fmac_f32 v64, v21, v73
    v_fmac_f32 v64, v22, v74
    v_fmac_f32 v64, v23, v75
    v_fmac_f32 v64, v24, v76
    v_fmac_f32 v64, v25, v77
    v_fmac_f32 v64, v26, v78
    v_fmac_f32 v64, v27, v79
    v_fmac_f32 v64, v28, v80
    v_fmac_f32 v64, v29, v81
    v_fmac_f32 v64, v30, v82
    v_fmac_f32 v64, v31, v83
    v_fmac_f32 v64, v32, v84
    v_fmac_f32 v64, v33, v85
    v_fmac_f32 v64, v34, v86
    v_fmac_f32 v64, v35, v87
    v_fmac_f32 v64, v36, v88
    v_fmac_f32 v64, v37, v89
    v_fmac_f32 v64, v38, v90
    v_fmac_f32 v64, v39, v91
    ds_read_b128 v[72:75], v7 offset:1920
    ds_read_b128 v[76:79], v7 offset:1936
    ds_read_b128 v[80:83], v7 offset:1952
    ds_read_b128 v[84:87], v7 offset:1968
    ds_read_b128 v[88:91], v7 offset:1984
    s_waitcnt lgkmcnt(0)
    v_mul_f32 v65, v20, v72
    v_fmac_f32 v65, v21, v73
    v_fmac_f32 v65, v22, v74
    v_fmac_f32 v65, v23, v75
    v_fmac_f32 v65, v24, v76
    v_fmac_f32 v65, v25, v77
    v_fmac_f32 v65, v26, v78
    v_fmac_f32 v65, v27, v79
    v_fmac_f32 v65, v28, v80
    v_fmac_f32 v65, v29, v81
    v_fmac_f32 v65, v30, v82
    v_fmac_f32 v65, v31, v83
    v_fmac_f32 v65, v32, v84
    v_fmac_f32 v65, v33, v85
    v_fmac_f32 v65, v34, v86
    v_fmac_f32 v65, v35, v87
    v_fmac_f32 v65, v36, v88
    v_fmac_f32 v65, v37, v89
    v_fmac_f32 v65, v38, v90
    v_fmac_f32 v65, v39, v91
    ds_read_b128 v[72:75], v7 offset:2048
    ds_read_b128 v[76:79], v7 offset:2064
    ds_read_b128 v[80:83], v7 offset:2080
    ds_read_b128 v[84:87], v7 offset:2096
    ds_read_b128 v[88:91], v7 offset:2112
    s_waitcnt lgkmcnt(0)
    v_mul_f32 v66, v20, v72
    v_fmac_f32 v66, v21, v73
    v_fmac_f32 v66, v22, v74
    v_fmac_f32 v66, v23, v75
    v_fmac_f32 v66, v24, v76
    v_fmac_f32 v66, v25, v77
    v_fmac_f32 v66, v26, v78
    v_fmac_f32 v66, v27, v79
    v_fmac_f32 v66, v28, v80
    v_fmac_f32 v66, v29, v81
    v_fmac_f32 v66, v30, v82
    v_fmac_f32 v66, v31, v83
    v_fmac_f32 v66, v32, v84
    v_fmac_f32 v66, v33, v85
    v_fmac_f32 v66, v34, v86
    v_fmac_f32 v66, v35, v87
    v_fmac_f32 v66, v36, v88
    v_fmac_f32 v66, v37, v89
    v_fmac_f32 v66, v38, v90
    v_fmac_f32 v66, v39, v91
    ds_read_b128 v[72:75], v7 offset:2176
    ds_read_b128 v[76:79], v7 offset:2192
    ds_read_b128 v[80:83], v7 offset:2208
    ds_read_b128 v[84:87], v7 offset:2224
    ds_read_b128 v[88:91], v7 offset:2240
    s_waitcnt lgkmcnt(0)
    v_mul_f32 v67, v20, v72
    v_fmac_f32 v67, v21, v73
    v_fmac_f32 v67, v22, v74
    v_fmac_f32 v67, v23, v75
    v_fmac_f32 v67, v24, v76
    v_fmac_f32 v67, v25, v77
    v_fmac_f32 v67, v26, v78
    v_fmac_f32 v67, v27, v79
    v_fmac_f32 v67, v28, v80
    v_fmac_f32 v67, v29, v81
    v_fmac_f32 v67, v30, v82
    v_fmac_f32 v67, v31, v83
    v_fmac_f32 v67, v32, v84
    v_fmac_f32 v67, v33, v85
    v_fmac_f32 v67, v34, v86
    v_fmac_f32 v67, v35, v87
    v_fmac_f32 v67, v36, v88
    v_fmac_f32 v67, v37, v89
    v_fmac_f32 v67, v38, v90
    v_fmac_f32 v67, v39, v91
    ds_read_b128 v[72:75], v7 offset:2304
    ds_read_b128 v[76:79], v7 offset:2320
    ds_read_b128 v[80:83], v7 offset:2336
    ds_read_b128 v[84:87], v7 offset:2352
    ds_read_b128 v[88:91], v7 offset:2368
    s_waitcnt lgkmcnt(0)
    v_mul_f32 v68, v20, v72
    v_fmac_f32 v68, v21, v73
    v_fmac_f32 v68, v22, v74
    v_fmac_f32 v68, v23, v75
    v_fmac_f32 v68, v24, v76
    v_fmac_f32 v68, v25, v77
    v_fmac_f32 v68, v26, v78
    v_fmac_f32 v68, v27, v79
    v_fmac_f32 v68, v28, v80
    v_fmac_f32 v68, v29, v81
    v_fmac_f32 v68, v30, v82
    v_fmac_f32 v68, v31, v83
    v_fmac_f32 v68, v32, v84
    v_fmac_f32 v68, v33, v85
    v_fmac_f32 v68, v34, v86
    v_fmac_f32 v68, v35, v87
    v_fmac_f32 v68, v36, v88
    v_fmac_f32 v68, v37, v89
    v_fmac_f32 v68, v38, v90
    v_fmac_f32 v68, v39, v91
    ds_read_b128 v[72:75], v7 offset:2432
    ds_read_b128 v[76:79], v7 offset:2448
    ds_read_b128 v[80:83], v7 offset:2464
    ds_read_b128 v[84:87], v7 offset:2480
    ds_read_b128 v[88:91], v7 offset:2496
    s_waitcnt lgkmcnt(0)
    v_mul_f32 v69, v20, v72
    v_fmac_f32 v69, v21, v73
    v_fmac_f32 v69, v22, v74
    v_fmac_f32 v69, v23, v75
    v_fmac_f32 v69, v24, v76
    v_fmac_f32 v69, v25, v77
    v_fmac_f32 v69, v26, v78
    v_fmac_f32 v69, v27, v79
    v_fmac_f32 v69, v28, v80
    v_fmac_f32 v69, v29, v81
    v_fmac_f32 v69, v30, v82
    v_fmac_f32 v69, v31, v83
    v_fmac_f32 v69, v32, v84
    v_fmac_f32 v69, v33, v85
    v_fmac_f32 v69, v34, v86
    v_fmac_f32 v69, v35, v87
    v_fmac_f32 v69, v36, v88
    v_fmac_f32 v69, v37, v89
    v_fmac_f32 v69, v38, v90
    v_fmac_f32 v69, v39, v91
    ds_read_b128 v[72:75], v7 offset:2560
    ds_read_b128 v[76:79], v7 offset:2576
    ds_read_b128 v[80:83], v7 offset:2592
    ds_read_b128 v[84:87], v7 offset:2608
    ds_read_b128 v[88:91], v7 offset:2624
    s_waitcnt lgkmcnt(0)
    v_mul_f32 v70, v20, v72
    v_fmac_f32 v70, v21, v73
    v_fmac_f32 v70, v22, v74
    v_fmac_f32 v70, v23, v75
    v_fmac_f32 v70, v24, v76
    v_fmac_f32 v70, v25, v77
    v_fmac_f32 v70, v26, v78
    v_fmac_f32 v70, v27, v79
    v_fmac_f32 v70, v28, v80
    v_fmac_f32 v70, v29, v81
    v_fmac_f32 v70, v30, v82
    v_fmac_f32 v70, v31, v83
    v_fmac_f32 v70, v32, v84
    v_fmac_f32 v70, v33, v85
    v_fmac_f32 v70, v34, v86
    v_fmac_f32 v70, v35, v87
    v_fmac_f32 v70, v36, v88
    v_fmac_f32 v70, v37, v89
    v_fmac_f32 v70, v38, v90
    v_fmac_f32 v70, v39, v91
    v_add_f32 v70, 0x358637bd, v70
    v_rcp_f32 v70, v70
    s_nop 0
    v_mul_f32 v50, v50, v70
    v_mul_f32 v51, v51, v70
    v_mul_f32 v52, v52, v70
    v_mul_f32 v53, v53, v70
    v_mul_f32 v54, v54, v70
    v_mul_f32 v55, v55, v70
    v_mul_f32 v56, v56, v70
    v_mul_f32 v57, v57, v70
    v_mul_f32 v58, v58, v70
    v_mul_f32 v59, v59, v70
    v_mul_f32 v60, v60, v70
    v_mul_f32 v61, v61, v70
    v_mul_f32 v62, v62, v70
    v_mul_f32 v63, v63, v70
    v_mul_f32 v64, v64, v70
    v_mul_f32 v65, v65, v70
    v_mul_f32 v66, v66, v70
    v_mul_f32 v67, v67, v70
    v_mul_f32 v68, v68, v70
    v_mul_f32 v69, v69, v70
    v_cvt_pk_bf16_f32 v8, v50, v51
    v_cvt_pk_bf16_f32 v9, v52, v53
    v_cvt_pk_bf16_f32 v10, v54, v55
    v_cvt_pk_bf16_f32 v11, v56, v57
    v_cvt_pk_bf16_f32 v12, v58, v59
    v_cvt_pk_bf16_f32 v13, v60, v61
    v_cvt_pk_bf16_f32 v14, v62, v63
    v_cvt_pk_bf16_f32 v15, v64, v65
    v_cvt_pk_bf16_f32 v16, v66, v67
    v_cvt_pk_bf16_f32 v17, v68, v69
    v_add_u32 v6, 18874368, v4
    buffer_store_dwordx2 v[8:9], v6, s[8:11], 0 offen offset:0
    buffer_store_dwordx2 v[10:11], v6, s[8:11], 0 offen offset:8
    buffer_store_dwordx2 v[12:13], v6, s[8:11], 0 offen offset:16
    buffer_store_dwordx2 v[14:15], v6, s[8:11], 0 offen offset:24
    buffer_store_dwordx2 v[16:17], v6, s[8:11], 0 offen offset:32
attn_a1_kernel_end:
    s_endpgm
.section .rodata,"a"
.p2align 6
.amdhsa_kernel attn_a1_kernel
  .amdhsa_next_free_vgpr 96
  .amdhsa_next_free_sgpr 40
  .amdhsa_accum_offset 96
  .amdhsa_group_segment_fixed_size 0
  .amdhsa_kernarg_size 104
  .amdhsa_user_sgpr_count 2
  .amdhsa_user_sgpr_kernarg_segment_ptr 1
  .amdhsa_system_sgpr_workgroup_id_x 1
.end_amdhsa_kernel
.text
.globl wo_a1_kernel
.p2align 8
.type wo_a1_kernel,@function
wo_a1_kernel:
    v_lshrrev_b32 v1, 6, v0
    v_and_b32 v2, 63, v0
    s_nop 0
    v_readfirstlane_b32 s3, v1
    s_cmp_ge_u32 s2, 128
    s_cbranch_scc1 wo_a1_kernel_end
    s_load_dwordx2 s[4:5], s[0:1], 96
    s_load_dwordx2 s[6:7], s[0:1], 80
    s_load_dwordx2 s[42:43], s[0:1], 0
    s_mul_i32 s20, s2, 1
    s_lshr_b32 s20, s20, 3
    s_mul_i32 s21, s20, 8
    s_sub_u32 s21, s2, s21
    s_lshl_b32 s20, s20, 2
    s_add_u32 s20, s20, s3
    s_mul_i32 s22, s20, 32
    s_mul_i32 s23, s21, 80
    s_waitcnt lgkmcnt(0)
    s_mov_b32 s8, s4
    s_mov_b32 s9, s5
    s_mov_b32 s10, 268435456
    s_mov_b32 s11, 0x00020000
    v_and_b32 v3, 15, v2
    v_lshrrev_b32 v4, 4, v2
    s_mov_b32 s24, 1280
    v_add_u32 v5, s22, v3
    v_mul_lo_u32 v5, v5, s24
    v_lshlrev_b32 v6, 4, v4
    v_add_u32 v5, v5, v6
    v_add_u32 v5, 18874368, v5
    v_mov_b32 v8, v5
    v_add_u32 v9, 20480, v5
    v_lshlrev_b32 v7, 4, v2
    s_mov_b32 s25, 0
    s_mov_b32 s26, 0
    s_mul_i32 s27, s21, 102400
    s_add_u32 s27, s27, s26
    s_add_u32 s27, s27, 29360128
    s_add_u32 s32, s27, 0
    s_add_u32 s33, s27, 20480
    s_add_u32 s34, s27, 40960
    s_add_u32 s35, s27, 61440
    s_add_u32 s36, s27, 81920
    v_accvgpr_write_b32 a0, 0
    v_accvgpr_write_b32 a1, 0
    v_accvgpr_write_b32 a2, 0
    v_accvgpr_write_b32 a3, 0
    v_accvgpr_write_b32 a4, 0
    v_accvgpr_write_b32 a5, 0
    v_accvgpr_write_b32 a6, 0
    v_accvgpr_write_b32 a7, 0
    v_accvgpr_write_b32 a8, 0
    v_accvgpr_write_b32 a9, 0
    v_accvgpr_write_b32 a10, 0
    v_accvgpr_write_b32 a11, 0
    v_accvgpr_write_b32 a12, 0
    v_accvgpr_write_b32 a13, 0
    v_accvgpr_write_b32 a14, 0
    v_accvgpr_write_b32 a15, 0
    v_accvgpr_write_b32 a16, 0
    v_accvgpr_write_b32 a17, 0
    v_accvgpr_write_b32 a18, 0
    v_accvgpr_write_b32 a19, 0
    v_accvgpr_write_b32 a20, 0
    v_accvgpr_write_b32 a21, 0
    v_accvgpr_write_b32 a22, 0
    v_accvgpr_write_b32 a23, 0
    v_accvgpr_write_b32 a24, 0
    v_accvgpr_write_b32 a25, 0
    v_accvgpr_write_b32 a26, 0
    v_accvgpr_write_b32 a27, 0
    v_accvgpr_write_b32 a28, 0
    v_accvgpr_write_b32 a29, 0
    v_accvgpr_write_b32 a30, 0
    v_accvgpr_write_b32 a31, 0
    v_accvgpr_write_b32 a32, 0
    v_accvgpr_write_b32 a33, 0
    v_accvgpr_write_b32 a34, 0
    v_accvgpr_write_b32 a35, 0
    v_accvgpr_write_b32 a36, 0
    v_accvgpr_write_b32 a37, 0
    v_accvgpr_write_b32 a38, 0
    v_accvgpr_write_b32 a39, 0
    buffer_load_dwordx4 v[16:19], v8, s[8:11], s25 offen
    buffer_load_dwordx4 v[20:23], v9, s[8:11], s25 offen
    buffer_load_dwordx4 v[24:27], v7, s[8:11], s32 offen
    buffer_load_dwordx4 v[28:31], v7, s[8:11], s33 offen
    buffer_load_dwordx4 v[32:35], v7, s[8:11], s34 offen
    buffer_load_dwordx4 v[36:39], v7, s[8:11], s35 offen
    buffer_load_dwordx4 v[40:43], v7, s[8:11], s36 offen
    s_mov_b32 s28, 10
wo_a1_kernel_loop0:
    s_add_u32 s25, s25, 64
    s_add_u32 s32, s32, 1024
    s_add_u32 s33, s33, 1024
    s_add_u32 s34, s34, 1024
    s_add_u32 s35, s35, 1024
    s_add_u32 s36, s36, 1024
    buffer_load_dwordx4 v[44:47], v8, s[8:11], s25 offen
    buffer_load_dwordx4 v[48:51], v9, s[8:11], s25 offen
    buffer_load_dwordx4 v[52:55], v7, s[8:11], s32 offen
    buffer_load_dwordx4 v[56:59], v7, s[8:11], s33 offen
    buffer_load_dwordx4 v[60:63], v7, s[8:11], s34 offen
    buffer_load_dwordx4 v[64:67], v7, s[8:11], s35 offen
    buffer_load_dwordx4 v[68:71], v7, s[8:11], s36 offen
    s_waitcnt vmcnt(7)
    v_mfma_f32_16x16x32_bf16 a[0:3], v[24:27], v[16:19], a[0:3]
    v_mfma_f32_16x16x32_bf16 a[20:23], v[24:27], v[20:23], a[20:23]
    v_mfma_f32_16x16x32_bf16 a[4:7], v[28:31], v[16:19], a[4:7]
    v_mfma_f32_16x16x32_bf16 a[24:27], v[28:31], v[20:23], a[24:27]
    v_mfma_f32_16x16x32_bf16 a[8:11], v[32:35], v[16:19], a[8:11]
    v_mfma_f32_16x16x32_bf16 a[28:31], v[32:35], v[20:23], a[28:31]
    v_mfma_f32_16x16x32_bf16 a[12:15], v[36:39], v[16:19], a[12:15]
    v_mfma_f32_16x16x32_bf16 a[32:35], v[36:39], v[20:23], a[32:35]
    v_mfma_f32_16x16x32_bf16 a[16:19], v[40:43], v[16:19], a[16:19]
    v_mfma_f32_16x16x32_bf16 a[36:39], v[40:43], v[20:23], a[36:39]
    s_sub_u32 s28, s28, 1
    s_cmp_eq_u32 s28, 0
    s_cbranch_scc1 wo_a1_kernel_loop0_last
    s_add_u32 s25, s25, 64
    s_add_u32 s32, s32, 1024
    s_add_u32 s33, s33, 1024
    s_add_u32 s34, s34, 1024
    s_add_u32 s35, s35, 1024
    s_add_u32 s36, s36, 1024
    buffer_load_dwordx4 v[16:19], v8, s[8:11], s25 offen
    buffer_load_dwordx4 v[20:23], v9, s[8:11], s25 offen
    buffer_load_dwordx4 v[24:27], v7, s[8:11], s32 offen
    buffer_load_dwordx4 v[28:31], v7, s[8:11], s33 offen
    buffer_load_dwordx4 v[32:35], v7, s[8:11], s34 offen
    buffer_load_dwordx4 v[36:39], v7, s[8:11], s35 offen
    buffer_load_dwordx4 v[40:43], v7, s[8:11], s36 offen
    s_waitcnt vmcnt(7)
    v_mfma_f32_16x16x32_bf16 a[0:3], v[52:55], v[44:47], a[0:3]
    v_mfma_f32_16x16x32_bf16 a[20:23], v[52:55], v[48:51], a[20:23]
    v_mfma_f32_16x16x32_bf16 a[4:7], v[56:59], v[44:47], a[4:7]
    v_mfma_f32_16x16x32_bf16 a[24:27], v[56:59], v[48:51], a[24:27]
    v_mfma_f32_16x16x32_bf16 a[8:11], v[60:63], v[44:47], a[8:11]
    v_mfma_f32_16x16x32_bf16 a[28:31], v[60:63], v[48:51], a[28:31]
    v_mfma_f32_16x16x32_bf16 a[12:15], v[64:67], v[44:47], a[12:15]
    v_mfma_f32_16x16x32_bf16 a[32:35], v[64:67], v[48:51], a[32:35]
    v_mfma_f32_16x16x32_bf16 a[16:19], v[68:71], v[44:47], a[16:19]
    v_mfma_f32_16x16x32_bf16 a[36:39], v[68:71], v[48:51], a[36:39]
    s_branch wo_a1_kernel_loop0
wo_a1_kernel_loop0_last:
    s_waitcnt vmcnt(0)
    v_mfma_f32_16x16x32_bf16 a[0:3], v[52:55], v[44:47], a[0:3]
    v_mfma_f32_16x16x32_bf16 a[20:23], v[52:55], v[48:51], a[20:23]
    v_mfma_f32_16x16x32_bf16 a[4:7], v[56:59], v[44:47], a[4:7]
    v_mfma_f32_16x16x32_bf16 a[24:27], v[56:59], v[48:51], a[24:27]
    v_mfma_f32_16x16x32_bf16 a[8:11], v[60:63], v[44:47], a[8:11]
    v_mfma_f32_16x16x32_bf16 a[28:31], v[60:63], v[48:51], a[28:31]
    v_mfma_f32_16x16x32_bf16 a[12:15], v[64:67], v[44:47], a[12:15]
    v_mfma_f32_16x16x32_bf16 a[32:35], v[64:67], v[48:51], a[32:35]
    v_mfma_f32_16x16x32_bf16 a[16:19], v[68:71], v[44:47], a[16:19]
    v_mfma_f32_16x16x32_bf16 a[36:39], v[68:71], v[48:51], a[36:39]
    s_nop 7
    s_nop 7
    s_mov_b32 s44, s42
    s_mov_b32 s45, s43
    s_mov_b32 s46, 2621440
    s_mov_b32 s47, 0x00020000
    s_mov_b32 s24, 1280
    v_add_u32 v5, s22, v3
    v_mul_lo_u32 v5, v5, s24
    v_lshlrev_b32 v6, 3, v4
    s_lshl_b32 s29, s23, 1
    v_add3_u32 v5, v5, v6, s29
    v_add_u32 v6, 0, v5
    buffer_load_dwordx2 v[72:73], v6, s[44:47], 0 offen
    v_accvgpr_read_b32 v76, a0
    v_accvgpr_read_b32 v77, a1
    v_accvgpr_read_b32 v78, a2
    v_accvgpr_read_b32 v79, a3
    v_cvt_pk_bf16_f32 v80, v76, v77
    v_cvt_pk_bf16_f32 v81, v78, v79
    s_waitcnt vmcnt(0)
    v_lshlrev_b32 v76, 16, v80
    v_and_b32 v77, 0xffff0000, v80
    v_lshlrev_b32 v82, 16, v72
    v_and_b32 v83, 0xffff0000, v72
    v_add_f32 v76, v76, v82
    v_add_f32 v77, v77, v83
    v_lshlrev_b32 v78, 16, v81
    v_and_b32 v79, 0xffff0000, v81
    v_lshlrev_b32 v82, 16, v73
    v_and_b32 v83, 0xffff0000, v73
    v_add_f32 v78, v78, v82
    v_add_f32 v79, v79, v83
    v_cvt_pk_bf16_f32 v80, v76, v77
    v_cvt_pk_bf16_f32 v81, v78, v79
    v_add_u32 v6, 4194304, v5
    buffer_store_dwordx2 v[80:81], v6, s[8:11], 0 offen
    v_add_u32 v6, 32, v5
    buffer_load_dwordx2 v[72:73], v6, s[44:47], 0 offen
    v_accvgpr_read_b32 v76, a4
    v_accvgpr_read_b32 v77, a5
    v_accvgpr_read_b32 v78, a6
    v_accvgpr_read_b32 v79, a7
    v_cvt_pk_bf16_f32 v80, v76, v77
    v_cvt_pk_bf16_f32 v81, v78, v79
    s_waitcnt vmcnt(0)
    v_lshlrev_b32 v76, 16, v80
    v_and_b32 v77, 0xffff0000, v80
    v_lshlrev_b32 v82, 16, v72
    v_and_b32 v83, 0xffff0000, v72
    v_add_f32 v76, v76, v82
    v_add_f32 v77, v77, v83
    v_lshlrev_b32 v78, 16, v81
    v_and_b32 v79, 0xffff0000, v81
    v_lshlrev_b32 v82, 16, v73
    v_and_b32 v83, 0xffff0000, v73
    v_add_f32 v78, v78, v82
    v_add_f32 v79, v79, v83
    v_cvt_pk_bf16_f32 v80, v76, v77
    v_cvt_pk_bf16_f32 v81, v78, v79
    v_add_u32 v6, 4194336, v5
    buffer_store_dwordx2 v[80:81], v6, s[8:11], 0 offen
    v_add_u32 v6, 64, v5
    buffer_load_dwordx2 v[72:73], v6, s[44:47], 0 offen
    v_accvgpr_read_b32 v76, a8
    v_accvgpr_read_b32 v77, a9
    v_accvgpr_read_b32 v78, a10
    v_accvgpr_read_b32 v79, a11
    v_cvt_pk_bf16_f32 v80, v76, v77
    v_cvt_pk_bf16_f32 v81, v78, v79
    s_waitcnt vmcnt(0)
    v_lshlrev_b32 v76, 16, v80
    v_and_b32 v77, 0xffff0000, v80
    v_lshlrev_b32 v82, 16, v72
    v_and_b32 v83, 0xffff0000, v72
    v_add_f32 v76, v76, v82
    v_add_f32 v77, v77, v83
    v_lshlrev_b32 v78, 16, v81
    v_and_b32 v79, 0xffff0000, v81
    v_lshlrev_b32 v82, 16, v73
    v_and_b32 v83, 0xffff0000, v73
    v_add_f32 v78, v78, v82
    v_add_f32 v79, v79, v83
    v_cvt_pk_bf16_f32 v80, v76, v77
    v_cvt_pk_bf16_f32 v81, v78, v79
    v_add_u32 v6, 4194368, v5
    buffer_store_dwordx2 v[80:81], v6, s[8:11], 0 offen
    v_add_u32 v6, 96, v5
    buffer_load_dwordx2 v[72:73], v6, s[44:47], 0 offen
    v_accvgpr_read_b32 v76, a12
    v_accvgpr_read_b32 v77, a13
    v_accvgpr_read_b32 v78, a14
    v_accvgpr_read_b32 v79, a15
    v_cvt_pk_bf16_f32 v80, v76, v77
    v_cvt_pk_bf16_f32 v81, v78, v79
    s_waitcnt vmcnt(0)
    v_lshlrev_b32 v76, 16, v80
    v_and_b32 v77, 0xffff0000, v80
    v_lshlrev_b32 v82, 16, v72
    v_and_b32 v83, 0xffff0000, v72
    v_add_f32 v76, v76, v82
    v_add_f32 v77, v77, v83
    v_lshlrev_b32 v78, 16, v81
    v_and_b32 v79, 0xffff0000, v81
    v_lshlrev_b32 v82, 16, v73
    v_and_b32 v83, 0xffff0000, v73
    v_add_f32 v78, v78, v82
    v_add_f32 v79, v79, v83
    v_cvt_pk_bf16_f32 v80, v76, v77
    v_cvt_pk_bf16_f32 v81, v78, v79
    v_add_u32 v6, 4194400, v5
    buffer_store_dwordx2 v[80:81], v6, s[8:11], 0 offen
    v_add_u32 v6, 128, v5
    buffer_load_dwordx2 v[72:73], v6, s[44:47], 0 offen
    v_accvgpr_read_b32 v76, a16
    v_accvgpr_read_b32 v77, a17
    v_accvgpr_read_b32 v78, a18
    v_accvgpr_read_b32 v79, a19
    v_cvt_pk_bf16_f32 v80, v76, v77
    v_cvt_pk_bf16_f32 v81, v78, v79
    s_waitcnt vmcnt(0)
    v_lshlrev_b32 v76, 16, v80
    v_and_b32 v77, 0xffff0000, v80
    v_lshlrev_b32 v82, 16, v72
    v_and_b32 v83, 0xffff0000, v72
    v_add_f32 v76, v76, v82
    v_add_f32 v77, v77, v83
    v_lshlrev_b32 v78, 16, v81
    v_and_b32 v79, 0xffff0000, v81
    v_lshlrev_b32 v82, 16, v73
    v_and_b32 v83, 0xffff0000, v73
    v_add_f32 v78, v78, v82
    v_add_f32 v79, v79, v83
    v_cvt_pk_bf16_f32 v80, v76, v77
    v_cvt_pk_bf16_f32 v81, v78, v79
    v_add_u32 v6, 4194432, v5
    buffer_store_dwordx2 v[80:81], v6, s[8:11], 0 offen
    v_add_u32 v6, 20480, v5
    buffer_load_dwordx2 v[72:73], v6, s[44:47], 0 offen
    v_accvgpr_read_b32 v76, a20
    v_accvgpr_read_b32 v77, a21
    v_accvgpr_read_b32 v78, a22
    v_accvgpr_read_b32 v79, a23
    v_cvt_pk_bf16_f32 v80, v76, v77
    v_cvt_pk_bf16_f32 v81, v78, v79
    s_waitcnt vmcnt(0)
    v_lshlrev_b32 v76, 16, v80
    v_and_b32 v77, 0xffff0000, v80
    v_lshlrev_b32 v82, 16, v72
    v_and_b32 v83, 0xffff0000, v72
    v_add_f32 v76, v76, v82
    v_add_f32 v77, v77, v83
    v_lshlrev_b32 v78, 16, v81
    v_and_b32 v79, 0xffff0000, v81
    v_lshlrev_b32 v82, 16, v73
    v_and_b32 v83, 0xffff0000, v73
    v_add_f32 v78, v78, v82
    v_add_f32 v79, v79, v83
    v_cvt_pk_bf16_f32 v80, v76, v77
    v_cvt_pk_bf16_f32 v81, v78, v79
    v_add_u32 v6, 4214784, v5
    buffer_store_dwordx2 v[80:81], v6, s[8:11], 0 offen
    v_add_u32 v6, 20512, v5
    buffer_load_dwordx2 v[72:73], v6, s[44:47], 0 offen
    v_accvgpr_read_b32 v76, a24
    v_accvgpr_read_b32 v77, a25
    v_accvgpr_read_b32 v78, a26
    v_accvgpr_read_b32 v79, a27
    v_cvt_pk_bf16_f32 v80, v76, v77
    v_cvt_pk_bf16_f32 v81, v78, v79
    s_waitcnt vmcnt(0)
    v_lshlrev_b32 v76, 16, v80
    v_and_b32 v77, 0xffff0000, v80
    v_lshlrev_b32 v82, 16, v72
    v_and_b32 v83, 0xffff0000, v72
    v_add_f32 v76, v76, v82
    v_add_f32 v77, v77, v83
    v_lshlrev_b32 v78, 16, v81
    v_and_b32 v79, 0xffff0000, v81
    v_lshlrev_b32 v82, 16, v73
    v_and_b32 v83, 0xffff0000, v73
    v_add_f32 v78, v78, v82
    v_add_f32 v79, v79, v83
    v_cvt_pk_bf16_f32 v80, v76, v77
    v_cvt_pk_bf16_f32 v81, v78, v79
    v_add_u32 v6, 4214816, v5
    buffer_store_dwordx2 v[80:81], v6, s[8:11], 0 offen
    v_add_u32 v6, 20544, v5
    buffer_load_dwordx2 v[72:73], v6, s[44:47], 0 offen
    v_accvgpr_read_b32 v76, a28
    v_accvgpr_read_b32 v77, a29
    v_accvgpr_read_b32 v78, a30
    v_accvgpr_read_b32 v79, a31
    v_cvt_pk_bf16_f32 v80, v76, v77
    v_cvt_pk_bf16_f32 v81, v78, v79
    s_waitcnt vmcnt(0)
    v_lshlrev_b32 v76, 16, v80
    v_and_b32 v77, 0xffff0000, v80
    v_lshlrev_b32 v82, 16, v72
    v_and_b32 v83, 0xffff0000, v72
    v_add_f32 v76, v76, v82
    v_add_f32 v77, v77, v83
    v_lshlrev_b32 v78, 16, v81
    v_and_b32 v79, 0xffff0000, v81
    v_lshlrev_b32 v82, 16, v73
    v_and_b32 v83, 0xffff0000, v73
    v_add_f32 v78, v78, v82
    v_add_f32 v79, v79, v83
    v_cvt_pk_bf16_f32 v80, v76, v77
    v_cvt_pk_bf16_f32 v81, v78, v79
    v_add_u32 v6, 4214848, v5
    buffer_store_dwordx2 v[80:81], v6, s[8:11], 0 offen
    v_add_u32 v6, 20576, v5
    buffer_load_dwordx2 v[72:73], v6, s[44:47], 0 offen
    v_accvgpr_read_b32 v76, a32
    v_accvgpr_read_b32 v77, a33
    v_accvgpr_read_b32 v78, a34
    v_accvgpr_read_b32 v79, a35
    v_cvt_pk_bf16_f32 v80, v76, v77
    v_cvt_pk_bf16_f32 v81, v78, v79
    s_waitcnt vmcnt(0)
    v_lshlrev_b32 v76, 16, v80
    v_and_b32 v77, 0xffff0000, v80
    v_lshlrev_b32 v82, 16, v72
    v_and_b32 v83, 0xffff0000, v72
    v_add_f32 v76, v76, v82
    v_add_f32 v77, v77, v83
    v_lshlrev_b32 v78, 16, v81
    v_and_b32 v79, 0xffff0000, v81
    v_lshlrev_b32 v82, 16, v73
    v_and_b32 v83, 0xffff0000, v73
    v_add_f32 v78, v78, v82
    v_add_f32 v79, v79, v83
    v_cvt_pk_bf16_f32 v80, v76, v77
    v_cvt_pk_bf16_f32 v81, v78, v79
    v_add_u32 v6, 4214880, v5
    buffer_store_dwordx2 v[80:81], v6, s[8:11], 0 offen
    v_add_u32 v6, 20608, v5
    buffer_load_dwordx2 v[72:73], v6, s[44:47], 0 offen
    v_accvgpr_read_b32 v76, a36
    v_accvgpr_read_b32 v77, a37
    v_accvgpr_read_b32 v78, a38
    v_accvgpr_read_b32 v79, a39
    v_cvt_pk_bf16_f32 v80, v76, v77
    v_cvt_pk_bf16_f32 v81, v78, v79
    s_waitcnt vmcnt(0)
    v_lshlrev_b32 v76, 16, v80
    v_and_b32 v77, 0xffff0000, v80
    v_lshlrev_b32 v82, 16, v72
    v_and_b32 v83, 0xffff0000, v72
    v_add_f32 v76, v76, v82
    v_add_f32 v77, v77, v83
    v_lshlrev_b32 v78, 16, v81
    v_and_b32 v79, 0xffff0000, v81
    v_lshlrev_b32 v82, 16, v73
    v_and_b32 v83, 0xffff0000, v73
    v_add_f32 v78, v78, v82
    v_add_f32 v79, v79, v83
    v_cvt_pk_bf16_f32 v80, v76, v77
    v_cvt_pk_bf16_f32 v81, v78, v79
    v_add_u32 v6, 4214912, v5
    buffer_store_dwordx2 v[80:81], v6, s[8:11], 0 offen
wo_a1_kernel_end:
    s_endpgm
.section .rodata,"a"
.p2align 6
.amdhsa_kernel wo_a1_kernel
  .amdhsa_next_free_vgpr 136
  .amdhsa_next_free_sgpr 64
  .amdhsa_accum_offset 96
  .amdhsa_group_segment_fixed_size 0
  .amdhsa_kernarg_size 104
  .amdhsa_user_sgpr_count 2
  .amdhsa_user_sgpr_kernarg_segment_ptr 1
  .amdhsa_system_sgpr_workgroup_id_x 1
.end_amdhsa_kernel
.text
.globl ln_b1_kernel
.p2align 8
.type ln_b1_kernel,@function
ln_b1_kernel:
    v_lshrrev_b32 v1, 6, v0
    v_and_b32 v2, 63, v0
    s_nop 0
    v_readfirstlane_b32 s3, v1
    s_lshl_b32 s4, s2, 2
    s_add_u32 s4, s4, s3
    s_cmp_ge_u32 s4, 2048
    s_cbranch_scc1 ln_b1_kernel_end
    s_load_dwordx2 s[6:7], s[0:1], 96
    s_load_dwordx2 s[12:13], s[0:1], 96
    s_waitcnt lgkmcnt(0)
    s_add_u32 s8, s6, 4194304
    s_addc_u32 s9, s7, 0
    s_mov_b32 s10, 2621440
    s_mov_b32 s11, 0x00020000
    s_mov_b32 s16, s12
    s_mov_b32 s17, s13
    s_mov_b32 s18, 2621440
    s_mov_b32 s19, 0x00020000
    s_mul_i32 s5, s4, 1280
    v_lshlrev_b32 v3, 2, v2
    v_add_u32 v3, s5, v3
    buffer_load_dword v4, v3, s[8:11], 0 offen offset:0
    buffer_load_dword v5, v3, s[8:11], 0 offen offset:256
    buffer_load_dword v6, v3, s[8:11], 0 offen offset:512
    buffer_load_dword v7, v3, s[8:11], 0 offen offset:768
    buffer_load_dword v8, v3, s[8:11], 0 offen offset:1024
    s_waitcnt vmcnt(0)
    v_lshlrev_b32 v10, 16, v4
    v_and_b32 v11, 0xffff0000, v4
    v_lshlrev_b32 v12, 16, v5
    v_and_b32 v13, 0xffff0000, v5
    v_lshlrev_b32 v14, 16, v6
    v_and_b32 v15, 0xffff0000, v6
    v_lshlrev_b32 v16, 16, v7
    v_and_b32 v17, 0xffff0000, v7
    v_lshlrev_b32 v18, 16, v8
    v_and_b32 v19, 0xffff0000, v8
    v_add_f32 v20, v10, v11
    v_add_f32 v20, v20, v12
    v_add_f32 v20, v20, v13
    v_add_f32 v20, v20, v14
    v_add_f32 v20, v20, v15
    v_add_f32 v20, v20, v16
    v_add_f32 v20, v20, v17
    v_add_f32 v20, v20, v18
    v_add_f32 v20, v20, v19
    s_nop 1
    v_add_f32 v21, v20, v20 quad_perm:[1,0,3,2] row_mask:0xf bank_mask:0xf
    s_nop 1
    v_add_f32 v21, v21, v21 quad_perm:[2,3,0,1] row_mask:0xf bank_mask:0xf
    s_nop 1
    v_add_f32 v21, v21, v21 row_half_mirror row_mask:0xf bank_mask:0xf
    s_nop 1
    v_add_f32 v21, v21, v21 row_mirror row_mask:0xf bank_mask:0xf
    s_nop 1
    v_readlane_b32 s24, v21, 0
    v_readlane_b32 s25, v21, 16
    v_readlane_b32 s26, v21, 32
    v_readlane_b32 s27, v21, 48
    s_nop 1
    v_mov_b32 v20, s24
    v_add_f32 v20, s25, v20
    v_add_f32 v20, s26, v20
    v_add_f32 v20, s27, v20
    v_mul_f32 v20, 0.0015625, v20
    v_sub_f32 v10, v10, v20
    v_sub_f32 v11, v11, v20
    v_sub_f32 v12, v12, v20
    v_sub_f32 v13, v13, v20
    v_sub_f32 v14, v14, v20
    v_sub_f32 v15, v15, v20
    v_sub_f32 v16, v16, v20
    v_sub_f32 v17, v17, v20
    v_sub_f32 v18, v18, v20
    v_sub_f32 v19, v19, v20
    v_mul_f32 v21, v10, v10
    v_fmac_f32 v21, v11, v11
    v_fmac_f32 v21, v12, v12
    v_fmac_f32 v21, v13, v13
    v_fmac_f32 v21, v14, v14
    v_fmac_f32 v21, v15, v15
    v_fmac_f32 v21, v16, v16
    v_fmac_f32 v21, v17, v17
    v_fmac_f32 v21, v18, v18
    v_fmac_f32 v21, v19, v19
    s_nop 1
    v_add_f32 v22, v21, v21 quad_perm:[1,0,3,2] row_mask:0xf bank_mask:0xf
    s_nop 1
    v_add_f32 v22, v22, v22 quad_perm:[2,3,0,1] row_mask:0xf bank_mask:0xf
    s_nop 1
    v_add_f32 v22, v22, v22 row_half_mirror row_mask:0xf bank_mask:0xf
    s_nop 1
    v_add_f32 v22, v22, v22 row_mirror row_mask:0xf bank_mask:0xf
    s_nop 1
    v_readlane_b32 s24, v22, 0
    v_readlane_b32 s25, v22, 16
    v_readlane_b32 s26, v22, 32
    v_readlane_b32 s27, v22, 48
    s_nop 1
    v_mov_b32 v21, s24
    v_add_f32 v21, s25, v21
    v_add_f32 v21, s26, v21
    v_add_f32 v21, s27, v21
    v_mov_b32 v22, 0x3727c5ac
    v_fmac_f32 v22, 0.0015625, v21
    v_rsq_f32 v22, v22
    s_nop 0
    v_mul_f32 v10, v10, v22
    v_mul_f32 v11, v11, v22
    v_mul_f32 v12, v12, v22
    v_mul_f32 v13, v13, v22
    v_mul_f32 v14, v14, v22
    v_mul_f32 v15, v15, v22
    v_mul_f32 v16, v16, v22
    v_mul_f32 v17, v17, v22
    v_mul_f32 v18, v18, v22
    v_mul_f32 v19, v19, v22
    v_cvt_pk_bf16_f32 v4, v10, v11
    v_cvt_pk_bf16_f32 v5, v12, v13
    v_cvt_pk_bf16_f32 v6, v14, v15
    v_cvt_pk_bf16_f32 v7, v16, v17
    v_cvt_pk_bf16_f32 v8, v18, v19
    buffer_store_dword v4, v3, s[16:19], 0 offen offset:0
    buffer_store_dword v5, v3, s[16:19], 0 offen offset:256
    buffer_store_dword v6, v3, s[16:19], 0 offen offset:512
    buffer_store_dword v7, v3, s[16:19], 0 offen offset:768
    buffer_store_dword v8, v3, s[16:19], 0 offen offset:1024
ln_b1_kernel_end:
    s_endpgm
.section .rodata,"a"
.p2align 6
.amdhsa_kernel ln_b1_kernel
  .amdhsa_next_free_vgpr 32
  .amdhsa_next_free_sgpr 40
  .amdhsa_accum_offset 32
  .amdhsa_group_segment_fixed_size 0
  .amdhsa_kernarg_size 104
  .amdhsa_user_sgpr_count 2
  .amdhsa_user_sgpr_kernarg_segment_ptr 1
  .amdhsa_system_sgpr_workgroup_id_x 1
.end_amdhsa_kernel
.text
.globl qkv_b_kernel
.p2align 8
.type qkv_b_kernel,@function
qkv_b_kernel:
    v_lshrrev_b32 v1, 6, v0
    v_and_b32 v2, 63, v0
    s_nop 0
    v_readfirstlane_b32 s3, v1
    s_cmp_ge_u32 s2, 768
    s_cbranch_scc1 qkv_b_kernel_end
    s_load_dwordx2 s[4:5], s[0:1], 96
    s_load_dwordx2 s[6:7], s[0:1], 80
    s_mul_i32 s20, s2, 683
    s_lshr_b32 s20, s20, 17
    s_mul_i32 s21, s20, 192
    s_sub_u32 s21, s2, s21
    s_lshl_b32 s20, s20, 2
    s_add_u32 s20, s20, s3
    s_mul_i32 s22, s20, 128
    s_mul_i32 s23, s21, 96
    s_waitcnt lgkmcnt(0)
    s_mov_b32 s8, s4
    s_mov_b32 s9, s5
    s_mov_b32 s10, 268435456
    s_mov_b32 s11, 0x00020000
    v_and_b32 v3, 15, v2
    v_lshrrev_b32 v4, 4, v2
    s_mov_b32 s24, 1280
    v_add_u32 v5, s22, v3
    v_mul_lo_u32 v5, v5, s24
    v_lshlrev_b32 v6, 4, v4
    v_add_u32 v5, v5, v6
    v_add_u32 v5, 0, v5
    v_mov_b32 v8, v5
    v_add_u32 v9, 20480, v5
    v_add_u32 v10, 40960, v5
    v_add_u32 v11, 61440, v5
    v_add_u32 v12, 81920, v5
    v_add_u32 v13, 102400, v5
    v_add_u32 v14, 122880, v5
    v_add_u32 v15, 143360, v5
    v_lshlrev_b32 v7, 4, v2
    s_mov_b32 s25, 0
    s_mov_b32 s26, 0
    s_mul_i32 s27, s21, 122880
    s_add_u32 s27, s27, s26
    s_add_u32 s27, s27, 33554432
    s_add_u32 s32, s27, 0
    s_add_u32 s33, s27, 20480
    s_add_u32 s34, s27, 40960
    s_add_u32 s35, s27, 61440
    s_add_u32 s36, s27, 81920
    s_add_u32 s37, s27, 102400
    v_accvgpr_write_b32 a0, 0
    v_accvgpr_write_b32 a1, 0
    v_accvgpr_write_b32 a2, 0
    v_accvgpr_write_b32 a3, 0
    v_accvgpr_write_b32 a4, 0
    v_accvgpr_write_b32 a5, 0
    v_accvgpr_write_b32 a6, 0
    v_accvgpr_write_b32 a7, 0
    v_accvgpr_write_b32 a8, 0
    v_accvgpr_write_b32 a9, 0
    v_accvgpr_write_b32 a10, 0
    v_accvgpr_write_b32 a11, 0
    v_accvgpr_write_b32 a12, 0
    v_accvgpr_write_b32 a13, 0
    v_accvgpr_write_b32 a14, 0
    v_accvgpr_write_b32 a15, 0
    v_accvgpr_write_b32 a16, 0
    v_accvgpr_write_b32 a17, 0
    v_accvgpr_write_b32 a18, 0
    v_accvgpr_write_b32 a19, 0
    v_accvgpr_write_b32 a20, 0
    v_accvgpr_write_b32 a21, 0
    v_accvgpr_write_b32 a22, 0
    v_accvgpr_write_b32 a23, 0
    v_accvgpr_write_b32 a24, 0
    v_accvgpr_write_b32 a25, 0
    v_accvgpr_write_b32 a26, 0
    v_accvgpr_write_b32 a27, 0
    v_accvgpr_write_b32 a28, 0
    v_accvgpr_write_b32 a29, 0
    v_accvgpr_write_b32 a30, 0
    v_accvgpr_write_b32 a31, 0
    v_accvgpr_write_b32 a32, 0
    v_accvgpr_write_b32 a33, 0
    v_accvgpr_write_b32 a34, 0
    v_accvgpr_write_b32 a35, 0
    v_accvgpr_write_b32 a36, 0
    v_accvgpr_write_b32 a37, 0
    v_accvgpr_write_b32 a38, 0
    v_accvgpr_write_b32 a39, 0
    v_accvgpr_write_b32 a40, 0
    v_accvgpr_write_b32 a41, 0
    v_accvgpr_write_b32 a42, 0
    v_accvgpr_write_b32 a43, 0
    v_accvgpr_write_b32 a44, 0
    v_accvgpr_write_b32 a45, 0
    v_accvgpr_write_b32 a46, 0
    v_accvgpr_write_b32 a47, 0
    v_accvgpr_write_b32 a48, 0
    v_accvgpr_write_b32 a49, 0
    v_accvgpr_write_b32 a50, 0
    v_accvgpr_write_b32 a51, 0
    v_accvgpr_write_b32 a52, 0
    v_accvgpr_write_b32 a53, 0
    v_accvgpr_write_b32 a54, 0
    v_accvgpr_write_b32 a55, 0
    v_accvgpr_write_b32 a56, 0
    v_accvgpr_write_b32 a57, 0
    v_accvgpr_write_b32 a58, 0
    v_accvgpr_write_b32 a59, 0
    v_accvgpr_write_b32 a60, 0
    v_accvgpr_write_b32 a61, 0
    v_accvgpr_write_b32 a62, 0
    v_accvgpr_write_b32 a63, 0
    v_accvgpr_write_b32 a64, 0
    v_accvgpr_write_b32 a65, 0
    v_accvgpr_write_b32 a66, 0
    v_accvgpr_write_b32 a67, 0
    v_accvgpr_write_b32 a68, 0
    v_accvgpr_write_b32 a69, 0
    v_accvgpr_write_b32 a70, 0
    v_accvgpr_write_b32 a71, 0
    v_accvgpr_write_b32 a72, 0
    v_accvgpr_write_b32 a73, 0
    v_accvgpr_write_b32 a74, 0
    v_accvgpr_write_b32 a75, 0
    v_accvgpr_write_b32 a76, 0
    v_accvgpr_write_b32 a77, 0
    v_accvgpr_write_b32 a78, 0
    v_accvgpr_write_b32 a79, 0
    v_accvgpr_write_b32 a80, 0
    v_accvgpr_write_b32 a81, 0
    v_accvgpr_write_b32 a82, 0
    v_accvgpr_write_b32 a83, 0
    v_accvgpr_write_b32 a84, 0
    v_accvgpr_write_b32 a85, 0
    v_accvgpr_write_b32 a86, 0
    v_accvgpr_write_b32 a87, 0
    v_accvgpr_write_b32 a88, 0
    v_accvgpr_write_b32 a89, 0
    v_accvgpr_write_b32 a90, 0
    v_accvgpr_write_b32 a91, 0
    v_accvgpr_write_b32 a92, 0
    v_accvgpr_write_b32 a93, 0
    v_accvgpr_write_b32 a94, 0
    v_accvgpr_write_b32 a95, 0
    v_accvgpr_write_b32 a96, 0
    v_accvgpr_write_b32 a97, 0
    v_accvgpr_write_b32 a98, 0
    v_accvgpr_write_b32 a99, 0
    v_accvgpr_write_b32 a100, 0
    v_accvgpr_write_b32 a101, 0
    v_accvgpr_write_b32 a102, 0
    v_accvgpr_write_b32 a103, 0
    v_accvgpr_write_b32 a104, 0
    v_accvgpr_write_b32 a105, 0
    v_accvgpr_write_b32 a106, 0
    v_accvgpr_write_b32 a107, 0
    v_accvgpr_write_b32 a108, 0
    v_accvgpr_write_b32 a109, 0
    v_accvgpr_write_b32 a110, 0
    v_accvgpr_write_b32 a111, 0
    v_accvgpr_write_b32 a112, 0
    v_accvgpr_write_b32 a113, 0
    v_accvgpr_write_b32 a114, 0
    v_accvgpr_write_b32 a115, 0
    v_accvgpr_write_b32 a116, 0
    v_accvgpr_write_b32 a117, 0
    v_accvgpr_write_b32 a118, 0
    v_accvgpr_write_b32 a119, 0
    v_accvgpr_write_b32 a120, 0
    v_accvgpr_write_b32 a121, 0
    v_accvgpr_write_b32 a122, 0
    v_accvgpr_write_b32 a123, 0
    v_accvgpr_write_b32 a124, 0
    v_accvgpr_write_b32 a125, 0
    v_accvgpr_write_b32 a126, 0
    v_accvgpr_write_b32 a127, 0
    v_accvgpr_write_b32 a128, 0
    v_accvgpr_write_b32 a129, 0
    v_accvgpr_write_b32 a130, 0
    v_accvgpr_write_b32 a131, 0
    v_accvgpr_write_b32 a132, 0
    v_accvgpr_write_b32 a133, 0
    v_accvgpr_write_b32 a134, 0
    v_accvgpr_write_b32 a135, 0
    v_accvgpr_write_b32 a136, 0
    v_accvgpr_write_b32 a137, 0
    v_accvgpr_write_b32 a138, 0
    v_accvgpr_write_b32 a139, 0
    v_accvgpr_write_b32 a140, 0
    v_accvgpr_write_b32 a141, 0
    v_accvgpr_write_b32 a142, 0
    v_accvgpr_write_b32 a143, 0
    v_accvgpr_write_b32 a144, 0
    v_accvgpr_write_b32 a145, 0
    v_accvgpr_write_b32 a146, 0
    v_accvgpr_write_b32 a147, 0
    v_accvgpr_write_b32 a148, 0
    v_accvgpr_write_b32 a149, 0
    v_accvgpr_write_b32 a150, 0
    v_accvgpr_write_b32 a151, 0
    v_accvgpr_write_b32 a152, 0
    v_accvgpr_write_b32 a153, 0
    v_accvgpr_write_b32 a154, 0
    v_accvgpr_write_b32 a155, 0
    v_accvgpr_write_b32 a156, 0
    v_accvgpr_write_b32 a157, 0
    v_accvgpr_write_b32 a158, 0
    v_accvgpr_write_b32 a159, 0
    v_accvgpr_write_b32 a160, 0
    v_accvgpr_write_b32 a161, 0
    v_accvgpr_write_b32 a162, 0
    v_accvgpr_write_b32 a163, 0
    v_accvgpr_write_b32 a164, 0
    v_accvgpr_write_b32 a165, 0
    v_accvgpr_write_b32 a166, 0
    v_accvgpr_write_b32 a167, 0
    v_accvgpr_write_b32 a168, 0
    v_accvgpr_write_b32 a169, 0
    v_accvgpr_write_b32 a170, 0
    v_accvgpr_write_b32 a171, 0
    v_accvgpr_write_b32 a172, 0
    v_accvgpr_write_b32 a173, 0
    v_accvgpr_write_b32 a174, 0
    v_accvgpr_write_b32 a175, 0
    v_accvgpr_write_b32 a176, 0
    v_accvgpr_write_b32 a177, 0
    v_accvgpr_write_b32 a178, 0
    v_accvgpr_write_b32 a179, 0
    v_accvgpr_write_b32 a180, 0
    v_accvgpr_write_b32 a181, 0
    v_accvgpr_write_b32 a182, 0
    v_accvgpr_write_b32 a183, 0
    v_accvgpr_write_b32 a184, 0
    v_accvgpr_write_b32 a185, 0
    v_accvgpr_write_b32 a186, 0
    v_accvgpr_write_b32 a187, 0
    v_accvgpr_write_b32 a188, 0
    v_accvgpr_write_b32 a189, 0
    v_accvgpr_write_b32 a190, 0
    v_accvgpr_write_b32 a191, 0
    s_cmp_ge_u32 s23, 12288
    s_cbranch_scc1 qkv_b_kernel_nrm
    buffer_load_dwordx4 v[16:19], v8, s[8:11], s25 offen
    buffer_load_dwordx4 v[20:23], v9, s[8:11], s25 offen
    buffer_load_dwordx4 v[24:27], v10, s[8:11], s25 offen
    buffer_load_dwordx4 v[28:31], v11, s[8:11], s25 offen
    buffer_load_dwordx4 v[32:35], v12, s[8:11], s25 offen
    buffer_load_dwordx4 v[36:39], v13, s[8:11], s25 offen
    buffer_load_dwordx4 v[40:43], v14, s[8:11], s25 offen
    buffer_load_dwordx4 v[44:47], v15, s[8:11], s25 offen
    buffer_load_dwordx4 v[48:51], v7, s[8:11], s32 offen
    buffer_load_dwordx4 v[52:55], v7, s[8:11], s33 offen
    buffer_load_dwordx4 v[56:59], v7, s[8:11], s34 offen
    buffer_load_dwordx4 v[60:63], v7, s[8:11], s35 offen
    buffer_load_dwordx4 v[64:67], v7, s[8:11], s36 offen
    buffer_load_dwordx4 v[68:71], v7, s[8:11], s37 offen
    s_mov_b32 s28, 10
qkv_b_kernel_loop0:
    s_add_u32 s25, s25, 64
    s_add_u32 s32, s32, 1024
    s_add_u32 s33, s33, 1024
    s_add_u32 s34, s34, 1024
    s_add_u32 s35, s35, 1024
    s_add_u32 s36, s36, 1024
    s_add_u32 s37, s37, 1024
    buffer_load_dwordx4 v[72:75], v8, s[8:11], s25 offen
    buffer_load_dwordx4 v[76:79], v9, s[8:11], s25 offen
    buffer_load_dwordx4 v[80:83], v10, s[8:11], s25 offen
    buffer_load_dwordx4 v[84:87], v11, s[8:11], s25 offen
    buffer_load_dwordx4 v[88:91], v12, s[8:11], s25 offen
    buffer_load_dwordx4 v[92:95], v13, s[8:11], s25 offen
    buffer_load_dwordx4 v[96:99], v14, s[8:11], s25 offen
    buffer_load_dwordx4 v[100:103], v15, s[8:11], s25 offen
    buffer_load_dwordx4 v[104:107], v7, s[8:11], s32 offen
    buffer_load_dwordx4 v[108:111], v7, s[8:11], s33 offen
    buffer_load_dwordx4 v[112:115], v7, s[8:11], s34 offen
    buffer_load_dwordx4 v[116:119], v7, s[8:11], s35 offen
    buffer_load_dwordx4 v[120:123], v7, s[8:11], s36 offen
    buffer_load_dwordx4 v[124:127], v7, s[8:11], s37 offen
    s_waitcnt vmcnt(14)
    v_mfma_f32_16x16x32_bf16 a[0:3], v[48:51], v[16:19], a[0:3]
    v_mfma_f32_16x16x32_bf16 a[24:27], v[48:51], v[20:23], a[24:27]
    v_mfma_f32_16x16x32_bf16 a[48:51], v[48:51], v[24:27], a[48:51]
    v_mfma_f32_16x16x32_bf16 a[72:75], v[48:51], v[28:31], a[72:75]
    v_mfma_f32_16x16x32_bf16 a[96:99], v[48:51], v[32:35], a[96:99]
    v_mfma_f32_16x16x32_bf16 a[120:123], v[48:51], v[36:39], a[120:123]
    v_mfma_f32_16x16x32_bf16 a[144:147], v[48:51], v[40:43], a[144:147]
    v_mfma_f32_16x16x32_bf16 a[168:171], v[48:51], v[44:47], a[168:171]
    v_mfma_f32_16x16x32_bf16 a[4:7], v[52:55], v[16:19], a[4:7]
    v_mfma_f32_16x16x32_bf16 a[28:31], v[52:55], v[20:23], a[28:31]
    v_mfma_f32_16x16x32_bf16 a[52:55], v[52:55], v[24:27], a[52:55]
    v_mfma_f32_16x16x32_bf16 a[76:79], v[52:55], v[28:31], a[76:79]
    v_mfma_f32_16x16x32_bf16 a[100:103], v[52:55], v[32:35], a[100:103]
    v_mfma_f32_16x16x32_bf16 a[124:127], v[52:55], v[36:39], a[124:127]
    v_mfma_f32_16x16x32_bf16 a[148:151], v[52:55], v[40:43], a[148:151]
    v_mfma_f32_16x16x32_bf16 a[172:175], v[52:55], v[44:47], a[172:175]
    v_mfma_f32_16x16x32_bf16 a[8:11], v[56:59], v[16:19], a[8:11]
    v_mfma_f32_16x16x32_bf16 a[32:35], v[56:59], v[20:23], a[32:35]
    v_mfma_f32_16x16x32_bf16 a[56:59], v[56:59], v[24:27], a[56:59]
    v_mfma_f32_16x16x32_bf16 a[80:83], v[56:59], v[28:31], a[80:83]
    v_mfma_f32_16x16x32_bf16 a[104:107], v[56:59], v[32:35], a[104:107]
    v_mfma_f32_16x16x32_bf16 a[128:131], v[56:59], v[36:39], a[128:131]
    v_mfma_f32_16x16x32_bf16 a[152:155], v[56:59], v[40:43], a[152:155]
    v_mfma_f32_16x16x32_bf16 a[176:179], v[56:59], v[44:47], a[176:179]
    v_mfma_f32_16x16x32_bf16 a[12:15], v[60:63], v[16:19], a[12:15]
    v_mfma_f32_16x16x32_bf16 a[36:39], v[60:63], v[20:23], a[36:39]
    v_mfma_f32_16x16x32_bf16 a[60:63], v[60:63], v[24:27], a[60:63]
    v_mfma_f32_16x16x32_bf16 a[84:87], v[60:63], v[28:31], a[84:87]
    v_mfma_f32_16x16x32_bf16 a[108:111], v[60:63], v[32:35], a[108:111]
    v_mfma_f32_16x16x32_bf16 a[132:135], v[60:63], v[36:39], a[132:135]
    v_mfma_f32_16x16x32_bf16 a[156:159], v[60:63], v[40:43], a[156:159]
    v_mfma_f32_16x16x32_bf16 a[180:183], v[60:63], v[44:47], a[180:183]
    v_mfma_f32_16x16x32_bf16 a[16:19], v[64:67], v[16:19], a[16:19]
    v_mfma_f32_16x16x32_bf16 a[40:43], v[64:67], v[20:23], a[40:43]
    v_mfma_f32_16x16x32_bf16 a[64:67], v[64:67], v[24:27], a[64:67]
    v_mfma_f32_16x16x32_bf16 a[88:91], v[64:67], v[28:31], a[88:91]
    v_mfma_f32_16x16x32_bf16 a[112:115], v[64:67], v[32:35], a[112:115]
    v_mfma_f32_16x16x32_bf16 a[136:139], v[64:67], v[36:39], a[136:139]
    v_mfma_f32_16x16x32_bf16 a[160:163], v[64:67], v[40:43], a[160:163]
    v_mfma_f32_16x16x32_bf16 a[184:187], v[64:67], v[44:47], a[184:187]
    v_mfma_f32_16x16x32_bf16 a[20:23], v[68:71], v[16:19], a[20:23]
    v_mfma_f32_16x16x32_bf16 a[44:47], v[68:71], v[20:23], a[44:47]
    v_mfma_f32_16x16x32_bf16 a[68:71], v[68:71], v[24:27], a[68:71]
    v_mfma_f32_16x16x32_bf16 a[92:95], v[68:71], v[28:31], a[92:95]
    v_mfma_f32_16x16x32_bf16 a[116:119], v[68:71], v[32:35], a[116:119]
    v_mfma_f32_16x16x32_bf16 a[140:143], v[68:71], v[36:39], a[140:143]
    v_mfma_f32_16x16x32_bf16 a[164:167], v[68:71], v[40:43], a[164:167]
    v_mfma_f32_16x16x32_bf16 a[188:191], v[68:71], v[44:47], a[188:191]
    s_sub_u32 s28, s28, 1
    s_cmp_eq_u32 s28, 0
    s_cbranch_scc1 qkv_b_kernel_loop0_last
    s_add_u32 s25, s25, 64
    s_add_u32 s32, s32, 1024
    s_add_u32 s33, s33, 1024
    s_add_u32 s34, s34, 1024
    s_add_u32 s35, s35, 1024
    s_add_u32 s36, s36, 1024
    s_add_u32 s37, s37, 1024
    buffer_load_dwordx4 v[16:19], v8, s[8:11], s25 offen
    buffer_load_dwordx4 v[20:23], v9, s[8:11], s25 offen
    buffer_load_dwordx4 v[24:27], v10, s[8:11], s25 offen
    buffer_load_dwordx4 v[28:31], v11, s[8:11], s25 offen
    buffer_load_dwordx4 v[32:35], v12, s[8:11], s25 offen
    buffer_load_dwordx4 v[36:39], v13, s[8:11], s25 offen
    buffer_load_dwordx4 v[40:43], v14, s[8:11], s25 offen
    buffer_load_dwordx4 v[44:47], v15, s[8:11], s25 offen
    buffer_load_dwordx4 v[48:51], v7, s[8:11], s32 offen
    buffer_load_dwordx4 v[52:55], v7, s[8:11], s33 offen
    buffer_load_dwordx4 v[56:59], v7, s[8:11], s34 offen
    buffer_load_dwordx4 v[60:63], v7, s[8:11], s35 offen
    buffer_load_dwordx4 v[64:67], v7, s[8:11], s36 offen
    buffer_load_dwordx4 v[68:71], v7, s[8:11], s37 offen
    s_waitcnt vmcnt(14)
    v_mfma_f32_16x16x32_bf16 a[0:3], v[104:107], v[72:75], a[0:3]
    v_mfma_f32_16x16x32_bf16 a[24:27], v[104:107], v[76:79], a[24:27]
    v_mfma_f32_16x16x32_bf16 a[48:51], v[104:107], v[80:83], a[48:51]
    v_mfma_f32_16x16x32_bf16 a[72:75], v[104:107], v[84:87], a[72:75]
    v_mfma_f32_16x16x32_bf16 a[96:99], v[104:107], v[88:91], a[96:99]
    v_mfma_f32_16x16x32_bf16 a[120:123], v[104:107], v[92:95], a[120:123]
    v_mfma_f32_16x16x32_bf16 a[144:147], v[104:107], v[96:99], a[144:147]
    v_mfma_f32_16x16x32_bf16 a[168:171], v[104:107], v[100:103], a[168:171]
    v_mfma_f32_16x16x32_bf16 a[4:7], v[108:111], v[72:75], a[4:7]
    v_mfma_f32_16x16x32_bf16 a[28:31], v[108:111], v[76:79], a[28:31]
    v_mfma_f32_16x16x32_bf16 a[52:55], v[108:111], v[80:83], a[52:55]
    v_mfma_f32_16x16x32_bf16 a[76:79], v[108:111], v[84:87], a[76:79]
    v_mfma_f32_16x16x32_bf16 a[100:103], v[108:111], v[88:91], a[100:103]
    v_mfma_f32_16x16x32_bf16 a[124:127], v[108:111], v[92:95], a[124:127]
    v_mfma_f32_16x16x32_bf16 a[148:151], v[108:111], v[96:99], a[148:151]
    v_mfma_f32_16x16x32_bf16 a[172:175], v[108:111], v[100:103], a[172:175]
    v_mfma_f32_16x16x32_bf16 a[8:11], v[112:115], v[72:75], a[8:11]
    v_mfma_f32_16x16x32_bf16 a[32:35], v[112:115], v[76:79], a[32:35]
    v_mfma_f32_16x16x32_bf16 a[56:59], v[112:115], v[80:83], a[56:59]
    v_mfma_f32_16x16x32_bf16 a[80:83], v[112:115], v[84:87], a[80:83]
    v_mfma_f32_16x16x32_bf16 a[104:107], v[112:115], v[88:91], a[104:107]
    v_mfma_f32_16x16x32_bf16 a[128:131], v[112:115], v[92:95], a[128:131]
    v_mfma_f32_16x16x32_bf16 a[152:155], v[112:115], v[96:99], a[152:155]
    v_mfma_f32_16x16x32_bf16 a[176:179], v[112:115], v[100:103], a[176:179]
    v_mfma_f32_16x16x32_bf16 a[12:15], v[116:119], v[72:75], a[12:15]
    v_mfma_f32_16x16x32_bf16 a[36:39], v[116:119], v[76:79], a[36:39]
    v_mfma_f32_16x16x32_bf16 a[60:63], v[116:119], v[80:83], a[60:63]
    v_mfma_f32_16x16x32_bf16 a[84:87], v[116:119], v[84:87], a[84:87]
    v_mfma_f32_16x16x32_bf16 a[108:111], v[116:119], v[88:91], a[108:111]
    v_mfma_f32_16x16x32_bf16 a[132:135], v[116:119], v[92:95], a[132:135]
    v_mfma_f32_16x16x32_bf16 a[156:159], v[116:119], v[96:99], a[156:159]
    v_mfma_f32_16x16x32_bf16 a[180:183], v[116:119], v[100:103], a[180:183]
    v_mfma_f32_16x16x32_bf16 a[16:19], v[120:123], v[72:75], a[16:19]
    v_mfma_f32_16x16x32_bf16 a[40:43], v[120:123], v[76:79], a[40:43]
    v_mfma_f32_16x16x32_bf16 a[64:67], v[120:123], v[80:83], a[64:67]
    v_mfma_f32_16x16x32_bf16 a[88:91], v[120:123], v[84:87], a[88:91]
    v_mfma_f32_16x16x32_bf16 a[112:115], v[120:123], v[88:91], a[112:115]
    v_mfma_f32_16x16x32_bf16 a[136:139], v[120:123], v[92:95], a[136:139]
    v_mfma_f32_16x16x32_bf16 a[160:163], v[120:123], v[96:99], a[160:163]
    v_mfma_f32_16x16x32_bf16 a[184:187], v[120:123], v[100:103], a[184:187]
    v_mfma_f32_16x16x32_bf16 a[20:23], v[124:127], v[72:75], a[20:23]
    v_mfma_f32_16x16x32_bf16 a[44:47], v[124:127], v[76:79], a[44:47]
    v_mfma_f32_16x16x32_bf16 a[68:71], v[124:127], v[80:83], a[68:71]
    v_mfma_f32_16x16x32_bf16 a[92:95], v[124:127], v[84:87], a[92:95]
    v_mfma_f32_16x16x32_bf16 a[116:119], v[124:127], v[88:91], a[116:119]
    v_mfma_f32_16x16x32_bf16 a[140:143], v[124:127], v[92:95], a[140:143]
    v_mfma_f32_16x16x32_bf16 a[164:167], v[124:127], v[96:99], a[164:167]
    v_mfma_f32_16x16x32_bf16 a[188:191], v[124:127], v[100:103], a[188:191]
    s_branch qkv_b_kernel_loop0
qkv_b_kernel_loop0_last:
    s_waitcnt vmcnt(0)
    v_mfma_f32_16x16x32_bf16 a[0:3], v[104:107], v[72:75], a[0:3]
    v_mfma_f32_16x16x32_bf16 a[24:27], v[104:107], v[76:79], a[24:27]
    v_mfma_f32_16x16x32_bf16 a[48:51], v[104:107], v[80:83], a[48:51]
    v_mfma_f32_16x16x32_bf16 a[72:75], v[104:107], v[84:87], a[72:75]
    v_mfma_f32_16x16x32_bf16 a[96:99], v[104:107], v[88:91], a[96:99]
    v_mfma_f32_16x16x32_bf16 a[120:123], v[104:107], v[92:95], a[120:123]
    v_mfma_f32_16x16x32_bf16 a[144:147], v[104:107], v[96:99], a[144:147]
    v_mfma_f32_16x16x32_bf16 a[168:171], v[104:107], v[100:103], a[168:171]
    v_mfma_f32_16x16x32_bf16 a[4:7], v[108:111], v[72:75], a[4:7]
    v_mfma_f32_16x16x32_bf16 a[28:31], v[108:111], v[76:79], a[28:31]
    v_mfma_f32_16x16x32_bf16 a[52:55], v[108:111], v[80:83], a[52:55]
    v_mfma_f32_16x16x32_bf16 a[76:79], v[108:111], v[84:87], a[76:79]
    v_mfma_f32_16x16x32_bf16 a[100:103], v[108:111], v[88:91], a[100:103]
    v_mfma_f32_16x16x32_bf16 a[124:127], v[108:111], v[92:95], a[124:127]
    v_mfma_f32_16x16x32_bf16 a[148:151], v[108:111], v[96:99], a[148:151]
    v_mfma_f32_16x16x32_bf16 a[172:175], v[108:111], v[100:103], a[172:175]
    v_mfma_f32_16x16x32_bf16 a[8:11], v[112:115], v[72:75], a[8:11]
    v_mfma_f32_16x16x32_bf16 a[32:35], v[112:115], v[76:79], a[32:35]
    v_mfma_f32_16x16x32_bf16 a[56:59], v[112:115], v[80:83], a[56:59]
    v_mfma_f32_16x16x32_bf16 a[80:83], v[112:115], v[84:87], a[80:83]
    v_mfma_f32_16x16x32_bf16 a[104:107], v[112:115], v[88:91], a[104:107]
    v_mfma_f32_16x16x32_bf16 a[128:131], v[112:115], v[92:95], a[128:131]
    v_mfma_f32_16x16x32_bf16 a[152:155], v[112:115], v[96:99], a[152:155]
    v_mfma_f32_16x16x32_bf16 a[176:179], v[112:115], v[100:103], a[176:179]
    v_mfma_f32_16x16x32_bf16 a[12:15], v[116:119], v[72:75], a[12:15]
    v_mfma_f32_16x16x32_bf16 a[36:39], v[116:119], v[76:79], a[36:39]
    v_mfma_f32_16x16x32_bf16 a[60:63], v[116:119], v[80:83], a[60:63]
    v_mfma_f32_16x16x32_bf16 a[84:87], v[116:119], v[84:87], a[84:87]
    v_mfma_f32_16x16x32_bf16 a[108:111], v[116:119], v[88:91], a[108:111]
    v_mfma_f32_16x16x32_bf16 a[132:135], v[116:119], v[92:95], a[132:135]
    v_mfma_f32_16x16x32_bf16 a[156:159], v[116:119], v[96:99], a[156:159]
    v_mfma_f32_16x16x32_bf16 a[180:183], v[116:119], v[100:103], a[180:183]
    v_mfma_f32_16x16x32_bf16 a[16:19], v[120:123], v[72:75], a[16:19]
    v_mfma_f32_16x16x32_bf16 a[40:43], v[120:123], v[76:79], a[40:43]
    v_mfma_f32_16x16x32_bf16 a[64:67], v[120:123], v[80:83], a[64:67]
    v_mfma_f32_16x16x32_bf16 a[88:91], v[120:123], v[84:87], a[88:91]
    v_mfma_f32_16x16x32_bf16 a[112:115], v[120:123], v[88:91], a[112:115]
    v_mfma_f32_16x16x32_bf16 a[136:139], v[120:123], v[92:95], a[136:139]
    v_mfma_f32_16x16x32_bf16 a[160:163], v[120:123], v[96:99], a[160:163]
    v_mfma_f32_16x16x32_bf16 a[184:187], v[120:123], v[100:103], a[184:187]
    v_mfma_f32_16x16x32_bf16 a[20:23], v[124:127], v[72:75], a[20:23]
    v_mfma_f32_16x16x32_bf16 a[44:47], v[124:127], v[76:79], a[44:47]
    v_mfma_f32_16x16x32_bf16 a[68:71], v[124:127], v[80:83], a[68:71]
    v_mfma_f32_16x16x32_bf16 a[92:95], v[124:127], v[84:87], a[92:95]
    v_mfma_f32_16x16x32_bf16 a[116:119], v[124:127], v[88:91], a[116:119]
    v_mfma_f32_16x16x32_bf16 a[140:143], v[124:127], v[92:95], a[140:143]
    v_mfma_f32_16x16x32_bf16 a[164:167], v[124:127], v[96:99], a[164:167]
    v_mfma_f32_16x16x32_bf16 a[188:191], v[124:127], v[100:103], a[188:191]
    s_nop 7
    s_nop 7
    s_mov_b32 s24, 12288
    s_mov_b32 s31, 92262400
    s_cmp_lt_u32 s23, 6144
    s_cselect_b32 s30, 67108864, s31
    s_lshl_b32 s29, s23, 1
    s_add_u32 s29, s29, s30
    v_add_u32 v5, s22, v3
    v_mul_lo_u32 v5, v5, s24
    v_lshlrev_b32 v6, 3, v4
    v_add3_u32 v5, v5, v6, s29
    v_accvgpr_read_b32 v132, a0
    v_accvgpr_read_b32 v133, a1
    v_accvgpr_read_b32 v134, a2
    v_accvgpr_read_b32 v135, a3
    v_cvt_pk_bf16_f32 v136, v132, v133
    v_cvt_pk_bf16_f32 v137, v134, v135
    v_add_u32 v6, 0, v5
    buffer_store_dwordx2 v[136:137], v6, s[8:11], 0 offen
    v_accvgpr_read_b32 v132, a4
    v_accvgpr_read_b32 v133, a5
    v_accvgpr_read_b32 v134, a6
    v_accvgpr_read_b32 v135, a7
    v_cvt_pk_bf16_f32 v136, v132, v133
    v_cvt_pk_bf16_f32 v137, v134, v135
    v_add_u32 v6, 32, v5
    buffer_store_dwordx2 v[136:137], v6, s[8:11], 0 offen
    v_accvgpr_read_b32 v132, a8
    v_accvgpr_read_b32 v133, a9
    v_accvgpr_read_b32 v134, a10
    v_accvgpr_read_b32 v135, a11
    v_cvt_pk_bf16_f32 v136, v132, v133
    v_cvt_pk_bf16_f32 v137, v134, v135
    v_add_u32 v6, 64, v5
    buffer_store_dwordx2 v[136:137], v6, s[8:11], 0 offen
    v_accvgpr_read_b32 v132, a12
    v_accvgpr_read_b32 v133, a13
    v_accvgpr_read_b32 v134, a14
    v_accvgpr_read_b32 v135, a15
    v_cvt_pk_bf16_f32 v136, v132, v133
    v_cvt_pk_bf16_f32 v137, v134, v135
    v_add_u32 v6, 96, v5
    buffer_store_dwordx2 v[136:137], v6, s[8:11], 0 offen
    v_accvgpr_read_b32 v132, a16
    v_accvgpr_read_b32 v133, a17
    v_accvgpr_read_b32 v134, a18
    v_accvgpr_read_b32 v135, a19
    v_cvt_pk_bf16_f32 v136, v132, v133
    v_cvt_pk_bf16_f32 v137, v134, v135
    v_add_u32 v6, 128, v5
    buffer_store_dwordx2 v[136:137], v6, s[8:11], 0 offen
    v_accvgpr_read_b32 v132, a20
    v_accvgpr_read_b32 v133, a21
    v_accvgpr_read_b32 v134, a22
    v_accvgpr_read_b32 v135, a23
    v_cvt_pk_bf16_f32 v136, v132, v133
    v_cvt_pk_bf16_f32 v137, v134, v135
    v_add_u32 v6, 160, v5
    buffer_store_dwordx2 v[136:137], v6, s[8:11], 0 offen
    v_accvgpr_read_b32 v132, a24
    v_accvgpr_read_b32 v133, a25
    v_accvgpr_read_b32 v134, a26
    v_accvgpr_read_b32 v135, a27
    v_cvt_pk_bf16_f32 v136, v132, v133
    v_cvt_pk_bf16_f32 v137, v134, v135
    v_add_u32 v6, 196608, v5
    buffer_store_dwordx2 v[136:137], v6, s[8:11], 0 offen
    v_accvgpr_read_b32 v132, a28
    v_accvgpr_read_b32 v133, a29
    v_accvgpr_read_b32 v134, a30
    v_accvgpr_read_b32 v135, a31
    v_cvt_pk_bf16_f32 v136, v132, v133
    v_cvt_pk_bf16_f32 v137, v134, v135
    v_add_u32 v6, 196640, v5
    buffer_store_dwordx2 v[136:137], v6, s[8:11], 0 offen
    v_accvgpr_read_b32 v132, a32
    v_accvgpr_read_b32 v133, a33
    v_accvgpr_read_b32 v134, a34
    v_accvgpr_read_b32 v135, a35
    v_cvt_pk_bf16_f32 v136, v132, v133
    v_cvt_pk_bf16_f32 v137, v134, v135
    v_add_u32 v6, 196672, v5
    buffer_store_dwordx2 v[136:137], v6, s[8:11], 0 offen
    v_accvgpr_read_b32 v132, a36
    v_accvgpr_read_b32 v133, a37
    v_accvgpr_read_b32 v134, a38
    v_accvgpr_read_b32 v135, a39
    v_cvt_pk_bf16_f32 v136, v132, v133
    v_cvt_pk_bf16_f32 v137, v134, v135
    v_add_u32 v6, 196704, v5
    buffer_store_dwordx2 v[136:137], v6, s[8:11], 0 offen
    v_accvgpr_read_b32 v132, a40
    v_accvgpr_read_b32 v133, a41
    v_accvgpr_read_b32 v134, a42
    v_accvgpr_read_b32 v135, a43
    v_cvt_pk_bf16_f32 v136, v132, v133
    v_cvt_pk_bf16_f32 v137, v134, v135
    v_add_u32 v6, 196736, v5
    buffer_store_dwordx2 v[136:137], v6, s[8:11], 0 offen
    v_accvgpr_read_b32 v132, a44
    v_accvgpr_read_b32 v133, a45
    v_accvgpr_read_b32 v134, a46
    v_accvgpr_read_b32 v135, a47
    v_cvt_pk_bf16_f32 v136, v132, v133
    v_cvt_pk_bf16_f32 v137, v134, v135
    v_add_u32 v6, 196768, v5
    buffer_store_dwordx2 v[136:137], v6, s[8:11], 0 offen
    v_accvgpr_read_b32 v132, a48
    v_accvgpr_read_b32 v133, a49
    v_accvgpr_read_b32 v134, a50
    v_accvgpr_read_b32 v135, a51
    v_cvt_pk_bf16_f32 v136, v132, v133
    v_cvt_pk_bf16_f32 v137, v134, v135
    v_add_u32 v6, 393216, v5
    buffer_store_dwordx2 v[136:137], v6, s[8:11], 0 offen
    v_accvgpr_read_b32 v132, a52
    v_accvgpr_read_b32 v133, a53
    v_accvgpr_read_b32 v134, a54
    v_accvgpr_read_b32 v135, a55
    v_cvt_pk_bf16_f32 v136, v132, v133
    v_cvt_pk_bf16_f32 v137, v134, v135
    v_add_u32 v6, 393248, v5
    buffer_store_dwordx2 v[136:137], v6, s[8:11], 0 offen
    v_accvgpr_read_b32 v132, a56
    v_accvgpr_read_b32 v133, a57
    v_accvgpr_read_b32 v134, a58
    v_accvgpr_read_b32 v135, a59
    v_cvt_pk_bf16_f32 v136, v132, v133
    v_cvt_pk_bf16_f32 v137, v134, v135
    v_add_u32 v6, 393280, v5
    buffer_store_dwordx2 v[136:137], v6, s[8:11], 0 offen
    v_accvgpr_read_b32 v132, a60
    v_accvgpr_read_b32 v133, a61
    v_accvgpr_read_b32 v134, a62
    v_accvgpr_read_b32 v135, a63
    v_cvt_pk_bf16_f32 v136, v132, v133
    v_cvt_pk_bf16_f32 v137, v134, v135
    v_add_u32 v6, 393312, v5
    buffer_store_dwordx2 v[136:137], v6, s[8:11], 0 offen
    v_accvgpr_read_b32 v132, a64
    v_accvgpr_read_b32 v133, a65
    v_accvgpr_read_b32 v134, a66
    v_accvgpr_read_b32 v135, a67
    v_cvt_pk_bf16_f32 v136, v132, v133
    v_cvt_pk_bf16_f32 v137, v134, v135
    v_add_u32 v6, 393344, v5
    buffer_store_dwordx2 v[136:137], v6, s[8:11], 0 offen
    v_accvgpr_read_b32 v132, a68
    v_accvgpr_read_b32 v133, a69
    v_accvgpr_read_b32 v134, a70
    v_accvgpr_read_b32 v135, a71
    v_cvt_pk_bf16_f32 v136, v132, v133
    v_cvt_pk_bf16_f32 v137, v134, v135
    v_add_u32 v6, 393376, v5
    buffer_store_dwordx2 v[136:137], v6, s[8:11], 0 offen
    v_accvgpr_read_b32 v132, a72
    v_accvgpr_read_b32 v133, a73
    v_accvgpr_read_b32 v134, a74
    v_accvgpr_read_b32 v135, a75
    v_cvt_pk_bf16_f32 v136, v132, v133
    v_cvt_pk_bf16_f32 v137, v134, v135
    v_add_u32 v6, 589824, v5
    buffer_store_dwordx2 v[136:137], v6, s[8:11], 0 offen
    v_accvgpr_read_b32 v132, a76
    v_accvgpr_read_b32 v133, a77
    v_accvgpr_read_b32 v134, a78
    v_accvgpr_read_b32 v135, a79
    v_cvt_pk_bf16_f32 v136, v132, v133
    v_cvt_pk_bf16_f32 v137, v134, v135
    v_add_u32 v6, 589856, v5
    buffer_store_dwordx2 v[136:137], v6, s[8:11], 0 offen
    v_accvgpr_read_b32 v132, a80
    v_accvgpr_read_b32 v133, a81
    v_accvgpr_read_b32 v134, a82
    v_accvgpr_read_b32 v135, a83
    v_cvt_pk_bf16_f32 v136, v132, v133
    v_cvt_pk_bf16_f32 v137, v134, v135
    v_add_u32 v6, 589888, v5
    buffer_store_dwordx2 v[136:137], v6, s[8:11], 0 offen
    v_accvgpr_read_b32 v132, a84
    v_accvgpr_read_b32 v133, a85
    v_accvgpr_read_b32 v134, a86
    v_accvgpr_read_b32 v135, a87
    v_cvt_pk_bf16_f32 v136, v132, v133
    v_cvt_pk_bf16_f32 v137, v134, v135
    v_add_u32 v6, 589920, v5
    buffer_store_dwordx2 v[136:137], v6, s[8:11], 0 offen
    v_accvgpr_read_b32 v132, a88
    v_accvgpr_read_b32 v133, a89
    v_accvgpr_read_b32 v134, a90
    v_accvgpr_read_b32 v135, a91
    v_cvt_pk_bf16_f32 v136, v132, v133
    v_cvt_pk_bf16_f32 v137, v134, v135
    v_add_u32 v6, 589952, v5
    buffer_store_dwordx2 v[136:137], v6, s[8:11], 0 offen
    v_accvgpr_read_b32 v132, a92
    v_accvgpr_read_b32 v133, a93
    v_accvgpr_read_b32 v134, a94
    v_accvgpr_read_b32 v135, a95
    v_cvt_pk_bf16_f32 v136, v132, v133
    v_cvt_pk_bf16_f32 v137, v134, v135
    v_add_u32 v6, 589984, v5
    buffer_store_dwordx2 v[136:137], v6, s[8:11], 0 offen
    v_accvgpr_read_b32 v132, a96
    v_accvgpr_read_b32 v133, a97
    v_accvgpr_read_b32 v134, a98
    v_accvgpr_read_b32 v135, a99
    v_cvt_pk_bf16_f32 v136, v132, v133
    v_cvt_pk_bf16_f32 v137, v134, v135
    v_add_u32 v6, 786432, v5
    buffer_store_dwordx2 v[136:137], v6, s[8:11], 0 offen
    v_accvgpr_read_b32 v132, a100
    v_accvgpr_read_b32 v133, a101
    v_accvgpr_read_b32 v134, a102
    v_accvgpr_read_b32 v135, a103
    v_cvt_pk_bf16_f32 v136, v132, v133
    v_cvt_pk_bf16_f32 v137, v134, v135
    v_add_u32 v6, 786464, v5
    buffer_store_dwordx2 v[136:137], v6, s[8:11], 0 offen
    v_accvgpr_read_b32 v132, a104
    v_accvgpr_read_b32 v133, a105
    v_accvgpr_read_b32 v134, a106
    v_accvgpr_read_b32 v135, a107
    v_cvt_pk_bf16_f32 v136, v132, v133
    v_cvt_pk_bf16_f32 v137, v134, v135
    v_add_u32 v6, 786496, v5
    buffer_store_dwordx2 v[136:137], v6, s[8:11], 0 offen
    v_accvgpr_read_b32 v132, a108
    v_accvgpr_read_b32 v133, a109
    v_accvgpr_read_b32 v134, a110
    v_accvgpr_read_b32 v135, a111
    v_cvt_pk_bf16_f32 v136, v132, v133
    v_cvt_pk_bf16_f32 v137, v134, v135
    v_add_u32 v6, 786528, v5
    buffer_store_dwordx2 v[136:137], v6, s[8:11], 0 offen
    v_accvgpr_read_b32 v132, a112
    v_accvgpr_read_b32 v133, a113
    v_accvgpr_read_b32 v134, a114
    v_accvgpr_read_b32 v135, a115
    v_cvt_pk_bf16_f32 v136, v132, v133
    v_cvt_pk_bf16_f32 v137, v134, v135
    v_add_u32 v6, 786560, v5
    buffer_store_dwordx2 v[136:137], v6, s[8:11], 0 offen
    v_accvgpr_read_b32 v132, a116
    v_accvgpr_read_b32 v133, a117
    v_accvgpr_read_b32 v134, a118
    v_accvgpr_read_b32 v135, a119
    v_cvt_pk_bf16_f32 v136, v132, v133
    v_cvt_pk_bf16_f32 v137, v134, v135
    v_add_u32 v6, 786592, v5
    buffer_store_dwordx2 v[136:137], v6, s[8:11], 0 offen
    v_accvgpr_read_b32 v132, a120
    v_accvgpr_read_b32 v133, a121
    v_accvgpr_read_b32 v134, a122
    v_accvgpr_read_b32 v135, a123
    v_cvt_pk_bf16_f32 v136, v132, v133
    v_cvt_pk_bf16_f32 v137, v134, v135
    v_add_u32 v6, 983040, v5
    buffer_store_dwordx2 v[136:137], v6, s[8:11], 0 offen
    v_accvgpr_read_b32 v132, a124
    v_accvgpr_read_b32 v133, a125
    v_accvgpr_read_b32 v134, a126
    v_accvgpr_read_b32 v135, a127
    v_cvt_pk_bf16_f32 v136, v132, v133
    v_cvt_pk_bf16_f32 v137, v134, v135
    v_add_u32 v6, 983072, v5
    buffer_store_dwordx2 v[136:137], v6, s[8:11], 0 offen
    v_accvgpr_read_b32 v132, a128
    v_accvgpr_read_b32 v133, a129
    v_accvgpr_read_b32 v134, a130
    v_accvgpr_read_b32 v135, a131
    v_cvt_pk_bf16_f32 v136, v132, v133
    v_cvt_pk_bf16_f32 v137, v134, v135
    v_add_u32 v6, 983104, v5
    buffer_store_dwordx2 v[136:137], v6, s[8:11], 0 offen
    v_accvgpr_read_b32 v132, a132
    v_accvgpr_read_b32 v133, a133
    v_accvgpr_read_b32 v134, a134
    v_accvgpr_read_b32 v135, a135
    v_cvt_pk_bf16_f32 v136, v132, v133
    v_cvt_pk_bf16_f32 v137, v134, v135
    v_add_u32 v6, 983136, v5
    buffer_store_dwordx2 v[136:137], v6, s[8:11], 0 offen
    v_accvgpr_read_b32 v132, a136
    v_accvgpr_read_b32 v133, a137
    v_accvgpr_read_b32 v134, a138
    v_accvgpr_read_b32 v135, a139
    v_cvt_pk_bf16_f32 v136, v132, v133
    v_cvt_pk_bf16_f32 v137, v134, v135
    v_add_u32 v6, 983168, v5
    buffer_store_dwordx2 v[136:137], v6, s[8:11], 0 offen
    v_accvgpr_read_b32 v132, a140
    v_accvgpr_read_b32 v133, a141
    v_accvgpr_read_b32 v134, a142
    v_accvgpr_read_b32 v135, a143
    v_cvt_pk_bf16_f32 v136, v132, v133
    v_cvt_pk_bf16_f32 v137, v134, v135
    v_add_u32 v6, 983200, v5
    buffer_store_dwordx2 v[136:137], v6, s[8:11], 0 offen
    v_accvgpr_read_b32 v132, a144
    v_accvgpr_read_b32 v133, a145
    v_accvgpr_read_b32 v134, a146
    v_accvgpr_read_b32 v135, a147
    v_cvt_pk_bf16_f32 v136, v132, v133
    v_cvt_pk_bf16_f32 v137, v134, v135
    v_add_u32 v6, 1179648, v5
    buffer_store_dwordx2 v[136:137], v6, s[8:11], 0 offen
    v_accvgpr_read_b32 v132, a148
    v_accvgpr_read_b32 v133, a149
    v_accvgpr_read_b32 v134, a150
    v_accvgpr_read_b32 v135, a151
    v_cvt_pk_bf16_f32 v136, v132, v133
    v_cvt_pk_bf16_f32 v137, v134, v135
    v_add_u32 v6, 1179680, v5
    buffer_store_dwordx2 v[136:137], v6, s[8:11], 0 offen
    v_accvgpr_read_b32 v132, a152
    v_accvgpr_read_b32 v133, a153
    v_accvgpr_read_b32 v134, a154
    v_accvgpr_read_b32 v135, a155
    v_cvt_pk_bf16_f32 v136, v132, v133
    v_cvt_pk_bf16_f32 v137, v134, v135
    v_add_u32 v6, 1179712, v5
    buffer_store_dwordx2 v[136:137], v6, s[8:11], 0 offen
    v_accvgpr_read_b32 v132, a156
    v_accvgpr_read_b32 v133, a157
    v_accvgpr_read_b32 v134, a158
    v_accvgpr_read_b32 v135, a159
    v_cvt_pk_bf16_f32 v136, v132, v133
    v_cvt_pk_bf16_f32 v137, v134, v135
    v_add_u32 v6, 1179744, v5
    buffer_store_dwordx2 v[136:137], v6, s[8:11], 0 offen
    v_accvgpr_read_b32 v132, a160
    v_accvgpr_read_b32 v133, a161
    v_accvgpr_read_b32 v134, a162
    v_accvgpr_read_b32 v135, a163
    v_cvt_pk_bf16_f32 v136, v132, v133
    v_cvt_pk_bf16_f32 v137, v134, v135
    v_add_u32 v6, 1179776, v5
    buffer_store_dwordx2 v[136:137], v6, s[8:11], 0 offen
    v_accvgpr_read_b32 v132, a164
    v_accvgpr_read_b32 v133, a165
    v_accvgpr_read_b32 v134, a166
    v_accvgpr_read_b32 v135, a167
    v_cvt_pk_bf16_f32 v136, v132, v133
    v_cvt_pk_bf16_f32 v137, v134, v135
    v_add_u32 v6, 1179808, v5
    buffer_store_dwordx2 v[136:137], v6, s[8:11], 0 offen
    v_accvgpr_read_b32 v132, a168
    v_accvgpr_read_b32 v133, a169
    v_accvgpr_read_b32 v134, a170
    v_accvgpr_read_b32 v135, a171
    v_cvt_pk_bf16_f32 v136, v132, v133
    v_cvt_pk_bf16_f32 v137, v134, v135
    v_add_u32 v6, 1376256, v5
    buffer_store_dwordx2 v[136:137], v6, s[8:11], 0 offen
    v_accvgpr_read_b32 v132, a172
    v_accvgpr_read_b32 v133, a173
    v_accvgpr_read_b32 v134, a174
    v_accvgpr_read_b32 v135, a175
    v_cvt_pk_bf16_f32 v136, v132, v133
    v_cvt_pk_bf16_f32 v137, v134, v135
    v_add_u32 v6, 1376288, v5
    buffer_store_dwordx2 v[136:137], v6, s[8:11], 0 offen
    v_accvgpr_read_b32 v132, a176
    v_accvgpr_read_b32 v133, a177
    v_accvgpr_read_b32 v134, a178
    v_accvgpr_read_b32 v135, a179
    v_cvt_pk_bf16_f32 v136, v132, v133
    v_cvt_pk_bf16_f32 v137, v134, v135
    v_add_u32 v6, 1376320, v5
    buffer_store_dwordx2 v[136:137], v6, s[8:11], 0 offen
    v_accvgpr_read_b32 v132, a180
    v_accvgpr_read_b32 v133, a181
    v_accvgpr_read_b32 v134, a182
    v_accvgpr_read_b32 v135, a183
    v_cvt_pk_bf16_f32 v136, v132, v133
    v_cvt_pk_bf16_f32 v137, v134, v135
    v_add_u32 v6, 1376352, v5
    buffer_store_dwordx2 v[136:137], v6, s[8:11], 0 offen
    v_accvgpr_read_b32 v132, a184
    v_accvgpr_read_b32 v133, a185
    v_accvgpr_read_b32 v134, a186
    v_accvgpr_read_b32 v135, a187
    v_cvt_pk_bf16_f32 v136, v132, v133
    v_cvt_pk_bf16_f32 v137, v134, v135
    v_add_u32 v6, 1376384, v5
    buffer_store_dwordx2 v[136:137], v6, s[8:11], 0 offen
    v_accvgpr_read_b32 v132, a188
    v_accvgpr_read_b32 v133, a189
    v_accvgpr_read_b32 v134, a190
    v_accvgpr_read_b32 v135, a191
    v_cvt_pk_bf16_f32 v136, v132, v133
    v_cvt_pk_bf16_f32 v137, v134, v135
    v_add_u32 v6, 1376416, v5
    buffer_store_dwordx2 v[136:137], v6, s[8:11], 0 offen
    s_branch qkv_b_kernel_end
qkv_b_kernel_nrm:
    buffer_load_dwordx4 v[16:19], v8, s[8:11], s25 offen
    buffer_load_dwordx4 v[20:23], v9, s[8:11], s25 offen
    buffer_load_dwordx4 v[24:27], v10, s[8:11], s25 offen
    buffer_load_dwordx4 v[28:31], v11, s[8:11], s25 offen
    buffer_load_dwordx4 v[32:35], v12, s[8:11], s25 offen
    buffer_load_dwordx4 v[36:39], v13, s[8:11], s25 offen
    buffer_load_dwordx4 v[40:43], v14, s[8:11], s25 offen
    buffer_load_dwordx4 v[44:47], v15, s[8:11], s25 offen
    buffer_load_dwordx4 v[48:51], v7, s[8:11], s32 offen
    buffer_load_dwordx4 v[52:55], v7, s[8:11], s33 offen
    buffer_load_dwordx4 v[56:59], v7, s[8:11], s34 offen
    buffer_load_dwordx4 v[60:63], v7, s[8:11], s35 offen
    buffer_load_dwordx4 v[64:67], v7, s[8:11], s36 offen
    buffer_load_dwordx4 v[68:71], v7, s[8:11], s37 offen
    s_mov_b32 s28, 10
qkv_b_kernel_loop1:
    s_add_u32 s25, s25, 64
    s_add_u32 s32, s32, 1024
    s_add_u32 s33, s33, 1024
    s_add_u32 s34, s34, 1024
    s_add_u32 s35, s35, 1024
    s_add_u32 s36, s36, 1024
    s_add_u32 s37, s37, 1024
    buffer_load_dwordx4 v[72:75], v8, s[8:11], s25 offen
    buffer_load_dwordx4 v[76:79], v9, s[8:11], s25 offen
    buffer_load_dwordx4 v[80:83], v10, s[8:11], s25 offen
    buffer_load_dwordx4 v[84:87], v11, s[8:11], s25 offen
    buffer_load_dwordx4 v[88:91], v12, s[8:11], s25 offen
    buffer_load_dwordx4 v[92:95], v13, s[8:11], s25 offen
    buffer_load_dwordx4 v[96:99], v14, s[8:11], s25 offen
    buffer_load_dwordx4 v[100:103], v15, s[8:11], s25 offen
    buffer_load_dwordx4 v[104:107], v7, s[8:11], s32 offen
    buffer_load_dwordx4 v[108:111], v7, s[8:11], s33 offen
    buffer_load_dwordx4 v[112:115], v7, s[8:11], s34 offen
    buffer_load_dwordx4 v[116:119], v7, s[8:11], s35 offen
    buffer_load_dwordx4 v[120:123], v7, s[8:11], s36 offen
    buffer_load_dwordx4 v[124:127], v7, s[8:11], s37 offen
    s_waitcnt vmcnt(14)
    v_mfma_f32_16x16x32_bf16 a[0:3], v[16:19], v[48:51], a[0:3]
    v_mfma_f32_16x16x32_bf16 a[24:27], v[20:23], v[48:51], a[24:27]
    v_mfma_f32_16x16x32_bf16 a[48:51], v[24:27], v[48:51], a[48:51]
    v_mfma_f32_16x16x32_bf16 a[72:75], v[28:31], v[48:51], a[72:75]
    v_mfma_f32_16x16x32_bf16 a[96:99], v[32:35], v[48:51], a[96:99]
    v_mfma_f32_16x16x32_bf16 a[120:123], v[36:39], v[48:51], a[120:123]
    v_mfma_f32_16x16x32_bf16 a[144:147], v[40:43], v[48:51], a[144:147]
    v_mfma_f32_16x16x32_bf16 a[168:171], v[44:47], v[48:51], a[168:171]
    v_mfma_f32_16x16x32_bf16 a[4:7], v[16:19], v[52:55], a[4:7]
    v_mfma_f32_16x16x32_bf16 a[28:31], v[20:23], v[52:55], a[28:31]
    v_mfma_f32_16x16x32_bf16 a[52:55], v[24:27], v[52:55], a[52:55]
    v_mfma_f32_16x16x32_bf16 a[76:79], v[28:31], v[52:55], a[76:79]
    v_mfma_f32_16x16x32_bf16 a[100:103], v[32:35], v[52:55], a[100:103]
    v_mfma_f32_16x16x32_bf16 a[124:127], v[36:39], v[52:55], a[124:127]
    v_mfma_f32_16x16x32_bf16 a[148:151], v[40:43], v[52:55], a[148:151]
    v_mfma_f32_16x16x32_bf16 a[172:175], v[44:47], v[52:55], a[172:175]
    v_mfma_f32_16x16x32_bf16 a[8:11], v[16:19], v[56:59], a[8:11]
    v_mfma_f32_16x16x32_bf16 a[32:35], v[20:23], v[56:59], a[32:35]
    v_mfma_f32_16x16x32_bf16 a[56:59], v[24:27], v[56:59], a[56:59]
    v_mfma_f32_16x16x32_bf16 a[80:83], v[28:31], v[56:59], a[80:83]
    v_mfma_f32_16x16x32_bf16 a[104:107], v[32:35], v[56:59], a[104:107]
    v_mfma_f32_16x16x32_bf16 a[128:131], v[36:39], v[56:59], a[128:131]
    v_mfma_f32_16x16x32_bf16 a[152:155], v[40:43], v[56:59], a[152:155]
    v_mfma_f32_16x16x32_bf16 a[176:179], v[44:47], v[56:59], a[176:179]
    v_mfma_f32_16x16x32_bf16 a[12:15], v[16:19], v[60:63], a[12:15]
    v_mfma_f32_16x16x32_bf16 a[36:39], v[20:23], v[60:63], a[36:39]
    v_mfma_f32_16x16x32_bf16 a[60:63], v[24:27], v[60:63], a[60:63]
    v_mfma_f32_16x16x32_bf16 a[84:87], v[28:31], v[60:63], a[84:87]
    v_mfma_f32_16x16x32_bf16 a[108:111], v[32:35], v[60:63], a[108:111]
    v_mfma_f32_16x16x32_bf16 a[132:135], v[36:39], v[60:63], a[132:135]
    v_mfma_f32_16x16x32_bf16 a[156:159], v[40:43], v[60:63], a[156:159]
    v_mfma_f32_16x16x32_bf16 a[180:183], v[44:47], v[60:63], a[180:183]
    v_mfma_f32_16x16x32_bf16 a[16:19], v[16:19], v[64:67], a[16:19]
    v_mfma_f32_16x16x32_bf16 a[40:43], v[20:23], v[64:67], a[40:43]
    v_mfma_f32_16x16x32_bf16 a[64:67], v[24:27], v[64:67], a[64:67]
    v_mfma_f32_16x16x32_bf16 a[88:91], v[28:31], v[64:67], a[88:91]
    v_mfma_f32_16x16x32_bf16 a[112:115], v[32:35], v[64:67], a[112:115]
    v_mfma_f32_16x16x32_bf16 a[136:139], v[36:39], v[64:67], a[136:139]
    v_mfma_f32_16x16x32_bf16 a[160:163], v[40:43], v[64:67], a[160:163]
    v_mfma_f32_16x16x32_bf16 a[184:187], v[44:47], v[64:67], a[184:187]
    v_mfma_f32_16x16x32_bf16 a[20:23], v[16:19], v[68:71], a[20:23]
    v_mfma_f32_16x16x32_bf16 a[44:47], v[20:23], v[68:71], a[44:47]
    v_mfma_f32_16x16x32_bf16 a[68:71], v[24:27], v[68:71], a[68:71]
    v_mfma_f32_16x16x32_bf16 a[92:95], v[28:31], v[68:71], a[92:95]
    v_mfma_f32_16x16x32_bf16 a[116:119], v[32:35], v[68:71], a[116:119]
    v_mfma_f32_16x16x32_bf16 a[140:143], v[36:39], v[68:71], a[140:143]
    v_mfma_f32_16x16x32_bf16 a[164:167], v[40:43], v[68:71], a[164:167]
    v_mfma_f32_16x16x32_bf16 a[188:191], v[44:47], v[68:71], a[188:191]
    s_sub_u32 s28, s28, 1
    s_cmp_eq_u32 s28, 0
    s_cbranch_scc1 qkv_b_kernel_loop1_last
    s_add_u32 s25, s25, 64
    s_add_u32 s32, s32, 1024
    s_add_u32 s33, s33, 1024
    s_add_u32 s34, s34, 1024
    s_add_u32 s35, s35, 1024
    s_add_u32 s36, s36, 1024
    s_add_u32 s37, s37, 1024
    buffer_load_dwordx4 v[16:19], v8, s[8:11], s25 offen
    buffer_load_dwordx4 v[20:23], v9, s[8:11], s25 offen
    buffer_load_dwordx4 v[24:27], v10, s[8:11], s25 offen
    buffer_load_dwordx4 v[28:31], v11, s[8:11], s25 offen
    buffer_load_dwordx4 v[32:35], v12, s[8:11], s25 offen
    buffer_load_dwordx4 v[36:39], v13, s[8:11], s25 offen
    buffer_load_dwordx4 v[40:43], v14, s[8:11], s25 offen
    buffer_load_dwordx4 v[44:47], v15, s[8:11], s25 offen
    buffer_load_dwordx4 v[48:51], v7, s[8:11], s32 offen
    buffer_load_dwordx4 v[52:55], v7, s[8:11], s33 offen
    buffer_load_dwordx4 v[56:59], v7, s[8:11], s34 offen
    buffer_load_dwordx4 v[60:63], v7, s[8:11], s35 offen
    buffer_load_dwordx4 v[64:67], v7, s[8:11], s36 offen
    buffer_load_dwordx4 v[68:71], v7, s[8:11], s37 offen
    s_waitcnt vmcnt(14)
    v_mfma_f32_16x16x32_bf16 a[0:3], v[72:75], v[104:107], a[0:3]
    v_mfma_f32_16x16x32_bf16 a[24:27], v[76:79], v[104:107], a[24:27]
    v_mfma_f32_16x16x32_bf16 a[48:51], v[80:83], v[104:107], a[48:51]
    v_mfma_f32_16x16x32_bf16 a[72:75], v[84:87], v[104:107], a[72:75]
    v_mfma_f32_16x16x32_bf16 a[96:99], v[88:91], v[104:107], a[96:99]
    v_mfma_f32_16x16x32_bf16 a[120:123], v[92:95], v[104:107], a[120:123]
    v_mfma_f32_16x16x32_bf16 a[144:147], v[96:99], v[104:107], a[144:147]
    v_mfma_f32_16x16x32_bf16 a[168:171], v[100:103], v[104:107], a[168:171]
    v_mfma_f32_16x16x32_bf16 a[4:7], v[72:75], v[108:111], a[4:7]
    v_mfma_f32_16x16x32_bf16 a[28:31], v[76:79], v[108:111], a[28:31]
    v_mfma_f32_16x16x32_bf16 a[52:55], v[80:83], v[108:111], a[52:55]
    v_mfma_f32_16x16x32_bf16 a[76:79], v[84:87], v[108:111], a[76:79]
    v_mfma_f32_16x16x32_bf16 a[100:103], v[88:91], v[108:111], a[100:103]
    v_mfma_f32_16x16x32_bf16 a[124:127], v[92:95], v[108:111], a[124:127]
    v_mfma_f32_16x16x32_bf16 a[148:151], v[96:99], v[108:111], a[148:151]
    v_mfma_f32_16x16x32_bf16 a[172:175], v[100:103], v[108:111], a[172:175]
    v_mfma_f32_16x16x32_bf16 a[8:11], v[72:75], v[112:115], a[8:11]
    v_mfma_f32_16x16x32_bf16 a[32:35], v[76:79], v[112:115], a[32:35]
    v_mfma_f32_16x16x32_bf16 a[56:59], v[80:83], v[112:115], a[56:59]
    v_mfma_f32_16x16x32_bf16 a[80:83], v[84:87], v[112:115], a[80:83]
    v_mfma_f32_16x16x32_bf16 a[104:107], v[88:91], v[112:115], a[104:107]
    v_mfma_f32_16x16x32_bf16 a[128:131], v[92:95], v[112:115], a[128:131]
    v_mfma_f32_16x16x32_bf16 a[152:155], v[96:99], v[112:115], a[152:155]
    v_mfma_f32_16x16x32_bf16 a[176:179], v[100:103], v[112:115], a[176:179]
    v_mfma_f32_16x16x32_bf16 a[12:15], v[72:75], v[116:119], a[12:15]
    v_mfma_f32_16x16x32_bf16 a[36:39], v[76:79], v[116:119], a[36:39]
    v_mfma_f32_16x16x32_bf16 a[60:63], v[80:83], v[116:119], a[60:63]
    v_mfma_f32_16x16x32_bf16 a[84:87], v[84:87], v[116:119], a[84:87]
    v_mfma_f32_16x16x32_bf16 a[108:111], v[88:91], v[116:119], a[108:111]
    v_mfma_f32_16x16x32_bf16 a[132:135], v[92:95], v[116:119], a[132:135]
    v_mfma_f32_16x16x32_bf16 a[156:159], v[96:99], v[116:119], a[156:159]
    v_mfma_f32_16x16x32_bf16 a[180:183], v[100:103], v[116:119], a[180:183]
    v_mfma_f32_16x16x32_bf16 a[16:19], v[72:75], v[120:123], a[16:19]
    v_mfma_f32_16x16x32_bf16 a[40:43], v[76:79], v[120:123], a[40:43]
    v_mfma_f32_16x16x32_bf16 a[64:67], v[80:83], v[120:123], a[64:67]
    v_mfma_f32_16x16x32_bf16 a[88:91], v[84:87], v[120:123], a[88:91]
    v_mfma_f32_16x16x32_bf16 a[112:115], v[88:91], v[120:123], a[112:115]
    v_mfma_f32_16x16x32_bf16 a[136:139], v[92:95], v[120:123], a[136:139]
    v_mfma_f32_16x16x32_bf16 a[160:163], v[96:99], v[120:123], a[160:163]
    v_mfma_f32_16x16x32_bf16 a[184:187], v[100:103], v[120:123], a[184:187]
    v_mfma_f32_16x16x32_bf16 a[20:23], v[72:75], v[124:127], a[20:23]
    v_mfma_f32_16x16x32_bf16 a[44:47], v[76:79], v[124:127], a[44:47]
    v_mfma_f32_16x16x32_bf16 a[68:71], v[80:83], v[124:127], a[68:71]
    v_mfma_f32_16x16x32_bf16 a[92:95], v[84:87], v[124:127], a[92:95]
    v_mfma_f32_16x16x32_bf16 a[116:119], v[88:91], v[124:127], a[116:119]
    v_mfma_f32_16x16x32_bf16 a[140:143], v[92:95], v[124:127], a[140:143]
    v_mfma_f32_16x16x32_bf16 a[164:167], v[96:99], v[124:127], a[164:167]
    v_mfma_f32_16x16x32_bf16 a[188:191], v[100:103], v[124:127], a[188:191]
    s_branch qkv_b_kernel_loop1
qkv_b_kernel_loop1_last:
    s_waitcnt vmcnt(0)
    v_mfma_f32_16x16x32_bf16 a[0:3], v[72:75], v[104:107], a[0:3]
    v_mfma_f32_16x16x32_bf16 a[24:27], v[76:79], v[104:107], a[24:27]
    v_mfma_f32_16x16x32_bf16 a[48:51], v[80:83], v[104:107], a[48:51]
    v_mfma_f32_16x16x32_bf16 a[72:75], v[84:87], v[104:107], a[72:75]
    v_mfma_f32_16x16x32_bf16 a[96:99], v[88:91], v[104:107], a[96:99]
    v_mfma_f32_16x16x32_bf16 a[120:123], v[92:95], v[104:107], a[120:123]
    v_mfma_f32_16x16x32_bf16 a[144:147], v[96:99], v[104:107], a[144:147]
    v_mfma_f32_16x16x32_bf16 a[168:171], v[100:103], v[104:107], a[168:171]
    v_mfma_f32_16x16x32_bf16 a[4:7], v[72:75], v[108:111], a[4:7]
    v_mfma_f32_16x16x32_bf16 a[28:31], v[76:79], v[108:111], a[28:31]
    v_mfma_f32_16x16x32_bf16 a[52:55], v[80:83], v[108:111], a[52:55]
    v_mfma_f32_16x16x32_bf16 a[76:79], v[84:87], v[108:111], a[76:79]
    v_mfma_f32_16x16x32_bf16 a[100:103], v[88:91], v[108:111], a[100:103]
    v_mfma_f32_16x16x32_bf16 a[124:127], v[92:95], v[108:111], a[124:127]
    v_mfma_f32_16x16x32_bf16 a[148:151], v[96:99], v[108:111], a[148:151]
    v_mfma_f32_16x16x32_bf16 a[172:175], v[100:103], v[108:111], a[172:175]
    v_mfma_f32_16x16x32_bf16 a[8:11], v[72:75], v[112:115], a[8:11]
    v_mfma_f32_16x16x32_bf16 a[32:35], v[76:79], v[112:115], a[32:35]
    v_mfma_f32_16x16x32_bf16 a[56:59], v[80:83], v[112:115], a[56:59]
    v_mfma_f32_16x16x32_bf16 a[80:83], v[84:87], v[112:115], a[80:83]
    v_mfma_f32_16x16x32_bf16 a[104:107], v[88:91], v[112:115], a[104:107]
    v_mfma_f32_16x16x32_bf16 a[128:131], v[92:95], v[112:115], a[128:131]
    v_mfma_f32_16x16x32_bf16 a[152:155], v[96:99], v[112:115], a[152:155]
    v_mfma_f32_16x16x32_bf16 a[176:179], v[100:103], v[112:115], a[176:179]
    v_mfma_f32_16x16x32_bf16 a[12:15], v[72:75], v[116:119], a[12:15]
    v_mfma_f32_16x16x32_bf16 a[36:39], v[76:79], v[116:119], a[36:39]
    v_mfma_f32_16x16x32_bf16 a[60:63], v[80:83], v[116:119], a[60:63]
    v_mfma_f32_16x16x32_bf16 a[84:87], v[84:87], v[116:119], a[84:87]
    v_mfma_f32_16x16x32_bf16 a[108:111], v[88:91], v[116:119], a[108:111]
    v_mfma_f32_16x16x32_bf16 a[132:135], v[92:95], v[116:119], a[132:135]
    v_mfma_f32_16x16x32_bf16 a[156:159], v[96:99], v[116:119], a[156:159]
    v_mfma_f32_16x16x32_bf16 a[180:183], v[100:103], v[116:119], a[180:183]
    v_mfma_f32_16x16x32_bf16 a[16:19], v[72:75], v[120:123], a[16:19]
    v_mfma_f32_16x16x32_bf16 a[40:43], v[76:79], v[120:123], a[40:43]
    v_mfma_f32_16x16x32_bf16 a[64:67], v[80:83], v[120:123], a[64:67]
    v_mfma_f32_16x16x32_bf16 a[88:91], v[84:87], v[120:123], a[88:91]
    v_mfma_f32_16x16x32_bf16 a[112:115], v[88:91], v[120:123], a[112:115]
    v_mfma_f32_16x16x32_bf16 a[136:139], v[92:95], v[120:123], a[136:139]
    v_mfma_f32_16x16x32_bf16 a[160:163], v[96:99], v[120:123], a[160:163]
    v_mfma_f32_16x16x32_bf16 a[184:187], v[100:103], v[120:123], a[184:187]
    v_mfma_f32_16x16x32_bf16 a[20:23], v[72:75], v[124:127], a[20:23]
    v_mfma_f32_16x16x32_bf16 a[44:47], v[76:79], v[124:127], a[44:47]
    v_mfma_f32_16x16x32_bf16 a[68:71], v[80:83], v[124:127], a[68:71]
    v_mfma_f32_16x16x32_bf16 a[92:95], v[84:87], v[124:127], a[92:95]
    v_mfma_f32_16x16x32_bf16 a[116:119], v[88:91], v[124:127], a[116:119]
    v_mfma_f32_16x16x32_bf16 a[140:143], v[92:95], v[124:127], a[140:143]
    v_mfma_f32_16x16x32_bf16 a[164:167], v[96:99], v[124:127], a[164:167]
    v_mfma_f32_16x16x32_bf16 a[188:191], v[100:103], v[124:127], a[188:191]
    s_nop 7
    s_nop 7
    s_sub_u32 s29, s23, 12288
    v_add_u32 v5, s29, v3
    v_lshlrev_b32 v5, 5, v5
    v_lshlrev_b32 v6, 2, v4
    v_add_u32 v5, v5, v6
    s_lshr_b32 s30, s22, 5
    s_mul_i32 s30, s30, 196608
    v_add_u32 v5, s30, v5
    v_lshlrev_b32 v5, 1, v5
    v_add_u32 v5, 117440512, v5
    v_accvgpr_read_b32 v132, a0
    v_accvgpr_read_b32 v133, a1
    v_accvgpr_read_b32 v134, a2
    v_accvgpr_read_b32 v135, a3
    v_cvt_pk_bf16_f32 v136, v132, v133
    v_cvt_pk_bf16_f32 v137, v134, v135
    v_add_u32 v6, 0, v5
    buffer_store_dwordx2 v[136:137], v6, s[8:11], 0 offen
    v_accvgpr_read_b32 v132, a4
    v_accvgpr_read_b32 v133, a5
    v_accvgpr_read_b32 v134, a6
    v_accvgpr_read_b32 v135, a7
    v_cvt_pk_bf16_f32 v136, v132, v133
    v_cvt_pk_bf16_f32 v137, v134, v135
    v_add_u32 v6, 1024, v5
    buffer_store_dwordx2 v[136:137], v6, s[8:11], 0 offen
    v_accvgpr_read_b32 v132, a8
    v_accvgpr_read_b32 v133, a9
    v_accvgpr_read_b32 v134, a10
    v_accvgpr_read_b32 v135, a11
    v_cvt_pk_bf16_f32 v136, v132, v133
    v_cvt_pk_bf16_f32 v137, v134, v135
    v_add_u32 v6, 2048, v5
    buffer_store_dwordx2 v[136:137], v6, s[8:11], 0 offen
    v_accvgpr_read_b32 v132, a12
    v_accvgpr_read_b32 v133, a13
    v_accvgpr_read_b32 v134, a14
    v_accvgpr_read_b32 v135, a15
    v_cvt_pk_bf16_f32 v136, v132, v133
    v_cvt_pk_bf16_f32 v137, v134, v135
    v_add_u32 v6, 3072, v5
    buffer_store_dwordx2 v[136:137], v6, s[8:11], 0 offen
    v_accvgpr_read_b32 v132, a16
    v_accvgpr_read_b32 v133, a17
    v_accvgpr_read_b32 v134, a18
    v_accvgpr_read_b32 v135, a19
    v_cvt_pk_bf16_f32 v136, v132, v133
    v_cvt_pk_bf16_f32 v137, v134, v135
    v_add_u32 v6, 4096, v5
    buffer_store_dwordx2 v[136:137], v6, s[8:11], 0 offen
    v_accvgpr_read_b32 v132, a20
    v_accvgpr_read_b32 v133, a21
    v_accvgpr_read_b32 v134, a22
    v_accvgpr_read_b32 v135, a23
    v_cvt_pk_bf16_f32 v136, v132, v133
    v_cvt_pk_bf16_f32 v137, v134, v135
    v_add_u32 v6, 5120, v5
    buffer_store_dwordx2 v[136:137], v6, s[8:11], 0 offen
    v_accvgpr_read_b32 v132, a24
    v_accvgpr_read_b32 v133, a25
    v_accvgpr_read_b32 v134, a26
    v_accvgpr_read_b32 v135, a27
    v_cvt_pk_bf16_f32 v136, v132, v133
    v_cvt_pk_bf16_f32 v137, v134, v135
    v_add_u32 v6, 32, v5
    buffer_store_dwordx2 v[136:137], v6, s[8:11], 0 offen
    v_accvgpr_read_b32 v132, a28
    v_accvgpr_read_b32 v133, a29
    v_accvgpr_read_b32 v134, a30
    v_accvgpr_read_b32 v135, a31
    v_cvt_pk_bf16_f32 v136, v132, v133
    v_cvt_pk_bf16_f32 v137, v134, v135
    v_add_u32 v6, 1056, v5
    buffer_store_dwordx2 v[136:137], v6, s[8:11], 0 offen
    v_accvgpr_read_b32 v132, a32
    v_accvgpr_read_b32 v133, a33
    v_accvgpr_read_b32 v134, a34
    v_accvgpr_read_b32 v135, a35
    v_cvt_pk_bf16_f32 v136, v132, v133
    v_cvt_pk_bf16_f32 v137, v134, v135
    v_add_u32 v6, 2080, v5
    buffer_store_dwordx2 v[136:137], v6, s[8:11], 0 offen
    v_accvgpr_read_b32 v132, a36
    v_accvgpr_read_b32 v133, a37
    v_accvgpr_read_b32 v134, a38
    v_accvgpr_read_b32 v135, a39
    v_cvt_pk_bf16_f32 v136, v132, v133
    v_cvt_pk_bf16_f32 v137, v134, v135
    v_add_u32 v6, 3104, v5
    buffer_store_dwordx2 v[136:137], v6, s[8:11], 0 offen
    v_accvgpr_read_b32 v132, a40
    v_accvgpr_read_b32 v133, a41
    v_accvgpr_read_b32 v134, a42
    v_accvgpr_read_b32 v135, a43
    v_cvt_pk_bf16_f32 v136, v132, v133
    v_cvt_pk_bf16_f32 v137, v134, v135
    v_add_u32 v6, 4128, v5
    buffer_store_dwordx2 v[136:137], v6, s[8:11], 0 offen
    v_accvgpr_read_b32 v132, a44
    v_accvgpr_read_b32 v133, a45
    v_accvgpr_read_b32 v134, a46
    v_accvgpr_read_b32 v135, a47
    v_cvt_pk_bf16_f32 v136, v132, v133
    v_cvt_pk_bf16_f32 v137, v134, v135
    v_add_u32 v6, 5152, v5
    buffer_store_dwordx2 v[136:137], v6, s[8:11], 0 offen
    v_accvgpr_read_b32 v132, a48
    v_accvgpr_read_b32 v133, a49
    v_accvgpr_read_b32 v134, a50
    v_accvgpr_read_b32 v135, a51
    v_cvt_pk_bf16_f32 v136, v132, v133
    v_cvt_pk_bf16_f32 v137, v134, v135
    v_add_u32 v6, 393216, v5
    buffer_store_dwordx2 v[136:137], v6, s[8:11], 0 offen
    v_accvgpr_read_b32 v132, a52
    v_accvgpr_read_b32 v133, a53
    v_accvgpr_read_b32 v134, a54
    v_accvgpr_read_b32 v135, a55
    v_cvt_pk_bf16_f32 v136, v132, v133
    v_cvt_pk_bf16_f32 v137, v134, v135
    v_add_u32 v6, 394240, v5
    buffer_store_dwordx2 v[136:137], v6, s[8:11], 0 offen
    v_accvgpr_read_b32 v132, a56
    v_accvgpr_read_b32 v133, a57
    v_accvgpr_read_b32 v134, a58
    v_accvgpr_read_b32 v135, a59
    v_cvt_pk_bf16_f32 v136, v132, v133
    v_cvt_pk_bf16_f32 v137, v134, v135
    v_add_u32 v6, 395264, v5
    buffer_store_dwordx2 v[136:137], v6, s[8:11], 0 offen
    v_accvgpr_read_b32 v132, a60
    v_accvgpr_read_b32 v133, a61
    v_accvgpr_read_b32 v134, a62
    v_accvgpr_read_b32 v135, a63
    v_cvt_pk_bf16_f32 v136, v132, v133
    v_cvt_pk_bf16_f32 v137, v134, v135
    v_add_u32 v6, 396288, v5
    buffer_store_dwordx2 v[136:137], v6, s[8:11], 0 offen
    v_accvgpr_read_b32 v132, a64
    v_accvgpr_read_b32 v133, a65
    v_accvgpr_read_b32 v134, a66
    v_accvgpr_read_b32 v135, a67
    v_cvt_pk_bf16_f32 v136, v132, v133
    v_cvt_pk_bf16_f32 v137, v134, v135
    v_add_u32 v6, 397312, v5
    buffer_store_dwordx2 v[136:137], v6, s[8:11], 0 offen
    v_accvgpr_read_b32 v132, a68
    v_accvgpr_read_b32 v133, a69
    v_accvgpr_read_b32 v134, a70
    v_accvgpr_read_b32 v135, a71
    v_cvt_pk_bf16_f32 v136, v132, v133
    v_cvt_pk_bf16_f32 v137, v134, v135
    v_add_u32 v6, 398336, v5
    buffer_store_dwordx2 v[136:137], v6, s[8:11], 0 offen
    v_accvgpr_read_b32 v132, a72
    v_accvgpr_read_b32 v133, a73
    v_accvgpr_read_b32 v134, a74
    v_accvgpr_read_b32 v135, a75
    v_cvt_pk_bf16_f32 v136, v132, v133
    v_cvt_pk_bf16_f32 v137, v134, v135
    v_add_u32 v6, 393248, v5
    buffer_store_dwordx2 v[136:137], v6, s[8:11], 0 offen
    v_accvgpr_read_b32 v132, a76
    v_accvgpr_read_b32 v133, a77
    v_accvgpr_read_b32 v134, a78
    v_accvgpr_read_b32 v135, a79
    v_cvt_pk_bf16_f32 v136, v132, v133
    v_cvt_pk_bf16_f32 v137, v134, v135
    v_add_u32 v6, 394272, v5
    buffer_store_dwordx2 v[136:137], v6, s[8:11], 0 offen
    v_accvgpr_read_b32 v132, a80
    v_accvgpr_read_b32 v133, a81
    v_accvgpr_read_b32 v134, a82
    v_accvgpr_read_b32 v135, a83
    v_cvt_pk_bf16_f32 v136, v132, v133
    v_cvt_pk_bf16_f32 v137, v134, v135
    v_add_u32 v6, 395296, v5
    buffer_store_dwordx2 v[136:137], v6, s[8:11], 0 offen
    v_accvgpr_read_b32 v132, a84
    v_accvgpr_read_b32 v133, a85
    v_accvgpr_read_b32 v134, a86
    v_accvgpr_read_b32 v135, a87
    v_cvt_pk_bf16_f32 v136, v132, v133
    v_cvt_pk_bf16_f32 v137, v134, v135
    v_add_u32 v6, 396320, v5
    buffer_store_dwordx2 v[136:137], v6, s[8:11], 0 offen
    v_accvgpr_read_b32 v132, a88
    v_accvgpr_read_b32 v133, a89
    v_accvgpr_read_b32 v134, a90
    v_accvgpr_read_b32 v135, a91
    v_cvt_pk_bf16_f32 v136, v132, v133
    v_cvt_pk_bf16_f32 v137, v134, v135
    v_add_u32 v6, 397344, v5
    buffer_store_dwordx2 v[136:137], v6, s[8:11], 0 offen
    v_accvgpr_read_b32 v132, a92
    v_accvgpr_read_b32 v133, a93
    v_accvgpr_read_b32 v134, a94
    v_accvgpr_read_b32 v135, a95
    v_cvt_pk_bf16_f32 v136, v132, v133
    v_cvt_pk_bf16_f32 v137, v134, v135
    v_add_u32 v6, 398368, v5
    buffer_store_dwordx2 v[136:137], v6, s[8:11], 0 offen
    v_accvgpr_read_b32 v132, a96
    v_accvgpr_read_b32 v133, a97
    v_accvgpr_read_b32 v134, a98
    v_accvgpr_read_b32 v135, a99
    v_cvt_pk_bf16_f32 v136, v132, v133
    v_cvt_pk_bf16_f32 v137, v134, v135
    v_add_u32 v6, 786432, v5
    buffer_store_dwordx2 v[136:137], v6, s[8:11], 0 offen
    v_accvgpr_read_b32 v132, a100
    v_accvgpr_read_b32 v133, a101
    v_accvgpr_read_b32 v134, a102
    v_accvgpr_read_b32 v135, a103
    v_cvt_pk_bf16_f32 v136, v132, v133
    v_cvt_pk_bf16_f32 v137, v134, v135
    v_add_u32 v6, 787456, v5
    buffer_store_dwordx2 v[136:137], v6, s[8:11], 0 offen
    v_accvgpr_read_b32 v132, a104
    v_accvgpr_read_b32 v133, a105
    v_accvgpr_read_b32 v134, a106
    v_accvgpr_read_b32 v135, a107
    v_cvt_pk_bf16_f32 v136, v132, v133
    v_cvt_pk_bf16_f32 v137, v134, v135
    v_add_u32 v6, 788480, v5
    buffer_store_dwordx2 v[136:137], v6, s[8:11], 0 offen
    v_accvgpr_read_b32 v132, a108
    v_accvgpr_read_b32 v133, a109
    v_accvgpr_read_b32 v134, a110
    v_accvgpr_read_b32 v135, a111
    v_cvt_pk_bf16_f32 v136, v132, v133
    v_cvt_pk_bf16_f32 v137, v134, v135
    v_add_u32 v6, 789504, v5
    buffer_store_dwordx2 v[136:137], v6, s[8:11], 0 offen
    v_accvgpr_read_b32 v132, a112
    v_accvgpr_read_b32 v133, a113
    v_accvgpr_read_b32 v134, a114
    v_accvgpr_read_b32 v135, a115
    v_cvt_pk_bf16_f32 v136, v132, v133
    v_cvt_pk_bf16_f32 v137, v134, v135
    v_add_u32 v6, 790528, v5
    buffer_store_dwordx2 v[136:137], v6, s[8:11], 0 offen
    v_accvgpr_read_b32 v132, a116
    v_accvgpr_read_b32 v133, a117
    v_accvgpr_read_b32 v134, a118
    v_accvgpr_read_b32 v135, a119
    v_cvt_pk_bf16_f32 v136, v132, v133
    v_cvt_pk_bf16_f32 v137, v134, v135
    v_add_u32 v6, 791552, v5
    buffer_store_dwordx2 v[136:137], v6, s[8:11], 0 offen
    v_accvgpr_read_b32 v132, a120
    v_accvgpr_read_b32 v133, a121
    v_accvgpr_read_b32 v134, a122
    v_accvgpr_read_b32 v135, a123
    v_cvt_pk_bf16_f32 v136, v132, v133
    v_cvt_pk_bf16_f32 v137, v134, v135
    v_add_u32 v6, 786464, v5
    buffer_store_dwordx2 v[136:137], v6, s[8:11], 0 offen
    v_accvgpr_read_b32 v132, a124
    v_accvgpr_read_b32 v133, a125
    v_accvgpr_read_b32 v134, a126
    v_accvgpr_read_b32 v135, a127
    v_cvt_pk_bf16_f32 v136, v132, v133
    v_cvt_pk_bf16_f32 v137, v134, v135
    v_add_u32 v6, 787488, v5
    buffer_store_dwordx2 v[136:137], v6, s[8:11], 0 offen
    v_accvgpr_read_b32 v132, a128
    v_accvgpr_read_b32 v133, a129
    v_accvgpr_read_b32 v134, a130
    v_accvgpr_read_b32 v135, a131
    v_cvt_pk_bf16_f32 v136, v132, v133
    v_cvt_pk_bf16_f32 v137, v134, v135
    v_add_u32 v6, 788512, v5
    buffer_store_dwordx2 v[136:137], v6, s[8:11], 0 offen
    v_accvgpr_read_b32 v132, a132
    v_accvgpr_read_b32 v133, a133
    v_accvgpr_read_b32 v134, a134
    v_accvgpr_read_b32 v135, a135
    v_cvt_pk_bf16_f32 v136, v132, v133
    v_cvt_pk_bf16_f32 v137, v134, v135
    v_add_u32 v6, 789536, v5
    buffer_store_dwordx2 v[136:137], v6, s[8:11], 0 offen
    v_accvgpr_read_b32 v132, a136
    v_accvgpr_read_b32 v133, a137
    v_accvgpr_read_b32 v134, a138
    v_accvgpr_read_b32 v135, a139
    v_cvt_pk_bf16_f32 v136, v132, v133
    v_cvt_pk_bf16_f32 v137, v134, v135
    v_add_u32 v6, 790560, v5
    buffer_store_dwordx2 v[136:137], v6, s[8:11], 0 offen
    v_accvgpr_read_b32 v132, a140
    v_accvgpr_read_b32 v133, a141
    v_accvgpr_read_b32 v134, a142
    v_accvgpr_read_b32 v135, a143
    v_cvt_pk_bf16_f32 v136, v132, v133
    v_cvt_pk_bf16_f32 v137, v134, v135
    v_add_u32 v6, 791584, v5
    buffer_store_dwordx2 v[136:137], v6, s[8:11], 0 offen
    v_accvgpr_read_b32 v132, a144
    v_accvgpr_read_b32 v133, a145
    v_accvgpr_read_b32 v134, a146
    v_accvgpr_read_b32 v135, a147
    v_cvt_pk_bf16_f32 v136, v132, v133
    v_cvt_pk_bf16_f32 v137, v134, v135
    v_add_u32 v6, 1179648, v5
    buffer_store_dwordx2 v[136:137], v6, s[8:11], 0 offen
    v_accvgpr_read_b32 v132, a148
    v_accvgpr_read_b32 v133, a149
    v_accvgpr_read_b32 v134, a150
    v_accvgpr_read_b32 v135, a151
    v_cvt_pk_bf16_f32 v136, v132, v133
    v_cvt_pk_bf16_f32 v137, v134, v135
    v_add_u32 v6, 1180672, v5
    buffer_store_dwordx2 v[136:137], v6, s[8:11], 0 offen
    v_accvgpr_read_b32 v132, a152
    v_accvgpr_read_b32 v133, a153
    v_accvgpr_read_b32 v134, a154
    v_accvgpr_read_b32 v135, a155
    v_cvt_pk_bf16_f32 v136, v132, v133
    v_cvt_pk_bf16_f32 v137, v134, v135
    v_add_u32 v6, 1181696, v5
    buffer_store_dwordx2 v[136:137], v6, s[8:11], 0 offen
    v_accvgpr_read_b32 v132, a156
    v_accvgpr_read_b32 v133, a157
    v_accvgpr_read_b32 v134, a158
    v_accvgpr_read_b32 v135, a159
    v_cvt_pk_bf16_f32 v136, v132, v133
    v_cvt_pk_bf16_f32 v137, v134, v135
    v_add_u32 v6, 1182720, v5
    buffer_store_dwordx2 v[136:137], v6, s[8:11], 0 offen
    v_accvgpr_read_b32 v132, a160
    v_accvgpr_read_b32 v133, a161
    v_accvgpr_read_b32 v134, a162
    v_accvgpr_read_b32 v135, a163
    v_cvt_pk_bf16_f32 v136, v132, v133
    v_cvt_pk_bf16_f32 v137, v134, v135
    v_add_u32 v6, 1183744, v5
    buffer_store_dwordx2 v[136:137], v6, s[8:11], 0 offen
    v_accvgpr_read_b32 v132, a164
    v_accvgpr_read_b32 v133, a165
    v_accvgpr_read_b32 v134, a166
    v_accvgpr_read_b32 v135, a167
    v_cvt_pk_bf16_f32 v136, v132, v133
    v_cvt_pk_bf16_f32 v137, v134, v135
    v_add_u32 v6, 1184768, v5
    buffer_store_dwordx2 v[136:137], v6, s[8:11], 0 offen
    v_accvgpr_read_b32 v132, a168
    v_accvgpr_read_b32 v133, a169
    v_accvgpr_read_b32 v134, a170
    v_accvgpr_read_b32 v135, a171
    v_cvt_pk_bf16_f32 v136, v132, v133
    v_cvt_pk_bf16_f32 v137, v134, v135
    v_add_u32 v6, 1179680, v5
    buffer_store_dwordx2 v[136:137], v6, s[8:11], 0 offen
    v_accvgpr_read_b32 v132, a172
    v_accvgpr_read_b32 v133, a173
    v_accvgpr_read_b32 v134, a174
    v_accvgpr_read_b32 v135, a175
    v_cvt_pk_bf16_f32 v136, v132, v133
    v_cvt_pk_bf16_f32 v137, v134, v135
    v_add_u32 v6, 1180704, v5
    buffer_store_dwordx2 v[136:137], v6, s[8:11], 0 offen
    v_accvgpr_read_b32 v132, a176
    v_accvgpr_read_b32 v133, a177
    v_accvgpr_read_b32 v134, a178
    v_accvgpr_read_b32 v135, a179
    v_cvt_pk_bf16_f32 v136, v132, v133
    v_cvt_pk_bf16_f32 v137, v134, v135
    v_add_u32 v6, 1181728, v5
    buffer_store_dwordx2 v[136:137], v6, s[8:11], 0 offen
    v_accvgpr_read_b32 v132, a180
    v_accvgpr_read_b32 v133, a181
    v_accvgpr_read_b32 v134, a182
    v_accvgpr_read_b32 v135, a183
    v_cvt_pk_bf16_f32 v136, v132, v133
    v_cvt_pk_bf16_f32 v137, v134, v135
    v_add_u32 v6, 1182752, v5
    buffer_store_dwordx2 v[136:137], v6, s[8:11], 0 offen
    v_accvgpr_read_b32 v132, a184
    v_accvgpr_read_b32 v133, a185
    v_accvgpr_read_b32 v134, a186
    v_accvgpr_read_b32 v135, a187
    v_cvt_pk_bf16_f32 v136, v132, v133
    v_cvt_pk_bf16_f32 v137, v134, v135
    v_add_u32 v6, 1183776, v5
    buffer_store_dwordx2 v[136:137], v6, s[8:11], 0 offen
    v_accvgpr_read_b32 v132, a188
    v_accvgpr_read_b32 v133, a189
    v_accvgpr_read_b32 v134, a190
    v_accvgpr_read_b32 v135, a191
    v_cvt_pk_bf16_f32 v136, v132, v133
    v_cvt_pk_bf16_f32 v137, v134, v135
    v_add_u32 v6, 1184800, v5
    buffer_store_dwordx2 v[136:137], v6, s[8:11], 0 offen
qkv_b_kernel_end:
    s_endpgm
.section .rodata,"a"
.p2align 6
.amdhsa_kernel qkv_b_kernel
  .amdhsa_next_free_vgpr 344
  .amdhsa_next_free_sgpr 64
  .amdhsa_accum_offset 152
  .amdhsa_group_segment_fixed_size 0
  .amdhsa_kernarg_size 104
  .amdhsa_user_sgpr_count 2
  .amdhsa_user_sgpr_kernarg_segment_ptr 1
  .amdhsa_system_sgpr_workgroup_id_x 1
.end_amdhsa_kernel
.text
.globl vvo_kernel
.p2align 8
.type vvo_kernel,@function
vvo_kernel:
    s_cmp_ge_u32 s2, 256
    s_cbranch_scc1 vvo_kernel_end
    s_load_dwordx2 s[4:5], s[0:1], 96
    v_and_b32 v1, 63, v0
    v_lshrrev_b32 v4, 6, v0
    v_and_b32 v2, 15, v1
    v_lshrrev_b32 v3, 4, v1
    v_readfirstlane_b32 s3, v4
    s_and_b32 s20, s2, 31
    s_lshr_b32 s21, s2, 5
    s_waitcnt lgkmcnt(0)
    s_mov_b32 s8, s4
    s_mov_b32 s9, s5
    s_mov_b32 s10, 268435456
    s_mov_b32 s11, 0x00020000
    s_lshl_b32 s22, s21, 8
    s_lshl_b32 s23, s3, 6
    s_add_u32 s22, s22, s23
    v_add_u32 v5, s22, v2
    v_mul_u32_u24 v5, 1280, v5
    v_lshl_add_u32 v5, v3, 4, v5
    v_add_u32 v5, 0, v5
    v_add_u32 v8, 0, v5
    v_add_u32 v9, 20480, v5
    v_add_u32 v10, 40960, v5
    v_add_u32 v11, 61440, v5
    v_lshrrev_b32 v5, 3, v2
    v_mul_u32_u24 v6, 20480, v5
    v_lshrrev_b32 v5, 2, v2
    v_and_b32 v5, 1, v5
    v_lshlrev_b32 v5, 3, v5
    v_and_b32 v7, 3, v2
    v_add_u32 v5, v5, v7
    v_lshl_add_u32 v5, v3, 4, v5
    v_lshl_add_u32 v6, v5, 4, v6
    s_mul_i32 s24, s20, 245760
    s_add_u32 s24, s24, 49283072
    s_add_u32 s32, s24, 0
    s_add_u32 s33, s24, 40960
    s_add_u32 s34, s24, 81920
    s_add_u32 s35, s24, 122880
    s_add_u32 s36, s24, 163840
    s_add_u32 s37, s24, 204800
    s_mov_b32 s25, 0
    v_accvgpr_write_b32 a0, 0
    v_accvgpr_write_b32 a1, 0
    v_accvgpr_write_b32 a2, 0
    v_accvgpr_write_b32 a3, 0
    v_accvgpr_write_b32 a4, 0
    v_accvgpr_write_b32 a5, 0
    v_accvgpr_write_b32 a6, 0
    v_accvgpr_write_b32 a7, 0
    v_accvgpr_write_b32 a8, 0
    v_accvgpr_write_b32 a9, 0
    v_accvgpr_write_b32 a10, 0
    v_accvgpr_write_b32 a11, 0
    v_accvgpr_write_b32 a12, 0
    v_accvgpr_write_b32 a13, 0
    v_accvgpr_write_b32 a14, 0
    v_accvgpr_write_b32 a15, 0
    v_accvgpr_write_b32 a16, 0
    v_accvgpr_write_b32 a17, 0
    v_accvgpr_write_b32 a18, 0
    v_accvgpr_write_b32 a19, 0
    v_accvgpr_write_b32 a20, 0
    v_accvgpr_write_b32 a21, 0
    v_accvgpr_write_b32 a22, 0
    v_accvgpr_write_b32 a23, 0
    v_accvgpr_write_b32 a24, 0
    v_accvgpr_write_b32 a25, 0
    v_accvgpr_write_b32 a26, 0
    v_accvgpr_write_b32 a27, 0
    v_accvgpr_write_b32 a28, 0
    v_accvgpr_write_b32 a29, 0
    v_accvgpr_write_b32 a30, 0
    v_accvgpr_write_b32 a31, 0
    v_accvgpr_write_b32 a32, 0
    v_accvgpr_write_b32 a33, 0
    v_accvgpr_write_b32 a34, 0
    v_accvgpr_write_b32 a35, 0
    v_accvgpr_write_b32 a36, 0
    v_accvgpr_write_b32 a37, 0
    v_accvgpr_write_b32 a38, 0
    v_accvgpr_write_b32 a39, 0
    v_accvgpr_write_b32 a40, 0
    v_accvgpr_write_b32 a41, 0
    v_accvgpr_write_b32 a42, 0
    v_accvgpr_write_b32 a43, 0
    v_accvgpr_write_b32 a44, 0
    v_accvgpr_write_b32 a45, 0
    v_accvgpr_write_b32 a46, 0
    v_accvgpr_write_b32 a47, 0
    v_accvgpr_write_b32 a48, 0
    v_accvgpr_write_b32 a49, 0
    v_accvgpr_write_b32 a50, 0
    v_accvgpr_write_b32 a51, 0
    v_accvgpr_write_b32 a52, 0
    v_accvgpr_write_b32 a53, 0
    v_accvgpr_write_b32 a54, 0
    v_accvgpr_write_b32 a55, 0
    v_accvgpr_write_b32 a56, 0
    v_accvgpr_write_b32 a57, 0
    v_accvgpr_write_b32 a58, 0
    v_accvgpr_write_b32 a59, 0
    v_accvgpr_write_b32 a60, 0
    v_accvgpr_write_b32 a61, 0
    v_accvgpr_write_b32 a62, 0
    v_accvgpr_write_b32 a63, 0
    v_accvgpr_write_b32 a64, 0
    v_accvgpr_write_b32 a65, 0
    v_accvgpr_write_b32 a66, 0
    v_accvgpr_write_b32 a67, 0
    v_accvgpr_write_b32 a68, 0
    v_accvgpr_write_b32 a69, 0
    v_accvgpr_write_b32 a70, 0
    v_accvgpr_write_b32 a71, 0
    v_accvgpr_write_b32 a72, 0
    v_accvgpr_write_b32 a73, 0
    v_accvgpr_write_b32 a74, 0
    v_accvgpr_write_b32 a75, 0
    v_accvgpr_write_b32 a76, 0
    v_accvgpr_write_b32 a77, 0
    v_accvgpr_write_b32 a78, 0
    v_accvgpr_write_b32 a79, 0
    v_accvgpr_write_b32 a80, 0
    v_accvgpr_write_b32 a81, 0
    v_accvgpr_write_b32 a82, 0
    v_accvgpr_write_b32 a83, 0
    v_accvgpr_write_b32 a84, 0
    v_accvgpr_write_b32 a85, 0
    v_accvgpr_write_b32 a86, 0
    v_accvgpr_write_b32 a87, 0
    v_accvgpr_write_b32 a88, 0
    v_accvgpr_write_b32 a89, 0
    v_accvgpr_write_b32 a90, 0
    v_accvgpr_write_b32 a91, 0
    v_accvgpr_write_b32 a92, 0
    v_accvgpr_write_b32 a93, 0
    v_accvgpr_write_b32 a94, 0
    v_accvgpr_write_b32 a95, 0
    v_accvgpr_write_b32 a96, 0
    v_accvgpr_write_b32 a97, 0
    v_accvgpr_write_b32 a98, 0
    v_accvgpr_write_b32 a99, 0
    v_accvgpr_write_b32 a100, 0
    v_accvgpr_write_b32 a101, 0
    v_accvgpr_write_b32 a102, 0
    v_accvgpr_write_b32 a103, 0
    v_accvgpr_write_b32 a104, 0
    v_accvgpr_write_b32 a105, 0
    v_accvgpr_write_b32 a106, 0
    v_accvgpr_write_b32 a107, 0
    v_accvgpr_write_b32 a108, 0
    v_accvgpr_write_b32 a109, 0
    v_accvgpr_write_b32 a110, 0
    v_accvgpr_write_b32 a111, 0
    v_accvgpr_write_b32 a112, 0
    v_accvgpr_write_b32 a113, 0
    v_accvgpr_write_b32 a114, 0
    v_accvgpr_write_b32 a115, 0
    v_accvgpr_write_b32 a116, 0
    v_accvgpr_write_b32 a117, 0
    v_accvgpr_write_b32 a118, 0
    v_accvgpr_write_b32 a119, 0
    v_accvgpr_write_b32 a120, 0
    v_accvgpr_write_b32 a121, 0
    v_accvgpr_write_b32 a122, 0
    v_accvgpr_write_b32 a123, 0
    v_accvgpr_write_b32 a124, 0
    v_accvgpr_write_b32 a125, 0
    v_accvgpr_write_b32 a126, 0
    v_accvgpr_write_b32 a127, 0
    v_accvgpr_write_b32 a128, 0
    v_accvgpr_write_b32 a129, 0
    v_accvgpr_write_b32 a130, 0
    v_accvgpr_write_b32 a131, 0
    v_accvgpr_write_b32 a132, 0
    v_accvgpr_write_b32 a133, 0
    v_accvgpr_write_b32 a134, 0
    v_accvgpr_write_b32 a135, 0
    v_accvgpr_write_b32 a136, 0
    v_accvgpr_write_b32 a137, 0
    v_accvgpr_write_b32 a138, 0
    v_accvgpr_write_b32 a139, 0
    v_accvgpr_write_b32 a140, 0
    v_accvgpr_write_b32 a141, 0
    v_accvgpr_write_b32 a142, 0
    v_accvgpr_write_b32 a143, 0
    v_accvgpr_write_b32 a144, 0
    v_accvgpr_write_b32 a145, 0
    v_accvgpr_write_b32 a146, 0
    v_accvgpr_write_b32 a147, 0
    v_accvgpr_write_b32 a148, 0
    v_accvgpr_write_b32 a149, 0
    v_accvgpr_write_b32 a150, 0
    v_accvgpr_write_b32 a151, 0
    v_accvgpr_write_b32 a152, 0
    v_accvgpr_write_b32 a153, 0
    v_accvgpr_write_b32 a154, 0
    v_accvgpr_write_b32 a155, 0
    v_accvgpr_write_b32 a156, 0
    v_accvgpr_write_b32 a157, 0
    v_accvgpr_write_b32 a158, 0
    v_accvgpr_write_b32 a159, 0
    v_accvgpr_write_b32 a160, 0
    v_accvgpr_write_b32 a161, 0
    v_accvgpr_write_b32 a162, 0
    v_accvgpr_write_b32 a163, 0
    v_accvgpr_write_b32 a164, 0
    v_accvgpr_write_b32 a165, 0
    v_accvgpr_write_b32 a166, 0
    v_accvgpr_write_b32 a167, 0
    v_accvgpr_write_b32 a168, 0
    v_accvgpr_write_b32 a169, 0
    v_accvgpr_write_b32 a170, 0
    v_accvgpr_write_b32 a171, 0
    v_accvgpr_write_b32 a172, 0
    v_accvgpr_write_b32 a173, 0
    v_accvgpr_write_b32 a174, 0
    v_accvgpr_write_b32 a175, 0
    v_accvgpr_write_b32 a176, 0
    v_accvgpr_write_b32 a177, 0
    v_accvgpr_write_b32 a178, 0
    v_accvgpr_write_b32 a179, 0
    v_accvgpr_write_b32 a180, 0
    v_accvgpr_write_b32 a181, 0
    v_accvgpr_write_b32 a182, 0
    v_accvgpr_write_b32 a183, 0
    v_accvgpr_write_b32 a184, 0
    v_accvgpr_write_b32 a185, 0
    v_accvgpr_write_b32 a186, 0
    v_accvgpr_write_b32 a187, 0
    v_accvgpr_write_b32 a188, 0
    v_accvgpr_write_b32 a189, 0
    v_accvgpr_write_b32 a190, 0
    v_accvgpr_write_b32 a191, 0
    buffer_load_dwordx4 v[16:19], v8, s[8:11], s25 offen
    buffer_load_dwordx4 v[20:23], v9, s[8:11], s25 offen
    buffer_load_dwordx4 v[24:27], v10, s[8:11], s25 offen
    buffer_load_dwordx4 v[28:31], v11, s[8:11], s25 offen
    buffer_load_dwordx4 v[48:51], v6, s[8:11], s32 offen offset:0
    buffer_load_dwordx4 v[52:55], v6, s[8:11], s32 offen offset:64
    buffer_load_dwordx4 v[56:59], v6, s[8:11], s33 offen offset:0
    buffer_load_dwordx4 v[60:63], v6, s[8:11], s33 offen offset:64
    buffer_load_dwordx4 v[64:67], v6, s[8:11], s34 offen offset:0
    buffer_load_dwordx4 v[68:71], v6, s[8:11], s34 offen offset:64
    buffer_load_dwordx4 v[72:75], v6, s[8:11], s35 offen offset:0
    buffer_load_dwordx4 v[76:79], v6, s[8:11], s35 offen offset:64
    buffer_load_dwordx4 v[80:83], v6, s[8:11], s36 offen offset:0
    buffer_load_dwordx4 v[84:87], v6, s[8:11], s36 offen offset:64
    buffer_load_dwordx4 v[88:91], v6, s[8:11], s37 offen offset:0
    buffer_load_dwordx4 v[92:95], v6, s[8:11], s37 offen offset:64
    s_mov_b32 s28, 10
vvo_kernel_l1:
    s_add_u32 s25, s25, 64
    s_add_u32 s32, s32, 1024
    s_add_u32 s33, s33, 1024
    s_add_u32 s34, s34, 1024
    s_add_u32 s35, s35, 1024
    s_add_u32 s36, s36, 1024
    s_add_u32 s37, s37, 1024
    buffer_load_dwordx4 v[32:35], v8, s[8:11], s25 offen
    buffer_load_dwordx4 v[36:39], v9, s[8:11], s25 offen
    buffer_load_dwordx4 v[40:43], v10, s[8:11], s25 offen
    buffer_load_dwordx4 v[44:47], v11, s[8:11], s25 offen
    buffer_load_dwordx4 v[96:99], v6, s[8:11], s32 offen offset:0
    buffer_load_dwordx4 v[100:103], v6, s[8:11], s32 offen offset:64
    buffer_load_dwordx4 v[104:107], v6, s[8:11], s33 offen offset:0
    buffer_load_dwordx4 v[108:111], v6, s[8:11], s33 offen offset:64
    buffer_load_dwordx4 v[112:115], v6, s[8:11], s34 offen offset:0
    buffer_load_dwordx4 v[116:119], v6, s[8:11], s34 offen offset:64
    buffer_load_dwordx4 v[120:123], v6, s[8:11], s35 offen offset:0
    buffer_load_dwordx4 v[124:127], v6, s[8:11], s35 offen offset:64
    buffer_load_dwordx4 v[128:131], v6, s[8:11], s36 offen offset:0
    buffer_load_dwordx4 v[132:135], v6, s[8:11], s36 offen offset:64
    buffer_load_dwordx4 v[136:139], v6, s[8:11], s37 offen offset:0
    buffer_load_dwordx4 v[140:143], v6, s[8:11], s37 offen offset:64
    s_waitcnt vmcnt(16)
    v_mfma_f32_16x16x32_bf16 a[0:3], v[48:51], v[16:19], a[0:3]
    v_mfma_f32_16x16x32_bf16 a[4:7], v[48:51], v[20:23], a[4:7]
    v_mfma_f32_16x16x32_bf16 a[8:11], v[48:51], v[24:27], a[8:11]
    v_mfma_f32_16x16x32_bf16 a[12:15], v[48:51], v[28:31], a[12:15]
    v_mfma_f32_16x16x32_bf16 a[16:19], v[52:55], v[16:19], a[16:19]
    v_mfma_f32_16x16x32_bf16 a[20:23], v[52:55], v[20:23], a[20:23]
    v_mfma_f32_16x16x32_bf16 a[24:27], v[52:55], v[24:27], a[24:27]
    v_mfma_f32_16x16x32_bf16 a[28:31], v[52:55], v[28:31], a[28:31]
    v_mfma_f32_16x16x32_bf16 a[32:35], v[56:59], v[16:19], a[32:35]
    v_mfma_f32_16x16x32_bf16 a[36:39], v[56:59], v[20:23], a[36:39]
    v_mfma_f32_16x16x32_bf16 a[40:43], v[56:59], v[24:27], a[40:43]
    v_mfma_f32_16x16x32_bf16 a[44:47], v[56:59], v[28:31], a[44:47]
    v_mfma_f32_16x16x32_bf16 a[48:51], v[60:63], v[16:19], a[48:51]
    v_mfma_f32_16x16x32_bf16 a[52:55], v[60:63], v[20:23], a[52:55]
    v_mfma_f32_16x16x32_bf16 a[56:59], v[60:63], v[24:27], a[56:59]
    v_mfma_f32_16x16x32_bf16 a[60:63], v[60:63], v[28:31], a[60:63]
    v_mfma_f32_16x16x32_bf16 a[64:67], v[64:67], v[16:19], a[64:67]
    v_mfma_f32_16x16x32_bf16 a[68:71], v[64:67], v[20:23], a[68:71]
    v_mfma_f32_16x16x32_bf16 a[72:75], v[64:67], v[24:27], a[72:75]
    v_mfma_f32_16x16x32_bf16 a[76:79], v[64:67], v[28:31], a[76:79]
    v_mfma_f32_16x16x32_bf16 a[80:83], v[68:71], v[16:19], a[80:83]
    v_mfma_f32_16x16x32_bf16 a[84:87], v[68:71], v[20:23], a[84:87]
    v_mfma_f32_16x16x32_bf16 a[88:91], v[68:71], v[24:27], a[88:91]
    v_mfma_f32_16x16x32_bf16 a[92:95], v[68:71], v[28:31], a[92:95]
    v_mfma_f32_16x16x32_bf16 a[96:99], v[72:75], v[16:19], a[96:99]
    v_mfma_f32_16x16x32_bf16 a[100:103], v[72:75], v[20:23], a[100:103]
    v_mfma_f32_16x16x32_bf16 a[104:107], v[72:75], v[24:27], a[104:107]
    v_mfma_f32_16x16x32_bf16 a[108:111], v[72:75], v[28:31], a[108:111]
    v_mfma_f32_16x16x32_bf16 a[112:115], v[76:79], v[16:19], a[112:115]
    v_mfma_f32_16x16x32_bf16 a[116:119], v[76:79], v[20:23], a[116:119]
    v_mfma_f32_16x16x32_bf16 a[120:123], v[76:79], v[24:27], a[120:123]
    v_mfma_f32_16x16x32_bf16 a[124:127], v[76:79], v[28:31], a[124:127]
    v_mfma_f32_16x16x32_bf16 a[128:131], v[80:83], v[16:19], a[128:131]
    v_mfma_f32_16x16x32_bf16 a[132:135], v[80:83], v[20:23], a[132:135]
    v_mfma_f32_16x16x32_bf16 a[136:139], v[80:83], v[24:27], a[136:139]
    v_mfma_f32_16x16x32_bf16 a[140:143], v[80:83], v[28:31], a[140:143]
    v_mfma_f32_16x16x32_bf16 a[144:147], v[84:87], v[16:19], a[144:147]
    v_mfma_f32_16x16x32_bf16 a[148:151], v[84:87], v[20:23], a[148:151]
    v_mfma_f32_16x16x32_bf16 a[152:155], v[84:87], v[24:27], a[152:155]
    v_mfma_f32_16x16x32_bf16 a[156:159], v[84:87], v[28:31], a[156:159]
    v_mfma_f32_16x16x32_bf16 a[160:163], v[88:91], v[16:19], a[160:163]
    v_mfma_f32_16x16x32_bf16 a[164:167], v[88:91], v[20:23], a[164:167]
    v_mfma_f32_16x16x32_bf16 a[168:171], v[88:91], v[24:27], a[168:171]
    v_mfma_f32_16x16x32_bf16 a[172:175], v[88:91], v[28:31], a[172:175]
    v_mfma_f32_16x16x32_bf16 a[176:179], v[92:95], v[16:19], a[176:179]
    v_mfma_f32_16x16x32_bf16 a[180:183], v[92:95], v[20:23], a[180:183]
    v_mfma_f32_16x16x32_bf16 a[184:187], v[92:95], v[24:27], a[184:187]
    v_mfma_f32_16x16x32_bf16 a[188:191], v[92:95], v[28:31], a[188:191]
    s_sub_u32 s28, s28, 1
    s_cmp_eq_u32 s28, 0
    s_cbranch_scc1 vvo_kernel_l1e
    s_add_u32 s25, s25, 64
    s_add_u32 s32, s32, 1024
    s_add_u32 s33, s33, 1024
    s_add_u32 s34, s34, 1024
    s_add_u32 s35, s35, 1024
    s_add_u32 s36, s36, 1024
    s_add_u32 s37, s37, 1024
    buffer_load_dwordx4 v[16:19], v8, s[8:11], s25 offen
    buffer_load_dwordx4 v[20:23], v9, s[8:11], s25 offen
    buffer_load_dwordx4 v[24:27], v10, s[8:11], s25 offen
    buffer_load_dwordx4 v[28:31], v11, s[8:11], s25 offen
    buffer_load_dwordx4 v[48:51], v6, s[8:11], s32 offen offset:0
    buffer_load_dwordx4 v[52:55], v6, s[8:11], s32 offen offset:64
    buffer_load_dwordx4 v[56:59], v6, s[8:11], s33 offen offset:0
    buffer_load_dwordx4 v[60:63], v6, s[8:11], s33 offen offset:64
    buffer_load_dwordx4 v[64:67], v6, s[8:11], s34 offen offset:0
    buffer_load_dwordx4 v[68:71], v6, s[8:11], s34 offen offset:64
    buffer_load_dwordx4 v[72:75], v6, s[8:11], s35 offen offset:0
    buffer_load_dwordx4 v[76:79], v6, s[8:11], s35 offen offset:64
    buffer_load_dwordx4 v[80:83], v6, s[8:11], s36 offen offset:0
    buffer_load_dwordx4 v[84:87], v6, s[8:11], s36 offen offset:64
    buffer_load_dwordx4 v[88:91], v6, s[8:11], s37 offen offset:0
    buffer_load_dwordx4 v[92:95], v6, s[8:11], s37 offen offset:64
    s_waitcnt vmcnt(16)
    v_mfma_f32_16x16x32_bf16 a[0:3], v[96:99], v[32:35], a[0:3]
    v_mfma_f32_16x16x32_bf16 a[4:7], v[96:99], v[36:39], a[4:7]
    v_mfma_f32_16x16x32_bf16 a[8:11], v[96:99], v[40:43], a[8:11]
    v_mfma_f32_16x16x32_bf16 a[12:15], v[96:99], v[44:47], a[12:15]
    v_mfma_f32_16x16x32_bf16 a[16:19], v[100:103], v[32:35], a[16:19]
    v_mfma_f32_16x16x32_bf16 a[20:23], v[100:103], v[36:39], a[20:23]
    v_mfma_f32_16x16x32_bf16 a[24:27], v[100:103], v[40:43], a[24:27]
    v_mfma_f32_16x16x32_bf16 a[28:31], v[100:103], v[44:47], a[28:31]
    v_mfma_f32_16x16x32_bf16 a[32:35], v[104:107], v[32:35], a[32:35]
    v_mfma_f32_16x16x32_bf16 a[36:39], v[104:107], v[36:39], a[36:39]
    v_mfma_f32_16x16x32_bf16 a[40:43], v[104:107], v[40:43], a[40:43]
    v_mfma_f32_16x16x32_bf16 a[44:47], v[104:107], v[44:47], a[44:47]
    v_mfma_f32_16x16x32_bf16 a[48:51], v[108:111], v[32:35], a[48:51]
    v_mfma_f32_16x16x32_bf16 a[52:55], v[108:111], v[36:39], a[52:55]
    v_mfma_f32_16x16x32_bf16 a[56:59], v[108:111], v[40:43], a[56:59]
    v_mfma_f32_16x16x32_bf16 a[60:63], v[108:111], v[44:47], a[60:63]
    v_mfma_f32_16x16x32_bf16 a[64:67], v[112:115], v[32:35], a[64:67]
    v_mfma_f32_16x16x32_bf16 a[68:71], v[112:115], v[36:39], a[68:71]
    v_mfma_f32_16x16x32_bf16 a[72:75], v[112:115], v[40:43], a[72:75]
    v_mfma_f32_16x16x32_bf16 a[76:79], v[112:115], v[44:47], a[76:79]
    v_mfma_f32_16x16x32_bf16 a[80:83], v[116:119], v[32:35], a[80:83]
    v_mfma_f32_16x16x32_bf16 a[84:87], v[116:119], v[36:39], a[84:87]
    v_mfma_f32_16x16x32_bf16 a[88:91], v[116:119], v[40:43], a[88:91]
    v_mfma_f32_16x16x32_bf16 a[92:95], v[116:119], v[44:47], a[92:95]
    v_mfma_f32_16x16x32_bf16 a[96:99], v[120:123], v[32:35], a[96:99]
    v_mfma_f32_16x16x32_bf16 a[100:103], v[120:123], v[36:39], a[100:103]
    v_mfma_f32_16x16x32_bf16 a[104:107], v[120:123], v[40:43], a[104:107]
    v_mfma_f32_16x16x32_bf16 a[108:111], v[120:123], v[44:47], a[108:111]
    v_mfma_f32_16x16x32_bf16 a[112:115], v[124:127], v[32:35], a[112:115]
    v_mfma_f32_16x16x32_bf16 a[116:119], v[124:127], v[36:39], a[116:119]
    v_mfma_f32_16x16x32_bf16 a[120:123], v[124:127], v[40:43], a[120:123]
    v_mfma_f32_16x16x32_bf16 a[124:127], v[124:127], v[44:47], a[124:127]
    v_mfma_f32_16x16x32_bf16 a[128:131], v[128:131], v[32:35], a[128:131]
    v_mfma_f32_16x16x32_bf16 a[132:135], v[128:131], v[36:39], a[132:135]
    v_mfma_f32_16x16x32_bf16 a[136:139], v[128:131], v[40:43], a[136:139]
    v_mfma_f32_16x16x32_bf16 a[140:143], v[128:131], v[44:47], a[140:143]
    v_mfma_f32_16x16x32_bf16 a[144:147], v[132:135], v[32:35], a[144:147]
    v_mfma_f32_16x16x32_bf16 a[148:151], v[132:135], v[36:39], a[148:151]
    v_mfma_f32_16x16x32_bf16 a[152:155], v[132:135], v[40:43], a[152:155]
    v_mfma_f32_16x16x32_bf16 a[156:159], v[132:135], v[44:47], a[156:159]
    v_mfma_f32_16x16x32_bf16 a[160:163], v[136:139], v[32:35], a[160:163]
    v_mfma_f32_16x16x32_bf16 a[164:167], v[136:139], v[36:39], a[164:167]
    v_mfma_f32_16x16x32_bf16 a[168:171], v[136:139], v[40:43], a[168:171]
    v_mfma_f32_16x16x32_bf16 a[172:175], v[136:139], v[44:47], a[172:175]
    v_mfma_f32_16x16x32_bf16 a[176:179], v[140:143], v[32:35], a[176:179]
    v_mfma_f32_16x16x32_bf16 a[180:183], v[140:143], v[36:39], a[180:183]
    v_mfma_f32_16x16x32_bf16 a[184:187], v[140:143], v[40:43], a[184:187]
    v_mfma_f32_16x16x32_bf16 a[188:191], v[140:143], v[44:47], a[188:191]
    s_branch vvo_kernel_l1
vvo_kernel_l1e:
    s_waitcnt vmcnt(0)
    v_mfma_f32_16x16x32_bf16 a[0:3], v[96:99], v[32:35], a[0:3]
    v_mfma_f32_16x16x32_bf16 a[4:7], v[96:99], v[36:39], a[4:7]
    v_mfma_f32_16x16x32_bf16 a[8:11], v[96:99], v[40:43], a[8:11]
    v_mfma_f32_16x16x32_bf16 a[12:15], v[96:99], v[44:47], a[12:15]
    v_mfma_f32_16x16x32_bf16 a[16:19], v[100:103], v[32:35], a[16:19]
    v_mfma_f32_16x16x32_bf16 a[20:23], v[100:103], v[36:39], a[20:23]
    v_mfma_f32_16x16x32_bf16 a[24:27], v[100:103], v[40:43], a[24:27]
    v_mfma_f32_16x16x32_bf16 a[28:31], v[100:103], v[44:47], a[28:31]
    v_mfma_f32_16x16x32_bf16 a[32:35], v[104:107], v[32:35], a[32:35]
    v_mfma_f32_16x16x32_bf16 a[36:39], v[104:107], v[36:39], a[36:39]
    v_mfma_f32_16x16x32_bf16 a[40:43], v[104:107], v[40:43], a[40:43]
    v_mfma_f32_16x16x32_bf16 a[44:47], v[104:107], v[44:47], a[44:47]
    v_mfma_f32_16x16x32_bf16 a[48:51], v[108:111], v[32:35], a[48:51]
    v_mfma_f32_16x16x32_bf16 a[52:55], v[108:111], v[36:39], a[52:55]
    v_mfma_f32_16x16x32_bf16 a[56:59], v[108:111], v[40:43], a[56:59]
    v_mfma_f32_16x16x32_bf16 a[60:63], v[108:111], v[44:47], a[60:63]
    v_mfma_f32_16x16x32_bf16 a[64:67], v[112:115], v[32:35], a[64:67]
    v_mfma_f32_16x16x32_bf16 a[68:71], v[112:115], v[36:39], a[68:71]
    v_mfma_f32_16x16x32_bf16 a[72:75], v[112:115], v[40:43], a[72:75]
    v_mfma_f32_16x16x32_bf16 a[76:79], v[112:115], v[44:47], a[76:79]
    v_mfma_f32_16x16x32_bf16 a[80:83], v[116:119], v[32:35], a[80:83]
    v_mfma_f32_16x16x32_bf16 a[84:87], v[116:119], v[36:39], a[84:87]
    v_mfma_f32_16x16x32_bf16 a[88:91], v[116:119], v[40:43], a[88:91]
    v_mfma_f32_16x16x32_bf16 a[92:95], v[116:119], v[44:47], a[92:95]
    v_mfma_f32_16x16x32_bf16 a[96:99], v[120:123], v[32:35], a[96:99]
    v_mfma_f32_16x16x32_bf16 a[100:103], v[120:123], v[36:39], a[100:103]
    v_mfma_f32_16x16x32_bf16 a[104:107], v[120:123], v[40:43], a[104:107]
    v_mfma_f32_16x16x32_bf16 a[108:111], v[120:123], v[44:47], a[108:111]
    v_mfma_f32_16x16x32_bf16 a[112:115], v[124:127], v[32:35], a[112:115]
    v_mfma_f32_16x16x32_bf16 a[116:119], v[124:127], v[36:39], a[116:119]
    v_mfma_f32_16x16x32_bf16 a[120:123], v[124:127], v[40:43], a[120:123]
    v_mfma_f32_16x16x32_bf16 a[124:127], v[124:127], v[44:47], a[124:127]
    v_mfma_f32_16x16x32_bf16 a[128:131], v[128:131], v[32:35], a[128:131]
    v_mfma_f32_16x16x32_bf16 a[132:135], v[128:131], v[36:39], a[132:135]
    v_mfma_f32_16x16x32_bf16 a[136:139], v[128:131], v[40:43], a[136:139]
    v_mfma_f32_16x16x32_bf16 a[140:143], v[128:131], v[44:47], a[140:143]
    v_mfma_f32_16x16x32_bf16 a[144:147], v[132:135], v[32:35], a[144:147]
    v_mfma_f32_16x16x32_bf16 a[148:151], v[132:135], v[36:39], a[148:151]
    v_mfma_f32_16x16x32_bf16 a[152:155], v[132:135], v[40:43], a[152:155]
    v_mfma_f32_16x16x32_bf16 a[156:159], v[132:135], v[44:47], a[156:159]
    v_mfma_f32_16x16x32_bf16 a[160:163], v[136:139], v[32:35], a[160:163]
    v_mfma_f32_16x16x32_bf16 a[164:167], v[136:139], v[36:39], a[164:167]
    v_mfma_f32_16x16x32_bf16 a[168:171], v[136:139], v[40:43], a[168:171]
    v_mfma_f32_16x16x32_bf16 a[172:175], v[136:139], v[44:47], a[172:175]
    v_mfma_f32_16x16x32_bf16 a[176:179], v[140:143], v[32:35], a[176:179]
    v_mfma_f32_16x16x32_bf16 a[180:183], v[140:143], v[36:39], a[180:183]
    v_mfma_f32_16x16x32_bf16 a[184:187], v[140:143], v[40:43], a[184:187]
    v_mfma_f32_16x16x32_bf16 a[188:191], v[140:143], v[44:47], a[188:191]
    v_accvgpr_read_b32 v16, a0
    v_accvgpr_read_b32 v17, a1
    v_accvgpr_read_b32 v18, a2
    v_accvgpr_read_b32 v19, a3
    v_cvt_pk_bf16_f32 v144, v16, v17
    v_cvt_pk_bf16_f32 v145, v18, v19
    v_accvgpr_read_b32 v16, a16
    v_accvgpr_read_b32 v17, a17
    v_accvgpr_read_b32 v18, a18
    v_accvgpr_read_b32 v19, a19
    v_cvt_pk_bf16_f32 v146, v16, v17
    v_cvt_pk_bf16_f32 v147, v18, v19
    v_accvgpr_read_b32 v16, a4
    v_accvgpr_read_b32 v17, a5
    v_accvgpr_read_b32 v18, a6
    v_accvgpr_read_b32 v19, a7
    v_cvt_pk_bf16_f32 v148, v16, v17
    v_cvt_pk_bf16_f32 v149, v18, v19
    v_accvgpr_read_b32 v16, a20
    v_accvgpr_read_b32 v17, a21
    v_accvgpr_read_b32 v18, a22
    v_accvgpr_read_b32 v19, a23
    v_cvt_pk_bf16_f32 v150, v16, v17
    v_cvt_pk_bf16_f32 v151, v18, v19
    v_accvgpr_read_b32 v16, a8
    v_accvgpr_read_b32 v17, a9
    v_accvgpr_read_b32 v18, a10
    v_accvgpr_read_b32 v19, a11
    v_cvt_pk_bf16_f32 v152, v16, v17
    v_cvt_pk_bf16_f32 v153, v18, v19
    v_accvgpr_read_b32 v16, a24
    v_accvgpr_read_b32 v17, a25
    v_accvgpr_read_b32 v18, a26
    v_accvgpr_read_b32 v19, a27
    v_cvt_pk_bf16_f32 v154, v16, v17
    v_cvt_pk_bf16_f32 v155, v18, v19
    v_accvgpr_read_b32 v16, a12
    v_accvgpr_read_b32 v17, a13
    v_accvgpr_read_b32 v18, a14
    v_accvgpr_read_b32 v19, a15
    v_cvt_pk_bf16_f32 v156, v16, v17
    v_cvt_pk_bf16_f32 v157, v18, v19
    v_accvgpr_read_b32 v16, a28
    v_accvgpr_read_b32 v17, a29
    v_accvgpr_read_b32 v18, a30
    v_accvgpr_read_b32 v19, a31
    v_cvt_pk_bf16_f32 v158, v16, v17
    v_cvt_pk_bf16_f32 v159, v18, v19
    v_accvgpr_read_b32 v16, a32
    v_accvgpr_read_b32 v17, a33
    v_accvgpr_read_b32 v18, a34
    v_accvgpr_read_b32 v19, a35
    v_cvt_pk_bf16_f32 v160, v16, v17
    v_cvt_pk_bf16_f32 v161, v18, v19
    v_accvgpr_read_b32 v16, a48
    v_accvgpr_read_b32 v17, a49
    v_accvgpr_read_b32 v18, a50
    v_accvgpr_read_b32 v19, a51
    v_cvt_pk_bf16_f32 v162, v16, v17
    v_cvt_pk_bf16_f32 v163, v18, v19
    v_accvgpr_read_b32 v16, a36
    v_accvgpr_read_b32 v17, a37
    v_accvgpr_read_b32 v18, a38
    v_accvgpr_read_b32 v19, a39
    v_cvt_pk_bf16_f32 v164, v16, v17
    v_cvt_pk_bf16_f32 v165, v18, v19
    v_accvgpr_read_b32 v16, a52
    v_accvgpr_read_b32 v17, a53
    v_accvgpr_read_b32 v18, a54
    v_accvgpr_read_b32 v19, a55
    v_cvt_pk_bf16_f32 v166, v16, v17
    v_cvt_pk_bf16_f32 v167, v18, v19
    v_accvgpr_read_b32 v16, a40
    v_accvgpr_read_b32 v17, a41
    v_accvgpr_read_b32 v18, a42
    v_accvgpr_read_b32 v19, a43
    v_cvt_pk_bf16_f32 v168, v16, v17
    v_cvt_pk_bf16_f32 v169, v18, v19
    v_accvgpr_read_b32 v16, a56
    v_accvgpr_read_b32 v17, a57
    v_accvgpr_read_b32 v18, a58
    v_accvgpr_read_b32 v19, a59
    v_cvt_pk_bf16_f32 v170, v16, v17
    v_cvt_pk_bf16_f32 v171, v18, v19
    v_accvgpr_read_b32 v16, a44
    v_accvgpr_read_b32 v17, a45
    v_accvgpr_read_b32 v18, a46
    v_accvgpr_read_b32 v19, a47
    v_cvt_pk_bf16_f32 v172, v16, v17
    v_cvt_pk_bf16_f32 v173, v18, v19
    v_accvgpr_read_b32 v16, a60
    v_accvgpr_read_b32 v17, a61
    v_accvgpr_read_b32 v18, a62
    v_accvgpr_read_b32 v19, a63
    v_cvt_pk_bf16_f32 v174, v16, v17
    v_cvt_pk_bf16_f32 v175, v18, v19
    v_accvgpr_read_b32 v16, a64
    v_accvgpr_read_b32 v17, a65
    v_accvgpr_read_b32 v18, a66
    v_accvgpr_read_b32 v19, a67
    v_cvt_pk_bf16_f32 v176, v16, v17
    v_cvt_pk_bf16_f32 v177, v18, v19
    v_accvgpr_read_b32 v16, a80
    v_accvgpr_read_b32 v17, a81
    v_accvgpr_read_b32 v18, a82
    v_accvgpr_read_b32 v19, a83
    v_cvt_pk_bf16_f32 v178, v16, v17
    v_cvt_pk_bf16_f32 v179, v18, v19
    v_accvgpr_read_b32 v16, a68
    v_accvgpr_read_b32 v17, a69
    v_accvgpr_read_b32 v18, a70
    v_accvgpr_read_b32 v19, a71
    v_cvt_pk_bf16_f32 v180, v16, v17
    v_cvt_pk_bf16_f32 v181, v18, v19
    v_accvgpr_read_b32 v16, a84
    v_accvgpr_read_b32 v17, a85
    v_accvgpr_read_b32 v18, a86
    v_accvgpr_read_b32 v19, a87
    v_cvt_pk_bf16_f32 v182, v16, v17
    v_cvt_pk_bf16_f32 v183, v18, v19
    v_accvgpr_read_b32 v16, a72
    v_accvgpr_read_b32 v17, a73
    v_accvgpr_read_b32 v18, a74
    v_accvgpr_read_b32 v19, a75
    v_cvt_pk_bf16_f32 v184, v16, v17
    v_cvt_pk_bf16_f32 v185, v18, v19
    v_accvgpr_read_b32 v16, a88
    v_accvgpr_read_b32 v17, a89
    v_accvgpr_read_b32 v18, a90
    v_accvgpr_read_b32 v19, a91
    v_cvt_pk_bf16_f32 v186, v16, v17
    v_cvt_pk_bf16_f32 v187, v18, v19
    v_accvgpr_read_b32 v16, a76
    v_accvgpr_read_b32 v17, a77
    v_accvgpr_read_b32 v18, a78
    v_accvgpr_read_b32 v19, a79
    v_cvt_pk_bf16_f32 v188, v16, v17
    v_cvt_pk_bf16_f32 v189, v18, v19
    v_accvgpr_read_b32 v16, a92
    v_accvgpr_read_b32 v17, a93
    v_accvgpr_read_b32 v18, a94
    v_accvgpr_read_b32 v19, a95
    v_cvt_pk_bf16_f32 v190, v16, v17
    v_cvt_pk_bf16_f32 v191, v18, v19
    v_accvgpr_read_b32 v16, a96
    v_accvgpr_read_b32 v17, a97
    v_accvgpr_read_b32 v18, a98
    v_accvgpr_read_b32 v19, a99
    v_cvt_pk_bf16_f32 v192, v16, v17
    v_cvt_pk_bf16_f32 v193, v18, v19
    v_accvgpr_read_b32 v16, a112
    v_accvgpr_read_b32 v17, a113
    v_accvgpr_read_b32 v18, a114
    v_accvgpr_read_b32 v19, a115
    v_cvt_pk_bf16_f32 v194, v16, v17
    v_cvt_pk_bf16_f32 v195, v18, v19
    v_accvgpr_read_b32 v16, a100
    v_accvgpr_read_b32 v17, a101
    v_accvgpr_read_b32 v18, a102
    v_accvgpr_read_b32 v19, a103
    v_cvt_pk_bf16_f32 v196, v16, v17
    v_cvt_pk_bf16_f32 v197, v18, v19
    v_accvgpr_read_b32 v16, a116
    v_accvgpr_read_b32 v17, a117
    v_accvgpr_read_b32 v18, a118
    v_accvgpr_read_b32 v19, a119
    v_cvt_pk_bf16_f32 v198, v16, v17
    v_cvt_pk_bf16_f32 v199, v18, v19
    v_accvgpr_read_b32 v16, a104
    v_accvgpr_read_b32 v17, a105
    v_accvgpr_read_b32 v18, a106
    v_accvgpr_read_b32 v19, a107
    v_cvt_pk_bf16_f32 v200, v16, v17
    v_cvt_pk_bf16_f32 v201, v18, v19
    v_accvgpr_read_b32 v16, a120
    v_accvgpr_read_b32 v17, a121
    v_accvgpr_read_b32 v18, a122
    v_accvgpr_read_b32 v19, a123
    v_cvt_pk_bf16_f32 v202, v16, v17
    v_cvt_pk_bf16_f32 v203, v18, v19
    v_accvgpr_read_b32 v16, a108
    v_accvgpr_read_b32 v17, a109
    v_accvgpr_read_b32 v18, a110
    v_accvgpr_read_b32 v19, a111
    v_cvt_pk_bf16_f32 v204, v16, v17
    v_cvt_pk_bf16_f32 v205, v18, v19
    v_accvgpr_read_b32 v16, a124
    v_accvgpr_read_b32 v17, a125
    v_accvgpr_read_b32 v18, a126
    v_accvgpr_read_b32 v19, a127
    v_cvt_pk_bf16_f32 v206, v16, v17
    v_cvt_pk_bf16_f32 v207, v18, v19
    v_accvgpr_read_b32 v16, a128
    v_accvgpr_read_b32 v17, a129
    v_accvgpr_read_b32 v18, a130
    v_accvgpr_read_b32 v19, a131
    v_cvt_pk_bf16_f32 v208, v16, v17
    v_cvt_pk_bf16_f32 v209, v18, v19
    v_accvgpr_read_b32 v16, a144
    v_accvgpr_read_b32 v17, a145
    v_accvgpr_read_b32 v18, a146
    v_accvgpr_read_b32 v19, a147
    v_cvt_pk_bf16_f32 v210, v16, v17
    v_cvt_pk_bf16_f32 v211, v18, v19
    v_accvgpr_read_b32 v16, a132
    v_accvgpr_read_b32 v17, a133
    v_accvgpr_read_b32 v18, a134
    v_accvgpr_read_b32 v19, a135
    v_cvt_pk_bf16_f32 v212, v16, v17
    v_cvt_pk_bf16_f32 v213, v18, v19
    v_accvgpr_read_b32 v16, a148
    v_accvgpr_read_b32 v17, a149
    v_accvgpr_read_b32 v18, a150
    v_accvgpr_read_b32 v19, a151
    v_cvt_pk_bf16_f32 v214, v16, v17
    v_cvt_pk_bf16_f32 v215, v18, v19
    v_accvgpr_read_b32 v16, a136
    v_accvgpr_read_b32 v17, a137
    v_accvgpr_read_b32 v18, a138
    v_accvgpr_read_b32 v19, a139
    v_cvt_pk_bf16_f32 v216, v16, v17
    v_cvt_pk_bf16_f32 v217, v18, v19
    v_accvgpr_read_b32 v16, a152
    v_accvgpr_read_b32 v17, a153
    v_accvgpr_read_b32 v18, a154
    v_accvgpr_read_b32 v19, a155
    v_cvt_pk_bf16_f32 v218, v16, v17
    v_cvt_pk_bf16_f32 v219, v18, v19
    v_accvgpr_read_b32 v16, a140
    v_accvgpr_read_b32 v17, a141
    v_accvgpr_read_b32 v18, a142
    v_accvgpr_read_b32 v19, a143
    v_cvt_pk_bf16_f32 v220, v16, v17
    v_cvt_pk_bf16_f32 v221, v18, v19
    v_accvgpr_read_b32 v16, a156
    v_accvgpr_read_b32 v17, a157
    v_accvgpr_read_b32 v18, a158
    v_accvgpr_read_b32 v19, a159
    v_cvt_pk_bf16_f32 v222, v16, v17
    v_cvt_pk_bf16_f32 v223, v18, v19
    v_accvgpr_read_b32 v16, a160
    v_accvgpr_read_b32 v17, a161
    v_accvgpr_read_b32 v18, a162
    v_accvgpr_read_b32 v19, a163
    v_cvt_pk_bf16_f32 v224, v16, v17
    v_cvt_pk_bf16_f32 v225, v18, v19
    v_accvgpr_read_b32 v16, a176
    v_accvgpr_read_b32 v17, a177
    v_accvgpr_read_b32 v18, a178
    v_accvgpr_read_b32 v19, a179
    v_cvt_pk_bf16_f32 v226, v16, v17
    v_cvt_pk_bf16_f32 v227, v18, v19
    v_accvgpr_read_b32 v16, a164
    v_accvgpr_read_b32 v17, a165
    v_accvgpr_read_b32 v18, a166
    v_accvgpr_read_b32 v19, a167
    v_cvt_pk_bf16_f32 v228, v16, v17
    v_cvt_pk_bf16_f32 v229, v18, v19
    v_accvgpr_read_b32 v16, a180
    v_accvgpr_read_b32 v17, a181
    v_accvgpr_read_b32 v18, a182
    v_accvgpr_read_b32 v19, a183
    v_cvt_pk_bf16_f32 v230, v16, v17
    v_cvt_pk_bf16_f32 v231, v18, v19
    v_accvgpr_read_b32 v16, a168
    v_accvgpr_read_b32 v17, a169
    v_accvgpr_read_b32 v18, a170
    v_accvgpr_read_b32 v19, a171
    v_cvt_pk_bf16_f32 v232, v16, v17
    v_cvt_pk_bf16_f32 v233, v18, v19
    v_accvgpr_read_b32 v16, a184
    v_accvgpr_read_b32 v17, a185
    v_accvgpr_read_b32 v18, a186
    v_accvgpr_read_b32 v19, a187
    v_cvt_pk_bf16_f32 v234, v16, v17
    v_cvt_pk_bf16_f32 v235, v18, v19
    v_accvgpr_read_b32 v16, a172
    v_accvgpr_read_b32 v17, a173
    v_accvgpr_read_b32 v18, a174
    v_accvgpr_read_b32 v19, a175
    v_cvt_pk_bf16_f32 v236, v16, v17
    v_cvt_pk_bf16_f32 v237, v18, v19
    v_accvgpr_read_b32 v16, a188
    v_accvgpr_read_b32 v17, a189
    v_accvgpr_read_b32 v18, a190
    v_accvgpr_read_b32 v19, a191
    v_cvt_pk_bf16_f32 v238, v16, v17
    v_cvt_pk_bf16_f32 v239, v18, v19
    v_lshlrev_b32 v5, 4, v1
    s_mul_i32 s24, s20, 6144
    s_add_u32 s24, s24, 58720256
    s_lshl_b32 s26, s21, 3
    s_lshl_b32 s27, s3, 1
    s_add_u32 s26, s26, s27
    s_mul_i32 s26, s26, 1310720
    s_lshl_b32 s27, s20, 10
    s_add_u32 s26, s26, s27
    s_add_u32 s26, s26, 184549376
    s_add_u32 s27, s26, 1310720
    s_add_u32 s29, s24, 4096
    buffer_load_dwordx4 v[16:19], v5, s[8:11], s24 offen offset:0
    buffer_load_dwordx4 v[20:23], v5, s[8:11], s24 offen offset:1024
    buffer_load_dwordx4 v[24:27], v5, s[8:11], s24 offen offset:2048
    buffer_load_dwordx4 v[28:31], v5, s[8:11], s24 offen offset:3072
    buffer_load_dwordx4 v[32:35], v5, s[8:11], s29 offen offset:0
    buffer_load_dwordx4 v[36:39], v5, s[8:11], s29 offen offset:1024
    s_add_u32 s24, s24, 196608
    s_mov_b32 s28, 20
vvo_kernel_l2:
    s_add_u32 s29, s24, 4096
    buffer_load_dwordx4 v[40:43], v5, s[8:11], s24 offen offset:0
    buffer_load_dwordx4 v[44:47], v5, s[8:11], s24 offen offset:1024
    buffer_load_dwordx4 v[48:51], v5, s[8:11], s24 offen offset:2048
    buffer_load_dwordx4 v[52:55], v5, s[8:11], s24 offen offset:3072
    buffer_load_dwordx4 v[56:59], v5, s[8:11], s29 offen offset:0
    buffer_load_dwordx4 v[60:63], v5, s[8:11], s29 offen offset:1024
    s_add_u32 s24, s24, 196608
    s_waitcnt vmcnt(6)
    v_mfma_f32_16x16x32_bf16 v[64:67], v[144:147], v[16:19], 0
    v_mfma_f32_16x16x32_bf16 v[68:71], v[148:151], v[16:19], 0
    v_mfma_f32_16x16x32_bf16 v[72:75], v[152:155], v[16:19], 0
    v_mfma_f32_16x16x32_bf16 v[76:79], v[156:159], v[16:19], 0
    v_mfma_f32_16x16x32_bf16 v[64:67], v[160:163], v[20:23], v[64:67]
    v_mfma_f32_16x16x32_bf16 v[68:71], v[164:167], v[20:23], v[68:71]
    v_mfma_f32_16x16x32_bf16 v[72:75], v[168:171], v[20:23], v[72:75]
    v_mfma_f32_16x16x32_bf16 v[76:79], v[172:175], v[20:23], v[76:79]
    v_mfma_f32_16x16x32_bf16 v[64:67], v[176:179], v[24:27], v[64:67]
    v_mfma_f32_16x16x32_bf16 v[68:71], v[180:183], v[24:27], v[68:71]
    v_mfma_f32_16x16x32_bf16 v[72:75], v[184:187], v[24:27], v[72:75]
    v_mfma_f32_16x16x32_bf16 v[76:79], v[188:191], v[24:27], v[76:79]
    v_mfma_f32_16x16x32_bf16 v[64:67], v[192:195], v[28:31], v[64:67]
    v_mfma_f32_16x16x32_bf16 v[68:71], v[196:199], v[28:31], v[68:71]
    v_mfma_f32_16x16x32_bf16 v[72:75], v[200:203], v[28:31], v[72:75]
    v_mfma_f32_16x16x32_bf16 v[76:79], v[204:207], v[28:31], v[76:79]
    v_mfma_f32_16x16x32_bf16 v[64:67], v[208:211], v[32:35], v[64:67]
    v_mfma_f32_16x16x32_bf16 v[68:71], v[212:215], v[32:35], v[68:71]
    v_mfma_f32_16x16x32_bf16 v[72:75], v[216:219], v[32:35], v[72:75]
    v_mfma_f32_16x16x32_bf16 v[76:79], v[220:223], v[32:35], v[76:79]
    v_mfma_f32_16x16x32_bf16 v[64:67], v[224:227], v[36:39], v[64:67]
    v_mfma_f32_16x16x32_bf16 v[68:71], v[228:231], v[36:39], v[68:71]
    v_mfma_f32_16x16x32_bf16 v[72:75], v[232:235], v[36:39], v[72:75]
    v_mfma_f32_16x16x32_bf16 v[76:79], v[236:239], v[36:39], v[76:79]
    s_nop 4
    v_cvt_pk_bf16_f32 v96, v64, v65
    v_cvt_pk_bf16_f32 v97, v66, v67
    v_cvt_pk_bf16_f32 v98, v68, v69
    v_cvt_pk_bf16_f32 v99, v70, v71
    buffer_store_dwordx4 v[96:99], v5, s[8:11], s26 offen
    v_cvt_pk_bf16_f32 v100, v72, v73
    v_cvt_pk_bf16_f32 v101, v74, v75
    v_cvt_pk_bf16_f32 v102, v76, v77
    v_cvt_pk_bf16_f32 v103, v78, v79
    buffer_store_dwordx4 v[100:103], v5, s[8:11], s27 offen
    s_add_u32 s26, s26, 32768
    s_add_u32 s27, s27, 32768
    s_sub_u32 s28, s28, 1
    s_cmp_eq_u32 s28, 0
    s_cbranch_scc1 vvo_kernel_l2e
    s_add_u32 s29, s24, 4096
    buffer_load_dwordx4 v[16:19], v5, s[8:11], s24 offen offset:0
    buffer_load_dwordx4 v[20:23], v5, s[8:11], s24 offen offset:1024
    buffer_load_dwordx4 v[24:27], v5, s[8:11], s24 offen offset:2048
    buffer_load_dwordx4 v[28:31], v5, s[8:11], s24 offen offset:3072
    buffer_load_dwordx4 v[32:35], v5, s[8:11], s29 offen offset:0
    buffer_load_dwordx4 v[36:39], v5, s[8:11], s29 offen offset:1024
    s_add_u32 s24, s24, 196608
    s_waitcnt vmcnt(6)
    v_mfma_f32_16x16x32_bf16 v[80:83], v[144:147], v[40:43], 0
    v_mfma_f32_16x16x32_bf16 v[84:87], v[148:151], v[40:43], 0
    v_mfma_f32_16x16x32_bf16 v[88:91], v[152:155], v[40:43], 0
    v_mfma_f32_16x16x32_bf16 v[92:95], v[156:159], v[40:43], 0
    v_mfma_f32_16x16x32_bf16 v[80:83], v[160:163], v[44:47], v[80:83]
    v_mfma_f32_16x16x32_bf16 v[84:87], v[164:167], v[44:47], v[84:87]
    v_mfma_f32_16x16x32_bf16 v[88:91], v[168:171], v[44:47], v[88:91]
    v_mfma_f32_16x16x32_bf16 v[92:95], v[172:175], v[44:47], v[92:95]
    v_mfma_f32_16x16x32_bf16 v[80:83], v[176:179], v[48:51], v[80:83]
    v_mfma_f32_16x16x32_bf16 v[84:87], v[180:183], v[48:51], v[84:87]
    v_mfma_f32_16x16x32_bf16 v[88:91], v[184:187], v[48:51], v[88:91]
    v_mfma_f32_16x16x32_bf16 v[92:95], v[188:191], v[48:51], v[92:95]
    v_mfma_f32_16x16x32_bf16 v[80:83], v[192:195], v[52:55], v[80:83]
    v_mfma_f32_16x16x32_bf16 v[84:87], v[196:199], v[52:55], v[84:87]
    v_mfma_f32_16x16x32_bf16 v[88:91], v[200:203], v[52:55], v[88:91]
    v_mfma_f32_16x16x32_bf16 v[92:95], v[204:207], v[52:55], v[92:95]
    v_mfma_f32_16x16x32_bf16 v[80:83], v[208:211], v[56:59], v[80:83]
    v_mfma_f32_16x16x32_bf16 v[84:87], v[212:215], v[56:59], v[84:87]
    v_mfma_f32_16x16x32_bf16 v[88:91], v[216:219], v[56:59], v[88:91]
    v_mfma_f32_16x16x32_bf16 v[92:95], v[220:223], v[56:59], v[92:95]
    v_mfma_f32_16x16x32_bf16 v[80:83], v[224:227], v[60:63], v[80:83]
    v_mfma_f32_16x16x32_bf16 v[84:87], v[228:231], v[60:63], v[84:87]
    v_mfma_f32_16x16x32_bf16 v[88:91], v[232:235], v[60:63], v[88:91]
    v_mfma_f32_16x16x32_bf16 v[92:95], v[236:239], v[60:63], v[92:95]
    s_nop 4
    v_cvt_pk_bf16_f32 v96, v80, v81
    v_cvt_pk_bf16_f32 v97, v82, v83
    v_cvt_pk_bf16_f32 v98, v84, v85
    v_cvt_pk_bf16_f32 v99, v86, v87
    buffer_store_dwordx4 v[96:99], v5, s[8:11], s26 offen
    v_cvt_pk_bf16_f32 v100, v88, v89
    v_cvt_pk_bf16_f32 v101, v90, v91
    v_cvt_pk_bf16_f32 v102, v92, v93
    v_cvt_pk_bf16_f32 v103, v94, v95
    buffer_store_dwordx4 v[100:103], v5, s[8:11], s27 offen
    s_add_u32 s26, s26, 32768
    s_add_u32 s27, s27, 32768
    s_branch vvo_kernel_l2
vvo_kernel_l2e:
    s_waitcnt vmcnt(2)
    v_mfma_f32_16x16x32_bf16 v[80:83], v[144:147], v[40:43], 0
    v_mfma_f32_16x16x32_bf16 v[84:87], v[148:151], v[40:43], 0
    v_mfma_f32_16x16x32_bf16 v[88:91], v[152:155], v[40:43], 0
    v_mfma_f32_16x16x32_bf16 v[92:95], v[156:159], v[40:43], 0
    v_mfma_f32_16x16x32_bf16 v[80:83], v[160:163], v[44:47], v[80:83]
    v_mfma_f32_16x16x32_bf16 v[84:87], v[164:167], v[44:47], v[84:87]
    v_mfma_f32_16x16x32_bf16 v[88:91], v[168:171], v[44:47], v[88:91]
    v_mfma_f32_16x16x32_bf16 v[92:95], v[172:175], v[44:47], v[92:95]
    v_mfma_f32_16x16x32_bf16 v[80:83], v[176:179], v[48:51], v[80:83]
    v_mfma_f32_16x16x32_bf16 v[84:87], v[180:183], v[48:51], v[84:87]
    v_mfma_f32_16x16x32_bf16 v[88:91], v[184:187], v[48:51], v[88:91]
    v_mfma_f32_16x16x32_bf16 v[92:95], v[188:191], v[48:51], v[92:95]
    v_mfma_f32_16x16x32_bf16 v[80:83], v[192:195], v[52:55], v[80:83]
    v_mfma_f32_16x16x32_bf16 v[84:87], v[196:199], v[52:55], v[84:87]
    v_mfma_f32_16x16x32_bf16 v[88:91], v[200:203], v[52:55], v[88:91]
    v_mfma_f32_16x16x32_bf16 v[92:95], v[204:207], v[52:55], v[92:95]
    v_mfma_f32_16x16x32_bf16 v[80:83], v[208:211], v[56:59], v[80:83]
    v_mfma_f32_16x16x32_bf16 v[84:87], v[212:215], v[56:59], v[84:87]
    v_mfma_f32_16x16x32_bf16 v[88:91], v[216:219], v[56:59], v[88:91]
    v_mfma_f32_16x16x32_bf16 v[92:95], v[220:223], v[56:59], v[92:95]
    v_mfma_f32_16x16x32_bf16 v[80:83], v[224:227], v[60:63], v[80:83]
    v_mfma_f32_16x16x32_bf16 v[84:87], v[228:231], v[60:63], v[84:87]
    v_mfma_f32_16x16x32_bf16 v[88:91], v[232:235], v[60:63], v[88:91]
    v_mfma_f32_16x16x32_bf16 v[92:95], v[236:239], v[60:63], v[92:95]
    s_nop 4
    v_cvt_pk_bf16_f32 v96, v80, v81
    v_cvt_pk_bf16_f32 v97, v82, v83
    v_cvt_pk_bf16_f32 v98, v84, v85
    v_cvt_pk_bf16_f32 v99, v86, v87
    buffer_store_dwordx4 v[96:99], v5, s[8:11], s26 offen
    v_cvt_pk_bf16_f32 v100, v88, v89
    v_cvt_pk_bf16_f32 v101, v90, v91
    v_cvt_pk_bf16_f32 v102, v92, v93
    v_cvt_pk_bf16_f32 v103, v94, v95
    buffer_store_dwordx4 v[100:103], v5, s[8:11], s27 offen
    s_add_u32 s26, s26, 32768
    s_add_u32 s27, s27, 32768
vvo_kernel_end:
    s_endpgm
.section .rodata,"a"
.p2align 6
.amdhsa_kernel vvo_kernel
  .amdhsa_next_free_vgpr 448
  .amdhsa_next_free_sgpr 64
  .amdhsa_accum_offset 256
  .amdhsa_group_segment_fixed_size 0
  .amdhsa_kernarg_size 104
  .amdhsa_user_sgpr_count 2
  .amdhsa_user_sgpr_kernarg_segment_ptr 1
  .amdhsa_system_sgpr_workgroup_id_x 1
.end_amdhsa_kernel
.text
.globl clr_kernel
.p2align 8
.type clr_kernel,@function
clr_kernel:
    s_cmp_ge_u32 s2, 880
    s_cbranch_scc1 clr_kernel_end
    s_load_dwordx2 s[4:5], s[0:1], 96
    s_waitcnt lgkmcnt(0)
    s_add_u32 s8, s4, 142606336
    s_addc_u32 s9, s5, 0
    s_mov_b32 s10, 28835840
    s_mov_b32 s11, 0x00020000
    s_mul_i32 s12, s2, 32768
    v_lshlrev_b32 v1, 4, v0
    v_add_u32 v1, s12, v1
    v_mov_b32 v4, -1
    v_mov_b32 v5, -1
    v_mov_b32 v6, -1
    v_mov_b32 v7, -1
    s_mov_b32 s13, 0
    buffer_store_dwordx4 v[4:7], v1, s[8:11], s13 offen
    s_mov_b32 s13, 4096
    buffer_store_dwordx4 v[4:7], v1, s[8:11], s13 offen
    s_mov_b32 s13, 8192
    buffer_store_dwordx4 v[4:7], v1, s[8:11], s13 offen
    s_mov_b32 s13, 12288
    buffer_store_dwordx4 v[4:7], v1, s[8:11], s13 offen
    s_mov_b32 s13, 16384
    buffer_store_dwordx4 v[4:7], v1, s[8:11], s13 offen
    s_mov_b32 s13, 20480
    buffer_store_dwordx4 v[4:7], v1, s[8:11], s13 offen
    s_mov_b32 s13, 24576
    buffer_store_dwordx4 v[4:7], v1, s[8:11], s13 offen
    s_mov_b32 s13, 28672
    buffer_store_dwordx4 v[4:7], v1, s[8:11], s13 offen
clr_kernel_end:
    s_endpgm
.section .rodata,"a"
.p2align 6
.amdhsa_kernel clr_kernel
  .amdhsa_next_free_vgpr 16
  .amdhsa_next_free_sgpr 24
  .amdhsa_accum_offset 16
  .amdhsa_group_segment_fixed_size 0
  .amdhsa_kernarg_size 104
  .amdhsa_user_sgpr_count 2
  .amdhsa_user_sgpr_kernarg_segment_ptr 1
  .amdhsa_system_sgpr_workgroup_id_x 1
.end_amdhsa_kernel
.text
.globl chainz_kernel
.p2align 8
.type chainz_kernel,@function
chainz_kernel:
    s_cmp_ge_u32 s2, 104
    s_cbranch_scc1 chainz_kernel_end
    s_load_dwordx2 s[4:5], s[0:1], 96
    s_load_dwordx2 s[6:7], s[0:1], 32
    v_and_b32 v1, 63, v0
    v_lshrrev_b32 v4, 6, v0
    v_and_b32 v2, 15, v1
    v_lshrrev_b32 v3, 4, v1
    v_readfirstlane_b32 s3, v4
    s_mov_b32 s60, 131072
    s_waitcnt lgkmcnt(0)
    s_mov_b32 s8, s4
    s_mov_b32 s9, s5
    s_mov_b32 s10, 268435456
    s_mov_b32 s11, 0x00020000
    s_mov_b32 s20, s6
    s_mov_b32 s21, s7
    s_mov_b32 s22, 10240
    s_mov_b32 s23, 0x00020000
    s_cmp_ge_u32 s2, 64
    s_cbranch_scc1 chainz_kernel_roleR
    s_cmp_ge_u32 s2, 32
    s_cbranch_scc1 chainz_kernel_roleV
    s_mov_b32 s44, s2
    s_load_dwordx2 s[6:7], s[0:1], 40
    s_load_dwordx2 s[24:25], s[0:1], 48
    s_waitcnt lgkmcnt(0)
    s_mov_b32 s12, s6
    s_mov_b32 s13, s7
    s_mov_b32 s14, 7864320
    s_mov_b32 s15, 0x00020000
    s_mov_b32 s16, s24
    s_mov_b32 s17, s25
    s_mov_b32 s18, 7864320
    s_mov_b32 s19, 0x00020000
    v_add_u32 v16, 0, v0
    s_mov_b32 s24, 683
    v_mul_lo_u32 v17, v16, s24
    v_lshrrev_b32 v17, 14, v17
    v_mul_u32_u24 v18, 24, v17
    v_sub_u32 v18, v16, v18
    s_mov_b32 s24, 12288
    v_mul_lo_u32 v4, v17, s24
    v_lshl_add_u32 v4, v18, 4, v4
    v_mul_u32_u24 v10, 400, v17
    v_lshl_add_u32 v10, v18, 4, v10
    v_add_u32 v10, 106496, v10
    v_add_u32 v16, 256, v0
    s_mov_b32 s24, 683
    v_mul_lo_u32 v17, v16, s24
    v_lshrrev_b32 v17, 14, v17
    v_mul_u32_u24 v18, 24, v17
    v_sub_u32 v18, v16, v18
    s_mov_b32 s24, 12288
    v_mul_lo_u32 v5, v17, s24
    v_lshl_add_u32 v5, v18, 4, v5
    v_mul_u32_u24 v11, 400, v17
    v_lshl_add_u32 v11, v18, 4, v11
    v_add_u32 v11, 106496, v11
    v_add_u32 v16, 512, v0
    s_mov_b32 s24, 683
    v_mul_lo_u32 v17, v16, s24
    v_lshrrev_b32 v17, 14, v17
    v_mul_u32_u24 v18, 24, v17
    v_sub_u32 v18, v16, v18
    s_mov_b32 s24, 12288
    v_mul_lo_u32 v6, v17, s24
    v_lshl_add_u32 v6, v18, 4, v6
    v_mul_u32_u24 v12, 400, v17
    v_lshl_add_u32 v12, v18, 4, v12
    v_add_u32 v12, 106496, v12
    v_add_u32 v16, 768, v0
    s_mov_b32 s24, 683
    v_mul_lo_u32 v17, v16, s24
    v_lshrrev_b32 v17, 14, v17
    v_mul_u32_u24 v18, 24, v17
    v_sub_u32 v18, v16, v18
    s_mov_b32 s24, 12288
    v_mul_lo_u32 v7, v17, s24
    v_lshl_add_u32 v7, v18, 4, v7
    v_mul_u32_u24 v13, 400, v17
    v_lshl_add_u32 v13, v18, 4, v13
    v_add_u32 v13, 106496, v13
    v_add_u32 v16, 1024, v0
    s_mov_b32 s24, 683
    v_mul_lo_u32 v17, v16, s24
    v_lshrrev_b32 v17, 14, v17
    v_mul_u32_u24 v18, 24, v17
    v_sub_u32 v18, v16, v18
    s_mov_b32 s24, 12288
    v_mul_lo_u32 v8, v17, s24
    v_lshl_add_u32 v8, v18, 4, v8
    v_mul_u32_u24 v14, 400, v17
    v_lshl_add_u32 v14, v18, 4, v14
    v_add_u32 v14, 106496, v14
    v_add_u32 v16, 1280, v0
    s_mov_b32 s24, 683
    v_mul_lo_u32 v17, v16, s24
    v_lshrrev_b32 v17, 14, v17
    v_mul_u32_u24 v18, 24, v17
    v_sub_u32 v18, v16, v18
    s_mov_b32 s24, 12288
    v_mul_lo_u32 v9, v17, s24
    v_lshl_add_u32 v9, v18, 4, v9
    v_mul_u32_u24 v15, 400, v17
    v_lshl_add_u32 v15, v18, 4, v15
    v_add_u32 v15, 106496, v15
    v_lshrrev_b32 v17, 1, v3
    v_lshlrev_b32 v17, 4, v17
    v_and_b32 v18, 1, v3
    v_lshl_add_u32 v17, v18, 2, v17
    v_lshrrev_b32 v18, 2, v2
    v_and_b32 v19, 1, v18
    v_add_u32 v17, v17, v19
    v_lshrrev_b32 v18, 1, v18
    v_lshl_add_u32 v17, v18, 3, v17
    v_mul_u32_u24 v16, 400, v17
    v_and_b32 v18, 3, v2
    v_lshl_add_u32 v16, v18, 3, v16
    v_add_u32 v16, 106496, v16
    s_mul_i32 s24, s3, 96
    v_add_u32 v16, s24, v16
    v_lshlrev_b32 v17, 4, v1
    s_mul_i32 s24, s3, 20480
    s_add_u32 s24, s24, 24576
    v_add_u32 v17, s24, v17
    s_mul_i32 s45, s44, 384
    s_add_u32 s46, s45, 0
    buffer_load_dwordx4 v[24:27], v4, s[12:15], s46 offen
    buffer_load_dwordx4 v[28:31], v5, s[12:15], s46 offen
    buffer_load_dwordx4 v[32:35], v6, s[12:15], s46 offen
    buffer_load_dwordx4 v[36:39], v7, s[12:15], s46 offen
    buffer_load_dwordx4 v[40:43], v8, s[12:15], s46 offen
    buffer_load_dwordx4 v[44:47], v9, s[12:15], s46 offen
    s_add_u32 s46, s45, 0
    buffer_load_dwordx4 v[48:51], v4, s[16:19], s46 offen
    buffer_load_dwordx4 v[52:55], v5, s[16:19], s46 offen
    buffer_load_dwordx4 v[56:59], v6, s[16:19], s46 offen
    buffer_load_dwordx4 v[60:63], v7, s[16:19], s46 offen
    buffer_load_dwordx4 v[64:67], v8, s[16:19], s46 offen
    buffer_load_dwordx4 v[68:71], v9, s[16:19], s46 offen
    s_waitcnt vmcnt(6)
    ds_write_b128 v10, v[24:27]
    ds_write_b128 v11, v[28:31]
    ds_write_b128 v12, v[32:35]
    ds_write_b128 v13, v[36:39]
    ds_write_b128 v14, v[40:43]
    ds_write_b128 v15, v[44:47]
    s_add_u32 s46, s45, 786432
    buffer_load_dwordx4 v[72:75], v4, s[12:15], s46 offen
    buffer_load_dwordx4 v[76:79], v5, s[12:15], s46 offen
    buffer_load_dwordx4 v[80:83], v6, s[12:15], s46 offen
    buffer_load_dwordx4 v[84:87], v7, s[12:15], s46 offen
    buffer_load_dwordx4 v[88:91], v8, s[12:15], s46 offen
    buffer_load_dwordx4 v[92:95], v9, s[12:15], s46 offen
    s_waitcnt lgkmcnt(0)
    s_barrier
    ds_read_b64_tr_b16 a[0:1], v16 offset:0
    ds_read_b64_tr_b16 a[2:3], v16 offset:800
    ds_read_b64_tr_b16 a[4:5], v16 offset:12800
    ds_read_b64_tr_b16 a[6:7], v16 offset:13600
    ds_read_b64_tr_b16 a[80:81], v16 offset:32
    ds_read_b64_tr_b16 a[82:83], v16 offset:832
    ds_read_b64_tr_b16 a[84:85], v16 offset:12832
    ds_read_b64_tr_b16 a[86:87], v16 offset:13632
    ds_read_b64_tr_b16 a[160:161], v16 offset:64
    ds_read_b64_tr_b16 a[162:163], v16 offset:864
    ds_read_b64_tr_b16 a[164:165], v16 offset:12864
    ds_read_b64_tr_b16 a[166:167], v16 offset:13664
    s_waitcnt lgkmcnt(0)
    s_barrier
    s_waitcnt vmcnt(6)
    ds_write_b128 v10, v[48:51]
    ds_write_b128 v11, v[52:55]
    ds_write_b128 v12, v[56:59]
    ds_write_b128 v13, v[60:63]
    ds_write_b128 v14, v[64:67]
    ds_write_b128 v15, v[68:71]
    s_add_u32 s46, s45, 786432
    buffer_load_dwordx4 v[24:27], v4, s[16:19], s46 offen
    buffer_load_dwordx4 v[28:31], v5, s[16:19], s46 offen
    buffer_load_dwordx4 v[32:35], v6, s[16:19], s46 offen
    buffer_load_dwordx4 v[36:39], v7, s[16:19], s46 offen
    buffer_load_dwordx4 v[40:43], v8, s[16:19], s46 offen
    buffer_load_dwordx4 v[44:47], v9, s[16:19], s46 offen
    s_waitcnt lgkmcnt(0)
    s_barrier
    ds_read_b64_tr_b16 v[96:97], v16 offset:0
    ds_read_b64_tr_b16 v[98:99], v16 offset:800
    ds_read_b64_tr_b16 v[100:101], v16 offset:12800
    ds_read_b64_tr_b16 v[102:103], v16 offset:13600
    ds_read_b64_tr_b16 v[176:177], v16 offset:32
    ds_read_b64_tr_b16 v[178:179], v16 offset:832
    ds_read_b64_tr_b16 v[180:181], v16 offset:12832
    ds_read_b64_tr_b16 v[182:183], v16 offset:13632
    ds_read_b64_tr_b16 v[48:49], v16 offset:64
    ds_read_b64_tr_b16 v[50:51], v16 offset:864
    ds_read_b64_tr_b16 v[52:53], v16 offset:12864
    ds_read_b64_tr_b16 v[54:55], v16 offset:13664
    s_waitcnt lgkmcnt(0)
    ds_write_b128 v17, v[48:51] offset:0
    ds_write_b128 v17, v[52:55] offset:1024
    s_waitcnt lgkmcnt(0)
    s_barrier
    s_waitcnt vmcnt(6)
    ds_write_b128 v10, v[72:75]
    ds_write_b128 v11, v[76:79]
    ds_write_b128 v12, v[80:83]
    ds_write_b128 v13, v[84:87]
    ds_write_b128 v14, v[88:91]
    ds_write_b128 v15, v[92:95]
    s_add_u32 s46, s45, 1572864
    buffer_load_dwordx4 v[48:51], v4, s[12:15], s46 offen
    buffer_load_dwordx4 v[52:55], v5, s[12:15], s46 offen
    buffer_load_dwordx4 v[56:59], v6, s[12:15], s46 offen
    buffer_load_dwordx4 v[60:63], v7, s[12:15], s46 offen
    buffer_load_dwordx4 v[64:67], v8, s[12:15], s46 offen
    buffer_load_dwordx4 v[68:71], v9, s[12:15], s46 offen
    s_waitcnt lgkmcnt(0)
    s_barrier
    ds_read_b64_tr_b16 a[8:9], v16 offset:0
    ds_read_b64_tr_b16 a[10:11], v16 offset:800
    ds_read_b64_tr_b16 a[12:13], v16 offset:12800
    ds_read_b64_tr_b16 a[14:15], v16 offset:13600
    ds_read_b64_tr_b16 a[88:89], v16 offset:32
    ds_read_b64_tr_b16 a[90:91], v16 offset:832
    ds_read_b64_tr_b16 a[92:93], v16 offset:12832
    ds_read_b64_tr_b16 a[94:95], v16 offset:13632
    ds_read_b64_tr_b16 a[168:169], v16 offset:64
    ds_read_b64_tr_b16 a[170:171], v16 offset:864
    ds_read_b64_tr_b16 a[172:173], v16 offset:12864
    ds_read_b64_tr_b16 a[174:175], v16 offset:13664
    s_waitcnt lgkmcnt(0)
    s_barrier
    s_waitcnt vmcnt(6)
    ds_write_b128 v10, v[24:27]
    ds_write_b128 v11, v[28:31]
    ds_write_b128 v12, v[32:35]
    ds_write_b128 v13, v[36:39]
    ds_write_b128 v14, v[40:43]
    ds_write_b128 v15, v[44:47]
    s_add_u32 s46, s45, 1572864
    buffer_load_dwordx4 v[72:75], v4, s[16:19], s46 offen
    buffer_load_dwordx4 v[76:79], v5, s[16:19], s46 offen
    buffer_load_dwordx4 v[80:83], v6, s[16:19], s46 offen
    buffer_load_dwordx4 v[84:87], v7, s[16:19], s46 offen
    buffer_load_dwordx4 v[88:91], v8, s[16:19], s46 offen
    buffer_load_dwordx4 v[92:95], v9, s[16:19], s46 offen
    s_waitcnt lgkmcnt(0)
    s_barrier
    ds_read_b64_tr_b16 v[104:105], v16 offset:0
    ds_read_b64_tr_b16 v[106:107], v16 offset:800
    ds_read_b64_tr_b16 v[108:109], v16 offset:12800
    ds_read_b64_tr_b16 v[110:111], v16 offset:13600
    ds_read_b64_tr_b16 v[184:185], v16 offset:32
    ds_read_b64_tr_b16 v[186:187], v16 offset:832
    ds_read_b64_tr_b16 v[188:189], v16 offset:12832
    ds_read_b64_tr_b16 v[190:191], v16 offset:13632
    ds_read_b64_tr_b16 v[24:25], v16 offset:64
    ds_read_b64_tr_b16 v[26:27], v16 offset:864
    ds_read_b64_tr_b16 v[28:29], v16 offset:12864
    ds_read_b64_tr_b16 v[30:31], v16 offset:13664
    s_waitcnt lgkmcnt(0)
    ds_write_b128 v17, v[24:27] offset:2048
    ds_write_b128 v17, v[28:31] offset:3072
    s_waitcnt lgkmcnt(0)
    s_barrier
    s_waitcnt vmcnt(6)
    ds_write_b128 v10, v[48:51]
    ds_write_b128 v11, v[52:55]
    ds_write_b128 v12, v[56:59]
    ds_write_b128 v13, v[60:63]
    ds_write_b128 v14, v[64:67]
    ds_write_b128 v15, v[68:71]
    s_add_u32 s46, s45, 2359296
    buffer_load_dwordx4 v[24:27], v4, s[12:15], s46 offen
    buffer_load_dwordx4 v[28:31], v5, s[12:15], s46 offen
    buffer_load_dwordx4 v[32:35], v6, s[12:15], s46 offen
    buffer_load_dwordx4 v[36:39], v7, s[12:15], s46 offen
    buffer_load_dwordx4 v[40:43], v8, s[12:15], s46 offen
    buffer_load_dwordx4 v[44:47], v9, s[12:15], s46 offen
    s_waitcnt lgkmcnt(0)
    s_barrier
    ds_read_b64_tr_b16 a[16:17], v16 offset:0
    ds_read_b64_tr_b16 a[18:19], v16 offset:800
    ds_read_b64_tr_b16 a[20:21], v16 offset:12800
    ds_read_b64_tr_b16 a[22:23], v16 offset:13600
    ds_read_b64_tr_b16 a[96:97], v16 offset:32
    ds_read_b64_tr_b16 a[98:99], v16 offset:832
    ds_read_b64_tr_b16 a[100:101], v16 offset:12832
    ds_read_b64_tr_b16 a[102:103], v16 offset:13632
    ds_read_b64_tr_b16 a[176:177], v16 offset:64
    ds_read_b64_tr_b16 a[178:179], v16 offset:864
    ds_read_b64_tr_b16 a[180:181], v16 offset:12864
    ds_read_b64_tr_b16 a[182:183], v16 offset:13664
    s_waitcnt lgkmcnt(0)
    s_barrier
    s_waitcnt vmcnt(6)
    ds_write_b128 v10, v[72:75]
    ds_write_b128 v11, v[76:79]
    ds_write_b128 v12, v[80:83]
    ds_write_b128 v13, v[84:87]
    ds_write_b128 v14, v[88:91]
    ds_write_b128 v15, v[92:95]
    s_add_u32 s46, s45, 2359296
    buffer_load_dwordx4 v[48:51], v4, s[16:19], s46 offen
    buffer_load_dwordx4 v[52:55], v5, s[16:19], s46 offen
    buffer_load_dwordx4 v[56:59], v6, s[16:19], s46 offen
    buffer_load_dwordx4 v[60:63], v7, s[16:19], s46 offen
    buffer_load_dwordx4 v[64:67], v8, s[16:19], s46 offen
    buffer_load_dwordx4 v[68:71], v9, s[16:19], s46 offen
    s_waitcnt lgkmcnt(0)
    s_barrier
    ds_read_b64_tr_b16 v[112:113], v16 offset:0
    ds_read_b64_tr_b16 v[114:115], v16 offset:800
    ds_read_b64_tr_b16 v[116:117], v16 offset:12800
    ds_read_b64_tr_b16 v[118:119], v16 offset:13600
    ds_read_b64_tr_b16 v[192:193], v16 offset:32
    ds_read_b64_tr_b16 v[194:195], v16 offset:832
    ds_read_b64_tr_b16 v[196:197], v16 offset:12832
    ds_read_b64_tr_b16 v[198:199], v16 offset:13632
    ds_read_b64_tr_b16 v[72:73], v16 offset:64
    ds_read_b64_tr_b16 v[74:75], v16 offset:864
    ds_read_b64_tr_b16 v[76:77], v16 offset:12864
    ds_read_b64_tr_b16 v[78:79], v16 offset:13664
    s_waitcnt lgkmcnt(0)
    ds_write_b128 v17, v[72:75] offset:4096
    ds_write_b128 v17, v[76:79] offset:5120
    s_waitcnt lgkmcnt(0)
    s_barrier
    s_waitcnt vmcnt(6)
    ds_write_b128 v10, v[24:27]
    ds_write_b128 v11, v[28:31]
    ds_write_b128 v12, v[32:35]
    ds_write_b128 v13, v[36:39]
    ds_write_b128 v14, v[40:43]
    ds_write_b128 v15, v[44:47]
    s_add_u32 s46, s45, 3145728
    buffer_load_dwordx4 v[72:75], v4, s[12:15], s46 offen
    buffer_load_dwordx4 v[76:79], v5, s[12:15], s46 offen
    buffer_load_dwordx4 v[80:83], v6, s[12:15], s46 offen
    buffer_load_dwordx4 v[84:87], v7, s[12:15], s46 offen
    buffer_load_dwordx4 v[88:91], v8, s[12:15], s46 offen
    buffer_load_dwordx4 v[92:95], v9, s[12:15], s46 offen
    s_waitcnt lgkmcnt(0)
    s_barrier
    ds_read_b64_tr_b16 a[24:25], v16 offset:0
    ds_read_b64_tr_b16 a[26:27], v16 offset:800
    ds_read_b64_tr_b16 a[28:29], v16 offset:12800
    ds_read_b64_tr_b16 a[30:31], v16 offset:13600
    ds_read_b64_tr_b16 a[104:105], v16 offset:32
    ds_read_b64_tr_b16 a[106:107], v16 offset:832
    ds_read_b64_tr_b16 a[108:109], v16 offset:12832
    ds_read_b64_tr_b16 a[110:111], v16 offset:13632
    ds_read_b64_tr_b16 a[184:185], v16 offset:64
    ds_read_b64_tr_b16 a[186:187], v16 offset:864
    ds_read_b64_tr_b16 a[188:189], v16 offset:12864
    ds_read_b64_tr_b16 a[190:191], v16 offset:13664
    s_waitcnt lgkmcnt(0)
    s_barrier
    s_waitcnt vmcnt(6)
    ds_write_b128 v10, v[48:51]
    ds_write_b128 v11, v[52:55]
    ds_write_b128 v12, v[56:59]
    ds_write_b128 v13, v[60:63]
    ds_write_b128 v14, v[64:67]
    ds_write_b128 v15, v[68:71]
    s_add_u32 s46, s45, 3145728
    buffer_load_dwordx4 v[24:27], v4, s[16:19], s46 offen
    buffer_load_dwordx4 v[28:31], v5, s[16:19], s46 offen
    buffer_load_dwordx4 v[32:35], v6, s[16:19], s46 offen
    buffer_load_dwordx4 v[36:39], v7, s[16:19], s46 offen
    buffer_load_dwordx4 v[40:43], v8, s[16:19], s46 offen
    buffer_load_dwordx4 v[44:47], v9, s[16:19], s46 offen
    s_waitcnt lgkmcnt(0)
    s_barrier
    ds_read_b64_tr_b16 v[120:121], v16 offset:0
    ds_read_b64_tr_b16 v[122:123], v16 offset:800
    ds_read_b64_tr_b16 v[124:125], v16 offset:12800
    ds_read_b64_tr_b16 v[126:127], v16 offset:13600
    ds_read_b64_tr_b16 v[200:201], v16 offset:32
    ds_read_b64_tr_b16 v[202:203], v16 offset:832
    ds_read_b64_tr_b16 v[204:205], v16 offset:12832
    ds_read_b64_tr_b16 v[206:207], v16 offset:13632
    ds_read_b64_tr_b16 v[48:49], v16 offset:64
    ds_read_b64_tr_b16 v[50:51], v16 offset:864
    ds_read_b64_tr_b16 v[52:53], v16 offset:12864
    ds_read_b64_tr_b16 v[54:55], v16 offset:13664
    s_waitcnt lgkmcnt(0)
    ds_write_b128 v17, v[48:51] offset:6144
    ds_write_b128 v17, v[52:55] offset:7168
    s_waitcnt lgkmcnt(0)
    s_barrier
    s_waitcnt vmcnt(6)
    ds_write_b128 v10, v[72:75]
    ds_write_b128 v11, v[76:79]
    ds_write_b128 v12, v[80:83]
    ds_write_b128 v13, v[84:87]
    ds_write_b128 v14, v[88:91]
    ds_write_b128 v15, v[92:95]
    s_add_u32 s46, s45, 3932160
    buffer_load_dwordx4 v[48:51], v4, s[12:15], s46 offen
    buffer_load_dwordx4 v[52:55], v5, s[12:15], s46 offen
    buffer_load_dwordx4 v[56:59], v6, s[12:15], s46 offen
    buffer_load_dwordx4 v[60:63], v7, s[12:15], s46 offen
    buffer_load_dwordx4 v[64:67], v8, s[12:15], s46 offen
    buffer_load_dwordx4 v[68:71], v9, s[12:15], s46 offen
    s_waitcnt lgkmcnt(0)
    s_barrier
    ds_read_b64_tr_b16 a[32:33], v16 offset:0
    ds_read_b64_tr_b16 a[34:35], v16 offset:800
    ds_read_b64_tr_b16 a[36:37], v16 offset:12800
    ds_read_b64_tr_b16 a[38:39], v16 offset:13600
    ds_read_b64_tr_b16 a[112:113], v16 offset:32
    ds_read_b64_tr_b16 a[114:115], v16 offset:832
    ds_read_b64_tr_b16 a[116:117], v16 offset:12832
    ds_read_b64_tr_b16 a[118:119], v16 offset:13632
    ds_read_b64_tr_b16 a[192:193], v16 offset:64
    ds_read_b64_tr_b16 a[194:195], v16 offset:864
    ds_read_b64_tr_b16 a[196:197], v16 offset:12864
    ds_read_b64_tr_b16 a[198:199], v16 offset:13664
    s_waitcnt lgkmcnt(0)
    s_barrier
    s_waitcnt vmcnt(6)
    ds_write_b128 v10, v[24:27]
    ds_write_b128 v11, v[28:31]
    ds_write_b128 v12, v[32:35]
    ds_write_b128 v13, v[36:39]
    ds_write_b128 v14, v[40:43]
    ds_write_b128 v15, v[44:47]
    s_add_u32 s46, s45, 3932160
    buffer_load_dwordx4 v[72:75], v4, s[16:19], s46 offen
    buffer_load_dwordx4 v[76:79], v5, s[16:19], s46 offen
    buffer_load_dwordx4 v[80:83], v6, s[16:19], s46 offen
    buffer_load_dwordx4 v[84:87], v7, s[16:19], s46 offen
    buffer_load_dwordx4 v[88:91], v8, s[16:19], s46 offen
    buffer_load_dwordx4 v[92:95], v9, s[16:19], s46 offen
    s_waitcnt lgkmcnt(0)
    s_barrier
    ds_read_b64_tr_b16 v[128:129], v16 offset:0
    ds_read_b64_tr_b16 v[130:131], v16 offset:800
    ds_read_b64_tr_b16 v[132:133], v16 offset:12800
    ds_read_b64_tr_b16 v[134:135], v16 offset:13600
    ds_read_b64_tr_b16 v[208:209], v16 offset:32
    ds_read_b64_tr_b16 v[210:211], v16 offset:832
    ds_read_b64_tr_b16 v[212:213], v16 offset:12832
    ds_read_b64_tr_b16 v[214:215], v16 offset:13632
    ds_read_b64_tr_b16 v[24:25], v16 offset:64
    ds_read_b64_tr_b16 v[26:27], v16 offset:864
    ds_read_b64_tr_b16 v[28:29], v16 offset:12864
    ds_read_b64_tr_b16 v[30:31], v16 offset:13664
    s_waitcnt lgkmcnt(0)
    ds_write_b128 v17, v[24:27] offset:8192
    ds_write_b128 v17, v[28:31] offset:9216
    s_waitcnt lgkmcnt(0)
    s_barrier
    s_waitcnt vmcnt(6)
    ds_write_b128 v10, v[48:51]
    ds_write_b128 v11, v[52:55]
    ds_write_b128 v12, v[56:59]
    ds_write_b128 v13, v[60:63]
    ds_write_b128 v14, v[64:67]
    ds_write_b128 v15, v[68:71]
    s_add_u32 s46, s45, 4718592
    buffer_load_dwordx4 v[24:27], v4, s[12:15], s46 offen
    buffer_load_dwordx4 v[28:31], v5, s[12:15], s46 offen
    buffer_load_dwordx4 v[32:35], v6, s[12:15], s46 offen
    buffer_load_dwordx4 v[36:39], v7, s[12:15], s46 offen
    buffer_load_dwordx4 v[40:43], v8, s[12:15], s46 offen
    buffer_load_dwordx4 v[44:47], v9, s[12:15], s46 offen
    s_waitcnt lgkmcnt(0)
    s_barrier
    ds_read_b64_tr_b16 a[40:41], v16 offset:0
    ds_read_b64_tr_b16 a[42:43], v16 offset:800
    ds_read_b64_tr_b16 a[44:45], v16 offset:12800
    ds_read_b64_tr_b16 a[46:47], v16 offset:13600
    ds_read_b64_tr_b16 a[120:121], v16 offset:32
    ds_read_b64_tr_b16 a[122:123], v16 offset:832
    ds_read_b64_tr_b16 a[124:125], v16 offset:12832
    ds_read_b64_tr_b16 a[126:127], v16 offset:13632
    ds_read_b64_tr_b16 a[200:201], v16 offset:64
    ds_read_b64_tr_b16 a[202:203], v16 offset:864
    ds_read_b64_tr_b16 a[204:205], v16 offset:12864
    ds_read_b64_tr_b16 a[206:207], v16 offset:13664
    s_waitcnt lgkmcnt(0)
    s_barrier
    s_waitcnt vmcnt(6)
    ds_write_b128 v10, v[72:75]
    ds_write_b128 v11, v[76:79]
    ds_write_b128 v12, v[80:83]
    ds_write_b128 v13, v[84:87]
    ds_write_b128 v14, v[88:91]
    ds_write_b128 v15, v[92:95]
    s_add_u32 s46, s45, 4718592
    buffer_load_dwordx4 v[48:51], v4, s[16:19], s46 offen
    buffer_load_dwordx4 v[52:55], v5, s[16:19], s46 offen
    buffer_load_dwordx4 v[56:59], v6, s[16:19], s46 offen
    buffer_load_dwordx4 v[60:63], v7, s[16:19], s46 offen
    buffer_load_dwordx4 v[64:67], v8, s[16:19], s46 offen
    buffer_load_dwordx4 v[68:71], v9, s[16:19], s46 offen
    s_waitcnt lgkmcnt(0)
    s_barrier
    ds_read_b64_tr_b16 v[136:137], v16 offset:0
    ds_read_b64_tr_b16 v[138:139], v16 offset:800
    ds_read_b64_tr_b16 v[140:141], v16 offset:12800
    ds_read_b64_tr_b16 v[142:143], v16 offset:13600
    ds_read_b64_tr_b16 v[216:217], v16 offset:32
    ds_read_b64_tr_b16 v[218:219], v16 offset:832
    ds_read_b64_tr_b16 v[220:221], v16 offset:12832
    ds_read_b64_tr_b16 v[222:223], v16 offset:13632
    ds_read_b64_tr_b16 v[72:73], v16 offset:64
    ds_read_b64_tr_b16 v[74:75], v16 offset:864
    ds_read_b64_tr_b16 v[76:77], v16 offset:12864
    ds_read_b64_tr_b16 v[78:79], v16 offset:13664
    s_waitcnt lgkmcnt(0)
    ds_write_b128 v17, v[72:75] offset:10240
    ds_write_b128 v17, v[76:79] offset:11264
    s_waitcnt lgkmcnt(0)
    s_barrier
    s_waitcnt vmcnt(6)
    ds_write_b128 v10, v[24:27]
    ds_write_b128 v11, v[28:31]
    ds_write_b128 v12, v[32:35]
    ds_write_b128 v13, v[36:39]
    ds_write_b128 v14, v[40:43]
    ds_write_b128 v15, v[44:47]
    s_add_u32 s46, s45, 5505024
    buffer_load_dwordx4 v[72:75], v4, s[12:15], s46 offen
    buffer_load_dwordx4 v[76:79], v5, s[12:15], s46 offen
    buffer_load_dwordx4 v[80:83], v6, s[12:15], s46 offen
    buffer_load_dwordx4 v[84:87], v7, s[12:15], s46 offen
    buffer_load_dwordx4 v[88:91], v8, s[12:15], s46 offen
    buffer_load_dwordx4 v[92:95], v9, s[12:15], s46 offen
    s_waitcnt lgkmcnt(0)
    s_barrier
    ds_read_b64_tr_b16 a[48:49], v16 offset:0
    ds_read_b64_tr_b16 a[50:51], v16 offset:800
    ds_read_b64_tr_b16 a[52:53], v16 offset:12800
    ds_read_b64_tr_b16 a[54:55], v16 offset:13600
    ds_read_b64_tr_b16 a[128:129], v16 offset:32
    ds_read_b64_tr_b16 a[130:131], v16 offset:832
    ds_read_b64_tr_b16 a[132:133], v16 offset:12832
    ds_read_b64_tr_b16 a[134:135], v16 offset:13632
    ds_read_b64_tr_b16 a[208:209], v16 offset:64
    ds_read_b64_tr_b16 a[210:211], v16 offset:864
    ds_read_b64_tr_b16 a[212:213], v16 offset:12864
    ds_read_b64_tr_b16 a[214:215], v16 offset:13664
    s_waitcnt lgkmcnt(0)
    s_barrier
    s_waitcnt vmcnt(6)
    ds_write_b128 v10, v[48:51]
    ds_write_b128 v11, v[52:55]
    ds_write_b128 v12, v[56:59]
    ds_write_b128 v13, v[60:63]
    ds_write_b128 v14, v[64:67]
    ds_write_b128 v15, v[68:71]
    s_add_u32 s46, s45, 5505024
    buffer_load_dwordx4 v[24:27], v4, s[16:19], s46 offen
    buffer_load_dwordx4 v[28:31], v5, s[16:19], s46 offen
    buffer_load_dwordx4 v[32:35], v6, s[16:19], s46 offen
    buffer_load_dwordx4 v[36:39], v7, s[16:19], s46 offen
    buffer_load_dwordx4 v[40:43], v8, s[16:19], s46 offen
    buffer_load_dwordx4 v[44:47], v9, s[16:19], s46 offen
    s_waitcnt lgkmcnt(0)
    s_barrier
    ds_read_b64_tr_b16 v[144:145], v16 offset:0
    ds_read_b64_tr_b16 v[146:147], v16 offset:800
    ds_read_b64_tr_b16 v[148:149], v16 offset:12800
    ds_read_b64_tr_b16 v[150:151], v16 offset:13600
    ds_read_b64_tr_b16 v[224:225], v16 offset:32
    ds_read_b64_tr_b16 v[226:227], v16 offset:832
    ds_read_b64_tr_b16 v[228:229], v16 offset:12832
    ds_read_b64_tr_b16 v[230:231], v16 offset:13632
    ds_read_b64_tr_b16 v[48:49], v16 offset:64
    ds_read_b64_tr_b16 v[50:51], v16 offset:864
    ds_read_b64_tr_b16 v[52:53], v16 offset:12864
    ds_read_b64_tr_b16 v[54:55], v16 offset:13664
    s_waitcnt lgkmcnt(0)
    ds_write_b128 v17, v[48:51] offset:12288
    ds_write_b128 v17, v[52:55] offset:13312
    s_waitcnt lgkmcnt(0)
    s_barrier
    s_waitcnt vmcnt(6)
    ds_write_b128 v10, v[72:75]
    ds_write_b128 v11, v[76:79]
    ds_write_b128 v12, v[80:83]
    ds_write_b128 v13, v[84:87]
    ds_write_b128 v14, v[88:91]
    ds_write_b128 v15, v[92:95]
    s_add_u32 s46, s45, 6291456
    buffer_load_dwordx4 v[48:51], v4, s[12:15], s46 offen
    buffer_load_dwordx4 v[52:55], v5, s[12:15], s46 offen
    buffer_load_dwordx4 v[56:59], v6, s[12:15], s46 offen
    buffer_load_dwordx4 v[60:63], v7, s[12:15], s46 offen
    buffer_load_dwordx4 v[64:67], v8, s[12:15], s46 offen
    buffer_load_dwordx4 v[68:71], v9, s[12:15], s46 offen
    s_waitcnt lgkmcnt(0)
    s_barrier
    ds_read_b64_tr_b16 a[56:57], v16 offset:0
    ds_read_b64_tr_b16 a[58:59], v16 offset:800
    ds_read_b64_tr_b16 a[60:61], v16 offset:12800
    ds_read_b64_tr_b16 a[62:63], v16 offset:13600
    ds_read_b64_tr_b16 a[136:137], v16 offset:32
    ds_read_b64_tr_b16 a[138:139], v16 offset:832
    ds_read_b64_tr_b16 a[140:141], v16 offset:12832
    ds_read_b64_tr_b16 a[142:143], v16 offset:13632
    ds_read_b64_tr_b16 a[216:217], v16 offset:64
    ds_read_b64_tr_b16 a[218:219], v16 offset:864
    ds_read_b64_tr_b16 a[220:221], v16 offset:12864
    ds_read_b64_tr_b16 a[222:223], v16 offset:13664
    s_waitcnt lgkmcnt(0)
    s_barrier
    s_waitcnt vmcnt(6)
    ds_write_b128 v10, v[24:27]
    ds_write_b128 v11, v[28:31]
    ds_write_b128 v12, v[32:35]
    ds_write_b128 v13, v[36:39]
    ds_write_b128 v14, v[40:43]
    ds_write_b128 v15, v[44:47]
    s_add_u32 s46, s45, 6291456
    buffer_load_dwordx4 v[72:75], v4, s[16:19], s46 offen
    buffer_load_dwordx4 v[76:79], v5, s[16:19], s46 offen
    buffer_load_dwordx4 v[80:83], v6, s[16:19], s46 offen
    buffer_load_dwordx4 v[84:87], v7, s[16:19], s46 offen
    buffer_load_dwordx4 v[88:91], v8, s[16:19], s46 offen
    buffer_load_dwordx4 v[92:95], v9, s[16:19], s46 offen
    s_waitcnt lgkmcnt(0)
    s_barrier
    ds_read_b64_tr_b16 v[152:153], v16 offset:0
    ds_read_b64_tr_b16 v[154:155], v16 offset:800
    ds_read_b64_tr_b16 v[156:157], v16 offset:12800
    ds_read_b64_tr_b16 v[158:159], v16 offset:13600
    ds_read_b64_tr_b16 v[232:233], v16 offset:32
    ds_read_b64_tr_b16 v[234:235], v16 offset:832
    ds_read_b64_tr_b16 v[236:237], v16 offset:12832
    ds_read_b64_tr_b16 v[238:239], v16 offset:13632
    ds_read_b64_tr_b16 v[24:25], v16 offset:64
    ds_read_b64_tr_b16 v[26:27], v16 offset:864
    ds_read_b64_tr_b16 v[28:29], v16 offset:12864
    ds_read_b64_tr_b16 v[30:31], v16 offset:13664
    s_waitcnt lgkmcnt(0)
    ds_write_b128 v17, v[24:27] offset:14336
    ds_write_b128 v17, v[28:31] offset:15360
    s_waitcnt lgkmcnt(0)
    s_barrier
    s_waitcnt vmcnt(6)
    ds_write_b128 v10, v[48:51]
    ds_write_b128 v11, v[52:55]
    ds_write_b128 v12, v[56:59]
    ds_write_b128 v13, v[60:63]
    ds_write_b128 v14, v[64:67]
    ds_write_b128 v15, v[68:71]
    s_add_u32 s46, s45, 7077888
    buffer_load_dwordx4 v[24:27], v4, s[12:15], s46 offen
    buffer_load_dwordx4 v[28:31], v5, s[12:15], s46 offen
    buffer_load_dwordx4 v[32:35], v6, s[12:15], s46 offen
    buffer_load_dwordx4 v[36:39], v7, s[12:15], s46 offen
    buffer_load_dwordx4 v[40:43], v8, s[12:15], s46 offen
    buffer_load_dwordx4 v[44:47], v9, s[12:15], s46 offen
    s_waitcnt lgkmcnt(0)
    s_barrier
    ds_read_b64_tr_b16 a[64:65], v16 offset:0
    ds_read_b64_tr_b16 a[66:67], v16 offset:800
    ds_read_b64_tr_b16 a[68:69], v16 offset:12800
    ds_read_b64_tr_b16 a[70:71], v16 offset:13600
    ds_read_b64_tr_b16 a[144:145], v16 offset:32
    ds_read_b64_tr_b16 a[146:147], v16 offset:832
    ds_read_b64_tr_b16 a[148:149], v16 offset:12832
    ds_read_b64_tr_b16 a[150:151], v16 offset:13632
    ds_read_b64_tr_b16 a[224:225], v16 offset:64
    ds_read_b64_tr_b16 a[226:227], v16 offset:864
    ds_read_b64_tr_b16 a[228:229], v16 offset:12864
    ds_read_b64_tr_b16 a[230:231], v16 offset:13664
    s_waitcnt lgkmcnt(0)
    s_barrier
    s_waitcnt vmcnt(6)
    ds_write_b128 v10, v[72:75]
    ds_write_b128 v11, v[76:79]
    ds_write_b128 v12, v[80:83]
    ds_write_b128 v13, v[84:87]
    ds_write_b128 v14, v[88:91]
    ds_write_b128 v15, v[92:95]
    s_add_u32 s46, s45, 7077888
    buffer_load_dwordx4 v[48:51], v4, s[16:19], s46 offen
    buffer_load_dwordx4 v[52:55], v5, s[16:19], s46 offen
    buffer_load_dwordx4 v[56:59], v6, s[16:19], s46 offen
    buffer_load_dwordx4 v[60:63], v7, s[16:19], s46 offen
    buffer_load_dwordx4 v[64:67], v8, s[16:19], s46 offen
    buffer_load_dwordx4 v[68:71], v9, s[16:19], s46 offen
    s_waitcnt lgkmcnt(0)
    s_barrier
    ds_read_b64_tr_b16 v[160:161], v16 offset:0
    ds_read_b64_tr_b16 v[162:163], v16 offset:800
    ds_read_b64_tr_b16 v[164:165], v16 offset:12800
    ds_read_b64_tr_b16 v[166:167], v16 offset:13600
    ds_read_b64_tr_b16 v[240:241], v16 offset:32
    ds_read_b64_tr_b16 v[242:243], v16 offset:832
    ds_read_b64_tr_b16 v[244:245], v16 offset:12832
    ds_read_b64_tr_b16 v[246:247], v16 offset:13632
    ds_read_b64_tr_b16 v[72:73], v16 offset:64
    ds_read_b64_tr_b16 v[74:75], v16 offset:864
    ds_read_b64_tr_b16 v[76:77], v16 offset:12864
    ds_read_b64_tr_b16 v[78:79], v16 offset:13664
    s_waitcnt lgkmcnt(0)
    ds_write_b128 v17, v[72:75] offset:16384
    ds_write_b128 v17, v[76:79] offset:17408
    s_waitcnt lgkmcnt(0)
    s_barrier
    s_waitcnt vmcnt(6)
    ds_write_b128 v10, v[24:27]
    ds_write_b128 v11, v[28:31]
    ds_write_b128 v12, v[32:35]
    ds_write_b128 v13, v[36:39]
    ds_write_b128 v14, v[40:43]
    ds_write_b128 v15, v[44:47]
    s_waitcnt lgkmcnt(0)
    s_barrier
    ds_read_b64_tr_b16 a[72:73], v16 offset:0
    ds_read_b64_tr_b16 a[74:75], v16 offset:800
    ds_read_b64_tr_b16 a[76:77], v16 offset:12800
    ds_read_b64_tr_b16 a[78:79], v16 offset:13600
    ds_read_b64_tr_b16 a[152:153], v16 offset:32
    ds_read_b64_tr_b16 a[154:155], v16 offset:832
    ds_read_b64_tr_b16 a[156:157], v16 offset:12832
    ds_read_b64_tr_b16 a[158:159], v16 offset:13632
    ds_read_b64_tr_b16 a[232:233], v16 offset:64
    ds_read_b64_tr_b16 a[234:235], v16 offset:864
    ds_read_b64_tr_b16 a[236:237], v16 offset:12864
    ds_read_b64_tr_b16 a[238:239], v16 offset:13664
    s_waitcnt lgkmcnt(0)
    s_barrier
    s_waitcnt vmcnt(0)
    ds_write_b128 v10, v[48:51]
    ds_write_b128 v11, v[52:55]
    ds_write_b128 v12, v[56:59]
    ds_write_b128 v13, v[60:63]
    ds_write_b128 v14, v[64:67]
    ds_write_b128 v15, v[68:71]
    s_waitcnt lgkmcnt(0)
    s_barrier
    ds_read_b64_tr_b16 v[168:169], v16 offset:0
    ds_read_b64_tr_b16 v[170:171], v16 offset:800
    ds_read_b64_tr_b16 v[172:173], v16 offset:12800
    ds_read_b64_tr_b16 v[174:175], v16 offset:13600
    ds_read_b64_tr_b16 v[248:249], v16 offset:32
    ds_read_b64_tr_b16 v[250:251], v16 offset:832
    ds_read_b64_tr_b16 v[252:253], v16 offset:12832
    ds_read_b64_tr_b16 v[254:255], v16 offset:13632
    ds_read_b64_tr_b16 v[48:49], v16 offset:64
    ds_read_b64_tr_b16 v[50:51], v16 offset:864
    ds_read_b64_tr_b16 v[52:53], v16 offset:12864
    ds_read_b64_tr_b16 v[54:55], v16 offset:13664
    s_waitcnt lgkmcnt(0)
    ds_write_b128 v17, v[48:51] offset:18432
    ds_write_b128 v17, v[52:55] offset:19456
    s_waitcnt lgkmcnt(0)
    s_barrier
    v_mov_b32 v6, v17
    v_mov_b32 v4, 0x4444
    v_mov_b32 v5, 0xeeee
    v_cmp_gt_u32 vcc, 8, v2
    s_nop 1
    v_cndmask_b32 v4, v5, v4, vcc
    v_lshlrev_b32 v5, 4, v1
    s_lshl_b32 s24, s3, 10
    v_add_u32 v7, s24, v5
    s_lshl_b32 s24, s3, 9
    s_add_u32 s24, s24, 8192
    v_lshlrev_b32 v8, 3, v1
    v_add_u32 v8, s24, v8
    s_mul_i32 s24, s3, 1536
    s_add_u32 s24, s24, 10240
    v_lshlrev_b32 v9, 5, v2
    v_lshl_add_u32 v9, v3, 3, v9
    v_add_u32 v9, s24, v9
    v_lshrrev_b32 v16, 2, v2
    v_and_b32 v17, 3, v2
    v_lshl_add_u32 v10, v3, 3, v16
    v_lshlrev_b32 v10, 5, v10
    v_lshl_add_u32 v10, v17, 3, v10
    v_add_u32 v10, s24, v10
    v_lshl_add_u32 v11, v3, 2, v16
    v_lshlrev_b32 v11, 5, v11
    v_lshl_add_u32 v11, v17, 3, v11
    v_add_u32 v11, s24, v11
    s_mul_i32 s24, s3, 1408
    s_add_u32 s24, s24, 16384
    v_mul_u32_u24 v16, 176, v2
    v_add_u32 v16, s24, v16
    v_lshl_add_u32 v12, v3, 5, v16
    v_lshlrev_b32 v17, 4, v1
    v_add_u32 v17, 22528, v17
    v_cmp_gt_u32 vcc, 8, v2
    s_nop 1
    v_cndmask_b32 v12, v17, v12, vcc
    v_lshl_add_u32 v13, v3, 4, v16
    v_add_u32 v13, 96, v13
    v_cmp_le_u32 s[24:25], 2, v3
    s_and_b64 vcc, vcc, s[24:25]
    v_cndmask_b32 v13, v17, v13, vcc
    v_lshrrev_b32 v16, 3, v1
    v_and_b32 v17, 7, v1
    v_min_u32 v18, 4, v17
    v_mul_u32_u24 v14, 176, v16
    v_lshl_add_u32 v14, v18, 5, v14
    v_add_u32 v14, 16384, v14
    v_cmp_gt_u32 s[50:51], 5, v17
    s_lshr_b32 s24, s44, 1
    s_lshl_b32 s24, s24, 10
    s_and_b32 s25, s44, 1
    s_lshl_b32 s25, s25, 7
    s_add_u32 s24, s24, s25
    v_lshlrev_b32 v15, 8, v17
    v_lshl_add_u32 v15, v16, 4, v15
    v_add_u32 v15, s24, v15
    s_lshr_b32 s24, s44, 3
    s_lshl_b32 s24, s24, 10
    s_and_b32 s25, s44, 3
    s_lshl_b32 s25, s25, 8
    s_add_u32 s24, s24, s25
    s_lshr_b32 s25, s44, 2
    s_and_b32 s25, s25, 1
    s_lshl_b32 s25, s25, 7
    s_add_u32 s24, s24, s25
    s_add_u32 s24, s24, 16384
    v_lshlrev_b32 v18, 4, v16
    v_add_u32 v18, s24, v18
    v_cmp_eq_u32 vcc, 4, v17
    s_nop 1
    v_cndmask_b32 v15, v15, v18, vcc
    v_mov_b32 v18, 2146435072
    v_cndmask_b32 v15, v18, v15, s[50:51]
    s_mul_i32 s24, s3, 20480
    v_add_u32 v15, s24, v15
    s_mul_i32 s24, s44, 384
    s_mul_i32 s25, s3, 96
    s_add_u32 s24, s24, s25
    v_mul_u32_u24 v16, 12288, v2
    v_add_u32 v16, s24, v16
    v_lshl_add_u32 v19, v3, 4, v16
    v_lshl_add_u32 v20, v3, 3, v16
    v_add_u32 v20, 64, v20
    v_subrev_u32 v16, 8, v2
    v_mul_u32_u24 v16, 384, v16
    v_add_u32 v16, s25, v16
    v_lshl_add_u32 v21, v3, 4, v16
    v_lshl_add_u32 v22, v3, 3, v16
    v_add_u32 v22, 64, v22
    v_mov_b32 v18, 2146435072
    v_cmp_le_u32 vcc, 8, v2
    s_nop 1
    v_cndmask_b32 v21, v18, v21, vcc
    v_cndmask_b32 v22, v18, v22, vcc
    v_add_u32 v48, 0, v0
    v_and_b32 v49, 7, v48
    v_mul_u32_u24 v49, 1280, v49
    v_lshrrev_b32 v50, 3, v48
    v_lshl_add_u32 v49, v50, 4, v49
    v_cmp_gt_u32 vcc, 640, v48
    v_mov_b32 v51, 2146435072
    s_nop 0
    v_cndmask_b32 v49, v51, v49, vcc
    buffer_load_dwordx4 v[52:55], v49, s[20:23], 0 offen
    v_lshlrev_b32 v48, 4, v48
    s_waitcnt vmcnt(0)
    s_and_saveexec_b64 s[30:31], vcc
    ds_write_b128 v48, v[52:55]
    s_mov_b64 exec, s[30:31]
    v_add_u32 v48, 256, v0
    v_and_b32 v49, 7, v48
    v_mul_u32_u24 v49, 1280, v49
    v_lshrrev_b32 v50, 3, v48
    v_lshl_add_u32 v49, v50, 4, v49
    v_cmp_gt_u32 vcc, 640, v48
    v_mov_b32 v51, 2146435072
    s_nop 0
    v_cndmask_b32 v49, v51, v49, vcc
    buffer_load_dwordx4 v[52:55], v49, s[20:23], 0 offen
    v_lshlrev_b32 v48, 4, v48
    s_waitcnt vmcnt(0)
    s_and_saveexec_b64 s[30:31], vcc
    ds_write_b128 v48, v[52:55]
    s_mov_b64 exec, s[30:31]
    v_add_u32 v48, 512, v0
    v_and_b32 v49, 7, v48
    v_mul_u32_u24 v49, 1280, v49
    v_lshrrev_b32 v50, 3, v48
    v_lshl_add_u32 v49, v50, 4, v49
    v_cmp_gt_u32 vcc, 640, v48
    v_mov_b32 v51, 2146435072
    s_nop 0
    v_cndmask_b32 v49, v51, v49, vcc
    buffer_load_dwordx4 v[52:55], v49, s[20:23], 0 offen
    v_lshlrev_b32 v48, 4, v48
    s_waitcnt vmcnt(0)
    s_and_saveexec_b64 s[30:31], vcc
    ds_write_b128 v48, v[52:55]
    s_mov_b64 exec, s[30:31]
    s_mov_b32 s40, 0
    s_mov_b32 s41, 92274688
    s_mul_i32 s42, s44, 3072
    s_add_u32 s42, s42, 171966464
    s_mov_b32 s43, 166199296
    s_mov_b32 s47, 163577856
    s_add_u32 s24, s41, 196608
    buffer_load_dwordx4 a[240:243], v19, s[8:11], s41 offen
    buffer_load_dwordx2 a[244:245], v20, s[8:11], s41 offen
    buffer_load_dwordx4 a[246:249], v19, s[8:11], s24 offen
    buffer_load_dwordx2 a[250:251], v20, s[8:11], s24 offen
    s_waitcnt lgkmcnt(0)
    s_branch chainz_kernel_s_go
chainz_kernel_s_step:
    v_mov_b32 v24, 0
    v_mov_b32 v25, 0
    v_mov_b32 v26, 0
    v_mov_b32 v27, 0
    v_mov_b32 v28, 0
    v_mov_b32 v29, 0
    v_mov_b32 v30, 0
    v_mov_b32 v31, 0
    v_mov_b32 v32, 0
    v_mov_b32 v33, 0
    v_mov_b32 v34, 0
    v_mov_b32 v35, 0
    v_mov_b32 v36, 0
    v_mov_b32 v37, 0
    v_mov_b32 v38, 0
    v_mov_b32 v39, 0
    v_mov_b32 v40, 0
    v_mov_b32 v41, 0
    v_mov_b32 v42, 0
    v_mov_b32 v43, 0
    v_mov_b32 v44, 0
    v_mov_b32 v45, 0
    v_mov_b32 v46, 0
    v_mov_b32 v47, 0
    s_add_u32 s48, s47, 4096
    s_mov_b32 s61, 0
chainz_kernel_s_pm:
    buffer_load_dwordx4 v[48:51], v7, s[8:11], s47 offen sc1
    buffer_load_dwordx4 v[52:55], v7, s[8:11], s48 offen sc1
    buffer_load_dwordx2 v[56:57], v8, s[8:11], s47 offen sc1
    s_waitcnt vmcnt(0)
    v_max3_u32 v58, v48, v49, v50
    v_max3_u32 v58, v58, v51, v52
    v_max3_u32 v58, v58, v53, v54
    v_max3_u32 v58, v58, v55, v56
    v_max_u32 v58, v58, v57
    v_cmp_eq_u32 vcc, -1, v58
    s_add_u32 s61, s61, 1
    s_cbranch_vccz chainz_kernel_s_pm_out
    s_cmp_ge_u32 s61, s60
    s_cbranch_scc1 chainz_kernel_s_pm_to
    s_sleep 1
    s_branch chainz_kernel_s_pm
chainz_kernel_s_pm_to:
    s_mov_b32 s60, 1
chainz_kernel_s_pm_out:
    ds_write_b128 v7, v[48:51]
    ds_write_b128 v7, v[52:55] offset:4096
    ds_write_b64 v8, v[56:57]
    s_waitcnt lgkmcnt(0)
chainz_kernel_s_go2:
    s_barrier
    ds_read_b128 v[48:51], v5 offset:0
    ds_read_b128 v[68:71], v6 offset:0
    ds_read_b128 v[72:75], v6 offset:1024
    ds_read_b128 v[52:55], v5 offset:1024
    ds_read_b128 v[76:79], v6 offset:2048
    ds_read_b128 v[80:83], v6 offset:3072
    ds_read_b128 v[56:59], v5 offset:2048
    ds_read_b128 v[60:63], v5 offset:3072
    ds_read_b128 v[64:67], v5 offset:4096
    s_waitcnt lgkmcnt(8)
    v_smfmac_f32_16x16x64_bf16 v[24:27], v[48:51], a[0:7], v4
    v_smfmac_f32_16x16x64_bf16 v[28:31], v[48:51], a[80:87], v4
    ds_read_b128 v[84:87], v6 offset:4096
    ds_read_b128 v[88:91], v6 offset:5120
    v_smfmac_f32_16x16x64_bf16 v[32:35], v[48:51], a[160:167], v4
    v_smfmac_f32_16x16x64_bf16 v[36:39], v[48:51], v[96:103], v4
    v_smfmac_f32_16x16x64_bf16 v[40:43], v[48:51], v[176:183], v4
    s_waitcnt lgkmcnt(8)
    v_smfmac_f32_16x16x64_bf16 v[44:47], v[48:51], v[68:75], v4
    ds_read_b128 v[48:51], v5 offset:5120
    s_waitcnt lgkmcnt(8)
    v_smfmac_f32_16x16x64_bf16 v[24:27], v[52:55], a[8:15], v4
    v_smfmac_f32_16x16x64_bf16 v[28:31], v[52:55], a[88:95], v4
    ds_read_b128 v[68:71], v6 offset:6144
    ds_read_b128 v[72:75], v6 offset:7168
    v_smfmac_f32_16x16x64_bf16 v[32:35], v[52:55], a[168:175], v4
    v_smfmac_f32_16x16x64_bf16 v[36:39], v[52:55], v[104:111], v4
    v_smfmac_f32_16x16x64_bf16 v[40:43], v[52:55], v[184:191], v4
    s_waitcnt lgkmcnt(8)
    v_smfmac_f32_16x16x64_bf16 v[44:47], v[52:55], v[76:83], v4
    ds_read_b128 v[52:55], v5 offset:6144
    s_waitcnt lgkmcnt(8)
    v_smfmac_f32_16x16x64_bf16 v[24:27], v[56:59], a[16:23], v4
    v_smfmac_f32_16x16x64_bf16 v[28:31], v[56:59], a[96:103], v4
    ds_read_b128 v[76:79], v6 offset:8192
    ds_read_b128 v[80:83], v6 offset:9216
    v_smfmac_f32_16x16x64_bf16 v[32:35], v[56:59], a[176:183], v4
    v_smfmac_f32_16x16x64_bf16 v[36:39], v[56:59], v[112:119], v4
    v_smfmac_f32_16x16x64_bf16 v[40:43], v[56:59], v[192:199], v4
    s_waitcnt lgkmcnt(6)
    v_smfmac_f32_16x16x64_bf16 v[44:47], v[56:59], v[84:91], v4
    ds_read_b128 v[56:59], v5 offset:7168
    v_smfmac_f32_16x16x64_bf16 v[24:27], v[60:63], a[24:31], v4
    v_smfmac_f32_16x16x64_bf16 v[28:31], v[60:63], a[104:111], v4
    ds_read_b128 v[84:87], v6 offset:10240
    ds_read_b128 v[88:91], v6 offset:11264
    v_smfmac_f32_16x16x64_bf16 v[32:35], v[60:63], a[184:191], v4
    v_smfmac_f32_16x16x64_bf16 v[36:39], v[60:63], v[120:127], v4
    v_smfmac_f32_16x16x64_bf16 v[40:43], v[60:63], v[200:207], v4
    s_waitcnt lgkmcnt(6)
    v_smfmac_f32_16x16x64_bf16 v[44:47], v[60:63], v[68:75], v4
    ds_read_b128 v[60:63], v5 offset:8192
    v_smfmac_f32_16x16x64_bf16 v[24:27], v[64:67], a[32:39], v4
    v_smfmac_f32_16x16x64_bf16 v[28:31], v[64:67], a[112:119], v4
    ds_read_b128 v[68:71], v6 offset:12288
    ds_read_b128 v[72:75], v6 offset:13312
    v_smfmac_f32_16x16x64_bf16 v[32:35], v[64:67], a[192:199], v4
    v_smfmac_f32_16x16x64_bf16 v[36:39], v[64:67], v[128:135], v4
    v_smfmac_f32_16x16x64_bf16 v[40:43], v[64:67], v[208:215], v4
    s_waitcnt lgkmcnt(6)
    v_smfmac_f32_16x16x64_bf16 v[44:47], v[64:67], v[76:83], v4
    ds_read_b128 v[64:67], v5 offset:9216
    v_smfmac_f32_16x16x64_bf16 v[24:27], v[48:51], a[40:47], v4
    v_smfmac_f32_16x16x64_bf16 v[28:31], v[48:51], a[120:127], v4
    ds_read_b128 v[76:79], v6 offset:14336
    ds_read_b128 v[80:83], v6 offset:15360
    v_smfmac_f32_16x16x64_bf16 v[32:35], v[48:51], a[200:207], v4
    v_smfmac_f32_16x16x64_bf16 v[36:39], v[48:51], v[136:143], v4
    v_smfmac_f32_16x16x64_bf16 v[40:43], v[48:51], v[216:223], v4
    s_waitcnt lgkmcnt(6)
    v_smfmac_f32_16x16x64_bf16 v[44:47], v[48:51], v[84:91], v4
    v_smfmac_f32_16x16x64_bf16 v[24:27], v[52:55], a[48:55], v4
    v_smfmac_f32_16x16x64_bf16 v[28:31], v[52:55], a[128:135], v4
    ds_read_b128 v[84:87], v6 offset:16384
    ds_read_b128 v[88:91], v6 offset:17408
    v_smfmac_f32_16x16x64_bf16 v[32:35], v[52:55], a[208:215], v4
    v_smfmac_f32_16x16x64_bf16 v[36:39], v[52:55], v[144:151], v4
    v_smfmac_f32_16x16x64_bf16 v[40:43], v[52:55], v[224:231], v4
    s_waitcnt lgkmcnt(5)
    v_smfmac_f32_16x16x64_bf16 v[44:47], v[52:55], v[68:75], v4
    v_smfmac_f32_16x16x64_bf16 v[24:27], v[56:59], a[56:63], v4
    v_smfmac_f32_16x16x64_bf16 v[28:31], v[56:59], a[136:143], v4
    ds_read_b128 v[68:71], v6 offset:18432
    ds_read_b128 v[72:75], v6 offset:19456
    v_smfmac_f32_16x16x64_bf16 v[32:35], v[56:59], a[216:223], v4
    v_smfmac_f32_16x16x64_bf16 v[36:39], v[56:59], v[152:159], v4
    v_smfmac_f32_16x16x64_bf16 v[40:43], v[56:59], v[232:239], v4
    s_waitcnt lgkmcnt(4)
    v_smfmac_f32_16x16x64_bf16 v[44:47], v[56:59], v[76:83], v4
    v_smfmac_f32_16x16x64_bf16 v[24:27], v[60:63], a[64:71], v4
    v_smfmac_f32_16x16x64_bf16 v[28:31], v[60:63], a[144:151], v4
    v_smfmac_f32_16x16x64_bf16 v[32:35], v[60:63], a[224:231], v4
    v_smfmac_f32_16x16x64_bf16 v[36:39], v[60:63], v[160:167], v4
    v_smfmac_f32_16x16x64_bf16 v[40:43], v[60:63], v[240:247], v4
    s_waitcnt lgkmcnt(2)
    v_smfmac_f32_16x16x64_bf16 v[44:47], v[60:63], v[84:91], v4
    v_smfmac_f32_16x16x64_bf16 v[24:27], v[64:67], a[72:79], v4
    v_smfmac_f32_16x16x64_bf16 v[28:31], v[64:67], a[152:159], v4
    v_smfmac_f32_16x16x64_bf16 v[32:35], v[64:67], a[232:239], v4
    v_smfmac_f32_16x16x64_bf16 v[36:39], v[64:67], v[168:175], v4
    v_smfmac_f32_16x16x64_bf16 v[40:43], v[64:67], v[248:255], v4
    s_waitcnt lgkmcnt(0)
    v_smfmac_f32_16x16x64_bf16 v[44:47], v[64:67], v[68:75], v4
    s_nop 8
    v_permlane32_swap_b32 v24, v36
    v_permlane32_swap_b32 v25, v37
    v_permlane32_swap_b32 v26, v38
    v_permlane32_swap_b32 v27, v39
    v_add_f32 v24, v24, v36
    v_add_f32 v25, v25, v37
    v_add_f32 v26, v26, v38
    v_add_f32 v27, v27, v39
    v_cvt_pk_bf16_f32 v48, v24, v25
    v_cvt_pk_bf16_f32 v49, v26, v27
    ds_write_b64 v9, v[48:49] offset:0
    v_permlane32_swap_b32 v28, v40
    v_permlane32_swap_b32 v29, v41
    v_permlane32_swap_b32 v30, v42
    v_permlane32_swap_b32 v31, v43
    v_add_f32 v28, v28, v40
    v_add_f32 v29, v29, v41
    v_add_f32 v30, v30, v42
    v_add_f32 v31, v31, v43
    v_cvt_pk_bf16_f32 v50, v28, v29
    v_cvt_pk_bf16_f32 v51, v30, v31
    ds_write_b64 v9, v[50:51] offset:512
    v_permlane32_swap_b32 v32, v44
    v_permlane32_swap_b32 v33, v45
    v_permlane32_swap_b32 v34, v46
    v_permlane32_swap_b32 v35, v47
    v_add_f32 v32, v32, v44
    v_add_f32 v33, v33, v45
    v_add_f32 v34, v34, v46
    v_add_f32 v35, v35, v47
    v_cvt_pk_bf16_f32 v52, v32, v33
    v_cvt_pk_bf16_f32 v53, v34, v35
    ds_write_b64 v9, v[52:53] offset:1024
    s_waitcnt lgkmcnt(0)
    ds_read_b64_tr_b16 v[56:57], v10
    ds_read_b64_tr_b16 v[58:59], v10 offset:128
    ds_read_b64_tr_b16 v[60:61], v11 offset:1024
    s_waitcnt lgkmcnt(0)
    buffer_store_dwordx4 v[56:59], v21, s[8:11], s42 offen
    buffer_store_dwordx2 v[60:61], v22, s[8:11], s42 offen
    s_cmp_eq_u32 s40, 63
    s_cbranch_scc1 chainz_kernel_end
    v_mfma_f32_16x16x32_bf16 v[64:67], a[240:243], v[56:59], 0
    v_mfma_f32_16x16x32_bf16 v[68:71], a[246:249], v[56:59], 0
    v_mfma_f32_16x16x32_bf16 v[72:75], v[56:59], v[56:59], 0
    s_nop 3
    v_mfma_f32_16x16x16_bf16 v[64:67], a[244:245], v[60:61], v[64:67]
    v_mfma_f32_16x16x16_bf16 v[68:71], a[250:251], v[60:61], v[68:71]
    v_mfma_f32_16x16x16_bf16 v[72:75], v[60:61], v[60:61], v[72:75]
    s_nop 5
    ds_write_b128 v12, v[64:67]
    ds_write_b128 v12, v[68:71] offset:16
    ds_write_b128 v13, v[72:75]
    s_waitcnt lgkmcnt(0)
    s_barrier
    ds_read_b128 v[48:51], v14 offset:0
    ds_read_b128 v[52:55], v14 offset:16
    ds_read_b128 v[56:59], v14 offset:1408
    ds_read_b128 v[60:63], v14 offset:1424
    ds_read_b128 v[64:67], v14 offset:2816
    ds_read_b128 v[68:71], v14 offset:2832
    ds_read_b128 v[72:75], v14 offset:4224
    ds_read_b128 v[76:79], v14 offset:4240
    s_waitcnt lgkmcnt(4)
    v_pk_add_f32 v[48:49], v[48:49], v[56:57]
    v_pk_add_f32 v[50:51], v[50:51], v[58:59]
    v_pk_add_f32 v[52:53], v[52:53], v[60:61]
    v_pk_add_f32 v[54:55], v[54:55], v[62:63]
    s_waitcnt lgkmcnt(0)
    v_pk_add_f32 v[64:65], v[64:65], v[72:73]
    v_pk_add_f32 v[66:67], v[66:67], v[74:75]
    v_pk_add_f32 v[68:69], v[68:69], v[76:77]
    v_pk_add_f32 v[70:71], v[70:71], v[78:79]
    v_pk_add_f32 v[48:49], v[48:49], v[64:65]
    v_pk_add_f32 v[50:51], v[50:51], v[66:67]
    v_pk_add_f32 v[52:53], v[52:53], v[68:69]
    v_pk_add_f32 v[54:55], v[54:55], v[70:71]
    v_max3_f32 v80, v48, v49, v50
    v_max3_f32 v80, v80, v51, v52
    v_max3_f32 v80, v80, v53, v54
    v_max_f32 v80, v80, v55
    v_mov_b32 v81, 0xff800000
    v_cndmask_b32 v80, v81, v80, s[50:51]
    s_nop 1
    v_max_f32 v80, v80, v80 quad_perm:[1,0,3,2] row_mask:0xf bank_mask:0xf
    s_nop 1
    v_max_f32 v80, v80, v80 quad_perm:[2,3,0,1] row_mask:0xf bank_mask:0xf
    s_nop 1
    v_max_f32 v80, v80, v80 row_half_mirror row_mask:0xf bank_mask:0xf
    s_mov_b32 s24, 0x3dd53b95
    v_mul_f32 v80, s24, v80
    v_fma_f32 v48, v48, s24, -v80
    v_fma_f32 v49, v49, s24, -v80
    v_fma_f32 v50, v50, s24, -v80
    v_fma_f32 v51, v51, s24, -v80
    v_fma_f32 v52, v52, s24, -v80
    v_fma_f32 v53, v53, s24, -v80
    v_fma_f32 v54, v54, s24, -v80
    v_fma_f32 v55, v55, s24, -v80
    v_exp_f32 v48, v48
    v_exp_f32 v49, v49
    v_exp_f32 v50, v50
    v_exp_f32 v51, v51
    v_exp_f32 v52, v52
    v_exp_f32 v53, v53
    v_exp_f32 v54, v54
    v_exp_f32 v55, v55
    v_add_f32 v80, v48, v49
    v_add_f32 v81, v50, v51
    v_add_f32 v80, v80, v52
    v_add_f32 v81, v81, v53
    v_add_f32 v80, v80, v54
    v_add_f32 v81, v81, v55
    v_add_f32 v80, v80, v81
    v_cndmask_b32 v80, 0, v80, s[50:51]
    s_nop 1
    v_add_f32 v80, v80, v80 quad_perm:[1,0,3,2] row_mask:0xf bank_mask:0xf
    s_nop 1
    v_add_f32 v80, v80, v80 quad_perm:[2,3,0,1] row_mask:0xf bank_mask:0xf
    s_nop 1
    v_add_f32 v80, v80, v80 row_half_mirror row_mask:0xf bank_mask:0xf
    v_rcp_f32 v80, v80
    s_nop 0
    v_mul_f32 v48, v48, v80
    v_mul_f32 v49, v49, v80
    v_mul_f32 v50, v50, v80
    v_mul_f32 v51, v51, v80
    v_mul_f32 v52, v52, v80
    v_mul_f32 v53, v53, v80
    v_mul_f32 v54, v54, v80
    v_mul_f32 v55, v55, v80
    v_cvt_pk_bf16_f32 v56, v48, v49
    v_cvt_pk_bf16_f32 v57, v50, v51
    v_cvt_pk_bf16_f32 v58, v52, v53
    v_cvt_pk_bf16_f32 v59, v54, v55
    v_min_u32 v56, -2, v56
    v_min_u32 v57, -2, v57
    v_min_u32 v58, -2, v58
    v_min_u32 v59, -2, v59
    buffer_store_dwordx4 v[56:59], v15, s[8:11], s43 offen sc1
    s_add_u32 s40, s40, 1
    s_add_u32 s41, s41, 393216
    s_add_u32 s42, s42, 98304
    s_add_u32 s43, s43, 81920
    s_add_u32 s47, s47, 40960
    s_add_u32 s24, s41, 196608
    buffer_load_dwordx4 a[240:243], v19, s[8:11], s41 offen
    buffer_load_dwordx2 a[244:245], v20, s[8:11], s41 offen
    buffer_load_dwordx4 a[246:249], v19, s[8:11], s24 offen
    buffer_load_dwordx2 a[250:251], v20, s[8:11], s24 offen
    s_branch chainz_kernel_s_step
chainz_kernel_s_go:
    v_mov_b32 v24, 0
    v_mov_b32 v25, 0
    v_mov_b32 v26, 0
    v_mov_b32 v27, 0
    v_mov_b32 v28, 0
    v_mov_b32 v29, 0
    v_mov_b32 v30, 0
    v_mov_b32 v31, 0
    v_mov_b32 v32, 0
    v_mov_b32 v33, 0
    v_mov_b32 v34, 0
    v_mov_b32 v35, 0
    v_mov_b32 v36, 0
    v_mov_b32 v37, 0
    v_mov_b32 v38, 0
    v_mov_b32 v39, 0
    v_mov_b32 v40, 0
    v_mov_b32 v41, 0
    v_mov_b32 v42, 0
    v_mov_b32 v43, 0
    v_mov_b32 v44, 0
    v_mov_b32 v45, 0
    v_mov_b32 v46, 0
    v_mov_b32 v47, 0
    s_waitcnt vmcnt(0)
    s_branch chainz_kernel_s_go2
chainz_kernel_roleV:
    s_sub_u32 s44, s2, 32
    s_load_dwordx2 s[6:7], s[0:1], 56
    s_load_dwordx2 s[24:25], s[0:1], 64
    s_waitcnt lgkmcnt(0)
    s_mov_b32 s12, s6
    s_mov_b32 s13, s7
    s_mov_b32 s14, 7864320
    s_mov_b32 s15, 0x00020000
    s_mov_b32 s16, s24
    s_mov_b32 s17, s25
    s_mov_b32 s18, 7864320
    s_mov_b32 s19, 0x00020000
    v_add_u32 v16, 0, v0
    s_mov_b32 s24, 683
    v_mul_lo_u32 v17, v16, s24
    v_lshrrev_b32 v17, 14, v17
    v_mul_u32_u24 v18, 24, v17
    v_sub_u32 v18, v16, v18
    s_mov_b32 s24, 12288
    v_mul_lo_u32 v4, v17, s24
    v_lshl_add_u32 v4, v18, 4, v4
    v_mul_u32_u24 v10, 400, v17
    v_lshl_add_u32 v10, v18, 4, v10
    v_add_u32 v10, 90112, v10
    v_add_u32 v16, 256, v0
    s_mov_b32 s24, 683
    v_mul_lo_u32 v17, v16, s24
    v_lshrrev_b32 v17, 14, v17
    v_mul_u32_u24 v18, 24, v17
    v_sub_u32 v18, v16, v18
    s_mov_b32 s24, 12288
    v_mul_lo_u32 v5, v17, s24
    v_lshl_add_u32 v5, v18, 4, v5
    v_mul_u32_u24 v11, 400, v17
    v_lshl_add_u32 v11, v18, 4, v11
    v_add_u32 v11, 90112, v11
    v_add_u32 v16, 512, v0
    s_mov_b32 s24, 683
    v_mul_lo_u32 v17, v16, s24
    v_lshrrev_b32 v17, 14, v17
    v_mul_u32_u24 v18, 24, v17
    v_sub_u32 v18, v16, v18
    s_mov_b32 s24, 12288
    v_mul_lo_u32 v6, v17, s24
    v_lshl_add_u32 v6, v18, 4, v6
    v_mul_u32_u24 v12, 400, v17
    v_lshl_add_u32 v12, v18, 4, v12
    v_add_u32 v12, 90112, v12
    v_add_u32 v16, 768, v0
    s_mov_b32 s24, 683
    v_mul_lo_u32 v17, v16, s24
    v_lshrrev_b32 v17, 14, v17
    v_mul_u32_u24 v18, 24, v17
    v_sub_u32 v18, v16, v18
    s_mov_b32 s24, 12288
    v_mul_lo_u32 v7, v17, s24
    v_lshl_add_u32 v7, v18, 4, v7
    v_mul_u32_u24 v13, 400, v17
    v_lshl_add_u32 v13, v18, 4, v13
    v_add_u32 v13, 90112, v13
    v_add_u32 v16, 1024, v0
    s_mov_b32 s24, 683
    v_mul_lo_u32 v17, v16, s24
    v_lshrrev_b32 v17, 14, v17
    v_mul_u32_u24 v18, 24, v17
    v_sub_u32 v18, v16, v18
    s_mov_b32 s24, 12288
    v_mul_lo_u32 v8, v17, s24
    v_lshl_add_u32 v8, v18, 4, v8
    v_mul_u32_u24 v14, 400, v17
    v_lshl_add_u32 v14, v18, 4, v14
    v_add_u32 v14, 90112, v14
    v_add_u32 v16, 1280, v0
    s_mov_b32 s24, 683
    v_mul_lo_u32 v17, v16, s24
    v_lshrrev_b32 v17, 14, v17
    v_mul_u32_u24 v18, 24, v17
    v_sub_u32 v18, v16, v18
    s_mov_b32 s24, 12288
    v_mul_lo_u32 v9, v17, s24
    v_lshl_add_u32 v9, v18, 4, v9
    v_mul_u32_u24 v15, 400, v17
    v_lshl_add_u32 v15, v18, 4, v15
    v_add_u32 v15, 90112, v15
    v_lshrrev_b32 v17, 1, v3
    v_lshlrev_b32 v17, 4, v17
    v_and_b32 v18, 1, v3
    v_lshl_add_u32 v17, v18, 2, v17
    v_lshrrev_b32 v18, 2, v2
    v_and_b32 v19, 1, v18
    v_add_u32 v17, v17, v19
    v_lshrrev_b32 v18, 1, v18
    v_lshl_add_u32 v17, v18, 3, v17
    v_mul_u32_u24 v16, 400, v17
    v_and_b32 v18, 3, v2
    v_lshl_add_u32 v16, v18, 3, v16
    v_add_u32 v16, 90112, v16
    s_mul_i32 s24, s3, 96
    v_add_u32 v16, s24, v16
    s_mul_i32 s45, s44, 384
    s_add_u32 s46, s45, 0
    buffer_load_dwordx4 v[24:27], v4, s[12:15], s46 offen
    buffer_load_dwordx4 v[28:31], v5, s[12:15], s46 offen
    buffer_load_dwordx4 v[32:35], v6, s[12:15], s46 offen
    buffer_load_dwordx4 v[36:39], v7, s[12:15], s46 offen
    buffer_load_dwordx4 v[40:43], v8, s[12:15], s46 offen
    buffer_load_dwordx4 v[44:47], v9, s[12:15], s46 offen
    s_add_u32 s46, s45, 786432
    buffer_load_dwordx4 v[48:51], v4, s[12:15], s46 offen
    buffer_load_dwordx4 v[52:55], v5, s[12:15], s46 offen
    buffer_load_dwordx4 v[56:59], v6, s[12:15], s46 offen
    buffer_load_dwordx4 v[60:63], v7, s[12:15], s46 offen
    buffer_load_dwordx4 v[64:67], v8, s[12:15], s46 offen
    buffer_load_dwordx4 v[68:71], v9, s[12:15], s46 offen
    s_waitcnt vmcnt(6)
    ds_write_b128 v10, v[24:27]
    ds_write_b128 v11, v[28:31]
    ds_write_b128 v12, v[32:35]
    ds_write_b128 v13, v[36:39]
    ds_write_b128 v14, v[40:43]
    ds_write_b128 v15, v[44:47]
    s_add_u32 s46, s45, 1572864
    buffer_load_dwordx4 v[72:75], v4, s[12:15], s46 offen
    buffer_load_dwordx4 v[76:79], v5, s[12:15], s46 offen
    buffer_load_dwordx4 v[80:83], v6, s[12:15], s46 offen
    buffer_load_dwordx4 v[84:87], v7, s[12:15], s46 offen
    buffer_load_dwordx4 v[88:91], v8, s[12:15], s46 offen
    buffer_load_dwordx4 v[92:95], v9, s[12:15], s46 offen
    s_waitcnt lgkmcnt(0)
    s_barrier
    ds_read_b64_tr_b16 a[0:1], v16 offset:0
    ds_read_b64_tr_b16 a[2:3], v16 offset:800
    ds_read_b64_tr_b16 a[4:5], v16 offset:12800
    ds_read_b64_tr_b16 a[6:7], v16 offset:13600
    ds_read_b64_tr_b16 a[80:81], v16 offset:32
    ds_read_b64_tr_b16 a[82:83], v16 offset:832
    ds_read_b64_tr_b16 a[84:85], v16 offset:12832
    ds_read_b64_tr_b16 a[86:87], v16 offset:13632
    ds_read_b64_tr_b16 a[160:161], v16 offset:64
    ds_read_b64_tr_b16 a[162:163], v16 offset:864
    ds_read_b64_tr_b16 a[164:165], v16 offset:12864
    ds_read_b64_tr_b16 a[166:167], v16 offset:13664
    s_waitcnt lgkmcnt(0)
    s_barrier
    s_waitcnt vmcnt(6)
    ds_write_b128 v10, v[48:51]
    ds_write_b128 v11, v[52:55]
    ds_write_b128 v12, v[56:59]
    ds_write_b128 v13, v[60:63]
    ds_write_b128 v14, v[64:67]
    ds_write_b128 v15, v[68:71]
    s_add_u32 s46, s45, 2359296
    buffer_load_dwordx4 v[24:27], v4, s[12:15], s46 offen
    buffer_load_dwordx4 v[28:31], v5, s[12:15], s46 offen
    buffer_load_dwordx4 v[32:35], v6, s[12:15], s46 offen
    buffer_load_dwordx4 v[36:39], v7, s[12:15], s46 offen
    buffer_load_dwordx4 v[40:43], v8, s[12:15], s46 offen
    buffer_load_dwordx4 v[44:47], v9, s[12:15], s46 offen
    s_waitcnt lgkmcnt(0)
    s_barrier
    ds_read_b64_tr_b16 a[8:9], v16 offset:0
    ds_read_b64_tr_b16 a[10:11], v16 offset:800
    ds_read_b64_tr_b16 a[12:13], v16 offset:12800
    ds_read_b64_tr_b16 a[14:15], v16 offset:13600
    ds_read_b64_tr_b16 a[88:89], v16 offset:32
    ds_read_b64_tr_b16 a[90:91], v16 offset:832
    ds_read_b64_tr_b16 a[92:93], v16 offset:12832
    ds_read_b64_tr_b16 a[94:95], v16 offset:13632
    ds_read_b64_tr_b16 a[168:169], v16 offset:64
    ds_read_b64_tr_b16 a[170:171], v16 offset:864
    ds_read_b64_tr_b16 a[172:173], v16 offset:12864
    ds_read_b64_tr_b16 a[174:175], v16 offset:13664
    s_waitcnt lgkmcnt(0)
    s_barrier
    s_waitcnt vmcnt(6)
    ds_write_b128 v10, v[72:75]
    ds_write_b128 v11, v[76:79]
    ds_write_b128 v12, v[80:83]
    ds_write_b128 v13, v[84:87]
    ds_write_b128 v14, v[88:91]
    ds_write_b128 v15, v[92:95]
    s_add_u32 s46, s45, 3145728
    buffer_load_dwordx4 v[48:51], v4, s[12:15], s46 offen
    buffer_load_dwordx4 v[52:55], v5, s[12:15], s46 offen
    buffer_load_dwordx4 v[56:59], v6, s[12:15], s46 offen
    buffer_load_dwordx4 v[60:63], v7, s[12:15], s46 offen
    buffer_load_dwordx4 v[64:67], v8, s[12:15], s46 offen
    buffer_load_dwordx4 v[68:71], v9, s[12:15], s46 offen
    s_waitcnt lgkmcnt(0)
    s_barrier
    ds_read_b64_tr_b16 a[16:17], v16 offset:0
    ds_read_b64_tr_b16 a[18:19], v16 offset:800
    ds_read_b64_tr_b16 a[20:21], v16 offset:12800
    ds_read_b64_tr_b16 a[22:23], v16 offset:13600
    ds_read_b64_tr_b16 a[96:97], v16 offset:32
    ds_read_b64_tr_b16 a[98:99], v16 offset:832
    ds_read_b64_tr_b16 a[100:101], v16 offset:12832
    ds_read_b64_tr_b16 a[102:103], v16 offset:13632
    ds_read_b64_tr_b16 a[176:177], v16 offset:64
    ds_read_b64_tr_b16 a[178:179], v16 offset:864
    ds_read_b64_tr_b16 a[180:181], v16 offset:12864
    ds_read_b64_tr_b16 a[182:183], v16 offset:13664
    s_waitcnt lgkmcnt(0)
    s_barrier
    s_waitcnt vmcnt(6)
    ds_write_b128 v10, v[24:27]
    ds_write_b128 v11, v[28:31]
    ds_write_b128 v12, v[32:35]
    ds_write_b128 v13, v[36:39]
    ds_write_b128 v14, v[40:43]
    ds_write_b128 v15, v[44:47]
    s_add_u32 s46, s45, 3932160
    buffer_load_dwordx4 v[72:75], v4, s[12:15], s46 offen
    buffer_load_dwordx4 v[76:79], v5, s[12:15], s46 offen
    buffer_load_dwordx4 v[80:83], v6, s[12:15], s46 offen
    buffer_load_dwordx4 v[84:87], v7, s[12:15], s46 offen
    buffer_load_dwordx4 v[88:91], v8, s[12:15], s46 offen
    buffer_load_dwordx4 v[92:95], v9, s[12:15], s46 offen
    s_waitcnt lgkmcnt(0)
    s_barrier
    ds_read_b64_tr_b16 a[24:25], v16 offset:0
    ds_read_b64_tr_b16 a[26:27], v16 offset:800
    ds_read_b64_tr_b16 a[28:29], v16 offset:12800
    ds_read_b64_tr_b16 a[30:31], v16 offset:13600
    ds_read_b64_tr_b16 a[104:105], v16 offset:32
    ds_read_b64_tr_b16 a[106:107], v16 offset:832
    ds_read_b64_tr_b16 a[108:109], v16 offset:12832
    ds_read_b64_tr_b16 a[110:111], v16 offset:13632
    ds_read_b64_tr_b16 a[184:185], v16 offset:64
    ds_read_b64_tr_b16 a[186:187], v16 offset:864
    ds_read_b64_tr_b16 a[188:189], v16 offset:12864
    ds_read_b64_tr_b16 a[190:191], v16 offset:13664
    s_waitcnt lgkmcnt(0)
    s_barrier
    s_waitcnt vmcnt(6)
    ds_write_b128 v10, v[48:51]
    ds_write_b128 v11, v[52:55]
    ds_write_b128 v12, v[56:59]
    ds_write_b128 v13, v[60:63]
    ds_write_b128 v14, v[64:67]
    ds_write_b128 v15, v[68:71]
    s_add_u32 s46, s45, 4718592
    buffer_load_dwordx4 v[24:27], v4, s[12:15], s46 offen
    buffer_load_dwordx4 v[28:31], v5, s[12:15], s46 offen
    buffer_load_dwordx4 v[32:35], v6, s[12:15], s46 offen
    buffer_load_dwordx4 v[36:39], v7, s[12:15], s46 offen
    buffer_load_dwordx4 v[40:43], v8, s[12:15], s46 offen
    buffer_load_dwordx4 v[44:47], v9, s[12:15], s46 offen
    s_waitcnt lgkmcnt(0)
    s_barrier
    ds_read_b64_tr_b16 a[32:33], v16 offset:0
    ds_read_b64_tr_b16 a[34:35], v16 offset:800
    ds_read_b64_tr_b16 a[36:37], v16 offset:12800
    ds_read_b64_tr_b16 a[38:39], v16 offset:13600
    ds_read_b64_tr_b16 a[112:113], v16 offset:32
    ds_read_b64_tr_b16 a[114:115], v16 offset:832
    ds_read_b64_tr_b16 a[116:117], v16 offset:12832
    ds_read_b64_tr_b16 a[118:119], v16 offset:13632
    ds_read_b64_tr_b16 a[192:193], v16 offset:64
    ds_read_b64_tr_b16 a[194:195], v16 offset:864
    ds_read_b64_tr_b16 a[196:197], v16 offset:12864
    ds_read_b64_tr_b16 a[198:199], v16 offset:13664
    s_waitcnt lgkmcnt(0)
    s_barrier
    s_waitcnt vmcnt(6)
    ds_write_b128 v10, v[72:75]
    ds_write_b128 v11, v[76:79]
    ds_write_b128 v12, v[80:83]
    ds_write_b128 v13, v[84:87]
    ds_write_b128 v14, v[88:91]
    ds_write_b128 v15, v[92:95]
    s_add_u32 s46, s45, 5505024
    buffer_load_dwordx4 v[48:51], v4, s[12:15], s46 offen
    buffer_load_dwordx4 v[52:55], v5, s[12:15], s46 offen
    buffer_load_dwordx4 v[56:59], v6, s[12:15], s46 offen
    buffer_load_dwordx4 v[60:63], v7, s[12:15], s46 offen
    buffer_load_dwordx4 v[64:67], v8, s[12:15], s46 offen
    buffer_load_dwordx4 v[68:71], v9, s[12:15], s46 offen
    s_waitcnt lgkmcnt(0)
    s_barrier
    ds_read_b64_tr_b16 a[40:41], v16 offset:0
    ds_read_b64_tr_b16 a[42:43], v16 offset:800
    ds_read_b64_tr_b16 a[44:45], v16 offset:12800
    ds_read_b64_tr_b16 a[46:47], v16 offset:13600
    ds_read_b64_tr_b16 a[120:121], v16 offset:32
    ds_read_b64_tr_b16 a[122:123], v16 offset:832
    ds_read_b64_tr_b16 a[124:125], v16 offset:12832
    ds_read_b64_tr_b16 a[126:127], v16 offset:13632
    ds_read_b64_tr_b16 a[200:201], v16 offset:64
    ds_read_b64_tr_b16 a[202:203], v16 offset:864
    ds_read_b64_tr_b16 a[204:205], v16 offset:12864
    ds_read_b64_tr_b16 a[206:207], v16 offset:13664
    s_waitcnt lgkmcnt(0)
    s_barrier
    s_waitcnt vmcnt(6)
    ds_write_b128 v10, v[24:27]
    ds_write_b128 v11, v[28:31]
    ds_write_b128 v12, v[32:35]
    ds_write_b128 v13, v[36:39]
    ds_write_b128 v14, v[40:43]
    ds_write_b128 v15, v[44:47]
    s_add_u32 s46, s45, 6291456
    buffer_load_dwordx4 v[72:75], v4, s[12:15], s46 offen
    buffer_load_dwordx4 v[76:79], v5, s[12:15], s46 offen
    buffer_load_dwordx4 v[80:83], v6, s[12:15], s46 offen
    buffer_load_dwordx4 v[84:87], v7, s[12:15], s46 offen
    buffer_load_dwordx4 v[88:91], v8, s[12:15], s46 offen
    buffer_load_dwordx4 v[92:95], v9, s[12:15], s46 offen
    s_waitcnt lgkmcnt(0)
    s_barrier
    ds_read_b64_tr_b16 a[48:49], v16 offset:0
    ds_read_b64_tr_b16 a[50:51], v16 offset:800
    ds_read_b64_tr_b16 a[52:53], v16 offset:12800
    ds_read_b64_tr_b16 a[54:55], v16 offset:13600
    ds_read_b64_tr_b16 a[128:129], v16 offset:32
    ds_read_b64_tr_b16 a[130:131], v16 offset:832
    ds_read_b64_tr_b16 a[132:133], v16 offset:12832
    ds_read_b64_tr_b16 a[134:135], v16 offset:13632
    ds_read_b64_tr_b16 a[208:209], v16 offset:64
    ds_read_b64_tr_b16 a[210:211], v16 offset:864
    ds_read_b64_tr_b16 a[212:213], v16 offset:12864
    ds_read_b64_tr_b16 a[214:215], v16 offset:13664
    s_waitcnt lgkmcnt(0)
    s_barrier
    s_waitcnt vmcnt(6)
    ds_write_b128 v10, v[48:51]
    ds_write_b128 v11, v[52:55]
    ds_write_b128 v12, v[56:59]
    ds_write_b128 v13, v[60:63]
    ds_write_b128 v14, v[64:67]
    ds_write_b128 v15, v[68:71]
    s_add_u32 s46, s45, 7077888
    buffer_load_dwordx4 v[24:27], v4, s[12:15], s46 offen
    buffer_load_dwordx4 v[28:31], v5, s[12:15], s46 offen
    buffer_load_dwordx4 v[32:35], v6, s[12:15], s46 offen
    buffer_load_dwordx4 v[36:39], v7, s[12:15], s46 offen
    buffer_load_dwordx4 v[40:43], v8, s[12:15], s46 offen
    buffer_load_dwordx4 v[44:47], v9, s[12:15], s46 offen
    s_waitcnt lgkmcnt(0)
    s_barrier
    ds_read_b64_tr_b16 a[56:57], v16 offset:0
    ds_read_b64_tr_b16 a[58:59], v16 offset:800
    ds_read_b64_tr_b16 a[60:61], v16 offset:12800
    ds_read_b64_tr_b16 a[62:63], v16 offset:13600
    ds_read_b64_tr_b16 a[136:137], v16 offset:32
    ds_read_b64_tr_b16 a[138:139], v16 offset:832
    ds_read_b64_tr_b16 a[140:141], v16 offset:12832
    ds_read_b64_tr_b16 a[142:143], v16 offset:13632
    ds_read_b64_tr_b16 a[216:217], v16 offset:64
    ds_read_b64_tr_b16 a[218:219], v16 offset:864
    ds_read_b64_tr_b16 a[220:221], v16 offset:12864
    ds_read_b64_tr_b16 a[222:223], v16 offset:13664
    s_waitcnt lgkmcnt(0)
    s_barrier
    s_waitcnt vmcnt(6)
    ds_write_b128 v10, v[72:75]
    ds_write_b128 v11, v[76:79]
    ds_write_b128 v12, v[80:83]
    ds_write_b128 v13, v[84:87]
    ds_write_b128 v14, v[88:91]
    ds_write_b128 v15, v[92:95]
    s_waitcnt lgkmcnt(0)
    s_barrier
    ds_read_b64_tr_b16 a[64:65], v16 offset:0
    ds_read_b64_tr_b16 a[66:67], v16 offset:800
    ds_read_b64_tr_b16 a[68:69], v16 offset:12800
    ds_read_b64_tr_b16 a[70:71], v16 offset:13600
    ds_read_b64_tr_b16 a[144:145], v16 offset:32
    ds_read_b64_tr_b16 a[146:147], v16 offset:832
    ds_read_b64_tr_b16 a[148:149], v16 offset:12832
    ds_read_b64_tr_b16 a[150:151], v16 offset:13632
    ds_read_b64_tr_b16 a[224:225], v16 offset:64
    ds_read_b64_tr_b16 a[226:227], v16 offset:864
    ds_read_b64_tr_b16 a[228:229], v16 offset:12864
    ds_read_b64_tr_b16 a[230:231], v16 offset:13664
    s_waitcnt lgkmcnt(0)
    s_barrier
    s_waitcnt vmcnt(0)
    ds_write_b128 v10, v[24:27]
    ds_write_b128 v11, v[28:31]
    ds_write_b128 v12, v[32:35]
    ds_write_b128 v13, v[36:39]
    ds_write_b128 v14, v[40:43]
    ds_write_b128 v15, v[44:47]
    s_waitcnt lgkmcnt(0)
    s_barrier
    ds_read_b64_tr_b16 a[72:73], v16 offset:0
    ds_read_b64_tr_b16 a[74:75], v16 offset:800
    ds_read_b64_tr_b16 a[76:77], v16 offset:12800
    ds_read_b64_tr_b16 a[78:79], v16 offset:13600
    ds_read_b64_tr_b16 a[152:153], v16 offset:32
    ds_read_b64_tr_b16 a[154:155], v16 offset:832
    ds_read_b64_tr_b16 a[156:157], v16 offset:12832
    ds_read_b64_tr_b16 a[158:159], v16 offset:13632
    ds_read_b64_tr_b16 a[232:233], v16 offset:64
    ds_read_b64_tr_b16 a[234:235], v16 offset:864
    ds_read_b64_tr_b16 a[236:237], v16 offset:12864
    ds_read_b64_tr_b16 a[238:239], v16 offset:13664
    s_waitcnt lgkmcnt(0)
    s_barrier
    v_add_u32 v64, 0, v0
    s_mov_b32 s24, 1639
    v_mul_lo_u32 v65, v64, s24
    v_lshrrev_b32 v65, 16, v65
    v_mul_u32_u24 v66, 40, v65
    v_sub_u32 v66, v64, v66
    s_mov_b32 s24, 1280
    v_mul_lo_u32 v4, v65, s24
    v_lshl_add_u32 v4, v66, 4, v4
    v_mul_u32_u24 v14, 656, v65
    v_lshl_add_u32 v14, v66, 4, v14
    v_add_u32 v14, 90112, v14
    v_add_u32 v64, 256, v0
    s_mov_b32 s24, 1639
    v_mul_lo_u32 v65, v64, s24
    v_lshrrev_b32 v65, 16, v65
    v_mul_u32_u24 v66, 40, v65
    v_sub_u32 v66, v64, v66
    s_mov_b32 s24, 1280
    v_mul_lo_u32 v5, v65, s24
    v_lshl_add_u32 v5, v66, 4, v5
    v_mul_u32_u24 v15, 656, v65
    v_lshl_add_u32 v15, v66, 4, v15
    v_add_u32 v15, 90112, v15
    v_add_u32 v64, 512, v0
    s_mov_b32 s24, 1639
    v_mul_lo_u32 v65, v64, s24
    v_lshrrev_b32 v65, 16, v65
    v_mul_u32_u24 v66, 40, v65
    v_sub_u32 v66, v64, v66
    s_mov_b32 s24, 1280
    v_mul_lo_u32 v6, v65, s24
    v_lshl_add_u32 v6, v66, 4, v6
    v_mul_u32_u24 v16, 656, v65
    v_lshl_add_u32 v16, v66, 4, v16
    v_add_u32 v16, 90112, v16
    v_add_u32 v64, 768, v0
    s_mov_b32 s24, 1639
    v_mul_lo_u32 v65, v64, s24
    v_lshrrev_b32 v65, 16, v65
    v_mul_u32_u24 v66, 40, v65
    v_sub_u32 v66, v64, v66
    s_mov_b32 s24, 1280
    v_mul_lo_u32 v7, v65, s24
    v_lshl_add_u32 v7, v66, 4, v7
    v_mul_u32_u24 v17, 656, v65
    v_lshl_add_u32 v17, v66, 4, v17
    v_add_u32 v17, 90112, v17
    v_add_u32 v64, 1024, v0
    s_mov_b32 s24, 1639
    v_mul_lo_u32 v65, v64, s24
    v_lshrrev_b32 v65, 16, v65
    v_mul_u32_u24 v66, 40, v65
    v_sub_u32 v66, v64, v66
    s_mov_b32 s24, 1280
    v_mul_lo_u32 v8, v65, s24
    v_lshl_add_u32 v8, v66, 4, v8
    v_mul_u32_u24 v18, 656, v65
    v_lshl_add_u32 v18, v66, 4, v18
    v_add_u32 v18, 90112, v18
    v_add_u32 v64, 1280, v0
    s_mov_b32 s24, 1639
    v_mul_lo_u32 v65, v64, s24
    v_lshrrev_b32 v65, 16, v65
    v_mul_u32_u24 v66, 40, v65
    v_sub_u32 v66, v64, v66
    s_mov_b32 s24, 1280
    v_mul_lo_u32 v9, v65, s24
    v_lshl_add_u32 v9, v66, 4, v9
    v_mul_u32_u24 v19, 656, v65
    v_lshl_add_u32 v19, v66, 4, v19
    v_add_u32 v19, 90112, v19
    v_add_u32 v64, 1536, v0
    s_mov_b32 s24, 1639
    v_mul_lo_u32 v65, v64, s24
    v_lshrrev_b32 v65, 16, v65
    v_mul_u32_u24 v66, 40, v65
    v_sub_u32 v66, v64, v66
    s_mov_b32 s24, 1280
    v_mul_lo_u32 v10, v65, s24
    v_lshl_add_u32 v10, v66, 4, v10
    v_mul_u32_u24 v20, 656, v65
    v_lshl_add_u32 v20, v66, 4, v20
    v_add_u32 v20, 90112, v20
    v_add_u32 v64, 1792, v0
    s_mov_b32 s24, 1639
    v_mul_lo_u32 v65, v64, s24
    v_lshrrev_b32 v65, 16, v65
    v_mul_u32_u24 v66, 40, v65
    v_sub_u32 v66, v64, v66
    s_mov_b32 s24, 1280
    v_mul_lo_u32 v11, v65, s24
    v_lshl_add_u32 v11, v66, 4, v11
    v_mul_u32_u24 v21, 656, v65
    v_lshl_add_u32 v21, v66, 4, v21
    v_add_u32 v21, 90112, v21
    v_add_u32 v64, 2048, v0
    s_mov_b32 s24, 1639
    v_mul_lo_u32 v65, v64, s24
    v_lshrrev_b32 v65, 16, v65
    v_mul_u32_u24 v66, 40, v65
    v_sub_u32 v66, v64, v66
    s_mov_b32 s24, 1280
    v_mul_lo_u32 v12, v65, s24
    v_lshl_add_u32 v12, v66, 4, v12
    v_mul_u32_u24 v22, 656, v65
    v_lshl_add_u32 v22, v66, 4, v22
    v_add_u32 v22, 90112, v22
    v_add_u32 v64, 2304, v0
    s_mov_b32 s24, 1639
    v_mul_lo_u32 v65, v64, s24
    v_lshrrev_b32 v65, 16, v65
    v_mul_u32_u24 v66, 40, v65
    v_sub_u32 v66, v64, v66
    s_mov_b32 s24, 1280
    v_mul_lo_u32 v13, v65, s24
    v_lshl_add_u32 v13, v66, 4, v13
    v_mul_u32_u24 v23, 656, v65
    v_lshl_add_u32 v23, v66, 4, v23
    v_add_u32 v23, 90112, v23
    v_lshrrev_b32 v64, 1, v3
    v_lshlrev_b32 v64, 4, v64
    v_and_b32 v65, 1, v3
    v_lshl_add_u32 v64, v65, 2, v64
    v_lshrrev_b32 v65, 2, v2
    v_and_b32 v66, 1, v65
    v_add_u32 v64, v64, v66
    v_lshrrev_b32 v65, 1, v65
    v_lshl_add_u32 v64, v65, 3, v64
    v_mul_u32_u24 v72, 656, v64
    v_and_b32 v65, 3, v2
    v_lshl_add_u32 v72, v65, 3, v72
    v_add_u32 v72, 90112, v72
    s_and_b32 s24, s3, 1
    s_mul_i32 s24, s24, 320
    v_add_u32 v72, s24, v72
    v_lshlrev_b32 v73, 4, v1
    s_mul_i32 s24, s3, 18432
    s_add_u32 s24, s24, 16384
    v_add_u32 v73, s24, v73
    s_mul_i32 s45, s44, 245760
    s_add_u32 s46, s45, 0
    buffer_load_dwordx4 v[24:27], v4, s[16:19], s46 offen
    buffer_load_dwordx4 v[28:31], v5, s[16:19], s46 offen
    buffer_load_dwordx4 v[32:35], v6, s[16:19], s46 offen
    buffer_load_dwordx4 v[36:39], v7, s[16:19], s46 offen
    buffer_load_dwordx4 v[40:43], v8, s[16:19], s46 offen
    buffer_load_dwordx4 v[44:47], v9, s[16:19], s46 offen
    buffer_load_dwordx4 v[48:51], v10, s[16:19], s46 offen
    buffer_load_dwordx4 v[52:55], v11, s[16:19], s46 offen
    buffer_load_dwordx4 v[56:59], v12, s[16:19], s46 offen
    buffer_load_dwordx4 v[60:63], v13, s[16:19], s46 offen
    s_waitcnt vmcnt(0)
    ds_write_b128 v14, v[24:27]
    ds_write_b128 v15, v[28:31]
    ds_write_b128 v16, v[32:35]
    ds_write_b128 v17, v[36:39]
    ds_write_b128 v18, v[40:43]
    ds_write_b128 v19, v[44:47]
    ds_write_b128 v20, v[48:51]
    ds_write_b128 v21, v[52:55]
    ds_write_b128 v22, v[56:59]
    ds_write_b128 v23, v[60:63]
    s_waitcnt lgkmcnt(0)
    s_barrier
    s_lshr_b32 s24, s3, 1
    s_cmp_eq_u32 s24, 0
    s_cbranch_scc0 chainz_kernel_wo1
    ds_read_b64_tr_b16 a[240:241], v72 offset:0
    ds_read_b64_tr_b16 a[242:243], v72 offset:1312
    ds_read_b64_tr_b16 a[244:245], v72 offset:20992
    ds_read_b64_tr_b16 a[246:247], v72 offset:22304
    ds_read_b64_tr_b16 v[112:113], v72 offset:32
    ds_read_b64_tr_b16 v[114:115], v72 offset:1344
    ds_read_b64_tr_b16 v[116:117], v72 offset:21024
    ds_read_b64_tr_b16 v[118:119], v72 offset:22336
    ds_read_b64_tr_b16 v[136:137], v72 offset:64
    ds_read_b64_tr_b16 v[138:139], v72 offset:1376
    ds_read_b64_tr_b16 v[140:141], v72 offset:21056
    ds_read_b64_tr_b16 v[142:143], v72 offset:22368
    ds_read_b64_tr_b16 v[160:161], v72 offset:96
    ds_read_b64_tr_b16 v[162:163], v72 offset:1408
    ds_read_b64_tr_b16 v[164:165], v72 offset:21088
    ds_read_b64_tr_b16 v[166:167], v72 offset:22400
    ds_read_b64_tr_b16 v[184:185], v72 offset:128
    ds_read_b64_tr_b16 v[186:187], v72 offset:1440
    ds_read_b64_tr_b16 v[188:189], v72 offset:21120
    ds_read_b64_tr_b16 v[190:191], v72 offset:22432
    ds_read_b64_tr_b16 v[208:209], v72 offset:160
    ds_read_b64_tr_b16 v[210:211], v72 offset:1472
    ds_read_b64_tr_b16 v[212:213], v72 offset:21152
    ds_read_b64_tr_b16 v[214:215], v72 offset:22464
    ds_read_b64_tr_b16 v[232:233], v72 offset:192
    ds_read_b64_tr_b16 v[234:235], v72 offset:1504
    ds_read_b64_tr_b16 v[236:237], v72 offset:21184
    ds_read_b64_tr_b16 v[238:239], v72 offset:22496
    ds_read_b64_tr_b16 v[64:65], v72 offset:224
    ds_read_b64_tr_b16 v[66:67], v72 offset:1536
    ds_read_b64_tr_b16 v[68:69], v72 offset:21216
    ds_read_b64_tr_b16 v[70:71], v72 offset:22528
    s_waitcnt lgkmcnt(0)
    ds_write_b128 v73, v[64:67] offset:0
    ds_write_b128 v73, v[68:71] offset:1024
    s_waitcnt lgkmcnt(0)
    ds_read_b64_tr_b16 v[64:65], v72 offset:256
    ds_read_b64_tr_b16 v[66:67], v72 offset:1568
    ds_read_b64_tr_b16 v[68:69], v72 offset:21248
    ds_read_b64_tr_b16 v[70:71], v72 offset:22560
    s_waitcnt lgkmcnt(0)
    ds_write_b128 v73, v[64:67] offset:6144
    ds_write_b128 v73, v[68:71] offset:7168
    s_waitcnt lgkmcnt(0)
    ds_read_b64_tr_b16 v[64:65], v72 offset:288
    ds_read_b64_tr_b16 v[66:67], v72 offset:1600
    ds_read_b64_tr_b16 v[68:69], v72 offset:21280
    ds_read_b64_tr_b16 v[70:71], v72 offset:22592
    s_waitcnt lgkmcnt(0)
    ds_write_b128 v73, v[64:67] offset:12288
    ds_write_b128 v73, v[68:71] offset:13312
    s_waitcnt lgkmcnt(0)
    s_waitcnt lgkmcnt(0)
chainz_kernel_wo1:
    s_barrier
    s_add_u32 s46, s45, 640
    buffer_load_dwordx4 v[24:27], v4, s[16:19], s46 offen
    buffer_load_dwordx4 v[28:31], v5, s[16:19], s46 offen
    buffer_load_dwordx4 v[32:35], v6, s[16:19], s46 offen
    buffer_load_dwordx4 v[36:39], v7, s[16:19], s46 offen
    buffer_load_dwordx4 v[40:43], v8, s[16:19], s46 offen
    buffer_load_dwordx4 v[44:47], v9, s[16:19], s46 offen
    buffer_load_dwordx4 v[48:51], v10, s[16:19], s46 offen
    buffer_load_dwordx4 v[52:55], v11, s[16:19], s46 offen
    buffer_load_dwordx4 v[56:59], v12, s[16:19], s46 offen
    buffer_load_dwordx4 v[60:63], v13, s[16:19], s46 offen
    s_waitcnt vmcnt(0)
    ds_write_b128 v14, v[24:27]
    ds_write_b128 v15, v[28:31]
    ds_write_b128 v16, v[32:35]
    ds_write_b128 v17, v[36:39]
    ds_write_b128 v18, v[40:43]
    ds_write_b128 v19, v[44:47]
    ds_write_b128 v20, v[48:51]
    ds_write_b128 v21, v[52:55]
    ds_write_b128 v22, v[56:59]
    ds_write_b128 v23, v[60:63]
    s_waitcnt lgkmcnt(0)
    s_barrier
    s_lshr_b32 s24, s3, 1
    s_cmp_eq_u32 s24, 1
    s_cbranch_scc0 chainz_kernel_wo2
    ds_read_b64_tr_b16 a[240:241], v72 offset:0
    ds_read_b64_tr_b16 a[242:243], v72 offset:1312
    ds_read_b64_tr_b16 a[244:245], v72 offset:20992
    ds_read_b64_tr_b16 a[246:247], v72 offset:22304
    ds_read_b64_tr_b16 v[112:113], v72 offset:32
    ds_read_b64_tr_b16 v[114:115], v72 offset:1344
    ds_read_b64_tr_b16 v[116:117], v72 offset:21024
    ds_read_b64_tr_b16 v[118:119], v72 offset:22336
    ds_read_b64_tr_b16 v[136:137], v72 offset:64
    ds_read_b64_tr_b16 v[138:139], v72 offset:1376
    ds_read_b64_tr_b16 v[140:141], v72 offset:21056
    ds_read_b64_tr_b16 v[142:143], v72 offset:22368
    ds_read_b64_tr_b16 v[160:161], v72 offset:96
    ds_read_b64_tr_b16 v[162:163], v72 offset:1408
    ds_read_b64_tr_b16 v[164:165], v72 offset:21088
    ds_read_b64_tr_b16 v[166:167], v72 offset:22400
    ds_read_b64_tr_b16 v[184:185], v72 offset:128
    ds_read_b64_tr_b16 v[186:187], v72 offset:1440
    ds_read_b64_tr_b16 v[188:189], v72 offset:21120
    ds_read_b64_tr_b16 v[190:191], v72 offset:22432
    ds_read_b64_tr_b16 v[208:209], v72 offset:160
    ds_read_b64_tr_b16 v[210:211], v72 offset:1472
    ds_read_b64_tr_b16 v[212:213], v72 offset:21152
    ds_read_b64_tr_b16 v[214:215], v72 offset:22464
    ds_read_b64_tr_b16 v[232:233], v72 offset:192
    ds_read_b64_tr_b16 v[234:235], v72 offset:1504
    ds_read_b64_tr_b16 v[236:237], v72 offset:21184
    ds_read_b64_tr_b16 v[238:239], v72 offset:22496
    ds_read_b64_tr_b16 v[64:65], v72 offset:224
    ds_read_b64_tr_b16 v[66:67], v72 offset:1536
    ds_read_b64_tr_b16 v[68:69], v72 offset:21216
    ds_read_b64_tr_b16 v[70:71], v72 offset:22528
    s_waitcnt lgkmcnt(0)
    ds_write_b128 v73, v[64:67] offset:0
    ds_write_b128 v73, v[68:71] offset:1024
    s_waitcnt lgkmcnt(0)
    ds_read_b64_tr_b16 v[64:65], v72 offset:256
    ds_read_b64_tr_b16 v[66:67], v72 offset:1568
    ds_read_b64_tr_b16 v[68:69], v72 offset:21248
    ds_read_b64_tr_b16 v[70:71], v72 offset:22560
    s_waitcnt lgkmcnt(0)
    ds_write_b128 v73, v[64:67] offset:6144
    ds_write_b128 v73, v[68:71] offset:7168
    s_waitcnt lgkmcnt(0)
    ds_read_b64_tr_b16 v[64:65], v72 offset:288
    ds_read_b64_tr_b16 v[66:67], v72 offset:1600
    ds_read_b64_tr_b16 v[68:69], v72 offset:21280
    ds_read_b64_tr_b16 v[70:71], v72 offset:22592
    s_waitcnt lgkmcnt(0)
    ds_write_b128 v73, v[64:67] offset:12288
    ds_write_b128 v73, v[68:71] offset:13312
    s_waitcnt lgkmcnt(0)
    s_waitcnt lgkmcnt(0)
chainz_kernel_wo2:
    s_barrier
    s_add_u32 s46, s45, 81920
    buffer_load_dwordx4 v[24:27], v4, s[16:19], s46 offen
    buffer_load_dwordx4 v[28:31], v5, s[16:19], s46 offen
    buffer_load_dwordx4 v[32:35], v6, s[16:19], s46 offen
    buffer_load_dwordx4 v[36:39], v7, s[16:19], s46 offen
    buffer_load_dwordx4 v[40:43], v8, s[16:19], s46 offen
    buffer_load_dwordx4 v[44:47], v9, s[16:19], s46 offen
    buffer_load_dwordx4 v[48:51], v10, s[16:19], s46 offen
    buffer_load_dwordx4 v[52:55], v11, s[16:19], s46 offen
    buffer_load_dwordx4 v[56:59], v12, s[16:19], s46 offen
    buffer_load_dwordx4 v[60:63], v13, s[16:19], s46 offen
    s_waitcnt vmcnt(0)
    ds_write_b128 v14, v[24:27]
    ds_write_b128 v15, v[28:31]
    ds_write_b128 v16, v[32:35]
    ds_write_b128 v17, v[36:39]
    ds_write_b128 v18, v[40:43]
    ds_write_b128 v19, v[44:47]
    ds_write_b128 v20, v[48:51]
    ds_write_b128 v21, v[52:55]
    ds_write_b128 v22, v[56:59]
    ds_write_b128 v23, v[60:63]
    s_waitcnt lgkmcnt(0)
    s_barrier
    s_lshr_b32 s24, s3, 1
    s_cmp_eq_u32 s24, 0
    s_cbranch_scc0 chainz_kernel_wo3
    ds_read_b64_tr_b16 a[248:249], v72 offset:0
    ds_read_b64_tr_b16 a[250:251], v72 offset:1312
    ds_read_b64_tr_b16 a[252:253], v72 offset:20992
    ds_read_b64_tr_b16 a[254:255], v72 offset:22304
    ds_read_b64_tr_b16 v[120:121], v72 offset:32
    ds_read_b64_tr_b16 v[122:123], v72 offset:1344
    ds_read_b64_tr_b16 v[124:125], v72 offset:21024
    ds_read_b64_tr_b16 v[126:127], v72 offset:22336
    ds_read_b64_tr_b16 v[144:145], v72 offset:64
    ds_read_b64_tr_b16 v[146:147], v72 offset:1376
    ds_read_b64_tr_b16 v[148:149], v72 offset:21056
    ds_read_b64_tr_b16 v[150:151], v72 offset:22368
    ds_read_b64_tr_b16 v[168:169], v72 offset:96
    ds_read_b64_tr_b16 v[170:171], v72 offset:1408
    ds_read_b64_tr_b16 v[172:173], v72 offset:21088
    ds_read_b64_tr_b16 v[174:175], v72 offset:22400
    ds_read_b64_tr_b16 v[192:193], v72 offset:128
    ds_read_b64_tr_b16 v[194:195], v72 offset:1440
    ds_read_b64_tr_b16 v[196:197], v72 offset:21120
    ds_read_b64_tr_b16 v[198:199], v72 offset:22432
    ds_read_b64_tr_b16 v[216:217], v72 offset:160
    ds_read_b64_tr_b16 v[218:219], v72 offset:1472
    ds_read_b64_tr_b16 v[220:221], v72 offset:21152
    ds_read_b64_tr_b16 v[222:223], v72 offset:22464
    ds_read_b64_tr_b16 v[240:241], v72 offset:192
    ds_read_b64_tr_b16 v[242:243], v72 offset:1504
    ds_read_b64_tr_b16 v[244:245], v72 offset:21184
    ds_read_b64_tr_b16 v[246:247], v72 offset:22496
    ds_read_b64_tr_b16 v[64:65], v72 offset:224
    ds_read_b64_tr_b16 v[66:67], v72 offset:1536
    ds_read_b64_tr_b16 v[68:69], v72 offset:21216
    ds_read_b64_tr_b16 v[70:71], v72 offset:22528
    s_waitcnt lgkmcnt(0)
    ds_write_b128 v73, v[64:67] offset:2048
    ds_write_b128 v73, v[68:71] offset:3072
    s_waitcnt lgkmcnt(0)
    ds_read_b64_tr_b16 v[64:65], v72 offset:256
    ds_read_b64_tr_b16 v[66:67], v72 offset:1568
    ds_read_b64_tr_b16 v[68:69], v72 offset:21248
    ds_read_b64_tr_b16 v[70:71], v72 offset:22560
    s_waitcnt lgkmcnt(0)
    ds_write_b128 v73, v[64:67] offset:8192
    ds_write_b128 v73, v[68:71] offset:9216
    s_waitcnt lgkmcnt(0)
    ds_read_b64_tr_b16 v[64:65], v72 offset:288
    ds_read_b64_tr_b16 v[66:67], v72 offset:1600
    ds_read_b64_tr_b16 v[68:69], v72 offset:21280
    ds_read_b64_tr_b16 v[70:71], v72 offset:22592
    s_waitcnt lgkmcnt(0)
    ds_write_b128 v73, v[64:67] offset:14336
    ds_write_b128 v73, v[68:71] offset:15360
    s_waitcnt lgkmcnt(0)
    s_waitcnt lgkmcnt(0)
chainz_kernel_wo3:
    s_barrier
    s_add_u32 s46, s45, 82560
    buffer_load_dwordx4 v[24:27], v4, s[16:19], s46 offen
    buffer_load_dwordx4 v[28:31], v5, s[16:19], s46 offen
    buffer_load_dwordx4 v[32:35], v6, s[16:19], s46 offen
    buffer_load_dwordx4 v[36:39], v7, s[16:19], s46 offen
    buffer_load_dwordx4 v[40:43], v8, s[16:19], s46 offen
    buffer_load_dwordx4 v[44:47], v9, s[16:19], s46 offen
    buffer_load_dwordx4 v[48:51], v10, s[16:19], s46 offen
    buffer_load_dwordx4 v[52:55], v11, s[16:19], s46 offen
    buffer_load_dwordx4 v[56:59], v12, s[16:19], s46 offen
    buffer_load_dwordx4 v[60:63], v13, s[16:19], s46 offen
    s_waitcnt vmcnt(0)
    ds_write_b128 v14, v[24:27]
    ds_write_b128 v15, v[28:31]
    ds_write_b128 v16, v[32:35]
    ds_write_b128 v17, v[36:39]
    ds_write_b128 v18, v[40:43]
    ds_write_b128 v19, v[44:47]
    ds_write_b128 v20, v[48:51]
    ds_write_b128 v21, v[52:55]
    ds_write_b128 v22, v[56:59]
    ds_write_b128 v23, v[60:63]
    s_waitcnt lgkmcnt(0)
    s_barrier
    s_lshr_b32 s24, s3, 1
    s_cmp_eq_u32 s24, 1
    s_cbranch_scc0 chainz_kernel_wo4
    ds_read_b64_tr_b16 a[248:249], v72 offset:0
    ds_read_b64_tr_b16 a[250:251], v72 offset:1312
    ds_read_b64_tr_b16 a[252:253], v72 offset:20992
    ds_read_b64_tr_b16 a[254:255], v72 offset:22304
    ds_read_b64_tr_b16 v[120:121], v72 offset:32
    ds_read_b64_tr_b16 v[122:123], v72 offset:1344
    ds_read_b64_tr_b16 v[124:125], v72 offset:21024
    ds_read_b64_tr_b16 v[126:127], v72 offset:22336
    ds_read_b64_tr_b16 v[144:145], v72 offset:64
    ds_read_b64_tr_b16 v[146:147], v72 offset:1376
    ds_read_b64_tr_b16 v[148:149], v72 offset:21056
    ds_read_b64_tr_b16 v[150:151], v72 offset:22368
    ds_read_b64_tr_b16 v[168:169], v72 offset:96
    ds_read_b64_tr_b16 v[170:171], v72 offset:1408
    ds_read_b64_tr_b16 v[172:173], v72 offset:21088
    ds_read_b64_tr_b16 v[174:175], v72 offset:22400
    ds_read_b64_tr_b16 v[192:193], v72 offset:128
    ds_read_b64_tr_b16 v[194:195], v72 offset:1440
    ds_read_b64_tr_b16 v[196:197], v72 offset:21120
    ds_read_b64_tr_b16 v[198:199], v72 offset:22432
    ds_read_b64_tr_b16 v[216:217], v72 offset:160
    ds_read_b64_tr_b16 v[218:219], v72 offset:1472
    ds_read_b64_tr_b16 v[220:221], v72 offset:21152
    ds_read_b64_tr_b16 v[222:223], v72 offset:22464
    ds_read_b64_tr_b16 v[240:241], v72 offset:192
    ds_read_b64_tr_b16 v[242:243], v72 offset:1504
    ds_read_b64_tr_b16 v[244:245], v72 offset:21184
    ds_read_b64_tr_b16 v[246:247], v72 offset:22496
    ds_read_b64_tr_b16 v[64:65], v72 offset:224
    ds_read_b64_tr_b16 v[66:67], v72 offset:1536
    ds_read_b64_tr_b16 v[68:69], v72 offset:21216
    ds_read_b64_tr_b16 v[70:71], v72 offset:22528
    s_waitcnt lgkmcnt(0)
    ds_write_b128 v73, v[64:67] offset:2048
    ds_write_b128 v73, v[68:71] offset:3072
    s_waitcnt lgkmcnt(0)
    ds_read_b64_tr_b16 v[64:65], v72 offset:256
    ds_read_b64_tr_b16 v[66:67], v72 offset:1568
    ds_read_b64_tr_b16 v[68:69], v72 offset:21248
    ds_read_b64_tr_b16 v[70:71], v72 offset:22560
    s_waitcnt lgkmcnt(0)
    ds_write_b128 v73, v[64:67] offset:8192
    ds_write_b128 v73, v[68:71] offset:9216
    s_waitcnt lgkmcnt(0)
    ds_read_b64_tr_b16 v[64:65], v72 offset:288
    ds_read_b64_tr_b16 v[66:67], v72 offset:1600
    ds_read_b64_tr_b16 v[68:69], v72 offset:21280
    ds_read_b64_tr_b16 v[70:71], v72 offset:22592
    s_waitcnt lgkmcnt(0)
    ds_write_b128 v73, v[64:67] offset:14336
    ds_write_b128 v73, v[68:71] offset:15360
    s_waitcnt lgkmcnt(0)
    s_waitcnt lgkmcnt(0)
chainz_kernel_wo4:
    s_barrier
    s_add_u32 s46, s45, 163840
    buffer_load_dwordx4 v[24:27], v4, s[16:19], s46 offen
    buffer_load_dwordx4 v[28:31], v5, s[16:19], s46 offen
    buffer_load_dwordx4 v[32:35], v6, s[16:19], s46 offen
    buffer_load_dwordx4 v[36:39], v7, s[16:19], s46 offen
    buffer_load_dwordx4 v[40:43], v8, s[16:19], s46 offen
    buffer_load_dwordx4 v[44:47], v9, s[16:19], s46 offen
    buffer_load_dwordx4 v[48:51], v10, s[16:19], s46 offen
    buffer_load_dwordx4 v[52:55], v11, s[16:19], s46 offen
    buffer_load_dwordx4 v[56:59], v12, s[16:19], s46 offen
    buffer_load_dwordx4 v[60:63], v13, s[16:19], s46 offen
    s_waitcnt vmcnt(0)
    ds_write_b128 v14, v[24:27]
    ds_write_b128 v15, v[28:31]
    ds_write_b128 v16, v[32:35]
    ds_write_b128 v17, v[36:39]
    ds_write_b128 v18, v[40:43]
    ds_write_b128 v19, v[44:47]
    ds_write_b128 v20, v[48:51]
    ds_write_b128 v21, v[52:55]
    ds_write_b128 v22, v[56:59]
    ds_write_b128 v23, v[60:63]
    s_waitcnt lgkmcnt(0)
    s_barrier
    s_lshr_b32 s24, s3, 1
    s_cmp_eq_u32 s24, 0
    s_cbranch_scc0 chainz_kernel_wo5
    ds_read_b64_tr_b16 v[104:105], v72 offset:0
    ds_read_b64_tr_b16 v[106:107], v72 offset:1312
    ds_read_b64_tr_b16 v[108:109], v72 offset:20992
    ds_read_b64_tr_b16 v[110:111], v72 offset:22304
    ds_read_b64_tr_b16 v[128:129], v72 offset:32
    ds_read_b64_tr_b16 v[130:131], v72 offset:1344
    ds_read_b64_tr_b16 v[132:133], v72 offset:21024
    ds_read_b64_tr_b16 v[134:135], v72 offset:22336
    ds_read_b64_tr_b16 v[152:153], v72 offset:64
    ds_read_b64_tr_b16 v[154:155], v72 offset:1376
    ds_read_b64_tr_b16 v[156:157], v72 offset:21056
    ds_read_b64_tr_b16 v[158:159], v72 offset:22368
    ds_read_b64_tr_b16 v[176:177], v72 offset:96
    ds_read_b64_tr_b16 v[178:179], v72 offset:1408
    ds_read_b64_tr_b16 v[180:181], v72 offset:21088
    ds_read_b64_tr_b16 v[182:183], v72 offset:22400
    ds_read_b64_tr_b16 v[200:201], v72 offset:128
    ds_read_b64_tr_b16 v[202:203], v72 offset:1440
    ds_read_b64_tr_b16 v[204:205], v72 offset:21120
    ds_read_b64_tr_b16 v[206:207], v72 offset:22432
    ds_read_b64_tr_b16 v[224:225], v72 offset:160
    ds_read_b64_tr_b16 v[226:227], v72 offset:1472
    ds_read_b64_tr_b16 v[228:229], v72 offset:21152
    ds_read_b64_tr_b16 v[230:231], v72 offset:22464
    ds_read_b64_tr_b16 v[248:249], v72 offset:192
    ds_read_b64_tr_b16 v[250:251], v72 offset:1504
    ds_read_b64_tr_b16 v[252:253], v72 offset:21184
    ds_read_b64_tr_b16 v[254:255], v72 offset:22496
    ds_read_b64_tr_b16 v[64:65], v72 offset:224
    ds_read_b64_tr_b16 v[66:67], v72 offset:1536
    ds_read_b64_tr_b16 v[68:69], v72 offset:21216
    ds_read_b64_tr_b16 v[70:71], v72 offset:22528
    s_waitcnt lgkmcnt(0)
    ds_write_b128 v73, v[64:67] offset:4096
    ds_write_b128 v73, v[68:71] offset:5120
    s_waitcnt lgkmcnt(0)
    ds_read_b64_tr_b16 v[64:65], v72 offset:256
    ds_read_b64_tr_b16 v[66:67], v72 offset:1568
    ds_read_b64_tr_b16 v[68:69], v72 offset:21248
    ds_read_b64_tr_b16 v[70:71], v72 offset:22560
    s_waitcnt lgkmcnt(0)
    ds_write_b128 v73, v[64:67] offset:10240
    ds_write_b128 v73, v[68:71] offset:11264
    s_waitcnt lgkmcnt(0)
    ds_read_b64_tr_b16 v[64:65], v72 offset:288
    ds_read_b64_tr_b16 v[66:67], v72 offset:1600
    ds_read_b64_tr_b16 v[68:69], v72 offset:21280
    ds_read_b64_tr_b16 v[70:71], v72 offset:22592
    s_waitcnt lgkmcnt(0)
    ds_write_b128 v73, v[64:67] offset:16384
    ds_write_b128 v73, v[68:71] offset:17408
    s_waitcnt lgkmcnt(0)
    s_waitcnt lgkmcnt(0)
chainz_kernel_wo5:
    s_barrier
    s_add_u32 s46, s45, 164480
    buffer_load_dwordx4 v[24:27], v4, s[16:19], s46 offen
    buffer_load_dwordx4 v[28:31], v5, s[16:19], s46 offen
    buffer_load_dwordx4 v[32:35], v6, s[16:19], s46 offen
    buffer_load_dwordx4 v[36:39], v7, s[16:19], s46 offen
    buffer_load_dwordx4 v[40:43], v8, s[16:19], s46 offen
    buffer_load_dwordx4 v[44:47], v9, s[16:19], s46 offen
    buffer_load_dwordx4 v[48:51], v10, s[16:19], s46 offen
    buffer_load_dwordx4 v[52:55], v11, s[16:19], s46 offen
    buffer_load_dwordx4 v[56:59], v12, s[16:19], s46 offen
    buffer_load_dwordx4 v[60:63], v13, s[16:19], s46 offen
    s_waitcnt vmcnt(0)
    ds_write_b128 v14, v[24:27]
    ds_write_b128 v15, v[28:31]
    ds_write_b128 v16, v[32:35]
    ds_write_b128 v17, v[36:39]
    ds_write_b128 v18, v[40:43]
    ds_write_b128 v19, v[44:47]
    ds_write_b128 v20, v[48:51]
    ds_write_b128 v21, v[52:55]
    ds_write_b128 v22, v[56:59]
    ds_write_b128 v23, v[60:63]
    s_waitcnt lgkmcnt(0)
    s_barrier
    s_lshr_b32 s24, s3, 1
    s_cmp_eq_u32 s24, 1
    s_cbranch_scc0 chainz_kernel_wo6
    ds_read_b64_tr_b16 v[104:105], v72 offset:0
    ds_read_b64_tr_b16 v[106:107], v72 offset:1312
    ds_read_b64_tr_b16 v[108:109], v72 offset:20992
    ds_read_b64_tr_b16 v[110:111], v72 offset:22304
    ds_read_b64_tr_b16 v[128:129], v72 offset:32
    ds_read_b64_tr_b16 v[130:131], v72 offset:1344
    ds_read_b64_tr_b16 v[132:133], v72 offset:21024
    ds_read_b64_tr_b16 v[134:135], v72 offset:22336
    ds_read_b64_tr_b16 v[152:153], v72 offset:64
    ds_read_b64_tr_b16 v[154:155], v72 offset:1376
    ds_read_b64_tr_b16 v[156:157], v72 offset:21056
    ds_read_b64_tr_b16 v[158:159], v72 offset:22368
    ds_read_b64_tr_b16 v[176:177], v72 offset:96
    ds_read_b64_tr_b16 v[178:179], v72 offset:1408
    ds_read_b64_tr_b16 v[180:181], v72 offset:21088
    ds_read_b64_tr_b16 v[182:183], v72 offset:22400
    ds_read_b64_tr_b16 v[200:201], v72 offset:128
    ds_read_b64_tr_b16 v[202:203], v72 offset:1440
    ds_read_b64_tr_b16 v[204:205], v72 offset:21120
    ds_read_b64_tr_b16 v[206:207], v72 offset:22432
    ds_read_b64_tr_b16 v[224:225], v72 offset:160
    ds_read_b64_tr_b16 v[226:227], v72 offset:1472
    ds_read_b64_tr_b16 v[228:229], v72 offset:21152
    ds_read_b64_tr_b16 v[230:231], v72 offset:22464
    ds_read_b64_tr_b16 v[248:249], v72 offset:192
    ds_read_b64_tr_b16 v[250:251], v72 offset:1504
    ds_read_b64_tr_b16 v[252:253], v72 offset:21184
    ds_read_b64_tr_b16 v[254:255], v72 offset:22496
    ds_read_b64_tr_b16 v[64:65], v72 offset:224
    ds_read_b64_tr_b16 v[66:67], v72 offset:1536
    ds_read_b64_tr_b16 v[68:69], v72 offset:21216
    ds_read_b64_tr_b16 v[70:71], v72 offset:22528
    s_waitcnt lgkmcnt(0)
    ds_write_b128 v73, v[64:67] offset:4096
    ds_write_b128 v73, v[68:71] offset:5120
    s_waitcnt lgkmcnt(0)
    ds_read_b64_tr_b16 v[64:65], v72 offset:256
    ds_read_b64_tr_b16 v[66:67], v72 offset:1568
    ds_read_b64_tr_b16 v[68:69], v72 offset:21248
    ds_read_b64_tr_b16 v[70:71], v72 offset:22560
    s_waitcnt lgkmcnt(0)
    ds_write_b128 v73, v[64:67] offset:10240
    ds_write_b128 v73, v[68:71] offset:11264
    s_waitcnt lgkmcnt(0)
    ds_read_b64_tr_b16 v[64:65], v72 offset:288
    ds_read_b64_tr_b16 v[66:67], v72 offset:1600
    ds_read_b64_tr_b16 v[68:69], v72 offset:21280
    ds_read_b64_tr_b16 v[70:71], v72 offset:22592
    s_waitcnt lgkmcnt(0)
    ds_write_b128 v73, v[64:67] offset:16384
    ds_write_b128 v73, v[68:71] offset:17408
    s_waitcnt lgkmcnt(0)
    s_waitcnt lgkmcnt(0)
chainz_kernel_wo6:
    s_barrier
    v_mov_b32 v6, v73
    v_mov_b32 v4, 0x4444
    v_mov_b32 v5, 0xeeee
    v_cmp_gt_u32 vcc, 8, v2
    s_nop 1
    v_cndmask_b32 v4, v5, v4, vcc
    v_lshlrev_b32 v5, 4, v1
    s_lshl_b32 s24, s3, 10
    v_add_u32 v7, s24, v5
    s_lshl_b32 s24, s3, 9
    s_add_u32 s24, s24, 8192
    v_lshlrev_b32 v8, 3, v1
    v_add_u32 v8, s24, v8
    v_and_b32 v64, 7, v2
    v_lshlrev_b32 v9, 5, v64
    v_lshrrev_b32 v64, 3, v2
    v_lshl_add_u32 v9, v64, 4, v9
    v_and_b32 v64, 1, v3
    v_lshl_add_u32 v9, v64, 3, v9
    s_mul_i32 s24, s3, 768
    s_add_u32 s24, s24, 10240
    v_add_u32 v9, s24, v9
    v_lshrrev_b32 v65, 1, v3
    v_lshl_add_u32 v10, v65, 8, v9
    v_lshrrev_b32 v64, 2, v2
    v_lshlrev_b32 v11, 5, v64
    v_and_b32 v64, 3, v2
    v_lshl_add_u32 v11, v64, 3, v11
    v_lshl_add_u32 v11, v3, 8, v11
    v_add_u32 v11, 10240, v11
    s_mul_i32 s24, s44, 192
    s_mul_i32 s25, s3, 48
    s_add_u32 s24, s24, s25
    s_lshl_b32 s24, s24, 4
    v_lshlrev_b32 v12, 4, v2
    v_and_b32 v64, 1, v3
    v_lshl_add_u32 v12, v64, 3, v12
    v_add_u32 v12, s24, v12
    v_lshl_add_u32 v13, v65, 8, v12
    v_mov_b32 v64, 2146435072
    v_cmp_gt_u32 vcc, 2, v3
    s_nop 1
    v_cndmask_b32 v12, v64, v12, vcc
    s_mul_i32 s24, s3, 10
    s_lshl_b32 s24, s24, 13
    s_lshl_b32 s25, s44, 8
    s_add_u32 s24, s24, s25
    v_lshlrev_b32 v14, 13, v3
    v_lshl_add_u32 v14, v2, 4, v14
    v_add_u32 v14, s24, v14
    v_lshrrev_b32 v64, 1, v3
    v_lshlrev_b32 v15, 13, v64
    v_lshl_add_u32 v15, v2, 4, v15
    v_add_u32 v15, s24, v15
    v_add_u32 v15, 65536, v15
    v_and_b32 v64, 1, v3
    v_cmp_eq_u32 vcc, 0, v64
    v_mov_b32 v64, 2146435072
    s_nop 0
    v_cndmask_b32 v15, v64, v15, vcc
    v_add_u32 v64, 0, v0
    v_and_b32 v65, 7, v64
    v_mul_u32_u24 v65, 1280, v65
    v_lshrrev_b32 v66, 3, v64
    v_lshl_add_u32 v65, v66, 4, v65
    v_cmp_gt_u32 vcc, 640, v64
    v_mov_b32 v67, 2146435072
    s_nop 0
    v_cndmask_b32 v65, v67, v65, vcc
    buffer_load_dwordx4 v[68:71], v65, s[20:23], 0 offen
    v_lshlrev_b32 v64, 4, v64
    s_waitcnt vmcnt(0)
    s_and_saveexec_b64 s[30:31], vcc
    ds_write_b128 v64, v[68:71]
    s_mov_b64 exec, s[30:31]
    v_add_u32 v64, 256, v0
    v_and_b32 v65, 7, v64
    v_mul_u32_u24 v65, 1280, v65
    v_lshrrev_b32 v66, 3, v64
    v_lshl_add_u32 v65, v66, 4, v65
    v_cmp_gt_u32 vcc, 640, v64
    v_mov_b32 v67, 2146435072
    s_nop 0
    v_cndmask_b32 v65, v67, v65, vcc
    buffer_load_dwordx4 v[68:71], v65, s[20:23], 0 offen
    v_lshlrev_b32 v64, 4, v64
    s_waitcnt vmcnt(0)
    s_and_saveexec_b64 s[30:31], vcc
    ds_write_b128 v64, v[68:71]
    s_mov_b64 exec, s[30:31]
    v_add_u32 v64, 512, v0
    v_and_b32 v65, 7, v64
    v_mul_u32_u24 v65, 1280, v65
    v_lshrrev_b32 v66, 3, v64
    v_lshl_add_u32 v65, v66, 4, v65
    v_cmp_gt_u32 vcc, 640, v64
    v_mov_b32 v67, 2146435072
    s_nop 0
    v_cndmask_b32 v65, v67, v65, vcc
    buffer_load_dwordx4 v[68:71], v65, s[20:23], 0 offen
    v_lshlrev_b32 v64, 4, v64
    s_waitcnt vmcnt(0)
    s_and_saveexec_b64 s[30:31], vcc
    ds_write_b128 v64, v[68:71]
    s_mov_b64 exec, s[30:31]
    s_mov_b32 s40, 0
    s_mov_b32 s42, 178257920
    s_mov_b32 s43, 142606336
    s_mov_b32 s47, 163577856
    s_waitcnt lgkmcnt(0)
    s_branch chainz_kernel_v_go2
chainz_kernel_v_step:
    s_add_u32 s48, s47, 4096
    s_mov_b32 s61, 0
chainz_kernel_v_pm:
    buffer_load_dwordx4 v[16:19], v7, s[8:11], s47 offen sc1
    buffer_load_dwordx4 v[20:23], v7, s[8:11], s48 offen sc1
    buffer_load_dwordx2 v[24:25], v8, s[8:11], s47 offen sc1
    s_waitcnt vmcnt(0)
    v_max3_u32 v26, v16, v17, v18
    v_max3_u32 v26, v26, v19, v20
    v_max3_u32 v26, v26, v21, v22
    v_max3_u32 v26, v26, v23, v24
    v_max_u32 v26, v26, v25
    v_cmp_eq_u32 vcc, -1, v26
    s_add_u32 s61, s61, 1
    s_cbranch_vccz chainz_kernel_v_pm_out
    s_cmp_ge_u32 s61, s60
    s_cbranch_scc1 chainz_kernel_v_pm_to
    s_sleep 1
    s_branch chainz_kernel_v_pm
chainz_kernel_v_pm_to:
    s_mov_b32 s60, 1
chainz_kernel_v_pm_out:
    ds_write_b128 v7, v[16:19]
    ds_write_b128 v7, v[20:23] offset:4096
    ds_write_b64 v8, v[24:25]
    s_waitcnt lgkmcnt(0)
chainz_kernel_v_go2:
    s_barrier
    ds_read_b128 v[16:19], v5 offset:0
    ds_read_b128 v[20:23], v5 offset:1024
    ds_read_b128 v[24:27], v5 offset:2048
    ds_read_b128 v[28:31], v5 offset:3072
    ds_read_b128 v[32:35], v5 offset:4096
    ds_read_b128 v[36:39], v5 offset:5120
    ds_read_b128 v[40:43], v5 offset:6144
    ds_read_b128 v[44:47], v5 offset:7168
    ds_read_b128 v[48:51], v5 offset:8192
    ds_read_b128 v[52:55], v5 offset:9216
    v_mov_b32 v56, 0
    v_mov_b32 v57, 0
    v_mov_b32 v58, 0
    v_mov_b32 v59, 0
    v_mov_b32 v60, 0
    v_mov_b32 v61, 0
    v_mov_b32 v62, 0
    v_mov_b32 v63, 0
    v_mov_b32 v64, 0
    v_mov_b32 v65, 0
    v_mov_b32 v66, 0
    v_mov_b32 v67, 0
    s_waitcnt lgkmcnt(9)
    v_smfmac_f32_16x16x64_bf16 v[56:59], v[16:19], a[0:7], v4
    v_smfmac_f32_16x16x64_bf16 v[60:63], v[16:19], a[80:87], v4
    v_smfmac_f32_16x16x64_bf16 v[64:67], v[16:19], a[160:167], v4
    s_waitcnt lgkmcnt(8)
    v_smfmac_f32_16x16x64_bf16 v[56:59], v[20:23], a[8:15], v4
    v_smfmac_f32_16x16x64_bf16 v[60:63], v[20:23], a[88:95], v4
    v_smfmac_f32_16x16x64_bf16 v[64:67], v[20:23], a[168:175], v4
    s_waitcnt lgkmcnt(7)
    v_smfmac_f32_16x16x64_bf16 v[56:59], v[24:27], a[16:23], v4
    v_smfmac_f32_16x16x64_bf16 v[60:63], v[24:27], a[96:103], v4
    v_smfmac_f32_16x16x64_bf16 v[64:67], v[24:27], a[176:183], v4
    s_waitcnt lgkmcnt(6)
    v_smfmac_f32_16x16x64_bf16 v[56:59], v[28:31], a[24:31], v4
    v_smfmac_f32_16x16x64_bf16 v[60:63], v[28:31], a[104:111], v4
    v_smfmac_f32_16x16x64_bf16 v[64:67], v[28:31], a[184:191], v4
    s_waitcnt lgkmcnt(5)
    v_smfmac_f32_16x16x64_bf16 v[56:59], v[32:35], a[32:39], v4
    v_smfmac_f32_16x16x64_bf16 v[60:63], v[32:35], a[112:119], v4
    v_smfmac_f32_16x16x64_bf16 v[64:67], v[32:35], a[192:199], v4
    s_waitcnt lgkmcnt(4)
    v_smfmac_f32_16x16x64_bf16 v[56:59], v[36:39], a[40:47], v4
    v_smfmac_f32_16x16x64_bf16 v[60:63], v[36:39], a[120:127], v4
    v_smfmac_f32_16x16x64_bf16 v[64:67], v[36:39], a[200:207], v4
    s_waitcnt lgkmcnt(3)
    v_smfmac_f32_16x16x64_bf16 v[56:59], v[40:43], a[48:55], v4
    v_smfmac_f32_16x16x64_bf16 v[60:63], v[40:43], a[128:135], v4
    v_smfmac_f32_16x16x64_bf16 v[64:67], v[40:43], a[208:215], v4
    s_waitcnt lgkmcnt(2)
    v_smfmac_f32_16x16x64_bf16 v[56:59], v[44:47], a[56:63], v4
    v_smfmac_f32_16x16x64_bf16 v[60:63], v[44:47], a[136:143], v4
    v_smfmac_f32_16x16x64_bf16 v[64:67], v[44:47], a[216:223], v4
    s_waitcnt lgkmcnt(1)
    v_smfmac_f32_16x16x64_bf16 v[56:59], v[48:51], a[64:71], v4
    v_smfmac_f32_16x16x64_bf16 v[60:63], v[48:51], a[144:151], v4
    v_smfmac_f32_16x16x64_bf16 v[64:67], v[48:51], a[224:231], v4
    s_waitcnt lgkmcnt(0)
    v_smfmac_f32_16x16x64_bf16 v[56:59], v[52:55], a[72:79], v4
    v_smfmac_f32_16x16x64_bf16 v[60:63], v[52:55], a[152:159], v4
    v_smfmac_f32_16x16x64_bf16 v[64:67], v[52:55], a[232:239], v4
    ds_read_b128 v[80:83], v6 offset:0
    ds_read_b128 v[84:87], v6 offset:1024
    ds_read_b128 v[88:91], v6 offset:2048
    ds_read_b128 v[92:95], v6 offset:3072
    ds_read_b128 v[96:99], v6 offset:4096
    ds_read_b128 v[100:103], v6 offset:5120
    v_mov_b32 v16, 0
    v_mov_b32 v17, 0
    v_mov_b32 v18, 0
    v_mov_b32 v19, 0
    v_mov_b32 v20, 0
    v_mov_b32 v21, 0
    v_mov_b32 v22, 0
    v_mov_b32 v23, 0
    v_mov_b32 v24, 0
    v_mov_b32 v25, 0
    v_mov_b32 v26, 0
    v_mov_b32 v27, 0
    v_mov_b32 v28, 0
    v_mov_b32 v29, 0
    v_mov_b32 v30, 0
    v_mov_b32 v31, 0
    v_mov_b32 v32, 0
    v_mov_b32 v33, 0
    v_mov_b32 v34, 0
    v_mov_b32 v35, 0
    v_mov_b32 v36, 0
    v_mov_b32 v37, 0
    v_mov_b32 v38, 0
    v_mov_b32 v39, 0
    v_mov_b32 v40, 0
    v_mov_b32 v41, 0
    v_mov_b32 v42, 0
    v_mov_b32 v43, 0
    v_mov_b32 v44, 0
    v_mov_b32 v45, 0
    v_mov_b32 v46, 0
    v_mov_b32 v47, 0
    v_mov_b32 v48, 0
    v_mov_b32 v49, 0
    v_mov_b32 v50, 0
    v_mov_b32 v51, 0
    v_mov_b32 v52, 0
    v_mov_b32 v53, 0
    v_mov_b32 v54, 0
    v_mov_b32 v55, 0
    v_permlane32_swap_b32 v56, v60
    v_permlane32_swap_b32 v57, v61
    v_permlane32_swap_b32 v58, v62
    v_permlane32_swap_b32 v59, v63
    v_add_f32 v56, v56, v60
    v_add_f32 v57, v57, v61
    v_add_f32 v58, v58, v62
    v_add_f32 v59, v59, v63
    v_cvt_pk_bf16_f32 v68, v56, v57
    v_cvt_pk_bf16_f32 v69, v58, v59
    v_mov_b32 v60, v64
    v_mov_b32 v61, v65
    v_mov_b32 v62, v66
    v_mov_b32 v63, v67
    v_permlane32_swap_b32 v64, v60
    v_permlane32_swap_b32 v65, v61
    v_permlane32_swap_b32 v66, v62
    v_permlane32_swap_b32 v67, v63
    v_add_f32 v64, v64, v60
    v_add_f32 v65, v65, v61
    v_add_f32 v66, v66, v62
    v_add_f32 v67, v67, v63
    v_cvt_pk_bf16_f32 v70, v64, v65
    v_cvt_pk_bf16_f32 v71, v66, v67
    ds_write_b64 v10, v[68:69]
    ds_write_b64 v9, v[70:71] offset:512
    buffer_store_dwordx2 v[68:69], v13, s[8:11], s42 offen
    buffer_store_dwordx2 v[70:71], v12, s[8:11], s42 offen offset:512
    s_cmp_eq_u32 s40, 63
    s_cbranch_scc1 chainz_kernel_end
    s_waitcnt lgkmcnt(0)
    s_barrier
    ds_read_b64_tr_b16 v[68:69], v11 offset:0
    ds_read_b64_tr_b16 v[70:71], v11 offset:128
    ds_read_b64_tr_b16 v[72:73], v11 offset:1024
    ds_read_b64_tr_b16 v[74:75], v11 offset:1152
    ds_read_b64_tr_b16 v[76:77], v11 offset:2048
    ds_read_b64_tr_b16 v[78:79], v11 offset:2176
    s_waitcnt lgkmcnt(4)
    v_smfmac_f32_16x16x64_bf16 v[16:19], v[68:71], a[240:247], v4
    v_smfmac_f32_16x16x64_bf16 v[20:23], v[68:71], v[112:119], v4
    v_smfmac_f32_16x16x64_bf16 v[24:27], v[68:71], v[136:143], v4
    v_smfmac_f32_16x16x64_bf16 v[28:31], v[68:71], v[160:167], v4
    s_waitcnt lgkmcnt(2)
    v_smfmac_f32_16x16x64_bf16 v[16:19], v[72:75], a[248:255], v4
    v_smfmac_f32_16x16x64_bf16 v[20:23], v[72:75], v[120:127], v4
    v_smfmac_f32_16x16x64_bf16 v[24:27], v[72:75], v[144:151], v4
    v_smfmac_f32_16x16x64_bf16 v[28:31], v[72:75], v[168:175], v4
    s_waitcnt lgkmcnt(0)
    v_smfmac_f32_16x16x64_bf16 v[16:19], v[76:79], v[104:111], v4
    v_smfmac_f32_16x16x64_bf16 v[20:23], v[76:79], v[128:135], v4
    v_smfmac_f32_16x16x64_bf16 v[24:27], v[76:79], v[152:159], v4
    v_smfmac_f32_16x16x64_bf16 v[28:31], v[76:79], v[176:183], v4
    v_smfmac_f32_16x16x64_bf16 v[32:35], v[68:71], v[184:191], v4
    v_smfmac_f32_16x16x64_bf16 v[36:39], v[68:71], v[208:215], v4
    v_smfmac_f32_16x16x64_bf16 v[40:43], v[68:71], v[232:239], v4
    v_smfmac_f32_16x16x64_bf16 v[44:47], v[68:71], v[80:87], v4
    ds_read_b128 v[80:83], v6 offset:6144
    ds_read_b128 v[84:87], v6 offset:7168
    v_smfmac_f32_16x16x64_bf16 v[32:35], v[72:75], v[192:199], v4
    v_smfmac_f32_16x16x64_bf16 v[36:39], v[72:75], v[216:223], v4
    v_smfmac_f32_16x16x64_bf16 v[40:43], v[72:75], v[240:247], v4
    v_smfmac_f32_16x16x64_bf16 v[44:47], v[72:75], v[88:95], v4
    ds_read_b128 v[88:91], v6 offset:8192
    ds_read_b128 v[92:95], v6 offset:9216
    v_smfmac_f32_16x16x64_bf16 v[32:35], v[76:79], v[200:207], v4
    v_smfmac_f32_16x16x64_bf16 v[36:39], v[76:79], v[224:231], v4
    v_smfmac_f32_16x16x64_bf16 v[40:43], v[76:79], v[248:255], v4
    v_smfmac_f32_16x16x64_bf16 v[44:47], v[76:79], v[96:103], v4
    ds_read_b128 v[96:99], v6 offset:10240
    ds_read_b128 v[100:103], v6 offset:11264
    v_permlane32_swap_b32 v16, v24
    v_permlane32_swap_b32 v17, v25
    v_permlane32_swap_b32 v18, v26
    v_permlane32_swap_b32 v19, v27
    v_add_f32 v16, v16, v24
    v_add_f32 v17, v17, v25
    v_add_f32 v18, v18, v26
    v_add_f32 v19, v19, v27
    v_permlane32_swap_b32 v20, v28
    v_permlane32_swap_b32 v21, v29
    v_permlane32_swap_b32 v22, v30
    v_permlane32_swap_b32 v23, v31
    v_add_f32 v20, v20, v28
    v_add_f32 v21, v21, v29
    v_add_f32 v22, v22, v30
    v_add_f32 v23, v23, v31
    v_cvt_pk_bf16_f32 v56, v16, v17
    v_cvt_pk_bf16_f32 v57, v18, v19
    v_cvt_pk_bf16_f32 v58, v20, v21
    v_cvt_pk_bf16_f32 v59, v22, v23
    s_nop 0
    v_permlane16_swap_b32 v56, v58
    v_permlane16_swap_b32 v57, v59
    v_min_u32 v56, -2, v56
    v_min_u32 v57, -2, v57
    v_min_u32 v58, -2, v58
    v_min_u32 v59, -2, v59
    buffer_store_dwordx4 v[56:59], v14, s[8:11], s43 offen sc1
    s_waitcnt lgkmcnt(4)
    v_smfmac_f32_16x16x64_bf16 v[48:51], v[68:71], v[80:87], v4
    ds_read_b128 v[80:83], v6 offset:12288
    ds_read_b128 v[84:87], v6 offset:13312
    s_waitcnt lgkmcnt(4)
    v_smfmac_f32_16x16x64_bf16 v[48:51], v[72:75], v[88:95], v4
    ds_read_b128 v[88:91], v6 offset:14336
    ds_read_b128 v[92:95], v6 offset:15360
    s_waitcnt lgkmcnt(4)
    v_smfmac_f32_16x16x64_bf16 v[48:51], v[76:79], v[96:103], v4
    ds_read_b128 v[96:99], v6 offset:16384
    ds_read_b128 v[100:103], v6 offset:17408
    v_permlane32_swap_b32 v32, v40
    v_permlane32_swap_b32 v33, v41
    v_permlane32_swap_b32 v34, v42
    v_permlane32_swap_b32 v35, v43
    v_add_f32 v32, v32, v40
    v_add_f32 v33, v33, v41
    v_add_f32 v34, v34, v42
    v_add_f32 v35, v35, v43
    v_permlane32_swap_b32 v36, v44
    v_permlane32_swap_b32 v37, v45
    v_permlane32_swap_b32 v38, v46
    v_permlane32_swap_b32 v39, v47
    v_add_f32 v36, v36, v44
    v_add_f32 v37, v37, v45
    v_add_f32 v38, v38, v46
    v_add_f32 v39, v39, v47
    v_cvt_pk_bf16_f32 v60, v32, v33
    v_cvt_pk_bf16_f32 v61, v34, v35
    v_cvt_pk_bf16_f32 v62, v36, v37
    v_cvt_pk_bf16_f32 v63, v38, v39
    s_nop 0
    v_permlane16_swap_b32 v60, v62
    v_permlane16_swap_b32 v61, v63
    v_min_u32 v60, -2, v60
    v_min_u32 v61, -2, v61
    v_min_u32 v62, -2, v62
    v_min_u32 v63, -2, v63
    s_add_u32 s49, s43, 32768
    buffer_store_dwordx4 v[60:63], v14, s[8:11], s49 offen sc1
    s_waitcnt lgkmcnt(4)
    v_smfmac_f32_16x16x64_bf16 v[52:55], v[68:71], v[80:87], v4
    s_waitcnt lgkmcnt(2)
    v_smfmac_f32_16x16x64_bf16 v[52:55], v[72:75], v[88:95], v4
    s_waitcnt lgkmcnt(0)
    v_smfmac_f32_16x16x64_bf16 v[52:55], v[76:79], v[96:103], v4
    s_nop 11
    v_permlane32_swap_b32 v48, v52
    v_permlane32_swap_b32 v49, v53
    v_permlane32_swap_b32 v50, v54
    v_permlane32_swap_b32 v51, v55
    v_add_f32 v48, v48, v52
    v_add_f32 v49, v49, v53
    v_add_f32 v50, v50, v54
    v_add_f32 v51, v51, v55
    v_cvt_pk_bf16_f32 v64, v48, v49
    v_cvt_pk_bf16_f32 v65, v50, v51
    v_mov_b32 v66, v64
    v_mov_b32 v67, v65
    s_nop 0
    v_permlane16_swap_b32 v64, v66
    v_permlane16_swap_b32 v65, v67
    v_min_u32 v64, -2, v64
    v_min_u32 v65, -2, v65
    v_min_u32 v66, -2, v66
    v_min_u32 v67, -2, v67
    buffer_store_dwordx4 v[64:67], v15, s[8:11], s43 offen sc1
    s_add_u32 s40, s40, 1
    s_add_u32 s42, s42, 98304
    s_add_u32 s43, s43, 327680
    s_add_u32 s47, s47, 40960
    s_branch chainz_kernel_v_step
chainz_kernel_roleR:
    s_sub_u32 s44, s2, 64
    v_lshlrev_b32 v5, 4, v1
    s_lshl_b32 s24, s44, 15
    s_lshl_b32 s25, s3, 13
    s_add_u32 s24, s24, s25
    v_add_u32 v6, s24, v5
    v_add_u32 v7, 4096, v6
    s_lshl_b32 s24, s3, 12
    v_add_u32 v8, s24, v5
    s_lshl_b32 s24, s3, 10
    s_add_u32 s24, s24, 16384
    v_add_u32 v9, s24, v5
    s_lshl_b32 s24, s44, 13
    s_lshl_b32 s25, s3, 11
    s_add_u32 s24, s24, s25
    v_add_u32 v10, s24, v5
    v_and_b32 v16, 7, v2
    v_mul_u32_u24 v11, 80, v16
    v_lshl_add_u32 v11, v3, 4, v11
    s_mul_i32 s24, s3, 640
    v_add_u32 v11, s24, v11
    v_add_u32 v16, 8192, v5
    v_cmp_gt_u32 vcc, 8, v2
    s_nop 1
    v_cndmask_b32 v11, v16, v11, vcc
    v_and_b32 v16, 7, v2
    v_mul_u32_u24 v12, 80, v16
    v_lshrrev_b32 v16, 3, v2
    v_lshl_add_u32 v12, v16, 5, v12
    v_mul_u32_u24 v13, 10240, v3
    v_lshl_add_u32 v13, v2, 4, v13
    s_lshl_b32 s24, s44, 8
    v_add_u32 v13, s24, v13
    v_cmp_le_u32 s[50:51], 8, v2
    s_mov_b32 s40, 0
    s_mov_b32 s41, 184549376
    s_mov_b32 s43, 166199296
    s_mov_b32 s42, 142606336
    s_mov_b32 s47, 163618816
    s_and_b32 s24, s44, 3
    s_mul_i32 s24, s24, 20480
    s_add_u32 s43, s43, s24
chainz_kernel_r_step:
    buffer_load_dwordx4 v[16:19], v6, s[8:11], s41 offen offset:0
    buffer_load_dwordx4 v[20:23], v6, s[8:11], s41 offen offset:1024
    buffer_load_dwordx4 v[24:27], v6, s[8:11], s41 offen offset:2048
    buffer_load_dwordx4 v[28:31], v6, s[8:11], s41 offen offset:3072
    buffer_load_dwordx4 v[32:35], v7, s[8:11], s41 offen offset:0
    buffer_load_dwordx4 v[36:39], v7, s[8:11], s41 offen offset:1024
    buffer_load_dwordx4 v[40:43], v7, s[8:11], s41 offen offset:2048
    buffer_load_dwordx4 v[44:47], v7, s[8:11], s41 offen offset:3072
    s_mov_b32 s61, 0
chainz_kernel_r_p:
    buffer_load_dwordx4 v[48:51], v8, s[8:11], s43 offen offset:0 sc1
    buffer_load_dwordx4 v[52:55], v8, s[8:11], s43 offen offset:1024 sc1
    buffer_load_dwordx4 v[56:59], v8, s[8:11], s43 offen offset:2048 sc1
    buffer_load_dwordx4 v[60:63], v8, s[8:11], s43 offen offset:3072 sc1
    buffer_load_dwordx4 v[64:67], v9, s[8:11], s43 offen sc1
    buffer_load_dwordx4 v[68:71], v10, s[8:11], s42 offen offset:0 sc1
    buffer_load_dwordx4 v[72:75], v10, s[8:11], s42 offen offset:1024 sc1
    s_waitcnt vmcnt(0)
    v_max3_u32 v84, v48, v49, v50
    v_max3_u32 v84, v84, v51, v52
    v_max3_u32 v84, v84, v53, v54
    v_max3_u32 v84, v84, v55, v56
    v_max3_u32 v84, v84, v57, v58
    v_max3_u32 v84, v84, v59, v60
    v_max3_u32 v84, v84, v61, v62
    v_max3_u32 v84, v84, v63, v64
    v_max3_u32 v84, v84, v65, v66
    v_max3_u32 v84, v84, v67, v68
    v_max3_u32 v84, v84, v69, v70
    v_max3_u32 v84, v84, v71, v72
    v_max3_u32 v84, v84, v73, v74
    v_max_u32 v84, v84, v75
    v_cmp_eq_u32 vcc, -1, v84
    s_add_u32 s61, s61, 1
    s_cbranch_vccz chainz_kernel_r_p_out
    s_cmp_ge_u32 s61, s60
    s_cbranch_scc1 chainz_kernel_r_p_to
    s_sleep 1
    s_branch chainz_kernel_r_p
chainz_kernel_r_p_to:
    s_mov_b32 s60, 1
chainz_kernel_r_p_out:
    v_mfma_f32_16x16x32_bf16 v[76:79], v[68:71], v[64:67], 0
    v_mfma_f32_16x16x32_bf16 v[80:83], v[72:75], v[64:67], 0
    v_mfma_f32_16x16x32_bf16 v[76:79], v[16:19], v[48:51], v[76:79]
    v_mfma_f32_16x16x32_bf16 v[80:83], v[20:23], v[48:51], v[80:83]
    v_mfma_f32_16x16x32_bf16 v[76:79], v[24:27], v[52:55], v[76:79]
    v_mfma_f32_16x16x32_bf16 v[80:83], v[28:31], v[52:55], v[80:83]
    v_mfma_f32_16x16x32_bf16 v[76:79], v[32:35], v[56:59], v[76:79]
    v_mfma_f32_16x16x32_bf16 v[80:83], v[36:39], v[56:59], v[80:83]
    v_mfma_f32_16x16x32_bf16 v[76:79], v[40:43], v[60:63], v[76:79]
    v_mfma_f32_16x16x32_bf16 v[80:83], v[44:47], v[60:63], v[80:83]
    s_nop 7
    v_cndmask_b32 v76, v76, v80, s[50:51]
    v_cndmask_b32 v77, v77, v81, s[50:51]
    v_cndmask_b32 v78, v78, v82, s[50:51]
    v_cndmask_b32 v79, v79, v83, s[50:51]
    v_add_f32 v76, v76, v76 row_ror:8 row_mask:0xf bank_mask:0xf
    v_add_f32 v77, v77, v77 row_ror:8 row_mask:0xf bank_mask:0xf
    v_add_f32 v78, v78, v78 row_ror:8 row_mask:0xf bank_mask:0xf
    v_add_f32 v79, v79, v79 row_ror:8 row_mask:0xf bank_mask:0xf
    s_and_b32 s24, s40, 1
    s_mul_i32 s24, s24, 2560
    v_add_u32 v14, s24, v11
    ds_write_b128 v14, v[76:79]
    v_add_u32 v15, s24, v12
    s_waitcnt lgkmcnt(0)
    s_barrier
    s_cmp_eq_u32 s3, 0
    s_cbranch_scc0 chainz_kernel_np7
    ds_read_b128 v[48:51], v15 offset:0
    ds_read_b128 v[52:55], v15 offset:16
    ds_read_b128 v[56:59], v15 offset:640
    ds_read_b128 v[60:63], v15 offset:656
    ds_read_b128 v[64:67], v15 offset:1280
    ds_read_b128 v[68:71], v15 offset:1296
    ds_read_b128 v[72:75], v15 offset:1920
    ds_read_b128 v[76:79], v15 offset:1936
    s_waitcnt lgkmcnt(4)
    v_pk_add_f32 v[48:49], v[48:49], v[56:57]
    v_pk_add_f32 v[50:51], v[50:51], v[58:59]
    v_pk_add_f32 v[52:53], v[52:53], v[60:61]
    v_pk_add_f32 v[54:55], v[54:55], v[62:63]
    s_waitcnt lgkmcnt(0)
    v_pk_add_f32 v[64:65], v[64:65], v[72:73]
    v_pk_add_f32 v[66:67], v[66:67], v[74:75]
    v_pk_add_f32 v[68:69], v[68:69], v[76:77]
    v_pk_add_f32 v[70:71], v[70:71], v[78:79]
    v_pk_add_f32 v[48:49], v[48:49], v[64:65]
    v_pk_add_f32 v[50:51], v[50:51], v[66:67]
    v_pk_add_f32 v[52:53], v[52:53], v[68:69]
    v_pk_add_f32 v[54:55], v[54:55], v[70:71]
    v_cvt_pk_bf16_f32 v56, v48, v49
    v_cvt_pk_bf16_f32 v57, v50, v51
    v_cvt_pk_bf16_f32 v58, v52, v53
    v_cvt_pk_bf16_f32 v59, v54, v55
    v_min_u32 v56, -2, v56
    v_min_u32 v57, -2, v57
    v_min_u32 v58, -2, v58
    v_min_u32 v59, -2, v59
    buffer_store_dwordx4 v[56:59], v13, s[8:11], s47 offen sc1
chainz_kernel_np7:
    s_add_u32 s40, s40, 1
    s_add_u32 s41, s41, 1310720
    s_add_u32 s42, s42, 327680
    s_add_u32 s43, s43, 81920
    s_add_u32 s47, s47, 40960
    s_cmp_lt_u32 s40, 63
    s_cbranch_scc1 chainz_kernel_r_step
    s_branch chainz_kernel_end
chainz_kernel_end:
    s_endpgm
.section .rodata,"a"
.p2align 6
.amdhsa_kernel chainz_kernel
  .amdhsa_next_free_vgpr 512
  .amdhsa_next_free_sgpr 96
  .amdhsa_accum_offset 256
  .amdhsa_group_segment_fixed_size 0
  .amdhsa_kernarg_size 104
  .amdhsa_user_sgpr_count 2
  .amdhsa_user_sgpr_kernarg_segment_ptr 1
  .amdhsa_system_sgpr_workgroup_id_x 1
.end_amdhsa_kernel
.text
.globl attn_b_kernel
.p2align 8
.type attn_b_kernel,@function
attn_b_kernel:
    s_cmp_ge_u32 s2, 512
    s_cbranch_scc1 attn_b_kernel_end
    s_load_dwordx2 s[4:5], s[0:1], 96
    v_and_b32 v2, 63, v0
    v_lshrrev_b32 v1, 6, v0
    v_and_b32 v3, 15, v2
    v_lshrrev_b32 v4, 4, v2
    v_readfirstlane_b32 s3, v1
    s_lshr_b32 s20, s2, 3
    s_and_b32 s21, s2, 7
    s_lshl_b32 s21, s21, 2
    s_add_u32 s21, s21, s3
    s_waitcnt lgkmcnt(0)
    s_mov_b32 s8, s4
    s_mov_b32 s9, s5
    s_mov_b32 s10, 268435456
    s_mov_b32 s11, 0x00020000
    s_mul_i32 s22, s21, 384
    s_mul_i32 s23, s20, 393216
    s_add_u32 s23, s23, s22
    v_mul_u32_u24 v5, 12288, v3
    v_lshlrev_b32 v6, 4, v4
    v_add3_u32 v5, v5, v6, s23
    v_add_u32 v8, 67108864, v5
    v_add_u32 v10, 92274688, v5
    v_add_u32 v9, 67305472, v5
    v_add_u32 v11, 92471296, v5
    v_and_b32 v7, 7, v3
    v_mul_u32_u24 v7, 384, v7
    s_lshl_b32 s24, s20, 5
    s_add_u32 s24, s24, s21
    s_mul_i32 s24, s24, 3072
    s_add_u32 s24, s24, 171966464
    v_add3_u32 v12, v7, v6, s24
    buffer_load_dwordx4 v[16:19], v8, s[8:11], 0 offen offset:0
    buffer_load_dwordx4 v[40:43], v9, s[8:11], 0 offen offset:0
    buffer_load_dwordx4 v[64:67], v12, s[8:11], 0 offen offset:0
    buffer_load_dwordx4 v[88:91], v10, s[8:11], 0 offen offset:0
    buffer_load_dwordx4 v[112:115], v11, s[8:11], 0 offen offset:0
    buffer_load_dwordx4 v[20:23], v8, s[8:11], 0 offen offset:64
    buffer_load_dwordx4 v[44:47], v9, s[8:11], 0 offen offset:64
    buffer_load_dwordx4 v[68:71], v12, s[8:11], 0 offen offset:64
    buffer_load_dwordx4 v[92:95], v10, s[8:11], 0 offen offset:64
    buffer_load_dwordx4 v[116:119], v11, s[8:11], 0 offen offset:64
    buffer_load_dwordx4 v[24:27], v8, s[8:11], 0 offen offset:128
    buffer_load_dwordx4 v[48:51], v9, s[8:11], 0 offen offset:128
    buffer_load_dwordx4 v[72:75], v12, s[8:11], 0 offen offset:128
    buffer_load_dwordx4 v[96:99], v10, s[8:11], 0 offen offset:128
    buffer_load_dwordx4 v[120:123], v11, s[8:11], 0 offen offset:128
    buffer_load_dwordx4 v[28:31], v8, s[8:11], 0 offen offset:192
    buffer_load_dwordx4 v[52:55], v9, s[8:11], 0 offen offset:192
    buffer_load_dwordx4 v[76:79], v12, s[8:11], 0 offen offset:192
    buffer_load_dwordx4 v[100:103], v10, s[8:11], 0 offen offset:192
    buffer_load_dwordx4 v[124:127], v11, s[8:11], 0 offen offset:192
    buffer_load_dwordx4 v[32:35], v8, s[8:11], 0 offen offset:256
    buffer_load_dwordx4 v[56:59], v9, s[8:11], 0 offen offset:256
    buffer_load_dwordx4 v[80:83], v12, s[8:11], 0 offen offset:256
    buffer_load_dwordx4 v[104:107], v10, s[8:11], 0 offen offset:256
    buffer_load_dwordx4 v[128:131], v11, s[8:11], 0 offen offset:256
    buffer_load_dwordx4 v[36:39], v8, s[8:11], 0 offen offset:320
    buffer_load_dwordx4 v[60:63], v9, s[8:11], 0 offen offset:320
    buffer_load_dwordx4 v[84:87], v12, s[8:11], 0 offen offset:320
    buffer_load_dwordx4 v[108:111], v10, s[8:11], 0 offen offset:320
    buffer_load_dwordx4 v[132:135], v11, s[8:11], 0 offen offset:320
    v_mov_b32 v136, 0
    v_mov_b32 v137, 0
    v_mov_b32 v138, 0
    v_mov_b32 v139, 0
    v_mov_b32 v140, 0
    v_mov_b32 v141, 0
    v_mov_b32 v142, 0
    v_mov_b32 v143, 0
    v_mov_b32 v144, 0
    v_mov_b32 v145, 0
    v_mov_b32 v146, 0
    v_mov_b32 v147, 0
    v_mov_b32 v148, 0
    v_mov_b32 v149, 0
    v_mov_b32 v150, 0
    v_mov_b32 v151, 0
    v_mov_b32 v152, 0
    v_mov_b32 v153, 0
    v_mov_b32 v154, 0
    v_mov_b32 v155, 0
    v_mov_b32 v156, 0
    v_mov_b32 v157, 0
    v_mov_b32 v158, 0
    v_mov_b32 v159, 0
    s_waitcnt vmcnt(0)
    v_mfma_f32_16x16x32_bf16 v[136:139], v[64:67], v[16:19], v[136:139]
    v_mfma_f32_16x16x32_bf16 v[140:143], v[64:67], v[40:43], v[140:143]
    v_mfma_f32_16x16x32_bf16 v[144:147], v[88:91], v[16:19], v[144:147]
    v_mfma_f32_16x16x32_bf16 v[148:151], v[88:91], v[40:43], v[148:151]
    v_mfma_f32_16x16x32_bf16 v[152:155], v[112:115], v[16:19], v[152:155]
    v_mfma_f32_16x16x32_bf16 v[156:159], v[112:115], v[40:43], v[156:159]
    v_mfma_f32_16x16x32_bf16 v[136:139], v[68:71], v[20:23], v[136:139]
    v_mfma_f32_16x16x32_bf16 v[140:143], v[68:71], v[44:47], v[140:143]
    v_mfma_f32_16x16x32_bf16 v[144:147], v[92:95], v[20:23], v[144:147]
    v_mfma_f32_16x16x32_bf16 v[148:151], v[92:95], v[44:47], v[148:151]
    v_mfma_f32_16x16x32_bf16 v[152:155], v[116:119], v[20:23], v[152:155]
    v_mfma_f32_16x16x32_bf16 v[156:159], v[116:119], v[44:47], v[156:159]
    v_mfma_f32_16x16x32_bf16 v[136:139], v[72:75], v[24:27], v[136:139]
    v_mfma_f32_16x16x32_bf16 v[140:143], v[72:75], v[48:51], v[140:143]
    v_mfma_f32_16x16x32_bf16 v[144:147], v[96:99], v[24:27], v[144:147]
    v_mfma_f32_16x16x32_bf16 v[148:151], v[96:99], v[48:51], v[148:151]
    v_mfma_f32_16x16x32_bf16 v[152:155], v[120:123], v[24:27], v[152:155]
    v_mfma_f32_16x16x32_bf16 v[156:159], v[120:123], v[48:51], v[156:159]
    v_mfma_f32_16x16x32_bf16 v[136:139], v[76:79], v[28:31], v[136:139]
    v_mfma_f32_16x16x32_bf16 v[140:143], v[76:79], v[52:55], v[140:143]
    v_mfma_f32_16x16x32_bf16 v[144:147], v[100:103], v[28:31], v[144:147]
    v_mfma_f32_16x16x32_bf16 v[148:151], v[100:103], v[52:55], v[148:151]
    v_mfma_f32_16x16x32_bf16 v[152:155], v[124:127], v[28:31], v[152:155]
    v_mfma_f32_16x16x32_bf16 v[156:159], v[124:127], v[52:55], v[156:159]
    v_mfma_f32_16x16x32_bf16 v[136:139], v[80:83], v[32:35], v[136:139]
    v_mfma_f32_16x16x32_bf16 v[140:143], v[80:83], v[56:59], v[140:143]
    v_mfma_f32_16x16x32_bf16 v[144:147], v[104:107], v[32:35], v[144:147]
    v_mfma_f32_16x16x32_bf16 v[148:151], v[104:107], v[56:59], v[148:151]
    v_mfma_f32_16x16x32_bf16 v[152:155], v[128:131], v[32:35], v[152:155]
    v_mfma_f32_16x16x32_bf16 v[156:159], v[128:131], v[56:59], v[156:159]
    v_mfma_f32_16x16x32_bf16 v[136:139], v[84:87], v[36:39], v[136:139]
    v_mfma_f32_16x16x32_bf16 v[140:143], v[84:87], v[60:63], v[140:143]
    v_mfma_f32_16x16x32_bf16 v[144:147], v[108:111], v[36:39], v[144:147]
    v_mfma_f32_16x16x32_bf16 v[148:151], v[108:111], v[60:63], v[148:151]
    v_mfma_f32_16x16x32_bf16 v[152:155], v[132:135], v[36:39], v[152:155]
    v_mfma_f32_16x16x32_bf16 v[156:159], v[132:135], v[60:63], v[156:159]
    s_nop 7
    s_mov_b32 s25, 0x3dd53b95
    v_mov_b32 v13, 0xff800000
    v_lshlrev_b32 v14, 2, v4
    v_mul_f32 v136, s25, v136
    v_mul_f32 v137, s25, v137
    v_mul_f32 v138, s25, v138
    v_mul_f32 v139, s25, v139
    v_mul_f32 v144, s25, v144
    v_mul_f32 v145, s25, v145
    v_mul_f32 v146, s25, v146
    v_mul_f32 v147, s25, v147
    v_mul_f32 v152, s25, v152
    v_mul_f32 v153, s25, v153
    v_mul_f32 v154, s25, v154
    v_mul_f32 v155, s25, v155
    v_cmp_gt_u32 vcc, 2, v4
    v_cndmask_b32 v136, v13, v136, vcc
    v_cndmask_b32 v137, v13, v137, vcc
    v_cndmask_b32 v138, v13, v138, vcc
    v_cndmask_b32 v139, v13, v139, vcc
    v_add_u32 v15, 0, v14
    v_cmp_le_i32 vcc, v15, v3
    s_nop 1
    v_cndmask_b32 v144, v13, v144, vcc
    v_add_u32 v15, 1, v14
    v_cmp_le_i32 vcc, v15, v3
    s_nop 1
    v_cndmask_b32 v145, v13, v145, vcc
    v_add_u32 v15, 2, v14
    v_cmp_le_i32 vcc, v15, v3
    s_nop 1
    v_cndmask_b32 v146, v13, v146, vcc
    v_add_u32 v15, 3, v14
    v_cmp_le_i32 vcc, v15, v3
    s_nop 1
    v_cndmask_b32 v147, v13, v147, vcc
    v_add_u32 v15, 16, v14
    v_cmp_le_i32 vcc, v15, v3
    s_nop 1
    v_cndmask_b32 v152, v13, v152, vcc
    v_add_u32 v15, 17, v14
    v_cmp_le_i32 vcc, v15, v3
    s_nop 1
    v_cndmask_b32 v153, v13, v153, vcc
    v_add_u32 v15, 18, v14
    v_cmp_le_i32 vcc, v15, v3
    s_nop 1
    v_cndmask_b32 v154, v13, v154, vcc
    v_add_u32 v15, 19, v14
    v_cmp_le_i32 vcc, v15, v3
    s_nop 1
    v_cndmask_b32 v155, v13, v155, vcc
    v_max3_f32 v190, v136, v137, v138
    v_max3_f32 v190, v190, v139, v144
    v_max3_f32 v190, v190, v145, v146
    v_max3_f32 v190, v190, v147, v152
    v_max3_f32 v190, v190, v153, v154
    v_max_f32 v190, v190, v155
    v_mov_b32 v191, v190
    s_nop 1
    v_permlane16_swap_b32 v190, v191
    v_max_f32 v190, v190, v191
    v_mov_b32 v191, v190
    s_nop 1
    v_permlane32_swap_b32 v190, v191
    v_max_f32 v190, v190, v191
    v_sub_f32 v136, v136, v190
    v_exp_f32 v136, v136
    v_sub_f32 v137, v137, v190
    v_exp_f32 v137, v137
    v_sub_f32 v138, v138, v190
    v_exp_f32 v138, v138
    v_sub_f32 v139, v139, v190
    v_exp_f32 v139, v139
    v_sub_f32 v144, v144, v190
    v_exp_f32 v144, v144
    v_sub_f32 v145, v145, v190
    v_exp_f32 v145, v145
    v_sub_f32 v146, v146, v190
    v_exp_f32 v146, v146
    v_sub_f32 v147, v147, v190
    v_exp_f32 v147, v147
    v_sub_f32 v152, v152, v190
    v_exp_f32 v152, v152
    v_sub_f32 v153, v153, v190
    v_exp_f32 v153, v153
    v_sub_f32 v154, v154, v190
    v_exp_f32 v154, v154
    v_sub_f32 v155, v155, v190
    v_exp_f32 v155, v155
    s_nop 0
    v_add_f32 v190, v136, v137
    v_add_f32 v190, v190, v138
    v_add_f32 v190, v190, v139
    v_add_f32 v190, v190, v144
    v_add_f32 v190, v190, v145
    v_add_f32 v190, v190, v146
    v_add_f32 v190, v190, v147
    v_add_f32 v190, v190, v152
    v_add_f32 v190, v190, v153
    v_add_f32 v190, v190, v154
    v_add_f32 v190, v190, v155
    v_mov_b32 v191, v190
    s_nop 1
    v_permlane16_swap_b32 v190, v191
    v_add_f32 v190, v190, v191
    v_mov_b32 v191, v190
    s_nop 1
    v_permlane32_swap_b32 v190, v191
    v_add_f32 v190, v190, v191
    v_rcp_f32 v190, v190
    s_nop 0
    v_mul_f32 v136, v136, v190
    v_mul_f32 v137, v137, v190
    v_mul_f32 v138, v138, v190
    v_mul_f32 v139, v139, v190
    v_mul_f32 v144, v144, v190
    v_mul_f32 v145, v145, v190
    v_mul_f32 v146, v146, v190
    v_mul_f32 v147, v147, v190
    v_mul_f32 v152, v152, v190
    v_mul_f32 v153, v153, v190
    v_mul_f32 v154, v154, v190
    v_mul_f32 v155, v155, v190
    v_cvt_pk_bf16_f32 v160, v136, v137
    v_cvt_pk_bf16_f32 v161, v138, v139
    v_cvt_pk_bf16_f32 v162, v144, v145
    v_cvt_pk_bf16_f32 v163, v146, v147
    v_cvt_pk_bf16_f32 v164, v152, v153
    v_cvt_pk_bf16_f32 v165, v154, v155
    v_mul_f32 v140, s25, v140
    v_mul_f32 v141, s25, v141
    v_mul_f32 v142, s25, v142
    v_mul_f32 v143, s25, v143
    v_mul_f32 v148, s25, v148
    v_mul_f32 v149, s25, v149
    v_mul_f32 v150, s25, v150
    v_mul_f32 v151, s25, v151
    v_mul_f32 v156, s25, v156
    v_mul_f32 v157, s25, v157
    v_mul_f32 v158, s25, v158
    v_mul_f32 v159, s25, v159
    v_cmp_gt_u32 vcc, 2, v4
    v_cndmask_b32 v140, v13, v140, vcc
    v_cndmask_b32 v141, v13, v141, vcc
    v_cndmask_b32 v142, v13, v142, vcc
    v_cndmask_b32 v143, v13, v143, vcc
    v_subrev_u32 v15, 16, v14
    v_cmp_le_i32 vcc, v15, v3
    s_nop 1
    v_cndmask_b32 v148, v13, v148, vcc
    v_subrev_u32 v15, 15, v14
    v_cmp_le_i32 vcc, v15, v3
    s_nop 1
    v_cndmask_b32 v149, v13, v149, vcc
    v_subrev_u32 v15, 14, v14
    v_cmp_le_i32 vcc, v15, v3
    s_nop 1
    v_cndmask_b32 v150, v13, v150, vcc
    v_subrev_u32 v15, 13, v14
    v_cmp_le_i32 vcc, v15, v3
    s_nop 1
    v_cndmask_b32 v151, v13, v151, vcc
    v_add_u32 v15, 0, v14
    v_cmp_le_i32 vcc, v15, v3
    s_nop 1
    v_cndmask_b32 v156, v13, v156, vcc
    v_add_u32 v15, 1, v14
    v_cmp_le_i32 vcc, v15, v3
    s_nop 1
    v_cndmask_b32 v157, v13, v157, vcc
    v_add_u32 v15, 2, v14
    v_cmp_le_i32 vcc, v15, v3
    s_nop 1
    v_cndmask_b32 v158, v13, v158, vcc
    v_add_u32 v15, 3, v14
    v_cmp_le_i32 vcc, v15, v3
    s_nop 1
    v_cndmask_b32 v159, v13, v159, vcc
    v_max3_f32 v190, v140, v141, v142
    v_max3_f32 v190, v190, v143, v148
    v_max3_f32 v190, v190, v149, v150
    v_max3_f32 v190, v190, v151, v156
    v_max3_f32 v190, v190, v157, v158
    v_max_f32 v190, v190, v159
    v_mov_b32 v191, v190
    s_nop 1
    v_permlane16_swap_b32 v190, v191
    v_max_f32 v190, v190, v191
    v_mov_b32 v191, v190
    s_nop 1
    v_permlane32_swap_b32 v190, v191
    v_max_f32 v190, v190, v191
    v_sub_f32 v140, v140, v190
    v_exp_f32 v140, v140
    v_sub_f32 v141, v141, v190
    v_exp_f32 v141, v141
    v_sub_f32 v142, v142, v190
    v_exp_f32 v142, v142
    v_sub_f32 v143, v143, v190
    v_exp_f32 v143, v143
    v_sub_f32 v148, v148, v190
    v_exp_f32 v148, v148
    v_sub_f32 v149, v149, v190
    v_exp_f32 v149, v149
    v_sub_f32 v150, v150, v190
    v_exp_f32 v150, v150
    v_sub_f32 v151, v151, v190
    v_exp_f32 v151, v151
    v_sub_f32 v156, v156, v190
    v_exp_f32 v156, v156
    v_sub_f32 v157, v157, v190
    v_exp_f32 v157, v157
    v_sub_f32 v158, v158, v190
    v_exp_f32 v158, v158
    v_sub_f32 v159, v159, v190
    v_exp_f32 v159, v159
    s_nop 0
    v_add_f32 v190, v140, v141
    v_add_f32 v190, v190, v142
    v_add_f32 v190, v190, v143
    v_add_f32 v190, v190, v148
    v_add_f32 v190, v190, v149
    v_add_f32 v190, v190, v150
    v_add_f32 v190, v190, v151
    v_add_f32 v190, v190, v156
    v_add_f32 v190, v190, v157
    v_add_f32 v190, v190, v158
    v_add_f32 v190, v190, v159
    v_mov_b32 v191, v190
    s_nop 1
    v_permlane16_swap_b32 v190, v191
    v_add_f32 v190, v190, v191
    v_mov_b32 v191, v190
    s_nop 1
    v_permlane32_swap_b32 v190, v191
    v_add_f32 v190, v190, v191
    v_rcp_f32 v190, v190
    s_nop 0
    v_mul_f32 v140, v140, v190
    v_mul_f32 v141, v141, v190
    v_mul_f32 v142, v142, v190
    v_mul_f32 v143, v143, v190
    v_mul_f32 v148, v148, v190
    v_mul_f32 v149, v149, v190
    v_mul_f32 v150, v150, v190
    v_mul_f32 v151, v151, v190
    v_mul_f32 v156, v156, v190
    v_mul_f32 v157, v157, v190
    v_mul_f32 v158, v158, v190
    v_mul_f32 v159, v159, v190
    v_cvt_pk_bf16_f32 v166, v140, v141
    v_cvt_pk_bf16_f32 v167, v142, v143
    v_cvt_pk_bf16_f32 v168, v148, v149
    v_cvt_pk_bf16_f32 v169, v150, v151
    v_cvt_pk_bf16_f32 v170, v156, v157
    v_cvt_pk_bf16_f32 v171, v158, v159
    s_mul_i32 s26, s21, 192
    v_add_u32 v16, s26, v3
    v_lshlrev_b32 v17, 6, v16
    v_lshlrev_b32 v18, 3, v4
    v_add_u32 v17, v17, v18
    s_mul_i32 s27, s20, 393216
    s_add_u32 s27, s27, 117440512
    v_add_u32 v17, s27, v17
    v_lshlrev_b32 v19, 4, v16
    v_and_b32 v18, 1, v4
    v_lshlrev_b32 v18, 3, v18
    v_add_u32 v19, v19, v18
    s_mul_i32 s27, s20, 98304
    s_add_u32 s27, s27, 178257920
    v_add_u32 v19, s27, v19
    v_mul_u32_u24 v20, 12288, v3
    v_lshlrev_b32 v18, 3, v4
    v_add3_u32 v20, v20, v18, s23
    v_add_u32 v20, 184549376, v20
    buffer_load_dwordx2 v[172:173], v19, s[8:11], 0 offen offset:0
    buffer_load_dwordx2 v[174:175], v17, s[8:11], 0 offen offset:0
    buffer_load_dwordx2 v[176:177], v17, s[8:11], 0 offen offset:32
    v_mov_b32 v180, 0
    v_mov_b32 v181, 0
    v_mov_b32 v182, 0
    v_mov_b32 v183, 0
    v_mov_b32 v184, 0
    v_mov_b32 v185, 0
    v_mov_b32 v186, 0
    v_mov_b32 v187, 0
    s_waitcnt vmcnt(0)
    v_mfma_f32_16x16x16_bf16 v[180:183], v[172:173], v[160:161], v[180:183]
    v_mfma_f32_16x16x16_bf16 v[180:183], v[174:175], v[162:163], v[180:183]
    v_mfma_f32_16x16x16_bf16 v[180:183], v[176:177], v[164:165], v[180:183]
    v_mfma_f32_16x16x16_bf16 v[184:187], v[172:173], v[166:167], v[184:187]
    v_mfma_f32_16x16x16_bf16 v[184:187], v[174:175], v[168:169], v[184:187]
    v_mfma_f32_16x16x16_bf16 v[184:187], v[176:177], v[170:171], v[184:187]
    s_nop 7
    v_cvt_pk_bf16_f32 v190, v180, v181
    v_cvt_pk_bf16_f32 v191, v182, v183
    v_add_u32 v21, 0, v20
    buffer_store_dwordx2 v[190:191], v21, s[8:11], 0 offen
    v_cvt_pk_bf16_f32 v190, v184, v185
    v_cvt_pk_bf16_f32 v191, v186, v187
    v_add_u32 v21, 196608, v20
    buffer_store_dwordx2 v[190:191], v21, s[8:11], 0 offen
    buffer_load_dwordx2 v[172:173], v19, s[8:11], 0 offen offset:256
    buffer_load_dwordx2 v[174:175], v17, s[8:11], 0 offen offset:1024
    buffer_load_dwordx2 v[176:177], v17, s[8:11], 0 offen offset:1056
    v_mov_b32 v180, 0
    v_mov_b32 v181, 0
    v_mov_b32 v182, 0
    v_mov_b32 v183, 0
    v_mov_b32 v184, 0
    v_mov_b32 v185, 0
    v_mov_b32 v186, 0
    v_mov_b32 v187, 0
    s_waitcnt vmcnt(0)
    v_mfma_f32_16x16x16_bf16 v[180:183], v[172:173], v[160:161], v[180:183]
    v_mfma_f32_16x16x16_bf16 v[180:183], v[174:175], v[162:163], v[180:183]
    v_mfma_f32_16x16x16_bf16 v[180:183], v[176:177], v[164:165], v[180:183]
    v_mfma_f32_16x16x16_bf16 v[184:187], v[172:173], v[166:167], v[184:187]
    v_mfma_f32_16x16x16_bf16 v[184:187], v[174:175], v[168:169], v[184:187]
    v_mfma_f32_16x16x16_bf16 v[184:187], v[176:177], v[170:171], v[184:187]
    s_nop 7
    v_cvt_pk_bf16_f32 v190, v180, v181
    v_cvt_pk_bf16_f32 v191, v182, v183
    v_add_u32 v21, 32, v20
    buffer_store_dwordx2 v[190:191], v21, s[8:11], 0 offen
    v_cvt_pk_bf16_f32 v190, v184, v185
    v_cvt_pk_bf16_f32 v191, v186, v187
    v_add_u32 v21, 196640, v20
    buffer_store_dwordx2 v[190:191], v21, s[8:11], 0 offen
    buffer_load_dwordx2 v[172:173], v19, s[8:11], 0 offen offset:512
    buffer_load_dwordx2 v[174:175], v17, s[8:11], 0 offen offset:2048
    buffer_load_dwordx2 v[176:177], v17, s[8:11], 0 offen offset:2080
    v_mov_b32 v180, 0
    v_mov_b32 v181, 0
    v_mov_b32 v182, 0
    v_mov_b32 v183, 0
    v_mov_b32 v184, 0
    v_mov_b32 v185, 0
    v_mov_b32 v186, 0
    v_mov_b32 v187, 0
    s_waitcnt vmcnt(0)
    v_mfma_f32_16x16x16_bf16 v[180:183], v[172:173], v[160:161], v[180:183]
    v_mfma_f32_16x16x16_bf16 v[180:183], v[174:175], v[162:163], v[180:183]
    v_mfma_f32_16x16x16_bf16 v[180:183], v[176:177], v[164:165], v[180:183]
    v_mfma_f32_16x16x16_bf16 v[184:187], v[172:173], v[166:167], v[184:187]
    v_mfma_f32_16x16x16_bf16 v[184:187], v[174:175], v[168:169], v[184:187]
    v_mfma_f32_16x16x16_bf16 v[184:187], v[176:177], v[170:171], v[184:187]
    s_nop 7
    v_cvt_pk_bf16_f32 v190, v180, v181
    v_cvt_pk_bf16_f32 v191, v182, v183
    v_add_u32 v21, 64, v20
    buffer_store_dwordx2 v[190:191], v21, s[8:11], 0 offen
    v_cvt_pk_bf16_f32 v190, v184, v185
    v_cvt_pk_bf16_f32 v191, v186, v187
    v_add_u32 v21, 196672, v20
    buffer_store_dwordx2 v[190:191], v21, s[8:11], 0 offen
    buffer_load_dwordx2 v[172:173], v19, s[8:11], 0 offen offset:768
    buffer_load_dwordx2 v[174:175], v17, s[8:11], 0 offen offset:3072
    buffer_load_dwordx2 v[176:177], v17, s[8:11], 0 offen offset:3104
    v_mov_b32 v180, 0
    v_mov_b32 v181, 0
    v_mov_b32 v182, 0
    v_mov_b32 v183, 0
    v_mov_b32 v184, 0
    v_mov_b32 v185, 0
    v_mov_b32 v186, 0
    v_mov_b32 v187, 0
    s_waitcnt vmcnt(0)
    v_mfma_f32_16x16x16_bf16 v[180:183], v[172:173], v[160:161], v[180:183]
    v_mfma_f32_16x16x16_bf16 v[180:183], v[174:175], v[162:163], v[180:183]
    v_mfma_f32_16x16x16_bf16 v[180:183], v[176:177], v[164:165], v[180:183]
    v_mfma_f32_16x16x16_bf16 v[184:187], v[172:173], v[166:167], v[184:187]
    v_mfma_f32_16x16x16_bf16 v[184:187], v[174:175], v[168:169], v[184:187]
    v_mfma_f32_16x16x16_bf16 v[184:187], v[176:177], v[170:171], v[184:187]
    s_nop 7
    v_cvt_pk_bf16_f32 v190, v180, v181
    v_cvt_pk_bf16_f32 v191, v182, v183
    v_add_u32 v21, 96, v20
    buffer_store_dwordx2 v[190:191], v21, s[8:11], 0 offen
    v_cvt_pk_bf16_f32 v190, v184, v185
    v_cvt_pk_bf16_f32 v191, v186, v187
    v_add_u32 v21, 196704, v20
    buffer_store_dwordx2 v[190:191], v21, s[8:11], 0 offen
    buffer_load_dwordx2 v[172:173], v19, s[8:11], 0 offen offset:1024
    s_mov_b32 s63, 4096
    buffer_load_dwordx2 v[174:175], v17, s[8:11], s63 offen
    s_mov_b32 s63, 4128
    buffer_load_dwordx2 v[176:177], v17, s[8:11], s63 offen
    v_mov_b32 v180, 0
    v_mov_b32 v181, 0
    v_mov_b32 v182, 0
    v_mov_b32 v183, 0
    v_mov_b32 v184, 0
    v_mov_b32 v185, 0
    v_mov_b32 v186, 0
    v_mov_b32 v187, 0
    s_waitcnt vmcnt(0)
    v_mfma_f32_16x16x16_bf16 v[180:183], v[172:173], v[160:161], v[180:183]
    v_mfma_f32_16x16x16_bf16 v[180:183], v[174:175], v[162:163], v[180:183]
    v_mfma_f32_16x16x16_bf16 v[180:183], v[176:177], v[164:165], v[180:183]
    v_mfma_f32_16x16x16_bf16 v[184:187], v[172:173], v[166:167], v[184:187]
    v_mfma_f32_16x16x16_bf16 v[184:187], v[174:175], v[168:169], v[184:187]
    v_mfma_f32_16x16x16_bf16 v[184:187], v[176:177], v[170:171], v[184:187]
    s_nop 7
    v_cvt_pk_bf16_f32 v190, v180, v181
    v_cvt_pk_bf16_f32 v191, v182, v183
    v_add_u32 v21, 128, v20
    buffer_store_dwordx2 v[190:191], v21, s[8:11], 0 offen
    v_cvt_pk_bf16_f32 v190, v184, v185
    v_cvt_pk_bf16_f32 v191, v186, v187
    v_add_u32 v21, 196736, v20
    buffer_store_dwordx2 v[190:191], v21, s[8:11], 0 offen
    buffer_load_dwordx2 v[172:173], v19, s[8:11], 0 offen offset:1280
    s_mov_b32 s63, 5120
    buffer_load_dwordx2 v[174:175], v17, s[8:11], s63 offen
    s_mov_b32 s63, 5152
    buffer_load_dwordx2 v[176:177], v17, s[8:11], s63 offen
    v_mov_b32 v180, 0
    v_mov_b32 v181, 0
    v_mov_b32 v182, 0
    v_mov_b32 v183, 0
    v_mov_b32 v184, 0
    v_mov_b32 v185, 0
    v_mov_b32 v186, 0
    v_mov_b32 v187, 0
    s_waitcnt vmcnt(0)
    v_mfma_f32_16x16x16_bf16 v[180:183], v[172:173], v[160:161], v[180:183]
    v_mfma_f32_16x16x16_bf16 v[180:183], v[174:175], v[162:163], v[180:183]
    v_mfma_f32_16x16x16_bf16 v[180:183], v[176:177], v[164:165], v[180:183]
    v_mfma_f32_16x16x16_bf16 v[184:187], v[172:173], v[166:167], v[184:187]
    v_mfma_f32_16x16x16_bf16 v[184:187], v[174:175], v[168:169], v[184:187]
    v_mfma_f32_16x16x16_bf16 v[184:187], v[176:177], v[170:171], v[184:187]
    s_nop 7
    v_cvt_pk_bf16_f32 v190, v180, v181
    v_cvt_pk_bf16_f32 v191, v182, v183
    v_add_u32 v21, 160, v20
    buffer_store_dwordx2 v[190:191], v21, s[8:11], 0 offen
    v_cvt_pk_bf16_f32 v190, v184, v185
    v_cvt_pk_bf16_f32 v191, v186, v187
    v_add_u32 v21, 196768, v20
    buffer_store_dwordx2 v[190:191], v21, s[8:11], 0 offen
    buffer_load_dwordx2 v[172:173], v19, s[8:11], 0 offen offset:1536
    s_mov_b32 s63, 6144
    buffer_load_dwordx2 v[174:175], v17, s[8:11], s63 offen
    s_mov_b32 s63, 6176
    buffer_load_dwordx2 v[176:177], v17, s[8:11], s63 offen
    v_mov_b32 v180, 0
    v_mov_b32 v181, 0
    v_mov_b32 v182, 0
    v_mov_b32 v183, 0
    v_mov_b32 v184, 0
    v_mov_b32 v185, 0
    v_mov_b32 v186, 0
    v_mov_b32 v187, 0
    s_waitcnt vmcnt(0)
    v_mfma_f32_16x16x16_bf16 v[180:183], v[172:173], v[160:161], v[180:183]
    v_mfma_f32_16x16x16_bf16 v[180:183], v[174:175], v[162:163], v[180:183]
    v_mfma_f32_16x16x16_bf16 v[180:183], v[176:177], v[164:165], v[180:183]
    v_mfma_f32_16x16x16_bf16 v[184:187], v[172:173], v[166:167], v[184:187]
    v_mfma_f32_16x16x16_bf16 v[184:187], v[174:175], v[168:169], v[184:187]
    v_mfma_f32_16x16x16_bf16 v[184:187], v[176:177], v[170:171], v[184:187]
    s_nop 7
    v_cvt_pk_bf16_f32 v190, v180, v181
    v_cvt_pk_bf16_f32 v191, v182, v183
    v_add_u32 v21, 192, v20
    buffer_store_dwordx2 v[190:191], v21, s[8:11], 0 offen
    v_cvt_pk_bf16_f32 v190, v184, v185
    v_cvt_pk_bf16_f32 v191, v186, v187
    v_add_u32 v21, 196800, v20
    buffer_store_dwordx2 v[190:191], v21, s[8:11], 0 offen
    buffer_load_dwordx2 v[172:173], v19, s[8:11], 0 offen offset:1792
    s_mov_b32 s63, 7168
    buffer_load_dwordx2 v[174:175], v17, s[8:11], s63 offen
    s_mov_b32 s63, 7200
    buffer_load_dwordx2 v[176:177], v17, s[8:11], s63 offen
    v_mov_b32 v180, 0
    v_mov_b32 v181, 0
    v_mov_b32 v182, 0
    v_mov_b32 v183, 0
    v_mov_b32 v184, 0
    v_mov_b32 v185, 0
    v_mov_b32 v186, 0
    v_mov_b32 v187, 0
    s_waitcnt vmcnt(0)
    v_mfma_f32_16x16x16_bf16 v[180:183], v[172:173], v[160:161], v[180:183]
    v_mfma_f32_16x16x16_bf16 v[180:183], v[174:175], v[162:163], v[180:183]
    v_mfma_f32_16x16x16_bf16 v[180:183], v[176:177], v[164:165], v[180:183]
    v_mfma_f32_16x16x16_bf16 v[184:187], v[172:173], v[166:167], v[184:187]
    v_mfma_f32_16x16x16_bf16 v[184:187], v[174:175], v[168:169], v[184:187]
    v_mfma_f32_16x16x16_bf16 v[184:187], v[176:177], v[170:171], v[184:187]
    s_nop 7
    v_cvt_pk_bf16_f32 v190, v180, v181
    v_cvt_pk_bf16_f32 v191, v182, v183
    v_add_u32 v21, 224, v20
    buffer_store_dwordx2 v[190:191], v21, s[8:11], 0 offen
    v_cvt_pk_bf16_f32 v190, v184, v185
    v_cvt_pk_bf16_f32 v191, v186, v187
    v_add_u32 v21, 196832, v20
    buffer_store_dwordx2 v[190:191], v21, s[8:11], 0 offen
    buffer_load_dwordx2 v[172:173], v19, s[8:11], 0 offen offset:2048
    s_mov_b32 s63, 8192
    buffer_load_dwordx2 v[174:175], v17, s[8:11], s63 offen
    s_mov_b32 s63, 8224
    buffer_load_dwordx2 v[176:177], v17, s[8:11], s63 offen
    v_mov_b32 v180, 0
    v_mov_b32 v181, 0
    v_mov_b32 v182, 0
    v_mov_b32 v183, 0
    v_mov_b32 v184, 0
    v_mov_b32 v185, 0
    v_mov_b32 v186, 0
    v_mov_b32 v187, 0
    s_waitcnt vmcnt(0)
    v_mfma_f32_16x16x16_bf16 v[180:183], v[172:173], v[160:161], v[180:183]
    v_mfma_f32_16x16x16_bf16 v[180:183], v[174:175], v[162:163], v[180:183]
    v_mfma_f32_16x16x16_bf16 v[180:183], v[176:177], v[164:165], v[180:183]
    v_mfma_f32_16x16x16_bf16 v[184:187], v[172:173], v[166:167], v[184:187]
    v_mfma_f32_16x16x16_bf16 v[184:187], v[174:175], v[168:169], v[184:187]
    v_mfma_f32_16x16x16_bf16 v[184:187], v[176:177], v[170:171], v[184:187]
    s_nop 7
    v_cvt_pk_bf16_f32 v190, v180, v181
    v_cvt_pk_bf16_f32 v191, v182, v183
    v_add_u32 v21, 256, v20
    buffer_store_dwordx2 v[190:191], v21, s[8:11], 0 offen
    v_cvt_pk_bf16_f32 v190, v184, v185
    v_cvt_pk_bf16_f32 v191, v186, v187
    v_add_u32 v21, 196864, v20
    buffer_store_dwordx2 v[190:191], v21, s[8:11], 0 offen
    buffer_load_dwordx2 v[172:173], v19, s[8:11], 0 offen offset:2304
    s_mov_b32 s63, 9216
    buffer_load_dwordx2 v[174:175], v17, s[8:11], s63 offen
    s_mov_b32 s63, 9248
    buffer_load_dwordx2 v[176:177], v17, s[8:11], s63 offen
    v_mov_b32 v180, 0
    v_mov_b32 v181, 0
    v_mov_b32 v182, 0
    v_mov_b32 v183, 0
    v_mov_b32 v184, 0
    v_mov_b32 v185, 0
    v_mov_b32 v186, 0
    v_mov_b32 v187, 0
    s_waitcnt vmcnt(0)
    v_mfma_f32_16x16x16_bf16 v[180:183], v[172:173], v[160:161], v[180:183]
    v_mfma_f32_16x16x16_bf16 v[180:183], v[174:175], v[162:163], v[180:183]
    v_mfma_f32_16x16x16_bf16 v[180:183], v[176:177], v[164:165], v[180:183]
    v_mfma_f32_16x16x16_bf16 v[184:187], v[172:173], v[166:167], v[184:187]
    v_mfma_f32_16x16x16_bf16 v[184:187], v[174:175], v[168:169], v[184:187]
    v_mfma_f32_16x16x16_bf16 v[184:187], v[176:177], v[170:171], v[184:187]
    s_nop 7
    v_cvt_pk_bf16_f32 v190, v180, v181
    v_cvt_pk_bf16_f32 v191, v182, v183
    v_add_u32 v21, 288, v20
    buffer_store_dwordx2 v[190:191], v21, s[8:11], 0 offen
    v_cvt_pk_bf16_f32 v190, v184, v185
    v_cvt_pk_bf16_f32 v191, v186, v187
    v_add_u32 v21, 196896, v20
    buffer_store_dwordx2 v[190:191], v21, s[8:11], 0 offen
    buffer_load_dwordx2 v[172:173], v19, s[8:11], 0 offen offset:2560
    s_mov_b32 s63, 10240
    buffer_load_dwordx2 v[174:175], v17, s[8:11], s63 offen
    s_mov_b32 s63, 10272
    buffer_load_dwordx2 v[176:177], v17, s[8:11], s63 offen
    v_mov_b32 v180, 0
    v_mov_b32 v181, 0
    v_mov_b32 v182, 0
    v_mov_b32 v183, 0
    v_mov_b32 v184, 0
    v_mov_b32 v185, 0
    v_mov_b32 v186, 0
    v_mov_b32 v187, 0
    s_waitcnt vmcnt(0)
    v_mfma_f32_16x16x16_bf16 v[180:183], v[172:173], v[160:161], v[180:183]
    v_mfma_f32_16x16x16_bf16 v[180:183], v[174:175], v[162:163], v[180:183]
    v_mfma_f32_16x16x16_bf16 v[180:183], v[176:177], v[164:165], v[180:183]
    v_mfma_f32_16x16x16_bf16 v[184:187], v[172:173], v[166:167], v[184:187]
    v_mfma_f32_16x16x16_bf16 v[184:187], v[174:175], v[168:169], v[184:187]
    v_mfma_f32_16x16x16_bf16 v[184:187], v[176:177], v[170:171], v[184:187]
    s_nop 7
    v_cvt_pk_bf16_f32 v190, v180, v181
    v_cvt_pk_bf16_f32 v191, v182, v183
    v_add_u32 v21, 320, v20
    buffer_store_dwordx2 v[190:191], v21, s[8:11], 0 offen
    v_cvt_pk_bf16_f32 v190, v184, v185
    v_cvt_pk_bf16_f32 v191, v186, v187
    v_add_u32 v21, 196928, v20
    buffer_store_dwordx2 v[190:191], v21, s[8:11], 0 offen
    buffer_load_dwordx2 v[172:173], v19, s[8:11], 0 offen offset:2816
    s_mov_b32 s63, 11264
    buffer_load_dwordx2 v[174:175], v17, s[8:11], s63 offen
    s_mov_b32 s63, 11296
    buffer_load_dwordx2 v[176:177], v17, s[8:11], s63 offen
    v_mov_b32 v180, 0
    v_mov_b32 v181, 0
    v_mov_b32 v182, 0
    v_mov_b32 v183, 0
    v_mov_b32 v184, 0
    v_mov_b32 v185, 0
    v_mov_b32 v186, 0
    v_mov_b32 v187, 0
    s_waitcnt vmcnt(0)
    v_mfma_f32_16x16x16_bf16 v[180:183], v[172:173], v[160:161], v[180:183]
    v_mfma_f32_16x16x16_bf16 v[180:183], v[174:175], v[162:163], v[180:183]
    v_mfma_f32_16x16x16_bf16 v[180:183], v[176:177], v[164:165], v[180:183]
    v_mfma_f32_16x16x16_bf16 v[184:187], v[172:173], v[166:167], v[184:187]
    v_mfma_f32_16x16x16_bf16 v[184:187], v[174:175], v[168:169], v[184:187]
    v_mfma_f32_16x16x16_bf16 v[184:187], v[176:177], v[170:171], v[184:187]
    s_nop 7
    v_cvt_pk_bf16_f32 v190, v180, v181
    v_cvt_pk_bf16_f32 v191, v182, v183
    v_add_u32 v21, 352, v20
    buffer_store_dwordx2 v[190:191], v21, s[8:11], 0 offen
    v_cvt_pk_bf16_f32 v190, v184, v185
    v_cvt_pk_bf16_f32 v191, v186, v187
    v_add_u32 v21, 196960, v20
    buffer_store_dwordx2 v[190:191], v21, s[8:11], 0 offen
attn_b_kernel_end:
    s_endpgm
.section .rodata,"a"
.p2align 6
.amdhsa_kernel attn_b_kernel
  .amdhsa_next_free_vgpr 200
  .amdhsa_next_free_sgpr 48
  .amdhsa_accum_offset 200
  .amdhsa_group_segment_fixed_size 0
  .amdhsa_kernarg_size 104
  .amdhsa_user_sgpr_count 2
  .amdhsa_user_sgpr_kernarg_segment_ptr 1
  .amdhsa_system_sgpr_workgroup_id_x 1
.end_amdhsa_kernel
.text
.globl wo_b1_kernel
.p2align 8
.type wo_b1_kernel,@function
wo_b1_kernel:
    v_lshrrev_b32 v1, 6, v0
    v_and_b32 v2, 63, v0
    s_nop 0
    v_readfirstlane_b32 s3, v1
    s_cmp_ge_u32 s2, 256
    s_cbranch_scc1 wo_b1_kernel_end
    s_load_dwordx2 s[4:5], s[0:1], 96
    s_load_dwordx2 s[6:7], s[0:1], 80
    s_mul_i32 s20, s2, 1
    s_lshr_b32 s20, s20, 3
    s_mul_i32 s21, s20, 8
    s_sub_u32 s21, s2, s21
    s_mul_i32 s22, s20, 64
    s_mul_i32 s23, s21, 80
    s_waitcnt lgkmcnt(0)
    s_mov_b32 s8, s4
    s_mov_b32 s9, s5
    s_mov_b32 s10, 268435456
    s_mov_b32 s11, 0x00020000
    v_and_b32 v3, 15, v2
    v_lshrrev_b32 v4, 4, v2
    s_mov_b32 s24, 12288
    v_add_u32 v5, s22, v3
    v_mul_lo_u32 v5, v5, s24
    v_lshlrev_b32 v6, 4, v4
    v_add_u32 v5, v5, v6
    v_add_u32 v5, 184549376, v5
    v_mov_b32 v8, v5
    v_add_u32 v9, 196608, v5
    v_add_u32 v10, 393216, v5
    v_add_u32 v11, 589824, v5
    v_lshlrev_b32 v7, 4, v2
    s_mul_i32 s26, s3, 49152
    s_mul_i32 s25, s3, 3072
    s_mul_i32 s27, s21, 983040
    s_add_u32 s27, s27, s26
    s_add_u32 s27, s27, 58720256
    s_add_u32 s32, s27, 0
    s_add_u32 s33, s27, 196608
    s_add_u32 s34, s27, 393216
    s_add_u32 s35, s27, 589824
    s_add_u32 s36, s27, 786432
    v_accvgpr_write_b32 a0, 0
    v_accvgpr_write_b32 a1, 0
    v_accvgpr_write_b32 a2, 0
    v_accvgpr_write_b32 a3, 0
    v_accvgpr_write_b32 a4, 0
    v_accvgpr_write_b32 a5, 0
    v_accvgpr_write_b32 a6, 0
    v_accvgpr_write_b32 a7, 0
    v_accvgpr_write_b32 a8, 0
    v_accvgpr_write_b32 a9, 0
    v_accvgpr_write_b32 a10, 0
    v_accvgpr_write_b32 a11, 0
    v_accvgpr_write_b32 a12, 0
    v_accvgpr_write_b32 a13, 0
    v_accvgpr_write_b32 a14, 0
    v_accvgpr_write_b32 a15, 0
    v_accvgpr_write_b32 a16, 0
    v_accvgpr_write_b32 a17, 0
    v_accvgpr_write_b32 a18, 0
    v_accvgpr_write_b32 a19, 0
    v_accvgpr_write_b32 a20, 0
    v_accvgpr_write_b32 a21, 0
    v_accvgpr_write_b32 a22, 0
    v_accvgpr_write_b32 a23, 0
    v_accvgpr_write_b32 a24, 0
    v_accvgpr_write_b32 a25, 0
    v_accvgpr_write_b32 a26, 0
    v_accvgpr_write_b32 a27, 0
    v_accvgpr_write_b32 a28, 0
    v_accvgpr_write_b32 a29, 0
    v_accvgpr_write_b32 a30, 0
    v_accvgpr_write_b32 a31, 0
    v_accvgpr_write_b32 a32, 0
    v_accvgpr_write_b32 a33, 0
    v_accvgpr_write_b32 a34, 0
    v_accvgpr_write_b32 a35, 0
    v_accvgpr_write_b32 a36, 0
    v_accvgpr_write_b32 a37, 0
    v_accvgpr_write_b32 a38, 0
    v_accvgpr_write_b32 a39, 0
    v_accvgpr_write_b32 a40, 0
    v_accvgpr_write_b32 a41, 0
    v_accvgpr_write_b32 a42, 0
    v_accvgpr_write_b32 a43, 0
    v_accvgpr_write_b32 a44, 0
    v_accvgpr_write_b32 a45, 0
    v_accvgpr_write_b32 a46, 0
    v_accvgpr_write_b32 a47, 0
    v_accvgpr_write_b32 a48, 0
    v_accvgpr_write_b32 a49, 0
    v_accvgpr_write_b32 a50, 0
    v_accvgpr_write_b32 a51, 0
    v_accvgpr_write_b32 a52, 0
    v_accvgpr_write_b32 a53, 0
    v_accvgpr_write_b32 a54, 0
    v_accvgpr_write_b32 a55, 0
    v_accvgpr_write_b32 a56, 0
    v_accvgpr_write_b32 a57, 0
    v_accvgpr_write_b32 a58, 0
    v_accvgpr_write_b32 a59, 0
    v_accvgpr_write_b32 a60, 0
    v_accvgpr_write_b32 a61, 0
    v_accvgpr_write_b32 a62, 0
    v_accvgpr_write_b32 a63, 0
    v_accvgpr_write_b32 a64, 0
    v_accvgpr_write_b32 a65, 0
    v_accvgpr_write_b32 a66, 0
    v_accvgpr_write_b32 a67, 0
    v_accvgpr_write_b32 a68, 0
    v_accvgpr_write_b32 a69, 0
    v_accvgpr_write_b32 a70, 0
    v_accvgpr_write_b32 a71, 0
    v_accvgpr_write_b32 a72, 0
    v_accvgpr_write_b32 a73, 0
    v_accvgpr_write_b32 a74, 0
    v_accvgpr_write_b32 a75, 0
    v_accvgpr_write_b32 a76, 0
    v_accvgpr_write_b32 a77, 0
    v_accvgpr_write_b32 a78, 0
    v_accvgpr_write_b32 a79, 0
    buffer_load_dwordx4 v[16:19], v8, s[8:11], s25 offen
    buffer_load_dwordx4 v[20:23], v9, s[8:11], s25 offen
    buffer_load_dwordx4 v[24:27], v10, s[8:11], s25 offen
    buffer_load_dwordx4 v[28:31], v11, s[8:11], s25 offen
    buffer_load_dwordx4 v[32:35], v7, s[8:11], s32 offen
    buffer_load_dwordx4 v[36:39], v7, s[8:11], s33 offen
    buffer_load_dwordx4 v[40:43], v7, s[8:11], s34 offen
    buffer_load_dwordx4 v[44:47], v7, s[8:11], s35 offen
    buffer_load_dwordx4 v[48:51], v7, s[8:11], s36 offen
    s_mov_b32 s28, 24
wo_b1_kernel_loop0:
    s_add_u32 s25, s25, 64
    s_add_u32 s32, s32, 1024
    s_add_u32 s33, s33, 1024
    s_add_u32 s34, s34, 1024
    s_add_u32 s35, s35, 1024
    s_add_u32 s36, s36, 1024
    buffer_load_dwordx4 v[52:55], v8, s[8:11], s25 offen
    buffer_load_dwordx4 v[56:59], v9, s[8:11], s25 offen
    buffer_load_dwordx4 v[60:63], v10, s[8:11], s25 offen
    buffer_load_dwordx4 v[64:67], v11, s[8:11], s25 offen
    buffer_load_dwordx4 v[68:71], v7, s[8:11], s32 offen
    buffer_load_dwordx4 v[72:75], v7, s[8:11], s33 offen
    buffer_load_dwordx4 v[76:79], v7, s[8:11], s34 offen
    buffer_load_dwordx4 v[80:83], v7, s[8:11], s35 offen
    buffer_load_dwordx4 v[84:87], v7, s[8:11], s36 offen
    s_waitcnt vmcnt(9)
    v_mfma_f32_16x16x32_bf16 a[0:3], v[32:35], v[16:19], a[0:3]
    v_mfma_f32_16x16x32_bf16 a[20:23], v[32:35], v[20:23], a[20:23]
    v_mfma_f32_16x16x32_bf16 a[40:43], v[32:35], v[24:27], a[40:43]
    v_mfma_f32_16x16x32_bf16 a[60:63], v[32:35], v[28:31], a[60:63]
    v_mfma_f32_16x16x32_bf16 a[4:7], v[36:39], v[16:19], a[4:7]
    v_mfma_f32_16x16x32_bf16 a[24:27], v[36:39], v[20:23], a[24:27]
    v_mfma_f32_16x16x32_bf16 a[44:47], v[36:39], v[24:27], a[44:47]
    v_mfma_f32_16x16x32_bf16 a[64:67], v[36:39], v[28:31], a[64:67]
    v_mfma_f32_16x16x32_bf16 a[8:11], v[40:43], v[16:19], a[8:11]
    v_mfma_f32_16x16x32_bf16 a[28:31], v[40:43], v[20:23], a[28:31]
    v_mfma_f32_16x16x32_bf16 a[48:51], v[40:43], v[24:27], a[48:51]
    v_mfma_f32_16x16x32_bf16 a[68:71], v[40:43], v[28:31], a[68:71]
    v_mfma_f32_16x16x32_bf16 a[12:15], v[44:47], v[16:19], a[12:15]
    v_mfma_f32_16x16x32_bf16 a[32:35], v[44:47], v[20:23], a[32:35]
    v_mfma_f32_16x16x32_bf16 a[52:55], v[44:47], v[24:27], a[52:55]
    v_mfma_f32_16x16x32_bf16 a[72:75], v[44:47], v[28:31], a[72:75]
    v_mfma_f32_16x16x32_bf16 a[16:19], v[48:51], v[16:19], a[16:19]
    v_mfma_f32_16x16x32_bf16 a[36:39], v[48:51], v[20:23], a[36:39]
    v_mfma_f32_16x16x32_bf16 a[56:59], v[48:51], v[24:27], a[56:59]
    v_mfma_f32_16x16x32_bf16 a[76:79], v[48:51], v[28:31], a[76:79]
    s_sub_u32 s28, s28, 1
    s_cmp_eq_u32 s28, 0
    s_cbranch_scc1 wo_b1_kernel_loop0_last
    s_add_u32 s25, s25, 64
    s_add_u32 s32, s32, 1024
    s_add_u32 s33, s33, 1024
    s_add_u32 s34, s34, 1024
    s_add_u32 s35, s35, 1024
    s_add_u32 s36, s36, 1024
    buffer_load_dwordx4 v[16:19], v8, s[8:11], s25 offen
    buffer_load_dwordx4 v[20:23], v9, s[8:11], s25 offen
    buffer_load_dwordx4 v[24:27], v10, s[8:11], s25 offen
    buffer_load_dwordx4 v[28:31], v11, s[8:11], s25 offen
    buffer_load_dwordx4 v[32:35], v7, s[8:11], s32 offen
    buffer_load_dwordx4 v[36:39], v7, s[8:11], s33 offen
    buffer_load_dwordx4 v[40:43], v7, s[8:11], s34 offen
    buffer_load_dwordx4 v[44:47], v7, s[8:11], s35 offen
    buffer_load_dwordx4 v[48:51], v7, s[8:11], s36 offen
    s_waitcnt vmcnt(9)
    v_mfma_f32_16x16x32_bf16 a[0:3], v[68:71], v[52:55], a[0:3]
    v_mfma_f32_16x16x32_bf16 a[20:23], v[68:71], v[56:59], a[20:23]
    v_mfma_f32_16x16x32_bf16 a[40:43], v[68:71], v[60:63], a[40:43]
    v_mfma_f32_16x16x32_bf16 a[60:63], v[68:71], v[64:67], a[60:63]
    v_mfma_f32_16x16x32_bf16 a[4:7], v[72:75], v[52:55], a[4:7]
    v_mfma_f32_16x16x32_bf16 a[24:27], v[72:75], v[56:59], a[24:27]
    v_mfma_f32_16x16x32_bf16 a[44:47], v[72:75], v[60:63], a[44:47]
    v_mfma_f32_16x16x32_bf16 a[64:67], v[72:75], v[64:67], a[64:67]
    v_mfma_f32_16x16x32_bf16 a[8:11], v[76:79], v[52:55], a[8:11]
    v_mfma_f32_16x16x32_bf16 a[28:31], v[76:79], v[56:59], a[28:31]
    v_mfma_f32_16x16x32_bf16 a[48:51], v[76:79], v[60:63], a[48:51]
    v_mfma_f32_16x16x32_bf16 a[68:71], v[76:79], v[64:67], a[68:71]
    v_mfma_f32_16x16x32_bf16 a[12:15], v[80:83], v[52:55], a[12:15]
    v_mfma_f32_16x16x32_bf16 a[32:35], v[80:83], v[56:59], a[32:35]
    v_mfma_f32_16x16x32_bf16 a[52:55], v[80:83], v[60:63], a[52:55]
    v_mfma_f32_16x16x32_bf16 a[72:75], v[80:83], v[64:67], a[72:75]
    v_mfma_f32_16x16x32_bf16 a[16:19], v[84:87], v[52:55], a[16:19]
    v_mfma_f32_16x16x32_bf16 a[36:39], v[84:87], v[56:59], a[36:39]
    v_mfma_f32_16x16x32_bf16 a[56:59], v[84:87], v[60:63], a[56:59]
    v_mfma_f32_16x16x32_bf16 a[76:79], v[84:87], v[64:67], a[76:79]
    s_branch wo_b1_kernel_loop0
wo_b1_kernel_loop0_last:
    s_waitcnt vmcnt(0)
    v_mfma_f32_16x16x32_bf16 a[0:3], v[68:71], v[52:55], a[0:3]
    v_mfma_f32_16x16x32_bf16 a[20:23], v[68:71], v[56:59], a[20:23]
    v_mfma_f32_16x16x32_bf16 a[40:43], v[68:71], v[60:63], a[40:43]
    v_mfma_f32_16x16x32_bf16 a[60:63], v[68:71], v[64:67], a[60:63]
    v_mfma_f32_16x16x32_bf16 a[4:7], v[72:75], v[52:55], a[4:7]
    v_mfma_f32_16x16x32_bf16 a[24:27], v[72:75], v[56:59], a[24:27]
    v_mfma_f32_16x16x32_bf16 a[44:47], v[72:75], v[60:63], a[44:47]
    v_mfma_f32_16x16x32_bf16 a[64:67], v[72:75], v[64:67], a[64:67]
    v_mfma_f32_16x16x32_bf16 a[8:11], v[76:79], v[52:55], a[8:11]
    v_mfma_f32_16x16x32_bf16 a[28:31], v[76:79], v[56:59], a[28:31]
    v_mfma_f32_16x16x32_bf16 a[48:51], v[76:79], v[60:63], a[48:51]
    v_mfma_f32_16x16x32_bf16 a[68:71], v[76:79], v[64:67], a[68:71]
    v_mfma_f32_16x16x32_bf16 a[12:15], v[80:83], v[52:55], a[12:15]
    v_mfma_f32_16x16x32_bf16 a[32:35], v[80:83], v[56:59], a[32:35]
    v_mfma_f32_16x16x32_bf16 a[52:55], v[80:83], v[60:63], a[52:55]
    v_mfma_f32_16x16x32_bf16 a[72:75], v[80:83], v[64:67], a[72:75]
    v_mfma_f32_16x16x32_bf16 a[16:19], v[84:87], v[52:55], a[16:19]
    v_mfma_f32_16x16x32_bf16 a[36:39], v[84:87], v[56:59], a[36:39]
    v_mfma_f32_16x16x32_bf16 a[56:59], v[84:87], v[60:63], a[56:59]
    v_mfma_f32_16x16x32_bf16 a[76:79], v[84:87], v[64:67], a[76:79]
    s_nop 7
    s_nop 7
    v_lshlrev_b32 v5, 4, v2
    s_cmp_eq_u32 s3, 0
    s_cbranch_scc1 wo_b1_kernel_red0
    s_sub_u32 s29, s3, 1
    s_mul_i32 s29, s29, 20480
    v_add_u32 v5, s29, v5
    v_accvgpr_read_b32 v88, a0
    v_accvgpr_read_b32 v89, a1
    v_accvgpr_read_b32 v90, a2
    v_accvgpr_read_b32 v91, a3
    ds_write_b128 v5, v[88:91] offset:0
    v_accvgpr_read_b32 v88, a4
    v_accvgpr_read_b32 v89, a5
    v_accvgpr_read_b32 v90, a6
    v_accvgpr_read_b32 v91, a7
    ds_write_b128 v5, v[88:91] offset:1024
    v_accvgpr_read_b32 v88, a8
    v_accvgpr_read_b32 v89, a9
    v_accvgpr_read_b32 v90, a10
    v_accvgpr_read_b32 v91, a11
    ds_write_b128 v5, v[88:91] offset:2048
    v_accvgpr_read_b32 v88, a12
    v_accvgpr_read_b32 v89, a13
    v_accvgpr_read_b32 v90, a14
    v_accvgpr_read_b32 v91, a15
    ds_write_b128 v5, v[88:91] offset:3072
    v_accvgpr_read_b32 v88, a16
    v_accvgpr_read_b32 v89, a17
    v_accvgpr_read_b32 v90, a18
    v_accvgpr_read_b32 v91, a19
    ds_write_b128 v5, v[88:91] offset:4096
    v_accvgpr_read_b32 v88, a20
    v_accvgpr_read_b32 v89, a21
    v_accvgpr_read_b32 v90, a22
    v_accvgpr_read_b32 v91, a23
    ds_write_b128 v5, v[88:91] offset:5120
    v_accvgpr_read_b32 v88, a24
    v_accvgpr_read_b32 v89, a25
    v_accvgpr_read_b32 v90, a26
    v_accvgpr_read_b32 v91, a27
    ds_write_b128 v5, v[88:91] offset:6144
    v_accvgpr_read_b32 v88, a28
    v_accvgpr_read_b32 v89, a29
    v_accvgpr_read_b32 v90, a30
    v_accvgpr_read_b32 v91, a31
    ds_write_b128 v5, v[88:91] offset:7168
    v_accvgpr_read_b32 v88, a32
    v_accvgpr_read_b32 v89, a33
    v_accvgpr_read_b32 v90, a34
    v_accvgpr_read_b32 v91, a35
    ds_write_b128 v5, v[88:91] offset:8192
    v_accvgpr_read_b32 v88, a36
    v_accvgpr_read_b32 v89, a37
    v_accvgpr_read_b32 v90, a38
    v_accvgpr_read_b32 v91, a39
    ds_write_b128 v5, v[88:91] offset:9216
    v_accvgpr_read_b32 v88, a40
    v_accvgpr_read_b32 v89, a41
    v_accvgpr_read_b32 v90, a42
    v_accvgpr_read_b32 v91, a43
    ds_write_b128 v5, v[88:91] offset:10240
    v_accvgpr_read_b32 v88, a44
    v_accvgpr_read_b32 v89, a45
    v_accvgpr_read_b32 v90, a46
    v_accvgpr_read_b32 v91, a47
    ds_write_b128 v5, v[88:91] offset:11264
    v_accvgpr_read_b32 v88, a48
    v_accvgpr_read_b32 v89, a49
    v_accvgpr_read_b32 v90, a50
    v_accvgpr_read_b32 v91, a51
    ds_write_b128 v5, v[88:91] offset:12288
    v_accvgpr_read_b32 v88, a52
    v_accvgpr_read_b32 v89, a53
    v_accvgpr_read_b32 v90, a54
    v_accvgpr_read_b32 v91, a55
    ds_write_b128 v5, v[88:91] offset:13312
    v_accvgpr_read_b32 v88, a56
    v_accvgpr_read_b32 v89, a57
    v_accvgpr_read_b32 v90, a58
    v_accvgpr_read_b32 v91, a59
    ds_write_b128 v5, v[88:91] offset:14336
    v_accvgpr_read_b32 v88, a60
    v_accvgpr_read_b32 v89, a61
    v_accvgpr_read_b32 v90, a62
    v_accvgpr_read_b32 v91, a63
    ds_write_b128 v5, v[88:91] offset:15360
    v_accvgpr_read_b32 v88, a64
    v_accvgpr_read_b32 v89, a65
    v_accvgpr_read_b32 v90, a66
    v_accvgpr_read_b32 v91, a67
    ds_write_b128 v5, v[88:91] offset:16384
    v_accvgpr_read_b32 v88, a68
    v_accvgpr_read_b32 v89, a69
    v_accvgpr_read_b32 v90, a70
    v_accvgpr_read_b32 v91, a71
    ds_write_b128 v5, v[88:91] offset:17408
    v_accvgpr_read_b32 v88, a72
    v_accvgpr_read_b32 v89, a73
    v_accvgpr_read_b32 v90, a74
    v_accvgpr_read_b32 v91, a75
    ds_write_b128 v5, v[88:91] offset:18432
    v_accvgpr_read_b32 v88, a76
    v_accvgpr_read_b32 v89, a77
    v_accvgpr_read_b32 v90, a78
    v_accvgpr_read_b32 v91, a79
    ds_write_b128 v5, v[88:91] offset:19456
    s_waitcnt lgkmcnt(0)
    s_barrier
    s_branch wo_b1_kernel_end
wo_b1_kernel_red0:
    s_barrier
    ds_read_b128 v[88:91], v5 offset:0
    ds_read_b128 v[92:95], v5 offset:20480
    ds_read_b128 v[96:99], v5 offset:40960
    s_waitcnt lgkmcnt(0)
    v_accvgpr_read_b32 v100, a0
    v_accvgpr_read_b32 v101, a1
    v_accvgpr_read_b32 v102, a2
    v_accvgpr_read_b32 v103, a3
    v_add_f32 v100, v100, v88
    v_add_f32 v92, v92, v96
    v_add_f32 v100, v100, v92
    v_accvgpr_write_b32 a0, v100
    v_add_f32 v101, v101, v89
    v_add_f32 v93, v93, v97
    v_add_f32 v101, v101, v93
    v_accvgpr_write_b32 a1, v101
    v_add_f32 v102, v102, v90
    v_add_f32 v94, v94, v98
    v_add_f32 v102, v102, v94
    v_accvgpr_write_b32 a2, v102
    v_add_f32 v103, v103, v91
    v_add_f32 v95, v95, v99
    v_add_f32 v103, v103, v95
    v_accvgpr_write_b32 a3, v103
    ds_read_b128 v[88:91], v5 offset:1024
    ds_read_b128 v[92:95], v5 offset:21504
    ds_read_b128 v[96:99], v5 offset:41984
    s_waitcnt lgkmcnt(0)
    v_accvgpr_read_b32 v100, a4
    v_accvgpr_read_b32 v101, a5
    v_accvgpr_read_b32 v102, a6
    v_accvgpr_read_b32 v103, a7
    v_add_f32 v100, v100, v88
    v_add_f32 v92, v92, v96
    v_add_f32 v100, v100, v92
    v_accvgpr_write_b32 a4, v100
    v_add_f32 v101, v101, v89
    v_add_f32 v93, v93, v97
    v_add_f32 v101, v101, v93
    v_accvgpr_write_b32 a5, v101
    v_add_f32 v102, v102, v90
    v_add_f32 v94, v94, v98
    v_add_f32 v102, v102, v94
    v_accvgpr_write_b32 a6, v102
    v_add_f32 v103, v103, v91
    v_add_f32 v95, v95, v99
    v_add_f32 v103, v103, v95
    v_accvgpr_write_b32 a7, v103
    ds_read_b128 v[88:91], v5 offset:2048
    ds_read_b128 v[92:95], v5 offset:22528
    ds_read_b128 v[96:99], v5 offset:43008
    s_waitcnt lgkmcnt(0)
    v_accvgpr_read_b32 v100, a8
    v_accvgpr_read_b32 v101, a9
    v_accvgpr_read_b32 v102, a10
    v_accvgpr_read_b32 v103, a11
    v_add_f32 v100, v100, v88
    v_add_f32 v92, v92, v96
    v_add_f32 v100, v100, v92
    v_accvgpr_write_b32 a8, v100
    v_add_f32 v101, v101, v89
    v_add_f32 v93, v93, v97
    v_add_f32 v101, v101, v93
    v_accvgpr_write_b32 a9, v101
    v_add_f32 v102, v102, v90
    v_add_f32 v94, v94, v98
    v_add_f32 v102, v102, v94
    v_accvgpr_write_b32 a10, v102
    v_add_f32 v103, v103, v91
    v_add_f32 v95, v95, v99
    v_add_f32 v103, v103, v95
    v_accvgpr_write_b32 a11, v103
    ds_read_b128 v[88:91], v5 offset:3072
    ds_read_b128 v[92:95], v5 offset:23552
    ds_read_b128 v[96:99], v5 offset:44032
    s_waitcnt lgkmcnt(0)
    v_accvgpr_read_b32 v100, a12
    v_accvgpr_read_b32 v101, a13
    v_accvgpr_read_b32 v102, a14
    v_accvgpr_read_b32 v103, a15
    v_add_f32 v100, v100, v88
    v_add_f32 v92, v92, v96
    v_add_f32 v100, v100, v92
    v_accvgpr_write_b32 a12, v100
    v_add_f32 v101, v101, v89
    v_add_f32 v93, v93, v97
    v_add_f32 v101, v101, v93
    v_accvgpr_write_b32 a13, v101
    v_add_f32 v102, v102, v90
    v_add_f32 v94, v94, v98
    v_add_f32 v102, v102, v94
    v_accvgpr_write_b32 a14, v102
    v_add_f32 v103, v103, v91
    v_add_f32 v95, v95, v99
    v_add_f32 v103, v103, v95
    v_accvgpr_write_b32 a15, v103
    ds_read_b128 v[88:91], v5 offset:4096
    ds_read_b128 v[92:95], v5 offset:24576
    ds_read_b128 v[96:99], v5 offset:45056
    s_waitcnt lgkmcnt(0)
    v_accvgpr_read_b32 v100, a16
    v_accvgpr_read_b32 v101, a17
    v_accvgpr_read_b32 v102, a18
    v_accvgpr_read_b32 v103, a19
    v_add_f32 v100, v100, v88
    v_add_f32 v92, v92, v96
    v_add_f32 v100, v100, v92
    v_accvgpr_write_b32 a16, v100
    v_add_f32 v101, v101, v89
    v_add_f32 v93, v93, v97
    v_add_f32 v101, v101, v93
    v_accvgpr_write_b32 a17, v101
    v_add_f32 v102, v102, v90
    v_add_f32 v94, v94, v98
    v_add_f32 v102, v102, v94
    v_accvgpr_write_b32 a18, v102
    v_add_f32 v103, v103, v91
    v_add_f32 v95, v95, v99
    v_add_f32 v103, v103, v95
    v_accvgpr_write_b32 a19, v103
    ds_read_b128 v[88:91], v5 offset:5120
    ds_read_b128 v[92:95], v5 offset:25600
    ds_read_b128 v[96:99], v5 offset:46080
    s_waitcnt lgkmcnt(0)
    v_accvgpr_read_b32 v100, a20
    v_accvgpr_read_b32 v101, a21
    v_accvgpr_read_b32 v102, a22
    v_accvgpr_read_b32 v103, a23
    v_add_f32 v100, v100, v88
    v_add_f32 v92, v92, v96
    v_add_f32 v100, v100, v92
    v_accvgpr_write_b32 a20, v100
    v_add_f32 v101, v101, v89
    v_add_f32 v93, v93, v97
    v_add_f32 v101, v101, v93
    v_accvgpr_write_b32 a21, v101
    v_add_f32 v102, v102, v90
    v_add_f32 v94, v94, v98
    v_add_f32 v102, v102, v94
    v_accvgpr_write_b32 a22, v102
    v_add_f32 v103, v103, v91
    v_add_f32 v95, v95, v99
    v_add_f32 v103, v103, v95
    v_accvgpr_write_b32 a23, v103
    ds_read_b128 v[88:91], v5 offset:6144
    ds_read_b128 v[92:95], v5 offset:26624
    ds_read_b128 v[96:99], v5 offset:47104
    s_waitcnt lgkmcnt(0)
    v_accvgpr_read_b32 v100, a24
    v_accvgpr_read_b32 v101, a25
    v_accvgpr_read_b32 v102, a26
    v_accvgpr_read_b32 v103, a27
    v_add_f32 v100, v100, v88
    v_add_f32 v92, v92, v96
    v_add_f32 v100, v100, v92
    v_accvgpr_write_b32 a24, v100
    v_add_f32 v101, v101, v89
    v_add_f32 v93, v93, v97
    v_add_f32 v101, v101, v93
    v_accvgpr_write_b32 a25, v101
    v_add_f32 v102, v102, v90
    v_add_f32 v94, v94, v98
    v_add_f32 v102, v102, v94
    v_accvgpr_write_b32 a26, v102
    v_add_f32 v103, v103, v91
    v_add_f32 v95, v95, v99
    v_add_f32 v103, v103, v95
    v_accvgpr_write_b32 a27, v103
    ds_read_b128 v[88:91], v5 offset:7168
    ds_read_b128 v[92:95], v5 offset:27648
    ds_read_b128 v[96:99], v5 offset:48128
    s_waitcnt lgkmcnt(0)
    v_accvgpr_read_b32 v100, a28
    v_accvgpr_read_b32 v101, a29
    v_accvgpr_read_b32 v102, a30
    v_accvgpr_read_b32 v103, a31
    v_add_f32 v100, v100, v88
    v_add_f32 v92, v92, v96
    v_add_f32 v100, v100, v92
    v_accvgpr_write_b32 a28, v100
    v_add_f32 v101, v101, v89
    v_add_f32 v93, v93, v97
    v_add_f32 v101, v101, v93
    v_accvgpr_write_b32 a29, v101
    v_add_f32 v102, v102, v90
    v_add_f32 v94, v94, v98
    v_add_f32 v102, v102, v94
    v_accvgpr_write_b32 a30, v102
    v_add_f32 v103, v103, v91
    v_add_f32 v95, v95, v99
    v_add_f32 v103, v103, v95
    v_accvgpr_write_b32 a31, v103
    ds_read_b128 v[88:91], v5 offset:8192
    ds_read_b128 v[92:95], v5 offset:28672
    ds_read_b128 v[96:99], v5 offset:49152
    s_waitcnt lgkmcnt(0)
    v_accvgpr_read_b32 v100, a32
    v_accvgpr_read_b32 v101, a33
    v_accvgpr_read_b32 v102, a34
    v_accvgpr_read_b32 v103, a35
    v_add_f32 v100, v100, v88
    v_add_f32 v92, v92, v96
    v_add_f32 v100, v100, v92
    v_accvgpr_write_b32 a32, v100
    v_add_f32 v101, v101, v89
    v_add_f32 v93, v93, v97
    v_add_f32 v101, v101, v93
    v_accvgpr_write_b32 a33, v101
    v_add_f32 v102, v102, v90
    v_add_f32 v94, v94, v98
    v_add_f32 v102, v102, v94
    v_accvgpr_write_b32 a34, v102
    v_add_f32 v103, v103, v91
    v_add_f32 v95, v95, v99
    v_add_f32 v103, v103, v95
    v_accvgpr_write_b32 a35, v103
    ds_read_b128 v[88:91], v5 offset:9216
    ds_read_b128 v[92:95], v5 offset:29696
    ds_read_b128 v[96:99], v5 offset:50176
    s_waitcnt lgkmcnt(0)
    v_accvgpr_read_b32 v100, a36
    v_accvgpr_read_b32 v101, a37
    v_accvgpr_read_b32 v102, a38
    v_accvgpr_read_b32 v103, a39
    v_add_f32 v100, v100, v88
    v_add_f32 v92, v92, v96
    v_add_f32 v100, v100, v92
    v_accvgpr_write_b32 a36, v100
    v_add_f32 v101, v101, v89
    v_add_f32 v93, v93, v97
    v_add_f32 v101, v101, v93
    v_accvgpr_write_b32 a37, v101
    v_add_f32 v102, v102, v90
    v_add_f32 v94, v94, v98
    v_add_f32 v102, v102, v94
    v_accvgpr_write_b32 a38, v102
    v_add_f32 v103, v103, v91
    v_add_f32 v95, v95, v99
    v_add_f32 v103, v103, v95
    v_accvgpr_write_b32 a39, v103
    ds_read_b128 v[88:91], v5 offset:10240
    ds_read_b128 v[92:95], v5 offset:30720
    ds_read_b128 v[96:99], v5 offset:51200
    s_waitcnt lgkmcnt(0)
    v_accvgpr_read_b32 v100, a40
    v_accvgpr_read_b32 v101, a41
    v_accvgpr_read_b32 v102, a42
    v_accvgpr_read_b32 v103, a43
    v_add_f32 v100, v100, v88
    v_add_f32 v92, v92, v96
    v_add_f32 v100, v100, v92
    v_accvgpr_write_b32 a40, v100
    v_add_f32 v101, v101, v89
    v_add_f32 v93, v93, v97
    v_add_f32 v101, v101, v93
    v_accvgpr_write_b32 a41, v101
    v_add_f32 v102, v102, v90
    v_add_f32 v94, v94, v98
    v_add_f32 v102, v102, v94
    v_accvgpr_write_b32 a42, v102
    v_add_f32 v103, v103, v91
    v_add_f32 v95, v95, v99
    v_add_f32 v103, v103, v95
    v_accvgpr_write_b32 a43, v103
    ds_read_b128 v[88:91], v5 offset:11264
    ds_read_b128 v[92:95], v5 offset:31744
    ds_read_b128 v[96:99], v5 offset:52224
    s_waitcnt lgkmcnt(0)
    v_accvgpr_read_b32 v100, a44
    v_accvgpr_read_b32 v101, a45
    v_accvgpr_read_b32 v102, a46
    v_accvgpr_read_b32 v103, a47
    v_add_f32 v100, v100, v88
    v_add_f32 v92, v92, v96
    v_add_f32 v100, v100, v92
    v_accvgpr_write_b32 a44, v100
    v_add_f32 v101, v101, v89
    v_add_f32 v93, v93, v97
    v_add_f32 v101, v101, v93
    v_accvgpr_write_b32 a45, v101
    v_add_f32 v102, v102, v90
    v_add_f32 v94, v94, v98
    v_add_f32 v102, v102, v94
    v_accvgpr_write_b32 a46, v102
    v_add_f32 v103, v103, v91
    v_add_f32 v95, v95, v99
    v_add_f32 v103, v103, v95
    v_accvgpr_write_b32 a47, v103
    ds_read_b128 v[88:91], v5 offset:12288
    ds_read_b128 v[92:95], v5 offset:32768
    ds_read_b128 v[96:99], v5 offset:53248
    s_waitcnt lgkmcnt(0)
    v_accvgpr_read_b32 v100, a48
    v_accvgpr_read_b32 v101, a49
    v_accvgpr_read_b32 v102, a50
    v_accvgpr_read_b32 v103, a51
    v_add_f32 v100, v100, v88
    v_add_f32 v92, v92, v96
    v_add_f32 v100, v100, v92
    v_accvgpr_write_b32 a48, v100
    v_add_f32 v101, v101, v89
    v_add_f32 v93, v93, v97
    v_add_f32 v101, v101, v93
    v_accvgpr_write_b32 a49, v101
    v_add_f32 v102, v102, v90
    v_add_f32 v94, v94, v98
    v_add_f32 v102, v102, v94
    v_accvgpr_write_b32 a50, v102
    v_add_f32 v103, v103, v91
    v_add_f32 v95, v95, v99
    v_add_f32 v103, v103, v95
    v_accvgpr_write_b32 a51, v103
    ds_read_b128 v[88:91], v5 offset:13312
    ds_read_b128 v[92:95], v5 offset:33792
    ds_read_b128 v[96:99], v5 offset:54272
    s_waitcnt lgkmcnt(0)
    v_accvgpr_read_b32 v100, a52
    v_accvgpr_read_b32 v101, a53
    v_accvgpr_read_b32 v102, a54
    v_accvgpr_read_b32 v103, a55
    v_add_f32 v100, v100, v88
    v_add_f32 v92, v92, v96
    v_add_f32 v100, v100, v92
    v_accvgpr_write_b32 a52, v100
    v_add_f32 v101, v101, v89
    v_add_f32 v93, v93, v97
    v_add_f32 v101, v101, v93
    v_accvgpr_write_b32 a53, v101
    v_add_f32 v102, v102, v90
    v_add_f32 v94, v94, v98
    v_add_f32 v102, v102, v94
    v_accvgpr_write_b32 a54, v102
    v_add_f32 v103, v103, v91
    v_add_f32 v95, v95, v99
    v_add_f32 v103, v103, v95
    v_accvgpr_write_b32 a55, v103
    ds_read_b128 v[88:91], v5 offset:14336
    ds_read_b128 v[92:95], v5 offset:34816
    ds_read_b128 v[96:99], v5 offset:55296
    s_waitcnt lgkmcnt(0)
    v_accvgpr_read_b32 v100, a56
    v_accvgpr_read_b32 v101, a57
    v_accvgpr_read_b32 v102, a58
    v_accvgpr_read_b32 v103, a59
    v_add_f32 v100, v100, v88
    v_add_f32 v92, v92, v96
    v_add_f32 v100, v100, v92
    v_accvgpr_write_b32 a56, v100
    v_add_f32 v101, v101, v89
    v_add_f32 v93, v93, v97
    v_add_f32 v101, v101, v93
    v_accvgpr_write_b32 a57, v101
    v_add_f32 v102, v102, v90
    v_add_f32 v94, v94, v98
    v_add_f32 v102, v102, v94
    v_accvgpr_write_b32 a58, v102
    v_add_f32 v103, v103, v91
    v_add_f32 v95, v95, v99
    v_add_f32 v103, v103, v95
    v_accvgpr_write_b32 a59, v103
    ds_read_b128 v[88:91], v5 offset:15360
    ds_read_b128 v[92:95], v5 offset:35840
    ds_read_b128 v[96:99], v5 offset:56320
    s_waitcnt lgkmcnt(0)
    v_accvgpr_read_b32 v100, a60
    v_accvgpr_read_b32 v101, a61
    v_accvgpr_read_b32 v102, a62
    v_accvgpr_read_b32 v103, a63
    v_add_f32 v100, v100, v88
    v_add_f32 v92, v92, v96
    v_add_f32 v100, v100, v92
    v_accvgpr_write_b32 a60, v100
    v_add_f32 v101, v101, v89
    v_add_f32 v93, v93, v97
    v_add_f32 v101, v101, v93
    v_accvgpr_write_b32 a61, v101
    v_add_f32 v102, v102, v90
    v_add_f32 v94, v94, v98
    v_add_f32 v102, v102, v94
    v_accvgpr_write_b32 a62, v102
    v_add_f32 v103, v103, v91
    v_add_f32 v95, v95, v99
    v_add_f32 v103, v103, v95
    v_accvgpr_write_b32 a63, v103
    ds_read_b128 v[88:91], v5 offset:16384
    ds_read_b128 v[92:95], v5 offset:36864
    ds_read_b128 v[96:99], v5 offset:57344
    s_waitcnt lgkmcnt(0)
    v_accvgpr_read_b32 v100, a64
    v_accvgpr_read_b32 v101, a65
    v_accvgpr_read_b32 v102, a66
    v_accvgpr_read_b32 v103, a67
    v_add_f32 v100, v100, v88
    v_add_f32 v92, v92, v96
    v_add_f32 v100, v100, v92
    v_accvgpr_write_b32 a64, v100
    v_add_f32 v101, v101, v89
    v_add_f32 v93, v93, v97
    v_add_f32 v101, v101, v93
    v_accvgpr_write_b32 a65, v101
    v_add_f32 v102, v102, v90
    v_add_f32 v94, v94, v98
    v_add_f32 v102, v102, v94
    v_accvgpr_write_b32 a66, v102
    v_add_f32 v103, v103, v91
    v_add_f32 v95, v95, v99
    v_add_f32 v103, v103, v95
    v_accvgpr_write_b32 a67, v103
    ds_read_b128 v[88:91], v5 offset:17408
    ds_read_b128 v[92:95], v5 offset:37888
    ds_read_b128 v[96:99], v5 offset:58368
    s_waitcnt lgkmcnt(0)
    v_accvgpr_read_b32 v100, a68
    v_accvgpr_read_b32 v101, a69
    v_accvgpr_read_b32 v102, a70
    v_accvgpr_read_b32 v103, a71
    v_add_f32 v100, v100, v88
    v_add_f32 v92, v92, v96
    v_add_f32 v100, v100, v92
    v_accvgpr_write_b32 a68, v100
    v_add_f32 v101, v101, v89
    v_add_f32 v93, v93, v97
    v_add_f32 v101, v101, v93
    v_accvgpr_write_b32 a69, v101
    v_add_f32 v102, v102, v90
    v_add_f32 v94, v94, v98
    v_add_f32 v102, v102, v94
    v_accvgpr_write_b32 a70, v102
    v_add_f32 v103, v103, v91
    v_add_f32 v95, v95, v99
    v_add_f32 v103, v103, v95
    v_accvgpr_write_b32 a71, v103
    ds_read_b128 v[88:91], v5 offset:18432
    ds_read_b128 v[92:95], v5 offset:38912
    ds_read_b128 v[96:99], v5 offset:59392
    s_waitcnt lgkmcnt(0)
    v_accvgpr_read_b32 v100, a72
    v_accvgpr_read_b32 v101, a73
    v_accvgpr_read_b32 v102, a74
    v_accvgpr_read_b32 v103, a75
    v_add_f32 v100, v100, v88
    v_add_f32 v92, v92, v96
    v_add_f32 v100, v100, v92
    v_accvgpr_write_b32 a72, v100
    v_add_f32 v101, v101, v89
    v_add_f32 v93, v93, v97
    v_add_f32 v101, v101, v93
    v_accvgpr_write_b32 a73, v101
    v_add_f32 v102, v102, v90
    v_add_f32 v94, v94, v98
    v_add_f32 v102, v102, v94
    v_accvgpr_write_b32 a74, v102
    v_add_f32 v103, v103, v91
    v_add_f32 v95, v95, v99
    v_add_f32 v103, v103, v95
    v_accvgpr_write_b32 a75, v103
    ds_read_b128 v[88:91], v5 offset:19456
    ds_read_b128 v[92:95], v5 offset:39936
    ds_read_b128 v[96:99], v5 offset:60416
    s_waitcnt lgkmcnt(0)
    v_accvgpr_read_b32 v100, a76
    v_accvgpr_read_b32 v101, a77
    v_accvgpr_read_b32 v102, a78
    v_accvgpr_read_b32 v103, a79
    v_add_f32 v100, v100, v88
    v_add_f32 v92, v92, v96
    v_add_f32 v100, v100, v92
    v_accvgpr_write_b32 a76, v100
    v_add_f32 v101, v101, v89
    v_add_f32 v93, v93, v97
    v_add_f32 v101, v101, v93
    v_accvgpr_write_b32 a77, v101
    v_add_f32 v102, v102, v90
    v_add_f32 v94, v94, v98
    v_add_f32 v102, v102, v94
    v_accvgpr_write_b32 a78, v102
    v_add_f32 v103, v103, v91
    v_add_f32 v95, v95, v99
    v_add_f32 v103, v103, v95
    v_accvgpr_write_b32 a79, v103
    s_nop 7
    s_nop 7
    s_mov_b32 s24, 1280
    v_add_u32 v5, s22, v3
    v_mul_lo_u32 v5, v5, s24
    v_lshlrev_b32 v6, 3, v4
    s_lshl_b32 s29, s23, 1
    v_add3_u32 v5, v5, v6, s29
    v_add_u32 v6, 4194304, v5
    buffer_load_dwordx2 v[88:89], v6, s[8:11], 0 offen
    v_accvgpr_read_b32 v92, a0
    v_accvgpr_read_b32 v93, a1
    v_accvgpr_read_b32 v94, a2
    v_accvgpr_read_b32 v95, a3
    v_cvt_pk_bf16_f32 v96, v92, v93
    v_cvt_pk_bf16_f32 v97, v94, v95
    s_waitcnt vmcnt(0)
    v_lshlrev_b32 v92, 16, v96
    v_and_b32 v93, 0xffff0000, v96
    v_lshlrev_b32 v98, 16, v88
    v_and_b32 v99, 0xffff0000, v88
    v_add_f32 v92, v92, v98
    v_add_f32 v93, v93, v99
    v_lshlrev_b32 v94, 16, v97
    v_and_b32 v95, 0xffff0000, v97
    v_lshlrev_b32 v98, 16, v89
    v_and_b32 v99, 0xffff0000, v89
    v_add_f32 v94, v94, v98
    v_add_f32 v95, v95, v99
    v_cvt_pk_bf16_f32 v96, v92, v93
    v_cvt_pk_bf16_f32 v97, v94, v95
    v_add_u32 v6, 4194304, v5
    buffer_store_dwordx2 v[96:97], v6, s[8:11], 0 offen
    v_add_u32 v6, 4194336, v5
    buffer_load_dwordx2 v[88:89], v6, s[8:11], 0 offen
    v_accvgpr_read_b32 v92, a4
    v_accvgpr_read_b32 v93, a5
    v_accvgpr_read_b32 v94, a6
    v_accvgpr_read_b32 v95, a7
    v_cvt_pk_bf16_f32 v96, v92, v93
    v_cvt_pk_bf16_f32 v97, v94, v95
    s_waitcnt vmcnt(0)
    v_lshlrev_b32 v92, 16, v96
    v_and_b32 v93, 0xffff0000, v96
    v_lshlrev_b32 v98, 16, v88
    v_and_b32 v99, 0xffff0000, v88
    v_add_f32 v92, v92, v98
    v_add_f32 v93, v93, v99
    v_lshlrev_b32 v94, 16, v97
    v_and_b32 v95, 0xffff0000, v97
    v_lshlrev_b32 v98, 16, v89
    v_and_b32 v99, 0xffff0000, v89
    v_add_f32 v94, v94, v98
    v_add_f32 v95, v95, v99
    v_cvt_pk_bf16_f32 v96, v92, v93
    v_cvt_pk_bf16_f32 v97, v94, v95
    v_add_u32 v6, 4194336, v5
    buffer_store_dwordx2 v[96:97], v6, s[8:11], 0 offen
    v_add_u32 v6, 4194368, v5
    buffer_load_dwordx2 v[88:89], v6, s[8:11], 0 offen
    v_accvgpr_read_b32 v92, a8
    v_accvgpr_read_b32 v93, a9
    v_accvgpr_read_b32 v94, a10
    v_accvgpr_read_b32 v95, a11
    v_cvt_pk_bf16_f32 v96, v92, v93
    v_cvt_pk_bf16_f32 v97, v94, v95
    s_waitcnt vmcnt(0)
    v_lshlrev_b32 v92, 16, v96
    v_and_b32 v93, 0xffff0000, v96
    v_lshlrev_b32 v98, 16, v88
    v_and_b32 v99, 0xffff0000, v88
    v_add_f32 v92, v92, v98
    v_add_f32 v93, v93, v99
    v_lshlrev_b32 v94, 16, v97
    v_and_b32 v95, 0xffff0000, v97
    v_lshlrev_b32 v98, 16, v89
    v_and_b32 v99, 0xffff0000, v89
    v_add_f32 v94, v94, v98
    v_add_f32 v95, v95, v99
    v_cvt_pk_bf16_f32 v96, v92, v93
    v_cvt_pk_bf16_f32 v97, v94, v95
    v_add_u32 v6, 4194368, v5
    buffer_store_dwordx2 v[96:97], v6, s[8:11], 0 offen
    v_add_u32 v6, 4194400, v5
    buffer_load_dwordx2 v[88:89], v6, s[8:11], 0 offen
    v_accvgpr_read_b32 v92, a12
    v_accvgpr_read_b32 v93, a13
    v_accvgpr_read_b32 v94, a14
    v_accvgpr_read_b32 v95, a15
    v_cvt_pk_bf16_f32 v96, v92, v93
    v_cvt_pk_bf16_f32 v97, v94, v95
    s_waitcnt vmcnt(0)
    v_lshlrev_b32 v92, 16, v96
    v_and_b32 v93, 0xffff0000, v96
    v_lshlrev_b32 v98, 16, v88
    v_and_b32 v99, 0xffff0000, v88
    v_add_f32 v92, v92, v98
    v_add_f32 v93, v93, v99
    v_lshlrev_b32 v94, 16, v97
    v_and_b32 v95, 0xffff0000, v97
    v_lshlrev_b32 v98, 16, v89
    v_and_b32 v99, 0xffff0000, v89
    v_add_f32 v94, v94, v98
    v_add_f32 v95, v95, v99
    v_cvt_pk_bf16_f32 v96, v92, v93
    v_cvt_pk_bf16_f32 v97, v94, v95
    v_add_u32 v6, 4194400, v5
    buffer_store_dwordx2 v[96:97], v6, s[8:11], 0 offen
    v_add_u32 v6, 4194432, v5
    buffer_load_dwordx2 v[88:89], v6, s[8:11], 0 offen
    v_accvgpr_read_b32 v92, a16
    v_accvgpr_read_b32 v93, a17
    v_accvgpr_read_b32 v94, a18
    v_accvgpr_read_b32 v95, a19
    v_cvt_pk_bf16_f32 v96, v92, v93
    v_cvt_pk_bf16_f32 v97, v94, v95
    s_waitcnt vmcnt(0)
    v_lshlrev_b32 v92, 16, v96
    v_and_b32 v93, 0xffff0000, v96
    v_lshlrev_b32 v98, 16, v88
    v_and_b32 v99, 0xffff0000, v88
    v_add_f32 v92, v92, v98
    v_add_f32 v93, v93, v99
    v_lshlrev_b32 v94, 16, v97
    v_and_b32 v95, 0xffff0000, v97
    v_lshlrev_b32 v98, 16, v89
    v_and_b32 v99, 0xffff0000, v89
    v_add_f32 v94, v94, v98
    v_add_f32 v95, v95, v99
    v_cvt_pk_bf16_f32 v96, v92, v93
    v_cvt_pk_bf16_f32 v97, v94, v95
    v_add_u32 v6, 4194432, v5
    buffer_store_dwordx2 v[96:97], v6, s[8:11], 0 offen
    v_add_u32 v6, 4214784, v5
    buffer_load_dwordx2 v[88:89], v6, s[8:11], 0 offen
    v_accvgpr_read_b32 v92, a20
    v_accvgpr_read_b32 v93, a21
    v_accvgpr_read_b32 v94, a22
    v_accvgpr_read_b32 v95, a23
    v_cvt_pk_bf16_f32 v96, v92, v93
    v_cvt_pk_bf16_f32 v97, v94, v95
    s_waitcnt vmcnt(0)
    v_lshlrev_b32 v92, 16, v96
    v_and_b32 v93, 0xffff0000, v96
    v_lshlrev_b32 v98, 16, v88
    v_and_b32 v99, 0xffff0000, v88
    v_add_f32 v92, v92, v98
    v_add_f32 v93, v93, v99
    v_lshlrev_b32 v94, 16, v97
    v_and_b32 v95, 0xffff0000, v97
    v_lshlrev_b32 v98, 16, v89
    v_and_b32 v99, 0xffff0000, v89
    v_add_f32 v94, v94, v98
    v_add_f32 v95, v95, v99
    v_cvt_pk_bf16_f32 v96, v92, v93
    v_cvt_pk_bf16_f32 v97, v94, v95
    v_add_u32 v6, 4214784, v5
    buffer_store_dwordx2 v[96:97], v6, s[8:11], 0 offen
    v_add_u32 v6, 4214816, v5
    buffer_load_dwordx2 v[88:89], v6, s[8:11], 0 offen
    v_accvgpr_read_b32 v92, a24
    v_accvgpr_read_b32 v93, a25
    v_accvgpr_read_b32 v94, a26
    v_accvgpr_read_b32 v95, a27
    v_cvt_pk_bf16_f32 v96, v92, v93
    v_cvt_pk_bf16_f32 v97, v94, v95
    s_waitcnt vmcnt(0)
    v_lshlrev_b32 v92, 16, v96
    v_and_b32 v93, 0xffff0000, v96
    v_lshlrev_b32 v98, 16, v88
    v_and_b32 v99, 0xffff0000, v88
    v_add_f32 v92, v92, v98
    v_add_f32 v93, v93, v99
    v_lshlrev_b32 v94, 16, v97
    v_and_b32 v95, 0xffff0000, v97
    v_lshlrev_b32 v98, 16, v89
    v_and_b32 v99, 0xffff0000, v89
    v_add_f32 v94, v94, v98
    v_add_f32 v95, v95, v99
    v_cvt_pk_bf16_f32 v96, v92, v93
    v_cvt_pk_bf16_f32 v97, v94, v95
    v_add_u32 v6, 4214816, v5
    buffer_store_dwordx2 v[96:97], v6, s[8:11], 0 offen
    v_add_u32 v6, 4214848, v5
    buffer_load_dwordx2 v[88:89], v6, s[8:11], 0 offen
    v_accvgpr_read_b32 v92, a28
    v_accvgpr_read_b32 v93, a29
    v_accvgpr_read_b32 v94, a30
    v_accvgpr_read_b32 v95, a31
    v_cvt_pk_bf16_f32 v96, v92, v93
    v_cvt_pk_bf16_f32 v97, v94, v95
    s_waitcnt vmcnt(0)
    v_lshlrev_b32 v92, 16, v96
    v_and_b32 v93, 0xffff0000, v96
    v_lshlrev_b32 v98, 16, v88
    v_and_b32 v99, 0xffff0000, v88
    v_add_f32 v92, v92, v98
    v_add_f32 v93, v93, v99
    v_lshlrev_b32 v94, 16, v97
    v_and_b32 v95, 0xffff0000, v97
    v_lshlrev_b32 v98, 16, v89
    v_and_b32 v99, 0xffff0000, v89
    v_add_f32 v94, v94, v98
    v_add_f32 v95, v95, v99
    v_cvt_pk_bf16_f32 v96, v92, v93
    v_cvt_pk_bf16_f32 v97, v94, v95
    v_add_u32 v6, 4214848, v5
    buffer_store_dwordx2 v[96:97], v6, s[8:11], 0 offen
    v_add_u32 v6, 4214880, v5
    buffer_load_dwordx2 v[88:89], v6, s[8:11], 0 offen
    v_accvgpr_read_b32 v92, a32
    v_accvgpr_read_b32 v93, a33
    v_accvgpr_read_b32 v94, a34
    v_accvgpr_read_b32 v95, a35
    v_cvt_pk_bf16_f32 v96, v92, v93
    v_cvt_pk_bf16_f32 v97, v94, v95
    s_waitcnt vmcnt(0)
    v_lshlrev_b32 v92, 16, v96
    v_and_b32 v93, 0xffff0000, v96
    v_lshlrev_b32 v98, 16, v88
    v_and_b32 v99, 0xffff0000, v88
    v_add_f32 v92, v92, v98
    v_add_f32 v93, v93, v99
    v_lshlrev_b32 v94, 16, v97
    v_and_b32 v95, 0xffff0000, v97
    v_lshlrev_b32 v98, 16, v89
    v_and_b32 v99, 0xffff0000, v89
    v_add_f32 v94, v94, v98
    v_add_f32 v95, v95, v99
    v_cvt_pk_bf16_f32 v96, v92, v93
    v_cvt_pk_bf16_f32 v97, v94, v95
    v_add_u32 v6, 4214880, v5
    buffer_store_dwordx2 v[96:97], v6, s[8:11], 0 offen
    v_add_u32 v6, 4214912, v5
    buffer_load_dwordx2 v[88:89], v6, s[8:11], 0 offen
    v_accvgpr_read_b32 v92, a36
    v_accvgpr_read_b32 v93, a37
    v_accvgpr_read_b32 v94, a38
    v_accvgpr_read_b32 v95, a39
    v_cvt_pk_bf16_f32 v96, v92, v93
    v_cvt_pk_bf16_f32 v97, v94, v95
    s_waitcnt vmcnt(0)
    v_lshlrev_b32 v92, 16, v96
    v_and_b32 v93, 0xffff0000, v96
    v_lshlrev_b32 v98, 16, v88
    v_and_b32 v99, 0xffff0000, v88
    v_add_f32 v92, v92, v98
    v_add_f32 v93, v93, v99
    v_lshlrev_b32 v94, 16, v97
    v_and_b32 v95, 0xffff0000, v97
    v_lshlrev_b32 v98, 16, v89
    v_and_b32 v99, 0xffff0000, v89
    v_add_f32 v94, v94, v98
    v_add_f32 v95, v95, v99
    v_cvt_pk_bf16_f32 v96, v92, v93
    v_cvt_pk_bf16_f32 v97, v94, v95
    v_add_u32 v6, 4214912, v5
    buffer_store_dwordx2 v[96:97], v6, s[8:11], 0 offen
    v_add_u32 v6, 4235264, v5
    buffer_load_dwordx2 v[88:89], v6, s[8:11], 0 offen
    v_accvgpr_read_b32 v92, a40
    v_accvgpr_read_b32 v93, a41
    v_accvgpr_read_b32 v94, a42
    v_accvgpr_read_b32 v95, a43
    v_cvt_pk_bf16_f32 v96, v92, v93
    v_cvt_pk_bf16_f32 v97, v94, v95
    s_waitcnt vmcnt(0)
    v_lshlrev_b32 v92, 16, v96
    v_and_b32 v93, 0xffff0000, v96
    v_lshlrev_b32 v98, 16, v88
    v_and_b32 v99, 0xffff0000, v88
    v_add_f32 v92, v92, v98
    v_add_f32 v93, v93, v99
    v_lshlrev_b32 v94, 16, v97
    v_and_b32 v95, 0xffff0000, v97
    v_lshlrev_b32 v98, 16, v89
    v_and_b32 v99, 0xffff0000, v89
    v_add_f32 v94, v94, v98
    v_add_f32 v95, v95, v99
    v_cvt_pk_bf16_f32 v96, v92, v93
    v_cvt_pk_bf16_f32 v97, v94, v95
    v_add_u32 v6, 4235264, v5
    buffer_store_dwordx2 v[96:97], v6, s[8:11], 0 offen
    v_add_u32 v6, 4235296, v5
    buffer_load_dwordx2 v[88:89], v6, s[8:11], 0 offen
    v_accvgpr_read_b32 v92, a44
    v_accvgpr_read_b32 v93, a45
    v_accvgpr_read_b32 v94, a46
    v_accvgpr_read_b32 v95, a47
    v_cvt_pk_bf16_f32 v96, v92, v93
    v_cvt_pk_bf16_f32 v97, v94, v95
    s_waitcnt vmcnt(0)
    v_lshlrev_b32 v92, 16, v96
    v_and_b32 v93, 0xffff0000, v96
    v_lshlrev_b32 v98, 16, v88
    v_and_b32 v99, 0xffff0000, v88
    v_add_f32 v92, v92, v98
    v_add_f32 v93, v93, v99
    v_lshlrev_b32 v94, 16, v97
    v_and_b32 v95, 0xffff0000, v97
    v_lshlrev_b32 v98, 16, v89
    v_and_b32 v99, 0xffff0000, v89
    v_add_f32 v94, v94, v98
    v_add_f32 v95, v95, v99
    v_cvt_pk_bf16_f32 v96, v92, v93
    v_cvt_pk_bf16_f32 v97, v94, v95
    v_add_u32 v6, 4235296, v5
    buffer_store_dwordx2 v[96:97], v6, s[8:11], 0 offen
    v_add_u32 v6, 4235328, v5
    buffer_load_dwordx2 v[88:89], v6, s[8:11], 0 offen
    v_accvgpr_read_b32 v92, a48
    v_accvgpr_read_b32 v93, a49
    v_accvgpr_read_b32 v94, a50
    v_accvgpr_read_b32 v95, a51
    v_cvt_pk_bf16_f32 v96, v92, v93
    v_cvt_pk_bf16_f32 v97, v94, v95
    s_waitcnt vmcnt(0)
    v_lshlrev_b32 v92, 16, v96
    v_and_b32 v93, 0xffff0000, v96
    v_lshlrev_b32 v98, 16, v88
    v_and_b32 v99, 0xffff0000, v88
    v_add_f32 v92, v92, v98
    v_add_f32 v93, v93, v99
    v_lshlrev_b32 v94, 16, v97
    v_and_b32 v95, 0xffff0000, v97
    v_lshlrev_b32 v98, 16, v89
    v_and_b32 v99, 0xffff0000, v89
    v_add_f32 v94, v94, v98
    v_add_f32 v95, v95, v99
    v_cvt_pk_bf16_f32 v96, v92, v93
    v_cvt_pk_bf16_f32 v97, v94, v95
    v_add_u32 v6, 4235328, v5
    buffer_store_dwordx2 v[96:97], v6, s[8:11], 0 offen
    v_add_u32 v6, 4235360, v5
    buffer_load_dwordx2 v[88:89], v6, s[8:11], 0 offen
    v_accvgpr_read_b32 v92, a52
    v_accvgpr_read_b32 v93, a53
    v_accvgpr_read_b32 v94, a54
    v_accvgpr_read_b32 v95, a55
    v_cvt_pk_bf16_f32 v96, v92, v93
    v_cvt_pk_bf16_f32 v97, v94, v95
    s_waitcnt vmcnt(0)
    v_lshlrev_b32 v92, 16, v96
    v_and_b32 v93, 0xffff0000, v96
    v_lshlrev_b32 v98, 16, v88
    v_and_b32 v99, 0xffff0000, v88
    v_add_f32 v92, v92, v98
    v_add_f32 v93, v93, v99
    v_lshlrev_b32 v94, 16, v97
    v_and_b32 v95, 0xffff0000, v97
    v_lshlrev_b32 v98, 16, v89
    v_and_b32 v99, 0xffff0000, v89
    v_add_f32 v94, v94, v98
    v_add_f32 v95, v95, v99
    v_cvt_pk_bf16_f32 v96, v92, v93
    v_cvt_pk_bf16_f32 v97, v94, v95
    v_add_u32 v6, 4235360, v5
    buffer_store_dwordx2 v[96:97], v6, s[8:11], 0 offen
    v_add_u32 v6, 4235392, v5
    buffer_load_dwordx2 v[88:89], v6, s[8:11], 0 offen
    v_accvgpr_read_b32 v92, a56
    v_accvgpr_read_b32 v93, a57
    v_accvgpr_read_b32 v94, a58
    v_accvgpr_read_b32 v95, a59
    v_cvt_pk_bf16_f32 v96, v92, v93
    v_cvt_pk_bf16_f32 v97, v94, v95
    s_waitcnt vmcnt(0)
    v_lshlrev_b32 v92, 16, v96
    v_and_b32 v93, 0xffff0000, v96
    v_lshlrev_b32 v98, 16, v88
    v_and_b32 v99, 0xffff0000, v88
    v_add_f32 v92, v92, v98
    v_add_f32 v93, v93, v99
    v_lshlrev_b32 v94, 16, v97
    v_and_b32 v95, 0xffff0000, v97
    v_lshlrev_b32 v98, 16, v89
    v_and_b32 v99, 0xffff0000, v89
    v_add_f32 v94, v94, v98
    v_add_f32 v95, v95, v99
    v_cvt_pk_bf16_f32 v96, v92, v93
    v_cvt_pk_bf16_f32 v97, v94, v95
    v_add_u32 v6, 4235392, v5
    buffer_store_dwordx2 v[96:97], v6, s[8:11], 0 offen
    v_add_u32 v6, 4255744, v5
    buffer_load_dwordx2 v[88:89], v6, s[8:11], 0 offen
    v_accvgpr_read_b32 v92, a60
    v_accvgpr_read_b32 v93, a61
    v_accvgpr_read_b32 v94, a62
    v_accvgpr_read_b32 v95, a63
    v_cvt_pk_bf16_f32 v96, v92, v93
    v_cvt_pk_bf16_f32 v97, v94, v95
    s_waitcnt vmcnt(0)
    v_lshlrev_b32 v92, 16, v96
    v_and_b32 v93, 0xffff0000, v96
    v_lshlrev_b32 v98, 16, v88
    v_and_b32 v99, 0xffff0000, v88
    v_add_f32 v92, v92, v98
    v_add_f32 v93, v93, v99
    v_lshlrev_b32 v94, 16, v97
    v_and_b32 v95, 0xffff0000, v97
    v_lshlrev_b32 v98, 16, v89
    v_and_b32 v99, 0xffff0000, v89
    v_add_f32 v94, v94, v98
    v_add_f32 v95, v95, v99
    v_cvt_pk_bf16_f32 v96, v92, v93
    v_cvt_pk_bf16_f32 v97, v94, v95
    v_add_u32 v6, 4255744, v5
    buffer_store_dwordx2 v[96:97], v6, s[8:11], 0 offen
    v_add_u32 v6, 4255776, v5
    buffer_load_dwordx2 v[88:89], v6, s[8:11], 0 offen
    v_accvgpr_read_b32 v92, a64
    v_accvgpr_read_b32 v93, a65
    v_accvgpr_read_b32 v94, a66
    v_accvgpr_read_b32 v95, a67
    v_cvt_pk_bf16_f32 v96, v92, v93
    v_cvt_pk_bf16_f32 v97, v94, v95
    s_waitcnt vmcnt(0)
    v_lshlrev_b32 v92, 16, v96
    v_and_b32 v93, 0xffff0000, v96
    v_lshlrev_b32 v98, 16, v88
    v_and_b32 v99, 0xffff0000, v88
    v_add_f32 v92, v92, v98
    v_add_f32 v93, v93, v99
    v_lshlrev_b32 v94, 16, v97
    v_and_b32 v95, 0xffff0000, v97
    v_lshlrev_b32 v98, 16, v89
    v_and_b32 v99, 0xffff0000, v89
    v_add_f32 v94, v94, v98
    v_add_f32 v95, v95, v99
    v_cvt_pk_bf16_f32 v96, v92, v93
    v_cvt_pk_bf16_f32 v97, v94, v95
    v_add_u32 v6, 4255776, v5
    buffer_store_dwordx2 v[96:97], v6, s[8:11], 0 offen
    v_add_u32 v6, 4255808, v5
    buffer_load_dwordx2 v[88:89], v6, s[8:11], 0 offen
    v_accvgpr_read_b32 v92, a68
    v_accvgpr_read_b32 v93, a69
    v_accvgpr_read_b32 v94, a70
    v_accvgpr_read_b32 v95, a71
    v_cvt_pk_bf16_f32 v96, v92, v93
    v_cvt_pk_bf16_f32 v97, v94, v95
    s_waitcnt vmcnt(0)
    v_lshlrev_b32 v92, 16, v96
    v_and_b32 v93, 0xffff0000, v96
    v_lshlrev_b32 v98, 16, v88
    v_and_b32 v99, 0xffff0000, v88
    v_add_f32 v92, v92, v98
    v_add_f32 v93, v93, v99
    v_lshlrev_b32 v94, 16, v97
    v_and_b32 v95, 0xffff0000, v97
    v_lshlrev_b32 v98, 16, v89
    v_and_b32 v99, 0xffff0000, v89
    v_add_f32 v94, v94, v98
    v_add_f32 v95, v95, v99
    v_cvt_pk_bf16_f32 v96, v92, v93
    v_cvt_pk_bf16_f32 v97, v94, v95
    v_add_u32 v6, 4255808, v5
    buffer_store_dwordx2 v[96:97], v6, s[8:11], 0 offen
    v_add_u32 v6, 4255840, v5
    buffer_load_dwordx2 v[88:89], v6, s[8:11], 0 offen
    v_accvgpr_read_b32 v92, a72
    v_accvgpr_read_b32 v93, a73
    v_accvgpr_read_b32 v94, a74
    v_accvgpr_read_b32 v95, a75
    v_cvt_pk_bf16_f32 v96, v92, v93
    v_cvt_pk_bf16_f32 v97, v94, v95
    s_waitcnt vmcnt(0)
    v_lshlrev_b32 v92, 16, v96
    v_and_b32 v93, 0xffff0000, v96
    v_lshlrev_b32 v98, 16, v88
    v_and_b32 v99, 0xffff0000, v88
    v_add_f32 v92, v92, v98
    v_add_f32 v93, v93, v99
    v_lshlrev_b32 v94, 16, v97
    v_and_b32 v95, 0xffff0000, v97
    v_lshlrev_b32 v98, 16, v89
    v_and_b32 v99, 0xffff0000, v89
    v_add_f32 v94, v94, v98
    v_add_f32 v95, v95, v99
    v_cvt_pk_bf16_f32 v96, v92, v93
    v_cvt_pk_bf16_f32 v97, v94, v95
    v_add_u32 v6, 4255840, v5
    buffer_store_dwordx2 v[96:97], v6, s[8:11], 0 offen
    v_add_u32 v6, 4255872, v5
    buffer_load_dwordx2 v[88:89], v6, s[8:11], 0 offen
    v_accvgpr_read_b32 v92, a76
    v_accvgpr_read_b32 v93, a77
    v_accvgpr_read_b32 v94, a78
    v_accvgpr_read_b32 v95, a79
    v_cvt_pk_bf16_f32 v96, v92, v93
    v_cvt_pk_bf16_f32 v97, v94, v95
    s_waitcnt vmcnt(0)
    v_lshlrev_b32 v92, 16, v96
    v_and_b32 v93, 0xffff0000, v96
    v_lshlrev_b32 v98, 16, v88
    v_and_b32 v99, 0xffff0000, v88
    v_add_f32 v92, v92, v98
    v_add_f32 v93, v93, v99
    v_lshlrev_b32 v94, 16, v97
    v_and_b32 v95, 0xffff0000, v97
    v_lshlrev_b32 v98, 16, v89
    v_and_b32 v99, 0xffff0000, v89
    v_add_f32 v94, v94, v98
    v_add_f32 v95, v95, v99
    v_cvt_pk_bf16_f32 v96, v92, v93
    v_cvt_pk_bf16_f32 v97, v94, v95
    v_add_u32 v6, 4255872, v5
    buffer_store_dwordx2 v[96:97], v6, s[8:11], 0 offen
wo_b1_kernel_end:
    s_endpgm
.section .rodata,"a"
.p2align 6
.amdhsa_kernel wo_b1_kernel
  .amdhsa_next_free_vgpr 192
  .amdhsa_next_free_sgpr 64
  .amdhsa_accum_offset 112
  .amdhsa_group_segment_fixed_size 0
  .amdhsa_kernarg_size 104
  .amdhsa_user_sgpr_count 2
  .amdhsa_user_sgpr_kernarg_segment_ptr 1
  .amdhsa_system_sgpr_workgroup_id_x 1
.end_amdhsa_kernel
.text
.globl ln_a2_kernel
.p2align 8
.type ln_a2_kernel,@function
ln_a2_kernel:
    v_lshrrev_b32 v1, 6, v0
    v_and_b32 v2, 63, v0
    s_nop 0
    v_readfirstlane_b32 s3, v1
    s_lshl_b32 s4, s2, 2
    s_add_u32 s4, s4, s3
    s_cmp_ge_u32 s4, 2048
    s_cbranch_scc1 ln_a2_kernel_end
    s_load_dwordx2 s[6:7], s[0:1], 96
    s_load_dwordx2 s[12:13], s[0:1], 96
    s_waitcnt lgkmcnt(0)
    s_add_u32 s8, s6, 4194304
    s_addc_u32 s9, s7, 0
    s_mov_b32 s10, 2621440
    s_mov_b32 s11, 0x00020000
    s_mov_b32 s16, s12
    s_mov_b32 s17, s13
    s_mov_b32 s18, 2621440
    s_mov_b32 s19, 0x00020000
    s_mul_i32 s5, s4, 1280
    v_lshlrev_b32 v3, 2, v2
    v_add_u32 v3, s5, v3
    buffer_load_dword v4, v3, s[8:11], 0 offen offset:0
    buffer_load_dword v5, v3, s[8:11], 0 offen offset:256
    buffer_load_dword v6, v3, s[8:11], 0 offen offset:512
    buffer_load_dword v7, v3, s[8:11], 0 offen offset:768
    buffer_load_dword v8, v3, s[8:11], 0 offen offset:1024
    s_waitcnt vmcnt(0)
    v_lshlrev_b32 v10, 16, v4
    v_and_b32 v11, 0xffff0000, v4
    v_lshlrev_b32 v12, 16, v5
    v_and_b32 v13, 0xffff0000, v5
    v_lshlrev_b32 v14, 16, v6
    v_and_b32 v15, 0xffff0000, v6
    v_lshlrev_b32 v16, 16, v7
    v_and_b32 v17, 0xffff0000, v7
    v_lshlrev_b32 v18, 16, v8
    v_and_b32 v19, 0xffff0000, v8
    v_add_f32 v20, v10, v11
    v_add_f32 v20, v20, v12
    v_add_f32 v20, v20, v13
    v_add_f32 v20, v20, v14
    v_add_f32 v20, v20, v15
    v_add_f32 v20, v20, v16
    v_add_f32 v20, v20, v17
    v_add_f32 v20, v20, v18
    v_add_f32 v20, v20, v19
    s_nop 1
    v_add_f32 v21, v20, v20 quad_perm:[1,0,3,2] row_mask:0xf bank_mask:0xf
    s_nop 1
    v_add_f32 v21, v21, v21 quad_perm:[2,3,0,1] row_mask:0xf bank_mask:0xf
    s_nop 1
    v_add_f32 v21, v21, v21 row_half_mirror row_mask:0xf bank_mask:0xf
    s_nop 1
    v_add_f32 v21, v21, v21 row_mirror row_mask:0xf bank_mask:0xf
    s_nop 1
    v_readlane_b32 s24, v21, 0
    v_readlane_b32 s25, v21, 16
    v_readlane_b32 s26, v21, 32
    v_readlane_b32 s27, v21, 48
    s_nop 1
    v_mov_b32 v20, s24
    v_add_f32 v20, s25, v20
    v_add_f32 v20, s26, v20
    v_add_f32 v20, s27, v20
    v_mul_f32 v20, 0.0015625, v20
    v_sub_f32 v10, v10, v20
    v_sub_f32 v11, v11, v20
    v_sub_f32 v12, v12, v20
    v_sub_f32 v13, v13, v20
    v_sub_f32 v14, v14, v20
    v_sub_f32 v15, v15, v20
    v_sub_f32 v16, v16, v20
    v_sub_f32 v17, v17, v20
    v_sub_f32 v18, v18, v20
    v_sub_f32 v19, v19, v20
    v_mul_f32 v21, v10, v10
    v_fmac_f32 v21, v11, v11
    v_fmac_f32 v21, v12, v12
    v_fmac_f32 v21, v13, v13
    v_fmac_f32 v21, v14, v14
    v_fmac_f32 v21, v15, v15
    v_fmac_f32 v21, v16, v16
    v_fmac_f32 v21, v17, v17
    v_fmac_f32 v21, v18, v18
    v_fmac_f32 v21, v19, v19
    s_nop 1
    v_add_f32 v22, v21, v21 quad_perm:[1,0,3,2] row_mask:0xf bank_mask:0xf
    s_nop 1
    v_add_f32 v22, v22, v22 quad_perm:[2,3,0,1] row_mask:0xf bank_mask:0xf
    s_nop 1
    v_add_f32 v22, v22, v22 row_half_mirror row_mask:0xf bank_mask:0xf
    s_nop 1
    v_add_f32 v22, v22, v22 row_mirror row_mask:0xf bank_mask:0xf
    s_nop 1
    v_readlane_b32 s24, v22, 0
    v_readlane_b32 s25, v22, 16
    v_readlane_b32 s26, v22, 32
    v_readlane_b32 s27, v22, 48
    s_nop 1
    v_mov_b32 v21, s24
    v_add_f32 v21, s25, v21
    v_add_f32 v21, s26, v21
    v_add_f32 v21, s27, v21
    v_mov_b32 v22, 0x3727c5ac
    v_fmac_f32 v22, 0.0015625, v21
    v_rsq_f32 v22, v22
    s_nop 0
    v_mul_f32 v10, v10, v22
    v_mul_f32 v11, v11, v22
    v_mul_f32 v12, v12, v22
    v_mul_f32 v13, v13, v22
    v_mul_f32 v14, v14, v22
    v_mul_f32 v15, v15, v22
    v_mul_f32 v16, v16, v22
    v_mul_f32 v17, v17, v22
    v_mul_f32 v18, v18, v22
    v_mul_f32 v19, v19, v22
    v_cvt_pk_bf16_f32 v4, v10, v11
    v_cvt_pk_bf16_f32 v5, v12, v13
    v_cvt_pk_bf16_f32 v6, v14, v15
    v_cvt_pk_bf16_f32 v7, v16, v17
    v_cvt_pk_bf16_f32 v8, v18, v19
    buffer_store_dword v4, v3, s[16:19], 0 offen offset:0
    buffer_store_dword v5, v3, s[16:19], 0 offen offset:256
    buffer_store_dword v6, v3, s[16:19], 0 offen offset:512
    buffer_store_dword v7, v3, s[16:19], 0 offen offset:768
    buffer_store_dword v8, v3, s[16:19], 0 offen offset:1024
ln_a2_kernel_end:
    s_endpgm
.section .rodata,"a"
.p2align 6
.amdhsa_kernel ln_a2_kernel
  .amdhsa_next_free_vgpr 32
  .amdhsa_next_free_sgpr 40
  .amdhsa_accum_offset 32
  .amdhsa_group_segment_fixed_size 0
  .amdhsa_kernarg_size 104
  .amdhsa_user_sgpr_count 2
  .amdhsa_user_sgpr_kernarg_segment_ptr 1
  .amdhsa_system_sgpr_workgroup_id_x 1
.end_amdhsa_kernel
.text
.globl kvz_a2_kernel
.p2align 8
.type kvz_a2_kernel,@function
kvz_a2_kernel:
    v_lshrrev_b32 v1, 6, v0
    v_and_b32 v2, 63, v0
    s_nop 0
    v_readfirstlane_b32 s3, v1
    s_lshl_b32 s4, s2, 2
    s_add_u32 s4, s4, s3
    s_cmp_ge_u32 s4, 512
    s_cbranch_scc1 kvz_a2_kernel_end
    s_load_dwordx2 s[6:7], s[0:1], 96
    s_waitcnt lgkmcnt(0)
    s_mov_b32 s8, s6
    s_mov_b32 s9, s7
    s_mov_b32 s10, 268435456
    s_mov_b32 s11, 0x00020000
    s_lshr_b32 s5, s4, 4
    s_and_b32 s12, s4, 15
    s_mul_i32 s13, s5, 20
    v_and_b32 v3, 15, v2
    v_lshrrev_b32 v4, 4, v2
    s_lshl_b32 s14, s12, 7
    v_lshlrev_b32 v5, 3, v4
    v_add_u32 v5, s14, v5
    v_add_u32 v6, 0, v3
    v_min_u32 v8, 19, v6
    v_add_u32 v8, s13, v8
    v_lshlrev_b32 v8, 11, v8
    v_add_u32 v8, v8, v5
    v_lshlrev_b32 v8, 1, v8
    v_add_u32 v8, 12582912, v8
    v_add_u32 v10, 2621440, v8
    v_add_u32 v7, 16, v3
    v_min_u32 v9, 19, v7
    v_add_u32 v9, s13, v9
    v_lshlrev_b32 v9, 11, v9
    v_add_u32 v9, v9, v5
    v_lshlrev_b32 v9, 1, v9
    v_add_u32 v9, 12582912, v9
    v_add_u32 v11, 2621440, v9
    v_accvgpr_write_b32 a0, 0
    v_accvgpr_write_b32 a1, 0
    v_accvgpr_write_b32 a2, 0
    v_accvgpr_write_b32 a3, 0
    v_accvgpr_write_b32 a4, 0
    v_accvgpr_write_b32 a5, 0
    v_accvgpr_write_b32 a6, 0
    v_accvgpr_write_b32 a7, 0
    v_accvgpr_write_b32 a8, 0
    v_accvgpr_write_b32 a9, 0
    v_accvgpr_write_b32 a10, 0
    v_accvgpr_write_b32 a11, 0
    v_accvgpr_write_b32 a12, 0
    v_accvgpr_write_b32 a13, 0
    v_accvgpr_write_b32 a14, 0
    v_accvgpr_write_b32 a15, 0
    v_cmp_gt_u32 s[16:17], 20, v7
    v_cmp_eq_u32 s[18:19], 20, v7
    buffer_load_dwordx4 v[16:19], v8, s[8:11], 0 offen offset:0
    buffer_load_dwordx4 v[24:27], v10, s[8:11], 0 offen offset:0
    buffer_load_dwordx4 v[20:23], v9, s[8:11], 0 offen offset:0
    buffer_load_dwordx4 v[28:31], v11, s[8:11], 0 offen offset:0
    s_waitcnt vmcnt(0)
    v_lshlrev_b32 v32, 16, v16
    v_and_b32 v33, 0xffff0000, v16
    v_mul_f32 v36, 1.4426950408889634, v32
    v_exp_f32 v36, v36
    v_add_f32 v34, 1.0, v32
    v_cmp_lt_f32 vcc, 0, v32
    s_nop 1
    v_cndmask_b32 v34, v36, v34, vcc
    v_add_f32 v34, 0x358637bd, v34
    v_mul_f32 v36, 1.4426950408889634, v33
    v_exp_f32 v36, v36
    v_add_f32 v35, 1.0, v33
    v_cmp_lt_f32 vcc, 0, v33
    s_nop 1
    v_cndmask_b32 v35, v36, v35, vcc
    v_add_f32 v35, 0x358637bd, v35
    v_cvt_pk_bf16_f32 v16, v34, v35
    v_lshlrev_b32 v32, 16, v17
    v_and_b32 v33, 0xffff0000, v17
    v_mul_f32 v36, 1.4426950408889634, v32
    v_exp_f32 v36, v36
    v_add_f32 v34, 1.0, v32
    v_cmp_lt_f32 vcc, 0, v32
    s_nop 1
    v_cndmask_b32 v34, v36, v34, vcc
    v_add_f32 v34, 0x358637bd, v34
    v_mul_f32 v36, 1.4426950408889634, v33
    v_exp_f32 v36, v36
    v_add_f32 v35, 1.0, v33
    v_cmp_lt_f32 vcc, 0, v33
    s_nop 1
    v_cndmask_b32 v35, v36, v35, vcc
    v_add_f32 v35, 0x358637bd, v35
    v_cvt_pk_bf16_f32 v17, v34, v35
    v_lshlrev_b32 v32, 16, v18
    v_and_b32 v33, 0xffff0000, v18
    v_mul_f32 v36, 1.4426950408889634, v32
    v_exp_f32 v36, v36
    v_add_f32 v34, 1.0, v32
    v_cmp_lt_f32 vcc, 0, v32
    s_nop 1
    v_cndmask_b32 v34, v36, v34, vcc
    v_add_f32 v34, 0x358637bd, v34
    v_mul_f32 v36, 1.4426950408889634, v33
    v_exp_f32 v36, v36
    v_add_f32 v35, 1.0, v33
    v_cmp_lt_f32 vcc, 0, v33
    s_nop 1
    v_cndmask_b32 v35, v36, v35, vcc
    v_add_f32 v35, 0x358637bd, v35
    v_cvt_pk_bf16_f32 v18, v34, v35
    v_lshlrev_b32 v32, 16, v19
    v_and_b32 v33, 0xffff0000, v19
    v_mul_f32 v36, 1.4426950408889634, v32
    v_exp_f32 v36, v36
    v_add_f32 v34, 1.0, v32
    v_cmp_lt_f32 vcc, 0, v32
    s_nop 1
    v_cndmask_b32 v34, v36, v34, vcc
    v_add_f32 v34, 0x358637bd, v34
    v_mul_f32 v36, 1.4426950408889634, v33
    v_exp_f32 v36, v36
    v_add_f32 v35, 1.0, v33
    v_cmp_lt_f32 vcc, 0, v33
    s_nop 1
    v_cndmask_b32 v35, v36, v35, vcc
    v_add_f32 v35, 0x358637bd, v35
    v_cvt_pk_bf16_f32 v19, v34, v35
    v_lshlrev_b32 v32, 16, v20
    v_and_b32 v33, 0xffff0000, v20
    v_mul_f32 v36, 1.4426950408889634, v32
    v_exp_f32 v36, v36
    v_add_f32 v34, 1.0, v32
    v_cmp_lt_f32 vcc, 0, v32
    s_nop 1
    v_cndmask_b32 v34, v36, v34, vcc
    v_add_f32 v34, 0x358637bd, v34
    v_mul_f32 v36, 1.4426950408889634, v33
    v_exp_f32 v36, v36
    v_add_f32 v35, 1.0, v33
    v_cmp_lt_f32 vcc, 0, v33
    s_nop 1
    v_cndmask_b32 v35, v36, v35, vcc
    v_add_f32 v35, 0x358637bd, v35
    v_cvt_pk_bf16_f32 v20, v34, v35
    v_lshlrev_b32 v32, 16, v21
    v_and_b32 v33, 0xffff0000, v21
    v_mul_f32 v36, 1.4426950408889634, v32
    v_exp_f32 v36, v36
    v_add_f32 v34, 1.0, v32
    v_cmp_lt_f32 vcc, 0, v32
    s_nop 1
    v_cndmask_b32 v34, v36, v34, vcc
    v_add_f32 v34, 0x358637bd, v34
    v_mul_f32 v36, 1.4426950408889634, v33
    v_exp_f32 v36, v36
    v_add_f32 v35, 1.0, v33
    v_cmp_lt_f32 vcc, 0, v33
    s_nop 1
    v_cndmask_b32 v35, v36, v35, vcc
    v_add_f32 v35, 0x358637bd, v35
    v_cvt_pk_bf16_f32 v21, v34, v35
    v_lshlrev_b32 v32, 16, v22
    v_and_b32 v33, 0xffff0000, v22
    v_mul_f32 v36, 1.4426950408889634, v32
    v_exp_f32 v36, v36
    v_add_f32 v34, 1.0, v32
    v_cmp_lt_f32 vcc, 0, v32
    s_nop 1
    v_cndmask_b32 v34, v36, v34, vcc
    v_add_f32 v34, 0x358637bd, v34
    v_mul_f32 v36, 1.4426950408889634, v33
    v_exp_f32 v36, v36
    v_add_f32 v35, 1.0, v33
    v_cmp_lt_f32 vcc, 0, v33
    s_nop 1
    v_cndmask_b32 v35, v36, v35, vcc
    v_add_f32 v35, 0x358637bd, v35
    v_cvt_pk_bf16_f32 v22, v34, v35
    v_lshlrev_b32 v32, 16, v23
    v_and_b32 v33, 0xffff0000, v23
    v_mul_f32 v36, 1.4426950408889634, v32
    v_exp_f32 v36, v36
    v_add_f32 v34, 1.0, v32
    v_cmp_lt_f32 vcc, 0, v32
    s_nop 1
    v_cndmask_b32 v34, v36, v34, vcc
    v_add_f32 v34, 0x358637bd, v34
    v_mul_f32 v36, 1.4426950408889634, v33
    v_exp_f32 v36, v36
    v_add_f32 v35, 1.0, v33
    v_cmp_lt_f32 vcc, 0, v33
    s_nop 1
    v_cndmask_b32 v35, v36, v35, vcc
    v_add_f32 v35, 0x358637bd, v35
    v_cvt_pk_bf16_f32 v23, v34, v35
    v_mov_b32 v37, 0x3f803f80
    v_cndmask_b32 v20, 0, v20, s[16:17]
    v_cndmask_b32 v28, 0, v28, s[16:17]
    v_cndmask_b32 v28, v28, v37, s[18:19]
    v_cndmask_b32 v21, 0, v21, s[16:17]
    v_cndmask_b32 v29, 0, v29, s[16:17]
    v_cndmask_b32 v29, v29, v37, s[18:19]
    v_cndmask_b32 v22, 0, v22, s[16:17]
    v_cndmask_b32 v30, 0, v30, s[16:17]
    v_cndmask_b32 v30, v30, v37, s[18:19]
    v_cndmask_b32 v23, 0, v23, s[16:17]
    v_cndmask_b32 v31, 0, v31, s[16:17]
    v_cndmask_b32 v31, v31, v37, s[18:19]
    s_nop 1
    v_mfma_f32_16x16x32_bf16 a[0:3], v[24:27], v[16:19], a[0:3]
    v_mfma_f32_16x16x32_bf16 a[4:7], v[24:27], v[20:23], a[4:7]
    v_mfma_f32_16x16x32_bf16 a[8:11], v[28:31], v[16:19], a[8:11]
    v_mfma_f32_16x16x32_bf16 a[12:15], v[28:31], v[20:23], a[12:15]
    buffer_load_dwordx4 v[16:19], v8, s[8:11], 0 offen offset:64
    buffer_load_dwordx4 v[24:27], v10, s[8:11], 0 offen offset:64
    buffer_load_dwordx4 v[20:23], v9, s[8:11], 0 offen offset:64
    buffer_load_dwordx4 v[28:31], v11, s[8:11], 0 offen offset:64
    s_waitcnt vmcnt(0)
    v_lshlrev_b32 v32, 16, v16
    v_and_b32 v33, 0xffff0000, v16
    v_mul_f32 v36, 1.4426950408889634, v32
    v_exp_f32 v36, v36
    v_add_f32 v34, 1.0, v32
    v_cmp_lt_f32 vcc, 0, v32
    s_nop 1
    v_cndmask_b32 v34, v36, v34, vcc
    v_add_f32 v34, 0x358637bd, v34
    v_mul_f32 v36, 1.4426950408889634, v33
    v_exp_f32 v36, v36
    v_add_f32 v35, 1.0, v33
    v_cmp_lt_f32 vcc, 0, v33
    s_nop 1
    v_cndmask_b32 v35, v36, v35, vcc
    v_add_f32 v35, 0x358637bd, v35
    v_cvt_pk_bf16_f32 v16, v34, v35
    v_lshlrev_b32 v32, 16, v17
    v_and_b32 v33, 0xffff0000, v17
    v_mul_f32 v36, 1.4426950408889634, v32
    v_exp_f32 v36, v36
    v_add_f32 v34, 1.0, v32
    v_cmp_lt_f32 vcc, 0, v32
    s_nop 1
    v_cndmask_b32 v34, v36, v34, vcc
    v_add_f32 v34, 0x358637bd, v34
    v_mul_f32 v36, 1.4426950408889634, v33
    v_exp_f32 v36, v36
    v_add_f32 v35, 1.0, v33
    v_cmp_lt_f32 vcc, 0, v33
    s_nop 1
    v_cndmask_b32 v35, v36, v35, vcc
    v_add_f32 v35, 0x358637bd, v35
    v_cvt_pk_bf16_f32 v17, v34, v35
    v_lshlrev_b32 v32, 16, v18
    v_and_b32 v33, 0xffff0000, v18
    v_mul_f32 v36, 1.4426950408889634, v32
    v_exp_f32 v36, v36
    v_add_f32 v34, 1.0, v32
    v_cmp_lt_f32 vcc, 0, v32
    s_nop 1
    v_cndmask_b32 v34, v36, v34, vcc
    v_add_f32 v34, 0x358637bd, v34
    v_mul_f32 v36, 1.4426950408889634, v33
    v_exp_f32 v36, v36
    v_add_f32 v35, 1.0, v33
    v_cmp_lt_f32 vcc, 0, v33
    s_nop 1
    v_cndmask_b32 v35, v36, v35, vcc
    v_add_f32 v35, 0x358637bd, v35
    v_cvt_pk_bf16_f32 v18, v34, v35
    v_lshlrev_b32 v32, 16, v19
    v_and_b32 v33, 0xffff0000, v19
    v_mul_f32 v36, 1.4426950408889634, v32
    v_exp_f32 v36, v36
    v_add_f32 v34, 1.0, v32
    v_cmp_lt_f32 vcc, 0, v32
    s_nop 1
    v_cndmask_b32 v34, v36, v34, vcc
    v_add_f32 v34, 0x358637bd, v34
    v_mul_f32 v36, 1.4426950408889634, v33
    v_exp_f32 v36, v36
    v_add_f32 v35, 1.0, v33
    v_cmp_lt_f32 vcc, 0, v33
    s_nop 1
    v_cndmask_b32 v35, v36, v35, vcc
    v_add_f32 v35, 0x358637bd, v35
    v_cvt_pk_bf16_f32 v19, v34, v35
    v_lshlrev_b32 v32, 16, v20
    v_and_b32 v33, 0xffff0000, v20
    v_mul_f32 v36, 1.4426950408889634, v32
    v_exp_f32 v36, v36
    v_add_f32 v34, 1.0, v32
    v_cmp_lt_f32 vcc, 0, v32
    s_nop 1
    v_cndmask_b32 v34, v36, v34, vcc
    v_add_f32 v34, 0x358637bd, v34
    v_mul_f32 v36, 1.4426950408889634, v33
    v_exp_f32 v36, v36
    v_add_f32 v35, 1.0, v33
    v_cmp_lt_f32 vcc, 0, v33
    s_nop 1
    v_cndmask_b32 v35, v36, v35, vcc
    v_add_f32 v35, 0x358637bd, v35
    v_cvt_pk_bf16_f32 v20, v34, v35
    v_lshlrev_b32 v32, 16, v21
    v_and_b32 v33, 0xffff0000, v21
    v_mul_f32 v36, 1.4426950408889634, v32
    v_exp_f32 v36, v36
    v_add_f32 v34, 1.0, v32
    v_cmp_lt_f32 vcc, 0, v32
    s_nop 1
    v_cndmask_b32 v34, v36, v34, vcc
    v_add_f32 v34, 0x358637bd, v34
    v_mul_f32 v36, 1.4426950408889634, v33
    v_exp_f32 v36, v36
    v_add_f32 v35, 1.0, v33
    v_cmp_lt_f32 vcc, 0, v33
    s_nop 1
    v_cndmask_b32 v35, v36, v35, vcc
    v_add_f32 v35, 0x358637bd, v35
    v_cvt_pk_bf16_f32 v21, v34, v35
    v_lshlrev_b32 v32, 16, v22
    v_and_b32 v33, 0xffff0000, v22
    v_mul_f32 v36, 1.4426950408889634, v32
    v_exp_f32 v36, v36
    v_add_f32 v34, 1.0, v32
    v_cmp_lt_f32 vcc, 0, v32
    s_nop 1
    v_cndmask_b32 v34, v36, v34, vcc
    v_add_f32 v34, 0x358637bd, v34
    v_mul_f32 v36, 1.4426950408889634, v33
    v_exp_f32 v36, v36
    v_add_f32 v35, 1.0, v33
    v_cmp_lt_f32 vcc, 0, v33
    s_nop 1
    v_cndmask_b32 v35, v36, v35, vcc
    v_add_f32 v35, 0x358637bd, v35
    v_cvt_pk_bf16_f32 v22, v34, v35
    v_lshlrev_b32 v32, 16, v23
    v_and_b32 v33, 0xffff0000, v23
    v_mul_f32 v36, 1.4426950408889634, v32
    v_exp_f32 v36, v36
    v_add_f32 v34, 1.0, v32
    v_cmp_lt_f32 vcc, 0, v32
    s_nop 1
    v_cndmask_b32 v34, v36, v34, vcc
    v_add_f32 v34, 0x358637bd, v34
    v_mul_f32 v36, 1.4426950408889634, v33
    v_exp_f32 v36, v36
    v_add_f32 v35, 1.0, v33
    v_cmp_lt_f32 vcc, 0, v33
    s_nop 1
    v_cndmask_b32 v35, v36, v35, vcc
    v_add_f32 v35, 0x358637bd, v35
    v_cvt_pk_bf16_f32 v23, v34, v35
    v_mov_b32 v37, 0x3f803f80
    v_cndmask_b32 v20, 0, v20, s[16:17]
    v_cndmask_b32 v28, 0, v28, s[16:17]
    v_cndmask_b32 v28, v28, v37, s[18:19]
    v_cndmask_b32 v21, 0, v21, s[16:17]
    v_cndmask_b32 v29, 0, v29, s[16:17]
    v_cndmask_b32 v29, v29, v37, s[18:19]
    v_cndmask_b32 v22, 0, v22, s[16:17]
    v_cndmask_b32 v30, 0, v30, s[16:17]
    v_cndmask_b32 v30, v30, v37, s[18:19]
    v_cndmask_b32 v23, 0, v23, s[16:17]
    v_cndmask_b32 v31, 0, v31, s[16:17]
    v_cndmask_b32 v31, v31, v37, s[18:19]
    s_nop 1
    v_mfma_f32_16x16x32_bf16 a[0:3], v[24:27], v[16:19], a[0:3]
    v_mfma_f32_16x16x32_bf16 a[4:7], v[24:27], v[20:23], a[4:7]
    v_mfma_f32_16x16x32_bf16 a[8:11], v[28:31], v[16:19], a[8:11]
    v_mfma_f32_16x16x32_bf16 a[12:15], v[28:31], v[20:23], a[12:15]
    buffer_load_dwordx4 v[16:19], v8, s[8:11], 0 offen offset:128
    buffer_load_dwordx4 v[24:27], v10, s[8:11], 0 offen offset:128
    buffer_load_dwordx4 v[20:23], v9, s[8:11], 0 offen offset:128
    buffer_load_dwordx4 v[28:31], v11, s[8:11], 0 offen offset:128
    s_waitcnt vmcnt(0)
    v_lshlrev_b32 v32, 16, v16
    v_and_b32 v33, 0xffff0000, v16
    v_mul_f32 v36, 1.4426950408889634, v32
    v_exp_f32 v36, v36
    v_add_f32 v34, 1.0, v32
    v_cmp_lt_f32 vcc, 0, v32
    s_nop 1
    v_cndmask_b32 v34, v36, v34, vcc
    v_add_f32 v34, 0x358637bd, v34
    v_mul_f32 v36, 1.4426950408889634, v33
    v_exp_f32 v36, v36
    v_add_f32 v35, 1.0, v33
    v_cmp_lt_f32 vcc, 0, v33
    s_nop 1
    v_cndmask_b32 v35, v36, v35, vcc
    v_add_f32 v35, 0x358637bd, v35
    v_cvt_pk_bf16_f32 v16, v34, v35
    v_lshlrev_b32 v32, 16, v17
    v_and_b32 v33, 0xffff0000, v17
    v_mul_f32 v36, 1.4426950408889634, v32
    v_exp_f32 v36, v36
    v_add_f32 v34, 1.0, v32
    v_cmp_lt_f32 vcc, 0, v32
    s_nop 1
    v_cndmask_b32 v34, v36, v34, vcc
    v_add_f32 v34, 0x358637bd, v34
    v_mul_f32 v36, 1.4426950408889634, v33
    v_exp_f32 v36, v36
    v_add_f32 v35, 1.0, v33
    v_cmp_lt_f32 vcc, 0, v33
    s_nop 1
    v_cndmask_b32 v35, v36, v35, vcc
    v_add_f32 v35, 0x358637bd, v35
    v_cvt_pk_bf16_f32 v17, v34, v35
    v_lshlrev_b32 v32, 16, v18
    v_and_b32 v33, 0xffff0000, v18
    v_mul_f32 v36, 1.4426950408889634, v32
    v_exp_f32 v36, v36
    v_add_f32 v34, 1.0, v32
    v_cmp_lt_f32 vcc, 0, v32
    s_nop 1
    v_cndmask_b32 v34, v36, v34, vcc
    v_add_f32 v34, 0x358637bd, v34
    v_mul_f32 v36, 1.4426950408889634, v33
    v_exp_f32 v36, v36
    v_add_f32 v35, 1.0, v33
    v_cmp_lt_f32 vcc, 0, v33
    s_nop 1
    v_cndmask_b32 v35, v36, v35, vcc
    v_add_f32 v35, 0x358637bd, v35
    v_cvt_pk_bf16_f32 v18, v34, v35
    v_lshlrev_b32 v32, 16, v19
    v_and_b32 v33, 0xffff0000, v19
    v_mul_f32 v36, 1.4426950408889634, v32
    v_exp_f32 v36, v36
    v_add_f32 v34, 1.0, v32
    v_cmp_lt_f32 vcc, 0, v32
    s_nop 1
    v_cndmask_b32 v34, v36, v34, vcc
    v_add_f32 v34, 0x358637bd, v34
    v_mul_f32 v36, 1.4426950408889634, v33
    v_exp_f32 v36, v36
    v_add_f32 v35, 1.0, v33
    v_cmp_lt_f32 vcc, 0, v33
    s_nop 1
    v_cndmask_b32 v35, v36, v35, vcc
    v_add_f32 v35, 0x358637bd, v35
    v_cvt_pk_bf16_f32 v19, v34, v35
    v_lshlrev_b32 v32, 16, v20
    v_and_b32 v33, 0xffff0000, v20
    v_mul_f32 v36, 1.4426950408889634, v32
    v_exp_f32 v36, v36
    v_add_f32 v34, 1.0, v32
    v_cmp_lt_f32 vcc, 0, v32
    s_nop 1
    v_cndmask_b32 v34, v36, v34, vcc
    v_add_f32 v34, 0x358637bd, v34
    v_mul_f32 v36, 1.4426950408889634, v33
    v_exp_f32 v36, v36
    v_add_f32 v35, 1.0, v33
    v_cmp_lt_f32 vcc, 0, v33
    s_nop 1
    v_cndmask_b32 v35, v36, v35, vcc
    v_add_f32 v35, 0x358637bd, v35
    v_cvt_pk_bf16_f32 v20, v34, v35
    v_lshlrev_b32 v32, 16, v21
    v_and_b32 v33, 0xffff0000, v21
    v_mul_f32 v36, 1.4426950408889634, v32
    v_exp_f32 v36, v36
    v_add_f32 v34, 1.0, v32
    v_cmp_lt_f32 vcc, 0, v32
    s_nop 1
    v_cndmask_b32 v34, v36, v34, vcc
    v_add_f32 v34, 0x358637bd, v34
    v_mul_f32 v36, 1.4426950408889634, v33
    v_exp_f32 v36, v36
    v_add_f32 v35, 1.0, v33
    v_cmp_lt_f32 vcc, 0, v33
    s_nop 1
    v_cndmask_b32 v35, v36, v35, vcc
    v_add_f32 v35, 0x358637bd, v35
    v_cvt_pk_bf16_f32 v21, v34, v35
    v_lshlrev_b32 v32, 16, v22
    v_and_b32 v33, 0xffff0000, v22
    v_mul_f32 v36, 1.4426950408889634, v32
    v_exp_f32 v36, v36
    v_add_f32 v34, 1.0, v32
    v_cmp_lt_f32 vcc, 0, v32
    s_nop 1
    v_cndmask_b32 v34, v36, v34, vcc
    v_add_f32 v34, 0x358637bd, v34
    v_mul_f32 v36, 1.4426950408889634, v33
    v_exp_f32 v36, v36
    v_add_f32 v35, 1.0, v33
    v_cmp_lt_f32 vcc, 0, v33
    s_nop 1
    v_cndmask_b32 v35, v36, v35, vcc
    v_add_f32 v35, 0x358637bd, v35
    v_cvt_pk_bf16_f32 v22, v34, v35
    v_lshlrev_b32 v32, 16, v23
    v_and_b32 v33, 0xffff0000, v23
    v_mul_f32 v36, 1.4426950408889634, v32
    v_exp_f32 v36, v36
    v_add_f32 v34, 1.0, v32
    v_cmp_lt_f32 vcc, 0, v32
    s_nop 1
    v_cndmask_b32 v34, v36, v34, vcc
    v_add_f32 v34, 0x358637bd, v34
    v_mul_f32 v36, 1.4426950408889634, v33
    v_exp_f32 v36, v36
    v_add_f32 v35, 1.0, v33
    v_cmp_lt_f32 vcc, 0, v33
    s_nop 1
    v_cndmask_b32 v35, v36, v35, vcc
    v_add_f32 v35, 0x358637bd, v35
    v_cvt_pk_bf16_f32 v23, v34, v35
    v_mov_b32 v37, 0x3f803f80
    v_cndmask_b32 v20, 0, v20, s[16:17]
    v_cndmask_b32 v28, 0, v28, s[16:17]
    v_cndmask_b32 v28, v28, v37, s[18:19]
    v_cndmask_b32 v21, 0, v21, s[16:17]
    v_cndmask_b32 v29, 0, v29, s[16:17]
    v_cndmask_b32 v29, v29, v37, s[18:19]
    v_cndmask_b32 v22, 0, v22, s[16:17]
    v_cndmask_b32 v30, 0, v30, s[16:17]
    v_cndmask_b32 v30, v30, v37, s[18:19]
    v_cndmask_b32 v23, 0, v23, s[16:17]
    v_cndmask_b32 v31, 0, v31, s[16:17]
    v_cndmask_b32 v31, v31, v37, s[18:19]
    s_nop 1
    v_mfma_f32_16x16x32_bf16 a[0:3], v[24:27], v[16:19], a[0:3]
    v_mfma_f32_16x16x32_bf16 a[4:7], v[24:27], v[20:23], a[4:7]
    v_mfma_f32_16x16x32_bf16 a[8:11], v[28:31], v[16:19], a[8:11]
    v_mfma_f32_16x16x32_bf16 a[12:15], v[28:31], v[20:23], a[12:15]
    buffer_load_dwordx4 v[16:19], v8, s[8:11], 0 offen offset:192
    buffer_load_dwordx4 v[24:27], v10, s[8:11], 0 offen offset:192
    buffer_load_dwordx4 v[20:23], v9, s[8:11], 0 offen offset:192
    buffer_load_dwordx4 v[28:31], v11, s[8:11], 0 offen offset:192
    s_waitcnt vmcnt(0)
    v_lshlrev_b32 v32, 16, v16
    v_and_b32 v33, 0xffff0000, v16
    v_mul_f32 v36, 1.4426950408889634, v32
    v_exp_f32 v36, v36
    v_add_f32 v34, 1.0, v32
    v_cmp_lt_f32 vcc, 0, v32
    s_nop 1
    v_cndmask_b32 v34, v36, v34, vcc
    v_add_f32 v34, 0x358637bd, v34
    v_mul_f32 v36, 1.4426950408889634, v33
    v_exp_f32 v36, v36
    v_add_f32 v35, 1.0, v33
    v_cmp_lt_f32 vcc, 0, v33
    s_nop 1
    v_cndmask_b32 v35, v36, v35, vcc
    v_add_f32 v35, 0x358637bd, v35
    v_cvt_pk_bf16_f32 v16, v34, v35
    v_lshlrev_b32 v32, 16, v17
    v_and_b32 v33, 0xffff0000, v17
    v_mul_f32 v36, 1.4426950408889634, v32
    v_exp_f32 v36, v36
    v_add_f32 v34, 1.0, v32
    v_cmp_lt_f32 vcc, 0, v32
    s_nop 1
    v_cndmask_b32 v34, v36, v34, vcc
    v_add_f32 v34, 0x358637bd, v34
    v_mul_f32 v36, 1.4426950408889634, v33
    v_exp_f32 v36, v36
    v_add_f32 v35, 1.0, v33
    v_cmp_lt_f32 vcc, 0, v33
    s_nop 1
    v_cndmask_b32 v35, v36, v35, vcc
    v_add_f32 v35, 0x358637bd, v35
    v_cvt_pk_bf16_f32 v17, v34, v35
    v_lshlrev_b32 v32, 16, v18
    v_and_b32 v33, 0xffff0000, v18
    v_mul_f32 v36, 1.4426950408889634, v32
    v_exp_f32 v36, v36
    v_add_f32 v34, 1.0, v32
    v_cmp_lt_f32 vcc, 0, v32
    s_nop 1
    v_cndmask_b32 v34, v36, v34, vcc
    v_add_f32 v34, 0x358637bd, v34
    v_mul_f32 v36, 1.4426950408889634, v33
    v_exp_f32 v36, v36
    v_add_f32 v35, 1.0, v33
    v_cmp_lt_f32 vcc, 0, v33
    s_nop 1
    v_cndmask_b32 v35, v36, v35, vcc
    v_add_f32 v35, 0x358637bd, v35
    v_cvt_pk_bf16_f32 v18, v34, v35
    v_lshlrev_b32 v32, 16, v19
    v_and_b32 v33, 0xffff0000, v19
    v_mul_f32 v36, 1.4426950408889634, v32
    v_exp_f32 v36, v36
    v_add_f32 v34, 1.0, v32
    v_cmp_lt_f32 vcc, 0, v32
    s_nop 1
    v_cndmask_b32 v34, v36, v34, vcc
    v_add_f32 v34, 0x358637bd, v34
    v_mul_f32 v36, 1.4426950408889634, v33
    v_exp_f32 v36, v36
    v_add_f32 v35, 1.0, v33
    v_cmp_lt_f32 vcc, 0, v33
    s_nop 1
    v_cndmask_b32 v35, v36, v35, vcc
    v_add_f32 v35, 0x358637bd, v35
    v_cvt_pk_bf16_f32 v19, v34, v35
    v_lshlrev_b32 v32, 16, v20
    v_and_b32 v33, 0xffff0000, v20
    v_mul_f32 v36, 1.4426950408889634, v32
    v_exp_f32 v36, v36
    v_add_f32 v34, 1.0, v32
    v_cmp_lt_f32 vcc, 0, v32
    s_nop 1
    v_cndmask_b32 v34, v36, v34, vcc
    v_add_f32 v34, 0x358637bd, v34
    v_mul_f32 v36, 1.4426950408889634, v33
    v_exp_f32 v36, v36
    v_add_f32 v35, 1.0, v33
    v_cmp_lt_f32 vcc, 0, v33
    s_nop 1
    v_cndmask_b32 v35, v36, v35, vcc
    v_add_f32 v35, 0x358637bd, v35
    v_cvt_pk_bf16_f32 v20, v34, v35
    v_lshlrev_b32 v32, 16, v21
    v_and_b32 v33, 0xffff0000, v21
    v_mul_f32 v36, 1.4426950408889634, v32
    v_exp_f32 v36, v36
    v_add_f32 v34, 1.0, v32
    v_cmp_lt_f32 vcc, 0, v32
    s_nop 1
    v_cndmask_b32 v34, v36, v34, vcc
    v_add_f32 v34, 0x358637bd, v34
    v_mul_f32 v36, 1.4426950408889634, v33
    v_exp_f32 v36, v36
    v_add_f32 v35, 1.0, v33
    v_cmp_lt_f32 vcc, 0, v33
    s_nop 1
    v_cndmask_b32 v35, v36, v35, vcc
    v_add_f32 v35, 0x358637bd, v35
    v_cvt_pk_bf16_f32 v21, v34, v35
    v_lshlrev_b32 v32, 16, v22
    v_and_b32 v33, 0xffff0000, v22
    v_mul_f32 v36, 1.4426950408889634, v32
    v_exp_f32 v36, v36
    v_add_f32 v34, 1.0, v32
    v_cmp_lt_f32 vcc, 0, v32
    s_nop 1
    v_cndmask_b32 v34, v36, v34, vcc
    v_add_f32 v34, 0x358637bd, v34
    v_mul_f32 v36, 1.4426950408889634, v33
    v_exp_f32 v36, v36
    v_add_f32 v35, 1.0, v33
    v_cmp_lt_f32 vcc, 0, v33
    s_nop 1
    v_cndmask_b32 v35, v36, v35, vcc
    v_add_f32 v35, 0x358637bd, v35
    v_cvt_pk_bf16_f32 v22, v34, v35
    v_lshlrev_b32 v32, 16, v23
    v_and_b32 v33, 0xffff0000, v23
    v_mul_f32 v36, 1.4426950408889634, v32
    v_exp_f32 v36, v36
    v_add_f32 v34, 1.0, v32
    v_cmp_lt_f32 vcc, 0, v32
    s_nop 1
    v_cndmask_b32 v34, v36, v34, vcc
    v_add_f32 v34, 0x358637bd, v34
    v_mul_f32 v36, 1.4426950408889634, v33
    v_exp_f32 v36, v36
    v_add_f32 v35, 1.0, v33
    v_cmp_lt_f32 vcc, 0, v33
    s_nop 1
    v_cndmask_b32 v35, v36, v35, vcc
    v_add_f32 v35, 0x358637bd, v35
    v_cvt_pk_bf16_f32 v23, v34, v35
    v_mov_b32 v37, 0x3f803f80
    v_cndmask_b32 v20, 0, v20, s[16:17]
    v_cndmask_b32 v28, 0, v28, s[16:17]
    v_cndmask_b32 v28, v28, v37, s[18:19]
    v_cndmask_b32 v21, 0, v21, s[16:17]
    v_cndmask_b32 v29, 0, v29, s[16:17]
    v_cndmask_b32 v29, v29, v37, s[18:19]
    v_cndmask_b32 v22, 0, v22, s[16:17]
    v_cndmask_b32 v30, 0, v30, s[16:17]
    v_cndmask_b32 v30, v30, v37, s[18:19]
    v_cndmask_b32 v23, 0, v23, s[16:17]
    v_cndmask_b32 v31, 0, v31, s[16:17]
    v_cndmask_b32 v31, v31, v37, s[18:19]
    s_nop 1
    v_mfma_f32_16x16x32_bf16 a[0:3], v[24:27], v[16:19], a[0:3]
    v_mfma_f32_16x16x32_bf16 a[4:7], v[24:27], v[20:23], a[4:7]
    v_mfma_f32_16x16x32_bf16 a[8:11], v[28:31], v[16:19], a[8:11]
    v_mfma_f32_16x16x32_bf16 a[12:15], v[28:31], v[20:23], a[12:15]
    s_nop 7
    s_nop 7
    v_lshlrev_b32 v5, 2, v4
    v_lshlrev_b32 v5, 5, v5
    v_add_u32 v5, v5, v3
    v_lshlrev_b32 v5, 2, v5
    s_lshl_b32 s14, s5, 12
    s_add_u32 s14, s14, 23199744
    v_add_u32 v5, s14, v5
    v_accvgpr_read_b32 v40, a0
    v_accvgpr_read_b32 v41, a1
    v_accvgpr_read_b32 v42, a2
    v_accvgpr_read_b32 v43, a3
    buffer_atomic_add_f32 v40, v5, s[8:11], 0 offen offset:0
    buffer_atomic_add_f32 v41, v5, s[8:11], 0 offen offset:128
    buffer_atomic_add_f32 v42, v5, s[8:11], 0 offen offset:256
    buffer_atomic_add_f32 v43, v5, s[8:11], 0 offen offset:384
    v_accvgpr_read_b32 v40, a4
    v_accvgpr_read_b32 v41, a5
    v_accvgpr_read_b32 v42, a6
    v_accvgpr_read_b32 v43, a7
    buffer_atomic_add_f32 v40, v5, s[8:11], 0 offen offset:64
    buffer_atomic_add_f32 v41, v5, s[8:11], 0 offen offset:192
    buffer_atomic_add_f32 v42, v5, s[8:11], 0 offen offset:320
    buffer_atomic_add_f32 v43, v5, s[8:11], 0 offen offset:448
    v_accvgpr_read_b32 v40, a8
    v_accvgpr_read_b32 v41, a9
    v_accvgpr_read_b32 v42, a10
    v_accvgpr_read_b32 v43, a11
    buffer_atomic_add_f32 v40, v5, s[8:11], 0 offen offset:2048
    buffer_atomic_add_f32 v41, v5, s[8:11], 0 offen offset:2176
    buffer_atomic_add_f32 v42, v5, s[8:11], 0 offen offset:2304
    buffer_atomic_add_f32 v43, v5, s[8:11], 0 offen offset:2432
    v_accvgpr_read_b32 v40, a12
    v_accvgpr_read_b32 v41, a13
    v_accvgpr_read_b32 v42, a14
    v_accvgpr_read_b32 v43, a15
    buffer_atomic_add_f32 v40, v5, s[8:11], 0 offen offset:2112
    buffer_atomic_add_f32 v41, v5, s[8:11], 0 offen offset:2240
    buffer_atomic_add_f32 v42, v5, s[8:11], 0 offen offset:2368
    buffer_atomic_add_f32 v43, v5, s[8:11], 0 offen offset:2496
kvz_a2_kernel_end:
    s_endpgm
.section .rodata,"a"
.p2align 6
.amdhsa_kernel kvz_a2_kernel
  .amdhsa_next_free_vgpr 80
  .amdhsa_next_free_sgpr 40
  .amdhsa_accum_offset 64
  .amdhsa_group_segment_fixed_size 0
  .amdhsa_kernarg_size 104
  .amdhsa_user_sgpr_count 2
  .amdhsa_user_sgpr_kernarg_segment_ptr 1
  .amdhsa_system_sgpr_workgroup_id_x 1
.end_amdhsa_kernel
.text
.globl attn_a2_kernel
.p2align 8
.type attn_a2_kernel,@function
attn_a2_kernel:
    s_cmp_ge_u32 s2, 256
    s_cbranch_scc1 attn_a2_kernel_end
    s_load_dwordx2 s[6:7], s[0:1], 96
    s_waitcnt lgkmcnt(0)
    s_mov_b32 s8, s6
    s_mov_b32 s9, s7
    s_mov_b32 s10, 268435456
    s_mov_b32 s11, 0x00020000
    v_mov_b32 v1, v0
    v_add_u32 v2, 0, v1
    s_mov_b32 s12, 3121
    v_mul_lo_u32 v3, v2, s12
    v_lshrrev_b32 v3, 19, v3
    v_mul_u32_u24 v4, 168, v3
    v_sub_u32 v4, v2, v4
    v_lshlrev_b32 v5, 12, v3
    v_lshlrev_b32 v6, 4, v4
    v_add_u32 v5, v5, v6
    v_add_u32 v5, 23199744, v5
    buffer_load_dwordx4 v[8:11], v5, s[8:11], 0 offen
    v_mul_u32_u24 v7, 2688, v3
    v_add_u32 v7, v7, v6
    s_waitcnt vmcnt(0)
    ds_write_b128 v7, v[8:11]
    v_add_u32 v2, 256, v1
    s_mov_b32 s12, 3121
    v_mul_lo_u32 v3, v2, s12
    v_lshrrev_b32 v3, 19, v3
    v_mul_u32_u24 v4, 168, v3
    v_sub_u32 v4, v2, v4
    v_lshlrev_b32 v5, 12, v3
    v_lshlrev_b32 v6, 4, v4
    v_add_u32 v5, v5, v6
    v_add_u32 v5, 23199744, v5
    buffer_load_dwordx4 v[8:11], v5, s[8:11], 0 offen
    v_mul_u32_u24 v7, 2688, v3
    v_add_u32 v7, v7, v6
    s_waitcnt vmcnt(0)
    ds_write_b128 v7, v[8:11]
    v_add_u32 v2, 512, v1
    s_mov_b32 s12, 3121
    v_mul_lo_u32 v3, v2, s12
    v_lshrrev_b32 v3, 19, v3
    v_mul_u32_u24 v4, 168, v3
    v_sub_u32 v4, v2, v4
    v_lshlrev_b32 v5, 12, v3
    v_lshlrev_b32 v6, 4, v4
    v_add_u32 v5, v5, v6
    v_add_u32 v5, 23199744, v5
    buffer_load_dwordx4 v[8:11], v5, s[8:11], 0 offen
    v_mul_u32_u24 v7, 2688, v3
    v_add_u32 v7, v7, v6
    s_waitcnt vmcnt(0)
    ds_write_b128 v7, v[8:11]
    v_add_u32 v2, 768, v1
    s_mov_b32 s12, 3121
    v_mul_lo_u32 v3, v2, s12
    v_lshrrev_b32 v3, 19, v3
    v_mul_u32_u24 v4, 168, v3
    v_sub_u32 v4, v2, v4
    v_lshlrev_b32 v5, 12, v3
    v_lshlrev_b32 v6, 4, v4
    v_add_u32 v5, v5, v6
    v_add_u32 v5, 23199744, v5
    buffer_load_dwordx4 v[8:11], v5, s[8:11], 0 offen
    v_mul_u32_u24 v7, 2688, v3
    v_add_u32 v7, v7, v6
    s_waitcnt vmcnt(0)
    ds_write_b128 v7, v[8:11]
    v_add_u32 v2, 1024, v1
    s_mov_b32 s12, 3121
    v_mul_lo_u32 v3, v2, s12
    v_lshrrev_b32 v3, 19, v3
    v_mul_u32_u24 v4, 168, v3
    v_sub_u32 v4, v2, v4
    v_lshlrev_b32 v5, 12, v3
    v_lshlrev_b32 v6, 4, v4
    v_add_u32 v5, v5, v6
    v_add_u32 v5, 23199744, v5
    buffer_load_dwordx4 v[8:11], v5, s[8:11], 0 offen
    v_mul_u32_u24 v7, 2688, v3
    v_add_u32 v7, v7, v6
    s_waitcnt vmcnt(0)
    ds_write_b128 v7, v[8:11]
    v_add_u32 v2, 1280, v1
    s_mov_b32 s12, 3121
    v_mul_lo_u32 v3, v2, s12
    v_lshrrev_b32 v3, 19, v3
    v_mul_u32_u24 v4, 168, v3
    v_sub_u32 v4, v2, v4
    v_lshlrev_b32 v5, 12, v3
    v_lshlrev_b32 v6, 4, v4
    v_add_u32 v5, v5, v6
    v_add_u32 v5, 23199744, v5
    buffer_load_dwordx4 v[8:11], v5, s[8:11], 0 offen
    v_mul_u32_u24 v7, 2688, v3
    v_add_u32 v7, v7, v6
    s_waitcnt vmcnt(0)
    ds_write_b128 v7, v[8:11]
    v_add_u32 v2, 1536, v1
    s_mov_b32 s12, 3121
    v_mul_lo_u32 v3, v2, s12
    v_lshrrev_b32 v3, 19, v3
    v_mul_u32_u24 v4, 168, v3
    v_sub_u32 v4, v2, v4
    v_lshlrev_b32 v5, 12, v3
    v_lshlrev_b32 v6, 4, v4
    v_add_u32 v5, v5, v6
    v_add_u32 v5, 23199744, v5
    buffer_load_dwordx4 v[8:11], v5, s[8:11], 0 offen
    v_mul_u32_u24 v7, 2688, v3
    v_add_u32 v7, v7, v6
    s_waitcnt vmcnt(0)
    ds_write_b128 v7, v[8:11]
    v_add_u32 v2, 1792, v1
    s_mov_b32 s12, 3121
    v_mul_lo_u32 v3, v2, s12
    v_lshrrev_b32 v3, 19, v3
    v_mul_u32_u24 v4, 168, v3
    v_sub_u32 v4, v2, v4
    v_lshlrev_b32 v5, 12, v3
    v_lshlrev_b32 v6, 4, v4
    v_add_u32 v5, v5, v6
    v_add_u32 v5, 23199744, v5
    buffer_load_dwordx4 v[8:11], v5, s[8:11], 0 offen
    v_mul_u32_u24 v7, 2688, v3
    v_add_u32 v7, v7, v6
    s_waitcnt vmcnt(0)
    ds_write_b128 v7, v[8:11]
    v_add_u32 v2, 2048, v1
    s_mov_b32 s12, 3121
    v_mul_lo_u32 v3, v2, s12
    v_lshrrev_b32 v3, 19, v3
    v_mul_u32_u24 v4, 168, v3
    v_sub_u32 v4, v2, v4
    v_lshlrev_b32 v5, 12, v3
    v_lshlrev_b32 v6, 4, v4
    v_add_u32 v5, v5, v6
    v_add_u32 v5, 23199744, v5
    buffer_load_dwordx4 v[8:11], v5, s[8:11], 0 offen
    v_mul_u32_u24 v7, 2688, v3
    v_add_u32 v7, v7, v6
    s_waitcnt vmcnt(0)
    ds_write_b128 v7, v[8:11]
    v_add_u32 v2, 2304, v1
    s_mov_b32 s12, 3121
    v_mul_lo_u32 v3, v2, s12
    v_lshrrev_b32 v3, 19, v3
    v_mul_u32_u24 v4, 168, v3
    v_sub_u32 v4, v2, v4
    v_lshlrev_b32 v5, 12, v3
    v_lshlrev_b32 v6, 4, v4
    v_add_u32 v5, v5, v6
    v_add_u32 v5, 23199744, v5
    buffer_load_dwordx4 v[8:11], v5, s[8:11], 0 offen
    v_mul_u32_u24 v7, 2688, v3
    v_add_u32 v7, v7, v6
    s_waitcnt vmcnt(0)
    ds_write_b128 v7, v[8:11]
    v_add_u32 v2, 2560, v1
    s_mov_b32 s12, 3121
    v_mul_lo_u32 v3, v2, s12
    v_lshrrev_b32 v3, 19, v3
    v_mul_u32_u24 v4, 168, v3
    v_sub_u32 v4, v2, v4
    v_lshlrev_b32 v5, 12, v3
    v_lshlrev_b32 v6, 4, v4
    v_add_u32 v5, v5, v6
    v_add_u32 v5, 23199744, v5
    buffer_load_dwordx4 v[8:11], v5, s[8:11], 0 offen
    v_mul_u32_u24 v7, 2688, v3
    v_add_u32 v7, v7, v6
    s_waitcnt vmcnt(0)
    ds_write_b128 v7, v[8:11]
    v_add_u32 v2, 2816, v1
    s_mov_b32 s12, 3121
    v_mul_lo_u32 v3, v2, s12
    v_lshrrev_b32 v3, 19, v3
    v_mul_u32_u24 v4, 168, v3
    v_sub_u32 v4, v2, v4
    v_lshlrev_b32 v5, 12, v3
    v_lshlrev_b32 v6, 4, v4
    v_add_u32 v5, v5, v6
    v_add_u32 v5, 23199744, v5
    buffer_load_dwordx4 v[8:11], v5, s[8:11], 0 offen
    v_mul_u32_u24 v7, 2688, v3
    v_add_u32 v7, v7, v6
    s_waitcnt vmcnt(0)
    ds_write_b128 v7, v[8:11]
    v_add_u32 v2, 3072, v1
    s_mov_b32 s12, 3121
    v_mul_lo_u32 v3, v2, s12
    v_lshrrev_b32 v3, 19, v3
    v_mul_u32_u24 v4, 168, v3
    v_sub_u32 v4, v2, v4
    v_lshlrev_b32 v5, 12, v3
    v_lshlrev_b32 v6, 4, v4
    v_add_u32 v5, v5, v6
    v_add_u32 v5, 23199744, v5
    buffer_load_dwordx4 v[8:11], v5, s[8:11], 0 offen
    v_mul_u32_u24 v7, 2688, v3
    v_add_u32 v7, v7, v6
    s_waitcnt vmcnt(0)
    ds_write_b128 v7, v[8:11]
    v_add_u32 v2, 3328, v1
    s_mov_b32 s12, 3121
    v_mul_lo_u32 v3, v2, s12
    v_lshrrev_b32 v3, 19, v3
    v_mul_u32_u24 v4, 168, v3
    v_sub_u32 v4, v2, v4
    v_lshlrev_b32 v5, 12, v3
    v_lshlrev_b32 v6, 4, v4
    v_add_u32 v5, v5, v6
    v_add_u32 v5, 23199744, v5
    buffer_load_dwordx4 v[8:11], v5, s[8:11], 0 offen
    v_mul_u32_u24 v7, 2688, v3
    v_add_u32 v7, v7, v6
    s_waitcnt vmcnt(0)
    ds_write_b128 v7, v[8:11]
    v_add_u32 v2, 3584, v1
    s_mov_b32 s12, 3121
    v_mul_lo_u32 v3, v2, s12
    v_lshrrev_b32 v3, 19, v3
    v_mul_u32_u24 v4, 168, v3
    v_sub_u32 v4, v2, v4
    v_lshlrev_b32 v5, 12, v3
    v_lshlrev_b32 v6, 4, v4
    v_add_u32 v5, v5, v6
    v_add_u32 v5, 23199744, v5
    buffer_load_dwordx4 v[8:11], v5, s[8:11], 0 offen
    v_mul_u32_u24 v7, 2688, v3
    v_add_u32 v7, v7, v6
    s_waitcnt vmcnt(0)
    ds_write_b128 v7, v[8:11]
    v_add_u32 v2, 3840, v1
    s_mov_b32 s12, 3121
    v_mul_lo_u32 v3, v2, s12
    v_lshrrev_b32 v3, 19, v3
    v_mul_u32_u24 v4, 168, v3
    v_sub_u32 v4, v2, v4
    v_lshlrev_b32 v5, 12, v3
    v_lshlrev_b32 v6, 4, v4
    v_add_u32 v5, v5, v6
    v_add_u32 v5, 23199744, v5
    buffer_load_dwordx4 v[8:11], v5, s[8:11], 0 offen
    v_mul_u32_u24 v7, 2688, v3
    v_add_u32 v7, v7, v6
    s_waitcnt vmcnt(0)
    ds_write_b128 v7, v[8:11]
    v_add_u32 v2, 4096, v1
    s_mov_b32 s12, 3121
    v_mul_lo_u32 v3, v2, s12
    v_lshrrev_b32 v3, 19, v3
    v_mul_u32_u24 v4, 168, v3
    v_sub_u32 v4, v2, v4
    v_lshlrev_b32 v5, 12, v3
    v_lshlrev_b32 v6, 4, v4
    v_add_u32 v5, v5, v6
    v_add_u32 v5, 23199744, v5
    buffer_load_dwordx4 v[8:11], v5, s[8:11], 0 offen
    v_mul_u32_u24 v7, 2688, v3
    v_add_u32 v7, v7, v6
    s_waitcnt vmcnt(0)
    ds_write_b128 v7, v[8:11]
    v_add_u32 v2, 4352, v1
    s_mov_b32 s12, 3121
    v_mul_lo_u32 v3, v2, s12
    v_lshrrev_b32 v3, 19, v3
    v_mul_u32_u24 v4, 168, v3
    v_sub_u32 v4, v2, v4
    v_lshlrev_b32 v5, 12, v3
    v_lshlrev_b32 v6, 4, v4
    v_add_u32 v5, v5, v6
    v_add_u32 v5, 23199744, v5
    buffer_load_dwordx4 v[8:11], v5, s[8:11], 0 offen
    v_mul_u32_u24 v7, 2688, v3
    v_add_u32 v7, v7, v6
    s_waitcnt vmcnt(0)
    ds_write_b128 v7, v[8:11]
    v_add_u32 v2, 4608, v1
    s_mov_b32 s12, 3121
    v_mul_lo_u32 v3, v2, s12
    v_lshrrev_b32 v3, 19, v3
    v_mul_u32_u24 v4, 168, v3
    v_sub_u32 v4, v2, v4
    v_lshlrev_b32 v5, 12, v3
    v_lshlrev_b32 v6, 4, v4
    v_add_u32 v5, v5, v6
    v_add_u32 v5, 23199744, v5
    buffer_load_dwordx4 v[8:11], v5, s[8:11], 0 offen
    v_mul_u32_u24 v7, 2688, v3
    v_add_u32 v7, v7, v6
    s_waitcnt vmcnt(0)
    ds_write_b128 v7, v[8:11]
    v_add_u32 v2, 4864, v1
    s_mov_b32 s12, 3121
    v_mul_lo_u32 v3, v2, s12
    v_lshrrev_b32 v3, 19, v3
    v_mul_u32_u24 v4, 168, v3
    v_sub_u32 v4, v2, v4
    v_lshlrev_b32 v5, 12, v3
    v_lshlrev_b32 v6, 4, v4
    v_add_u32 v5, v5, v6
    v_add_u32 v5, 23199744, v5
    buffer_load_dwordx4 v[8:11], v5, s[8:11], 0 offen
    v_mul_u32_u24 v7, 2688, v3
    v_add_u32 v7, v7, v6
    s_waitcnt vmcnt(0)
    ds_write_b128 v7, v[8:11]
    v_add_u32 v2, 5120, v1
    s_mov_b32 s12, 3121
    v_mul_lo_u32 v3, v2, s12
    v_lshrrev_b32 v3, 19, v3
    v_mul_u32_u24 v4, 168, v3
    v_sub_u32 v4, v2, v4
    v_lshlrev_b32 v5, 12, v3
    v_lshlrev_b32 v6, 4, v4
    v_add_u32 v5, v5, v6
    v_add_u32 v5, 23199744, v5
    buffer_load_dwordx4 v[8:11], v5, s[8:11], 0 offen
    v_mul_u32_u24 v7, 2688, v3
    v_add_u32 v7, v7, v6
    s_waitcnt vmcnt(0)
    ds_write_b128 v7, v[8:11]
    s_waitcnt lgkmcnt(0)
    s_barrier
    v_and_b32 v2, 31, v0
    v_lshrrev_b32 v3, 5, v0
    s_lshl_b32 s12, s2, 3
    v_add_u32 v3, s12, v3
    v_mul_u32_u24 v4, 1280, v3
    v_mul_u32_u24 v5, 40, v2
    v_add_u32 v4, v4, v5
    v_add_u32 v6, 8388608, v4
    buffer_load_dwordx2 v[8:9], v6, s[8:11], 0 offen offset:0
    buffer_load_dwordx2 v[10:11], v6, s[8:11], 0 offen offset:8
    buffer_load_dwordx2 v[12:13], v6, s[8:11], 0 offen offset:16
    buffer_load_dwordx2 v[14:15], v6, s[8:11], 0 offen offset:24
    buffer_load_dwordx2 v[16:17], v6, s[8:11], 0 offen offset:32
    s_waitcnt vmcnt(0)
    v_lshlrev_b32 v40, 16, v8
    v_and_b32 v41, 0xffff0000, v8
    v_mul_f32 v44, 1.4426950408889634, v40
    v_exp_f32 v44, v44
    v_add_f32 v42, 1.0, v40
    v_cmp_lt_f32 vcc, 0, v40
    s_nop 1
    v_cndmask_b32 v42, v44, v42, vcc
    v_add_f32 v42, 0x358637bd, v42
    v_mul_f32 v44, 1.4426950408889634, v41
    v_exp_f32 v44, v44
    v_add_f32 v43, 1.0, v41
    v_cmp_lt_f32 vcc, 0, v41
    s_nop 1
    v_cndmask_b32 v43, v44, v43, vcc
    v_add_f32 v43, 0x358637bd, v43
    v_cvt_pk_bf16_f32 v45, v42, v43
    v_lshlrev_b32 v20, 16, v45
    v_and_b32 v21, 0xffff0000, v45
    v_lshlrev_b32 v40, 16, v9
    v_and_b32 v41, 0xffff0000, v9
    v_mul_f32 v44, 1.4426950408889634, v40
    v_exp_f32 v44, v44
    v_add_f32 v42, 1.0, v40
    v_cmp_lt_f32 vcc, 0, v40
    s_nop 1
    v_cndmask_b32 v42, v44, v42, vcc
    v_add_f32 v42, 0x358637bd, v42
    v_mul_f32 v44, 1.4426950408889634, v41
    v_exp_f32 v44, v44
    v_add_f32 v43, 1.0, v41
    v_cmp_lt_f32 vcc, 0, v41
    s_nop 1
    v_cndmask_b32 v43, v44, v43, vcc
    v_add_f32 v43, 0x358637bd, v43
    v_cvt_pk_bf16_f32 v45, v42, v43
    v_lshlrev_b32 v22, 16, v45
    v_and_b32 v23, 0xffff0000, v45
    v_lshlrev_b32 v40, 16, v10
    v_and_b32 v41, 0xffff0000, v10
    v_mul_f32 v44, 1.4426950408889634, v40
    v_exp_f32 v44, v44
    v_add_f32 v42, 1.0, v40
    v_cmp_lt_f32 vcc, 0, v40
    s_nop 1
    v_cndmask_b32 v42, v44, v42, vcc
    v_add_f32 v42, 0x358637bd, v42
    v_mul_f32 v44, 1.4426950408889634, v41
    v_exp_f32 v44, v44
    v_add_f32 v43, 1.0, v41
    v_cmp_lt_f32 vcc, 0, v41
    s_nop 1
    v_cndmask_b32 v43, v44, v43, vcc
    v_add_f32 v43, 0x358637bd, v43
    v_cvt_pk_bf16_f32 v45, v42, v43
    v_lshlrev_b32 v24, 16, v45
    v_and_b32 v25, 0xffff0000, v45
    v_lshlrev_b32 v40, 16, v11
    v_and_b32 v41, 0xffff0000, v11
    v_mul_f32 v44, 1.4426950408889634, v40
    v_exp_f32 v44, v44
    v_add_f32 v42, 1.0, v40
    v_cmp_lt_f32 vcc, 0, v40
    s_nop 1
    v_cndmask_b32 v42, v44, v42, vcc
    v_add_f32 v42, 0x358637bd, v42
    v_mul_f32 v44, 1.4426950408889634, v41
    v_exp_f32 v44, v44
    v_add_f32 v43, 1.0, v41
    v_cmp_lt_f32 vcc, 0, v41
    s_nop 1
    v_cndmask_b32 v43, v44, v43, vcc
    v_add_f32 v43, 0x358637bd, v43
    v_cvt_pk_bf16_f32 v45, v42, v43
    v_lshlrev_b32 v26, 16, v45
    v_and_b32 v27, 0xffff0000, v45
    v_lshlrev_b32 v40, 16, v12
    v_and_b32 v41, 0xffff0000, v12
    v_mul_f32 v44, 1.4426950408889634, v40
    v_exp_f32 v44, v44
    v_add_f32 v42, 1.0, v40
    v_cmp_lt_f32 vcc, 0, v40
    s_nop 1
    v_cndmask_b32 v42, v44, v42, vcc
    v_add_f32 v42, 0x358637bd, v42
    v_mul_f32 v44, 1.4426950408889634, v41
    v_exp_f32 v44, v44
    v_add_f32 v43, 1.0, v41
    v_cmp_lt_f32 vcc, 0, v41
    s_nop 1
    v_cndmask_b32 v43, v44, v43, vcc
    v_add_f32 v43, 0x358637bd, v43
    v_cvt_pk_bf16_f32 v45, v42, v43
    v_lshlrev_b32 v28, 16, v45
    v_and_b32 v29, 0xffff0000, v45
    v_lshlrev_b32 v40, 16, v13
    v_and_b32 v41, 0xffff0000, v13
    v_mul_f32 v44, 1.4426950408889634, v40
    v_exp_f32 v44, v44
    v_add_f32 v42, 1.0, v40
    v_cmp_lt_f32 vcc, 0, v40
    s_nop 1
    v_cndmask_b32 v42, v44, v42, vcc
    v_add_f32 v42, 0x358637bd, v42
    v_mul_f32 v44, 1.4426950408889634, v41
    v_exp_f32 v44, v44
    v_add_f32 v43, 1.0, v41
    v_cmp_lt_f32 vcc, 0, v41
    s_nop 1
    v_cndmask_b32 v43, v44, v43, vcc
    v_add_f32 v43, 0x358637bd, v43
    v_cvt_pk_bf16_f32 v45, v42, v43
    v_lshlrev_b32 v30, 16, v45
    v_and_b32 v31, 0xffff0000, v45
    v_lshlrev_b32 v40, 16, v14
    v_and_b32 v41, 0xffff0000, v14
    v_mul_f32 v44, 1.4426950408889634, v40
    v_exp_f32 v44, v44
    v_add_f32 v42, 1.0, v40
    v_cmp_lt_f32 vcc, 0, v40
    s_nop 1
    v_cndmask_b32 v42, v44, v42, vcc
    v_add_f32 v42, 0x358637bd, v42
    v_mul_f32 v44, 1.4426950408889634, v41
    v_exp_f32 v44, v44
    v_add_f32 v43, 1.0, v41
    v_cmp_lt_f32 vcc, 0, v41
    s_nop 1
    v_cndmask_b32 v43, v44, v43, vcc
    v_add_f32 v43, 0x358637bd, v43
    v_cvt_pk_bf16_f32 v45, v42, v43
    v_lshlrev_b32 v32, 16, v45
    v_and_b32 v33, 0xffff0000, v45
    v_lshlrev_b32 v40, 16, v15
    v_and_b32 v41, 0xffff0000, v15
    v_mul_f32 v44, 1.4426950408889634, v40
    v_exp_f32 v44, v44
    v_add_f32 v42, 1.0, v40
    v_cmp_lt_f32 vcc, 0, v40
    s_nop 1
    v_cndmask_b32 v42, v44, v42, vcc
    v_add_f32 v42, 0x358637bd, v42
    v_mul_f32 v44, 1.4426950408889634, v41
    v_exp_f32 v44, v44
    v_add_f32 v43, 1.0, v41
    v_cmp_lt_f32 vcc, 0, v41
    s_nop 1
    v_cndmask_b32 v43, v44, v43, vcc
    v_add_f32 v43, 0x358637bd, v43
    v_cvt_pk_bf16_f32 v45, v42, v43
    v_lshlrev_b32 v34, 16, v45
    v_and_b32 v35, 0xffff0000, v45
    v_lshlrev_b32 v40, 16, v16
    v_and_b32 v41, 0xffff0000, v16
    v_mul_f32 v44, 1.4426950408889634, v40
    v_exp_f32 v44, v44
    v_add_f32 v42, 1.0, v40
    v_cmp_lt_f32 vcc, 0, v40
    s_nop 1
    v_cndmask_b32 v42, v44, v42, vcc
    v_add_f32 v42, 0x358637bd, v42
    v_mul_f32 v44, 1.4426950408889634, v41
    v_exp_f32 v44, v44
    v_add_f32 v43, 1.0, v41
    v_cmp_lt_f32 vcc, 0, v41
    s_nop 1
    v_cndmask_b32 v43, v44, v43, vcc
    v_add_f32 v43, 0x358637bd, v43
    v_cvt_pk_bf16_f32 v45, v42, v43
    v_lshlrev_b32 v36, 16, v45
    v_and_b32 v37, 0xffff0000, v45
    v_lshlrev_b32 v40, 16, v17
    v_and_b32 v41, 0xffff0000, v17
    v_mul_f32 v44, 1.4426950408889634, v40
    v_exp_f32 v44, v44
    v_add_f32 v42, 1.0, v40
    v_cmp_lt_f32 vcc, 0, v40
    s_nop 1
    v_cndmask_b32 v42, v44, v42, vcc
    v_add_f32 v42, 0x358637bd, v42
    v_mul_f32 v44, 1.4426950408889634, v41
    v_exp_f32 v44, v44
    v_add_f32 v43, 1.0, v41
    v_cmp_lt_f32 vcc, 0, v41
    s_nop 1
    v_cndmask_b32 v43, v44, v43, vcc
    v_add_f32 v43, 0x358637bd, v43
    v_cvt_pk_bf16_f32 v45, v42, v43
    v_lshlrev_b32 v38, 16, v45
    v_and_b32 v39, 0xffff0000, v45
    v_mul_u32_u24 v7, 2688, v2
    ds_read_b128 v[72:75], v7 offset:0
    ds_read_b128 v[76:79], v7 offset:16
    ds_read_b128 v[80:83], v7 offset:32
    ds_read_b128 v[84:87], v7 offset:48
    ds_read_b128 v[88:91], v7 offset:64
    s_waitcnt lgkmcnt(0)
    v_mul_f32 v50, v20, v72
    v_fmac_f32 v50, v21, v73
    v_fmac_f32 v50, v22, v74
    v_fmac_f32 v50, v23, v75
    v_fmac_f32 v50, v24, v76
    v_fmac_f32 v50, v25, v77
    v_fmac_f32 v50, v26, v78
    v_fmac_f32 v50, v27, v79
    v_fmac_f32 v50, v28, v80
    v_fmac_f32 v50, v29, v81
    v_fmac_f32 v50, v30, v82
    v_fmac_f32 v50, v31, v83
    v_fmac_f32 v50, v32, v84
    v_fmac_f32 v50, v33, v85
    v_fmac_f32 v50, v34, v86
    v_fmac_f32 v50, v35, v87
    v_fmac_f32 v50, v36, v88
    v_fmac_f32 v50, v37, v89
    v_fmac_f32 v50, v38, v90
    v_fmac_f32 v50, v39, v91
    ds_read_b128 v[72:75], v7 offset:128
    ds_read_b128 v[76:79], v7 offset:144
    ds_read_b128 v[80:83], v7 offset:160
    ds_read_b128 v[84:87], v7 offset:176
    ds_read_b128 v[88:91], v7 offset:192
    s_waitcnt lgkmcnt(0)
    v_mul_f32 v51, v20, v72
    v_fmac_f32 v51, v21, v73
    v_fmac_f32 v51, v22, v74
    v_fmac_f32 v51, v23, v75
    v_fmac_f32 v51, v24, v76
    v_fmac_f32 v51, v25, v77
    v_fmac_f32 v51, v26, v78
    v_fmac_f32 v51, v27, v79
    v_fmac_f32 v51, v28, v80
    v_fmac_f32 v51, v29, v81
    v_fmac_f32 v51, v30, v82
    v_fmac_f32 v51, v31, v83
    v_fmac_f32 v51, v32, v84
    v_fmac_f32 v51, v33, v85
    v_fmac_f32 v51, v34, v86
    v_fmac_f32 v51, v35, v87
    v_fmac_f32 v51, v36, v88
    v_fmac_f32 v51, v37, v89
    v_fmac_f32 v51, v38, v90
    v_fmac_f32 v51, v39, v91
    ds_read_b128 v[72:75], v7 offset:256
    ds_read_b128 v[76:79], v7 offset:272
    ds_read_b128 v[80:83], v7 offset:288
    ds_read_b128 v[84:87], v7 offset:304
    ds_read_b128 v[88:91], v7 offset:320
    s_waitcnt lgkmcnt(0)
    v_mul_f32 v52, v20, v72
    v_fmac_f32 v52, v21, v73
    v_fmac_f32 v52, v22, v74
    v_fmac_f32 v52, v23, v75
    v_fmac_f32 v52, v24, v76
    v_fmac_f32 v52, v25, v77
    v_fmac_f32 v52, v26, v78
    v_fmac_f32 v52, v27, v79
    v_fmac_f32 v52, v28, v80
    v_fmac_f32 v52, v29, v81
    v_fmac_f32 v52, v30, v82
    v_fmac_f32 v52, v31, v83
    v_fmac_f32 v52, v32, v84
    v_fmac_f32 v52, v33, v85
    v_fmac_f32 v52, v34, v86
    v_fmac_f32 v52, v35, v87
    v_fmac_f32 v52, v36, v88
    v_fmac_f32 v52, v37, v89
    v_fmac_f32 v52, v38, v90
    v_fmac_f32 v52, v39, v91
    ds_read_b128 v[72:75], v7 offset:384
    ds_read_b128 v[76:79], v7 offset:400
    ds_read_b128 v[80:83], v7 offset:416
    ds_read_b128 v[84:87], v7 offset:432
    ds_read_b128 v[88:91], v7 offset:448
    s_waitcnt lgkmcnt(0)
    v_mul_f32 v53, v20, v72
    v_fmac_f32 v53, v21, v73
    v_fmac_f32 v53, v22, v74
    v_fmac_f32 v53, v23, v75
    v_fmac_f32 v53, v24, v76
    v_fmac_f32 v53, v25, v77
    v_fmac_f32 v53, v26, v78
    v_fmac_f32 v53, v27, v79
    v_fmac_f32 v53, v28, v80
    v_fmac_f32 v53, v29, v81
    v_fmac_f32 v53, v30, v82
    v_fmac_f32 v53, v31, v83
    v_fmac_f32 v53, v32, v84
    v_fmac_f32 v53, v33, v85
    v_fmac_f32 v53, v34, v86
    v_fmac_f32 v53, v35, v87
    v_fmac_f32 v53, v36, v88
    v_fmac_f32 v53, v37, v89
    v_fmac_f32 v53, v38, v90
    v_fmac_f32 v53, v39, v91
    ds_read_b128 v[72:75], v7 offset:512
    ds_read_b128 v[76:79], v7 offset:528
    ds_read_b128 v[80:83], v7 offset:544
    ds_read_b128 v[84:87], v7 offset:560
    ds_read_b128 v[88:91], v7 offset:576
    s_waitcnt lgkmcnt(0)
    v_mul_f32 v54, v20, v72
    v_fmac_f32 v54, v21, v73
    v_fmac_f32 v54, v22, v74
    v_fmac_f32 v54, v23, v75
    v_fmac_f32 v54, v24, v76
    v_fmac_f32 v54, v25, v77
    v_fmac_f32 v54, v26, v78
    v_fmac_f32 v54, v27, v79
    v_fmac_f32 v54, v28, v80
    v_fmac_f32 v54, v29, v81
    v_fmac_f32 v54, v30, v82
    v_fmac_f32 v54, v31, v83
    v_fmac_f32 v54, v32, v84
    v_fmac_f32 v54, v33, v85
    v_fmac_f32 v54, v34, v86
    v_fmac_f32 v54, v35, v87
    v_fmac_f32 v54, v36, v88
    v_fmac_f32 v54, v37, v89
    v_fmac_f32 v54, v38, v90
    v_fmac_f32 v54, v39, v91
    ds_read_b128 v[72:75], v7 offset:640
    ds_read_b128 v[76:79], v7 offset:656
    ds_read_b128 v[80:83], v7 offset:672
    ds_read_b128 v[84:87], v7 offset:688
    ds_read_b128 v[88:91], v7 offset:704
    s_waitcnt lgkmcnt(0)
    v_mul_f32 v55, v20, v72
    v_fmac_f32 v55, v21, v73
    v_fmac_f32 v55, v22, v74
    v_fmac_f32 v55, v23, v75
    v_fmac_f32 v55, v24, v76
    v_fmac_f32 v55, v25, v77
    v_fmac_f32 v55, v26, v78
    v_fmac_f32 v55, v27, v79
    v_fmac_f32 v55, v28, v80
    v_fmac_f32 v55, v29, v81
    v_fmac_f32 v55, v30, v82
    v_fmac_f32 v55, v31, v83
    v_fmac_f32 v55, v32, v84
    v_fmac_f32 v55, v33, v85
    v_fmac_f32 v55, v34, v86
    v_fmac_f32 v55, v35, v87
    v_fmac_f32 v55, v36, v88
    v_fmac_f32 v55, v37, v89
    v_fmac_f32 v55, v38, v90
    v_fmac_f32 v55, v39, v91
    ds_read_b128 v[72:75], v7 offset:768
    ds_read_b128 v[76:79], v7 offset:784
    ds_read_b128 v[80:83], v7 offset:800
    ds_read_b128 v[84:87], v7 offset:816
    ds_read_b128 v[88:91], v7 offset:832
    s_waitcnt lgkmcnt(0)
    v_mul_f32 v56, v20, v72
    v_fmac_f32 v56, v21, v73
    v_fmac_f32 v56, v22, v74
    v_fmac_f32 v56, v23, v75
    v_fmac_f32 v56, v24, v76
    v_fmac_f32 v56, v25, v77
    v_fmac_f32 v56, v26, v78
    v_fmac_f32 v56, v27, v79
    v_fmac_f32 v56, v28, v80
    v_fmac_f32 v56, v29, v81
    v_fmac_f32 v56, v30, v82
    v_fmac_f32 v56, v31, v83
    v_fmac_f32 v56, v32, v84
    v_fmac_f32 v56, v33, v85
    v_fmac_f32 v56, v34, v86
    v_fmac_f32 v56, v35, v87
    v_fmac_f32 v56, v36, v88
    v_fmac_f32 v56, v37, v89
    v_fmac_f32 v56, v38, v90
    v_fmac_f32 v56, v39, v91
    ds_read_b128 v[72:75], v7 offset:896
    ds_read_b128 v[76:79], v7 offset:912
    ds_read_b128 v[80:83], v7 offset:928
    ds_read_b128 v[84:87], v7 offset:944
    ds_read_b128 v[88:91], v7 offset:960
    s_waitcnt lgkmcnt(0)
    v_mul_f32 v57, v20, v72
    v_fmac_f32 v57, v21, v73
    v_fmac_f32 v57, v22, v74
    v_fmac_f32 v57, v23, v75
    v_fmac_f32 v57, v24, v76
    v_fmac_f32 v57, v25, v77
    v_fmac_f32 v57, v26, v78
    v_fmac_f32 v57, v27, v79
    v_fmac_f32 v57, v28, v80
    v_fmac_f32 v57, v29, v81
    v_fmac_f32 v57, v30, v82
    v_fmac_f32 v57, v31, v83
    v_fmac_f32 v57, v32, v84
    v_fmac_f32 v57, v33, v85
    v_fmac_f32 v57, v34, v86
    v_fmac_f32 v57, v35, v87
    v_fmac_f32 v57, v36, v88
    v_fmac_f32 v57, v37, v89
    v_fmac_f32 v57, v38, v90
    v_fmac_f32 v57, v39, v91
    ds_read_b128 v[72:75], v7 offset:1024
    ds_read_b128 v[76:79], v7 offset:1040
    ds_read_b128 v[80:83], v7 offset:1056
    ds_read_b128 v[84:87], v7 offset:1072
    ds_read_b128 v[88:91], v7 offset:1088
    s_waitcnt lgkmcnt(0)
    v_mul_f32 v58, v20, v72
    v_fmac_f32 v58, v21, v73
    v_fmac_f32 v58, v22, v74
    v_fmac_f32 v58, v23, v75
    v_fmac_f32 v58, v24, v76
    v_fmac_f32 v58, v25, v77
    v_fmac_f32 v58, v26, v78
    v_fmac_f32 v58, v27, v79
    v_fmac_f32 v58, v28, v80
    v_fmac_f32 v58, v29, v81
    v_fmac_f32 v58, v30, v82
    v_fmac_f32 v58, v31, v83
    v_fmac_f32 v58, v32, v84
    v_fmac_f32 v58, v33, v85
    v_fmac_f32 v58, v34, v86
    v_fmac_f32 v58, v35, v87
    v_fmac_f32 v58, v36, v88
    v_fmac_f32 v58, v37, v89
    v_fmac_f32 v58, v38, v90
    v_fmac_f32 v58, v39, v91
    ds_read_b128 v[72:75], v7 offset:1152
    ds_read_b128 v[76:79], v7 offset:1168
    ds_read_b128 v[80:83], v7 offset:1184
    ds_read_b128 v[84:87], v7 offset:1200
    ds_read_b128 v[88:91], v7 offset:1216
    s_waitcnt lgkmcnt(0)
    v_mul_f32 v59, v20, v72
    v_fmac_f32 v59, v21, v73
    v_fmac_f32 v59, v22, v74
    v_fmac_f32 v59, v23, v75
    v_fmac_f32 v59, v24, v76
    v_fmac_f32 v59, v25, v77
    v_fmac_f32 v59, v26, v78
    v_fmac_f32 v59, v27, v79
    v_fmac_f32 v59, v28, v80
    v_fmac_f32 v59, v29, v81
    v_fmac_f32 v59, v30, v82
    v_fmac_f32 v59, v31, v83
    v_fmac_f32 v59, v32, v84
    v_fmac_f32 v59, v33, v85
    v_fmac_f32 v59, v34, v86
    v_fmac_f32 v59, v35, v87
    v_fmac_f32 v59, v36, v88
    v_fmac_f32 v59, v37, v89
    v_fmac_f32 v59, v38, v90
    v_fmac_f32 v59, v39, v91
    ds_read_b128 v[72:75], v7 offset:1280
    ds_read_b128 v[76:79], v7 offset:1296
    ds_read_b128 v[80:83], v7 offset:1312
    ds_read_b128 v[84:87], v7 offset:1328
    ds_read_b128 v[88:91], v7 offset:1344
    s_waitcnt lgkmcnt(0)
    v_mul_f32 v60, v20, v72
    v_fmac_f32 v60, v21, v73
    v_fmac_f32 v60, v22, v74
    v_fmac_f32 v60, v23, v75
    v_fmac_f32 v60, v24, v76
    v_fmac_f32 v60, v25, v77
    v_fmac_f32 v60, v26, v78
    v_fmac_f32 v60, v27, v79
    v_fmac_f32 v60, v28, v80
    v_fmac_f32 v60, v29, v81
    v_fmac_f32 v60, v30, v82
    v_fmac_f32 v60, v31, v83
    v_fmac_f32 v60, v32, v84
    v_fmac_f32 v60, v33, v85
    v_fmac_f32 v60, v34, v86
    v_fmac_f32 v60, v35, v87
    v_fmac_f32 v60, v36, v88
    v_fmac_f32 v60, v37, v89
    v_fmac_f32 v60, v38, v90
    v_fmac_f32 v60, v39, v91
    ds_read_b128 v[72:75], v7 offset:1408
    ds_read_b128 v[76:79], v7 offset:1424
    ds_read_b128 v[80:83], v7 offset:1440
    ds_read_b128 v[84:87], v7 offset:1456
    ds_read_b128 v[88:91], v7 offset:1472
    s_waitcnt lgkmcnt(0)
    v_mul_f32 v61, v20, v72
    v_fmac_f32 v61, v21, v73
    v_fmac_f32 v61, v22, v74
    v_fmac_f32 v61, v23, v75
    v_fmac_f32 v61, v24, v76
    v_fmac_f32 v61, v25, v77
    v_fmac_f32 v61, v26, v78
    v_fmac_f32 v61, v27, v79
    v_fmac_f32 v61, v28, v80
    v_fmac_f32 v61, v29, v81
    v_fmac_f32 v61, v30, v82
    v_fmac_f32 v61, v31, v83
    v_fmac_f32 v61, v32, v84
    v_fmac_f32 v61, v33, v85
    v_fmac_f32 v61, v34, v86
    v_fmac_f32 v61, v35, v87
    v_fmac_f32 v61, v36, v88
    v_fmac_f32 v61, v37, v89
    v_fmac_f32 v61, v38, v90
    v_fmac_f32 v61, v39, v91
    ds_read_b128 v[72:75], v7 offset:1536
    ds_read_b128 v[76:79], v7 offset:1552
    ds_read_b128 v[80:83], v7 offset:1568
    ds_read_b128 v[84:87], v7 offset:1584
    ds_read_b128 v[88:91], v7 offset:1600
    s_waitcnt lgkmcnt(0)
    v_mul_f32 v62, v20, v72
    v_fmac_f32 v62, v21, v73
    v_fmac_f32 v62, v22, v74
    v_fmac_f32 v62, v23, v75
    v_fmac_f32 v62, v24, v76
    v_fmac_f32 v62, v25, v77
    v_fmac_f32 v62, v26, v78
    v_fmac_f32 v62, v27, v79
    v_fmac_f32 v62, v28, v80
    v_fmac_f32 v62, v29, v81
    v_fmac_f32 v62, v30, v82
    v_fmac_f32 v62, v31, v83
    v_fmac_f32 v62, v32, v84
    v_fmac_f32 v62, v33, v85
    v_fmac_f32 v62, v34, v86
    v_fmac_f32 v62, v35, v87
    v_fmac_f32 v62, v36, v88
    v_fmac_f32 v62, v37, v89
    v_fmac_f32 v62, v38, v90
    v_fmac_f32 v62, v39, v91
    ds_read_b128 v[72:75], v7 offset:1664
    ds_read_b128 v[76:79], v7 offset:1680
    ds_read_b128 v[80:83], v7 offset:1696
    ds_read_b128 v[84:87], v7 offset:1712
    ds_read_b128 v[88:91], v7 offset:1728
    s_waitcnt lgkmcnt(0)
    v_mul_f32 v63, v20, v72
    v_fmac_f32 v63, v21, v73
    v_fmac_f32 v63, v22, v74
    v_fmac_f32 v63, v23, v75
    v_fmac_f32 v63, v24, v76
    v_fmac_f32 v63, v25, v77
    v_fmac_f32 v63, v26, v78
    v_fmac_f32 v63, v27, v79
    v_fmac_f32 v63, v28, v80
    v_fmac_f32 v63, v29, v81
    v_fmac_f32 v63, v30, v82
    v_fmac_f32 v63, v31, v83
    v_fmac_f32 v63, v32, v84
    v_fmac_f32 v63, v33, v85
    v_fmac_f32 v63, v34, v86
    v_fmac_f32 v63, v35, v87
    v_fmac_f32 v63, v36, v88
    v_fmac_f32 v63, v37, v89
    v_fmac_f32 v63, v38, v90
    v_fmac_f32 v63, v39, v91
    ds_read_b128 v[72:75], v7 offset:1792
    ds_read_b128 v[76:79], v7 offset:1808
    ds_read_b128 v[80:83], v7 offset:1824
    ds_read_b128 v[84:87], v7 offset:1840
    ds_read_b128 v[88:91], v7 offset:1856
    s_waitcnt lgkmcnt(0)
    v_mul_f32 v64, v20, v72
    v_fmac_f32 v64, v21, v73
    v_fmac_f32 v64, v22, v74
    v_fmac_f32 v64, v23, v75
    v_fmac_f32 v64, v24, v76
    v_fmac_f32 v64, v25, v77
    v_fmac_f32 v64, v26, v78
    v_fmac_f32 v64, v27, v79
    v_fmac_f32 v64, v28, v80
    v_fmac_f32 v64, v29, v81
    v_fmac_f32 v64, v30, v82
    v_fmac_f32 v64, v31, v83
    v_fmac_f32 v64, v32, v84
    v_fmac_f32 v64, v33, v85
    v_fmac_f32 v64, v34, v86
    v_fmac_f32 v64, v35, v87
    v_fmac_f32 v64, v36, v88
    v_fmac_f32 v64, v37, v89
    v_fmac_f32 v64, v38, v90
    v_fmac_f32 v64, v39, v91
    ds_read_b128 v[72:75], v7 offset:1920
    ds_read_b128 v[76:79], v7 offset:1936
    ds_read_b128 v[80:83], v7 offset:1952
    ds_read_b128 v[84:87], v7 offset:1968
    ds_read_b128 v[88:91], v7 offset:1984
    s_waitcnt lgkmcnt(0)
    v_mul_f32 v65, v20, v72
    v_fmac_f32 v65, v21, v73
    v_fmac_f32 v65, v22, v74
    v_fmac_f32 v65, v23, v75
    v_fmac_f32 v65, v24, v76
    v_fmac_f32 v65, v25, v77
    v_fmac_f32 v65, v26, v78
    v_fmac_f32 v65, v27, v79
    v_fmac_f32 v65, v28, v80
    v_fmac_f32 v65, v29, v81
    v_fmac_f32 v65, v30, v82
    v_fmac_f32 v65, v31, v83
    v_fmac_f32 v65, v32, v84
    v_fmac_f32 v65, v33, v85
    v_fmac_f32 v65, v34, v86
    v_fmac_f32 v65, v35, v87
    v_fmac_f32 v65, v36, v88
    v_fmac_f32 v65, v37, v89
    v_fmac_f32 v65, v38, v90
    v_fmac_f32 v65, v39, v91
    ds_read_b128 v[72:75], v7 offset:2048
    ds_read_b128 v[76:79], v7 offset:2064
    ds_read_b128 v[80:83], v7 offset:2080
    ds_read_b128 v[84:87], v7 offset:2096
    ds_read_b128 v[88:91], v7 offset:2112
    s_waitcnt lgkmcnt(0)
    v_mul_f32 v66, v20, v72
    v_fmac_f32 v66, v21, v73
    v_fmac_f32 v66, v22, v74
    v_fmac_f32 v66, v23, v75
    v_fmac_f32 v66, v24, v76
    v_fmac_f32 v66, v25, v77
    v_fmac_f32 v66, v26, v78
    v_fmac_f32 v66, v27, v79
    v_fmac_f32 v66, v28, v80
    v_fmac_f32 v66, v29, v81
    v_fmac_f32 v66, v30, v82
    v_fmac_f32 v66, v31, v83
    v_fmac_f32 v66, v32, v84
    v_fmac_f32 v66, v33, v85
    v_fmac_f32 v66, v34, v86
    v_fmac_f32 v66, v35, v87
    v_fmac_f32 v66, v36, v88
    v_fmac_f32 v66, v37, v89
    v_fmac_f32 v66, v38, v90
    v_fmac_f32 v66, v39, v91
    ds_read_b128 v[72:75], v7 offset:2176
    ds_read_b128 v[76:79], v7 offset:2192
    ds_read_b128 v[80:83], v7 offset:2208
    ds_read_b128 v[84:87], v7 offset:2224
    ds_read_b128 v[88:91], v7 offset:2240
    s_waitcnt lgkmcnt(0)
    v_mul_f32 v67, v20, v72
    v_fmac_f32 v67, v21, v73
    v_fmac_f32 v67, v22, v74
    v_fmac_f32 v67, v23, v75
    v_fmac_f32 v67, v24, v76
    v_fmac_f32 v67, v25, v77
    v_fmac_f32 v67, v26, v78
    v_fmac_f32 v67, v27, v79
    v_fmac_f32 v67, v28, v80
    v_fmac_f32 v67, v29, v81
    v_fmac_f32 v67, v30, v82
    v_fmac_f32 v67, v31, v83
    v_fmac_f32 v67, v32, v84
    v_fmac_f32 v67, v33, v85
    v_fmac_f32 v67, v34, v86
    v_fmac_f32 v67, v35, v87
    v_fmac_f32 v67, v36, v88
    v_fmac_f32 v67, v37, v89
    v_fmac_f32 v67, v38, v90
    v_fmac_f32 v67, v39, v91
    ds_read_b128 v[72:75], v7 offset:2304
    ds_read_b128 v[76:79], v7 offset:2320
    ds_read_b128 v[80:83], v7 offset:2336
    ds_read_b128 v[84:87], v7 offset:2352
    ds_read_b128 v[88:91], v7 offset:2368
    s_waitcnt lgkmcnt(0)
    v_mul_f32 v68, v20, v72
    v_fmac_f32 v68, v21, v73
    v_fmac_f32 v68, v22, v74
    v_fmac_f32 v68, v23, v75
    v_fmac_f32 v68, v24, v76
    v_fmac_f32 v68, v25, v77
    v_fmac_f32 v68, v26, v78
    v_fmac_f32 v68, v27, v79
    v_fmac_f32 v68, v28, v80
    v_fmac_f32 v68, v29, v81
    v_fmac_f32 v68, v30, v82
    v_fmac_f32 v68, v31, v83
    v_fmac_f32 v68, v32, v84
    v_fmac_f32 v68, v33, v85
    v_fmac_f32 v68, v34, v86
    v_fmac_f32 v68, v35, v87
    v_fmac_f32 v68, v36, v88
    v_fmac_f32 v68, v37, v89
    v_fmac_f32 v68, v38, v90
    v_fmac_f32 v68, v39, v91
    ds_read_b128 v[72:75], v7 offset:2432
    ds_read_b128 v[76:79], v7 offset:2448
    ds_read_b128 v[80:83], v7 offset:2464
    ds_read_b128 v[84:87], v7 offset:2480
    ds_read_b128 v[88:91], v7 offset:2496
    s_waitcnt lgkmcnt(0)
    v_mul_f32 v69, v20, v72
    v_fmac_f32 v69, v21, v73
    v_fmac_f32 v69, v22, v74
    v_fmac_f32 v69, v23, v75
    v_fmac_f32 v69, v24, v76
    v_fmac_f32 v69, v25, v77
    v_fmac_f32 v69, v26, v78
    v_fmac_f32 v69, v27, v79
    v_fmac_f32 v69, v28, v80
    v_fmac_f32 v69, v29, v81
    v_fmac_f32 v69, v30, v82
    v_fmac_f32 v69, v31, v83
    v_fmac_f32 v69, v32, v84
    v_fmac_f32 v69, v33, v85
    v_fmac_f32 v69, v34, v86
    v_fmac_f32 v69, v35, v87
    v_fmac_f32 v69, v36, v88
    v_fmac_f32 v69, v37, v89
    v_fmac_f32 v69, v38, v90
    v_fmac_f32 v69, v39, v91
    ds_read_b128 v[72:75], v7 offset:2560
    ds_read_b128 v[76:79], v7 offset:2576
    ds_read_b128 v[80:83], v7 offset:2592
    ds_read_b128 v[84:87], v7 offset:2608
    ds_read_b128 v[88:91], v7 offset:2624
    s_waitcnt lgkmcnt(0)
    v_mul_f32 v70, v20, v72
    v_fmac_f32 v70, v21, v73
    v_fmac_f32 v70, v22, v74
    v_fmac_f32 v70, v23, v75
    v_fmac_f32 v70, v24, v76
    v_fmac_f32 v70, v25, v77
    v_fmac_f32 v70, v26, v78
    v_fmac_f32 v70, v27, v79
    v_fmac_f32 v70, v28, v80
    v_fmac_f32 v70, v29, v81
    v_fmac_f32 v70, v30, v82
    v_fmac_f32 v70, v31, v83
    v_fmac_f32 v70, v32, v84
    v_fmac_f32 v70, v33, v85
    v_fmac_f32 v70, v34, v86
    v_fmac_f32 v70, v35, v87
    v_fmac_f32 v70, v36, v88
    v_fmac_f32 v70, v37, v89
    v_fmac_f32 v70, v38, v90
    v_fmac_f32 v70, v39, v91
    v_add_f32 v70, 0x358637bd, v70
    v_rcp_f32 v70, v70
    s_nop 0
    v_mul_f32 v50, v50, v70
    v_mul_f32 v51, v51, v70
    v_mul_f32 v52, v52, v70
    v_mul_f32 v53, v53, v70
    v_mul_f32 v54, v54, v70
    v_mul_f32 v55, v55, v70
    v_mul_f32 v56, v56, v70
    v_mul_f32 v57, v57, v70
    v_mul_f32 v58, v58, v70
    v_mul_f32 v59, v59, v70
    v_mul_f32 v60, v60, v70
    v_mul_f32 v61, v61, v70
    v_mul_f32 v62, v62, v70
    v_mul_f32 v63, v63, v70
    v_mul_f32 v64, v64, v70
    v_mul_f32 v65, v65, v70
    v_mul_f32 v66, v66, v70
    v_mul_f32 v67, v67, v70
    v_mul_f32 v68, v68, v70
    v_mul_f32 v69, v69, v70
    v_cvt_pk_bf16_f32 v8, v50, v51
    v_cvt_pk_bf16_f32 v9, v52, v53
    v_cvt_pk_bf16_f32 v10, v54, v55
    v_cvt_pk_bf16_f32 v11, v56, v57
    v_cvt_pk_bf16_f32 v12, v58, v59
    v_cvt_pk_bf16_f32 v13, v60, v61
    v_cvt_pk_bf16_f32 v14, v62, v63
    v_cvt_pk_bf16_f32 v15, v64, v65
    v_cvt_pk_bf16_f32 v16, v66, v67
    v_cvt_pk_bf16_f32 v17, v68, v69
    v_add_u32 v6, 18874368, v4
    buffer_store_dwordx2 v[8:9], v6, s[8:11], 0 offen offset:0
    buffer_store_dwordx2 v[10:11], v6, s[8:11], 0 offen offset:8
    buffer_store_dwordx2 v[12:13], v6, s[8:11], 0 offen offset:16
    buffer_store_dwordx2 v[14:15], v6, s[8:11], 0 offen offset:24
    buffer_store_dwordx2 v[16:17], v6, s[8:11], 0 offen offset:32
attn_a2_kernel_end:
    s_endpgm
.section .rodata,"a"
.p2align 6
.amdhsa_kernel attn_a2_kernel
  .amdhsa_next_free_vgpr 96
  .amdhsa_next_free_sgpr 40
  .amdhsa_accum_offset 96
  .amdhsa_group_segment_fixed_size 0
  .amdhsa_kernarg_size 104
  .amdhsa_user_sgpr_count 2
  .amdhsa_user_sgpr_kernarg_segment_ptr 1
  .amdhsa_system_sgpr_workgroup_id_x 1
.end_amdhsa_kernel
.text
.globl wo_a2_kernel
.p2align 8
.type wo_a2_kernel,@function
wo_a2_kernel:
    v_lshrrev_b32 v1, 6, v0
    v_and_b32 v2, 63, v0
    s_nop 0
    v_readfirstlane_b32 s3, v1
    s_cmp_ge_u32 s2, 128
    s_cbranch_scc1 wo_a2_kernel_end
    s_load_dwordx2 s[4:5], s[0:1], 96
    s_load_dwordx2 s[6:7], s[0:1], 80
    s_mul_i32 s20, s2, 1
    s_lshr_b32 s20, s20, 3
    s_mul_i32 s21, s20, 8
    s_sub_u32 s21, s2, s21
    s_lshl_b32 s20, s20, 2
    s_add_u32 s20, s20, s3
    s_mul_i32 s22, s20, 32
    s_mul_i32 s23, s21, 80
    s_waitcnt lgkmcnt(0)
    s_mov_b32 s8, s4
    s_mov_b32 s9, s5
    s_mov_b32 s10, 268435456
    s_mov_b32 s11, 0x00020000
    v_and_b32 v3, 15, v2
    v_lshrrev_b32 v4, 4, v2
    s_mov_b32 s24, 1280
    v_add_u32 v5, s22, v3
    v_mul_lo_u32 v5, v5, s24
    v_lshlrev_b32 v6, 4, v4
    v_add_u32 v5, v5, v6
    v_add_u32 v5, 18874368, v5
    v_mov_b32 v8, v5
    v_add_u32 v9, 20480, v5
    v_lshlrev_b32 v7, 4, v2
    s_mov_b32 s25, 0
    s_mov_b32 s26, 0
    s_mul_i32 s27, s21, 102400
    s_add_u32 s27, s27, s26
    s_add_u32 s27, s27, 29360128
    s_add_u32 s32, s27, 0
    s_add_u32 s33, s27, 20480
    s_add_u32 s34, s27, 40960
    s_add_u32 s35, s27, 61440
    s_add_u32 s36, s27, 81920
    v_accvgpr_write_b32 a0, 0
    v_accvgpr_write_b32 a1, 0
    v_accvgpr_write_b32 a2, 0
    v_accvgpr_write_b32 a3, 0
    v_accvgpr_write_b32 a4, 0
    v_accvgpr_write_b32 a5, 0
    v_accvgpr_write_b32 a6, 0
    v_accvgpr_write_b32 a7, 0
    v_accvgpr_write_b32 a8, 0
    v_accvgpr_write_b32 a9, 0
    v_accvgpr_write_b32 a10, 0
    v_accvgpr_write_b32 a11, 0
    v_accvgpr_write_b32 a12, 0
    v_accvgpr_write_b32 a13, 0
    v_accvgpr_write_b32 a14, 0
    v_accvgpr_write_b32 a15, 0
    v_accvgpr_write_b32 a16, 0
    v_accvgpr_write_b32 a17, 0
    v_accvgpr_write_b32 a18, 0
    v_accvgpr_write_b32 a19, 0
    v_accvgpr_write_b32 a20, 0
    v_accvgpr_write_b32 a21, 0
    v_accvgpr_write_b32 a22, 0
    v_accvgpr_write_b32 a23, 0
    v_accvgpr_write_b32 a24, 0
    v_accvgpr_write_b32 a25, 0
    v_accvgpr_write_b32 a26, 0
    v_accvgpr_write_b32 a27, 0
    v_accvgpr_write_b32 a28, 0
    v_accvgpr_write_b32 a29, 0
    v_accvgpr_write_b32 a30, 0
    v_accvgpr_write_b32 a31, 0
    v_accvgpr_write_b32 a32, 0
    v_accvgpr_write_b32 a33, 0
    v_accvgpr_write_b32 a34, 0
    v_accvgpr_write_b32 a35, 0
    v_accvgpr_write_b32 a36, 0
    v_accvgpr_write_b32 a37, 0
    v_accvgpr_write_b32 a38, 0
    v_accvgpr_write_b32 a39, 0
    buffer_load_dwordx4 v[16:19], v8, s[8:11], s25 offen
    buffer_load_dwordx4 v[20:23], v9, s[8:11], s25 offen
    buffer_load_dwordx4 v[24:27], v7, s[8:11], s32 offen
    buffer_load_dwordx4 v[28:31], v7, s[8:11], s33 offen
    buffer_load_dwordx4 v[32:35], v7, s[8:11], s34 offen
    buffer_load_dwordx4 v[36:39], v7, s[8:11], s35 offen
    buffer_load_dwordx4 v[40:43], v7, s[8:11], s36 offen
    s_mov_b32 s28, 10
wo_a2_kernel_loop0:
    s_add_u32 s25, s25, 64
    s_add_u32 s32, s32, 1024
    s_add_u32 s33, s33, 1024
    s_add_u32 s34, s34, 1024
    s_add_u32 s35, s35, 1024
    s_add_u32 s36, s36, 1024
    buffer_load_dwordx4 v[44:47], v8, s[8:11], s25 offen
    buffer_load_dwordx4 v[48:51], v9, s[8:11], s25 offen
    buffer_load_dwordx4 v[52:55], v7, s[8:11], s32 offen
    buffer_load_dwordx4 v[56:59], v7, s[8:11], s33 offen
    buffer_load_dwordx4 v[60:63], v7, s[8:11], s34 offen
    buffer_load_dwordx4 v[64:67], v7, s[8:11], s35 offen
    buffer_load_dwordx4 v[68:71], v7, s[8:11], s36 offen
    s_waitcnt vmcnt(7)
    v_mfma_f32_16x16x32_bf16 a[0:3], v[24:27], v[16:19], a[0:3]
    v_mfma_f32_16x16x32_bf16 a[20:23], v[24:27], v[20:23], a[20:23]
    v_mfma_f32_16x16x32_bf16 a[4:7], v[28:31], v[16:19], a[4:7]
    v_mfma_f32_16x16x32_bf16 a[24:27], v[28:31], v[20:23], a[24:27]
    v_mfma_f32_16x16x32_bf16 a[8:11], v[32:35], v[16:19], a[8:11]
    v_mfma_f32_16x16x32_bf16 a[28:31], v[32:35], v[20:23], a[28:31]
    v_mfma_f32_16x16x32_bf16 a[12:15], v[36:39], v[16:19], a[12:15]
    v_mfma_f32_16x16x32_bf16 a[32:35], v[36:39], v[20:23], a[32:35]
    v_mfma_f32_16x16x32_bf16 a[16:19], v[40:43], v[16:19], a[16:19]
    v_mfma_f32_16x16x32_bf16 a[36:39], v[40:43], v[20:23], a[36:39]
    s_sub_u32 s28, s28, 1
    s_cmp_eq_u32 s28, 0
    s_cbranch_scc1 wo_a2_kernel_loop0_last
    s_add_u32 s25, s25, 64
    s_add_u32 s32, s32, 1024
    s_add_u32 s33, s33, 1024
    s_add_u32 s34, s34, 1024
    s_add_u32 s35, s35, 1024
    s_add_u32 s36, s36, 1024
    buffer_load_dwordx4 v[16:19], v8, s[8:11], s25 offen
    buffer_load_dwordx4 v[20:23], v9, s[8:11], s25 offen
    buffer_load_dwordx4 v[24:27], v7, s[8:11], s32 offen
    buffer_load_dwordx4 v[28:31], v7, s[8:11], s33 offen
    buffer_load_dwordx4 v[32:35], v7, s[8:11], s34 offen
    buffer_load_dwordx4 v[36:39], v7, s[8:11], s35 offen
    buffer_load_dwordx4 v[40:43], v7, s[8:11], s36 offen
    s_waitcnt vmcnt(7)
    v_mfma_f32_16x16x32_bf16 a[0:3], v[52:55], v[44:47], a[0:3]
    v_mfma_f32_16x16x32_bf16 a[20:23], v[52:55], v[48:51], a[20:23]
    v_mfma_f32_16x16x32_bf16 a[4:7], v[56:59], v[44:47], a[4:7]
    v_mfma_f32_16x16x32_bf16 a[24:27], v[56:59], v[48:51], a[24:27]
    v_mfma_f32_16x16x32_bf16 a[8:11], v[60:63], v[44:47], a[8:11]
    v_mfma_f32_16x16x32_bf16 a[28:31], v[60:63], v[48:51], a[28:31]
    v_mfma_f32_16x16x32_bf16 a[12:15], v[64:67], v[44:47], a[12:15]
    v_mfma_f32_16x16x32_bf16 a[32:35], v[64:67], v[48:51], a[32:35]
    v_mfma_f32_16x16x32_bf16 a[16:19], v[68:71], v[44:47], a[16:19]
    v_mfma_f32_16x16x32_bf16 a[36:39], v[68:71], v[48:51], a[36:39]
    s_branch wo_a2_kernel_loop0
wo_a2_kernel_loop0_last:
    s_waitcnt vmcnt(0)
    v_mfma_f32_16x16x32_bf16 a[0:3], v[52:55], v[44:47], a[0:3]
    v_mfma_f32_16x16x32_bf16 a[20:23], v[52:55], v[48:51], a[20:23]
    v_mfma_f32_16x16x32_bf16 a[4:7], v[56:59], v[44:47], a[4:7]
    v_mfma_f32_16x16x32_bf16 a[24:27], v[56:59], v[48:51], a[24:27]
    v_mfma_f32_16x16x32_bf16 a[8:11], v[60:63], v[44:47], a[8:11]
    v_mfma_f32_16x16x32_bf16 a[28:31], v[60:63], v[48:51], a[28:31]
    v_mfma_f32_16x16x32_bf16 a[12:15], v[64:67], v[44:47], a[12:15]
    v_mfma_f32_16x16x32_bf16 a[32:35], v[64:67], v[48:51], a[32:35]
    v_mfma_f32_16x16x32_bf16 a[16:19], v[68:71], v[44:47], a[16:19]
    v_mfma_f32_16x16x32_bf16 a[36:39], v[68:71], v[48:51], a[36:39]
    s_nop 7
    s_nop 7
    s_mov_b32 s24, 1280
    v_add_u32 v5, s22, v3
    v_mul_lo_u32 v5, v5, s24
    v_lshlrev_b32 v6, 3, v4
    s_lshl_b32 s29, s23, 1
    v_add3_u32 v5, v5, v6, s29
    v_add_u32 v6, 4194304, v5
    buffer_load_dwordx2 v[72:73], v6, s[8:11], 0 offen
    v_accvgpr_read_b32 v76, a0
    v_accvgpr_read_b32 v77, a1
    v_accvgpr_read_b32 v78, a2
    v_accvgpr_read_b32 v79, a3
    v_cvt_pk_bf16_f32 v80, v76, v77
    v_cvt_pk_bf16_f32 v81, v78, v79
    s_waitcnt vmcnt(0)
    v_lshlrev_b32 v76, 16, v80
    v_and_b32 v77, 0xffff0000, v80
    v_lshlrev_b32 v82, 16, v72
    v_and_b32 v83, 0xffff0000, v72
    v_add_f32 v76, v76, v82
    v_add_f32 v77, v77, v83
    v_lshlrev_b32 v78, 16, v81
    v_and_b32 v79, 0xffff0000, v81
    v_lshlrev_b32 v82, 16, v73
    v_and_b32 v83, 0xffff0000, v73
    v_add_f32 v78, v78, v82
    v_add_f32 v79, v79, v83
    v_cvt_pk_bf16_f32 v80, v76, v77
    v_cvt_pk_bf16_f32 v81, v78, v79
    v_add_u32 v6, 4194304, v5
    buffer_store_dwordx2 v[80:81], v6, s[8:11], 0 offen
    v_add_u32 v6, 4194336, v5
    buffer_load_dwordx2 v[72:73], v6, s[8:11], 0 offen
    v_accvgpr_read_b32 v76, a4
    v_accvgpr_read_b32 v77, a5
    v_accvgpr_read_b32 v78, a6
    v_accvgpr_read_b32 v79, a7
    v_cvt_pk_bf16_f32 v80, v76, v77
    v_cvt_pk_bf16_f32 v81, v78, v79
    s_waitcnt vmcnt(0)
    v_lshlrev_b32 v76, 16, v80
    v_and_b32 v77, 0xffff0000, v80
    v_lshlrev_b32 v82, 16, v72
    v_and_b32 v83, 0xffff0000, v72
    v_add_f32 v76, v76, v82
    v_add_f32 v77, v77, v83
    v_lshlrev_b32 v78, 16, v81
    v_and_b32 v79, 0xffff0000, v81
    v_lshlrev_b32 v82, 16, v73
    v_and_b32 v83, 0xffff0000, v73
    v_add_f32 v78, v78, v82
    v_add_f32 v79, v79, v83
    v_cvt_pk_bf16_f32 v80, v76, v77
    v_cvt_pk_bf16_f32 v81, v78, v79
    v_add_u32 v6, 4194336, v5
    buffer_store_dwordx2 v[80:81], v6, s[8:11], 0 offen
    v_add_u32 v6, 4194368, v5
    buffer_load_dwordx2 v[72:73], v6, s[8:11], 0 offen
    v_accvgpr_read_b32 v76, a8
    v_accvgpr_read_b32 v77, a9
    v_accvgpr_read_b32 v78, a10
    v_accvgpr_read_b32 v79, a11
    v_cvt_pk_bf16_f32 v80, v76, v77
    v_cvt_pk_bf16_f32 v81, v78, v79
    s_waitcnt vmcnt(0)
    v_lshlrev_b32 v76, 16, v80
    v_and_b32 v77, 0xffff0000, v80
    v_lshlrev_b32 v82, 16, v72
    v_and_b32 v83, 0xffff0000, v72
    v_add_f32 v76, v76, v82
    v_add_f32 v77, v77, v83
    v_lshlrev_b32 v78, 16, v81
    v_and_b32 v79, 0xffff0000, v81
    v_lshlrev_b32 v82, 16, v73
    v_and_b32 v83, 0xffff0000, v73
    v_add_f32 v78, v78, v82
    v_add_f32 v79, v79, v83
    v_cvt_pk_bf16_f32 v80, v76, v77
    v_cvt_pk_bf16_f32 v81, v78, v79
    v_add_u32 v6, 4194368, v5
    buffer_store_dwordx2 v[80:81], v6, s[8:11], 0 offen
    v_add_u32 v6, 4194400, v5
    buffer_load_dwordx2 v[72:73], v6, s[8:11], 0 offen
    v_accvgpr_read_b32 v76, a12
    v_accvgpr_read_b32 v77, a13
    v_accvgpr_read_b32 v78, a14
    v_accvgpr_read_b32 v79, a15
    v_cvt_pk_bf16_f32 v80, v76, v77
    v_cvt_pk_bf16_f32 v81, v78, v79
    s_waitcnt vmcnt(0)
    v_lshlrev_b32 v76, 16, v80
    v_and_b32 v77, 0xffff0000, v80
    v_lshlrev_b32 v82, 16, v72
    v_and_b32 v83, 0xffff0000, v72
    v_add_f32 v76, v76, v82
    v_add_f32 v77, v77, v83
    v_lshlrev_b32 v78, 16, v81
    v_and_b32 v79, 0xffff0000, v81
    v_lshlrev_b32 v82, 16, v73
    v_and_b32 v83, 0xffff0000, v73
    v_add_f32 v78, v78, v82
    v_add_f32 v79, v79, v83
    v_cvt_pk_bf16_f32 v80, v76, v77
    v_cvt_pk_bf16_f32 v81, v78, v79
    v_add_u32 v6, 4194400, v5
    buffer_store_dwordx2 v[80:81], v6, s[8:11], 0 offen
    v_add_u32 v6, 4194432, v5
    buffer_load_dwordx2 v[72:73], v6, s[8:11], 0 offen
    v_accvgpr_read_b32 v76, a16
    v_accvgpr_read_b32 v77, a17
    v_accvgpr_read_b32 v78, a18
    v_accvgpr_read_b32 v79, a19
    v_cvt_pk_bf16_f32 v80, v76, v77
    v_cvt_pk_bf16_f32 v81, v78, v79
    s_waitcnt vmcnt(0)
    v_lshlrev_b32 v76, 16, v80
    v_and_b32 v77, 0xffff0000, v80
    v_lshlrev_b32 v82, 16, v72
    v_and_b32 v83, 0xffff0000, v72
    v_add_f32 v76, v76, v82
    v_add_f32 v77, v77, v83
    v_lshlrev_b32 v78, 16, v81
    v_and_b32 v79, 0xffff0000, v81
    v_lshlrev_b32 v82, 16, v73
    v_and_b32 v83, 0xffff0000, v73
    v_add_f32 v78, v78, v82
    v_add_f32 v79, v79, v83
    v_cvt_pk_bf16_f32 v80, v76, v77
    v_cvt_pk_bf16_f32 v81, v78, v79
    v_add_u32 v6, 4194432, v5
    buffer_store_dwordx2 v[80:81], v6, s[8:11], 0 offen
    v_add_u32 v6, 4214784, v5
    buffer_load_dwordx2 v[72:73], v6, s[8:11], 0 offen
    v_accvgpr_read_b32 v76, a20
    v_accvgpr_read_b32 v77, a21
    v_accvgpr_read_b32 v78, a22
    v_accvgpr_read_b32 v79, a23
    v_cvt_pk_bf16_f32 v80, v76, v77
    v_cvt_pk_bf16_f32 v81, v78, v79
    s_waitcnt vmcnt(0)
    v_lshlrev_b32 v76, 16, v80
    v_and_b32 v77, 0xffff0000, v80
    v_lshlrev_b32 v82, 16, v72
    v_and_b32 v83, 0xffff0000, v72
    v_add_f32 v76, v76, v82
    v_add_f32 v77, v77, v83
    v_lshlrev_b32 v78, 16, v81
    v_and_b32 v79, 0xffff0000, v81
    v_lshlrev_b32 v82, 16, v73
    v_and_b32 v83, 0xffff0000, v73
    v_add_f32 v78, v78, v82
    v_add_f32 v79, v79, v83
    v_cvt_pk_bf16_f32 v80, v76, v77
    v_cvt_pk_bf16_f32 v81, v78, v79
    v_add_u32 v6, 4214784, v5
    buffer_store_dwordx2 v[80:81], v6, s[8:11], 0 offen
    v_add_u32 v6, 4214816, v5
    buffer_load_dwordx2 v[72:73], v6, s[8:11], 0 offen
    v_accvgpr_read_b32 v76, a24
    v_accvgpr_read_b32 v77, a25
    v_accvgpr_read_b32 v78, a26
    v_accvgpr_read_b32 v79, a27
    v_cvt_pk_bf16_f32 v80, v76, v77
    v_cvt_pk_bf16_f32 v81, v78, v79
    s_waitcnt vmcnt(0)
    v_lshlrev_b32 v76, 16, v80
    v_and_b32 v77, 0xffff0000, v80
    v_lshlrev_b32 v82, 16, v72
    v_and_b32 v83, 0xffff0000, v72
    v_add_f32 v76, v76, v82
    v_add_f32 v77, v77, v83
    v_lshlrev_b32 v78, 16, v81
    v_and_b32 v79, 0xffff0000, v81
    v_lshlrev_b32 v82, 16, v73
    v_and_b32 v83, 0xffff0000, v73
    v_add_f32 v78, v78, v82
    v_add_f32 v79, v79, v83
    v_cvt_pk_bf16_f32 v80, v76, v77
    v_cvt_pk_bf16_f32 v81, v78, v79
    v_add_u32 v6, 4214816, v5
    buffer_store_dwordx2 v[80:81], v6, s[8:11], 0 offen
    v_add_u32 v6, 4214848, v5
    buffer_load_dwordx2 v[72:73], v6, s[8:11], 0 offen
    v_accvgpr_read_b32 v76, a28
    v_accvgpr_read_b32 v77, a29
    v_accvgpr_read_b32 v78, a30
    v_accvgpr_read_b32 v79, a31
    v_cvt_pk_bf16_f32 v80, v76, v77
    v_cvt_pk_bf16_f32 v81, v78, v79
    s_waitcnt vmcnt(0)
    v_lshlrev_b32 v76, 16, v80
    v_and_b32 v77, 0xffff0000, v80
    v_lshlrev_b32 v82, 16, v72
    v_and_b32 v83, 0xffff0000, v72
    v_add_f32 v76, v76, v82
    v_add_f32 v77, v77, v83
    v_lshlrev_b32 v78, 16, v81
    v_and_b32 v79, 0xffff0000, v81
    v_lshlrev_b32 v82, 16, v73
    v_and_b32 v83, 0xffff0000, v73
    v_add_f32 v78, v78, v82
    v_add_f32 v79, v79, v83
    v_cvt_pk_bf16_f32 v80, v76, v77
    v_cvt_pk_bf16_f32 v81, v78, v79
    v_add_u32 v6, 4214848, v5
    buffer_store_dwordx2 v[80:81], v6, s[8:11], 0 offen
    v_add_u32 v6, 4214880, v5
    buffer_load_dwordx2 v[72:73], v6, s[8:11], 0 offen
    v_accvgpr_read_b32 v76, a32
    v_accvgpr_read_b32 v77, a33
    v_accvgpr_read_b32 v78, a34
    v_accvgpr_read_b32 v79, a35
    v_cvt_pk_bf16_f32 v80, v76, v77
    v_cvt_pk_bf16_f32 v81, v78, v79
    s_waitcnt vmcnt(0)
    v_lshlrev_b32 v76, 16, v80
    v_and_b32 v77, 0xffff0000, v80
    v_lshlrev_b32 v82, 16, v72
    v_and_b32 v83, 0xffff0000, v72
    v_add_f32 v76, v76, v82
    v_add_f32 v77, v77, v83
    v_lshlrev_b32 v78, 16, v81
    v_and_b32 v79, 0xffff0000, v81
    v_lshlrev_b32 v82, 16, v73
    v_and_b32 v83, 0xffff0000, v73
    v_add_f32 v78, v78, v82
    v_add_f32 v79, v79, v83
    v_cvt_pk_bf16_f32 v80, v76, v77
    v_cvt_pk_bf16_f32 v81, v78, v79
    v_add_u32 v6, 4214880, v5
    buffer_store_dwordx2 v[80:81], v6, s[8:11], 0 offen
    v_add_u32 v6, 4214912, v5
    buffer_load_dwordx2 v[72:73], v6, s[8:11], 0 offen
    v_accvgpr_read_b32 v76, a36
    v_accvgpr_read_b32 v77, a37
    v_accvgpr_read_b32 v78, a38
    v_accvgpr_read_b32 v79, a39
    v_cvt_pk_bf16_f32 v80, v76, v77
    v_cvt_pk_bf16_f32 v81, v78, v79
    s_waitcnt vmcnt(0)
    v_lshlrev_b32 v76, 16, v80
    v_and_b32 v77, 0xffff0000, v80
    v_lshlrev_b32 v82, 16, v72
    v_and_b32 v83, 0xffff0000, v72
    v_add_f32 v76, v76, v82
    v_add_f32 v77, v77, v83
    v_lshlrev_b32 v78, 16, v81
    v_and_b32 v79, 0xffff0000, v81
    v_lshlrev_b32 v82, 16, v73
    v_and_b32 v83, 0xffff0000, v73
    v_add_f32 v78, v78, v82
    v_add_f32 v79, v79, v83
    v_cvt_pk_bf16_f32 v80, v76, v77
    v_cvt_pk_bf16_f32 v81, v78, v79
    v_add_u32 v6, 4214912, v5
    buffer_store_dwordx2 v[80:81], v6, s[8:11], 0 offen
wo_a2_kernel_end:
    s_endpgm
.section .rodata,"a"
.p2align 6
.amdhsa_kernel wo_a2_kernel
  .amdhsa_next_free_vgpr 136
  .amdhsa_next_free_sgpr 64
  .amdhsa_accum_offset 96
  .amdhsa_group_segment_fixed_size 0
  .amdhsa_kernarg_size 104
  .amdhsa_user_sgpr_count 2
  .amdhsa_user_sgpr_kernarg_segment_ptr 1
  .amdhsa_system_sgpr_workgroup_id_x 1
.end_amdhsa_kernel
.text
.globl wo_b2_kernel
.p2align 8
.type wo_b2_kernel,@function
wo_b2_kernel:
    v_lshrrev_b32 v1, 6, v0
    v_and_b32 v2, 63, v0
    s_nop 0
    v_readfirstlane_b32 s3, v1
    s_cmp_ge_u32 s2, 256
    s_cbranch_scc1 wo_b2_kernel_end
    s_load_dwordx2 s[4:5], s[0:1], 96
    s_load_dwordx2 s[6:7], s[0:1], 80
    s_mul_i32 s20, s2, 1
    s_lshr_b32 s20, s20, 3
    s_mul_i32 s21, s20, 8
    s_sub_u32 s21, s2, s21
    s_mul_i32 s22, s20, 64
    s_mul_i32 s23, s21, 80
    s_waitcnt lgkmcnt(0)
    s_mov_b32 s8, s4
    s_mov_b32 s9, s5
    s_mov_b32 s10, 268435456
    s_mov_b32 s11, 0x00020000
    v_and_b32 v3, 15, v2
    v_lshrrev_b32 v4, 4, v2
    s_mov_b32 s24, 12288
    v_add_u32 v5, s22, v3
    v_mul_lo_u32 v5, v5, s24
    v_lshlrev_b32 v6, 4, v4
    v_add_u32 v5, v5, v6
    v_add_u32 v5, 184549376, v5
    v_mov_b32 v8, v5
    v_add_u32 v9, 196608, v5
    v_add_u32 v10, 393216, v5
    v_add_u32 v11, 589824, v5
    v_lshlrev_b32 v7, 4, v2
    s_mul_i32 s26, s3, 49152
    s_mul_i32 s25, s3, 3072
    s_mul_i32 s27, s21, 983040
    s_add_u32 s27, s27, s26
    s_add_u32 s27, s27, 58720256
    s_add_u32 s32, s27, 0
    s_add_u32 s33, s27, 196608
    s_add_u32 s34, s27, 393216
    s_add_u32 s35, s27, 589824
    s_add_u32 s36, s27, 786432
    v_accvgpr_write_b32 a0, 0
    v_accvgpr_write_b32 a1, 0
    v_accvgpr_write_b32 a2, 0
    v_accvgpr_write_b32 a3, 0
    v_accvgpr_write_b32 a4, 0
    v_accvgpr_write_b32 a5, 0
    v_accvgpr_write_b32 a6, 0
    v_accvgpr_write_b32 a7, 0
    v_accvgpr_write_b32 a8, 0
    v_accvgpr_write_b32 a9, 0
    v_accvgpr_write_b32 a10, 0
    v_accvgpr_write_b32 a11, 0
    v_accvgpr_write_b32 a12, 0
    v_accvgpr_write_b32 a13, 0
    v_accvgpr_write_b32 a14, 0
    v_accvgpr_write_b32 a15, 0
    v_accvgpr_write_b32 a16, 0
    v_accvgpr_write_b32 a17, 0
    v_accvgpr_write_b32 a18, 0
    v_accvgpr_write_b32 a19, 0
    v_accvgpr_write_b32 a20, 0
    v_accvgpr_write_b32 a21, 0
    v_accvgpr_write_b32 a22, 0
    v_accvgpr_write_b32 a23, 0
    v_accvgpr_write_b32 a24, 0
    v_accvgpr_write_b32 a25, 0
    v_accvgpr_write_b32 a26, 0
    v_accvgpr_write_b32 a27, 0
    v_accvgpr_write_b32 a28, 0
    v_accvgpr_write_b32 a29, 0
    v_accvgpr_write_b32 a30, 0
    v_accvgpr_write_b32 a31, 0
    v_accvgpr_write_b32 a32, 0
    v_accvgpr_write_b32 a33, 0
    v_accvgpr_write_b32 a34, 0
    v_accvgpr_write_b32 a35, 0
    v_accvgpr_write_b32 a36, 0
    v_accvgpr_write_b32 a37, 0
    v_accvgpr_write_b32 a38, 0
    v_accvgpr_write_b32 a39, 0
    v_accvgpr_write_b32 a40, 0
    v_accvgpr_write_b32 a41, 0
    v_accvgpr_write_b32 a42, 0
    v_accvgpr_write_b32 a43, 0
    v_accvgpr_write_b32 a44, 0
    v_accvgpr_write_b32 a45, 0
    v_accvgpr_write_b32 a46, 0
    v_accvgpr_write_b32 a47, 0
    v_accvgpr_write_b32 a48, 0
    v_accvgpr_write_b32 a49, 0
    v_accvgpr_write_b32 a50, 0
    v_accvgpr_write_b32 a51, 0
    v_accvgpr_write_b32 a52, 0
    v_accvgpr_write_b32 a53, 0
    v_accvgpr_write_b32 a54, 0
    v_accvgpr_write_b32 a55, 0
    v_accvgpr_write_b32 a56, 0
    v_accvgpr_write_b32 a57, 0
    v_accvgpr_write_b32 a58, 0
    v_accvgpr_write_b32 a59, 0
    v_accvgpr_write_b32 a60, 0
    v_accvgpr_write_b32 a61, 0
    v_accvgpr_write_b32 a62, 0
    v_accvgpr_write_b32 a63, 0
    v_accvgpr_write_b32 a64, 0
    v_accvgpr_write_b32 a65, 0
    v_accvgpr_write_b32 a66, 0
    v_accvgpr_write_b32 a67, 0
    v_accvgpr_write_b32 a68, 0
    v_accvgpr_write_b32 a69, 0
    v_accvgpr_write_b32 a70, 0
    v_accvgpr_write_b32 a71, 0
    v_accvgpr_write_b32 a72, 0
    v_accvgpr_write_b32 a73, 0
    v_accvgpr_write_b32 a74, 0
    v_accvgpr_write_b32 a75, 0
    v_accvgpr_write_b32 a76, 0
    v_accvgpr_write_b32 a77, 0
    v_accvgpr_write_b32 a78, 0
    v_accvgpr_write_b32 a79, 0
    buffer_load_dwordx4 v[16:19], v8, s[8:11], s25 offen
    buffer_load_dwordx4 v[20:23], v9, s[8:11], s25 offen
    buffer_load_dwordx4 v[24:27], v10, s[8:11], s25 offen
    buffer_load_dwordx4 v[28:31], v11, s[8:11], s25 offen
    buffer_load_dwordx4 v[32:35], v7, s[8:11], s32 offen
    buffer_load_dwordx4 v[36:39], v7, s[8:11], s33 offen
    buffer_load_dwordx4 v[40:43], v7, s[8:11], s34 offen
    buffer_load_dwordx4 v[44:47], v7, s[8:11], s35 offen
    buffer_load_dwordx4 v[48:51], v7, s[8:11], s36 offen
    s_mov_b32 s28, 24
wo_b2_kernel_loop0:
    s_add_u32 s25, s25, 64
    s_add_u32 s32, s32, 1024
    s_add_u32 s33, s33, 1024
    s_add_u32 s34, s34, 1024
    s_add_u32 s35, s35, 1024
    s_add_u32 s36, s36, 1024
    buffer_load_dwordx4 v[52:55], v8, s[8:11], s25 offen
    buffer_load_dwordx4 v[56:59], v9, s[8:11], s25 offen
    buffer_load_dwordx4 v[60:63], v10, s[8:11], s25 offen
    buffer_load_dwordx4 v[64:67], v11, s[8:11], s25 offen
    buffer_load_dwordx4 v[68:71], v7, s[8:11], s32 offen
    buffer_load_dwordx4 v[72:75], v7, s[8:11], s33 offen
    buffer_load_dwordx4 v[76:79], v7, s[8:11], s34 offen
    buffer_load_dwordx4 v[80:83], v7, s[8:11], s35 offen
    buffer_load_dwordx4 v[84:87], v7, s[8:11], s36 offen
    s_waitcnt vmcnt(9)
    v_mfma_f32_16x16x32_bf16 a[0:3], v[32:35], v[16:19], a[0:3]
    v_mfma_f32_16x16x32_bf16 a[20:23], v[32:35], v[20:23], a[20:23]
    v_mfma_f32_16x16x32_bf16 a[40:43], v[32:35], v[24:27], a[40:43]
    v_mfma_f32_16x16x32_bf16 a[60:63], v[32:35], v[28:31], a[60:63]
    v_mfma_f32_16x16x32_bf16 a[4:7], v[36:39], v[16:19], a[4:7]
    v_mfma_f32_16x16x32_bf16 a[24:27], v[36:39], v[20:23], a[24:27]
    v_mfma_f32_16x16x32_bf16 a[44:47], v[36:39], v[24:27], a[44:47]
    v_mfma_f32_16x16x32_bf16 a[64:67], v[36:39], v[28:31], a[64:67]
    v_mfma_f32_16x16x32_bf16 a[8:11], v[40:43], v[16:19], a[8:11]
    v_mfma_f32_16x16x32_bf16 a[28:31], v[40:43], v[20:23], a[28:31]
    v_mfma_f32_16x16x32_bf16 a[48:51], v[40:43], v[24:27], a[48:51]
    v_mfma_f32_16x16x32_bf16 a[68:71], v[40:43], v[28:31], a[68:71]
    v_mfma_f32_16x16x32_bf16 a[12:15], v[44:47], v[16:19], a[12:15]
    v_mfma_f32_16x16x32_bf16 a[32:35], v[44:47], v[20:23], a[32:35]
    v_mfma_f32_16x16x32_bf16 a[52:55], v[44:47], v[24:27], a[52:55]
    v_mfma_f32_16x16x32_bf16 a[72:75], v[44:47], v[28:31], a[72:75]
    v_mfma_f32_16x16x32_bf16 a[16:19], v[48:51], v[16:19], a[16:19]
    v_mfma_f32_16x16x32_bf16 a[36:39], v[48:51], v[20:23], a[36:39]
    v_mfma_f32_16x16x32_bf16 a[56:59], v[48:51], v[24:27], a[56:59]
    v_mfma_f32_16x16x32_bf16 a[76:79], v[48:51], v[28:31], a[76:79]
    s_sub_u32 s28, s28, 1
    s_cmp_eq_u32 s28, 0
    s_cbranch_scc1 wo_b2_kernel_loop0_last
    s_add_u32 s25, s25, 64
    s_add_u32 s32, s32, 1024
    s_add_u32 s33, s33, 1024
    s_add_u32 s34, s34, 1024
    s_add_u32 s35, s35, 1024
    s_add_u32 s36, s36, 1024
    buffer_load_dwordx4 v[16:19], v8, s[8:11], s25 offen
    buffer_load_dwordx4 v[20:23], v9, s[8:11], s25 offen
    buffer_load_dwordx4 v[24:27], v10, s[8:11], s25 offen
    buffer_load_dwordx4 v[28:31], v11, s[8:11], s25 offen
    buffer_load_dwordx4 v[32:35], v7, s[8:11], s32 offen
    buffer_load_dwordx4 v[36:39], v7, s[8:11], s33 offen
    buffer_load_dwordx4 v[40:43], v7, s[8:11], s34 offen
    buffer_load_dwordx4 v[44:47], v7, s[8:11], s35 offen
    buffer_load_dwordx4 v[48:51], v7, s[8:11], s36 offen
    s_waitcnt vmcnt(9)
    v_mfma_f32_16x16x32_bf16 a[0:3], v[68:71], v[52:55], a[0:3]
    v_mfma_f32_16x16x32_bf16 a[20:23], v[68:71], v[56:59], a[20:23]
    v_mfma_f32_16x16x32_bf16 a[40:43], v[68:71], v[60:63], a[40:43]
    v_mfma_f32_16x16x32_bf16 a[60:63], v[68:71], v[64:67], a[60:63]
    v_mfma_f32_16x16x32_bf16 a[4:7], v[72:75], v[52:55], a[4:7]
    v_mfma_f32_16x16x32_bf16 a[24:27], v[72:75], v[56:59], a[24:27]
    v_mfma_f32_16x16x32_bf16 a[44:47], v[72:75], v[60:63], a[44:47]
    v_mfma_f32_16x16x32_bf16 a[64:67], v[72:75], v[64:67], a[64:67]
    v_mfma_f32_16x16x32_bf16 a[8:11], v[76:79], v[52:55], a[8:11]
    v_mfma_f32_16x16x32_bf16 a[28:31], v[76:79], v[56:59], a[28:31]
    v_mfma_f32_16x16x32_bf16 a[48:51], v[76:79], v[60:63], a[48:51]
    v_mfma_f32_16x16x32_bf16 a[68:71], v[76:79], v[64:67], a[68:71]
    v_mfma_f32_16x16x32_bf16 a[12:15], v[80:83], v[52:55], a[12:15]
    v_mfma_f32_16x16x32_bf16 a[32:35], v[80:83], v[56:59], a[32:35]
    v_mfma_f32_16x16x32_bf16 a[52:55], v[80:83], v[60:63], a[52:55]
    v_mfma_f32_16x16x32_bf16 a[72:75], v[80:83], v[64:67], a[72:75]
    v_mfma_f32_16x16x32_bf16 a[16:19], v[84:87], v[52:55], a[16:19]
    v_mfma_f32_16x16x32_bf16 a[36:39], v[84:87], v[56:59], a[36:39]
    v_mfma_f32_16x16x32_bf16 a[56:59], v[84:87], v[60:63], a[56:59]
    v_mfma_f32_16x16x32_bf16 a[76:79], v[84:87], v[64:67], a[76:79]
    s_branch wo_b2_kernel_loop0
wo_b2_kernel_loop0_last:
    s_waitcnt vmcnt(0)
    v_mfma_f32_16x16x32_bf16 a[0:3], v[68:71], v[52:55], a[0:3]
    v_mfma_f32_16x16x32_bf16 a[20:23], v[68:71], v[56:59], a[20:23]
    v_mfma_f32_16x16x32_bf16 a[40:43], v[68:71], v[60:63], a[40:43]
    v_mfma_f32_16x16x32_bf16 a[60:63], v[68:71], v[64:67], a[60:63]
    v_mfma_f32_16x16x32_bf16 a[4:7], v[72:75], v[52:55], a[4:7]
    v_mfma_f32_16x16x32_bf16 a[24:27], v[72:75], v[56:59], a[24:27]
    v_mfma_f32_16x16x32_bf16 a[44:47], v[72:75], v[60:63], a[44:47]
    v_mfma_f32_16x16x32_bf16 a[64:67], v[72:75], v[64:67], a[64:67]
    v_mfma_f32_16x16x32_bf16 a[8:11], v[76:79], v[52:55], a[8:11]
    v_mfma_f32_16x16x32_bf16 a[28:31], v[76:79], v[56:59], a[28:31]
    v_mfma_f32_16x16x32_bf16 a[48:51], v[76:79], v[60:63], a[48:51]
    v_mfma_f32_16x16x32_bf16 a[68:71], v[76:79], v[64:67], a[68:71]
    v_mfma_f32_16x16x32_bf16 a[12:15], v[80:83], v[52:55], a[12:15]
    v_mfma_f32_16x16x32_bf16 a[32:35], v[80:83], v[56:59], a[32:35]
    v_mfma_f32_16x16x32_bf16 a[52:55], v[80:83], v[60:63], a[52:55]
    v_mfma_f32_16x16x32_bf16 a[72:75], v[80:83], v[64:67], a[72:75]
    v_mfma_f32_16x16x32_bf16 a[16:19], v[84:87], v[52:55], a[16:19]
    v_mfma_f32_16x16x32_bf16 a[36:39], v[84:87], v[56:59], a[36:39]
    v_mfma_f32_16x16x32_bf16 a[56:59], v[84:87], v[60:63], a[56:59]
    v_mfma_f32_16x16x32_bf16 a[76:79], v[84:87], v[64:67], a[76:79]
    s_nop 7
    s_nop 7
    v_lshlrev_b32 v5, 4, v2
    s_cmp_eq_u32 s3, 0
    s_cbranch_scc1 wo_b2_kernel_red0
    s_sub_u32 s29, s3, 1
    s_mul_i32 s29, s29, 20480
    v_add_u32 v5, s29, v5
    v_accvgpr_read_b32 v88, a0
    v_accvgpr_read_b32 v89, a1
    v_accvgpr_read_b32 v90, a2
    v_accvgpr_read_b32 v91, a3
    ds_write_b128 v5, v[88:91] offset:0
    v_accvgpr_read_b32 v88, a4
    v_accvgpr_read_b32 v89, a5
    v_accvgpr_read_b32 v90, a6
    v_accvgpr_read_b32 v91, a7
    ds_write_b128 v5, v[88:91] offset:1024
    v_accvgpr_read_b32 v88, a8
    v_accvgpr_read_b32 v89, a9
    v_accvgpr_read_b32 v90, a10
    v_accvgpr_read_b32 v91, a11
    ds_write_b128 v5, v[88:91] offset:2048
    v_accvgpr_read_b32 v88, a12
    v_accvgpr_read_b32 v89, a13
    v_accvgpr_read_b32 v90, a14
    v_accvgpr_read_b32 v91, a15
    ds_write_b128 v5, v[88:91] offset:3072
    v_accvgpr_read_b32 v88, a16
    v_accvgpr_read_b32 v89, a17
    v_accvgpr_read_b32 v90, a18
    v_accvgpr_read_b32 v91, a19
    ds_write_b128 v5, v[88:91] offset:4096
    v_accvgpr_read_b32 v88, a20
    v_accvgpr_read_b32 v89, a21
    v_accvgpr_read_b32 v90, a22
    v_accvgpr_read_b32 v91, a23
    ds_write_b128 v5, v[88:91] offset:5120
    v_accvgpr_read_b32 v88, a24
    v_accvgpr_read_b32 v89, a25
    v_accvgpr_read_b32 v90, a26
    v_accvgpr_read_b32 v91, a27
    ds_write_b128 v5, v[88:91] offset:6144
    v_accvgpr_read_b32 v88, a28
    v_accvgpr_read_b32 v89, a29
    v_accvgpr_read_b32 v90, a30
    v_accvgpr_read_b32 v91, a31
    ds_write_b128 v5, v[88:91] offset:7168
    v_accvgpr_read_b32 v88, a32
    v_accvgpr_read_b32 v89, a33
    v_accvgpr_read_b32 v90, a34
    v_accvgpr_read_b32 v91, a35
    ds_write_b128 v5, v[88:91] offset:8192
    v_accvgpr_read_b32 v88, a36
    v_accvgpr_read_b32 v89, a37
    v_accvgpr_read_b32 v90, a38
    v_accvgpr_read_b32 v91, a39
    ds_write_b128 v5, v[88:91] offset:9216
    v_accvgpr_read_b32 v88, a40
    v_accvgpr_read_b32 v89, a41
    v_accvgpr_read_b32 v90, a42
    v_accvgpr_read_b32 v91, a43
    ds_write_b128 v5, v[88:91] offset:10240
    v_accvgpr_read_b32 v88, a44
    v_accvgpr_read_b32 v89, a45
    v_accvgpr_read_b32 v90, a46
    v_accvgpr_read_b32 v91, a47
    ds_write_b128 v5, v[88:91] offset:11264
    v_accvgpr_read_b32 v88, a48
    v_accvgpr_read_b32 v89, a49
    v_accvgpr_read_b32 v90, a50
    v_accvgpr_read_b32 v91, a51
    ds_write_b128 v5, v[88:91] offset:12288
    v_accvgpr_read_b32 v88, a52
    v_accvgpr_read_b32 v89, a53
    v_accvgpr_read_b32 v90, a54
    v_accvgpr_read_b32 v91, a55
    ds_write_b128 v5, v[88:91] offset:13312
    v_accvgpr_read_b32 v88, a56
    v_accvgpr_read_b32 v89, a57
    v_accvgpr_read_b32 v90, a58
    v_accvgpr_read_b32 v91, a59
    ds_write_b128 v5, v[88:91] offset:14336
    v_accvgpr_read_b32 v88, a60
    v_accvgpr_read_b32 v89, a61
    v_accvgpr_read_b32 v90, a62
    v_accvgpr_read_b32 v91, a63
    ds_write_b128 v5, v[88:91] offset:15360
    v_accvgpr_read_b32 v88, a64
    v_accvgpr_read_b32 v89, a65
    v_accvgpr_read_b32 v90, a66
    v_accvgpr_read_b32 v91, a67
    ds_write_b128 v5, v[88:91] offset:16384
    v_accvgpr_read_b32 v88, a68
    v_accvgpr_read_b32 v89, a69
    v_accvgpr_read_b32 v90, a70
    v_accvgpr_read_b32 v91, a71
    ds_write_b128 v5, v[88:91] offset:17408
    v_accvgpr_read_b32 v88, a72
    v_accvgpr_read_b32 v89, a73
    v_accvgpr_read_b32 v90, a74
    v_accvgpr_read_b32 v91, a75
    ds_write_b128 v5, v[88:91] offset:18432
    v_accvgpr_read_b32 v88, a76
    v_accvgpr_read_b32 v89, a77
    v_accvgpr_read_b32 v90, a78
    v_accvgpr_read_b32 v91, a79
    ds_write_b128 v5, v[88:91] offset:19456
    s_waitcnt lgkmcnt(0)
    s_barrier
    s_branch wo_b2_kernel_end
wo_b2_kernel_red0:
    s_barrier
    ds_read_b128 v[88:91], v5 offset:0
    ds_read_b128 v[92:95], v5 offset:20480
    ds_read_b128 v[96:99], v5 offset:40960
    s_waitcnt lgkmcnt(0)
    v_accvgpr_read_b32 v100, a0
    v_accvgpr_read_b32 v101, a1
    v_accvgpr_read_b32 v102, a2
    v_accvgpr_read_b32 v103, a3
    v_add_f32 v100, v100, v88
    v_add_f32 v92, v92, v96
    v_add_f32 v100, v100, v92
    v_accvgpr_write_b32 a0, v100
    v_add_f32 v101, v101, v89
    v_add_f32 v93, v93, v97
    v_add_f32 v101, v101, v93
    v_accvgpr_write_b32 a1, v101
    v_add_f32 v102, v102, v90
    v_add_f32 v94, v94, v98
    v_add_f32 v102, v102, v94
    v_accvgpr_write_b32 a2, v102
    v_add_f32 v103, v103, v91
    v_add_f32 v95, v95, v99
    v_add_f32 v103, v103, v95
    v_accvgpr_write_b32 a3, v103
    ds_read_b128 v[88:91], v5 offset:1024
    ds_read_b128 v[92:95], v5 offset:21504
    ds_read_b128 v[96:99], v5 offset:41984
    s_waitcnt lgkmcnt(0)
    v_accvgpr_read_b32 v100, a4
    v_accvgpr_read_b32 v101, a5
    v_accvgpr_read_b32 v102, a6
    v_accvgpr_read_b32 v103, a7
    v_add_f32 v100, v100, v88
    v_add_f32 v92, v92, v96
    v_add_f32 v100, v100, v92
    v_accvgpr_write_b32 a4, v100
    v_add_f32 v101, v101, v89
    v_add_f32 v93, v93, v97
    v_add_f32 v101, v101, v93
    v_accvgpr_write_b32 a5, v101
    v_add_f32 v102, v102, v90
    v_add_f32 v94, v94, v98
    v_add_f32 v102, v102, v94
    v_accvgpr_write_b32 a6, v102
    v_add_f32 v103, v103, v91
    v_add_f32 v95, v95, v99
    v_add_f32 v103, v103, v95
    v_accvgpr_write_b32 a7, v103
    ds_read_b128 v[88:91], v5 offset:2048
    ds_read_b128 v[92:95], v5 offset:22528
    ds_read_b128 v[96:99], v5 offset:43008
    s_waitcnt lgkmcnt(0)
    v_accvgpr_read_b32 v100, a8
    v_accvgpr_read_b32 v101, a9
    v_accvgpr_read_b32 v102, a10
    v_accvgpr_read_b32 v103, a11
    v_add_f32 v100, v100, v88
    v_add_f32 v92, v92, v96
    v_add_f32 v100, v100, v92
    v_accvgpr_write_b32 a8, v100
    v_add_f32 v101, v101, v89
    v_add_f32 v93, v93, v97
    v_add_f32 v101, v101, v93
    v_accvgpr_write_b32 a9, v101
    v_add_f32 v102, v102, v90
    v_add_f32 v94, v94, v98
    v_add_f32 v102, v102, v94
    v_accvgpr_write_b32 a10, v102
    v_add_f32 v103, v103, v91
    v_add_f32 v95, v95, v99
    v_add_f32 v103, v103, v95
    v_accvgpr_write_b32 a11, v103
    ds_read_b128 v[88:91], v5 offset:3072
    ds_read_b128 v[92:95], v5 offset:23552
    ds_read_b128 v[96:99], v5 offset:44032
    s_waitcnt lgkmcnt(0)
    v_accvgpr_read_b32 v100, a12
    v_accvgpr_read_b32 v101, a13
    v_accvgpr_read_b32 v102, a14
    v_accvgpr_read_b32 v103, a15
    v_add_f32 v100, v100, v88
    v_add_f32 v92, v92, v96
    v_add_f32 v100, v100, v92
    v_accvgpr_write_b32 a12, v100
    v_add_f32 v101, v101, v89
    v_add_f32 v93, v93, v97
    v_add_f32 v101, v101, v93
    v_accvgpr_write_b32 a13, v101
    v_add_f32 v102, v102, v90
    v_add_f32 v94, v94, v98
    v_add_f32 v102, v102, v94
    v_accvgpr_write_b32 a14, v102
    v_add_f32 v103, v103, v91
    v_add_f32 v95, v95, v99
    v_add_f32 v103, v103, v95
    v_accvgpr_write_b32 a15, v103
    ds_read_b128 v[88:91], v5 offset:4096
    ds_read_b128 v[92:95], v5 offset:24576
    ds_read_b128 v[96:99], v5 offset:45056
    s_waitcnt lgkmcnt(0)
    v_accvgpr_read_b32 v100, a16
    v_accvgpr_read_b32 v101, a17
    v_accvgpr_read_b32 v102, a18
    v_accvgpr_read_b32 v103, a19
    v_add_f32 v100, v100, v88
    v_add_f32 v92, v92, v96
    v_add_f32 v100, v100, v92
    v_accvgpr_write_b32 a16, v100
    v_add_f32 v101, v101, v89
    v_add_f32 v93, v93, v97
    v_add_f32 v101, v101, v93
    v_accvgpr_write_b32 a17, v101
    v_add_f32 v102, v102, v90
    v_add_f32 v94, v94, v98
    v_add_f32 v102, v102, v94
    v_accvgpr_write_b32 a18, v102
    v_add_f32 v103, v103, v91
    v_add_f32 v95, v95, v99
    v_add_f32 v103, v103, v95
    v_accvgpr_write_b32 a19, v103
    ds_read_b128 v[88:91], v5 offset:5120
    ds_read_b128 v[92:95], v5 offset:25600
    ds_read_b128 v[96:99], v5 offset:46080
    s_waitcnt lgkmcnt(0)
    v_accvgpr_read_b32 v100, a20
    v_accvgpr_read_b32 v101, a21
    v_accvgpr_read_b32 v102, a22
    v_accvgpr_read_b32 v103, a23
    v_add_f32 v100, v100, v88
    v_add_f32 v92, v92, v96
    v_add_f32 v100, v100, v92
    v_accvgpr_write_b32 a20, v100
    v_add_f32 v101, v101, v89
    v_add_f32 v93, v93, v97
    v_add_f32 v101, v101, v93
    v_accvgpr_write_b32 a21, v101
    v_add_f32 v102, v102, v90
    v_add_f32 v94, v94, v98
    v_add_f32 v102, v102, v94
    v_accvgpr_write_b32 a22, v102
    v_add_f32 v103, v103, v91
    v_add_f32 v95, v95, v99
    v_add_f32 v103, v103, v95
    v_accvgpr_write_b32 a23, v103
    ds_read_b128 v[88:91], v5 offset:6144
    ds_read_b128 v[92:95], v5 offset:26624
    ds_read_b128 v[96:99], v5 offset:47104
    s_waitcnt lgkmcnt(0)
    v_accvgpr_read_b32 v100, a24
    v_accvgpr_read_b32 v101, a25
    v_accvgpr_read_b32 v102, a26
    v_accvgpr_read_b32 v103, a27
    v_add_f32 v100, v100, v88
    v_add_f32 v92, v92, v96
    v_add_f32 v100, v100, v92
    v_accvgpr_write_b32 a24, v100
    v_add_f32 v101, v101, v89
    v_add_f32 v93, v93, v97
    v_add_f32 v101, v101, v93
    v_accvgpr_write_b32 a25, v101
    v_add_f32 v102, v102, v90
    v_add_f32 v94, v94, v98
    v_add_f32 v102, v102, v94
    v_accvgpr_write_b32 a26, v102
    v_add_f32 v103, v103, v91
    v_add_f32 v95, v95, v99
    v_add_f32 v103, v103, v95
    v_accvgpr_write_b32 a27, v103
    ds_read_b128 v[88:91], v5 offset:7168
    ds_read_b128 v[92:95], v5 offset:27648
    ds_read_b128 v[96:99], v5 offset:48128
    s_waitcnt lgkmcnt(0)
    v_accvgpr_read_b32 v100, a28
    v_accvgpr_read_b32 v101, a29
    v_accvgpr_read_b32 v102, a30
    v_accvgpr_read_b32 v103, a31
    v_add_f32 v100, v100, v88
    v_add_f32 v92, v92, v96
    v_add_f32 v100, v100, v92
    v_accvgpr_write_b32 a28, v100
    v_add_f32 v101, v101, v89
    v_add_f32 v93, v93, v97
    v_add_f32 v101, v101, v93
    v_accvgpr_write_b32 a29, v101
    v_add_f32 v102, v102, v90
    v_add_f32 v94, v94, v98
    v_add_f32 v102, v102, v94
    v_accvgpr_write_b32 a30, v102
    v_add_f32 v103, v103, v91
    v_add_f32 v95, v95, v99
    v_add_f32 v103, v103, v95
    v_accvgpr_write_b32 a31, v103
    ds_read_b128 v[88:91], v5 offset:8192
    ds_read_b128 v[92:95], v5 offset:28672
    ds_read_b128 v[96:99], v5 offset:49152
    s_waitcnt lgkmcnt(0)
    v_accvgpr_read_b32 v100, a32
    v_accvgpr_read_b32 v101, a33
    v_accvgpr_read_b32 v102, a34
    v_accvgpr_read_b32 v103, a35
    v_add_f32 v100, v100, v88
    v_add_f32 v92, v92, v96
    v_add_f32 v100, v100, v92
    v_accvgpr_write_b32 a32, v100
    v_add_f32 v101, v101, v89
    v_add_f32 v93, v93, v97
    v_add_f32 v101, v101, v93
    v_accvgpr_write_b32 a33, v101
    v_add_f32 v102, v102, v90
    v_add_f32 v94, v94, v98
    v_add_f32 v102, v102, v94
    v_accvgpr_write_b32 a34, v102
    v_add_f32 v103, v103, v91
    v_add_f32 v95, v95, v99
    v_add_f32 v103, v103, v95
    v_accvgpr_write_b32 a35, v103
    ds_read_b128 v[88:91], v5 offset:9216
    ds_read_b128 v[92:95], v5 offset:29696
    ds_read_b128 v[96:99], v5 offset:50176
    s_waitcnt lgkmcnt(0)
    v_accvgpr_read_b32 v100, a36
    v_accvgpr_read_b32 v101, a37
    v_accvgpr_read_b32 v102, a38
    v_accvgpr_read_b32 v103, a39
    v_add_f32 v100, v100, v88
    v_add_f32 v92, v92, v96
    v_add_f32 v100, v100, v92
    v_accvgpr_write_b32 a36, v100
    v_add_f32 v101, v101, v89
    v_add_f32 v93, v93, v97
    v_add_f32 v101, v101, v93
    v_accvgpr_write_b32 a37, v101
    v_add_f32 v102, v102, v90
    v_add_f32 v94, v94, v98
    v_add_f32 v102, v102, v94
    v_accvgpr_write_b32 a38, v102
    v_add_f32 v103, v103, v91
    v_add_f32 v95, v95, v99
    v_add_f32 v103, v103, v95
    v_accvgpr_write_b32 a39, v103
    ds_read_b128 v[88:91], v5 offset:10240
    ds_read_b128 v[92:95], v5 offset:30720
    ds_read_b128 v[96:99], v5 offset:51200
    s_waitcnt lgkmcnt(0)
    v_accvgpr_read_b32 v100, a40
    v_accvgpr_read_b32 v101, a41
    v_accvgpr_read_b32 v102, a42
    v_accvgpr_read_b32 v103, a43
    v_add_f32 v100, v100, v88
    v_add_f32 v92, v92, v96
    v_add_f32 v100, v100, v92
    v_accvgpr_write_b32 a40, v100
    v_add_f32 v101, v101, v89
    v_add_f32 v93, v93, v97
    v_add_f32 v101, v101, v93
    v_accvgpr_write_b32 a41, v101
    v_add_f32 v102, v102, v90
    v_add_f32 v94, v94, v98
    v_add_f32 v102, v102, v94
    v_accvgpr_write_b32 a42, v102
    v_add_f32 v103, v103, v91
    v_add_f32 v95, v95, v99
    v_add_f32 v103, v103, v95
    v_accvgpr_write_b32 a43, v103
    ds_read_b128 v[88:91], v5 offset:11264
    ds_read_b128 v[92:95], v5 offset:31744
    ds_read_b128 v[96:99], v5 offset:52224
    s_waitcnt lgkmcnt(0)
    v_accvgpr_read_b32 v100, a44
    v_accvgpr_read_b32 v101, a45
    v_accvgpr_read_b32 v102, a46
    v_accvgpr_read_b32 v103, a47
    v_add_f32 v100, v100, v88
    v_add_f32 v92, v92, v96
    v_add_f32 v100, v100, v92
    v_accvgpr_write_b32 a44, v100
    v_add_f32 v101, v101, v89
    v_add_f32 v93, v93, v97
    v_add_f32 v101, v101, v93
    v_accvgpr_write_b32 a45, v101
    v_add_f32 v102, v102, v90
    v_add_f32 v94, v94, v98
    v_add_f32 v102, v102, v94
    v_accvgpr_write_b32 a46, v102
    v_add_f32 v103, v103, v91
    v_add_f32 v95, v95, v99
    v_add_f32 v103, v103, v95
    v_accvgpr_write_b32 a47, v103
    ds_read_b128 v[88:91], v5 offset:12288
    ds_read_b128 v[92:95], v5 offset:32768
    ds_read_b128 v[96:99], v5 offset:53248
    s_waitcnt lgkmcnt(0)
    v_accvgpr_read_b32 v100, a48
    v_accvgpr_read_b32 v101, a49
    v_accvgpr_read_b32 v102, a50
    v_accvgpr_read_b32 v103, a51
    v_add_f32 v100, v100, v88
    v_add_f32 v92, v92, v96
    v_add_f32 v100, v100, v92
    v_accvgpr_write_b32 a48, v100
    v_add_f32 v101, v101, v89
    v_add_f32 v93, v93, v97
    v_add_f32 v101, v101, v93
    v_accvgpr_write_b32 a49, v101
    v_add_f32 v102, v102, v90
    v_add_f32 v94, v94, v98
    v_add_f32 v102, v102, v94
    v_accvgpr_write_b32 a50, v102
    v_add_f32 v103, v103, v91
    v_add_f32 v95, v95, v99
    v_add_f32 v103, v103, v95
    v_accvgpr_write_b32 a51, v103
    ds_read_b128 v[88:91], v5 offset:13312
    ds_read_b128 v[92:95], v5 offset:33792
    ds_read_b128 v[96:99], v5 offset:54272
    s_waitcnt lgkmcnt(0)
    v_accvgpr_read_b32 v100, a52
    v_accvgpr_read_b32 v101, a53
    v_accvgpr_read_b32 v102, a54
    v_accvgpr_read_b32 v103, a55
    v_add_f32 v100, v100, v88
    v_add_f32 v92, v92, v96
    v_add_f32 v100, v100, v92
    v_accvgpr_write_b32 a52, v100
    v_add_f32 v101, v101, v89
    v_add_f32 v93, v93, v97
    v_add_f32 v101, v101, v93
    v_accvgpr_write_b32 a53, v101
    v_add_f32 v102, v102, v90
    v_add_f32 v94, v94, v98
    v_add_f32 v102, v102, v94
    v_accvgpr_write_b32 a54, v102
    v_add_f32 v103, v103, v91
    v_add_f32 v95, v95, v99
    v_add_f32 v103, v103, v95
    v_accvgpr_write_b32 a55, v103
    ds_read_b128 v[88:91], v5 offset:14336
    ds_read_b128 v[92:95], v5 offset:34816
    ds_read_b128 v[96:99], v5 offset:55296
    s_waitcnt lgkmcnt(0)
    v_accvgpr_read_b32 v100, a56
    v_accvgpr_read_b32 v101, a57
    v_accvgpr_read_b32 v102, a58
    v_accvgpr_read_b32 v103, a59
    v_add_f32 v100, v100, v88
    v_add_f32 v92, v92, v96
    v_add_f32 v100, v100, v92
    v_accvgpr_write_b32 a56, v100
    v_add_f32 v101, v101, v89
    v_add_f32 v93, v93, v97
    v_add_f32 v101, v101, v93
    v_accvgpr_write_b32 a57, v101
    v_add_f32 v102, v102, v90
    v_add_f32 v94, v94, v98
    v_add_f32 v102, v102, v94
    v_accvgpr_write_b32 a58, v102
    v_add_f32 v103, v103, v91
    v_add_f32 v95, v95, v99
    v_add_f32 v103, v103, v95
    v_accvgpr_write_b32 a59, v103
    ds_read_b128 v[88:91], v5 offset:15360
    ds_read_b128 v[92:95], v5 offset:35840
    ds_read_b128 v[96:99], v5 offset:56320
    s_waitcnt lgkmcnt(0)
    v_accvgpr_read_b32 v100, a60
    v_accvgpr_read_b32 v101, a61
    v_accvgpr_read_b32 v102, a62
    v_accvgpr_read_b32 v103, a63
    v_add_f32 v100, v100, v88
    v_add_f32 v92, v92, v96
    v_add_f32 v100, v100, v92
    v_accvgpr_write_b32 a60, v100
    v_add_f32 v101, v101, v89
    v_add_f32 v93, v93, v97
    v_add_f32 v101, v101, v93
    v_accvgpr_write_b32 a61, v101
    v_add_f32 v102, v102, v90
    v_add_f32 v94, v94, v98
    v_add_f32 v102, v102, v94
    v_accvgpr_write_b32 a62, v102
    v_add_f32 v103, v103, v91
    v_add_f32 v95, v95, v99
    v_add_f32 v103, v103, v95
    v_accvgpr_write_b32 a63, v103
    ds_read_b128 v[88:91], v5 offset:16384
    ds_read_b128 v[92:95], v5 offset:36864
    ds_read_b128 v[96:99], v5 offset:57344
    s_waitcnt lgkmcnt(0)
    v_accvgpr_read_b32 v100, a64
    v_accvgpr_read_b32 v101, a65
    v_accvgpr_read_b32 v102, a66
    v_accvgpr_read_b32 v103, a67
    v_add_f32 v100, v100, v88
    v_add_f32 v92, v92, v96
    v_add_f32 v100, v100, v92
    v_accvgpr_write_b32 a64, v100
    v_add_f32 v101, v101, v89
    v_add_f32 v93, v93, v97
    v_add_f32 v101, v101, v93
    v_accvgpr_write_b32 a65, v101
    v_add_f32 v102, v102, v90
    v_add_f32 v94, v94, v98
    v_add_f32 v102, v102, v94
    v_accvgpr_write_b32 a66, v102
    v_add_f32 v103, v103, v91
    v_add_f32 v95, v95, v99
    v_add_f32 v103, v103, v95
    v_accvgpr_write_b32 a67, v103
    ds_read_b128 v[88:91], v5 offset:17408
    ds_read_b128 v[92:95], v5 offset:37888
    ds_read_b128 v[96:99], v5 offset:58368
    s_waitcnt lgkmcnt(0)
    v_accvgpr_read_b32 v100, a68
    v_accvgpr_read_b32 v101, a69
    v_accvgpr_read_b32 v102, a70
    v_accvgpr_read_b32 v103, a71
    v_add_f32 v100, v100, v88
    v_add_f32 v92, v92, v96
    v_add_f32 v100, v100, v92
    v_accvgpr_write_b32 a68, v100
    v_add_f32 v101, v101, v89
    v_add_f32 v93, v93, v97
    v_add_f32 v101, v101, v93
    v_accvgpr_write_b32 a69, v101
    v_add_f32 v102, v102, v90
    v_add_f32 v94, v94, v98
    v_add_f32 v102, v102, v94
    v_accvgpr_write_b32 a70, v102
    v_add_f32 v103, v103, v91
    v_add_f32 v95, v95, v99
    v_add_f32 v103, v103, v95
    v_accvgpr_write_b32 a71, v103
    ds_read_b128 v[88:91], v5 offset:18432
    ds_read_b128 v[92:95], v5 offset:38912
    ds_read_b128 v[96:99], v5 offset:59392
    s_waitcnt lgkmcnt(0)
    v_accvgpr_read_b32 v100, a72
    v_accvgpr_read_b32 v101, a73
    v_accvgpr_read_b32 v102, a74
    v_accvgpr_read_b32 v103, a75
    v_add_f32 v100, v100, v88
    v_add_f32 v92, v92, v96
    v_add_f32 v100, v100, v92
    v_accvgpr_write_b32 a72, v100
    v_add_f32 v101, v101, v89
    v_add_f32 v93, v93, v97
    v_add_f32 v101, v101, v93
    v_accvgpr_write_b32 a73, v101
    v_add_f32 v102, v102, v90
    v_add_f32 v94, v94, v98
    v_add_f32 v102, v102, v94
    v_accvgpr_write_b32 a74, v102
    v_add_f32 v103, v103, v91
    v_add_f32 v95, v95, v99
    v_add_f32 v103, v103, v95
    v_accvgpr_write_b32 a75, v103
    ds_read_b128 v[88:91], v5 offset:19456
    ds_read_b128 v[92:95], v5 offset:39936
    ds_read_b128 v[96:99], v5 offset:60416
    s_waitcnt lgkmcnt(0)
    v_accvgpr_read_b32 v100, a76
    v_accvgpr_read_b32 v101, a77
    v_accvgpr_read_b32 v102, a78
    v_accvgpr_read_b32 v103, a79
    v_add_f32 v100, v100, v88
    v_add_f32 v92, v92, v96
    v_add_f32 v100, v100, v92
    v_accvgpr_write_b32 a76, v100
    v_add_f32 v101, v101, v89
    v_add_f32 v93, v93, v97
    v_add_f32 v101, v101, v93
    v_accvgpr_write_b32 a77, v101
    v_add_f32 v102, v102, v90
    v_add_f32 v94, v94, v98
    v_add_f32 v102, v102, v94
    v_accvgpr_write_b32 a78, v102
    v_add_f32 v103, v103, v91
    v_add_f32 v95, v95, v99
    v_add_f32 v103, v103, v95
    v_accvgpr_write_b32 a79, v103
    s_nop 7
    s_nop 7
    s_mov_b32 s12, s6
    s_mov_b32 s13, s7
    s_mov_b32 s14, 2621440
    s_mov_b32 s15, 0x00020000
    s_mov_b32 s24, 1280
    v_add_u32 v5, s22, v3
    v_mul_lo_u32 v5, v5, s24
    v_lshlrev_b32 v6, 3, v4
    s_lshl_b32 s29, s23, 1
    v_add3_u32 v5, v5, v6, s29
    v_add_u32 v6, 4194304, v5
    buffer_load_dwordx2 v[88:89], v6, s[8:11], 0 offen
    v_accvgpr_read_b32 v92, a0
    v_accvgpr_read_b32 v93, a1
    v_accvgpr_read_b32 v94, a2
    v_accvgpr_read_b32 v95, a3
    v_cvt_pk_bf16_f32 v96, v92, v93
    v_cvt_pk_bf16_f32 v97, v94, v95
    s_waitcnt vmcnt(0)
    v_lshlrev_b32 v92, 16, v96
    v_and_b32 v93, 0xffff0000, v96
    v_lshlrev_b32 v98, 16, v88
    v_and_b32 v99, 0xffff0000, v88
    v_add_f32 v92, v92, v98
    v_add_f32 v93, v93, v99
    v_lshlrev_b32 v94, 16, v97
    v_and_b32 v95, 0xffff0000, v97
    v_lshlrev_b32 v98, 16, v89
    v_and_b32 v99, 0xffff0000, v89
    v_add_f32 v94, v94, v98
    v_add_f32 v95, v95, v99
    v_cvt_pk_bf16_f32 v96, v92, v93
    v_cvt_pk_bf16_f32 v97, v94, v95
    v_add_u32 v6, 0, v5
    buffer_store_dwordx2 v[96:97], v6, s[12:15], 0 offen
    v_add_u32 v6, 4194336, v5
    buffer_load_dwordx2 v[88:89], v6, s[8:11], 0 offen
    v_accvgpr_read_b32 v92, a4
    v_accvgpr_read_b32 v93, a5
    v_accvgpr_read_b32 v94, a6
    v_accvgpr_read_b32 v95, a7
    v_cvt_pk_bf16_f32 v96, v92, v93
    v_cvt_pk_bf16_f32 v97, v94, v95
    s_waitcnt vmcnt(0)
    v_lshlrev_b32 v92, 16, v96
    v_and_b32 v93, 0xffff0000, v96
    v_lshlrev_b32 v98, 16, v88
    v_and_b32 v99, 0xffff0000, v88
    v_add_f32 v92, v92, v98
    v_add_f32 v93, v93, v99
    v_lshlrev_b32 v94, 16, v97
    v_and_b32 v95, 0xffff0000, v97
    v_lshlrev_b32 v98, 16, v89
    v_and_b32 v99, 0xffff0000, v89
    v_add_f32 v94, v94, v98
    v_add_f32 v95, v95, v99
    v_cvt_pk_bf16_f32 v96, v92, v93
    v_cvt_pk_bf16_f32 v97, v94, v95
    v_add_u32 v6, 32, v5
    buffer_store_dwordx2 v[96:97], v6, s[12:15], 0 offen
    v_add_u32 v6, 4194368, v5
    buffer_load_dwordx2 v[88:89], v6, s[8:11], 0 offen
    v_accvgpr_read_b32 v92, a8
    v_accvgpr_read_b32 v93, a9
    v_accvgpr_read_b32 v94, a10
    v_accvgpr_read_b32 v95, a11
    v_cvt_pk_bf16_f32 v96, v92, v93
    v_cvt_pk_bf16_f32 v97, v94, v95
    s_waitcnt vmcnt(0)
    v_lshlrev_b32 v92, 16, v96
    v_and_b32 v93, 0xffff0000, v96
    v_lshlrev_b32 v98, 16, v88
    v_and_b32 v99, 0xffff0000, v88
    v_add_f32 v92, v92, v98
    v_add_f32 v93, v93, v99
    v_lshlrev_b32 v94, 16, v97
    v_and_b32 v95, 0xffff0000, v97
    v_lshlrev_b32 v98, 16, v89
    v_and_b32 v99, 0xffff0000, v89
    v_add_f32 v94, v94, v98
    v_add_f32 v95, v95, v99
    v_cvt_pk_bf16_f32 v96, v92, v93
    v_cvt_pk_bf16_f32 v97, v94, v95
    v_add_u32 v6, 64, v5
    buffer_store_dwordx2 v[96:97], v6, s[12:15], 0 offen
    v_add_u32 v6, 4194400, v5
    buffer_load_dwordx2 v[88:89], v6, s[8:11], 0 offen
    v_accvgpr_read_b32 v92, a12
    v_accvgpr_read_b32 v93, a13
    v_accvgpr_read_b32 v94, a14
    v_accvgpr_read_b32 v95, a15
    v_cvt_pk_bf16_f32 v96, v92, v93
    v_cvt_pk_bf16_f32 v97, v94, v95
    s_waitcnt vmcnt(0)
    v_lshlrev_b32 v92, 16, v96
    v_and_b32 v93, 0xffff0000, v96
    v_lshlrev_b32 v98, 16, v88
    v_and_b32 v99, 0xffff0000, v88
    v_add_f32 v92, v92, v98
    v_add_f32 v93, v93, v99
    v_lshlrev_b32 v94, 16, v97
    v_and_b32 v95, 0xffff0000, v97
    v_lshlrev_b32 v98, 16, v89
    v_and_b32 v99, 0xffff0000, v89
    v_add_f32 v94, v94, v98
    v_add_f32 v95, v95, v99
    v_cvt_pk_bf16_f32 v96, v92, v93
    v_cvt_pk_bf16_f32 v97, v94, v95
    v_add_u32 v6, 96, v5
    buffer_store_dwordx2 v[96:97], v6, s[12:15], 0 offen
    v_add_u32 v6, 4194432, v5
    buffer_load_dwordx2 v[88:89], v6, s[8:11], 0 offen
    v_accvgpr_read_b32 v92, a16
    v_accvgpr_read_b32 v93, a17
    v_accvgpr_read_b32 v94, a18
    v_accvgpr_read_b32 v95, a19
    v_cvt_pk_bf16_f32 v96, v92, v93
    v_cvt_pk_bf16_f32 v97, v94, v95
    s_waitcnt vmcnt(0)
    v_lshlrev_b32 v92, 16, v96
    v_and_b32 v93, 0xffff0000, v96
    v_lshlrev_b32 v98, 16, v88
    v_and_b32 v99, 0xffff0000, v88
    v_add_f32 v92, v92, v98
    v_add_f32 v93, v93, v99
    v_lshlrev_b32 v94, 16, v97
    v_and_b32 v95, 0xffff0000, v97
    v_lshlrev_b32 v98, 16, v89
    v_and_b32 v99, 0xffff0000, v89
    v_add_f32 v94, v94, v98
    v_add_f32 v95, v95, v99
    v_cvt_pk_bf16_f32 v96, v92, v93
    v_cvt_pk_bf16_f32 v97, v94, v95
    v_add_u32 v6, 128, v5
    buffer_store_dwordx2 v[96:97], v6, s[12:15], 0 offen
    v_add_u32 v6, 4214784, v5
    buffer_load_dwordx2 v[88:89], v6, s[8:11], 0 offen
    v_accvgpr_read_b32 v92, a20
    v_accvgpr_read_b32 v93, a21
    v_accvgpr_read_b32 v94, a22
    v_accvgpr_read_b32 v95, a23
    v_cvt_pk_bf16_f32 v96, v92, v93
    v_cvt_pk_bf16_f32 v97, v94, v95
    s_waitcnt vmcnt(0)
    v_lshlrev_b32 v92, 16, v96
    v_and_b32 v93, 0xffff0000, v96
    v_lshlrev_b32 v98, 16, v88
    v_and_b32 v99, 0xffff0000, v88
    v_add_f32 v92, v92, v98
    v_add_f32 v93, v93, v99
    v_lshlrev_b32 v94, 16, v97
    v_and_b32 v95, 0xffff0000, v97
    v_lshlrev_b32 v98, 16, v89
    v_and_b32 v99, 0xffff0000, v89
    v_add_f32 v94, v94, v98
    v_add_f32 v95, v95, v99
    v_cvt_pk_bf16_f32 v96, v92, v93
    v_cvt_pk_bf16_f32 v97, v94, v95
    v_add_u32 v6, 20480, v5
    buffer_store_dwordx2 v[96:97], v6, s[12:15], 0 offen
    v_add_u32 v6, 4214816, v5
    buffer_load_dwordx2 v[88:89], v6, s[8:11], 0 offen
    v_accvgpr_read_b32 v92, a24
    v_accvgpr_read_b32 v93, a25
    v_accvgpr_read_b32 v94, a26
    v_accvgpr_read_b32 v95, a27
    v_cvt_pk_bf16_f32 v96, v92, v93
    v_cvt_pk_bf16_f32 v97, v94, v95
    s_waitcnt vmcnt(0)
    v_lshlrev_b32 v92, 16, v96
    v_and_b32 v93, 0xffff0000, v96
    v_lshlrev_b32 v98, 16, v88
    v_and_b32 v99, 0xffff0000, v88
    v_add_f32 v92, v92, v98
    v_add_f32 v93, v93, v99
    v_lshlrev_b32 v94, 16, v97
    v_and_b32 v95, 0xffff0000, v97
    v_lshlrev_b32 v98, 16, v89
    v_and_b32 v99, 0xffff0000, v89
    v_add_f32 v94, v94, v98
    v_add_f32 v95, v95, v99
    v_cvt_pk_bf16_f32 v96, v92, v93
    v_cvt_pk_bf16_f32 v97, v94, v95
    v_add_u32 v6, 20512, v5
    buffer_store_dwordx2 v[96:97], v6, s[12:15], 0 offen
    v_add_u32 v6, 4214848, v5
    buffer_load_dwordx2 v[88:89], v6, s[8:11], 0 offen
    v_accvgpr_read_b32 v92, a28
    v_accvgpr_read_b32 v93, a29
    v_accvgpr_read_b32 v94, a30
    v_accvgpr_read_b32 v95, a31
    v_cvt_pk_bf16_f32 v96, v92, v93
    v_cvt_pk_bf16_f32 v97, v94, v95
    s_waitcnt vmcnt(0)
    v_lshlrev_b32 v92, 16, v96
    v_and_b32 v93, 0xffff0000, v96
    v_lshlrev_b32 v98, 16, v88
    v_and_b32 v99, 0xffff0000, v88
    v_add_f32 v92, v92, v98
    v_add_f32 v93, v93, v99
    v_lshlrev_b32 v94, 16, v97
    v_and_b32 v95, 0xffff0000, v97
    v_lshlrev_b32 v98, 16, v89
    v_and_b32 v99, 0xffff0000, v89
    v_add_f32 v94, v94, v98
    v_add_f32 v95, v95, v99
    v_cvt_pk_bf16_f32 v96, v92, v93
    v_cvt_pk_bf16_f32 v97, v94, v95
    v_add_u32 v6, 20544, v5
    buffer_store_dwordx2 v[96:97], v6, s[12:15], 0 offen
    v_add_u32 v6, 4214880, v5
    buffer_load_dwordx2 v[88:89], v6, s[8:11], 0 offen
    v_accvgpr_read_b32 v92, a32
    v_accvgpr_read_b32 v93, a33
    v_accvgpr_read_b32 v94, a34
    v_accvgpr_read_b32 v95, a35
    v_cvt_pk_bf16_f32 v96, v92, v93
    v_cvt_pk_bf16_f32 v97, v94, v95
    s_waitcnt vmcnt(0)
    v_lshlrev_b32 v92, 16, v96
    v_and_b32 v93, 0xffff0000, v96
    v_lshlrev_b32 v98, 16, v88
    v_and_b32 v99, 0xffff0000, v88
    v_add_f32 v92, v92, v98
    v_add_f32 v93, v93, v99
    v_lshlrev_b32 v94, 16, v97
    v_and_b32 v95, 0xffff0000, v97
    v_lshlrev_b32 v98, 16, v89
    v_and_b32 v99, 0xffff0000, v89
    v_add_f32 v94, v94, v98
    v_add_f32 v95, v95, v99
    v_cvt_pk_bf16_f32 v96, v92, v93
    v_cvt_pk_bf16_f32 v97, v94, v95
    v_add_u32 v6, 20576, v5
    buffer_store_dwordx2 v[96:97], v6, s[12:15], 0 offen
    v_add_u32 v6, 4214912, v5
    buffer_load_dwordx2 v[88:89], v6, s[8:11], 0 offen
    v_accvgpr_read_b32 v92, a36
    v_accvgpr_read_b32 v93, a37
    v_accvgpr_read_b32 v94, a38
    v_accvgpr_read_b32 v95, a39
    v_cvt_pk_bf16_f32 v96, v92, v93
    v_cvt_pk_bf16_f32 v97, v94, v95
    s_waitcnt vmcnt(0)
    v_lshlrev_b32 v92, 16, v96
    v_and_b32 v93, 0xffff0000, v96
    v_lshlrev_b32 v98, 16, v88
    v_and_b32 v99, 0xffff0000, v88
    v_add_f32 v92, v92, v98
    v_add_f32 v93, v93, v99
    v_lshlrev_b32 v94, 16, v97
    v_and_b32 v95, 0xffff0000, v97
    v_lshlrev_b32 v98, 16, v89
    v_and_b32 v99, 0xffff0000, v89
    v_add_f32 v94, v94, v98
    v_add_f32 v95, v95, v99
    v_cvt_pk_bf16_f32 v96, v92, v93
    v_cvt_pk_bf16_f32 v97, v94, v95
    v_add_u32 v6, 20608, v5
    buffer_store_dwordx2 v[96:97], v6, s[12:15], 0 offen
    v_add_u32 v6, 4235264, v5
    buffer_load_dwordx2 v[88:89], v6, s[8:11], 0 offen
    v_accvgpr_read_b32 v92, a40
    v_accvgpr_read_b32 v93, a41
    v_accvgpr_read_b32 v94, a42
    v_accvgpr_read_b32 v95, a43
    v_cvt_pk_bf16_f32 v96, v92, v93
    v_cvt_pk_bf16_f32 v97, v94, v95
    s_waitcnt vmcnt(0)
    v_lshlrev_b32 v92, 16, v96
    v_and_b32 v93, 0xffff0000, v96
    v_lshlrev_b32 v98, 16, v88
    v_and_b32 v99, 0xffff0000, v88
    v_add_f32 v92, v92, v98
    v_add_f32 v93, v93, v99
    v_lshlrev_b32 v94, 16, v97
    v_and_b32 v95, 0xffff0000, v97
    v_lshlrev_b32 v98, 16, v89
    v_and_b32 v99, 0xffff0000, v89
    v_add_f32 v94, v94, v98
    v_add_f32 v95, v95, v99
    v_cvt_pk_bf16_f32 v96, v92, v93
    v_cvt_pk_bf16_f32 v97, v94, v95
    v_add_u32 v6, 40960, v5
    buffer_store_dwordx2 v[96:97], v6, s[12:15], 0 offen
    v_add_u32 v6, 4235296, v5
    buffer_load_dwordx2 v[88:89], v6, s[8:11], 0 offen
    v_accvgpr_read_b32 v92, a44
    v_accvgpr_read_b32 v93, a45
    v_accvgpr_read_b32 v94, a46
    v_accvgpr_read_b32 v95, a47
    v_cvt_pk_bf16_f32 v96, v92, v93
    v_cvt_pk_bf16_f32 v97, v94, v95
    s_waitcnt vmcnt(0)
    v_lshlrev_b32 v92, 16, v96
    v_and_b32 v93, 0xffff0000, v96
    v_lshlrev_b32 v98, 16, v88
    v_and_b32 v99, 0xffff0000, v88
    v_add_f32 v92, v92, v98
    v_add_f32 v93, v93, v99
    v_lshlrev_b32 v94, 16, v97
    v_and_b32 v95, 0xffff0000, v97
    v_lshlrev_b32 v98, 16, v89
    v_and_b32 v99, 0xffff0000, v89
    v_add_f32 v94, v94, v98
    v_add_f32 v95, v95, v99
    v_cvt_pk_bf16_f32 v96, v92, v93
    v_cvt_pk_bf16_f32 v97, v94, v95
    v_add_u32 v6, 40992, v5
    buffer_store_dwordx2 v[96:97], v6, s[12:15], 0 offen
    v_add_u32 v6, 4235328, v5
    buffer_load_dwordx2 v[88:89], v6, s[8:11], 0 offen
    v_accvgpr_read_b32 v92, a48
    v_accvgpr_read_b32 v93, a49
    v_accvgpr_read_b32 v94, a50
    v_accvgpr_read_b32 v95, a51
    v_cvt_pk_bf16_f32 v96, v92, v93
    v_cvt_pk_bf16_f32 v97, v94, v95
    s_waitcnt vmcnt(0)
    v_lshlrev_b32 v92, 16, v96
    v_and_b32 v93, 0xffff0000, v96
    v_lshlrev_b32 v98, 16, v88
    v_and_b32 v99, 0xffff0000, v88
    v_add_f32 v92, v92, v98
    v_add_f32 v93, v93, v99
    v_lshlrev_b32 v94, 16, v97
    v_and_b32 v95, 0xffff0000, v97
    v_lshlrev_b32 v98, 16, v89
    v_and_b32 v99, 0xffff0000, v89
    v_add_f32 v94, v94, v98
    v_add_f32 v95, v95, v99
    v_cvt_pk_bf16_f32 v96, v92, v93
    v_cvt_pk_bf16_f32 v97, v94, v95
    v_add_u32 v6, 41024, v5
    buffer_store_dwordx2 v[96:97], v6, s[12:15], 0 offen
    v_add_u32 v6, 4235360, v5
    buffer_load_dwordx2 v[88:89], v6, s[8:11], 0 offen
    v_accvgpr_read_b32 v92, a52
    v_accvgpr_read_b32 v93, a53
    v_accvgpr_read_b32 v94, a54
    v_accvgpr_read_b32 v95, a55
    v_cvt_pk_bf16_f32 v96, v92, v93
    v_cvt_pk_bf16_f32 v97, v94, v95
    s_waitcnt vmcnt(0)
    v_lshlrev_b32 v92, 16, v96
    v_and_b32 v93, 0xffff0000, v96
    v_lshlrev_b32 v98, 16, v88
    v_and_b32 v99, 0xffff0000, v88
    v_add_f32 v92, v92, v98
    v_add_f32 v93, v93, v99
    v_lshlrev_b32 v94, 16, v97
    v_and_b32 v95, 0xffff0000, v97
    v_lshlrev_b32 v98, 16, v89
    v_and_b32 v99, 0xffff0000, v89
    v_add_f32 v94, v94, v98
    v_add_f32 v95, v95, v99
    v_cvt_pk_bf16_f32 v96, v92, v93
    v_cvt_pk_bf16_f32 v97, v94, v95
    v_add_u32 v6, 41056, v5
    buffer_store_dwordx2 v[96:97], v6, s[12:15], 0 offen
    v_add_u32 v6, 4235392, v5
    buffer_load_dwordx2 v[88:89], v6, s[8:11], 0 offen
    v_accvgpr_read_b32 v92, a56
    v_accvgpr_read_b32 v93, a57
    v_accvgpr_read_b32 v94, a58
    v_accvgpr_read_b32 v95, a59
    v_cvt_pk_bf16_f32 v96, v92, v93
    v_cvt_pk_bf16_f32 v97, v94, v95
    s_waitcnt vmcnt(0)
    v_lshlrev_b32 v92, 16, v96
    v_and_b32 v93, 0xffff0000, v96
    v_lshlrev_b32 v98, 16, v88
    v_and_b32 v99, 0xffff0000, v88
    v_add_f32 v92, v92, v98
    v_add_f32 v93, v93, v99
    v_lshlrev_b32 v94, 16, v97
    v_and_b32 v95, 0xffff0000, v97
    v_lshlrev_b32 v98, 16, v89
    v_and_b32 v99, 0xffff0000, v89
    v_add_f32 v94, v94, v98
    v_add_f32 v95, v95, v99
    v_cvt_pk_bf16_f32 v96, v92, v93
    v_cvt_pk_bf16_f32 v97, v94, v95
    v_add_u32 v6, 41088, v5
    buffer_store_dwordx2 v[96:97], v6, s[12:15], 0 offen
    v_add_u32 v6, 4255744, v5
    buffer_load_dwordx2 v[88:89], v6, s[8:11], 0 offen
    v_accvgpr_read_b32 v92, a60
    v_accvgpr_read_b32 v93, a61
    v_accvgpr_read_b32 v94, a62
    v_accvgpr_read_b32 v95, a63
    v_cvt_pk_bf16_f32 v96, v92, v93
    v_cvt_pk_bf16_f32 v97, v94, v95
    s_waitcnt vmcnt(0)
    v_lshlrev_b32 v92, 16, v96
    v_and_b32 v93, 0xffff0000, v96
    v_lshlrev_b32 v98, 16, v88
    v_and_b32 v99, 0xffff0000, v88
    v_add_f32 v92, v92, v98
    v_add_f32 v93, v93, v99
    v_lshlrev_b32 v94, 16, v97
    v_and_b32 v95, 0xffff0000, v97
    v_lshlrev_b32 v98, 16, v89
    v_and_b32 v99, 0xffff0000, v89
    v_add_f32 v94, v94, v98
    v_add_f32 v95, v95, v99
    v_cvt_pk_bf16_f32 v96, v92, v93
    v_cvt_pk_bf16_f32 v97, v94, v95
    v_add_u32 v6, 61440, v5
    buffer_store_dwordx2 v[96:97], v6, s[12:15], 0 offen
    v_add_u32 v6, 4255776, v5
    buffer_load_dwordx2 v[88:89], v6, s[8:11], 0 offen
    v_accvgpr_read_b32 v92, a64
    v_accvgpr_read_b32 v93, a65
    v_accvgpr_read_b32 v94, a66
    v_accvgpr_read_b32 v95, a67
    v_cvt_pk_bf16_f32 v96, v92, v93
    v_cvt_pk_bf16_f32 v97, v94, v95
    s_waitcnt vmcnt(0)
    v_lshlrev_b32 v92, 16, v96
    v_and_b32 v93, 0xffff0000, v96
    v_lshlrev_b32 v98, 16, v88
    v_and_b32 v99, 0xffff0000, v88
    v_add_f32 v92, v92, v98
    v_add_f32 v93, v93, v99
    v_lshlrev_b32 v94, 16, v97
    v_and_b32 v95, 0xffff0000, v97
    v_lshlrev_b32 v98, 16, v89
    v_and_b32 v99, 0xffff0000, v89
    v_add_f32 v94, v94, v98
    v_add_f32 v95, v95, v99
    v_cvt_pk_bf16_f32 v96, v92, v93
    v_cvt_pk_bf16_f32 v97, v94, v95
    v_add_u32 v6, 61472, v5
    buffer_store_dwordx2 v[96:97], v6, s[12:15], 0 offen
    v_add_u32 v6, 4255808, v5
    buffer_load_dwordx2 v[88:89], v6, s[8:11], 0 offen
    v_accvgpr_read_b32 v92, a68
    v_accvgpr_read_b32 v93, a69
    v_accvgpr_read_b32 v94, a70
    v_accvgpr_read_b32 v95, a71
    v_cvt_pk_bf16_f32 v96, v92, v93
    v_cvt_pk_bf16_f32 v97, v94, v95
    s_waitcnt vmcnt(0)
    v_lshlrev_b32 v92, 16, v96
    v_and_b32 v93, 0xffff0000, v96
    v_lshlrev_b32 v98, 16, v88
    v_and_b32 v99, 0xffff0000, v88
    v_add_f32 v92, v92, v98
    v_add_f32 v93, v93, v99
    v_lshlrev_b32 v94, 16, v97
    v_and_b32 v95, 0xffff0000, v97
    v_lshlrev_b32 v98, 16, v89
    v_and_b32 v99, 0xffff0000, v89
    v_add_f32 v94, v94, v98
    v_add_f32 v95, v95, v99
    v_cvt_pk_bf16_f32 v96, v92, v93
    v_cvt_pk_bf16_f32 v97, v94, v95
    v_add_u32 v6, 61504, v5
    buffer_store_dwordx2 v[96:97], v6, s[12:15], 0 offen
    v_add_u32 v6, 4255840, v5
    buffer_load_dwordx2 v[88:89], v6, s[8:11], 0 offen
    v_accvgpr_read_b32 v92, a72
    v_accvgpr_read_b32 v93, a73
    v_accvgpr_read_b32 v94, a74
    v_accvgpr_read_b32 v95, a75
    v_cvt_pk_bf16_f32 v96, v92, v93
    v_cvt_pk_bf16_f32 v97, v94, v95
    s_waitcnt vmcnt(0)
    v_lshlrev_b32 v92, 16, v96
    v_and_b32 v93, 0xffff0000, v96
    v_lshlrev_b32 v98, 16, v88
    v_and_b32 v99, 0xffff0000, v88
    v_add_f32 v92, v92, v98
    v_add_f32 v93, v93, v99
    v_lshlrev_b32 v94, 16, v97
    v_and_b32 v95, 0xffff0000, v97
    v_lshlrev_b32 v98, 16, v89
    v_and_b32 v99, 0xffff0000, v89
    v_add_f32 v94, v94, v98
    v_add_f32 v95, v95, v99
    v_cvt_pk_bf16_f32 v96, v92, v93
    v_cvt_pk_bf16_f32 v97, v94, v95
    v_add_u32 v6, 61536, v5
    buffer_store_dwordx2 v[96:97], v6, s[12:15], 0 offen
    v_add_u32 v6, 4255872, v5
    buffer_load_dwordx2 v[88:89], v6, s[8:11], 0 offen
    v_accvgpr_read_b32 v92, a76
    v_accvgpr_read_b32 v93, a77
    v_accvgpr_read_b32 v94, a78
    v_accvgpr_read_b32 v95, a79
    v_cvt_pk_bf16_f32 v96, v92, v93
    v_cvt_pk_bf16_f32 v97, v94, v95
    s_waitcnt vmcnt(0)
    v_lshlrev_b32 v92, 16, v96
    v_and_b32 v93, 0xffff0000, v96
    v_lshlrev_b32 v98, 16, v88
    v_and_b32 v99, 0xffff0000, v88
    v_add_f32 v92, v92, v98
    v_add_f32 v93, v93, v99
    v_lshlrev_b32 v94, 16, v97
    v_and_b32 v95, 0xffff0000, v97
    v_lshlrev_b32 v98, 16, v89
    v_and_b32 v99, 0xffff0000, v89
    v_add_f32 v94, v94, v98
    v_add_f32 v95, v95, v99
    v_cvt_pk_bf16_f32 v96, v92, v93
    v_cvt_pk_bf16_f32 v97, v94, v95
    v_add_u32 v6, 61568, v5
    buffer_store_dwordx2 v[96:97], v6, s[12:15], 0 offen
wo_b2_kernel_end:
    s_endpgm
.section .rodata,"a"
.p2align 6
.amdhsa_kernel wo_b2_kernel
  .amdhsa_next_free_vgpr 192
  .amdhsa_next_free_sgpr 64
  .amdhsa_accum_offset 112
  .amdhsa_group_segment_fixed_size 0
  .amdhsa_kernarg_size 104
  .amdhsa_user_sgpr_count 2
  .amdhsa_user_sgpr_kernarg_segment_ptr 1
  .amdhsa_system_sgpr_workgroup_id_x 1
.end_amdhsa_kernel
```

```asm
; @launch kernel=pack_kernel grid=(9840,1,1) block=(256,1,1) lds=0
; @launch kernel=ln_a1_kernel grid=(512,1,1) block=(256,1,1) lds=0
; @launch kernel=qkv_a_kernel grid=(192,1,1) block=(256,1,1) lds=0
; @launch kernel=kvz_a1_kernel grid=(128,1,1) block=(256,1,1) lds=0
; @launch kernel=attn_a1_kernel grid=(256,1,1) block=(256,1,1) lds=86016
; @launch kernel=wo_a1_kernel grid=(128,1,1) block=(256,1,1) lds=0
; @launch kernel=ln_b1_kernel grid=(512,1,1) block=(256,1,1) lds=0
; @launch kernel=qk_b_kernel grid=(512,1,1) block=(256,1,1) lds=0
; @launch kernel=vvo_kernel grid=(256,1,1) block=(256,1,1) lds=0
; @launch kernel=clr_kernel grid=(1042,1,1) block=(256,1,1) lds=0
; @launch kernel=chain1_kernel grid=(104,1,1) block=(256,1,1) lds=135168
; @launch kernel=ln_a2_kernel grid=(512,1,1) block=(256,1,1) lds=0
; @launch kernel=qkv_a_kernel grid=(192,1,1) block=(256,1,1) lds=0
; @launch kernel=kvz_a2_kernel grid=(128,1,1) block=(256,1,1) lds=0
; @launch kernel=attn_a2_kernel grid=(256,1,1) block=(256,1,1) lds=86016
; @launch kernel=wo_a2_kernel grid=(128,1,1) block=(256,1,1) lds=0
; @launch kernel=ln_b1_kernel grid=(512,1,1) block=(256,1,1) lds=0
; @launch kernel=qk_b_kernel grid=(512,1,1) block=(256,1,1) lds=0
; @launch kernel=vvo_kernel grid=(256,1,1) block=(256,1,1) lds=0
; @launch kernel=clr_kernel grid=(1042,1,1) block=(256,1,1) lds=0
; @launch kernel=chain2_kernel grid=(104,1,1) block=(256,1,1) lds=135168
.amdgcn_target "amdgcn-amd-amdhsa--gfx950"
.text
.globl pack_kernel
.p2align 8
.type pack_kernel,@function
pack_kernel:
    v_lshrrev_b32 v1, 6, v0
    v_and_b32 v2, 63, v0
    s_nop 0
    v_readfirstlane_b32 s3, v1
    s_lshl_b32 s4, s2, 2
    s_add_u32 s4, s4, s3
    s_load_dwordx2 s[6:7], s[0:1], 96
    s_waitcnt lgkmcnt(0)
    s_mov_b32 s8, s6
    s_mov_b32 s9, s7
    s_mov_b32 s10, 268435456
    s_mov_b32 s11, 0x00020000
    s_cmp_lt_u32 s4, 33920
    s_cbranch_scc1 pack_kernel_pk
    s_cmp_ge_u32 s4, 39360
    s_cbranch_scc1 pack_kernel_end
    s_sub_u32 s4, s4, 33920
    s_lshl_b32 s5, s4, 10
    v_lshlrev_b32 v3, 4, v2
    v_add_u32 v3, s5, v3
    v_add_u32 v4, 218103808, v3
    s_cmp_lt_u32 s5, 5308416
    s_cbranch_scc1 pack_kernel_clr
    v_add_u32 v4, 17760256, v3
pack_kernel_clr:
    v_mov_b32 v8, 0
    v_mov_b32 v9, 0
    v_mov_b32 v10, 0
    v_mov_b32 v11, 0
    buffer_store_dwordx4 v[8:11], v4, s[8:11], 0 offen
    s_branch pack_kernel_end
pack_kernel_pk:
    s_cmp_lt_u32 s4, 2400
    s_cbranch_scc0 pack_kernel_nx0
    s_sub_u32 s4, s4, 0
    s_load_dwordx2 s[12:13], s[0:1], 8
    s_mov_b32 s20, 1920
    s_mov_b32 s21, 20
    s_mov_b32 s22, 25165824
    s_mov_b32 s23, 2457600
    s_mul_i32 s24, s4, 1639
    s_lshr_b32 s24, s24, 15
    s_branch pack_kernel_go
pack_kernel_nx0:
    s_cmp_lt_u32 s4, 3200
    s_cbranch_scc0 pack_kernel_nx1
    s_sub_u32 s4, s4, 2400
    s_load_dwordx2 s[12:13], s[0:1], 16
    s_mov_b32 s20, 640
    s_mov_b32 s21, 20
    s_mov_b32 s22, 29360128
    s_mov_b32 s23, 819200
    s_mul_i32 s24, s4, 205
    s_lshr_b32 s24, s24, 12
    s_branch pack_kernel_go
pack_kernel_nx1:
    s_cmp_lt_u32 s4, 10880
    s_cbranch_scc0 pack_kernel_nx2
    s_sub_u32 s4, s4, 3200
    s_load_dwordx2 s[12:13], s[0:1], 40
    s_mov_b32 s20, 6144
    s_mov_b32 s21, 20
    s_mov_b32 s22, 33554432
    s_mov_b32 s23, 7864320
    s_mul_i32 s24, s4, 3277
    s_lshr_b32 s24, s24, 16
    s_branch pack_kernel_go
pack_kernel_nx2:
    s_cmp_lt_u32 s4, 18560
    s_cbranch_scc0 pack_kernel_nx3
    s_sub_u32 s4, s4, 10880
    s_load_dwordx2 s[12:13], s[0:1], 48
    s_mov_b32 s20, 6144
    s_mov_b32 s21, 20
    s_mov_b32 s22, 41418752
    s_mov_b32 s23, 7864320
    s_mul_i32 s24, s4, 3277
    s_lshr_b32 s24, s24, 16
    s_branch pack_kernel_go
pack_kernel_nx3:
    s_cmp_lt_u32 s4, 26240
    s_cbranch_scc0 pack_kernel_nx4
    s_sub_u32 s4, s4, 18560
    s_load_dwordx2 s[12:13], s[0:1], 56
    s_mov_b32 s20, 6144
    s_mov_b32 s21, 20
    s_mov_b32 s22, 49283072
    s_mov_b32 s23, 7864320
    s_mul_i32 s24, s4, 3277
    s_lshr_b32 s24, s24, 16
    s_branch pack_kernel_go
pack_kernel_nx4:
    s_cmp_lt_u32 s4, 33920
    s_cbranch_scc0 pack_kernel_nx5
    s_sub_u32 s4, s4, 26240
    s_load_dwordx2 s[12:13], s[0:1], 64
    s_mov_b32 s20, 640
    s_mov_b32 s21, 192
    s_mov_b32 s22, 58720256
    s_mov_b32 s23, 7864320
    s_mul_i32 s24, s4, 2731
    s_lshr_b32 s24, s24, 19
    s_branch pack_kernel_go
pack_kernel_nx5:
    s_branch pack_kernel_end
pack_kernel_go:
    s_waitcnt lgkmcnt(0)
    s_mov_b32 s16, s12
    s_mov_b32 s17, s13
    s_mov_b32 s18, s23
    s_mov_b32 s19, 0x00020000
    s_mul_i32 s25, s24, s21
    s_sub_u32 s25, s4, s25
    v_lshrrev_b32 v3, 4, v2
    v_lshlrev_b32 v3, 3, v3
    s_lshl_b32 s26, s25, 5
    v_add_u32 v3, s26, v3
    v_mul_lo_u32 v3, v3, s20
    v_and_b32 v4, 15, v2
    s_lshl_b32 s27, s24, 4
    v_add3_u32 v3, v3, v4, s27
    v_lshlrev_b32 v3, 1, v3
    s_lshl_b32 s28, s20, 1
    s_mov_b32 s29, 0
    buffer_load_ushort v12, v3, s[16:19], s29 offen
    s_add_u32 s29, s29, s28
    buffer_load_ushort v13, v3, s[16:19], s29 offen
    s_add_u32 s29, s29, s28
    buffer_load_ushort v14, v3, s[16:19], s29 offen
    s_add_u32 s29, s29, s28
    buffer_load_ushort v15, v3, s[16:19], s29 offen
    s_add_u32 s29, s29, s28
    buffer_load_ushort v16, v3, s[16:19], s29 offen
    s_add_u32 s29, s29, s28
    buffer_load_ushort v17, v3, s[16:19], s29 offen
    s_add_u32 s29, s29, s28
    buffer_load_ushort v18, v3, s[16:19], s29 offen
    s_add_u32 s29, s29, s28
    buffer_load_ushort v19, v3, s[16:19], s29 offen
    s_lshl_b32 s5, s4, 10
    s_add_u32 s5, s5, s22
    v_lshlrev_b32 v5, 4, v2
    v_add_u32 v5, s5, v5
    s_waitcnt vmcnt(0)
    v_lshl_or_b32 v8, v13, 16, v12
    v_lshl_or_b32 v9, v15, 16, v14
    v_lshl_or_b32 v10, v17, 16, v16
    v_lshl_or_b32 v11, v19, 16, v18
    buffer_store_dwordx4 v[8:11], v5, s[8:11], 0 offen
pack_kernel_end:
    s_endpgm
.section .rodata,"a"
.p2align 6
.amdhsa_kernel pack_kernel
  .amdhsa_next_free_vgpr 24
  .amdhsa_next_free_sgpr 40
  .amdhsa_accum_offset 24
  .amdhsa_group_segment_fixed_size 0
  .amdhsa_kernarg_size 104
  .amdhsa_user_sgpr_count 2
  .amdhsa_user_sgpr_kernarg_segment_ptr 1
  .amdhsa_system_sgpr_workgroup_id_x 1
.end_amdhsa_kernel
.text
.globl ln_a1_kernel
.p2align 8
.type ln_a1_kernel,@function
ln_a1_kernel:
    v_lshrrev_b32 v1, 6, v0
    v_and_b32 v2, 63, v0
    s_nop 0
    v_readfirstlane_b32 s3, v1
    s_lshl_b32 s4, s2, 2
    s_add_u32 s4, s4, s3
    s_cmp_ge_u32 s4, 2048
    s_cbranch_scc1 ln_a1_kernel_end
    s_load_dwordx2 s[6:7], s[0:1], 0
    s_load_dwordx2 s[12:13], s[0:1], 96
    s_waitcnt lgkmcnt(0)
    s_mov_b32 s8, s6
    s_mov_b32 s9, s7
    s_mov_b32 s10, 2621440
    s_mov_b32 s11, 0x00020000
    s_mov_b32 s16, s12
    s_mov_b32 s17, s13
    s_mov_b32 s18, 2621440
    s_mov_b32 s19, 0x00020000
    s_mul_i32 s5, s4, 1280
    v_lshlrev_b32 v3, 2, v2
    v_add_u32 v3, s5, v3
    buffer_load_dword v4, v3, s[8:11], 0 offen offset:0
    buffer_load_dword v5, v3, s[8:11], 0 offen offset:256
    buffer_load_dword v6, v3, s[8:11], 0 offen offset:512
    buffer_load_dword v7, v3, s[8:11], 0 offen offset:768
    buffer_load_dword v8, v3, s[8:11], 0 offen offset:1024
    s_waitcnt vmcnt(0)
    v_lshlrev_b32 v10, 16, v4
    v_and_b32 v11, 0xffff0000, v4
    v_lshlrev_b32 v12, 16, v5
    v_and_b32 v13, 0xffff0000, v5
    v_lshlrev_b32 v14, 16, v6
    v_and_b32 v15, 0xffff0000, v6
    v_lshlrev_b32 v16, 16, v7
    v_and_b32 v17, 0xffff0000, v7
    v_lshlrev_b32 v18, 16, v8
    v_and_b32 v19, 0xffff0000, v8
    v_add_f32 v20, v10, v11
    v_add_f32 v20, v20, v12
    v_add_f32 v20, v20, v13
    v_add_f32 v20, v20, v14
    v_add_f32 v20, v20, v15
    v_add_f32 v20, v20, v16
    v_add_f32 v20, v20, v17
    v_add_f32 v20, v20, v18
    v_add_f32 v20, v20, v19
    s_nop 1
    v_add_f32 v21, v20, v20 quad_perm:[1,0,3,2] row_mask:0xf bank_mask:0xf
    s_nop 1
    v_add_f32 v21, v21, v21 quad_perm:[2,3,0,1] row_mask:0xf bank_mask:0xf
    s_nop 1
    v_add_f32 v21, v21, v21 row_half_mirror row_mask:0xf bank_mask:0xf
    s_nop 1
    v_add_f32 v21, v21, v21 row_mirror row_mask:0xf bank_mask:0xf
    s_nop 1
    v_readlane_b32 s24, v21, 0
    v_readlane_b32 s25, v21, 16
    v_readlane_b32 s26, v21, 32
    v_readlane_b32 s27, v21, 48
    s_nop 1
    v_mov_b32 v20, s24
    v_add_f32 v20, s25, v20
    v_add_f32 v20, s26, v20
    v_add_f32 v20, s27, v20
    v_mul_f32 v20, 0.0015625, v20
    v_sub_f32 v10, v10, v20
    v_sub_f32 v11, v11, v20
    v_sub_f32 v12, v12, v20
    v_sub_f32 v13, v13, v20
    v_sub_f32 v14, v14, v20
    v_sub_f32 v15, v15, v20
    v_sub_f32 v16, v16, v20
    v_sub_f32 v17, v17, v20
    v_sub_f32 v18, v18, v20
    v_sub_f32 v19, v19, v20
    v_mul_f32 v21, v10, v10
    v_fmac_f32 v21, v11, v11
    v_fmac_f32 v21, v12, v12
    v_fmac_f32 v21, v13, v13
    v_fmac_f32 v21, v14, v14
    v_fmac_f32 v21, v15, v15
    v_fmac_f32 v21, v16, v16
    v_fmac_f32 v21, v17, v17
    v_fmac_f32 v21, v18, v18
    v_fmac_f32 v21, v19, v19
    s_nop 1
    v_add_f32 v22, v21, v21 quad_perm:[1,0,3,2] row_mask:0xf bank_mask:0xf
    s_nop 1
    v_add_f32 v22, v22, v22 quad_perm:[2,3,0,1] row_mask:0xf bank_mask:0xf
    s_nop 1
    v_add_f32 v22, v22, v22 row_half_mirror row_mask:0xf bank_mask:0xf
    s_nop 1
    v_add_f32 v22, v22, v22 row_mirror row_mask:0xf bank_mask:0xf
    s_nop 1
    v_readlane_b32 s24, v22, 0
    v_readlane_b32 s25, v22, 16
    v_readlane_b32 s26, v22, 32
    v_readlane_b32 s27, v22, 48
    s_nop 1
    v_mov_b32 v21, s24
    v_add_f32 v21, s25, v21
    v_add_f32 v21, s26, v21
    v_add_f32 v21, s27, v21
    v_mov_b32 v22, 0x3727c5ac
    v_fmac_f32 v22, 0.0015625, v21
    v_rsq_f32 v22, v22
    s_nop 0
    v_mul_f32 v10, v10, v22
    v_mul_f32 v11, v11, v22
    v_mul_f32 v12, v12, v22
    v_mul_f32 v13, v13, v22
    v_mul_f32 v14, v14, v22
    v_mul_f32 v15, v15, v22
    v_mul_f32 v16, v16, v22
    v_mul_f32 v17, v17, v22
    v_mul_f32 v18, v18, v22
    v_mul_f32 v19, v19, v22
    v_cvt_pk_bf16_f32 v4, v10, v11
    v_cvt_pk_bf16_f32 v5, v12, v13
    v_cvt_pk_bf16_f32 v6, v14, v15
    v_cvt_pk_bf16_f32 v7, v16, v17
    v_cvt_pk_bf16_f32 v8, v18, v19
    buffer_store_dword v4, v3, s[16:19], 0 offen offset:0
    buffer_store_dword v5, v3, s[16:19], 0 offen offset:256
    buffer_store_dword v6, v3, s[16:19], 0 offen offset:512
    buffer_store_dword v7, v3, s[16:19], 0 offen offset:768
    buffer_store_dword v8, v3, s[16:19], 0 offen offset:1024
ln_a1_kernel_end:
    s_endpgm
.section .rodata,"a"
.p2align 6
.amdhsa_kernel ln_a1_kernel
  .amdhsa_next_free_vgpr 32
  .amdhsa_next_free_sgpr 40
  .amdhsa_accum_offset 32
  .amdhsa_group_segment_fixed_size 0
  .amdhsa_kernarg_size 104
  .amdhsa_user_sgpr_count 2
  .amdhsa_user_sgpr_kernarg_segment_ptr 1
  .amdhsa_system_sgpr_workgroup_id_x 1
.end_amdhsa_kernel
.text
.globl qkv_a_kernel
.p2align 8
.type qkv_a_kernel,@function
qkv_a_kernel:
    v_lshrrev_b32 v1, 6, v0
    v_and_b32 v2, 63, v0
    s_nop 0
    v_readfirstlane_b32 s3, v1
    s_cmp_ge_u32 s2, 192
    s_cbranch_scc1 qkv_a_kernel_end
    s_load_dwordx2 s[4:5], s[0:1], 96
    s_load_dwordx2 s[6:7], s[0:1], 80
    s_mul_i32 s20, s2, 171
    s_lshr_b32 s20, s20, 12
    s_mul_i32 s21, s20, 24
    s_sub_u32 s21, s2, s21
    s_lshl_b32 s20, s20, 2
    s_add_u32 s20, s20, s3
    s_mul_i32 s22, s20, 64
    s_mul_i32 s23, s21, 80
    s_waitcnt lgkmcnt(0)
    s_mov_b32 s8, s4
    s_mov_b32 s9, s5
    s_mov_b32 s10, 268435456
    s_mov_b32 s11, 0x00020000
    v_and_b32 v3, 15, v2
    v_lshrrev_b32 v4, 4, v2
    s_mov_b32 s24, 1280
    v_add_u32 v5, s22, v3
    v_mul_lo_u32 v5, v5, s24
    v_lshlrev_b32 v6, 4, v4
    v_add_u32 v5, v5, v6
    v_add_u32 v5, 0, v5
    v_mov_b32 v8, v5
    v_add_u32 v9, 20480, v5
    v_add_u32 v10, 40960, v5
    v_add_u32 v11, 61440, v5
    v_lshlrev_b32 v7, 4, v2
    s_mov_b32 s25, 0
    s_mov_b32 s26, 0
    s_mul_i32 s27, s21, 102400
    s_add_u32 s27, s27, s26
    s_add_u32 s27, s27, 25165824
    s_add_u32 s32, s27, 0
    s_add_u32 s33, s27, 20480
    s_add_u32 s34, s27, 40960
    s_add_u32 s35, s27, 61440
    s_add_u32 s36, s27, 81920
    v_accvgpr_write_b32 a0, 0
    v_accvgpr_write_b32 a1, 0
    v_accvgpr_write_b32 a2, 0
    v_accvgpr_write_b32 a3, 0
    v_accvgpr_write_b32 a4, 0
    v_accvgpr_write_b32 a5, 0
    v_accvgpr_write_b32 a6, 0
    v_accvgpr_write_b32 a7, 0
    v_accvgpr_write_b32 a8, 0
    v_accvgpr_write_b32 a9, 0
    v_accvgpr_write_b32 a10, 0
    v_accvgpr_write_b32 a11, 0
    v_accvgpr_write_b32 a12, 0
    v_accvgpr_write_b32 a13, 0
    v_accvgpr_write_b32 a14, 0
    v_accvgpr_write_b32 a15, 0
    v_accvgpr_write_b32 a16, 0
    v_accvgpr_write_b32 a17, 0
    v_accvgpr_write_b32 a18, 0
    v_accvgpr_write_b32 a19, 0
    v_accvgpr_write_b32 a20, 0
    v_accvgpr_write_b32 a21, 0
    v_accvgpr_write_b32 a22, 0
    v_accvgpr_write_b32 a23, 0
    v_accvgpr_write_b32 a24, 0
    v_accvgpr_write_b32 a25, 0
    v_accvgpr_write_b32 a26, 0
    v_accvgpr_write_b32 a27, 0
    v_accvgpr_write_b32 a28, 0
    v_accvgpr_write_b32 a29, 0
    v_accvgpr_write_b32 a30, 0
    v_accvgpr_write_b32 a31, 0
    v_accvgpr_write_b32 a32, 0
    v_accvgpr_write_b32 a33, 0
    v_accvgpr_write_b32 a34, 0
    v_accvgpr_write_b32 a35, 0
    v_accvgpr_write_b32 a36, 0
    v_accvgpr_write_b32 a37, 0
    v_accvgpr_write_b32 a38, 0
    v_accvgpr_write_b32 a39, 0
    v_accvgpr_write_b32 a40, 0
    v_accvgpr_write_b32 a41, 0
    v_accvgpr_write_b32 a42, 0
    v_accvgpr_write_b32 a43, 0
    v_accvgpr_write_b32 a44, 0
    v_accvgpr_write_b32 a45, 0
    v_accvgpr_write_b32 a46, 0
    v_accvgpr_write_b32 a47, 0
    v_accvgpr_write_b32 a48, 0
    v_accvgpr_write_b32 a49, 0
    v_accvgpr_write_b32 a50, 0
    v_accvgpr_write_b32 a51, 0
    v_accvgpr_write_b32 a52, 0
    v_accvgpr_write_b32 a53, 0
    v_accvgpr_write_b32 a54, 0
    v_accvgpr_write_b32 a55, 0
    v_accvgpr_write_b32 a56, 0
    v_accvgpr_write_b32 a57, 0
    v_accvgpr_write_b32 a58, 0
    v_accvgpr_write_b32 a59, 0
    v_accvgpr_write_b32 a60, 0
    v_accvgpr_write_b32 a61, 0
    v_accvgpr_write_b32 a62, 0
    v_accvgpr_write_b32 a63, 0
    v_accvgpr_write_b32 a64, 0
    v_accvgpr_write_b32 a65, 0
    v_accvgpr_write_b32 a66, 0
    v_accvgpr_write_b32 a67, 0
    v_accvgpr_write_b32 a68, 0
    v_accvgpr_write_b32 a69, 0
    v_accvgpr_write_b32 a70, 0
    v_accvgpr_write_b32 a71, 0
    v_accvgpr_write_b32 a72, 0
    v_accvgpr_write_b32 a73, 0
    v_accvgpr_write_b32 a74, 0
    v_accvgpr_write_b32 a75, 0
    v_accvgpr_write_b32 a76, 0
    v_accvgpr_write_b32 a77, 0
    v_accvgpr_write_b32 a78, 0
    v_accvgpr_write_b32 a79, 0
    s_cmp_ge_u32 s23, 640
    s_cbranch_scc1 qkv_a_kernel_nrm
    buffer_load_dwordx4 v[16:19], v8, s[8:11], s25 offen
    buffer_load_dwordx4 v[20:23], v9, s[8:11], s25 offen
    buffer_load_dwordx4 v[24:27], v10, s[8:11], s25 offen
    buffer_load_dwordx4 v[28:31], v11, s[8:11], s25 offen
    buffer_load_dwordx4 v[32:35], v7, s[8:11], s32 offen
    buffer_load_dwordx4 v[36:39], v7, s[8:11], s33 offen
    buffer_load_dwordx4 v[40:43], v7, s[8:11], s34 offen
    buffer_load_dwordx4 v[44:47], v7, s[8:11], s35 offen
    buffer_load_dwordx4 v[48:51], v7, s[8:11], s36 offen
    s_mov_b32 s28, 10
qkv_a_kernel_loop0:
    s_add_u32 s25, s25, 64
    s_add_u32 s32, s32, 1024
    s_add_u32 s33, s33, 1024
    s_add_u32 s34, s34, 1024
    s_add_u32 s35, s35, 1024
    s_add_u32 s36, s36, 1024
    buffer_load_dwordx4 v[52:55], v8, s[8:11], s25 offen
    buffer_load_dwordx4 v[56:59], v9, s[8:11], s25 offen
    buffer_load_dwordx4 v[60:63], v10, s[8:11], s25 offen
    buffer_load_dwordx4 v[64:67], v11, s[8:11], s25 offen
    buffer_load_dwordx4 v[68:71], v7, s[8:11], s32 offen
    buffer_load_dwordx4 v[72:75], v7, s[8:11], s33 offen
    buffer_load_dwordx4 v[76:79], v7, s[8:11], s34 offen
    buffer_load_dwordx4 v[80:83], v7, s[8:11], s35 offen
    buffer_load_dwordx4 v[84:87], v7, s[8:11], s36 offen
    s_waitcnt vmcnt(9)
    v_mfma_f32_16x16x32_bf16 a[0:3], v[32:35], v[16:19], a[0:3]
    v_mfma_f32_16x16x32_bf16 a[20:23], v[32:35], v[20:23], a[20:23]
    v_mfma_f32_16x16x32_bf16 a[40:43], v[32:35], v[24:27], a[40:43]
    v_mfma_f32_16x16x32_bf16 a[60:63], v[32:35], v[28:31], a[60:63]
    v_mfma_f32_16x16x32_bf16 a[4:7], v[36:39], v[16:19], a[4:7]
    v_mfma_f32_16x16x32_bf16 a[24:27], v[36:39], v[20:23], a[24:27]
    v_mfma_f32_16x16x32_bf16 a[44:47], v[36:39], v[24:27], a[44:47]
    v_mfma_f32_16x16x32_bf16 a[64:67], v[36:39], v[28:31], a[64:67]
    v_mfma_f32_16x16x32_bf16 a[8:11], v[40:43], v[16:19], a[8:11]
    v_mfma_f32_16x16x32_bf16 a[28:31], v[40:43], v[20:23], a[28:31]
    v_mfma_f32_16x16x32_bf16 a[48:51], v[40:43], v[24:27], a[48:51]
    v_mfma_f32_16x16x32_bf16 a[68:71], v[40:43], v[28:31], a[68:71]
    v_mfma_f32_16x16x32_bf16 a[12:15], v[44:47], v[16:19], a[12:15]
    v_mfma_f32_16x16x32_bf16 a[32:35], v[44:47], v[20:23], a[32:35]
    v_mfma_f32_16x16x32_bf16 a[52:55], v[44:47], v[24:27], a[52:55]
    v_mfma_f32_16x16x32_bf16 a[72:75], v[44:47], v[28:31], a[72:75]
    v_mfma_f32_16x16x32_bf16 a[16:19], v[48:51], v[16:19], a[16:19]
    v_mfma_f32_16x16x32_bf16 a[36:39], v[48:51], v[20:23], a[36:39]
    v_mfma_f32_16x16x32_bf16 a[56:59], v[48:51], v[24:27], a[56:59]
    v_mfma_f32_16x16x32_bf16 a[76:79], v[48:51], v[28:31], a[76:79]
    s_sub_u32 s28, s28, 1
    s_cmp_eq_u32 s28, 0
    s_cbranch_scc1 qkv_a_kernel_loop0_last
    s_add_u32 s25, s25, 64
    s_add_u32 s32, s32, 1024
    s_add_u32 s33, s33, 1024
    s_add_u32 s34, s34, 1024
    s_add_u32 s35, s35, 1024
    s_add_u32 s36, s36, 1024
    buffer_load_dwordx4 v[16:19], v8, s[8:11], s25 offen
    buffer_load_dwordx4 v[20:23], v9, s[8:11], s25 offen
    buffer_load_dwordx4 v[24:27], v10, s[8:11], s25 offen
    buffer_load_dwordx4 v[28:31], v11, s[8:11], s25 offen
    buffer_load_dwordx4 v[32:35], v7, s[8:11], s32 offen
    buffer_load_dwordx4 v[36:39], v7, s[8:11], s33 offen
    buffer_load_dwordx4 v[40:43], v7, s[8:11], s34 offen
    buffer_load_dwordx4 v[44:47], v7, s[8:11], s35 offen
    buffer_load_dwordx4 v[48:51], v7, s[8:11], s36 offen
    s_waitcnt vmcnt(9)
    v_mfma_f32_16x16x32_bf16 a[0:3], v[68:71], v[52:55], a[0:3]
    v_mfma_f32_16x16x32_bf16 a[20:23], v[68:71], v[56:59], a[20:23]
    v_mfma_f32_16x16x32_bf16 a[40:43], v[68:71], v[60:63], a[40:43]
    v_mfma_f32_16x16x32_bf16 a[60:63], v[68:71], v[64:67], a[60:63]
    v_mfma_f32_16x16x32_bf16 a[4:7], v[72:75], v[52:55], a[4:7]
    v_mfma_f32_16x16x32_bf16 a[24:27], v[72:75], v[56:59], a[24:27]
    v_mfma_f32_16x16x32_bf16 a[44:47], v[72:75], v[60:63], a[44:47]
    v_mfma_f32_16x16x32_bf16 a[64:67], v[72:75], v[64:67], a[64:67]
    v_mfma_f32_16x16x32_bf16 a[8:11], v[76:79], v[52:55], a[8:11]
    v_mfma_f32_16x16x32_bf16 a[28:31], v[76:79], v[56:59], a[28:31]
    v_mfma_f32_16x16x32_bf16 a[48:51], v[76:79], v[60:63], a[48:51]
    v_mfma_f32_16x16x32_bf16 a[68:71], v[76:79], v[64:67], a[68:71]
    v_mfma_f32_16x16x32_bf16 a[12:15], v[80:83], v[52:55], a[12:15]
    v_mfma_f32_16x16x32_bf16 a[32:35], v[80:83], v[56:59], a[32:35]
    v_mfma_f32_16x16x32_bf16 a[52:55], v[80:83], v[60:63], a[52:55]
    v_mfma_f32_16x16x32_bf16 a[72:75], v[80:83], v[64:67], a[72:75]
    v_mfma_f32_16x16x32_bf16 a[16:19], v[84:87], v[52:55], a[16:19]
    v_mfma_f32_16x16x32_bf16 a[36:39], v[84:87], v[56:59], a[36:39]
    v_mfma_f32_16x16x32_bf16 a[56:59], v[84:87], v[60:63], a[56:59]
    v_mfma_f32_16x16x32_bf16 a[76:79], v[84:87], v[64:67], a[76:79]
    s_branch qkv_a_kernel_loop0
qkv_a_kernel_loop0_last:
    s_waitcnt vmcnt(0)
    v_mfma_f32_16x16x32_bf16 a[0:3], v[68:71], v[52:55], a[0:3]
    v_mfma_f32_16x16x32_bf16 a[20:23], v[68:71], v[56:59], a[20:23]
    v_mfma_f32_16x16x32_bf16 a[40:43], v[68:71], v[60:63], a[40:43]
    v_mfma_f32_16x16x32_bf16 a[60:63], v[68:71], v[64:67], a[60:63]
    v_mfma_f32_16x16x32_bf16 a[4:7], v[72:75], v[52:55], a[4:7]
    v_mfma_f32_16x16x32_bf16 a[24:27], v[72:75], v[56:59], a[24:27]
    v_mfma_f32_16x16x32_bf16 a[44:47], v[72:75], v[60:63], a[44:47]
    v_mfma_f32_16x16x32_bf16 a[64:67], v[72:75], v[64:67], a[64:67]
    v_mfma_f32_16x16x32_bf16 a[8:11], v[76:79], v[52:55], a[8:11]
    v_mfma_f32_16x16x32_bf16 a[28:31], v[76:79], v[56:59], a[28:31]
    v_mfma_f32_16x16x32_bf16 a[48:51], v[76:79], v[60:63], a[48:51]
    v_mfma_f32_16x16x32_bf16 a[68:71], v[76:79], v[64:67], a[68:71]
    v_mfma_f32_16x16x32_bf16 a[12:15], v[80:83], v[52:55], a[12:15]
    v_mfma_f32_16x16x32_bf16 a[32:35], v[80:83], v[56:59], a[32:35]
    v_mfma_f32_16x16x32_bf16 a[52:55], v[80:83], v[60:63], a[52:55]
    v_mfma_f32_16x16x32_bf16 a[72:75], v[80:83], v[64:67], a[72:75]
    v_mfma_f32_16x16x32_bf16 a[16:19], v[84:87], v[52:55], a[16:19]
    v_mfma_f32_16x16x32_bf16 a[36:39], v[84:87], v[56:59], a[36:39]
    v_mfma_f32_16x16x32_bf16 a[56:59], v[84:87], v[60:63], a[56:59]
    v_mfma_f32_16x16x32_bf16 a[76:79], v[84:87], v[64:67], a[76:79]
    s_nop 7
    s_nop 7
    s_mov_b32 s24, 1280
    s_lshl_b32 s29, s23, 1
    s_add_u32 s29, s29, 8388608
    v_add_u32 v5, s22, v3
    v_mul_lo_u32 v5, v5, s24
    v_lshlrev_b32 v6, 3, v4
    v_add3_u32 v5, v5, v6, s29
    v_accvgpr_read_b32 v92, a0
    v_accvgpr_read_b32 v93, a1
    v_accvgpr_read_b32 v94, a2
    v_accvgpr_read_b32 v95, a3
    v_cvt_pk_bf16_f32 v96, v92, v93
    v_cvt_pk_bf16_f32 v97, v94, v95
    v_add_u32 v6, 0, v5
    buffer_store_dwordx2 v[96:97], v6, s[8:11], 0 offen
    v_accvgpr_read_b32 v92, a4
    v_accvgpr_read_b32 v93, a5
    v_accvgpr_read_b32 v94, a6
    v_accvgpr_read_b32 v95, a7
    v_cvt_pk_bf16_f32 v96, v92, v93
    v_cvt_pk_bf16_f32 v97, v94, v95
    v_add_u32 v6, 32, v5
    buffer_store_dwordx2 v[96:97], v6, s[8:11], 0 offen
    v_accvgpr_read_b32 v92, a8
    v_accvgpr_read_b32 v93, a9
    v_accvgpr_read_b32 v94, a10
    v_accvgpr_read_b32 v95, a11
    v_cvt_pk_bf16_f32 v96, v92, v93
    v_cvt_pk_bf16_f32 v97, v94, v95
    v_add_u32 v6, 64, v5
    buffer_store_dwordx2 v[96:97], v6, s[8:11], 0 offen
    v_accvgpr_read_b32 v92, a12
    v_accvgpr_read_b32 v93, a13
    v_accvgpr_read_b32 v94, a14
    v_accvgpr_read_b32 v95, a15
    v_cvt_pk_bf16_f32 v96, v92, v93
    v_cvt_pk_bf16_f32 v97, v94, v95
    v_add_u32 v6, 96, v5
    buffer_store_dwordx2 v[96:97], v6, s[8:11], 0 offen
    v_accvgpr_read_b32 v92, a16
    v_accvgpr_read_b32 v93, a17
    v_accvgpr_read_b32 v94, a18
    v_accvgpr_read_b32 v95, a19
    v_cvt_pk_bf16_f32 v96, v92, v93
    v_cvt_pk_bf16_f32 v97, v94, v95
    v_add_u32 v6, 128, v5
    buffer_store_dwordx2 v[96:97], v6, s[8:11], 0 offen
    v_accvgpr_read_b32 v92, a20
    v_accvgpr_read_b32 v93, a21
    v_accvgpr_read_b32 v94, a22
    v_accvgpr_read_b32 v95, a23
    v_cvt_pk_bf16_f32 v96, v92, v93
    v_cvt_pk_bf16_f32 v97, v94, v95
    v_add_u32 v6, 20480, v5
    buffer_store_dwordx2 v[96:97], v6, s[8:11], 0 offen
    v_accvgpr_read_b32 v92, a24
    v_accvgpr_read_b32 v93, a25
    v_accvgpr_read_b32 v94, a26
    v_accvgpr_read_b32 v95, a27
    v_cvt_pk_bf16_f32 v96, v92, v93
    v_cvt_pk_bf16_f32 v97, v94, v95
    v_add_u32 v6, 20512, v5
    buffer_store_dwordx2 v[96:97], v6, s[8:11], 0 offen
    v_accvgpr_read_b32 v92, a28
    v_accvgpr_read_b32 v93, a29
    v_accvgpr_read_b32 v94, a30
    v_accvgpr_read_b32 v95, a31
    v_cvt_pk_bf16_f32 v96, v92, v93
    v_cvt_pk_bf16_f32 v97, v94, v95
    v_add_u32 v6, 20544, v5
    buffer_store_dwordx2 v[96:97], v6, s[8:11], 0 offen
    v_accvgpr_read_b32 v92, a32
    v_accvgpr_read_b32 v93, a33
    v_accvgpr_read_b32 v94, a34
    v_accvgpr_read_b32 v95, a35
    v_cvt_pk_bf16_f32 v96, v92, v93
    v_cvt_pk_bf16_f32 v97, v94, v95
    v_add_u32 v6, 20576, v5
    buffer_store_dwordx2 v[96:97], v6, s[8:11], 0 offen
    v_accvgpr_read_b32 v92, a36
    v_accvgpr_read_b32 v93, a37
    v_accvgpr_read_b32 v94, a38
    v_accvgpr_read_b32 v95, a39
    v_cvt_pk_bf16_f32 v96, v92, v93
    v_cvt_pk_bf16_f32 v97, v94, v95
    v_add_u32 v6, 20608, v5
    buffer_store_dwordx2 v[96:97], v6, s[8:11], 0 offen
    v_accvgpr_read_b32 v92, a40
    v_accvgpr_read_b32 v93, a41
    v_accvgpr_read_b32 v94, a42
    v_accvgpr_read_b32 v95, a43
    v_cvt_pk_bf16_f32 v96, v92, v93
    v_cvt_pk_bf16_f32 v97, v94, v95
    v_add_u32 v6, 40960, v5
    buffer_store_dwordx2 v[96:97], v6, s[8:11], 0 offen
    v_accvgpr_read_b32 v92, a44
    v_accvgpr_read_b32 v93, a45
    v_accvgpr_read_b32 v94, a46
    v_accvgpr_read_b32 v95, a47
    v_cvt_pk_bf16_f32 v96, v92, v93
    v_cvt_pk_bf16_f32 v97, v94, v95
    v_add_u32 v6, 40992, v5
    buffer_store_dwordx2 v[96:97], v6, s[8:11], 0 offen
    v_accvgpr_read_b32 v92, a48
    v_accvgpr_read_b32 v93, a49
    v_accvgpr_read_b32 v94, a50
    v_accvgpr_read_b32 v95, a51
    v_cvt_pk_bf16_f32 v96, v92, v93
    v_cvt_pk_bf16_f32 v97, v94, v95
    v_add_u32 v6, 41024, v5
    buffer_store_dwordx2 v[96:97], v6, s[8:11], 0 offen
    v_accvgpr_read_b32 v92, a52
    v_accvgpr_read_b32 v93, a53
    v_accvgpr_read_b32 v94, a54
    v_accvgpr_read_b32 v95, a55
    v_cvt_pk_bf16_f32 v96, v92, v93
    v_cvt_pk_bf16_f32 v97, v94, v95
    v_add_u32 v6, 41056, v5
    buffer_store_dwordx2 v[96:97], v6, s[8:11], 0 offen
    v_accvgpr_read_b32 v92, a56
    v_accvgpr_read_b32 v93, a57
    v_accvgpr_read_b32 v94, a58
    v_accvgpr_read_b32 v95, a59
    v_cvt_pk_bf16_f32 v96, v92, v93
    v_cvt_pk_bf16_f32 v97, v94, v95
    v_add_u32 v6, 41088, v5
    buffer_store_dwordx2 v[96:97], v6, s[8:11], 0 offen
    v_accvgpr_read_b32 v92, a60
    v_accvgpr_read_b32 v93, a61
    v_accvgpr_read_b32 v94, a62
    v_accvgpr_read_b32 v95, a63
    v_cvt_pk_bf16_f32 v96, v92, v93
    v_cvt_pk_bf16_f32 v97, v94, v95
    v_add_u32 v6, 61440, v5
    buffer_store_dwordx2 v[96:97], v6, s[8:11], 0 offen
    v_accvgpr_read_b32 v92, a64
    v_accvgpr_read_b32 v93, a65
    v_accvgpr_read_b32 v94, a66
    v_accvgpr_read_b32 v95, a67
    v_cvt_pk_bf16_f32 v96, v92, v93
    v_cvt_pk_bf16_f32 v97, v94, v95
    v_add_u32 v6, 61472, v5
    buffer_store_dwordx2 v[96:97], v6, s[8:11], 0 offen
    v_accvgpr_read_b32 v92, a68
    v_accvgpr_read_b32 v93, a69
    v_accvgpr_read_b32 v94, a70
    v_accvgpr_read_b32 v95, a71
    v_cvt_pk_bf16_f32 v96, v92, v93
    v_cvt_pk_bf16_f32 v97, v94, v95
    v_add_u32 v6, 61504, v5
    buffer_store_dwordx2 v[96:97], v6, s[8:11], 0 offen
    v_accvgpr_read_b32 v92, a72
    v_accvgpr_read_b32 v93, a73
    v_accvgpr_read_b32 v94, a74
    v_accvgpr_read_b32 v95, a75
    v_cvt_pk_bf16_f32 v96, v92, v93
    v_cvt_pk_bf16_f32 v97, v94, v95
    v_add_u32 v6, 61536, v5
    buffer_store_dwordx2 v[96:97], v6, s[8:11], 0 offen
    v_accvgpr_read_b32 v92, a76
    v_accvgpr_read_b32 v93, a77
    v_accvgpr_read_b32 v94, a78
    v_accvgpr_read_b32 v95, a79
    v_cvt_pk_bf16_f32 v96, v92, v93
    v_cvt_pk_bf16_f32 v97, v94, v95
    v_add_u32 v6, 61568, v5
    buffer_store_dwordx2 v[96:97], v6, s[8:11], 0 offen
    s_branch qkv_a_kernel_end
qkv_a_kernel_nrm:
    buffer_load_dwordx4 v[16:19], v8, s[8:11], s25 offen
    buffer_load_dwordx4 v[20:23], v9, s[8:11], s25 offen
    buffer_load_dwordx4 v[24:27], v10, s[8:11], s25 offen
    buffer_load_dwordx4 v[28:31], v11, s[8:11], s25 offen
    buffer_load_dwordx4 v[32:35], v7, s[8:11], s32 offen
    buffer_load_dwordx4 v[36:39], v7, s[8:11], s33 offen
    buffer_load_dwordx4 v[40:43], v7, s[8:11], s34 offen
    buffer_load_dwordx4 v[44:47], v7, s[8:11], s35 offen
    buffer_load_dwordx4 v[48:51], v7, s[8:11], s36 offen
    s_mov_b32 s28, 10
qkv_a_kernel_loop1:
    s_add_u32 s25, s25, 64
    s_add_u32 s32, s32, 1024
    s_add_u32 s33, s33, 1024
    s_add_u32 s34, s34, 1024
    s_add_u32 s35, s35, 1024
    s_add_u32 s36, s36, 1024
    buffer_load_dwordx4 v[52:55], v8, s[8:11], s25 offen
    buffer_load_dwordx4 v[56:59], v9, s[8:11], s25 offen
    buffer_load_dwordx4 v[60:63], v10, s[8:11], s25 offen
    buffer_load_dwordx4 v[64:67], v11, s[8:11], s25 offen
    buffer_load_dwordx4 v[68:71], v7, s[8:11], s32 offen
    buffer_load_dwordx4 v[72:75], v7, s[8:11], s33 offen
    buffer_load_dwordx4 v[76:79], v7, s[8:11], s34 offen
    buffer_load_dwordx4 v[80:83], v7, s[8:11], s35 offen
    buffer_load_dwordx4 v[84:87], v7, s[8:11], s36 offen
    s_waitcnt vmcnt(9)
    v_mfma_f32_16x16x32_bf16 a[0:3], v[16:19], v[32:35], a[0:3]
    v_mfma_f32_16x16x32_bf16 a[20:23], v[20:23], v[32:35], a[20:23]
    v_mfma_f32_16x16x32_bf16 a[40:43], v[24:27], v[32:35], a[40:43]
    v_mfma_f32_16x16x32_bf16 a[60:63], v[28:31], v[32:35], a[60:63]
    v_mfma_f32_16x16x32_bf16 a[4:7], v[16:19], v[36:39], a[4:7]
    v_mfma_f32_16x16x32_bf16 a[24:27], v[20:23], v[36:39], a[24:27]
    v_mfma_f32_16x16x32_bf16 a[44:47], v[24:27], v[36:39], a[44:47]
    v_mfma_f32_16x16x32_bf16 a[64:67], v[28:31], v[36:39], a[64:67]
    v_mfma_f32_16x16x32_bf16 a[8:11], v[16:19], v[40:43], a[8:11]
    v_mfma_f32_16x16x32_bf16 a[28:31], v[20:23], v[40:43], a[28:31]
    v_mfma_f32_16x16x32_bf16 a[48:51], v[24:27], v[40:43], a[48:51]
    v_mfma_f32_16x16x32_bf16 a[68:71], v[28:31], v[40:43], a[68:71]
    v_mfma_f32_16x16x32_bf16 a[12:15], v[16:19], v[44:47], a[12:15]
    v_mfma_f32_16x16x32_bf16 a[32:35], v[20:23], v[44:47], a[32:35]
    v_mfma_f32_16x16x32_bf16 a[52:55], v[24:27], v[44:47], a[52:55]
    v_mfma_f32_16x16x32_bf16 a[72:75], v[28:31], v[44:47], a[72:75]
    v_mfma_f32_16x16x32_bf16 a[16:19], v[16:19], v[48:51], a[16:19]
    v_mfma_f32_16x16x32_bf16 a[36:39], v[20:23], v[48:51], a[36:39]
    v_mfma_f32_16x16x32_bf16 a[56:59], v[24:27], v[48:51], a[56:59]
    v_mfma_f32_16x16x32_bf16 a[76:79], v[28:31], v[48:51], a[76:79]
    s_sub_u32 s28, s28, 1
    s_cmp_eq_u32 s28, 0
    s_cbranch_scc1 qkv_a_kernel_loop1_last
    s_add_u32 s25, s25, 64
    s_add_u32 s32, s32, 1024
    s_add_u32 s33, s33, 1024
    s_add_u32 s34, s34, 1024
    s_add_u32 s35, s35, 1024
    s_add_u32 s36, s36, 1024
    buffer_load_dwordx4 v[16:19], v8, s[8:11], s25 offen
    buffer_load_dwordx4 v[20:23], v9, s[8:11], s25 offen
    buffer_load_dwordx4 v[24:27], v10, s[8:11], s25 offen
    buffer_load_dwordx4 v[28:31], v11, s[8:11], s25 offen
    buffer_load_dwordx4 v[32:35], v7, s[8:11], s32 offen
    buffer_load_dwordx4 v[36:39], v7, s[8:11], s33 offen
    buffer_load_dwordx4 v[40:43], v7, s[8:11], s34 offen
    buffer_load_dwordx4 v[44:47], v7, s[8:11], s35 offen
    buffer_load_dwordx4 v[48:51], v7, s[8:11], s36 offen
    s_waitcnt vmcnt(9)
    v_mfma_f32_16x16x32_bf16 a[0:3], v[52:55], v[68:71], a[0:3]
    v_mfma_f32_16x16x32_bf16 a[20:23], v[56:59], v[68:71], a[20:23]
    v_mfma_f32_16x16x32_bf16 a[40:43], v[60:63], v[68:71], a[40:43]
    v_mfma_f32_16x16x32_bf16 a[60:63], v[64:67], v[68:71], a[60:63]
    v_mfma_f32_16x16x32_bf16 a[4:7], v[52:55], v[72:75], a[4:7]
    v_mfma_f32_16x16x32_bf16 a[24:27], v[56:59], v[72:75], a[24:27]
    v_mfma_f32_16x16x32_bf16 a[44:47], v[60:63], v[72:75], a[44:47]
    v_mfma_f32_16x16x32_bf16 a[64:67], v[64:67], v[72:75], a[64:67]
    v_mfma_f32_16x16x32_bf16 a[8:11], v[52:55], v[76:79], a[8:11]
    v_mfma_f32_16x16x32_bf16 a[28:31], v[56:59], v[76:79], a[28:31]
    v_mfma_f32_16x16x32_bf16 a[48:51], v[60:63], v[76:79], a[48:51]
    v_mfma_f32_16x16x32_bf16 a[68:71], v[64:67], v[76:79], a[68:71]
    v_mfma_f32_16x16x32_bf16 a[12:15], v[52:55], v[80:83], a[12:15]
    v_mfma_f32_16x16x32_bf16 a[32:35], v[56:59], v[80:83], a[32:35]
    v_mfma_f32_16x16x32_bf16 a[52:55], v[60:63], v[80:83], a[52:55]
    v_mfma_f32_16x16x32_bf16 a[72:75], v[64:67], v[80:83], a[72:75]
    v_mfma_f32_16x16x32_bf16 a[16:19], v[52:55], v[84:87], a[16:19]
    v_mfma_f32_16x16x32_bf16 a[36:39], v[56:59], v[84:87], a[36:39]
    v_mfma_f32_16x16x32_bf16 a[56:59], v[60:63], v[84:87], a[56:59]
    v_mfma_f32_16x16x32_bf16 a[76:79], v[64:67], v[84:87], a[76:79]
    s_branch qkv_a_kernel_loop1
qkv_a_kernel_loop1_last:
    s_waitcnt vmcnt(0)
    v_mfma_f32_16x16x32_bf16 a[0:3], v[52:55], v[68:71], a[0:3]
    v_mfma_f32_16x16x32_bf16 a[20:23], v[56:59], v[68:71], a[20:23]
    v_mfma_f32_16x16x32_bf16 a[40:43], v[60:63], v[68:71], a[40:43]
    v_mfma_f32_16x16x32_bf16 a[60:63], v[64:67], v[68:71], a[60:63]
    v_mfma_f32_16x16x32_bf16 a[4:7], v[52:55], v[72:75], a[4:7]
    v_mfma_f32_16x16x32_bf16 a[24:27], v[56:59], v[72:75], a[24:27]
    v_mfma_f32_16x16x32_bf16 a[44:47], v[60:63], v[72:75], a[44:47]
    v_mfma_f32_16x16x32_bf16 a[64:67], v[64:67], v[72:75], a[64:67]
    v_mfma_f32_16x16x32_bf16 a[8:11], v[52:55], v[76:79], a[8:11]
    v_mfma_f32_16x16x32_bf16 a[28:31], v[56:59], v[76:79], a[28:31]
    v_mfma_f32_16x16x32_bf16 a[48:51], v[60:63], v[76:79], a[48:51]
    v_mfma_f32_16x16x32_bf16 a[68:71], v[64:67], v[76:79], a[68:71]
    v_mfma_f32_16x16x32_bf16 a[12:15], v[52:55], v[80:83], a[12:15]
    v_mfma_f32_16x16x32_bf16 a[32:35], v[56:59], v[80:83], a[32:35]
    v_mfma_f32_16x16x32_bf16 a[52:55], v[60:63], v[80:83], a[52:55]
    v_mfma_f32_16x16x32_bf16 a[72:75], v[64:67], v[80:83], a[72:75]
    v_mfma_f32_16x16x32_bf16 a[16:19], v[52:55], v[84:87], a[16:19]
    v_mfma_f32_16x16x32_bf16 a[36:39], v[56:59], v[84:87], a[36:39]
    v_mfma_f32_16x16x32_bf16 a[56:59], v[60:63], v[84:87], a[56:59]
    v_mfma_f32_16x16x32_bf16 a[76:79], v[64:67], v[84:87], a[76:79]
    s_nop 7
    s_nop 7
    s_sub_u32 s29, s23, 640
    v_add_u32 v5, s29, v3
    v_lshlrev_b32 v5, 11, v5
    v_lshlrev_b32 v6, 2, v4
    v_add3_u32 v5, v5, v6, s22
    v_lshlrev_b32 v5, 1, v5
    v_add_u32 v5, 12582912, v5
    v_accvgpr_read_b32 v92, a0
    v_accvgpr_read_b32 v93, a1
    v_accvgpr_read_b32 v94, a2
    v_accvgpr_read_b32 v95, a3
    v_cvt_pk_bf16_f32 v96, v92, v93
    v_cvt_pk_bf16_f32 v97, v94, v95
    v_add_u32 v6, 0, v5
    buffer_store_dwordx2 v[96:97], v6, s[8:11], 0 offen
    v_accvgpr_read_b32 v92, a4
    v_accvgpr_read_b32 v93, a5
    v_accvgpr_read_b32 v94, a6
    v_accvgpr_read_b32 v95, a7
    v_cvt_pk_bf16_f32 v96, v92, v93
    v_cvt_pk_bf16_f32 v97, v94, v95
    v_add_u32 v6, 65536, v5
    buffer_store_dwordx2 v[96:97], v6, s[8:11], 0 offen
    v_accvgpr_read_b32 v92, a8
    v_accvgpr_read_b32 v93, a9
    v_accvgpr_read_b32 v94, a10
    v_accvgpr_read_b32 v95, a11
    v_cvt_pk_bf16_f32 v96, v92, v93
    v_cvt_pk_bf16_f32 v97, v94, v95
    v_add_u32 v6, 131072, v5
    buffer_store_dwordx2 v[96:97], v6, s[8:11], 0 offen
    v_accvgpr_read_b32 v92, a12
    v_accvgpr_read_b32 v93, a13
    v_accvgpr_read_b32 v94, a14
    v_accvgpr_read_b32 v95, a15
    v_cvt_pk_bf16_f32 v96, v92, v93
    v_cvt_pk_bf16_f32 v97, v94, v95
    v_add_u32 v6, 196608, v5
    buffer_store_dwordx2 v[96:97], v6, s[8:11], 0 offen
    v_accvgpr_read_b32 v92, a16
    v_accvgpr_read_b32 v93, a17
    v_accvgpr_read_b32 v94, a18
    v_accvgpr_read_b32 v95, a19
    v_cvt_pk_bf16_f32 v96, v92, v93
    v_cvt_pk_bf16_f32 v97, v94, v95
    v_add_u32 v6, 262144, v5
    buffer_store_dwordx2 v[96:97], v6, s[8:11], 0 offen
    v_accvgpr_read_b32 v92, a20
    v_accvgpr_read_b32 v93, a21
    v_accvgpr_read_b32 v94, a22
    v_accvgpr_read_b32 v95, a23
    v_cvt_pk_bf16_f32 v96, v92, v93
    v_cvt_pk_bf16_f32 v97, v94, v95
    v_add_u32 v6, 32, v5
    buffer_store_dwordx2 v[96:97], v6, s[8:11], 0 offen
    v_accvgpr_read_b32 v92, a24
    v_accvgpr_read_b32 v93, a25
    v_accvgpr_read_b32 v94, a26
    v_accvgpr_read_b32 v95, a27
    v_cvt_pk_bf16_f32 v96, v92, v93
    v_cvt_pk_bf16_f32 v97, v94, v95
    v_add_u32 v6, 65568, v5
    buffer_store_dwordx2 v[96:97], v6, s[8:11], 0 offen
    v_accvgpr_read_b32 v92, a28
    v_accvgpr_read_b32 v93, a29
    v_accvgpr_read_b32 v94, a30
    v_accvgpr_read_b32 v95, a31
    v_cvt_pk_bf16_f32 v96, v92, v93
    v_cvt_pk_bf16_f32 v97, v94, v95
    v_add_u32 v6, 131104, v5
    buffer_store_dwordx2 v[96:97], v6, s[8:11], 0 offen
    v_accvgpr_read_b32 v92, a32
    v_accvgpr_read_b32 v93, a33
    v_accvgpr_read_b32 v94, a34
    v_accvgpr_read_b32 v95, a35
    v_cvt_pk_bf16_f32 v96, v92, v93
    v_cvt_pk_bf16_f32 v97, v94, v95
    v_add_u32 v6, 196640, v5
    buffer_store_dwordx2 v[96:97], v6, s[8:11], 0 offen
    v_accvgpr_read_b32 v92, a36
    v_accvgpr_read_b32 v93, a37
    v_accvgpr_read_b32 v94, a38
    v_accvgpr_read_b32 v95, a39
    v_cvt_pk_bf16_f32 v96, v92, v93
    v_cvt_pk_bf16_f32 v97, v94, v95
    v_add_u32 v6, 262176, v5
    buffer_store_dwordx2 v[96:97], v6, s[8:11], 0 offen
    v_accvgpr_read_b32 v92, a40
    v_accvgpr_read_b32 v93, a41
    v_accvgpr_read_b32 v94, a42
    v_accvgpr_read_b32 v95, a43
    v_cvt_pk_bf16_f32 v96, v92, v93
    v_cvt_pk_bf16_f32 v97, v94, v95
    v_add_u32 v6, 64, v5
    buffer_store_dwordx2 v[96:97], v6, s[8:11], 0 offen
    v_accvgpr_read_b32 v92, a44
    v_accvgpr_read_b32 v93, a45
    v_accvgpr_read_b32 v94, a46
    v_accvgpr_read_b32 v95, a47
    v_cvt_pk_bf16_f32 v96, v92, v93
    v_cvt_pk_bf16_f32 v97, v94, v95
    v_add_u32 v6, 65600, v5
    buffer_store_dwordx2 v[96:97], v6, s[8:11], 0 offen
    v_accvgpr_read_b32 v92, a48
    v_accvgpr_read_b32 v93, a49
    v_accvgpr_read_b32 v94, a50
    v_accvgpr_read_b32 v95, a51
    v_cvt_pk_bf16_f32 v96, v92, v93
    v_cvt_pk_bf16_f32 v97, v94, v95
    v_add_u32 v6, 131136, v5
    buffer_store_dwordx2 v[96:97], v6, s[8:11], 0 offen
    v_accvgpr_read_b32 v92, a52
    v_accvgpr_read_b32 v93, a53
    v_accvgpr_read_b32 v94, a54
    v_accvgpr_read_b32 v95, a55
    v_cvt_pk_bf16_f32 v96, v92, v93
    v_cvt_pk_bf16_f32 v97, v94, v95
    v_add_u32 v6, 196672, v5
    buffer_store_dwordx2 v[96:97], v6, s[8:11], 0 offen
    v_accvgpr_read_b32 v92, a56
    v_accvgpr_read_b32 v93, a57
    v_accvgpr_read_b32 v94, a58
    v_accvgpr_read_b32 v95, a59
    v_cvt_pk_bf16_f32 v96, v92, v93
    v_cvt_pk_bf16_f32 v97, v94, v95
    v_add_u32 v6, 262208, v5
    buffer_store_dwordx2 v[96:97], v6, s[8:11], 0 offen
    v_accvgpr_read_b32 v92, a60
    v_accvgpr_read_b32 v93, a61
    v_accvgpr_read_b32 v94, a62
    v_accvgpr_read_b32 v95, a63
    v_cvt_pk_bf16_f32 v96, v92, v93
    v_cvt_pk_bf16_f32 v97, v94, v95
    v_add_u32 v6, 96, v5
    buffer_store_dwordx2 v[96:97], v6, s[8:11], 0 offen
    v_accvgpr_read_b32 v92, a64
    v_accvgpr_read_b32 v93, a65
    v_accvgpr_read_b32 v94, a66
    v_accvgpr_read_b32 v95, a67
    v_cvt_pk_bf16_f32 v96, v92, v93
    v_cvt_pk_bf16_f32 v97, v94, v95
    v_add_u32 v6, 65632, v5
    buffer_store_dwordx2 v[96:97], v6, s[8:11], 0 offen
    v_accvgpr_read_b32 v92, a68
    v_accvgpr_read_b32 v93, a69
    v_accvgpr_read_b32 v94, a70
    v_accvgpr_read_b32 v95, a71
    v_cvt_pk_bf16_f32 v96, v92, v93
    v_cvt_pk_bf16_f32 v97, v94, v95
    v_add_u32 v6, 131168, v5
    buffer_store_dwordx2 v[96:97], v6, s[8:11], 0 offen
    v_accvgpr_read_b32 v92, a72
    v_accvgpr_read_b32 v93, a73
    v_accvgpr_read_b32 v94, a74
    v_accvgpr_read_b32 v95, a75
    v_cvt_pk_bf16_f32 v96, v92, v93
    v_cvt_pk_bf16_f32 v97, v94, v95
    v_add_u32 v6, 196704, v5
    buffer_store_dwordx2 v[96:97], v6, s[8:11], 0 offen
    v_accvgpr_read_b32 v92, a76
    v_accvgpr_read_b32 v93, a77
    v_accvgpr_read_b32 v94, a78
    v_accvgpr_read_b32 v95, a79
    v_cvt_pk_bf16_f32 v96, v92, v93
    v_cvt_pk_bf16_f32 v97, v94, v95
    v_add_u32 v6, 262240, v5
    buffer_store_dwordx2 v[96:97], v6, s[8:11], 0 offen
qkv_a_kernel_end:
    s_endpgm
.section .rodata,"a"
.p2align 6
.amdhsa_kernel qkv_a_kernel
  .amdhsa_next_free_vgpr 192
  .amdhsa_next_free_sgpr 64
  .amdhsa_accum_offset 112
  .amdhsa_group_segment_fixed_size 0
  .amdhsa_kernarg_size 104
  .amdhsa_user_sgpr_count 2
  .amdhsa_user_sgpr_kernarg_segment_ptr 1
  .amdhsa_system_sgpr_workgroup_id_x 1
.end_amdhsa_kernel
.text
.globl kvz_a1_kernel
.p2align 8
.type kvz_a1_kernel,@function
kvz_a1_kernel:
    v_lshrrev_b32 v1, 6, v0
    v_and_b32 v2, 63, v0
    s_nop 0
    v_readfirstlane_b32 s3, v1
    s_lshl_b32 s4, s2, 2
    s_add_u32 s4, s4, s3
    s_cmp_ge_u32 s4, 512
    s_cbranch_scc1 kvz_a1_kernel_end
    s_load_dwordx2 s[6:7], s[0:1], 96
    s_waitcnt lgkmcnt(0)
    s_mov_b32 s8, s6
    s_mov_b32 s9, s7
    s_mov_b32 s10, 268435456
    s_mov_b32 s11, 0x00020000
    s_lshr_b32 s5, s4, 4
    s_and_b32 s12, s4, 15
    s_mul_i32 s13, s5, 20
    v_and_b32 v3, 15, v2
    v_lshrrev_b32 v4, 4, v2
    s_lshl_b32 s14, s12, 7
    v_lshlrev_b32 v5, 3, v4
    v_add_u32 v5, s14, v5
    v_add_u32 v6, 0, v3
    v_min_u32 v8, 19, v6
    v_add_u32 v8, s13, v8
    v_lshlrev_b32 v8, 11, v8
    v_add_u32 v8, v8, v5
    v_lshlrev_b32 v8, 1, v8
    v_add_u32 v8, 12582912, v8
    v_add_u32 v10, 2621440, v8
    v_add_u32 v7, 16, v3
    v_min_u32 v9, 19, v7
    v_add_u32 v9, s13, v9
    v_lshlrev_b32 v9, 11, v9
    v_add_u32 v9, v9, v5
    v_lshlrev_b32 v9, 1, v9
    v_add_u32 v9, 12582912, v9
    v_add_u32 v11, 2621440, v9
    v_accvgpr_write_b32 a0, 0
    v_accvgpr_write_b32 a1, 0
    v_accvgpr_write_b32 a2, 0
    v_accvgpr_write_b32 a3, 0
    v_accvgpr_write_b32 a4, 0
    v_accvgpr_write_b32 a5, 0
    v_accvgpr_write_b32 a6, 0
    v_accvgpr_write_b32 a7, 0
    v_accvgpr_write_b32 a8, 0
    v_accvgpr_write_b32 a9, 0
    v_accvgpr_write_b32 a10, 0
    v_accvgpr_write_b32 a11, 0
    v_accvgpr_write_b32 a12, 0
    v_accvgpr_write_b32 a13, 0
    v_accvgpr_write_b32 a14, 0
    v_accvgpr_write_b32 a15, 0
    v_cmp_gt_u32 s[16:17], 20, v7
    v_cmp_eq_u32 s[18:19], 20, v7
    buffer_load_dwordx4 v[16:19], v8, s[8:11], 0 offen offset:0
    buffer_load_dwordx4 v[24:27], v10, s[8:11], 0 offen offset:0
    buffer_load_dwordx4 v[20:23], v9, s[8:11], 0 offen offset:0
    buffer_load_dwordx4 v[28:31], v11, s[8:11], 0 offen offset:0
    s_waitcnt vmcnt(0)
    v_lshlrev_b32 v32, 16, v16
    v_and_b32 v33, 0xffff0000, v16
    v_mul_f32 v36, 1.4426950408889634, v32
    v_exp_f32 v36, v36
    v_add_f32 v34, 1.0, v32
    v_cmp_lt_f32 vcc, 0, v32
    s_nop 1
    v_cndmask_b32 v34, v36, v34, vcc
    v_add_f32 v34, 0x358637bd, v34
    v_mul_f32 v36, 1.4426950408889634, v33
    v_exp_f32 v36, v36
    v_add_f32 v35, 1.0, v33
    v_cmp_lt_f32 vcc, 0, v33
    s_nop 1
    v_cndmask_b32 v35, v36, v35, vcc
    v_add_f32 v35, 0x358637bd, v35
    v_cvt_pk_bf16_f32 v16, v34, v35
    v_lshlrev_b32 v32, 16, v17
    v_and_b32 v33, 0xffff0000, v17
    v_mul_f32 v36, 1.4426950408889634, v32
    v_exp_f32 v36, v36
    v_add_f32 v34, 1.0, v32
    v_cmp_lt_f32 vcc, 0, v32
    s_nop 1
    v_cndmask_b32 v34, v36, v34, vcc
    v_add_f32 v34, 0x358637bd, v34
    v_mul_f32 v36, 1.4426950408889634, v33
    v_exp_f32 v36, v36
    v_add_f32 v35, 1.0, v33
    v_cmp_lt_f32 vcc, 0, v33
    s_nop 1
    v_cndmask_b32 v35, v36, v35, vcc
    v_add_f32 v35, 0x358637bd, v35
    v_cvt_pk_bf16_f32 v17, v34, v35
    v_lshlrev_b32 v32, 16, v18
    v_and_b32 v33, 0xffff0000, v18
    v_mul_f32 v36, 1.4426950408889634, v32
    v_exp_f32 v36, v36
    v_add_f32 v34, 1.0, v32
    v_cmp_lt_f32 vcc, 0, v32
    s_nop 1
    v_cndmask_b32 v34, v36, v34, vcc
    v_add_f32 v34, 0x358637bd, v34
    v_mul_f32 v36, 1.4426950408889634, v33
    v_exp_f32 v36, v36
    v_add_f32 v35, 1.0, v33
    v_cmp_lt_f32 vcc, 0, v33
    s_nop 1
    v_cndmask_b32 v35, v36, v35, vcc
    v_add_f32 v35, 0x358637bd, v35
    v_cvt_pk_bf16_f32 v18, v34, v35
    v_lshlrev_b32 v32, 16, v19
    v_and_b32 v33, 0xffff0000, v19
    v_mul_f32 v36, 1.4426950408889634, v32
    v_exp_f32 v36, v36
    v_add_f32 v34, 1.0, v32
    v_cmp_lt_f32 vcc, 0, v32
    s_nop 1
    v_cndmask_b32 v34, v36, v34, vcc
    v_add_f32 v34, 0x358637bd, v34
    v_mul_f32 v36, 1.4426950408889634, v33
    v_exp_f32 v36, v36
    v_add_f32 v35, 1.0, v33
    v_cmp_lt_f32 vcc, 0, v33
    s_nop 1
    v_cndmask_b32 v35, v36, v35, vcc
    v_add_f32 v35, 0x358637bd, v35
    v_cvt_pk_bf16_f32 v19, v34, v35
    v_lshlrev_b32 v32, 16, v20
    v_and_b32 v33, 0xffff0000, v20
    v_mul_f32 v36, 1.4426950408889634, v32
    v_exp_f32 v36, v36
    v_add_f32 v34, 1.0, v32
    v_cmp_lt_f32 vcc, 0, v32
    s_nop 1
    v_cndmask_b32 v34, v36, v34, vcc
    v_add_f32 v34, 0x358637bd, v34
    v_mul_f32 v36, 1.4426950408889634, v33
    v_exp_f32 v36, v36
    v_add_f32 v35, 1.0, v33
    v_cmp_lt_f32 vcc, 0, v33
    s_nop 1
    v_cndmask_b32 v35, v36, v35, vcc
    v_add_f32 v35, 0x358637bd, v35
    v_cvt_pk_bf16_f32 v20, v34, v35
    v_lshlrev_b32 v32, 16, v21
    v_and_b32 v33, 0xffff0000, v21
    v_mul_f32 v36, 1.4426950408889634, v32
    v_exp_f32 v36, v36
    v_add_f32 v34, 1.0, v32
    v_cmp_lt_f32 vcc, 0, v32
    s_nop 1
    v_cndmask_b32 v34, v36, v34, vcc
    v_add_f32 v34, 0x358637bd, v34
    v_mul_f32 v36, 1.4426950408889634, v33
    v_exp_f32 v36, v36
    v_add_f32 v35, 1.0, v33
    v_cmp_lt_f32 vcc, 0, v33
    s_nop 1
    v_cndmask_b32 v35, v36, v35, vcc
    v_add_f32 v35, 0x358637bd, v35
    v_cvt_pk_bf16_f32 v21, v34, v35
    v_lshlrev_b32 v32, 16, v22
    v_and_b32 v33, 0xffff0000, v22
    v_mul_f32 v36, 1.4426950408889634, v32
    v_exp_f32 v36, v36
    v_add_f32 v34, 1.0, v32
    v_cmp_lt_f32 vcc, 0, v32
    s_nop 1
    v_cndmask_b32 v34, v36, v34, vcc
    v_add_f32 v34, 0x358637bd, v34
    v_mul_f32 v36, 1.4426950408889634, v33
    v_exp_f32 v36, v36
    v_add_f32 v35, 1.0, v33
    v_cmp_lt_f32 vcc, 0, v33
    s_nop 1
    v_cndmask_b32 v35, v36, v35, vcc
    v_add_f32 v35, 0x358637bd, v35
    v_cvt_pk_bf16_f32 v22, v34, v35
    v_lshlrev_b32 v32, 16, v23
    v_and_b32 v33, 0xffff0000, v23
    v_mul_f32 v36, 1.4426950408889634, v32
    v_exp_f32 v36, v36
    v_add_f32 v34, 1.0, v32
    v_cmp_lt_f32 vcc, 0, v32
    s_nop 1
    v_cndmask_b32 v34, v36, v34, vcc
    v_add_f32 v34, 0x358637bd, v34
    v_mul_f32 v36, 1.4426950408889634, v33
    v_exp_f32 v36, v36
    v_add_f32 v35, 1.0, v33
    v_cmp_lt_f32 vcc, 0, v33
    s_nop 1
    v_cndmask_b32 v35, v36, v35, vcc
    v_add_f32 v35, 0x358637bd, v35
    v_cvt_pk_bf16_f32 v23, v34, v35
    v_mov_b32 v37, 0x3f803f80
    v_cndmask_b32 v20, 0, v20, s[16:17]
    v_cndmask_b32 v28, 0, v28, s[16:17]
    v_cndmask_b32 v28, v28, v37, s[18:19]
    v_cndmask_b32 v21, 0, v21, s[16:17]
    v_cndmask_b32 v29, 0, v29, s[16:17]
    v_cndmask_b32 v29, v29, v37, s[18:19]
    v_cndmask_b32 v22, 0, v22, s[16:17]
    v_cndmask_b32 v30, 0, v30, s[16:17]
    v_cndmask_b32 v30, v30, v37, s[18:19]
    v_cndmask_b32 v23, 0, v23, s[16:17]
    v_cndmask_b32 v31, 0, v31, s[16:17]
    v_cndmask_b32 v31, v31, v37, s[18:19]
    s_nop 1
    v_mfma_f32_16x16x32_bf16 a[0:3], v[24:27], v[16:19], a[0:3]
    v_mfma_f32_16x16x32_bf16 a[4:7], v[24:27], v[20:23], a[4:7]
    v_mfma_f32_16x16x32_bf16 a[8:11], v[28:31], v[16:19], a[8:11]
    v_mfma_f32_16x16x32_bf16 a[12:15], v[28:31], v[20:23], a[12:15]
    buffer_load_dwordx4 v[16:19], v8, s[8:11], 0 offen offset:64
    buffer_load_dwordx4 v[24:27], v10, s[8:11], 0 offen offset:64
    buffer_load_dwordx4 v[20:23], v9, s[8:11], 0 offen offset:64
    buffer_load_dwordx4 v[28:31], v11, s[8:11], 0 offen offset:64
    s_waitcnt vmcnt(0)
    v_lshlrev_b32 v32, 16, v16
    v_and_b32 v33, 0xffff0000, v16
    v_mul_f32 v36, 1.4426950408889634, v32
    v_exp_f32 v36, v36
    v_add_f32 v34, 1.0, v32
    v_cmp_lt_f32 vcc, 0, v32
    s_nop 1
    v_cndmask_b32 v34, v36, v34, vcc
    v_add_f32 v34, 0x358637bd, v34
    v_mul_f32 v36, 1.4426950408889634, v33
    v_exp_f32 v36, v36
    v_add_f32 v35, 1.0, v33
    v_cmp_lt_f32 vcc, 0, v33
    s_nop 1
    v_cndmask_b32 v35, v36, v35, vcc
    v_add_f32 v35, 0x358637bd, v35
    v_cvt_pk_bf16_f32 v16, v34, v35
    v_lshlrev_b32 v32, 16, v17
    v_and_b32 v33, 0xffff0000, v17
    v_mul_f32 v36, 1.4426950408889634, v32
    v_exp_f32 v36, v36
    v_add_f32 v34, 1.0, v32
    v_cmp_lt_f32 vcc, 0, v32
    s_nop 1
    v_cndmask_b32 v34, v36, v34, vcc
    v_add_f32 v34, 0x358637bd, v34
    v_mul_f32 v36, 1.4426950408889634, v33
    v_exp_f32 v36, v36
    v_add_f32 v35, 1.0, v33
    v_cmp_lt_f32 vcc, 0, v33
    s_nop 1
    v_cndmask_b32 v35, v36, v35, vcc
    v_add_f32 v35, 0x358637bd, v35
    v_cvt_pk_bf16_f32 v17, v34, v35
    v_lshlrev_b32 v32, 16, v18
    v_and_b32 v33, 0xffff0000, v18
    v_mul_f32 v36, 1.4426950408889634, v32
    v_exp_f32 v36, v36
    v_add_f32 v34, 1.0, v32
    v_cmp_lt_f32 vcc, 0, v32
    s_nop 1
    v_cndmask_b32 v34, v36, v34, vcc
    v_add_f32 v34, 0x358637bd, v34
    v_mul_f32 v36, 1.4426950408889634, v33
    v_exp_f32 v36, v36
    v_add_f32 v35, 1.0, v33
    v_cmp_lt_f32 vcc, 0, v33
    s_nop 1
    v_cndmask_b32 v35, v36, v35, vcc
    v_add_f32 v35, 0x358637bd, v35
    v_cvt_pk_bf16_f32 v18, v34, v35
    v_lshlrev_b32 v32, 16, v19
    v_and_b32 v33, 0xffff0000, v19
    v_mul_f32 v36, 1.4426950408889634, v32
    v_exp_f32 v36, v36
    v_add_f32 v34, 1.0, v32
    v_cmp_lt_f32 vcc, 0, v32
    s_nop 1
    v_cndmask_b32 v34, v36, v34, vcc
    v_add_f32 v34, 0x358637bd, v34
    v_mul_f32 v36, 1.4426950408889634, v33
    v_exp_f32 v36, v36
    v_add_f32 v35, 1.0, v33
    v_cmp_lt_f32 vcc, 0, v33
    s_nop 1
    v_cndmask_b32 v35, v36, v35, vcc
    v_add_f32 v35, 0x358637bd, v35
    v_cvt_pk_bf16_f32 v19, v34, v35
    v_lshlrev_b32 v32, 16, v20
    v_and_b32 v33, 0xffff0000, v20
    v_mul_f32 v36, 1.4426950408889634, v32
    v_exp_f32 v36, v36
    v_add_f32 v34, 1.0, v32
    v_cmp_lt_f32 vcc, 0, v32
    s_nop 1
    v_cndmask_b32 v34, v36, v34, vcc
    v_add_f32 v34, 0x358637bd, v34
    v_mul_f32 v36, 1.4426950408889634, v33
    v_exp_f32 v36, v36
    v_add_f32 v35, 1.0, v33
    v_cmp_lt_f32 vcc, 0, v33
    s_nop 1
    v_cndmask_b32 v35, v36, v35, vcc
    v_add_f32 v35, 0x358637bd, v35
    v_cvt_pk_bf16_f32 v20, v34, v35
    v_lshlrev_b32 v32, 16, v21
    v_and_b32 v33, 0xffff0000, v21
    v_mul_f32 v36, 1.4426950408889634, v32
    v_exp_f32 v36, v36
    v_add_f32 v34, 1.0, v32
    v_cmp_lt_f32 vcc, 0, v32
    s_nop 1
    v_cndmask_b32 v34, v36, v34, vcc
    v_add_f32 v34, 0x358637bd, v34
    v_mul_f32 v36, 1.4426950408889634, v33
    v_exp_f32 v36, v36
    v_add_f32 v35, 1.0, v33
    v_cmp_lt_f32 vcc, 0, v33
    s_nop 1
    v_cndmask_b32 v35, v36, v35, vcc
    v_add_f32 v35, 0x358637bd, v35
    v_cvt_pk_bf16_f32 v21, v34, v35
    v_lshlrev_b32 v32, 16, v22
    v_and_b32 v33, 0xffff0000, v22
    v_mul_f32 v36, 1.4426950408889634, v32
    v_exp_f32 v36, v36
    v_add_f32 v34, 1.0, v32
    v_cmp_lt_f32 vcc, 0, v32
    s_nop 1
    v_cndmask_b32 v34, v36, v34, vcc
    v_add_f32 v34, 0x358637bd, v34
    v_mul_f32 v36, 1.4426950408889634, v33
    v_exp_f32 v36, v36
    v_add_f32 v35, 1.0, v33
    v_cmp_lt_f32 vcc, 0, v33
    s_nop 1
    v_cndmask_b32 v35, v36, v35, vcc
    v_add_f32 v35, 0x358637bd, v35
    v_cvt_pk_bf16_f32 v22, v34, v35
    v_lshlrev_b32 v32, 16, v23
    v_and_b32 v33, 0xffff0000, v23
    v_mul_f32 v36, 1.4426950408889634, v32
    v_exp_f32 v36, v36
    v_add_f32 v34, 1.0, v32
    v_cmp_lt_f32 vcc, 0, v32
    s_nop 1
    v_cndmask_b32 v34, v36, v34, vcc
    v_add_f32 v34, 0x358637bd, v34
    v_mul_f32 v36, 1.4426950408889634, v33
    v_exp_f32 v36, v36
    v_add_f32 v35, 1.0, v33
    v_cmp_lt_f32 vcc, 0, v33
    s_nop 1
    v_cndmask_b32 v35, v36, v35, vcc
    v_add_f32 v35, 0x358637bd, v35
    v_cvt_pk_bf16_f32 v23, v34, v35
    v_mov_b32 v37, 0x3f803f80
    v_cndmask_b32 v20, 0, v20, s[16:17]
    v_cndmask_b32 v28, 0, v28, s[16:17]
    v_cndmask_b32 v28, v28, v37, s[18:19]
    v_cndmask_b32 v21, 0, v21, s[16:17]
    v_cndmask_b32 v29, 0, v29, s[16:17]
    v_cndmask_b32 v29, v29, v37, s[18:19]
    v_cndmask_b32 v22, 0, v22, s[16:17]
    v_cndmask_b32 v30, 0, v30, s[16:17]
    v_cndmask_b32 v30, v30, v37, s[18:19]
    v_cndmask_b32 v23, 0, v23, s[16:17]
    v_cndmask_b32 v31, 0, v31, s[16:17]
    v_cndmask_b32 v31, v31, v37, s[18:19]
    s_nop 1
    v_mfma_f32_16x16x32_bf16 a[0:3], v[24:27], v[16:19], a[0:3]
    v_mfma_f32_16x16x32_bf16 a[4:7], v[24:27], v[20:23], a[4:7]
    v_mfma_f32_16x16x32_bf16 a[8:11], v[28:31], v[16:19], a[8:11]
    v_mfma_f32_16x16x32_bf16 a[12:15], v[28:31], v[20:23], a[12:15]
    buffer_load_dwordx4 v[16:19], v8, s[8:11], 0 offen offset:128
    buffer_load_dwordx4 v[24:27], v10, s[8:11], 0 offen offset:128
    buffer_load_dwordx4 v[20:23], v9, s[8:11], 0 offen offset:128
    buffer_load_dwordx4 v[28:31], v11, s[8:11], 0 offen offset:128
    s_waitcnt vmcnt(0)
    v_lshlrev_b32 v32, 16, v16
    v_and_b32 v33, 0xffff0000, v16
    v_mul_f32 v36, 1.4426950408889634, v32
    v_exp_f32 v36, v36
    v_add_f32 v34, 1.0, v32
    v_cmp_lt_f32 vcc, 0, v32
    s_nop 1
    v_cndmask_b32 v34, v36, v34, vcc
    v_add_f32 v34, 0x358637bd, v34
    v_mul_f32 v36, 1.4426950408889634, v33
    v_exp_f32 v36, v36
    v_add_f32 v35, 1.0, v33
    v_cmp_lt_f32 vcc, 0, v33
    s_nop 1
    v_cndmask_b32 v35, v36, v35, vcc
    v_add_f32 v35, 0x358637bd, v35
    v_cvt_pk_bf16_f32 v16, v34, v35
    v_lshlrev_b32 v32, 16, v17
    v_and_b32 v33, 0xffff0000, v17
    v_mul_f32 v36, 1.4426950408889634, v32
    v_exp_f32 v36, v36
    v_add_f32 v34, 1.0, v32
    v_cmp_lt_f32 vcc, 0, v32
    s_nop 1
    v_cndmask_b32 v34, v36, v34, vcc
    v_add_f32 v34, 0x358637bd, v34
    v_mul_f32 v36, 1.4426950408889634, v33
    v_exp_f32 v36, v36
    v_add_f32 v35, 1.0, v33
    v_cmp_lt_f32 vcc, 0, v33
    s_nop 1
    v_cndmask_b32 v35, v36, v35, vcc
    v_add_f32 v35, 0x358637bd, v35
    v_cvt_pk_bf16_f32 v17, v34, v35
    v_lshlrev_b32 v32, 16, v18
    v_and_b32 v33, 0xffff0000, v18
    v_mul_f32 v36, 1.4426950408889634, v32
    v_exp_f32 v36, v36
    v_add_f32 v34, 1.0, v32
    v_cmp_lt_f32 vcc, 0, v32
    s_nop 1
    v_cndmask_b32 v34, v36, v34, vcc
    v_add_f32 v34, 0x358637bd, v34
    v_mul_f32 v36, 1.4426950408889634, v33
    v_exp_f32 v36, v36
    v_add_f32 v35, 1.0, v33
    v_cmp_lt_f32 vcc, 0, v33
    s_nop 1
    v_cndmask_b32 v35, v36, v35, vcc
    v_add_f32 v35, 0x358637bd, v35
    v_cvt_pk_bf16_f32 v18, v34, v35
    v_lshlrev_b32 v32, 16, v19
    v_and_b32 v33, 0xffff0000, v19
    v_mul_f32 v36, 1.4426950408889634, v32
    v_exp_f32 v36, v36
    v_add_f32 v34, 1.0, v32
    v_cmp_lt_f32 vcc, 0, v32
    s_nop 1
    v_cndmask_b32 v34, v36, v34, vcc
    v_add_f32 v34, 0x358637bd, v34
    v_mul_f32 v36, 1.4426950408889634, v33
    v_exp_f32 v36, v36
    v_add_f32 v35, 1.0, v33
    v_cmp_lt_f32 vcc, 0, v33
    s_nop 1
    v_cndmask_b32 v35, v36, v35, vcc
    v_add_f32 v35, 0x358637bd, v35
    v_cvt_pk_bf16_f32 v19, v34, v35
    v_lshlrev_b32 v32, 16, v20
    v_and_b32 v33, 0xffff0000, v20
    v_mul_f32 v36, 1.4426950408889634, v32
    v_exp_f32 v36, v36
    v_add_f32 v34, 1.0, v32
    v_cmp_lt_f32 vcc, 0, v32
    s_nop 1
    v_cndmask_b32 v34, v36, v34, vcc
    v_add_f32 v34, 0x358637bd, v34
    v_mul_f32 v36, 1.4426950408889634, v33
    v_exp_f32 v36, v36
    v_add_f32 v35, 1.0, v33
    v_cmp_lt_f32 vcc, 0, v33
    s_nop 1
    v_cndmask_b32 v35, v36, v35, vcc
    v_add_f32 v35, 0x358637bd, v35
    v_cvt_pk_bf16_f32 v20, v34, v35
    v_lshlrev_b32 v32, 16, v21
    v_and_b32 v33, 0xffff0000, v21
    v_mul_f32 v36, 1.4426950408889634, v32
    v_exp_f32 v36, v36
    v_add_f32 v34, 1.0, v32
    v_cmp_lt_f32 vcc, 0, v32
    s_nop 1
    v_cndmask_b32 v34, v36, v34, vcc
    v_add_f32 v34, 0x358637bd, v34
    v_mul_f32 v36, 1.4426950408889634, v33
    v_exp_f32 v36, v36
    v_add_f32 v35, 1.0, v33
    v_cmp_lt_f32 vcc, 0, v33
    s_nop 1
    v_cndmask_b32 v35, v36, v35, vcc
    v_add_f32 v35, 0x358637bd, v35
    v_cvt_pk_bf16_f32 v21, v34, v35
    v_lshlrev_b32 v32, 16, v22
    v_and_b32 v33, 0xffff0000, v22
    v_mul_f32 v36, 1.4426950408889634, v32
    v_exp_f32 v36, v36
    v_add_f32 v34, 1.0, v32
    v_cmp_lt_f32 vcc, 0, v32
    s_nop 1
    v_cndmask_b32 v34, v36, v34, vcc
    v_add_f32 v34, 0x358637bd, v34
    v_mul_f32 v36, 1.4426950408889634, v33
    v_exp_f32 v36, v36
    v_add_f32 v35, 1.0, v33
    v_cmp_lt_f32 vcc, 0, v33
    s_nop 1
    v_cndmask_b32 v35, v36, v35, vcc
    v_add_f32 v35, 0x358637bd, v35
    v_cvt_pk_bf16_f32 v22, v34, v35
    v_lshlrev_b32 v32, 16, v23
    v_and_b32 v33, 0xffff0000, v23
    v_mul_f32 v36, 1.4426950408889634, v32
    v_exp_f32 v36, v36
    v_add_f32 v34, 1.0, v32
    v_cmp_lt_f32 vcc, 0, v32
    s_nop 1
    v_cndmask_b32 v34, v36, v34, vcc
    v_add_f32 v34, 0x358637bd, v34
    v_mul_f32 v36, 1.4426950408889634, v33
    v_exp_f32 v36, v36
    v_add_f32 v35, 1.0, v33
    v_cmp_lt_f32 vcc, 0, v33
    s_nop 1
    v_cndmask_b32 v35, v36, v35, vcc
    v_add_f32 v35, 0x358637bd, v35
    v_cvt_pk_bf16_f32 v23, v34, v35
    v_mov_b32 v37, 0x3f803f80
    v_cndmask_b32 v20, 0, v20, s[16:17]
    v_cndmask_b32 v28, 0, v28, s[16:17]
    v_cndmask_b32 v28, v28, v37, s[18:19]
    v_cndmask_b32 v21, 0, v21, s[16:17]
    v_cndmask_b32 v29, 0, v29, s[16:17]
    v_cndmask_b32 v29, v29, v37, s[18:19]
    v_cndmask_b32 v22, 0, v22, s[16:17]
    v_cndmask_b32 v30, 0, v30, s[16:17]
    v_cndmask_b32 v30, v30, v37, s[18:19]
    v_cndmask_b32 v23, 0, v23, s[16:17]
    v_cndmask_b32 v31, 0, v31, s[16:17]
    v_cndmask_b32 v31, v31, v37, s[18:19]
    s_nop 1
    v_mfma_f32_16x16x32_bf16 a[0:3], v[24:27], v[16:19], a[0:3]
    v_mfma_f32_16x16x32_bf16 a[4:7], v[24:27], v[20:23], a[4:7]
    v_mfma_f32_16x16x32_bf16 a[8:11], v[28:31], v[16:19], a[8:11]
    v_mfma_f32_16x16x32_bf16 a[12:15], v[28:31], v[20:23], a[12:15]
    buffer_load_dwordx4 v[16:19], v8, s[8:11], 0 offen offset:192
    buffer_load_dwordx4 v[24:27], v10, s[8:11], 0 offen offset:192
    buffer_load_dwordx4 v[20:23], v9, s[8:11], 0 offen offset:192
    buffer_load_dwordx4 v[28:31], v11, s[8:11], 0 offen offset:192
    s_waitcnt vmcnt(0)
    v_lshlrev_b32 v32, 16, v16
    v_and_b32 v33, 0xffff0000, v16
    v_mul_f32 v36, 1.4426950408889634, v32
    v_exp_f32 v36, v36
    v_add_f32 v34, 1.0, v32
    v_cmp_lt_f32 vcc, 0, v32
    s_nop 1
    v_cndmask_b32 v34, v36, v34, vcc
    v_add_f32 v34, 0x358637bd, v34
    v_mul_f32 v36, 1.4426950408889634, v33
    v_exp_f32 v36, v36
    v_add_f32 v35, 1.0, v33
    v_cmp_lt_f32 vcc, 0, v33
    s_nop 1
    v_cndmask_b32 v35, v36, v35, vcc
    v_add_f32 v35, 0x358637bd, v35
    v_cvt_pk_bf16_f32 v16, v34, v35
    v_lshlrev_b32 v32, 16, v17
    v_and_b32 v33, 0xffff0000, v17
    v_mul_f32 v36, 1.4426950408889634, v32
    v_exp_f32 v36, v36
    v_add_f32 v34, 1.0, v32
    v_cmp_lt_f32 vcc, 0, v32
    s_nop 1
    v_cndmask_b32 v34, v36, v34, vcc
    v_add_f32 v34, 0x358637bd, v34
    v_mul_f32 v36, 1.4426950408889634, v33
    v_exp_f32 v36, v36
    v_add_f32 v35, 1.0, v33
    v_cmp_lt_f32 vcc, 0, v33
    s_nop 1
    v_cndmask_b32 v35, v36, v35, vcc
    v_add_f32 v35, 0x358637bd, v35
    v_cvt_pk_bf16_f32 v17, v34, v35
    v_lshlrev_b32 v32, 16, v18
    v_and_b32 v33, 0xffff0000, v18
    v_mul_f32 v36, 1.4426950408889634, v32
    v_exp_f32 v36, v36
    v_add_f32 v34, 1.0, v32
    v_cmp_lt_f32 vcc, 0, v32
    s_nop 1
    v_cndmask_b32 v34, v36, v34, vcc
    v_add_f32 v34, 0x358637bd, v34
    v_mul_f32 v36, 1.4426950408889634, v33
    v_exp_f32 v36, v36
    v_add_f32 v35, 1.0, v33
    v_cmp_lt_f32 vcc, 0, v33
    s_nop 1
    v_cndmask_b32 v35, v36, v35, vcc
    v_add_f32 v35, 0x358637bd, v35
    v_cvt_pk_bf16_f32 v18, v34, v35
    v_lshlrev_b32 v32, 16, v19
    v_and_b32 v33, 0xffff0000, v19
    v_mul_f32 v36, 1.4426950408889634, v32
    v_exp_f32 v36, v36
    v_add_f32 v34, 1.0, v32
    v_cmp_lt_f32 vcc, 0, v32
    s_nop 1
    v_cndmask_b32 v34, v36, v34, vcc
    v_add_f32 v34, 0x358637bd, v34
    v_mul_f32 v36, 1.4426950408889634, v33
    v_exp_f32 v36, v36
    v_add_f32 v35, 1.0, v33
    v_cmp_lt_f32 vcc, 0, v33
    s_nop 1
    v_cndmask_b32 v35, v36, v35, vcc
    v_add_f32 v35, 0x358637bd, v35
    v_cvt_pk_bf16_f32 v19, v34, v35
    v_lshlrev_b32 v32, 16, v20
    v_and_b32 v33, 0xffff0000, v20
    v_mul_f32 v36, 1.4426950408889634, v32
    v_exp_f32 v36, v36
    v_add_f32 v34, 1.0, v32
    v_cmp_lt_f32 vcc, 0, v32
    s_nop 1
    v_cndmask_b32 v34, v36, v34, vcc
    v_add_f32 v34, 0x358637bd, v34
    v_mul_f32 v36, 1.4426950408889634, v33
    v_exp_f32 v36, v36
    v_add_f32 v35, 1.0, v33
    v_cmp_lt_f32 vcc, 0, v33
    s_nop 1
    v_cndmask_b32 v35, v36, v35, vcc
    v_add_f32 v35, 0x358637bd, v35
    v_cvt_pk_bf16_f32 v20, v34, v35
    v_lshlrev_b32 v32, 16, v21
    v_and_b32 v33, 0xffff0000, v21
    v_mul_f32 v36, 1.4426950408889634, v32
    v_exp_f32 v36, v36
    v_add_f32 v34, 1.0, v32
    v_cmp_lt_f32 vcc, 0, v32
    s_nop 1
    v_cndmask_b32 v34, v36, v34, vcc
    v_add_f32 v34, 0x358637bd, v34
    v_mul_f32 v36, 1.4426950408889634, v33
    v_exp_f32 v36, v36
    v_add_f32 v35, 1.0, v33
    v_cmp_lt_f32 vcc, 0, v33
    s_nop 1
    v_cndmask_b32 v35, v36, v35, vcc
    v_add_f32 v35, 0x358637bd, v35
    v_cvt_pk_bf16_f32 v21, v34, v35
    v_lshlrev_b32 v32, 16, v22
    v_and_b32 v33, 0xffff0000, v22
    v_mul_f32 v36, 1.4426950408889634, v32
    v_exp_f32 v36, v36
    v_add_f32 v34, 1.0, v32
    v_cmp_lt_f32 vcc, 0, v32
    s_nop 1
    v_cndmask_b32 v34, v36, v34, vcc
    v_add_f32 v34, 0x358637bd, v34
    v_mul_f32 v36, 1.4426950408889634, v33
    v_exp_f32 v36, v36
    v_add_f32 v35, 1.0, v33
    v_cmp_lt_f32 vcc, 0, v33
    s_nop 1
    v_cndmask_b32 v35, v36, v35, vcc
    v_add_f32 v35, 0x358637bd, v35
    v_cvt_pk_bf16_f32 v22, v34, v35
    v_lshlrev_b32 v32, 16, v23
    v_and_b32 v33, 0xffff0000, v23
    v_mul_f32 v36, 1.4426950408889634, v32
    v_exp_f32 v36, v36
    v_add_f32 v34, 1.0, v32
    v_cmp_lt_f32 vcc, 0, v32
    s_nop 1
    v_cndmask_b32 v34, v36, v34, vcc
    v_add_f32 v34, 0x358637bd, v34
    v_mul_f32 v36, 1.4426950408889634, v33
    v_exp_f32 v36, v36
    v_add_f32 v35, 1.0, v33
    v_cmp_lt_f32 vcc, 0, v33
    s_nop 1
    v_cndmask_b32 v35, v36, v35, vcc
    v_add_f32 v35, 0x358637bd, v35
    v_cvt_pk_bf16_f32 v23, v34, v35
    v_mov_b32 v37, 0x3f803f80
    v_cndmask_b32 v20, 0, v20, s[16:17]
    v_cndmask_b32 v28, 0, v28, s[16:17]
    v_cndmask_b32 v28, v28, v37, s[18:19]
    v_cndmask_b32 v21, 0, v21, s[16:17]
    v_cndmask_b32 v29, 0, v29, s[16:17]
    v_cndmask_b32 v29, v29, v37, s[18:19]
    v_cndmask_b32 v22, 0, v22, s[16:17]
    v_cndmask_b32 v30, 0, v30, s[16:17]
    v_cndmask_b32 v30, v30, v37, s[18:19]
    v_cndmask_b32 v23, 0, v23, s[16:17]
    v_cndmask_b32 v31, 0, v31, s[16:17]
    v_cndmask_b32 v31, v31, v37, s[18:19]
    s_nop 1
    v_mfma_f32_16x16x32_bf16 a[0:3], v[24:27], v[16:19], a[0:3]
    v_mfma_f32_16x16x32_bf16 a[4:7], v[24:27], v[20:23], a[4:7]
    v_mfma_f32_16x16x32_bf16 a[8:11], v[28:31], v[16:19], a[8:11]
    v_mfma_f32_16x16x32_bf16 a[12:15], v[28:31], v[20:23], a[12:15]
    s_nop 7
    s_nop 7
    v_lshlrev_b32 v5, 2, v4
    v_lshlrev_b32 v5, 5, v5
    v_add_u32 v5, v5, v3
    v_lshlrev_b32 v5, 2, v5
    s_lshl_b32 s14, s5, 12
    s_add_u32 s14, s14, 23068672
    v_add_u32 v5, s14, v5
    v_accvgpr_read_b32 v40, a0
    v_accvgpr_read_b32 v41, a1
    v_accvgpr_read_b32 v42, a2
    v_accvgpr_read_b32 v43, a3
    buffer_atomic_add_f32 v40, v5, s[8:11], 0 offen offset:0
    buffer_atomic_add_f32 v41, v5, s[8:11], 0 offen offset:128
    buffer_atomic_add_f32 v42, v5, s[8:11], 0 offen offset:256
    buffer_atomic_add_f32 v43, v5, s[8:11], 0 offen offset:384
    v_accvgpr_read_b32 v40, a4
    v_accvgpr_read_b32 v41, a5
    v_accvgpr_read_b32 v42, a6
    v_accvgpr_read_b32 v43, a7
    buffer_atomic_add_f32 v40, v5, s[8:11], 0 offen offset:64
    buffer_atomic_add_f32 v41, v5, s[8:11], 0 offen offset:192
    buffer_atomic_add_f32 v42, v5, s[8:11], 0 offen offset:320
    buffer_atomic_add_f32 v43, v5, s[8:11], 0 offen offset:448
    v_accvgpr_read_b32 v40, a8
    v_accvgpr_read_b32 v41, a9
    v_accvgpr_read_b32 v42, a10
    v_accvgpr_read_b32 v43, a11
    buffer_atomic_add_f32 v40, v5, s[8:11], 0 offen offset:2048
    buffer_atomic_add_f32 v41, v5, s[8:11], 0 offen offset:2176
    buffer_atomic_add_f32 v42, v5, s[8:11], 0 offen offset:2304
    buffer_atomic_add_f32 v43, v5, s[8:11], 0 offen offset:2432
    v_accvgpr_read_b32 v40, a12
    v_accvgpr_read_b32 v41, a13
    v_accvgpr_read_b32 v42, a14
    v_accvgpr_read_b32 v43, a15
    buffer_atomic_add_f32 v40, v5, s[8:11], 0 offen offset:2112
    buffer_atomic_add_f32 v41, v5, s[8:11], 0 offen offset:2240
    buffer_atomic_add_f32 v42, v5, s[8:11], 0 offen offset:2368
    buffer_atomic_add_f32 v43, v5, s[8:11], 0 offen offset:2496
kvz_a1_kernel_end:
    s_endpgm
.section .rodata,"a"
.p2align 6
.amdhsa_kernel kvz_a1_kernel
  .amdhsa_next_free_vgpr 80
  .amdhsa_next_free_sgpr 40
  .amdhsa_accum_offset 64
  .amdhsa_group_segment_fixed_size 0
  .amdhsa_kernarg_size 104
  .amdhsa_user_sgpr_count 2
  .amdhsa_user_sgpr_kernarg_segment_ptr 1
  .amdhsa_system_sgpr_workgroup_id_x 1
.end_amdhsa_kernel
.text
.globl attn_a1_kernel
.p2align 8
.type attn_a1_kernel,@function
attn_a1_kernel:
    s_cmp_ge_u32 s2, 256
    s_cbranch_scc1 attn_a1_kernel_end
    s_load_dwordx2 s[6:7], s[0:1], 96
    s_waitcnt lgkmcnt(0)
    s_mov_b32 s8, s6
    s_mov_b32 s9, s7
    s_mov_b32 s10, 268435456
    s_mov_b32 s11, 0x00020000
    v_mov_b32 v1, v0
    v_add_u32 v2, 0, v1
    s_mov_b32 s12, 3121
    v_mul_lo_u32 v3, v2, s12
    v_lshrrev_b32 v3, 19, v3
    v_mul_u32_u24 v4, 168, v3
    v_sub_u32 v4, v2, v4
    v_lshlrev_b32 v5, 12, v3
    v_lshlrev_b32 v6, 4, v4
    v_add_u32 v5, v5, v6
    v_add_u32 v5, 23068672, v5
    buffer_load_dwordx4 v[8:11], v5, s[8:11], 0 offen
    v_mul_u32_u24 v7, 2688, v3
    v_add_u32 v7, v7, v6
    s_waitcnt vmcnt(0)
    ds_write_b128 v7, v[8:11]
    v_add_u32 v2, 256, v1
    s_mov_b32 s12, 3121
    v_mul_lo_u32 v3, v2, s12
    v_lshrrev_b32 v3, 19, v3
    v_mul_u32_u24 v4, 168, v3
    v_sub_u32 v4, v2, v4
    v_lshlrev_b32 v5, 12, v3
    v_lshlrev_b32 v6, 4, v4
    v_add_u32 v5, v5, v6
    v_add_u32 v5, 23068672, v5
    buffer_load_dwordx4 v[8:11], v5, s[8:11], 0 offen
    v_mul_u32_u24 v7, 2688, v3
    v_add_u32 v7, v7, v6
    s_waitcnt vmcnt(0)
    ds_write_b128 v7, v[8:11]
    v_add_u32 v2, 512, v1
    s_mov_b32 s12, 3121
    v_mul_lo_u32 v3, v2, s12
    v_lshrrev_b32 v3, 19, v3
    v_mul_u32_u24 v4, 168, v3
    v_sub_u32 v4, v2, v4
    v_lshlrev_b32 v5, 12, v3
    v_lshlrev_b32 v6, 4, v4
    v_add_u32 v5, v5, v6
    v_add_u32 v5, 23068672, v5
    buffer_load_dwordx4 v[8:11], v5, s[8:11], 0 offen
    v_mul_u32_u24 v7, 2688, v3
    v_add_u32 v7, v7, v6
    s_waitcnt vmcnt(0)
    ds_write_b128 v7, v[8:11]
    v_add_u32 v2, 768, v1
    s_mov_b32 s12, 3121
    v_mul_lo_u32 v3, v2, s12
    v_lshrrev_b32 v3, 19, v3
    v_mul_u32_u24 v4, 168, v3
    v_sub_u32 v4, v2, v4
    v_lshlrev_b32 v5, 12, v3
    v_lshlrev_b32 v6, 4, v4
    v_add_u32 v5, v5, v6
    v_add_u32 v5, 23068672, v5
    buffer_load_dwordx4 v[8:11], v5, s[8:11], 0 offen
    v_mul_u32_u24 v7, 2688, v3
    v_add_u32 v7, v7, v6
    s_waitcnt vmcnt(0)
    ds_write_b128 v7, v[8:11]
    v_add_u32 v2, 1024, v1
    s_mov_b32 s12, 3121
    v_mul_lo_u32 v3, v2, s12
    v_lshrrev_b32 v3, 19, v3
    v_mul_u32_u24 v4, 168, v3
    v_sub_u32 v4, v2, v4
    v_lshlrev_b32 v5, 12, v3
    v_lshlrev_b32 v6, 4, v4
    v_add_u32 v5, v5, v6
    v_add_u32 v5, 23068672, v5
    buffer_load_dwordx4 v[8:11], v5, s[8:11], 0 offen
    v_mul_u32_u24 v7, 2688, v3
    v_add_u32 v7, v7, v6
    s_waitcnt vmcnt(0)
    ds_write_b128 v7, v[8:11]
    v_add_u32 v2, 1280, v1
    s_mov_b32 s12, 3121
    v_mul_lo_u32 v3, v2, s12
    v_lshrrev_b32 v3, 19, v3
    v_mul_u32_u24 v4, 168, v3
    v_sub_u32 v4, v2, v4
    v_lshlrev_b32 v5, 12, v3
    v_lshlrev_b32 v6, 4, v4
    v_add_u32 v5, v5, v6
    v_add_u32 v5, 23068672, v5
    buffer_load_dwordx4 v[8:11], v5, s[8:11], 0 offen
    v_mul_u32_u24 v7, 2688, v3
    v_add_u32 v7, v7, v6
    s_waitcnt vmcnt(0)
    ds_write_b128 v7, v[8:11]
    v_add_u32 v2, 1536, v1
    s_mov_b32 s12, 3121
    v_mul_lo_u32 v3, v2, s12
    v_lshrrev_b32 v3, 19, v3
    v_mul_u32_u24 v4, 168, v3
    v_sub_u32 v4, v2, v4
    v_lshlrev_b32 v5, 12, v3
    v_lshlrev_b32 v6, 4, v4
    v_add_u32 v5, v5, v6
    v_add_u32 v5, 23068672, v5
    buffer_load_dwordx4 v[8:11], v5, s[8:11], 0 offen
    v_mul_u32_u24 v7, 2688, v3
    v_add_u32 v7, v7, v6
    s_waitcnt vmcnt(0)
    ds_write_b128 v7, v[8:11]
    v_add_u32 v2, 1792, v1
    s_mov_b32 s12, 3121
    v_mul_lo_u32 v3, v2, s12
    v_lshrrev_b32 v3, 19, v3
    v_mul_u32_u24 v4, 168, v3
    v_sub_u32 v4, v2, v4
    v_lshlrev_b32 v5, 12, v3
    v_lshlrev_b32 v6, 4, v4
    v_add_u32 v5, v5, v6
    v_add_u32 v5, 23068672, v5
    buffer_load_dwordx4 v[8:11], v5, s[8:11], 0 offen
    v_mul_u32_u24 v7, 2688, v3
    v_add_u32 v7, v7, v6
    s_waitcnt vmcnt(0)
    ds_write_b128 v7, v[8:11]
    v_add_u32 v2, 2048, v1
    s_mov_b32 s12, 3121
    v_mul_lo_u32 v3, v2, s12
    v_lshrrev_b32 v3, 19, v3
    v_mul_u32_u24 v4, 168, v3
    v_sub_u32 v4, v2, v4
    v_lshlrev_b32 v5, 12, v3
    v_lshlrev_b32 v6, 4, v4
    v_add_u32 v5, v5, v6
    v_add_u32 v5, 23068672, v5
    buffer_load_dwordx4 v[8:11], v5, s[8:11], 0 offen
    v_mul_u32_u24 v7, 2688, v3
    v_add_u32 v7, v7, v6
    s_waitcnt vmcnt(0)
    ds_write_b128 v7, v[8:11]
    v_add_u32 v2, 2304, v1
    s_mov_b32 s12, 3121
    v_mul_lo_u32 v3, v2, s12
    v_lshrrev_b32 v3, 19, v3
    v_mul_u32_u24 v4, 168, v3
    v_sub_u32 v4, v2, v4
    v_lshlrev_b32 v5, 12, v3
    v_lshlrev_b32 v6, 4, v4
    v_add_u32 v5, v5, v6
    v_add_u32 v5, 23068672, v5
    buffer_load_dwordx4 v[8:11], v5, s[8:11], 0 offen
    v_mul_u32_u24 v7, 2688, v3
    v_add_u32 v7, v7, v6
    s_waitcnt vmcnt(0)
    ds_write_b128 v7, v[8:11]
    v_add_u32 v2, 2560, v1
    s_mov_b32 s12, 3121
    v_mul_lo_u32 v3, v2, s12
    v_lshrrev_b32 v3, 19, v3
    v_mul_u32_u24 v4, 168, v3
    v_sub_u32 v4, v2, v4
    v_lshlrev_b32 v5, 12, v3
    v_lshlrev_b32 v6, 4, v4
    v_add_u32 v5, v5, v6
    v_add_u32 v5, 23068672, v5
    buffer_load_dwordx4 v[8:11], v5, s[8:11], 0 offen
    v_mul_u32_u24 v7, 2688, v3
    v_add_u32 v7, v7, v6
    s_waitcnt vmcnt(0)
    ds_write_b128 v7, v[8:11]
    v_add_u32 v2, 2816, v1
    s_mov_b32 s12, 3121
    v_mul_lo_u32 v3, v2, s12
    v_lshrrev_b32 v3, 19, v3
    v_mul_u32_u24 v4, 168, v3
    v_sub_u32 v4, v2, v4
    v_lshlrev_b32 v5, 12, v3
    v_lshlrev_b32 v6, 4, v4
    v_add_u32 v5, v5, v6
    v_add_u32 v5, 23068672, v5
    buffer_load_dwordx4 v[8:11], v5, s[8:11], 0 offen
    v_mul_u32_u24 v7, 2688, v3
    v_add_u32 v7, v7, v6
    s_waitcnt vmcnt(0)
    ds_write_b128 v7, v[8:11]
    v_add_u32 v2, 3072, v1
    s_mov_b32 s12, 3121
    v_mul_lo_u32 v3, v2, s12
    v_lshrrev_b32 v3, 19, v3
    v_mul_u32_u24 v4, 168, v3
    v_sub_u32 v4, v2, v4
    v_lshlrev_b32 v5, 12, v3
    v_lshlrev_b32 v6, 4, v4
    v_add_u32 v5, v5, v6
    v_add_u32 v5, 23068672, v5
    buffer_load_dwordx4 v[8:11], v5, s[8:11], 0 offen
    v_mul_u32_u24 v7, 2688, v3
    v_add_u32 v7, v7, v6
    s_waitcnt vmcnt(0)
    ds_write_b128 v7, v[8:11]
    v_add_u32 v2, 3328, v1
    s_mov_b32 s12, 3121
    v_mul_lo_u32 v3, v2, s12
    v_lshrrev_b32 v3, 19, v3
    v_mul_u32_u24 v4, 168, v3
    v_sub_u32 v4, v2, v4
    v_lshlrev_b32 v5, 12, v3
    v_lshlrev_b32 v6, 4, v4
    v_add_u32 v5, v5, v6
    v_add_u32 v5, 23068672, v5
    buffer_load_dwordx4 v[8:11], v5, s[8:11], 0 offen
    v_mul_u32_u24 v7, 2688, v3
    v_add_u32 v7, v7, v6
    s_waitcnt vmcnt(0)
    ds_write_b128 v7, v[8:11]
    v_add_u32 v2, 3584, v1
    s_mov_b32 s12, 3121
    v_mul_lo_u32 v3, v2, s12
    v_lshrrev_b32 v3, 19, v3
    v_mul_u32_u24 v4, 168, v3
    v_sub_u32 v4, v2, v4
    v_lshlrev_b32 v5, 12, v3
    v_lshlrev_b32 v6, 4, v4
    v_add_u32 v5, v5, v6
    v_add_u32 v5, 23068672, v5
    buffer_load_dwordx4 v[8:11], v5, s[8:11], 0 offen
    v_mul_u32_u24 v7, 2688, v3
    v_add_u32 v7, v7, v6
    s_waitcnt vmcnt(0)
    ds_write_b128 v7, v[8:11]
    v_add_u32 v2, 3840, v1
    s_mov_b32 s12, 3121
    v_mul_lo_u32 v3, v2, s12
    v_lshrrev_b32 v3, 19, v3
    v_mul_u32_u24 v4, 168, v3
    v_sub_u32 v4, v2, v4
    v_lshlrev_b32 v5, 12, v3
    v_lshlrev_b32 v6, 4, v4
    v_add_u32 v5, v5, v6
    v_add_u32 v5, 23068672, v5
    buffer_load_dwordx4 v[8:11], v5, s[8:11], 0 offen
    v_mul_u32_u24 v7, 2688, v3
    v_add_u32 v7, v7, v6
    s_waitcnt vmcnt(0)
    ds_write_b128 v7, v[8:11]
    v_add_u32 v2, 4096, v1
    s_mov_b32 s12, 3121
    v_mul_lo_u32 v3, v2, s12
    v_lshrrev_b32 v3, 19, v3
    v_mul_u32_u24 v4, 168, v3
    v_sub_u32 v4, v2, v4
    v_lshlrev_b32 v5, 12, v3
    v_lshlrev_b32 v6, 4, v4
    v_add_u32 v5, v5, v6
    v_add_u32 v5, 23068672, v5
    buffer_load_dwordx4 v[8:11], v5, s[8:11], 0 offen
    v_mul_u32_u24 v7, 2688, v3
    v_add_u32 v7, v7, v6
    s_waitcnt vmcnt(0)
    ds_write_b128 v7, v[8:11]
    v_add_u32 v2, 4352, v1
    s_mov_b32 s12, 3121
    v_mul_lo_u32 v3, v2, s12
    v_lshrrev_b32 v3, 19, v3
    v_mul_u32_u24 v4, 168, v3
    v_sub_u32 v4, v2, v4
    v_lshlrev_b32 v5, 12, v3
    v_lshlrev_b32 v6, 4, v4
    v_add_u32 v5, v5, v6
    v_add_u32 v5, 23068672, v5
    buffer_load_dwordx4 v[8:11], v5, s[8:11], 0 offen
    v_mul_u32_u24 v7, 2688, v3
    v_add_u32 v7, v7, v6
    s_waitcnt vmcnt(0)
    ds_write_b128 v7, v[8:11]
    v_add_u32 v2, 4608, v1
    s_mov_b32 s12, 3121
    v_mul_lo_u32 v3, v2, s12
    v_lshrrev_b32 v3, 19, v3
    v_mul_u32_u24 v4, 168, v3
    v_sub_u32 v4, v2, v4
    v_lshlrev_b32 v5, 12, v3
    v_lshlrev_b32 v6, 4, v4
    v_add_u32 v5, v5, v6
    v_add_u32 v5, 23068672, v5
    buffer_load_dwordx4 v[8:11], v5, s[8:11], 0 offen
    v_mul_u32_u24 v7, 2688, v3
    v_add_u32 v7, v7, v6
    s_waitcnt vmcnt(0)
    ds_write_b128 v7, v[8:11]
    v_add_u32 v2, 4864, v1
    s_mov_b32 s12, 3121
    v_mul_lo_u32 v3, v2, s12
    v_lshrrev_b32 v3, 19, v3
    v_mul_u32_u24 v4, 168, v3
    v_sub_u32 v4, v2, v4
    v_lshlrev_b32 v5, 12, v3
    v_lshlrev_b32 v6, 4, v4
    v_add_u32 v5, v5, v6
    v_add_u32 v5, 23068672, v5
    buffer_load_dwordx4 v[8:11], v5, s[8:11], 0 offen
    v_mul_u32_u24 v7, 2688, v3
    v_add_u32 v7, v7, v6
    s_waitcnt vmcnt(0)
    ds_write_b128 v7, v[8:11]
    v_add_u32 v2, 5120, v1
    s_mov_b32 s12, 3121
    v_mul_lo_u32 v3, v2, s12
    v_lshrrev_b32 v3, 19, v3
    v_mul_u32_u24 v4, 168, v3
    v_sub_u32 v4, v2, v4
    v_lshlrev_b32 v5, 12, v3
    v_lshlrev_b32 v6, 4, v4
    v_add_u32 v5, v5, v6
    v_add_u32 v5, 23068672, v5
    buffer_load_dwordx4 v[8:11], v5, s[8:11], 0 offen
    v_mul_u32_u24 v7, 2688, v3
    v_add_u32 v7, v7, v6
    s_waitcnt vmcnt(0)
    ds_write_b128 v7, v[8:11]
    s_waitcnt lgkmcnt(0)
    s_barrier
    v_and_b32 v2, 31, v0
    v_lshrrev_b32 v3, 5, v0
    s_lshl_b32 s12, s2, 3
    v_add_u32 v3, s12, v3
    v_mul_u32_u24 v4, 1280, v3
    v_mul_u32_u24 v5, 40, v2
    v_add_u32 v4, v4, v5
    v_add_u32 v6, 8388608, v4
    buffer_load_dwordx2 v[8:9], v6, s[8:11], 0 offen offset:0
    buffer_load_dwordx2 v[10:11], v6, s[8:11], 0 offen offset:8
    buffer_load_dwordx2 v[12:13], v6, s[8:11], 0 offen offset:16
    buffer_load_dwordx2 v[14:15], v6, s[8:11], 0 offen offset:24
    buffer_load_dwordx2 v[16:17], v6, s[8:11], 0 offen offset:32
    s_waitcnt vmcnt(0)
    v_lshlrev_b32 v40, 16, v8
    v_and_b32 v41, 0xffff0000, v8
    v_mul_f32 v44, 1.4426950408889634, v40
    v_exp_f32 v44, v44
    v_add_f32 v42, 1.0, v40
    v_cmp_lt_f32 vcc, 0, v40
    s_nop 1
    v_cndmask_b32 v42, v44, v42, vcc
    v_add_f32 v42, 0x358637bd, v42
    v_mul_f32 v44, 1.4426950408889634, v41
    v_exp_f32 v44, v44
    v_add_f32 v43, 1.0, v41
    v_cmp_lt_f32 vcc, 0, v41
    s_nop 1
    v_cndmask_b32 v43, v44, v43, vcc
    v_add_f32 v43, 0x358637bd, v43
    v_cvt_pk_bf16_f32 v45, v42, v43
    v_lshlrev_b32 v20, 16, v45
    v_and_b32 v21, 0xffff0000, v45
    v_lshlrev_b32 v40, 16, v9
    v_and_b32 v41, 0xffff0000, v9
    v_mul_f32 v44, 1.4426950408889634, v40
    v_exp_f32 v44, v44
    v_add_f32 v42, 1.0, v40
    v_cmp_lt_f32 vcc, 0, v40
    s_nop 1
    v_cndmask_b32 v42, v44, v42, vcc
    v_add_f32 v42, 0x358637bd, v42
    v_mul_f32 v44, 1.4426950408889634, v41
    v_exp_f32 v44, v44
    v_add_f32 v43, 1.0, v41
    v_cmp_lt_f32 vcc, 0, v41
    s_nop 1
    v_cndmask_b32 v43, v44, v43, vcc
    v_add_f32 v43, 0x358637bd, v43
    v_cvt_pk_bf16_f32 v45, v42, v43
    v_lshlrev_b32 v22, 16, v45
    v_and_b32 v23, 0xffff0000, v45
    v_lshlrev_b32 v40, 16, v10
    v_and_b32 v41, 0xffff0000, v10
    v_mul_f32 v44, 1.4426950408889634, v40
    v_exp_f32 v44, v44
    v_add_f32 v42, 1.0, v40
    v_cmp_lt_f32 vcc, 0, v40
    s_nop 1
    v_cndmask_b32 v42, v44, v42, vcc
    v_add_f32 v42, 0x358637bd, v42
    v_mul_f32 v44, 1.4426950408889634, v41
    v_exp_f32 v44, v44
    v_add_f32 v43, 1.0, v41
    v_cmp_lt_f32 vcc, 0, v41
    s_nop 1
    v_cndmask_b32 v43, v44, v43, vcc
    v_add_f32 v43, 0x358637bd, v43
    v_cvt_pk_bf16_f32 v45, v42, v43
    v_lshlrev_b32 v24, 16, v45
    v_and_b32 v25, 0xffff0000, v45
    v_lshlrev_b32 v40, 16, v11
    v_and_b32 v41, 0xffff0000, v11
    v_mul_f32 v44, 1.4426950408889634, v40
    v_exp_f32 v44, v44
    v_add_f32 v42, 1.0, v40
    v_cmp_lt_f32 vcc, 0, v40
    s_nop 1
    v_cndmask_b32 v42, v44, v42, vcc
    v_add_f32 v42, 0x358637bd, v42
    v_mul_f32 v44, 1.4426950408889634, v41
    v_exp_f32 v44, v44
    v_add_f32 v43, 1.0, v41
    v_cmp_lt_f32 vcc, 0, v41
    s_nop 1
    v_cndmask_b32 v43, v44, v43, vcc
    v_add_f32 v43, 0x358637bd, v43
    v_cvt_pk_bf16_f32 v45, v42, v43
    v_lshlrev_b32 v26, 16, v45
    v_and_b32 v27, 0xffff0000, v45
    v_lshlrev_b32 v40, 16, v12
    v_and_b32 v41, 0xffff0000, v12
    v_mul_f32 v44, 1.4426950408889634, v40
    v_exp_f32 v44, v44
    v_add_f32 v42, 1.0, v40
    v_cmp_lt_f32 vcc, 0, v40
    s_nop 1
    v_cndmask_b32 v42, v44, v42, vcc
    v_add_f32 v42, 0x358637bd, v42
    v_mul_f32 v44, 1.4426950408889634, v41
    v_exp_f32 v44, v44
    v_add_f32 v43, 1.0, v41
    v_cmp_lt_f32 vcc, 0, v41
    s_nop 1
    v_cndmask_b32 v43, v44, v43, vcc
    v_add_f32 v43, 0x358637bd, v43
    v_cvt_pk_bf16_f32 v45, v42, v43
    v_lshlrev_b32 v28, 16, v45
    v_and_b32 v29, 0xffff0000, v45
    v_lshlrev_b32 v40, 16, v13
    v_and_b32 v41, 0xffff0000, v13
    v_mul_f32 v44, 1.4426950408889634, v40
    v_exp_f32 v44, v44
    v_add_f32 v42, 1.0, v40
    v_cmp_lt_f32 vcc, 0, v40
    s_nop 1
    v_cndmask_b32 v42, v44, v42, vcc
    v_add_f32 v42, 0x358637bd, v42
    v_mul_f32 v44, 1.4426950408889634, v41
    v_exp_f32 v44, v44
    v_add_f32 v43, 1.0, v41
    v_cmp_lt_f32 vcc, 0, v41
    s_nop 1
    v_cndmask_b32 v43, v44, v43, vcc
    v_add_f32 v43, 0x358637bd, v43
    v_cvt_pk_bf16_f32 v45, v42, v43
    v_lshlrev_b32 v30, 16, v45
    v_and_b32 v31, 0xffff0000, v45
    v_lshlrev_b32 v40, 16, v14
    v_and_b32 v41, 0xffff0000, v14
    v_mul_f32 v44, 1.4426950408889634, v40
    v_exp_f32 v44, v44
    v_add_f32 v42, 1.0, v40
    v_cmp_lt_f32 vcc, 0, v40
    s_nop 1
    v_cndmask_b32 v42, v44, v42, vcc
    v_add_f32 v42, 0x358637bd, v42
    v_mul_f32 v44, 1.4426950408889634, v41
    v_exp_f32 v44, v44
    v_add_f32 v43, 1.0, v41
    v_cmp_lt_f32 vcc, 0, v41
    s_nop 1
    v_cndmask_b32 v43, v44, v43, vcc
    v_add_f32 v43, 0x358637bd, v43
    v_cvt_pk_bf16_f32 v45, v42, v43
    v_lshlrev_b32 v32, 16, v45
    v_and_b32 v33, 0xffff0000, v45
    v_lshlrev_b32 v40, 16, v15
    v_and_b32 v41, 0xffff0000, v15
    v_mul_f32 v44, 1.4426950408889634, v40
    v_exp_f32 v44, v44
    v_add_f32 v42, 1.0, v40
    v_cmp_lt_f32 vcc, 0, v40
    s_nop 1
    v_cndmask_b32 v42, v44, v42, vcc
    v_add_f32 v42, 0x358637bd, v42
    v_mul_f32 v44, 1.4426950408889634, v41
    v_exp_f32 v44, v44
    v_add_f32 v43, 1.0, v41
    v_cmp_lt_f32 vcc, 0, v41
    s_nop 1
    v_cndmask_b32 v43, v44, v43, vcc
    v_add_f32 v43, 0x358637bd, v43
    v_cvt_pk_bf16_f32 v45, v42, v43
    v_lshlrev_b32 v34, 16, v45
    v_and_b32 v35, 0xffff0000, v45
    v_lshlrev_b32 v40, 16, v16
    v_and_b32 v41, 0xffff0000, v16
    v_mul_f32 v44, 1.4426950408889634, v40
    v_exp_f32 v44, v44
    v_add_f32 v42, 1.0, v40
    v_cmp_lt_f32 vcc, 0, v40
    s_nop 1
    v_cndmask_b32 v42, v44, v42, vcc
    v_add_f32 v42, 0x358637bd, v42
    v_mul_f32 v44, 1.4426950408889634, v41
    v_exp_f32 v44, v44
    v_add_f32 v43, 1.0, v41
    v_cmp_lt_f32 vcc, 0, v41
    s_nop 1
    v_cndmask_b32 v43, v44, v43, vcc
    v_add_f32 v43, 0x358637bd, v43
    v_cvt_pk_bf16_f32 v45, v42, v43
    v_lshlrev_b32 v36, 16, v45
    v_and_b32 v37, 0xffff0000, v45
    v_lshlrev_b32 v40, 16, v17
    v_and_b32 v41, 0xffff0000, v17
    v_mul_f32 v44, 1.4426950408889634, v40
    v_exp_f32 v44, v44
    v_add_f32 v42, 1.0, v40
    v_cmp_lt_f32 vcc, 0, v40
    s_nop 1
    v_cndmask_b32 v42, v44, v42, vcc
    v_add_f32 v42, 0x358637bd, v42
    v_mul_f32 v44, 1.4426950408889634, v41
    v_exp_f32 v44, v44
    v_add_f32 v43, 1.0, v41
    v_cmp_lt_f32 vcc, 0, v41
    s_nop 1
    v_cndmask_b32 v43, v44, v43, vcc
    v_add_f32 v43, 0x358637bd, v43
    v_cvt_pk_bf16_f32 v45, v42, v43
    v_lshlrev_b32 v38, 16, v45
    v_and_b32 v39, 0xffff0000, v45
    v_mul_u32_u24 v7, 2688, v2
    ds_read_b128 v[72:75], v7 offset:0
    ds_read_b128 v[76:79], v7 offset:16
    ds_read_b128 v[80:83], v7 offset:32
    ds_read_b128 v[84:87], v7 offset:48
    ds_read_b128 v[88:91], v7 offset:64
    s_waitcnt lgkmcnt(0)
    v_mul_f32 v50, v20, v72
    v_fmac_f32 v50, v21, v73
    v_fmac_f32 v50, v22, v74
    v_fmac_f32 v50, v23, v75
    v_fmac_f32 v50, v24, v76
    v_fmac_f32 v50, v25, v77
    v_fmac_f32 v50, v26, v78
    v_fmac_f32 v50, v27, v79
    v_fmac_f32 v50, v28, v80
    v_fmac_f32 v50, v29, v81
    v_fmac_f32 v50, v30, v82
    v_fmac_f32 v50, v31, v83
    v_fmac_f32 v50, v32, v84
    v_fmac_f32 v50, v33, v85
    v_fmac_f32 v50, v34, v86
    v_fmac_f32 v50, v35, v87
    v_fmac_f32 v50, v36, v88
    v_fmac_f32 v50, v37, v89
    v_fmac_f32 v50, v38, v90
    v_fmac_f32 v50, v39, v91
    ds_read_b128 v[72:75], v7 offset:128
    ds_read_b128 v[76:79], v7 offset:144
    ds_read_b128 v[80:83], v7 offset:160
    ds_read_b128 v[84:87], v7 offset:176
    ds_read_b128 v[88:91], v7 offset:192
    s_waitcnt lgkmcnt(0)
    v_mul_f32 v51, v20, v72
    v_fmac_f32 v51, v21, v73
    v_fmac_f32 v51, v22, v74
    v_fmac_f32 v51, v23, v75
    v_fmac_f32 v51, v24, v76
    v_fmac_f32 v51, v25, v77
    v_fmac_f32 v51, v26, v78
    v_fmac_f32 v51, v27, v79
    v_fmac_f32 v51, v28, v80
    v_fmac_f32 v51, v29, v81
    v_fmac_f32 v51, v30, v82
    v_fmac_f32 v51, v31, v83
    v_fmac_f32 v51, v32, v84
    v_fmac_f32 v51, v33, v85
    v_fmac_f32 v51, v34, v86
    v_fmac_f32 v51, v35, v87
    v_fmac_f32 v51, v36, v88
    v_fmac_f32 v51, v37, v89
    v_fmac_f32 v51, v38, v90
    v_fmac_f32 v51, v39, v91
    ds_read_b128 v[72:75], v7 offset:256
    ds_read_b128 v[76:79], v7 offset:272
    ds_read_b128 v[80:83], v7 offset:288
    ds_read_b128 v[84:87], v7 offset:304
    ds_read_b128 v[88:91], v7 offset:320
    s_waitcnt lgkmcnt(0)
    v_mul_f32 v52, v20, v72
    v_fmac_f32 v52, v21, v73
    v_fmac_f32 v52, v22, v74
    v_fmac_f32 v52, v23, v75
    v_fmac_f32 v52, v24, v76
    v_fmac_f32 v52, v25, v77
    v_fmac_f32 v52, v26, v78
    v_fmac_f32 v52, v27, v79
    v_fmac_f32 v52, v28, v80
    v_fmac_f32 v52, v29, v81
    v_fmac_f32 v52, v30, v82
    v_fmac_f32 v52, v31, v83
    v_fmac_f32 v52, v32, v84
    v_fmac_f32 v52, v33, v85
    v_fmac_f32 v52, v34, v86
    v_fmac_f32 v52, v35, v87
    v_fmac_f32 v52, v36, v88
    v_fmac_f32 v52, v37, v89
    v_fmac_f32 v52, v38, v90
    v_fmac_f32 v52, v39, v91
    ds_read_b128 v[72:75], v7 offset:384
    ds_read_b128 v[76:79], v7 offset:400
    ds_read_b128 v[80:83], v7 offset:416
    ds_read_b128 v[84:87], v7 offset:432
    ds_read_b128 v[88:91], v7 offset:448
    s_waitcnt lgkmcnt(0)
    v_mul_f32 v53, v20, v72
    v_fmac_f32 v53, v21, v73
    v_fmac_f32 v53, v22, v74
    v_fmac_f32 v53, v23, v75
    v_fmac_f32 v53, v24, v76
    v_fmac_f32 v53, v25, v77
    v_fmac_f32 v53, v26, v78
    v_fmac_f32 v53, v27, v79
    v_fmac_f32 v53, v28, v80
    v_fmac_f32 v53, v29, v81
    v_fmac_f32 v53, v30, v82
    v_fmac_f32 v53, v31, v83
    v_fmac_f32 v53, v32, v84
    v_fmac_f32 v53, v33, v85
    v_fmac_f32 v53, v34, v86
    v_fmac_f32 v53, v35, v87
    v_fmac_f32 v53, v36, v88
    v_fmac_f32 v53, v37, v89
    v_fmac_f32 v53, v38, v90
    v_fmac_f32 v53, v39, v91
    ds_read_b128 v[72:75], v7 offset:512
    ds_read_b128 v[76:79], v7 offset:528
    ds_read_b128 v[80:83], v7 offset:544
    ds_read_b128 v[84:87], v7 offset:560
    ds_read_b128 v[88:91], v7 offset:576
    s_waitcnt lgkmcnt(0)
    v_mul_f32 v54, v20, v72
    v_fmac_f32 v54, v21, v73
    v_fmac_f32 v54, v22, v74
    v_fmac_f32 v54, v23, v75
    v_fmac_f32 v54, v24, v76
    v_fmac_f32 v54, v25, v77
    v_fmac_f32 v54, v26, v78
    v_fmac_f32 v54, v27, v79
    v_fmac_f32 v54, v28, v80
    v_fmac_f32 v54, v29, v81
    v_fmac_f32 v54, v30, v82
    v_fmac_f32 v54, v31, v83
    v_fmac_f32 v54, v32, v84
    v_fmac_f32 v54, v33, v85
    v_fmac_f32 v54, v34, v86
    v_fmac_f32 v54, v35, v87
    v_fmac_f32 v54, v36, v88
    v_fmac_f32 v54, v37, v89
    v_fmac_f32 v54, v38, v90
    v_fmac_f32 v54, v39, v91
    ds_read_b128 v[72:75], v7 offset:640
    ds_read_b128 v[76:79], v7 offset:656
    ds_read_b128 v[80:83], v7 offset:672
    ds_read_b128 v[84:87], v7 offset:688
    ds_read_b128 v[88:91], v7 offset:704
    s_waitcnt lgkmcnt(0)
    v_mul_f32 v55, v20, v72
    v_fmac_f32 v55, v21, v73
    v_fmac_f32 v55, v22, v74
    v_fmac_f32 v55, v23, v75
    v_fmac_f32 v55, v24, v76
    v_fmac_f32 v55, v25, v77
    v_fmac_f32 v55, v26, v78
    v_fmac_f32 v55, v27, v79
    v_fmac_f32 v55, v28, v80
    v_fmac_f32 v55, v29, v81
    v_fmac_f32 v55, v30, v82
    v_fmac_f32 v55, v31, v83
    v_fmac_f32 v55, v32, v84
    v_fmac_f32 v55, v33, v85
    v_fmac_f32 v55, v34, v86
    v_fmac_f32 v55, v35, v87
    v_fmac_f32 v55, v36, v88
    v_fmac_f32 v55, v37, v89
    v_fmac_f32 v55, v38, v90
    v_fmac_f32 v55, v39, v91
    ds_read_b128 v[72:75], v7 offset:768
    ds_read_b128 v[76:79], v7 offset:784
    ds_read_b128 v[80:83], v7 offset:800
    ds_read_b128 v[84:87], v7 offset:816
    ds_read_b128 v[88:91], v7 offset:832
    s_waitcnt lgkmcnt(0)
    v_mul_f32 v56, v20, v72
    v_fmac_f32 v56, v21, v73
    v_fmac_f32 v56, v22, v74
    v_fmac_f32 v56, v23, v75
    v_fmac_f32 v56, v24, v76
    v_fmac_f32 v56, v25, v77
    v_fmac_f32 v56, v26, v78
    v_fmac_f32 v56, v27, v79
    v_fmac_f32 v56, v28, v80
    v_fmac_f32 v56, v29, v81
    v_fmac_f32 v56, v30, v82
    v_fmac_f32 v56, v31, v83
    v_fmac_f32 v56, v32, v84
    v_fmac_f32 v56, v33, v85
    v_fmac_f32 v56, v34, v86
    v_fmac_f32 v56, v35, v87
    v_fmac_f32 v56, v36, v88
    v_fmac_f32 v56, v37, v89
    v_fmac_f32 v56, v38, v90
    v_fmac_f32 v56, v39, v91
    ds_read_b128 v[72:75], v7 offset:896
    ds_read_b128 v[76:79], v7 offset:912
    ds_read_b128 v[80:83], v7 offset:928
    ds_read_b128 v[84:87], v7 offset:944
    ds_read_b128 v[88:91], v7 offset:960
    s_waitcnt lgkmcnt(0)
    v_mul_f32 v57, v20, v72
    v_fmac_f32 v57, v21, v73
    v_fmac_f32 v57, v22, v74
    v_fmac_f32 v57, v23, v75
    v_fmac_f32 v57, v24, v76
    v_fmac_f32 v57, v25, v77
    v_fmac_f32 v57, v26, v78
    v_fmac_f32 v57, v27, v79
    v_fmac_f32 v57, v28, v80
    v_fmac_f32 v57, v29, v81
    v_fmac_f32 v57, v30, v82
    v_fmac_f32 v57, v31, v83
    v_fmac_f32 v57, v32, v84
    v_fmac_f32 v57, v33, v85
    v_fmac_f32 v57, v34, v86
    v_fmac_f32 v57, v35, v87
    v_fmac_f32 v57, v36, v88
    v_fmac_f32 v57, v37, v89
    v_fmac_f32 v57, v38, v90
    v_fmac_f32 v57, v39, v91
    ds_read_b128 v[72:75], v7 offset:1024
    ds_read_b128 v[76:79], v7 offset:1040
    ds_read_b128 v[80:83], v7 offset:1056
    ds_read_b128 v[84:87], v7 offset:1072
    ds_read_b128 v[88:91], v7 offset:1088
    s_waitcnt lgkmcnt(0)
    v_mul_f32 v58, v20, v72
    v_fmac_f32 v58, v21, v73
    v_fmac_f32 v58, v22, v74
    v_fmac_f32 v58, v23, v75
    v_fmac_f32 v58, v24, v76
    v_fmac_f32 v58, v25, v77
    v_fmac_f32 v58, v26, v78
    v_fmac_f32 v58, v27, v79
    v_fmac_f32 v58, v28, v80
    v_fmac_f32 v58, v29, v81
    v_fmac_f32 v58, v30, v82
    v_fmac_f32 v58, v31, v83
    v_fmac_f32 v58, v32, v84
    v_fmac_f32 v58, v33, v85
    v_fmac_f32 v58, v34, v86
    v_fmac_f32 v58, v35, v87
    v_fmac_f32 v58, v36, v88
    v_fmac_f32 v58, v37, v89
    v_fmac_f32 v58, v38, v90
    v_fmac_f32 v58, v39, v91
    ds_read_b128 v[72:75], v7 offset:1152
    ds_read_b128 v[76:79], v7 offset:1168
    ds_read_b128 v[80:83], v7 offset:1184
    ds_read_b128 v[84:87], v7 offset:1200
    ds_read_b128 v[88:91], v7 offset:1216
    s_waitcnt lgkmcnt(0)
    v_mul_f32 v59, v20, v72
    v_fmac_f32 v59, v21, v73
    v_fmac_f32 v59, v22, v74
    v_fmac_f32 v59, v23, v75
    v_fmac_f32 v59, v24, v76
    v_fmac_f32 v59, v25, v77
    v_fmac_f32 v59, v26, v78
    v_fmac_f32 v59, v27, v79
    v_fmac_f32 v59, v28, v80
    v_fmac_f32 v59, v29, v81
    v_fmac_f32 v59, v30, v82
    v_fmac_f32 v59, v31, v83
    v_fmac_f32 v59, v32, v84
    v_fmac_f32 v59, v33, v85
    v_fmac_f32 v59, v34, v86
    v_fmac_f32 v59, v35, v87
    v_fmac_f32 v59, v36, v88
    v_fmac_f32 v59, v37, v89
    v_fmac_f32 v59, v38, v90
    v_fmac_f32 v59, v39, v91
    ds_read_b128 v[72:75], v7 offset:1280
    ds_read_b128 v[76:79], v7 offset:1296
    ds_read_b128 v[80:83], v7 offset:1312
    ds_read_b128 v[84:87], v7 offset:1328
    ds_read_b128 v[88:91], v7 offset:1344
    s_waitcnt lgkmcnt(0)
    v_mul_f32 v60, v20, v72
    v_fmac_f32 v60, v21, v73
    v_fmac_f32 v60, v22, v74
    v_fmac_f32 v60, v23, v75
    v_fmac_f32 v60, v24, v76
    v_fmac_f32 v60, v25, v77
    v_fmac_f32 v60, v26, v78
    v_fmac_f32 v60, v27, v79
    v_fmac_f32 v60, v28, v80
    v_fmac_f32 v60, v29, v81
    v_fmac_f32 v60, v30, v82
    v_fmac_f32 v60, v31, v83
    v_fmac_f32 v60, v32, v84
    v_fmac_f32 v60, v33, v85
    v_fmac_f32 v60, v34, v86
    v_fmac_f32 v60, v35, v87
    v_fmac_f32 v60, v36, v88
    v_fmac_f32 v60, v37, v89
    v_fmac_f32 v60, v38, v90
    v_fmac_f32 v60, v39, v91
    ds_read_b128 v[72:75], v7 offset:1408
    ds_read_b128 v[76:79], v7 offset:1424
    ds_read_b128 v[80:83], v7 offset:1440
    ds_read_b128 v[84:87], v7 offset:1456
    ds_read_b128 v[88:91], v7 offset:1472
    s_waitcnt lgkmcnt(0)
    v_mul_f32 v61, v20, v72
    v_fmac_f32 v61, v21, v73
    v_fmac_f32 v61, v22, v74
    v_fmac_f32 v61, v23, v75
    v_fmac_f32 v61, v24, v76
    v_fmac_f32 v61, v25, v77
    v_fmac_f32 v61, v26, v78
    v_fmac_f32 v61, v27, v79
    v_fmac_f32 v61, v28, v80
    v_fmac_f32 v61, v29, v81
    v_fmac_f32 v61, v30, v82
    v_fmac_f32 v61, v31, v83
    v_fmac_f32 v61, v32, v84
    v_fmac_f32 v61, v33, v85
    v_fmac_f32 v61, v34, v86
    v_fmac_f32 v61, v35, v87
    v_fmac_f32 v61, v36, v88
    v_fmac_f32 v61, v37, v89
    v_fmac_f32 v61, v38, v90
    v_fmac_f32 v61, v39, v91
    ds_read_b128 v[72:75], v7 offset:1536
    ds_read_b128 v[76:79], v7 offset:1552
    ds_read_b128 v[80:83], v7 offset:1568
    ds_read_b128 v[84:87], v7 offset:1584
    ds_read_b128 v[88:91], v7 offset:1600
    s_waitcnt lgkmcnt(0)
    v_mul_f32 v62, v20, v72
    v_fmac_f32 v62, v21, v73
    v_fmac_f32 v62, v22, v74
    v_fmac_f32 v62, v23, v75
    v_fmac_f32 v62, v24, v76
    v_fmac_f32 v62, v25, v77
    v_fmac_f32 v62, v26, v78
    v_fmac_f32 v62, v27, v79
    v_fmac_f32 v62, v28, v80
    v_fmac_f32 v62, v29, v81
    v_fmac_f32 v62, v30, v82
    v_fmac_f32 v62, v31, v83
    v_fmac_f32 v62, v32, v84
    v_fmac_f32 v62, v33, v85
    v_fmac_f32 v62, v34, v86
    v_fmac_f32 v62, v35, v87
    v_fmac_f32 v62, v36, v88
    v_fmac_f32 v62, v37, v89
    v_fmac_f32 v62, v38, v90
    v_fmac_f32 v62, v39, v91
    ds_read_b128 v[72:75], v7 offset:1664
    ds_read_b128 v[76:79], v7 offset:1680
    ds_read_b128 v[80:83], v7 offset:1696
    ds_read_b128 v[84:87], v7 offset:1712
    ds_read_b128 v[88:91], v7 offset:1728
    s_waitcnt lgkmcnt(0)
    v_mul_f32 v63, v20, v72
    v_fmac_f32 v63, v21, v73
    v_fmac_f32 v63, v22, v74
    v_fmac_f32 v63, v23, v75
    v_fmac_f32 v63, v24, v76
    v_fmac_f32 v63, v25, v77
    v_fmac_f32 v63, v26, v78
    v_fmac_f32 v63, v27, v79
    v_fmac_f32 v63, v28, v80
    v_fmac_f32 v63, v29, v81
    v_fmac_f32 v63, v30, v82
    v_fmac_f32 v63, v31, v83
    v_fmac_f32 v63, v32, v84
    v_fmac_f32 v63, v33, v85
    v_fmac_f32 v63, v34, v86
    v_fmac_f32 v63, v35, v87
    v_fmac_f32 v63, v36, v88
    v_fmac_f32 v63, v37, v89
    v_fmac_f32 v63, v38, v90
    v_fmac_f32 v63, v39, v91
    ds_read_b128 v[72:75], v7 offset:1792
    ds_read_b128 v[76:79], v7 offset:1808
    ds_read_b128 v[80:83], v7 offset:1824
    ds_read_b128 v[84:87], v7 offset:1840
    ds_read_b128 v[88:91], v7 offset:1856
    s_waitcnt lgkmcnt(0)
    v_mul_f32 v64, v20, v72
    v_fmac_f32 v64, v21, v73
    v_fmac_f32 v64, v22, v74
    v_fmac_f32 v64, v23, v75
    v_fmac_f32 v64, v24, v76
    v_fmac_f32 v64, v25, v77
    v_fmac_f32 v64, v26, v78
    v_fmac_f32 v64, v27, v79
    v_fmac_f32 v64, v28, v80
    v_fmac_f32 v64, v29, v81
    v_fmac_f32 v64, v30, v82
    v_fmac_f32 v64, v31, v83
    v_fmac_f32 v64, v32, v84
    v_fmac_f32 v64, v33, v85
    v_fmac_f32 v64, v34, v86
    v_fmac_f32 v64, v35, v87
    v_fmac_f32 v64, v36, v88
    v_fmac_f32 v64, v37, v89
    v_fmac_f32 v64, v38, v90
    v_fmac_f32 v64, v39, v91
    ds_read_b128 v[72:75], v7 offset:1920
    ds_read_b128 v[76:79], v7 offset:1936
    ds_read_b128 v[80:83], v7 offset:1952
    ds_read_b128 v[84:87], v7 offset:1968
    ds_read_b128 v[88:91], v7 offset:1984
    s_waitcnt lgkmcnt(0)
    v_mul_f32 v65, v20, v72
    v_fmac_f32 v65, v21, v73
    v_fmac_f32 v65, v22, v74
    v_fmac_f32 v65, v23, v75
    v_fmac_f32 v65, v24, v76
    v_fmac_f32 v65, v25, v77
    v_fmac_f32 v65, v26, v78
    v_fmac_f32 v65, v27, v79
    v_fmac_f32 v65, v28, v80
    v_fmac_f32 v65, v29, v81
    v_fmac_f32 v65, v30, v82
    v_fmac_f32 v65, v31, v83
    v_fmac_f32 v65, v32, v84
    v_fmac_f32 v65, v33, v85
    v_fmac_f32 v65, v34, v86
    v_fmac_f32 v65, v35, v87
    v_fmac_f32 v65, v36, v88
    v_fmac_f32 v65, v37, v89
    v_fmac_f32 v65, v38, v90
    v_fmac_f32 v65, v39, v91
    ds_read_b128 v[72:75], v7 offset:2048
    ds_read_b128 v[76:79], v7 offset:2064
    ds_read_b128 v[80:83], v7 offset:2080
    ds_read_b128 v[84:87], v7 offset:2096
    ds_read_b128 v[88:91], v7 offset:2112
    s_waitcnt lgkmcnt(0)
    v_mul_f32 v66, v20, v72
    v_fmac_f32 v66, v21, v73
    v_fmac_f32 v66, v22, v74
    v_fmac_f32 v66, v23, v75
    v_fmac_f32 v66, v24, v76
    v_fmac_f32 v66, v25, v77
    v_fmac_f32 v66, v26, v78
    v_fmac_f32 v66, v27, v79
    v_fmac_f32 v66, v28, v80
    v_fmac_f32 v66, v29, v81
    v_fmac_f32 v66, v30, v82
    v_fmac_f32 v66, v31, v83
    v_fmac_f32 v66, v32, v84
    v_fmac_f32 v66, v33, v85
    v_fmac_f32 v66, v34, v86
    v_fmac_f32 v66, v35, v87
    v_fmac_f32 v66, v36, v88
    v_fmac_f32 v66, v37, v89
    v_fmac_f32 v66, v38, v90
    v_fmac_f32 v66, v39, v91
    ds_read_b128 v[72:75], v7 offset:2176
    ds_read_b128 v[76:79], v7 offset:2192
    ds_read_b128 v[80:83], v7 offset:2208
    ds_read_b128 v[84:87], v7 offset:2224
    ds_read_b128 v[88:91], v7 offset:2240
    s_waitcnt lgkmcnt(0)
    v_mul_f32 v67, v20, v72
    v_fmac_f32 v67, v21, v73
    v_fmac_f32 v67, v22, v74
    v_fmac_f32 v67, v23, v75
    v_fmac_f32 v67, v24, v76
    v_fmac_f32 v67, v25, v77
    v_fmac_f32 v67, v26, v78
    v_fmac_f32 v67, v27, v79
    v_fmac_f32 v67, v28, v80
    v_fmac_f32 v67, v29, v81
    v_fmac_f32 v67, v30, v82
    v_fmac_f32 v67, v31, v83
    v_fmac_f32 v67, v32, v84
    v_fmac_f32 v67, v33, v85
    v_fmac_f32 v67, v34, v86
    v_fmac_f32 v67, v35, v87
    v_fmac_f32 v67, v36, v88
    v_fmac_f32 v67, v37, v89
    v_fmac_f32 v67, v38, v90
    v_fmac_f32 v67, v39, v91
    ds_read_b128 v[72:75], v7 offset:2304
    ds_read_b128 v[76:79], v7 offset:2320
    ds_read_b128 v[80:83], v7 offset:2336
    ds_read_b128 v[84:87], v7 offset:2352
    ds_read_b128 v[88:91], v7 offset:2368
    s_waitcnt lgkmcnt(0)
    v_mul_f32 v68, v20, v72
    v_fmac_f32 v68, v21, v73
    v_fmac_f32 v68, v22, v74
    v_fmac_f32 v68, v23, v75
    v_fmac_f32 v68, v24, v76
    v_fmac_f32 v68, v25, v77
    v_fmac_f32 v68, v26, v78
    v_fmac_f32 v68, v27, v79
    v_fmac_f32 v68, v28, v80
    v_fmac_f32 v68, v29, v81
    v_fmac_f32 v68, v30, v82
    v_fmac_f32 v68, v31, v83
    v_fmac_f32 v68, v32, v84
    v_fmac_f32 v68, v33, v85
    v_fmac_f32 v68, v34, v86
    v_fmac_f32 v68, v35, v87
    v_fmac_f32 v68, v36, v88
    v_fmac_f32 v68, v37, v89
    v_fmac_f32 v68, v38, v90
    v_fmac_f32 v68, v39, v91
    ds_read_b128 v[72:75], v7 offset:2432
    ds_read_b128 v[76:79], v7 offset:2448
    ds_read_b128 v[80:83], v7 offset:2464
    ds_read_b128 v[84:87], v7 offset:2480
    ds_read_b128 v[88:91], v7 offset:2496
    s_waitcnt lgkmcnt(0)
    v_mul_f32 v69, v20, v72
    v_fmac_f32 v69, v21, v73
    v_fmac_f32 v69, v22, v74
    v_fmac_f32 v69, v23, v75
    v_fmac_f32 v69, v24, v76
    v_fmac_f32 v69, v25, v77
    v_fmac_f32 v69, v26, v78
    v_fmac_f32 v69, v27, v79
    v_fmac_f32 v69, v28, v80
    v_fmac_f32 v69, v29, v81
    v_fmac_f32 v69, v30, v82
    v_fmac_f32 v69, v31, v83
    v_fmac_f32 v69, v32, v84
    v_fmac_f32 v69, v33, v85
    v_fmac_f32 v69, v34, v86
    v_fmac_f32 v69, v35, v87
    v_fmac_f32 v69, v36, v88
    v_fmac_f32 v69, v37, v89
    v_fmac_f32 v69, v38, v90
    v_fmac_f32 v69, v39, v91
    ds_read_b128 v[72:75], v7 offset:2560
    ds_read_b128 v[76:79], v7 offset:2576
    ds_read_b128 v[80:83], v7 offset:2592
    ds_read_b128 v[84:87], v7 offset:2608
    ds_read_b128 v[88:91], v7 offset:2624
    s_waitcnt lgkmcnt(0)
    v_mul_f32 v70, v20, v72
    v_fmac_f32 v70, v21, v73
    v_fmac_f32 v70, v22, v74
    v_fmac_f32 v70, v23, v75
    v_fmac_f32 v70, v24, v76
    v_fmac_f32 v70, v25, v77
    v_fmac_f32 v70, v26, v78
    v_fmac_f32 v70, v27, v79
    v_fmac_f32 v70, v28, v80
    v_fmac_f32 v70, v29, v81
    v_fmac_f32 v70, v30, v82
    v_fmac_f32 v70, v31, v83
    v_fmac_f32 v70, v32, v84
    v_fmac_f32 v70, v33, v85
    v_fmac_f32 v70, v34, v86
    v_fmac_f32 v70, v35, v87
    v_fmac_f32 v70, v36, v88
    v_fmac_f32 v70, v37, v89
    v_fmac_f32 v70, v38, v90
    v_fmac_f32 v70, v39, v91
    v_add_f32 v70, 0x358637bd, v70
    v_rcp_f32 v70, v70
    s_nop 0
    v_mul_f32 v50, v50, v70
    v_mul_f32 v51, v51, v70
    v_mul_f32 v52, v52, v70
    v_mul_f32 v53, v53, v70
    v_mul_f32 v54, v54, v70
    v_mul_f32 v55, v55, v70
    v_mul_f32 v56, v56, v70
    v_mul_f32 v57, v57, v70
    v_mul_f32 v58, v58, v70
    v_mul_f32 v59, v59, v70
    v_mul_f32 v60, v60, v70
    v_mul_f32 v61, v61, v70
    v_mul_f32 v62, v62, v70
    v_mul_f32 v63, v63, v70
    v_mul_f32 v64, v64, v70
    v_mul_f32 v65, v65, v70
    v_mul_f32 v66, v66, v70
    v_mul_f32 v67, v67, v70
    v_mul_f32 v68, v68, v70
    v_mul_f32 v69, v69, v70
    v_cvt_pk_bf16_f32 v8, v50, v51
    v_cvt_pk_bf16_f32 v9, v52, v53
    v_cvt_pk_bf16_f32 v10, v54, v55
    v_cvt_pk_bf16_f32 v11, v56, v57
    v_cvt_pk_bf16_f32 v12, v58, v59
    v_cvt_pk_bf16_f32 v13, v60, v61
    v_cvt_pk_bf16_f32 v14, v62, v63
    v_cvt_pk_bf16_f32 v15, v64, v65
    v_cvt_pk_bf16_f32 v16, v66, v67
    v_cvt_pk_bf16_f32 v17, v68, v69
    v_add_u32 v6, 18874368, v4
    buffer_store_dwordx2 v[8:9], v6, s[8:11], 0 offen offset:0
    buffer_store_dwordx2 v[10:11], v6, s[8:11], 0 offen offset:8
    buffer_store_dwordx2 v[12:13], v6, s[8:11], 0 offen offset:16
    buffer_store_dwordx2 v[14:15], v6, s[8:11], 0 offen offset:24
    buffer_store_dwordx2 v[16:17], v6, s[8:11], 0 offen offset:32
attn_a1_kernel_end:
    s_endpgm
.section .rodata,"a"
.p2align 6
.amdhsa_kernel attn_a1_kernel
  .amdhsa_next_free_vgpr 96
  .amdhsa_next_free_sgpr 40
  .amdhsa_accum_offset 96
  .amdhsa_group_segment_fixed_size 0
  .amdhsa_kernarg_size 104
  .amdhsa_user_sgpr_count 2
  .amdhsa_user_sgpr_kernarg_segment_ptr 1
  .amdhsa_system_sgpr_workgroup_id_x 1
.end_amdhsa_kernel
.text
.globl wo_a1_kernel
.p2align 8
.type wo_a1_kernel,@function
wo_a1_kernel:
    v_lshrrev_b32 v1, 6, v0
    v_and_b32 v2, 63, v0
    s_nop 0
    v_readfirstlane_b32 s3, v1
    s_cmp_ge_u32 s2, 128
    s_cbranch_scc1 wo_a1_kernel_end
    s_load_dwordx2 s[4:5], s[0:1], 96
    s_load_dwordx2 s[6:7], s[0:1], 80
    s_load_dwordx2 s[42:43], s[0:1], 0
    s_mul_i32 s20, s2, 1
    s_lshr_b32 s20, s20, 3
    s_mul_i32 s21, s20, 8
    s_sub_u32 s21, s2, s21
    s_lshl_b32 s20, s20, 2
    s_add_u32 s20, s20, s3
    s_mul_i32 s22, s20, 32
    s_mul_i32 s23, s21, 80
    s_waitcnt lgkmcnt(0)
    s_mov_b32 s8, s4
    s_mov_b32 s9, s5
    s_mov_b32 s10, 268435456
    s_mov_b32 s11, 0x00020000
    v_and_b32 v3, 15, v2
    v_lshrrev_b32 v4, 4, v2
    s_mov_b32 s24, 1280
    v_add_u32 v5, s22, v3
    v_mul_lo_u32 v5, v5, s24
    v_lshlrev_b32 v6, 4, v4
    v_add_u32 v5, v5, v6
    v_add_u32 v5, 18874368, v5
    v_mov_b32 v8, v5
    v_add_u32 v9, 20480, v5
    v_lshlrev_b32 v7, 4, v2
    s_mov_b32 s25, 0
    s_mov_b32 s26, 0
    s_mul_i32 s27, s21, 102400
    s_add_u32 s27, s27, s26
    s_add_u32 s27, s27, 29360128
    s_add_u32 s32, s27, 0
    s_add_u32 s33, s27, 20480
    s_add_u32 s34, s27, 40960
    s_add_u32 s35, s27, 61440
    s_add_u32 s36, s27, 81920
    v_accvgpr_write_b32 a0, 0
    v_accvgpr_write_b32 a1, 0
    v_accvgpr_write_b32 a2, 0
    v_accvgpr_write_b32 a3, 0
    v_accvgpr_write_b32 a4, 0
    v_accvgpr_write_b32 a5, 0
    v_accvgpr_write_b32 a6, 0
    v_accvgpr_write_b32 a7, 0
    v_accvgpr_write_b32 a8, 0
    v_accvgpr_write_b32 a9, 0
    v_accvgpr_write_b32 a10, 0
    v_accvgpr_write_b32 a11, 0
    v_accvgpr_write_b32 a12, 0
    v_accvgpr_write_b32 a13, 0
    v_accvgpr_write_b32 a14, 0
    v_accvgpr_write_b32 a15, 0
    v_accvgpr_write_b32 a16, 0
    v_accvgpr_write_b32 a17, 0
    v_accvgpr_write_b32 a18, 0
    v_accvgpr_write_b32 a19, 0
    v_accvgpr_write_b32 a20, 0
    v_accvgpr_write_b32 a21, 0
    v_accvgpr_write_b32 a22, 0
    v_accvgpr_write_b32 a23, 0
    v_accvgpr_write_b32 a24, 0
    v_accvgpr_write_b32 a25, 0
    v_accvgpr_write_b32 a26, 0
    v_accvgpr_write_b32 a27, 0
    v_accvgpr_write_b32 a28, 0
    v_accvgpr_write_b32 a29, 0
    v_accvgpr_write_b32 a30, 0
    v_accvgpr_write_b32 a31, 0
    v_accvgpr_write_b32 a32, 0
    v_accvgpr_write_b32 a33, 0
    v_accvgpr_write_b32 a34, 0
    v_accvgpr_write_b32 a35, 0
    v_accvgpr_write_b32 a36, 0
    v_accvgpr_write_b32 a37, 0
    v_accvgpr_write_b32 a38, 0
    v_accvgpr_write_b32 a39, 0
    buffer_load_dwordx4 v[16:19], v8, s[8:11], s25 offen
    buffer_load_dwordx4 v[20:23], v9, s[8:11], s25 offen
    buffer_load_dwordx4 v[24:27], v7, s[8:11], s32 offen
    buffer_load_dwordx4 v[28:31], v7, s[8:11], s33 offen
    buffer_load_dwordx4 v[32:35], v7, s[8:11], s34 offen
    buffer_load_dwordx4 v[36:39], v7, s[8:11], s35 offen
    buffer_load_dwordx4 v[40:43], v7, s[8:11], s36 offen
    s_mov_b32 s28, 10
wo_a1_kernel_loop0:
    s_add_u32 s25, s25, 64
    s_add_u32 s32, s32, 1024
    s_add_u32 s33, s33, 1024
    s_add_u32 s34, s34, 1024
    s_add_u32 s35, s35, 1024
    s_add_u32 s36, s36, 1024
    buffer_load_dwordx4 v[44:47], v8, s[8:11], s25 offen
    buffer_load_dwordx4 v[48:51], v9, s[8:11], s25 offen
    buffer_load_dwordx4 v[52:55], v7, s[8:11], s32 offen
    buffer_load_dwordx4 v[56:59], v7, s[8:11], s33 offen
    buffer_load_dwordx4 v[60:63], v7, s[8:11], s34 offen
    buffer_load_dwordx4 v[64:67], v7, s[8:11], s35 offen
    buffer_load_dwordx4 v[68:71], v7, s[8:11], s36 offen
    s_waitcnt vmcnt(7)
    v_mfma_f32_16x16x32_bf16 a[0:3], v[24:27], v[16:19], a[0:3]
    v_mfma_f32_16x16x32_bf16 a[20:23], v[24:27], v[20:23], a[20:23]
    v_mfma_f32_16x16x32_bf16 a[4:7], v[28:31], v[16:19], a[4:7]
    v_mfma_f32_16x16x32_bf16 a[24:27], v[28:31], v[20:23], a[24:27]
    v_mfma_f32_16x16x32_bf16 a[8:11], v[32:35], v[16:19], a[8:11]
    v_mfma_f32_16x16x32_bf16 a[28:31], v[32:35], v[20:23], a[28:31]
    v_mfma_f32_16x16x32_bf16 a[12:15], v[36:39], v[16:19], a[12:15]
    v_mfma_f32_16x16x32_bf16 a[32:35], v[36:39], v[20:23], a[32:35]
    v_mfma_f32_16x16x32_bf16 a[16:19], v[40:43], v[16:19], a[16:19]
    v_mfma_f32_16x16x32_bf16 a[36:39], v[40:43], v[20:23], a[36:39]
    s_sub_u32 s28, s28, 1
    s_cmp_eq_u32 s28, 0
    s_cbranch_scc1 wo_a1_kernel_loop0_last
    s_add_u32 s25, s25, 64
    s_add_u32 s32, s32, 1024
    s_add_u32 s33, s33, 1024
    s_add_u32 s34, s34, 1024
    s_add_u32 s35, s35, 1024
    s_add_u32 s36, s36, 1024
    buffer_load_dwordx4 v[16:19], v8, s[8:11], s25 offen
    buffer_load_dwordx4 v[20:23], v9, s[8:11], s25 offen
    buffer_load_dwordx4 v[24:27], v7, s[8:11], s32 offen
    buffer_load_dwordx4 v[28:31], v7, s[8:11], s33 offen
    buffer_load_dwordx4 v[32:35], v7, s[8:11], s34 offen
    buffer_load_dwordx4 v[36:39], v7, s[8:11], s35 offen
    buffer_load_dwordx4 v[40:43], v7, s[8:11], s36 offen
    s_waitcnt vmcnt(7)
    v_mfma_f32_16x16x32_bf16 a[0:3], v[52:55], v[44:47], a[0:3]
    v_mfma_f32_16x16x32_bf16 a[20:23], v[52:55], v[48:51], a[20:23]
    v_mfma_f32_16x16x32_bf16 a[4:7], v[56:59], v[44:47], a[4:7]
    v_mfma_f32_16x16x32_bf16 a[24:27], v[56:59], v[48:51], a[24:27]
    v_mfma_f32_16x16x32_bf16 a[8:11], v[60:63], v[44:47], a[8:11]
    v_mfma_f32_16x16x32_bf16 a[28:31], v[60:63], v[48:51], a[28:31]
    v_mfma_f32_16x16x32_bf16 a[12:15], v[64:67], v[44:47], a[12:15]
    v_mfma_f32_16x16x32_bf16 a[32:35], v[64:67], v[48:51], a[32:35]
    v_mfma_f32_16x16x32_bf16 a[16:19], v[68:71], v[44:47], a[16:19]
    v_mfma_f32_16x16x32_bf16 a[36:39], v[68:71], v[48:51], a[36:39]
    s_branch wo_a1_kernel_loop0
wo_a1_kernel_loop0_last:
    s_waitcnt vmcnt(0)
    v_mfma_f32_16x16x32_bf16 a[0:3], v[52:55], v[44:47], a[0:3]
    v_mfma_f32_16x16x32_bf16 a[20:23], v[52:55], v[48:51], a[20:23]
    v_mfma_f32_16x16x32_bf16 a[4:7], v[56:59], v[44:47], a[4:7]
    v_mfma_f32_16x16x32_bf16 a[24:27], v[56:59], v[48:51], a[24:27]
    v_mfma_f32_16x16x32_bf16 a[8:11], v[60:63], v[44:47], a[8:11]
    v_mfma_f32_16x16x32_bf16 a[28:31], v[60:63], v[48:51], a[28:31]
    v_mfma_f32_16x16x32_bf16 a[12:15], v[64:67], v[44:47], a[12:15]
    v_mfma_f32_16x16x32_bf16 a[32:35], v[64:67], v[48:51], a[32:35]
    v_mfma_f32_16x16x32_bf16 a[16:19], v[68:71], v[44:47], a[16:19]
    v_mfma_f32_16x16x32_bf16 a[36:39], v[68:71], v[48:51], a[36:39]
    s_nop 7
    s_nop 7
    s_mov_b32 s44, s42
    s_mov_b32 s45, s43
    s_mov_b32 s46, 2621440
    s_mov_b32 s47, 0x00020000
    s_mov_b32 s24, 1280
    v_add_u32 v5, s22, v3
    v_mul_lo_u32 v5, v5, s24
    v_lshlrev_b32 v6, 3, v4
    s_lshl_b32 s29, s23, 1
    v_add3_u32 v5, v5, v6, s29
    v_add_u32 v6, 0, v5
    buffer_load_dwordx2 v[72:73], v6, s[44:47], 0 offen
    v_accvgpr_read_b32 v76, a0
    v_accvgpr_read_b32 v77, a1
    v_accvgpr_read_b32 v78, a2
    v_accvgpr_read_b32 v79, a3
    v_cvt_pk_bf16_f32 v80, v76, v77
    v_cvt_pk_bf16_f32 v81, v78, v79
    s_waitcnt vmcnt(0)
    v_lshlrev_b32 v76, 16, v80
    v_and_b32 v77, 0xffff0000, v80
    v_lshlrev_b32 v82, 16, v72
    v_and_b32 v83, 0xffff0000, v72
    v_add_f32 v76, v76, v82
    v_add_f32 v77, v77, v83
    v_lshlrev_b32 v78, 16, v81
    v_and_b32 v79, 0xffff0000, v81
    v_lshlrev_b32 v82, 16, v73
    v_and_b32 v83, 0xffff0000, v73
    v_add_f32 v78, v78, v82
    v_add_f32 v79, v79, v83
    v_cvt_pk_bf16_f32 v80, v76, v77
    v_cvt_pk_bf16_f32 v81, v78, v79
    v_add_u32 v6, 4194304, v5
    buffer_store_dwordx2 v[80:81], v6, s[8:11], 0 offen
    v_add_u32 v6, 32, v5
    buffer_load_dwordx2 v[72:73], v6, s[44:47], 0 offen
    v_accvgpr_read_b32 v76, a4
    v_accvgpr_read_b32 v77, a5
    v_accvgpr_read_b32 v78, a6
    v_accvgpr_read_b32 v79, a7
    v_cvt_pk_bf16_f32 v80, v76, v77
    v_cvt_pk_bf16_f32 v81, v78, v79
    s_waitcnt vmcnt(0)
    v_lshlrev_b32 v76, 16, v80
    v_and_b32 v77, 0xffff0000, v80
    v_lshlrev_b32 v82, 16, v72
    v_and_b32 v83, 0xffff0000, v72
    v_add_f32 v76, v76, v82
    v_add_f32 v77, v77, v83
    v_lshlrev_b32 v78, 16, v81
    v_and_b32 v79, 0xffff0000, v81
    v_lshlrev_b32 v82, 16, v73
    v_and_b32 v83, 0xffff0000, v73
    v_add_f32 v78, v78, v82
    v_add_f32 v79, v79, v83
    v_cvt_pk_bf16_f32 v80, v76, v77
    v_cvt_pk_bf16_f32 v81, v78, v79
    v_add_u32 v6, 4194336, v5
    buffer_store_dwordx2 v[80:81], v6, s[8:11], 0 offen
    v_add_u32 v6, 64, v5
    buffer_load_dwordx2 v[72:73], v6, s[44:47], 0 offen
    v_accvgpr_read_b32 v76, a8
    v_accvgpr_read_b32 v77, a9
    v_accvgpr_read_b32 v78, a10
    v_accvgpr_read_b32 v79, a11
    v_cvt_pk_bf16_f32 v80, v76, v77
    v_cvt_pk_bf16_f32 v81, v78, v79
    s_waitcnt vmcnt(0)
    v_lshlrev_b32 v76, 16, v80
    v_and_b32 v77, 0xffff0000, v80
    v_lshlrev_b32 v82, 16, v72
    v_and_b32 v83, 0xffff0000, v72
    v_add_f32 v76, v76, v82
    v_add_f32 v77, v77, v83
    v_lshlrev_b32 v78, 16, v81
    v_and_b32 v79, 0xffff0000, v81
    v_lshlrev_b32 v82, 16, v73
    v_and_b32 v83, 0xffff0000, v73
    v_add_f32 v78, v78, v82
    v_add_f32 v79, v79, v83
    v_cvt_pk_bf16_f32 v80, v76, v77
    v_cvt_pk_bf16_f32 v81, v78, v79
    v_add_u32 v6, 4194368, v5
    buffer_store_dwordx2 v[80:81], v6, s[8:11], 0 offen
    v_add_u32 v6, 96, v5
    buffer_load_dwordx2 v[72:73], v6, s[44:47], 0 offen
    v_accvgpr_read_b32 v76, a12
    v_accvgpr_read_b32 v77, a13
    v_accvgpr_read_b32 v78, a14
    v_accvgpr_read_b32 v79, a15
    v_cvt_pk_bf16_f32 v80, v76, v77
    v_cvt_pk_bf16_f32 v81, v78, v79
    s_waitcnt vmcnt(0)
    v_lshlrev_b32 v76, 16, v80
    v_and_b32 v77, 0xffff0000, v80
    v_lshlrev_b32 v82, 16, v72
    v_and_b32 v83, 0xffff0000, v72
    v_add_f32 v76, v76, v82
    v_add_f32 v77, v77, v83
    v_lshlrev_b32 v78, 16, v81
    v_and_b32 v79, 0xffff0000, v81
    v_lshlrev_b32 v82, 16, v73
    v_and_b32 v83, 0xffff0000, v73
    v_add_f32 v78, v78, v82
    v_add_f32 v79, v79, v83
    v_cvt_pk_bf16_f32 v80, v76, v77
    v_cvt_pk_bf16_f32 v81, v78, v79
    v_add_u32 v6, 4194400, v5
    buffer_store_dwordx2 v[80:81], v6, s[8:11], 0 offen
    v_add_u32 v6, 128, v5
    buffer_load_dwordx2 v[72:73], v6, s[44:47], 0 offen
    v_accvgpr_read_b32 v76, a16
    v_accvgpr_read_b32 v77, a17
    v_accvgpr_read_b32 v78, a18
    v_accvgpr_read_b32 v79, a19
    v_cvt_pk_bf16_f32 v80, v76, v77
    v_cvt_pk_bf16_f32 v81, v78, v79
    s_waitcnt vmcnt(0)
    v_lshlrev_b32 v76, 16, v80
    v_and_b32 v77, 0xffff0000, v80
    v_lshlrev_b32 v82, 16, v72
    v_and_b32 v83, 0xffff0000, v72
    v_add_f32 v76, v76, v82
    v_add_f32 v77, v77, v83
    v_lshlrev_b32 v78, 16, v81
    v_and_b32 v79, 0xffff0000, v81
    v_lshlrev_b32 v82, 16, v73
    v_and_b32 v83, 0xffff0000, v73
    v_add_f32 v78, v78, v82
    v_add_f32 v79, v79, v83
    v_cvt_pk_bf16_f32 v80, v76, v77
    v_cvt_pk_bf16_f32 v81, v78, v79
    v_add_u32 v6, 4194432, v5
    buffer_store_dwordx2 v[80:81], v6, s[8:11], 0 offen
    v_add_u32 v6, 20480, v5
    buffer_load_dwordx2 v[72:73], v6, s[44:47], 0 offen
    v_accvgpr_read_b32 v76, a20
    v_accvgpr_read_b32 v77, a21
    v_accvgpr_read_b32 v78, a22
    v_accvgpr_read_b32 v79, a23
    v_cvt_pk_bf16_f32 v80, v76, v77
    v_cvt_pk_bf16_f32 v81, v78, v79
    s_waitcnt vmcnt(0)
    v_lshlrev_b32 v76, 16, v80
    v_and_b32 v77, 0xffff0000, v80
    v_lshlrev_b32 v82, 16, v72
    v_and_b32 v83, 0xffff0000, v72
    v_add_f32 v76, v76, v82
    v_add_f32 v77, v77, v83
    v_lshlrev_b32 v78, 16, v81
    v_and_b32 v79, 0xffff0000, v81
    v_lshlrev_b32 v82, 16, v73
    v_and_b32 v83, 0xffff0000, v73
    v_add_f32 v78, v78, v82
    v_add_f32 v79, v79, v83
    v_cvt_pk_bf16_f32 v80, v76, v77
    v_cvt_pk_bf16_f32 v81, v78, v79
    v_add_u32 v6, 4214784, v5
    buffer_store_dwordx2 v[80:81], v6, s[8:11], 0 offen
    v_add_u32 v6, 20512, v5
    buffer_load_dwordx2 v[72:73], v6, s[44:47], 0 offen
    v_accvgpr_read_b32 v76, a24
    v_accvgpr_read_b32 v77, a25
    v_accvgpr_read_b32 v78, a26
    v_accvgpr_read_b32 v79, a27
    v_cvt_pk_bf16_f32 v80, v76, v77
    v_cvt_pk_bf16_f32 v81, v78, v79
    s_waitcnt vmcnt(0)
    v_lshlrev_b32 v76, 16, v80
    v_and_b32 v77, 0xffff0000, v80
    v_lshlrev_b32 v82, 16, v72
    v_and_b32 v83, 0xffff0000, v72
    v_add_f32 v76, v76, v82
    v_add_f32 v77, v77, v83
    v_lshlrev_b32 v78, 16, v81
    v_and_b32 v79, 0xffff0000, v81
    v_lshlrev_b32 v82, 16, v73
    v_and_b32 v83, 0xffff0000, v73
    v_add_f32 v78, v78, v82
    v_add_f32 v79, v79, v83
    v_cvt_pk_bf16_f32 v80, v76, v77
    v_cvt_pk_bf16_f32 v81, v78, v79
    v_add_u32 v6, 4214816, v5
    buffer_store_dwordx2 v[80:81], v6, s[8:11], 0 offen
    v_add_u32 v6, 20544, v5
    buffer_load_dwordx2 v[72:73], v6, s[44:47], 0 offen
    v_accvgpr_read_b32 v76, a28
    v_accvgpr_read_b32 v77, a29
    v_accvgpr_read_b32 v78, a30
    v_accvgpr_read_b32 v79, a31
    v_cvt_pk_bf16_f32 v80, v76, v77
    v_cvt_pk_bf16_f32 v81, v78, v79
    s_waitcnt vmcnt(0)
    v_lshlrev_b32 v76, 16, v80
    v_and_b32 v77, 0xffff0000, v80
    v_lshlrev_b32 v82, 16, v72
    v_and_b32 v83, 0xffff0000, v72
    v_add_f32 v76, v76, v82
    v_add_f32 v77, v77, v83
    v_lshlrev_b32 v78, 16, v81
    v_and_b32 v79, 0xffff0000, v81
    v_lshlrev_b32 v82, 16, v73
    v_and_b32 v83, 0xffff0000, v73
    v_add_f32 v78, v78, v82
    v_add_f32 v79, v79, v83
    v_cvt_pk_bf16_f32 v80, v76, v77
    v_cvt_pk_bf16_f32 v81, v78, v79
    v_add_u32 v6, 4214848, v5
    buffer_store_dwordx2 v[80:81], v6, s[8:11], 0 offen
    v_add_u32 v6, 20576, v5
    buffer_load_dwordx2 v[72:73], v6, s[44:47], 0 offen
    v_accvgpr_read_b32 v76, a32
    v_accvgpr_read_b32 v77, a33
    v_accvgpr_read_b32 v78, a34
    v_accvgpr_read_b32 v79, a35
    v_cvt_pk_bf16_f32 v80, v76, v77
    v_cvt_pk_bf16_f32 v81, v78, v79
    s_waitcnt vmcnt(0)
    v_lshlrev_b32 v76, 16, v80
    v_and_b32 v77, 0xffff0000, v80
    v_lshlrev_b32 v82, 16, v72
    v_and_b32 v83, 0xffff0000, v72
    v_add_f32 v76, v76, v82
    v_add_f32 v77, v77, v83
    v_lshlrev_b32 v78, 16, v81
    v_and_b32 v79, 0xffff0000, v81
    v_lshlrev_b32 v82, 16, v73
    v_and_b32 v83, 0xffff0000, v73
    v_add_f32 v78, v78, v82
    v_add_f32 v79, v79, v83
    v_cvt_pk_bf16_f32 v80, v76, v77
    v_cvt_pk_bf16_f32 v81, v78, v79
    v_add_u32 v6, 4214880, v5
    buffer_store_dwordx2 v[80:81], v6, s[8:11], 0 offen
    v_add_u32 v6, 20608, v5
    buffer_load_dwordx2 v[72:73], v6, s[44:47], 0 offen
    v_accvgpr_read_b32 v76, a36
    v_accvgpr_read_b32 v77, a37
    v_accvgpr_read_b32 v78, a38
    v_accvgpr_read_b32 v79, a39
    v_cvt_pk_bf16_f32 v80, v76, v77
    v_cvt_pk_bf16_f32 v81, v78, v79
    s_waitcnt vmcnt(0)
    v_lshlrev_b32 v76, 16, v80
    v_and_b32 v77, 0xffff0000, v80
    v_lshlrev_b32 v82, 16, v72
    v_and_b32 v83, 0xffff0000, v72
    v_add_f32 v76, v76, v82
    v_add_f32 v77, v77, v83
    v_lshlrev_b32 v78, 16, v81
    v_and_b32 v79, 0xffff0000, v81
    v_lshlrev_b32 v82, 16, v73
    v_and_b32 v83, 0xffff0000, v73
    v_add_f32 v78, v78, v82
    v_add_f32 v79, v79, v83
    v_cvt_pk_bf16_f32 v80, v76, v77
    v_cvt_pk_bf16_f32 v81, v78, v79
    v_add_u32 v6, 4214912, v5
    buffer_store_dwordx2 v[80:81], v6, s[8:11], 0 offen
wo_a1_kernel_end:
    s_endpgm
.section .rodata,"a"
.p2align 6
.amdhsa_kernel wo_a1_kernel
  .amdhsa_next_free_vgpr 136
  .amdhsa_next_free_sgpr 64
  .amdhsa_accum_offset 96
  .amdhsa_group_segment_fixed_size 0
  .amdhsa_kernarg_size 104
  .amdhsa_user_sgpr_count 2
  .amdhsa_user_sgpr_kernarg_segment_ptr 1
  .amdhsa_system_sgpr_workgroup_id_x 1
.end_amdhsa_kernel
.text
.globl ln_b1_kernel
.p2align 8
.type ln_b1_kernel,@function
ln_b1_kernel:
    v_lshrrev_b32 v1, 6, v0
    v_and_b32 v2, 63, v0
    s_nop 0
    v_readfirstlane_b32 s3, v1
    s_lshl_b32 s4, s2, 2
    s_add_u32 s4, s4, s3
    s_cmp_ge_u32 s4, 2048
    s_cbranch_scc1 ln_b1_kernel_end
    s_load_dwordx2 s[6:7], s[0:1], 96
    s_load_dwordx2 s[12:13], s[0:1], 96
    s_waitcnt lgkmcnt(0)
    s_add_u32 s8, s6, 4194304
    s_addc_u32 s9, s7, 0
    s_mov_b32 s10, 2621440
    s_mov_b32 s11, 0x00020000
    s_mov_b32 s16, s12
    s_mov_b32 s17, s13
    s_mov_b32 s18, 2621440
    s_mov_b32 s19, 0x00020000
    s_mul_i32 s5, s4, 1280
    v_lshlrev_b32 v3, 2, v2
    v_add_u32 v3, s5, v3
    buffer_load_dword v4, v3, s[8:11], 0 offen offset:0
    buffer_load_dword v5, v3, s[8:11], 0 offen offset:256
    buffer_load_dword v6, v3, s[8:11], 0 offen offset:512
    buffer_load_dword v7, v3, s[8:11], 0 offen offset:768
    buffer_load_dword v8, v3, s[8:11], 0 offen offset:1024
    s_waitcnt vmcnt(0)
    v_lshlrev_b32 v10, 16, v4
    v_and_b32 v11, 0xffff0000, v4
    v_lshlrev_b32 v12, 16, v5
    v_and_b32 v13, 0xffff0000, v5
    v_lshlrev_b32 v14, 16, v6
    v_and_b32 v15, 0xffff0000, v6
    v_lshlrev_b32 v16, 16, v7
    v_and_b32 v17, 0xffff0000, v7
    v_lshlrev_b32 v18, 16, v8
    v_and_b32 v19, 0xffff0000, v8
    v_add_f32 v20, v10, v11
    v_add_f32 v20, v20, v12
    v_add_f32 v20, v20, v13
    v_add_f32 v20, v20, v14
    v_add_f32 v20, v20, v15
    v_add_f32 v20, v20, v16
    v_add_f32 v20, v20, v17
    v_add_f32 v20, v20, v18
    v_add_f32 v20, v20, v19
    s_nop 1
    v_add_f32 v21, v20, v20 quad_perm:[1,0,3,2] row_mask:0xf bank_mask:0xf
    s_nop 1
    v_add_f32 v21, v21, v21 quad_perm:[2,3,0,1] row_mask:0xf bank_mask:0xf
    s_nop 1
    v_add_f32 v21, v21, v21 row_half_mirror row_mask:0xf bank_mask:0xf
    s_nop 1
    v_add_f32 v21, v21, v21 row_mirror row_mask:0xf bank_mask:0xf
    s_nop 1
    v_readlane_b32 s24, v21, 0
    v_readlane_b32 s25, v21, 16
    v_readlane_b32 s26, v21, 32
    v_readlane_b32 s27, v21, 48
    s_nop 1
    v_mov_b32 v20, s24
    v_add_f32 v20, s25, v20
    v_add_f32 v20, s26, v20
    v_add_f32 v20, s27, v20
    v_mul_f32 v20, 0.0015625, v20
    v_sub_f32 v10, v10, v20
    v_sub_f32 v11, v11, v20
    v_sub_f32 v12, v12, v20
    v_sub_f32 v13, v13, v20
    v_sub_f32 v14, v14, v20
    v_sub_f32 v15, v15, v20
    v_sub_f32 v16, v16, v20
    v_sub_f32 v17, v17, v20
    v_sub_f32 v18, v18, v20
    v_sub_f32 v19, v19, v20
    v_mul_f32 v21, v10, v10
    v_fmac_f32 v21, v11, v11
    v_fmac_f32 v21, v12, v12
    v_fmac_f32 v21, v13, v13
    v_fmac_f32 v21, v14, v14
    v_fmac_f32 v21, v15, v15
    v_fmac_f32 v21, v16, v16
    v_fmac_f32 v21, v17, v17
    v_fmac_f32 v21, v18, v18
    v_fmac_f32 v21, v19, v19
    s_nop 1
    v_add_f32 v22, v21, v21 quad_perm:[1,0,3,2] row_mask:0xf bank_mask:0xf
    s_nop 1
    v_add_f32 v22, v22, v22 quad_perm:[2,3,0,1] row_mask:0xf bank_mask:0xf
    s_nop 1
    v_add_f32 v22, v22, v22 row_half_mirror row_mask:0xf bank_mask:0xf
    s_nop 1
    v_add_f32 v22, v22, v22 row_mirror row_mask:0xf bank_mask:0xf
    s_nop 1
    v_readlane_b32 s24, v22, 0
    v_readlane_b32 s25, v22, 16
    v_readlane_b32 s26, v22, 32
    v_readlane_b32 s27, v22, 48
    s_nop 1
    v_mov_b32 v21, s24
    v_add_f32 v21, s25, v21
    v_add_f32 v21, s26, v21
    v_add_f32 v21, s27, v21
    v_mov_b32 v22, 0x3727c5ac
    v_fmac_f32 v22, 0.0015625, v21
    v_rsq_f32 v22, v22
    s_nop 0
    v_mul_f32 v10, v10, v22
    v_mul_f32 v11, v11, v22
    v_mul_f32 v12, v12, v22
    v_mul_f32 v13, v13, v22
    v_mul_f32 v14, v14, v22
    v_mul_f32 v15, v15, v22
    v_mul_f32 v16, v16, v22
    v_mul_f32 v17, v17, v22
    v_mul_f32 v18, v18, v22
    v_mul_f32 v19, v19, v22
    v_cvt_pk_bf16_f32 v4, v10, v11
    v_cvt_pk_bf16_f32 v5, v12, v13
    v_cvt_pk_bf16_f32 v6, v14, v15
    v_cvt_pk_bf16_f32 v7, v16, v17
    v_cvt_pk_bf16_f32 v8, v18, v19
    buffer_store_dword v4, v3, s[16:19], 0 offen offset:0
    buffer_store_dword v5, v3, s[16:19], 0 offen offset:256
    buffer_store_dword v6, v3, s[16:19], 0 offen offset:512
    buffer_store_dword v7, v3, s[16:19], 0 offen offset:768
    buffer_store_dword v8, v3, s[16:19], 0 offen offset:1024
ln_b1_kernel_end:
    s_endpgm
.section .rodata,"a"
.p2align 6
.amdhsa_kernel ln_b1_kernel
  .amdhsa_next_free_vgpr 32
  .amdhsa_next_free_sgpr 40
  .amdhsa_accum_offset 32
  .amdhsa_group_segment_fixed_size 0
  .amdhsa_kernarg_size 104
  .amdhsa_user_sgpr_count 2
  .amdhsa_user_sgpr_kernarg_segment_ptr 1
  .amdhsa_system_sgpr_workgroup_id_x 1
.end_amdhsa_kernel
.text
.globl qk_b_kernel
.p2align 8
.type qk_b_kernel,@function
qk_b_kernel:
    v_lshrrev_b32 v1, 6, v0
    v_and_b32 v2, 63, v0
    s_nop 0
    v_readfirstlane_b32 s3, v1
    s_cmp_ge_u32 s2, 512
    s_cbranch_scc1 qk_b_kernel_end
    s_load_dwordx2 s[4:5], s[0:1], 96
    s_load_dwordx2 s[6:7], s[0:1], 80
    s_mul_i32 s20, s2, 1
    s_lshr_b32 s20, s20, 7
    s_mul_i32 s21, s20, 128
    s_sub_u32 s21, s2, s21
    s_lshl_b32 s20, s20, 2
    s_add_u32 s20, s20, s3
    s_mul_i32 s22, s20, 128
    s_mul_i32 s23, s21, 96
    s_waitcnt lgkmcnt(0)
    s_mov_b32 s8, s4
    s_mov_b32 s9, s5
    s_mov_b32 s10, 268435456
    s_mov_b32 s11, 0x00020000
    v_and_b32 v3, 15, v2
    v_lshrrev_b32 v4, 4, v2
    s_mov_b32 s24, 1280
    v_add_u32 v5, s22, v3
    v_mul_lo_u32 v5, v5, s24
    v_lshlrev_b32 v6, 4, v4
    v_add_u32 v5, v5, v6
    v_add_u32 v5, 0, v5
    v_mov_b32 v8, v5
    v_add_u32 v9, 20480, v5
    v_add_u32 v10, 40960, v5
    v_add_u32 v11, 61440, v5
    v_add_u32 v12, 81920, v5
    v_add_u32 v13, 102400, v5
    v_add_u32 v14, 122880, v5
    v_add_u32 v15, 143360, v5
    v_lshlrev_b32 v7, 4, v2
    s_mov_b32 s25, 0
    s_mov_b32 s26, 0
    s_mul_i32 s27, s21, 122880
    s_add_u32 s27, s27, s26
    s_add_u32 s27, s27, 33554432
    s_add_u32 s32, s27, 0
    s_add_u32 s33, s27, 20480
    s_add_u32 s34, s27, 40960
    s_add_u32 s35, s27, 61440
    s_add_u32 s36, s27, 81920
    s_add_u32 s37, s27, 102400
    v_accvgpr_write_b32 a0, 0
    v_accvgpr_write_b32 a1, 0
    v_accvgpr_write_b32 a2, 0
    v_accvgpr_write_b32 a3, 0
    v_accvgpr_write_b32 a4, 0
    v_accvgpr_write_b32 a5, 0
    v_accvgpr_write_b32 a6, 0
    v_accvgpr_write_b32 a7, 0
    v_accvgpr_write_b32 a8, 0
    v_accvgpr_write_b32 a9, 0
    v_accvgpr_write_b32 a10, 0
    v_accvgpr_write_b32 a11, 0
    v_accvgpr_write_b32 a12, 0
    v_accvgpr_write_b32 a13, 0
    v_accvgpr_write_b32 a14, 0
    v_accvgpr_write_b32 a15, 0
    v_accvgpr_write_b32 a16, 0
    v_accvgpr_write_b32 a17, 0
    v_accvgpr_write_b32 a18, 0
    v_accvgpr_write_b32 a19, 0
    v_accvgpr_write_b32 a20, 0
    v_accvgpr_write_b32 a21, 0
    v_accvgpr_write_b32 a22, 0
    v_accvgpr_write_b32 a23, 0
    v_accvgpr_write_b32 a24, 0
    v_accvgpr_write_b32 a25, 0
    v_accvgpr_write_b32 a26, 0
    v_accvgpr_write_b32 a27, 0
    v_accvgpr_write_b32 a28, 0
    v_accvgpr_write_b32 a29, 0
    v_accvgpr_write_b32 a30, 0
    v_accvgpr_write_b32 a31, 0
    v_accvgpr_write_b32 a32, 0
    v_accvgpr_write_b32 a33, 0
    v_accvgpr_write_b32 a34, 0
    v_accvgpr_write_b32 a35, 0
    v_accvgpr_write_b32 a36, 0
    v_accvgpr_write_b32 a37, 0
    v_accvgpr_write_b32 a38, 0
    v_accvgpr_write_b32 a39, 0
    v_accvgpr_write_b32 a40, 0
    v_accvgpr_write_b32 a41, 0
    v_accvgpr_write_b32 a42, 0
    v_accvgpr_write_b32 a43, 0
    v_accvgpr_write_b32 a44, 0
    v_accvgpr_write_b32 a45, 0
    v_accvgpr_write_b32 a46, 0
    v_accvgpr_write_b32 a47, 0
    v_accvgpr_write_b32 a48, 0
    v_accvgpr_write_b32 a49, 0
    v_accvgpr_write_b32 a50, 0
    v_accvgpr_write_b32 a51, 0
    v_accvgpr_write_b32 a52, 0
    v_accvgpr_write_b32 a53, 0
    v_accvgpr_write_b32 a54, 0
    v_accvgpr_write_b32 a55, 0
    v_accvgpr_write_b32 a56, 0
    v_accvgpr_write_b32 a57, 0
    v_accvgpr_write_b32 a58, 0
    v_accvgpr_write_b32 a59, 0
    v_accvgpr_write_b32 a60, 0
    v_accvgpr_write_b32 a61, 0
    v_accvgpr_write_b32 a62, 0
    v_accvgpr_write_b32 a63, 0
    v_accvgpr_write_b32 a64, 0
    v_accvgpr_write_b32 a65, 0
    v_accvgpr_write_b32 a66, 0
    v_accvgpr_write_b32 a67, 0
    v_accvgpr_write_b32 a68, 0
    v_accvgpr_write_b32 a69, 0
    v_accvgpr_write_b32 a70, 0
    v_accvgpr_write_b32 a71, 0
    v_accvgpr_write_b32 a72, 0
    v_accvgpr_write_b32 a73, 0
    v_accvgpr_write_b32 a74, 0
    v_accvgpr_write_b32 a75, 0
    v_accvgpr_write_b32 a76, 0
    v_accvgpr_write_b32 a77, 0
    v_accvgpr_write_b32 a78, 0
    v_accvgpr_write_b32 a79, 0
    v_accvgpr_write_b32 a80, 0
    v_accvgpr_write_b32 a81, 0
    v_accvgpr_write_b32 a82, 0
    v_accvgpr_write_b32 a83, 0
    v_accvgpr_write_b32 a84, 0
    v_accvgpr_write_b32 a85, 0
    v_accvgpr_write_b32 a86, 0
    v_accvgpr_write_b32 a87, 0
    v_accvgpr_write_b32 a88, 0
    v_accvgpr_write_b32 a89, 0
    v_accvgpr_write_b32 a90, 0
    v_accvgpr_write_b32 a91, 0
    v_accvgpr_write_b32 a92, 0
    v_accvgpr_write_b32 a93, 0
    v_accvgpr_write_b32 a94, 0
    v_accvgpr_write_b32 a95, 0
    v_accvgpr_write_b32 a96, 0
    v_accvgpr_write_b32 a97, 0
    v_accvgpr_write_b32 a98, 0
    v_accvgpr_write_b32 a99, 0
    v_accvgpr_write_b32 a100, 0
    v_accvgpr_write_b32 a101, 0
    v_accvgpr_write_b32 a102, 0
    v_accvgpr_write_b32 a103, 0
    v_accvgpr_write_b32 a104, 0
    v_accvgpr_write_b32 a105, 0
    v_accvgpr_write_b32 a106, 0
    v_accvgpr_write_b32 a107, 0
    v_accvgpr_write_b32 a108, 0
    v_accvgpr_write_b32 a109, 0
    v_accvgpr_write_b32 a110, 0
    v_accvgpr_write_b32 a111, 0
    v_accvgpr_write_b32 a112, 0
    v_accvgpr_write_b32 a113, 0
    v_accvgpr_write_b32 a114, 0
    v_accvgpr_write_b32 a115, 0
    v_accvgpr_write_b32 a116, 0
    v_accvgpr_write_b32 a117, 0
    v_accvgpr_write_b32 a118, 0
    v_accvgpr_write_b32 a119, 0
    v_accvgpr_write_b32 a120, 0
    v_accvgpr_write_b32 a121, 0
    v_accvgpr_write_b32 a122, 0
    v_accvgpr_write_b32 a123, 0
    v_accvgpr_write_b32 a124, 0
    v_accvgpr_write_b32 a125, 0
    v_accvgpr_write_b32 a126, 0
    v_accvgpr_write_b32 a127, 0
    v_accvgpr_write_b32 a128, 0
    v_accvgpr_write_b32 a129, 0
    v_accvgpr_write_b32 a130, 0
    v_accvgpr_write_b32 a131, 0
    v_accvgpr_write_b32 a132, 0
    v_accvgpr_write_b32 a133, 0
    v_accvgpr_write_b32 a134, 0
    v_accvgpr_write_b32 a135, 0
    v_accvgpr_write_b32 a136, 0
    v_accvgpr_write_b32 a137, 0
    v_accvgpr_write_b32 a138, 0
    v_accvgpr_write_b32 a139, 0
    v_accvgpr_write_b32 a140, 0
    v_accvgpr_write_b32 a141, 0
    v_accvgpr_write_b32 a142, 0
    v_accvgpr_write_b32 a143, 0
    v_accvgpr_write_b32 a144, 0
    v_accvgpr_write_b32 a145, 0
    v_accvgpr_write_b32 a146, 0
    v_accvgpr_write_b32 a147, 0
    v_accvgpr_write_b32 a148, 0
    v_accvgpr_write_b32 a149, 0
    v_accvgpr_write_b32 a150, 0
    v_accvgpr_write_b32 a151, 0
    v_accvgpr_write_b32 a152, 0
    v_accvgpr_write_b32 a153, 0
    v_accvgpr_write_b32 a154, 0
    v_accvgpr_write_b32 a155, 0
    v_accvgpr_write_b32 a156, 0
    v_accvgpr_write_b32 a157, 0
    v_accvgpr_write_b32 a158, 0
    v_accvgpr_write_b32 a159, 0
    v_accvgpr_write_b32 a160, 0
    v_accvgpr_write_b32 a161, 0
    v_accvgpr_write_b32 a162, 0
    v_accvgpr_write_b32 a163, 0
    v_accvgpr_write_b32 a164, 0
    v_accvgpr_write_b32 a165, 0
    v_accvgpr_write_b32 a166, 0
    v_accvgpr_write_b32 a167, 0
    v_accvgpr_write_b32 a168, 0
    v_accvgpr_write_b32 a169, 0
    v_accvgpr_write_b32 a170, 0
    v_accvgpr_write_b32 a171, 0
    v_accvgpr_write_b32 a172, 0
    v_accvgpr_write_b32 a173, 0
    v_accvgpr_write_b32 a174, 0
    v_accvgpr_write_b32 a175, 0
    v_accvgpr_write_b32 a176, 0
    v_accvgpr_write_b32 a177, 0
    v_accvgpr_write_b32 a178, 0
    v_accvgpr_write_b32 a179, 0
    v_accvgpr_write_b32 a180, 0
    v_accvgpr_write_b32 a181, 0
    v_accvgpr_write_b32 a182, 0
    v_accvgpr_write_b32 a183, 0
    v_accvgpr_write_b32 a184, 0
    v_accvgpr_write_b32 a185, 0
    v_accvgpr_write_b32 a186, 0
    v_accvgpr_write_b32 a187, 0
    v_accvgpr_write_b32 a188, 0
    v_accvgpr_write_b32 a189, 0
    v_accvgpr_write_b32 a190, 0
    v_accvgpr_write_b32 a191, 0
    s_cmp_ge_u32 s23, 12288
    s_cbranch_scc1 qk_b_kernel_nrm
    buffer_load_dwordx4 v[16:19], v8, s[8:11], s25 offen
    buffer_load_dwordx4 v[20:23], v9, s[8:11], s25 offen
    buffer_load_dwordx4 v[24:27], v10, s[8:11], s25 offen
    buffer_load_dwordx4 v[28:31], v11, s[8:11], s25 offen
    buffer_load_dwordx4 v[32:35], v12, s[8:11], s25 offen
    buffer_load_dwordx4 v[36:39], v13, s[8:11], s25 offen
    buffer_load_dwordx4 v[40:43], v14, s[8:11], s25 offen
    buffer_load_dwordx4 v[44:47], v15, s[8:11], s25 offen
    buffer_load_dwordx4 v[48:51], v7, s[8:11], s32 offen
    buffer_load_dwordx4 v[52:55], v7, s[8:11], s33 offen
    buffer_load_dwordx4 v[56:59], v7, s[8:11], s34 offen
    buffer_load_dwordx4 v[60:63], v7, s[8:11], s35 offen
    buffer_load_dwordx4 v[64:67], v7, s[8:11], s36 offen
    buffer_load_dwordx4 v[68:71], v7, s[8:11], s37 offen
    s_mov_b32 s28, 10
qk_b_kernel_loop0:
    s_add_u32 s25, s25, 64
    s_add_u32 s32, s32, 1024
    s_add_u32 s33, s33, 1024
    s_add_u32 s34, s34, 1024
    s_add_u32 s35, s35, 1024
    s_add_u32 s36, s36, 1024
    s_add_u32 s37, s37, 1024
    buffer_load_dwordx4 v[72:75], v8, s[8:11], s25 offen
    buffer_load_dwordx4 v[76:79], v9, s[8:11], s25 offen
    buffer_load_dwordx4 v[80:83], v10, s[8:11], s25 offen
    buffer_load_dwordx4 v[84:87], v11, s[8:11], s25 offen
    buffer_load_dwordx4 v[88:91], v12, s[8:11], s25 offen
    buffer_load_dwordx4 v[92:95], v13, s[8:11], s25 offen
    buffer_load_dwordx4 v[96:99], v14, s[8:11], s25 offen
    buffer_load_dwordx4 v[100:103], v15, s[8:11], s25 offen
    buffer_load_dwordx4 v[104:107], v7, s[8:11], s32 offen
    buffer_load_dwordx4 v[108:111], v7, s[8:11], s33 offen
    buffer_load_dwordx4 v[112:115], v7, s[8:11], s34 offen
    buffer_load_dwordx4 v[116:119], v7, s[8:11], s35 offen
    buffer_load_dwordx4 v[120:123], v7, s[8:11], s36 offen
    buffer_load_dwordx4 v[124:127], v7, s[8:11], s37 offen
    s_waitcnt vmcnt(14)
    v_mfma_f32_16x16x32_bf16 a[0:3], v[48:51], v[16:19], a[0:3]
    v_mfma_f32_16x16x32_bf16 a[24:27], v[48:51], v[20:23], a[24:27]
    v_mfma_f32_16x16x32_bf16 a[48:51], v[48:51], v[24:27], a[48:51]
    v_mfma_f32_16x16x32_bf16 a[72:75], v[48:51], v[28:31], a[72:75]
    v_mfma_f32_16x16x32_bf16 a[96:99], v[48:51], v[32:35], a[96:99]
    v_mfma_f32_16x16x32_bf16 a[120:123], v[48:51], v[36:39], a[120:123]
    v_mfma_f32_16x16x32_bf16 a[144:147], v[48:51], v[40:43], a[144:147]
    v_mfma_f32_16x16x32_bf16 a[168:171], v[48:51], v[44:47], a[168:171]
    v_mfma_f32_16x16x32_bf16 a[4:7], v[52:55], v[16:19], a[4:7]
    v_mfma_f32_16x16x32_bf16 a[28:31], v[52:55], v[20:23], a[28:31]
    v_mfma_f32_16x16x32_bf16 a[52:55], v[52:55], v[24:27], a[52:55]
    v_mfma_f32_16x16x32_bf16 a[76:79], v[52:55], v[28:31], a[76:79]
    v_mfma_f32_16x16x32_bf16 a[100:103], v[52:55], v[32:35], a[100:103]
    v_mfma_f32_16x16x32_bf16 a[124:127], v[52:55], v[36:39], a[124:127]
    v_mfma_f32_16x16x32_bf16 a[148:151], v[52:55], v[40:43], a[148:151]
    v_mfma_f32_16x16x32_bf16 a[172:175], v[52:55], v[44:47], a[172:175]
    v_mfma_f32_16x16x32_bf16 a[8:11], v[56:59], v[16:19], a[8:11]
    v_mfma_f32_16x16x32_bf16 a[32:35], v[56:59], v[20:23], a[32:35]
    v_mfma_f32_16x16x32_bf16 a[56:59], v[56:59], v[24:27], a[56:59]
    v_mfma_f32_16x16x32_bf16 a[80:83], v[56:59], v[28:31], a[80:83]
    v_mfma_f32_16x16x32_bf16 a[104:107], v[56:59], v[32:35], a[104:107]
    v_mfma_f32_16x16x32_bf16 a[128:131], v[56:59], v[36:39], a[128:131]
    v_mfma_f32_16x16x32_bf16 a[152:155], v[56:59], v[40:43], a[152:155]
    v_mfma_f32_16x16x32_bf16 a[176:179], v[56:59], v[44:47], a[176:179]
    v_mfma_f32_16x16x32_bf16 a[12:15], v[60:63], v[16:19], a[12:15]
    v_mfma_f32_16x16x32_bf16 a[36:39], v[60:63], v[20:23], a[36:39]
    v_mfma_f32_16x16x32_bf16 a[60:63], v[60:63], v[24:27], a[60:63]
    v_mfma_f32_16x16x32_bf16 a[84:87], v[60:63], v[28:31], a[84:87]
    v_mfma_f32_16x16x32_bf16 a[108:111], v[60:63], v[32:35], a[108:111]
    v_mfma_f32_16x16x32_bf16 a[132:135], v[60:63], v[36:39], a[132:135]
    v_mfma_f32_16x16x32_bf16 a[156:159], v[60:63], v[40:43], a[156:159]
    v_mfma_f32_16x16x32_bf16 a[180:183], v[60:63], v[44:47], a[180:183]
    v_mfma_f32_16x16x32_bf16 a[16:19], v[64:67], v[16:19], a[16:19]
    v_mfma_f32_16x16x32_bf16 a[40:43], v[64:67], v[20:23], a[40:43]
    v_mfma_f32_16x16x32_bf16 a[64:67], v[64:67], v[24:27], a[64:67]
    v_mfma_f32_16x16x32_bf16 a[88:91], v[64:67], v[28:31], a[88:91]
    v_mfma_f32_16x16x32_bf16 a[112:115], v[64:67], v[32:35], a[112:115]
    v_mfma_f32_16x16x32_bf16 a[136:139], v[64:67], v[36:39], a[136:139]
    v_mfma_f32_16x16x32_bf16 a[160:163], v[64:67], v[40:43], a[160:163]
    v_mfma_f32_16x16x32_bf16 a[184:187], v[64:67], v[44:47], a[184:187]
    v_mfma_f32_16x16x32_bf16 a[20:23], v[68:71], v[16:19], a[20:23]
    v_mfma_f32_16x16x32_bf16 a[44:47], v[68:71], v[20:23], a[44:47]
    v_mfma_f32_16x16x32_bf16 a[68:71], v[68:71], v[24:27], a[68:71]
    v_mfma_f32_16x16x32_bf16 a[92:95], v[68:71], v[28:31], a[92:95]
    v_mfma_f32_16x16x32_bf16 a[116:119], v[68:71], v[32:35], a[116:119]
    v_mfma_f32_16x16x32_bf16 a[140:143], v[68:71], v[36:39], a[140:143]
    v_mfma_f32_16x16x32_bf16 a[164:167], v[68:71], v[40:43], a[164:167]
    v_mfma_f32_16x16x32_bf16 a[188:191], v[68:71], v[44:47], a[188:191]
    s_sub_u32 s28, s28, 1
    s_cmp_eq_u32 s28, 0
    s_cbranch_scc1 qk_b_kernel_loop0_last
    s_add_u32 s25, s25, 64
    s_add_u32 s32, s32, 1024
    s_add_u32 s33, s33, 1024
    s_add_u32 s34, s34, 1024
    s_add_u32 s35, s35, 1024
    s_add_u32 s36, s36, 1024
    s_add_u32 s37, s37, 1024
    buffer_load_dwordx4 v[16:19], v8, s[8:11], s25 offen
    buffer_load_dwordx4 v[20:23], v9, s[8:11], s25 offen
    buffer_load_dwordx4 v[24:27], v10, s[8:11], s25 offen
    buffer_load_dwordx4 v[28:31], v11, s[8:11], s25 offen
    buffer_load_dwordx4 v[32:35], v12, s[8:11], s25 offen
    buffer_load_dwordx4 v[36:39], v13, s[8:11], s25 offen
    buffer_load_dwordx4 v[40:43], v14, s[8:11], s25 offen
    buffer_load_dwordx4 v[44:47], v15, s[8:11], s25 offen
    buffer_load_dwordx4 v[48:51], v7, s[8:11], s32 offen
    buffer_load_dwordx4 v[52:55], v7, s[8:11], s33 offen
    buffer_load_dwordx4 v[56:59], v7, s[8:11], s34 offen
    buffer_load_dwordx4 v[60:63], v7, s[8:11], s35 offen
    buffer_load_dwordx4 v[64:67], v7, s[8:11], s36 offen
    buffer_load_dwordx4 v[68:71], v7, s[8:11], s37 offen
    s_waitcnt vmcnt(14)
    v_mfma_f32_16x16x32_bf16 a[0:3], v[104:107], v[72:75], a[0:3]
    v_mfma_f32_16x16x32_bf16 a[24:27], v[104:107], v[76:79], a[24:27]
    v_mfma_f32_16x16x32_bf16 a[48:51], v[104:107], v[80:83], a[48:51]
    v_mfma_f32_16x16x32_bf16 a[72:75], v[104:107], v[84:87], a[72:75]
    v_mfma_f32_16x16x32_bf16 a[96:99], v[104:107], v[88:91], a[96:99]
    v_mfma_f32_16x16x32_bf16 a[120:123], v[104:107], v[92:95], a[120:123]
    v_mfma_f32_16x16x32_bf16 a[144:147], v[104:107], v[96:99], a[144:147]
    v_mfma_f32_16x16x32_bf16 a[168:171], v[104:107], v[100:103], a[168:171]
    v_mfma_f32_16x16x32_bf16 a[4:7], v[108:111], v[72:75], a[4:7]
    v_mfma_f32_16x16x32_bf16 a[28:31], v[108:111], v[76:79], a[28:31]
    v_mfma_f32_16x16x32_bf16 a[52:55], v[108:111], v[80:83], a[52:55]
    v_mfma_f32_16x16x32_bf16 a[76:79], v[108:111], v[84:87], a[76:79]
    v_mfma_f32_16x16x32_bf16 a[100:103], v[108:111], v[88:91], a[100:103]
    v_mfma_f32_16x16x32_bf16 a[124:127], v[108:111], v[92:95], a[124:127]
    v_mfma_f32_16x16x32_bf16 a[148:151], v[108:111], v[96:99], a[148:151]
    v_mfma_f32_16x16x32_bf16 a[172:175], v[108:111], v[100:103], a[172:175]
    v_mfma_f32_16x16x32_bf16 a[8:11], v[112:115], v[72:75], a[8:11]
    v_mfma_f32_16x16x32_bf16 a[32:35], v[112:115], v[76:79], a[32:35]
    v_mfma_f32_16x16x32_bf16 a[56:59], v[112:115], v[80:83], a[56:59]
    v_mfma_f32_16x16x32_bf16 a[80:83], v[112:115], v[84:87], a[80:83]
    v_mfma_f32_16x16x32_bf16 a[104:107], v[112:115], v[88:91], a[104:107]
    v_mfma_f32_16x16x32_bf16 a[128:131], v[112:115], v[92:95], a[128:131]
    v_mfma_f32_16x16x32_bf16 a[152:155], v[112:115], v[96:99], a[152:155]
    v_mfma_f32_16x16x32_bf16 a[176:179], v[112:115], v[100:103], a[176:179]
    v_mfma_f32_16x16x32_bf16 a[12:15], v[116:119], v[72:75], a[12:15]
    v_mfma_f32_16x16x32_bf16 a[36:39], v[116:119], v[76:79], a[36:39]
    v_mfma_f32_16x16x32_bf16 a[60:63], v[116:119], v[80:83], a[60:63]
    v_mfma_f32_16x16x32_bf16 a[84:87], v[116:119], v[84:87], a[84:87]
    v_mfma_f32_16x16x32_bf16 a[108:111], v[116:119], v[88:91], a[108:111]
    v_mfma_f32_16x16x32_bf16 a[132:135], v[116:119], v[92:95], a[132:135]
    v_mfma_f32_16x16x32_bf16 a[156:159], v[116:119], v[96:99], a[156:159]
    v_mfma_f32_16x16x32_bf16 a[180:183], v[116:119], v[100:103], a[180:183]
    v_mfma_f32_16x16x32_bf16 a[16:19], v[120:123], v[72:75], a[16:19]
    v_mfma_f32_16x16x32_bf16 a[40:43], v[120:123], v[76:79], a[40:43]
    v_mfma_f32_16x16x32_bf16 a[64:67], v[120:123], v[80:83], a[64:67]
    v_mfma_f32_16x16x32_bf16 a[88:91], v[120:123], v[84:87], a[88:91]
    v_mfma_f32_16x16x32_bf16 a[112:115], v[120:123], v[88:91], a[112:115]
    v_mfma_f32_16x16x32_bf16 a[136:139], v[120:123], v[92:95], a[136:139]
    v_mfma_f32_16x16x32_bf16 a[160:163], v[120:123], v[96:99], a[160:163]
    v_mfma_f32_16x16x32_bf16 a[184:187], v[120:123], v[100:103], a[184:187]
    v_mfma_f32_16x16x32_bf16 a[20:23], v[124:127], v[72:75], a[20:23]
    v_mfma_f32_16x16x32_bf16 a[44:47], v[124:127], v[76:79], a[44:47]
    v_mfma_f32_16x16x32_bf16 a[68:71], v[124:127], v[80:83], a[68:71]
    v_mfma_f32_16x16x32_bf16 a[92:95], v[124:127], v[84:87], a[92:95]
    v_mfma_f32_16x16x32_bf16 a[116:119], v[124:127], v[88:91], a[116:119]
    v_mfma_f32_16x16x32_bf16 a[140:143], v[124:127], v[92:95], a[140:143]
    v_mfma_f32_16x16x32_bf16 a[164:167], v[124:127], v[96:99], a[164:167]
    v_mfma_f32_16x16x32_bf16 a[188:191], v[124:127], v[100:103], a[188:191]
    s_branch qk_b_kernel_loop0
qk_b_kernel_loop0_last:
    s_waitcnt vmcnt(0)
    v_mfma_f32_16x16x32_bf16 a[0:3], v[104:107], v[72:75], a[0:3]
    v_mfma_f32_16x16x32_bf16 a[24:27], v[104:107], v[76:79], a[24:27]
    v_mfma_f32_16x16x32_bf16 a[48:51], v[104:107], v[80:83], a[48:51]
    v_mfma_f32_16x16x32_bf16 a[72:75], v[104:107], v[84:87], a[72:75]
    v_mfma_f32_16x16x32_bf16 a[96:99], v[104:107], v[88:91], a[96:99]
    v_mfma_f32_16x16x32_bf16 a[120:123], v[104:107], v[92:95], a[120:123]
    v_mfma_f32_16x16x32_bf16 a[144:147], v[104:107], v[96:99], a[144:147]
    v_mfma_f32_16x16x32_bf16 a[168:171], v[104:107], v[100:103], a[168:171]
    v_mfma_f32_16x16x32_bf16 a[4:7], v[108:111], v[72:75], a[4:7]
    v_mfma_f32_16x16x32_bf16 a[28:31], v[108:111], v[76:79], a[28:31]
    v_mfma_f32_16x16x32_bf16 a[52:55], v[108:111], v[80:83], a[52:55]
    v_mfma_f32_16x16x32_bf16 a[76:79], v[108:111], v[84:87], a[76:79]
    v_mfma_f32_16x16x32_bf16 a[100:103], v[108:111], v[88:91], a[100:103]
    v_mfma_f32_16x16x32_bf16 a[124:127], v[108:111], v[92:95], a[124:127]
    v_mfma_f32_16x16x32_bf16 a[148:151], v[108:111], v[96:99], a[148:151]
    v_mfma_f32_16x16x32_bf16 a[172:175], v[108:111], v[100:103], a[172:175]
    v_mfma_f32_16x16x32_bf16 a[8:11], v[112:115], v[72:75], a[8:11]
    v_mfma_f32_16x16x32_bf16 a[32:35], v[112:115], v[76:79], a[32:35]
    v_mfma_f32_16x16x32_bf16 a[56:59], v[112:115], v[80:83], a[56:59]
    v_mfma_f32_16x16x32_bf16 a[80:83], v[112:115], v[84:87], a[80:83]
    v_mfma_f32_16x16x32_bf16 a[104:107], v[112:115], v[88:91], a[104:107]
    v_mfma_f32_16x16x32_bf16 a[128:131], v[112:115], v[92:95], a[128:131]
    v_mfma_f32_16x16x32_bf16 a[152:155], v[112:115], v[96:99], a[152:155]
    v_mfma_f32_16x16x32_bf16 a[176:179], v[112:115], v[100:103], a[176:179]
    v_mfma_f32_16x16x32_bf16 a[12:15], v[116:119], v[72:75], a[12:15]
    v_mfma_f32_16x16x32_bf16 a[36:39], v[116:119], v[76:79], a[36:39]
    v_mfma_f32_16x16x32_bf16 a[60:63], v[116:119], v[80:83], a[60:63]
    v_mfma_f32_16x16x32_bf16 a[84:87], v[116:119], v[84:87], a[84:87]
    v_mfma_f32_16x16x32_bf16 a[108:111], v[116:119], v[88:91], a[108:111]
    v_mfma_f32_16x16x32_bf16 a[132:135], v[116:119], v[92:95], a[132:135]
    v_mfma_f32_16x16x32_bf16 a[156:159], v[116:119], v[96:99], a[156:159]
    v_mfma_f32_16x16x32_bf16 a[180:183], v[116:119], v[100:103], a[180:183]
    v_mfma_f32_16x16x32_bf16 a[16:19], v[120:123], v[72:75], a[16:19]
    v_mfma_f32_16x16x32_bf16 a[40:43], v[120:123], v[76:79], a[40:43]
    v_mfma_f32_16x16x32_bf16 a[64:67], v[120:123], v[80:83], a[64:67]
    v_mfma_f32_16x16x32_bf16 a[88:91], v[120:123], v[84:87], a[88:91]
    v_mfma_f32_16x16x32_bf16 a[112:115], v[120:123], v[88:91], a[112:115]
    v_mfma_f32_16x16x32_bf16 a[136:139], v[120:123], v[92:95], a[136:139]
    v_mfma_f32_16x16x32_bf16 a[160:163], v[120:123], v[96:99], a[160:163]
    v_mfma_f32_16x16x32_bf16 a[184:187], v[120:123], v[100:103], a[184:187]
    v_mfma_f32_16x16x32_bf16 a[20:23], v[124:127], v[72:75], a[20:23]
    v_mfma_f32_16x16x32_bf16 a[44:47], v[124:127], v[76:79], a[44:47]
    v_mfma_f32_16x16x32_bf16 a[68:71], v[124:127], v[80:83], a[68:71]
    v_mfma_f32_16x16x32_bf16 a[92:95], v[124:127], v[84:87], a[92:95]
    v_mfma_f32_16x16x32_bf16 a[116:119], v[124:127], v[88:91], a[116:119]
    v_mfma_f32_16x16x32_bf16 a[140:143], v[124:127], v[92:95], a[140:143]
    v_mfma_f32_16x16x32_bf16 a[164:167], v[124:127], v[96:99], a[164:167]
    v_mfma_f32_16x16x32_bf16 a[188:191], v[124:127], v[100:103], a[188:191]
    s_nop 7
    s_nop 7
    s_mov_b32 s24, 12288
    s_mov_b32 s31, 92262400
    s_cmp_lt_u32 s23, 6144
    s_cselect_b32 s30, 67108864, s31
    s_lshl_b32 s29, s23, 1
    s_add_u32 s29, s29, s30
    v_add_u32 v5, s22, v3
    v_mul_lo_u32 v5, v5, s24
    v_lshlrev_b32 v6, 3, v4
    v_add3_u32 v5, v5, v6, s29
    v_accvgpr_read_b32 v132, a0
    v_accvgpr_read_b32 v133, a1
    v_accvgpr_read_b32 v134, a2
    v_accvgpr_read_b32 v135, a3
    v_cvt_pk_bf16_f32 v136, v132, v133
    v_cvt_pk_bf16_f32 v137, v134, v135
    v_add_u32 v6, 0, v5
    buffer_store_dwordx2 v[136:137], v6, s[8:11], 0 offen
    v_accvgpr_read_b32 v132, a4
    v_accvgpr_read_b32 v133, a5
    v_accvgpr_read_b32 v134, a6
    v_accvgpr_read_b32 v135, a7
    v_cvt_pk_bf16_f32 v136, v132, v133
    v_cvt_pk_bf16_f32 v137, v134, v135
    v_add_u32 v6, 32, v5
    buffer_store_dwordx2 v[136:137], v6, s[8:11], 0 offen
    v_accvgpr_read_b32 v132, a8
    v_accvgpr_read_b32 v133, a9
    v_accvgpr_read_b32 v134, a10
    v_accvgpr_read_b32 v135, a11
    v_cvt_pk_bf16_f32 v136, v132, v133
    v_cvt_pk_bf16_f32 v137, v134, v135
    v_add_u32 v6, 64, v5
    buffer_store_dwordx2 v[136:137], v6, s[8:11], 0 offen
    v_accvgpr_read_b32 v132, a12
    v_accvgpr_read_b32 v133, a13
    v_accvgpr_read_b32 v134, a14
    v_accvgpr_read_b32 v135, a15
    v_cvt_pk_bf16_f32 v136, v132, v133
    v_cvt_pk_bf16_f32 v137, v134, v135
    v_add_u32 v6, 96, v5
    buffer_store_dwordx2 v[136:137], v6, s[8:11], 0 offen
    v_accvgpr_read_b32 v132, a16
    v_accvgpr_read_b32 v133, a17
    v_accvgpr_read_b32 v134, a18
    v_accvgpr_read_b32 v135, a19
    v_cvt_pk_bf16_f32 v136, v132, v133
    v_cvt_pk_bf16_f32 v137, v134, v135
    v_add_u32 v6, 128, v5
    buffer_store_dwordx2 v[136:137], v6, s[8:11], 0 offen
    v_accvgpr_read_b32 v132, a20
    v_accvgpr_read_b32 v133, a21
    v_accvgpr_read_b32 v134, a22
    v_accvgpr_read_b32 v135, a23
    v_cvt_pk_bf16_f32 v136, v132, v133
    v_cvt_pk_bf16_f32 v137, v134, v135
    v_add_u32 v6, 160, v5
    buffer_store_dwordx2 v[136:137], v6, s[8:11], 0 offen
    v_accvgpr_read_b32 v132, a24
    v_accvgpr_read_b32 v133, a25
    v_accvgpr_read_b32 v134, a26
    v_accvgpr_read_b32 v135, a27
    v_cvt_pk_bf16_f32 v136, v132, v133
    v_cvt_pk_bf16_f32 v137, v134, v135
    v_add_u32 v6, 196608, v5
    buffer_store_dwordx2 v[136:137], v6, s[8:11], 0 offen
    v_accvgpr_read_b32 v132, a28
    v_accvgpr_read_b32 v133, a29
    v_accvgpr_read_b32 v134, a30
    v_accvgpr_read_b32 v135, a31
    v_cvt_pk_bf16_f32 v136, v132, v133
    v_cvt_pk_bf16_f32 v137, v134, v135
    v_add_u32 v6, 196640, v5
    buffer_store_dwordx2 v[136:137], v6, s[8:11], 0 offen
    v_accvgpr_read_b32 v132, a32
    v_accvgpr_read_b32 v133, a33
    v_accvgpr_read_b32 v134, a34
    v_accvgpr_read_b32 v135, a35
    v_cvt_pk_bf16_f32 v136, v132, v133
    v_cvt_pk_bf16_f32 v137, v134, v135
    v_add_u32 v6, 196672, v5
    buffer_store_dwordx2 v[136:137], v6, s[8:11], 0 offen
    v_accvgpr_read_b32 v132, a36
    v_accvgpr_read_b32 v133, a37
    v_accvgpr_read_b32 v134, a38
    v_accvgpr_read_b32 v135, a39
    v_cvt_pk_bf16_f32 v136, v132, v133
    v_cvt_pk_bf16_f32 v137, v134, v135
    v_add_u32 v6, 196704, v5
    buffer_store_dwordx2 v[136:137], v6, s[8:11], 0 offen
    v_accvgpr_read_b32 v132, a40
    v_accvgpr_read_b32 v133, a41
    v_accvgpr_read_b32 v134, a42
    v_accvgpr_read_b32 v135, a43
    v_cvt_pk_bf16_f32 v136, v132, v133
    v_cvt_pk_bf16_f32 v137, v134, v135
    v_add_u32 v6, 196736, v5
    buffer_store_dwordx2 v[136:137], v6, s[8:11], 0 offen
    v_accvgpr_read_b32 v132, a44
    v_accvgpr_read_b32 v133, a45
    v_accvgpr_read_b32 v134, a46
    v_accvgpr_read_b32 v135, a47
    v_cvt_pk_bf16_f32 v136, v132, v133
    v_cvt_pk_bf16_f32 v137, v134, v135
    v_add_u32 v6, 196768, v5
    buffer_store_dwordx2 v[136:137], v6, s[8:11], 0 offen
    v_accvgpr_read_b32 v132, a48
    v_accvgpr_read_b32 v133, a49
    v_accvgpr_read_b32 v134, a50
    v_accvgpr_read_b32 v135, a51
    v_cvt_pk_bf16_f32 v136, v132, v133
    v_cvt_pk_bf16_f32 v137, v134, v135
    v_add_u32 v6, 393216, v5
    buffer_store_dwordx2 v[136:137], v6, s[8:11], 0 offen
    v_accvgpr_read_b32 v132, a52
    v_accvgpr_read_b32 v133, a53
    v_accvgpr_read_b32 v134, a54
    v_accvgpr_read_b32 v135, a55
    v_cvt_pk_bf16_f32 v136, v132, v133
    v_cvt_pk_bf16_f32 v137, v134, v135
    v_add_u32 v6, 393248, v5
    buffer_store_dwordx2 v[136:137], v6, s[8:11], 0 offen
    v_accvgpr_read_b32 v132, a56
    v_accvgpr_read_b32 v133, a57
    v_accvgpr_read_b32 v134, a58
    v_accvgpr_read_b32 v135, a59
    v_cvt_pk_bf16_f32 v136, v132, v133
    v_cvt_pk_bf16_f32 v137, v134, v135
    v_add_u32 v6, 393280, v5
    buffer_store_dwordx2 v[136:137], v6, s[8:11], 0 offen
    v_accvgpr_read_b32 v132, a60
    v_accvgpr_read_b32 v133, a61
    v_accvgpr_read_b32 v134, a62
    v_accvgpr_read_b32 v135, a63
    v_cvt_pk_bf16_f32 v136, v132, v133
    v_cvt_pk_bf16_f32 v137, v134, v135
    v_add_u32 v6, 393312, v5
    buffer_store_dwordx2 v[136:137], v6, s[8:11], 0 offen
    v_accvgpr_read_b32 v132, a64
    v_accvgpr_read_b32 v133, a65
    v_accvgpr_read_b32 v134, a66
    v_accvgpr_read_b32 v135, a67
    v_cvt_pk_bf16_f32 v136, v132, v133
    v_cvt_pk_bf16_f32 v137, v134, v135
    v_add_u32 v6, 393344, v5
    buffer_store_dwordx2 v[136:137], v6, s[8:11], 0 offen
    v_accvgpr_read_b32 v132, a68
    v_accvgpr_read_b32 v133, a69
    v_accvgpr_read_b32 v134, a70
    v_accvgpr_read_b32 v135, a71
    v_cvt_pk_bf16_f32 v136, v132, v133
    v_cvt_pk_bf16_f32 v137, v134, v135
    v_add_u32 v6, 393376, v5
    buffer_store_dwordx2 v[136:137], v6, s[8:11], 0 offen
    v_accvgpr_read_b32 v132, a72
    v_accvgpr_read_b32 v133, a73
    v_accvgpr_read_b32 v134, a74
    v_accvgpr_read_b32 v135, a75
    v_cvt_pk_bf16_f32 v136, v132, v133
    v_cvt_pk_bf16_f32 v137, v134, v135
    v_add_u32 v6, 589824, v5
    buffer_store_dwordx2 v[136:137], v6, s[8:11], 0 offen
    v_accvgpr_read_b32 v132, a76
    v_accvgpr_read_b32 v133, a77
    v_accvgpr_read_b32 v134, a78
    v_accvgpr_read_b32 v135, a79
    v_cvt_pk_bf16_f32 v136, v132, v133
    v_cvt_pk_bf16_f32 v137, v134, v135
    v_add_u32 v6, 589856, v5
    buffer_store_dwordx2 v[136:137], v6, s[8:11], 0 offen
    v_accvgpr_read_b32 v132, a80
    v_accvgpr_read_b32 v133, a81
    v_accvgpr_read_b32 v134, a82
    v_accvgpr_read_b32 v135, a83
    v_cvt_pk_bf16_f32 v136, v132, v133
    v_cvt_pk_bf16_f32 v137, v134, v135
    v_add_u32 v6, 589888, v5
    buffer_store_dwordx2 v[136:137], v6, s[8:11], 0 offen
    v_accvgpr_read_b32 v132, a84
    v_accvgpr_read_b32 v133, a85
    v_accvgpr_read_b32 v134, a86
    v_accvgpr_read_b32 v135, a87
    v_cvt_pk_bf16_f32 v136, v132, v133
    v_cvt_pk_bf16_f32 v137, v134, v135
    v_add_u32 v6, 589920, v5
    buffer_store_dwordx2 v[136:137], v6, s[8:11], 0 offen
    v_accvgpr_read_b32 v132, a88
    v_accvgpr_read_b32 v133, a89
    v_accvgpr_read_b32 v134, a90
    v_accvgpr_read_b32 v135, a91
    v_cvt_pk_bf16_f32 v136, v132, v133
    v_cvt_pk_bf16_f32 v137, v134, v135
    v_add_u32 v6, 589952, v5
    buffer_store_dwordx2 v[136:137], v6, s[8:11], 0 offen
    v_accvgpr_read_b32 v132, a92
    v_accvgpr_read_b32 v133, a93
    v_accvgpr_read_b32 v134, a94
    v_accvgpr_read_b32 v135, a95
    v_cvt_pk_bf16_f32 v136, v132, v133
    v_cvt_pk_bf16_f32 v137, v134, v135
    v_add_u32 v6, 589984, v5
    buffer_store_dwordx2 v[136:137], v6, s[8:11], 0 offen
    v_accvgpr_read_b32 v132, a96
    v_accvgpr_read_b32 v133, a97
    v_accvgpr_read_b32 v134, a98
    v_accvgpr_read_b32 v135, a99
    v_cvt_pk_bf16_f32 v136, v132, v133
    v_cvt_pk_bf16_f32 v137, v134, v135
    v_add_u32 v6, 786432, v5
    buffer_store_dwordx2 v[136:137], v6, s[8:11], 0 offen
    v_accvgpr_read_b32 v132, a100
    v_accvgpr_read_b32 v133, a101
    v_accvgpr_read_b32 v134, a102
    v_accvgpr_read_b32 v135, a103
    v_cvt_pk_bf16_f32 v136, v132, v133
    v_cvt_pk_bf16_f32 v137, v134, v135
    v_add_u32 v6, 786464, v5
    buffer_store_dwordx2 v[136:137], v6, s[8:11], 0 offen
    v_accvgpr_read_b32 v132, a104
    v_accvgpr_read_b32 v133, a105
    v_accvgpr_read_b32 v134, a106
    v_accvgpr_read_b32 v135, a107
    v_cvt_pk_bf16_f32 v136, v132, v133
    v_cvt_pk_bf16_f32 v137, v134, v135
    v_add_u32 v6, 786496, v5
    buffer_store_dwordx2 v[136:137], v6, s[8:11], 0 offen
    v_accvgpr_read_b32 v132, a108
    v_accvgpr_read_b32 v133, a109
    v_accvgpr_read_b32 v134, a110
    v_accvgpr_read_b32 v135, a111
    v_cvt_pk_bf16_f32 v136, v132, v133
    v_cvt_pk_bf16_f32 v137, v134, v135
    v_add_u32 v6, 786528, v5
    buffer_store_dwordx2 v[136:137], v6, s[8:11], 0 offen
    v_accvgpr_read_b32 v132, a112
    v_accvgpr_read_b32 v133, a113
    v_accvgpr_read_b32 v134, a114
    v_accvgpr_read_b32 v135, a115
    v_cvt_pk_bf16_f32 v136, v132, v133
    v_cvt_pk_bf16_f32 v137, v134, v135
    v_add_u32 v6, 786560, v5
    buffer_store_dwordx2 v[136:137], v6, s[8:11], 0 offen
    v_accvgpr_read_b32 v132, a116
    v_accvgpr_read_b32 v133, a117
    v_accvgpr_read_b32 v134, a118
    v_accvgpr_read_b32 v135, a119
    v_cvt_pk_bf16_f32 v136, v132, v133
    v_cvt_pk_bf16_f32 v137, v134, v135
    v_add_u32 v6, 786592, v5
    buffer_store_dwordx2 v[136:137], v6, s[8:11], 0 offen
    v_accvgpr_read_b32 v132, a120
    v_accvgpr_read_b32 v133, a121
    v_accvgpr_read_b32 v134, a122
    v_accvgpr_read_b32 v135, a123
    v_cvt_pk_bf16_f32 v136, v132, v133
    v_cvt_pk_bf16_f32 v137, v134, v135
    v_add_u32 v6, 983040, v5
    buffer_store_dwordx2 v[136:137], v6, s[8:11], 0 offen
    v_accvgpr_read_b32 v132, a124
    v_accvgpr_read_b32 v133, a125
    v_accvgpr_read_b32 v134, a126
    v_accvgpr_read_b32 v135, a127
    v_cvt_pk_bf16_f32 v136, v132, v133
    v_cvt_pk_bf16_f32 v137, v134, v135
    v_add_u32 v6, 983072, v5
    buffer_store_dwordx2 v[136:137], v6, s[8:11], 0 offen
    v_accvgpr_read_b32 v132, a128
    v_accvgpr_read_b32 v133, a129
    v_accvgpr_read_b32 v134, a130
    v_accvgpr_read_b32 v135, a131
    v_cvt_pk_bf16_f32 v136, v132, v133
    v_cvt_pk_bf16_f32 v137, v134, v135
    v_add_u32 v6, 983104, v5
    buffer_store_dwordx2 v[136:137], v6, s[8:11], 0 offen
    v_accvgpr_read_b32 v132, a132
    v_accvgpr_read_b32 v133, a133
    v_accvgpr_read_b32 v134, a134
    v_accvgpr_read_b32 v135, a135
    v_cvt_pk_bf16_f32 v136, v132, v133
    v_cvt_pk_bf16_f32 v137, v134, v135
    v_add_u32 v6, 983136, v5
    buffer_store_dwordx2 v[136:137], v6, s[8:11], 0 offen
    v_accvgpr_read_b32 v132, a136
    v_accvgpr_read_b32 v133, a137
    v_accvgpr_read_b32 v134, a138
    v_accvgpr_read_b32 v135, a139
    v_cvt_pk_bf16_f32 v136, v132, v133
    v_cvt_pk_bf16_f32 v137, v134, v135
    v_add_u32 v6, 983168, v5
    buffer_store_dwordx2 v[136:137], v6, s[8:11], 0 offen
    v_accvgpr_read_b32 v132, a140
    v_accvgpr_read_b32 v133, a141
    v_accvgpr_read_b32 v134, a142
    v_accvgpr_read_b32 v135, a143
    v_cvt_pk_bf16_f32 v136, v132, v133
    v_cvt_pk_bf16_f32 v137, v134, v135
    v_add_u32 v6, 983200, v5
    buffer_store_dwordx2 v[136:137], v6, s[8:11], 0 offen
    v_accvgpr_read_b32 v132, a144
    v_accvgpr_read_b32 v133, a145
    v_accvgpr_read_b32 v134, a146
    v_accvgpr_read_b32 v135, a147
    v_cvt_pk_bf16_f32 v136, v132, v133
    v_cvt_pk_bf16_f32 v137, v134, v135
    v_add_u32 v6, 1179648, v5
    buffer_store_dwordx2 v[136:137], v6, s[8:11], 0 offen
    v_accvgpr_read_b32 v132, a148
    v_accvgpr_read_b32 v133, a149
    v_accvgpr_read_b32 v134, a150
    v_accvgpr_read_b32 v135, a151
    v_cvt_pk_bf16_f32 v136, v132, v133
    v_cvt_pk_bf16_f32 v137, v134, v135
    v_add_u32 v6, 1179680, v5
    buffer_store_dwordx2 v[136:137], v6, s[8:11], 0 offen
    v_accvgpr_read_b32 v132, a152
    v_accvgpr_read_b32 v133, a153
    v_accvgpr_read_b32 v134, a154
    v_accvgpr_read_b32 v135, a155
    v_cvt_pk_bf16_f32 v136, v132, v133
    v_cvt_pk_bf16_f32 v137, v134, v135
    v_add_u32 v6, 1179712, v5
    buffer_store_dwordx2 v[136:137], v6, s[8:11], 0 offen
    v_accvgpr_read_b32 v132, a156
    v_accvgpr_read_b32 v133, a157
    v_accvgpr_read_b32 v134, a158
    v_accvgpr_read_b32 v135, a159
    v_cvt_pk_bf16_f32 v136, v132, v133
    v_cvt_pk_bf16_f32 v137, v134, v135
    v_add_u32 v6, 1179744, v5
    buffer_store_dwordx2 v[136:137], v6, s[8:11], 0 offen
    v_accvgpr_read_b32 v132, a160
    v_accvgpr_read_b32 v133, a161
    v_accvgpr_read_b32 v134, a162
    v_accvgpr_read_b32 v135, a163
    v_cvt_pk_bf16_f32 v136, v132, v133
    v_cvt_pk_bf16_f32 v137, v134, v135
    v_add_u32 v6, 1179776, v5
    buffer_store_dwordx2 v[136:137], v6, s[8:11], 0 offen
    v_accvgpr_read_b32 v132, a164
    v_accvgpr_read_b32 v133, a165
    v_accvgpr_read_b32 v134, a166
    v_accvgpr_read_b32 v135, a167
    v_cvt_pk_bf16_f32 v136, v132, v133
    v_cvt_pk_bf16_f32 v137, v134, v135
    v_add_u32 v6, 1179808, v5
    buffer_store_dwordx2 v[136:137], v6, s[8:11], 0 offen
    v_accvgpr_read_b32 v132, a168
    v_accvgpr_read_b32 v133, a169
    v_accvgpr_read_b32 v134, a170
    v_accvgpr_read_b32 v135, a171
    v_cvt_pk_bf16_f32 v136, v132, v133
    v_cvt_pk_bf16_f32 v137, v134, v135
    v_add_u32 v6, 1376256, v5
    buffer_store_dwordx2 v[136:137], v6, s[8:11], 0 offen
    v_accvgpr_read_b32 v132, a172
    v_accvgpr_read_b32 v133, a173
    v_accvgpr_read_b32 v134, a174
    v_accvgpr_read_b32 v135, a175
    v_cvt_pk_bf16_f32 v136, v132, v133
    v_cvt_pk_bf16_f32 v137, v134, v135
    v_add_u32 v6, 1376288, v5
    buffer_store_dwordx2 v[136:137], v6, s[8:11], 0 offen
    v_accvgpr_read_b32 v132, a176
    v_accvgpr_read_b32 v133, a177
    v_accvgpr_read_b32 v134, a178
    v_accvgpr_read_b32 v135, a179
    v_cvt_pk_bf16_f32 v136, v132, v133
    v_cvt_pk_bf16_f32 v137, v134, v135
    v_add_u32 v6, 1376320, v5
    buffer_store_dwordx2 v[136:137], v6, s[8:11], 0 offen
    v_accvgpr_read_b32 v132, a180
    v_accvgpr_read_b32 v133, a181
    v_accvgpr_read_b32 v134, a182
    v_accvgpr_read_b32 v135, a183
    v_cvt_pk_bf16_f32 v136, v132, v133
    v_cvt_pk_bf16_f32 v137, v134, v135
    v_add_u32 v6, 1376352, v5
    buffer_store_dwordx2 v[136:137], v6, s[8:11], 0 offen
    v_accvgpr_read_b32 v132, a184
    v_accvgpr_read_b32 v133, a185
    v_accvgpr_read_b32 v134, a186
    v_accvgpr_read_b32 v135, a187
    v_cvt_pk_bf16_f32 v136, v132, v133
    v_cvt_pk_bf16_f32 v137, v134, v135
    v_add_u32 v6, 1376384, v5
    buffer_store_dwordx2 v[136:137], v6, s[8:11], 0 offen
    v_accvgpr_read_b32 v132, a188
    v_accvgpr_read_b32 v133, a189
    v_accvgpr_read_b32 v134, a190
    v_accvgpr_read_b32 v135, a191
    v_cvt_pk_bf16_f32 v136, v132, v133
    v_cvt_pk_bf16_f32 v137, v134, v135
    v_add_u32 v6, 1376416, v5
    buffer_store_dwordx2 v[136:137], v6, s[8:11], 0 offen
    s_branch qk_b_kernel_end
qk_b_kernel_nrm:
    buffer_load_dwordx4 v[16:19], v8, s[8:11], s25 offen
    buffer_load_dwordx4 v[20:23], v9, s[8:11], s25 offen
    buffer_load_dwordx4 v[24:27], v10, s[8:11], s25 offen
    buffer_load_dwordx4 v[28:31], v11, s[8:11], s25 offen
    buffer_load_dwordx4 v[32:35], v12, s[8:11], s25 offen
    buffer_load_dwordx4 v[36:39], v13, s[8:11], s25 offen
    buffer_load_dwordx4 v[40:43], v14, s[8:11], s25 offen
    buffer_load_dwordx4 v[44:47], v15, s[8:11], s25 offen
    buffer_load_dwordx4 v[48:51], v7, s[8:11], s32 offen
    buffer_load_dwordx4 v[52:55], v7, s[8:11], s33 offen
    buffer_load_dwordx4 v[56:59], v7, s[8:11], s34 offen
    buffer_load_dwordx4 v[60:63], v7, s[8:11], s35 offen
    buffer_load_dwordx4 v[64:67], v7, s[8:11], s36 offen
    buffer_load_dwordx4 v[68:71], v7, s[8:11], s37 offen
    s_mov_b32 s28, 10
qk_b_kernel_loop1:
    s_add_u32 s25, s25, 64
    s_add_u32 s32, s32, 1024
    s_add_u32 s33, s33, 1024
    s_add_u32 s34, s34, 1024
    s_add_u32 s35, s35, 1024
    s_add_u32 s36, s36, 1024
    s_add_u32 s37, s37, 1024
    buffer_load_dwordx4 v[72:75], v8, s[8:11], s25 offen
    buffer_load_dwordx4 v[76:79], v9, s[8:11], s25 offen
    buffer_load_dwordx4 v[80:83], v10, s[8:11], s25 offen
    buffer_load_dwordx4 v[84:87], v11, s[8:11], s25 offen
    buffer_load_dwordx4 v[88:91], v12, s[8:11], s25 offen
    buffer_load_dwordx4 v[92:95], v13, s[8:11], s25 offen
    buffer_load_dwordx4 v[96:99], v14, s[8:11], s25 offen
    buffer_load_dwordx4 v[100:103], v15, s[8:11], s25 offen
    buffer_load_dwordx4 v[104:107], v7, s[8:11], s32 offen
    buffer_load_dwordx4 v[108:111], v7, s[8:11], s33 offen
    buffer_load_dwordx4 v[112:115], v7, s[8:11], s34 offen
    buffer_load_dwordx4 v[116:119], v7, s[8:11], s35 offen
    buffer_load_dwordx4 v[120:123], v7, s[8:11], s36 offen
    buffer_load_dwordx4 v[124:127], v7, s[8:11], s37 offen
    s_waitcnt vmcnt(14)
    v_mfma_f32_16x16x32_bf16 a[0:3], v[16:19], v[48:51], a[0:3]
    v_mfma_f32_16x16x32_bf16 a[24:27], v[20:23], v[48:51], a[24:27]
    v_mfma_f32_16x16x32_bf16 a[48:51], v[24:27], v[48:51], a[48:51]
    v_mfma_f32_16x16x32_bf16 a[72:75], v[28:31], v[48:51], a[72:75]
    v_mfma_f32_16x16x32_bf16 a[96:99], v[32:35], v[48:51], a[96:99]
    v_mfma_f32_16x16x32_bf16 a[120:123], v[36:39], v[48:51], a[120:123]
    v_mfma_f32_16x16x32_bf16 a[144:147], v[40:43], v[48:51], a[144:147]
    v_mfma_f32_16x16x32_bf16 a[168:171], v[44:47], v[48:51], a[168:171]
    v_mfma_f32_16x16x32_bf16 a[4:7], v[16:19], v[52:55], a[4:7]
    v_mfma_f32_16x16x32_bf16 a[28:31], v[20:23], v[52:55], a[28:31]
    v_mfma_f32_16x16x32_bf16 a[52:55], v[24:27], v[52:55], a[52:55]
    v_mfma_f32_16x16x32_bf16 a[76:79], v[28:31], v[52:55], a[76:79]
    v_mfma_f32_16x16x32_bf16 a[100:103], v[32:35], v[52:55], a[100:103]
    v_mfma_f32_16x16x32_bf16 a[124:127], v[36:39], v[52:55], a[124:127]
    v_mfma_f32_16x16x32_bf16 a[148:151], v[40:43], v[52:55], a[148:151]
    v_mfma_f32_16x16x32_bf16 a[172:175], v[44:47], v[52:55], a[172:175]
    v_mfma_f32_16x16x32_bf16 a[8:11], v[16:19], v[56:59], a[8:11]
    v_mfma_f32_16x16x32_bf16 a[32:35], v[20:23], v[56:59], a[32:35]
    v_mfma_f32_16x16x32_bf16 a[56:59], v[24:27], v[56:59], a[56:59]
    v_mfma_f32_16x16x32_bf16 a[80:83], v[28:31], v[56:59], a[80:83]
    v_mfma_f32_16x16x32_bf16 a[104:107], v[32:35], v[56:59], a[104:107]
    v_mfma_f32_16x16x32_bf16 a[128:131], v[36:39], v[56:59], a[128:131]
    v_mfma_f32_16x16x32_bf16 a[152:155], v[40:43], v[56:59], a[152:155]
    v_mfma_f32_16x16x32_bf16 a[176:179], v[44:47], v[56:59], a[176:179]
    v_mfma_f32_16x16x32_bf16 a[12:15], v[16:19], v[60:63], a[12:15]
    v_mfma_f32_16x16x32_bf16 a[36:39], v[20:23], v[60:63], a[36:39]
    v_mfma_f32_16x16x32_bf16 a[60:63], v[24:27], v[60:63], a[60:63]
    v_mfma_f32_16x16x32_bf16 a[84:87], v[28:31], v[60:63], a[84:87]
    v_mfma_f32_16x16x32_bf16 a[108:111], v[32:35], v[60:63], a[108:111]
    v_mfma_f32_16x16x32_bf16 a[132:135], v[36:39], v[60:63], a[132:135]
    v_mfma_f32_16x16x32_bf16 a[156:159], v[40:43], v[60:63], a[156:159]
    v_mfma_f32_16x16x32_bf16 a[180:183], v[44:47], v[60:63], a[180:183]
    v_mfma_f32_16x16x32_bf16 a[16:19], v[16:19], v[64:67], a[16:19]
    v_mfma_f32_16x16x32_bf16 a[40:43], v[20:23], v[64:67], a[40:43]
    v_mfma_f32_16x16x32_bf16 a[64:67], v[24:27], v[64:67], a[64:67]
    v_mfma_f32_16x16x32_bf16 a[88:91], v[28:31], v[64:67], a[88:91]
    v_mfma_f32_16x16x32_bf16 a[112:115], v[32:35], v[64:67], a[112:115]
    v_mfma_f32_16x16x32_bf16 a[136:139], v[36:39], v[64:67], a[136:139]
    v_mfma_f32_16x16x32_bf16 a[160:163], v[40:43], v[64:67], a[160:163]
    v_mfma_f32_16x16x32_bf16 a[184:187], v[44:47], v[64:67], a[184:187]
    v_mfma_f32_16x16x32_bf16 a[20:23], v[16:19], v[68:71], a[20:23]
    v_mfma_f32_16x16x32_bf16 a[44:47], v[20:23], v[68:71], a[44:47]
    v_mfma_f32_16x16x32_bf16 a[68:71], v[24:27], v[68:71], a[68:71]
    v_mfma_f32_16x16x32_bf16 a[92:95], v[28:31], v[68:71], a[92:95]
    v_mfma_f32_16x16x32_bf16 a[116:119], v[32:35], v[68:71], a[116:119]
    v_mfma_f32_16x16x32_bf16 a[140:143], v[36:39], v[68:71], a[140:143]
    v_mfma_f32_16x16x32_bf16 a[164:167], v[40:43], v[68:71], a[164:167]
    v_mfma_f32_16x16x32_bf16 a[188:191], v[44:47], v[68:71], a[188:191]
    s_sub_u32 s28, s28, 1
    s_cmp_eq_u32 s28, 0
    s_cbranch_scc1 qk_b_kernel_loop1_last
    s_add_u32 s25, s25, 64
    s_add_u32 s32, s32, 1024
    s_add_u32 s33, s33, 1024
    s_add_u32 s34, s34, 1024
    s_add_u32 s35, s35, 1024
    s_add_u32 s36, s36, 1024
    s_add_u32 s37, s37, 1024
    buffer_load_dwordx4 v[16:19], v8, s[8:11], s25 offen
    buffer_load_dwordx4 v[20:23], v9, s[8:11], s25 offen
    buffer_load_dwordx4 v[24:27], v10, s[8:11], s25 offen
    buffer_load_dwordx4 v[28:31], v11, s[8:11], s25 offen
    buffer_load_dwordx4 v[32:35], v12, s[8:11], s25 offen
    buffer_load_dwordx4 v[36:39], v13, s[8:11], s25 offen
    buffer_load_dwordx4 v[40:43], v14, s[8:11], s25 offen
    buffer_load_dwordx4 v[44:47], v15, s[8:11], s25 offen
    buffer_load_dwordx4 v[48:51], v7, s[8:11], s32 offen
    buffer_load_dwordx4 v[52:55], v7, s[8:11], s33 offen
    buffer_load_dwordx4 v[56:59], v7, s[8:11], s34 offen
    buffer_load_dwordx4 v[60:63], v7, s[8:11], s35 offen
    buffer_load_dwordx4 v[64:67], v7, s[8:11], s36 offen
    buffer_load_dwordx4 v[68:71], v7, s[8:11], s37 offen
    s_waitcnt vmcnt(14)
    v_mfma_f32_16x16x32_bf16 a[0:3], v[72:75], v[104:107], a[0:3]
    v_mfma_f32_16x16x32_bf16 a[24:27], v[76:79], v[104:107], a[24:27]
    v_mfma_f32_16x16x32_bf16 a[48:51], v[80:83], v[104:107], a[48:51]
    v_mfma_f32_16x16x32_bf16 a[72:75], v[84:87], v[104:107], a[72:75]
    v_mfma_f32_16x16x32_bf16 a[96:99], v[88:91], v[104:107], a[96:99]
    v_mfma_f32_16x16x32_bf16 a[120:123], v[92:95], v[104:107], a[120:123]
    v_mfma_f32_16x16x32_bf16 a[144:147], v[96:99], v[104:107], a[144:147]
    v_mfma_f32_16x16x32_bf16 a[168:171], v[100:103], v[104:107], a[168:171]
    v_mfma_f32_16x16x32_bf16 a[4:7], v[72:75], v[108:111], a[4:7]
    v_mfma_f32_16x16x32_bf16 a[28:31], v[76:79], v[108:111], a[28:31]
    v_mfma_f32_16x16x32_bf16 a[52:55], v[80:83], v[108:111], a[52:55]
    v_mfma_f32_16x16x32_bf16 a[76:79], v[84:87], v[108:111], a[76:79]
    v_mfma_f32_16x16x32_bf16 a[100:103], v[88:91], v[108:111], a[100:103]
    v_mfma_f32_16x16x32_bf16 a[124:127], v[92:95], v[108:111], a[124:127]
    v_mfma_f32_16x16x32_bf16 a[148:151], v[96:99], v[108:111], a[148:151]
    v_mfma_f32_16x16x32_bf16 a[172:175], v[100:103], v[108:111], a[172:175]
    v_mfma_f32_16x16x32_bf16 a[8:11], v[72:75], v[112:115], a[8:11]
    v_mfma_f32_16x16x32_bf16 a[32:35], v[76:79], v[112:115], a[32:35]
    v_mfma_f32_16x16x32_bf16 a[56:59], v[80:83], v[112:115], a[56:59]
    v_mfma_f32_16x16x32_bf16 a[80:83], v[84:87], v[112:115], a[80:83]
    v_mfma_f32_16x16x32_bf16 a[104:107], v[88:91], v[112:115], a[104:107]
    v_mfma_f32_16x16x32_bf16 a[128:131], v[92:95], v[112:115], a[128:131]
    v_mfma_f32_16x16x32_bf16 a[152:155], v[96:99], v[112:115], a[152:155]
    v_mfma_f32_16x16x32_bf16 a[176:179], v[100:103], v[112:115], a[176:179]
    v_mfma_f32_16x16x32_bf16 a[12:15], v[72:75], v[116:119], a[12:15]
    v_mfma_f32_16x16x32_bf16 a[36:39], v[76:79], v[116:119], a[36:39]
    v_mfma_f32_16x16x32_bf16 a[60:63], v[80:83], v[116:119], a[60:63]
    v_mfma_f32_16x16x32_bf16 a[84:87], v[84:87], v[116:119], a[84:87]
    v_mfma_f32_16x16x32_bf16 a[108:111], v[88:91], v[116:119], a[108:111]
    v_mfma_f32_16x16x32_bf16 a[132:135], v[92:95], v[116:119], a[132:135]
    v_mfma_f32_16x16x32_bf16 a[156:159], v[96:99], v[116:119], a[156:159]
    v_mfma_f32_16x16x32_bf16 a[180:183], v[100:103], v[116:119], a[180:183]
    v_mfma_f32_16x16x32_bf16 a[16:19], v[72:75], v[120:123], a[16:19]
    v_mfma_f32_16x16x32_bf16 a[40:43], v[76:79], v[120:123], a[40:43]
    v_mfma_f32_16x16x32_bf16 a[64:67], v[80:83], v[120:123], a[64:67]
    v_mfma_f32_16x16x32_bf16 a[88:91], v[84:87], v[120:123], a[88:91]
    v_mfma_f32_16x16x32_bf16 a[112:115], v[88:91], v[120:123], a[112:115]
    v_mfma_f32_16x16x32_bf16 a[136:139], v[92:95], v[120:123], a[136:139]
    v_mfma_f32_16x16x32_bf16 a[160:163], v[96:99], v[120:123], a[160:163]
    v_mfma_f32_16x16x32_bf16 a[184:187], v[100:103], v[120:123], a[184:187]
    v_mfma_f32_16x16x32_bf16 a[20:23], v[72:75], v[124:127], a[20:23]
    v_mfma_f32_16x16x32_bf16 a[44:47], v[76:79], v[124:127], a[44:47]
    v_mfma_f32_16x16x32_bf16 a[68:71], v[80:83], v[124:127], a[68:71]
    v_mfma_f32_16x16x32_bf16 a[92:95], v[84:87], v[124:127], a[92:95]
    v_mfma_f32_16x16x32_bf16 a[116:119], v[88:91], v[124:127], a[116:119]
    v_mfma_f32_16x16x32_bf16 a[140:143], v[92:95], v[124:127], a[140:143]
    v_mfma_f32_16x16x32_bf16 a[164:167], v[96:99], v[124:127], a[164:167]
    v_mfma_f32_16x16x32_bf16 a[188:191], v[100:103], v[124:127], a[188:191]
    s_branch qk_b_kernel_loop1
qk_b_kernel_loop1_last:
    s_waitcnt vmcnt(0)
    v_mfma_f32_16x16x32_bf16 a[0:3], v[72:75], v[104:107], a[0:3]
    v_mfma_f32_16x16x32_bf16 a[24:27], v[76:79], v[104:107], a[24:27]
    v_mfma_f32_16x16x32_bf16 a[48:51], v[80:83], v[104:107], a[48:51]
    v_mfma_f32_16x16x32_bf16 a[72:75], v[84:87], v[104:107], a[72:75]
    v_mfma_f32_16x16x32_bf16 a[96:99], v[88:91], v[104:107], a[96:99]
    v_mfma_f32_16x16x32_bf16 a[120:123], v[92:95], v[104:107], a[120:123]
    v_mfma_f32_16x16x32_bf16 a[144:147], v[96:99], v[104:107], a[144:147]
    v_mfma_f32_16x16x32_bf16 a[168:171], v[100:103], v[104:107], a[168:171]
    v_mfma_f32_16x16x32_bf16 a[4:7], v[72:75], v[108:111], a[4:7]
    v_mfma_f32_16x16x32_bf16 a[28:31], v[76:79], v[108:111], a[28:31]
    v_mfma_f32_16x16x32_bf16 a[52:55], v[80:83], v[108:111], a[52:55]
    v_mfma_f32_16x16x32_bf16 a[76:79], v[84:87], v[108:111], a[76:79]
    v_mfma_f32_16x16x32_bf16 a[100:103], v[88:91], v[108:111], a[100:103]
    v_mfma_f32_16x16x32_bf16 a[124:127], v[92:95], v[108:111], a[124:127]
    v_mfma_f32_16x16x32_bf16 a[148:151], v[96:99], v[108:111], a[148:151]
    v_mfma_f32_16x16x32_bf16 a[172:175], v[100:103], v[108:111], a[172:175]
    v_mfma_f32_16x16x32_bf16 a[8:11], v[72:75], v[112:115], a[8:11]
    v_mfma_f32_16x16x32_bf16 a[32:35], v[76:79], v[112:115], a[32:35]
    v_mfma_f32_16x16x32_bf16 a[56:59], v[80:83], v[112:115], a[56:59]
    v_mfma_f32_16x16x32_bf16 a[80:83], v[84:87], v[112:115], a[80:83]
    v_mfma_f32_16x16x32_bf16 a[104:107], v[88:91], v[112:115], a[104:107]
    v_mfma_f32_16x16x32_bf16 a[128:131], v[92:95], v[112:115], a[128:131]
    v_mfma_f32_16x16x32_bf16 a[152:155], v[96:99], v[112:115], a[152:155]
    v_mfma_f32_16x16x32_bf16 a[176:179], v[100:103], v[112:115], a[176:179]
    v_mfma_f32_16x16x32_bf16 a[12:15], v[72:75], v[116:119], a[12:15]
    v_mfma_f32_16x16x32_bf16 a[36:39], v[76:79], v[116:119], a[36:39]
    v_mfma_f32_16x16x32_bf16 a[60:63], v[80:83], v[116:119], a[60:63]
    v_mfma_f32_16x16x32_bf16 a[84:87], v[84:87], v[116:119], a[84:87]
    v_mfma_f32_16x16x32_bf16 a[108:111], v[88:91], v[116:119], a[108:111]
    v_mfma_f32_16x16x32_bf16 a[132:135], v[92:95], v[116:119], a[132:135]
    v_mfma_f32_16x16x32_bf16 a[156:159], v[96:99], v[116:119], a[156:159]
    v_mfma_f32_16x16x32_bf16 a[180:183], v[100:103], v[116:119], a[180:183]
    v_mfma_f32_16x16x32_bf16 a[16:19], v[72:75], v[120:123], a[16:19]
    v_mfma_f32_16x16x32_bf16 a[40:43], v[76:79], v[120:123], a[40:43]
    v_mfma_f32_16x16x32_bf16 a[64:67], v[80:83], v[120:123], a[64:67]
    v_mfma_f32_16x16x32_bf16 a[88:91], v[84:87], v[120:123], a[88:91]
    v_mfma_f32_16x16x32_bf16 a[112:115], v[88:91], v[120:123], a[112:115]
    v_mfma_f32_16x16x32_bf16 a[136:139], v[92:95], v[120:123], a[136:139]
    v_mfma_f32_16x16x32_bf16 a[160:163], v[96:99], v[120:123], a[160:163]
    v_mfma_f32_16x16x32_bf16 a[184:187], v[100:103], v[120:123], a[184:187]
    v_mfma_f32_16x16x32_bf16 a[20:23], v[72:75], v[124:127], a[20:23]
    v_mfma_f32_16x16x32_bf16 a[44:47], v[76:79], v[124:127], a[44:47]
    v_mfma_f32_16x16x32_bf16 a[68:71], v[80:83], v[124:127], a[68:71]
    v_mfma_f32_16x16x32_bf16 a[92:95], v[84:87], v[124:127], a[92:95]
    v_mfma_f32_16x16x32_bf16 a[116:119], v[88:91], v[124:127], a[116:119]
    v_mfma_f32_16x16x32_bf16 a[140:143], v[92:95], v[124:127], a[140:143]
    v_mfma_f32_16x16x32_bf16 a[164:167], v[96:99], v[124:127], a[164:167]
    v_mfma_f32_16x16x32_bf16 a[188:191], v[100:103], v[124:127], a[188:191]
    s_nop 7
    s_nop 7
    s_sub_u32 s29, s23, 12288
    v_add_u32 v5, s29, v3
    v_lshlrev_b32 v5, 5, v5
    v_lshlrev_b32 v6, 2, v4
    v_add_u32 v5, v5, v6
    s_lshr_b32 s30, s22, 5
    s_mul_i32 s30, s30, 196608
    v_add_u32 v5, s30, v5
    v_lshlrev_b32 v5, 1, v5
    v_add_u32 v5, 117440512, v5
    v_accvgpr_read_b32 v132, a0
    v_accvgpr_read_b32 v133, a1
    v_accvgpr_read_b32 v134, a2
    v_accvgpr_read_b32 v135, a3
    v_cvt_pk_bf16_f32 v136, v132, v133
    v_cvt_pk_bf16_f32 v137, v134, v135
    v_add_u32 v6, 0, v5
    buffer_store_dwordx2 v[136:137], v6, s[8:11], 0 offen
    v_accvgpr_read_b32 v132, a4
    v_accvgpr_read_b32 v133, a5
    v_accvgpr_read_b32 v134, a6
    v_accvgpr_read_b32 v135, a7
    v_cvt_pk_bf16_f32 v136, v132, v133
    v_cvt_pk_bf16_f32 v137, v134, v135
    v_add_u32 v6, 1024, v5
    buffer_store_dwordx2 v[136:137], v6, s[8:11], 0 offen
    v_accvgpr_read_b32 v132, a8
    v_accvgpr_read_b32 v133, a9
    v_accvgpr_read_b32 v134, a10
    v_accvgpr_read_b32 v135, a11
    v_cvt_pk_bf16_f32 v136, v132, v133
    v_cvt_pk_bf16_f32 v137, v134, v135
    v_add_u32 v6, 2048, v5
    buffer_store_dwordx2 v[136:137], v6, s[8:11], 0 offen
    v_accvgpr_read_b32 v132, a12
    v_accvgpr_read_b32 v133, a13
    v_accvgpr_read_b32 v134, a14
    v_accvgpr_read_b32 v135, a15
    v_cvt_pk_bf16_f32 v136, v132, v133
    v_cvt_pk_bf16_f32 v137, v134, v135
    v_add_u32 v6, 3072, v5
    buffer_store_dwordx2 v[136:137], v6, s[8:11], 0 offen
    v_accvgpr_read_b32 v132, a16
    v_accvgpr_read_b32 v133, a17
    v_accvgpr_read_b32 v134, a18
    v_accvgpr_read_b32 v135, a19
    v_cvt_pk_bf16_f32 v136, v132, v133
    v_cvt_pk_bf16_f32 v137, v134, v135
    v_add_u32 v6, 4096, v5
    buffer_store_dwordx2 v[136:137], v6, s[8:11], 0 offen
    v_accvgpr_read_b32 v132, a20
    v_accvgpr_read_b32 v133, a21
    v_accvgpr_read_b32 v134, a22
    v_accvgpr_read_b32 v135, a23
    v_cvt_pk_bf16_f32 v136, v132, v133
    v_cvt_pk_bf16_f32 v137, v134, v135
    v_add_u32 v6, 5120, v5
    buffer_store_dwordx2 v[136:137], v6, s[8:11], 0 offen
    v_accvgpr_read_b32 v132, a24
    v_accvgpr_read_b32 v133, a25
    v_accvgpr_read_b32 v134, a26
    v_accvgpr_read_b32 v135, a27
    v_cvt_pk_bf16_f32 v136, v132, v133
    v_cvt_pk_bf16_f32 v137, v134, v135
    v_add_u32 v6, 32, v5
    buffer_store_dwordx2 v[136:137], v6, s[8:11], 0 offen
    v_accvgpr_read_b32 v132, a28
    v_accvgpr_read_b32 v133, a29
    v_accvgpr_read_b32 v134, a30
    v_accvgpr_read_b32 v135, a31
    v_cvt_pk_bf16_f32 v136, v132, v133
    v_cvt_pk_bf16_f32 v137, v134, v135
    v_add_u32 v6, 1056, v5
    buffer_store_dwordx2 v[136:137], v6, s[8:11], 0 offen
    v_accvgpr_read_b32 v132, a32
    v_accvgpr_read_b32 v133, a33
    v_accvgpr_read_b32 v134, a34
    v_accvgpr_read_b32 v135, a35
    v_cvt_pk_bf16_f32 v136, v132, v133
    v_cvt_pk_bf16_f32 v137, v134, v135
    v_add_u32 v6, 2080, v5
    buffer_store_dwordx2 v[136:137], v6, s[8:11], 0 offen
    v_accvgpr_read_b32 v132, a36
    v_accvgpr_read_b32 v133, a37
    v_accvgpr_read_b32 v134, a38
    v_accvgpr_read_b32 v135, a39
    v_cvt_pk_bf16_f32 v136, v132, v133
    v_cvt_pk_bf16_f32 v137, v134, v135
    v_add_u32 v6, 3104, v5
    buffer_store_dwordx2 v[136:137], v6, s[8:11], 0 offen
    v_accvgpr_read_b32 v132, a40
    v_accvgpr_read_b32 v133, a41
    v_accvgpr_read_b32 v134, a42
    v_accvgpr_read_b32 v135, a43
    v_cvt_pk_bf16_f32 v136, v132, v133
    v_cvt_pk_bf16_f32 v137, v134, v135
    v_add_u32 v6, 4128, v5
    buffer_store_dwordx2 v[136:137], v6, s[8:11], 0 offen
    v_accvgpr_read_b32 v132, a44
    v_accvgpr_read_b32 v133, a45
    v_accvgpr_read_b32 v134, a46
    v_accvgpr_read_b32 v135, a47
    v_cvt_pk_bf16_f32 v136, v132, v133
    v_cvt_pk_bf16_f32 v137, v134, v135
    v_add_u32 v6, 5152, v5
    buffer_store_dwordx2 v[136:137], v6, s[8:11], 0 offen
    v_accvgpr_read_b32 v132, a48
    v_accvgpr_read_b32 v133, a49
    v_accvgpr_read_b32 v134, a50
    v_accvgpr_read_b32 v135, a51
    v_cvt_pk_bf16_f32 v136, v132, v133
    v_cvt_pk_bf16_f32 v137, v134, v135
    v_add_u32 v6, 393216, v5
    buffer_store_dwordx2 v[136:137], v6, s[8:11], 0 offen
    v_accvgpr_read_b32 v132, a52
    v_accvgpr_read_b32 v133, a53
    v_accvgpr_read_b32 v134, a54
    v_accvgpr_read_b32 v135, a55
    v_cvt_pk_bf16_f32 v136, v132, v133
    v_cvt_pk_bf16_f32 v137, v134, v135
    v_add_u32 v6, 394240, v5
    buffer_store_dwordx2 v[136:137], v6, s[8:11], 0 offen
    v_accvgpr_read_b32 v132, a56
    v_accvgpr_read_b32 v133, a57
    v_accvgpr_read_b32 v134, a58
    v_accvgpr_read_b32 v135, a59
    v_cvt_pk_bf16_f32 v136, v132, v133
    v_cvt_pk_bf16_f32 v137, v134, v135
    v_add_u32 v6, 395264, v5
    buffer_store_dwordx2 v[136:137], v6, s[8:11], 0 offen
    v_accvgpr_read_b32 v132, a60
    v_accvgpr_read_b32 v133, a61
    v_accvgpr_read_b32 v134, a62
    v_accvgpr_read_b32 v135, a63
    v_cvt_pk_bf16_f32 v136, v132, v133
    v_cvt_pk_bf16_f32 v137, v134, v135
    v_add_u32 v6, 396288, v5
    buffer_store_dwordx2 v[136:137], v6, s[8:11], 0 offen
    v_accvgpr_read_b32 v132, a64
    v_accvgpr_read_b32 v133, a65
    v_accvgpr_read_b32 v134, a66
    v_accvgpr_read_b32 v135, a67
    v_cvt_pk_bf16_f32 v136, v132, v133
    v_cvt_pk_bf16_f32 v137, v134, v135
    v_add_u32 v6, 397312, v5
    buffer_store_dwordx2 v[136:137], v6, s[8:11], 0 offen
    v_accvgpr_read_b32 v132, a68
    v_accvgpr_read_b32 v133, a69
    v_accvgpr_read_b32 v134, a70
    v_accvgpr_read_b32 v135, a71
    v_cvt_pk_bf16_f32 v136, v132, v133
    v_cvt_pk_bf16_f32 v137, v134, v135
    v_add_u32 v6, 398336, v5
    buffer_store_dwordx2 v[136:137], v6, s[8:11], 0 offen
    v_accvgpr_read_b32 v132, a72
    v_accvgpr_read_b32 v133, a73
    v_accvgpr_read_b32 v134, a74
    v_accvgpr_read_b32 v135, a75
    v_cvt_pk_bf16_f32 v136, v132, v133
    v_cvt_pk_bf16_f32 v137, v134, v135
    v_add_u32 v6, 393248, v5
    buffer_store_dwordx2 v[136:137], v6, s[8:11], 0 offen
    v_accvgpr_read_b32 v132, a76
    v_accvgpr_read_b32 v133, a77
    v_accvgpr_read_b32 v134, a78
    v_accvgpr_read_b32 v135, a79
    v_cvt_pk_bf16_f32 v136, v132, v133
    v_cvt_pk_bf16_f32 v137, v134, v135
    v_add_u32 v6, 394272, v5
    buffer_store_dwordx2 v[136:137], v6, s[8:11], 0 offen
    v_accvgpr_read_b32 v132, a80
    v_accvgpr_read_b32 v133, a81
    v_accvgpr_read_b32 v134, a82
    v_accvgpr_read_b32 v135, a83
    v_cvt_pk_bf16_f32 v136, v132, v133
    v_cvt_pk_bf16_f32 v137, v134, v135
    v_add_u32 v6, 395296, v5
    buffer_store_dwordx2 v[136:137], v6, s[8:11], 0 offen
    v_accvgpr_read_b32 v132, a84
    v_accvgpr_read_b32 v133, a85
    v_accvgpr_read_b32 v134, a86
    v_accvgpr_read_b32 v135, a87
    v_cvt_pk_bf16_f32 v136, v132, v133
    v_cvt_pk_bf16_f32 v137, v134, v135
    v_add_u32 v6, 396320, v5
    buffer_store_dwordx2 v[136:137], v6, s[8:11], 0 offen
    v_accvgpr_read_b32 v132, a88
    v_accvgpr_read_b32 v133, a89
    v_accvgpr_read_b32 v134, a90
    v_accvgpr_read_b32 v135, a91
    v_cvt_pk_bf16_f32 v136, v132, v133
    v_cvt_pk_bf16_f32 v137, v134, v135
    v_add_u32 v6, 397344, v5
    buffer_store_dwordx2 v[136:137], v6, s[8:11], 0 offen
    v_accvgpr_read_b32 v132, a92
    v_accvgpr_read_b32 v133, a93
    v_accvgpr_read_b32 v134, a94
    v_accvgpr_read_b32 v135, a95
    v_cvt_pk_bf16_f32 v136, v132, v133
    v_cvt_pk_bf16_f32 v137, v134, v135
    v_add_u32 v6, 398368, v5
    buffer_store_dwordx2 v[136:137], v6, s[8:11], 0 offen
    v_accvgpr_read_b32 v132, a96
    v_accvgpr_read_b32 v133, a97
    v_accvgpr_read_b32 v134, a98
    v_accvgpr_read_b32 v135, a99
    v_cvt_pk_bf16_f32 v136, v132, v133
    v_cvt_pk_bf16_f32 v137, v134, v135
    v_add_u32 v6, 786432, v5
    buffer_store_dwordx2 v[136:137], v6, s[8:11], 0 offen
    v_accvgpr_read_b32 v132, a100
    v_accvgpr_read_b32 v133, a101
    v_accvgpr_read_b32 v134, a102
    v_accvgpr_read_b32 v135, a103
    v_cvt_pk_bf16_f32 v136, v132, v133
    v_cvt_pk_bf16_f32 v137, v134, v135
    v_add_u32 v6, 787456, v5
    buffer_store_dwordx2 v[136:137], v6, s[8:11], 0 offen
    v_accvgpr_read_b32 v132, a104
    v_accvgpr_read_b32 v133, a105
    v_accvgpr_read_b32 v134, a106
    v_accvgpr_read_b32 v135, a107
    v_cvt_pk_bf16_f32 v136, v132, v133
    v_cvt_pk_bf16_f32 v137, v134, v135
    v_add_u32 v6, 788480, v5
    buffer_store_dwordx2 v[136:137], v6, s[8:11], 0 offen
    v_accvgpr_read_b32 v132, a108
    v_accvgpr_read_b32 v133, a109
    v_accvgpr_read_b32 v134, a110
    v_accvgpr_read_b32 v135, a111
    v_cvt_pk_bf16_f32 v136, v132, v133
    v_cvt_pk_bf16_f32 v137, v134, v135
    v_add_u32 v6, 789504, v5
    buffer_store_dwordx2 v[136:137], v6, s[8:11], 0 offen
    v_accvgpr_read_b32 v132, a112
    v_accvgpr_read_b32 v133, a113
    v_accvgpr_read_b32 v134, a114
    v_accvgpr_read_b32 v135, a115
    v_cvt_pk_bf16_f32 v136, v132, v133
    v_cvt_pk_bf16_f32 v137, v134, v135
    v_add_u32 v6, 790528, v5
    buffer_store_dwordx2 v[136:137], v6, s[8:11], 0 offen
    v_accvgpr_read_b32 v132, a116
    v_accvgpr_read_b32 v133, a117
    v_accvgpr_read_b32 v134, a118
    v_accvgpr_read_b32 v135, a119
    v_cvt_pk_bf16_f32 v136, v132, v133
    v_cvt_pk_bf16_f32 v137, v134, v135
    v_add_u32 v6, 791552, v5
    buffer_store_dwordx2 v[136:137], v6, s[8:11], 0 offen
    v_accvgpr_read_b32 v132, a120
    v_accvgpr_read_b32 v133, a121
    v_accvgpr_read_b32 v134, a122
    v_accvgpr_read_b32 v135, a123
    v_cvt_pk_bf16_f32 v136, v132, v133
    v_cvt_pk_bf16_f32 v137, v134, v135
    v_add_u32 v6, 786464, v5
    buffer_store_dwordx2 v[136:137], v6, s[8:11], 0 offen
    v_accvgpr_read_b32 v132, a124
    v_accvgpr_read_b32 v133, a125
    v_accvgpr_read_b32 v134, a126
    v_accvgpr_read_b32 v135, a127
    v_cvt_pk_bf16_f32 v136, v132, v133
    v_cvt_pk_bf16_f32 v137, v134, v135
    v_add_u32 v6, 787488, v5
    buffer_store_dwordx2 v[136:137], v6, s[8:11], 0 offen
    v_accvgpr_read_b32 v132, a128
    v_accvgpr_read_b32 v133, a129
    v_accvgpr_read_b32 v134, a130
    v_accvgpr_read_b32 v135, a131
    v_cvt_pk_bf16_f32 v136, v132, v133
    v_cvt_pk_bf16_f32 v137, v134, v135
    v_add_u32 v6, 788512, v5
    buffer_store_dwordx2 v[136:137], v6, s[8:11], 0 offen
    v_accvgpr_read_b32 v132, a132
    v_accvgpr_read_b32 v133, a133
    v_accvgpr_read_b32 v134, a134
    v_accvgpr_read_b32 v135, a135
    v_cvt_pk_bf16_f32 v136, v132, v133
    v_cvt_pk_bf16_f32 v137, v134, v135
    v_add_u32 v6, 789536, v5
    buffer_store_dwordx2 v[136:137], v6, s[8:11], 0 offen
    v_accvgpr_read_b32 v132, a136
    v_accvgpr_read_b32 v133, a137
    v_accvgpr_read_b32 v134, a138
    v_accvgpr_read_b32 v135, a139
    v_cvt_pk_bf16_f32 v136, v132, v133
    v_cvt_pk_bf16_f32 v137, v134, v135
    v_add_u32 v6, 790560, v5
    buffer_store_dwordx2 v[136:137], v6, s[8:11], 0 offen
    v_accvgpr_read_b32 v132, a140
    v_accvgpr_read_b32 v133, a141
    v_accvgpr_read_b32 v134, a142
    v_accvgpr_read_b32 v135, a143
    v_cvt_pk_bf16_f32 v136, v132, v133
    v_cvt_pk_bf16_f32 v137, v134, v135
    v_add_u32 v6, 791584, v5
    buffer_store_dwordx2 v[136:137], v6, s[8:11], 0 offen
    v_accvgpr_read_b32 v132, a144
    v_accvgpr_read_b32 v133, a145
    v_accvgpr_read_b32 v134, a146
    v_accvgpr_read_b32 v135, a147
    v_cvt_pk_bf16_f32 v136, v132, v133
    v_cvt_pk_bf16_f32 v137, v134, v135
    v_add_u32 v6, 1179648, v5
    buffer_store_dwordx2 v[136:137], v6, s[8:11], 0 offen
    v_accvgpr_read_b32 v132, a148
    v_accvgpr_read_b32 v133, a149
    v_accvgpr_read_b32 v134, a150
    v_accvgpr_read_b32 v135, a151
    v_cvt_pk_bf16_f32 v136, v132, v133
    v_cvt_pk_bf16_f32 v137, v134, v135
    v_add_u32 v6, 1180672, v5
    buffer_store_dwordx2 v[136:137], v6, s[8:11], 0 offen
    v_accvgpr_read_b32 v132, a152
    v_accvgpr_read_b32 v133, a153
    v_accvgpr_read_b32 v134, a154
    v_accvgpr_read_b32 v135, a155
    v_cvt_pk_bf16_f32 v136, v132, v133
    v_cvt_pk_bf16_f32 v137, v134, v135
    v_add_u32 v6, 1181696, v5
    buffer_store_dwordx2 v[136:137], v6, s[8:11], 0 offen
    v_accvgpr_read_b32 v132, a156
    v_accvgpr_read_b32 v133, a157
    v_accvgpr_read_b32 v134, a158
    v_accvgpr_read_b32 v135, a159
    v_cvt_pk_bf16_f32 v136, v132, v133
    v_cvt_pk_bf16_f32 v137, v134, v135
    v_add_u32 v6, 1182720, v5
    buffer_store_dwordx2 v[136:137], v6, s[8:11], 0 offen
    v_accvgpr_read_b32 v132, a160
    v_accvgpr_read_b32 v133, a161
    v_accvgpr_read_b32 v134, a162
    v_accvgpr_read_b32 v135, a163
    v_cvt_pk_bf16_f32 v136, v132, v133
    v_cvt_pk_bf16_f32 v137, v134, v135
    v_add_u32 v6, 1183744, v5
    buffer_store_dwordx2 v[136:137], v6, s[8:11], 0 offen
    v_accvgpr_read_b32 v132, a164
    v_accvgpr_read_b32 v133, a165
    v_accvgpr_read_b32 v134, a166
    v_accvgpr_read_b32 v135, a167
    v_cvt_pk_bf16_f32 v136, v132, v133
    v_cvt_pk_bf16_f32 v137, v134, v135
    v_add_u32 v6, 1184768, v5
    buffer_store_dwordx2 v[136:137], v6, s[8:11], 0 offen
    v_accvgpr_read_b32 v132, a168
    v_accvgpr_read_b32 v133, a169
    v_accvgpr_read_b32 v134, a170
    v_accvgpr_read_b32 v135, a171
    v_cvt_pk_bf16_f32 v136, v132, v133
    v_cvt_pk_bf16_f32 v137, v134, v135
    v_add_u32 v6, 1179680, v5
    buffer_store_dwordx2 v[136:137], v6, s[8:11], 0 offen
    v_accvgpr_read_b32 v132, a172
    v_accvgpr_read_b32 v133, a173
    v_accvgpr_read_b32 v134, a174
    v_accvgpr_read_b32 v135, a175
    v_cvt_pk_bf16_f32 v136, v132, v133
    v_cvt_pk_bf16_f32 v137, v134, v135
    v_add_u32 v6, 1180704, v5
    buffer_store_dwordx2 v[136:137], v6, s[8:11], 0 offen
    v_accvgpr_read_b32 v132, a176
    v_accvgpr_read_b32 v133, a177
    v_accvgpr_read_b32 v134, a178
    v_accvgpr_read_b32 v135, a179
    v_cvt_pk_bf16_f32 v136, v132, v133
    v_cvt_pk_bf16_f32 v137, v134, v135
    v_add_u32 v6, 1181728, v5
    buffer_store_dwordx2 v[136:137], v6, s[8:11], 0 offen
    v_accvgpr_read_b32 v132, a180
    v_accvgpr_read_b32 v133, a181
    v_accvgpr_read_b32 v134, a182
    v_accvgpr_read_b32 v135, a183
    v_cvt_pk_bf16_f32 v136, v132, v133
    v_cvt_pk_bf16_f32 v137, v134, v135
    v_add_u32 v6, 1182752, v5
    buffer_store_dwordx2 v[136:137], v6, s[8:11], 0 offen
    v_accvgpr_read_b32 v132, a184
    v_accvgpr_read_b32 v133, a185
    v_accvgpr_read_b32 v134, a186
    v_accvgpr_read_b32 v135, a187
    v_cvt_pk_bf16_f32 v136, v132, v133
    v_cvt_pk_bf16_f32 v137, v134, v135
    v_add_u32 v6, 1183776, v5
    buffer_store_dwordx2 v[136:137], v6, s[8:11], 0 offen
    v_accvgpr_read_b32 v132, a188
    v_accvgpr_read_b32 v133, a189
    v_accvgpr_read_b32 v134, a190
    v_accvgpr_read_b32 v135, a191
    v_cvt_pk_bf16_f32 v136, v132, v133
    v_cvt_pk_bf16_f32 v137, v134, v135
    v_add_u32 v6, 1184800, v5
    buffer_store_dwordx2 v[136:137], v6, s[8:11], 0 offen
qk_b_kernel_end:
    s_endpgm
.section .rodata,"a"
.p2align 6
.amdhsa_kernel qk_b_kernel
  .amdhsa_next_free_vgpr 344
  .amdhsa_next_free_sgpr 64
  .amdhsa_accum_offset 152
  .amdhsa_group_segment_fixed_size 0
  .amdhsa_kernarg_size 104
  .amdhsa_user_sgpr_count 2
  .amdhsa_user_sgpr_kernarg_segment_ptr 1
  .amdhsa_system_sgpr_workgroup_id_x 1
.end_amdhsa_kernel
.text
.globl vvo_kernel
.p2align 8
.type vvo_kernel,@function
vvo_kernel:
    s_cmp_ge_u32 s2, 256
    s_cbranch_scc1 vvo_kernel_end
    s_load_dwordx2 s[4:5], s[0:1], 96
    v_and_b32 v1, 63, v0
    v_lshrrev_b32 v4, 6, v0
    v_and_b32 v2, 15, v1
    v_lshrrev_b32 v3, 4, v1
    v_readfirstlane_b32 s3, v4
    s_and_b32 s20, s2, 31
    s_lshr_b32 s21, s2, 5
    s_waitcnt lgkmcnt(0)
    s_mov_b32 s8, s4
    s_mov_b32 s9, s5
    s_mov_b32 s10, 268435456
    s_mov_b32 s11, 0x00020000
    s_lshl_b32 s22, s21, 8
    s_lshl_b32 s23, s3, 6
    s_add_u32 s22, s22, s23
    v_add_u32 v5, s22, v2
    v_mul_u32_u24 v5, 1280, v5
    v_lshl_add_u32 v5, v3, 4, v5
    v_add_u32 v5, 0, v5
    v_add_u32 v8, 0, v5
    v_add_u32 v9, 20480, v5
    v_add_u32 v10, 40960, v5
    v_add_u32 v11, 61440, v5
    v_lshrrev_b32 v5, 3, v2
    v_mul_u32_u24 v6, 20480, v5
    v_lshrrev_b32 v5, 2, v2
    v_and_b32 v5, 1, v5
    v_lshlrev_b32 v5, 3, v5
    v_and_b32 v7, 3, v2
    v_add_u32 v5, v5, v7
    v_lshl_add_u32 v5, v3, 4, v5
    v_lshl_add_u32 v6, v5, 4, v6
    s_mul_i32 s24, s20, 245760
    s_add_u32 s24, s24, 49283072
    s_add_u32 s32, s24, 0
    s_add_u32 s33, s24, 40960
    s_add_u32 s34, s24, 81920
    s_add_u32 s35, s24, 122880
    s_add_u32 s36, s24, 163840
    s_add_u32 s37, s24, 204800
    s_mov_b32 s25, 0
    v_accvgpr_write_b32 a0, 0
    v_accvgpr_write_b32 a1, 0
    v_accvgpr_write_b32 a2, 0
    v_accvgpr_write_b32 a3, 0
    v_accvgpr_write_b32 a4, 0
    v_accvgpr_write_b32 a5, 0
    v_accvgpr_write_b32 a6, 0
    v_accvgpr_write_b32 a7, 0
    v_accvgpr_write_b32 a8, 0
    v_accvgpr_write_b32 a9, 0
    v_accvgpr_write_b32 a10, 0
    v_accvgpr_write_b32 a11, 0
    v_accvgpr_write_b32 a12, 0
    v_accvgpr_write_b32 a13, 0
    v_accvgpr_write_b32 a14, 0
    v_accvgpr_write_b32 a15, 0
    v_accvgpr_write_b32 a16, 0
    v_accvgpr_write_b32 a17, 0
    v_accvgpr_write_b32 a18, 0
    v_accvgpr_write_b32 a19, 0
    v_accvgpr_write_b32 a20, 0
    v_accvgpr_write_b32 a21, 0
    v_accvgpr_write_b32 a22, 0
    v_accvgpr_write_b32 a23, 0
    v_accvgpr_write_b32 a24, 0
    v_accvgpr_write_b32 a25, 0
    v_accvgpr_write_b32 a26, 0
    v_accvgpr_write_b32 a27, 0
    v_accvgpr_write_b32 a28, 0
    v_accvgpr_write_b32 a29, 0
    v_accvgpr_write_b32 a30, 0
    v_accvgpr_write_b32 a31, 0
    v_accvgpr_write_b32 a32, 0
    v_accvgpr_write_b32 a33, 0
    v_accvgpr_write_b32 a34, 0
    v_accvgpr_write_b32 a35, 0
    v_accvgpr_write_b32 a36, 0
    v_accvgpr_write_b32 a37, 0
    v_accvgpr_write_b32 a38, 0
    v_accvgpr_write_b32 a39, 0
    v_accvgpr_write_b32 a40, 0
    v_accvgpr_write_b32 a41, 0
    v_accvgpr_write_b32 a42, 0
    v_accvgpr_write_b32 a43, 0
    v_accvgpr_write_b32 a44, 0
    v_accvgpr_write_b32 a45, 0
    v_accvgpr_write_b32 a46, 0
    v_accvgpr_write_b32 a47, 0
    v_accvgpr_write_b32 a48, 0
    v_accvgpr_write_b32 a49, 0
    v_accvgpr_write_b32 a50, 0
    v_accvgpr_write_b32 a51, 0
    v_accvgpr_write_b32 a52, 0
    v_accvgpr_write_b32 a53, 0
    v_accvgpr_write_b32 a54, 0
    v_accvgpr_write_b32 a55, 0
    v_accvgpr_write_b32 a56, 0
    v_accvgpr_write_b32 a57, 0
    v_accvgpr_write_b32 a58, 0
    v_accvgpr_write_b32 a59, 0
    v_accvgpr_write_b32 a60, 0
    v_accvgpr_write_b32 a61, 0
    v_accvgpr_write_b32 a62, 0
    v_accvgpr_write_b32 a63, 0
    v_accvgpr_write_b32 a64, 0
    v_accvgpr_write_b32 a65, 0
    v_accvgpr_write_b32 a66, 0
    v_accvgpr_write_b32 a67, 0
    v_accvgpr_write_b32 a68, 0
    v_accvgpr_write_b32 a69, 0
    v_accvgpr_write_b32 a70, 0
    v_accvgpr_write_b32 a71, 0
    v_accvgpr_write_b32 a72, 0
    v_accvgpr_write_b32 a73, 0
    v_accvgpr_write_b32 a74, 0
    v_accvgpr_write_b32 a75, 0
    v_accvgpr_write_b32 a76, 0
    v_accvgpr_write_b32 a77, 0
    v_accvgpr_write_b32 a78, 0
    v_accvgpr_write_b32 a79, 0
    v_accvgpr_write_b32 a80, 0
    v_accvgpr_write_b32 a81, 0
    v_accvgpr_write_b32 a82, 0
    v_accvgpr_write_b32 a83, 0
    v_accvgpr_write_b32 a84, 0
    v_accvgpr_write_b32 a85, 0
    v_accvgpr_write_b32 a86, 0
    v_accvgpr_write_b32 a87, 0
    v_accvgpr_write_b32 a88, 0
    v_accvgpr_write_b32 a89, 0
    v_accvgpr_write_b32 a90, 0
    v_accvgpr_write_b32 a91, 0
    v_accvgpr_write_b32 a92, 0
    v_accvgpr_write_b32 a93, 0
    v_accvgpr_write_b32 a94, 0
    v_accvgpr_write_b32 a95, 0
    v_accvgpr_write_b32 a96, 0
    v_accvgpr_write_b32 a97, 0
    v_accvgpr_write_b32 a98, 0
    v_accvgpr_write_b32 a99, 0
    v_accvgpr_write_b32 a100, 0
    v_accvgpr_write_b32 a101, 0
    v_accvgpr_write_b32 a102, 0
    v_accvgpr_write_b32 a103, 0
    v_accvgpr_write_b32 a104, 0
    v_accvgpr_write_b32 a105, 0
    v_accvgpr_write_b32 a106, 0
    v_accvgpr_write_b32 a107, 0
    v_accvgpr_write_b32 a108, 0
    v_accvgpr_write_b32 a109, 0
    v_accvgpr_write_b32 a110, 0
    v_accvgpr_write_b32 a111, 0
    v_accvgpr_write_b32 a112, 0
    v_accvgpr_write_b32 a113, 0
    v_accvgpr_write_b32 a114, 0
    v_accvgpr_write_b32 a115, 0
    v_accvgpr_write_b32 a116, 0
    v_accvgpr_write_b32 a117, 0
    v_accvgpr_write_b32 a118, 0
    v_accvgpr_write_b32 a119, 0
    v_accvgpr_write_b32 a120, 0
    v_accvgpr_write_b32 a121, 0
    v_accvgpr_write_b32 a122, 0
    v_accvgpr_write_b32 a123, 0
    v_accvgpr_write_b32 a124, 0
    v_accvgpr_write_b32 a125, 0
    v_accvgpr_write_b32 a126, 0
    v_accvgpr_write_b32 a127, 0
    v_accvgpr_write_b32 a128, 0
    v_accvgpr_write_b32 a129, 0
    v_accvgpr_write_b32 a130, 0
    v_accvgpr_write_b32 a131, 0
    v_accvgpr_write_b32 a132, 0
    v_accvgpr_write_b32 a133, 0
    v_accvgpr_write_b32 a134, 0
    v_accvgpr_write_b32 a135, 0
    v_accvgpr_write_b32 a136, 0
    v_accvgpr_write_b32 a137, 0
    v_accvgpr_write_b32 a138, 0
    v_accvgpr_write_b32 a139, 0
    v_accvgpr_write_b32 a140, 0
    v_accvgpr_write_b32 a141, 0
    v_accvgpr_write_b32 a142, 0
    v_accvgpr_write_b32 a143, 0
    v_accvgpr_write_b32 a144, 0
    v_accvgpr_write_b32 a145, 0
    v_accvgpr_write_b32 a146, 0
    v_accvgpr_write_b32 a147, 0
    v_accvgpr_write_b32 a148, 0
    v_accvgpr_write_b32 a149, 0
    v_accvgpr_write_b32 a150, 0
    v_accvgpr_write_b32 a151, 0
    v_accvgpr_write_b32 a152, 0
    v_accvgpr_write_b32 a153, 0
    v_accvgpr_write_b32 a154, 0
    v_accvgpr_write_b32 a155, 0
    v_accvgpr_write_b32 a156, 0
    v_accvgpr_write_b32 a157, 0
    v_accvgpr_write_b32 a158, 0
    v_accvgpr_write_b32 a159, 0
    v_accvgpr_write_b32 a160, 0
    v_accvgpr_write_b32 a161, 0
    v_accvgpr_write_b32 a162, 0
    v_accvgpr_write_b32 a163, 0
    v_accvgpr_write_b32 a164, 0
    v_accvgpr_write_b32 a165, 0
    v_accvgpr_write_b32 a166, 0
    v_accvgpr_write_b32 a167, 0
    v_accvgpr_write_b32 a168, 0
    v_accvgpr_write_b32 a169, 0
    v_accvgpr_write_b32 a170, 0
    v_accvgpr_write_b32 a171, 0
    v_accvgpr_write_b32 a172, 0
    v_accvgpr_write_b32 a173, 0
    v_accvgpr_write_b32 a174, 0
    v_accvgpr_write_b32 a175, 0
    v_accvgpr_write_b32 a176, 0
    v_accvgpr_write_b32 a177, 0
    v_accvgpr_write_b32 a178, 0
    v_accvgpr_write_b32 a179, 0
    v_accvgpr_write_b32 a180, 0
    v_accvgpr_write_b32 a181, 0
    v_accvgpr_write_b32 a182, 0
    v_accvgpr_write_b32 a183, 0
    v_accvgpr_write_b32 a184, 0
    v_accvgpr_write_b32 a185, 0
    v_accvgpr_write_b32 a186, 0
    v_accvgpr_write_b32 a187, 0
    v_accvgpr_write_b32 a188, 0
    v_accvgpr_write_b32 a189, 0
    v_accvgpr_write_b32 a190, 0
    v_accvgpr_write_b32 a191, 0
    buffer_load_dwordx4 v[16:19], v8, s[8:11], s25 offen
    buffer_load_dwordx4 v[20:23], v9, s[8:11], s25 offen
    buffer_load_dwordx4 v[24:27], v10, s[8:11], s25 offen
    buffer_load_dwordx4 v[28:31], v11, s[8:11], s25 offen
    buffer_load_dwordx4 v[48:51], v6, s[8:11], s32 offen offset:0
    buffer_load_dwordx4 v[52:55], v6, s[8:11], s32 offen offset:64
    buffer_load_dwordx4 v[56:59], v6, s[8:11], s33 offen offset:0
    buffer_load_dwordx4 v[60:63], v6, s[8:11], s33 offen offset:64
    buffer_load_dwordx4 v[64:67], v6, s[8:11], s34 offen offset:0
    buffer_load_dwordx4 v[68:71], v6, s[8:11], s34 offen offset:64
    buffer_load_dwordx4 v[72:75], v6, s[8:11], s35 offen offset:0
    buffer_load_dwordx4 v[76:79], v6, s[8:11], s35 offen offset:64
    buffer_load_dwordx4 v[80:83], v6, s[8:11], s36 offen offset:0
    buffer_load_dwordx4 v[84:87], v6, s[8:11], s36 offen offset:64
    buffer_load_dwordx4 v[88:91], v6, s[8:11], s37 offen offset:0
    buffer_load_dwordx4 v[92:95], v6, s[8:11], s37 offen offset:64
    s_mov_b32 s28, 10
vvo_kernel_l1:
    s_add_u32 s25, s25, 64
    s_add_u32 s32, s32, 1024
    s_add_u32 s33, s33, 1024
    s_add_u32 s34, s34, 1024
    s_add_u32 s35, s35, 1024
    s_add_u32 s36, s36, 1024
    s_add_u32 s37, s37, 1024
    buffer_load_dwordx4 v[32:35], v8, s[8:11], s25 offen
    buffer_load_dwordx4 v[36:39], v9, s[8:11], s25 offen
    buffer_load_dwordx4 v[40:43], v10, s[8:11], s25 offen
    buffer_load_dwordx4 v[44:47], v11, s[8:11], s25 offen
    buffer_load_dwordx4 v[96:99], v6, s[8:11], s32 offen offset:0
    buffer_load_dwordx4 v[100:103], v6, s[8:11], s32 offen offset:64
    buffer_load_dwordx4 v[104:107], v6, s[8:11], s33 offen offset:0
    buffer_load_dwordx4 v[108:111], v6, s[8:11], s33 offen offset:64
    buffer_load_dwordx4 v[112:115], v6, s[8:11], s34 offen offset:0
    buffer_load_dwordx4 v[116:119], v6, s[8:11], s34 offen offset:64
    buffer_load_dwordx4 v[120:123], v6, s[8:11], s35 offen offset:0
    buffer_load_dwordx4 v[124:127], v6, s[8:11], s35 offen offset:64
    buffer_load_dwordx4 v[128:131], v6, s[8:11], s36 offen offset:0
    buffer_load_dwordx4 v[132:135], v6, s[8:11], s36 offen offset:64
    buffer_load_dwordx4 v[136:139], v6, s[8:11], s37 offen offset:0
    buffer_load_dwordx4 v[140:143], v6, s[8:11], s37 offen offset:64
    s_waitcnt vmcnt(16)
    v_mfma_f32_16x16x32_bf16 a[0:3], v[48:51], v[16:19], a[0:3]
    v_mfma_f32_16x16x32_bf16 a[4:7], v[48:51], v[20:23], a[4:7]
    v_mfma_f32_16x16x32_bf16 a[8:11], v[48:51], v[24:27], a[8:11]
    v_mfma_f32_16x16x32_bf16 a[12:15], v[48:51], v[28:31], a[12:15]
    v_mfma_f32_16x16x32_bf16 a[16:19], v[52:55], v[16:19], a[16:19]
    v_mfma_f32_16x16x32_bf16 a[20:23], v[52:55], v[20:23], a[20:23]
    v_mfma_f32_16x16x32_bf16 a[24:27], v[52:55], v[24:27], a[24:27]
    v_mfma_f32_16x16x32_bf16 a[28:31], v[52:55], v[28:31], a[28:31]
    v_mfma_f32_16x16x32_bf16 a[32:35], v[56:59], v[16:19], a[32:35]
    v_mfma_f32_16x16x32_bf16 a[36:39], v[56:59], v[20:23], a[36:39]
    v_mfma_f32_16x16x32_bf16 a[40:43], v[56:59], v[24:27], a[40:43]
    v_mfma_f32_16x16x32_bf16 a[44:47], v[56:59], v[28:31], a[44:47]
    v_mfma_f32_16x16x32_bf16 a[48:51], v[60:63], v[16:19], a[48:51]
    v_mfma_f32_16x16x32_bf16 a[52:55], v[60:63], v[20:23], a[52:55]
    v_mfma_f32_16x16x32_bf16 a[56:59], v[60:63], v[24:27], a[56:59]
    v_mfma_f32_16x16x32_bf16 a[60:63], v[60:63], v[28:31], a[60:63]
    v_mfma_f32_16x16x32_bf16 a[64:67], v[64:67], v[16:19], a[64:67]
    v_mfma_f32_16x16x32_bf16 a[68:71], v[64:67], v[20:23], a[68:71]
    v_mfma_f32_16x16x32_bf16 a[72:75], v[64:67], v[24:27], a[72:75]
    v_mfma_f32_16x16x32_bf16 a[76:79], v[64:67], v[28:31], a[76:79]
    v_mfma_f32_16x16x32_bf16 a[80:83], v[68:71], v[16:19], a[80:83]
    v_mfma_f32_16x16x32_bf16 a[84:87], v[68:71], v[20:23], a[84:87]
    v_mfma_f32_16x16x32_bf16 a[88:91], v[68:71], v[24:27], a[88:91]
    v_mfma_f32_16x16x32_bf16 a[92:95], v[68:71], v[28:31], a[92:95]
    v_mfma_f32_16x16x32_bf16 a[96:99], v[72:75], v[16:19], a[96:99]
    v_mfma_f32_16x16x32_bf16 a[100:103], v[72:75], v[20:23], a[100:103]
    v_mfma_f32_16x16x32_bf16 a[104:107], v[72:75], v[24:27], a[104:107]
    v_mfma_f32_16x16x32_bf16 a[108:111], v[72:75], v[28:31], a[108:111]
    v_mfma_f32_16x16x32_bf16 a[112:115], v[76:79], v[16:19], a[112:115]
    v_mfma_f32_16x16x32_bf16 a[116:119], v[76:79], v[20:23], a[116:119]
    v_mfma_f32_16x16x32_bf16 a[120:123], v[76:79], v[24:27], a[120:123]
    v_mfma_f32_16x16x32_bf16 a[124:127], v[76:79], v[28:31], a[124:127]
    v_mfma_f32_16x16x32_bf16 a[128:131], v[80:83], v[16:19], a[128:131]
    v_mfma_f32_16x16x32_bf16 a[132:135], v[80:83], v[20:23], a[132:135]
    v_mfma_f32_16x16x32_bf16 a[136:139], v[80:83], v[24:27], a[136:139]
    v_mfma_f32_16x16x32_bf16 a[140:143], v[80:83], v[28:31], a[140:143]
    v_mfma_f32_16x16x32_bf16 a[144:147], v[84:87], v[16:19], a[144:147]
    v_mfma_f32_16x16x32_bf16 a[148:151], v[84:87], v[20:23], a[148:151]
    v_mfma_f32_16x16x32_bf16 a[152:155], v[84:87], v[24:27], a[152:155]
    v_mfma_f32_16x16x32_bf16 a[156:159], v[84:87], v[28:31], a[156:159]
    v_mfma_f32_16x16x32_bf16 a[160:163], v[88:91], v[16:19], a[160:163]
    v_mfma_f32_16x16x32_bf16 a[164:167], v[88:91], v[20:23], a[164:167]
    v_mfma_f32_16x16x32_bf16 a[168:171], v[88:91], v[24:27], a[168:171]
    v_mfma_f32_16x16x32_bf16 a[172:175], v[88:91], v[28:31], a[172:175]
    v_mfma_f32_16x16x32_bf16 a[176:179], v[92:95], v[16:19], a[176:179]
    v_mfma_f32_16x16x32_bf16 a[180:183], v[92:95], v[20:23], a[180:183]
    v_mfma_f32_16x16x32_bf16 a[184:187], v[92:95], v[24:27], a[184:187]
    v_mfma_f32_16x16x32_bf16 a[188:191], v[92:95], v[28:31], a[188:191]
    s_sub_u32 s28, s28, 1
    s_cmp_eq_u32 s28, 0
    s_cbranch_scc1 vvo_kernel_l1e
    s_add_u32 s25, s25, 64
    s_add_u32 s32, s32, 1024
    s_add_u32 s33, s33, 1024
    s_add_u32 s34, s34, 1024
    s_add_u32 s35, s35, 1024
    s_add_u32 s36, s36, 1024
    s_add_u32 s37, s37, 1024
    buffer_load_dwordx4 v[16:19], v8, s[8:11], s25 offen
    buffer_load_dwordx4 v[20:23], v9, s[8:11], s25 offen
    buffer_load_dwordx4 v[24:27], v10, s[8:11], s25 offen
    buffer_load_dwordx4 v[28:31], v11, s[8:11], s25 offen
    buffer_load_dwordx4 v[48:51], v6, s[8:11], s32 offen offset:0
    buffer_load_dwordx4 v[52:55], v6, s[8:11], s32 offen offset:64
    buffer_load_dwordx4 v[56:59], v6, s[8:11], s33 offen offset:0
    buffer_load_dwordx4 v[60:63], v6, s[8:11], s33 offen offset:64
    buffer_load_dwordx4 v[64:67], v6, s[8:11], s34 offen offset:0
    buffer_load_dwordx4 v[68:71], v6, s[8:11], s34 offen offset:64
    buffer_load_dwordx4 v[72:75], v6, s[8:11], s35 offen offset:0
    buffer_load_dwordx4 v[76:79], v6, s[8:11], s35 offen offset:64
    buffer_load_dwordx4 v[80:83], v6, s[8:11], s36 offen offset:0
    buffer_load_dwordx4 v[84:87], v6, s[8:11], s36 offen offset:64
    buffer_load_dwordx4 v[88:91], v6, s[8:11], s37 offen offset:0
    buffer_load_dwordx4 v[92:95], v6, s[8:11], s37 offen offset:64
    s_waitcnt vmcnt(16)
    v_mfma_f32_16x16x32_bf16 a[0:3], v[96:99], v[32:35], a[0:3]
    v_mfma_f32_16x16x32_bf16 a[4:7], v[96:99], v[36:39], a[4:7]
    v_mfma_f32_16x16x32_bf16 a[8:11], v[96:99], v[40:43], a[8:11]
    v_mfma_f32_16x16x32_bf16 a[12:15], v[96:99], v[44:47], a[12:15]
    v_mfma_f32_16x16x32_bf16 a[16:19], v[100:103], v[32:35], a[16:19]
    v_mfma_f32_16x16x32_bf16 a[20:23], v[100:103], v[36:39], a[20:23]
    v_mfma_f32_16x16x32_bf16 a[24:27], v[100:103], v[40:43], a[24:27]
    v_mfma_f32_16x16x32_bf16 a[28:31], v[100:103], v[44:47], a[28:31]
    v_mfma_f32_16x16x32_bf16 a[32:35], v[104:107], v[32:35], a[32:35]
    v_mfma_f32_16x16x32_bf16 a[36:39], v[104:107], v[36:39], a[36:39]
    v_mfma_f32_16x16x32_bf16 a[40:43], v[104:107], v[40:43], a[40:43]
    v_mfma_f32_16x16x32_bf16 a[44:47], v[104:107], v[44:47], a[44:47]
    v_mfma_f32_16x16x32_bf16 a[48:51], v[108:111], v[32:35], a[48:51]
    v_mfma_f32_16x16x32_bf16 a[52:55], v[108:111], v[36:39], a[52:55]
    v_mfma_f32_16x16x32_bf16 a[56:59], v[108:111], v[40:43], a[56:59]
    v_mfma_f32_16x16x32_bf16 a[60:63], v[108:111], v[44:47], a[60:63]
    v_mfma_f32_16x16x32_bf16 a[64:67], v[112:115], v[32:35], a[64:67]
    v_mfma_f32_16x16x32_bf16 a[68:71], v[112:115], v[36:39], a[68:71]
    v_mfma_f32_16x16x32_bf16 a[72:75], v[112:115], v[40:43], a[72:75]
    v_mfma_f32_16x16x32_bf16 a[76:79], v[112:115], v[44:47], a[76:79]
    v_mfma_f32_16x16x32_bf16 a[80:83], v[116:119], v[32:35], a[80:83]
    v_mfma_f32_16x16x32_bf16 a[84:87], v[116:119], v[36:39], a[84:87]
    v_mfma_f32_16x16x32_bf16 a[88:91], v[116:119], v[40:43], a[88:91]
    v_mfma_f32_16x16x32_bf16 a[92:95], v[116:119], v[44:47], a[92:95]
    v_mfma_f32_16x16x32_bf16 a[96:99], v[120:123], v[32:35], a[96:99]
    v_mfma_f32_16x16x32_bf16 a[100:103], v[120:123], v[36:39], a[100:103]
    v_mfma_f32_16x16x32_bf16 a[104:107], v[120:123], v[40:43], a[104:107]
    v_mfma_f32_16x16x32_bf16 a[108:111], v[120:123], v[44:47], a[108:111]
    v_mfma_f32_16x16x32_bf16 a[112:115], v[124:127], v[32:35], a[112:115]
    v_mfma_f32_16x16x32_bf16 a[116:119], v[124:127], v[36:39], a[116:119]
    v_mfma_f32_16x16x32_bf16 a[120:123], v[124:127], v[40:43], a[120:123]
    v_mfma_f32_16x16x32_bf16 a[124:127], v[124:127], v[44:47], a[124:127]
    v_mfma_f32_16x16x32_bf16 a[128:131], v[128:131], v[32:35], a[128:131]
    v_mfma_f32_16x16x32_bf16 a[132:135], v[128:131], v[36:39], a[132:135]
    v_mfma_f32_16x16x32_bf16 a[136:139], v[128:131], v[40:43], a[136:139]
    v_mfma_f32_16x16x32_bf16 a[140:143], v[128:131], v[44:47], a[140:143]
    v_mfma_f32_16x16x32_bf16 a[144:147], v[132:135], v[32:35], a[144:147]
    v_mfma_f32_16x16x32_bf16 a[148:151], v[132:135], v[36:39], a[148:151]
    v_mfma_f32_16x16x32_bf16 a[152:155], v[132:135], v[40:43], a[152:155]
    v_mfma_f32_16x16x32_bf16 a[156:159], v[132:135], v[44:47], a[156:159]
    v_mfma_f32_16x16x32_bf16 a[160:163], v[136:139], v[32:35], a[160:163]
    v_mfma_f32_16x16x32_bf16 a[164:167], v[136:139], v[36:39], a[164:167]
    v_mfma_f32_16x16x32_bf16 a[168:171], v[136:139], v[40:43], a[168:171]
    v_mfma_f32_16x16x32_bf16 a[172:175], v[136:139], v[44:47], a[172:175]
    v_mfma_f32_16x16x32_bf16 a[176:179], v[140:143], v[32:35], a[176:179]
    v_mfma_f32_16x16x32_bf16 a[180:183], v[140:143], v[36:39], a[180:183]
    v_mfma_f32_16x16x32_bf16 a[184:187], v[140:143], v[40:43], a[184:187]
    v_mfma_f32_16x16x32_bf16 a[188:191], v[140:143], v[44:47], a[188:191]
    s_branch vvo_kernel_l1
vvo_kernel_l1e:
    s_waitcnt vmcnt(0)
    v_mfma_f32_16x16x32_bf16 a[0:3], v[96:99], v[32:35], a[0:3]
    v_mfma_f32_16x16x32_bf16 a[4:7], v[96:99], v[36:39], a[4:7]
    v_mfma_f32_16x16x32_bf16 a[8:11], v[96:99], v[40:43], a[8:11]
    v_mfma_f32_16x16x32_bf16 a[12:15], v[96:99], v[44:47], a[12:15]
    v_mfma_f32_16x16x32_bf16 a[16:19], v[100:103], v[32:35], a[16:19]
    v_mfma_f32_16x16x32_bf16 a[20:23], v[100:103], v[36:39], a[20:23]
    v_mfma_f32_16x16x32_bf16 a[24:27], v[100:103], v[40:43], a[24:27]
    v_mfma_f32_16x16x32_bf16 a[28:31], v[100:103], v[44:47], a[28:31]
    v_mfma_f32_16x16x32_bf16 a[32:35], v[104:107], v[32:35], a[32:35]
    v_mfma_f32_16x16x32_bf16 a[36:39], v[104:107], v[36:39], a[36:39]
    v_mfma_f32_16x16x32_bf16 a[40:43], v[104:107], v[40:43], a[40:43]
    v_mfma_f32_16x16x32_bf16 a[44:47], v[104:107], v[44:47], a[44:47]
    v_mfma_f32_16x16x32_bf16 a[48:51], v[108:111], v[32:35], a[48:51]
    v_mfma_f32_16x16x32_bf16 a[52:55], v[108:111], v[36:39], a[52:55]
    v_mfma_f32_16x16x32_bf16 a[56:59], v[108:111], v[40:43], a[56:59]
    v_mfma_f32_16x16x32_bf16 a[60:63], v[108:111], v[44:47], a[60:63]
    v_mfma_f32_16x16x32_bf16 a[64:67], v[112:115], v[32:35], a[64:67]
    v_mfma_f32_16x16x32_bf16 a[68:71], v[112:115], v[36:39], a[68:71]
    v_mfma_f32_16x16x32_bf16 a[72:75], v[112:115], v[40:43], a[72:75]
    v_mfma_f32_16x16x32_bf16 a[76:79], v[112:115], v[44:47], a[76:79]
    v_mfma_f32_16x16x32_bf16 a[80:83], v[116:119], v[32:35], a[80:83]
    v_mfma_f32_16x16x32_bf16 a[84:87], v[116:119], v[36:39], a[84:87]
    v_mfma_f32_16x16x32_bf16 a[88:91], v[116:119], v[40:43], a[88:91]
    v_mfma_f32_16x16x32_bf16 a[92:95], v[116:119], v[44:47], a[92:95]
    v_mfma_f32_16x16x32_bf16 a[96:99], v[120:123], v[32:35], a[96:99]
    v_mfma_f32_16x16x32_bf16 a[100:103], v[120:123], v[36:39], a[100:103]
    v_mfma_f32_16x16x32_bf16 a[104:107], v[120:123], v[40:43], a[104:107]
    v_mfma_f32_16x16x32_bf16 a[108:111], v[120:123], v[44:47], a[108:111]
    v_mfma_f32_16x16x32_bf16 a[112:115], v[124:127], v[32:35], a[112:115]
    v_mfma_f32_16x16x32_bf16 a[116:119], v[124:127], v[36:39], a[116:119]
    v_mfma_f32_16x16x32_bf16 a[120:123], v[124:127], v[40:43], a[120:123]
    v_mfma_f32_16x16x32_bf16 a[124:127], v[124:127], v[44:47], a[124:127]
    v_mfma_f32_16x16x32_bf16 a[128:131], v[128:131], v[32:35], a[128:131]
    v_mfma_f32_16x16x32_bf16 a[132:135], v[128:131], v[36:39], a[132:135]
    v_mfma_f32_16x16x32_bf16 a[136:139], v[128:131], v[40:43], a[136:139]
    v_mfma_f32_16x16x32_bf16 a[140:143], v[128:131], v[44:47], a[140:143]
    v_mfma_f32_16x16x32_bf16 a[144:147], v[132:135], v[32:35], a[144:147]
    v_mfma_f32_16x16x32_bf16 a[148:151], v[132:135], v[36:39], a[148:151]
    v_mfma_f32_16x16x32_bf16 a[152:155], v[132:135], v[40:43], a[152:155]
    v_mfma_f32_16x16x32_bf16 a[156:159], v[132:135], v[44:47], a[156:159]
    v_mfma_f32_16x16x32_bf16 a[160:163], v[136:139], v[32:35], a[160:163]
    v_mfma_f32_16x16x32_bf16 a[164:167], v[136:139], v[36:39], a[164:167]
    v_mfma_f32_16x16x32_bf16 a[168:171], v[136:139], v[40:43], a[168:171]
    v_mfma_f32_16x16x32_bf16 a[172:175], v[136:139], v[44:47], a[172:175]
    v_mfma_f32_16x16x32_bf16 a[176:179], v[140:143], v[32:35], a[176:179]
    v_mfma_f32_16x16x32_bf16 a[180:183], v[140:143], v[36:39], a[180:183]
    v_mfma_f32_16x16x32_bf16 a[184:187], v[140:143], v[40:43], a[184:187]
    v_mfma_f32_16x16x32_bf16 a[188:191], v[140:143], v[44:47], a[188:191]
    v_accvgpr_read_b32 v16, a0
    v_accvgpr_read_b32 v17, a1
    v_accvgpr_read_b32 v18, a2
    v_accvgpr_read_b32 v19, a3
    v_cvt_pk_bf16_f32 v144, v16, v17
    v_cvt_pk_bf16_f32 v145, v18, v19
    v_accvgpr_read_b32 v16, a16
    v_accvgpr_read_b32 v17, a17
    v_accvgpr_read_b32 v18, a18
    v_accvgpr_read_b32 v19, a19
    v_cvt_pk_bf16_f32 v146, v16, v17
    v_cvt_pk_bf16_f32 v147, v18, v19
    v_accvgpr_read_b32 v16, a4
    v_accvgpr_read_b32 v17, a5
    v_accvgpr_read_b32 v18, a6
    v_accvgpr_read_b32 v19, a7
    v_cvt_pk_bf16_f32 v148, v16, v17
    v_cvt_pk_bf16_f32 v149, v18, v19
    v_accvgpr_read_b32 v16, a20
    v_accvgpr_read_b32 v17, a21
    v_accvgpr_read_b32 v18, a22
    v_accvgpr_read_b32 v19, a23
    v_cvt_pk_bf16_f32 v150, v16, v17
    v_cvt_pk_bf16_f32 v151, v18, v19
    v_accvgpr_read_b32 v16, a8
    v_accvgpr_read_b32 v17, a9
    v_accvgpr_read_b32 v18, a10
    v_accvgpr_read_b32 v19, a11
    v_cvt_pk_bf16_f32 v152, v16, v17
    v_cvt_pk_bf16_f32 v153, v18, v19
    v_accvgpr_read_b32 v16, a24
    v_accvgpr_read_b32 v17, a25
    v_accvgpr_read_b32 v18, a26
    v_accvgpr_read_b32 v19, a27
    v_cvt_pk_bf16_f32 v154, v16, v17
    v_cvt_pk_bf16_f32 v155, v18, v19
    v_accvgpr_read_b32 v16, a12
    v_accvgpr_read_b32 v17, a13
    v_accvgpr_read_b32 v18, a14
    v_accvgpr_read_b32 v19, a15
    v_cvt_pk_bf16_f32 v156, v16, v17
    v_cvt_pk_bf16_f32 v157, v18, v19
    v_accvgpr_read_b32 v16, a28
    v_accvgpr_read_b32 v17, a29
    v_accvgpr_read_b32 v18, a30
    v_accvgpr_read_b32 v19, a31
    v_cvt_pk_bf16_f32 v158, v16, v17
    v_cvt_pk_bf16_f32 v159, v18, v19
    v_accvgpr_read_b32 v16, a32
    v_accvgpr_read_b32 v17, a33
    v_accvgpr_read_b32 v18, a34
    v_accvgpr_read_b32 v19, a35
    v_cvt_pk_bf16_f32 v160, v16, v17
    v_cvt_pk_bf16_f32 v161, v18, v19
    v_accvgpr_read_b32 v16, a48
    v_accvgpr_read_b32 v17, a49
    v_accvgpr_read_b32 v18, a50
    v_accvgpr_read_b32 v19, a51
    v_cvt_pk_bf16_f32 v162, v16, v17
    v_cvt_pk_bf16_f32 v163, v18, v19
    v_accvgpr_read_b32 v16, a36
    v_accvgpr_read_b32 v17, a37
    v_accvgpr_read_b32 v18, a38
    v_accvgpr_read_b32 v19, a39
    v_cvt_pk_bf16_f32 v164, v16, v17
    v_cvt_pk_bf16_f32 v165, v18, v19
    v_accvgpr_read_b32 v16, a52
    v_accvgpr_read_b32 v17, a53
    v_accvgpr_read_b32 v18, a54
    v_accvgpr_read_b32 v19, a55
    v_cvt_pk_bf16_f32 v166, v16, v17
    v_cvt_pk_bf16_f32 v167, v18, v19
    v_accvgpr_read_b32 v16, a40
    v_accvgpr_read_b32 v17, a41
    v_accvgpr_read_b32 v18, a42
    v_accvgpr_read_b32 v19, a43
    v_cvt_pk_bf16_f32 v168, v16, v17
    v_cvt_pk_bf16_f32 v169, v18, v19
    v_accvgpr_read_b32 v16, a56
    v_accvgpr_read_b32 v17, a57
    v_accvgpr_read_b32 v18, a58
    v_accvgpr_read_b32 v19, a59
    v_cvt_pk_bf16_f32 v170, v16, v17
    v_cvt_pk_bf16_f32 v171, v18, v19
    v_accvgpr_read_b32 v16, a44
    v_accvgpr_read_b32 v17, a45
    v_accvgpr_read_b32 v18, a46
    v_accvgpr_read_b32 v19, a47
    v_cvt_pk_bf16_f32 v172, v16, v17
    v_cvt_pk_bf16_f32 v173, v18, v19
    v_accvgpr_read_b32 v16, a60
    v_accvgpr_read_b32 v17, a61
    v_accvgpr_read_b32 v18, a62
    v_accvgpr_read_b32 v19, a63
    v_cvt_pk_bf16_f32 v174, v16, v17
    v_cvt_pk_bf16_f32 v175, v18, v19
    v_accvgpr_read_b32 v16, a64
    v_accvgpr_read_b32 v17, a65
    v_accvgpr_read_b32 v18, a66
    v_accvgpr_read_b32 v19, a67
    v_cvt_pk_bf16_f32 v176, v16, v17
    v_cvt_pk_bf16_f32 v177, v18, v19
    v_accvgpr_read_b32 v16, a80
    v_accvgpr_read_b32 v17, a81
    v_accvgpr_read_b32 v18, a82
    v_accvgpr_read_b32 v19, a83
    v_cvt_pk_bf16_f32 v178, v16, v17
    v_cvt_pk_bf16_f32 v179, v18, v19
    v_accvgpr_read_b32 v16, a68
    v_accvgpr_read_b32 v17, a69
    v_accvgpr_read_b32 v18, a70
    v_accvgpr_read_b32 v19, a71
    v_cvt_pk_bf16_f32 v180, v16, v17
    v_cvt_pk_bf16_f32 v181, v18, v19
    v_accvgpr_read_b32 v16, a84
    v_accvgpr_read_b32 v17, a85
    v_accvgpr_read_b32 v18, a86
    v_accvgpr_read_b32 v19, a87
    v_cvt_pk_bf16_f32 v182, v16, v17
    v_cvt_pk_bf16_f32 v183, v18, v19
    v_accvgpr_read_b32 v16, a72
    v_accvgpr_read_b32 v17, a73
    v_accvgpr_read_b32 v18, a74
    v_accvgpr_read_b32 v19, a75
    v_cvt_pk_bf16_f32 v184, v16, v17
    v_cvt_pk_bf16_f32 v185, v18, v19
    v_accvgpr_read_b32 v16, a88
    v_accvgpr_read_b32 v17, a89
    v_accvgpr_read_b32 v18, a90
    v_accvgpr_read_b32 v19, a91
    v_cvt_pk_bf16_f32 v186, v16, v17
    v_cvt_pk_bf16_f32 v187, v18, v19
    v_accvgpr_read_b32 v16, a76
    v_accvgpr_read_b32 v17, a77
    v_accvgpr_read_b32 v18, a78
    v_accvgpr_read_b32 v19, a79
    v_cvt_pk_bf16_f32 v188, v16, v17
    v_cvt_pk_bf16_f32 v189, v18, v19
    v_accvgpr_read_b32 v16, a92
    v_accvgpr_read_b32 v17, a93
    v_accvgpr_read_b32 v18, a94
    v_accvgpr_read_b32 v19, a95
    v_cvt_pk_bf16_f32 v190, v16, v17
    v_cvt_pk_bf16_f32 v191, v18, v19
    v_accvgpr_read_b32 v16, a96
    v_accvgpr_read_b32 v17, a97
    v_accvgpr_read_b32 v18, a98
    v_accvgpr_read_b32 v19, a99
    v_cvt_pk_bf16_f32 v192, v16, v17
    v_cvt_pk_bf16_f32 v193, v18, v19
    v_accvgpr_read_b32 v16, a112
    v_accvgpr_read_b32 v17, a113
    v_accvgpr_read_b32 v18, a114
    v_accvgpr_read_b32 v19, a115
    v_cvt_pk_bf16_f32 v194, v16, v17
    v_cvt_pk_bf16_f32 v195, v18, v19
    v_accvgpr_read_b32 v16, a100
    v_accvgpr_read_b32 v17, a101
    v_accvgpr_read_b32 v18, a102
    v_accvgpr_read_b32 v19, a103
    v_cvt_pk_bf16_f32 v196, v16, v17
    v_cvt_pk_bf16_f32 v197, v18, v19
    v_accvgpr_read_b32 v16, a116
    v_accvgpr_read_b32 v17, a117
    v_accvgpr_read_b32 v18, a118
    v_accvgpr_read_b32 v19, a119
    v_cvt_pk_bf16_f32 v198, v16, v17
    v_cvt_pk_bf16_f32 v199, v18, v19
    v_accvgpr_read_b32 v16, a104
    v_accvgpr_read_b32 v17, a105
    v_accvgpr_read_b32 v18, a106
    v_accvgpr_read_b32 v19, a107
    v_cvt_pk_bf16_f32 v200, v16, v17
    v_cvt_pk_bf16_f32 v201, v18, v19
    v_accvgpr_read_b32 v16, a120
    v_accvgpr_read_b32 v17, a121
    v_accvgpr_read_b32 v18, a122
    v_accvgpr_read_b32 v19, a123
    v_cvt_pk_bf16_f32 v202, v16, v17
    v_cvt_pk_bf16_f32 v203, v18, v19
    v_accvgpr_read_b32 v16, a108
    v_accvgpr_read_b32 v17, a109
    v_accvgpr_read_b32 v18, a110
    v_accvgpr_read_b32 v19, a111
    v_cvt_pk_bf16_f32 v204, v16, v17
    v_cvt_pk_bf16_f32 v205, v18, v19
    v_accvgpr_read_b32 v16, a124
    v_accvgpr_read_b32 v17, a125
    v_accvgpr_read_b32 v18, a126
    v_accvgpr_read_b32 v19, a127
    v_cvt_pk_bf16_f32 v206, v16, v17
    v_cvt_pk_bf16_f32 v207, v18, v19
    v_accvgpr_read_b32 v16, a128
    v_accvgpr_read_b32 v17, a129
    v_accvgpr_read_b32 v18, a130
    v_accvgpr_read_b32 v19, a131
    v_cvt_pk_bf16_f32 v208, v16, v17
    v_cvt_pk_bf16_f32 v209, v18, v19
    v_accvgpr_read_b32 v16, a144
    v_accvgpr_read_b32 v17, a145
    v_accvgpr_read_b32 v18, a146
    v_accvgpr_read_b32 v19, a147
    v_cvt_pk_bf16_f32 v210, v16, v17
    v_cvt_pk_bf16_f32 v211, v18, v19
    v_accvgpr_read_b32 v16, a132
    v_accvgpr_read_b32 v17, a133
    v_accvgpr_read_b32 v18, a134
    v_accvgpr_read_b32 v19, a135
    v_cvt_pk_bf16_f32 v212, v16, v17
    v_cvt_pk_bf16_f32 v213, v18, v19
    v_accvgpr_read_b32 v16, a148
    v_accvgpr_read_b32 v17, a149
    v_accvgpr_read_b32 v18, a150
    v_accvgpr_read_b32 v19, a151
    v_cvt_pk_bf16_f32 v214, v16, v17
    v_cvt_pk_bf16_f32 v215, v18, v19
    v_accvgpr_read_b32 v16, a136
    v_accvgpr_read_b32 v17, a137
    v_accvgpr_read_b32 v18, a138
    v_accvgpr_read_b32 v19, a139
    v_cvt_pk_bf16_f32 v216, v16, v17
    v_cvt_pk_bf16_f32 v217, v18, v19
    v_accvgpr_read_b32 v16, a152
    v_accvgpr_read_b32 v17, a153
    v_accvgpr_read_b32 v18, a154
    v_accvgpr_read_b32 v19, a155
    v_cvt_pk_bf16_f32 v218, v16, v17
    v_cvt_pk_bf16_f32 v219, v18, v19
    v_accvgpr_read_b32 v16, a140
    v_accvgpr_read_b32 v17, a141
    v_accvgpr_read_b32 v18, a142
    v_accvgpr_read_b32 v19, a143
    v_cvt_pk_bf16_f32 v220, v16, v17
    v_cvt_pk_bf16_f32 v221, v18, v19
    v_accvgpr_read_b32 v16, a156
    v_accvgpr_read_b32 v17, a157
    v_accvgpr_read_b32 v18, a158
    v_accvgpr_read_b32 v19, a159
    v_cvt_pk_bf16_f32 v222, v16, v17
    v_cvt_pk_bf16_f32 v223, v18, v19
    v_accvgpr_read_b32 v16, a160
    v_accvgpr_read_b32 v17, a161
    v_accvgpr_read_b32 v18, a162
    v_accvgpr_read_b32 v19, a163
    v_cvt_pk_bf16_f32 v224, v16, v17
    v_cvt_pk_bf16_f32 v225, v18, v19
    v_accvgpr_read_b32 v16, a176
    v_accvgpr_read_b32 v17, a177
    v_accvgpr_read_b32 v18, a178
    v_accvgpr_read_b32 v19, a179
    v_cvt_pk_bf16_f32 v226, v16, v17
    v_cvt_pk_bf16_f32 v227, v18, v19
    v_accvgpr_read_b32 v16, a164
    v_accvgpr_read_b32 v17, a165
    v_accvgpr_read_b32 v18, a166
    v_accvgpr_read_b32 v19, a167
    v_cvt_pk_bf16_f32 v228, v16, v17
    v_cvt_pk_bf16_f32 v229, v18, v19
    v_accvgpr_read_b32 v16, a180
    v_accvgpr_read_b32 v17, a181
    v_accvgpr_read_b32 v18, a182
    v_accvgpr_read_b32 v19, a183
    v_cvt_pk_bf16_f32 v230, v16, v17
    v_cvt_pk_bf16_f32 v231, v18, v19
    v_accvgpr_read_b32 v16, a168
    v_accvgpr_read_b32 v17, a169
    v_accvgpr_read_b32 v18, a170
    v_accvgpr_read_b32 v19, a171
    v_cvt_pk_bf16_f32 v232, v16, v17
    v_cvt_pk_bf16_f32 v233, v18, v19
    v_accvgpr_read_b32 v16, a184
    v_accvgpr_read_b32 v17, a185
    v_accvgpr_read_b32 v18, a186
    v_accvgpr_read_b32 v19, a187
    v_cvt_pk_bf16_f32 v234, v16, v17
    v_cvt_pk_bf16_f32 v235, v18, v19
    v_accvgpr_read_b32 v16, a172
    v_accvgpr_read_b32 v17, a173
    v_accvgpr_read_b32 v18, a174
    v_accvgpr_read_b32 v19, a175
    v_cvt_pk_bf16_f32 v236, v16, v17
    v_cvt_pk_bf16_f32 v237, v18, v19
    v_accvgpr_read_b32 v16, a188
    v_accvgpr_read_b32 v17, a189
    v_accvgpr_read_b32 v18, a190
    v_accvgpr_read_b32 v19, a191
    v_cvt_pk_bf16_f32 v238, v16, v17
    v_cvt_pk_bf16_f32 v239, v18, v19
    v_lshlrev_b32 v5, 4, v1
    s_mul_i32 s24, s20, 6144
    s_add_u32 s24, s24, 58720256
    s_lshl_b32 s26, s21, 3
    s_lshl_b32 s27, s3, 1
    s_add_u32 s26, s26, s27
    s_mul_i32 s26, s26, 1310720
    s_lshl_b32 s27, s20, 10
    s_add_u32 s26, s26, s27
    s_add_u32 s26, s26, 184549376
    s_add_u32 s27, s26, 1310720
    s_add_u32 s29, s24, 4096
    buffer_load_dwordx4 v[16:19], v5, s[8:11], s24 offen offset:0
    buffer_load_dwordx4 v[20:23], v5, s[8:11], s24 offen offset:1024
    buffer_load_dwordx4 v[24:27], v5, s[8:11], s24 offen offset:2048
    buffer_load_dwordx4 v[28:31], v5, s[8:11], s24 offen offset:3072
    buffer_load_dwordx4 v[32:35], v5, s[8:11], s29 offen offset:0
    buffer_load_dwordx4 v[36:39], v5, s[8:11], s29 offen offset:1024
    s_add_u32 s24, s24, 196608
    s_mov_b32 s28, 20
vvo_kernel_l2:
    s_add_u32 s29, s24, 4096
    buffer_load_dwordx4 v[40:43], v5, s[8:11], s24 offen offset:0
    buffer_load_dwordx4 v[44:47], v5, s[8:11], s24 offen offset:1024
    buffer_load_dwordx4 v[48:51], v5, s[8:11], s24 offen offset:2048
    buffer_load_dwordx4 v[52:55], v5, s[8:11], s24 offen offset:3072
    buffer_load_dwordx4 v[56:59], v5, s[8:11], s29 offen offset:0
    buffer_load_dwordx4 v[60:63], v5, s[8:11], s29 offen offset:1024
    s_add_u32 s24, s24, 196608
    s_waitcnt vmcnt(6)
    v_mfma_f32_16x16x32_bf16 v[64:67], v[144:147], v[16:19], 0
    v_mfma_f32_16x16x32_bf16 v[68:71], v[148:151], v[16:19], 0
    v_mfma_f32_16x16x32_bf16 v[72:75], v[152:155], v[16:19], 0
    v_mfma_f32_16x16x32_bf16 v[76:79], v[156:159], v[16:19], 0
    v_mfma_f32_16x16x32_bf16 v[64:67], v[160:163], v[20:23], v[64:67]
    v_mfma_f32_16x16x32_bf16 v[68:71], v[164:167], v[20:23], v[68:71]
    v_mfma_f32_16x16x32_bf16 v[72:75], v[168:171], v[20:23], v[72:75]
    v_mfma_f32_16x16x32_bf16 v[76:79], v[172:175], v[20:23], v[76:79]
    v_mfma_f32_16x16x32_bf16 v[64:67], v[176:179], v[24:27], v[64:67]
    v_mfma_f32_16x16x32_bf16 v[68:71], v[180:183], v[24:27], v[68:71]
    v_mfma_f32_16x16x32_bf16 v[72:75], v[184:187], v[24:27], v[72:75]
    v_mfma_f32_16x16x32_bf16 v[76:79], v[188:191], v[24:27], v[76:79]
    v_mfma_f32_16x16x32_bf16 v[64:67], v[192:195], v[28:31], v[64:67]
    v_mfma_f32_16x16x32_bf16 v[68:71], v[196:199], v[28:31], v[68:71]
    v_mfma_f32_16x16x32_bf16 v[72:75], v[200:203], v[28:31], v[72:75]
    v_mfma_f32_16x16x32_bf16 v[76:79], v[204:207], v[28:31], v[76:79]
    v_mfma_f32_16x16x32_bf16 v[64:67], v[208:211], v[32:35], v[64:67]
    v_mfma_f32_16x16x32_bf16 v[68:71], v[212:215], v[32:35], v[68:71]
    v_mfma_f32_16x16x32_bf16 v[72:75], v[216:219], v[32:35], v[72:75]
    v_mfma_f32_16x16x32_bf16 v[76:79], v[220:223], v[32:35], v[76:79]
    v_mfma_f32_16x16x32_bf16 v[64:67], v[224:227], v[36:39], v[64:67]
    v_mfma_f32_16x16x32_bf16 v[68:71], v[228:231], v[36:39], v[68:71]
    v_mfma_f32_16x16x32_bf16 v[72:75], v[232:235], v[36:39], v[72:75]
    v_mfma_f32_16x16x32_bf16 v[76:79], v[236:239], v[36:39], v[76:79]
    s_nop 4
    v_cvt_pk_bf16_f32 v96, v64, v65
    v_cvt_pk_bf16_f32 v97, v66, v67
    v_cvt_pk_bf16_f32 v98, v68, v69
    v_cvt_pk_bf16_f32 v99, v70, v71
    buffer_store_dwordx4 v[96:99], v5, s[8:11], s26 offen
    v_cvt_pk_bf16_f32 v100, v72, v73
    v_cvt_pk_bf16_f32 v101, v74, v75
    v_cvt_pk_bf16_f32 v102, v76, v77
    v_cvt_pk_bf16_f32 v103, v78, v79
    buffer_store_dwordx4 v[100:103], v5, s[8:11], s27 offen
    s_add_u32 s26, s26, 32768
    s_add_u32 s27, s27, 32768
    s_sub_u32 s28, s28, 1
    s_cmp_eq_u32 s28, 0
    s_cbranch_scc1 vvo_kernel_l2e
    s_add_u32 s29, s24, 4096
    buffer_load_dwordx4 v[16:19], v5, s[8:11], s24 offen offset:0
    buffer_load_dwordx4 v[20:23], v5, s[8:11], s24 offen offset:1024
    buffer_load_dwordx4 v[24:27], v5, s[8:11], s24 offen offset:2048
    buffer_load_dwordx4 v[28:31], v5, s[8:11], s24 offen offset:3072
    buffer_load_dwordx4 v[32:35], v5, s[8:11], s29 offen offset:0
    buffer_load_dwordx4 v[36:39], v5, s[8:11], s29 offen offset:1024
    s_add_u32 s24, s24, 196608
    s_waitcnt vmcnt(6)
    v_mfma_f32_16x16x32_bf16 v[80:83], v[144:147], v[40:43], 0
    v_mfma_f32_16x16x32_bf16 v[84:87], v[148:151], v[40:43], 0
    v_mfma_f32_16x16x32_bf16 v[88:91], v[152:155], v[40:43], 0
    v_mfma_f32_16x16x32_bf16 v[92:95], v[156:159], v[40:43], 0
    v_mfma_f32_16x16x32_bf16 v[80:83], v[160:163], v[44:47], v[80:83]
    v_mfma_f32_16x16x32_bf16 v[84:87], v[164:167], v[44:47], v[84:87]
    v_mfma_f32_16x16x32_bf16 v[88:91], v[168:171], v[44:47], v[88:91]
    v_mfma_f32_16x16x32_bf16 v[92:95], v[172:175], v[44:47], v[92:95]
    v_mfma_f32_16x16x32_bf16 v[80:83], v[176:179], v[48:51], v[80:83]
    v_mfma_f32_16x16x32_bf16 v[84:87], v[180:183], v[48:51], v[84:87]
    v_mfma_f32_16x16x32_bf16 v[88:91], v[184:187], v[48:51], v[88:91]
    v_mfma_f32_16x16x32_bf16 v[92:95], v[188:191], v[48:51], v[92:95]
    v_mfma_f32_16x16x32_bf16 v[80:83], v[192:195], v[52:55], v[80:83]
    v_mfma_f32_16x16x32_bf16 v[84:87], v[196:199], v[52:55], v[84:87]
    v_mfma_f32_16x16x32_bf16 v[88:91], v[200:203], v[52:55], v[88:91]
    v_mfma_f32_16x16x32_bf16 v[92:95], v[204:207], v[52:55], v[92:95]
    v_mfma_f32_16x16x32_bf16 v[80:83], v[208:211], v[56:59], v[80:83]
    v_mfma_f32_16x16x32_bf16 v[84:87], v[212:215], v[56:59], v[84:87]
    v_mfma_f32_16x16x32_bf16 v[88:91], v[216:219], v[56:59], v[88:91]
    v_mfma_f32_16x16x32_bf16 v[92:95], v[220:223], v[56:59], v[92:95]
    v_mfma_f32_16x16x32_bf16 v[80:83], v[224:227], v[60:63], v[80:83]
    v_mfma_f32_16x16x32_bf16 v[84:87], v[228:231], v[60:63], v[84:87]
    v_mfma_f32_16x16x32_bf16 v[88:91], v[232:235], v[60:63], v[88:91]
    v_mfma_f32_16x16x32_bf16 v[92:95], v[236:239], v[60:63], v[92:95]
    s_nop 4
    v_cvt_pk_bf16_f32 v96, v80, v81
    v_cvt_pk_bf16_f32 v97, v82, v83
    v_cvt_pk_bf16_f32 v98, v84, v85
    v_cvt_pk_bf16_f32 v99, v86, v87
    buffer_store_dwordx4 v[96:99], v5, s[8:11], s26 offen
    v_cvt_pk_bf16_f32 v100, v88, v89
    v_cvt_pk_bf16_f32 v101, v90, v91
    v_cvt_pk_bf16_f32 v102, v92, v93
    v_cvt_pk_bf16_f32 v103, v94, v95
    buffer_store_dwordx4 v[100:103], v5, s[8:11], s27 offen
    s_add_u32 s26, s26, 32768
    s_add_u32 s27, s27, 32768
    s_branch vvo_kernel_l2
vvo_kernel_l2e:
    s_waitcnt vmcnt(2)
    v_mfma_f32_16x16x32_bf16 v[80:83], v[144:147], v[40:43], 0
    v_mfma_f32_16x16x32_bf16 v[84:87], v[148:151], v[40:43], 0
    v_mfma_f32_16x16x32_bf16 v[88:91], v[152:155], v[40:43], 0
    v_mfma_f32_16x16x32_bf16 v[92:95], v[156:159], v[40:43], 0
    v_mfma_f32_16x16x32_bf16 v[80:83], v[160:163], v[44:47], v[80:83]
    v_mfma_f32_16x16x32_bf16 v[84:87], v[164:167], v[44:47], v[84:87]
    v_mfma_f32_16x16x32_bf16 v[88:91], v[168:171], v[44:47], v[88:91]
    v_mfma_f32_16x16x32_bf16 v[92:95], v[172:175], v[44:47], v[92:95]
    v_mfma_f32_16x16x32_bf16 v[80:83], v[176:179], v[48:51], v[80:83]
    v_mfma_f32_16x16x32_bf16 v[84:87], v[180:183], v[48:51], v[84:87]
    v_mfma_f32_16x16x32_bf16 v[88:91], v[184:187], v[48:51], v[88:91]
    v_mfma_f32_16x16x32_bf16 v[92:95], v[188:191], v[48:51], v[92:95]
    v_mfma_f32_16x16x32_bf16 v[80:83], v[192:195], v[52:55], v[80:83]
    v_mfma_f32_16x16x32_bf16 v[84:87], v[196:199], v[52:55], v[84:87]
    v_mfma_f32_16x16x32_bf16 v[88:91], v[200:203], v[52:55], v[88:91]
    v_mfma_f32_16x16x32_bf16 v[92:95], v[204:207], v[52:55], v[92:95]
    v_mfma_f32_16x16x32_bf16 v[80:83], v[208:211], v[56:59], v[80:83]
    v_mfma_f32_16x16x32_bf16 v[84:87], v[212:215], v[56:59], v[84:87]
    v_mfma_f32_16x16x32_bf16 v[88:91], v[216:219], v[56:59], v[88:91]
    v_mfma_f32_16x16x32_bf16 v[92:95], v[220:223], v[56:59], v[92:95]
    v_mfma_f32_16x16x32_bf16 v[80:83], v[224:227], v[60:63], v[80:83]
    v_mfma_f32_16x16x32_bf16 v[84:87], v[228:231], v[60:63], v[84:87]
    v_mfma_f32_16x16x32_bf16 v[88:91], v[232:235], v[60:63], v[88:91]
    v_mfma_f32_16x16x32_bf16 v[92:95], v[236:239], v[60:63], v[92:95]
    s_nop 4
    v_cvt_pk_bf16_f32 v96, v80, v81
    v_cvt_pk_bf16_f32 v97, v82, v83
    v_cvt_pk_bf16_f32 v98, v84, v85
    v_cvt_pk_bf16_f32 v99, v86, v87
    buffer_store_dwordx4 v[96:99], v5, s[8:11], s26 offen
    v_cvt_pk_bf16_f32 v100, v88, v89
    v_cvt_pk_bf16_f32 v101, v90, v91
    v_cvt_pk_bf16_f32 v102, v92, v93
    v_cvt_pk_bf16_f32 v103, v94, v95
    buffer_store_dwordx4 v[100:103], v5, s[8:11], s27 offen
    s_add_u32 s26, s26, 32768
    s_add_u32 s27, s27, 32768
vvo_kernel_end:
    s_endpgm
.section .rodata,"a"
.p2align 6
.amdhsa_kernel vvo_kernel
  .amdhsa_next_free_vgpr 448
  .amdhsa_next_free_sgpr 64
  .amdhsa_accum_offset 256
  .amdhsa_group_segment_fixed_size 0
  .amdhsa_kernarg_size 104
  .amdhsa_user_sgpr_count 2
  .amdhsa_user_sgpr_kernarg_segment_ptr 1
  .amdhsa_system_sgpr_workgroup_id_x 1
.end_amdhsa_kernel
.text
.globl clr_kernel
.p2align 8
.type clr_kernel,@function
clr_kernel:
    s_cmp_ge_u32 s2, 1042
    s_cbranch_scc1 clr_kernel_end
    s_load_dwordx2 s[4:5], s[0:1], 96
    s_waitcnt lgkmcnt(0)
    s_add_u32 s8, s4, 117440512
    s_addc_u32 s9, s5, 0
    s_mov_b32 s10, 34119680
    s_mov_b32 s11, 0x00020000
    s_mul_i32 s12, s2, 32768
    v_lshlrev_b32 v1, 4, v0
    v_add_u32 v1, s12, v1
    v_mov_b32 v4, -1
    v_mov_b32 v5, -1
    v_mov_b32 v6, -1
    v_mov_b32 v7, -1
    s_mov_b32 s13, 0
    buffer_store_dwordx4 v[4:7], v1, s[8:11], s13 offen
    s_mov_b32 s13, 4096
    buffer_store_dwordx4 v[4:7], v1, s[8:11], s13 offen
    s_mov_b32 s13, 8192
    buffer_store_dwordx4 v[4:7], v1, s[8:11], s13 offen
    s_mov_b32 s13, 12288
    buffer_store_dwordx4 v[4:7], v1, s[8:11], s13 offen
    s_mov_b32 s13, 16384
    buffer_store_dwordx4 v[4:7], v1, s[8:11], s13 offen
    s_mov_b32 s13, 20480
    buffer_store_dwordx4 v[4:7], v1, s[8:11], s13 offen
    s_mov_b32 s13, 24576
    buffer_store_dwordx4 v[4:7], v1, s[8:11], s13 offen
    s_mov_b32 s13, 28672
    buffer_store_dwordx4 v[4:7], v1, s[8:11], s13 offen
clr_kernel_end:
    s_endpgm
.section .rodata,"a"
.p2align 6
.amdhsa_kernel clr_kernel
  .amdhsa_next_free_vgpr 16
  .amdhsa_next_free_sgpr 24
  .amdhsa_accum_offset 16
  .amdhsa_group_segment_fixed_size 0
  .amdhsa_kernarg_size 104
  .amdhsa_user_sgpr_count 2
  .amdhsa_user_sgpr_kernarg_segment_ptr 1
  .amdhsa_system_sgpr_workgroup_id_x 1
.end_amdhsa_kernel
.text
.globl chain1_kernel
.p2align 8
.type chain1_kernel,@function
chain1_kernel:
    s_cmp_ge_u32 s2, 104
    s_cbranch_scc1 chain1_kernel_end
    s_load_dwordx2 s[4:5], s[0:1], 96
    s_load_dwordx2 s[6:7], s[0:1], 32
    v_and_b32 v1, 63, v0
    v_lshrrev_b32 v4, 6, v0
    v_and_b32 v2, 15, v1
    v_lshrrev_b32 v3, 4, v1
    v_readfirstlane_b32 s3, v4
    s_mov_b32 s60, 131072
    s_waitcnt lgkmcnt(0)
    s_mov_b32 s8, s4
    s_mov_b32 s9, s5
    s_mov_b32 s10, 268435456
    s_mov_b32 s11, 0x00020000
    s_mov_b32 s20, s6
    s_mov_b32 s21, s7
    s_mov_b32 s22, 10240
    s_mov_b32 s23, 0x00020000
    s_cmp_ge_u32 s2, 64
    s_cbranch_scc1 chain1_kernel_roleR
    s_cmp_ge_u32 s2, 32
    s_cbranch_scc1 chain1_kernel_roleV
    s_mov_b32 s44, s2
    s_load_dwordx2 s[6:7], s[0:1], 40
    s_load_dwordx2 s[24:25], s[0:1], 48
    s_waitcnt lgkmcnt(0)
    s_mov_b32 s12, s6
    s_mov_b32 s13, s7
    s_mov_b32 s14, 7864320
    s_mov_b32 s15, 0x00020000
    s_mov_b32 s16, s24
    s_mov_b32 s17, s25
    s_mov_b32 s18, 7864320
    s_mov_b32 s19, 0x00020000
    v_add_u32 v16, 0, v0
    s_mov_b32 s24, 683
    v_mul_lo_u32 v17, v16, s24
    v_lshrrev_b32 v17, 14, v17
    v_mul_u32_u24 v18, 24, v17
    v_sub_u32 v18, v16, v18
    s_mov_b32 s24, 12288
    v_mul_lo_u32 v4, v17, s24
    v_lshl_add_u32 v4, v18, 4, v4
    v_mul_u32_u24 v10, 400, v17
    v_lshl_add_u32 v10, v18, 4, v10
    v_add_u32 v10, 106496, v10
    v_add_u32 v16, 256, v0
    s_mov_b32 s24, 683
    v_mul_lo_u32 v17, v16, s24
    v_lshrrev_b32 v17, 14, v17
    v_mul_u32_u24 v18, 24, v17
    v_sub_u32 v18, v16, v18
    s_mov_b32 s24, 12288
    v_mul_lo_u32 v5, v17, s24
    v_lshl_add_u32 v5, v18, 4, v5
    v_mul_u32_u24 v11, 400, v17
    v_lshl_add_u32 v11, v18, 4, v11
    v_add_u32 v11, 106496, v11
    v_add_u32 v16, 512, v0
    s_mov_b32 s24, 683
    v_mul_lo_u32 v17, v16, s24
    v_lshrrev_b32 v17, 14, v17
    v_mul_u32_u24 v18, 24, v17
    v_sub_u32 v18, v16, v18
    s_mov_b32 s24, 12288
    v_mul_lo_u32 v6, v17, s24
    v_lshl_add_u32 v6, v18, 4, v6
    v_mul_u32_u24 v12, 400, v17
    v_lshl_add_u32 v12, v18, 4, v12
    v_add_u32 v12, 106496, v12
    v_add_u32 v16, 768, v0
    s_mov_b32 s24, 683
    v_mul_lo_u32 v17, v16, s24
    v_lshrrev_b32 v17, 14, v17
    v_mul_u32_u24 v18, 24, v17
    v_sub_u32 v18, v16, v18
    s_mov_b32 s24, 12288
    v_mul_lo_u32 v7, v17, s24
    v_lshl_add_u32 v7, v18, 4, v7
    v_mul_u32_u24 v13, 400, v17
    v_lshl_add_u32 v13, v18, 4, v13
    v_add_u32 v13, 106496, v13
    v_add_u32 v16, 1024, v0
    s_mov_b32 s24, 683
    v_mul_lo_u32 v17, v16, s24
    v_lshrrev_b32 v17, 14, v17
    v_mul_u32_u24 v18, 24, v17
    v_sub_u32 v18, v16, v18
    s_mov_b32 s24, 12288
    v_mul_lo_u32 v8, v17, s24
    v_lshl_add_u32 v8, v18, 4, v8
    v_mul_u32_u24 v14, 400, v17
    v_lshl_add_u32 v14, v18, 4, v14
    v_add_u32 v14, 106496, v14
    v_add_u32 v16, 1280, v0
    s_mov_b32 s24, 683
    v_mul_lo_u32 v17, v16, s24
    v_lshrrev_b32 v17, 14, v17
    v_mul_u32_u24 v18, 24, v17
    v_sub_u32 v18, v16, v18
    s_mov_b32 s24, 12288
    v_mul_lo_u32 v9, v17, s24
    v_lshl_add_u32 v9, v18, 4, v9
    v_mul_u32_u24 v15, 400, v17
    v_lshl_add_u32 v15, v18, 4, v15
    v_add_u32 v15, 106496, v15
    v_lshrrev_b32 v17, 1, v3
    v_lshlrev_b32 v17, 4, v17
    v_and_b32 v18, 1, v3
    v_lshl_add_u32 v17, v18, 2, v17
    v_lshrrev_b32 v18, 2, v2
    v_and_b32 v19, 1, v18
    v_add_u32 v17, v17, v19
    v_lshrrev_b32 v18, 1, v18
    v_lshl_add_u32 v17, v18, 3, v17
    v_mul_u32_u24 v16, 400, v17
    v_and_b32 v18, 3, v2
    v_lshl_add_u32 v16, v18, 3, v16
    v_add_u32 v16, 106496, v16
    s_mul_i32 s24, s3, 96
    v_add_u32 v16, s24, v16
    v_lshlrev_b32 v17, 4, v1
    s_mul_i32 s24, s3, 20480
    s_add_u32 s24, s24, 24576
    v_add_u32 v17, s24, v17
    s_mul_i32 s45, s44, 384
    s_add_u32 s46, s45, 0
    buffer_load_dwordx4 v[24:27], v4, s[12:15], s46 offen
    buffer_load_dwordx4 v[28:31], v5, s[12:15], s46 offen
    buffer_load_dwordx4 v[32:35], v6, s[12:15], s46 offen
    buffer_load_dwordx4 v[36:39], v7, s[12:15], s46 offen
    buffer_load_dwordx4 v[40:43], v8, s[12:15], s46 offen
    buffer_load_dwordx4 v[44:47], v9, s[12:15], s46 offen
    s_add_u32 s46, s45, 0
    buffer_load_dwordx4 v[48:51], v4, s[16:19], s46 offen
    buffer_load_dwordx4 v[52:55], v5, s[16:19], s46 offen
    buffer_load_dwordx4 v[56:59], v6, s[16:19], s46 offen
    buffer_load_dwordx4 v[60:63], v7, s[16:19], s46 offen
    buffer_load_dwordx4 v[64:67], v8, s[16:19], s46 offen
    buffer_load_dwordx4 v[68:71], v9, s[16:19], s46 offen
    s_waitcnt vmcnt(6)
    ds_write_b128 v10, v[24:27]
    ds_write_b128 v11, v[28:31]
    ds_write_b128 v12, v[32:35]
    ds_write_b128 v13, v[36:39]
    ds_write_b128 v14, v[40:43]
    ds_write_b128 v15, v[44:47]
    s_add_u32 s46, s45, 786432
    buffer_load_dwordx4 v[72:75], v4, s[12:15], s46 offen
    buffer_load_dwordx4 v[76:79], v5, s[12:15], s46 offen
    buffer_load_dwordx4 v[80:83], v6, s[12:15], s46 offen
    buffer_load_dwordx4 v[84:87], v7, s[12:15], s46 offen
    buffer_load_dwordx4 v[88:91], v8, s[12:15], s46 offen
    buffer_load_dwordx4 v[92:95], v9, s[12:15], s46 offen
    s_waitcnt lgkmcnt(0)
    s_barrier
    ds_read_b64_tr_b16 a[0:1], v16 offset:0
    ds_read_b64_tr_b16 a[2:3], v16 offset:800
    ds_read_b64_tr_b16 a[4:5], v16 offset:12800
    ds_read_b64_tr_b16 a[6:7], v16 offset:13600
    ds_read_b64_tr_b16 a[80:81], v16 offset:32
    ds_read_b64_tr_b16 a[82:83], v16 offset:832
    ds_read_b64_tr_b16 a[84:85], v16 offset:12832
    ds_read_b64_tr_b16 a[86:87], v16 offset:13632
    ds_read_b64_tr_b16 a[160:161], v16 offset:64
    ds_read_b64_tr_b16 a[162:163], v16 offset:864
    ds_read_b64_tr_b16 a[164:165], v16 offset:12864
    ds_read_b64_tr_b16 a[166:167], v16 offset:13664
    s_waitcnt lgkmcnt(0)
    s_barrier
    s_waitcnt vmcnt(6)
    ds_write_b128 v10, v[48:51]
    ds_write_b128 v11, v[52:55]
    ds_write_b128 v12, v[56:59]
    ds_write_b128 v13, v[60:63]
    ds_write_b128 v14, v[64:67]
    ds_write_b128 v15, v[68:71]
    s_add_u32 s46, s45, 786432
    buffer_load_dwordx4 v[24:27], v4, s[16:19], s46 offen
    buffer_load_dwordx4 v[28:31], v5, s[16:19], s46 offen
    buffer_load_dwordx4 v[32:35], v6, s[16:19], s46 offen
    buffer_load_dwordx4 v[36:39], v7, s[16:19], s46 offen
    buffer_load_dwordx4 v[40:43], v8, s[16:19], s46 offen
    buffer_load_dwordx4 v[44:47], v9, s[16:19], s46 offen
    s_waitcnt lgkmcnt(0)
    s_barrier
    ds_read_b64_tr_b16 v[96:97], v16 offset:0
    ds_read_b64_tr_b16 v[98:99], v16 offset:800
    ds_read_b64_tr_b16 v[100:101], v16 offset:12800
    ds_read_b64_tr_b16 v[102:103], v16 offset:13600
    ds_read_b64_tr_b16 v[176:177], v16 offset:32
    ds_read_b64_tr_b16 v[178:179], v16 offset:832
    ds_read_b64_tr_b16 v[180:181], v16 offset:12832
    ds_read_b64_tr_b16 v[182:183], v16 offset:13632
    ds_read_b64_tr_b16 v[48:49], v16 offset:64
    ds_read_b64_tr_b16 v[50:51], v16 offset:864
    ds_read_b64_tr_b16 v[52:53], v16 offset:12864
    ds_read_b64_tr_b16 v[54:55], v16 offset:13664
    s_waitcnt lgkmcnt(0)
    ds_write_b128 v17, v[48:51] offset:0
    ds_write_b128 v17, v[52:55] offset:1024
    s_waitcnt lgkmcnt(0)
    s_barrier
    s_waitcnt vmcnt(6)
    ds_write_b128 v10, v[72:75]
    ds_write_b128 v11, v[76:79]
    ds_write_b128 v12, v[80:83]
    ds_write_b128 v13, v[84:87]
    ds_write_b128 v14, v[88:91]
    ds_write_b128 v15, v[92:95]
    s_add_u32 s46, s45, 1572864
    buffer_load_dwordx4 v[48:51], v4, s[12:15], s46 offen
    buffer_load_dwordx4 v[52:55], v5, s[12:15], s46 offen
    buffer_load_dwordx4 v[56:59], v6, s[12:15], s46 offen
    buffer_load_dwordx4 v[60:63], v7, s[12:15], s46 offen
    buffer_load_dwordx4 v[64:67], v8, s[12:15], s46 offen
    buffer_load_dwordx4 v[68:71], v9, s[12:15], s46 offen
    s_waitcnt lgkmcnt(0)
    s_barrier
    ds_read_b64_tr_b16 a[8:9], v16 offset:0
    ds_read_b64_tr_b16 a[10:11], v16 offset:800
    ds_read_b64_tr_b16 a[12:13], v16 offset:12800
    ds_read_b64_tr_b16 a[14:15], v16 offset:13600
    ds_read_b64_tr_b16 a[88:89], v16 offset:32
    ds_read_b64_tr_b16 a[90:91], v16 offset:832
    ds_read_b64_tr_b16 a[92:93], v16 offset:12832
    ds_read_b64_tr_b16 a[94:95], v16 offset:13632
    ds_read_b64_tr_b16 a[168:169], v16 offset:64
    ds_read_b64_tr_b16 a[170:171], v16 offset:864
    ds_read_b64_tr_b16 a[172:173], v16 offset:12864
    ds_read_b64_tr_b16 a[174:175], v16 offset:13664
    s_waitcnt lgkmcnt(0)
    s_barrier
    s_waitcnt vmcnt(6)
    ds_write_b128 v10, v[24:27]
    ds_write_b128 v11, v[28:31]
    ds_write_b128 v12, v[32:35]
    ds_write_b128 v13, v[36:39]
    ds_write_b128 v14, v[40:43]
    ds_write_b128 v15, v[44:47]
    s_add_u32 s46, s45, 1572864
    buffer_load_dwordx4 v[72:75], v4, s[16:19], s46 offen
    buffer_load_dwordx4 v[76:79], v5, s[16:19], s46 offen
    buffer_load_dwordx4 v[80:83], v6, s[16:19], s46 offen
    buffer_load_dwordx4 v[84:87], v7, s[16:19], s46 offen
    buffer_load_dwordx4 v[88:91], v8, s[16:19], s46 offen
    buffer_load_dwordx4 v[92:95], v9, s[16:19], s46 offen
    s_waitcnt lgkmcnt(0)
    s_barrier
    ds_read_b64_tr_b16 v[104:105], v16 offset:0
    ds_read_b64_tr_b16 v[106:107], v16 offset:800
    ds_read_b64_tr_b16 v[108:109], v16 offset:12800
    ds_read_b64_tr_b16 v[110:111], v16 offset:13600
    ds_read_b64_tr_b16 v[184:185], v16 offset:32
    ds_read_b64_tr_b16 v[186:187], v16 offset:832
    ds_read_b64_tr_b16 v[188:189], v16 offset:12832
    ds_read_b64_tr_b16 v[190:191], v16 offset:13632
    ds_read_b64_tr_b16 v[24:25], v16 offset:64
    ds_read_b64_tr_b16 v[26:27], v16 offset:864
    ds_read_b64_tr_b16 v[28:29], v16 offset:12864
    ds_read_b64_tr_b16 v[30:31], v16 offset:13664
    s_waitcnt lgkmcnt(0)
    ds_write_b128 v17, v[24:27] offset:2048
    ds_write_b128 v17, v[28:31] offset:3072
    s_waitcnt lgkmcnt(0)
    s_barrier
    s_waitcnt vmcnt(6)
    ds_write_b128 v10, v[48:51]
    ds_write_b128 v11, v[52:55]
    ds_write_b128 v12, v[56:59]
    ds_write_b128 v13, v[60:63]
    ds_write_b128 v14, v[64:67]
    ds_write_b128 v15, v[68:71]
    s_add_u32 s46, s45, 2359296
    buffer_load_dwordx4 v[24:27], v4, s[12:15], s46 offen
    buffer_load_dwordx4 v[28:31], v5, s[12:15], s46 offen
    buffer_load_dwordx4 v[32:35], v6, s[12:15], s46 offen
    buffer_load_dwordx4 v[36:39], v7, s[12:15], s46 offen
    buffer_load_dwordx4 v[40:43], v8, s[12:15], s46 offen
    buffer_load_dwordx4 v[44:47], v9, s[12:15], s46 offen
    s_waitcnt lgkmcnt(0)
    s_barrier
    ds_read_b64_tr_b16 a[16:17], v16 offset:0
    ds_read_b64_tr_b16 a[18:19], v16 offset:800
    ds_read_b64_tr_b16 a[20:21], v16 offset:12800
    ds_read_b64_tr_b16 a[22:23], v16 offset:13600
    ds_read_b64_tr_b16 a[96:97], v16 offset:32
    ds_read_b64_tr_b16 a[98:99], v16 offset:832
    ds_read_b64_tr_b16 a[100:101], v16 offset:12832
    ds_read_b64_tr_b16 a[102:103], v16 offset:13632
    ds_read_b64_tr_b16 a[176:177], v16 offset:64
    ds_read_b64_tr_b16 a[178:179], v16 offset:864
    ds_read_b64_tr_b16 a[180:181], v16 offset:12864
    ds_read_b64_tr_b16 a[182:183], v16 offset:13664
    s_waitcnt lgkmcnt(0)
    s_barrier
    s_waitcnt vmcnt(6)
    ds_write_b128 v10, v[72:75]
    ds_write_b128 v11, v[76:79]
    ds_write_b128 v12, v[80:83]
    ds_write_b128 v13, v[84:87]
    ds_write_b128 v14, v[88:91]
    ds_write_b128 v15, v[92:95]
    s_add_u32 s46, s45, 2359296
    buffer_load_dwordx4 v[48:51], v4, s[16:19], s46 offen
    buffer_load_dwordx4 v[52:55], v5, s[16:19], s46 offen
    buffer_load_dwordx4 v[56:59], v6, s[16:19], s46 offen
    buffer_load_dwordx4 v[60:63], v7, s[16:19], s46 offen
    buffer_load_dwordx4 v[64:67], v8, s[16:19], s46 offen
    buffer_load_dwordx4 v[68:71], v9, s[16:19], s46 offen
    s_waitcnt lgkmcnt(0)
    s_barrier
    ds_read_b64_tr_b16 v[112:113], v16 offset:0
    ds_read_b64_tr_b16 v[114:115], v16 offset:800
    ds_read_b64_tr_b16 v[116:117], v16 offset:12800
    ds_read_b64_tr_b16 v[118:119], v16 offset:13600
    ds_read_b64_tr_b16 v[192:193], v16 offset:32
    ds_read_b64_tr_b16 v[194:195], v16 offset:832
    ds_read_b64_tr_b16 v[196:197], v16 offset:12832
    ds_read_b64_tr_b16 v[198:199], v16 offset:13632
    ds_read_b64_tr_b16 v[72:73], v16 offset:64
    ds_read_b64_tr_b16 v[74:75], v16 offset:864
    ds_read_b64_tr_b16 v[76:77], v16 offset:12864
    ds_read_b64_tr_b16 v[78:79], v16 offset:13664
    s_waitcnt lgkmcnt(0)
    ds_write_b128 v17, v[72:75] offset:4096
    ds_write_b128 v17, v[76:79] offset:5120
    s_waitcnt lgkmcnt(0)
    s_barrier
    s_waitcnt vmcnt(6)
    ds_write_b128 v10, v[24:27]
    ds_write_b128 v11, v[28:31]
    ds_write_b128 v12, v[32:35]
    ds_write_b128 v13, v[36:39]
    ds_write_b128 v14, v[40:43]
    ds_write_b128 v15, v[44:47]
    s_add_u32 s46, s45, 3145728
    buffer_load_dwordx4 v[72:75], v4, s[12:15], s46 offen
    buffer_load_dwordx4 v[76:79], v5, s[12:15], s46 offen
    buffer_load_dwordx4 v[80:83], v6, s[12:15], s46 offen
    buffer_load_dwordx4 v[84:87], v7, s[12:15], s46 offen
    buffer_load_dwordx4 v[88:91], v8, s[12:15], s46 offen
    buffer_load_dwordx4 v[92:95], v9, s[12:15], s46 offen
    s_waitcnt lgkmcnt(0)
    s_barrier
    ds_read_b64_tr_b16 a[24:25], v16 offset:0
    ds_read_b64_tr_b16 a[26:27], v16 offset:800
    ds_read_b64_tr_b16 a[28:29], v16 offset:12800
    ds_read_b64_tr_b16 a[30:31], v16 offset:13600
    ds_read_b64_tr_b16 a[104:105], v16 offset:32
    ds_read_b64_tr_b16 a[106:107], v16 offset:832
    ds_read_b64_tr_b16 a[108:109], v16 offset:12832
    ds_read_b64_tr_b16 a[110:111], v16 offset:13632
    ds_read_b64_tr_b16 a[184:185], v16 offset:64
    ds_read_b64_tr_b16 a[186:187], v16 offset:864
    ds_read_b64_tr_b16 a[188:189], v16 offset:12864
    ds_read_b64_tr_b16 a[190:191], v16 offset:13664
    s_waitcnt lgkmcnt(0)
    s_barrier
    s_waitcnt vmcnt(6)
    ds_write_b128 v10, v[48:51]
    ds_write_b128 v11, v[52:55]
    ds_write_b128 v12, v[56:59]
    ds_write_b128 v13, v[60:63]
    ds_write_b128 v14, v[64:67]
    ds_write_b128 v15, v[68:71]
    s_add_u32 s46, s45, 3145728
    buffer_load_dwordx4 v[24:27], v4, s[16:19], s46 offen
    buffer_load_dwordx4 v[28:31], v5, s[16:19], s46 offen
    buffer_load_dwordx4 v[32:35], v6, s[16:19], s46 offen
    buffer_load_dwordx4 v[36:39], v7, s[16:19], s46 offen
    buffer_load_dwordx4 v[40:43], v8, s[16:19], s46 offen
    buffer_load_dwordx4 v[44:47], v9, s[16:19], s46 offen
    s_waitcnt lgkmcnt(0)
    s_barrier
    ds_read_b64_tr_b16 v[120:121], v16 offset:0
    ds_read_b64_tr_b16 v[122:123], v16 offset:800
    ds_read_b64_tr_b16 v[124:125], v16 offset:12800
    ds_read_b64_tr_b16 v[126:127], v16 offset:13600
    ds_read_b64_tr_b16 v[200:201], v16 offset:32
    ds_read_b64_tr_b16 v[202:203], v16 offset:832
    ds_read_b64_tr_b16 v[204:205], v16 offset:12832
    ds_read_b64_tr_b16 v[206:207], v16 offset:13632
    ds_read_b64_tr_b16 v[48:49], v16 offset:64
    ds_read_b64_tr_b16 v[50:51], v16 offset:864
    ds_read_b64_tr_b16 v[52:53], v16 offset:12864
    ds_read_b64_tr_b16 v[54:55], v16 offset:13664
    s_waitcnt lgkmcnt(0)
    ds_write_b128 v17, v[48:51] offset:6144
    ds_write_b128 v17, v[52:55] offset:7168
    s_waitcnt lgkmcnt(0)
    s_barrier
    s_waitcnt vmcnt(6)
    ds_write_b128 v10, v[72:75]
    ds_write_b128 v11, v[76:79]
    ds_write_b128 v12, v[80:83]
    ds_write_b128 v13, v[84:87]
    ds_write_b128 v14, v[88:91]
    ds_write_b128 v15, v[92:95]
    s_add_u32 s46, s45, 3932160
    buffer_load_dwordx4 v[48:51], v4, s[12:15], s46 offen
    buffer_load_dwordx4 v[52:55], v5, s[12:15], s46 offen
    buffer_load_dwordx4 v[56:59], v6, s[12:15], s46 offen
    buffer_load_dwordx4 v[60:63], v7, s[12:15], s46 offen
    buffer_load_dwordx4 v[64:67], v8, s[12:15], s46 offen
    buffer_load_dwordx4 v[68:71], v9, s[12:15], s46 offen
    s_waitcnt lgkmcnt(0)
    s_barrier
    ds_read_b64_tr_b16 a[32:33], v16 offset:0
    ds_read_b64_tr_b16 a[34:35], v16 offset:800
    ds_read_b64_tr_b16 a[36:37], v16 offset:12800
    ds_read_b64_tr_b16 a[38:39], v16 offset:13600
    ds_read_b64_tr_b16 a[112:113], v16 offset:32
    ds_read_b64_tr_b16 a[114:115], v16 offset:832
    ds_read_b64_tr_b16 a[116:117], v16 offset:12832
    ds_read_b64_tr_b16 a[118:119], v16 offset:13632
    ds_read_b64_tr_b16 a[192:193], v16 offset:64
    ds_read_b64_tr_b16 a[194:195], v16 offset:864
    ds_read_b64_tr_b16 a[196:197], v16 offset:12864
    ds_read_b64_tr_b16 a[198:199], v16 offset:13664
    s_waitcnt lgkmcnt(0)
    s_barrier
    s_waitcnt vmcnt(6)
    ds_write_b128 v10, v[24:27]
    ds_write_b128 v11, v[28:31]
    ds_write_b128 v12, v[32:35]
    ds_write_b128 v13, v[36:39]
    ds_write_b128 v14, v[40:43]
    ds_write_b128 v15, v[44:47]
    s_add_u32 s46, s45, 3932160
    buffer_load_dwordx4 v[72:75], v4, s[16:19], s46 offen
    buffer_load_dwordx4 v[76:79], v5, s[16:19], s46 offen
    buffer_load_dwordx4 v[80:83], v6, s[16:19], s46 offen
    buffer_load_dwordx4 v[84:87], v7, s[16:19], s46 offen
    buffer_load_dwordx4 v[88:91], v8, s[16:19], s46 offen
    buffer_load_dwordx4 v[92:95], v9, s[16:19], s46 offen
    s_waitcnt lgkmcnt(0)
    s_barrier
    ds_read_b64_tr_b16 v[128:129], v16 offset:0
    ds_read_b64_tr_b16 v[130:131], v16 offset:800
    ds_read_b64_tr_b16 v[132:133], v16 offset:12800
    ds_read_b64_tr_b16 v[134:135], v16 offset:13600
    ds_read_b64_tr_b16 v[208:209], v16 offset:32
    ds_read_b64_tr_b16 v[210:211], v16 offset:832
    ds_read_b64_tr_b16 v[212:213], v16 offset:12832
    ds_read_b64_tr_b16 v[214:215], v16 offset:13632
    ds_read_b64_tr_b16 v[24:25], v16 offset:64
    ds_read_b64_tr_b16 v[26:27], v16 offset:864
    ds_read_b64_tr_b16 v[28:29], v16 offset:12864
    ds_read_b64_tr_b16 v[30:31], v16 offset:13664
    s_waitcnt lgkmcnt(0)
    ds_write_b128 v17, v[24:27] offset:8192
    ds_write_b128 v17, v[28:31] offset:9216
    s_waitcnt lgkmcnt(0)
    s_barrier
    s_waitcnt vmcnt(6)
    ds_write_b128 v10, v[48:51]
    ds_write_b128 v11, v[52:55]
    ds_write_b128 v12, v[56:59]
    ds_write_b128 v13, v[60:63]
    ds_write_b128 v14, v[64:67]
    ds_write_b128 v15, v[68:71]
    s_add_u32 s46, s45, 4718592
    buffer_load_dwordx4 v[24:27], v4, s[12:15], s46 offen
    buffer_load_dwordx4 v[28:31], v5, s[12:15], s46 offen
    buffer_load_dwordx4 v[32:35], v6, s[12:15], s46 offen
    buffer_load_dwordx4 v[36:39], v7, s[12:15], s46 offen
    buffer_load_dwordx4 v[40:43], v8, s[12:15], s46 offen
    buffer_load_dwordx4 v[44:47], v9, s[12:15], s46 offen
    s_waitcnt lgkmcnt(0)
    s_barrier
    ds_read_b64_tr_b16 a[40:41], v16 offset:0
    ds_read_b64_tr_b16 a[42:43], v16 offset:800
    ds_read_b64_tr_b16 a[44:45], v16 offset:12800
    ds_read_b64_tr_b16 a[46:47], v16 offset:13600
    ds_read_b64_tr_b16 a[120:121], v16 offset:32
    ds_read_b64_tr_b16 a[122:123], v16 offset:832
    ds_read_b64_tr_b16 a[124:125], v16 offset:12832
    ds_read_b64_tr_b16 a[126:127], v16 offset:13632
    ds_read_b64_tr_b16 a[200:201], v16 offset:64
    ds_read_b64_tr_b16 a[202:203], v16 offset:864
    ds_read_b64_tr_b16 a[204:205], v16 offset:12864
    ds_read_b64_tr_b16 a[206:207], v16 offset:13664
    s_waitcnt lgkmcnt(0)
    s_barrier
    s_waitcnt vmcnt(6)
    ds_write_b128 v10, v[72:75]
    ds_write_b128 v11, v[76:79]
    ds_write_b128 v12, v[80:83]
    ds_write_b128 v13, v[84:87]
    ds_write_b128 v14, v[88:91]
    ds_write_b128 v15, v[92:95]
    s_add_u32 s46, s45, 4718592
    buffer_load_dwordx4 v[48:51], v4, s[16:19], s46 offen
    buffer_load_dwordx4 v[52:55], v5, s[16:19], s46 offen
    buffer_load_dwordx4 v[56:59], v6, s[16:19], s46 offen
    buffer_load_dwordx4 v[60:63], v7, s[16:19], s46 offen
    buffer_load_dwordx4 v[64:67], v8, s[16:19], s46 offen
    buffer_load_dwordx4 v[68:71], v9, s[16:19], s46 offen
    s_waitcnt lgkmcnt(0)
    s_barrier
    ds_read_b64_tr_b16 v[136:137], v16 offset:0
    ds_read_b64_tr_b16 v[138:139], v16 offset:800
    ds_read_b64_tr_b16 v[140:141], v16 offset:12800
    ds_read_b64_tr_b16 v[142:143], v16 offset:13600
    ds_read_b64_tr_b16 v[216:217], v16 offset:32
    ds_read_b64_tr_b16 v[218:219], v16 offset:832
    ds_read_b64_tr_b16 v[220:221], v16 offset:12832
    ds_read_b64_tr_b16 v[222:223], v16 offset:13632
    ds_read_b64_tr_b16 v[72:73], v16 offset:64
    ds_read_b64_tr_b16 v[74:75], v16 offset:864
    ds_read_b64_tr_b16 v[76:77], v16 offset:12864
    ds_read_b64_tr_b16 v[78:79], v16 offset:13664
    s_waitcnt lgkmcnt(0)
    ds_write_b128 v17, v[72:75] offset:10240
    ds_write_b128 v17, v[76:79] offset:11264
    s_waitcnt lgkmcnt(0)
    s_barrier
    s_waitcnt vmcnt(6)
    ds_write_b128 v10, v[24:27]
    ds_write_b128 v11, v[28:31]
    ds_write_b128 v12, v[32:35]
    ds_write_b128 v13, v[36:39]
    ds_write_b128 v14, v[40:43]
    ds_write_b128 v15, v[44:47]
    s_add_u32 s46, s45, 5505024
    buffer_load_dwordx4 v[72:75], v4, s[12:15], s46 offen
    buffer_load_dwordx4 v[76:79], v5, s[12:15], s46 offen
    buffer_load_dwordx4 v[80:83], v6, s[12:15], s46 offen
    buffer_load_dwordx4 v[84:87], v7, s[12:15], s46 offen
    buffer_load_dwordx4 v[88:91], v8, s[12:15], s46 offen
    buffer_load_dwordx4 v[92:95], v9, s[12:15], s46 offen
    s_waitcnt lgkmcnt(0)
    s_barrier
    ds_read_b64_tr_b16 a[48:49], v16 offset:0
    ds_read_b64_tr_b16 a[50:51], v16 offset:800
    ds_read_b64_tr_b16 a[52:53], v16 offset:12800
    ds_read_b64_tr_b16 a[54:55], v16 offset:13600
    ds_read_b64_tr_b16 a[128:129], v16 offset:32
    ds_read_b64_tr_b16 a[130:131], v16 offset:832
    ds_read_b64_tr_b16 a[132:133], v16 offset:12832
    ds_read_b64_tr_b16 a[134:135], v16 offset:13632
    ds_read_b64_tr_b16 a[208:209], v16 offset:64
    ds_read_b64_tr_b16 a[210:211], v16 offset:864
    ds_read_b64_tr_b16 a[212:213], v16 offset:12864
    ds_read_b64_tr_b16 a[214:215], v16 offset:13664
    s_waitcnt lgkmcnt(0)
    s_barrier
    s_waitcnt vmcnt(6)
    ds_write_b128 v10, v[48:51]
    ds_write_b128 v11, v[52:55]
    ds_write_b128 v12, v[56:59]
    ds_write_b128 v13, v[60:63]
    ds_write_b128 v14, v[64:67]
    ds_write_b128 v15, v[68:71]
    s_add_u32 s46, s45, 5505024
    buffer_load_dwordx4 v[24:27], v4, s[16:19], s46 offen
    buffer_load_dwordx4 v[28:31], v5, s[16:19], s46 offen
    buffer_load_dwordx4 v[32:35], v6, s[16:19], s46 offen
    buffer_load_dwordx4 v[36:39], v7, s[16:19], s46 offen
    buffer_load_dwordx4 v[40:43], v8, s[16:19], s46 offen
    buffer_load_dwordx4 v[44:47], v9, s[16:19], s46 offen
    s_waitcnt lgkmcnt(0)
    s_barrier
    ds_read_b64_tr_b16 v[144:145], v16 offset:0
    ds_read_b64_tr_b16 v[146:147], v16 offset:800
    ds_read_b64_tr_b16 v[148:149], v16 offset:12800
    ds_read_b64_tr_b16 v[150:151], v16 offset:13600
    ds_read_b64_tr_b16 v[224:225], v16 offset:32
    ds_read_b64_tr_b16 v[226:227], v16 offset:832
    ds_read_b64_tr_b16 v[228:229], v16 offset:12832
    ds_read_b64_tr_b16 v[230:231], v16 offset:13632
    ds_read_b64_tr_b16 v[48:49], v16 offset:64
    ds_read_b64_tr_b16 v[50:51], v16 offset:864
    ds_read_b64_tr_b16 v[52:53], v16 offset:12864
    ds_read_b64_tr_b16 v[54:55], v16 offset:13664
    s_waitcnt lgkmcnt(0)
    ds_write_b128 v17, v[48:51] offset:12288
    ds_write_b128 v17, v[52:55] offset:13312
    s_waitcnt lgkmcnt(0)
    s_barrier
    s_waitcnt vmcnt(6)
    ds_write_b128 v10, v[72:75]
    ds_write_b128 v11, v[76:79]
    ds_write_b128 v12, v[80:83]
    ds_write_b128 v13, v[84:87]
    ds_write_b128 v14, v[88:91]
    ds_write_b128 v15, v[92:95]
    s_add_u32 s46, s45, 6291456
    buffer_load_dwordx4 v[48:51], v4, s[12:15], s46 offen
    buffer_load_dwordx4 v[52:55], v5, s[12:15], s46 offen
    buffer_load_dwordx4 v[56:59], v6, s[12:15], s46 offen
    buffer_load_dwordx4 v[60:63], v7, s[12:15], s46 offen
    buffer_load_dwordx4 v[64:67], v8, s[12:15], s46 offen
    buffer_load_dwordx4 v[68:71], v9, s[12:15], s46 offen
    s_waitcnt lgkmcnt(0)
    s_barrier
    ds_read_b64_tr_b16 a[56:57], v16 offset:0
    ds_read_b64_tr_b16 a[58:59], v16 offset:800
    ds_read_b64_tr_b16 a[60:61], v16 offset:12800
    ds_read_b64_tr_b16 a[62:63], v16 offset:13600
    ds_read_b64_tr_b16 a[136:137], v16 offset:32
    ds_read_b64_tr_b16 a[138:139], v16 offset:832
    ds_read_b64_tr_b16 a[140:141], v16 offset:12832
    ds_read_b64_tr_b16 a[142:143], v16 offset:13632
    ds_read_b64_tr_b16 a[216:217], v16 offset:64
    ds_read_b64_tr_b16 a[218:219], v16 offset:864
    ds_read_b64_tr_b16 a[220:221], v16 offset:12864
    ds_read_b64_tr_b16 a[222:223], v16 offset:13664
    s_waitcnt lgkmcnt(0)
    s_barrier
    s_waitcnt vmcnt(6)
    ds_write_b128 v10, v[24:27]
    ds_write_b128 v11, v[28:31]
    ds_write_b128 v12, v[32:35]
    ds_write_b128 v13, v[36:39]
    ds_write_b128 v14, v[40:43]
    ds_write_b128 v15, v[44:47]
    s_add_u32 s46, s45, 6291456
    buffer_load_dwordx4 v[72:75], v4, s[16:19], s46 offen
    buffer_load_dwordx4 v[76:79], v5, s[16:19], s46 offen
    buffer_load_dwordx4 v[80:83], v6, s[16:19], s46 offen
    buffer_load_dwordx4 v[84:87], v7, s[16:19], s46 offen
    buffer_load_dwordx4 v[88:91], v8, s[16:19], s46 offen
    buffer_load_dwordx4 v[92:95], v9, s[16:19], s46 offen
    s_waitcnt lgkmcnt(0)
    s_barrier
    ds_read_b64_tr_b16 v[152:153], v16 offset:0
    ds_read_b64_tr_b16 v[154:155], v16 offset:800
    ds_read_b64_tr_b16 v[156:157], v16 offset:12800
    ds_read_b64_tr_b16 v[158:159], v16 offset:13600
    ds_read_b64_tr_b16 v[232:233], v16 offset:32
    ds_read_b64_tr_b16 v[234:235], v16 offset:832
    ds_read_b64_tr_b16 v[236:237], v16 offset:12832
    ds_read_b64_tr_b16 v[238:239], v16 offset:13632
    ds_read_b64_tr_b16 v[24:25], v16 offset:64
    ds_read_b64_tr_b16 v[26:27], v16 offset:864
    ds_read_b64_tr_b16 v[28:29], v16 offset:12864
    ds_read_b64_tr_b16 v[30:31], v16 offset:13664
    s_waitcnt lgkmcnt(0)
    ds_write_b128 v17, v[24:27] offset:14336
    ds_write_b128 v17, v[28:31] offset:15360
    s_waitcnt lgkmcnt(0)
    s_barrier
    s_waitcnt vmcnt(6)
    ds_write_b128 v10, v[48:51]
    ds_write_b128 v11, v[52:55]
    ds_write_b128 v12, v[56:59]
    ds_write_b128 v13, v[60:63]
    ds_write_b128 v14, v[64:67]
    ds_write_b128 v15, v[68:71]
    s_add_u32 s46, s45, 7077888
    buffer_load_dwordx4 v[24:27], v4, s[12:15], s46 offen
    buffer_load_dwordx4 v[28:31], v5, s[12:15], s46 offen
    buffer_load_dwordx4 v[32:35], v6, s[12:15], s46 offen
    buffer_load_dwordx4 v[36:39], v7, s[12:15], s46 offen
    buffer_load_dwordx4 v[40:43], v8, s[12:15], s46 offen
    buffer_load_dwordx4 v[44:47], v9, s[12:15], s46 offen
    s_waitcnt lgkmcnt(0)
    s_barrier
    ds_read_b64_tr_b16 a[64:65], v16 offset:0
    ds_read_b64_tr_b16 a[66:67], v16 offset:800
    ds_read_b64_tr_b16 a[68:69], v16 offset:12800
    ds_read_b64_tr_b16 a[70:71], v16 offset:13600
    ds_read_b64_tr_b16 a[144:145], v16 offset:32
    ds_read_b64_tr_b16 a[146:147], v16 offset:832
    ds_read_b64_tr_b16 a[148:149], v16 offset:12832
    ds_read_b64_tr_b16 a[150:151], v16 offset:13632
    ds_read_b64_tr_b16 a[224:225], v16 offset:64
    ds_read_b64_tr_b16 a[226:227], v16 offset:864
    ds_read_b64_tr_b16 a[228:229], v16 offset:12864
    ds_read_b64_tr_b16 a[230:231], v16 offset:13664
    s_waitcnt lgkmcnt(0)
    s_barrier
    s_waitcnt vmcnt(6)
    ds_write_b128 v10, v[72:75]
    ds_write_b128 v11, v[76:79]
    ds_write_b128 v12, v[80:83]
    ds_write_b128 v13, v[84:87]
    ds_write_b128 v14, v[88:91]
    ds_write_b128 v15, v[92:95]
    s_add_u32 s46, s45, 7077888
    buffer_load_dwordx4 v[48:51], v4, s[16:19], s46 offen
    buffer_load_dwordx4 v[52:55], v5, s[16:19], s46 offen
    buffer_load_dwordx4 v[56:59], v6, s[16:19], s46 offen
    buffer_load_dwordx4 v[60:63], v7, s[16:19], s46 offen
    buffer_load_dwordx4 v[64:67], v8, s[16:19], s46 offen
    buffer_load_dwordx4 v[68:71], v9, s[16:19], s46 offen
    s_waitcnt lgkmcnt(0)
    s_barrier
    ds_read_b64_tr_b16 v[160:161], v16 offset:0
    ds_read_b64_tr_b16 v[162:163], v16 offset:800
    ds_read_b64_tr_b16 v[164:165], v16 offset:12800
    ds_read_b64_tr_b16 v[166:167], v16 offset:13600
    ds_read_b64_tr_b16 v[240:241], v16 offset:32
    ds_read_b64_tr_b16 v[242:243], v16 offset:832
    ds_read_b64_tr_b16 v[244:245], v16 offset:12832
    ds_read_b64_tr_b16 v[246:247], v16 offset:13632
    ds_read_b64_tr_b16 v[72:73], v16 offset:64
    ds_read_b64_tr_b16 v[74:75], v16 offset:864
    ds_read_b64_tr_b16 v[76:77], v16 offset:12864
    ds_read_b64_tr_b16 v[78:79], v16 offset:13664
    s_waitcnt lgkmcnt(0)
    ds_write_b128 v17, v[72:75] offset:16384
    ds_write_b128 v17, v[76:79] offset:17408
    s_waitcnt lgkmcnt(0)
    s_barrier
    s_waitcnt vmcnt(6)
    ds_write_b128 v10, v[24:27]
    ds_write_b128 v11, v[28:31]
    ds_write_b128 v12, v[32:35]
    ds_write_b128 v13, v[36:39]
    ds_write_b128 v14, v[40:43]
    ds_write_b128 v15, v[44:47]
    s_waitcnt lgkmcnt(0)
    s_barrier
    ds_read_b64_tr_b16 a[72:73], v16 offset:0
    ds_read_b64_tr_b16 a[74:75], v16 offset:800
    ds_read_b64_tr_b16 a[76:77], v16 offset:12800
    ds_read_b64_tr_b16 a[78:79], v16 offset:13600
    ds_read_b64_tr_b16 a[152:153], v16 offset:32
    ds_read_b64_tr_b16 a[154:155], v16 offset:832
    ds_read_b64_tr_b16 a[156:157], v16 offset:12832
    ds_read_b64_tr_b16 a[158:159], v16 offset:13632
    ds_read_b64_tr_b16 a[232:233], v16 offset:64
    ds_read_b64_tr_b16 a[234:235], v16 offset:864
    ds_read_b64_tr_b16 a[236:237], v16 offset:12864
    ds_read_b64_tr_b16 a[238:239], v16 offset:13664
    s_waitcnt lgkmcnt(0)
    s_barrier
    s_waitcnt vmcnt(0)
    ds_write_b128 v10, v[48:51]
    ds_write_b128 v11, v[52:55]
    ds_write_b128 v12, v[56:59]
    ds_write_b128 v13, v[60:63]
    ds_write_b128 v14, v[64:67]
    ds_write_b128 v15, v[68:71]
    s_waitcnt lgkmcnt(0)
    s_barrier
    ds_read_b64_tr_b16 v[168:169], v16 offset:0
    ds_read_b64_tr_b16 v[170:171], v16 offset:800
    ds_read_b64_tr_b16 v[172:173], v16 offset:12800
    ds_read_b64_tr_b16 v[174:175], v16 offset:13600
    ds_read_b64_tr_b16 v[248:249], v16 offset:32
    ds_read_b64_tr_b16 v[250:251], v16 offset:832
    ds_read_b64_tr_b16 v[252:253], v16 offset:12832
    ds_read_b64_tr_b16 v[254:255], v16 offset:13632
    ds_read_b64_tr_b16 v[48:49], v16 offset:64
    ds_read_b64_tr_b16 v[50:51], v16 offset:864
    ds_read_b64_tr_b16 v[52:53], v16 offset:12864
    ds_read_b64_tr_b16 v[54:55], v16 offset:13664
    s_waitcnt lgkmcnt(0)
    ds_write_b128 v17, v[48:51] offset:18432
    ds_write_b128 v17, v[52:55] offset:19456
    s_waitcnt lgkmcnt(0)
    s_barrier
    v_mov_b32 v6, v17
    v_mov_b32 v30, 0xeeee
    v_mov_b32 v4, 0x4444
    v_cmp_gt_u32 vcc, 8, v2
    s_nop 1
    v_cndmask_b32 v4, v30, v4, vcc
    v_lshlrev_b32 v5, 4, v1
    s_lshl_b32 s24, s3, 10
    v_add_u32 v7, s24, v5
    s_lshl_b32 s24, s3, 9
    s_add_u32 s24, s24, 8192
    v_lshlrev_b32 v8, 3, v1
    v_add_u32 v8, s24, v8
    s_mul_i32 s24, s3, 1536
    s_add_u32 s24, s24, 10240
    v_lshlrev_b32 v9, 5, v2
    v_lshl_add_u32 v9, v3, 3, v9
    v_add_u32 v9, s24, v9
    v_lshrrev_b32 v30, 2, v2
    v_and_b32 v31, 3, v2
    v_lshl_add_u32 v10, v3, 3, v30
    v_lshlrev_b32 v10, 5, v10
    v_lshl_add_u32 v10, v31, 3, v10
    v_add_u32 v10, s24, v10
    v_lshl_add_u32 v11, v3, 2, v30
    v_lshlrev_b32 v11, 5, v11
    v_lshl_add_u32 v11, v31, 3, v11
    v_add_u32 v11, s24, v11
    v_add_u32 v33, 22528, v5
    s_mul_i32 s24, s3, 1408
    s_add_u32 s24, s24, 16384
    v_mul_u32_u24 v30, 176, v2
    v_add_u32 v30, s24, v30
    v_lshl_add_u32 v12, v3, 5, v30
    v_cmp_gt_u32 vcc, 8, v2
    s_nop 1
    v_cndmask_b32 v12, v33, v12, vcc
    v_lshl_add_u32 v13, v3, 4, v30
    v_add_u32 v13, 96, v13
    v_cmp_le_u32 s[24:25], 2, v3
    s_and_b64 vcc, vcc, s[24:25]
    v_cndmask_b32 v13, v33, v13, vcc
    s_mul_i32 s24, s3, 5632
    s_add_u32 s24, s24, 106496
    v_mul_u32_u24 v30, 176, v2
    v_add_u32 v30, s24, v30
    v_lshl_add_u32 v16, v3, 5, v30
    v_lshl_add_u32 v17, v3, 4, v30
    v_add_u32 v17, 96, v17
    v_add_u32 v18, 2816, v17
    v_cmp_le_u32 vcc, 2, v3
    s_nop 1
    v_cndmask_b32 v17, v33, v17, vcc
    v_cndmask_b32 v18, v33, v18, vcc
    v_lshrrev_b32 v30, 3, v1
    v_and_b32 v31, 7, v1
    v_min_u32 v32, 4, v31
    v_mul_u32_u24 v14, 176, v30
    v_lshl_add_u32 v14, v32, 5, v14
    s_mul_i32 s24, s3, 1408
    s_add_u32 s24, s24, 106496
    v_add_u32 v21, s24, v14
    v_add_u32 v14, 16384, v14
    v_cmp_gt_u32 s[50:51], 5, v31
    s_lshl_b32 s24, s3, 3
    v_add_u32 v32, s24, v30
    v_lshlrev_b32 v33, 2, v31
    v_sub_u32 v32, v32, v33
    v_mov_b32 v33, 100
    v_cmp_gt_u32 vcc, 4, v31
    s_nop 1
    v_cndmask_b32 v32, v33, v32, vcc
    v_cmp_le_i32 s[64:65], 0, v32
    v_cmp_le_i32 s[66:67], 1, v32
    v_cmp_le_i32 s[68:69], 2, v32
    v_cmp_le_i32 s[70:71], 3, v32
    v_cmp_le_i32 s[72:73], 16, v32
    v_cmp_le_i32 s[74:75], 17, v32
    v_cmp_le_i32 s[76:77], 18, v32
    v_cmp_le_i32 s[78:79], 19, v32
    s_lshr_b32 s24, s44, 1
    s_lshl_b32 s24, s24, 10
    s_and_b32 s25, s44, 1
    s_lshl_b32 s25, s25, 7
    s_add_u32 s24, s24, s25
    v_lshlrev_b32 v15, 8, v31
    v_lshl_add_u32 v15, v30, 4, v15
    v_add_u32 v15, s24, v15
    s_lshr_b32 s24, s44, 3
    s_lshl_b32 s24, s24, 10
    s_and_b32 s25, s44, 3
    s_lshl_b32 s25, s25, 8
    s_add_u32 s24, s24, s25
    s_lshr_b32 s25, s44, 2
    s_and_b32 s25, s25, 1
    s_lshl_b32 s25, s25, 7
    s_add_u32 s24, s24, s25
    s_add_u32 s24, s24, 16384
    v_lshlrev_b32 v32, 4, v30
    v_add_u32 v32, s24, v32
    v_cmp_eq_u32 vcc, 4, v31
    s_nop 1
    v_cndmask_b32 v15, v15, v32, vcc
    v_mov_b32 v32, 2146435072
    v_cndmask_b32 v15, v32, v15, s[50:51]
    s_mul_i32 s24, s3, 20480
    v_add_u32 v15, s24, v15
    s_cmp_lt_u32 s3, 1
    s_cselect_b32 s24, 0, 2146435072
    v_or_b32 v15, s24, v15
    s_and_b32 s24, s3, 1
    s_lshl_b32 s24, s24, 7
    s_lshr_b32 s25, s3, 1
    s_lshl_b32 s25, s25, 10
    s_add_u32 s24, s24, s25
    s_lshl_b32 s25, s44, 11
    s_add_u32 s25, s25, s24
    v_lshlrev_b32 v22, 8, v31
    v_lshl_add_u32 v22, v30, 4, v22
    v_add_u32 v22, s25, v22
    s_lshr_b32 s25, s44, 2
    s_lshl_b32 s25, s25, 11
    s_add_u32 s25, s25, s24
    s_and_b32 s26, s44, 3
    s_lshl_b32 s26, s26, 8
    s_add_u32 s25, s25, s26
    s_add_u32 s25, s25, 65536
    v_lshlrev_b32 v32, 4, v30
    v_add_u32 v32, s25, v32
    v_cmp_eq_u32 vcc, 4, v31
    s_nop 1
    v_cndmask_b32 v22, v22, v32, vcc
    v_mov_b32 v32, 2146435072
    v_cndmask_b32 v22, v32, v22, s[50:51]
    s_mul_i32 s24, s44, 384
    s_mul_i32 s25, s3, 96
    s_add_u32 s24, s24, s25
    v_mul_u32_u24 v30, 12288, v2
    v_add_u32 v30, s24, v30
    v_lshl_add_u32 v19, v3, 4, v30
    v_lshl_add_u32 v20, v3, 3, v30
    v_add_u32 v20, 64, v20
    v_add_u32 v48, 0, v0
    v_and_b32 v49, 7, v48
    v_mul_u32_u24 v49, 1280, v49
    v_lshrrev_b32 v50, 3, v48
    v_lshl_add_u32 v49, v50, 4, v49
    v_cmp_gt_u32 vcc, 640, v48
    v_mov_b32 v51, 2146435072
    s_nop 0
    v_cndmask_b32 v49, v51, v49, vcc
    buffer_load_dwordx4 v[52:55], v49, s[20:23], 0 offen
    v_lshlrev_b32 v48, 4, v48
    s_waitcnt vmcnt(0)
    s_and_saveexec_b64 s[30:31], vcc
    ds_write_b128 v48, v[52:55]
    s_mov_b64 exec, s[30:31]
    v_add_u32 v48, 256, v0
    v_and_b32 v49, 7, v48
    v_mul_u32_u24 v49, 1280, v49
    v_lshrrev_b32 v50, 3, v48
    v_lshl_add_u32 v49, v50, 4, v49
    v_cmp_gt_u32 vcc, 640, v48
    v_mov_b32 v51, 2146435072
    s_nop 0
    v_cndmask_b32 v49, v51, v49, vcc
    buffer_load_dwordx4 v[52:55], v49, s[20:23], 0 offen
    v_lshlrev_b32 v48, 4, v48
    s_waitcnt vmcnt(0)
    s_and_saveexec_b64 s[30:31], vcc
    ds_write_b128 v48, v[52:55]
    s_mov_b64 exec, s[30:31]
    v_add_u32 v48, 512, v0
    v_and_b32 v49, 7, v48
    v_mul_u32_u24 v49, 1280, v49
    v_lshrrev_b32 v50, 3, v48
    v_lshl_add_u32 v49, v50, 4, v49
    v_cmp_gt_u32 vcc, 640, v48
    v_mov_b32 v51, 2146435072
    s_nop 0
    v_cndmask_b32 v49, v51, v49, vcc
    buffer_load_dwordx4 v[52:55], v49, s[20:23], 0 offen
    v_lshlrev_b32 v48, 4, v48
    s_waitcnt vmcnt(0)
    s_and_saveexec_b64 s[30:31], vcc
    ds_write_b128 v48, v[52:55]
    s_mov_b64 exec, s[30:31]
    s_mov_b32 s40, 0
    s_mov_b32 s41, 92274688
    s_mov_b32 s42, 146317312
    s_mov_b32 s43, 141074432
    s_mov_b32 s45, 67108864
    s_mov_b32 s47, 138412032
    s_add_u32 s24, s41, 196608
    buffer_load_dwordx4 a[240:243], v19, s[8:11], s41 offen
    buffer_load_dwordx2 a[244:245], v20, s[8:11], s41 offen
    buffer_load_dwordx4 a[246:249], v19, s[8:11], s24 offen
    buffer_load_dwordx2 a[250:251], v20, s[8:11], s24 offen
    s_waitcnt lgkmcnt(0)
    s_branch chain1_kernel_s_go
chain1_kernel_s_step:
    v_mov_b32 v24, 0
    v_mov_b32 v25, 0
    v_mov_b32 v26, 0
    v_mov_b32 v27, 0
    v_mov_b32 v28, 0
    v_mov_b32 v29, 0
    v_mov_b32 v30, 0
    v_mov_b32 v31, 0
    v_mov_b32 v32, 0
    v_mov_b32 v33, 0
    v_mov_b32 v34, 0
    v_mov_b32 v35, 0
    v_mov_b32 v36, 0
    v_mov_b32 v37, 0
    v_mov_b32 v38, 0
    v_mov_b32 v39, 0
    v_mov_b32 v40, 0
    v_mov_b32 v41, 0
    v_mov_b32 v42, 0
    v_mov_b32 v43, 0
    v_mov_b32 v44, 0
    v_mov_b32 v45, 0
    v_mov_b32 v46, 0
    v_mov_b32 v47, 0
    s_add_u32 s48, s47, 4096
    s_mov_b32 s61, 0
chain1_kernel_s_pm:
    buffer_load_dwordx4 v[48:51], v7, s[8:11], s47 offen sc1
    buffer_load_dwordx4 v[52:55], v7, s[8:11], s48 offen sc1
    buffer_load_dwordx2 v[56:57], v8, s[8:11], s47 offen sc1
    s_waitcnt vmcnt(0)
    v_max3_u32 v58, v48, v49, v50
    v_max3_u32 v58, v58, v51, v52
    v_max3_u32 v58, v58, v53, v54
    v_max3_u32 v58, v58, v55, v56
    v_max_u32 v58, v58, v57
    v_cmp_eq_u32 vcc, -1, v58
    s_add_u32 s61, s61, 1
    s_cbranch_vccz chain1_kernel_s_pm_out
    s_cmp_ge_u32 s61, s60
    s_cbranch_scc1 chain1_kernel_s_pm_to
    s_sleep 1
    s_branch chain1_kernel_s_pm
chain1_kernel_s_pm_to:
    s_mov_b32 s60, 1
chain1_kernel_s_pm_out:
    ds_write_b128 v7, v[48:51]
    ds_write_b128 v7, v[52:55] offset:4096
    ds_write_b64 v8, v[56:57]
    s_waitcnt lgkmcnt(0)
chain1_kernel_s_go2:
    s_barrier
    ds_read_b128 v[48:51], v5 offset:0
    ds_read_b128 v[68:71], v6 offset:0
    ds_read_b128 v[72:75], v6 offset:1024
    ds_read_b128 v[52:55], v5 offset:1024
    ds_read_b128 v[76:79], v6 offset:2048
    ds_read_b128 v[80:83], v6 offset:3072
    ds_read_b128 v[56:59], v5 offset:2048
    ds_read_b128 v[60:63], v5 offset:3072
    ds_read_b128 v[64:67], v5 offset:4096
    s_waitcnt lgkmcnt(8)
    v_smfmac_f32_16x16x64_bf16 v[24:27], v[48:51], a[0:7], v4
    v_smfmac_f32_16x16x64_bf16 v[28:31], v[48:51], a[80:87], v4
    ds_read_b128 v[84:87], v6 offset:4096
    ds_read_b128 v[88:91], v6 offset:5120
    v_smfmac_f32_16x16x64_bf16 v[32:35], v[48:51], a[160:167], v4
    v_smfmac_f32_16x16x64_bf16 v[36:39], v[48:51], v[96:103], v4
    v_smfmac_f32_16x16x64_bf16 v[40:43], v[48:51], v[176:183], v4
    s_waitcnt lgkmcnt(8)
    v_smfmac_f32_16x16x64_bf16 v[44:47], v[48:51], v[68:75], v4
    ds_read_b128 v[48:51], v5 offset:5120
    s_waitcnt lgkmcnt(8)
    v_smfmac_f32_16x16x64_bf16 v[24:27], v[52:55], a[8:15], v4
    v_smfmac_f32_16x16x64_bf16 v[28:31], v[52:55], a[88:95], v4
    ds_read_b128 v[68:71], v6 offset:6144
    ds_read_b128 v[72:75], v6 offset:7168
    v_smfmac_f32_16x16x64_bf16 v[32:35], v[52:55], a[168:175], v4
    v_smfmac_f32_16x16x64_bf16 v[36:39], v[52:55], v[104:111], v4
    v_smfmac_f32_16x16x64_bf16 v[40:43], v[52:55], v[184:191], v4
    s_waitcnt lgkmcnt(8)
    v_smfmac_f32_16x16x64_bf16 v[44:47], v[52:55], v[76:83], v4
    ds_read_b128 v[52:55], v5 offset:6144
    s_waitcnt lgkmcnt(8)
    v_smfmac_f32_16x16x64_bf16 v[24:27], v[56:59], a[16:23], v4
    v_smfmac_f32_16x16x64_bf16 v[28:31], v[56:59], a[96:103], v4
    ds_read_b128 v[76:79], v6 offset:8192
    ds_read_b128 v[80:83], v6 offset:9216
    v_smfmac_f32_16x16x64_bf16 v[32:35], v[56:59], a[176:183], v4
    v_smfmac_f32_16x16x64_bf16 v[36:39], v[56:59], v[112:119], v4
    v_smfmac_f32_16x16x64_bf16 v[40:43], v[56:59], v[192:199], v4
    s_waitcnt lgkmcnt(6)
    v_smfmac_f32_16x16x64_bf16 v[44:47], v[56:59], v[84:91], v4
    ds_read_b128 v[56:59], v5 offset:7168
    v_smfmac_f32_16x16x64_bf16 v[24:27], v[60:63], a[24:31], v4
    v_smfmac_f32_16x16x64_bf16 v[28:31], v[60:63], a[104:111], v4
    ds_read_b128 v[84:87], v6 offset:10240
    ds_read_b128 v[88:91], v6 offset:11264
    v_smfmac_f32_16x16x64_bf16 v[32:35], v[60:63], a[184:191], v4
    v_smfmac_f32_16x16x64_bf16 v[36:39], v[60:63], v[120:127], v4
    v_smfmac_f32_16x16x64_bf16 v[40:43], v[60:63], v[200:207], v4
    s_waitcnt lgkmcnt(6)
    v_smfmac_f32_16x16x64_bf16 v[44:47], v[60:63], v[68:75], v4
    ds_read_b128 v[60:63], v5 offset:8192
    v_smfmac_f32_16x16x64_bf16 v[24:27], v[64:67], a[32:39], v4
    v_smfmac_f32_16x16x64_bf16 v[28:31], v[64:67], a[112:119], v4
    ds_read_b128 v[68:71], v6 offset:12288
    ds_read_b128 v[72:75], v6 offset:13312
    v_smfmac_f32_16x16x64_bf16 v[32:35], v[64:67], a[192:199], v4
    v_smfmac_f32_16x16x64_bf16 v[36:39], v[64:67], v[128:135], v4
    v_smfmac_f32_16x16x64_bf16 v[40:43], v[64:67], v[208:215], v4
    s_waitcnt lgkmcnt(6)
    v_smfmac_f32_16x16x64_bf16 v[44:47], v[64:67], v[76:83], v4
    ds_read_b128 v[64:67], v5 offset:9216
    v_smfmac_f32_16x16x64_bf16 v[24:27], v[48:51], a[40:47], v4
    v_smfmac_f32_16x16x64_bf16 v[28:31], v[48:51], a[120:127], v4
    ds_read_b128 v[76:79], v6 offset:14336
    ds_read_b128 v[80:83], v6 offset:15360
    v_smfmac_f32_16x16x64_bf16 v[32:35], v[48:51], a[200:207], v4
    v_smfmac_f32_16x16x64_bf16 v[36:39], v[48:51], v[136:143], v4
    v_smfmac_f32_16x16x64_bf16 v[40:43], v[48:51], v[216:223], v4
    s_waitcnt lgkmcnt(6)
    v_smfmac_f32_16x16x64_bf16 v[44:47], v[48:51], v[84:91], v4
    v_smfmac_f32_16x16x64_bf16 v[24:27], v[52:55], a[48:55], v4
    v_smfmac_f32_16x16x64_bf16 v[28:31], v[52:55], a[128:135], v4
    ds_read_b128 v[84:87], v6 offset:16384
    ds_read_b128 v[88:91], v6 offset:17408
    v_smfmac_f32_16x16x64_bf16 v[32:35], v[52:55], a[208:215], v4
    v_smfmac_f32_16x16x64_bf16 v[36:39], v[52:55], v[144:151], v4
    v_smfmac_f32_16x16x64_bf16 v[40:43], v[52:55], v[224:231], v4
    s_waitcnt lgkmcnt(5)
    v_smfmac_f32_16x16x64_bf16 v[44:47], v[52:55], v[68:75], v4
    v_smfmac_f32_16x16x64_bf16 v[24:27], v[56:59], a[56:63], v4
    v_smfmac_f32_16x16x64_bf16 v[28:31], v[56:59], a[136:143], v4
    ds_read_b128 v[68:71], v6 offset:18432
    ds_read_b128 v[72:75], v6 offset:19456
    v_smfmac_f32_16x16x64_bf16 v[32:35], v[56:59], a[216:223], v4
    v_smfmac_f32_16x16x64_bf16 v[36:39], v[56:59], v[152:159], v4
    v_smfmac_f32_16x16x64_bf16 v[40:43], v[56:59], v[232:239], v4
    s_waitcnt lgkmcnt(4)
    v_smfmac_f32_16x16x64_bf16 v[44:47], v[56:59], v[76:83], v4
    v_smfmac_f32_16x16x64_bf16 v[24:27], v[60:63], a[64:71], v4
    v_smfmac_f32_16x16x64_bf16 v[28:31], v[60:63], a[144:151], v4
    v_smfmac_f32_16x16x64_bf16 v[32:35], v[60:63], a[224:231], v4
    v_smfmac_f32_16x16x64_bf16 v[36:39], v[60:63], v[160:167], v4
    v_smfmac_f32_16x16x64_bf16 v[40:43], v[60:63], v[240:247], v4
    s_waitcnt lgkmcnt(2)
    v_smfmac_f32_16x16x64_bf16 v[44:47], v[60:63], v[84:91], v4
    v_smfmac_f32_16x16x64_bf16 v[24:27], v[64:67], a[72:79], v4
    v_smfmac_f32_16x16x64_bf16 v[28:31], v[64:67], a[152:159], v4
    v_smfmac_f32_16x16x64_bf16 v[32:35], v[64:67], a[232:239], v4
    v_smfmac_f32_16x16x64_bf16 v[36:39], v[64:67], v[168:175], v4
    v_smfmac_f32_16x16x64_bf16 v[40:43], v[64:67], v[248:255], v4
    s_waitcnt lgkmcnt(0)
    v_smfmac_f32_16x16x64_bf16 v[44:47], v[64:67], v[68:75], v4
    s_add_u32 s24, s45, 196608
    buffer_load_dwordx4 v[80:83], v19, s[8:11], s45 offen
    buffer_load_dwordx2 v[84:85], v20, s[8:11], s45 offen
    buffer_load_dwordx4 v[86:89], v19, s[8:11], s24 offen
    buffer_load_dwordx2 v[90:91], v20, s[8:11], s24 offen
    s_nop 3
    v_permlane32_swap_b32 v24, v36
    v_permlane32_swap_b32 v25, v37
    v_permlane32_swap_b32 v26, v38
    v_permlane32_swap_b32 v27, v39
    v_add_f32 v24, v24, v36
    v_add_f32 v25, v25, v37
    v_add_f32 v26, v26, v38
    v_add_f32 v27, v27, v39
    v_cvt_pk_bf16_f32 v48, v24, v25
    v_cvt_pk_bf16_f32 v49, v26, v27
    ds_write_b64 v9, v[48:49] offset:0
    v_permlane32_swap_b32 v28, v40
    v_permlane32_swap_b32 v29, v41
    v_permlane32_swap_b32 v30, v42
    v_permlane32_swap_b32 v31, v43
    v_add_f32 v28, v28, v40
    v_add_f32 v29, v29, v41
    v_add_f32 v30, v30, v42
    v_add_f32 v31, v31, v43
    v_cvt_pk_bf16_f32 v50, v28, v29
    v_cvt_pk_bf16_f32 v51, v30, v31
    ds_write_b64 v9, v[50:51] offset:512
    v_permlane32_swap_b32 v32, v44
    v_permlane32_swap_b32 v33, v45
    v_permlane32_swap_b32 v34, v46
    v_permlane32_swap_b32 v35, v47
    v_add_f32 v32, v32, v44
    v_add_f32 v33, v33, v45
    v_add_f32 v34, v34, v46
    v_add_f32 v35, v35, v47
    v_cvt_pk_bf16_f32 v52, v32, v33
    v_cvt_pk_bf16_f32 v53, v34, v35
    ds_write_b64 v9, v[52:53] offset:1024
    s_waitcnt lgkmcnt(0)
    ds_read_b64_tr_b16 v[24:25], v10
    ds_read_b64_tr_b16 v[26:27], v10 offset:128
    ds_read_b64_tr_b16 v[28:29], v11 offset:1024
    s_waitcnt lgkmcnt(0)
    v_mfma_f32_16x16x32_bf16 v[64:67], a[240:243], v[24:27], 0
    v_mfma_f32_16x16x32_bf16 v[68:71], a[246:249], v[24:27], 0
    v_mfma_f32_16x16x32_bf16 v[72:75], v[24:27], v[24:27], 0
    s_nop 3
    v_mfma_f32_16x16x16_bf16 v[64:67], a[244:245], v[28:29], v[64:67]
    v_mfma_f32_16x16x16_bf16 v[68:71], a[250:251], v[28:29], v[68:71]
    v_mfma_f32_16x16x16_bf16 v[72:75], v[28:29], v[28:29], v[72:75]
    s_nop 5
    ds_write_b128 v12, v[64:67]
    ds_write_b128 v12, v[68:71] offset:16
    ds_write_b128 v13, v[72:75]
    s_waitcnt lgkmcnt(0)
    s_barrier
    ds_read_b128 v[48:51], v14 offset:0
    ds_read_b128 v[52:55], v14 offset:16
    ds_read_b128 v[56:59], v14 offset:1408
    ds_read_b128 v[60:63], v14 offset:1424
    ds_read_b128 v[64:67], v14 offset:2816
    ds_read_b128 v[68:71], v14 offset:2832
    ds_read_b128 v[72:75], v14 offset:4224
    ds_read_b128 v[76:79], v14 offset:4240
    s_waitcnt lgkmcnt(4)
    v_pk_add_f32 v[48:49], v[48:49], v[56:57]
    v_pk_add_f32 v[50:51], v[50:51], v[58:59]
    v_pk_add_f32 v[52:53], v[52:53], v[60:61]
    v_pk_add_f32 v[54:55], v[54:55], v[62:63]
    s_waitcnt lgkmcnt(0)
    v_pk_add_f32 v[64:65], v[64:65], v[72:73]
    v_pk_add_f32 v[66:67], v[66:67], v[74:75]
    v_pk_add_f32 v[68:69], v[68:69], v[76:77]
    v_pk_add_f32 v[70:71], v[70:71], v[78:79]
    v_pk_add_f32 v[48:49], v[48:49], v[64:65]
    v_pk_add_f32 v[50:51], v[50:51], v[66:67]
    v_pk_add_f32 v[52:53], v[52:53], v[68:69]
    v_pk_add_f32 v[54:55], v[54:55], v[70:71]
    v_max3_f32 v92, v48, v49, v50
    v_max3_f32 v92, v92, v51, v52
    v_max3_f32 v92, v92, v53, v54
    v_max_f32 v92, v92, v55
    v_mov_b32 v93, 0xff800000
    v_cndmask_b32 v92, v93, v92, s[50:51]
    s_nop 1
    v_max_f32 v92, v92, v92 quad_perm:[1,0,3,2] row_mask:0xf bank_mask:0xf
    s_nop 1
    v_max_f32 v92, v92, v92 quad_perm:[2,3,0,1] row_mask:0xf bank_mask:0xf
    s_nop 1
    v_max_f32 v92, v92, v92 row_half_mirror row_mask:0xf bank_mask:0xf
    s_mov_b32 s24, 0x3dd53b95
    v_mul_f32 v92, s24, v92
    v_fma_f32 v48, v48, s24, -v92
    v_fma_f32 v49, v49, s24, -v92
    v_fma_f32 v50, v50, s24, -v92
    v_fma_f32 v51, v51, s24, -v92
    v_fma_f32 v52, v52, s24, -v92
    v_fma_f32 v53, v53, s24, -v92
    v_fma_f32 v54, v54, s24, -v92
    v_fma_f32 v55, v55, s24, -v92
    v_exp_f32 v48, v48
    v_exp_f32 v49, v49
    v_exp_f32 v50, v50
    v_exp_f32 v51, v51
    v_exp_f32 v52, v52
    v_exp_f32 v53, v53
    v_exp_f32 v54, v54
    v_exp_f32 v55, v55
    v_add_f32 v92, v48, v49
    v_add_f32 v93, v50, v51
    v_add_f32 v92, v92, v52
    v_add_f32 v93, v93, v53
    v_add_f32 v92, v92, v54
    v_add_f32 v93, v93, v55
    v_add_f32 v92, v92, v93
    v_cndmask_b32 v92, 0, v92, s[50:51]
    s_nop 1
    v_add_f32 v92, v92, v92 quad_perm:[1,0,3,2] row_mask:0xf bank_mask:0xf
    s_nop 1
    v_add_f32 v92, v92, v92 quad_perm:[2,3,0,1] row_mask:0xf bank_mask:0xf
    s_nop 1
    v_add_f32 v92, v92, v92 row_half_mirror row_mask:0xf bank_mask:0xf
    v_rcp_f32 v92, v92
    s_nop 0
    v_mul_f32 v48, v48, v92
    v_mul_f32 v49, v49, v92
    v_mul_f32 v50, v50, v92
    v_mul_f32 v51, v51, v92
    v_mul_f32 v52, v52, v92
    v_mul_f32 v53, v53, v92
    v_mul_f32 v54, v54, v92
    v_mul_f32 v55, v55, v92
    v_cvt_pk_bf16_f32 v56, v48, v49
    v_cvt_pk_bf16_f32 v57, v50, v51
    v_cvt_pk_bf16_f32 v58, v52, v53
    v_cvt_pk_bf16_f32 v59, v54, v55
    v_min_u32 v56, -2, v56
    v_min_u32 v57, -2, v57
    v_min_u32 v58, -2, v58
    v_min_u32 v59, -2, v59
    buffer_store_dwordx4 v[56:59], v15, s[8:11], s43 offen sc1
    s_waitcnt vmcnt(1)
    v_mfma_f32_16x16x32_bf16 v[32:35], a[240:243], v[80:83], 0
    v_mfma_f32_16x16x32_bf16 v[40:43], a[246:249], v[80:83], 0
    v_mfma_f32_16x16x32_bf16 v[64:67], v[24:27], v[80:83], 0
    v_mfma_f32_16x16x32_bf16 v[36:39], a[240:243], v[86:89], 0
    v_mfma_f32_16x16x32_bf16 v[44:47], a[246:249], v[86:89], 0
    v_mfma_f32_16x16x32_bf16 v[68:71], v[24:27], v[86:89], 0
    s_nop 0
    v_mfma_f32_16x16x16_bf16 v[32:35], a[244:245], v[84:85], v[32:35]
    v_mfma_f32_16x16x16_bf16 v[40:43], a[250:251], v[84:85], v[40:43]
    v_mfma_f32_16x16x16_bf16 v[64:67], v[28:29], v[84:85], v[64:67]
    v_mfma_f32_16x16x16_bf16 v[36:39], a[244:245], v[90:91], v[36:39]
    v_mfma_f32_16x16x16_bf16 v[44:47], a[250:251], v[90:91], v[44:47]
    v_mfma_f32_16x16x16_bf16 v[68:71], v[28:29], v[90:91], v[68:71]
    s_nop 2
    ds_write_b128 v16, v[32:35] offset:0
    ds_write_b128 v16, v[40:43] offset:16
    ds_write_b128 v17, v[64:67]
    ds_write_b128 v16, v[36:39] offset:2816
    ds_write_b128 v16, v[44:47] offset:2832
    ds_write_b128 v18, v[68:71]
    s_add_u32 s40, s40, 1
    s_add_u32 s41, s41, 393216
    s_add_u32 s45, s45, 393216
    s_add_u32 s43, s43, 81920
    s_add_u32 s47, s47, 40960
    s_waitcnt lgkmcnt(0)
    s_barrier
    s_add_u32 s24, s41, 196608
    buffer_load_dwordx4 a[240:243], v19, s[8:11], s41 offen
    buffer_load_dwordx2 a[244:245], v20, s[8:11], s41 offen
    buffer_load_dwordx4 a[246:249], v19, s[8:11], s24 offen
    buffer_load_dwordx2 a[250:251], v20, s[8:11], s24 offen
    ds_read_b128 v[48:51], v21 offset:0
    ds_read_b128 v[52:55], v21 offset:16
    ds_read_b128 v[56:59], v21 offset:5632
    ds_read_b128 v[60:63], v21 offset:5648
    ds_read_b128 v[64:67], v21 offset:11264
    ds_read_b128 v[68:71], v21 offset:11280
    ds_read_b128 v[72:75], v21 offset:16896
    ds_read_b128 v[76:79], v21 offset:16912
    s_waitcnt lgkmcnt(4)
    v_pk_add_f32 v[48:49], v[48:49], v[56:57]
    v_pk_add_f32 v[50:51], v[50:51], v[58:59]
    v_pk_add_f32 v[52:53], v[52:53], v[60:61]
    v_pk_add_f32 v[54:55], v[54:55], v[62:63]
    s_waitcnt lgkmcnt(0)
    v_pk_add_f32 v[64:65], v[64:65], v[72:73]
    v_pk_add_f32 v[66:67], v[66:67], v[74:75]
    v_pk_add_f32 v[68:69], v[68:69], v[76:77]
    v_pk_add_f32 v[70:71], v[70:71], v[78:79]
    v_pk_add_f32 v[48:49], v[48:49], v[64:65]
    v_pk_add_f32 v[50:51], v[50:51], v[66:67]
    v_pk_add_f32 v[52:53], v[52:53], v[68:69]
    v_pk_add_f32 v[54:55], v[54:55], v[70:71]
    v_mov_b32 v93, 0xff800000
    v_cndmask_b32 v48, v93, v48, s[64:65]
    v_cndmask_b32 v49, v93, v49, s[66:67]
    v_cndmask_b32 v50, v93, v50, s[68:69]
    v_cndmask_b32 v51, v93, v51, s[70:71]
    v_cndmask_b32 v52, v93, v52, s[72:73]
    v_cndmask_b32 v53, v93, v53, s[74:75]
    v_cndmask_b32 v54, v93, v54, s[76:77]
    v_cndmask_b32 v55, v93, v55, s[78:79]
    v_max3_f32 v92, v48, v49, v50
    v_max3_f32 v92, v92, v51, v52
    v_max3_f32 v92, v92, v53, v54
    v_max_f32 v92, v92, v55
    v_mov_b32 v93, 0xff800000
    v_cndmask_b32 v92, v93, v92, s[50:51]
    s_nop 1
    v_max_f32 v92, v92, v92 quad_perm:[1,0,3,2] row_mask:0xf bank_mask:0xf
    s_nop 1
    v_max_f32 v92, v92, v92 quad_perm:[2,3,0,1] row_mask:0xf bank_mask:0xf
    s_nop 1
    v_max_f32 v92, v92, v92 row_half_mirror row_mask:0xf bank_mask:0xf
    s_mov_b32 s24, 0x3dd53b95
    v_mul_f32 v92, s24, v92
    v_fma_f32 v48, v48, s24, -v92
    v_fma_f32 v49, v49, s24, -v92
    v_fma_f32 v50, v50, s24, -v92
    v_fma_f32 v51, v51, s24, -v92
    v_fma_f32 v52, v52, s24, -v92
    v_fma_f32 v53, v53, s24, -v92
    v_fma_f32 v54, v54, s24, -v92
    v_fma_f32 v55, v55, s24, -v92
    v_exp_f32 v48, v48
    v_exp_f32 v49, v49
    v_exp_f32 v50, v50
    v_exp_f32 v51, v51
    v_exp_f32 v52, v52
    v_exp_f32 v53, v53
    v_exp_f32 v54, v54
    v_exp_f32 v55, v55
    v_add_f32 v92, v48, v49
    v_add_f32 v93, v50, v51
    v_add_f32 v92, v92, v52
    v_add_f32 v93, v93, v53
    v_add_f32 v92, v92, v54
    v_add_f32 v93, v93, v55
    v_add_f32 v92, v92, v93
    v_cndmask_b32 v92, 0, v92, s[50:51]
    s_nop 1
    v_add_f32 v92, v92, v92 quad_perm:[1,0,3,2] row_mask:0xf bank_mask:0xf
    s_nop 1
    v_add_f32 v92, v92, v92 quad_perm:[2,3,0,1] row_mask:0xf bank_mask:0xf
    s_nop 1
    v_add_f32 v92, v92, v92 row_half_mirror row_mask:0xf bank_mask:0xf
    v_rcp_f32 v92, v92
    s_nop 0
    v_mul_f32 v48, v48, v92
    v_mul_f32 v49, v49, v92
    v_mul_f32 v50, v50, v92
    v_mul_f32 v51, v51, v92
    v_mul_f32 v52, v52, v92
    v_mul_f32 v53, v53, v92
    v_mul_f32 v54, v54, v92
    v_mul_f32 v55, v55, v92
    v_cvt_pk_bf16_f32 v56, v48, v49
    v_cvt_pk_bf16_f32 v57, v50, v51
    v_cvt_pk_bf16_f32 v58, v52, v53
    v_cvt_pk_bf16_f32 v59, v54, v55
    v_min_u32 v56, -2, v56
    v_min_u32 v57, -2, v57
    v_min_u32 v58, -2, v58
    v_min_u32 v59, -2, v59
    buffer_store_dwordx4 v[56:59], v22, s[8:11], s42 offen sc1
    s_add_u32 s42, s42, 81920
    s_cmp_lt_u32 s40, 64
    s_cbranch_scc1 chain1_kernel_s_step
    s_branch chain1_kernel_end
chain1_kernel_s_go:
    v_mov_b32 v24, 0
    v_mov_b32 v25, 0
    v_mov_b32 v26, 0
    v_mov_b32 v27, 0
    v_mov_b32 v28, 0
    v_mov_b32 v29, 0
    v_mov_b32 v30, 0
    v_mov_b32 v31, 0
    v_mov_b32 v32, 0
    v_mov_b32 v33, 0
    v_mov_b32 v34, 0
    v_mov_b32 v35, 0
    v_mov_b32 v36, 0
    v_mov_b32 v37, 0
    v_mov_b32 v38, 0
    v_mov_b32 v39, 0
    v_mov_b32 v40, 0
    v_mov_b32 v41, 0
    v_mov_b32 v42, 0
    v_mov_b32 v43, 0
    v_mov_b32 v44, 0
    v_mov_b32 v45, 0
    v_mov_b32 v46, 0
    v_mov_b32 v47, 0
    s_waitcnt vmcnt(0)
    s_branch chain1_kernel_s_go2
chain1_kernel_roleV:
    s_sub_u32 s44, s2, 32
    s_load_dwordx2 s[6:7], s[0:1], 56
    s_load_dwordx2 s[24:25], s[0:1], 64
    s_waitcnt lgkmcnt(0)
    s_mov_b32 s12, s6
    s_mov_b32 s13, s7
    s_mov_b32 s14, 7864320
    s_mov_b32 s15, 0x00020000
    s_mov_b32 s16, s24
    s_mov_b32 s17, s25
    s_mov_b32 s18, 7864320
    s_mov_b32 s19, 0x00020000
    v_add_u32 v16, 0, v0
    s_mov_b32 s24, 683
    v_mul_lo_u32 v17, v16, s24
    v_lshrrev_b32 v17, 14, v17
    v_mul_u32_u24 v18, 24, v17
    v_sub_u32 v18, v16, v18
    s_mov_b32 s24, 12288
    v_mul_lo_u32 v4, v17, s24
    v_lshl_add_u32 v4, v18, 4, v4
    v_mul_u32_u24 v10, 400, v17
    v_lshl_add_u32 v10, v18, 4, v10
    v_add_u32 v10, 90112, v10
    v_add_u32 v16, 256, v0
    s_mov_b32 s24, 683
    v_mul_lo_u32 v17, v16, s24
    v_lshrrev_b32 v17, 14, v17
    v_mul_u32_u24 v18, 24, v17
    v_sub_u32 v18, v16, v18
    s_mov_b32 s24, 12288
    v_mul_lo_u32 v5, v17, s24
    v_lshl_add_u32 v5, v18, 4, v5
    v_mul_u32_u24 v11, 400, v17
    v_lshl_add_u32 v11, v18, 4, v11
    v_add_u32 v11, 90112, v11
    v_add_u32 v16, 512, v0
    s_mov_b32 s24, 683
    v_mul_lo_u32 v17, v16, s24
    v_lshrrev_b32 v17, 14, v17
    v_mul_u32_u24 v18, 24, v17
    v_sub_u32 v18, v16, v18
    s_mov_b32 s24, 12288
    v_mul_lo_u32 v6, v17, s24
    v_lshl_add_u32 v6, v18, 4, v6
    v_mul_u32_u24 v12, 400, v17
    v_lshl_add_u32 v12, v18, 4, v12
    v_add_u32 v12, 90112, v12
    v_add_u32 v16, 768, v0
    s_mov_b32 s24, 683
    v_mul_lo_u32 v17, v16, s24
    v_lshrrev_b32 v17, 14, v17
    v_mul_u32_u24 v18, 24, v17
    v_sub_u32 v18, v16, v18
    s_mov_b32 s24, 12288
    v_mul_lo_u32 v7, v17, s24
    v_lshl_add_u32 v7, v18, 4, v7
    v_mul_u32_u24 v13, 400, v17
    v_lshl_add_u32 v13, v18, 4, v13
    v_add_u32 v13, 90112, v13
    v_add_u32 v16, 1024, v0
    s_mov_b32 s24, 683
    v_mul_lo_u32 v17, v16, s24
    v_lshrrev_b32 v17, 14, v17
    v_mul_u32_u24 v18, 24, v17
    v_sub_u32 v18, v16, v18
    s_mov_b32 s24, 12288
    v_mul_lo_u32 v8, v17, s24
    v_lshl_add_u32 v8, v18, 4, v8
    v_mul_u32_u24 v14, 400, v17
    v_lshl_add_u32 v14, v18, 4, v14
    v_add_u32 v14, 90112, v14
    v_add_u32 v16, 1280, v0
    s_mov_b32 s24, 683
    v_mul_lo_u32 v17, v16, s24
    v_lshrrev_b32 v17, 14, v17
    v_mul_u32_u24 v18, 24, v17
    v_sub_u32 v18, v16, v18
    s_mov_b32 s24, 12288
    v_mul_lo_u32 v9, v17, s24
    v_lshl_add_u32 v9, v18, 4, v9
    v_mul_u32_u24 v15, 400, v17
    v_lshl_add_u32 v15, v18, 4, v15
    v_add_u32 v15, 90112, v15
    v_lshrrev_b32 v17, 1, v3
    v_lshlrev_b32 v17, 4, v17
    v_and_b32 v18, 1, v3
    v_lshl_add_u32 v17, v18, 2, v17
    v_lshrrev_b32 v18, 2, v2
    v_and_b32 v19, 1, v18
    v_add_u32 v17, v17, v19
    v_lshrrev_b32 v18, 1, v18
    v_lshl_add_u32 v17, v18, 3, v17
    v_mul_u32_u24 v16, 400, v17
    v_and_b32 v18, 3, v2
    v_lshl_add_u32 v16, v18, 3, v16
    v_add_u32 v16, 90112, v16
    s_mul_i32 s24, s3, 96
    v_add_u32 v16, s24, v16
    s_mul_i32 s45, s44, 384
    s_add_u32 s46, s45, 0
    buffer_load_dwordx4 v[24:27], v4, s[12:15], s46 offen
    buffer_load_dwordx4 v[28:31], v5, s[12:15], s46 offen
    buffer_load_dwordx4 v[32:35], v6, s[12:15], s46 offen
    buffer_load_dwordx4 v[36:39], v7, s[12:15], s46 offen
    buffer_load_dwordx4 v[40:43], v8, s[12:15], s46 offen
    buffer_load_dwordx4 v[44:47], v9, s[12:15], s46 offen
    s_add_u32 s46, s45, 786432
    buffer_load_dwordx4 v[48:51], v4, s[12:15], s46 offen
    buffer_load_dwordx4 v[52:55], v5, s[12:15], s46 offen
    buffer_load_dwordx4 v[56:59], v6, s[12:15], s46 offen
    buffer_load_dwordx4 v[60:63], v7, s[12:15], s46 offen
    buffer_load_dwordx4 v[64:67], v8, s[12:15], s46 offen
    buffer_load_dwordx4 v[68:71], v9, s[12:15], s46 offen
    s_waitcnt vmcnt(6)
    ds_write_b128 v10, v[24:27]
    ds_write_b128 v11, v[28:31]
    ds_write_b128 v12, v[32:35]
    ds_write_b128 v13, v[36:39]
    ds_write_b128 v14, v[40:43]
    ds_write_b128 v15, v[44:47]
    s_add_u32 s46, s45, 1572864
    buffer_load_dwordx4 v[72:75], v4, s[12:15], s46 offen
    buffer_load_dwordx4 v[76:79], v5, s[12:15], s46 offen
    buffer_load_dwordx4 v[80:83], v6, s[12:15], s46 offen
    buffer_load_dwordx4 v[84:87], v7, s[12:15], s46 offen
    buffer_load_dwordx4 v[88:91], v8, s[12:15], s46 offen
    buffer_load_dwordx4 v[92:95], v9, s[12:15], s46 offen
    s_waitcnt lgkmcnt(0)
    s_barrier
    ds_read_b64_tr_b16 a[0:1], v16 offset:0
    ds_read_b64_tr_b16 a[2:3], v16 offset:800
    ds_read_b64_tr_b16 a[4:5], v16 offset:12800
    ds_read_b64_tr_b16 a[6:7], v16 offset:13600
    ds_read_b64_tr_b16 a[80:81], v16 offset:32
    ds_read_b64_tr_b16 a[82:83], v16 offset:832
    ds_read_b64_tr_b16 a[84:85], v16 offset:12832
    ds_read_b64_tr_b16 a[86:87], v16 offset:13632
    ds_read_b64_tr_b16 a[160:161], v16 offset:64
    ds_read_b64_tr_b16 a[162:163], v16 offset:864
    ds_read_b64_tr_b16 a[164:165], v16 offset:12864
    ds_read_b64_tr_b16 a[166:167], v16 offset:13664
    s_waitcnt lgkmcnt(0)
    s_barrier
    s_waitcnt vmcnt(6)
    ds_write_b128 v10, v[48:51]
    ds_write_b128 v11, v[52:55]
    ds_write_b128 v12, v[56:59]
    ds_write_b128 v13, v[60:63]
    ds_write_b128 v14, v[64:67]
    ds_write_b128 v15, v[68:71]
    s_add_u32 s46, s45, 2359296
    buffer_load_dwordx4 v[24:27], v4, s[12:15], s46 offen
    buffer_load_dwordx4 v[28:31], v5, s[12:15], s46 offen
    buffer_load_dwordx4 v[32:35], v6, s[12:15], s46 offen
    buffer_load_dwordx4 v[36:39], v7, s[12:15], s46 offen
    buffer_load_dwordx4 v[40:43], v8, s[12:15], s46 offen
    buffer_load_dwordx4 v[44:47], v9, s[12:15], s46 offen
    s_waitcnt lgkmcnt(0)
    s_barrier
    ds_read_b64_tr_b16 a[8:9], v16 offset:0
    ds_read_b64_tr_b16 a[10:11], v16 offset:800
    ds_read_b64_tr_b16 a[12:13], v16 offset:12800
    ds_read_b64_tr_b16 a[14:15], v16 offset:13600
    ds_read_b64_tr_b16 a[88:89], v16 offset:32
    ds_read_b64_tr_b16 a[90:91], v16 offset:832
    ds_read_b64_tr_b16 a[92:93], v16 offset:12832
    ds_read_b64_tr_b16 a[94:95], v16 offset:13632
    ds_read_b64_tr_b16 a[168:169], v16 offset:64
    ds_read_b64_tr_b16 a[170:171], v16 offset:864
    ds_read_b64_tr_b16 a[172:173], v16 offset:12864
    ds_read_b64_tr_b16 a[174:175], v16 offset:13664
    s_waitcnt lgkmcnt(0)
    s_barrier
    s_waitcnt vmcnt(6)
    ds_write_b128 v10, v[72:75]
    ds_write_b128 v11, v[76:79]
    ds_write_b128 v12, v[80:83]
    ds_write_b128 v13, v[84:87]
    ds_write_b128 v14, v[88:91]
    ds_write_b128 v15, v[92:95]
    s_add_u32 s46, s45, 3145728
    buffer_load_dwordx4 v[48:51], v4, s[12:15], s46 offen
    buffer_load_dwordx4 v[52:55], v5, s[12:15], s46 offen
    buffer_load_dwordx4 v[56:59], v6, s[12:15], s46 offen
    buffer_load_dwordx4 v[60:63], v7, s[12:15], s46 offen
    buffer_load_dwordx4 v[64:67], v8, s[12:15], s46 offen
    buffer_load_dwordx4 v[68:71], v9, s[12:15], s46 offen
    s_waitcnt lgkmcnt(0)
    s_barrier
    ds_read_b64_tr_b16 a[16:17], v16 offset:0
    ds_read_b64_tr_b16 a[18:19], v16 offset:800
    ds_read_b64_tr_b16 a[20:21], v16 offset:12800
    ds_read_b64_tr_b16 a[22:23], v16 offset:13600
    ds_read_b64_tr_b16 a[96:97], v16 offset:32
    ds_read_b64_tr_b16 a[98:99], v16 offset:832
    ds_read_b64_tr_b16 a[100:101], v16 offset:12832
    ds_read_b64_tr_b16 a[102:103], v16 offset:13632
    ds_read_b64_tr_b16 a[176:177], v16 offset:64
    ds_read_b64_tr_b16 a[178:179], v16 offset:864
    ds_read_b64_tr_b16 a[180:181], v16 offset:12864
    ds_read_b64_tr_b16 a[182:183], v16 offset:13664
    s_waitcnt lgkmcnt(0)
    s_barrier
    s_waitcnt vmcnt(6)
    ds_write_b128 v10, v[24:27]
    ds_write_b128 v11, v[28:31]
    ds_write_b128 v12, v[32:35]
    ds_write_b128 v13, v[36:39]
    ds_write_b128 v14, v[40:43]
    ds_write_b128 v15, v[44:47]
    s_add_u32 s46, s45, 3932160
    buffer_load_dwordx4 v[72:75], v4, s[12:15], s46 offen
    buffer_load_dwordx4 v[76:79], v5, s[12:15], s46 offen
    buffer_load_dwordx4 v[80:83], v6, s[12:15], s46 offen
    buffer_load_dwordx4 v[84:87], v7, s[12:15], s46 offen
    buffer_load_dwordx4 v[88:91], v8, s[12:15], s46 offen
    buffer_load_dwordx4 v[92:95], v9, s[12:15], s46 offen
    s_waitcnt lgkmcnt(0)
    s_barrier
    ds_read_b64_tr_b16 a[24:25], v16 offset:0
    ds_read_b64_tr_b16 a[26:27], v16 offset:800
    ds_read_b64_tr_b16 a[28:29], v16 offset:12800
    ds_read_b64_tr_b16 a[30:31], v16 offset:13600
    ds_read_b64_tr_b16 a[104:105], v16 offset:32
    ds_read_b64_tr_b16 a[106:107], v16 offset:832
    ds_read_b64_tr_b16 a[108:109], v16 offset:12832
    ds_read_b64_tr_b16 a[110:111], v16 offset:13632
    ds_read_b64_tr_b16 a[184:185], v16 offset:64
    ds_read_b64_tr_b16 a[186:187], v16 offset:864
    ds_read_b64_tr_b16 a[188:189], v16 offset:12864
    ds_read_b64_tr_b16 a[190:191], v16 offset:13664
    s_waitcnt lgkmcnt(0)
    s_barrier
    s_waitcnt vmcnt(6)
    ds_write_b128 v10, v[48:51]
    ds_write_b128 v11, v[52:55]
    ds_write_b128 v12, v[56:59]
    ds_write_b128 v13, v[60:63]
    ds_write_b128 v14, v[64:67]
    ds_write_b128 v15, v[68:71]
    s_add_u32 s46, s45, 4718592
    buffer_load_dwordx4 v[24:27], v4, s[12:15], s46 offen
    buffer_load_dwordx4 v[28:31], v5, s[12:15], s46 offen
    buffer_load_dwordx4 v[32:35], v6, s[12:15], s46 offen
    buffer_load_dwordx4 v[36:39], v7, s[12:15], s46 offen
    buffer_load_dwordx4 v[40:43], v8, s[12:15], s46 offen
    buffer_load_dwordx4 v[44:47], v9, s[12:15], s46 offen
    s_waitcnt lgkmcnt(0)
    s_barrier
    ds_read_b64_tr_b16 a[32:33], v16 offset:0
    ds_read_b64_tr_b16 a[34:35], v16 offset:800
    ds_read_b64_tr_b16 a[36:37], v16 offset:12800
    ds_read_b64_tr_b16 a[38:39], v16 offset:13600
    ds_read_b64_tr_b16 a[112:113], v16 offset:32
    ds_read_b64_tr_b16 a[114:115], v16 offset:832
    ds_read_b64_tr_b16 a[116:117], v16 offset:12832
    ds_read_b64_tr_b16 a[118:119], v16 offset:13632
    ds_read_b64_tr_b16 a[192:193], v16 offset:64
    ds_read_b64_tr_b16 a[194:195], v16 offset:864
    ds_read_b64_tr_b16 a[196:197], v16 offset:12864
    ds_read_b64_tr_b16 a[198:199], v16 offset:13664
    s_waitcnt lgkmcnt(0)
    s_barrier
    s_waitcnt vmcnt(6)
    ds_write_b128 v10, v[72:75]
    ds_write_b128 v11, v[76:79]
    ds_write_b128 v12, v[80:83]
    ds_write_b128 v13, v[84:87]
    ds_write_b128 v14, v[88:91]
    ds_write_b128 v15, v[92:95]
    s_add_u32 s46, s45, 5505024
    buffer_load_dwordx4 v[48:51], v4, s[12:15], s46 offen
    buffer_load_dwordx4 v[52:55], v5, s[12:15], s46 offen
    buffer_load_dwordx4 v[56:59], v6, s[12:15], s46 offen
    buffer_load_dwordx4 v[60:63], v7, s[12:15], s46 offen
    buffer_load_dwordx4 v[64:67], v8, s[12:15], s46 offen
    buffer_load_dwordx4 v[68:71], v9, s[12:15], s46 offen
    s_waitcnt lgkmcnt(0)
    s_barrier
    ds_read_b64_tr_b16 a[40:41], v16 offset:0
    ds_read_b64_tr_b16 a[42:43], v16 offset:800
    ds_read_b64_tr_b16 a[44:45], v16 offset:12800
    ds_read_b64_tr_b16 a[46:47], v16 offset:13600
    ds_read_b64_tr_b16 a[120:121], v16 offset:32
    ds_read_b64_tr_b16 a[122:123], v16 offset:832
    ds_read_b64_tr_b16 a[124:125], v16 offset:12832
    ds_read_b64_tr_b16 a[126:127], v16 offset:13632
    ds_read_b64_tr_b16 a[200:201], v16 offset:64
    ds_read_b64_tr_b16 a[202:203], v16 offset:864
    ds_read_b64_tr_b16 a[204:205], v16 offset:12864
    ds_read_b64_tr_b16 a[206:207], v16 offset:13664
    s_waitcnt lgkmcnt(0)
    s_barrier
    s_waitcnt vmcnt(6)
    ds_write_b128 v10, v[24:27]
    ds_write_b128 v11, v[28:31]
    ds_write_b128 v12, v[32:35]
    ds_write_b128 v13, v[36:39]
    ds_write_b128 v14, v[40:43]
    ds_write_b128 v15, v[44:47]
    s_add_u32 s46, s45, 6291456
    buffer_load_dwordx4 v[72:75], v4, s[12:15], s46 offen
    buffer_load_dwordx4 v[76:79], v5, s[12:15], s46 offen
    buffer_load_dwordx4 v[80:83], v6, s[12:15], s46 offen
    buffer_load_dwordx4 v[84:87], v7, s[12:15], s46 offen
    buffer_load_dwordx4 v[88:91], v8, s[12:15], s46 offen
    buffer_load_dwordx4 v[92:95], v9, s[12:15], s46 offen
    s_waitcnt lgkmcnt(0)
    s_barrier
    ds_read_b64_tr_b16 a[48:49], v16 offset:0
    ds_read_b64_tr_b16 a[50:51], v16 offset:800
    ds_read_b64_tr_b16 a[52:53], v16 offset:12800
    ds_read_b64_tr_b16 a[54:55], v16 offset:13600
    ds_read_b64_tr_b16 a[128:129], v16 offset:32
    ds_read_b64_tr_b16 a[130:131], v16 offset:832
    ds_read_b64_tr_b16 a[132:133], v16 offset:12832
    ds_read_b64_tr_b16 a[134:135], v16 offset:13632
    ds_read_b64_tr_b16 a[208:209], v16 offset:64
    ds_read_b64_tr_b16 a[210:211], v16 offset:864
    ds_read_b64_tr_b16 a[212:213], v16 offset:12864
    ds_read_b64_tr_b16 a[214:215], v16 offset:13664
    s_waitcnt lgkmcnt(0)
    s_barrier
    s_waitcnt vmcnt(6)
    ds_write_b128 v10, v[48:51]
    ds_write_b128 v11, v[52:55]
    ds_write_b128 v12, v[56:59]
    ds_write_b128 v13, v[60:63]
    ds_write_b128 v14, v[64:67]
    ds_write_b128 v15, v[68:71]
    s_add_u32 s46, s45, 7077888
    buffer_load_dwordx4 v[24:27], v4, s[12:15], s46 offen
    buffer_load_dwordx4 v[28:31], v5, s[12:15], s46 offen
    buffer_load_dwordx4 v[32:35], v6, s[12:15], s46 offen
    buffer_load_dwordx4 v[36:39], v7, s[12:15], s46 offen
    buffer_load_dwordx4 v[40:43], v8, s[12:15], s46 offen
    buffer_load_dwordx4 v[44:47], v9, s[12:15], s46 offen
    s_waitcnt lgkmcnt(0)
    s_barrier
    ds_read_b64_tr_b16 a[56:57], v16 offset:0
    ds_read_b64_tr_b16 a[58:59], v16 offset:800
    ds_read_b64_tr_b16 a[60:61], v16 offset:12800
    ds_read_b64_tr_b16 a[62:63], v16 offset:13600
    ds_read_b64_tr_b16 a[136:137], v16 offset:32
    ds_read_b64_tr_b16 a[138:139], v16 offset:832
    ds_read_b64_tr_b16 a[140:141], v16 offset:12832
    ds_read_b64_tr_b16 a[142:143], v16 offset:13632
    ds_read_b64_tr_b16 a[216:217], v16 offset:64
    ds_read_b64_tr_b16 a[218:219], v16 offset:864
    ds_read_b64_tr_b16 a[220:221], v16 offset:12864
    ds_read_b64_tr_b16 a[222:223], v16 offset:13664
    s_waitcnt lgkmcnt(0)
    s_barrier
    s_waitcnt vmcnt(6)
    ds_write_b128 v10, v[72:75]
    ds_write_b128 v11, v[76:79]
    ds_write_b128 v12, v[80:83]
    ds_write_b128 v13, v[84:87]
    ds_write_b128 v14, v[88:91]
    ds_write_b128 v15, v[92:95]
    s_waitcnt lgkmcnt(0)
    s_barrier
    ds_read_b64_tr_b16 a[64:65], v16 offset:0
    ds_read_b64_tr_b16 a[66:67], v16 offset:800
    ds_read_b64_tr_b16 a[68:69], v16 offset:12800
    ds_read_b64_tr_b16 a[70:71], v16 offset:13600
    ds_read_b64_tr_b16 a[144:145], v16 offset:32
    ds_read_b64_tr_b16 a[146:147], v16 offset:832
    ds_read_b64_tr_b16 a[148:149], v16 offset:12832
    ds_read_b64_tr_b16 a[150:151], v16 offset:13632
    ds_read_b64_tr_b16 a[224:225], v16 offset:64
    ds_read_b64_tr_b16 a[226:227], v16 offset:864
    ds_read_b64_tr_b16 a[228:229], v16 offset:12864
    ds_read_b64_tr_b16 a[230:231], v16 offset:13664
    s_waitcnt lgkmcnt(0)
    s_barrier
    s_waitcnt vmcnt(0)
    ds_write_b128 v10, v[24:27]
    ds_write_b128 v11, v[28:31]
    ds_write_b128 v12, v[32:35]
    ds_write_b128 v13, v[36:39]
    ds_write_b128 v14, v[40:43]
    ds_write_b128 v15, v[44:47]
    s_waitcnt lgkmcnt(0)
    s_barrier
    ds_read_b64_tr_b16 a[72:73], v16 offset:0
    ds_read_b64_tr_b16 a[74:75], v16 offset:800
    ds_read_b64_tr_b16 a[76:77], v16 offset:12800
    ds_read_b64_tr_b16 a[78:79], v16 offset:13600
    ds_read_b64_tr_b16 a[152:153], v16 offset:32
    ds_read_b64_tr_b16 a[154:155], v16 offset:832
    ds_read_b64_tr_b16 a[156:157], v16 offset:12832
    ds_read_b64_tr_b16 a[158:159], v16 offset:13632
    ds_read_b64_tr_b16 a[232:233], v16 offset:64
    ds_read_b64_tr_b16 a[234:235], v16 offset:864
    ds_read_b64_tr_b16 a[236:237], v16 offset:12864
    ds_read_b64_tr_b16 a[238:239], v16 offset:13664
    s_waitcnt lgkmcnt(0)
    s_barrier
    v_add_u32 v64, 0, v0
    s_mov_b32 s24, 1639
    v_mul_lo_u32 v65, v64, s24
    v_lshrrev_b32 v65, 16, v65
    v_mul_u32_u24 v66, 40, v65
    v_sub_u32 v66, v64, v66
    s_mov_b32 s24, 1280
    v_mul_lo_u32 v4, v65, s24
    v_lshl_add_u32 v4, v66, 4, v4
    v_mul_u32_u24 v14, 656, v65
    v_lshl_add_u32 v14, v66, 4, v14
    v_add_u32 v14, 90112, v14
    v_add_u32 v64, 256, v0
    s_mov_b32 s24, 1639
    v_mul_lo_u32 v65, v64, s24
    v_lshrrev_b32 v65, 16, v65
    v_mul_u32_u24 v66, 40, v65
    v_sub_u32 v66, v64, v66
    s_mov_b32 s24, 1280
    v_mul_lo_u32 v5, v65, s24
    v_lshl_add_u32 v5, v66, 4, v5
    v_mul_u32_u24 v15, 656, v65
    v_lshl_add_u32 v15, v66, 4, v15
    v_add_u32 v15, 90112, v15
    v_add_u32 v64, 512, v0
    s_mov_b32 s24, 1639
    v_mul_lo_u32 v65, v64, s24
    v_lshrrev_b32 v65, 16, v65
    v_mul_u32_u24 v66, 40, v65
    v_sub_u32 v66, v64, v66
    s_mov_b32 s24, 1280
    v_mul_lo_u32 v6, v65, s24
    v_lshl_add_u32 v6, v66, 4, v6
    v_mul_u32_u24 v16, 656, v65
    v_lshl_add_u32 v16, v66, 4, v16
    v_add_u32 v16, 90112, v16
    v_add_u32 v64, 768, v0
    s_mov_b32 s24, 1639
    v_mul_lo_u32 v65, v64, s24
    v_lshrrev_b32 v65, 16, v65
    v_mul_u32_u24 v66, 40, v65
    v_sub_u32 v66, v64, v66
    s_mov_b32 s24, 1280
    v_mul_lo_u32 v7, v65, s24
    v_lshl_add_u32 v7, v66, 4, v7
    v_mul_u32_u24 v17, 656, v65
    v_lshl_add_u32 v17, v66, 4, v17
    v_add_u32 v17, 90112, v17
    v_add_u32 v64, 1024, v0
    s_mov_b32 s24, 1639
    v_mul_lo_u32 v65, v64, s24
    v_lshrrev_b32 v65, 16, v65
    v_mul_u32_u24 v66, 40, v65
    v_sub_u32 v66, v64, v66
    s_mov_b32 s24, 1280
    v_mul_lo_u32 v8, v65, s24
    v_lshl_add_u32 v8, v66, 4, v8
    v_mul_u32_u24 v18, 656, v65
    v_lshl_add_u32 v18, v66, 4, v18
    v_add_u32 v18, 90112, v18
    v_add_u32 v64, 1280, v0
    s_mov_b32 s24, 1639
    v_mul_lo_u32 v65, v64, s24
    v_lshrrev_b32 v65, 16, v65
    v_mul_u32_u24 v66, 40, v65
    v_sub_u32 v66, v64, v66
    s_mov_b32 s24, 1280
    v_mul_lo_u32 v9, v65, s24
    v_lshl_add_u32 v9, v66, 4, v9
    v_mul_u32_u24 v19, 656, v65
    v_lshl_add_u32 v19, v66, 4, v19
    v_add_u32 v19, 90112, v19
    v_add_u32 v64, 1536, v0
    s_mov_b32 s24, 1639
    v_mul_lo_u32 v65, v64, s24
    v_lshrrev_b32 v65, 16, v65
    v_mul_u32_u24 v66, 40, v65
    v_sub_u32 v66, v64, v66
    s_mov_b32 s24, 1280
    v_mul_lo_u32 v10, v65, s24
    v_lshl_add_u32 v10, v66, 4, v10
    v_mul_u32_u24 v20, 656, v65
    v_lshl_add_u32 v20, v66, 4, v20
    v_add_u32 v20, 90112, v20
    v_add_u32 v64, 1792, v0
    s_mov_b32 s24, 1639
    v_mul_lo_u32 v65, v64, s24
    v_lshrrev_b32 v65, 16, v65
    v_mul_u32_u24 v66, 40, v65
    v_sub_u32 v66, v64, v66
    s_mov_b32 s24, 1280
    v_mul_lo_u32 v11, v65, s24
    v_lshl_add_u32 v11, v66, 4, v11
    v_mul_u32_u24 v21, 656, v65
    v_lshl_add_u32 v21, v66, 4, v21
    v_add_u32 v21, 90112, v21
    v_add_u32 v64, 2048, v0
    s_mov_b32 s24, 1639
    v_mul_lo_u32 v65, v64, s24
    v_lshrrev_b32 v65, 16, v65
    v_mul_u32_u24 v66, 40, v65
    v_sub_u32 v66, v64, v66
    s_mov_b32 s24, 1280
    v_mul_lo_u32 v12, v65, s24
    v_lshl_add_u32 v12, v66, 4, v12
    v_mul_u32_u24 v22, 656, v65
    v_lshl_add_u32 v22, v66, 4, v22
    v_add_u32 v22, 90112, v22
    v_add_u32 v64, 2304, v0
    s_mov_b32 s24, 1639
    v_mul_lo_u32 v65, v64, s24
    v_lshrrev_b32 v65, 16, v65
    v_mul_u32_u24 v66, 40, v65
    v_sub_u32 v66, v64, v66
    s_mov_b32 s24, 1280
    v_mul_lo_u32 v13, v65, s24
    v_lshl_add_u32 v13, v66, 4, v13
    v_mul_u32_u24 v23, 656, v65
    v_lshl_add_u32 v23, v66, 4, v23
    v_add_u32 v23, 90112, v23
    v_lshrrev_b32 v64, 1, v3
    v_lshlrev_b32 v64, 4, v64
    v_and_b32 v65, 1, v3
    v_lshl_add_u32 v64, v65, 2, v64
    v_lshrrev_b32 v65, 2, v2
    v_and_b32 v66, 1, v65
    v_add_u32 v64, v64, v66
    v_lshrrev_b32 v65, 1, v65
    v_lshl_add_u32 v64, v65, 3, v64
    v_mul_u32_u24 v72, 656, v64
    v_and_b32 v65, 3, v2
    v_lshl_add_u32 v72, v65, 3, v72
    v_add_u32 v72, 90112, v72
    s_and_b32 s24, s3, 1
    s_mul_i32 s24, s24, 320
    v_add_u32 v72, s24, v72
    v_lshlrev_b32 v73, 4, v1
    s_mul_i32 s24, s3, 18432
    s_add_u32 s24, s24, 16384
    v_add_u32 v73, s24, v73
    s_mul_i32 s45, s44, 245760
    s_add_u32 s46, s45, 0
    buffer_load_dwordx4 v[24:27], v4, s[16:19], s46 offen
    buffer_load_dwordx4 v[28:31], v5, s[16:19], s46 offen
    buffer_load_dwordx4 v[32:35], v6, s[16:19], s46 offen
    buffer_load_dwordx4 v[36:39], v7, s[16:19], s46 offen
    buffer_load_dwordx4 v[40:43], v8, s[16:19], s46 offen
    buffer_load_dwordx4 v[44:47], v9, s[16:19], s46 offen
    buffer_load_dwordx4 v[48:51], v10, s[16:19], s46 offen
    buffer_load_dwordx4 v[52:55], v11, s[16:19], s46 offen
    buffer_load_dwordx4 v[56:59], v12, s[16:19], s46 offen
    buffer_load_dwordx4 v[60:63], v13, s[16:19], s46 offen
    s_waitcnt vmcnt(0)
    ds_write_b128 v14, v[24:27]
    ds_write_b128 v15, v[28:31]
    ds_write_b128 v16, v[32:35]
    ds_write_b128 v17, v[36:39]
    ds_write_b128 v18, v[40:43]
    ds_write_b128 v19, v[44:47]
    ds_write_b128 v20, v[48:51]
    ds_write_b128 v21, v[52:55]
    ds_write_b128 v22, v[56:59]
    ds_write_b128 v23, v[60:63]
    s_waitcnt lgkmcnt(0)
    s_barrier
    s_lshr_b32 s24, s3, 1
    s_cmp_eq_u32 s24, 0
    s_cbranch_scc0 chain1_kernel_wo1
    ds_read_b64_tr_b16 a[240:241], v72 offset:0
    ds_read_b64_tr_b16 a[242:243], v72 offset:1312
    ds_read_b64_tr_b16 a[244:245], v72 offset:20992
    ds_read_b64_tr_b16 a[246:247], v72 offset:22304
    ds_read_b64_tr_b16 v[112:113], v72 offset:32
    ds_read_b64_tr_b16 v[114:115], v72 offset:1344
    ds_read_b64_tr_b16 v[116:117], v72 offset:21024
    ds_read_b64_tr_b16 v[118:119], v72 offset:22336
    ds_read_b64_tr_b16 v[136:137], v72 offset:64
    ds_read_b64_tr_b16 v[138:139], v72 offset:1376
    ds_read_b64_tr_b16 v[140:141], v72 offset:21056
    ds_read_b64_tr_b16 v[142:143], v72 offset:22368
    ds_read_b64_tr_b16 v[160:161], v72 offset:96
    ds_read_b64_tr_b16 v[162:163], v72 offset:1408
    ds_read_b64_tr_b16 v[164:165], v72 offset:21088
    ds_read_b64_tr_b16 v[166:167], v72 offset:22400
    ds_read_b64_tr_b16 v[184:185], v72 offset:128
    ds_read_b64_tr_b16 v[186:187], v72 offset:1440
    ds_read_b64_tr_b16 v[188:189], v72 offset:21120
    ds_read_b64_tr_b16 v[190:191], v72 offset:22432
    ds_read_b64_tr_b16 v[208:209], v72 offset:160
    ds_read_b64_tr_b16 v[210:211], v72 offset:1472
    ds_read_b64_tr_b16 v[212:213], v72 offset:21152
    ds_read_b64_tr_b16 v[214:215], v72 offset:22464
    ds_read_b64_tr_b16 v[232:233], v72 offset:192
    ds_read_b64_tr_b16 v[234:235], v72 offset:1504
    ds_read_b64_tr_b16 v[236:237], v72 offset:21184
    ds_read_b64_tr_b16 v[238:239], v72 offset:22496
    ds_read_b64_tr_b16 v[64:65], v72 offset:224
    ds_read_b64_tr_b16 v[66:67], v72 offset:1536
    ds_read_b64_tr_b16 v[68:69], v72 offset:21216
    ds_read_b64_tr_b16 v[70:71], v72 offset:22528
    s_waitcnt lgkmcnt(0)
    ds_write_b128 v73, v[64:67] offset:0
    ds_write_b128 v73, v[68:71] offset:1024
    s_waitcnt lgkmcnt(0)
    ds_read_b64_tr_b16 v[64:65], v72 offset:256
    ds_read_b64_tr_b16 v[66:67], v72 offset:1568
    ds_read_b64_tr_b16 v[68:69], v72 offset:21248
    ds_read_b64_tr_b16 v[70:71], v72 offset:22560
    s_waitcnt lgkmcnt(0)
    ds_write_b128 v73, v[64:67] offset:6144
    ds_write_b128 v73, v[68:71] offset:7168
    s_waitcnt lgkmcnt(0)
    ds_read_b64_tr_b16 v[64:65], v72 offset:288
    ds_read_b64_tr_b16 v[66:67], v72 offset:1600
    ds_read_b64_tr_b16 v[68:69], v72 offset:21280
    ds_read_b64_tr_b16 v[70:71], v72 offset:22592
    s_waitcnt lgkmcnt(0)
    ds_write_b128 v73, v[64:67] offset:12288
    ds_write_b128 v73, v[68:71] offset:13312
    s_waitcnt lgkmcnt(0)
    s_waitcnt lgkmcnt(0)
chain1_kernel_wo1:
    s_barrier
    s_add_u32 s46, s45, 640
    buffer_load_dwordx4 v[24:27], v4, s[16:19], s46 offen
    buffer_load_dwordx4 v[28:31], v5, s[16:19], s46 offen
    buffer_load_dwordx4 v[32:35], v6, s[16:19], s46 offen
    buffer_load_dwordx4 v[36:39], v7, s[16:19], s46 offen
    buffer_load_dwordx4 v[40:43], v8, s[16:19], s46 offen
    buffer_load_dwordx4 v[44:47], v9, s[16:19], s46 offen
    buffer_load_dwordx4 v[48:51], v10, s[16:19], s46 offen
    buffer_load_dwordx4 v[52:55], v11, s[16:19], s46 offen
    buffer_load_dwordx4 v[56:59], v12, s[16:19], s46 offen
    buffer_load_dwordx4 v[60:63], v13, s[16:19], s46 offen
    s_waitcnt vmcnt(0)
    ds_write_b128 v14, v[24:27]
    ds_write_b128 v15, v[28:31]
    ds_write_b128 v16, v[32:35]
    ds_write_b128 v17, v[36:39]
    ds_write_b128 v18, v[40:43]
    ds_write_b128 v19, v[44:47]
    ds_write_b128 v20, v[48:51]
    ds_write_b128 v21, v[52:55]
    ds_write_b128 v22, v[56:59]
    ds_write_b128 v23, v[60:63]
    s_waitcnt lgkmcnt(0)
    s_barrier
    s_lshr_b32 s24, s3, 1
    s_cmp_eq_u32 s24, 1
    s_cbranch_scc0 chain1_kernel_wo2
    ds_read_b64_tr_b16 a[240:241], v72 offset:0
    ds_read_b64_tr_b16 a[242:243], v72 offset:1312
    ds_read_b64_tr_b16 a[244:245], v72 offset:20992
    ds_read_b64_tr_b16 a[246:247], v72 offset:22304
    ds_read_b64_tr_b16 v[112:113], v72 offset:32
    ds_read_b64_tr_b16 v[114:115], v72 offset:1344
    ds_read_b64_tr_b16 v[116:117], v72 offset:21024
    ds_read_b64_tr_b16 v[118:119], v72 offset:22336
    ds_read_b64_tr_b16 v[136:137], v72 offset:64
    ds_read_b64_tr_b16 v[138:139], v72 offset:1376
    ds_read_b64_tr_b16 v[140:141], v72 offset:21056
    ds_read_b64_tr_b16 v[142:143], v72 offset:22368
    ds_read_b64_tr_b16 v[160:161], v72 offset:96
    ds_read_b64_tr_b16 v[162:163], v72 offset:1408
    ds_read_b64_tr_b16 v[164:165], v72 offset:21088
    ds_read_b64_tr_b16 v[166:167], v72 offset:22400
    ds_read_b64_tr_b16 v[184:185], v72 offset:128
    ds_read_b64_tr_b16 v[186:187], v72 offset:1440
    ds_read_b64_tr_b16 v[188:189], v72 offset:21120
    ds_read_b64_tr_b16 v[190:191], v72 offset:22432
    ds_read_b64_tr_b16 v[208:209], v72 offset:160
    ds_read_b64_tr_b16 v[210:211], v72 offset:1472
    ds_read_b64_tr_b16 v[212:213], v72 offset:21152
    ds_read_b64_tr_b16 v[214:215], v72 offset:22464
    ds_read_b64_tr_b16 v[232:233], v72 offset:192
    ds_read_b64_tr_b16 v[234:235], v72 offset:1504
    ds_read_b64_tr_b16 v[236:237], v72 offset:21184
    ds_read_b64_tr_b16 v[238:239], v72 offset:22496
    ds_read_b64_tr_b16 v[64:65], v72 offset:224
    ds_read_b64_tr_b16 v[66:67], v72 offset:1536
    ds_read_b64_tr_b16 v[68:69], v72 offset:21216
    ds_read_b64_tr_b16 v[70:71], v72 offset:22528
    s_waitcnt lgkmcnt(0)
    ds_write_b128 v73, v[64:67] offset:0
    ds_write_b128 v73, v[68:71] offset:1024
    s_waitcnt lgkmcnt(0)
    ds_read_b64_tr_b16 v[64:65], v72 offset:256
    ds_read_b64_tr_b16 v[66:67], v72 offset:1568
    ds_read_b64_tr_b16 v[68:69], v72 offset:21248
    ds_read_b64_tr_b16 v[70:71], v72 offset:22560
    s_waitcnt lgkmcnt(0)
    ds_write_b128 v73, v[64:67] offset:6144
    ds_write_b128 v73, v[68:71] offset:7168
    s_waitcnt lgkmcnt(0)
    ds_read_b64_tr_b16 v[64:65], v72 offset:288
    ds_read_b64_tr_b16 v[66:67], v72 offset:1600
    ds_read_b64_tr_b16 v[68:69], v72 offset:21280
    ds_read_b64_tr_b16 v[70:71], v72 offset:22592
    s_waitcnt lgkmcnt(0)
    ds_write_b128 v73, v[64:67] offset:12288
    ds_write_b128 v73, v[68:71] offset:13312
    s_waitcnt lgkmcnt(0)
    s_waitcnt lgkmcnt(0)
chain1_kernel_wo2:
    s_barrier
    s_add_u32 s46, s45, 81920
    buffer_load_dwordx4 v[24:27], v4, s[16:19], s46 offen
    buffer_load_dwordx4 v[28:31], v5, s[16:19], s46 offen
    buffer_load_dwordx4 v[32:35], v6, s[16:19], s46 offen
    buffer_load_dwordx4 v[36:39], v7, s[16:19], s46 offen
    buffer_load_dwordx4 v[40:43], v8, s[16:19], s46 offen
    buffer_load_dwordx4 v[44:47], v9, s[16:19], s46 offen
    buffer_load_dwordx4 v[48:51], v10, s[16:19], s46 offen
    buffer_load_dwordx4 v[52:55], v11, s[16:19], s46 offen
    buffer_load_dwordx4 v[56:59], v12, s[16:19], s46 offen
    buffer_load_dwordx4 v[60:63], v13, s[16:19], s46 offen
    s_waitcnt vmcnt(0)
    ds_write_b128 v14, v[24:27]
    ds_write_b128 v15, v[28:31]
    ds_write_b128 v16, v[32:35]
    ds_write_b128 v17, v[36:39]
    ds_write_b128 v18, v[40:43]
    ds_write_b128 v19, v[44:47]
    ds_write_b128 v20, v[48:51]
    ds_write_b128 v21, v[52:55]
    ds_write_b128 v22, v[56:59]
    ds_write_b128 v23, v[60:63]
    s_waitcnt lgkmcnt(0)
    s_barrier
    s_lshr_b32 s24, s3, 1
    s_cmp_eq_u32 s24, 0
    s_cbranch_scc0 chain1_kernel_wo3
    ds_read_b64_tr_b16 a[248:249], v72 offset:0
    ds_read_b64_tr_b16 a[250:251], v72 offset:1312
    ds_read_b64_tr_b16 a[252:253], v72 offset:20992
    ds_read_b64_tr_b16 a[254:255], v72 offset:22304
    ds_read_b64_tr_b16 v[120:121], v72 offset:32
    ds_read_b64_tr_b16 v[122:123], v72 offset:1344
    ds_read_b64_tr_b16 v[124:125], v72 offset:21024
    ds_read_b64_tr_b16 v[126:127], v72 offset:22336
    ds_read_b64_tr_b16 v[144:145], v72 offset:64
    ds_read_b64_tr_b16 v[146:147], v72 offset:1376
    ds_read_b64_tr_b16 v[148:149], v72 offset:21056
    ds_read_b64_tr_b16 v[150:151], v72 offset:22368
    ds_read_b64_tr_b16 v[168:169], v72 offset:96
    ds_read_b64_tr_b16 v[170:171], v72 offset:1408
    ds_read_b64_tr_b16 v[172:173], v72 offset:21088
    ds_read_b64_tr_b16 v[174:175], v72 offset:22400
    ds_read_b64_tr_b16 v[192:193], v72 offset:128
    ds_read_b64_tr_b16 v[194:195], v72 offset:1440
    ds_read_b64_tr_b16 v[196:197], v72 offset:21120
    ds_read_b64_tr_b16 v[198:199], v72 offset:22432
    ds_read_b64_tr_b16 v[216:217], v72 offset:160
    ds_read_b64_tr_b16 v[218:219], v72 offset:1472
    ds_read_b64_tr_b16 v[220:221], v72 offset:21152
    ds_read_b64_tr_b16 v[222:223], v72 offset:22464
    ds_read_b64_tr_b16 v[240:241], v72 offset:192
    ds_read_b64_tr_b16 v[242:243], v72 offset:1504
    ds_read_b64_tr_b16 v[244:245], v72 offset:21184
    ds_read_b64_tr_b16 v[246:247], v72 offset:22496
    ds_read_b64_tr_b16 v[64:65], v72 offset:224
    ds_read_b64_tr_b16 v[66:67], v72 offset:1536
    ds_read_b64_tr_b16 v[68:69], v72 offset:21216
    ds_read_b64_tr_b16 v[70:71], v72 offset:22528
    s_waitcnt lgkmcnt(0)
    ds_write_b128 v73, v[64:67] offset:2048
    ds_write_b128 v73, v[68:71] offset:3072
    s_waitcnt lgkmcnt(0)
    ds_read_b64_tr_b16 v[64:65], v72 offset:256
    ds_read_b64_tr_b16 v[66:67], v72 offset:1568
    ds_read_b64_tr_b16 v[68:69], v72 offset:21248
    ds_read_b64_tr_b16 v[70:71], v72 offset:22560
    s_waitcnt lgkmcnt(0)
    ds_write_b128 v73, v[64:67] offset:8192
    ds_write_b128 v73, v[68:71] offset:9216
    s_waitcnt lgkmcnt(0)
    ds_read_b64_tr_b16 v[64:65], v72 offset:288
    ds_read_b64_tr_b16 v[66:67], v72 offset:1600
    ds_read_b64_tr_b16 v[68:69], v72 offset:21280
    ds_read_b64_tr_b16 v[70:71], v72 offset:22592
    s_waitcnt lgkmcnt(0)
    ds_write_b128 v73, v[64:67] offset:14336
    ds_write_b128 v73, v[68:71] offset:15360
    s_waitcnt lgkmcnt(0)
    s_waitcnt lgkmcnt(0)
chain1_kernel_wo3:
    s_barrier
    s_add_u32 s46, s45, 82560
    buffer_load_dwordx4 v[24:27], v4, s[16:19], s46 offen
    buffer_load_dwordx4 v[28:31], v5, s[16:19], s46 offen
    buffer_load_dwordx4 v[32:35], v6, s[16:19], s46 offen
    buffer_load_dwordx4 v[36:39], v7, s[16:19], s46 offen
    buffer_load_dwordx4 v[40:43], v8, s[16:19], s46 offen
    buffer_load_dwordx4 v[44:47], v9, s[16:19], s46 offen
    buffer_load_dwordx4 v[48:51], v10, s[16:19], s46 offen
    buffer_load_dwordx4 v[52:55], v11, s[16:19], s46 offen
    buffer_load_dwordx4 v[56:59], v12, s[16:19], s46 offen
    buffer_load_dwordx4 v[60:63], v13, s[16:19], s46 offen
    s_waitcnt vmcnt(0)
    ds_write_b128 v14, v[24:27]
    ds_write_b128 v15, v[28:31]
    ds_write_b128 v16, v[32:35]
    ds_write_b128 v17, v[36:39]
    ds_write_b128 v18, v[40:43]
    ds_write_b128 v19, v[44:47]
    ds_write_b128 v20, v[48:51]
    ds_write_b128 v21, v[52:55]
    ds_write_b128 v22, v[56:59]
    ds_write_b128 v23, v[60:63]
    s_waitcnt lgkmcnt(0)
    s_barrier
    s_lshr_b32 s24, s3, 1
    s_cmp_eq_u32 s24, 1
    s_cbranch_scc0 chain1_kernel_wo4
    ds_read_b64_tr_b16 a[248:249], v72 offset:0
    ds_read_b64_tr_b16 a[250:251], v72 offset:1312
    ds_read_b64_tr_b16 a[252:253], v72 offset:20992
    ds_read_b64_tr_b16 a[254:255], v72 offset:22304
    ds_read_b64_tr_b16 v[120:121], v72 offset:32
    ds_read_b64_tr_b16 v[122:123], v72 offset:1344
    ds_read_b64_tr_b16 v[124:125], v72 offset:21024
    ds_read_b64_tr_b16 v[126:127], v72 offset:22336
    ds_read_b64_tr_b16 v[144:145], v72 offset:64
    ds_read_b64_tr_b16 v[146:147], v72 offset:1376
    ds_read_b64_tr_b16 v[148:149], v72 offset:21056
    ds_read_b64_tr_b16 v[150:151], v72 offset:22368
    ds_read_b64_tr_b16 v[168:169], v72 offset:96
    ds_read_b64_tr_b16 v[170:171], v72 offset:1408
    ds_read_b64_tr_b16 v[172:173], v72 offset:21088
    ds_read_b64_tr_b16 v[174:175], v72 offset:22400
    ds_read_b64_tr_b16 v[192:193], v72 offset:128
    ds_read_b64_tr_b16 v[194:195], v72 offset:1440
    ds_read_b64_tr_b16 v[196:197], v72 offset:21120
    ds_read_b64_tr_b16 v[198:199], v72 offset:22432
    ds_read_b64_tr_b16 v[216:217], v72 offset:160
    ds_read_b64_tr_b16 v[218:219], v72 offset:1472
    ds_read_b64_tr_b16 v[220:221], v72 offset:21152
    ds_read_b64_tr_b16 v[222:223], v72 offset:22464
    ds_read_b64_tr_b16 v[240:241], v72 offset:192
    ds_read_b64_tr_b16 v[242:243], v72 offset:1504
    ds_read_b64_tr_b16 v[244:245], v72 offset:21184
    ds_read_b64_tr_b16 v[246:247], v72 offset:22496
    ds_read_b64_tr_b16 v[64:65], v72 offset:224
    ds_read_b64_tr_b16 v[66:67], v72 offset:1536
    ds_read_b64_tr_b16 v[68:69], v72 offset:21216
    ds_read_b64_tr_b16 v[70:71], v72 offset:22528
    s_waitcnt lgkmcnt(0)
    ds_write_b128 v73, v[64:67] offset:2048
    ds_write_b128 v73, v[68:71] offset:3072
    s_waitcnt lgkmcnt(0)
    ds_read_b64_tr_b16 v[64:65], v72 offset:256
    ds_read_b64_tr_b16 v[66:67], v72 offset:1568
    ds_read_b64_tr_b16 v[68:69], v72 offset:21248
    ds_read_b64_tr_b16 v[70:71], v72 offset:22560
    s_waitcnt lgkmcnt(0)
    ds_write_b128 v73, v[64:67] offset:8192
    ds_write_b128 v73, v[68:71] offset:9216
    s_waitcnt lgkmcnt(0)
    ds_read_b64_tr_b16 v[64:65], v72 offset:288
    ds_read_b64_tr_b16 v[66:67], v72 offset:1600
    ds_read_b64_tr_b16 v[68:69], v72 offset:21280
    ds_read_b64_tr_b16 v[70:71], v72 offset:22592
    s_waitcnt lgkmcnt(0)
    ds_write_b128 v73, v[64:67] offset:14336
    ds_write_b128 v73, v[68:71] offset:15360
    s_waitcnt lgkmcnt(0)
    s_waitcnt lgkmcnt(0)
chain1_kernel_wo4:
    s_barrier
    s_add_u32 s46, s45, 163840
    buffer_load_dwordx4 v[24:27], v4, s[16:19], s46 offen
    buffer_load_dwordx4 v[28:31], v5, s[16:19], s46 offen
    buffer_load_dwordx4 v[32:35], v6, s[16:19], s46 offen
    buffer_load_dwordx4 v[36:39], v7, s[16:19], s46 offen
    buffer_load_dwordx4 v[40:43], v8, s[16:19], s46 offen
    buffer_load_dwordx4 v[44:47], v9, s[16:19], s46 offen
    buffer_load_dwordx4 v[48:51], v10, s[16:19], s46 offen
    buffer_load_dwordx4 v[52:55], v11, s[16:19], s46 offen
    buffer_load_dwordx4 v[56:59], v12, s[16:19], s46 offen
    buffer_load_dwordx4 v[60:63], v13, s[16:19], s46 offen
    s_waitcnt vmcnt(0)
    ds_write_b128 v14, v[24:27]
    ds_write_b128 v15, v[28:31]
    ds_write_b128 v16, v[32:35]
    ds_write_b128 v17, v[36:39]
    ds_write_b128 v18, v[40:43]
    ds_write_b128 v19, v[44:47]
    ds_write_b128 v20, v[48:51]
    ds_write_b128 v21, v[52:55]
    ds_write_b128 v22, v[56:59]
    ds_write_b128 v23, v[60:63]
    s_waitcnt lgkmcnt(0)
    s_barrier
    s_lshr_b32 s24, s3, 1
    s_cmp_eq_u32 s24, 0
    s_cbranch_scc0 chain1_kernel_wo5
    ds_read_b64_tr_b16 v[104:105], v72 offset:0
    ds_read_b64_tr_b16 v[106:107], v72 offset:1312
    ds_read_b64_tr_b16 v[108:109], v72 offset:20992
    ds_read_b64_tr_b16 v[110:111], v72 offset:22304
    ds_read_b64_tr_b16 v[128:129], v72 offset:32
    ds_read_b64_tr_b16 v[130:131], v72 offset:1344
    ds_read_b64_tr_b16 v[132:133], v72 offset:21024
    ds_read_b64_tr_b16 v[134:135], v72 offset:22336
    ds_read_b64_tr_b16 v[152:153], v72 offset:64
    ds_read_b64_tr_b16 v[154:155], v72 offset:1376
    ds_read_b64_tr_b16 v[156:157], v72 offset:21056
    ds_read_b64_tr_b16 v[158:159], v72 offset:22368
    ds_read_b64_tr_b16 v[176:177], v72 offset:96
    ds_read_b64_tr_b16 v[178:179], v72 offset:1408
    ds_read_b64_tr_b16 v[180:181], v72 offset:21088
    ds_read_b64_tr_b16 v[182:183], v72 offset:22400
    ds_read_b64_tr_b16 v[200:201], v72 offset:128
    ds_read_b64_tr_b16 v[202:203], v72 offset:1440
    ds_read_b64_tr_b16 v[204:205], v72 offset:21120
    ds_read_b64_tr_b16 v[206:207], v72 offset:22432
    ds_read_b64_tr_b16 v[224:225], v72 offset:160
    ds_read_b64_tr_b16 v[226:227], v72 offset:1472
    ds_read_b64_tr_b16 v[228:229], v72 offset:21152
    ds_read_b64_tr_b16 v[230:231], v72 offset:22464
    ds_read_b64_tr_b16 v[248:249], v72 offset:192
    ds_read_b64_tr_b16 v[250:251], v72 offset:1504
    ds_read_b64_tr_b16 v[252:253], v72 offset:21184
    ds_read_b64_tr_b16 v[254:255], v72 offset:22496
    ds_read_b64_tr_b16 v[64:65], v72 offset:224
    ds_read_b64_tr_b16 v[66:67], v72 offset:1536
    ds_read_b64_tr_b16 v[68:69], v72 offset:21216
    ds_read_b64_tr_b16 v[70:71], v72 offset:22528
    s_waitcnt lgkmcnt(0)
    ds_write_b128 v73, v[64:67] offset:4096
    ds_write_b128 v73, v[68:71] offset:5120
    s_waitcnt lgkmcnt(0)
    ds_read_b64_tr_b16 v[64:65], v72 offset:256
    ds_read_b64_tr_b16 v[66:67], v72 offset:1568
    ds_read_b64_tr_b16 v[68:69], v72 offset:21248
    ds_read_b64_tr_b16 v[70:71], v72 offset:22560
    s_waitcnt lgkmcnt(0)
    ds_write_b128 v73, v[64:67] offset:10240
    ds_write_b128 v73, v[68:71] offset:11264
    s_waitcnt lgkmcnt(0)
    ds_read_b64_tr_b16 v[64:65], v72 offset:288
    ds_read_b64_tr_b16 v[66:67], v72 offset:1600
    ds_read_b64_tr_b16 v[68:69], v72 offset:21280
    ds_read_b64_tr_b16 v[70:71], v72 offset:22592
    s_waitcnt lgkmcnt(0)
    ds_write_b128 v73, v[64:67] offset:16384
    ds_write_b128 v73, v[68:71] offset:17408
    s_waitcnt lgkmcnt(0)
    s_waitcnt lgkmcnt(0)
chain1_kernel_wo5:
    s_barrier
    s_add_u32 s46, s45, 164480
    buffer_load_dwordx4 v[24:27], v4, s[16:19], s46 offen
    buffer_load_dwordx4 v[28:31], v5, s[16:19], s46 offen
    buffer_load_dwordx4 v[32:35], v6, s[16:19], s46 offen
    buffer_load_dwordx4 v[36:39], v7, s[16:19], s46 offen
    buffer_load_dwordx4 v[40:43], v8, s[16:19], s46 offen
    buffer_load_dwordx4 v[44:47], v9, s[16:19], s46 offen
    buffer_load_dwordx4 v[48:51], v10, s[16:19], s46 offen
    buffer_load_dwordx4 v[52:55], v11, s[16:19], s46 offen
    buffer_load_dwordx4 v[56:59], v12, s[16:19], s46 offen
    buffer_load_dwordx4 v[60:63], v13, s[16:19], s46 offen
    s_waitcnt vmcnt(0)
    ds_write_b128 v14, v[24:27]
    ds_write_b128 v15, v[28:31]
    ds_write_b128 v16, v[32:35]
    ds_write_b128 v17, v[36:39]
    ds_write_b128 v18, v[40:43]
    ds_write_b128 v19, v[44:47]
    ds_write_b128 v20, v[48:51]
    ds_write_b128 v21, v[52:55]
    ds_write_b128 v22, v[56:59]
    ds_write_b128 v23, v[60:63]
    s_waitcnt lgkmcnt(0)
    s_barrier
    s_lshr_b32 s24, s3, 1
    s_cmp_eq_u32 s24, 1
    s_cbranch_scc0 chain1_kernel_wo6
    ds_read_b64_tr_b16 v[104:105], v72 offset:0
    ds_read_b64_tr_b16 v[106:107], v72 offset:1312
    ds_read_b64_tr_b16 v[108:109], v72 offset:20992
    ds_read_b64_tr_b16 v[110:111], v72 offset:22304
    ds_read_b64_tr_b16 v[128:129], v72 offset:32
    ds_read_b64_tr_b16 v[130:131], v72 offset:1344
    ds_read_b64_tr_b16 v[132:133], v72 offset:21024
    ds_read_b64_tr_b16 v[134:135], v72 offset:22336
    ds_read_b64_tr_b16 v[152:153], v72 offset:64
    ds_read_b64_tr_b16 v[154:155], v72 offset:1376
    ds_read_b64_tr_b16 v[156:157], v72 offset:21056
    ds_read_b64_tr_b16 v[158:159], v72 offset:22368
    ds_read_b64_tr_b16 v[176:177], v72 offset:96
    ds_read_b64_tr_b16 v[178:179], v72 offset:1408
    ds_read_b64_tr_b16 v[180:181], v72 offset:21088
    ds_read_b64_tr_b16 v[182:183], v72 offset:22400
    ds_read_b64_tr_b16 v[200:201], v72 offset:128
    ds_read_b64_tr_b16 v[202:203], v72 offset:1440
    ds_read_b64_tr_b16 v[204:205], v72 offset:21120
    ds_read_b64_tr_b16 v[206:207], v72 offset:22432
    ds_read_b64_tr_b16 v[224:225], v72 offset:160
    ds_read_b64_tr_b16 v[226:227], v72 offset:1472
    ds_read_b64_tr_b16 v[228:229], v72 offset:21152
    ds_read_b64_tr_b16 v[230:231], v72 offset:22464
    ds_read_b64_tr_b16 v[248:249], v72 offset:192
    ds_read_b64_tr_b16 v[250:251], v72 offset:1504
    ds_read_b64_tr_b16 v[252:253], v72 offset:21184
    ds_read_b64_tr_b16 v[254:255], v72 offset:22496
    ds_read_b64_tr_b16 v[64:65], v72 offset:224
    ds_read_b64_tr_b16 v[66:67], v72 offset:1536
    ds_read_b64_tr_b16 v[68:69], v72 offset:21216
    ds_read_b64_tr_b16 v[70:71], v72 offset:22528
    s_waitcnt lgkmcnt(0)
    ds_write_b128 v73, v[64:67] offset:4096
    ds_write_b128 v73, v[68:71] offset:5120
    s_waitcnt lgkmcnt(0)
    ds_read_b64_tr_b16 v[64:65], v72 offset:256
    ds_read_b64_tr_b16 v[66:67], v72 offset:1568
    ds_read_b64_tr_b16 v[68:69], v72 offset:21248
    ds_read_b64_tr_b16 v[70:71], v72 offset:22560
    s_waitcnt lgkmcnt(0)
    ds_write_b128 v73, v[64:67] offset:10240
    ds_write_b128 v73, v[68:71] offset:11264
    s_waitcnt lgkmcnt(0)
    ds_read_b64_tr_b16 v[64:65], v72 offset:288
    ds_read_b64_tr_b16 v[66:67], v72 offset:1600
    ds_read_b64_tr_b16 v[68:69], v72 offset:21280
    ds_read_b64_tr_b16 v[70:71], v72 offset:22592
    s_waitcnt lgkmcnt(0)
    ds_write_b128 v73, v[64:67] offset:16384
    ds_write_b128 v73, v[68:71] offset:17408
    s_waitcnt lgkmcnt(0)
    s_waitcnt lgkmcnt(0)
chain1_kernel_wo6:
    s_barrier
    v_mov_b32 v6, v73
    v_mov_b32 v4, 0x4444
    v_mov_b32 v5, 0xeeee
    v_cmp_gt_u32 vcc, 8, v2
    s_nop 1
    v_cndmask_b32 v4, v5, v4, vcc
    v_lshlrev_b32 v5, 4, v1
    s_lshl_b32 s24, s3, 10
    v_add_u32 v7, s24, v5
    s_lshl_b32 s24, s3, 9
    s_add_u32 s24, s24, 8192
    v_lshlrev_b32 v8, 3, v1
    v_add_u32 v8, s24, v8
    v_and_b32 v64, 7, v2
    v_lshlrev_b32 v9, 5, v64
    v_lshrrev_b32 v64, 3, v2
    v_lshl_add_u32 v9, v64, 4, v9
    v_and_b32 v64, 1, v3
    v_lshl_add_u32 v9, v64, 3, v9
    s_mul_i32 s24, s3, 768
    s_add_u32 s24, s24, 10240
    v_add_u32 v9, s24, v9
    v_lshrrev_b32 v65, 1, v3
    v_lshl_add_u32 v10, v65, 8, v9
    v_lshrrev_b32 v64, 2, v2
    v_lshlrev_b32 v11, 5, v64
    v_and_b32 v64, 3, v2
    v_lshl_add_u32 v11, v64, 3, v11
    v_lshl_add_u32 v11, v3, 8, v11
    v_add_u32 v11, 10240, v11
    s_mul_i32 s24, s3, 10
    s_lshl_b32 s24, s24, 13
    s_lshl_b32 s25, s44, 8
    s_add_u32 s24, s24, s25
    v_lshlrev_b32 v14, 13, v3
    v_lshl_add_u32 v14, v2, 4, v14
    v_add_u32 v14, s24, v14
    v_lshrrev_b32 v64, 1, v3
    v_lshlrev_b32 v15, 13, v64
    v_lshl_add_u32 v15, v2, 4, v15
    v_add_u32 v15, s24, v15
    v_add_u32 v15, 65536, v15
    v_and_b32 v64, 1, v3
    v_cmp_eq_u32 vcc, 0, v64
    v_mov_b32 v64, 2146435072
    s_nop 0
    v_cndmask_b32 v15, v64, v15, vcc
    v_add_u32 v64, 0, v0
    v_and_b32 v65, 7, v64
    v_mul_u32_u24 v65, 1280, v65
    v_lshrrev_b32 v66, 3, v64
    v_lshl_add_u32 v65, v66, 4, v65
    v_cmp_gt_u32 vcc, 640, v64
    v_mov_b32 v67, 2146435072
    s_nop 0
    v_cndmask_b32 v65, v67, v65, vcc
    buffer_load_dwordx4 v[68:71], v65, s[20:23], 0 offen
    v_lshlrev_b32 v64, 4, v64
    s_waitcnt vmcnt(0)
    s_and_saveexec_b64 s[30:31], vcc
    ds_write_b128 v64, v[68:71]
    s_mov_b64 exec, s[30:31]
    v_add_u32 v64, 256, v0
    v_and_b32 v65, 7, v64
    v_mul_u32_u24 v65, 1280, v65
    v_lshrrev_b32 v66, 3, v64
    v_lshl_add_u32 v65, v66, 4, v65
    v_cmp_gt_u32 vcc, 640, v64
    v_mov_b32 v67, 2146435072
    s_nop 0
    v_cndmask_b32 v65, v67, v65, vcc
    buffer_load_dwordx4 v[68:71], v65, s[20:23], 0 offen
    v_lshlrev_b32 v64, 4, v64
    s_waitcnt vmcnt(0)
    s_and_saveexec_b64 s[30:31], vcc
    ds_write_b128 v64, v[68:71]
    s_mov_b64 exec, s[30:31]
    v_add_u32 v64, 512, v0
    v_and_b32 v65, 7, v64
    v_mul_u32_u24 v65, 1280, v65
    v_lshrrev_b32 v66, 3, v64
    v_lshl_add_u32 v65, v66, 4, v65
    v_cmp_gt_u32 vcc, 640, v64
    v_mov_b32 v67, 2146435072
    s_nop 0
    v_cndmask_b32 v65, v67, v65, vcc
    buffer_load_dwordx4 v[68:71], v65, s[20:23], 0 offen
    v_lshlrev_b32 v64, 4, v64
    s_waitcnt vmcnt(0)
    s_and_saveexec_b64 s[30:31], vcc
    ds_write_b128 v64, v[68:71]
    s_mov_b64 exec, s[30:31]
    s_mov_b32 s40, 0
    s_mov_b32 s43, 117440512
    s_mov_b32 s47, 138412032
    s_waitcnt lgkmcnt(0)
    s_branch chain1_kernel_v_go2
chain1_kernel_v_step:
    s_add_u32 s48, s47, 4096
    s_mov_b32 s61, 0
chain1_kernel_v_pm:
    buffer_load_dwordx4 v[16:19], v7, s[8:11], s47 offen sc1
    buffer_load_dwordx4 v[20:23], v7, s[8:11], s48 offen sc1
    buffer_load_dwordx2 v[24:25], v8, s[8:11], s47 offen sc1
    s_waitcnt vmcnt(0)
    v_max3_u32 v26, v16, v17, v18
    v_max3_u32 v26, v26, v19, v20
    v_max3_u32 v26, v26, v21, v22
    v_max3_u32 v26, v26, v23, v24
    v_max_u32 v26, v26, v25
    v_cmp_eq_u32 vcc, -1, v26
    s_add_u32 s61, s61, 1
    s_cbranch_vccz chain1_kernel_v_pm_out
    s_cmp_ge_u32 s61, s60
    s_cbranch_scc1 chain1_kernel_v_pm_to
    s_sleep 1
    s_branch chain1_kernel_v_pm
chain1_kernel_v_pm_to:
    s_mov_b32 s60, 1
chain1_kernel_v_pm_out:
    ds_write_b128 v7, v[16:19]
    ds_write_b128 v7, v[20:23] offset:4096
    ds_write_b64 v8, v[24:25]
    s_waitcnt lgkmcnt(0)
chain1_kernel_v_go2:
    s_barrier
    ds_read_b128 v[16:19], v5 offset:0
    ds_read_b128 v[20:23], v5 offset:1024
    ds_read_b128 v[24:27], v5 offset:2048
    ds_read_b128 v[28:31], v5 offset:3072
    ds_read_b128 v[32:35], v5 offset:4096
    ds_read_b128 v[36:39], v5 offset:5120
    ds_read_b128 v[40:43], v5 offset:6144
    ds_read_b128 v[44:47], v5 offset:7168
    ds_read_b128 v[48:51], v5 offset:8192
    ds_read_b128 v[52:55], v5 offset:9216
    v_mov_b32 v56, 0
    v_mov_b32 v57, 0
    v_mov_b32 v58, 0
    v_mov_b32 v59, 0
    v_mov_b32 v60, 0
    v_mov_b32 v61, 0
    v_mov_b32 v62, 0
    v_mov_b32 v63, 0
    v_mov_b32 v64, 0
    v_mov_b32 v65, 0
    v_mov_b32 v66, 0
    v_mov_b32 v67, 0
    s_waitcnt lgkmcnt(9)
    v_smfmac_f32_16x16x64_bf16 v[56:59], v[16:19], a[0:7], v4
    v_smfmac_f32_16x16x64_bf16 v[60:63], v[16:19], a[80:87], v4
    v_smfmac_f32_16x16x64_bf16 v[64:67], v[16:19], a[160:167], v4
    s_waitcnt lgkmcnt(8)
    v_smfmac_f32_16x16x64_bf16 v[56:59], v[20:23], a[8:15], v4
    v_smfmac_f32_16x16x64_bf16 v[60:63], v[20:23], a[88:95], v4
    v_smfmac_f32_16x16x64_bf16 v[64:67], v[20:23], a[168:175], v4
    s_waitcnt lgkmcnt(7)
    v_smfmac_f32_16x16x64_bf16 v[56:59], v[24:27], a[16:23], v4
    v_smfmac_f32_16x16x64_bf16 v[60:63], v[24:27], a[96:103], v4
    v_smfmac_f32_16x16x64_bf16 v[64:67], v[24:27], a[176:183], v4
    s_waitcnt lgkmcnt(6)
    v_smfmac_f32_16x16x64_bf16 v[56:59], v[28:31], a[24:31], v4
    v_smfmac_f32_16x16x64_bf16 v[60:63], v[28:31], a[104:111], v4
    v_smfmac_f32_16x16x64_bf16 v[64:67], v[28:31], a[184:191], v4
    s_waitcnt lgkmcnt(5)
    v_smfmac_f32_16x16x64_bf16 v[56:59], v[32:35], a[32:39], v4
    v_smfmac_f32_16x16x64_bf16 v[60:63], v[32:35], a[112:119], v4
    v_smfmac_f32_16x16x64_bf16 v[64:67], v[32:35], a[192:199], v4
    s_waitcnt lgkmcnt(4)
    v_smfmac_f32_16x16x64_bf16 v[56:59], v[36:39], a[40:47], v4
    v_smfmac_f32_16x16x64_bf16 v[60:63], v[36:39], a[120:127], v4
    v_smfmac_f32_16x16x64_bf16 v[64:67], v[36:39], a[200:207], v4
    s_waitcnt lgkmcnt(3)
    v_smfmac_f32_16x16x64_bf16 v[56:59], v[40:43], a[48:55], v4
    v_smfmac_f32_16x16x64_bf16 v[60:63], v[40:43], a[128:135], v4
    v_smfmac_f32_16x16x64_bf16 v[64:67], v[40:43], a[208:215], v4
    s_waitcnt lgkmcnt(2)
    v_smfmac_f32_16x16x64_bf16 v[56:59], v[44:47], a[56:63], v4
    v_smfmac_f32_16x16x64_bf16 v[60:63], v[44:47], a[136:143], v4
    v_smfmac_f32_16x16x64_bf16 v[64:67], v[44:47], a[216:223], v4
    s_waitcnt lgkmcnt(1)
    v_smfmac_f32_16x16x64_bf16 v[56:59], v[48:51], a[64:71], v4
    v_smfmac_f32_16x16x64_bf16 v[60:63], v[48:51], a[144:151], v4
    v_smfmac_f32_16x16x64_bf16 v[64:67], v[48:51], a[224:231], v4
    s_waitcnt lgkmcnt(0)
    v_smfmac_f32_16x16x64_bf16 v[56:59], v[52:55], a[72:79], v4
    v_smfmac_f32_16x16x64_bf16 v[60:63], v[52:55], a[152:159], v4
    v_smfmac_f32_16x16x64_bf16 v[64:67], v[52:55], a[232:239], v4
    ds_read_b128 v[80:83], v6 offset:0
    ds_read_b128 v[84:87], v6 offset:1024
    ds_read_b128 v[88:91], v6 offset:2048
    ds_read_b128 v[92:95], v6 offset:3072
    ds_read_b128 v[96:99], v6 offset:4096
    ds_read_b128 v[100:103], v6 offset:5120
    v_mov_b32 v16, 0
    v_mov_b32 v17, 0
    v_mov_b32 v18, 0
    v_mov_b32 v19, 0
    v_mov_b32 v20, 0
    v_mov_b32 v21, 0
    v_mov_b32 v22, 0
    v_mov_b32 v23, 0
    v_mov_b32 v24, 0
    v_mov_b32 v25, 0
    v_mov_b32 v26, 0
    v_mov_b32 v27, 0
    v_mov_b32 v28, 0
    v_mov_b32 v29, 0
    v_mov_b32 v30, 0
    v_mov_b32 v31, 0
    v_mov_b32 v32, 0
    v_mov_b32 v33, 0
    v_mov_b32 v34, 0
    v_mov_b32 v35, 0
    v_mov_b32 v36, 0
    v_mov_b32 v37, 0
    v_mov_b32 v38, 0
    v_mov_b32 v39, 0
    v_mov_b32 v40, 0
    v_mov_b32 v41, 0
    v_mov_b32 v42, 0
    v_mov_b32 v43, 0
    v_mov_b32 v44, 0
    v_mov_b32 v45, 0
    v_mov_b32 v46, 0
    v_mov_b32 v47, 0
    v_mov_b32 v48, 0
    v_mov_b32 v49, 0
    v_mov_b32 v50, 0
    v_mov_b32 v51, 0
    v_mov_b32 v52, 0
    v_mov_b32 v53, 0
    v_mov_b32 v54, 0
    v_mov_b32 v55, 0
    v_permlane32_swap_b32 v56, v60
    v_permlane32_swap_b32 v57, v61
    v_permlane32_swap_b32 v58, v62
    v_permlane32_swap_b32 v59, v63
    v_add_f32 v56, v56, v60
    v_add_f32 v57, v57, v61
    v_add_f32 v58, v58, v62
    v_add_f32 v59, v59, v63
    v_cvt_pk_bf16_f32 v68, v56, v57
    v_cvt_pk_bf16_f32 v69, v58, v59
    v_mov_b32 v60, v64
    v_mov_b32 v61, v65
    v_mov_b32 v62, v66
    v_mov_b32 v63, v67
    v_permlane32_swap_b32 v64, v60
    v_permlane32_swap_b32 v65, v61
    v_permlane32_swap_b32 v66, v62
    v_permlane32_swap_b32 v67, v63
    v_add_f32 v64, v64, v60
    v_add_f32 v65, v65, v61
    v_add_f32 v66, v66, v62
    v_add_f32 v67, v67, v63
    v_cvt_pk_bf16_f32 v70, v64, v65
    v_cvt_pk_bf16_f32 v71, v66, v67
    ds_write_b64 v10, v[68:69]
    ds_write_b64 v9, v[70:71] offset:512
    s_waitcnt lgkmcnt(0)
    s_barrier
    ds_read_b64_tr_b16 v[68:69], v11 offset:0
    ds_read_b64_tr_b16 v[70:71], v11 offset:128
    ds_read_b64_tr_b16 v[72:73], v11 offset:1024
    ds_read_b64_tr_b16 v[74:75], v11 offset:1152
    ds_read_b64_tr_b16 v[76:77], v11 offset:2048
    ds_read_b64_tr_b16 v[78:79], v11 offset:2176
    s_waitcnt lgkmcnt(4)
    v_smfmac_f32_16x16x64_bf16 v[16:19], v[68:71], a[240:247], v4
    v_smfmac_f32_16x16x64_bf16 v[20:23], v[68:71], v[112:119], v4
    v_smfmac_f32_16x16x64_bf16 v[24:27], v[68:71], v[136:143], v4
    v_smfmac_f32_16x16x64_bf16 v[28:31], v[68:71], v[160:167], v4
    s_waitcnt lgkmcnt(2)
    v_smfmac_f32_16x16x64_bf16 v[16:19], v[72:75], a[248:255], v4
    v_smfmac_f32_16x16x64_bf16 v[20:23], v[72:75], v[120:127], v4
    v_smfmac_f32_16x16x64_bf16 v[24:27], v[72:75], v[144:151], v4
    v_smfmac_f32_16x16x64_bf16 v[28:31], v[72:75], v[168:175], v4
    s_waitcnt lgkmcnt(0)
    v_smfmac_f32_16x16x64_bf16 v[16:19], v[76:79], v[104:111], v4
    v_smfmac_f32_16x16x64_bf16 v[20:23], v[76:79], v[128:135], v4
    v_smfmac_f32_16x16x64_bf16 v[24:27], v[76:79], v[152:159], v4
    v_smfmac_f32_16x16x64_bf16 v[28:31], v[76:79], v[176:183], v4
    v_smfmac_f32_16x16x64_bf16 v[32:35], v[68:71], v[184:191], v4
    v_smfmac_f32_16x16x64_bf16 v[36:39], v[68:71], v[208:215], v4
    v_smfmac_f32_16x16x64_bf16 v[40:43], v[68:71], v[232:239], v4
    v_smfmac_f32_16x16x64_bf16 v[44:47], v[68:71], v[80:87], v4
    ds_read_b128 v[80:83], v6 offset:6144
    ds_read_b128 v[84:87], v6 offset:7168
    v_smfmac_f32_16x16x64_bf16 v[32:35], v[72:75], v[192:199], v4
    v_smfmac_f32_16x16x64_bf16 v[36:39], v[72:75], v[216:223], v4
    v_smfmac_f32_16x16x64_bf16 v[40:43], v[72:75], v[240:247], v4
    v_smfmac_f32_16x16x64_bf16 v[44:47], v[72:75], v[88:95], v4
    ds_read_b128 v[88:91], v6 offset:8192
    ds_read_b128 v[92:95], v6 offset:9216
    v_smfmac_f32_16x16x64_bf16 v[32:35], v[76:79], v[200:207], v4
    v_smfmac_f32_16x16x64_bf16 v[36:39], v[76:79], v[224:231], v4
    v_smfmac_f32_16x16x64_bf16 v[40:43], v[76:79], v[248:255], v4
    v_smfmac_f32_16x16x64_bf16 v[44:47], v[76:79], v[96:103], v4
    ds_read_b128 v[96:99], v6 offset:10240
    ds_read_b128 v[100:103], v6 offset:11264
    v_permlane32_swap_b32 v16, v24
    v_permlane32_swap_b32 v17, v25
    v_permlane32_swap_b32 v18, v26
    v_permlane32_swap_b32 v19, v27
    v_add_f32 v16, v16, v24
    v_add_f32 v17, v17, v25
    v_add_f32 v18, v18, v26
    v_add_f32 v19, v19, v27
    v_permlane32_swap_b32 v20, v28
    v_permlane32_swap_b32 v21, v29
    v_permlane32_swap_b32 v22, v30
    v_permlane32_swap_b32 v23, v31
    v_add_f32 v20, v20, v28
    v_add_f32 v21, v21, v29
    v_add_f32 v22, v22, v30
    v_add_f32 v23, v23, v31
    v_cvt_pk_bf16_f32 v56, v16, v17
    v_cvt_pk_bf16_f32 v57, v18, v19
    v_cvt_pk_bf16_f32 v58, v20, v21
    v_cvt_pk_bf16_f32 v59, v22, v23
    s_nop 0
    v_permlane16_swap_b32 v56, v58
    v_permlane16_swap_b32 v57, v59
    v_min_u32 v56, -2, v56
    v_min_u32 v57, -2, v57
    v_min_u32 v58, -2, v58
    v_min_u32 v59, -2, v59
    buffer_store_dwordx4 v[56:59], v14, s[8:11], s43 offen sc1
    s_waitcnt lgkmcnt(4)
    v_smfmac_f32_16x16x64_bf16 v[48:51], v[68:71], v[80:87], v4
    ds_read_b128 v[80:83], v6 offset:12288
    ds_read_b128 v[84:87], v6 offset:13312
    s_waitcnt lgkmcnt(4)
    v_smfmac_f32_16x16x64_bf16 v[48:51], v[72:75], v[88:95], v4
    ds_read_b128 v[88:91], v6 offset:14336
    ds_read_b128 v[92:95], v6 offset:15360
    s_waitcnt lgkmcnt(4)
    v_smfmac_f32_16x16x64_bf16 v[48:51], v[76:79], v[96:103], v4
    ds_read_b128 v[96:99], v6 offset:16384
    ds_read_b128 v[100:103], v6 offset:17408
    v_permlane32_swap_b32 v32, v40
    v_permlane32_swap_b32 v33, v41
    v_permlane32_swap_b32 v34, v42
    v_permlane32_swap_b32 v35, v43
    v_add_f32 v32, v32, v40
    v_add_f32 v33, v33, v41
    v_add_f32 v34, v34, v42
    v_add_f32 v35, v35, v43
    v_permlane32_swap_b32 v36, v44
    v_permlane32_swap_b32 v37, v45
    v_permlane32_swap_b32 v38, v46
    v_permlane32_swap_b32 v39, v47
    v_add_f32 v36, v36, v44
    v_add_f32 v37, v37, v45
    v_add_f32 v38, v38, v46
    v_add_f32 v39, v39, v47
    v_cvt_pk_bf16_f32 v60, v32, v33
    v_cvt_pk_bf16_f32 v61, v34, v35
    v_cvt_pk_bf16_f32 v62, v36, v37
    v_cvt_pk_bf16_f32 v63, v38, v39
    s_nop 0
    v_permlane16_swap_b32 v60, v62
    v_permlane16_swap_b32 v61, v63
    v_min_u32 v60, -2, v60
    v_min_u32 v61, -2, v61
    v_min_u32 v62, -2, v62
    v_min_u32 v63, -2, v63
    s_add_u32 s49, s43, 32768
    buffer_store_dwordx4 v[60:63], v14, s[8:11], s49 offen sc1
    s_waitcnt lgkmcnt(4)
    v_smfmac_f32_16x16x64_bf16 v[52:55], v[68:71], v[80:87], v4
    s_waitcnt lgkmcnt(2)
    v_smfmac_f32_16x16x64_bf16 v[52:55], v[72:75], v[88:95], v4
    s_waitcnt lgkmcnt(0)
    v_smfmac_f32_16x16x64_bf16 v[52:55], v[76:79], v[96:103], v4
    s_nop 11
    v_permlane32_swap_b32 v48, v52
    v_permlane32_swap_b32 v49, v53
    v_permlane32_swap_b32 v50, v54
    v_permlane32_swap_b32 v51, v55
    v_add_f32 v48, v48, v52
    v_add_f32 v49, v49, v53
    v_add_f32 v50, v50, v54
    v_add_f32 v51, v51, v55
    v_cvt_pk_bf16_f32 v64, v48, v49
    v_cvt_pk_bf16_f32 v65, v50, v51
    v_mov_b32 v66, v64
    v_mov_b32 v67, v65
    s_nop 0
    v_permlane16_swap_b32 v64, v66
    v_permlane16_swap_b32 v65, v67
    v_min_u32 v64, -2, v64
    v_min_u32 v65, -2, v65
    v_min_u32 v66, -2, v66
    v_min_u32 v67, -2, v67
    buffer_store_dwordx4 v[64:67], v15, s[8:11], s43 offen sc1
    s_add_u32 s40, s40, 1
    s_add_u32 s43, s43, 327680
    s_add_u32 s47, s47, 40960
    s_cmp_lt_u32 s40, 64
    s_cbranch_scc1 chain1_kernel_v_step
    s_branch chain1_kernel_end
chain1_kernel_roleR:
    s_sub_u32 s44, s2, 64
    v_lshlrev_b32 v5, 4, v1
    s_lshl_b32 s24, s44, 15
    s_lshl_b32 s25, s3, 13
    s_add_u32 s24, s24, s25
    v_add_u32 v6, s24, v5
    v_add_u32 v7, 4096, v6
    s_lshl_b32 s24, s3, 12
    v_add_u32 v8, s24, v5
    s_lshl_b32 s24, s3, 10
    s_add_u32 s24, s24, 16384
    v_add_u32 v9, s24, v5
    s_lshl_b32 s24, s44, 13
    s_lshl_b32 s25, s3, 11
    s_add_u32 s24, s24, s25
    v_add_u32 v10, s24, v5
    v_and_b32 v204, 7, v2
    v_mul_u32_u24 v11, 80, v204
    v_lshl_add_u32 v11, v3, 4, v11
    s_mul_i32 s24, s3, 640
    v_add_u32 v11, s24, v11
    v_add_u32 v204, 8192, v5
    v_cmp_gt_u32 vcc, 8, v2
    s_nop 1
    v_cndmask_b32 v11, v204, v11, vcc
    v_and_b32 v204, 7, v2
    v_mul_u32_u24 v12, 80, v204
    v_lshrrev_b32 v204, 3, v2
    v_lshl_add_u32 v12, v204, 5, v12
    v_mul_u32_u24 v13, 10240, v3
    v_lshl_add_u32 v13, v2, 4, v13
    s_lshl_b32 s24, s44, 8
    v_add_u32 v13, s24, v13
    v_mov_b32 v204, 2146435072
    v_cmp_gt_u32 vcc, 1, v3
    s_nop 1
    v_cndmask_b32 v13, v204, v13, vcc
    v_cmp_le_u32 s[50:51], 8, v2
    s_lshl_b32 s24, s3, 14
    v_add_u32 v205, s24, v5
    v_add_u32 v212, 0, v205
    v_add_u32 v213, 4096, v205
    v_add_u32 v214, 8192, v205
    v_add_u32 v215, 12288, v205
    s_lshl_b32 s24, s3, 12
    s_add_u32 s24, s24, 65536
    v_add_u32 v216, s24, v5
    s_lshl_b32 s24, s3, 11
    s_add_u32 s24, s24, 16384
    v_add_u32 v217, s24, v5
    s_lshl_b32 s24, s3, 10
    s_add_u32 s24, s24, 16384
    v_add_u32 v218, s24, v5
    s_lshl_b32 s24, s3, 4
    v_add_u32 v219, s24, v2
    v_mul_u32_u24 v219, 1280, v219
    v_lshl_add_u32 v219, v3, 3, v219
    s_lshl_b32 s24, s44, 5
    v_add_u32 v219, s24, v219
    s_add_u32 s12, s4, 4194304
    s_addc_u32 s13, s5, 0
    s_mov_b32 s14, 2621440
    s_mov_b32 s15, 0x00020000
    s_add_u32 s16, s4, 4194304
    s_addc_u32 s17, s5, 0
    s_mov_b32 s18, 2621440
    s_mov_b32 s19, 0x00020000
    s_mov_b32 s40, 0
    s_mov_b32 s41, 184549376
    s_mov_b32 s43, 141074432
    s_mov_b32 s42, 117440512
    s_mov_b32 s45, 146317312
    s_mov_b32 s46, 0
    s_mov_b32 s47, 138452992
    buffer_load_dwordx4 v[48:51], v6, s[8:11], s41 offen offset:0
    buffer_load_dwordx4 v[52:55], v6, s[8:11], s41 offen offset:1024
    buffer_load_dwordx4 v[56:59], v6, s[8:11], s41 offen offset:2048
    buffer_load_dwordx4 v[60:63], v6, s[8:11], s41 offen offset:3072
    buffer_load_dwordx4 v[64:67], v7, s[8:11], s41 offen offset:0
    buffer_load_dwordx4 v[68:71], v7, s[8:11], s41 offen offset:1024
    buffer_load_dwordx4 v[72:75], v7, s[8:11], s41 offen offset:2048
    buffer_load_dwordx4 v[76:79], v7, s[8:11], s41 offen offset:3072
    s_add_u32 s41, s41, 1310720
    s_waitcnt vmcnt(0)
chain1_kernel_r_step:
    v_mov_b32 v16, v48
    v_mov_b32 v17, v49
    v_mov_b32 v18, v50
    v_mov_b32 v19, v51
    v_mov_b32 v20, v52
    v_mov_b32 v21, v53
    v_mov_b32 v22, v54
    v_mov_b32 v23, v55
    v_mov_b32 v24, v56
    v_mov_b32 v25, v57
    v_mov_b32 v26, v58
    v_mov_b32 v27, v59
    v_mov_b32 v28, v60
    v_mov_b32 v29, v61
    v_mov_b32 v30, v62
    v_mov_b32 v31, v63
    v_mov_b32 v32, v64
    v_mov_b32 v33, v65
    v_mov_b32 v34, v66
    v_mov_b32 v35, v67
    v_mov_b32 v36, v68
    v_mov_b32 v37, v69
    v_mov_b32 v38, v70
    v_mov_b32 v39, v71
    v_mov_b32 v40, v72
    v_mov_b32 v41, v73
    v_mov_b32 v42, v74
    v_mov_b32 v43, v75
    v_mov_b32 v44, v76
    v_mov_b32 v45, v77
    v_mov_b32 v46, v78
    v_mov_b32 v47, v79
    s_mov_b32 s61, 0
chain1_kernel_r_p:
    buffer_load_dwordx4 v[80:83], v8, s[8:11], s43 offen offset:0 sc1
    buffer_load_dwordx4 v[84:87], v8, s[8:11], s43 offen offset:1024 sc1
    buffer_load_dwordx4 v[88:91], v8, s[8:11], s43 offen offset:2048 sc1
    buffer_load_dwordx4 v[92:95], v8, s[8:11], s43 offen offset:3072 sc1
    buffer_load_dwordx4 v[96:99], v9, s[8:11], s43 offen sc1
    buffer_load_dwordx4 v[100:103], v10, s[8:11], s42 offen offset:0 sc1
    buffer_load_dwordx4 v[104:107], v10, s[8:11], s42 offen offset:1024 sc1
    s_waitcnt vmcnt(0)
    v_max3_u32 v204, v80, v81, v82
    v_max3_u32 v204, v204, v83, v84
    v_max3_u32 v204, v204, v85, v86
    v_max3_u32 v204, v204, v87, v88
    v_max3_u32 v204, v204, v89, v90
    v_max3_u32 v204, v204, v91, v92
    v_max3_u32 v204, v204, v93, v94
    v_max3_u32 v204, v204, v95, v96
    v_max3_u32 v204, v204, v97, v98
    v_max3_u32 v204, v204, v99, v100
    v_max3_u32 v204, v204, v101, v102
    v_max3_u32 v204, v204, v103, v104
    v_max3_u32 v204, v204, v105, v106
    v_max_u32 v204, v204, v107
    v_cmp_eq_u32 vcc, -1, v204
    s_add_u32 s61, s61, 1
    s_cbranch_vccz chain1_kernel_r_p_out
    s_cmp_ge_u32 s61, s60
    s_cbranch_scc1 chain1_kernel_r_p_to
    s_sleep 1
    s_branch chain1_kernel_r_p
chain1_kernel_r_p_to:
    s_mov_b32 s60, 1
chain1_kernel_r_p_out:
    v_mfma_f32_16x16x32_bf16 v[108:111], v[100:103], v[96:99], 0
    v_mfma_f32_16x16x32_bf16 v[112:115], v[104:107], v[96:99], 0
    v_mfma_f32_16x16x32_bf16 v[108:111], v[16:19], v[80:83], v[108:111]
    v_mfma_f32_16x16x32_bf16 v[112:115], v[20:23], v[80:83], v[112:115]
    v_mfma_f32_16x16x32_bf16 v[108:111], v[24:27], v[84:87], v[108:111]
    v_mfma_f32_16x16x32_bf16 v[112:115], v[28:31], v[84:87], v[112:115]
    v_mfma_f32_16x16x32_bf16 v[108:111], v[32:35], v[88:91], v[108:111]
    v_mfma_f32_16x16x32_bf16 v[112:115], v[36:39], v[88:91], v[112:115]
    v_mfma_f32_16x16x32_bf16 v[108:111], v[40:43], v[92:95], v[108:111]
    v_mfma_f32_16x16x32_bf16 v[112:115], v[44:47], v[92:95], v[112:115]
    s_and_b32 s24, s40, 1
    s_mul_i32 s24, s24, 2560
    v_add_u32 v14, s24, v11
    v_add_u32 v15, s24, v12
    s_nop 3
    v_cndmask_b32 v108, v108, v112, s[50:51]
    v_cndmask_b32 v109, v109, v113, s[50:51]
    v_cndmask_b32 v110, v110, v114, s[50:51]
    v_cndmask_b32 v111, v111, v115, s[50:51]
    v_add_f32 v108, v108, v108 row_ror:8 row_mask:0xf bank_mask:0xf
    v_add_f32 v109, v109, v109 row_ror:8 row_mask:0xf bank_mask:0xf
    v_add_f32 v110, v110, v110 row_ror:8 row_mask:0xf bank_mask:0xf
    v_add_f32 v111, v111, v111 row_ror:8 row_mask:0xf bank_mask:0xf
    ds_write_b128 v14, v[108:111]
    s_waitcnt lgkmcnt(0)
    s_barrier
    s_cmp_eq_u32 s3, 0
    s_cbranch_scc0 chain1_kernel_np7
    ds_read_b128 v[220:223], v15 offset:0
    ds_read_b128 v[224:227], v15 offset:16
    ds_read_b128 v[228:231], v15 offset:640
    ds_read_b128 v[232:235], v15 offset:656
    ds_read_b128 v[236:239], v15 offset:1280
    ds_read_b128 v[240:243], v15 offset:1296
    ds_read_b128 v[244:247], v15 offset:1920
    ds_read_b128 v[248:251], v15 offset:1936
    s_waitcnt lgkmcnt(4)
    v_pk_add_f32 v[220:221], v[220:221], v[228:229]
    v_pk_add_f32 v[222:223], v[222:223], v[230:231]
    v_pk_add_f32 v[224:225], v[224:225], v[232:233]
    v_pk_add_f32 v[226:227], v[226:227], v[234:235]
    s_waitcnt lgkmcnt(0)
    v_pk_add_f32 v[236:237], v[236:237], v[244:245]
    v_pk_add_f32 v[238:239], v[238:239], v[246:247]
    v_pk_add_f32 v[240:241], v[240:241], v[248:249]
    v_pk_add_f32 v[242:243], v[242:243], v[250:251]
    v_pk_add_f32 v[220:221], v[220:221], v[236:237]
    v_pk_add_f32 v[222:223], v[222:223], v[238:239]
    v_pk_add_f32 v[224:225], v[224:225], v[240:241]
    v_pk_add_f32 v[226:227], v[226:227], v[242:243]
    v_cvt_pk_bf16_f32 v228, v220, v221
    v_cvt_pk_bf16_f32 v229, v222, v223
    v_cvt_pk_bf16_f32 v230, v224, v225
    v_cvt_pk_bf16_f32 v231, v226, v227
    v_min_u32 v228, -2, v228
    v_min_u32 v229, -2, v229
    v_min_u32 v230, -2, v230
    v_min_u32 v231, -2, v231
    buffer_store_dwordx4 v[228:231], v13, s[8:11], s47 offen sc1
chain1_kernel_np7:
    buffer_load_dwordx4 v[48:51], v6, s[8:11], s41 offen offset:0
    buffer_load_dwordx4 v[52:55], v6, s[8:11], s41 offen offset:1024
    buffer_load_dwordx4 v[56:59], v6, s[8:11], s41 offen offset:2048
    buffer_load_dwordx4 v[60:63], v6, s[8:11], s41 offen offset:3072
    buffer_load_dwordx4 v[64:67], v7, s[8:11], s41 offen offset:0
    buffer_load_dwordx4 v[68:71], v7, s[8:11], s41 offen offset:1024
    buffer_load_dwordx4 v[72:75], v7, s[8:11], s41 offen offset:2048
    buffer_load_dwordx4 v[76:79], v7, s[8:11], s41 offen offset:3072
    s_add_u32 s41, s41, 1310720
    buffer_load_dwordx2 v[206:207], v219, s[16:19], s46 offen
    s_mov_b32 s61, 0
chain1_kernel_r_x:
    buffer_load_dwordx4 v[116:119], v212, s[8:11], s45 offen offset:0 sc1
    buffer_load_dwordx4 v[120:123], v212, s[8:11], s45 offen offset:1024 sc1
    buffer_load_dwordx4 v[124:127], v212, s[8:11], s45 offen offset:2048 sc1
    buffer_load_dwordx4 v[128:131], v212, s[8:11], s45 offen offset:3072 sc1
    buffer_load_dwordx4 v[132:135], v213, s[8:11], s45 offen offset:0 sc1
    buffer_load_dwordx4 v[136:139], v213, s[8:11], s45 offen offset:1024 sc1
    buffer_load_dwordx4 v[140:143], v213, s[8:11], s45 offen offset:2048 sc1
    buffer_load_dwordx4 v[144:147], v213, s[8:11], s45 offen offset:3072 sc1
    buffer_load_dwordx4 v[148:151], v214, s[8:11], s45 offen offset:0 sc1
    buffer_load_dwordx4 v[152:155], v214, s[8:11], s45 offen offset:1024 sc1
    buffer_load_dwordx4 v[156:159], v214, s[8:11], s45 offen offset:2048 sc1
    buffer_load_dwordx4 v[160:163], v214, s[8:11], s45 offen offset:3072 sc1
    buffer_load_dwordx4 v[164:167], v215, s[8:11], s45 offen offset:0 sc1
    buffer_load_dwordx4 v[168:171], v215, s[8:11], s45 offen offset:1024 sc1
    buffer_load_dwordx4 v[172:175], v215, s[8:11], s45 offen offset:2048 sc1
    buffer_load_dwordx4 v[176:179], v215, s[8:11], s45 offen offset:3072 sc1
    buffer_load_dwordx4 v[180:183], v216, s[8:11], s45 offen offset:0 sc1
    buffer_load_dwordx4 v[184:187], v216, s[8:11], s45 offen offset:1024 sc1
    buffer_load_dwordx4 v[188:191], v216, s[8:11], s45 offen offset:2048 sc1
    buffer_load_dwordx4 v[192:195], v216, s[8:11], s45 offen offset:3072 sc1
    s_waitcnt vmcnt(0)
    v_max3_u32 v204, v116, v117, v118
    v_max3_u32 v204, v204, v119, v120
    v_max3_u32 v204, v204, v121, v122
    v_max3_u32 v204, v204, v123, v124
    v_max3_u32 v204, v204, v125, v126
    v_max3_u32 v204, v204, v127, v128
    v_max3_u32 v204, v204, v129, v130
    v_max3_u32 v204, v204, v131, v132
    v_max3_u32 v204, v204, v133, v134
    v_max3_u32 v204, v204, v135, v136
    v_max3_u32 v204, v204, v137, v138
    v_max3_u32 v204, v204, v139, v140
    v_max3_u32 v204, v204, v141, v142
    v_max3_u32 v204, v204, v143, v144
    v_max3_u32 v204, v204, v145, v146
    v_max3_u32 v204, v204, v147, v148
    v_max3_u32 v204, v204, v149, v150
    v_max3_u32 v204, v204, v151, v152
    v_max3_u32 v204, v204, v153, v154
    v_max3_u32 v204, v204, v155, v156
    v_max3_u32 v204, v204, v157, v158
    v_max3_u32 v204, v204, v159, v160
    v_max3_u32 v204, v204, v161, v162
    v_max3_u32 v204, v204, v163, v164
    v_max3_u32 v204, v204, v165, v166
    v_max3_u32 v204, v204, v167, v168
    v_max3_u32 v204, v204, v169, v170
    v_max3_u32 v204, v204, v171, v172
    v_max3_u32 v204, v204, v173, v174
    v_max3_u32 v204, v204, v175, v176
    v_max3_u32 v204, v204, v177, v178
    v_max3_u32 v204, v204, v179, v180
    v_max3_u32 v204, v204, v181, v182
    v_max3_u32 v204, v204, v183, v184
    v_max3_u32 v204, v204, v185, v186
    v_max3_u32 v204, v204, v187, v188
    v_max3_u32 v204, v204, v189, v190
    v_max3_u32 v204, v204, v191, v192
    v_max3_u32 v204, v204, v193, v194
    v_max_u32 v204, v204, v195
    v_cmp_eq_u32 vcc, -1, v204
    s_add_u32 s61, s61, 1
    s_cbranch_vccz chain1_kernel_r_x_out
    s_cmp_ge_u32 s61, s60
    s_cbranch_scc1 chain1_kernel_r_x_to
    s_sleep 2
    s_branch chain1_kernel_r_x
chain1_kernel_r_x_to:
    s_mov_b32 s60, 1
chain1_kernel_r_x_out:
    v_mfma_f32_16x16x32_bf16 v[196:199], v[100:103], v[180:183], 0
    v_mfma_f32_16x16x32_bf16 v[200:203], v[100:103], v[184:187], 0
    v_mfma_f32_16x16x32_bf16 v[196:199], v[104:107], v[188:191], v[196:199]
    v_mfma_f32_16x16x32_bf16 v[200:203], v[104:107], v[192:195], v[200:203]
    v_mfma_f32_16x16x32_bf16 v[196:199], v[16:19], v[116:119], v[196:199]
    v_mfma_f32_16x16x32_bf16 v[200:203], v[16:19], v[120:123], v[200:203]
    v_mfma_f32_16x16x32_bf16 v[196:199], v[20:23], v[124:127], v[196:199]
    v_mfma_f32_16x16x32_bf16 v[200:203], v[20:23], v[128:131], v[200:203]
    v_mfma_f32_16x16x32_bf16 v[196:199], v[24:27], v[132:135], v[196:199]
    v_mfma_f32_16x16x32_bf16 v[200:203], v[24:27], v[136:139], v[200:203]
    v_mfma_f32_16x16x32_bf16 v[196:199], v[28:31], v[140:143], v[196:199]
    v_mfma_f32_16x16x32_bf16 v[200:203], v[28:31], v[144:147], v[200:203]
    v_mfma_f32_16x16x32_bf16 v[196:199], v[32:35], v[148:151], v[196:199]
    v_mfma_f32_16x16x32_bf16 v[200:203], v[32:35], v[152:155], v[200:203]
    v_mfma_f32_16x16x32_bf16 v[196:199], v[36:39], v[156:159], v[196:199]
    v_mfma_f32_16x16x32_bf16 v[200:203], v[36:39], v[160:163], v[200:203]
    v_mfma_f32_16x16x32_bf16 v[196:199], v[40:43], v[164:167], v[196:199]
    v_mfma_f32_16x16x32_bf16 v[200:203], v[40:43], v[168:171], v[200:203]
    v_mfma_f32_16x16x32_bf16 v[196:199], v[44:47], v[172:175], v[196:199]
    v_mfma_f32_16x16x32_bf16 v[200:203], v[44:47], v[176:179], v[200:203]
    s_nop 6
    ds_write_b128 v217, v[196:199] offset:0
    ds_write_b128 v217, v[200:203] offset:1024
    s_waitcnt lgkmcnt(0)
    s_barrier
    s_cmp_lt_u32 s3, 2
    s_cbranch_scc0 chain1_kernel_no8
    ds_read_b128 v[220:223], v218 offset:0
    ds_read_b128 v[224:227], v218 offset:2048
    ds_read_b128 v[228:231], v218 offset:4096
    ds_read_b128 v[232:235], v218 offset:6144
    s_waitcnt lgkmcnt(0)
    v_pk_add_f32 v[220:221], v[220:221], v[224:225]
    v_pk_add_f32 v[228:229], v[228:229], v[232:233]
    v_pk_add_f32 v[222:223], v[222:223], v[226:227]
    v_pk_add_f32 v[230:231], v[230:231], v[234:235]
    v_pk_add_f32 v[220:221], v[220:221], v[228:229]
    v_pk_add_f32 v[222:223], v[222:223], v[230:231]
    v_cvt_pk_bf16_f32 v224, v220, v221
    v_cvt_pk_bf16_f32 v225, v222, v223
    v_lshlrev_b32 v220, 16, v224
    v_and_b32 v221, 0xffff0000, v224
    v_lshlrev_b32 v226, 16, v206
    v_and_b32 v227, 0xffff0000, v206
    v_add_f32 v220, v220, v226
    v_add_f32 v221, v221, v227
    v_lshlrev_b32 v222, 16, v225
    v_and_b32 v223, 0xffff0000, v225
    v_lshlrev_b32 v226, 16, v207
    v_and_b32 v227, 0xffff0000, v207
    v_add_f32 v222, v222, v226
    v_add_f32 v223, v223, v227
    v_cvt_pk_bf16_f32 v224, v220, v221
    v_cvt_pk_bf16_f32 v225, v222, v223
    buffer_store_dwordx2 v[224:225], v219, s[12:15], s46 offen
chain1_kernel_no8:
    s_add_u32 s40, s40, 1
    s_add_u32 s42, s42, 327680
    s_add_u32 s43, s43, 81920
    s_add_u32 s45, s45, 81920
    s_add_u32 s46, s46, 40960
    s_add_u32 s47, s47, 40960
    s_cmp_lt_u32 s40, 64
    s_cbranch_scc1 chain1_kernel_r_step
    s_branch chain1_kernel_end
chain1_kernel_end:
    s_endpgm
.section .rodata,"a"
.p2align 6
.amdhsa_kernel chain1_kernel
  .amdhsa_next_free_vgpr 512
  .amdhsa_next_free_sgpr 100
  .amdhsa_accum_offset 256
  .amdhsa_group_segment_fixed_size 0
  .amdhsa_kernarg_size 104
  .amdhsa_user_sgpr_count 2
  .amdhsa_user_sgpr_kernarg_segment_ptr 1
  .amdhsa_system_sgpr_workgroup_id_x 1
.end_amdhsa_kernel
.text
.globl ln_a2_kernel
.p2align 8
.type ln_a2_kernel,@function
ln_a2_kernel:
    v_lshrrev_b32 v1, 6, v0
    v_and_b32 v2, 63, v0
    s_nop 0
    v_readfirstlane_b32 s3, v1
    s_lshl_b32 s4, s2, 2
    s_add_u32 s4, s4, s3
    s_cmp_ge_u32 s4, 2048
    s_cbranch_scc1 ln_a2_kernel_end
    s_load_dwordx2 s[6:7], s[0:1], 96
    s_load_dwordx2 s[12:13], s[0:1], 96
    s_waitcnt lgkmcnt(0)
    s_add_u32 s8, s6, 4194304
    s_addc_u32 s9, s7, 0
    s_mov_b32 s10, 2621440
    s_mov_b32 s11, 0x00020000
    s_mov_b32 s16, s12
    s_mov_b32 s17, s13
    s_mov_b32 s18, 2621440
    s_mov_b32 s19, 0x00020000
    s_mul_i32 s5, s4, 1280
    v_lshlrev_b32 v3, 2, v2
    v_add_u32 v3, s5, v3
    buffer_load_dword v4, v3, s[8:11], 0 offen offset:0
    buffer_load_dword v5, v3, s[8:11], 0 offen offset:256
    buffer_load_dword v6, v3, s[8:11], 0 offen offset:512
    buffer_load_dword v7, v3, s[8:11], 0 offen offset:768
    buffer_load_dword v8, v3, s[8:11], 0 offen offset:1024
    s_waitcnt vmcnt(0)
    v_lshlrev_b32 v10, 16, v4
    v_and_b32 v11, 0xffff0000, v4
    v_lshlrev_b32 v12, 16, v5
    v_and_b32 v13, 0xffff0000, v5
    v_lshlrev_b32 v14, 16, v6
    v_and_b32 v15, 0xffff0000, v6
    v_lshlrev_b32 v16, 16, v7
    v_and_b32 v17, 0xffff0000, v7
    v_lshlrev_b32 v18, 16, v8
    v_and_b32 v19, 0xffff0000, v8
    v_add_f32 v20, v10, v11
    v_add_f32 v20, v20, v12
    v_add_f32 v20, v20, v13
    v_add_f32 v20, v20, v14
    v_add_f32 v20, v20, v15
    v_add_f32 v20, v20, v16
    v_add_f32 v20, v20, v17
    v_add_f32 v20, v20, v18
    v_add_f32 v20, v20, v19
    s_nop 1
    v_add_f32 v21, v20, v20 quad_perm:[1,0,3,2] row_mask:0xf bank_mask:0xf
    s_nop 1
    v_add_f32 v21, v21, v21 quad_perm:[2,3,0,1] row_mask:0xf bank_mask:0xf
    s_nop 1
    v_add_f32 v21, v21, v21 row_half_mirror row_mask:0xf bank_mask:0xf
    s_nop 1
    v_add_f32 v21, v21, v21 row_mirror row_mask:0xf bank_mask:0xf
    s_nop 1
    v_readlane_b32 s24, v21, 0
    v_readlane_b32 s25, v21, 16
    v_readlane_b32 s26, v21, 32
    v_readlane_b32 s27, v21, 48
    s_nop 1
    v_mov_b32 v20, s24
    v_add_f32 v20, s25, v20
    v_add_f32 v20, s26, v20
    v_add_f32 v20, s27, v20
    v_mul_f32 v20, 0.0015625, v20
    v_sub_f32 v10, v10, v20
    v_sub_f32 v11, v11, v20
    v_sub_f32 v12, v12, v20
    v_sub_f32 v13, v13, v20
    v_sub_f32 v14, v14, v20
    v_sub_f32 v15, v15, v20
    v_sub_f32 v16, v16, v20
    v_sub_f32 v17, v17, v20
    v_sub_f32 v18, v18, v20
    v_sub_f32 v19, v19, v20
    v_mul_f32 v21, v10, v10
    v_fmac_f32 v21, v11, v11
    v_fmac_f32 v21, v12, v12
    v_fmac_f32 v21, v13, v13
    v_fmac_f32 v21, v14, v14
    v_fmac_f32 v21, v15, v15
    v_fmac_f32 v21, v16, v16
    v_fmac_f32 v21, v17, v17
    v_fmac_f32 v21, v18, v18
    v_fmac_f32 v21, v19, v19
    s_nop 1
    v_add_f32 v22, v21, v21 quad_perm:[1,0,3,2] row_mask:0xf bank_mask:0xf
    s_nop 1
    v_add_f32 v22, v22, v22 quad_perm:[2,3,0,1] row_mask:0xf bank_mask:0xf
    s_nop 1
    v_add_f32 v22, v22, v22 row_half_mirror row_mask:0xf bank_mask:0xf
    s_nop 1
    v_add_f32 v22, v22, v22 row_mirror row_mask:0xf bank_mask:0xf
    s_nop 1
    v_readlane_b32 s24, v22, 0
    v_readlane_b32 s25, v22, 16
    v_readlane_b32 s26, v22, 32
    v_readlane_b32 s27, v22, 48
    s_nop 1
    v_mov_b32 v21, s24
    v_add_f32 v21, s25, v21
    v_add_f32 v21, s26, v21
    v_add_f32 v21, s27, v21
    v_mov_b32 v22, 0x3727c5ac
    v_fmac_f32 v22, 0.0015625, v21
    v_rsq_f32 v22, v22
    s_nop 0
    v_mul_f32 v10, v10, v22
    v_mul_f32 v11, v11, v22
    v_mul_f32 v12, v12, v22
    v_mul_f32 v13, v13, v22
    v_mul_f32 v14, v14, v22
    v_mul_f32 v15, v15, v22
    v_mul_f32 v16, v16, v22
    v_mul_f32 v17, v17, v22
    v_mul_f32 v18, v18, v22
    v_mul_f32 v19, v19, v22
    v_cvt_pk_bf16_f32 v4, v10, v11
    v_cvt_pk_bf16_f32 v5, v12, v13
    v_cvt_pk_bf16_f32 v6, v14, v15
    v_cvt_pk_bf16_f32 v7, v16, v17
    v_cvt_pk_bf16_f32 v8, v18, v19
    buffer_store_dword v4, v3, s[16:19], 0 offen offset:0
    buffer_store_dword v5, v3, s[16:19], 0 offen offset:256
    buffer_store_dword v6, v3, s[16:19], 0 offen offset:512
    buffer_store_dword v7, v3, s[16:19], 0 offen offset:768
    buffer_store_dword v8, v3, s[16:19], 0 offen offset:1024
ln_a2_kernel_end:
    s_endpgm
.section .rodata,"a"
.p2align 6
.amdhsa_kernel ln_a2_kernel
  .amdhsa_next_free_vgpr 32
  .amdhsa_next_free_sgpr 40
  .amdhsa_accum_offset 32
  .amdhsa_group_segment_fixed_size 0
  .amdhsa_kernarg_size 104
  .amdhsa_user_sgpr_count 2
  .amdhsa_user_sgpr_kernarg_segment_ptr 1
  .amdhsa_system_sgpr_workgroup_id_x 1
.end_amdhsa_kernel
.text
.globl kvz_a2_kernel
.p2align 8
.type kvz_a2_kernel,@function
kvz_a2_kernel:
    v_lshrrev_b32 v1, 6, v0
    v_and_b32 v2, 63, v0
    s_nop 0
    v_readfirstlane_b32 s3, v1
    s_lshl_b32 s4, s2, 2
    s_add_u32 s4, s4, s3
    s_cmp_ge_u32 s4, 512
    s_cbranch_scc1 kvz_a2_kernel_end
    s_load_dwordx2 s[6:7], s[0:1], 96
    s_waitcnt lgkmcnt(0)
    s_mov_b32 s8, s6
    s_mov_b32 s9, s7
    s_mov_b32 s10, 268435456
    s_mov_b32 s11, 0x00020000
    s_lshr_b32 s5, s4, 4
    s_and_b32 s12, s4, 15
    s_mul_i32 s13, s5, 20
    v_and_b32 v3, 15, v2
    v_lshrrev_b32 v4, 4, v2
    s_lshl_b32 s14, s12, 7
    v_lshlrev_b32 v5, 3, v4
    v_add_u32 v5, s14, v5
    v_add_u32 v6, 0, v3
    v_min_u32 v8, 19, v6
    v_add_u32 v8, s13, v8
    v_lshlrev_b32 v8, 11, v8
    v_add_u32 v8, v8, v5
    v_lshlrev_b32 v8, 1, v8
    v_add_u32 v8, 12582912, v8
    v_add_u32 v10, 2621440, v8
    v_add_u32 v7, 16, v3
    v_min_u32 v9, 19, v7
    v_add_u32 v9, s13, v9
    v_lshlrev_b32 v9, 11, v9
    v_add_u32 v9, v9, v5
    v_lshlrev_b32 v9, 1, v9
    v_add_u32 v9, 12582912, v9
    v_add_u32 v11, 2621440, v9
    v_accvgpr_write_b32 a0, 0
    v_accvgpr_write_b32 a1, 0
    v_accvgpr_write_b32 a2, 0
    v_accvgpr_write_b32 a3, 0
    v_accvgpr_write_b32 a4, 0
    v_accvgpr_write_b32 a5, 0
    v_accvgpr_write_b32 a6, 0
    v_accvgpr_write_b32 a7, 0
    v_accvgpr_write_b32 a8, 0
    v_accvgpr_write_b32 a9, 0
    v_accvgpr_write_b32 a10, 0
    v_accvgpr_write_b32 a11, 0
    v_accvgpr_write_b32 a12, 0
    v_accvgpr_write_b32 a13, 0
    v_accvgpr_write_b32 a14, 0
    v_accvgpr_write_b32 a15, 0
    v_cmp_gt_u32 s[16:17], 20, v7
    v_cmp_eq_u32 s[18:19], 20, v7
    buffer_load_dwordx4 v[16:19], v8, s[8:11], 0 offen offset:0
    buffer_load_dwordx4 v[24:27], v10, s[8:11], 0 offen offset:0
    buffer_load_dwordx4 v[20:23], v9, s[8:11], 0 offen offset:0
    buffer_load_dwordx4 v[28:31], v11, s[8:11], 0 offen offset:0
    s_waitcnt vmcnt(0)
    v_lshlrev_b32 v32, 16, v16
    v_and_b32 v33, 0xffff0000, v16
    v_mul_f32 v36, 1.4426950408889634, v32
    v_exp_f32 v36, v36
    v_add_f32 v34, 1.0, v32
    v_cmp_lt_f32 vcc, 0, v32
    s_nop 1
    v_cndmask_b32 v34, v36, v34, vcc
    v_add_f32 v34, 0x358637bd, v34
    v_mul_f32 v36, 1.4426950408889634, v33
    v_exp_f32 v36, v36
    v_add_f32 v35, 1.0, v33
    v_cmp_lt_f32 vcc, 0, v33
    s_nop 1
    v_cndmask_b32 v35, v36, v35, vcc
    v_add_f32 v35, 0x358637bd, v35
    v_cvt_pk_bf16_f32 v16, v34, v35
    v_lshlrev_b32 v32, 16, v17
    v_and_b32 v33, 0xffff0000, v17
    v_mul_f32 v36, 1.4426950408889634, v32
    v_exp_f32 v36, v36
    v_add_f32 v34, 1.0, v32
    v_cmp_lt_f32 vcc, 0, v32
    s_nop 1
    v_cndmask_b32 v34, v36, v34, vcc
    v_add_f32 v34, 0x358637bd, v34
    v_mul_f32 v36, 1.4426950408889634, v33
    v_exp_f32 v36, v36
    v_add_f32 v35, 1.0, v33
    v_cmp_lt_f32 vcc, 0, v33
    s_nop 1
    v_cndmask_b32 v35, v36, v35, vcc
    v_add_f32 v35, 0x358637bd, v35
    v_cvt_pk_bf16_f32 v17, v34, v35
    v_lshlrev_b32 v32, 16, v18
    v_and_b32 v33, 0xffff0000, v18
    v_mul_f32 v36, 1.4426950408889634, v32
    v_exp_f32 v36, v36
    v_add_f32 v34, 1.0, v32
    v_cmp_lt_f32 vcc, 0, v32
    s_nop 1
    v_cndmask_b32 v34, v36, v34, vcc
    v_add_f32 v34, 0x358637bd, v34
    v_mul_f32 v36, 1.4426950408889634, v33
    v_exp_f32 v36, v36
    v_add_f32 v35, 1.0, v33
    v_cmp_lt_f32 vcc, 0, v33
    s_nop 1
    v_cndmask_b32 v35, v36, v35, vcc
    v_add_f32 v35, 0x358637bd, v35
    v_cvt_pk_bf16_f32 v18, v34, v35
    v_lshlrev_b32 v32, 16, v19
    v_and_b32 v33, 0xffff0000, v19
    v_mul_f32 v36, 1.4426950408889634, v32
    v_exp_f32 v36, v36
    v_add_f32 v34, 1.0, v32
    v_cmp_lt_f32 vcc, 0, v32
    s_nop 1
    v_cndmask_b32 v34, v36, v34, vcc
    v_add_f32 v34, 0x358637bd, v34
    v_mul_f32 v36, 1.4426950408889634, v33
    v_exp_f32 v36, v36
    v_add_f32 v35, 1.0, v33
    v_cmp_lt_f32 vcc, 0, v33
    s_nop 1
    v_cndmask_b32 v35, v36, v35, vcc
    v_add_f32 v35, 0x358637bd, v35
    v_cvt_pk_bf16_f32 v19, v34, v35
    v_lshlrev_b32 v32, 16, v20
    v_and_b32 v33, 0xffff0000, v20
    v_mul_f32 v36, 1.4426950408889634, v32
    v_exp_f32 v36, v36
    v_add_f32 v34, 1.0, v32
    v_cmp_lt_f32 vcc, 0, v32
    s_nop 1
    v_cndmask_b32 v34, v36, v34, vcc
    v_add_f32 v34, 0x358637bd, v34
    v_mul_f32 v36, 1.4426950408889634, v33
    v_exp_f32 v36, v36
    v_add_f32 v35, 1.0, v33
    v_cmp_lt_f32 vcc, 0, v33
    s_nop 1
    v_cndmask_b32 v35, v36, v35, vcc
    v_add_f32 v35, 0x358637bd, v35
    v_cvt_pk_bf16_f32 v20, v34, v35
    v_lshlrev_b32 v32, 16, v21
    v_and_b32 v33, 0xffff0000, v21
    v_mul_f32 v36, 1.4426950408889634, v32
    v_exp_f32 v36, v36
    v_add_f32 v34, 1.0, v32
    v_cmp_lt_f32 vcc, 0, v32
    s_nop 1
    v_cndmask_b32 v34, v36, v34, vcc
    v_add_f32 v34, 0x358637bd, v34
    v_mul_f32 v36, 1.4426950408889634, v33
    v_exp_f32 v36, v36
    v_add_f32 v35, 1.0, v33
    v_cmp_lt_f32 vcc, 0, v33
    s_nop 1
    v_cndmask_b32 v35, v36, v35, vcc
    v_add_f32 v35, 0x358637bd, v35
    v_cvt_pk_bf16_f32 v21, v34, v35
    v_lshlrev_b32 v32, 16, v22
    v_and_b32 v33, 0xffff0000, v22
    v_mul_f32 v36, 1.4426950408889634, v32
    v_exp_f32 v36, v36
    v_add_f32 v34, 1.0, v32
    v_cmp_lt_f32 vcc, 0, v32
    s_nop 1
    v_cndmask_b32 v34, v36, v34, vcc
    v_add_f32 v34, 0x358637bd, v34
    v_mul_f32 v36, 1.4426950408889634, v33
    v_exp_f32 v36, v36
    v_add_f32 v35, 1.0, v33
    v_cmp_lt_f32 vcc, 0, v33
    s_nop 1
    v_cndmask_b32 v35, v36, v35, vcc
    v_add_f32 v35, 0x358637bd, v35
    v_cvt_pk_bf16_f32 v22, v34, v35
    v_lshlrev_b32 v32, 16, v23
    v_and_b32 v33, 0xffff0000, v23
    v_mul_f32 v36, 1.4426950408889634, v32
    v_exp_f32 v36, v36
    v_add_f32 v34, 1.0, v32
    v_cmp_lt_f32 vcc, 0, v32
    s_nop 1
    v_cndmask_b32 v34, v36, v34, vcc
    v_add_f32 v34, 0x358637bd, v34
    v_mul_f32 v36, 1.4426950408889634, v33
    v_exp_f32 v36, v36
    v_add_f32 v35, 1.0, v33
    v_cmp_lt_f32 vcc, 0, v33
    s_nop 1
    v_cndmask_b32 v35, v36, v35, vcc
    v_add_f32 v35, 0x358637bd, v35
    v_cvt_pk_bf16_f32 v23, v34, v35
    v_mov_b32 v37, 0x3f803f80
    v_cndmask_b32 v20, 0, v20, s[16:17]
    v_cndmask_b32 v28, 0, v28, s[16:17]
    v_cndmask_b32 v28, v28, v37, s[18:19]
    v_cndmask_b32 v21, 0, v21, s[16:17]
    v_cndmask_b32 v29, 0, v29, s[16:17]
    v_cndmask_b32 v29, v29, v37, s[18:19]
    v_cndmask_b32 v22, 0, v22, s[16:17]
    v_cndmask_b32 v30, 0, v30, s[16:17]
    v_cndmask_b32 v30, v30, v37, s[18:19]
    v_cndmask_b32 v23, 0, v23, s[16:17]
    v_cndmask_b32 v31, 0, v31, s[16:17]
    v_cndmask_b32 v31, v31, v37, s[18:19]
    s_nop 1
    v_mfma_f32_16x16x32_bf16 a[0:3], v[24:27], v[16:19], a[0:3]
    v_mfma_f32_16x16x32_bf16 a[4:7], v[24:27], v[20:23], a[4:7]
    v_mfma_f32_16x16x32_bf16 a[8:11], v[28:31], v[16:19], a[8:11]
    v_mfma_f32_16x16x32_bf16 a[12:15], v[28:31], v[20:23], a[12:15]
    buffer_load_dwordx4 v[16:19], v8, s[8:11], 0 offen offset:64
    buffer_load_dwordx4 v[24:27], v10, s[8:11], 0 offen offset:64
    buffer_load_dwordx4 v[20:23], v9, s[8:11], 0 offen offset:64
    buffer_load_dwordx4 v[28:31], v11, s[8:11], 0 offen offset:64
    s_waitcnt vmcnt(0)
    v_lshlrev_b32 v32, 16, v16
    v_and_b32 v33, 0xffff0000, v16
    v_mul_f32 v36, 1.4426950408889634, v32
    v_exp_f32 v36, v36
    v_add_f32 v34, 1.0, v32
    v_cmp_lt_f32 vcc, 0, v32
    s_nop 1
    v_cndmask_b32 v34, v36, v34, vcc
    v_add_f32 v34, 0x358637bd, v34
    v_mul_f32 v36, 1.4426950408889634, v33
    v_exp_f32 v36, v36
    v_add_f32 v35, 1.0, v33
    v_cmp_lt_f32 vcc, 0, v33
    s_nop 1
    v_cndmask_b32 v35, v36, v35, vcc
    v_add_f32 v35, 0x358637bd, v35
    v_cvt_pk_bf16_f32 v16, v34, v35
    v_lshlrev_b32 v32, 16, v17
    v_and_b32 v33, 0xffff0000, v17
    v_mul_f32 v36, 1.4426950408889634, v32
    v_exp_f32 v36, v36
    v_add_f32 v34, 1.0, v32
    v_cmp_lt_f32 vcc, 0, v32
    s_nop 1
    v_cndmask_b32 v34, v36, v34, vcc
    v_add_f32 v34, 0x358637bd, v34
    v_mul_f32 v36, 1.4426950408889634, v33
    v_exp_f32 v36, v36
    v_add_f32 v35, 1.0, v33
    v_cmp_lt_f32 vcc, 0, v33
    s_nop 1
    v_cndmask_b32 v35, v36, v35, vcc
    v_add_f32 v35, 0x358637bd, v35
    v_cvt_pk_bf16_f32 v17, v34, v35
    v_lshlrev_b32 v32, 16, v18
    v_and_b32 v33, 0xffff0000, v18
    v_mul_f32 v36, 1.4426950408889634, v32
    v_exp_f32 v36, v36
    v_add_f32 v34, 1.0, v32
    v_cmp_lt_f32 vcc, 0, v32
    s_nop 1
    v_cndmask_b32 v34, v36, v34, vcc
    v_add_f32 v34, 0x358637bd, v34
    v_mul_f32 v36, 1.4426950408889634, v33
    v_exp_f32 v36, v36
    v_add_f32 v35, 1.0, v33
    v_cmp_lt_f32 vcc, 0, v33
    s_nop 1
    v_cndmask_b32 v35, v36, v35, vcc
    v_add_f32 v35, 0x358637bd, v35
    v_cvt_pk_bf16_f32 v18, v34, v35
    v_lshlrev_b32 v32, 16, v19
    v_and_b32 v33, 0xffff0000, v19
    v_mul_f32 v36, 1.4426950408889634, v32
    v_exp_f32 v36, v36
    v_add_f32 v34, 1.0, v32
    v_cmp_lt_f32 vcc, 0, v32
    s_nop 1
    v_cndmask_b32 v34, v36, v34, vcc
    v_add_f32 v34, 0x358637bd, v34
    v_mul_f32 v36, 1.4426950408889634, v33
    v_exp_f32 v36, v36
    v_add_f32 v35, 1.0, v33
    v_cmp_lt_f32 vcc, 0, v33
    s_nop 1
    v_cndmask_b32 v35, v36, v35, vcc
    v_add_f32 v35, 0x358637bd, v35
    v_cvt_pk_bf16_f32 v19, v34, v35
    v_lshlrev_b32 v32, 16, v20
    v_and_b32 v33, 0xffff0000, v20
    v_mul_f32 v36, 1.4426950408889634, v32
    v_exp_f32 v36, v36
    v_add_f32 v34, 1.0, v32
    v_cmp_lt_f32 vcc, 0, v32
    s_nop 1
    v_cndmask_b32 v34, v36, v34, vcc
    v_add_f32 v34, 0x358637bd, v34
    v_mul_f32 v36, 1.4426950408889634, v33
    v_exp_f32 v36, v36
    v_add_f32 v35, 1.0, v33
    v_cmp_lt_f32 vcc, 0, v33
    s_nop 1
    v_cndmask_b32 v35, v36, v35, vcc
    v_add_f32 v35, 0x358637bd, v35
    v_cvt_pk_bf16_f32 v20, v34, v35
    v_lshlrev_b32 v32, 16, v21
    v_and_b32 v33, 0xffff0000, v21
    v_mul_f32 v36, 1.4426950408889634, v32
    v_exp_f32 v36, v36
    v_add_f32 v34, 1.0, v32
    v_cmp_lt_f32 vcc, 0, v32
    s_nop 1
    v_cndmask_b32 v34, v36, v34, vcc
    v_add_f32 v34, 0x358637bd, v34
    v_mul_f32 v36, 1.4426950408889634, v33
    v_exp_f32 v36, v36
    v_add_f32 v35, 1.0, v33
    v_cmp_lt_f32 vcc, 0, v33
    s_nop 1
    v_cndmask_b32 v35, v36, v35, vcc
    v_add_f32 v35, 0x358637bd, v35
    v_cvt_pk_bf16_f32 v21, v34, v35
    v_lshlrev_b32 v32, 16, v22
    v_and_b32 v33, 0xffff0000, v22
    v_mul_f32 v36, 1.4426950408889634, v32
    v_exp_f32 v36, v36
    v_add_f32 v34, 1.0, v32
    v_cmp_lt_f32 vcc, 0, v32
    s_nop 1
    v_cndmask_b32 v34, v36, v34, vcc
    v_add_f32 v34, 0x358637bd, v34
    v_mul_f32 v36, 1.4426950408889634, v33
    v_exp_f32 v36, v36
    v_add_f32 v35, 1.0, v33
    v_cmp_lt_f32 vcc, 0, v33
    s_nop 1
    v_cndmask_b32 v35, v36, v35, vcc
    v_add_f32 v35, 0x358637bd, v35
    v_cvt_pk_bf16_f32 v22, v34, v35
    v_lshlrev_b32 v32, 16, v23
    v_and_b32 v33, 0xffff0000, v23
    v_mul_f32 v36, 1.4426950408889634, v32
    v_exp_f32 v36, v36
    v_add_f32 v34, 1.0, v32
    v_cmp_lt_f32 vcc, 0, v32
    s_nop 1
    v_cndmask_b32 v34, v36, v34, vcc
    v_add_f32 v34, 0x358637bd, v34
    v_mul_f32 v36, 1.4426950408889634, v33
    v_exp_f32 v36, v36
    v_add_f32 v35, 1.0, v33
    v_cmp_lt_f32 vcc, 0, v33
    s_nop 1
    v_cndmask_b32 v35, v36, v35, vcc
    v_add_f32 v35, 0x358637bd, v35
    v_cvt_pk_bf16_f32 v23, v34, v35
    v_mov_b32 v37, 0x3f803f80
    v_cndmask_b32 v20, 0, v20, s[16:17]
    v_cndmask_b32 v28, 0, v28, s[16:17]
    v_cndmask_b32 v28, v28, v37, s[18:19]
    v_cndmask_b32 v21, 0, v21, s[16:17]
    v_cndmask_b32 v29, 0, v29, s[16:17]
    v_cndmask_b32 v29, v29, v37, s[18:19]
    v_cndmask_b32 v22, 0, v22, s[16:17]
    v_cndmask_b32 v30, 0, v30, s[16:17]
    v_cndmask_b32 v30, v30, v37, s[18:19]
    v_cndmask_b32 v23, 0, v23, s[16:17]
    v_cndmask_b32 v31, 0, v31, s[16:17]
    v_cndmask_b32 v31, v31, v37, s[18:19]
    s_nop 1
    v_mfma_f32_16x16x32_bf16 a[0:3], v[24:27], v[16:19], a[0:3]
    v_mfma_f32_16x16x32_bf16 a[4:7], v[24:27], v[20:23], a[4:7]
    v_mfma_f32_16x16x32_bf16 a[8:11], v[28:31], v[16:19], a[8:11]
    v_mfma_f32_16x16x32_bf16 a[12:15], v[28:31], v[20:23], a[12:15]
    buffer_load_dwordx4 v[16:19], v8, s[8:11], 0 offen offset:128
    buffer_load_dwordx4 v[24:27], v10, s[8:11], 0 offen offset:128
    buffer_load_dwordx4 v[20:23], v9, s[8:11], 0 offen offset:128
    buffer_load_dwordx4 v[28:31], v11, s[8:11], 0 offen offset:128
    s_waitcnt vmcnt(0)
    v_lshlrev_b32 v32, 16, v16
    v_and_b32 v33, 0xffff0000, v16
    v_mul_f32 v36, 1.4426950408889634, v32
    v_exp_f32 v36, v36
    v_add_f32 v34, 1.0, v32
    v_cmp_lt_f32 vcc, 0, v32
    s_nop 1
    v_cndmask_b32 v34, v36, v34, vcc
    v_add_f32 v34, 0x358637bd, v34
    v_mul_f32 v36, 1.4426950408889634, v33
    v_exp_f32 v36, v36
    v_add_f32 v35, 1.0, v33
    v_cmp_lt_f32 vcc, 0, v33
    s_nop 1
    v_cndmask_b32 v35, v36, v35, vcc
    v_add_f32 v35, 0x358637bd, v35
    v_cvt_pk_bf16_f32 v16, v34, v35
    v_lshlrev_b32 v32, 16, v17
    v_and_b32 v33, 0xffff0000, v17
    v_mul_f32 v36, 1.4426950408889634, v32
    v_exp_f32 v36, v36
    v_add_f32 v34, 1.0, v32
    v_cmp_lt_f32 vcc, 0, v32
    s_nop 1
    v_cndmask_b32 v34, v36, v34, vcc
    v_add_f32 v34, 0x358637bd, v34
    v_mul_f32 v36, 1.4426950408889634, v33
    v_exp_f32 v36, v36
    v_add_f32 v35, 1.0, v33
    v_cmp_lt_f32 vcc, 0, v33
    s_nop 1
    v_cndmask_b32 v35, v36, v35, vcc
    v_add_f32 v35, 0x358637bd, v35
    v_cvt_pk_bf16_f32 v17, v34, v35
    v_lshlrev_b32 v32, 16, v18
    v_and_b32 v33, 0xffff0000, v18
    v_mul_f32 v36, 1.4426950408889634, v32
    v_exp_f32 v36, v36
    v_add_f32 v34, 1.0, v32
    v_cmp_lt_f32 vcc, 0, v32
    s_nop 1
    v_cndmask_b32 v34, v36, v34, vcc
    v_add_f32 v34, 0x358637bd, v34
    v_mul_f32 v36, 1.4426950408889634, v33
    v_exp_f32 v36, v36
    v_add_f32 v35, 1.0, v33
    v_cmp_lt_f32 vcc, 0, v33
    s_nop 1
    v_cndmask_b32 v35, v36, v35, vcc
    v_add_f32 v35, 0x358637bd, v35
    v_cvt_pk_bf16_f32 v18, v34, v35
    v_lshlrev_b32 v32, 16, v19
    v_and_b32 v33, 0xffff0000, v19
    v_mul_f32 v36, 1.4426950408889634, v32
    v_exp_f32 v36, v36
    v_add_f32 v34, 1.0, v32
    v_cmp_lt_f32 vcc, 0, v32
    s_nop 1
    v_cndmask_b32 v34, v36, v34, vcc
    v_add_f32 v34, 0x358637bd, v34
    v_mul_f32 v36, 1.4426950408889634, v33
    v_exp_f32 v36, v36
    v_add_f32 v35, 1.0, v33
    v_cmp_lt_f32 vcc, 0, v33
    s_nop 1
    v_cndmask_b32 v35, v36, v35, vcc
    v_add_f32 v35, 0x358637bd, v35
    v_cvt_pk_bf16_f32 v19, v34, v35
    v_lshlrev_b32 v32, 16, v20
    v_and_b32 v33, 0xffff0000, v20
    v_mul_f32 v36, 1.4426950408889634, v32
    v_exp_f32 v36, v36
    v_add_f32 v34, 1.0, v32
    v_cmp_lt_f32 vcc, 0, v32
    s_nop 1
    v_cndmask_b32 v34, v36, v34, vcc
    v_add_f32 v34, 0x358637bd, v34
    v_mul_f32 v36, 1.4426950408889634, v33
    v_exp_f32 v36, v36
    v_add_f32 v35, 1.0, v33
    v_cmp_lt_f32 vcc, 0, v33
    s_nop 1
    v_cndmask_b32 v35, v36, v35, vcc
    v_add_f32 v35, 0x358637bd, v35
    v_cvt_pk_bf16_f32 v20, v34, v35
    v_lshlrev_b32 v32, 16, v21
    v_and_b32 v33, 0xffff0000, v21
    v_mul_f32 v36, 1.4426950408889634, v32
    v_exp_f32 v36, v36
    v_add_f32 v34, 1.0, v32
    v_cmp_lt_f32 vcc, 0, v32
    s_nop 1
    v_cndmask_b32 v34, v36, v34, vcc
    v_add_f32 v34, 0x358637bd, v34
    v_mul_f32 v36, 1.4426950408889634, v33
    v_exp_f32 v36, v36
    v_add_f32 v35, 1.0, v33
    v_cmp_lt_f32 vcc, 0, v33
    s_nop 1
    v_cndmask_b32 v35, v36, v35, vcc
    v_add_f32 v35, 0x358637bd, v35
    v_cvt_pk_bf16_f32 v21, v34, v35
    v_lshlrev_b32 v32, 16, v22
    v_and_b32 v33, 0xffff0000, v22
    v_mul_f32 v36, 1.4426950408889634, v32
    v_exp_f32 v36, v36
    v_add_f32 v34, 1.0, v32
    v_cmp_lt_f32 vcc, 0, v32
    s_nop 1
    v_cndmask_b32 v34, v36, v34, vcc
    v_add_f32 v34, 0x358637bd, v34
    v_mul_f32 v36, 1.4426950408889634, v33
    v_exp_f32 v36, v36
    v_add_f32 v35, 1.0, v33
    v_cmp_lt_f32 vcc, 0, v33
    s_nop 1
    v_cndmask_b32 v35, v36, v35, vcc
    v_add_f32 v35, 0x358637bd, v35
    v_cvt_pk_bf16_f32 v22, v34, v35
    v_lshlrev_b32 v32, 16, v23
    v_and_b32 v33, 0xffff0000, v23
    v_mul_f32 v36, 1.4426950408889634, v32
    v_exp_f32 v36, v36
    v_add_f32 v34, 1.0, v32
    v_cmp_lt_f32 vcc, 0, v32
    s_nop 1
    v_cndmask_b32 v34, v36, v34, vcc
    v_add_f32 v34, 0x358637bd, v34
    v_mul_f32 v36, 1.4426950408889634, v33
    v_exp_f32 v36, v36
    v_add_f32 v35, 1.0, v33
    v_cmp_lt_f32 vcc, 0, v33
    s_nop 1
    v_cndmask_b32 v35, v36, v35, vcc
    v_add_f32 v35, 0x358637bd, v35
    v_cvt_pk_bf16_f32 v23, v34, v35
    v_mov_b32 v37, 0x3f803f80
    v_cndmask_b32 v20, 0, v20, s[16:17]
    v_cndmask_b32 v28, 0, v28, s[16:17]
    v_cndmask_b32 v28, v28, v37, s[18:19]
    v_cndmask_b32 v21, 0, v21, s[16:17]
    v_cndmask_b32 v29, 0, v29, s[16:17]
    v_cndmask_b32 v29, v29, v37, s[18:19]
    v_cndmask_b32 v22, 0, v22, s[16:17]
    v_cndmask_b32 v30, 0, v30, s[16:17]
    v_cndmask_b32 v30, v30, v37, s[18:19]
    v_cndmask_b32 v23, 0, v23, s[16:17]
    v_cndmask_b32 v31, 0, v31, s[16:17]
    v_cndmask_b32 v31, v31, v37, s[18:19]
    s_nop 1
    v_mfma_f32_16x16x32_bf16 a[0:3], v[24:27], v[16:19], a[0:3]
    v_mfma_f32_16x16x32_bf16 a[4:7], v[24:27], v[20:23], a[4:7]
    v_mfma_f32_16x16x32_bf16 a[8:11], v[28:31], v[16:19], a[8:11]
    v_mfma_f32_16x16x32_bf16 a[12:15], v[28:31], v[20:23], a[12:15]
    buffer_load_dwordx4 v[16:19], v8, s[8:11], 0 offen offset:192
    buffer_load_dwordx4 v[24:27], v10, s[8:11], 0 offen offset:192
    buffer_load_dwordx4 v[20:23], v9, s[8:11], 0 offen offset:192
    buffer_load_dwordx4 v[28:31], v11, s[8:11], 0 offen offset:192
    s_waitcnt vmcnt(0)
    v_lshlrev_b32 v32, 16, v16
    v_and_b32 v33, 0xffff0000, v16
    v_mul_f32 v36, 1.4426950408889634, v32
    v_exp_f32 v36, v36
    v_add_f32 v34, 1.0, v32
    v_cmp_lt_f32 vcc, 0, v32
    s_nop 1
    v_cndmask_b32 v34, v36, v34, vcc
    v_add_f32 v34, 0x358637bd, v34
    v_mul_f32 v36, 1.4426950408889634, v33
    v_exp_f32 v36, v36
    v_add_f32 v35, 1.0, v33
    v_cmp_lt_f32 vcc, 0, v33
    s_nop 1
    v_cndmask_b32 v35, v36, v35, vcc
    v_add_f32 v35, 0x358637bd, v35
    v_cvt_pk_bf16_f32 v16, v34, v35
    v_lshlrev_b32 v32, 16, v17
    v_and_b32 v33, 0xffff0000, v17
    v_mul_f32 v36, 1.4426950408889634, v32
    v_exp_f32 v36, v36
    v_add_f32 v34, 1.0, v32
    v_cmp_lt_f32 vcc, 0, v32
    s_nop 1
    v_cndmask_b32 v34, v36, v34, vcc
    v_add_f32 v34, 0x358637bd, v34
    v_mul_f32 v36, 1.4426950408889634, v33
    v_exp_f32 v36, v36
    v_add_f32 v35, 1.0, v33
    v_cmp_lt_f32 vcc, 0, v33
    s_nop 1
    v_cndmask_b32 v35, v36, v35, vcc
    v_add_f32 v35, 0x358637bd, v35
    v_cvt_pk_bf16_f32 v17, v34, v35
    v_lshlrev_b32 v32, 16, v18
    v_and_b32 v33, 0xffff0000, v18
    v_mul_f32 v36, 1.4426950408889634, v32
    v_exp_f32 v36, v36
    v_add_f32 v34, 1.0, v32
    v_cmp_lt_f32 vcc, 0, v32
    s_nop 1
    v_cndmask_b32 v34, v36, v34, vcc
    v_add_f32 v34, 0x358637bd, v34
    v_mul_f32 v36, 1.4426950408889634, v33
    v_exp_f32 v36, v36
    v_add_f32 v35, 1.0, v33
    v_cmp_lt_f32 vcc, 0, v33
    s_nop 1
    v_cndmask_b32 v35, v36, v35, vcc
    v_add_f32 v35, 0x358637bd, v35
    v_cvt_pk_bf16_f32 v18, v34, v35
    v_lshlrev_b32 v32, 16, v19
    v_and_b32 v33, 0xffff0000, v19
    v_mul_f32 v36, 1.4426950408889634, v32
    v_exp_f32 v36, v36
    v_add_f32 v34, 1.0, v32
    v_cmp_lt_f32 vcc, 0, v32
    s_nop 1
    v_cndmask_b32 v34, v36, v34, vcc
    v_add_f32 v34, 0x358637bd, v34
    v_mul_f32 v36, 1.4426950408889634, v33
    v_exp_f32 v36, v36
    v_add_f32 v35, 1.0, v33
    v_cmp_lt_f32 vcc, 0, v33
    s_nop 1
    v_cndmask_b32 v35, v36, v35, vcc
    v_add_f32 v35, 0x358637bd, v35
    v_cvt_pk_bf16_f32 v19, v34, v35
    v_lshlrev_b32 v32, 16, v20
    v_and_b32 v33, 0xffff0000, v20
    v_mul_f32 v36, 1.4426950408889634, v32
    v_exp_f32 v36, v36
    v_add_f32 v34, 1.0, v32
    v_cmp_lt_f32 vcc, 0, v32
    s_nop 1
    v_cndmask_b32 v34, v36, v34, vcc
    v_add_f32 v34, 0x358637bd, v34
    v_mul_f32 v36, 1.4426950408889634, v33
    v_exp_f32 v36, v36
    v_add_f32 v35, 1.0, v33
    v_cmp_lt_f32 vcc, 0, v33
    s_nop 1
    v_cndmask_b32 v35, v36, v35, vcc
    v_add_f32 v35, 0x358637bd, v35
    v_cvt_pk_bf16_f32 v20, v34, v35
    v_lshlrev_b32 v32, 16, v21
    v_and_b32 v33, 0xffff0000, v21
    v_mul_f32 v36, 1.4426950408889634, v32
    v_exp_f32 v36, v36
    v_add_f32 v34, 1.0, v32
    v_cmp_lt_f32 vcc, 0, v32
    s_nop 1
    v_cndmask_b32 v34, v36, v34, vcc
    v_add_f32 v34, 0x358637bd, v34
    v_mul_f32 v36, 1.4426950408889634, v33
    v_exp_f32 v36, v36
    v_add_f32 v35, 1.0, v33
    v_cmp_lt_f32 vcc, 0, v33
    s_nop 1
    v_cndmask_b32 v35, v36, v35, vcc
    v_add_f32 v35, 0x358637bd, v35
    v_cvt_pk_bf16_f32 v21, v34, v35
    v_lshlrev_b32 v32, 16, v22
    v_and_b32 v33, 0xffff0000, v22
    v_mul_f32 v36, 1.4426950408889634, v32
    v_exp_f32 v36, v36
    v_add_f32 v34, 1.0, v32
    v_cmp_lt_f32 vcc, 0, v32
    s_nop 1
    v_cndmask_b32 v34, v36, v34, vcc
    v_add_f32 v34, 0x358637bd, v34
    v_mul_f32 v36, 1.4426950408889634, v33
    v_exp_f32 v36, v36
    v_add_f32 v35, 1.0, v33
    v_cmp_lt_f32 vcc, 0, v33
    s_nop 1
    v_cndmask_b32 v35, v36, v35, vcc
    v_add_f32 v35, 0x358637bd, v35
    v_cvt_pk_bf16_f32 v22, v34, v35
    v_lshlrev_b32 v32, 16, v23
    v_and_b32 v33, 0xffff0000, v23
    v_mul_f32 v36, 1.4426950408889634, v32
    v_exp_f32 v36, v36
    v_add_f32 v34, 1.0, v32
    v_cmp_lt_f32 vcc, 0, v32
    s_nop 1
    v_cndmask_b32 v34, v36, v34, vcc
    v_add_f32 v34, 0x358637bd, v34
    v_mul_f32 v36, 1.4426950408889634, v33
    v_exp_f32 v36, v36
    v_add_f32 v35, 1.0, v33
    v_cmp_lt_f32 vcc, 0, v33
    s_nop 1
    v_cndmask_b32 v35, v36, v35, vcc
    v_add_f32 v35, 0x358637bd, v35
    v_cvt_pk_bf16_f32 v23, v34, v35
    v_mov_b32 v37, 0x3f803f80
    v_cndmask_b32 v20, 0, v20, s[16:17]
    v_cndmask_b32 v28, 0, v28, s[16:17]
    v_cndmask_b32 v28, v28, v37, s[18:19]
    v_cndmask_b32 v21, 0, v21, s[16:17]
    v_cndmask_b32 v29, 0, v29, s[16:17]
    v_cndmask_b32 v29, v29, v37, s[18:19]
    v_cndmask_b32 v22, 0, v22, s[16:17]
    v_cndmask_b32 v30, 0, v30, s[16:17]
    v_cndmask_b32 v30, v30, v37, s[18:19]
    v_cndmask_b32 v23, 0, v23, s[16:17]
    v_cndmask_b32 v31, 0, v31, s[16:17]
    v_cndmask_b32 v31, v31, v37, s[18:19]
    s_nop 1
    v_mfma_f32_16x16x32_bf16 a[0:3], v[24:27], v[16:19], a[0:3]
    v_mfma_f32_16x16x32_bf16 a[4:7], v[24:27], v[20:23], a[4:7]
    v_mfma_f32_16x16x32_bf16 a[8:11], v[28:31], v[16:19], a[8:11]
    v_mfma_f32_16x16x32_bf16 a[12:15], v[28:31], v[20:23], a[12:15]
    s_nop 7
    s_nop 7
    v_lshlrev_b32 v5, 2, v4
    v_lshlrev_b32 v5, 5, v5
    v_add_u32 v5, v5, v3
    v_lshlrev_b32 v5, 2, v5
    s_lshl_b32 s14, s5, 12
    s_add_u32 s14, s14, 23199744
    v_add_u32 v5, s14, v5
    v_accvgpr_read_b32 v40, a0
    v_accvgpr_read_b32 v41, a1
    v_accvgpr_read_b32 v42, a2
    v_accvgpr_read_b32 v43, a3
    buffer_atomic_add_f32 v40, v5, s[8:11], 0 offen offset:0
    buffer_atomic_add_f32 v41, v5, s[8:11], 0 offen offset:128
    buffer_atomic_add_f32 v42, v5, s[8:11], 0 offen offset:256
    buffer_atomic_add_f32 v43, v5, s[8:11], 0 offen offset:384
    v_accvgpr_read_b32 v40, a4
    v_accvgpr_read_b32 v41, a5
    v_accvgpr_read_b32 v42, a6
    v_accvgpr_read_b32 v43, a7
    buffer_atomic_add_f32 v40, v5, s[8:11], 0 offen offset:64
    buffer_atomic_add_f32 v41, v5, s[8:11], 0 offen offset:192
    buffer_atomic_add_f32 v42, v5, s[8:11], 0 offen offset:320
    buffer_atomic_add_f32 v43, v5, s[8:11], 0 offen offset:448
    v_accvgpr_read_b32 v40, a8
    v_accvgpr_read_b32 v41, a9
    v_accvgpr_read_b32 v42, a10
    v_accvgpr_read_b32 v43, a11
    buffer_atomic_add_f32 v40, v5, s[8:11], 0 offen offset:2048
    buffer_atomic_add_f32 v41, v5, s[8:11], 0 offen offset:2176
    buffer_atomic_add_f32 v42, v5, s[8:11], 0 offen offset:2304
    buffer_atomic_add_f32 v43, v5, s[8:11], 0 offen offset:2432
    v_accvgpr_read_b32 v40, a12
    v_accvgpr_read_b32 v41, a13
    v_accvgpr_read_b32 v42, a14
    v_accvgpr_read_b32 v43, a15
    buffer_atomic_add_f32 v40, v5, s[8:11], 0 offen offset:2112
    buffer_atomic_add_f32 v41, v5, s[8:11], 0 offen offset:2240
    buffer_atomic_add_f32 v42, v5, s[8:11], 0 offen offset:2368
    buffer_atomic_add_f32 v43, v5, s[8:11], 0 offen offset:2496
kvz_a2_kernel_end:
    s_endpgm
.section .rodata,"a"
.p2align 6
.amdhsa_kernel kvz_a2_kernel
  .amdhsa_next_free_vgpr 80
  .amdhsa_next_free_sgpr 40
  .amdhsa_accum_offset 64
  .amdhsa_group_segment_fixed_size 0
  .amdhsa_kernarg_size 104
  .amdhsa_user_sgpr_count 2
  .amdhsa_user_sgpr_kernarg_segment_ptr 1
  .amdhsa_system_sgpr_workgroup_id_x 1
.end_amdhsa_kernel
.text
.globl attn_a2_kernel
.p2align 8
.type attn_a2_kernel,@function
attn_a2_kernel:
    s_cmp_ge_u32 s2, 256
    s_cbranch_scc1 attn_a2_kernel_end
    s_load_dwordx2 s[6:7], s[0:1], 96
    s_waitcnt lgkmcnt(0)
    s_mov_b32 s8, s6
    s_mov_b32 s9, s7
    s_mov_b32 s10, 268435456
    s_mov_b32 s11, 0x00020000
    v_mov_b32 v1, v0
    v_add_u32 v2, 0, v1
    s_mov_b32 s12, 3121
    v_mul_lo_u32 v3, v2, s12
    v_lshrrev_b32 v3, 19, v3
    v_mul_u32_u24 v4, 168, v3
    v_sub_u32 v4, v2, v4
    v_lshlrev_b32 v5, 12, v3
    v_lshlrev_b32 v6, 4, v4
    v_add_u32 v5, v5, v6
    v_add_u32 v5, 23199744, v5
    buffer_load_dwordx4 v[8:11], v5, s[8:11], 0 offen
    v_mul_u32_u24 v7, 2688, v3
    v_add_u32 v7, v7, v6
    s_waitcnt vmcnt(0)
    ds_write_b128 v7, v[8:11]
    v_add_u32 v2, 256, v1
    s_mov_b32 s12, 3121
    v_mul_lo_u32 v3, v2, s12
    v_lshrrev_b32 v3, 19, v3
    v_mul_u32_u24 v4, 168, v3
    v_sub_u32 v4, v2, v4
    v_lshlrev_b32 v5, 12, v3
    v_lshlrev_b32 v6, 4, v4
    v_add_u32 v5, v5, v6
    v_add_u32 v5, 23199744, v5
    buffer_load_dwordx4 v[8:11], v5, s[8:11], 0 offen
    v_mul_u32_u24 v7, 2688, v3
    v_add_u32 v7, v7, v6
    s_waitcnt vmcnt(0)
    ds_write_b128 v7, v[8:11]
    v_add_u32 v2, 512, v1
    s_mov_b32 s12, 3121
    v_mul_lo_u32 v3, v2, s12
    v_lshrrev_b32 v3, 19, v3
    v_mul_u32_u24 v4, 168, v3
    v_sub_u32 v4, v2, v4
    v_lshlrev_b32 v5, 12, v3
    v_lshlrev_b32 v6, 4, v4
    v_add_u32 v5, v5, v6
    v_add_u32 v5, 23199744, v5
    buffer_load_dwordx4 v[8:11], v5, s[8:11], 0 offen
    v_mul_u32_u24 v7, 2688, v3
    v_add_u32 v7, v7, v6
    s_waitcnt vmcnt(0)
    ds_write_b128 v7, v[8:11]
    v_add_u32 v2, 768, v1
    s_mov_b32 s12, 3121
    v_mul_lo_u32 v3, v2, s12
    v_lshrrev_b32 v3, 19, v3
    v_mul_u32_u24 v4, 168, v3
    v_sub_u32 v4, v2, v4
    v_lshlrev_b32 v5, 12, v3
    v_lshlrev_b32 v6, 4, v4
    v_add_u32 v5, v5, v6
    v_add_u32 v5, 23199744, v5
    buffer_load_dwordx4 v[8:11], v5, s[8:11], 0 offen
    v_mul_u32_u24 v7, 2688, v3
    v_add_u32 v7, v7, v6
    s_waitcnt vmcnt(0)
    ds_write_b128 v7, v[8:11]
    v_add_u32 v2, 1024, v1
    s_mov_b32 s12, 3121
    v_mul_lo_u32 v3, v2, s12
    v_lshrrev_b32 v3, 19, v3
    v_mul_u32_u24 v4, 168, v3
    v_sub_u32 v4, v2, v4
    v_lshlrev_b32 v5, 12, v3
    v_lshlrev_b32 v6, 4, v4
    v_add_u32 v5, v5, v6
    v_add_u32 v5, 23199744, v5
    buffer_load_dwordx4 v[8:11], v5, s[8:11], 0 offen
    v_mul_u32_u24 v7, 2688, v3
    v_add_u32 v7, v7, v6
    s_waitcnt vmcnt(0)
    ds_write_b128 v7, v[8:11]
    v_add_u32 v2, 1280, v1
    s_mov_b32 s12, 3121
    v_mul_lo_u32 v3, v2, s12
    v_lshrrev_b32 v3, 19, v3
    v_mul_u32_u24 v4, 168, v3
    v_sub_u32 v4, v2, v4
    v_lshlrev_b32 v5, 12, v3
    v_lshlrev_b32 v6, 4, v4
    v_add_u32 v5, v5, v6
    v_add_u32 v5, 23199744, v5
    buffer_load_dwordx4 v[8:11], v5, s[8:11], 0 offen
    v_mul_u32_u24 v7, 2688, v3
    v_add_u32 v7, v7, v6
    s_waitcnt vmcnt(0)
    ds_write_b128 v7, v[8:11]
    v_add_u32 v2, 1536, v1
    s_mov_b32 s12, 3121
    v_mul_lo_u32 v3, v2, s12
    v_lshrrev_b32 v3, 19, v3
    v_mul_u32_u24 v4, 168, v3
    v_sub_u32 v4, v2, v4
    v_lshlrev_b32 v5, 12, v3
    v_lshlrev_b32 v6, 4, v4
    v_add_u32 v5, v5, v6
    v_add_u32 v5, 23199744, v5
    buffer_load_dwordx4 v[8:11], v5, s[8:11], 0 offen
    v_mul_u32_u24 v7, 2688, v3
    v_add_u32 v7, v7, v6
    s_waitcnt vmcnt(0)
    ds_write_b128 v7, v[8:11]
    v_add_u32 v2, 1792, v1
    s_mov_b32 s12, 3121
    v_mul_lo_u32 v3, v2, s12
    v_lshrrev_b32 v3, 19, v3
    v_mul_u32_u24 v4, 168, v3
    v_sub_u32 v4, v2, v4
    v_lshlrev_b32 v5, 12, v3
    v_lshlrev_b32 v6, 4, v4
    v_add_u32 v5, v5, v6
    v_add_u32 v5, 23199744, v5
    buffer_load_dwordx4 v[8:11], v5, s[8:11], 0 offen
    v_mul_u32_u24 v7, 2688, v3
    v_add_u32 v7, v7, v6
    s_waitcnt vmcnt(0)
    ds_write_b128 v7, v[8:11]
    v_add_u32 v2, 2048, v1
    s_mov_b32 s12, 3121
    v_mul_lo_u32 v3, v2, s12
    v_lshrrev_b32 v3, 19, v3
    v_mul_u32_u24 v4, 168, v3
    v_sub_u32 v4, v2, v4
    v_lshlrev_b32 v5, 12, v3
    v_lshlrev_b32 v6, 4, v4
    v_add_u32 v5, v5, v6
    v_add_u32 v5, 23199744, v5
    buffer_load_dwordx4 v[8:11], v5, s[8:11], 0 offen
    v_mul_u32_u24 v7, 2688, v3
    v_add_u32 v7, v7, v6
    s_waitcnt vmcnt(0)
    ds_write_b128 v7, v[8:11]
    v_add_u32 v2, 2304, v1
    s_mov_b32 s12, 3121
    v_mul_lo_u32 v3, v2, s12
    v_lshrrev_b32 v3, 19, v3
    v_mul_u32_u24 v4, 168, v3
    v_sub_u32 v4, v2, v4
    v_lshlrev_b32 v5, 12, v3
    v_lshlrev_b32 v6, 4, v4
    v_add_u32 v5, v5, v6
    v_add_u32 v5, 23199744, v5
    buffer_load_dwordx4 v[8:11], v5, s[8:11], 0 offen
    v_mul_u32_u24 v7, 2688, v3
    v_add_u32 v7, v7, v6
    s_waitcnt vmcnt(0)
    ds_write_b128 v7, v[8:11]
    v_add_u32 v2, 2560, v1
    s_mov_b32 s12, 3121
    v_mul_lo_u32 v3, v2, s12
    v_lshrrev_b32 v3, 19, v3
    v_mul_u32_u24 v4, 168, v3
    v_sub_u32 v4, v2, v4
    v_lshlrev_b32 v5, 12, v3
    v_lshlrev_b32 v6, 4, v4
    v_add_u32 v5, v5, v6
    v_add_u32 v5, 23199744, v5
    buffer_load_dwordx4 v[8:11], v5, s[8:11], 0 offen
    v_mul_u32_u24 v7, 2688, v3
    v_add_u32 v7, v7, v6
    s_waitcnt vmcnt(0)
    ds_write_b128 v7, v[8:11]
    v_add_u32 v2, 2816, v1
    s_mov_b32 s12, 3121
    v_mul_lo_u32 v3, v2, s12
    v_lshrrev_b32 v3, 19, v3
    v_mul_u32_u24 v4, 168, v3
    v_sub_u32 v4, v2, v4
    v_lshlrev_b32 v5, 12, v3
    v_lshlrev_b32 v6, 4, v4
    v_add_u32 v5, v5, v6
    v_add_u32 v5, 23199744, v5
    buffer_load_dwordx4 v[8:11], v5, s[8:11], 0 offen
    v_mul_u32_u24 v7, 2688, v3
    v_add_u32 v7, v7, v6
    s_waitcnt vmcnt(0)
    ds_write_b128 v7, v[8:11]
    v_add_u32 v2, 3072, v1
    s_mov_b32 s12, 3121
    v_mul_lo_u32 v3, v2, s12
    v_lshrrev_b32 v3, 19, v3
    v_mul_u32_u24 v4, 168, v3
    v_sub_u32 v4, v2, v4
    v_lshlrev_b32 v5, 12, v3
    v_lshlrev_b32 v6, 4, v4
    v_add_u32 v5, v5, v6
    v_add_u32 v5, 23199744, v5
    buffer_load_dwordx4 v[8:11], v5, s[8:11], 0 offen
    v_mul_u32_u24 v7, 2688, v3
    v_add_u32 v7, v7, v6
    s_waitcnt vmcnt(0)
    ds_write_b128 v7, v[8:11]
    v_add_u32 v2, 3328, v1
    s_mov_b32 s12, 3121
    v_mul_lo_u32 v3, v2, s12
    v_lshrrev_b32 v3, 19, v3
    v_mul_u32_u24 v4, 168, v3
    v_sub_u32 v4, v2, v4
    v_lshlrev_b32 v5, 12, v3
    v_lshlrev_b32 v6, 4, v4
    v_add_u32 v5, v5, v6
    v_add_u32 v5, 23199744, v5
    buffer_load_dwordx4 v[8:11], v5, s[8:11], 0 offen
    v_mul_u32_u24 v7, 2688, v3
    v_add_u32 v7, v7, v6
    s_waitcnt vmcnt(0)
    ds_write_b128 v7, v[8:11]
    v_add_u32 v2, 3584, v1
    s_mov_b32 s12, 3121
    v_mul_lo_u32 v3, v2, s12
    v_lshrrev_b32 v3, 19, v3
    v_mul_u32_u24 v4, 168, v3
    v_sub_u32 v4, v2, v4
    v_lshlrev_b32 v5, 12, v3
    v_lshlrev_b32 v6, 4, v4
    v_add_u32 v5, v5, v6
    v_add_u32 v5, 23199744, v5
    buffer_load_dwordx4 v[8:11], v5, s[8:11], 0 offen
    v_mul_u32_u24 v7, 2688, v3
    v_add_u32 v7, v7, v6
    s_waitcnt vmcnt(0)
    ds_write_b128 v7, v[8:11]
    v_add_u32 v2, 3840, v1
    s_mov_b32 s12, 3121
    v_mul_lo_u32 v3, v2, s12
    v_lshrrev_b32 v3, 19, v3
    v_mul_u32_u24 v4, 168, v3
    v_sub_u32 v4, v2, v4
    v_lshlrev_b32 v5, 12, v3
    v_lshlrev_b32 v6, 4, v4
    v_add_u32 v5, v5, v6
    v_add_u32 v5, 23199744, v5
    buffer_load_dwordx4 v[8:11], v5, s[8:11], 0 offen
    v_mul_u32_u24 v7, 2688, v3
    v_add_u32 v7, v7, v6
    s_waitcnt vmcnt(0)
    ds_write_b128 v7, v[8:11]
    v_add_u32 v2, 4096, v1
    s_mov_b32 s12, 3121
    v_mul_lo_u32 v3, v2, s12
    v_lshrrev_b32 v3, 19, v3
    v_mul_u32_u24 v4, 168, v3
    v_sub_u32 v4, v2, v4
    v_lshlrev_b32 v5, 12, v3
    v_lshlrev_b32 v6, 4, v4
    v_add_u32 v5, v5, v6
    v_add_u32 v5, 23199744, v5
    buffer_load_dwordx4 v[8:11], v5, s[8:11], 0 offen
    v_mul_u32_u24 v7, 2688, v3
    v_add_u32 v7, v7, v6
    s_waitcnt vmcnt(0)
    ds_write_b128 v7, v[8:11]
    v_add_u32 v2, 4352, v1
    s_mov_b32 s12, 3121
    v_mul_lo_u32 v3, v2, s12
    v_lshrrev_b32 v3, 19, v3
    v_mul_u32_u24 v4, 168, v3
    v_sub_u32 v4, v2, v4
    v_lshlrev_b32 v5, 12, v3
    v_lshlrev_b32 v6, 4, v4
    v_add_u32 v5, v5, v6
    v_add_u32 v5, 23199744, v5
    buffer_load_dwordx4 v[8:11], v5, s[8:11], 0 offen
    v_mul_u32_u24 v7, 2688, v3
    v_add_u32 v7, v7, v6
    s_waitcnt vmcnt(0)
    ds_write_b128 v7, v[8:11]
    v_add_u32 v2, 4608, v1
    s_mov_b32 s12, 3121
    v_mul_lo_u32 v3, v2, s12
    v_lshrrev_b32 v3, 19, v3
    v_mul_u32_u24 v4, 168, v3
    v_sub_u32 v4, v2, v4
    v_lshlrev_b32 v5, 12, v3
    v_lshlrev_b32 v6, 4, v4
    v_add_u32 v5, v5, v6
    v_add_u32 v5, 23199744, v5
    buffer_load_dwordx4 v[8:11], v5, s[8:11], 0 offen
    v_mul_u32_u24 v7, 2688, v3
    v_add_u32 v7, v7, v6
    s_waitcnt vmcnt(0)
    ds_write_b128 v7, v[8:11]
    v_add_u32 v2, 4864, v1
    s_mov_b32 s12, 3121
    v_mul_lo_u32 v3, v2, s12
    v_lshrrev_b32 v3, 19, v3
    v_mul_u32_u24 v4, 168, v3
    v_sub_u32 v4, v2, v4
    v_lshlrev_b32 v5, 12, v3
    v_lshlrev_b32 v6, 4, v4
    v_add_u32 v5, v5, v6
    v_add_u32 v5, 23199744, v5
    buffer_load_dwordx4 v[8:11], v5, s[8:11], 0 offen
    v_mul_u32_u24 v7, 2688, v3
    v_add_u32 v7, v7, v6
    s_waitcnt vmcnt(0)
    ds_write_b128 v7, v[8:11]
    v_add_u32 v2, 5120, v1
    s_mov_b32 s12, 3121
    v_mul_lo_u32 v3, v2, s12
    v_lshrrev_b32 v3, 19, v3
    v_mul_u32_u24 v4, 168, v3
    v_sub_u32 v4, v2, v4
    v_lshlrev_b32 v5, 12, v3
    v_lshlrev_b32 v6, 4, v4
    v_add_u32 v5, v5, v6
    v_add_u32 v5, 23199744, v5
    buffer_load_dwordx4 v[8:11], v5, s[8:11], 0 offen
    v_mul_u32_u24 v7, 2688, v3
    v_add_u32 v7, v7, v6
    s_waitcnt vmcnt(0)
    ds_write_b128 v7, v[8:11]
    s_waitcnt lgkmcnt(0)
    s_barrier
    v_and_b32 v2, 31, v0
    v_lshrrev_b32 v3, 5, v0
    s_lshl_b32 s12, s2, 3
    v_add_u32 v3, s12, v3
    v_mul_u32_u24 v4, 1280, v3
    v_mul_u32_u24 v5, 40, v2
    v_add_u32 v4, v4, v5
    v_add_u32 v6, 8388608, v4
    buffer_load_dwordx2 v[8:9], v6, s[8:11], 0 offen offset:0
    buffer_load_dwordx2 v[10:11], v6, s[8:11], 0 offen offset:8
    buffer_load_dwordx2 v[12:13], v6, s[8:11], 0 offen offset:16
    buffer_load_dwordx2 v[14:15], v6, s[8:11], 0 offen offset:24
    buffer_load_dwordx2 v[16:17], v6, s[8:11], 0 offen offset:32
    s_waitcnt vmcnt(0)
    v_lshlrev_b32 v40, 16, v8
    v_and_b32 v41, 0xffff0000, v8
    v_mul_f32 v44, 1.4426950408889634, v40
    v_exp_f32 v44, v44
    v_add_f32 v42, 1.0, v40
    v_cmp_lt_f32 vcc, 0, v40
    s_nop 1
    v_cndmask_b32 v42, v44, v42, vcc
    v_add_f32 v42, 0x358637bd, v42
    v_mul_f32 v44, 1.4426950408889634, v41
    v_exp_f32 v44, v44
    v_add_f32 v43, 1.0, v41
    v_cmp_lt_f32 vcc, 0, v41
    s_nop 1
    v_cndmask_b32 v43, v44, v43, vcc
    v_add_f32 v43, 0x358637bd, v43
    v_cvt_pk_bf16_f32 v45, v42, v43
    v_lshlrev_b32 v20, 16, v45
    v_and_b32 v21, 0xffff0000, v45
    v_lshlrev_b32 v40, 16, v9
    v_and_b32 v41, 0xffff0000, v9
    v_mul_f32 v44, 1.4426950408889634, v40
    v_exp_f32 v44, v44
    v_add_f32 v42, 1.0, v40
    v_cmp_lt_f32 vcc, 0, v40
    s_nop 1
    v_cndmask_b32 v42, v44, v42, vcc
    v_add_f32 v42, 0x358637bd, v42
    v_mul_f32 v44, 1.4426950408889634, v41
    v_exp_f32 v44, v44
    v_add_f32 v43, 1.0, v41
    v_cmp_lt_f32 vcc, 0, v41
    s_nop 1
    v_cndmask_b32 v43, v44, v43, vcc
    v_add_f32 v43, 0x358637bd, v43
    v_cvt_pk_bf16_f32 v45, v42, v43
    v_lshlrev_b32 v22, 16, v45
    v_and_b32 v23, 0xffff0000, v45
    v_lshlrev_b32 v40, 16, v10
    v_and_b32 v41, 0xffff0000, v10
    v_mul_f32 v44, 1.4426950408889634, v40
    v_exp_f32 v44, v44
    v_add_f32 v42, 1.0, v40
    v_cmp_lt_f32 vcc, 0, v40
    s_nop 1
    v_cndmask_b32 v42, v44, v42, vcc
    v_add_f32 v42, 0x358637bd, v42
    v_mul_f32 v44, 1.4426950408889634, v41
    v_exp_f32 v44, v44
    v_add_f32 v43, 1.0, v41
    v_cmp_lt_f32 vcc, 0, v41
    s_nop 1
    v_cndmask_b32 v43, v44, v43, vcc
    v_add_f32 v43, 0x358637bd, v43
    v_cvt_pk_bf16_f32 v45, v42, v43
    v_lshlrev_b32 v24, 16, v45
    v_and_b32 v25, 0xffff0000, v45
    v_lshlrev_b32 v40, 16, v11
    v_and_b32 v41, 0xffff0000, v11
    v_mul_f32 v44, 1.4426950408889634, v40
    v_exp_f32 v44, v44
    v_add_f32 v42, 1.0, v40
    v_cmp_lt_f32 vcc, 0, v40
    s_nop 1
    v_cndmask_b32 v42, v44, v42, vcc
    v_add_f32 v42, 0x358637bd, v42
    v_mul_f32 v44, 1.4426950408889634, v41
    v_exp_f32 v44, v44
    v_add_f32 v43, 1.0, v41
    v_cmp_lt_f32 vcc, 0, v41
    s_nop 1
    v_cndmask_b32 v43, v44, v43, vcc
    v_add_f32 v43, 0x358637bd, v43
    v_cvt_pk_bf16_f32 v45, v42, v43
    v_lshlrev_b32 v26, 16, v45
    v_and_b32 v27, 0xffff0000, v45
    v_lshlrev_b32 v40, 16, v12
    v_and_b32 v41, 0xffff0000, v12
    v_mul_f32 v44, 1.4426950408889634, v40
    v_exp_f32 v44, v44
    v_add_f32 v42, 1.0, v40
    v_cmp_lt_f32 vcc, 0, v40
    s_nop 1
    v_cndmask_b32 v42, v44, v42, vcc
    v_add_f32 v42, 0x358637bd, v42
    v_mul_f32 v44, 1.4426950408889634, v41
    v_exp_f32 v44, v44
    v_add_f32 v43, 1.0, v41
    v_cmp_lt_f32 vcc, 0, v41
    s_nop 1
    v_cndmask_b32 v43, v44, v43, vcc
    v_add_f32 v43, 0x358637bd, v43
    v_cvt_pk_bf16_f32 v45, v42, v43
    v_lshlrev_b32 v28, 16, v45
    v_and_b32 v29, 0xffff0000, v45
    v_lshlrev_b32 v40, 16, v13
    v_and_b32 v41, 0xffff0000, v13
    v_mul_f32 v44, 1.4426950408889634, v40
    v_exp_f32 v44, v44
    v_add_f32 v42, 1.0, v40
    v_cmp_lt_f32 vcc, 0, v40
    s_nop 1
    v_cndmask_b32 v42, v44, v42, vcc
    v_add_f32 v42, 0x358637bd, v42
    v_mul_f32 v44, 1.4426950408889634, v41
    v_exp_f32 v44, v44
    v_add_f32 v43, 1.0, v41
    v_cmp_lt_f32 vcc, 0, v41
    s_nop 1
    v_cndmask_b32 v43, v44, v43, vcc
    v_add_f32 v43, 0x358637bd, v43
    v_cvt_pk_bf16_f32 v45, v42, v43
    v_lshlrev_b32 v30, 16, v45
    v_and_b32 v31, 0xffff0000, v45
    v_lshlrev_b32 v40, 16, v14
    v_and_b32 v41, 0xffff0000, v14
    v_mul_f32 v44, 1.4426950408889634, v40
    v_exp_f32 v44, v44
    v_add_f32 v42, 1.0, v40
    v_cmp_lt_f32 vcc, 0, v40
    s_nop 1
    v_cndmask_b32 v42, v44, v42, vcc
    v_add_f32 v42, 0x358637bd, v42
    v_mul_f32 v44, 1.4426950408889634, v41
    v_exp_f32 v44, v44
    v_add_f32 v43, 1.0, v41
    v_cmp_lt_f32 vcc, 0, v41
    s_nop 1
    v_cndmask_b32 v43, v44, v43, vcc
    v_add_f32 v43, 0x358637bd, v43
    v_cvt_pk_bf16_f32 v45, v42, v43
    v_lshlrev_b32 v32, 16, v45
    v_and_b32 v33, 0xffff0000, v45
    v_lshlrev_b32 v40, 16, v15
    v_and_b32 v41, 0xffff0000, v15
    v_mul_f32 v44, 1.4426950408889634, v40
    v_exp_f32 v44, v44
    v_add_f32 v42, 1.0, v40
    v_cmp_lt_f32 vcc, 0, v40
    s_nop 1
    v_cndmask_b32 v42, v44, v42, vcc
    v_add_f32 v42, 0x358637bd, v42
    v_mul_f32 v44, 1.4426950408889634, v41
    v_exp_f32 v44, v44
    v_add_f32 v43, 1.0, v41
    v_cmp_lt_f32 vcc, 0, v41
    s_nop 1
    v_cndmask_b32 v43, v44, v43, vcc
    v_add_f32 v43, 0x358637bd, v43
    v_cvt_pk_bf16_f32 v45, v42, v43
    v_lshlrev_b32 v34, 16, v45
    v_and_b32 v35, 0xffff0000, v45
    v_lshlrev_b32 v40, 16, v16
    v_and_b32 v41, 0xffff0000, v16
    v_mul_f32 v44, 1.4426950408889634, v40
    v_exp_f32 v44, v44
    v_add_f32 v42, 1.0, v40
    v_cmp_lt_f32 vcc, 0, v40
    s_nop 1
    v_cndmask_b32 v42, v44, v42, vcc
    v_add_f32 v42, 0x358637bd, v42
    v_mul_f32 v44, 1.4426950408889634, v41
    v_exp_f32 v44, v44
    v_add_f32 v43, 1.0, v41
    v_cmp_lt_f32 vcc, 0, v41
    s_nop 1
    v_cndmask_b32 v43, v44, v43, vcc
    v_add_f32 v43, 0x358637bd, v43
    v_cvt_pk_bf16_f32 v45, v42, v43
    v_lshlrev_b32 v36, 16, v45
    v_and_b32 v37, 0xffff0000, v45
    v_lshlrev_b32 v40, 16, v17
    v_and_b32 v41, 0xffff0000, v17
    v_mul_f32 v44, 1.4426950408889634, v40
    v_exp_f32 v44, v44
    v_add_f32 v42, 1.0, v40
    v_cmp_lt_f32 vcc, 0, v40
    s_nop 1
    v_cndmask_b32 v42, v44, v42, vcc
    v_add_f32 v42, 0x358637bd, v42
    v_mul_f32 v44, 1.4426950408889634, v41
    v_exp_f32 v44, v44
    v_add_f32 v43, 1.0, v41
    v_cmp_lt_f32 vcc, 0, v41
    s_nop 1
    v_cndmask_b32 v43, v44, v43, vcc
    v_add_f32 v43, 0x358637bd, v43
    v_cvt_pk_bf16_f32 v45, v42, v43
    v_lshlrev_b32 v38, 16, v45
    v_and_b32 v39, 0xffff0000, v45
    v_mul_u32_u24 v7, 2688, v2
    ds_read_b128 v[72:75], v7 offset:0
    ds_read_b128 v[76:79], v7 offset:16
    ds_read_b128 v[80:83], v7 offset:32
    ds_read_b128 v[84:87], v7 offset:48
    ds_read_b128 v[88:91], v7 offset:64
    s_waitcnt lgkmcnt(0)
    v_mul_f32 v50, v20, v72
    v_fmac_f32 v50, v21, v73
    v_fmac_f32 v50, v22, v74
    v_fmac_f32 v50, v23, v75
    v_fmac_f32 v50, v24, v76
    v_fmac_f32 v50, v25, v77
    v_fmac_f32 v50, v26, v78
    v_fmac_f32 v50, v27, v79
    v_fmac_f32 v50, v28, v80
    v_fmac_f32 v50, v29, v81
    v_fmac_f32 v50, v30, v82
    v_fmac_f32 v50, v31, v83
    v_fmac_f32 v50, v32, v84
    v_fmac_f32 v50, v33, v85
    v_fmac_f32 v50, v34, v86
    v_fmac_f32 v50, v35, v87
    v_fmac_f32 v50, v36, v88
    v_fmac_f32 v50, v37, v89
    v_fmac_f32 v50, v38, v90
    v_fmac_f32 v50, v39, v91
    ds_read_b128 v[72:75], v7 offset:128
    ds_read_b128 v[76:79], v7 offset:144
    ds_read_b128 v[80:83], v7 offset:160
    ds_read_b128 v[84:87], v7 offset:176
    ds_read_b128 v[88:91], v7 offset:192
    s_waitcnt lgkmcnt(0)
    v_mul_f32 v51, v20, v72
    v_fmac_f32 v51, v21, v73
    v_fmac_f32 v51, v22, v74
    v_fmac_f32 v51, v23, v75
    v_fmac_f32 v51, v24, v76
    v_fmac_f32 v51, v25, v77
    v_fmac_f32 v51, v26, v78
    v_fmac_f32 v51, v27, v79
    v_fmac_f32 v51, v28, v80
    v_fmac_f32 v51, v29, v81
    v_fmac_f32 v51, v30, v82
    v_fmac_f32 v51, v31, v83
    v_fmac_f32 v51, v32, v84
    v_fmac_f32 v51, v33, v85
    v_fmac_f32 v51, v34, v86
    v_fmac_f32 v51, v35, v87
    v_fmac_f32 v51, v36, v88
    v_fmac_f32 v51, v37, v89
    v_fmac_f32 v51, v38, v90
    v_fmac_f32 v51, v39, v91
    ds_read_b128 v[72:75], v7 offset:256
    ds_read_b128 v[76:79], v7 offset:272
    ds_read_b128 v[80:83], v7 offset:288
    ds_read_b128 v[84:87], v7 offset:304
    ds_read_b128 v[88:91], v7 offset:320
    s_waitcnt lgkmcnt(0)
    v_mul_f32 v52, v20, v72
    v_fmac_f32 v52, v21, v73
    v_fmac_f32 v52, v22, v74
    v_fmac_f32 v52, v23, v75
    v_fmac_f32 v52, v24, v76
    v_fmac_f32 v52, v25, v77
    v_fmac_f32 v52, v26, v78
    v_fmac_f32 v52, v27, v79
    v_fmac_f32 v52, v28, v80
    v_fmac_f32 v52, v29, v81
    v_fmac_f32 v52, v30, v82
    v_fmac_f32 v52, v31, v83
    v_fmac_f32 v52, v32, v84
    v_fmac_f32 v52, v33, v85
    v_fmac_f32 v52, v34, v86
    v_fmac_f32 v52, v35, v87
    v_fmac_f32 v52, v36, v88
    v_fmac_f32 v52, v37, v89
    v_fmac_f32 v52, v38, v90
    v_fmac_f32 v52, v39, v91
    ds_read_b128 v[72:75], v7 offset:384
    ds_read_b128 v[76:79], v7 offset:400
    ds_read_b128 v[80:83], v7 offset:416
    ds_read_b128 v[84:87], v7 offset:432
    ds_read_b128 v[88:91], v7 offset:448
    s_waitcnt lgkmcnt(0)
    v_mul_f32 v53, v20, v72
    v_fmac_f32 v53, v21, v73
    v_fmac_f32 v53, v22, v74
    v_fmac_f32 v53, v23, v75
    v_fmac_f32 v53, v24, v76
    v_fmac_f32 v53, v25, v77
    v_fmac_f32 v53, v26, v78
    v_fmac_f32 v53, v27, v79
    v_fmac_f32 v53, v28, v80
    v_fmac_f32 v53, v29, v81
    v_fmac_f32 v53, v30, v82
    v_fmac_f32 v53, v31, v83
    v_fmac_f32 v53, v32, v84
    v_fmac_f32 v53, v33, v85
    v_fmac_f32 v53, v34, v86
    v_fmac_f32 v53, v35, v87
    v_fmac_f32 v53, v36, v88
    v_fmac_f32 v53, v37, v89
    v_fmac_f32 v53, v38, v90
    v_fmac_f32 v53, v39, v91
    ds_read_b128 v[72:75], v7 offset:512
    ds_read_b128 v[76:79], v7 offset:528
    ds_read_b128 v[80:83], v7 offset:544
    ds_read_b128 v[84:87], v7 offset:560
    ds_read_b128 v[88:91], v7 offset:576
    s_waitcnt lgkmcnt(0)
    v_mul_f32 v54, v20, v72
    v_fmac_f32 v54, v21, v73
    v_fmac_f32 v54, v22, v74
    v_fmac_f32 v54, v23, v75
    v_fmac_f32 v54, v24, v76
    v_fmac_f32 v54, v25, v77
    v_fmac_f32 v54, v26, v78
    v_fmac_f32 v54, v27, v79
    v_fmac_f32 v54, v28, v80
    v_fmac_f32 v54, v29, v81
    v_fmac_f32 v54, v30, v82
    v_fmac_f32 v54, v31, v83
    v_fmac_f32 v54, v32, v84
    v_fmac_f32 v54, v33, v85
    v_fmac_f32 v54, v34, v86
    v_fmac_f32 v54, v35, v87
    v_fmac_f32 v54, v36, v88
    v_fmac_f32 v54, v37, v89
    v_fmac_f32 v54, v38, v90
    v_fmac_f32 v54, v39, v91
    ds_read_b128 v[72:75], v7 offset:640
    ds_read_b128 v[76:79], v7 offset:656
    ds_read_b128 v[80:83], v7 offset:672
    ds_read_b128 v[84:87], v7 offset:688
    ds_read_b128 v[88:91], v7 offset:704
    s_waitcnt lgkmcnt(0)
    v_mul_f32 v55, v20, v72
    v_fmac_f32 v55, v21, v73
    v_fmac_f32 v55, v22, v74
    v_fmac_f32 v55, v23, v75
    v_fmac_f32 v55, v24, v76
    v_fmac_f32 v55, v25, v77
    v_fmac_f32 v55, v26, v78
    v_fmac_f32 v55, v27, v79
    v_fmac_f32 v55, v28, v80
    v_fmac_f32 v55, v29, v81
    v_fmac_f32 v55, v30, v82
    v_fmac_f32 v55, v31, v83
    v_fmac_f32 v55, v32, v84
    v_fmac_f32 v55, v33, v85
    v_fmac_f32 v55, v34, v86
    v_fmac_f32 v55, v35, v87
    v_fmac_f32 v55, v36, v88
    v_fmac_f32 v55, v37, v89
    v_fmac_f32 v55, v38, v90
    v_fmac_f32 v55, v39, v91
    ds_read_b128 v[72:75], v7 offset:768
    ds_read_b128 v[76:79], v7 offset:784
    ds_read_b128 v[80:83], v7 offset:800
    ds_read_b128 v[84:87], v7 offset:816
    ds_read_b128 v[88:91], v7 offset:832
    s_waitcnt lgkmcnt(0)
    v_mul_f32 v56, v20, v72
    v_fmac_f32 v56, v21, v73
    v_fmac_f32 v56, v22, v74
    v_fmac_f32 v56, v23, v75
    v_fmac_f32 v56, v24, v76
    v_fmac_f32 v56, v25, v77
    v_fmac_f32 v56, v26, v78
    v_fmac_f32 v56, v27, v79
    v_fmac_f32 v56, v28, v80
    v_fmac_f32 v56, v29, v81
    v_fmac_f32 v56, v30, v82
    v_fmac_f32 v56, v31, v83
    v_fmac_f32 v56, v32, v84
    v_fmac_f32 v56, v33, v85
    v_fmac_f32 v56, v34, v86
    v_fmac_f32 v56, v35, v87
    v_fmac_f32 v56, v36, v88
    v_fmac_f32 v56, v37, v89
    v_fmac_f32 v56, v38, v90
    v_fmac_f32 v56, v39, v91
    ds_read_b128 v[72:75], v7 offset:896
    ds_read_b128 v[76:79], v7 offset:912
    ds_read_b128 v[80:83], v7 offset:928
    ds_read_b128 v[84:87], v7 offset:944
    ds_read_b128 v[88:91], v7 offset:960
    s_waitcnt lgkmcnt(0)
    v_mul_f32 v57, v20, v72
    v_fmac_f32 v57, v21, v73
    v_fmac_f32 v57, v22, v74
    v_fmac_f32 v57, v23, v75
    v_fmac_f32 v57, v24, v76
    v_fmac_f32 v57, v25, v77
    v_fmac_f32 v57, v26, v78
    v_fmac_f32 v57, v27, v79
    v_fmac_f32 v57, v28, v80
    v_fmac_f32 v57, v29, v81
    v_fmac_f32 v57, v30, v82
    v_fmac_f32 v57, v31, v83
    v_fmac_f32 v57, v32, v84
    v_fmac_f32 v57, v33, v85
    v_fmac_f32 v57, v34, v86
    v_fmac_f32 v57, v35, v87
    v_fmac_f32 v57, v36, v88
    v_fmac_f32 v57, v37, v89
    v_fmac_f32 v57, v38, v90
    v_fmac_f32 v57, v39, v91
    ds_read_b128 v[72:75], v7 offset:1024
    ds_read_b128 v[76:79], v7 offset:1040
    ds_read_b128 v[80:83], v7 offset:1056
    ds_read_b128 v[84:87], v7 offset:1072
    ds_read_b128 v[88:91], v7 offset:1088
    s_waitcnt lgkmcnt(0)
    v_mul_f32 v58, v20, v72
    v_fmac_f32 v58, v21, v73
    v_fmac_f32 v58, v22, v74
    v_fmac_f32 v58, v23, v75
    v_fmac_f32 v58, v24, v76
    v_fmac_f32 v58, v25, v77
    v_fmac_f32 v58, v26, v78
    v_fmac_f32 v58, v27, v79
    v_fmac_f32 v58, v28, v80
    v_fmac_f32 v58, v29, v81
    v_fmac_f32 v58, v30, v82
    v_fmac_f32 v58, v31, v83
    v_fmac_f32 v58, v32, v84
    v_fmac_f32 v58, v33, v85
    v_fmac_f32 v58, v34, v86
    v_fmac_f32 v58, v35, v87
    v_fmac_f32 v58, v36, v88
    v_fmac_f32 v58, v37, v89
    v_fmac_f32 v58, v38, v90
    v_fmac_f32 v58, v39, v91
    ds_read_b128 v[72:75], v7 offset:1152
    ds_read_b128 v[76:79], v7 offset:1168
    ds_read_b128 v[80:83], v7 offset:1184
    ds_read_b128 v[84:87], v7 offset:1200
    ds_read_b128 v[88:91], v7 offset:1216
    s_waitcnt lgkmcnt(0)
    v_mul_f32 v59, v20, v72
    v_fmac_f32 v59, v21, v73
    v_fmac_f32 v59, v22, v74
    v_fmac_f32 v59, v23, v75
    v_fmac_f32 v59, v24, v76
    v_fmac_f32 v59, v25, v77
    v_fmac_f32 v59, v26, v78
    v_fmac_f32 v59, v27, v79
    v_fmac_f32 v59, v28, v80
    v_fmac_f32 v59, v29, v81
    v_fmac_f32 v59, v30, v82
    v_fmac_f32 v59, v31, v83
    v_fmac_f32 v59, v32, v84
    v_fmac_f32 v59, v33, v85
    v_fmac_f32 v59, v34, v86
    v_fmac_f32 v59, v35, v87
    v_fmac_f32 v59, v36, v88
    v_fmac_f32 v59, v37, v89
    v_fmac_f32 v59, v38, v90
    v_fmac_f32 v59, v39, v91
    ds_read_b128 v[72:75], v7 offset:1280
    ds_read_b128 v[76:79], v7 offset:1296
    ds_read_b128 v[80:83], v7 offset:1312
    ds_read_b128 v[84:87], v7 offset:1328
    ds_read_b128 v[88:91], v7 offset:1344
    s_waitcnt lgkmcnt(0)
    v_mul_f32 v60, v20, v72
    v_fmac_f32 v60, v21, v73
    v_fmac_f32 v60, v22, v74
    v_fmac_f32 v60, v23, v75
    v_fmac_f32 v60, v24, v76
    v_fmac_f32 v60, v25, v77
    v_fmac_f32 v60, v26, v78
    v_fmac_f32 v60, v27, v79
    v_fmac_f32 v60, v28, v80
    v_fmac_f32 v60, v29, v81
    v_fmac_f32 v60, v30, v82
    v_fmac_f32 v60, v31, v83
    v_fmac_f32 v60, v32, v84
    v_fmac_f32 v60, v33, v85
    v_fmac_f32 v60, v34, v86
    v_fmac_f32 v60, v35, v87
    v_fmac_f32 v60, v36, v88
    v_fmac_f32 v60, v37, v89
    v_fmac_f32 v60, v38, v90
    v_fmac_f32 v60, v39, v91
    ds_read_b128 v[72:75], v7 offset:1408
    ds_read_b128 v[76:79], v7 offset:1424
    ds_read_b128 v[80:83], v7 offset:1440
    ds_read_b128 v[84:87], v7 offset:1456
    ds_read_b128 v[88:91], v7 offset:1472
    s_waitcnt lgkmcnt(0)
    v_mul_f32 v61, v20, v72
    v_fmac_f32 v61, v21, v73
    v_fmac_f32 v61, v22, v74
    v_fmac_f32 v61, v23, v75
    v_fmac_f32 v61, v24, v76
    v_fmac_f32 v61, v25, v77
    v_fmac_f32 v61, v26, v78
    v_fmac_f32 v61, v27, v79
    v_fmac_f32 v61, v28, v80
    v_fmac_f32 v61, v29, v81
    v_fmac_f32 v61, v30, v82
    v_fmac_f32 v61, v31, v83
    v_fmac_f32 v61, v32, v84
    v_fmac_f32 v61, v33, v85
    v_fmac_f32 v61, v34, v86
    v_fmac_f32 v61, v35, v87
    v_fmac_f32 v61, v36, v88
    v_fmac_f32 v61, v37, v89
    v_fmac_f32 v61, v38, v90
    v_fmac_f32 v61, v39, v91
    ds_read_b128 v[72:75], v7 offset:1536
    ds_read_b128 v[76:79], v7 offset:1552
    ds_read_b128 v[80:83], v7 offset:1568
    ds_read_b128 v[84:87], v7 offset:1584
    ds_read_b128 v[88:91], v7 offset:1600
    s_waitcnt lgkmcnt(0)
    v_mul_f32 v62, v20, v72
    v_fmac_f32 v62, v21, v73
    v_fmac_f32 v62, v22, v74
    v_fmac_f32 v62, v23, v75
    v_fmac_f32 v62, v24, v76
    v_fmac_f32 v62, v25, v77
    v_fmac_f32 v62, v26, v78
    v_fmac_f32 v62, v27, v79
    v_fmac_f32 v62, v28, v80
    v_fmac_f32 v62, v29, v81
    v_fmac_f32 v62, v30, v82
    v_fmac_f32 v62, v31, v83
    v_fmac_f32 v62, v32, v84
    v_fmac_f32 v62, v33, v85
    v_fmac_f32 v62, v34, v86
    v_fmac_f32 v62, v35, v87
    v_fmac_f32 v62, v36, v88
    v_fmac_f32 v62, v37, v89
    v_fmac_f32 v62, v38, v90
    v_fmac_f32 v62, v39, v91
    ds_read_b128 v[72:75], v7 offset:1664
    ds_read_b128 v[76:79], v7 offset:1680
    ds_read_b128 v[80:83], v7 offset:1696
    ds_read_b128 v[84:87], v7 offset:1712
    ds_read_b128 v[88:91], v7 offset:1728
    s_waitcnt lgkmcnt(0)
    v_mul_f32 v63, v20, v72
    v_fmac_f32 v63, v21, v73
    v_fmac_f32 v63, v22, v74
    v_fmac_f32 v63, v23, v75
    v_fmac_f32 v63, v24, v76
    v_fmac_f32 v63, v25, v77
    v_fmac_f32 v63, v26, v78
    v_fmac_f32 v63, v27, v79
    v_fmac_f32 v63, v28, v80
    v_fmac_f32 v63, v29, v81
    v_fmac_f32 v63, v30, v82
    v_fmac_f32 v63, v31, v83
    v_fmac_f32 v63, v32, v84
    v_fmac_f32 v63, v33, v85
    v_fmac_f32 v63, v34, v86
    v_fmac_f32 v63, v35, v87
    v_fmac_f32 v63, v36, v88
    v_fmac_f32 v63, v37, v89
    v_fmac_f32 v63, v38, v90
    v_fmac_f32 v63, v39, v91
    ds_read_b128 v[72:75], v7 offset:1792
    ds_read_b128 v[76:79], v7 offset:1808
    ds_read_b128 v[80:83], v7 offset:1824
    ds_read_b128 v[84:87], v7 offset:1840
    ds_read_b128 v[88:91], v7 offset:1856
    s_waitcnt lgkmcnt(0)
    v_mul_f32 v64, v20, v72
    v_fmac_f32 v64, v21, v73
    v_fmac_f32 v64, v22, v74
    v_fmac_f32 v64, v23, v75
    v_fmac_f32 v64, v24, v76
    v_fmac_f32 v64, v25, v77
    v_fmac_f32 v64, v26, v78
    v_fmac_f32 v64, v27, v79
    v_fmac_f32 v64, v28, v80
    v_fmac_f32 v64, v29, v81
    v_fmac_f32 v64, v30, v82
    v_fmac_f32 v64, v31, v83
    v_fmac_f32 v64, v32, v84
    v_fmac_f32 v64, v33, v85
    v_fmac_f32 v64, v34, v86
    v_fmac_f32 v64, v35, v87
    v_fmac_f32 v64, v36, v88
    v_fmac_f32 v64, v37, v89
    v_fmac_f32 v64, v38, v90
    v_fmac_f32 v64, v39, v91
    ds_read_b128 v[72:75], v7 offset:1920
    ds_read_b128 v[76:79], v7 offset:1936
    ds_read_b128 v[80:83], v7 offset:1952
    ds_read_b128 v[84:87], v7 offset:1968
    ds_read_b128 v[88:91], v7 offset:1984
    s_waitcnt lgkmcnt(0)
    v_mul_f32 v65, v20, v72
    v_fmac_f32 v65, v21, v73
    v_fmac_f32 v65, v22, v74
    v_fmac_f32 v65, v23, v75
    v_fmac_f32 v65, v24, v76
    v_fmac_f32 v65, v25, v77
    v_fmac_f32 v65, v26, v78
    v_fmac_f32 v65, v27, v79
    v_fmac_f32 v65, v28, v80
    v_fmac_f32 v65, v29, v81
    v_fmac_f32 v65, v30, v82
    v_fmac_f32 v65, v31, v83
    v_fmac_f32 v65, v32, v84
    v_fmac_f32 v65, v33, v85
    v_fmac_f32 v65, v34, v86
    v_fmac_f32 v65, v35, v87
    v_fmac_f32 v65, v36, v88
    v_fmac_f32 v65, v37, v89
    v_fmac_f32 v65, v38, v90
    v_fmac_f32 v65, v39, v91
    ds_read_b128 v[72:75], v7 offset:2048
    ds_read_b128 v[76:79], v7 offset:2064
    ds_read_b128 v[80:83], v7 offset:2080
    ds_read_b128 v[84:87], v7 offset:2096
    ds_read_b128 v[88:91], v7 offset:2112
    s_waitcnt lgkmcnt(0)
    v_mul_f32 v66, v20, v72
    v_fmac_f32 v66, v21, v73
    v_fmac_f32 v66, v22, v74
    v_fmac_f32 v66, v23, v75
    v_fmac_f32 v66, v24, v76
    v_fmac_f32 v66, v25, v77
    v_fmac_f32 v66, v26, v78
    v_fmac_f32 v66, v27, v79
    v_fmac_f32 v66, v28, v80
    v_fmac_f32 v66, v29, v81
    v_fmac_f32 v66, v30, v82
    v_fmac_f32 v66, v31, v83
    v_fmac_f32 v66, v32, v84
    v_fmac_f32 v66, v33, v85
    v_fmac_f32 v66, v34, v86
    v_fmac_f32 v66, v35, v87
    v_fmac_f32 v66, v36, v88
    v_fmac_f32 v66, v37, v89
    v_fmac_f32 v66, v38, v90
    v_fmac_f32 v66, v39, v91
    ds_read_b128 v[72:75], v7 offset:2176
    ds_read_b128 v[76:79], v7 offset:2192
    ds_read_b128 v[80:83], v7 offset:2208
    ds_read_b128 v[84:87], v7 offset:2224
    ds_read_b128 v[88:91], v7 offset:2240
    s_waitcnt lgkmcnt(0)
    v_mul_f32 v67, v20, v72
    v_fmac_f32 v67, v21, v73
    v_fmac_f32 v67, v22, v74
    v_fmac_f32 v67, v23, v75
    v_fmac_f32 v67, v24, v76
    v_fmac_f32 v67, v25, v77
    v_fmac_f32 v67, v26, v78
    v_fmac_f32 v67, v27, v79
    v_fmac_f32 v67, v28, v80
    v_fmac_f32 v67, v29, v81
    v_fmac_f32 v67, v30, v82
    v_fmac_f32 v67, v31, v83
    v_fmac_f32 v67, v32, v84
    v_fmac_f32 v67, v33, v85
    v_fmac_f32 v67, v34, v86
    v_fmac_f32 v67, v35, v87
    v_fmac_f32 v67, v36, v88
    v_fmac_f32 v67, v37, v89
    v_fmac_f32 v67, v38, v90
    v_fmac_f32 v67, v39, v91
    ds_read_b128 v[72:75], v7 offset:2304
    ds_read_b128 v[76:79], v7 offset:2320
    ds_read_b128 v[80:83], v7 offset:2336
    ds_read_b128 v[84:87], v7 offset:2352
    ds_read_b128 v[88:91], v7 offset:2368
    s_waitcnt lgkmcnt(0)
    v_mul_f32 v68, v20, v72
    v_fmac_f32 v68, v21, v73
    v_fmac_f32 v68, v22, v74
    v_fmac_f32 v68, v23, v75
    v_fmac_f32 v68, v24, v76
    v_fmac_f32 v68, v25, v77
    v_fmac_f32 v68, v26, v78
    v_fmac_f32 v68, v27, v79
    v_fmac_f32 v68, v28, v80
    v_fmac_f32 v68, v29, v81
    v_fmac_f32 v68, v30, v82
    v_fmac_f32 v68, v31, v83
    v_fmac_f32 v68, v32, v84
    v_fmac_f32 v68, v33, v85
    v_fmac_f32 v68, v34, v86
    v_fmac_f32 v68, v35, v87
    v_fmac_f32 v68, v36, v88
    v_fmac_f32 v68, v37, v89
    v_fmac_f32 v68, v38, v90
    v_fmac_f32 v68, v39, v91
    ds_read_b128 v[72:75], v7 offset:2432
    ds_read_b128 v[76:79], v7 offset:2448
    ds_read_b128 v[80:83], v7 offset:2464
    ds_read_b128 v[84:87], v7 offset:2480
    ds_read_b128 v[88:91], v7 offset:2496
    s_waitcnt lgkmcnt(0)
    v_mul_f32 v69, v20, v72
    v_fmac_f32 v69, v21, v73
    v_fmac_f32 v69, v22, v74
    v_fmac_f32 v69, v23, v75
    v_fmac_f32 v69, v24, v76
    v_fmac_f32 v69, v25, v77
    v_fmac_f32 v69, v26, v78
    v_fmac_f32 v69, v27, v79
    v_fmac_f32 v69, v28, v80
    v_fmac_f32 v69, v29, v81
    v_fmac_f32 v69, v30, v82
    v_fmac_f32 v69, v31, v83
    v_fmac_f32 v69, v32, v84
    v_fmac_f32 v69, v33, v85
    v_fmac_f32 v69, v34, v86
    v_fmac_f32 v69, v35, v87
    v_fmac_f32 v69, v36, v88
    v_fmac_f32 v69, v37, v89
    v_fmac_f32 v69, v38, v90
    v_fmac_f32 v69, v39, v91
    ds_read_b128 v[72:75], v7 offset:2560
    ds_read_b128 v[76:79], v7 offset:2576
    ds_read_b128 v[80:83], v7 offset:2592
    ds_read_b128 v[84:87], v7 offset:2608
    ds_read_b128 v[88:91], v7 offset:2624
    s_waitcnt lgkmcnt(0)
    v_mul_f32 v70, v20, v72
    v_fmac_f32 v70, v21, v73
    v_fmac_f32 v70, v22, v74
    v_fmac_f32 v70, v23, v75
    v_fmac_f32 v70, v24, v76
    v_fmac_f32 v70, v25, v77
    v_fmac_f32 v70, v26, v78
    v_fmac_f32 v70, v27, v79
    v_fmac_f32 v70, v28, v80
    v_fmac_f32 v70, v29, v81
    v_fmac_f32 v70, v30, v82
    v_fmac_f32 v70, v31, v83
    v_fmac_f32 v70, v32, v84
    v_fmac_f32 v70, v33, v85
    v_fmac_f32 v70, v34, v86
    v_fmac_f32 v70, v35, v87
    v_fmac_f32 v70, v36, v88
    v_fmac_f32 v70, v37, v89
    v_fmac_f32 v70, v38, v90
    v_fmac_f32 v70, v39, v91
    v_add_f32 v70, 0x358637bd, v70
    v_rcp_f32 v70, v70
    s_nop 0
    v_mul_f32 v50, v50, v70
    v_mul_f32 v51, v51, v70
    v_mul_f32 v52, v52, v70
    v_mul_f32 v53, v53, v70
    v_mul_f32 v54, v54, v70
    v_mul_f32 v55, v55, v70
    v_mul_f32 v56, v56, v70
    v_mul_f32 v57, v57, v70
    v_mul_f32 v58, v58, v70
    v_mul_f32 v59, v59, v70
    v_mul_f32 v60, v60, v70
    v_mul_f32 v61, v61, v70
    v_mul_f32 v62, v62, v70
    v_mul_f32 v63, v63, v70
    v_mul_f32 v64, v64, v70
    v_mul_f32 v65, v65, v70
    v_mul_f32 v66, v66, v70
    v_mul_f32 v67, v67, v70
    v_mul_f32 v68, v68, v70
    v_mul_f32 v69, v69, v70
    v_cvt_pk_bf16_f32 v8, v50, v51
    v_cvt_pk_bf16_f32 v9, v52, v53
    v_cvt_pk_bf16_f32 v10, v54, v55
    v_cvt_pk_bf16_f32 v11, v56, v57
    v_cvt_pk_bf16_f32 v12, v58, v59
    v_cvt_pk_bf16_f32 v13, v60, v61
    v_cvt_pk_bf16_f32 v14, v62, v63
    v_cvt_pk_bf16_f32 v15, v64, v65
    v_cvt_pk_bf16_f32 v16, v66, v67
    v_cvt_pk_bf16_f32 v17, v68, v69
    v_add_u32 v6, 18874368, v4
    buffer_store_dwordx2 v[8:9], v6, s[8:11], 0 offen offset:0
    buffer_store_dwordx2 v[10:11], v6, s[8:11], 0 offen offset:8
    buffer_store_dwordx2 v[12:13], v6, s[8:11], 0 offen offset:16
    buffer_store_dwordx2 v[14:15], v6, s[8:11], 0 offen offset:24
    buffer_store_dwordx2 v[16:17], v6, s[8:11], 0 offen offset:32
attn_a2_kernel_end:
    s_endpgm
.section .rodata,"a"
.p2align 6
.amdhsa_kernel attn_a2_kernel
  .amdhsa_next_free_vgpr 96
  .amdhsa_next_free_sgpr 40
  .amdhsa_accum_offset 96
  .amdhsa_group_segment_fixed_size 0
  .amdhsa_kernarg_size 104
  .amdhsa_user_sgpr_count 2
  .amdhsa_user_sgpr_kernarg_segment_ptr 1
  .amdhsa_system_sgpr_workgroup_id_x 1
.end_amdhsa_kernel
.text
.globl wo_a2_kernel
.p2align 8
.type wo_a2_kernel,@function
wo_a2_kernel:
    v_lshrrev_b32 v1, 6, v0
    v_and_b32 v2, 63, v0
    s_nop 0
    v_readfirstlane_b32 s3, v1
    s_cmp_ge_u32 s2, 128
    s_cbranch_scc1 wo_a2_kernel_end
    s_load_dwordx2 s[4:5], s[0:1], 96
    s_load_dwordx2 s[6:7], s[0:1], 80
    s_mul_i32 s20, s2, 1
    s_lshr_b32 s20, s20, 3
    s_mul_i32 s21, s20, 8
    s_sub_u32 s21, s2, s21
    s_lshl_b32 s20, s20, 2
    s_add_u32 s20, s20, s3
    s_mul_i32 s22, s20, 32
    s_mul_i32 s23, s21, 80
    s_waitcnt lgkmcnt(0)
    s_mov_b32 s8, s4
    s_mov_b32 s9, s5
    s_mov_b32 s10, 268435456
    s_mov_b32 s11, 0x00020000
    v_and_b32 v3, 15, v2
    v_lshrrev_b32 v4, 4, v2
    s_mov_b32 s24, 1280
    v_add_u32 v5, s22, v3
    v_mul_lo_u32 v5, v5, s24
    v_lshlrev_b32 v6, 4, v4
    v_add_u32 v5, v5, v6
    v_add_u32 v5, 18874368, v5
    v_mov_b32 v8, v5
    v_add_u32 v9, 20480, v5
    v_lshlrev_b32 v7, 4, v2
    s_mov_b32 s25, 0
    s_mov_b32 s26, 0
    s_mul_i32 s27, s21, 102400
    s_add_u32 s27, s27, s26
    s_add_u32 s27, s27, 29360128
    s_add_u32 s32, s27, 0
    s_add_u32 s33, s27, 20480
    s_add_u32 s34, s27, 40960
    s_add_u32 s35, s27, 61440
    s_add_u32 s36, s27, 81920
    v_accvgpr_write_b32 a0, 0
    v_accvgpr_write_b32 a1, 0
    v_accvgpr_write_b32 a2, 0
    v_accvgpr_write_b32 a3, 0
    v_accvgpr_write_b32 a4, 0
    v_accvgpr_write_b32 a5, 0
    v_accvgpr_write_b32 a6, 0
    v_accvgpr_write_b32 a7, 0
    v_accvgpr_write_b32 a8, 0
    v_accvgpr_write_b32 a9, 0
    v_accvgpr_write_b32 a10, 0
    v_accvgpr_write_b32 a11, 0
    v_accvgpr_write_b32 a12, 0
    v_accvgpr_write_b32 a13, 0
    v_accvgpr_write_b32 a14, 0
    v_accvgpr_write_b32 a15, 0
    v_accvgpr_write_b32 a16, 0
    v_accvgpr_write_b32 a17, 0
    v_accvgpr_write_b32 a18, 0
    v_accvgpr_write_b32 a19, 0
    v_accvgpr_write_b32 a20, 0
    v_accvgpr_write_b32 a21, 0
    v_accvgpr_write_b32 a22, 0
    v_accvgpr_write_b32 a23, 0
    v_accvgpr_write_b32 a24, 0
    v_accvgpr_write_b32 a25, 0
    v_accvgpr_write_b32 a26, 0
    v_accvgpr_write_b32 a27, 0
    v_accvgpr_write_b32 a28, 0
    v_accvgpr_write_b32 a29, 0
    v_accvgpr_write_b32 a30, 0
    v_accvgpr_write_b32 a31, 0
    v_accvgpr_write_b32 a32, 0
    v_accvgpr_write_b32 a33, 0
    v_accvgpr_write_b32 a34, 0
    v_accvgpr_write_b32 a35, 0
    v_accvgpr_write_b32 a36, 0
    v_accvgpr_write_b32 a37, 0
    v_accvgpr_write_b32 a38, 0
    v_accvgpr_write_b32 a39, 0
    buffer_load_dwordx4 v[16:19], v8, s[8:11], s25 offen
    buffer_load_dwordx4 v[20:23], v9, s[8:11], s25 offen
    buffer_load_dwordx4 v[24:27], v7, s[8:11], s32 offen
    buffer_load_dwordx4 v[28:31], v7, s[8:11], s33 offen
    buffer_load_dwordx4 v[32:35], v7, s[8:11], s34 offen
    buffer_load_dwordx4 v[36:39], v7, s[8:11], s35 offen
    buffer_load_dwordx4 v[40:43], v7, s[8:11], s36 offen
    s_mov_b32 s28, 10
wo_a2_kernel_loop0:
    s_add_u32 s25, s25, 64
    s_add_u32 s32, s32, 1024
    s_add_u32 s33, s33, 1024
    s_add_u32 s34, s34, 1024
    s_add_u32 s35, s35, 1024
    s_add_u32 s36, s36, 1024
    buffer_load_dwordx4 v[44:47], v8, s[8:11], s25 offen
    buffer_load_dwordx4 v[48:51], v9, s[8:11], s25 offen
    buffer_load_dwordx4 v[52:55], v7, s[8:11], s32 offen
    buffer_load_dwordx4 v[56:59], v7, s[8:11], s33 offen
    buffer_load_dwordx4 v[60:63], v7, s[8:11], s34 offen
    buffer_load_dwordx4 v[64:67], v7, s[8:11], s35 offen
    buffer_load_dwordx4 v[68:71], v7, s[8:11], s36 offen
    s_waitcnt vmcnt(7)
    v_mfma_f32_16x16x32_bf16 a[0:3], v[24:27], v[16:19], a[0:3]
    v_mfma_f32_16x16x32_bf16 a[20:23], v[24:27], v[20:23], a[20:23]
    v_mfma_f32_16x16x32_bf16 a[4:7], v[28:31], v[16:19], a[4:7]
    v_mfma_f32_16x16x32_bf16 a[24:27], v[28:31], v[20:23], a[24:27]
    v_mfma_f32_16x16x32_bf16 a[8:11], v[32:35], v[16:19], a[8:11]
    v_mfma_f32_16x16x32_bf16 a[28:31], v[32:35], v[20:23], a[28:31]
    v_mfma_f32_16x16x32_bf16 a[12:15], v[36:39], v[16:19], a[12:15]
    v_mfma_f32_16x16x32_bf16 a[32:35], v[36:39], v[20:23], a[32:35]
    v_mfma_f32_16x16x32_bf16 a[16:19], v[40:43], v[16:19], a[16:19]
    v_mfma_f32_16x16x32_bf16 a[36:39], v[40:43], v[20:23], a[36:39]
    s_sub_u32 s28, s28, 1
    s_cmp_eq_u32 s28, 0
    s_cbranch_scc1 wo_a2_kernel_loop0_last
    s_add_u32 s25, s25, 64
    s_add_u32 s32, s32, 1024
    s_add_u32 s33, s33, 1024
    s_add_u32 s34, s34, 1024
    s_add_u32 s35, s35, 1024
    s_add_u32 s36, s36, 1024
    buffer_load_dwordx4 v[16:19], v8, s[8:11], s25 offen
    buffer_load_dwordx4 v[20:23], v9, s[8:11], s25 offen
    buffer_load_dwordx4 v[24:27], v7, s[8:11], s32 offen
    buffer_load_dwordx4 v[28:31], v7, s[8:11], s33 offen
    buffer_load_dwordx4 v[32:35], v7, s[8:11], s34 offen
    buffer_load_dwordx4 v[36:39], v7, s[8:11], s35 offen
    buffer_load_dwordx4 v[40:43], v7, s[8:11], s36 offen
    s_waitcnt vmcnt(7)
    v_mfma_f32_16x16x32_bf16 a[0:3], v[52:55], v[44:47], a[0:3]
    v_mfma_f32_16x16x32_bf16 a[20:23], v[52:55], v[48:51], a[20:23]
    v_mfma_f32_16x16x32_bf16 a[4:7], v[56:59], v[44:47], a[4:7]
    v_mfma_f32_16x16x32_bf16 a[24:27], v[56:59], v[48:51], a[24:27]
    v_mfma_f32_16x16x32_bf16 a[8:11], v[60:63], v[44:47], a[8:11]
    v_mfma_f32_16x16x32_bf16 a[28:31], v[60:63], v[48:51], a[28:31]
    v_mfma_f32_16x16x32_bf16 a[12:15], v[64:67], v[44:47], a[12:15]
    v_mfma_f32_16x16x32_bf16 a[32:35], v[64:67], v[48:51], a[32:35]
    v_mfma_f32_16x16x32_bf16 a[16:19], v[68:71], v[44:47], a[16:19]
    v_mfma_f32_16x16x32_bf16 a[36:39], v[68:71], v[48:51], a[36:39]
    s_branch wo_a2_kernel_loop0
wo_a2_kernel_loop0_last:
    s_waitcnt vmcnt(0)
    v_mfma_f32_16x16x32_bf16 a[0:3], v[52:55], v[44:47], a[0:3]
    v_mfma_f32_16x16x32_bf16 a[20:23], v[52:55], v[48:51], a[20:23]
    v_mfma_f32_16x16x32_bf16 a[4:7], v[56:59], v[44:47], a[4:7]
    v_mfma_f32_16x16x32_bf16 a[24:27], v[56:59], v[48:51], a[24:27]
    v_mfma_f32_16x16x32_bf16 a[8:11], v[60:63], v[44:47], a[8:11]
    v_mfma_f32_16x16x32_bf16 a[28:31], v[60:63], v[48:51], a[28:31]
    v_mfma_f32_16x16x32_bf16 a[12:15], v[64:67], v[44:47], a[12:15]
    v_mfma_f32_16x16x32_bf16 a[32:35], v[64:67], v[48:51], a[32:35]
    v_mfma_f32_16x16x32_bf16 a[16:19], v[68:71], v[44:47], a[16:19]
    v_mfma_f32_16x16x32_bf16 a[36:39], v[68:71], v[48:51], a[36:39]
    s_nop 7
    s_nop 7
    s_mov_b32 s24, 1280
    v_add_u32 v5, s22, v3
    v_mul_lo_u32 v5, v5, s24
    v_lshlrev_b32 v6, 3, v4
    s_lshl_b32 s29, s23, 1
    v_add3_u32 v5, v5, v6, s29
    v_add_u32 v6, 4194304, v5
    buffer_load_dwordx2 v[72:73], v6, s[8:11], 0 offen
    v_accvgpr_read_b32 v76, a0
    v_accvgpr_read_b32 v77, a1
    v_accvgpr_read_b32 v78, a2
    v_accvgpr_read_b32 v79, a3
    v_cvt_pk_bf16_f32 v80, v76, v77
    v_cvt_pk_bf16_f32 v81, v78, v79
    s_waitcnt vmcnt(0)
    v_lshlrev_b32 v76, 16, v80
    v_and_b32 v77, 0xffff0000, v80
    v_lshlrev_b32 v82, 16, v72
    v_and_b32 v83, 0xffff0000, v72
    v_add_f32 v76, v76, v82
    v_add_f32 v77, v77, v83
    v_lshlrev_b32 v78, 16, v81
    v_and_b32 v79, 0xffff0000, v81
    v_lshlrev_b32 v82, 16, v73
    v_and_b32 v83, 0xffff0000, v73
    v_add_f32 v78, v78, v82
    v_add_f32 v79, v79, v83
    v_cvt_pk_bf16_f32 v80, v76, v77
    v_cvt_pk_bf16_f32 v81, v78, v79
    v_add_u32 v6, 4194304, v5
    buffer_store_dwordx2 v[80:81], v6, s[8:11], 0 offen
    v_add_u32 v6, 4194336, v5
    buffer_load_dwordx2 v[72:73], v6, s[8:11], 0 offen
    v_accvgpr_read_b32 v76, a4
    v_accvgpr_read_b32 v77, a5
    v_accvgpr_read_b32 v78, a6
    v_accvgpr_read_b32 v79, a7
    v_cvt_pk_bf16_f32 v80, v76, v77
    v_cvt_pk_bf16_f32 v81, v78, v79
    s_waitcnt vmcnt(0)
    v_lshlrev_b32 v76, 16, v80
    v_and_b32 v77, 0xffff0000, v80
    v_lshlrev_b32 v82, 16, v72
    v_and_b32 v83, 0xffff0000, v72
    v_add_f32 v76, v76, v82
    v_add_f32 v77, v77, v83
    v_lshlrev_b32 v78, 16, v81
    v_and_b32 v79, 0xffff0000, v81
    v_lshlrev_b32 v82, 16, v73
    v_and_b32 v83, 0xffff0000, v73
    v_add_f32 v78, v78, v82
    v_add_f32 v79, v79, v83
    v_cvt_pk_bf16_f32 v80, v76, v77
    v_cvt_pk_bf16_f32 v81, v78, v79
    v_add_u32 v6, 4194336, v5
    buffer_store_dwordx2 v[80:81], v6, s[8:11], 0 offen
    v_add_u32 v6, 4194368, v5
    buffer_load_dwordx2 v[72:73], v6, s[8:11], 0 offen
    v_accvgpr_read_b32 v76, a8
    v_accvgpr_read_b32 v77, a9
    v_accvgpr_read_b32 v78, a10
    v_accvgpr_read_b32 v79, a11
    v_cvt_pk_bf16_f32 v80, v76, v77
    v_cvt_pk_bf16_f32 v81, v78, v79
    s_waitcnt vmcnt(0)
    v_lshlrev_b32 v76, 16, v80
    v_and_b32 v77, 0xffff0000, v80
    v_lshlrev_b32 v82, 16, v72
    v_and_b32 v83, 0xffff0000, v72
    v_add_f32 v76, v76, v82
    v_add_f32 v77, v77, v83
    v_lshlrev_b32 v78, 16, v81
    v_and_b32 v79, 0xffff0000, v81
    v_lshlrev_b32 v82, 16, v73
    v_and_b32 v83, 0xffff0000, v73
    v_add_f32 v78, v78, v82
    v_add_f32 v79, v79, v83
    v_cvt_pk_bf16_f32 v80, v76, v77
    v_cvt_pk_bf16_f32 v81, v78, v79
    v_add_u32 v6, 4194368, v5
    buffer_store_dwordx2 v[80:81], v6, s[8:11], 0 offen
    v_add_u32 v6, 4194400, v5
    buffer_load_dwordx2 v[72:73], v6, s[8:11], 0 offen
    v_accvgpr_read_b32 v76, a12
    v_accvgpr_read_b32 v77, a13
    v_accvgpr_read_b32 v78, a14
    v_accvgpr_read_b32 v79, a15
    v_cvt_pk_bf16_f32 v80, v76, v77
    v_cvt_pk_bf16_f32 v81, v78, v79
    s_waitcnt vmcnt(0)
    v_lshlrev_b32 v76, 16, v80
    v_and_b32 v77, 0xffff0000, v80
    v_lshlrev_b32 v82, 16, v72
    v_and_b32 v83, 0xffff0000, v72
    v_add_f32 v76, v76, v82
    v_add_f32 v77, v77, v83
    v_lshlrev_b32 v78, 16, v81
    v_and_b32 v79, 0xffff0000, v81
    v_lshlrev_b32 v82, 16, v73
    v_and_b32 v83, 0xffff0000, v73
    v_add_f32 v78, v78, v82
    v_add_f32 v79, v79, v83
    v_cvt_pk_bf16_f32 v80, v76, v77
    v_cvt_pk_bf16_f32 v81, v78, v79
    v_add_u32 v6, 4194400, v5
    buffer_store_dwordx2 v[80:81], v6, s[8:11], 0 offen
    v_add_u32 v6, 4194432, v5
    buffer_load_dwordx2 v[72:73], v6, s[8:11], 0 offen
    v_accvgpr_read_b32 v76, a16
    v_accvgpr_read_b32 v77, a17
    v_accvgpr_read_b32 v78, a18
    v_accvgpr_read_b32 v79, a19
    v_cvt_pk_bf16_f32 v80, v76, v77
    v_cvt_pk_bf16_f32 v81, v78, v79
    s_waitcnt vmcnt(0)
    v_lshlrev_b32 v76, 16, v80
    v_and_b32 v77, 0xffff0000, v80
    v_lshlrev_b32 v82, 16, v72
    v_and_b32 v83, 0xffff0000, v72
    v_add_f32 v76, v76, v82
    v_add_f32 v77, v77, v83
    v_lshlrev_b32 v78, 16, v81
    v_and_b32 v79, 0xffff0000, v81
    v_lshlrev_b32 v82, 16, v73
    v_and_b32 v83, 0xffff0000, v73
    v_add_f32 v78, v78, v82
    v_add_f32 v79, v79, v83
    v_cvt_pk_bf16_f32 v80, v76, v77
    v_cvt_pk_bf16_f32 v81, v78, v79
    v_add_u32 v6, 4194432, v5
    buffer_store_dwordx2 v[80:81], v6, s[8:11], 0 offen
    v_add_u32 v6, 4214784, v5
    buffer_load_dwordx2 v[72:73], v6, s[8:11], 0 offen
    v_accvgpr_read_b32 v76, a20
    v_accvgpr_read_b32 v77, a21
    v_accvgpr_read_b32 v78, a22
    v_accvgpr_read_b32 v79, a23
    v_cvt_pk_bf16_f32 v80, v76, v77
    v_cvt_pk_bf16_f32 v81, v78, v79
    s_waitcnt vmcnt(0)
    v_lshlrev_b32 v76, 16, v80
    v_and_b32 v77, 0xffff0000, v80
    v_lshlrev_b32 v82, 16, v72
    v_and_b32 v83, 0xffff0000, v72
    v_add_f32 v76, v76, v82
    v_add_f32 v77, v77, v83
    v_lshlrev_b32 v78, 16, v81
    v_and_b32 v79, 0xffff0000, v81
    v_lshlrev_b32 v82, 16, v73
    v_and_b32 v83, 0xffff0000, v73
    v_add_f32 v78, v78, v82
    v_add_f32 v79, v79, v83
    v_cvt_pk_bf16_f32 v80, v76, v77
    v_cvt_pk_bf16_f32 v81, v78, v79
    v_add_u32 v6, 4214784, v5
    buffer_store_dwordx2 v[80:81], v6, s[8:11], 0 offen
    v_add_u32 v6, 4214816, v5
    buffer_load_dwordx2 v[72:73], v6, s[8:11], 0 offen
    v_accvgpr_read_b32 v76, a24
    v_accvgpr_read_b32 v77, a25
    v_accvgpr_read_b32 v78, a26
    v_accvgpr_read_b32 v79, a27
    v_cvt_pk_bf16_f32 v80, v76, v77
    v_cvt_pk_bf16_f32 v81, v78, v79
    s_waitcnt vmcnt(0)
    v_lshlrev_b32 v76, 16, v80
    v_and_b32 v77, 0xffff0000, v80
    v_lshlrev_b32 v82, 16, v72
    v_and_b32 v83, 0xffff0000, v72
    v_add_f32 v76, v76, v82
    v_add_f32 v77, v77, v83
    v_lshlrev_b32 v78, 16, v81
    v_and_b32 v79, 0xffff0000, v81
    v_lshlrev_b32 v82, 16, v73
    v_and_b32 v83, 0xffff0000, v73
    v_add_f32 v78, v78, v82
    v_add_f32 v79, v79, v83
    v_cvt_pk_bf16_f32 v80, v76, v77
    v_cvt_pk_bf16_f32 v81, v78, v79
    v_add_u32 v6, 4214816, v5
    buffer_store_dwordx2 v[80:81], v6, s[8:11], 0 offen
    v_add_u32 v6, 4214848, v5
    buffer_load_dwordx2 v[72:73], v6, s[8:11], 0 offen
    v_accvgpr_read_b32 v76, a28
    v_accvgpr_read_b32 v77, a29
    v_accvgpr_read_b32 v78, a30
    v_accvgpr_read_b32 v79, a31
    v_cvt_pk_bf16_f32 v80, v76, v77
    v_cvt_pk_bf16_f32 v81, v78, v79
    s_waitcnt vmcnt(0)
    v_lshlrev_b32 v76, 16, v80
    v_and_b32 v77, 0xffff0000, v80
    v_lshlrev_b32 v82, 16, v72
    v_and_b32 v83, 0xffff0000, v72
    v_add_f32 v76, v76, v82
    v_add_f32 v77, v77, v83
    v_lshlrev_b32 v78, 16, v81
    v_and_b32 v79, 0xffff0000, v81
    v_lshlrev_b32 v82, 16, v73
    v_and_b32 v83, 0xffff0000, v73
    v_add_f32 v78, v78, v82
    v_add_f32 v79, v79, v83
    v_cvt_pk_bf16_f32 v80, v76, v77
    v_cvt_pk_bf16_f32 v81, v78, v79
    v_add_u32 v6, 4214848, v5
    buffer_store_dwordx2 v[80:81], v6, s[8:11], 0 offen
    v_add_u32 v6, 4214880, v5
    buffer_load_dwordx2 v[72:73], v6, s[8:11], 0 offen
    v_accvgpr_read_b32 v76, a32
    v_accvgpr_read_b32 v77, a33
    v_accvgpr_read_b32 v78, a34
    v_accvgpr_read_b32 v79, a35
    v_cvt_pk_bf16_f32 v80, v76, v77
    v_cvt_pk_bf16_f32 v81, v78, v79
    s_waitcnt vmcnt(0)
    v_lshlrev_b32 v76, 16, v80
    v_and_b32 v77, 0xffff0000, v80
    v_lshlrev_b32 v82, 16, v72
    v_and_b32 v83, 0xffff0000, v72
    v_add_f32 v76, v76, v82
    v_add_f32 v77, v77, v83
    v_lshlrev_b32 v78, 16, v81
    v_and_b32 v79, 0xffff0000, v81
    v_lshlrev_b32 v82, 16, v73
    v_and_b32 v83, 0xffff0000, v73
    v_add_f32 v78, v78, v82
    v_add_f32 v79, v79, v83
    v_cvt_pk_bf16_f32 v80, v76, v77
    v_cvt_pk_bf16_f32 v81, v78, v79
    v_add_u32 v6, 4214880, v5
    buffer_store_dwordx2 v[80:81], v6, s[8:11], 0 offen
    v_add_u32 v6, 4214912, v5
    buffer_load_dwordx2 v[72:73], v6, s[8:11], 0 offen
    v_accvgpr_read_b32 v76, a36
    v_accvgpr_read_b32 v77, a37
    v_accvgpr_read_b32 v78, a38
    v_accvgpr_read_b32 v79, a39
    v_cvt_pk_bf16_f32 v80, v76, v77
    v_cvt_pk_bf16_f32 v81, v78, v79
    s_waitcnt vmcnt(0)
    v_lshlrev_b32 v76, 16, v80
    v_and_b32 v77, 0xffff0000, v80
    v_lshlrev_b32 v82, 16, v72
    v_and_b32 v83, 0xffff0000, v72
    v_add_f32 v76, v76, v82
    v_add_f32 v77, v77, v83
    v_lshlrev_b32 v78, 16, v81
    v_and_b32 v79, 0xffff0000, v81
    v_lshlrev_b32 v82, 16, v73
    v_and_b32 v83, 0xffff0000, v73
    v_add_f32 v78, v78, v82
    v_add_f32 v79, v79, v83
    v_cvt_pk_bf16_f32 v80, v76, v77
    v_cvt_pk_bf16_f32 v81, v78, v79
    v_add_u32 v6, 4214912, v5
    buffer_store_dwordx2 v[80:81], v6, s[8:11], 0 offen
wo_a2_kernel_end:
    s_endpgm
.section .rodata,"a"
.p2align 6
.amdhsa_kernel wo_a2_kernel
  .amdhsa_next_free_vgpr 136
  .amdhsa_next_free_sgpr 64
  .amdhsa_accum_offset 96
  .amdhsa_group_segment_fixed_size 0
  .amdhsa_kernarg_size 104
  .amdhsa_user_sgpr_count 2
  .amdhsa_user_sgpr_kernarg_segment_ptr 1
  .amdhsa_system_sgpr_workgroup_id_x 1
.end_amdhsa_kernel
.text
.globl chain2_kernel
.p2align 8
.type chain2_kernel,@function
chain2_kernel:
    s_cmp_ge_u32 s2, 104
    s_cbranch_scc1 chain2_kernel_end
    s_load_dwordx2 s[4:5], s[0:1], 96
    s_load_dwordx2 s[6:7], s[0:1], 32
    v_and_b32 v1, 63, v0
    v_lshrrev_b32 v4, 6, v0
    v_and_b32 v2, 15, v1
    v_lshrrev_b32 v3, 4, v1
    v_readfirstlane_b32 s3, v4
    s_mov_b32 s60, 131072
    s_waitcnt lgkmcnt(0)
    s_mov_b32 s8, s4
    s_mov_b32 s9, s5
    s_mov_b32 s10, 268435456
    s_mov_b32 s11, 0x00020000
    s_mov_b32 s20, s6
    s_mov_b32 s21, s7
    s_mov_b32 s22, 10240
    s_mov_b32 s23, 0x00020000
    s_cmp_ge_u32 s2, 64
    s_cbranch_scc1 chain2_kernel_roleR
    s_cmp_ge_u32 s2, 32
    s_cbranch_scc1 chain2_kernel_roleV
    s_mov_b32 s44, s2
    s_load_dwordx2 s[6:7], s[0:1], 40
    s_load_dwordx2 s[24:25], s[0:1], 48
    s_waitcnt lgkmcnt(0)
    s_mov_b32 s12, s6
    s_mov_b32 s13, s7
    s_mov_b32 s14, 7864320
    s_mov_b32 s15, 0x00020000
    s_mov_b32 s16, s24
    s_mov_b32 s17, s25
    s_mov_b32 s18, 7864320
    s_mov_b32 s19, 0x00020000
    v_add_u32 v16, 0, v0
    s_mov_b32 s24, 683
    v_mul_lo_u32 v17, v16, s24
    v_lshrrev_b32 v17, 14, v17
    v_mul_u32_u24 v18, 24, v17
    v_sub_u32 v18, v16, v18
    s_mov_b32 s24, 12288
    v_mul_lo_u32 v4, v17, s24
    v_lshl_add_u32 v4, v18, 4, v4
    v_mul_u32_u24 v10, 400, v17
    v_lshl_add_u32 v10, v18, 4, v10
    v_add_u32 v10, 106496, v10
    v_add_u32 v16, 256, v0
    s_mov_b32 s24, 683
    v_mul_lo_u32 v17, v16, s24
    v_lshrrev_b32 v17, 14, v17
    v_mul_u32_u24 v18, 24, v17
    v_sub_u32 v18, v16, v18
    s_mov_b32 s24, 12288
    v_mul_lo_u32 v5, v17, s24
    v_lshl_add_u32 v5, v18, 4, v5
    v_mul_u32_u24 v11, 400, v17
    v_lshl_add_u32 v11, v18, 4, v11
    v_add_u32 v11, 106496, v11
    v_add_u32 v16, 512, v0
    s_mov_b32 s24, 683
    v_mul_lo_u32 v17, v16, s24
    v_lshrrev_b32 v17, 14, v17
    v_mul_u32_u24 v18, 24, v17
    v_sub_u32 v18, v16, v18
    s_mov_b32 s24, 12288
    v_mul_lo_u32 v6, v17, s24
    v_lshl_add_u32 v6, v18, 4, v6
    v_mul_u32_u24 v12, 400, v17
    v_lshl_add_u32 v12, v18, 4, v12
    v_add_u32 v12, 106496, v12
    v_add_u32 v16, 768, v0
    s_mov_b32 s24, 683
    v_mul_lo_u32 v17, v16, s24
    v_lshrrev_b32 v17, 14, v17
    v_mul_u32_u24 v18, 24, v17
    v_sub_u32 v18, v16, v18
    s_mov_b32 s24, 12288
    v_mul_lo_u32 v7, v17, s24
    v_lshl_add_u32 v7, v18, 4, v7
    v_mul_u32_u24 v13, 400, v17
    v_lshl_add_u32 v13, v18, 4, v13
    v_add_u32 v13, 106496, v13
    v_add_u32 v16, 1024, v0
    s_mov_b32 s24, 683
    v_mul_lo_u32 v17, v16, s24
    v_lshrrev_b32 v17, 14, v17
    v_mul_u32_u24 v18, 24, v17
    v_sub_u32 v18, v16, v18
    s_mov_b32 s24, 12288
    v_mul_lo_u32 v8, v17, s24
    v_lshl_add_u32 v8, v18, 4, v8
    v_mul_u32_u24 v14, 400, v17
    v_lshl_add_u32 v14, v18, 4, v14
    v_add_u32 v14, 106496, v14
    v_add_u32 v16, 1280, v0
    s_mov_b32 s24, 683
    v_mul_lo_u32 v17, v16, s24
    v_lshrrev_b32 v17, 14, v17
    v_mul_u32_u24 v18, 24, v17
    v_sub_u32 v18, v16, v18
    s_mov_b32 s24, 12288
    v_mul_lo_u32 v9, v17, s24
    v_lshl_add_u32 v9, v18, 4, v9
    v_mul_u32_u24 v15, 400, v17
    v_lshl_add_u32 v15, v18, 4, v15
    v_add_u32 v15, 106496, v15
    v_lshrrev_b32 v17, 1, v3
    v_lshlrev_b32 v17, 4, v17
    v_and_b32 v18, 1, v3
    v_lshl_add_u32 v17, v18, 2, v17
    v_lshrrev_b32 v18, 2, v2
    v_and_b32 v19, 1, v18
    v_add_u32 v17, v17, v19
    v_lshrrev_b32 v18, 1, v18
    v_lshl_add_u32 v17, v18, 3, v17
    v_mul_u32_u24 v16, 400, v17
    v_and_b32 v18, 3, v2
    v_lshl_add_u32 v16, v18, 3, v16
    v_add_u32 v16, 106496, v16
    s_mul_i32 s24, s3, 96
    v_add_u32 v16, s24, v16
    v_lshlrev_b32 v17, 4, v1
    s_mul_i32 s24, s3, 20480
    s_add_u32 s24, s24, 24576
    v_add_u32 v17, s24, v17
    s_mul_i32 s45, s44, 384
    s_add_u32 s46, s45, 0
    buffer_load_dwordx4 v[24:27], v4, s[12:15], s46 offen
    buffer_load_dwordx4 v[28:31], v5, s[12:15], s46 offen
    buffer_load_dwordx4 v[32:35], v6, s[12:15], s46 offen
    buffer_load_dwordx4 v[36:39], v7, s[12:15], s46 offen
    buffer_load_dwordx4 v[40:43], v8, s[12:15], s46 offen
    buffer_load_dwordx4 v[44:47], v9, s[12:15], s46 offen
    s_add_u32 s46, s45, 0
    buffer_load_dwordx4 v[48:51], v4, s[16:19], s46 offen
    buffer_load_dwordx4 v[52:55], v5, s[16:19], s46 offen
    buffer_load_dwordx4 v[56:59], v6, s[16:19], s46 offen
    buffer_load_dwordx4 v[60:63], v7, s[16:19], s46 offen
    buffer_load_dwordx4 v[64:67], v8, s[16:19], s46 offen
    buffer_load_dwordx4 v[68:71], v9, s[16:19], s46 offen
    s_waitcnt vmcnt(6)
    ds_write_b128 v10, v[24:27]
    ds_write_b128 v11, v[28:31]
    ds_write_b128 v12, v[32:35]
    ds_write_b128 v13, v[36:39]
    ds_write_b128 v14, v[40:43]
    ds_write_b128 v15, v[44:47]
    s_add_u32 s46, s45, 786432
    buffer_load_dwordx4 v[72:75], v4, s[12:15], s46 offen
    buffer_load_dwordx4 v[76:79], v5, s[12:15], s46 offen
    buffer_load_dwordx4 v[80:83], v6, s[12:15], s46 offen
    buffer_load_dwordx4 v[84:87], v7, s[12:15], s46 offen
    buffer_load_dwordx4 v[88:91], v8, s[12:15], s46 offen
    buffer_load_dwordx4 v[92:95], v9, s[12:15], s46 offen
    s_waitcnt lgkmcnt(0)
    s_barrier
    ds_read_b64_tr_b16 a[0:1], v16 offset:0
    ds_read_b64_tr_b16 a[2:3], v16 offset:800
    ds_read_b64_tr_b16 a[4:5], v16 offset:12800
    ds_read_b64_tr_b16 a[6:7], v16 offset:13600
    ds_read_b64_tr_b16 a[80:81], v16 offset:32
    ds_read_b64_tr_b16 a[82:83], v16 offset:832
    ds_read_b64_tr_b16 a[84:85], v16 offset:12832
    ds_read_b64_tr_b16 a[86:87], v16 offset:13632
    ds_read_b64_tr_b16 a[160:161], v16 offset:64
    ds_read_b64_tr_b16 a[162:163], v16 offset:864
    ds_read_b64_tr_b16 a[164:165], v16 offset:12864
    ds_read_b64_tr_b16 a[166:167], v16 offset:13664
    s_waitcnt lgkmcnt(0)
    s_barrier
    s_waitcnt vmcnt(6)
    ds_write_b128 v10, v[48:51]
    ds_write_b128 v11, v[52:55]
    ds_write_b128 v12, v[56:59]
    ds_write_b128 v13, v[60:63]
    ds_write_b128 v14, v[64:67]
    ds_write_b128 v15, v[68:71]
    s_add_u32 s46, s45, 786432
    buffer_load_dwordx4 v[24:27], v4, s[16:19], s46 offen
    buffer_load_dwordx4 v[28:31], v5, s[16:19], s46 offen
    buffer_load_dwordx4 v[32:35], v6, s[16:19], s46 offen
    buffer_load_dwordx4 v[36:39], v7, s[16:19], s46 offen
    buffer_load_dwordx4 v[40:43], v8, s[16:19], s46 offen
    buffer_load_dwordx4 v[44:47], v9, s[16:19], s46 offen
    s_waitcnt lgkmcnt(0)
    s_barrier
    ds_read_b64_tr_b16 v[96:97], v16 offset:0
    ds_read_b64_tr_b16 v[98:99], v16 offset:800
    ds_read_b64_tr_b16 v[100:101], v16 offset:12800
    ds_read_b64_tr_b16 v[102:103], v16 offset:13600
    ds_read_b64_tr_b16 v[176:177], v16 offset:32
    ds_read_b64_tr_b16 v[178:179], v16 offset:832
    ds_read_b64_tr_b16 v[180:181], v16 offset:12832
    ds_read_b64_tr_b16 v[182:183], v16 offset:13632
    ds_read_b64_tr_b16 v[48:49], v16 offset:64
    ds_read_b64_tr_b16 v[50:51], v16 offset:864
    ds_read_b64_tr_b16 v[52:53], v16 offset:12864
    ds_read_b64_tr_b16 v[54:55], v16 offset:13664
    s_waitcnt lgkmcnt(0)
    ds_write_b128 v17, v[48:51] offset:0
    ds_write_b128 v17, v[52:55] offset:1024
    s_waitcnt lgkmcnt(0)
    s_barrier
    s_waitcnt vmcnt(6)
    ds_write_b128 v10, v[72:75]
    ds_write_b128 v11, v[76:79]
    ds_write_b128 v12, v[80:83]
    ds_write_b128 v13, v[84:87]
    ds_write_b128 v14, v[88:91]
    ds_write_b128 v15, v[92:95]
    s_add_u32 s46, s45, 1572864
    buffer_load_dwordx4 v[48:51], v4, s[12:15], s46 offen
    buffer_load_dwordx4 v[52:55], v5, s[12:15], s46 offen
    buffer_load_dwordx4 v[56:59], v6, s[12:15], s46 offen
    buffer_load_dwordx4 v[60:63], v7, s[12:15], s46 offen
    buffer_load_dwordx4 v[64:67], v8, s[12:15], s46 offen
    buffer_load_dwordx4 v[68:71], v9, s[12:15], s46 offen
    s_waitcnt lgkmcnt(0)
    s_barrier
    ds_read_b64_tr_b16 a[8:9], v16 offset:0
    ds_read_b64_tr_b16 a[10:11], v16 offset:800
    ds_read_b64_tr_b16 a[12:13], v16 offset:12800
    ds_read_b64_tr_b16 a[14:15], v16 offset:13600
    ds_read_b64_tr_b16 a[88:89], v16 offset:32
    ds_read_b64_tr_b16 a[90:91], v16 offset:832
    ds_read_b64_tr_b16 a[92:93], v16 offset:12832
    ds_read_b64_tr_b16 a[94:95], v16 offset:13632
    ds_read_b64_tr_b16 a[168:169], v16 offset:64
    ds_read_b64_tr_b16 a[170:171], v16 offset:864
    ds_read_b64_tr_b16 a[172:173], v16 offset:12864
    ds_read_b64_tr_b16 a[174:175], v16 offset:13664
    s_waitcnt lgkmcnt(0)
    s_barrier
    s_waitcnt vmcnt(6)
    ds_write_b128 v10, v[24:27]
    ds_write_b128 v11, v[28:31]
    ds_write_b128 v12, v[32:35]
    ds_write_b128 v13, v[36:39]
    ds_write_b128 v14, v[40:43]
    ds_write_b128 v15, v[44:47]
    s_add_u32 s46, s45, 1572864
    buffer_load_dwordx4 v[72:75], v4, s[16:19], s46 offen
    buffer_load_dwordx4 v[76:79], v5, s[16:19], s46 offen
    buffer_load_dwordx4 v[80:83], v6, s[16:19], s46 offen
    buffer_load_dwordx4 v[84:87], v7, s[16:19], s46 offen
    buffer_load_dwordx4 v[88:91], v8, s[16:19], s46 offen
    buffer_load_dwordx4 v[92:95], v9, s[16:19], s46 offen
    s_waitcnt lgkmcnt(0)
    s_barrier
    ds_read_b64_tr_b16 v[104:105], v16 offset:0
    ds_read_b64_tr_b16 v[106:107], v16 offset:800
    ds_read_b64_tr_b16 v[108:109], v16 offset:12800
    ds_read_b64_tr_b16 v[110:111], v16 offset:13600
    ds_read_b64_tr_b16 v[184:185], v16 offset:32
    ds_read_b64_tr_b16 v[186:187], v16 offset:832
    ds_read_b64_tr_b16 v[188:189], v16 offset:12832
    ds_read_b64_tr_b16 v[190:191], v16 offset:13632
    ds_read_b64_tr_b16 v[24:25], v16 offset:64
    ds_read_b64_tr_b16 v[26:27], v16 offset:864
    ds_read_b64_tr_b16 v[28:29], v16 offset:12864
    ds_read_b64_tr_b16 v[30:31], v16 offset:13664
    s_waitcnt lgkmcnt(0)
    ds_write_b128 v17, v[24:27] offset:2048
    ds_write_b128 v17, v[28:31] offset:3072
    s_waitcnt lgkmcnt(0)
    s_barrier
    s_waitcnt vmcnt(6)
    ds_write_b128 v10, v[48:51]
    ds_write_b128 v11, v[52:55]
    ds_write_b128 v12, v[56:59]
    ds_write_b128 v13, v[60:63]
    ds_write_b128 v14, v[64:67]
    ds_write_b128 v15, v[68:71]
    s_add_u32 s46, s45, 2359296
    buffer_load_dwordx4 v[24:27], v4, s[12:15], s46 offen
    buffer_load_dwordx4 v[28:31], v5, s[12:15], s46 offen
    buffer_load_dwordx4 v[32:35], v6, s[12:15], s46 offen
    buffer_load_dwordx4 v[36:39], v7, s[12:15], s46 offen
    buffer_load_dwordx4 v[40:43], v8, s[12:15], s46 offen
    buffer_load_dwordx4 v[44:47], v9, s[12:15], s46 offen
    s_waitcnt lgkmcnt(0)
    s_barrier
    ds_read_b64_tr_b16 a[16:17], v16 offset:0
    ds_read_b64_tr_b16 a[18:19], v16 offset:800
    ds_read_b64_tr_b16 a[20:21], v16 offset:12800
    ds_read_b64_tr_b16 a[22:23], v16 offset:13600
    ds_read_b64_tr_b16 a[96:97], v16 offset:32
    ds_read_b64_tr_b16 a[98:99], v16 offset:832
    ds_read_b64_tr_b16 a[100:101], v16 offset:12832
    ds_read_b64_tr_b16 a[102:103], v16 offset:13632
    ds_read_b64_tr_b16 a[176:177], v16 offset:64
    ds_read_b64_tr_b16 a[178:179], v16 offset:864
    ds_read_b64_tr_b16 a[180:181], v16 offset:12864
    ds_read_b64_tr_b16 a[182:183], v16 offset:13664
    s_waitcnt lgkmcnt(0)
    s_barrier
    s_waitcnt vmcnt(6)
    ds_write_b128 v10, v[72:75]
    ds_write_b128 v11, v[76:79]
    ds_write_b128 v12, v[80:83]
    ds_write_b128 v13, v[84:87]
    ds_write_b128 v14, v[88:91]
    ds_write_b128 v15, v[92:95]
    s_add_u32 s46, s45, 2359296
    buffer_load_dwordx4 v[48:51], v4, s[16:19], s46 offen
    buffer_load_dwordx4 v[52:55], v5, s[16:19], s46 offen
    buffer_load_dwordx4 v[56:59], v6, s[16:19], s46 offen
    buffer_load_dwordx4 v[60:63], v7, s[16:19], s46 offen
    buffer_load_dwordx4 v[64:67], v8, s[16:19], s46 offen
    buffer_load_dwordx4 v[68:71], v9, s[16:19], s46 offen
    s_waitcnt lgkmcnt(0)
    s_barrier
    ds_read_b64_tr_b16 v[112:113], v16 offset:0
    ds_read_b64_tr_b16 v[114:115], v16 offset:800
    ds_read_b64_tr_b16 v[116:117], v16 offset:12800
    ds_read_b64_tr_b16 v[118:119], v16 offset:13600
    ds_read_b64_tr_b16 v[192:193], v16 offset:32
    ds_read_b64_tr_b16 v[194:195], v16 offset:832
    ds_read_b64_tr_b16 v[196:197], v16 offset:12832
    ds_read_b64_tr_b16 v[198:199], v16 offset:13632
    ds_read_b64_tr_b16 v[72:73], v16 offset:64
    ds_read_b64_tr_b16 v[74:75], v16 offset:864
    ds_read_b64_tr_b16 v[76:77], v16 offset:12864
    ds_read_b64_tr_b16 v[78:79], v16 offset:13664
    s_waitcnt lgkmcnt(0)
    ds_write_b128 v17, v[72:75] offset:4096
    ds_write_b128 v17, v[76:79] offset:5120
    s_waitcnt lgkmcnt(0)
    s_barrier
    s_waitcnt vmcnt(6)
    ds_write_b128 v10, v[24:27]
    ds_write_b128 v11, v[28:31]
    ds_write_b128 v12, v[32:35]
    ds_write_b128 v13, v[36:39]
    ds_write_b128 v14, v[40:43]
    ds_write_b128 v15, v[44:47]
    s_add_u32 s46, s45, 3145728
    buffer_load_dwordx4 v[72:75], v4, s[12:15], s46 offen
    buffer_load_dwordx4 v[76:79], v5, s[12:15], s46 offen
    buffer_load_dwordx4 v[80:83], v6, s[12:15], s46 offen
    buffer_load_dwordx4 v[84:87], v7, s[12:15], s46 offen
    buffer_load_dwordx4 v[88:91], v8, s[12:15], s46 offen
    buffer_load_dwordx4 v[92:95], v9, s[12:15], s46 offen
    s_waitcnt lgkmcnt(0)
    s_barrier
    ds_read_b64_tr_b16 a[24:25], v16 offset:0
    ds_read_b64_tr_b16 a[26:27], v16 offset:800
    ds_read_b64_tr_b16 a[28:29], v16 offset:12800
    ds_read_b64_tr_b16 a[30:31], v16 offset:13600
    ds_read_b64_tr_b16 a[104:105], v16 offset:32
    ds_read_b64_tr_b16 a[106:107], v16 offset:832
    ds_read_b64_tr_b16 a[108:109], v16 offset:12832
    ds_read_b64_tr_b16 a[110:111], v16 offset:13632
    ds_read_b64_tr_b16 a[184:185], v16 offset:64
    ds_read_b64_tr_b16 a[186:187], v16 offset:864
    ds_read_b64_tr_b16 a[188:189], v16 offset:12864
    ds_read_b64_tr_b16 a[190:191], v16 offset:13664
    s_waitcnt lgkmcnt(0)
    s_barrier
    s_waitcnt vmcnt(6)
    ds_write_b128 v10, v[48:51]
    ds_write_b128 v11, v[52:55]
    ds_write_b128 v12, v[56:59]
    ds_write_b128 v13, v[60:63]
    ds_write_b128 v14, v[64:67]
    ds_write_b128 v15, v[68:71]
    s_add_u32 s46, s45, 3145728
    buffer_load_dwordx4 v[24:27], v4, s[16:19], s46 offen
    buffer_load_dwordx4 v[28:31], v5, s[16:19], s46 offen
    buffer_load_dwordx4 v[32:35], v6, s[16:19], s46 offen
    buffer_load_dwordx4 v[36:39], v7, s[16:19], s46 offen
    buffer_load_dwordx4 v[40:43], v8, s[16:19], s46 offen
    buffer_load_dwordx4 v[44:47], v9, s[16:19], s46 offen
    s_waitcnt lgkmcnt(0)
    s_barrier
    ds_read_b64_tr_b16 v[120:121], v16 offset:0
    ds_read_b64_tr_b16 v[122:123], v16 offset:800
    ds_read_b64_tr_b16 v[124:125], v16 offset:12800
    ds_read_b64_tr_b16 v[126:127], v16 offset:13600
    ds_read_b64_tr_b16 v[200:201], v16 offset:32
    ds_read_b64_tr_b16 v[202:203], v16 offset:832
    ds_read_b64_tr_b16 v[204:205], v16 offset:12832
    ds_read_b64_tr_b16 v[206:207], v16 offset:13632
    ds_read_b64_tr_b16 v[48:49], v16 offset:64
    ds_read_b64_tr_b16 v[50:51], v16 offset:864
    ds_read_b64_tr_b16 v[52:53], v16 offset:12864
    ds_read_b64_tr_b16 v[54:55], v16 offset:13664
    s_waitcnt lgkmcnt(0)
    ds_write_b128 v17, v[48:51] offset:6144
    ds_write_b128 v17, v[52:55] offset:7168
    s_waitcnt lgkmcnt(0)
    s_barrier
    s_waitcnt vmcnt(6)
    ds_write_b128 v10, v[72:75]
    ds_write_b128 v11, v[76:79]
    ds_write_b128 v12, v[80:83]
    ds_write_b128 v13, v[84:87]
    ds_write_b128 v14, v[88:91]
    ds_write_b128 v15, v[92:95]
    s_add_u32 s46, s45, 3932160
    buffer_load_dwordx4 v[48:51], v4, s[12:15], s46 offen
    buffer_load_dwordx4 v[52:55], v5, s[12:15], s46 offen
    buffer_load_dwordx4 v[56:59], v6, s[12:15], s46 offen
    buffer_load_dwordx4 v[60:63], v7, s[12:15], s46 offen
    buffer_load_dwordx4 v[64:67], v8, s[12:15], s46 offen
    buffer_load_dwordx4 v[68:71], v9, s[12:15], s46 offen
    s_waitcnt lgkmcnt(0)
    s_barrier
    ds_read_b64_tr_b16 a[32:33], v16 offset:0
    ds_read_b64_tr_b16 a[34:35], v16 offset:800
    ds_read_b64_tr_b16 a[36:37], v16 offset:12800
    ds_read_b64_tr_b16 a[38:39], v16 offset:13600
    ds_read_b64_tr_b16 a[112:113], v16 offset:32
    ds_read_b64_tr_b16 a[114:115], v16 offset:832
    ds_read_b64_tr_b16 a[116:117], v16 offset:12832
    ds_read_b64_tr_b16 a[118:119], v16 offset:13632
    ds_read_b64_tr_b16 a[192:193], v16 offset:64
    ds_read_b64_tr_b16 a[194:195], v16 offset:864
    ds_read_b64_tr_b16 a[196:197], v16 offset:12864
    ds_read_b64_tr_b16 a[198:199], v16 offset:13664
    s_waitcnt lgkmcnt(0)
    s_barrier
    s_waitcnt vmcnt(6)
    ds_write_b128 v10, v[24:27]
    ds_write_b128 v11, v[28:31]
    ds_write_b128 v12, v[32:35]
    ds_write_b128 v13, v[36:39]
    ds_write_b128 v14, v[40:43]
    ds_write_b128 v15, v[44:47]
    s_add_u32 s46, s45, 3932160
    buffer_load_dwordx4 v[72:75], v4, s[16:19], s46 offen
    buffer_load_dwordx4 v[76:79], v5, s[16:19], s46 offen
    buffer_load_dwordx4 v[80:83], v6, s[16:19], s46 offen
    buffer_load_dwordx4 v[84:87], v7, s[16:19], s46 offen
    buffer_load_dwordx4 v[88:91], v8, s[16:19], s46 offen
    buffer_load_dwordx4 v[92:95], v9, s[16:19], s46 offen
    s_waitcnt lgkmcnt(0)
    s_barrier
    ds_read_b64_tr_b16 v[128:129], v16 offset:0
    ds_read_b64_tr_b16 v[130:131], v16 offset:800
    ds_read_b64_tr_b16 v[132:133], v16 offset:12800
    ds_read_b64_tr_b16 v[134:135], v16 offset:13600
    ds_read_b64_tr_b16 v[208:209], v16 offset:32
    ds_read_b64_tr_b16 v[210:211], v16 offset:832
    ds_read_b64_tr_b16 v[212:213], v16 offset:12832
    ds_read_b64_tr_b16 v[214:215], v16 offset:13632
    ds_read_b64_tr_b16 v[24:25], v16 offset:64
    ds_read_b64_tr_b16 v[26:27], v16 offset:864
    ds_read_b64_tr_b16 v[28:29], v16 offset:12864
    ds_read_b64_tr_b16 v[30:31], v16 offset:13664
    s_waitcnt lgkmcnt(0)
    ds_write_b128 v17, v[24:27] offset:8192
    ds_write_b128 v17, v[28:31] offset:9216
    s_waitcnt lgkmcnt(0)
    s_barrier
    s_waitcnt vmcnt(6)
    ds_write_b128 v10, v[48:51]
    ds_write_b128 v11, v[52:55]
    ds_write_b128 v12, v[56:59]
    ds_write_b128 v13, v[60:63]
    ds_write_b128 v14, v[64:67]
    ds_write_b128 v15, v[68:71]
    s_add_u32 s46, s45, 4718592
    buffer_load_dwordx4 v[24:27], v4, s[12:15], s46 offen
    buffer_load_dwordx4 v[28:31], v5, s[12:15], s46 offen
    buffer_load_dwordx4 v[32:35], v6, s[12:15], s46 offen
    buffer_load_dwordx4 v[36:39], v7, s[12:15], s46 offen
    buffer_load_dwordx4 v[40:43], v8, s[12:15], s46 offen
    buffer_load_dwordx4 v[44:47], v9, s[12:15], s46 offen
    s_waitcnt lgkmcnt(0)
    s_barrier
    ds_read_b64_tr_b16 a[40:41], v16 offset:0
    ds_read_b64_tr_b16 a[42:43], v16 offset:800
    ds_read_b64_tr_b16 a[44:45], v16 offset:12800
    ds_read_b64_tr_b16 a[46:47], v16 offset:13600
    ds_read_b64_tr_b16 a[120:121], v16 offset:32
    ds_read_b64_tr_b16 a[122:123], v16 offset:832
    ds_read_b64_tr_b16 a[124:125], v16 offset:12832
    ds_read_b64_tr_b16 a[126:127], v16 offset:13632
    ds_read_b64_tr_b16 a[200:201], v16 offset:64
    ds_read_b64_tr_b16 a[202:203], v16 offset:864
    ds_read_b64_tr_b16 a[204:205], v16 offset:12864
    ds_read_b64_tr_b16 a[206:207], v16 offset:13664
    s_waitcnt lgkmcnt(0)
    s_barrier
    s_waitcnt vmcnt(6)
    ds_write_b128 v10, v[72:75]
    ds_write_b128 v11, v[76:79]
    ds_write_b128 v12, v[80:83]
    ds_write_b128 v13, v[84:87]
    ds_write_b128 v14, v[88:91]
    ds_write_b128 v15, v[92:95]
    s_add_u32 s46, s45, 4718592
    buffer_load_dwordx4 v[48:51], v4, s[16:19], s46 offen
    buffer_load_dwordx4 v[52:55], v5, s[16:19], s46 offen
    buffer_load_dwordx4 v[56:59], v6, s[16:19], s46 offen
    buffer_load_dwordx4 v[60:63], v7, s[16:19], s46 offen
    buffer_load_dwordx4 v[64:67], v8, s[16:19], s46 offen
    buffer_load_dwordx4 v[68:71], v9, s[16:19], s46 offen
    s_waitcnt lgkmcnt(0)
    s_barrier
    ds_read_b64_tr_b16 v[136:137], v16 offset:0
    ds_read_b64_tr_b16 v[138:139], v16 offset:800
    ds_read_b64_tr_b16 v[140:141], v16 offset:12800
    ds_read_b64_tr_b16 v[142:143], v16 offset:13600
    ds_read_b64_tr_b16 v[216:217], v16 offset:32
    ds_read_b64_tr_b16 v[218:219], v16 offset:832
    ds_read_b64_tr_b16 v[220:221], v16 offset:12832
    ds_read_b64_tr_b16 v[222:223], v16 offset:13632
    ds_read_b64_tr_b16 v[72:73], v16 offset:64
    ds_read_b64_tr_b16 v[74:75], v16 offset:864
    ds_read_b64_tr_b16 v[76:77], v16 offset:12864
    ds_read_b64_tr_b16 v[78:79], v16 offset:13664
    s_waitcnt lgkmcnt(0)
    ds_write_b128 v17, v[72:75] offset:10240
    ds_write_b128 v17, v[76:79] offset:11264
    s_waitcnt lgkmcnt(0)
    s_barrier
    s_waitcnt vmcnt(6)
    ds_write_b128 v10, v[24:27]
    ds_write_b128 v11, v[28:31]
    ds_write_b128 v12, v[32:35]
    ds_write_b128 v13, v[36:39]
    ds_write_b128 v14, v[40:43]
    ds_write_b128 v15, v[44:47]
    s_add_u32 s46, s45, 5505024
    buffer_load_dwordx4 v[72:75], v4, s[12:15], s46 offen
    buffer_load_dwordx4 v[76:79], v5, s[12:15], s46 offen
    buffer_load_dwordx4 v[80:83], v6, s[12:15], s46 offen
    buffer_load_dwordx4 v[84:87], v7, s[12:15], s46 offen
    buffer_load_dwordx4 v[88:91], v8, s[12:15], s46 offen
    buffer_load_dwordx4 v[92:95], v9, s[12:15], s46 offen
    s_waitcnt lgkmcnt(0)
    s_barrier
    ds_read_b64_tr_b16 a[48:49], v16 offset:0
    ds_read_b64_tr_b16 a[50:51], v16 offset:800
    ds_read_b64_tr_b16 a[52:53], v16 offset:12800
    ds_read_b64_tr_b16 a[54:55], v16 offset:13600
    ds_read_b64_tr_b16 a[128:129], v16 offset:32
    ds_read_b64_tr_b16 a[130:131], v16 offset:832
    ds_read_b64_tr_b16 a[132:133], v16 offset:12832
    ds_read_b64_tr_b16 a[134:135], v16 offset:13632
    ds_read_b64_tr_b16 a[208:209], v16 offset:64
    ds_read_b64_tr_b16 a[210:211], v16 offset:864
    ds_read_b64_tr_b16 a[212:213], v16 offset:12864
    ds_read_b64_tr_b16 a[214:215], v16 offset:13664
    s_waitcnt lgkmcnt(0)
    s_barrier
    s_waitcnt vmcnt(6)
    ds_write_b128 v10, v[48:51]
    ds_write_b128 v11, v[52:55]
    ds_write_b128 v12, v[56:59]
    ds_write_b128 v13, v[60:63]
    ds_write_b128 v14, v[64:67]
    ds_write_b128 v15, v[68:71]
    s_add_u32 s46, s45, 5505024
    buffer_load_dwordx4 v[24:27], v4, s[16:19], s46 offen
    buffer_load_dwordx4 v[28:31], v5, s[16:19], s46 offen
    buffer_load_dwordx4 v[32:35], v6, s[16:19], s46 offen
    buffer_load_dwordx4 v[36:39], v7, s[16:19], s46 offen
    buffer_load_dwordx4 v[40:43], v8, s[16:19], s46 offen
    buffer_load_dwordx4 v[44:47], v9, s[16:19], s46 offen
    s_waitcnt lgkmcnt(0)
    s_barrier
    ds_read_b64_tr_b16 v[144:145], v16 offset:0
    ds_read_b64_tr_b16 v[146:147], v16 offset:800
    ds_read_b64_tr_b16 v[148:149], v16 offset:12800
    ds_read_b64_tr_b16 v[150:151], v16 offset:13600
    ds_read_b64_tr_b16 v[224:225], v16 offset:32
    ds_read_b64_tr_b16 v[226:227], v16 offset:832
    ds_read_b64_tr_b16 v[228:229], v16 offset:12832
    ds_read_b64_tr_b16 v[230:231], v16 offset:13632
    ds_read_b64_tr_b16 v[48:49], v16 offset:64
    ds_read_b64_tr_b16 v[50:51], v16 offset:864
    ds_read_b64_tr_b16 v[52:53], v16 offset:12864
    ds_read_b64_tr_b16 v[54:55], v16 offset:13664
    s_waitcnt lgkmcnt(0)
    ds_write_b128 v17, v[48:51] offset:12288
    ds_write_b128 v17, v[52:55] offset:13312
    s_waitcnt lgkmcnt(0)
    s_barrier
    s_waitcnt vmcnt(6)
    ds_write_b128 v10, v[72:75]
    ds_write_b128 v11, v[76:79]
    ds_write_b128 v12, v[80:83]
    ds_write_b128 v13, v[84:87]
    ds_write_b128 v14, v[88:91]
    ds_write_b128 v15, v[92:95]
    s_add_u32 s46, s45, 6291456
    buffer_load_dwordx4 v[48:51], v4, s[12:15], s46 offen
    buffer_load_dwordx4 v[52:55], v5, s[12:15], s46 offen
    buffer_load_dwordx4 v[56:59], v6, s[12:15], s46 offen
    buffer_load_dwordx4 v[60:63], v7, s[12:15], s46 offen
    buffer_load_dwordx4 v[64:67], v8, s[12:15], s46 offen
    buffer_load_dwordx4 v[68:71], v9, s[12:15], s46 offen
    s_waitcnt lgkmcnt(0)
    s_barrier
    ds_read_b64_tr_b16 a[56:57], v16 offset:0
    ds_read_b64_tr_b16 a[58:59], v16 offset:800
    ds_read_b64_tr_b16 a[60:61], v16 offset:12800
    ds_read_b64_tr_b16 a[62:63], v16 offset:13600
    ds_read_b64_tr_b16 a[136:137], v16 offset:32
    ds_read_b64_tr_b16 a[138:139], v16 offset:832
    ds_read_b64_tr_b16 a[140:141], v16 offset:12832
    ds_read_b64_tr_b16 a[142:143], v16 offset:13632
    ds_read_b64_tr_b16 a[216:217], v16 offset:64
    ds_read_b64_tr_b16 a[218:219], v16 offset:864
    ds_read_b64_tr_b16 a[220:221], v16 offset:12864
    ds_read_b64_tr_b16 a[222:223], v16 offset:13664
    s_waitcnt lgkmcnt(0)
    s_barrier
    s_waitcnt vmcnt(6)
    ds_write_b128 v10, v[24:27]
    ds_write_b128 v11, v[28:31]
    ds_write_b128 v12, v[32:35]
    ds_write_b128 v13, v[36:39]
    ds_write_b128 v14, v[40:43]
    ds_write_b128 v15, v[44:47]
    s_add_u32 s46, s45, 6291456
    buffer_load_dwordx4 v[72:75], v4, s[16:19], s46 offen
    buffer_load_dwordx4 v[76:79], v5, s[16:19], s46 offen
    buffer_load_dwordx4 v[80:83], v6, s[16:19], s46 offen
    buffer_load_dwordx4 v[84:87], v7, s[16:19], s46 offen
    buffer_load_dwordx4 v[88:91], v8, s[16:19], s46 offen
    buffer_load_dwordx4 v[92:95], v9, s[16:19], s46 offen
    s_waitcnt lgkmcnt(0)
    s_barrier
    ds_read_b64_tr_b16 v[152:153], v16 offset:0
    ds_read_b64_tr_b16 v[154:155], v16 offset:800
    ds_read_b64_tr_b16 v[156:157], v16 offset:12800
    ds_read_b64_tr_b16 v[158:159], v16 offset:13600
    ds_read_b64_tr_b16 v[232:233], v16 offset:32
    ds_read_b64_tr_b16 v[234:235], v16 offset:832
    ds_read_b64_tr_b16 v[236:237], v16 offset:12832
    ds_read_b64_tr_b16 v[238:239], v16 offset:13632
    ds_read_b64_tr_b16 v[24:25], v16 offset:64
    ds_read_b64_tr_b16 v[26:27], v16 offset:864
    ds_read_b64_tr_b16 v[28:29], v16 offset:12864
    ds_read_b64_tr_b16 v[30:31], v16 offset:13664
    s_waitcnt lgkmcnt(0)
    ds_write_b128 v17, v[24:27] offset:14336
    ds_write_b128 v17, v[28:31] offset:15360
    s_waitcnt lgkmcnt(0)
    s_barrier
    s_waitcnt vmcnt(6)
    ds_write_b128 v10, v[48:51]
    ds_write_b128 v11, v[52:55]
    ds_write_b128 v12, v[56:59]
    ds_write_b128 v13, v[60:63]
    ds_write_b128 v14, v[64:67]
    ds_write_b128 v15, v[68:71]
    s_add_u32 s46, s45, 7077888
    buffer_load_dwordx4 v[24:27], v4, s[12:15], s46 offen
    buffer_load_dwordx4 v[28:31], v5, s[12:15], s46 offen
    buffer_load_dwordx4 v[32:35], v6, s[12:15], s46 offen
    buffer_load_dwordx4 v[36:39], v7, s[12:15], s46 offen
    buffer_load_dwordx4 v[40:43], v8, s[12:15], s46 offen
    buffer_load_dwordx4 v[44:47], v9, s[12:15], s46 offen
    s_waitcnt lgkmcnt(0)
    s_barrier
    ds_read_b64_tr_b16 a[64:65], v16 offset:0
    ds_read_b64_tr_b16 a[66:67], v16 offset:800
    ds_read_b64_tr_b16 a[68:69], v16 offset:12800
    ds_read_b64_tr_b16 a[70:71], v16 offset:13600
    ds_read_b64_tr_b16 a[144:145], v16 offset:32
    ds_read_b64_tr_b16 a[146:147], v16 offset:832
    ds_read_b64_tr_b16 a[148:149], v16 offset:12832
    ds_read_b64_tr_b16 a[150:151], v16 offset:13632
    ds_read_b64_tr_b16 a[224:225], v16 offset:64
    ds_read_b64_tr_b16 a[226:227], v16 offset:864
    ds_read_b64_tr_b16 a[228:229], v16 offset:12864
    ds_read_b64_tr_b16 a[230:231], v16 offset:13664
    s_waitcnt lgkmcnt(0)
    s_barrier
    s_waitcnt vmcnt(6)
    ds_write_b128 v10, v[72:75]
    ds_write_b128 v11, v[76:79]
    ds_write_b128 v12, v[80:83]
    ds_write_b128 v13, v[84:87]
    ds_write_b128 v14, v[88:91]
    ds_write_b128 v15, v[92:95]
    s_add_u32 s46, s45, 7077888
    buffer_load_dwordx4 v[48:51], v4, s[16:19], s46 offen
    buffer_load_dwordx4 v[52:55], v5, s[16:19], s46 offen
    buffer_load_dwordx4 v[56:59], v6, s[16:19], s46 offen
    buffer_load_dwordx4 v[60:63], v7, s[16:19], s46 offen
    buffer_load_dwordx4 v[64:67], v8, s[16:19], s46 offen
    buffer_load_dwordx4 v[68:71], v9, s[16:19], s46 offen
    s_waitcnt lgkmcnt(0)
    s_barrier
    ds_read_b64_tr_b16 v[160:161], v16 offset:0
    ds_read_b64_tr_b16 v[162:163], v16 offset:800
    ds_read_b64_tr_b16 v[164:165], v16 offset:12800
    ds_read_b64_tr_b16 v[166:167], v16 offset:13600
    ds_read_b64_tr_b16 v[240:241], v16 offset:32
    ds_read_b64_tr_b16 v[242:243], v16 offset:832
    ds_read_b64_tr_b16 v[244:245], v16 offset:12832
    ds_read_b64_tr_b16 v[246:247], v16 offset:13632
    ds_read_b64_tr_b16 v[72:73], v16 offset:64
    ds_read_b64_tr_b16 v[74:75], v16 offset:864
    ds_read_b64_tr_b16 v[76:77], v16 offset:12864
    ds_read_b64_tr_b16 v[78:79], v16 offset:13664
    s_waitcnt lgkmcnt(0)
    ds_write_b128 v17, v[72:75] offset:16384
    ds_write_b128 v17, v[76:79] offset:17408
    s_waitcnt lgkmcnt(0)
    s_barrier
    s_waitcnt vmcnt(6)
    ds_write_b128 v10, v[24:27]
    ds_write_b128 v11, v[28:31]
    ds_write_b128 v12, v[32:35]
    ds_write_b128 v13, v[36:39]
    ds_write_b128 v14, v[40:43]
    ds_write_b128 v15, v[44:47]
    s_waitcnt lgkmcnt(0)
    s_barrier
    ds_read_b64_tr_b16 a[72:73], v16 offset:0
    ds_read_b64_tr_b16 a[74:75], v16 offset:800
    ds_read_b64_tr_b16 a[76:77], v16 offset:12800
    ds_read_b64_tr_b16 a[78:79], v16 offset:13600
    ds_read_b64_tr_b16 a[152:153], v16 offset:32
    ds_read_b64_tr_b16 a[154:155], v16 offset:832
    ds_read_b64_tr_b16 a[156:157], v16 offset:12832
    ds_read_b64_tr_b16 a[158:159], v16 offset:13632
    ds_read_b64_tr_b16 a[232:233], v16 offset:64
    ds_read_b64_tr_b16 a[234:235], v16 offset:864
    ds_read_b64_tr_b16 a[236:237], v16 offset:12864
    ds_read_b64_tr_b16 a[238:239], v16 offset:13664
    s_waitcnt lgkmcnt(0)
    s_barrier
    s_waitcnt vmcnt(0)
    ds_write_b128 v10, v[48:51]
    ds_write_b128 v11, v[52:55]
    ds_write_b128 v12, v[56:59]
    ds_write_b128 v13, v[60:63]
    ds_write_b128 v14, v[64:67]
    ds_write_b128 v15, v[68:71]
    s_waitcnt lgkmcnt(0)
    s_barrier
    ds_read_b64_tr_b16 v[168:169], v16 offset:0
    ds_read_b64_tr_b16 v[170:171], v16 offset:800
    ds_read_b64_tr_b16 v[172:173], v16 offset:12800
    ds_read_b64_tr_b16 v[174:175], v16 offset:13600
    ds_read_b64_tr_b16 v[248:249], v16 offset:32
    ds_read_b64_tr_b16 v[250:251], v16 offset:832
    ds_read_b64_tr_b16 v[252:253], v16 offset:12832
    ds_read_b64_tr_b16 v[254:255], v16 offset:13632
    ds_read_b64_tr_b16 v[48:49], v16 offset:64
    ds_read_b64_tr_b16 v[50:51], v16 offset:864
    ds_read_b64_tr_b16 v[52:53], v16 offset:12864
    ds_read_b64_tr_b16 v[54:55], v16 offset:13664
    s_waitcnt lgkmcnt(0)
    ds_write_b128 v17, v[48:51] offset:18432
    ds_write_b128 v17, v[52:55] offset:19456
    s_waitcnt lgkmcnt(0)
    s_barrier
    v_mov_b32 v6, v17
    v_mov_b32 v30, 0xeeee
    v_mov_b32 v4, 0x4444
    v_cmp_gt_u32 vcc, 8, v2
    s_nop 1
    v_cndmask_b32 v4, v30, v4, vcc
    v_lshlrev_b32 v5, 4, v1
    s_lshl_b32 s24, s3, 10
    v_add_u32 v7, s24, v5
    s_lshl_b32 s24, s3, 9
    s_add_u32 s24, s24, 8192
    v_lshlrev_b32 v8, 3, v1
    v_add_u32 v8, s24, v8
    s_mul_i32 s24, s3, 1536
    s_add_u32 s24, s24, 10240
    v_lshlrev_b32 v9, 5, v2
    v_lshl_add_u32 v9, v3, 3, v9
    v_add_u32 v9, s24, v9
    v_lshrrev_b32 v30, 2, v2
    v_and_b32 v31, 3, v2
    v_lshl_add_u32 v10, v3, 3, v30
    v_lshlrev_b32 v10, 5, v10
    v_lshl_add_u32 v10, v31, 3, v10
    v_add_u32 v10, s24, v10
    v_lshl_add_u32 v11, v3, 2, v30
    v_lshlrev_b32 v11, 5, v11
    v_lshl_add_u32 v11, v31, 3, v11
    v_add_u32 v11, s24, v11
    v_add_u32 v33, 22528, v5
    s_mul_i32 s24, s3, 1408
    s_add_u32 s24, s24, 16384
    v_mul_u32_u24 v30, 176, v2
    v_add_u32 v30, s24, v30
    v_lshl_add_u32 v12, v3, 5, v30
    v_cmp_gt_u32 vcc, 8, v2
    s_nop 1
    v_cndmask_b32 v12, v33, v12, vcc
    v_lshl_add_u32 v13, v3, 4, v30
    v_add_u32 v13, 96, v13
    v_cmp_le_u32 s[24:25], 2, v3
    s_and_b64 vcc, vcc, s[24:25]
    v_cndmask_b32 v13, v33, v13, vcc
    s_mul_i32 s24, s3, 5632
    s_add_u32 s24, s24, 106496
    v_mul_u32_u24 v30, 176, v2
    v_add_u32 v30, s24, v30
    v_lshl_add_u32 v16, v3, 5, v30
    v_lshl_add_u32 v17, v3, 4, v30
    v_add_u32 v17, 96, v17
    v_add_u32 v18, 2816, v17
    v_cmp_le_u32 vcc, 2, v3
    s_nop 1
    v_cndmask_b32 v17, v33, v17, vcc
    v_cndmask_b32 v18, v33, v18, vcc
    v_lshrrev_b32 v30, 3, v1
    v_and_b32 v31, 7, v1
    v_min_u32 v32, 4, v31
    v_mul_u32_u24 v14, 176, v30
    v_lshl_add_u32 v14, v32, 5, v14
    s_mul_i32 s24, s3, 1408
    s_add_u32 s24, s24, 106496
    v_add_u32 v21, s24, v14
    v_add_u32 v14, 16384, v14
    v_cmp_gt_u32 s[50:51], 5, v31
    s_lshl_b32 s24, s3, 3
    v_add_u32 v32, s24, v30
    v_lshlrev_b32 v33, 2, v31
    v_sub_u32 v32, v32, v33
    v_mov_b32 v33, 100
    v_cmp_gt_u32 vcc, 4, v31
    s_nop 1
    v_cndmask_b32 v32, v33, v32, vcc
    v_cmp_le_i32 s[64:65], 0, v32
    v_cmp_le_i32 s[66:67], 1, v32
    v_cmp_le_i32 s[68:69], 2, v32
    v_cmp_le_i32 s[70:71], 3, v32
    v_cmp_le_i32 s[72:73], 16, v32
    v_cmp_le_i32 s[74:75], 17, v32
    v_cmp_le_i32 s[76:77], 18, v32
    v_cmp_le_i32 s[78:79], 19, v32
    s_lshr_b32 s24, s44, 1
    s_lshl_b32 s24, s24, 10
    s_and_b32 s25, s44, 1
    s_lshl_b32 s25, s25, 7
    s_add_u32 s24, s24, s25
    v_lshlrev_b32 v15, 8, v31
    v_lshl_add_u32 v15, v30, 4, v15
    v_add_u32 v15, s24, v15
    s_lshr_b32 s24, s44, 3
    s_lshl_b32 s24, s24, 10
    s_and_b32 s25, s44, 3
    s_lshl_b32 s25, s25, 8
    s_add_u32 s24, s24, s25
    s_lshr_b32 s25, s44, 2
    s_and_b32 s25, s25, 1
    s_lshl_b32 s25, s25, 7
    s_add_u32 s24, s24, s25
    s_add_u32 s24, s24, 16384
    v_lshlrev_b32 v32, 4, v30
    v_add_u32 v32, s24, v32
    v_cmp_eq_u32 vcc, 4, v31
    s_nop 1
    v_cndmask_b32 v15, v15, v32, vcc
    v_mov_b32 v32, 2146435072
    v_cndmask_b32 v15, v32, v15, s[50:51]
    s_mul_i32 s24, s3, 20480
    v_add_u32 v15, s24, v15
    s_cmp_lt_u32 s3, 1
    s_cselect_b32 s24, 0, 2146435072
    v_or_b32 v15, s24, v15
    s_and_b32 s24, s3, 1
    s_lshl_b32 s24, s24, 7
    s_lshr_b32 s25, s3, 1
    s_lshl_b32 s25, s25, 10
    s_add_u32 s24, s24, s25
    s_lshl_b32 s25, s44, 11
    s_add_u32 s25, s25, s24
    v_lshlrev_b32 v22, 8, v31
    v_lshl_add_u32 v22, v30, 4, v22
    v_add_u32 v22, s25, v22
    s_lshr_b32 s25, s44, 2
    s_lshl_b32 s25, s25, 11
    s_add_u32 s25, s25, s24
    s_and_b32 s26, s44, 3
    s_lshl_b32 s26, s26, 8
    s_add_u32 s25, s25, s26
    s_add_u32 s25, s25, 65536
    v_lshlrev_b32 v32, 4, v30
    v_add_u32 v32, s25, v32
    v_cmp_eq_u32 vcc, 4, v31
    s_nop 1
    v_cndmask_b32 v22, v22, v32, vcc
    v_mov_b32 v32, 2146435072
    v_cndmask_b32 v22, v32, v22, s[50:51]
    s_mul_i32 s24, s44, 384
    s_mul_i32 s25, s3, 96
    s_add_u32 s24, s24, s25
    v_mul_u32_u24 v30, 12288, v2
    v_add_u32 v30, s24, v30
    v_lshl_add_u32 v19, v3, 4, v30
    v_lshl_add_u32 v20, v3, 3, v30
    v_add_u32 v20, 64, v20
    v_add_u32 v48, 0, v0
    v_and_b32 v49, 7, v48
    v_mul_u32_u24 v49, 1280, v49
    v_lshrrev_b32 v50, 3, v48
    v_lshl_add_u32 v49, v50, 4, v49
    v_cmp_gt_u32 vcc, 640, v48
    v_mov_b32 v51, 2146435072
    s_nop 0
    v_cndmask_b32 v49, v51, v49, vcc
    buffer_load_dwordx4 v[52:55], v49, s[20:23], 0 offen
    v_lshlrev_b32 v48, 4, v48
    s_waitcnt vmcnt(0)
    s_and_saveexec_b64 s[30:31], vcc
    ds_write_b128 v48, v[52:55]
    s_mov_b64 exec, s[30:31]
    v_add_u32 v48, 256, v0
    v_and_b32 v49, 7, v48
    v_mul_u32_u24 v49, 1280, v49
    v_lshrrev_b32 v50, 3, v48
    v_lshl_add_u32 v49, v50, 4, v49
    v_cmp_gt_u32 vcc, 640, v48
    v_mov_b32 v51, 2146435072
    s_nop 0
    v_cndmask_b32 v49, v51, v49, vcc
    buffer_load_dwordx4 v[52:55], v49, s[20:23], 0 offen
    v_lshlrev_b32 v48, 4, v48
    s_waitcnt vmcnt(0)
    s_and_saveexec_b64 s[30:31], vcc
    ds_write_b128 v48, v[52:55]
    s_mov_b64 exec, s[30:31]
    v_add_u32 v48, 512, v0
    v_and_b32 v49, 7, v48
    v_mul_u32_u24 v49, 1280, v49
    v_lshrrev_b32 v50, 3, v48
    v_lshl_add_u32 v49, v50, 4, v49
    v_cmp_gt_u32 vcc, 640, v48
    v_mov_b32 v51, 2146435072
    s_nop 0
    v_cndmask_b32 v49, v51, v49, vcc
    buffer_load_dwordx4 v[52:55], v49, s[20:23], 0 offen
    v_lshlrev_b32 v48, 4, v48
    s_waitcnt vmcnt(0)
    s_and_saveexec_b64 s[30:31], vcc
    ds_write_b128 v48, v[52:55]
    s_mov_b64 exec, s[30:31]
    s_mov_b32 s40, 0
    s_mov_b32 s41, 92274688
    s_mov_b32 s42, 146317312
    s_mov_b32 s43, 141074432
    s_mov_b32 s45, 67108864
    s_mov_b32 s47, 138412032
    s_add_u32 s24, s41, 196608
    buffer_load_dwordx4 a[240:243], v19, s[8:11], s41 offen
    buffer_load_dwordx2 a[244:245], v20, s[8:11], s41 offen
    buffer_load_dwordx4 a[246:249], v19, s[8:11], s24 offen
    buffer_load_dwordx2 a[250:251], v20, s[8:11], s24 offen
    s_waitcnt lgkmcnt(0)
    s_branch chain2_kernel_s_go
chain2_kernel_s_step:
    v_mov_b32 v24, 0
    v_mov_b32 v25, 0
    v_mov_b32 v26, 0
    v_mov_b32 v27, 0
    v_mov_b32 v28, 0
    v_mov_b32 v29, 0
    v_mov_b32 v30, 0
    v_mov_b32 v31, 0
    v_mov_b32 v32, 0
    v_mov_b32 v33, 0
    v_mov_b32 v34, 0
    v_mov_b32 v35, 0
    v_mov_b32 v36, 0
    v_mov_b32 v37, 0
    v_mov_b32 v38, 0
    v_mov_b32 v39, 0
    v_mov_b32 v40, 0
    v_mov_b32 v41, 0
    v_mov_b32 v42, 0
    v_mov_b32 v43, 0
    v_mov_b32 v44, 0
    v_mov_b32 v45, 0
    v_mov_b32 v46, 0
    v_mov_b32 v47, 0
    s_add_u32 s48, s47, 4096
    s_mov_b32 s61, 0
chain2_kernel_s_pm:
    buffer_load_dwordx4 v[48:51], v7, s[8:11], s47 offen sc1
    buffer_load_dwordx4 v[52:55], v7, s[8:11], s48 offen sc1
    buffer_load_dwordx2 v[56:57], v8, s[8:11], s47 offen sc1
    s_waitcnt vmcnt(0)
    v_max3_u32 v58, v48, v49, v50
    v_max3_u32 v58, v58, v51, v52
    v_max3_u32 v58, v58, v53, v54
    v_max3_u32 v58, v58, v55, v56
    v_max_u32 v58, v58, v57
    v_cmp_eq_u32 vcc, -1, v58
    s_add_u32 s61, s61, 1
    s_cbranch_vccz chain2_kernel_s_pm_out
    s_cmp_ge_u32 s61, s60
    s_cbranch_scc1 chain2_kernel_s_pm_to
    s_sleep 1
    s_branch chain2_kernel_s_pm
chain2_kernel_s_pm_to:
    s_mov_b32 s60, 1
chain2_kernel_s_pm_out:
    ds_write_b128 v7, v[48:51]
    ds_write_b128 v7, v[52:55] offset:4096
    ds_write_b64 v8, v[56:57]
    s_waitcnt lgkmcnt(0)
chain2_kernel_s_go2:
    s_barrier
    ds_read_b128 v[48:51], v5 offset:0
    ds_read_b128 v[68:71], v6 offset:0
    ds_read_b128 v[72:75], v6 offset:1024
    ds_read_b128 v[52:55], v5 offset:1024
    ds_read_b128 v[76:79], v6 offset:2048
    ds_read_b128 v[80:83], v6 offset:3072
    ds_read_b128 v[56:59], v5 offset:2048
    ds_read_b128 v[60:63], v5 offset:3072
    ds_read_b128 v[64:67], v5 offset:4096
    s_waitcnt lgkmcnt(8)
    v_smfmac_f32_16x16x64_bf16 v[24:27], v[48:51], a[0:7], v4
    v_smfmac_f32_16x16x64_bf16 v[28:31], v[48:51], a[80:87], v4
    ds_read_b128 v[84:87], v6 offset:4096
    ds_read_b128 v[88:91], v6 offset:5120
    v_smfmac_f32_16x16x64_bf16 v[32:35], v[48:51], a[160:167], v4
    v_smfmac_f32_16x16x64_bf16 v[36:39], v[48:51], v[96:103], v4
    v_smfmac_f32_16x16x64_bf16 v[40:43], v[48:51], v[176:183], v4
    s_waitcnt lgkmcnt(8)
    v_smfmac_f32_16x16x64_bf16 v[44:47], v[48:51], v[68:75], v4
    ds_read_b128 v[48:51], v5 offset:5120
    s_waitcnt lgkmcnt(8)
    v_smfmac_f32_16x16x64_bf16 v[24:27], v[52:55], a[8:15], v4
    v_smfmac_f32_16x16x64_bf16 v[28:31], v[52:55], a[88:95], v4
    ds_read_b128 v[68:71], v6 offset:6144
    ds_read_b128 v[72:75], v6 offset:7168
    v_smfmac_f32_16x16x64_bf16 v[32:35], v[52:55], a[168:175], v4
    v_smfmac_f32_16x16x64_bf16 v[36:39], v[52:55], v[104:111], v4
    v_smfmac_f32_16x16x64_bf16 v[40:43], v[52:55], v[184:191], v4
    s_waitcnt lgkmcnt(8)
    v_smfmac_f32_16x16x64_bf16 v[44:47], v[52:55], v[76:83], v4
    ds_read_b128 v[52:55], v5 offset:6144
    s_waitcnt lgkmcnt(8)
    v_smfmac_f32_16x16x64_bf16 v[24:27], v[56:59], a[16:23], v4
    v_smfmac_f32_16x16x64_bf16 v[28:31], v[56:59], a[96:103], v4
    ds_read_b128 v[76:79], v6 offset:8192
    ds_read_b128 v[80:83], v6 offset:9216
    v_smfmac_f32_16x16x64_bf16 v[32:35], v[56:59], a[176:183], v4
    v_smfmac_f32_16x16x64_bf16 v[36:39], v[56:59], v[112:119], v4
    v_smfmac_f32_16x16x64_bf16 v[40:43], v[56:59], v[192:199], v4
    s_waitcnt lgkmcnt(6)
    v_smfmac_f32_16x16x64_bf16 v[44:47], v[56:59], v[84:91], v4
    ds_read_b128 v[56:59], v5 offset:7168
    v_smfmac_f32_16x16x64_bf16 v[24:27], v[60:63], a[24:31], v4
    v_smfmac_f32_16x16x64_bf16 v[28:31], v[60:63], a[104:111], v4
    ds_read_b128 v[84:87], v6 offset:10240
    ds_read_b128 v[88:91], v6 offset:11264
    v_smfmac_f32_16x16x64_bf16 v[32:35], v[60:63], a[184:191], v4
    v_smfmac_f32_16x16x64_bf16 v[36:39], v[60:63], v[120:127], v4
    v_smfmac_f32_16x16x64_bf16 v[40:43], v[60:63], v[200:207], v4
    s_waitcnt lgkmcnt(6)
    v_smfmac_f32_16x16x64_bf16 v[44:47], v[60:63], v[68:75], v4
    ds_read_b128 v[60:63], v5 offset:8192
    v_smfmac_f32_16x16x64_bf16 v[24:27], v[64:67], a[32:39], v4
    v_smfmac_f32_16x16x64_bf16 v[28:31], v[64:67], a[112:119], v4
    ds_read_b128 v[68:71], v6 offset:12288
    ds_read_b128 v[72:75], v6 offset:13312
    v_smfmac_f32_16x16x64_bf16 v[32:35], v[64:67], a[192:199], v4
    v_smfmac_f32_16x16x64_bf16 v[36:39], v[64:67], v[128:135], v4
    v_smfmac_f32_16x16x64_bf16 v[40:43], v[64:67], v[208:215], v4
    s_waitcnt lgkmcnt(6)
    v_smfmac_f32_16x16x64_bf16 v[44:47], v[64:67], v[76:83], v4
    ds_read_b128 v[64:67], v5 offset:9216
    v_smfmac_f32_16x16x64_bf16 v[24:27], v[48:51], a[40:47], v4
    v_smfmac_f32_16x16x64_bf16 v[28:31], v[48:51], a[120:127], v4
    ds_read_b128 v[76:79], v6 offset:14336
    ds_read_b128 v[80:83], v6 offset:15360
    v_smfmac_f32_16x16x64_bf16 v[32:35], v[48:51], a[200:207], v4
    v_smfmac_f32_16x16x64_bf16 v[36:39], v[48:51], v[136:143], v4
    v_smfmac_f32_16x16x64_bf16 v[40:43], v[48:51], v[216:223], v4
    s_waitcnt lgkmcnt(6)
    v_smfmac_f32_16x16x64_bf16 v[44:47], v[48:51], v[84:91], v4
    v_smfmac_f32_16x16x64_bf16 v[24:27], v[52:55], a[48:55], v4
    v_smfmac_f32_16x16x64_bf16 v[28:31], v[52:55], a[128:135], v4
    ds_read_b128 v[84:87], v6 offset:16384
    ds_read_b128 v[88:91], v6 offset:17408
    v_smfmac_f32_16x16x64_bf16 v[32:35], v[52:55], a[208:215], v4
    v_smfmac_f32_16x16x64_bf16 v[36:39], v[52:55], v[144:151], v4
    v_smfmac_f32_16x16x64_bf16 v[40:43], v[52:55], v[224:231], v4
    s_waitcnt lgkmcnt(5)
    v_smfmac_f32_16x16x64_bf16 v[44:47], v[52:55], v[68:75], v4
    v_smfmac_f32_16x16x64_bf16 v[24:27], v[56:59], a[56:63], v4
    v_smfmac_f32_16x16x64_bf16 v[28:31], v[56:59], a[136:143], v4
    ds_read_b128 v[68:71], v6 offset:18432
    ds_read_b128 v[72:75], v6 offset:19456
    v_smfmac_f32_16x16x64_bf16 v[32:35], v[56:59], a[216:223], v4
    v_smfmac_f32_16x16x64_bf16 v[36:39], v[56:59], v[152:159], v4
    v_smfmac_f32_16x16x64_bf16 v[40:43], v[56:59], v[232:239], v4
    s_waitcnt lgkmcnt(4)
    v_smfmac_f32_16x16x64_bf16 v[44:47], v[56:59], v[76:83], v4
    v_smfmac_f32_16x16x64_bf16 v[24:27], v[60:63], a[64:71], v4
    v_smfmac_f32_16x16x64_bf16 v[28:31], v[60:63], a[144:151], v4
    v_smfmac_f32_16x16x64_bf16 v[32:35], v[60:63], a[224:231], v4
    v_smfmac_f32_16x16x64_bf16 v[36:39], v[60:63], v[160:167], v4
    v_smfmac_f32_16x16x64_bf16 v[40:43], v[60:63], v[240:247], v4
    s_waitcnt lgkmcnt(2)
    v_smfmac_f32_16x16x64_bf16 v[44:47], v[60:63], v[84:91], v4
    v_smfmac_f32_16x16x64_bf16 v[24:27], v[64:67], a[72:79], v4
    v_smfmac_f32_16x16x64_bf16 v[28:31], v[64:67], a[152:159], v4
    v_smfmac_f32_16x16x64_bf16 v[32:35], v[64:67], a[232:239], v4
    v_smfmac_f32_16x16x64_bf16 v[36:39], v[64:67], v[168:175], v4
    v_smfmac_f32_16x16x64_bf16 v[40:43], v[64:67], v[248:255], v4
    s_waitcnt lgkmcnt(0)
    v_smfmac_f32_16x16x64_bf16 v[44:47], v[64:67], v[68:75], v4
    s_add_u32 s24, s45, 196608
    buffer_load_dwordx4 v[80:83], v19, s[8:11], s45 offen
    buffer_load_dwordx2 v[84:85], v20, s[8:11], s45 offen
    buffer_load_dwordx4 v[86:89], v19, s[8:11], s24 offen
    buffer_load_dwordx2 v[90:91], v20, s[8:11], s24 offen
    s_nop 3
    v_permlane32_swap_b32 v24, v36
    v_permlane32_swap_b32 v25, v37
    v_permlane32_swap_b32 v26, v38
    v_permlane32_swap_b32 v27, v39
    v_add_f32 v24, v24, v36
    v_add_f32 v25, v25, v37
    v_add_f32 v26, v26, v38
    v_add_f32 v27, v27, v39
    v_cvt_pk_bf16_f32 v48, v24, v25
    v_cvt_pk_bf16_f32 v49, v26, v27
    ds_write_b64 v9, v[48:49] offset:0
    v_permlane32_swap_b32 v28, v40
    v_permlane32_swap_b32 v29, v41
    v_permlane32_swap_b32 v30, v42
    v_permlane32_swap_b32 v31, v43
    v_add_f32 v28, v28, v40
    v_add_f32 v29, v29, v41
    v_add_f32 v30, v30, v42
    v_add_f32 v31, v31, v43
    v_cvt_pk_bf16_f32 v50, v28, v29
    v_cvt_pk_bf16_f32 v51, v30, v31
    ds_write_b64 v9, v[50:51] offset:512
    v_permlane32_swap_b32 v32, v44
    v_permlane32_swap_b32 v33, v45
    v_permlane32_swap_b32 v34, v46
    v_permlane32_swap_b32 v35, v47
    v_add_f32 v32, v32, v44
    v_add_f32 v33, v33, v45
    v_add_f32 v34, v34, v46
    v_add_f32 v35, v35, v47
    v_cvt_pk_bf16_f32 v52, v32, v33
    v_cvt_pk_bf16_f32 v53, v34, v35
    ds_write_b64 v9, v[52:53] offset:1024
    s_waitcnt lgkmcnt(0)
    ds_read_b64_tr_b16 v[24:25], v10
    ds_read_b64_tr_b16 v[26:27], v10 offset:128
    ds_read_b64_tr_b16 v[28:29], v11 offset:1024
    s_waitcnt lgkmcnt(0)
    v_mfma_f32_16x16x32_bf16 v[64:67], a[240:243], v[24:27], 0
    v_mfma_f32_16x16x32_bf16 v[68:71], a[246:249], v[24:27], 0
    v_mfma_f32_16x16x32_bf16 v[72:75], v[24:27], v[24:27], 0
    s_nop 3
    v_mfma_f32_16x16x16_bf16 v[64:67], a[244:245], v[28:29], v[64:67]
    v_mfma_f32_16x16x16_bf16 v[68:71], a[250:251], v[28:29], v[68:71]
    v_mfma_f32_16x16x16_bf16 v[72:75], v[28:29], v[28:29], v[72:75]
    s_nop 5
    ds_write_b128 v12, v[64:67]
    ds_write_b128 v12, v[68:71] offset:16
    ds_write_b128 v13, v[72:75]
    s_waitcnt lgkmcnt(0)
    s_barrier
    ds_read_b128 v[48:51], v14 offset:0
    ds_read_b128 v[52:55], v14 offset:16
    ds_read_b128 v[56:59], v14 offset:1408
    ds_read_b128 v[60:63], v14 offset:1424
    ds_read_b128 v[64:67], v14 offset:2816
    ds_read_b128 v[68:71], v14 offset:2832
    ds_read_b128 v[72:75], v14 offset:4224
    ds_read_b128 v[76:79], v14 offset:4240
    s_waitcnt lgkmcnt(4)
    v_pk_add_f32 v[48:49], v[48:49], v[56:57]
    v_pk_add_f32 v[50:51], v[50:51], v[58:59]
    v_pk_add_f32 v[52:53], v[52:53], v[60:61]
    v_pk_add_f32 v[54:55], v[54:55], v[62:63]
    s_waitcnt lgkmcnt(0)
    v_pk_add_f32 v[64:65], v[64:65], v[72:73]
    v_pk_add_f32 v[66:67], v[66:67], v[74:75]
    v_pk_add_f32 v[68:69], v[68:69], v[76:77]
    v_pk_add_f32 v[70:71], v[70:71], v[78:79]
    v_pk_add_f32 v[48:49], v[48:49], v[64:65]
    v_pk_add_f32 v[50:51], v[50:51], v[66:67]
    v_pk_add_f32 v[52:53], v[52:53], v[68:69]
    v_pk_add_f32 v[54:55], v[54:55], v[70:71]
    v_max3_f32 v92, v48, v49, v50
    v_max3_f32 v92, v92, v51, v52
    v_max3_f32 v92, v92, v53, v54
    v_max_f32 v92, v92, v55
    v_mov_b32 v93, 0xff800000
    v_cndmask_b32 v92, v93, v92, s[50:51]
    s_nop 1
    v_max_f32 v92, v92, v92 quad_perm:[1,0,3,2] row_mask:0xf bank_mask:0xf
    s_nop 1
    v_max_f32 v92, v92, v92 quad_perm:[2,3,0,1] row_mask:0xf bank_mask:0xf
    s_nop 1
    v_max_f32 v92, v92, v92 row_half_mirror row_mask:0xf bank_mask:0xf
    s_mov_b32 s24, 0x3dd53b95
    v_mul_f32 v92, s24, v92
    v_fma_f32 v48, v48, s24, -v92
    v_fma_f32 v49, v49, s24, -v92
    v_fma_f32 v50, v50, s24, -v92
    v_fma_f32 v51, v51, s24, -v92
    v_fma_f32 v52, v52, s24, -v92
    v_fma_f32 v53, v53, s24, -v92
    v_fma_f32 v54, v54, s24, -v92
    v_fma_f32 v55, v55, s24, -v92
    v_exp_f32 v48, v48
    v_exp_f32 v49, v49
    v_exp_f32 v50, v50
    v_exp_f32 v51, v51
    v_exp_f32 v52, v52
    v_exp_f32 v53, v53
    v_exp_f32 v54, v54
    v_exp_f32 v55, v55
    v_add_f32 v92, v48, v49
    v_add_f32 v93, v50, v51
    v_add_f32 v92, v92, v52
    v_add_f32 v93, v93, v53
    v_add_f32 v92, v92, v54
    v_add_f32 v93, v93, v55
    v_add_f32 v92, v92, v93
    v_cndmask_b32 v92, 0, v92, s[50:51]
    s_nop 1
    v_add_f32 v92, v92, v92 quad_perm:[1,0,3,2] row_mask:0xf bank_mask:0xf
    s_nop 1
    v_add_f32 v92, v92, v92 quad_perm:[2,3,0,1] row_mask:0xf bank_mask:0xf
    s_nop 1
    v_add_f32 v92, v92, v92 row_half_mirror row_mask:0xf bank_mask:0xf
    v_rcp_f32 v92, v92
    s_nop 0
    v_mul_f32 v48, v48, v92
    v_mul_f32 v49, v49, v92
    v_mul_f32 v50, v50, v92
    v_mul_f32 v51, v51, v92
    v_mul_f32 v52, v52, v92
    v_mul_f32 v53, v53, v92
    v_mul_f32 v54, v54, v92
    v_mul_f32 v55, v55, v92
    v_cvt_pk_bf16_f32 v56, v48, v49
    v_cvt_pk_bf16_f32 v57, v50, v51
    v_cvt_pk_bf16_f32 v58, v52, v53
    v_cvt_pk_bf16_f32 v59, v54, v55
    v_min_u32 v56, -2, v56
    v_min_u32 v57, -2, v57
    v_min_u32 v58, -2, v58
    v_min_u32 v59, -2, v59
    buffer_store_dwordx4 v[56:59], v15, s[8:11], s43 offen sc1
    s_waitcnt vmcnt(1)
    v_mfma_f32_16x16x32_bf16 v[32:35], a[240:243], v[80:83], 0
    v_mfma_f32_16x16x32_bf16 v[40:43], a[246:249], v[80:83], 0
    v_mfma_f32_16x16x32_bf16 v[64:67], v[24:27], v[80:83], 0
    v_mfma_f32_16x16x32_bf16 v[36:39], a[240:243], v[86:89], 0
    v_mfma_f32_16x16x32_bf16 v[44:47], a[246:249], v[86:89], 0
    v_mfma_f32_16x16x32_bf16 v[68:71], v[24:27], v[86:89], 0
    s_nop 0
    v_mfma_f32_16x16x16_bf16 v[32:35], a[244:245], v[84:85], v[32:35]
    v_mfma_f32_16x16x16_bf16 v[40:43], a[250:251], v[84:85], v[40:43]
    v_mfma_f32_16x16x16_bf16 v[64:67], v[28:29], v[84:85], v[64:67]
    v_mfma_f32_16x16x16_bf16 v[36:39], a[244:245], v[90:91], v[36:39]
    v_mfma_f32_16x16x16_bf16 v[44:47], a[250:251], v[90:91], v[44:47]
    v_mfma_f32_16x16x16_bf16 v[68:71], v[28:29], v[90:91], v[68:71]
    s_nop 2
    ds_write_b128 v16, v[32:35] offset:0
    ds_write_b128 v16, v[40:43] offset:16
    ds_write_b128 v17, v[64:67]
    ds_write_b128 v16, v[36:39] offset:2816
    ds_write_b128 v16, v[44:47] offset:2832
    ds_write_b128 v18, v[68:71]
    s_add_u32 s40, s40, 1
    s_add_u32 s41, s41, 393216
    s_add_u32 s45, s45, 393216
    s_add_u32 s43, s43, 81920
    s_add_u32 s47, s47, 40960
    s_waitcnt lgkmcnt(0)
    s_barrier
    s_add_u32 s24, s41, 196608
    buffer_load_dwordx4 a[240:243], v19, s[8:11], s41 offen
    buffer_load_dwordx2 a[244:245], v20, s[8:11], s41 offen
    buffer_load_dwordx4 a[246:249], v19, s[8:11], s24 offen
    buffer_load_dwordx2 a[250:251], v20, s[8:11], s24 offen
    ds_read_b128 v[48:51], v21 offset:0
    ds_read_b128 v[52:55], v21 offset:16
    ds_read_b128 v[56:59], v21 offset:5632
    ds_read_b128 v[60:63], v21 offset:5648
    ds_read_b128 v[64:67], v21 offset:11264
    ds_read_b128 v[68:71], v21 offset:11280
    ds_read_b128 v[72:75], v21 offset:16896
    ds_read_b128 v[76:79], v21 offset:16912
    s_waitcnt lgkmcnt(4)
    v_pk_add_f32 v[48:49], v[48:49], v[56:57]
    v_pk_add_f32 v[50:51], v[50:51], v[58:59]
    v_pk_add_f32 v[52:53], v[52:53], v[60:61]
    v_pk_add_f32 v[54:55], v[54:55], v[62:63]
    s_waitcnt lgkmcnt(0)
    v_pk_add_f32 v[64:65], v[64:65], v[72:73]
    v_pk_add_f32 v[66:67], v[66:67], v[74:75]
    v_pk_add_f32 v[68:69], v[68:69], v[76:77]
    v_pk_add_f32 v[70:71], v[70:71], v[78:79]
    v_pk_add_f32 v[48:49], v[48:49], v[64:65]
    v_pk_add_f32 v[50:51], v[50:51], v[66:67]
    v_pk_add_f32 v[52:53], v[52:53], v[68:69]
    v_pk_add_f32 v[54:55], v[54:55], v[70:71]
    v_mov_b32 v93, 0xff800000
    v_cndmask_b32 v48, v93, v48, s[64:65]
    v_cndmask_b32 v49, v93, v49, s[66:67]
    v_cndmask_b32 v50, v93, v50, s[68:69]
    v_cndmask_b32 v51, v93, v51, s[70:71]
    v_cndmask_b32 v52, v93, v52, s[72:73]
    v_cndmask_b32 v53, v93, v53, s[74:75]
    v_cndmask_b32 v54, v93, v54, s[76:77]
    v_cndmask_b32 v55, v93, v55, s[78:79]
    v_max3_f32 v92, v48, v49, v50
    v_max3_f32 v92, v92, v51, v52
    v_max3_f32 v92, v92, v53, v54
    v_max_f32 v92, v92, v55
    v_mov_b32 v93, 0xff800000
    v_cndmask_b32 v92, v93, v92, s[50:51]
    s_nop 1
    v_max_f32 v92, v92, v92 quad_perm:[1,0,3,2] row_mask:0xf bank_mask:0xf
    s_nop 1
    v_max_f32 v92, v92, v92 quad_perm:[2,3,0,1] row_mask:0xf bank_mask:0xf
    s_nop 1
    v_max_f32 v92, v92, v92 row_half_mirror row_mask:0xf bank_mask:0xf
    s_mov_b32 s24, 0x3dd53b95
    v_mul_f32 v92, s24, v92
    v_fma_f32 v48, v48, s24, -v92
    v_fma_f32 v49, v49, s24, -v92
    v_fma_f32 v50, v50, s24, -v92
    v_fma_f32 v51, v51, s24, -v92
    v_fma_f32 v52, v52, s24, -v92
    v_fma_f32 v53, v53, s24, -v92
    v_fma_f32 v54, v54, s24, -v92
    v_fma_f32 v55, v55, s24, -v92
    v_exp_f32 v48, v48
    v_exp_f32 v49, v49
    v_exp_f32 v50, v50
    v_exp_f32 v51, v51
    v_exp_f32 v52, v52
    v_exp_f32 v53, v53
    v_exp_f32 v54, v54
    v_exp_f32 v55, v55
    v_add_f32 v92, v48, v49
    v_add_f32 v93, v50, v51
    v_add_f32 v92, v92, v52
    v_add_f32 v93, v93, v53
    v_add_f32 v92, v92, v54
    v_add_f32 v93, v93, v55
    v_add_f32 v92, v92, v93
    v_cndmask_b32 v92, 0, v92, s[50:51]
    s_nop 1
    v_add_f32 v92, v92, v92 quad_perm:[1,0,3,2] row_mask:0xf bank_mask:0xf
    s_nop 1
    v_add_f32 v92, v92, v92 quad_perm:[2,3,0,1] row_mask:0xf bank_mask:0xf
    s_nop 1
    v_add_f32 v92, v92, v92 row_half_mirror row_mask:0xf bank_mask:0xf
    v_rcp_f32 v92, v92
    s_nop 0
    v_mul_f32 v48, v48, v92
    v_mul_f32 v49, v49, v92
    v_mul_f32 v50, v50, v92
    v_mul_f32 v51, v51, v92
    v_mul_f32 v52, v52, v92
    v_mul_f32 v53, v53, v92
    v_mul_f32 v54, v54, v92
    v_mul_f32 v55, v55, v92
    v_cvt_pk_bf16_f32 v56, v48, v49
    v_cvt_pk_bf16_f32 v57, v50, v51
    v_cvt_pk_bf16_f32 v58, v52, v53
    v_cvt_pk_bf16_f32 v59, v54, v55
    v_min_u32 v56, -2, v56
    v_min_u32 v57, -2, v57
    v_min_u32 v58, -2, v58
    v_min_u32 v59, -2, v59
    buffer_store_dwordx4 v[56:59], v22, s[8:11], s42 offen sc1
    s_add_u32 s42, s42, 81920
    s_cmp_lt_u32 s40, 64
    s_cbranch_scc1 chain2_kernel_s_step
    s_branch chain2_kernel_end
chain2_kernel_s_go:
    v_mov_b32 v24, 0
    v_mov_b32 v25, 0
    v_mov_b32 v26, 0
    v_mov_b32 v27, 0
    v_mov_b32 v28, 0
    v_mov_b32 v29, 0
    v_mov_b32 v30, 0
    v_mov_b32 v31, 0
    v_mov_b32 v32, 0
    v_mov_b32 v33, 0
    v_mov_b32 v34, 0
    v_mov_b32 v35, 0
    v_mov_b32 v36, 0
    v_mov_b32 v37, 0
    v_mov_b32 v38, 0
    v_mov_b32 v39, 0
    v_mov_b32 v40, 0
    v_mov_b32 v41, 0
    v_mov_b32 v42, 0
    v_mov_b32 v43, 0
    v_mov_b32 v44, 0
    v_mov_b32 v45, 0
    v_mov_b32 v46, 0
    v_mov_b32 v47, 0
    s_waitcnt vmcnt(0)
    s_branch chain2_kernel_s_go2
chain2_kernel_roleV:
    s_sub_u32 s44, s2, 32
    s_load_dwordx2 s[6:7], s[0:1], 56
    s_load_dwordx2 s[24:25], s[0:1], 64
    s_waitcnt lgkmcnt(0)
    s_mov_b32 s12, s6
    s_mov_b32 s13, s7
    s_mov_b32 s14, 7864320
    s_mov_b32 s15, 0x00020000
    s_mov_b32 s16, s24
    s_mov_b32 s17, s25
    s_mov_b32 s18, 7864320
    s_mov_b32 s19, 0x00020000
    v_add_u32 v16, 0, v0
    s_mov_b32 s24, 683
    v_mul_lo_u32 v17, v16, s24
    v_lshrrev_b32 v17, 14, v17
    v_mul_u32_u24 v18, 24, v17
    v_sub_u32 v18, v16, v18
    s_mov_b32 s24, 12288
    v_mul_lo_u32 v4, v17, s24
    v_lshl_add_u32 v4, v18, 4, v4
    v_mul_u32_u24 v10, 400, v17
    v_lshl_add_u32 v10, v18, 4, v10
    v_add_u32 v10, 90112, v10
    v_add_u32 v16, 256, v0
    s_mov_b32 s24, 683
    v_mul_lo_u32 v17, v16, s24
    v_lshrrev_b32 v17, 14, v17
    v_mul_u32_u24 v18, 24, v17
    v_sub_u32 v18, v16, v18
    s_mov_b32 s24, 12288
    v_mul_lo_u32 v5, v17, s24
    v_lshl_add_u32 v5, v18, 4, v5
    v_mul_u32_u24 v11, 400, v17
    v_lshl_add_u32 v11, v18, 4, v11
    v_add_u32 v11, 90112, v11
    v_add_u32 v16, 512, v0
    s_mov_b32 s24, 683
    v_mul_lo_u32 v17, v16, s24
    v_lshrrev_b32 v17, 14, v17
    v_mul_u32_u24 v18, 24, v17
    v_sub_u32 v18, v16, v18
    s_mov_b32 s24, 12288
    v_mul_lo_u32 v6, v17, s24
    v_lshl_add_u32 v6, v18, 4, v6
    v_mul_u32_u24 v12, 400, v17
    v_lshl_add_u32 v12, v18, 4, v12
    v_add_u32 v12, 90112, v12
    v_add_u32 v16, 768, v0
    s_mov_b32 s24, 683
    v_mul_lo_u32 v17, v16, s24
    v_lshrrev_b32 v17, 14, v17
    v_mul_u32_u24 v18, 24, v17
    v_sub_u32 v18, v16, v18
    s_mov_b32 s24, 12288
    v_mul_lo_u32 v7, v17, s24
    v_lshl_add_u32 v7, v18, 4, v7
    v_mul_u32_u24 v13, 400, v17
    v_lshl_add_u32 v13, v18, 4, v13
    v_add_u32 v13, 90112, v13
    v_add_u32 v16, 1024, v0
    s_mov_b32 s24, 683
    v_mul_lo_u32 v17, v16, s24
    v_lshrrev_b32 v17, 14, v17
    v_mul_u32_u24 v18, 24, v17
    v_sub_u32 v18, v16, v18
    s_mov_b32 s24, 12288
    v_mul_lo_u32 v8, v17, s24
    v_lshl_add_u32 v8, v18, 4, v8
    v_mul_u32_u24 v14, 400, v17
    v_lshl_add_u32 v14, v18, 4, v14
    v_add_u32 v14, 90112, v14
    v_add_u32 v16, 1280, v0
    s_mov_b32 s24, 683
    v_mul_lo_u32 v17, v16, s24
    v_lshrrev_b32 v17, 14, v17
    v_mul_u32_u24 v18, 24, v17
    v_sub_u32 v18, v16, v18
    s_mov_b32 s24, 12288
    v_mul_lo_u32 v9, v17, s24
    v_lshl_add_u32 v9, v18, 4, v9
    v_mul_u32_u24 v15, 400, v17
    v_lshl_add_u32 v15, v18, 4, v15
    v_add_u32 v15, 90112, v15
    v_lshrrev_b32 v17, 1, v3
    v_lshlrev_b32 v17, 4, v17
    v_and_b32 v18, 1, v3
    v_lshl_add_u32 v17, v18, 2, v17
    v_lshrrev_b32 v18, 2, v2
    v_and_b32 v19, 1, v18
    v_add_u32 v17, v17, v19
    v_lshrrev_b32 v18, 1, v18
    v_lshl_add_u32 v17, v18, 3, v17
    v_mul_u32_u24 v16, 400, v17
    v_and_b32 v18, 3, v2
    v_lshl_add_u32 v16, v18, 3, v16
    v_add_u32 v16, 90112, v16
    s_mul_i32 s24, s3, 96
    v_add_u32 v16, s24, v16
    s_mul_i32 s45, s44, 384
    s_add_u32 s46, s45, 0
    buffer_load_dwordx4 v[24:27], v4, s[12:15], s46 offen
    buffer_load_dwordx4 v[28:31], v5, s[12:15], s46 offen
    buffer_load_dwordx4 v[32:35], v6, s[12:15], s46 offen
    buffer_load_dwordx4 v[36:39], v7, s[12:15], s46 offen
    buffer_load_dwordx4 v[40:43], v8, s[12:15], s46 offen
    buffer_load_dwordx4 v[44:47], v9, s[12:15], s46 offen
    s_add_u32 s46, s45, 786432
    buffer_load_dwordx4 v[48:51], v4, s[12:15], s46 offen
    buffer_load_dwordx4 v[52:55], v5, s[12:15], s46 offen
    buffer_load_dwordx4 v[56:59], v6, s[12:15], s46 offen
    buffer_load_dwordx4 v[60:63], v7, s[12:15], s46 offen
    buffer_load_dwordx4 v[64:67], v8, s[12:15], s46 offen
    buffer_load_dwordx4 v[68:71], v9, s[12:15], s46 offen
    s_waitcnt vmcnt(6)
    ds_write_b128 v10, v[24:27]
    ds_write_b128 v11, v[28:31]
    ds_write_b128 v12, v[32:35]
    ds_write_b128 v13, v[36:39]
    ds_write_b128 v14, v[40:43]
    ds_write_b128 v15, v[44:47]
    s_add_u32 s46, s45, 1572864
    buffer_load_dwordx4 v[72:75], v4, s[12:15], s46 offen
    buffer_load_dwordx4 v[76:79], v5, s[12:15], s46 offen
    buffer_load_dwordx4 v[80:83], v6, s[12:15], s46 offen
    buffer_load_dwordx4 v[84:87], v7, s[12:15], s46 offen
    buffer_load_dwordx4 v[88:91], v8, s[12:15], s46 offen
    buffer_load_dwordx4 v[92:95], v9, s[12:15], s46 offen
    s_waitcnt lgkmcnt(0)
    s_barrier
    ds_read_b64_tr_b16 a[0:1], v16 offset:0
    ds_read_b64_tr_b16 a[2:3], v16 offset:800
    ds_read_b64_tr_b16 a[4:5], v16 offset:12800
    ds_read_b64_tr_b16 a[6:7], v16 offset:13600
    ds_read_b64_tr_b16 a[80:81], v16 offset:32
    ds_read_b64_tr_b16 a[82:83], v16 offset:832
    ds_read_b64_tr_b16 a[84:85], v16 offset:12832
    ds_read_b64_tr_b16 a[86:87], v16 offset:13632
    ds_read_b64_tr_b16 a[160:161], v16 offset:64
    ds_read_b64_tr_b16 a[162:163], v16 offset:864
    ds_read_b64_tr_b16 a[164:165], v16 offset:12864
    ds_read_b64_tr_b16 a[166:167], v16 offset:13664
    s_waitcnt lgkmcnt(0)
    s_barrier
    s_waitcnt vmcnt(6)
    ds_write_b128 v10, v[48:51]
    ds_write_b128 v11, v[52:55]
    ds_write_b128 v12, v[56:59]
    ds_write_b128 v13, v[60:63]
    ds_write_b128 v14, v[64:67]
    ds_write_b128 v15, v[68:71]
    s_add_u32 s46, s45, 2359296
    buffer_load_dwordx4 v[24:27], v4, s[12:15], s46 offen
    buffer_load_dwordx4 v[28:31], v5, s[12:15], s46 offen
    buffer_load_dwordx4 v[32:35], v6, s[12:15], s46 offen
    buffer_load_dwordx4 v[36:39], v7, s[12:15], s46 offen
    buffer_load_dwordx4 v[40:43], v8, s[12:15], s46 offen
    buffer_load_dwordx4 v[44:47], v9, s[12:15], s46 offen
    s_waitcnt lgkmcnt(0)
    s_barrier
    ds_read_b64_tr_b16 a[8:9], v16 offset:0
    ds_read_b64_tr_b16 a[10:11], v16 offset:800
    ds_read_b64_tr_b16 a[12:13], v16 offset:12800
    ds_read_b64_tr_b16 a[14:15], v16 offset:13600
    ds_read_b64_tr_b16 a[88:89], v16 offset:32
    ds_read_b64_tr_b16 a[90:91], v16 offset:832
    ds_read_b64_tr_b16 a[92:93], v16 offset:12832
    ds_read_b64_tr_b16 a[94:95], v16 offset:13632
    ds_read_b64_tr_b16 a[168:169], v16 offset:64
    ds_read_b64_tr_b16 a[170:171], v16 offset:864
    ds_read_b64_tr_b16 a[172:173], v16 offset:12864
    ds_read_b64_tr_b16 a[174:175], v16 offset:13664
    s_waitcnt lgkmcnt(0)
    s_barrier
    s_waitcnt vmcnt(6)
    ds_write_b128 v10, v[72:75]
    ds_write_b128 v11, v[76:79]
    ds_write_b128 v12, v[80:83]
    ds_write_b128 v13, v[84:87]
    ds_write_b128 v14, v[88:91]
    ds_write_b128 v15, v[92:95]
    s_add_u32 s46, s45, 3145728
    buffer_load_dwordx4 v[48:51], v4, s[12:15], s46 offen
    buffer_load_dwordx4 v[52:55], v5, s[12:15], s46 offen
    buffer_load_dwordx4 v[56:59], v6, s[12:15], s46 offen
    buffer_load_dwordx4 v[60:63], v7, s[12:15], s46 offen
    buffer_load_dwordx4 v[64:67], v8, s[12:15], s46 offen
    buffer_load_dwordx4 v[68:71], v9, s[12:15], s46 offen
    s_waitcnt lgkmcnt(0)
    s_barrier
    ds_read_b64_tr_b16 a[16:17], v16 offset:0
    ds_read_b64_tr_b16 a[18:19], v16 offset:800
    ds_read_b64_tr_b16 a[20:21], v16 offset:12800
    ds_read_b64_tr_b16 a[22:23], v16 offset:13600
    ds_read_b64_tr_b16 a[96:97], v16 offset:32
    ds_read_b64_tr_b16 a[98:99], v16 offset:832
    ds_read_b64_tr_b16 a[100:101], v16 offset:12832
    ds_read_b64_tr_b16 a[102:103], v16 offset:13632
    ds_read_b64_tr_b16 a[176:177], v16 offset:64
    ds_read_b64_tr_b16 a[178:179], v16 offset:864
    ds_read_b64_tr_b16 a[180:181], v16 offset:12864
    ds_read_b64_tr_b16 a[182:183], v16 offset:13664
    s_waitcnt lgkmcnt(0)
    s_barrier
    s_waitcnt vmcnt(6)
    ds_write_b128 v10, v[24:27]
    ds_write_b128 v11, v[28:31]
    ds_write_b128 v12, v[32:35]
    ds_write_b128 v13, v[36:39]
    ds_write_b128 v14, v[40:43]
    ds_write_b128 v15, v[44:47]
    s_add_u32 s46, s45, 3932160
    buffer_load_dwordx4 v[72:75], v4, s[12:15], s46 offen
    buffer_load_dwordx4 v[76:79], v5, s[12:15], s46 offen
    buffer_load_dwordx4 v[80:83], v6, s[12:15], s46 offen
    buffer_load_dwordx4 v[84:87], v7, s[12:15], s46 offen
    buffer_load_dwordx4 v[88:91], v8, s[12:15], s46 offen
    buffer_load_dwordx4 v[92:95], v9, s[12:15], s46 offen
    s_waitcnt lgkmcnt(0)
    s_barrier
    ds_read_b64_tr_b16 a[24:25], v16 offset:0
    ds_read_b64_tr_b16 a[26:27], v16 offset:800
    ds_read_b64_tr_b16 a[28:29], v16 offset:12800
    ds_read_b64_tr_b16 a[30:31], v16 offset:13600
    ds_read_b64_tr_b16 a[104:105], v16 offset:32
    ds_read_b64_tr_b16 a[106:107], v16 offset:832
    ds_read_b64_tr_b16 a[108:109], v16 offset:12832
    ds_read_b64_tr_b16 a[110:111], v16 offset:13632
    ds_read_b64_tr_b16 a[184:185], v16 offset:64
    ds_read_b64_tr_b16 a[186:187], v16 offset:864
    ds_read_b64_tr_b16 a[188:189], v16 offset:12864
    ds_read_b64_tr_b16 a[190:191], v16 offset:13664
    s_waitcnt lgkmcnt(0)
    s_barrier
    s_waitcnt vmcnt(6)
    ds_write_b128 v10, v[48:51]
    ds_write_b128 v11, v[52:55]
    ds_write_b128 v12, v[56:59]
    ds_write_b128 v13, v[60:63]
    ds_write_b128 v14, v[64:67]
    ds_write_b128 v15, v[68:71]
    s_add_u32 s46, s45, 4718592
    buffer_load_dwordx4 v[24:27], v4, s[12:15], s46 offen
    buffer_load_dwordx4 v[28:31], v5, s[12:15], s46 offen
    buffer_load_dwordx4 v[32:35], v6, s[12:15], s46 offen
    buffer_load_dwordx4 v[36:39], v7, s[12:15], s46 offen
    buffer_load_dwordx4 v[40:43], v8, s[12:15], s46 offen
    buffer_load_dwordx4 v[44:47], v9, s[12:15], s46 offen
    s_waitcnt lgkmcnt(0)
    s_barrier
    ds_read_b64_tr_b16 a[32:33], v16 offset:0
    ds_read_b64_tr_b16 a[34:35], v16 offset:800
    ds_read_b64_tr_b16 a[36:37], v16 offset:12800
    ds_read_b64_tr_b16 a[38:39], v16 offset:13600
    ds_read_b64_tr_b16 a[112:113], v16 offset:32
    ds_read_b64_tr_b16 a[114:115], v16 offset:832
    ds_read_b64_tr_b16 a[116:117], v16 offset:12832
    ds_read_b64_tr_b16 a[118:119], v16 offset:13632
    ds_read_b64_tr_b16 a[192:193], v16 offset:64
    ds_read_b64_tr_b16 a[194:195], v16 offset:864
    ds_read_b64_tr_b16 a[196:197], v16 offset:12864
    ds_read_b64_tr_b16 a[198:199], v16 offset:13664
    s_waitcnt lgkmcnt(0)
    s_barrier
    s_waitcnt vmcnt(6)
    ds_write_b128 v10, v[72:75]
    ds_write_b128 v11, v[76:79]
    ds_write_b128 v12, v[80:83]
    ds_write_b128 v13, v[84:87]
    ds_write_b128 v14, v[88:91]
    ds_write_b128 v15, v[92:95]
    s_add_u32 s46, s45, 5505024
    buffer_load_dwordx4 v[48:51], v4, s[12:15], s46 offen
    buffer_load_dwordx4 v[52:55], v5, s[12:15], s46 offen
    buffer_load_dwordx4 v[56:59], v6, s[12:15], s46 offen
    buffer_load_dwordx4 v[60:63], v7, s[12:15], s46 offen
    buffer_load_dwordx4 v[64:67], v8, s[12:15], s46 offen
    buffer_load_dwordx4 v[68:71], v9, s[12:15], s46 offen
    s_waitcnt lgkmcnt(0)
    s_barrier
    ds_read_b64_tr_b16 a[40:41], v16 offset:0
    ds_read_b64_tr_b16 a[42:43], v16 offset:800
    ds_read_b64_tr_b16 a[44:45], v16 offset:12800
    ds_read_b64_tr_b16 a[46:47], v16 offset:13600
    ds_read_b64_tr_b16 a[120:121], v16 offset:32
    ds_read_b64_tr_b16 a[122:123], v16 offset:832
    ds_read_b64_tr_b16 a[124:125], v16 offset:12832
    ds_read_b64_tr_b16 a[126:127], v16 offset:13632
    ds_read_b64_tr_b16 a[200:201], v16 offset:64
    ds_read_b64_tr_b16 a[202:203], v16 offset:864
    ds_read_b64_tr_b16 a[204:205], v16 offset:12864
    ds_read_b64_tr_b16 a[206:207], v16 offset:13664
    s_waitcnt lgkmcnt(0)
    s_barrier
    s_waitcnt vmcnt(6)
    ds_write_b128 v10, v[24:27]
    ds_write_b128 v11, v[28:31]
    ds_write_b128 v12, v[32:35]
    ds_write_b128 v13, v[36:39]
    ds_write_b128 v14, v[40:43]
    ds_write_b128 v15, v[44:47]
    s_add_u32 s46, s45, 6291456
    buffer_load_dwordx4 v[72:75], v4, s[12:15], s46 offen
    buffer_load_dwordx4 v[76:79], v5, s[12:15], s46 offen
    buffer_load_dwordx4 v[80:83], v6, s[12:15], s46 offen
    buffer_load_dwordx4 v[84:87], v7, s[12:15], s46 offen
    buffer_load_dwordx4 v[88:91], v8, s[12:15], s46 offen
    buffer_load_dwordx4 v[92:95], v9, s[12:15], s46 offen
    s_waitcnt lgkmcnt(0)
    s_barrier
    ds_read_b64_tr_b16 a[48:49], v16 offset:0
    ds_read_b64_tr_b16 a[50:51], v16 offset:800
    ds_read_b64_tr_b16 a[52:53], v16 offset:12800
    ds_read_b64_tr_b16 a[54:55], v16 offset:13600
    ds_read_b64_tr_b16 a[128:129], v16 offset:32
    ds_read_b64_tr_b16 a[130:131], v16 offset:832
    ds_read_b64_tr_b16 a[132:133], v16 offset:12832
    ds_read_b64_tr_b16 a[134:135], v16 offset:13632
    ds_read_b64_tr_b16 a[208:209], v16 offset:64
    ds_read_b64_tr_b16 a[210:211], v16 offset:864
    ds_read_b64_tr_b16 a[212:213], v16 offset:12864
    ds_read_b64_tr_b16 a[214:215], v16 offset:13664
    s_waitcnt lgkmcnt(0)
    s_barrier
    s_waitcnt vmcnt(6)
    ds_write_b128 v10, v[48:51]
    ds_write_b128 v11, v[52:55]
    ds_write_b128 v12, v[56:59]
    ds_write_b128 v13, v[60:63]
    ds_write_b128 v14, v[64:67]
    ds_write_b128 v15, v[68:71]
    s_add_u32 s46, s45, 7077888
    buffer_load_dwordx4 v[24:27], v4, s[12:15], s46 offen
    buffer_load_dwordx4 v[28:31], v5, s[12:15], s46 offen
    buffer_load_dwordx4 v[32:35], v6, s[12:15], s46 offen
    buffer_load_dwordx4 v[36:39], v7, s[12:15], s46 offen
    buffer_load_dwordx4 v[40:43], v8, s[12:15], s46 offen
    buffer_load_dwordx4 v[44:47], v9, s[12:15], s46 offen
    s_waitcnt lgkmcnt(0)
    s_barrier
    ds_read_b64_tr_b16 a[56:57], v16 offset:0
    ds_read_b64_tr_b16 a[58:59], v16 offset:800
    ds_read_b64_tr_b16 a[60:61], v16 offset:12800
    ds_read_b64_tr_b16 a[62:63], v16 offset:13600
    ds_read_b64_tr_b16 a[136:137], v16 offset:32
    ds_read_b64_tr_b16 a[138:139], v16 offset:832
    ds_read_b64_tr_b16 a[140:141], v16 offset:12832
    ds_read_b64_tr_b16 a[142:143], v16 offset:13632
    ds_read_b64_tr_b16 a[216:217], v16 offset:64
    ds_read_b64_tr_b16 a[218:219], v16 offset:864
    ds_read_b64_tr_b16 a[220:221], v16 offset:12864
    ds_read_b64_tr_b16 a[222:223], v16 offset:13664
    s_waitcnt lgkmcnt(0)
    s_barrier
    s_waitcnt vmcnt(6)
    ds_write_b128 v10, v[72:75]
    ds_write_b128 v11, v[76:79]
    ds_write_b128 v12, v[80:83]
    ds_write_b128 v13, v[84:87]
    ds_write_b128 v14, v[88:91]
    ds_write_b128 v15, v[92:95]
    s_waitcnt lgkmcnt(0)
    s_barrier
    ds_read_b64_tr_b16 a[64:65], v16 offset:0
    ds_read_b64_tr_b16 a[66:67], v16 offset:800
    ds_read_b64_tr_b16 a[68:69], v16 offset:12800
    ds_read_b64_tr_b16 a[70:71], v16 offset:13600
    ds_read_b64_tr_b16 a[144:145], v16 offset:32
    ds_read_b64_tr_b16 a[146:147], v16 offset:832
    ds_read_b64_tr_b16 a[148:149], v16 offset:12832
    ds_read_b64_tr_b16 a[150:151], v16 offset:13632
    ds_read_b64_tr_b16 a[224:225], v16 offset:64
    ds_read_b64_tr_b16 a[226:227], v16 offset:864
    ds_read_b64_tr_b16 a[228:229], v16 offset:12864
    ds_read_b64_tr_b16 a[230:231], v16 offset:13664
    s_waitcnt lgkmcnt(0)
    s_barrier
    s_waitcnt vmcnt(0)
    ds_write_b128 v10, v[24:27]
    ds_write_b128 v11, v[28:31]
    ds_write_b128 v12, v[32:35]
    ds_write_b128 v13, v[36:39]
    ds_write_b128 v14, v[40:43]
    ds_write_b128 v15, v[44:47]
    s_waitcnt lgkmcnt(0)
    s_barrier
    ds_read_b64_tr_b16 a[72:73], v16 offset:0
    ds_read_b64_tr_b16 a[74:75], v16 offset:800
    ds_read_b64_tr_b16 a[76:77], v16 offset:12800
    ds_read_b64_tr_b16 a[78:79], v16 offset:13600
    ds_read_b64_tr_b16 a[152:153], v16 offset:32
    ds_read_b64_tr_b16 a[154:155], v16 offset:832
    ds_read_b64_tr_b16 a[156:157], v16 offset:12832
    ds_read_b64_tr_b16 a[158:159], v16 offset:13632
    ds_read_b64_tr_b16 a[232:233], v16 offset:64
    ds_read_b64_tr_b16 a[234:235], v16 offset:864
    ds_read_b64_tr_b16 a[236:237], v16 offset:12864
    ds_read_b64_tr_b16 a[238:239], v16 offset:13664
    s_waitcnt lgkmcnt(0)
    s_barrier
    v_add_u32 v64, 0, v0
    s_mov_b32 s24, 1639
    v_mul_lo_u32 v65, v64, s24
    v_lshrrev_b32 v65, 16, v65
    v_mul_u32_u24 v66, 40, v65
    v_sub_u32 v66, v64, v66
    s_mov_b32 s24, 1280
    v_mul_lo_u32 v4, v65, s24
    v_lshl_add_u32 v4, v66, 4, v4
    v_mul_u32_u24 v14, 656, v65
    v_lshl_add_u32 v14, v66, 4, v14
    v_add_u32 v14, 90112, v14
    v_add_u32 v64, 256, v0
    s_mov_b32 s24, 1639
    v_mul_lo_u32 v65, v64, s24
    v_lshrrev_b32 v65, 16, v65
    v_mul_u32_u24 v66, 40, v65
    v_sub_u32 v66, v64, v66
    s_mov_b32 s24, 1280
    v_mul_lo_u32 v5, v65, s24
    v_lshl_add_u32 v5, v66, 4, v5
    v_mul_u32_u24 v15, 656, v65
    v_lshl_add_u32 v15, v66, 4, v15
    v_add_u32 v15, 90112, v15
    v_add_u32 v64, 512, v0
    s_mov_b32 s24, 1639
    v_mul_lo_u32 v65, v64, s24
    v_lshrrev_b32 v65, 16, v65
    v_mul_u32_u24 v66, 40, v65
    v_sub_u32 v66, v64, v66
    s_mov_b32 s24, 1280
    v_mul_lo_u32 v6, v65, s24
    v_lshl_add_u32 v6, v66, 4, v6
    v_mul_u32_u24 v16, 656, v65
    v_lshl_add_u32 v16, v66, 4, v16
    v_add_u32 v16, 90112, v16
    v_add_u32 v64, 768, v0
    s_mov_b32 s24, 1639
    v_mul_lo_u32 v65, v64, s24
    v_lshrrev_b32 v65, 16, v65
    v_mul_u32_u24 v66, 40, v65
    v_sub_u32 v66, v64, v66
    s_mov_b32 s24, 1280
    v_mul_lo_u32 v7, v65, s24
    v_lshl_add_u32 v7, v66, 4, v7
    v_mul_u32_u24 v17, 656, v65
    v_lshl_add_u32 v17, v66, 4, v17
    v_add_u32 v17, 90112, v17
    v_add_u32 v64, 1024, v0
    s_mov_b32 s24, 1639
    v_mul_lo_u32 v65, v64, s24
    v_lshrrev_b32 v65, 16, v65
    v_mul_u32_u24 v66, 40, v65
    v_sub_u32 v66, v64, v66
    s_mov_b32 s24, 1280
    v_mul_lo_u32 v8, v65, s24
    v_lshl_add_u32 v8, v66, 4, v8
    v_mul_u32_u24 v18, 656, v65
    v_lshl_add_u32 v18, v66, 4, v18
    v_add_u32 v18, 90112, v18
    v_add_u32 v64, 1280, v0
    s_mov_b32 s24, 1639
    v_mul_lo_u32 v65, v64, s24
    v_lshrrev_b32 v65, 16, v65
    v_mul_u32_u24 v66, 40, v65
    v_sub_u32 v66, v64, v66
    s_mov_b32 s24, 1280
    v_mul_lo_u32 v9, v65, s24
    v_lshl_add_u32 v9, v66, 4, v9
    v_mul_u32_u24 v19, 656, v65
    v_lshl_add_u32 v19, v66, 4, v19
    v_add_u32 v19, 90112, v19
    v_add_u32 v64, 1536, v0
    s_mov_b32 s24, 1639
    v_mul_lo_u32 v65, v64, s24
    v_lshrrev_b32 v65, 16, v65
    v_mul_u32_u24 v66, 40, v65
    v_sub_u32 v66, v64, v66
    s_mov_b32 s24, 1280
    v_mul_lo_u32 v10, v65, s24
    v_lshl_add_u32 v10, v66, 4, v10
    v_mul_u32_u24 v20, 656, v65
    v_lshl_add_u32 v20, v66, 4, v20
    v_add_u32 v20, 90112, v20
    v_add_u32 v64, 1792, v0
    s_mov_b32 s24, 1639
    v_mul_lo_u32 v65, v64, s24
    v_lshrrev_b32 v65, 16, v65
    v_mul_u32_u24 v66, 40, v65
    v_sub_u32 v66, v64, v66
    s_mov_b32 s24, 1280
    v_mul_lo_u32 v11, v65, s24
    v_lshl_add_u32 v11, v66, 4, v11
    v_mul_u32_u24 v21, 656, v65
    v_lshl_add_u32 v21, v66, 4, v21
    v_add_u32 v21, 90112, v21
    v_add_u32 v64, 2048, v0
    s_mov_b32 s24, 1639
    v_mul_lo_u32 v65, v64, s24
    v_lshrrev_b32 v65, 16, v65
    v_mul_u32_u24 v66, 40, v65
    v_sub_u32 v66, v64, v66
    s_mov_b32 s24, 1280
    v_mul_lo_u32 v12, v65, s24
    v_lshl_add_u32 v12, v66, 4, v12
    v_mul_u32_u24 v22, 656, v65
    v_lshl_add_u32 v22, v66, 4, v22
    v_add_u32 v22, 90112, v22
    v_add_u32 v64, 2304, v0
    s_mov_b32 s24, 1639
    v_mul_lo_u32 v65, v64, s24
    v_lshrrev_b32 v65, 16, v65
    v_mul_u32_u24 v66, 40, v65
    v_sub_u32 v66, v64, v66
    s_mov_b32 s24, 1280
    v_mul_lo_u32 v13, v65, s24
    v_lshl_add_u32 v13, v66, 4, v13
    v_mul_u32_u24 v23, 656, v65
    v_lshl_add_u32 v23, v66, 4, v23
    v_add_u32 v23, 90112, v23
    v_lshrrev_b32 v64, 1, v3
    v_lshlrev_b32 v64, 4, v64
    v_and_b32 v65, 1, v3
    v_lshl_add_u32 v64, v65, 2, v64
    v_lshrrev_b32 v65, 2, v2
    v_and_b32 v66, 1, v65
    v_add_u32 v64, v64, v66
    v_lshrrev_b32 v65, 1, v65
    v_lshl_add_u32 v64, v65, 3, v64
    v_mul_u32_u24 v72, 656, v64
    v_and_b32 v65, 3, v2
    v_lshl_add_u32 v72, v65, 3, v72
    v_add_u32 v72, 90112, v72
    s_and_b32 s24, s3, 1
    s_mul_i32 s24, s24, 320
    v_add_u32 v72, s24, v72
    v_lshlrev_b32 v73, 4, v1
    s_mul_i32 s24, s3, 18432
    s_add_u32 s24, s24, 16384
    v_add_u32 v73, s24, v73
    s_mul_i32 s45, s44, 245760
    s_add_u32 s46, s45, 0
    buffer_load_dwordx4 v[24:27], v4, s[16:19], s46 offen
    buffer_load_dwordx4 v[28:31], v5, s[16:19], s46 offen
    buffer_load_dwordx4 v[32:35], v6, s[16:19], s46 offen
    buffer_load_dwordx4 v[36:39], v7, s[16:19], s46 offen
    buffer_load_dwordx4 v[40:43], v8, s[16:19], s46 offen
    buffer_load_dwordx4 v[44:47], v9, s[16:19], s46 offen
    buffer_load_dwordx4 v[48:51], v10, s[16:19], s46 offen
    buffer_load_dwordx4 v[52:55], v11, s[16:19], s46 offen
    buffer_load_dwordx4 v[56:59], v12, s[16:19], s46 offen
    buffer_load_dwordx4 v[60:63], v13, s[16:19], s46 offen
    s_waitcnt vmcnt(0)
    ds_write_b128 v14, v[24:27]
    ds_write_b128 v15, v[28:31]
    ds_write_b128 v16, v[32:35]
    ds_write_b128 v17, v[36:39]
    ds_write_b128 v18, v[40:43]
    ds_write_b128 v19, v[44:47]
    ds_write_b128 v20, v[48:51]
    ds_write_b128 v21, v[52:55]
    ds_write_b128 v22, v[56:59]
    ds_write_b128 v23, v[60:63]
    s_waitcnt lgkmcnt(0)
    s_barrier
    s_lshr_b32 s24, s3, 1
    s_cmp_eq_u32 s24, 0
    s_cbranch_scc0 chain2_kernel_wo1
    ds_read_b64_tr_b16 a[240:241], v72 offset:0
    ds_read_b64_tr_b16 a[242:243], v72 offset:1312
    ds_read_b64_tr_b16 a[244:245], v72 offset:20992
    ds_read_b64_tr_b16 a[246:247], v72 offset:22304
    ds_read_b64_tr_b16 v[112:113], v72 offset:32
    ds_read_b64_tr_b16 v[114:115], v72 offset:1344
    ds_read_b64_tr_b16 v[116:117], v72 offset:21024
    ds_read_b64_tr_b16 v[118:119], v72 offset:22336
    ds_read_b64_tr_b16 v[136:137], v72 offset:64
    ds_read_b64_tr_b16 v[138:139], v72 offset:1376
    ds_read_b64_tr_b16 v[140:141], v72 offset:21056
    ds_read_b64_tr_b16 v[142:143], v72 offset:22368
    ds_read_b64_tr_b16 v[160:161], v72 offset:96
    ds_read_b64_tr_b16 v[162:163], v72 offset:1408
    ds_read_b64_tr_b16 v[164:165], v72 offset:21088
    ds_read_b64_tr_b16 v[166:167], v72 offset:22400
    ds_read_b64_tr_b16 v[184:185], v72 offset:128
    ds_read_b64_tr_b16 v[186:187], v72 offset:1440
    ds_read_b64_tr_b16 v[188:189], v72 offset:21120
    ds_read_b64_tr_b16 v[190:191], v72 offset:22432
    ds_read_b64_tr_b16 v[208:209], v72 offset:160
    ds_read_b64_tr_b16 v[210:211], v72 offset:1472
    ds_read_b64_tr_b16 v[212:213], v72 offset:21152
    ds_read_b64_tr_b16 v[214:215], v72 offset:22464
    ds_read_b64_tr_b16 v[232:233], v72 offset:192
    ds_read_b64_tr_b16 v[234:235], v72 offset:1504
    ds_read_b64_tr_b16 v[236:237], v72 offset:21184
    ds_read_b64_tr_b16 v[238:239], v72 offset:22496
    ds_read_b64_tr_b16 v[64:65], v72 offset:224
    ds_read_b64_tr_b16 v[66:67], v72 offset:1536
    ds_read_b64_tr_b16 v[68:69], v72 offset:21216
    ds_read_b64_tr_b16 v[70:71], v72 offset:22528
    s_waitcnt lgkmcnt(0)
    ds_write_b128 v73, v[64:67] offset:0
    ds_write_b128 v73, v[68:71] offset:1024
    s_waitcnt lgkmcnt(0)
    ds_read_b64_tr_b16 v[64:65], v72 offset:256
    ds_read_b64_tr_b16 v[66:67], v72 offset:1568
    ds_read_b64_tr_b16 v[68:69], v72 offset:21248
    ds_read_b64_tr_b16 v[70:71], v72 offset:22560
    s_waitcnt lgkmcnt(0)
    ds_write_b128 v73, v[64:67] offset:6144
    ds_write_b128 v73, v[68:71] offset:7168
    s_waitcnt lgkmcnt(0)
    ds_read_b64_tr_b16 v[64:65], v72 offset:288
    ds_read_b64_tr_b16 v[66:67], v72 offset:1600
    ds_read_b64_tr_b16 v[68:69], v72 offset:21280
    ds_read_b64_tr_b16 v[70:71], v72 offset:22592
    s_waitcnt lgkmcnt(0)
    ds_write_b128 v73, v[64:67] offset:12288
    ds_write_b128 v73, v[68:71] offset:13312
    s_waitcnt lgkmcnt(0)
    s_waitcnt lgkmcnt(0)
chain2_kernel_wo1:
    s_barrier
    s_add_u32 s46, s45, 640
    buffer_load_dwordx4 v[24:27], v4, s[16:19], s46 offen
    buffer_load_dwordx4 v[28:31], v5, s[16:19], s46 offen
    buffer_load_dwordx4 v[32:35], v6, s[16:19], s46 offen
    buffer_load_dwordx4 v[36:39], v7, s[16:19], s46 offen
    buffer_load_dwordx4 v[40:43], v8, s[16:19], s46 offen
    buffer_load_dwordx4 v[44:47], v9, s[16:19], s46 offen
    buffer_load_dwordx4 v[48:51], v10, s[16:19], s46 offen
    buffer_load_dwordx4 v[52:55], v11, s[16:19], s46 offen
    buffer_load_dwordx4 v[56:59], v12, s[16:19], s46 offen
    buffer_load_dwordx4 v[60:63], v13, s[16:19], s46 offen
    s_waitcnt vmcnt(0)
    ds_write_b128 v14, v[24:27]
    ds_write_b128 v15, v[28:31]
    ds_write_b128 v16, v[32:35]
    ds_write_b128 v17, v[36:39]
    ds_write_b128 v18, v[40:43]
    ds_write_b128 v19, v[44:47]
    ds_write_b128 v20, v[48:51]
    ds_write_b128 v21, v[52:55]
    ds_write_b128 v22, v[56:59]
    ds_write_b128 v23, v[60:63]
    s_waitcnt lgkmcnt(0)
    s_barrier
    s_lshr_b32 s24, s3, 1
    s_cmp_eq_u32 s24, 1
    s_cbranch_scc0 chain2_kernel_wo2
    ds_read_b64_tr_b16 a[240:241], v72 offset:0
    ds_read_b64_tr_b16 a[242:243], v72 offset:1312
    ds_read_b64_tr_b16 a[244:245], v72 offset:20992
    ds_read_b64_tr_b16 a[246:247], v72 offset:22304
    ds_read_b64_tr_b16 v[112:113], v72 offset:32
    ds_read_b64_tr_b16 v[114:115], v72 offset:1344
    ds_read_b64_tr_b16 v[116:117], v72 offset:21024
    ds_read_b64_tr_b16 v[118:119], v72 offset:22336
    ds_read_b64_tr_b16 v[136:137], v72 offset:64
    ds_read_b64_tr_b16 v[138:139], v72 offset:1376
    ds_read_b64_tr_b16 v[140:141], v72 offset:21056
    ds_read_b64_tr_b16 v[142:143], v72 offset:22368
    ds_read_b64_tr_b16 v[160:161], v72 offset:96
    ds_read_b64_tr_b16 v[162:163], v72 offset:1408
    ds_read_b64_tr_b16 v[164:165], v72 offset:21088
    ds_read_b64_tr_b16 v[166:167], v72 offset:22400
    ds_read_b64_tr_b16 v[184:185], v72 offset:128
    ds_read_b64_tr_b16 v[186:187], v72 offset:1440
    ds_read_b64_tr_b16 v[188:189], v72 offset:21120
    ds_read_b64_tr_b16 v[190:191], v72 offset:22432
    ds_read_b64_tr_b16 v[208:209], v72 offset:160
    ds_read_b64_tr_b16 v[210:211], v72 offset:1472
    ds_read_b64_tr_b16 v[212:213], v72 offset:21152
    ds_read_b64_tr_b16 v[214:215], v72 offset:22464
    ds_read_b64_tr_b16 v[232:233], v72 offset:192
    ds_read_b64_tr_b16 v[234:235], v72 offset:1504
    ds_read_b64_tr_b16 v[236:237], v72 offset:21184
    ds_read_b64_tr_b16 v[238:239], v72 offset:22496
    ds_read_b64_tr_b16 v[64:65], v72 offset:224
    ds_read_b64_tr_b16 v[66:67], v72 offset:1536
    ds_read_b64_tr_b16 v[68:69], v72 offset:21216
    ds_read_b64_tr_b16 v[70:71], v72 offset:22528
    s_waitcnt lgkmcnt(0)
    ds_write_b128 v73, v[64:67] offset:0
    ds_write_b128 v73, v[68:71] offset:1024
    s_waitcnt lgkmcnt(0)
    ds_read_b64_tr_b16 v[64:65], v72 offset:256
    ds_read_b64_tr_b16 v[66:67], v72 offset:1568
    ds_read_b64_tr_b16 v[68:69], v72 offset:21248
    ds_read_b64_tr_b16 v[70:71], v72 offset:22560
    s_waitcnt lgkmcnt(0)
    ds_write_b128 v73, v[64:67] offset:6144
    ds_write_b128 v73, v[68:71] offset:7168
    s_waitcnt lgkmcnt(0)
    ds_read_b64_tr_b16 v[64:65], v72 offset:288
    ds_read_b64_tr_b16 v[66:67], v72 offset:1600
    ds_read_b64_tr_b16 v[68:69], v72 offset:21280
    ds_read_b64_tr_b16 v[70:71], v72 offset:22592
    s_waitcnt lgkmcnt(0)
    ds_write_b128 v73, v[64:67] offset:12288
    ds_write_b128 v73, v[68:71] offset:13312
    s_waitcnt lgkmcnt(0)
    s_waitcnt lgkmcnt(0)
chain2_kernel_wo2:
    s_barrier
    s_add_u32 s46, s45, 81920
    buffer_load_dwordx4 v[24:27], v4, s[16:19], s46 offen
    buffer_load_dwordx4 v[28:31], v5, s[16:19], s46 offen
    buffer_load_dwordx4 v[32:35], v6, s[16:19], s46 offen
    buffer_load_dwordx4 v[36:39], v7, s[16:19], s46 offen
    buffer_load_dwordx4 v[40:43], v8, s[16:19], s46 offen
    buffer_load_dwordx4 v[44:47], v9, s[16:19], s46 offen
    buffer_load_dwordx4 v[48:51], v10, s[16:19], s46 offen
    buffer_load_dwordx4 v[52:55], v11, s[16:19], s46 offen
    buffer_load_dwordx4 v[56:59], v12, s[16:19], s46 offen
    buffer_load_dwordx4 v[60:63], v13, s[16:19], s46 offen
    s_waitcnt vmcnt(0)
    ds_write_b128 v14, v[24:27]
    ds_write_b128 v15, v[28:31]
    ds_write_b128 v16, v[32:35]
    ds_write_b128 v17, v[36:39]
    ds_write_b128 v18, v[40:43]
    ds_write_b128 v19, v[44:47]
    ds_write_b128 v20, v[48:51]
    ds_write_b128 v21, v[52:55]
    ds_write_b128 v22, v[56:59]
    ds_write_b128 v23, v[60:63]
    s_waitcnt lgkmcnt(0)
    s_barrier
    s_lshr_b32 s24, s3, 1
    s_cmp_eq_u32 s24, 0
    s_cbranch_scc0 chain2_kernel_wo3
    ds_read_b64_tr_b16 a[248:249], v72 offset:0
    ds_read_b64_tr_b16 a[250:251], v72 offset:1312
    ds_read_b64_tr_b16 a[252:253], v72 offset:20992
    ds_read_b64_tr_b16 a[254:255], v72 offset:22304
    ds_read_b64_tr_b16 v[120:121], v72 offset:32
    ds_read_b64_tr_b16 v[122:123], v72 offset:1344
    ds_read_b64_tr_b16 v[124:125], v72 offset:21024
    ds_read_b64_tr_b16 v[126:127], v72 offset:22336
    ds_read_b64_tr_b16 v[144:145], v72 offset:64
    ds_read_b64_tr_b16 v[146:147], v72 offset:1376
    ds_read_b64_tr_b16 v[148:149], v72 offset:21056
    ds_read_b64_tr_b16 v[150:151], v72 offset:22368
    ds_read_b64_tr_b16 v[168:169], v72 offset:96
    ds_read_b64_tr_b16 v[170:171], v72 offset:1408
    ds_read_b64_tr_b16 v[172:173], v72 offset:21088
    ds_read_b64_tr_b16 v[174:175], v72 offset:22400
    ds_read_b64_tr_b16 v[192:193], v72 offset:128
    ds_read_b64_tr_b16 v[194:195], v72 offset:1440
    ds_read_b64_tr_b16 v[196:197], v72 offset:21120
    ds_read_b64_tr_b16 v[198:199], v72 offset:22432
    ds_read_b64_tr_b16 v[216:217], v72 offset:160
    ds_read_b64_tr_b16 v[218:219], v72 offset:1472
    ds_read_b64_tr_b16 v[220:221], v72 offset:21152
    ds_read_b64_tr_b16 v[222:223], v72 offset:22464
    ds_read_b64_tr_b16 v[240:241], v72 offset:192
    ds_read_b64_tr_b16 v[242:243], v72 offset:1504
    ds_read_b64_tr_b16 v[244:245], v72 offset:21184
    ds_read_b64_tr_b16 v[246:247], v72 offset:22496
    ds_read_b64_tr_b16 v[64:65], v72 offset:224
    ds_read_b64_tr_b16 v[66:67], v72 offset:1536
    ds_read_b64_tr_b16 v[68:69], v72 offset:21216
    ds_read_b64_tr_b16 v[70:71], v72 offset:22528
    s_waitcnt lgkmcnt(0)
    ds_write_b128 v73, v[64:67] offset:2048
    ds_write_b128 v73, v[68:71] offset:3072
    s_waitcnt lgkmcnt(0)
    ds_read_b64_tr_b16 v[64:65], v72 offset:256
    ds_read_b64_tr_b16 v[66:67], v72 offset:1568
    ds_read_b64_tr_b16 v[68:69], v72 offset:21248
    ds_read_b64_tr_b16 v[70:71], v72 offset:22560
    s_waitcnt lgkmcnt(0)
    ds_write_b128 v73, v[64:67] offset:8192
    ds_write_b128 v73, v[68:71] offset:9216
    s_waitcnt lgkmcnt(0)
    ds_read_b64_tr_b16 v[64:65], v72 offset:288
    ds_read_b64_tr_b16 v[66:67], v72 offset:1600
    ds_read_b64_tr_b16 v[68:69], v72 offset:21280
    ds_read_b64_tr_b16 v[70:71], v72 offset:22592
    s_waitcnt lgkmcnt(0)
    ds_write_b128 v73, v[64:67] offset:14336
    ds_write_b128 v73, v[68:71] offset:15360
    s_waitcnt lgkmcnt(0)
    s_waitcnt lgkmcnt(0)
chain2_kernel_wo3:
    s_barrier
    s_add_u32 s46, s45, 82560
    buffer_load_dwordx4 v[24:27], v4, s[16:19], s46 offen
    buffer_load_dwordx4 v[28:31], v5, s[16:19], s46 offen
    buffer_load_dwordx4 v[32:35], v6, s[16:19], s46 offen
    buffer_load_dwordx4 v[36:39], v7, s[16:19], s46 offen
    buffer_load_dwordx4 v[40:43], v8, s[16:19], s46 offen
    buffer_load_dwordx4 v[44:47], v9, s[16:19], s46 offen
    buffer_load_dwordx4 v[48:51], v10, s[16:19], s46 offen
    buffer_load_dwordx4 v[52:55], v11, s[16:19], s46 offen
    buffer_load_dwordx4 v[56:59], v12, s[16:19], s46 offen
    buffer_load_dwordx4 v[60:63], v13, s[16:19], s46 offen
    s_waitcnt vmcnt(0)
    ds_write_b128 v14, v[24:27]
    ds_write_b128 v15, v[28:31]
    ds_write_b128 v16, v[32:35]
    ds_write_b128 v17, v[36:39]
    ds_write_b128 v18, v[40:43]
    ds_write_b128 v19, v[44:47]
    ds_write_b128 v20, v[48:51]
    ds_write_b128 v21, v[52:55]
    ds_write_b128 v22, v[56:59]
    ds_write_b128 v23, v[60:63]
    s_waitcnt lgkmcnt(0)
    s_barrier
    s_lshr_b32 s24, s3, 1
    s_cmp_eq_u32 s24, 1
    s_cbranch_scc0 chain2_kernel_wo4
    ds_read_b64_tr_b16 a[248:249], v72 offset:0
    ds_read_b64_tr_b16 a[250:251], v72 offset:1312
    ds_read_b64_tr_b16 a[252:253], v72 offset:20992
    ds_read_b64_tr_b16 a[254:255], v72 offset:22304
    ds_read_b64_tr_b16 v[120:121], v72 offset:32
    ds_read_b64_tr_b16 v[122:123], v72 offset:1344
    ds_read_b64_tr_b16 v[124:125], v72 offset:21024
    ds_read_b64_tr_b16 v[126:127], v72 offset:22336
    ds_read_b64_tr_b16 v[144:145], v72 offset:64
    ds_read_b64_tr_b16 v[146:147], v72 offset:1376
    ds_read_b64_tr_b16 v[148:149], v72 offset:21056
    ds_read_b64_tr_b16 v[150:151], v72 offset:22368
    ds_read_b64_tr_b16 v[168:169], v72 offset:96
    ds_read_b64_tr_b16 v[170:171], v72 offset:1408
    ds_read_b64_tr_b16 v[172:173], v72 offset:21088
    ds_read_b64_tr_b16 v[174:175], v72 offset:22400
    ds_read_b64_tr_b16 v[192:193], v72 offset:128
    ds_read_b64_tr_b16 v[194:195], v72 offset:1440
    ds_read_b64_tr_b16 v[196:197], v72 offset:21120
    ds_read_b64_tr_b16 v[198:199], v72 offset:22432
    ds_read_b64_tr_b16 v[216:217], v72 offset:160
    ds_read_b64_tr_b16 v[218:219], v72 offset:1472
    ds_read_b64_tr_b16 v[220:221], v72 offset:21152
    ds_read_b64_tr_b16 v[222:223], v72 offset:22464
    ds_read_b64_tr_b16 v[240:241], v72 offset:192
    ds_read_b64_tr_b16 v[242:243], v72 offset:1504
    ds_read_b64_tr_b16 v[244:245], v72 offset:21184
    ds_read_b64_tr_b16 v[246:247], v72 offset:22496
    ds_read_b64_tr_b16 v[64:65], v72 offset:224
    ds_read_b64_tr_b16 v[66:67], v72 offset:1536
    ds_read_b64_tr_b16 v[68:69], v72 offset:21216
    ds_read_b64_tr_b16 v[70:71], v72 offset:22528
    s_waitcnt lgkmcnt(0)
    ds_write_b128 v73, v[64:67] offset:2048
    ds_write_b128 v73, v[68:71] offset:3072
    s_waitcnt lgkmcnt(0)
    ds_read_b64_tr_b16 v[64:65], v72 offset:256
    ds_read_b64_tr_b16 v[66:67], v72 offset:1568
    ds_read_b64_tr_b16 v[68:69], v72 offset:21248
    ds_read_b64_tr_b16 v[70:71], v72 offset:22560
    s_waitcnt lgkmcnt(0)
    ds_write_b128 v73, v[64:67] offset:8192
    ds_write_b128 v73, v[68:71] offset:9216
    s_waitcnt lgkmcnt(0)
    ds_read_b64_tr_b16 v[64:65], v72 offset:288
    ds_read_b64_tr_b16 v[66:67], v72 offset:1600
    ds_read_b64_tr_b16 v[68:69], v72 offset:21280
    ds_read_b64_tr_b16 v[70:71], v72 offset:22592
    s_waitcnt lgkmcnt(0)
    ds_write_b128 v73, v[64:67] offset:14336
    ds_write_b128 v73, v[68:71] offset:15360
    s_waitcnt lgkmcnt(0)
    s_waitcnt lgkmcnt(0)
chain2_kernel_wo4:
    s_barrier
    s_add_u32 s46, s45, 163840
    buffer_load_dwordx4 v[24:27], v4, s[16:19], s46 offen
    buffer_load_dwordx4 v[28:31], v5, s[16:19], s46 offen
    buffer_load_dwordx4 v[32:35], v6, s[16:19], s46 offen
    buffer_load_dwordx4 v[36:39], v7, s[16:19], s46 offen
    buffer_load_dwordx4 v[40:43], v8, s[16:19], s46 offen
    buffer_load_dwordx4 v[44:47], v9, s[16:19], s46 offen
    buffer_load_dwordx4 v[48:51], v10, s[16:19], s46 offen
    buffer_load_dwordx4 v[52:55], v11, s[16:19], s46 offen
    buffer_load_dwordx4 v[56:59], v12, s[16:19], s46 offen
    buffer_load_dwordx4 v[60:63], v13, s[16:19], s46 offen
    s_waitcnt vmcnt(0)
    ds_write_b128 v14, v[24:27]
    ds_write_b128 v15, v[28:31]
    ds_write_b128 v16, v[32:35]
    ds_write_b128 v17, v[36:39]
    ds_write_b128 v18, v[40:43]
    ds_write_b128 v19, v[44:47]
    ds_write_b128 v20, v[48:51]
    ds_write_b128 v21, v[52:55]
    ds_write_b128 v22, v[56:59]
    ds_write_b128 v23, v[60:63]
    s_waitcnt lgkmcnt(0)
    s_barrier
    s_lshr_b32 s24, s3, 1
    s_cmp_eq_u32 s24, 0
    s_cbranch_scc0 chain2_kernel_wo5
    ds_read_b64_tr_b16 v[104:105], v72 offset:0
    ds_read_b64_tr_b16 v[106:107], v72 offset:1312
    ds_read_b64_tr_b16 v[108:109], v72 offset:20992
    ds_read_b64_tr_b16 v[110:111], v72 offset:22304
    ds_read_b64_tr_b16 v[128:129], v72 offset:32
    ds_read_b64_tr_b16 v[130:131], v72 offset:1344
    ds_read_b64_tr_b16 v[132:133], v72 offset:21024
    ds_read_b64_tr_b16 v[134:135], v72 offset:22336
    ds_read_b64_tr_b16 v[152:153], v72 offset:64
    ds_read_b64_tr_b16 v[154:155], v72 offset:1376
    ds_read_b64_tr_b16 v[156:157], v72 offset:21056
    ds_read_b64_tr_b16 v[158:159], v72 offset:22368
    ds_read_b64_tr_b16 v[176:177], v72 offset:96
    ds_read_b64_tr_b16 v[178:179], v72 offset:1408
    ds_read_b64_tr_b16 v[180:181], v72 offset:21088
    ds_read_b64_tr_b16 v[182:183], v72 offset:22400
    ds_read_b64_tr_b16 v[200:201], v72 offset:128
    ds_read_b64_tr_b16 v[202:203], v72 offset:1440
    ds_read_b64_tr_b16 v[204:205], v72 offset:21120
    ds_read_b64_tr_b16 v[206:207], v72 offset:22432
    ds_read_b64_tr_b16 v[224:225], v72 offset:160
    ds_read_b64_tr_b16 v[226:227], v72 offset:1472
    ds_read_b64_tr_b16 v[228:229], v72 offset:21152
    ds_read_b64_tr_b16 v[230:231], v72 offset:22464
    ds_read_b64_tr_b16 v[248:249], v72 offset:192
    ds_read_b64_tr_b16 v[250:251], v72 offset:1504
    ds_read_b64_tr_b16 v[252:253], v72 offset:21184
    ds_read_b64_tr_b16 v[254:255], v72 offset:22496
    ds_read_b64_tr_b16 v[64:65], v72 offset:224
    ds_read_b64_tr_b16 v[66:67], v72 offset:1536
    ds_read_b64_tr_b16 v[68:69], v72 offset:21216
    ds_read_b64_tr_b16 v[70:71], v72 offset:22528
    s_waitcnt lgkmcnt(0)
    ds_write_b128 v73, v[64:67] offset:4096
    ds_write_b128 v73, v[68:71] offset:5120
    s_waitcnt lgkmcnt(0)
    ds_read_b64_tr_b16 v[64:65], v72 offset:256
    ds_read_b64_tr_b16 v[66:67], v72 offset:1568
    ds_read_b64_tr_b16 v[68:69], v72 offset:21248
    ds_read_b64_tr_b16 v[70:71], v72 offset:22560
    s_waitcnt lgkmcnt(0)
    ds_write_b128 v73, v[64:67] offset:10240
    ds_write_b128 v73, v[68:71] offset:11264
    s_waitcnt lgkmcnt(0)
    ds_read_b64_tr_b16 v[64:65], v72 offset:288
    ds_read_b64_tr_b16 v[66:67], v72 offset:1600
    ds_read_b64_tr_b16 v[68:69], v72 offset:21280
    ds_read_b64_tr_b16 v[70:71], v72 offset:22592
    s_waitcnt lgkmcnt(0)
    ds_write_b128 v73, v[64:67] offset:16384
    ds_write_b128 v73, v[68:71] offset:17408
    s_waitcnt lgkmcnt(0)
    s_waitcnt lgkmcnt(0)
chain2_kernel_wo5:
    s_barrier
    s_add_u32 s46, s45, 164480
    buffer_load_dwordx4 v[24:27], v4, s[16:19], s46 offen
    buffer_load_dwordx4 v[28:31], v5, s[16:19], s46 offen
    buffer_load_dwordx4 v[32:35], v6, s[16:19], s46 offen
    buffer_load_dwordx4 v[36:39], v7, s[16:19], s46 offen
    buffer_load_dwordx4 v[40:43], v8, s[16:19], s46 offen
    buffer_load_dwordx4 v[44:47], v9, s[16:19], s46 offen
    buffer_load_dwordx4 v[48:51], v10, s[16:19], s46 offen
    buffer_load_dwordx4 v[52:55], v11, s[16:19], s46 offen
    buffer_load_dwordx4 v[56:59], v12, s[16:19], s46 offen
    buffer_load_dwordx4 v[60:63], v13, s[16:19], s46 offen
    s_waitcnt vmcnt(0)
    ds_write_b128 v14, v[24:27]
    ds_write_b128 v15, v[28:31]
    ds_write_b128 v16, v[32:35]
    ds_write_b128 v17, v[36:39]
    ds_write_b128 v18, v[40:43]
    ds_write_b128 v19, v[44:47]
    ds_write_b128 v20, v[48:51]
    ds_write_b128 v21, v[52:55]
    ds_write_b128 v22, v[56:59]
    ds_write_b128 v23, v[60:63]
    s_waitcnt lgkmcnt(0)
    s_barrier
    s_lshr_b32 s24, s3, 1
    s_cmp_eq_u32 s24, 1
    s_cbranch_scc0 chain2_kernel_wo6
    ds_read_b64_tr_b16 v[104:105], v72 offset:0
    ds_read_b64_tr_b16 v[106:107], v72 offset:1312
    ds_read_b64_tr_b16 v[108:109], v72 offset:20992
    ds_read_b64_tr_b16 v[110:111], v72 offset:22304
    ds_read_b64_tr_b16 v[128:129], v72 offset:32
    ds_read_b64_tr_b16 v[130:131], v72 offset:1344
    ds_read_b64_tr_b16 v[132:133], v72 offset:21024
    ds_read_b64_tr_b16 v[134:135], v72 offset:22336
    ds_read_b64_tr_b16 v[152:153], v72 offset:64
    ds_read_b64_tr_b16 v[154:155], v72 offset:1376
    ds_read_b64_tr_b16 v[156:157], v72 offset:21056
    ds_read_b64_tr_b16 v[158:159], v72 offset:22368
    ds_read_b64_tr_b16 v[176:177], v72 offset:96
    ds_read_b64_tr_b16 v[178:179], v72 offset:1408
    ds_read_b64_tr_b16 v[180:181], v72 offset:21088
    ds_read_b64_tr_b16 v[182:183], v72 offset:22400
    ds_read_b64_tr_b16 v[200:201], v72 offset:128
    ds_read_b64_tr_b16 v[202:203], v72 offset:1440
    ds_read_b64_tr_b16 v[204:205], v72 offset:21120
    ds_read_b64_tr_b16 v[206:207], v72 offset:22432
    ds_read_b64_tr_b16 v[224:225], v72 offset:160
    ds_read_b64_tr_b16 v[226:227], v72 offset:1472
    ds_read_b64_tr_b16 v[228:229], v72 offset:21152
    ds_read_b64_tr_b16 v[230:231], v72 offset:22464
    ds_read_b64_tr_b16 v[248:249], v72 offset:192
    ds_read_b64_tr_b16 v[250:251], v72 offset:1504
    ds_read_b64_tr_b16 v[252:253], v72 offset:21184
    ds_read_b64_tr_b16 v[254:255], v72 offset:22496
    ds_read_b64_tr_b16 v[64:65], v72 offset:224
    ds_read_b64_tr_b16 v[66:67], v72 offset:1536
    ds_read_b64_tr_b16 v[68:69], v72 offset:21216
    ds_read_b64_tr_b16 v[70:71], v72 offset:22528
    s_waitcnt lgkmcnt(0)
    ds_write_b128 v73, v[64:67] offset:4096
    ds_write_b128 v73, v[68:71] offset:5120
    s_waitcnt lgkmcnt(0)
    ds_read_b64_tr_b16 v[64:65], v72 offset:256
    ds_read_b64_tr_b16 v[66:67], v72 offset:1568
    ds_read_b64_tr_b16 v[68:69], v72 offset:21248
    ds_read_b64_tr_b16 v[70:71], v72 offset:22560
    s_waitcnt lgkmcnt(0)
    ds_write_b128 v73, v[64:67] offset:10240
    ds_write_b128 v73, v[68:71] offset:11264
    s_waitcnt lgkmcnt(0)
    ds_read_b64_tr_b16 v[64:65], v72 offset:288
    ds_read_b64_tr_b16 v[66:67], v72 offset:1600
    ds_read_b64_tr_b16 v[68:69], v72 offset:21280
    ds_read_b64_tr_b16 v[70:71], v72 offset:22592
    s_waitcnt lgkmcnt(0)
    ds_write_b128 v73, v[64:67] offset:16384
    ds_write_b128 v73, v[68:71] offset:17408
    s_waitcnt lgkmcnt(0)
    s_waitcnt lgkmcnt(0)
chain2_kernel_wo6:
    s_barrier
    v_mov_b32 v6, v73
    v_mov_b32 v4, 0x4444
    v_mov_b32 v5, 0xeeee
    v_cmp_gt_u32 vcc, 8, v2
    s_nop 1
    v_cndmask_b32 v4, v5, v4, vcc
    v_lshlrev_b32 v5, 4, v1
    s_lshl_b32 s24, s3, 10
    v_add_u32 v7, s24, v5
    s_lshl_b32 s24, s3, 9
    s_add_u32 s24, s24, 8192
    v_lshlrev_b32 v8, 3, v1
    v_add_u32 v8, s24, v8
    v_and_b32 v64, 7, v2
    v_lshlrev_b32 v9, 5, v64
    v_lshrrev_b32 v64, 3, v2
    v_lshl_add_u32 v9, v64, 4, v9
    v_and_b32 v64, 1, v3
    v_lshl_add_u32 v9, v64, 3, v9
    s_mul_i32 s24, s3, 768
    s_add_u32 s24, s24, 10240
    v_add_u32 v9, s24, v9
    v_lshrrev_b32 v65, 1, v3
    v_lshl_add_u32 v10, v65, 8, v9
    v_lshrrev_b32 v64, 2, v2
    v_lshlrev_b32 v11, 5, v64
    v_and_b32 v64, 3, v2
    v_lshl_add_u32 v11, v64, 3, v11
    v_lshl_add_u32 v11, v3, 8, v11
    v_add_u32 v11, 10240, v11
    s_mul_i32 s24, s3, 10
    s_lshl_b32 s24, s24, 13
    s_lshl_b32 s25, s44, 8
    s_add_u32 s24, s24, s25
    v_lshlrev_b32 v14, 13, v3
    v_lshl_add_u32 v14, v2, 4, v14
    v_add_u32 v14, s24, v14
    v_lshrrev_b32 v64, 1, v3
    v_lshlrev_b32 v15, 13, v64
    v_lshl_add_u32 v15, v2, 4, v15
    v_add_u32 v15, s24, v15
    v_add_u32 v15, 65536, v15
    v_and_b32 v64, 1, v3
    v_cmp_eq_u32 vcc, 0, v64
    v_mov_b32 v64, 2146435072
    s_nop 0
    v_cndmask_b32 v15, v64, v15, vcc
    v_add_u32 v64, 0, v0
    v_and_b32 v65, 7, v64
    v_mul_u32_u24 v65, 1280, v65
    v_lshrrev_b32 v66, 3, v64
    v_lshl_add_u32 v65, v66, 4, v65
    v_cmp_gt_u32 vcc, 640, v64
    v_mov_b32 v67, 2146435072
    s_nop 0
    v_cndmask_b32 v65, v67, v65, vcc
    buffer_load_dwordx4 v[68:71], v65, s[20:23], 0 offen
    v_lshlrev_b32 v64, 4, v64
    s_waitcnt vmcnt(0)
    s_and_saveexec_b64 s[30:31], vcc
    ds_write_b128 v64, v[68:71]
    s_mov_b64 exec, s[30:31]
    v_add_u32 v64, 256, v0
    v_and_b32 v65, 7, v64
    v_mul_u32_u24 v65, 1280, v65
    v_lshrrev_b32 v66, 3, v64
    v_lshl_add_u32 v65, v66, 4, v65
    v_cmp_gt_u32 vcc, 640, v64
    v_mov_b32 v67, 2146435072
    s_nop 0
    v_cndmask_b32 v65, v67, v65, vcc
    buffer_load_dwordx4 v[68:71], v65, s[20:23], 0 offen
    v_lshlrev_b32 v64, 4, v64
    s_waitcnt vmcnt(0)
    s_and_saveexec_b64 s[30:31], vcc
    ds_write_b128 v64, v[68:71]
    s_mov_b64 exec, s[30:31]
    v_add_u32 v64, 512, v0
    v_and_b32 v65, 7, v64
    v_mul_u32_u24 v65, 1280, v65
    v_lshrrev_b32 v66, 3, v64
    v_lshl_add_u32 v65, v66, 4, v65
    v_cmp_gt_u32 vcc, 640, v64
    v_mov_b32 v67, 2146435072
    s_nop 0
    v_cndmask_b32 v65, v67, v65, vcc
    buffer_load_dwordx4 v[68:71], v65, s[20:23], 0 offen
    v_lshlrev_b32 v64, 4, v64
    s_waitcnt vmcnt(0)
    s_and_saveexec_b64 s[30:31], vcc
    ds_write_b128 v64, v[68:71]
    s_mov_b64 exec, s[30:31]
    s_mov_b32 s40, 0
    s_mov_b32 s43, 117440512
    s_mov_b32 s47, 138412032
    s_waitcnt lgkmcnt(0)
    s_branch chain2_kernel_v_go2
chain2_kernel_v_step:
    s_add_u32 s48, s47, 4096
    s_mov_b32 s61, 0
chain2_kernel_v_pm:
    buffer_load_dwordx4 v[16:19], v7, s[8:11], s47 offen sc1
    buffer_load_dwordx4 v[20:23], v7, s[8:11], s48 offen sc1
    buffer_load_dwordx2 v[24:25], v8, s[8:11], s47 offen sc1
    s_waitcnt vmcnt(0)
    v_max3_u32 v26, v16, v17, v18
    v_max3_u32 v26, v26, v19, v20
    v_max3_u32 v26, v26, v21, v22
    v_max3_u32 v26, v26, v23, v24
    v_max_u32 v26, v26, v25
    v_cmp_eq_u32 vcc, -1, v26
    s_add_u32 s61, s61, 1
    s_cbranch_vccz chain2_kernel_v_pm_out
    s_cmp_ge_u32 s61, s60
    s_cbranch_scc1 chain2_kernel_v_pm_to
    s_sleep 1
    s_branch chain2_kernel_v_pm
chain2_kernel_v_pm_to:
    s_mov_b32 s60, 1
chain2_kernel_v_pm_out:
    ds_write_b128 v7, v[16:19]
    ds_write_b128 v7, v[20:23] offset:4096
    ds_write_b64 v8, v[24:25]
    s_waitcnt lgkmcnt(0)
chain2_kernel_v_go2:
    s_barrier
    ds_read_b128 v[16:19], v5 offset:0
    ds_read_b128 v[20:23], v5 offset:1024
    ds_read_b128 v[24:27], v5 offset:2048
    ds_read_b128 v[28:31], v5 offset:3072
    ds_read_b128 v[32:35], v5 offset:4096
    ds_read_b128 v[36:39], v5 offset:5120
    ds_read_b128 v[40:43], v5 offset:6144
    ds_read_b128 v[44:47], v5 offset:7168
    ds_read_b128 v[48:51], v5 offset:8192
    ds_read_b128 v[52:55], v5 offset:9216
    v_mov_b32 v56, 0
    v_mov_b32 v57, 0
    v_mov_b32 v58, 0
    v_mov_b32 v59, 0
    v_mov_b32 v60, 0
    v_mov_b32 v61, 0
    v_mov_b32 v62, 0
    v_mov_b32 v63, 0
    v_mov_b32 v64, 0
    v_mov_b32 v65, 0
    v_mov_b32 v66, 0
    v_mov_b32 v67, 0
    s_waitcnt lgkmcnt(9)
    v_smfmac_f32_16x16x64_bf16 v[56:59], v[16:19], a[0:7], v4
    v_smfmac_f32_16x16x64_bf16 v[60:63], v[16:19], a[80:87], v4
    v_smfmac_f32_16x16x64_bf16 v[64:67], v[16:19], a[160:167], v4
    s_waitcnt lgkmcnt(8)
    v_smfmac_f32_16x16x64_bf16 v[56:59], v[20:23], a[8:15], v4
    v_smfmac_f32_16x16x64_bf16 v[60:63], v[20:23], a[88:95], v4
    v_smfmac_f32_16x16x64_bf16 v[64:67], v[20:23], a[168:175], v4
    s_waitcnt lgkmcnt(7)
    v_smfmac_f32_16x16x64_bf16 v[56:59], v[24:27], a[16:23], v4
    v_smfmac_f32_16x16x64_bf16 v[60:63], v[24:27], a[96:103], v4
    v_smfmac_f32_16x16x64_bf16 v[64:67], v[24:27], a[176:183], v4
    s_waitcnt lgkmcnt(6)
    v_smfmac_f32_16x16x64_bf16 v[56:59], v[28:31], a[24:31], v4
    v_smfmac_f32_16x16x64_bf16 v[60:63], v[28:31], a[104:111], v4
    v_smfmac_f32_16x16x64_bf16 v[64:67], v[28:31], a[184:191], v4
    s_waitcnt lgkmcnt(5)
    v_smfmac_f32_16x16x64_bf16 v[56:59], v[32:35], a[32:39], v4
    v_smfmac_f32_16x16x64_bf16 v[60:63], v[32:35], a[112:119], v4
    v_smfmac_f32_16x16x64_bf16 v[64:67], v[32:35], a[192:199], v4
    s_waitcnt lgkmcnt(4)
    v_smfmac_f32_16x16x64_bf16 v[56:59], v[36:39], a[40:47], v4
    v_smfmac_f32_16x16x64_bf16 v[60:63], v[36:39], a[120:127], v4
    v_smfmac_f32_16x16x64_bf16 v[64:67], v[36:39], a[200:207], v4
    s_waitcnt lgkmcnt(3)
    v_smfmac_f32_16x16x64_bf16 v[56:59], v[40:43], a[48:55], v4
    v_smfmac_f32_16x16x64_bf16 v[60:63], v[40:43], a[128:135], v4
    v_smfmac_f32_16x16x64_bf16 v[64:67], v[40:43], a[208:215], v4
    s_waitcnt lgkmcnt(2)
    v_smfmac_f32_16x16x64_bf16 v[56:59], v[44:47], a[56:63], v4
    v_smfmac_f32_16x16x64_bf16 v[60:63], v[44:47], a[136:143], v4
    v_smfmac_f32_16x16x64_bf16 v[64:67], v[44:47], a[216:223], v4
    s_waitcnt lgkmcnt(1)
    v_smfmac_f32_16x16x64_bf16 v[56:59], v[48:51], a[64:71], v4
    v_smfmac_f32_16x16x64_bf16 v[60:63], v[48:51], a[144:151], v4
    v_smfmac_f32_16x16x64_bf16 v[64:67], v[48:51], a[224:231], v4
    s_waitcnt lgkmcnt(0)
    v_smfmac_f32_16x16x64_bf16 v[56:59], v[52:55], a[72:79], v4
    v_smfmac_f32_16x16x64_bf16 v[60:63], v[52:55], a[152:159], v4
    v_smfmac_f32_16x16x64_bf16 v[64:67], v[52:55], a[232:239], v4
    ds_read_b128 v[80:83], v6 offset:0
    ds_read_b128 v[84:87], v6 offset:1024
    ds_read_b128 v[88:91], v6 offset:2048
    ds_read_b128 v[92:95], v6 offset:3072
    ds_read_b128 v[96:99], v6 offset:4096
    ds_read_b128 v[100:103], v6 offset:5120
    v_mov_b32 v16, 0
    v_mov_b32 v17, 0
    v_mov_b32 v18, 0
    v_mov_b32 v19, 0
    v_mov_b32 v20, 0
    v_mov_b32 v21, 0
    v_mov_b32 v22, 0
    v_mov_b32 v23, 0
    v_mov_b32 v24, 0
    v_mov_b32 v25, 0
    v_mov_b32 v26, 0
    v_mov_b32 v27, 0
    v_mov_b32 v28, 0
    v_mov_b32 v29, 0
    v_mov_b32 v30, 0
    v_mov_b32 v31, 0
    v_mov_b32 v32, 0
    v_mov_b32 v33, 0
    v_mov_b32 v34, 0
    v_mov_b32 v35, 0
    v_mov_b32 v36, 0
    v_mov_b32 v37, 0
    v_mov_b32 v38, 0
    v_mov_b32 v39, 0
    v_mov_b32 v40, 0
    v_mov_b32 v41, 0
    v_mov_b32 v42, 0
    v_mov_b32 v43, 0
    v_mov_b32 v44, 0
    v_mov_b32 v45, 0
    v_mov_b32 v46, 0
    v_mov_b32 v47, 0
    v_mov_b32 v48, 0
    v_mov_b32 v49, 0
    v_mov_b32 v50, 0
    v_mov_b32 v51, 0
    v_mov_b32 v52, 0
    v_mov_b32 v53, 0
    v_mov_b32 v54, 0
    v_mov_b32 v55, 0
    v_permlane32_swap_b32 v56, v60
    v_permlane32_swap_b32 v57, v61
    v_permlane32_swap_b32 v58, v62
    v_permlane32_swap_b32 v59, v63
    v_add_f32 v56, v56, v60
    v_add_f32 v57, v57, v61
    v_add_f32 v58, v58, v62
    v_add_f32 v59, v59, v63
    v_cvt_pk_bf16_f32 v68, v56, v57
    v_cvt_pk_bf16_f32 v69, v58, v59
    v_mov_b32 v60, v64
    v_mov_b32 v61, v65
    v_mov_b32 v62, v66
    v_mov_b32 v63, v67
    v_permlane32_swap_b32 v64, v60
    v_permlane32_swap_b32 v65, v61
    v_permlane32_swap_b32 v66, v62
    v_permlane32_swap_b32 v67, v63
    v_add_f32 v64, v64, v60
    v_add_f32 v65, v65, v61
    v_add_f32 v66, v66, v62
    v_add_f32 v67, v67, v63
    v_cvt_pk_bf16_f32 v70, v64, v65
    v_cvt_pk_bf16_f32 v71, v66, v67
    ds_write_b64 v10, v[68:69]
    ds_write_b64 v9, v[70:71] offset:512
    s_waitcnt lgkmcnt(0)
    s_barrier
    ds_read_b64_tr_b16 v[68:69], v11 offset:0
    ds_read_b64_tr_b16 v[70:71], v11 offset:128
    ds_read_b64_tr_b16 v[72:73], v11 offset:1024
    ds_read_b64_tr_b16 v[74:75], v11 offset:1152
    ds_read_b64_tr_b16 v[76:77], v11 offset:2048
    ds_read_b64_tr_b16 v[78:79], v11 offset:2176
    s_waitcnt lgkmcnt(4)
    v_smfmac_f32_16x16x64_bf16 v[16:19], v[68:71], a[240:247], v4
    v_smfmac_f32_16x16x64_bf16 v[20:23], v[68:71], v[112:119], v4
    v_smfmac_f32_16x16x64_bf16 v[24:27], v[68:71], v[136:143], v4
    v_smfmac_f32_16x16x64_bf16 v[28:31], v[68:71], v[160:167], v4
    s_waitcnt lgkmcnt(2)
    v_smfmac_f32_16x16x64_bf16 v[16:19], v[72:75], a[248:255], v4
    v_smfmac_f32_16x16x64_bf16 v[20:23], v[72:75], v[120:127], v4
    v_smfmac_f32_16x16x64_bf16 v[24:27], v[72:75], v[144:151], v4
    v_smfmac_f32_16x16x64_bf16 v[28:31], v[72:75], v[168:175], v4
    s_waitcnt lgkmcnt(0)
    v_smfmac_f32_16x16x64_bf16 v[16:19], v[76:79], v[104:111], v4
    v_smfmac_f32_16x16x64_bf16 v[20:23], v[76:79], v[128:135], v4
    v_smfmac_f32_16x16x64_bf16 v[24:27], v[76:79], v[152:159], v4
    v_smfmac_f32_16x16x64_bf16 v[28:31], v[76:79], v[176:183], v4
    v_smfmac_f32_16x16x64_bf16 v[32:35], v[68:71], v[184:191], v4
    v_smfmac_f32_16x16x64_bf16 v[36:39], v[68:71], v[208:215], v4
    v_smfmac_f32_16x16x64_bf16 v[40:43], v[68:71], v[232:239], v4
    v_smfmac_f32_16x16x64_bf16 v[44:47], v[68:71], v[80:87], v4
    ds_read_b128 v[80:83], v6 offset:6144
    ds_read_b128 v[84:87], v6 offset:7168
    v_smfmac_f32_16x16x64_bf16 v[32:35], v[72:75], v[192:199], v4
    v_smfmac_f32_16x16x64_bf16 v[36:39], v[72:75], v[216:223], v4
    v_smfmac_f32_16x16x64_bf16 v[40:43], v[72:75], v[240:247], v4
    v_smfmac_f32_16x16x64_bf16 v[44:47], v[72:75], v[88:95], v4
    ds_read_b128 v[88:91], v6 offset:8192
    ds_read_b128 v[92:95], v6 offset:9216
    v_smfmac_f32_16x16x64_bf16 v[32:35], v[76:79], v[200:207], v4
    v_smfmac_f32_16x16x64_bf16 v[36:39], v[76:79], v[224:231], v4
    v_smfmac_f32_16x16x64_bf16 v[40:43], v[76:79], v[248:255], v4
    v_smfmac_f32_16x16x64_bf16 v[44:47], v[76:79], v[96:103], v4
    ds_read_b128 v[96:99], v6 offset:10240
    ds_read_b128 v[100:103], v6 offset:11264
    v_permlane32_swap_b32 v16, v24
    v_permlane32_swap_b32 v17, v25
    v_permlane32_swap_b32 v18, v26
    v_permlane32_swap_b32 v19, v27
    v_add_f32 v16, v16, v24
    v_add_f32 v17, v17, v25
    v_add_f32 v18, v18, v26
    v_add_f32 v19, v19, v27
    v_permlane32_swap_b32 v20, v28
    v_permlane32_swap_b32 v21, v29
    v_permlane32_swap_b32 v22, v30
    v_permlane32_swap_b32 v23, v31
    v_add_f32 v20, v20, v28
    v_add_f32 v21, v21, v29
    v_add_f32 v22, v22, v30
    v_add_f32 v23, v23, v31
    v_cvt_pk_bf16_f32 v56, v16, v17
    v_cvt_pk_bf16_f32 v57, v18, v19
    v_cvt_pk_bf16_f32 v58, v20, v21
    v_cvt_pk_bf16_f32 v59, v22, v23
    s_nop 0
    v_permlane16_swap_b32 v56, v58
    v_permlane16_swap_b32 v57, v59
    v_min_u32 v56, -2, v56
    v_min_u32 v57, -2, v57
    v_min_u32 v58, -2, v58
    v_min_u32 v59, -2, v59
    buffer_store_dwordx4 v[56:59], v14, s[8:11], s43 offen sc1
    s_waitcnt lgkmcnt(4)
    v_smfmac_f32_16x16x64_bf16 v[48:51], v[68:71], v[80:87], v4
    ds_read_b128 v[80:83], v6 offset:12288
    ds_read_b128 v[84:87], v6 offset:13312
    s_waitcnt lgkmcnt(4)
    v_smfmac_f32_16x16x64_bf16 v[48:51], v[72:75], v[88:95], v4
    ds_read_b128 v[88:91], v6 offset:14336
    ds_read_b128 v[92:95], v6 offset:15360
    s_waitcnt lgkmcnt(4)
    v_smfmac_f32_16x16x64_bf16 v[48:51], v[76:79], v[96:103], v4
    ds_read_b128 v[96:99], v6 offset:16384
    ds_read_b128 v[100:103], v6 offset:17408
    v_permlane32_swap_b32 v32, v40
    v_permlane32_swap_b32 v33, v41
    v_permlane32_swap_b32 v34, v42
    v_permlane32_swap_b32 v35, v43
    v_add_f32 v32, v32, v40
    v_add_f32 v33, v33, v41
    v_add_f32 v34, v34, v42
    v_add_f32 v35, v35, v43
    v_permlane32_swap_b32 v36, v44
    v_permlane32_swap_b32 v37, v45
    v_permlane32_swap_b32 v38, v46
    v_permlane32_swap_b32 v39, v47
    v_add_f32 v36, v36, v44
    v_add_f32 v37, v37, v45
    v_add_f32 v38, v38, v46
    v_add_f32 v39, v39, v47
    v_cvt_pk_bf16_f32 v60, v32, v33
    v_cvt_pk_bf16_f32 v61, v34, v35
    v_cvt_pk_bf16_f32 v62, v36, v37
    v_cvt_pk_bf16_f32 v63, v38, v39
    s_nop 0
    v_permlane16_swap_b32 v60, v62
    v_permlane16_swap_b32 v61, v63
    v_min_u32 v60, -2, v60
    v_min_u32 v61, -2, v61
    v_min_u32 v62, -2, v62
    v_min_u32 v63, -2, v63
    s_add_u32 s49, s43, 32768
    buffer_store_dwordx4 v[60:63], v14, s[8:11], s49 offen sc1
    s_waitcnt lgkmcnt(4)
    v_smfmac_f32_16x16x64_bf16 v[52:55], v[68:71], v[80:87], v4
    s_waitcnt lgkmcnt(2)
    v_smfmac_f32_16x16x64_bf16 v[52:55], v[72:75], v[88:95], v4
    s_waitcnt lgkmcnt(0)
    v_smfmac_f32_16x16x64_bf16 v[52:55], v[76:79], v[96:103], v4
    s_nop 11
    v_permlane32_swap_b32 v48, v52
    v_permlane32_swap_b32 v49, v53
    v_permlane32_swap_b32 v50, v54
    v_permlane32_swap_b32 v51, v55
    v_add_f32 v48, v48, v52
    v_add_f32 v49, v49, v53
    v_add_f32 v50, v50, v54
    v_add_f32 v51, v51, v55
    v_cvt_pk_bf16_f32 v64, v48, v49
    v_cvt_pk_bf16_f32 v65, v50, v51
    v_mov_b32 v66, v64
    v_mov_b32 v67, v65
    s_nop 0
    v_permlane16_swap_b32 v64, v66
    v_permlane16_swap_b32 v65, v67
    v_min_u32 v64, -2, v64
    v_min_u32 v65, -2, v65
    v_min_u32 v66, -2, v66
    v_min_u32 v67, -2, v67
    buffer_store_dwordx4 v[64:67], v15, s[8:11], s43 offen sc1
    s_add_u32 s40, s40, 1
    s_add_u32 s43, s43, 327680
    s_add_u32 s47, s47, 40960
    s_cmp_lt_u32 s40, 64
    s_cbranch_scc1 chain2_kernel_v_step
    s_branch chain2_kernel_end
chain2_kernel_roleR:
    s_sub_u32 s44, s2, 64
    v_lshlrev_b32 v5, 4, v1
    s_lshl_b32 s24, s44, 15
    s_lshl_b32 s25, s3, 13
    s_add_u32 s24, s24, s25
    v_add_u32 v6, s24, v5
    v_add_u32 v7, 4096, v6
    s_lshl_b32 s24, s3, 12
    v_add_u32 v8, s24, v5
    s_lshl_b32 s24, s3, 10
    s_add_u32 s24, s24, 16384
    v_add_u32 v9, s24, v5
    s_lshl_b32 s24, s44, 13
    s_lshl_b32 s25, s3, 11
    s_add_u32 s24, s24, s25
    v_add_u32 v10, s24, v5
    v_and_b32 v204, 7, v2
    v_mul_u32_u24 v11, 80, v204
    v_lshl_add_u32 v11, v3, 4, v11
    s_mul_i32 s24, s3, 640
    v_add_u32 v11, s24, v11
    v_add_u32 v204, 8192, v5
    v_cmp_gt_u32 vcc, 8, v2
    s_nop 1
    v_cndmask_b32 v11, v204, v11, vcc
    v_and_b32 v204, 7, v2
    v_mul_u32_u24 v12, 80, v204
    v_lshrrev_b32 v204, 3, v2
    v_lshl_add_u32 v12, v204, 5, v12
    v_mul_u32_u24 v13, 10240, v3
    v_lshl_add_u32 v13, v2, 4, v13
    s_lshl_b32 s24, s44, 8
    v_add_u32 v13, s24, v13
    v_mov_b32 v204, 2146435072
    v_cmp_gt_u32 vcc, 1, v3
    s_nop 1
    v_cndmask_b32 v13, v204, v13, vcc
    v_cmp_le_u32 s[50:51], 8, v2
    s_lshl_b32 s24, s3, 14
    v_add_u32 v205, s24, v5
    v_add_u32 v212, 0, v205
    v_add_u32 v213, 4096, v205
    v_add_u32 v214, 8192, v205
    v_add_u32 v215, 12288, v205
    s_lshl_b32 s24, s3, 12
    s_add_u32 s24, s24, 65536
    v_add_u32 v216, s24, v5
    s_lshl_b32 s24, s3, 11
    s_add_u32 s24, s24, 16384
    v_add_u32 v217, s24, v5
    s_lshl_b32 s24, s3, 10
    s_add_u32 s24, s24, 16384
    v_add_u32 v218, s24, v5
    s_lshl_b32 s24, s3, 4
    v_add_u32 v219, s24, v2
    v_mul_u32_u24 v219, 1280, v219
    v_lshl_add_u32 v219, v3, 3, v219
    s_lshl_b32 s24, s44, 5
    v_add_u32 v219, s24, v219
    s_load_dwordx2 s[26:27], s[0:1], 80
    s_waitcnt lgkmcnt(0)
    s_mov_b32 s12, s26
    s_mov_b32 s13, s27
    s_mov_b32 s14, 2621440
    s_mov_b32 s15, 0x00020000
    s_add_u32 s16, s4, 4194304
    s_addc_u32 s17, s5, 0
    s_mov_b32 s18, 2621440
    s_mov_b32 s19, 0x00020000
    s_mov_b32 s40, 0
    s_mov_b32 s41, 184549376
    s_mov_b32 s43, 141074432
    s_mov_b32 s42, 117440512
    s_mov_b32 s45, 146317312
    s_mov_b32 s46, 0
    s_mov_b32 s47, 138452992
    buffer_load_dwordx4 v[48:51], v6, s[8:11], s41 offen offset:0
    buffer_load_dwordx4 v[52:55], v6, s[8:11], s41 offen offset:1024
    buffer_load_dwordx4 v[56:59], v6, s[8:11], s41 offen offset:2048
    buffer_load_dwordx4 v[60:63], v6, s[8:11], s41 offen offset:3072
    buffer_load_dwordx4 v[64:67], v7, s[8:11], s41 offen offset:0
    buffer_load_dwordx4 v[68:71], v7, s[8:11], s41 offen offset:1024
    buffer_load_dwordx4 v[72:75], v7, s[8:11], s41 offen offset:2048
    buffer_load_dwordx4 v[76:79], v7, s[8:11], s41 offen offset:3072
    s_add_u32 s41, s41, 1310720
    s_waitcnt vmcnt(0)
chain2_kernel_r_step:
    v_mov_b32 v16, v48
    v_mov_b32 v17, v49
    v_mov_b32 v18, v50
    v_mov_b32 v19, v51
    v_mov_b32 v20, v52
    v_mov_b32 v21, v53
    v_mov_b32 v22, v54
    v_mov_b32 v23, v55
    v_mov_b32 v24, v56
    v_mov_b32 v25, v57
    v_mov_b32 v26, v58
    v_mov_b32 v27, v59
    v_mov_b32 v28, v60
    v_mov_b32 v29, v61
    v_mov_b32 v30, v62
    v_mov_b32 v31, v63
    v_mov_b32 v32, v64
    v_mov_b32 v33, v65
    v_mov_b32 v34, v66
    v_mov_b32 v35, v67
    v_mov_b32 v36, v68
    v_mov_b32 v37, v69
    v_mov_b32 v38, v70
    v_mov_b32 v39, v71
    v_mov_b32 v40, v72
    v_mov_b32 v41, v73
    v_mov_b32 v42, v74
    v_mov_b32 v43, v75
    v_mov_b32 v44, v76
    v_mov_b32 v45, v77
    v_mov_b32 v46, v78
    v_mov_b32 v47, v79
    s_mov_b32 s61, 0
chain2_kernel_r_p:
    buffer_load_dwordx4 v[80:83], v8, s[8:11], s43 offen offset:0 sc1
    buffer_load_dwordx4 v[84:87], v8, s[8:11], s43 offen offset:1024 sc1
    buffer_load_dwordx4 v[88:91], v8, s[8:11], s43 offen offset:2048 sc1
    buffer_load_dwordx4 v[92:95], v8, s[8:11], s43 offen offset:3072 sc1
    buffer_load_dwordx4 v[96:99], v9, s[8:11], s43 offen sc1
    buffer_load_dwordx4 v[100:103], v10, s[8:11], s42 offen offset:0 sc1
    buffer_load_dwordx4 v[104:107], v10, s[8:11], s42 offen offset:1024 sc1
    s_waitcnt vmcnt(0)
    v_max3_u32 v204, v80, v81, v82
    v_max3_u32 v204, v204, v83, v84
    v_max3_u32 v204, v204, v85, v86
    v_max3_u32 v204, v204, v87, v88
    v_max3_u32 v204, v204, v89, v90
    v_max3_u32 v204, v204, v91, v92
    v_max3_u32 v204, v204, v93, v94
    v_max3_u32 v204, v204, v95, v96
    v_max3_u32 v204, v204, v97, v98
    v_max3_u32 v204, v204, v99, v100
    v_max3_u32 v204, v204, v101, v102
    v_max3_u32 v204, v204, v103, v104
    v_max3_u32 v204, v204, v105, v106
    v_max_u32 v204, v204, v107
    v_cmp_eq_u32 vcc, -1, v204
    s_add_u32 s61, s61, 1
    s_cbranch_vccz chain2_kernel_r_p_out
    s_cmp_ge_u32 s61, s60
    s_cbranch_scc1 chain2_kernel_r_p_to
    s_sleep 1
    s_branch chain2_kernel_r_p
chain2_kernel_r_p_to:
    s_mov_b32 s60, 1
chain2_kernel_r_p_out:
    v_mfma_f32_16x16x32_bf16 v[108:111], v[100:103], v[96:99], 0
    v_mfma_f32_16x16x32_bf16 v[112:115], v[104:107], v[96:99], 0
    v_mfma_f32_16x16x32_bf16 v[108:111], v[16:19], v[80:83], v[108:111]
    v_mfma_f32_16x16x32_bf16 v[112:115], v[20:23], v[80:83], v[112:115]
    v_mfma_f32_16x16x32_bf16 v[108:111], v[24:27], v[84:87], v[108:111]
    v_mfma_f32_16x16x32_bf16 v[112:115], v[28:31], v[84:87], v[112:115]
    v_mfma_f32_16x16x32_bf16 v[108:111], v[32:35], v[88:91], v[108:111]
    v_mfma_f32_16x16x32_bf16 v[112:115], v[36:39], v[88:91], v[112:115]
    v_mfma_f32_16x16x32_bf16 v[108:111], v[40:43], v[92:95], v[108:111]
    v_mfma_f32_16x16x32_bf16 v[112:115], v[44:47], v[92:95], v[112:115]
    s_and_b32 s24, s40, 1
    s_mul_i32 s24, s24, 2560
    v_add_u32 v14, s24, v11
    v_add_u32 v15, s24, v12
    s_nop 3
    v_cndmask_b32 v108, v108, v112, s[50:51]
    v_cndmask_b32 v109, v109, v113, s[50:51]
    v_cndmask_b32 v110, v110, v114, s[50:51]
    v_cndmask_b32 v111, v111, v115, s[50:51]
    v_add_f32 v108, v108, v108 row_ror:8 row_mask:0xf bank_mask:0xf
    v_add_f32 v109, v109, v109 row_ror:8 row_mask:0xf bank_mask:0xf
    v_add_f32 v110, v110, v110 row_ror:8 row_mask:0xf bank_mask:0xf
    v_add_f32 v111, v111, v111 row_ror:8 row_mask:0xf bank_mask:0xf
    ds_write_b128 v14, v[108:111]
    s_waitcnt lgkmcnt(0)
    s_barrier
    s_cmp_eq_u32 s3, 0
    s_cbranch_scc0 chain2_kernel_np7
    ds_read_b128 v[220:223], v15 offset:0
    ds_read_b128 v[224:227], v15 offset:16
    ds_read_b128 v[228:231], v15 offset:640
    ds_read_b128 v[232:235], v15 offset:656
    ds_read_b128 v[236:239], v15 offset:1280
    ds_read_b128 v[240:243], v15 offset:1296
    ds_read_b128 v[244:247], v15 offset:1920
    ds_read_b128 v[248:251], v15 offset:1936
    s_waitcnt lgkmcnt(4)
    v_pk_add_f32 v[220:221], v[220:221], v[228:229]
    v_pk_add_f32 v[222:223], v[222:223], v[230:231]
    v_pk_add_f32 v[224:225], v[224:225], v[232:233]
    v_pk_add_f32 v[226:227], v[226:227], v[234:235]
    s_waitcnt lgkmcnt(0)
    v_pk_add_f32 v[236:237], v[236:237], v[244:245]
    v_pk_add_f32 v[238:239], v[238:239], v[246:247]
    v_pk_add_f32 v[240:241], v[240:241], v[248:249]
    v_pk_add_f32 v[242:243], v[242:243], v[250:251]
    v_pk_add_f32 v[220:221], v[220:221], v[236:237]
    v_pk_add_f32 v[222:223], v[222:223], v[238:239]
    v_pk_add_f32 v[224:225], v[224:225], v[240:241]
    v_pk_add_f32 v[226:227], v[226:227], v[242:243]
    v_cvt_pk_bf16_f32 v228, v220, v221
    v_cvt_pk_bf16_f32 v229, v222, v223
    v_cvt_pk_bf16_f32 v230, v224, v225
    v_cvt_pk_bf16_f32 v231, v226, v227
    v_min_u32 v228, -2, v228
    v_min_u32 v229, -2, v229
    v_min_u32 v230, -2, v230
    v_min_u32 v231, -2, v231
    buffer_store_dwordx4 v[228:231], v13, s[8:11], s47 offen sc1
chain2_kernel_np7:
    buffer_load_dwordx4 v[48:51], v6, s[8:11], s41 offen offset:0
    buffer_load_dwordx4 v[52:55], v6, s[8:11], s41 offen offset:1024
    buffer_load_dwordx4 v[56:59], v6, s[8:11], s41 offen offset:2048
    buffer_load_dwordx4 v[60:63], v6, s[8:11], s41 offen offset:3072
    buffer_load_dwordx4 v[64:67], v7, s[8:11], s41 offen offset:0
    buffer_load_dwordx4 v[68:71], v7, s[8:11], s41 offen offset:1024
    buffer_load_dwordx4 v[72:75], v7, s[8:11], s41 offen offset:2048
    buffer_load_dwordx4 v[76:79], v7, s[8:11], s41 offen offset:3072
    s_add_u32 s41, s41, 1310720
    buffer_load_dwordx2 v[206:207], v219, s[16:19], s46 offen
    s_mov_b32 s61, 0
chain2_kernel_r_x:
    buffer_load_dwordx4 v[116:119], v212, s[8:11], s45 offen offset:0 sc1
    buffer_load_dwordx4 v[120:123], v212, s[8:11], s45 offen offset:1024 sc1
    buffer_load_dwordx4 v[124:127], v212, s[8:11], s45 offen offset:2048 sc1
    buffer_load_dwordx4 v[128:131], v212, s[8:11], s45 offen offset:3072 sc1
    buffer_load_dwordx4 v[132:135], v213, s[8:11], s45 offen offset:0 sc1
    buffer_load_dwordx4 v[136:139], v213, s[8:11], s45 offen offset:1024 sc1
    buffer_load_dwordx4 v[140:143], v213, s[8:11], s45 offen offset:2048 sc1
    buffer_load_dwordx4 v[144:147], v213, s[8:11], s45 offen offset:3072 sc1
    buffer_load_dwordx4 v[148:151], v214, s[8:11], s45 offen offset:0 sc1
    buffer_load_dwordx4 v[152:155], v214, s[8:11], s45 offen offset:1024 sc1
    buffer_load_dwordx4 v[156:159], v214, s[8:11], s45 offen offset:2048 sc1
    buffer_load_dwordx4 v[160:163], v214, s[8:11], s45 offen offset:3072 sc1
    buffer_load_dwordx4 v[164:167], v215, s[8:11], s45 offen offset:0 sc1
    buffer_load_dwordx4 v[168:171], v215, s[8:11], s45 offen offset:1024 sc1
    buffer_load_dwordx4 v[172:175], v215, s[8:11], s45 offen offset:2048 sc1
    buffer_load_dwordx4 v[176:179], v215, s[8:11], s45 offen offset:3072 sc1
    buffer_load_dwordx4 v[180:183], v216, s[8:11], s45 offen offset:0 sc1
    buffer_load_dwordx4 v[184:187], v216, s[8:11], s45 offen offset:1024 sc1
    buffer_load_dwordx4 v[188:191], v216, s[8:11], s45 offen offset:2048 sc1
    buffer_load_dwordx4 v[192:195], v216, s[8:11], s45 offen offset:3072 sc1
    s_waitcnt vmcnt(0)
    v_max3_u32 v204, v116, v117, v118
    v_max3_u32 v204, v204, v119, v120
    v_max3_u32 v204, v204, v121, v122
    v_max3_u32 v204, v204, v123, v124
    v_max3_u32 v204, v204, v125, v126
    v_max3_u32 v204, v204, v127, v128
    v_max3_u32 v204, v204, v129, v130
    v_max3_u32 v204, v204, v131, v132
    v_max3_u32 v204, v204, v133, v134
    v_max3_u32 v204, v204, v135, v136
    v_max3_u32 v204, v204, v137, v138
    v_max3_u32 v204, v204, v139, v140
    v_max3_u32 v204, v204, v141, v142
    v_max3_u32 v204, v204, v143, v144
    v_max3_u32 v204, v204, v145, v146
    v_max3_u32 v204, v204, v147, v148
    v_max3_u32 v204, v204, v149, v150
    v_max3_u32 v204, v204, v151, v152
    v_max3_u32 v204, v204, v153, v154
    v_max3_u32 v204, v204, v155, v156
    v_max3_u32 v204, v204, v157, v158
    v_max3_u32 v204, v204, v159, v160
    v_max3_u32 v204, v204, v161, v162
    v_max3_u32 v204, v204, v163, v164
    v_max3_u32 v204, v204, v165, v166
    v_max3_u32 v204, v204, v167, v168
    v_max3_u32 v204, v204, v169, v170
    v_max3_u32 v204, v204, v171, v172
    v_max3_u32 v204, v204, v173, v174
    v_max3_u32 v204, v204, v175, v176
    v_max3_u32 v204, v204, v177, v178
    v_max3_u32 v204, v204, v179, v180
    v_max3_u32 v204, v204, v181, v182
    v_max3_u32 v204, v204, v183, v184
    v_max3_u32 v204, v204, v185, v186
    v_max3_u32 v204, v204, v187, v188
    v_max3_u32 v204, v204, v189, v190
    v_max3_u32 v204, v204, v191, v192
    v_max3_u32 v204, v204, v193, v194
    v_max_u32 v204, v204, v195
    v_cmp_eq_u32 vcc, -1, v204
    s_add_u32 s61, s61, 1
    s_cbranch_vccz chain2_kernel_r_x_out
    s_cmp_ge_u32 s61, s60
    s_cbranch_scc1 chain2_kernel_r_x_to
    s_sleep 2
    s_branch chain2_kernel_r_x
chain2_kernel_r_x_to:
    s_mov_b32 s60, 1
chain2_kernel_r_x_out:
    v_mfma_f32_16x16x32_bf16 v[196:199], v[100:103], v[180:183], 0
    v_mfma_f32_16x16x32_bf16 v[200:203], v[100:103], v[184:187], 0
    v_mfma_f32_16x16x32_bf16 v[196:199], v[104:107], v[188:191], v[196:199]
    v_mfma_f32_16x16x32_bf16 v[200:203], v[104:107], v[192:195], v[200:203]
    v_mfma_f32_16x16x32_bf16 v[196:199], v[16:19], v[116:119], v[196:199]
    v_mfma_f32_16x16x32_bf16 v[200:203], v[16:19], v[120:123], v[200:203]
    v_mfma_f32_16x16x32_bf16 v[196:199], v[20:23], v[124:127], v[196:199]
    v_mfma_f32_16x16x32_bf16 v[200:203], v[20:23], v[128:131], v[200:203]
    v_mfma_f32_16x16x32_bf16 v[196:199], v[24:27], v[132:135], v[196:199]
    v_mfma_f32_16x16x32_bf16 v[200:203], v[24:27], v[136:139], v[200:203]
    v_mfma_f32_16x16x32_bf16 v[196:199], v[28:31], v[140:143], v[196:199]
    v_mfma_f32_16x16x32_bf16 v[200:203], v[28:31], v[144:147], v[200:203]
    v_mfma_f32_16x16x32_bf16 v[196:199], v[32:35], v[148:151], v[196:199]
    v_mfma_f32_16x16x32_bf16 v[200:203], v[32:35], v[152:155], v[200:203]
    v_mfma_f32_16x16x32_bf16 v[196:199], v[36:39], v[156:159], v[196:199]
    v_mfma_f32_16x16x32_bf16 v[200:203], v[36:39], v[160:163], v[200:203]
    v_mfma_f32_16x16x32_bf16 v[196:199], v[40:43], v[164:167], v[196:199]
    v_mfma_f32_16x16x32_bf16 v[200:203], v[40:43], v[168:171], v[200:203]
    v_mfma_f32_16x16x32_bf16 v[196:199], v[44:47], v[172:175], v[196:199]
    v_mfma_f32_16x16x32_bf16 v[200:203], v[44:47], v[176:179], v[200:203]
    s_nop 6
    ds_write_b128 v217, v[196:199] offset:0
    ds_write_b128 v217, v[200:203] offset:1024
    s_waitcnt lgkmcnt(0)
    s_barrier
    s_cmp_lt_u32 s3, 2
    s_cbranch_scc0 chain2_kernel_no8
    ds_read_b128 v[220:223], v218 offset:0
    ds_read_b128 v[224:227], v218 offset:2048
    ds_read_b128 v[228:231], v218 offset:4096
    ds_read_b128 v[232:235], v218 offset:6144
    s_waitcnt lgkmcnt(0)
    v_pk_add_f32 v[220:221], v[220:221], v[224:225]
    v_pk_add_f32 v[228:229], v[228:229], v[232:233]
    v_pk_add_f32 v[222:223], v[222:223], v[226:227]
    v_pk_add_f32 v[230:231], v[230:231], v[234:235]
    v_pk_add_f32 v[220:221], v[220:221], v[228:229]
    v_pk_add_f32 v[222:223], v[222:223], v[230:231]
    v_cvt_pk_bf16_f32 v224, v220, v221
    v_cvt_pk_bf16_f32 v225, v222, v223
    v_lshlrev_b32 v220, 16, v224
    v_and_b32 v221, 0xffff0000, v224
    v_lshlrev_b32 v226, 16, v206
    v_and_b32 v227, 0xffff0000, v206
    v_add_f32 v220, v220, v226
    v_add_f32 v221, v221, v227
    v_lshlrev_b32 v222, 16, v225
    v_and_b32 v223, 0xffff0000, v225
    v_lshlrev_b32 v226, 16, v207
    v_and_b32 v227, 0xffff0000, v207
    v_add_f32 v222, v222, v226
    v_add_f32 v223, v223, v227
    v_cvt_pk_bf16_f32 v224, v220, v221
    v_cvt_pk_bf16_f32 v225, v222, v223
    buffer_store_dwordx2 v[224:225], v219, s[12:15], s46 offen
chain2_kernel_no8:
    s_add_u32 s40, s40, 1
    s_add_u32 s42, s42, 327680
    s_add_u32 s43, s43, 81920
    s_add_u32 s45, s45, 81920
    s_add_u32 s46, s46, 40960
    s_add_u32 s47, s47, 40960
    s_cmp_lt_u32 s40, 64
    s_cbranch_scc1 chain2_kernel_r_step
    s_branch chain2_kernel_end
chain2_kernel_end:
    s_endpgm
.section .rodata,"a"
.p2align 6
.amdhsa_kernel chain2_kernel
  .amdhsa_next_free_vgpr 512
  .amdhsa_next_free_sgpr 100
  .amdhsa_accum_offset 256
  .amdhsa_group_segment_fixed_size 0
  .amdhsa_kernarg_size 104
  .amdhsa_user_sgpr_count 2
  .amdhsa_user_sgpr_kernarg_segment_ptr 1
  .amdhsa_system_sgpr_workgroup_id_x 1
.end_amdhsa_kernel
```

```asm
; @launch kernel=pack_kernel grid=(864,1,1) block=(256,1,1) lds=0
; @launch kernel=ln_a1_kernel grid=(512,1,1) block=(256,1,1) lds=0
; @launch kernel=qkv_a_kernel grid=(192,1,1) block=(256,1,1) lds=0
; @launch kernel=kvz_a1_kernel grid=(128,1,1) block=(256,1,1) lds=0
; @launch kernel=attn_a1_kernel grid=(256,1,1) block=(256,1,1) lds=86016
; @launch kernel=wo_a1_kernel grid=(128,1,1) block=(256,1,1) lds=0
; @launch kernel=lnf_kernel grid=(128,1,1) block=(256,1,1) lds=512
; @launch kernel=clr_kernel grid=(1042,1,1) block=(256,1,1) lds=0
; @launch kernel=chain1_kernel grid=(232,1,1) block=(256,1,1) lds=135168
; @launch kernel=ln_a2_kernel grid=(512,1,1) block=(256,1,1) lds=0
; @launch kernel=qkv_a_kernel grid=(192,1,1) block=(256,1,1) lds=0
; @launch kernel=kvz_a2_kernel grid=(128,1,1) block=(256,1,1) lds=0
; @launch kernel=attn_a2_kernel grid=(256,1,1) block=(256,1,1) lds=86016
; @launch kernel=wo_a2_kernel grid=(128,1,1) block=(256,1,1) lds=0
; @launch kernel=lnf_kernel grid=(128,1,1) block=(256,1,1) lds=512
; @launch kernel=clr_kernel grid=(1042,1,1) block=(256,1,1) lds=0
; @launch kernel=chain2_kernel grid=(232,1,1) block=(256,1,1) lds=135168
.amdgcn_target "amdgcn-amd-amdhsa--gfx950"
.text
.globl pack_kernel
.p2align 8
.type pack_kernel,@function
pack_kernel:
    v_lshrrev_b32 v1, 6, v0
    v_and_b32 v2, 63, v0
    s_nop 0
    v_readfirstlane_b32 s3, v1
    s_lshl_b32 s4, s2, 2
    s_add_u32 s4, s4, s3
    s_load_dwordx2 s[6:7], s[0:1], 96
    s_waitcnt lgkmcnt(0)
    s_mov_b32 s8, s6
    s_mov_b32 s9, s7
    s_mov_b32 s10, 268435456
    s_mov_b32 s11, 0x00020000
    s_cmp_lt_u32 s4, 3200
    s_cbranch_scc1 pack_kernel_pk
    s_cmp_ge_u32 s4, 3456
    s_cbranch_scc1 pack_kernel_end
    s_sub_u32 s4, s4, 3200
    s_lshl_b32 s5, s4, 10
    v_lshlrev_b32 v3, 4, v2
    v_add_u32 v3, s5, v3
    v_add_u32 v4, 218103808, v3
    s_cmp_lt_u32 s5, 0
    s_cbranch_scc1 pack_kernel_clr
    v_add_u32 v4, 23068672, v3
pack_kernel_clr:
    v_mov_b32 v8, 0
    v_mov_b32 v9, 0
    v_mov_b32 v10, 0
    v_mov_b32 v11, 0
    buffer_store_dwordx4 v[8:11], v4, s[8:11], 0 offen
    s_branch pack_kernel_end
pack_kernel_pk:
    s_cmp_lt_u32 s4, 2400
    s_cbranch_scc0 pack_kernel_nx0
    s_sub_u32 s4, s4, 0
    s_load_dwordx2 s[12:13], s[0:1], 8
    s_mov_b32 s20, 1920
    s_mov_b32 s21, 20
    s_mov_b32 s22, 25165824
    s_mov_b32 s23, 2457600
    s_mul_i32 s24, s4, 1639
    s_lshr_b32 s24, s24, 15
    s_branch pack_kernel_go
pack_kernel_nx0:
    s_cmp_lt_u32 s4, 3200
    s_cbranch_scc0 pack_kernel_nx1
    s_sub_u32 s4, s4, 2400
    s_load_dwordx2 s[12:13], s[0:1], 16
    s_mov_b32 s20, 640
    s_mov_b32 s21, 20
    s_mov_b32 s22, 29360128
    s_mov_b32 s23, 819200
    s_mul_i32 s24, s4, 205
    s_lshr_b32 s24, s24, 12
    s_branch pack_kernel_go
pack_kernel_nx1:
    s_branch pack_kernel_end
pack_kernel_go:
    s_waitcnt lgkmcnt(0)
    s_mov_b32 s16, s12
    s_mov_b32 s17, s13
    s_mov_b32 s18, s23
    s_mov_b32 s19, 0x00020000
    s_mul_i32 s25, s24, s21
    s_sub_u32 s25, s4, s25
    v_lshrrev_b32 v3, 4, v2
    v_lshlrev_b32 v3, 3, v3
    s_lshl_b32 s26, s25, 5
    v_add_u32 v3, s26, v3
    v_mul_lo_u32 v3, v3, s20
    v_and_b32 v4, 15, v2
    s_lshl_b32 s27, s24, 4
    v_add3_u32 v3, v3, v4, s27
    v_lshlrev_b32 v3, 1, v3
    s_lshl_b32 s28, s20, 1
    s_mov_b32 s29, 0
    buffer_load_ushort v12, v3, s[16:19], s29 offen
    s_add_u32 s29, s29, s28
    buffer_load_ushort v13, v3, s[16:19], s29 offen
    s_add_u32 s29, s29, s28
    buffer_load_ushort v14, v3, s[16:19], s29 offen
    s_add_u32 s29, s29, s28
    buffer_load_ushort v15, v3, s[16:19], s29 offen
    s_add_u32 s29, s29, s28
    buffer_load_ushort v16, v3, s[16:19], s29 offen
    s_add_u32 s29, s29, s28
    buffer_load_ushort v17, v3, s[16:19], s29 offen
    s_add_u32 s29, s29, s28
    buffer_load_ushort v18, v3, s[16:19], s29 offen
    s_add_u32 s29, s29, s28
    buffer_load_ushort v19, v3, s[16:19], s29 offen
    s_lshl_b32 s5, s4, 10
    s_add_u32 s5, s5, s22
    v_lshlrev_b32 v5, 4, v2
    v_add_u32 v5, s5, v5
    s_waitcnt vmcnt(0)
    v_lshl_or_b32 v8, v13, 16, v12
    v_lshl_or_b32 v9, v15, 16, v14
    v_lshl_or_b32 v10, v17, 16, v16
    v_lshl_or_b32 v11, v19, 16, v18
    buffer_store_dwordx4 v[8:11], v5, s[8:11], 0 offen
pack_kernel_end:
    s_endpgm
.section .rodata,"a"
.p2align 6
.amdhsa_kernel pack_kernel
  .amdhsa_next_free_vgpr 24
  .amdhsa_next_free_sgpr 40
  .amdhsa_accum_offset 24
  .amdhsa_group_segment_fixed_size 0
  .amdhsa_kernarg_size 104
  .amdhsa_user_sgpr_count 2
  .amdhsa_user_sgpr_kernarg_segment_ptr 1
  .amdhsa_system_sgpr_workgroup_id_x 1
.end_amdhsa_kernel
.text
.globl ln_a1_kernel
.p2align 8
.type ln_a1_kernel,@function
ln_a1_kernel:
    v_lshrrev_b32 v1, 6, v0
    v_and_b32 v2, 63, v0
    s_nop 0
    v_readfirstlane_b32 s3, v1
    s_lshl_b32 s4, s2, 2
    s_add_u32 s4, s4, s3
    s_cmp_ge_u32 s4, 2048
    s_cbranch_scc1 ln_a1_kernel_end
    s_load_dwordx2 s[6:7], s[0:1], 0
    s_load_dwordx2 s[12:13], s[0:1], 96
    s_waitcnt lgkmcnt(0)
    s_mov_b32 s8, s6
    s_mov_b32 s9, s7
    s_mov_b32 s10, 2621440
    s_mov_b32 s11, 0x00020000
    s_mov_b32 s16, s12
    s_mov_b32 s17, s13
    s_mov_b32 s18, 2621440
    s_mov_b32 s19, 0x00020000
    s_mul_i32 s5, s4, 1280
    v_lshlrev_b32 v3, 2, v2
    v_add_u32 v3, s5, v3
    buffer_load_dword v4, v3, s[8:11], 0 offen offset:0
    buffer_load_dword v5, v3, s[8:11], 0 offen offset:256
    buffer_load_dword v6, v3, s[8:11], 0 offen offset:512
    buffer_load_dword v7, v3, s[8:11], 0 offen offset:768
    buffer_load_dword v8, v3, s[8:11], 0 offen offset:1024
    s_waitcnt vmcnt(0)
    v_lshlrev_b32 v10, 16, v4
    v_and_b32 v11, 0xffff0000, v4
    v_lshlrev_b32 v12, 16, v5
    v_and_b32 v13, 0xffff0000, v5
    v_lshlrev_b32 v14, 16, v6
    v_and_b32 v15, 0xffff0000, v6
    v_lshlrev_b32 v16, 16, v7
    v_and_b32 v17, 0xffff0000, v7
    v_lshlrev_b32 v18, 16, v8
    v_and_b32 v19, 0xffff0000, v8
    v_add_f32 v20, v10, v11
    v_add_f32 v20, v20, v12
    v_add_f32 v20, v20, v13
    v_add_f32 v20, v20, v14
    v_add_f32 v20, v20, v15
    v_add_f32 v20, v20, v16
    v_add_f32 v20, v20, v17
    v_add_f32 v20, v20, v18
    v_add_f32 v20, v20, v19
    s_nop 1
    v_add_f32 v21, v20, v20 quad_perm:[1,0,3,2] row_mask:0xf bank_mask:0xf
    s_nop 1
    v_add_f32 v21, v21, v21 quad_perm:[2,3,0,1] row_mask:0xf bank_mask:0xf
    s_nop 1
    v_add_f32 v21, v21, v21 row_half_mirror row_mask:0xf bank_mask:0xf
    s_nop 1
    v_add_f32 v21, v21, v21 row_mirror row_mask:0xf bank_mask:0xf
    s_nop 1
    v_readlane_b32 s24, v21, 0
    v_readlane_b32 s25, v21, 16
    v_readlane_b32 s26, v21, 32
    v_readlane_b32 s27, v21, 48
    s_nop 1
    v_mov_b32 v20, s24
    v_add_f32 v20, s25, v20
    v_add_f32 v20, s26, v20
    v_add_f32 v20, s27, v20
    v_mul_f32 v20, 0.0015625, v20
    v_sub_f32 v10, v10, v20
    v_sub_f32 v11, v11, v20
    v_sub_f32 v12, v12, v20
    v_sub_f32 v13, v13, v20
    v_sub_f32 v14, v14, v20
    v_sub_f32 v15, v15, v20
    v_sub_f32 v16, v16, v20
    v_sub_f32 v17, v17, v20
    v_sub_f32 v18, v18, v20
    v_sub_f32 v19, v19, v20
    v_mul_f32 v21, v10, v10
    v_fmac_f32 v21, v11, v11
    v_fmac_f32 v21, v12, v12
    v_fmac_f32 v21, v13, v13
    v_fmac_f32 v21, v14, v14
    v_fmac_f32 v21, v15, v15
    v_fmac_f32 v21, v16, v16
    v_fmac_f32 v21, v17, v17
    v_fmac_f32 v21, v18, v18
    v_fmac_f32 v21, v19, v19
    s_nop 1
    v_add_f32 v22, v21, v21 quad_perm:[1,0,3,2] row_mask:0xf bank_mask:0xf
    s_nop 1
    v_add_f32 v22, v22, v22 quad_perm:[2,3,0,1] row_mask:0xf bank_mask:0xf
    s_nop 1
    v_add_f32 v22, v22, v22 row_half_mirror row_mask:0xf bank_mask:0xf
    s_nop 1
    v_add_f32 v22, v22, v22 row_mirror row_mask:0xf bank_mask:0xf
    s_nop 1
    v_readlane_b32 s24, v22, 0
    v_readlane_b32 s25, v22, 16
    v_readlane_b32 s26, v22, 32
    v_readlane_b32 s27, v22, 48
    s_nop 1
    v_mov_b32 v21, s24
    v_add_f32 v21, s25, v21
    v_add_f32 v21, s26, v21
    v_add_f32 v21, s27, v21
    v_mov_b32 v22, 0x3727c5ac
    v_fmac_f32 v22, 0.0015625, v21
    v_rsq_f32 v22, v22
    s_nop 0
    v_mul_f32 v10, v10, v22
    v_mul_f32 v11, v11, v22
    v_mul_f32 v12, v12, v22
    v_mul_f32 v13, v13, v22
    v_mul_f32 v14, v14, v22
    v_mul_f32 v15, v15, v22
    v_mul_f32 v16, v16, v22
    v_mul_f32 v17, v17, v22
    v_mul_f32 v18, v18, v22
    v_mul_f32 v19, v19, v22
    v_cvt_pk_bf16_f32 v4, v10, v11
    v_cvt_pk_bf16_f32 v5, v12, v13
    v_cvt_pk_bf16_f32 v6, v14, v15
    v_cvt_pk_bf16_f32 v7, v16, v17
    v_cvt_pk_bf16_f32 v8, v18, v19
    buffer_store_dword v4, v3, s[16:19], 0 offen offset:0
    buffer_store_dword v5, v3, s[16:19], 0 offen offset:256
    buffer_store_dword v6, v3, s[16:19], 0 offen offset:512
    buffer_store_dword v7, v3, s[16:19], 0 offen offset:768
    buffer_store_dword v8, v3, s[16:19], 0 offen offset:1024
ln_a1_kernel_end:
    s_endpgm
.section .rodata,"a"
.p2align 6
.amdhsa_kernel ln_a1_kernel
  .amdhsa_next_free_vgpr 32
  .amdhsa_next_free_sgpr 40
  .amdhsa_accum_offset 32
  .amdhsa_group_segment_fixed_size 0
  .amdhsa_kernarg_size 104
  .amdhsa_user_sgpr_count 2
  .amdhsa_user_sgpr_kernarg_segment_ptr 1
  .amdhsa_system_sgpr_workgroup_id_x 1
.end_amdhsa_kernel
.text
.globl qkv_a_kernel
.p2align 8
.type qkv_a_kernel,@function
qkv_a_kernel:
    v_lshrrev_b32 v1, 6, v0
    v_and_b32 v2, 63, v0
    s_nop 0
    v_readfirstlane_b32 s3, v1
    s_cmp_ge_u32 s2, 192
    s_cbranch_scc1 qkv_a_kernel_end
    s_load_dwordx2 s[4:5], s[0:1], 96
    s_load_dwordx2 s[6:7], s[0:1], 80
    s_mul_i32 s20, s2, 171
    s_lshr_b32 s20, s20, 12
    s_mul_i32 s21, s20, 24
    s_sub_u32 s21, s2, s21
    s_lshl_b32 s20, s20, 2
    s_add_u32 s20, s20, s3
    s_mul_i32 s22, s20, 64
    s_mul_i32 s23, s21, 80
    s_waitcnt lgkmcnt(0)
    s_mov_b32 s8, s4
    s_mov_b32 s9, s5
    s_mov_b32 s10, 268435456
    s_mov_b32 s11, 0x00020000
    v_and_b32 v3, 15, v2
    v_lshrrev_b32 v4, 4, v2
    s_mov_b32 s24, 1280
    v_add_u32 v5, s22, v3
    v_mul_lo_u32 v5, v5, s24
    v_lshlrev_b32 v6, 4, v4
    v_add_u32 v5, v5, v6
    v_add_u32 v5, 0, v5
    v_mov_b32 v8, v5
    v_add_u32 v9, 20480, v5
    v_add_u32 v10, 40960, v5
    v_add_u32 v11, 61440, v5
    v_lshlrev_b32 v7, 4, v2
    s_mov_b32 s25, 0
    s_mov_b32 s26, 0
    s_mul_i32 s27, s21, 102400
    s_add_u32 s27, s27, s26
    s_add_u32 s27, s27, 25165824
    s_add_u32 s32, s27, 0
    s_add_u32 s33, s27, 20480
    s_add_u32 s34, s27, 40960
    s_add_u32 s35, s27, 61440
    s_add_u32 s36, s27, 81920
    v_accvgpr_write_b32 a0, 0
    v_accvgpr_write_b32 a1, 0
    v_accvgpr_write_b32 a2, 0
    v_accvgpr_write_b32 a3, 0
    v_accvgpr_write_b32 a4, 0
    v_accvgpr_write_b32 a5, 0
    v_accvgpr_write_b32 a6, 0
    v_accvgpr_write_b32 a7, 0
    v_accvgpr_write_b32 a8, 0
    v_accvgpr_write_b32 a9, 0
    v_accvgpr_write_b32 a10, 0
    v_accvgpr_write_b32 a11, 0
    v_accvgpr_write_b32 a12, 0
    v_accvgpr_write_b32 a13, 0
    v_accvgpr_write_b32 a14, 0
    v_accvgpr_write_b32 a15, 0
    v_accvgpr_write_b32 a16, 0
    v_accvgpr_write_b32 a17, 0
    v_accvgpr_write_b32 a18, 0
    v_accvgpr_write_b32 a19, 0
    v_accvgpr_write_b32 a20, 0
    v_accvgpr_write_b32 a21, 0
    v_accvgpr_write_b32 a22, 0
    v_accvgpr_write_b32 a23, 0
    v_accvgpr_write_b32 a24, 0
    v_accvgpr_write_b32 a25, 0
    v_accvgpr_write_b32 a26, 0
    v_accvgpr_write_b32 a27, 0
    v_accvgpr_write_b32 a28, 0
    v_accvgpr_write_b32 a29, 0
    v_accvgpr_write_b32 a30, 0
    v_accvgpr_write_b32 a31, 0
    v_accvgpr_write_b32 a32, 0
    v_accvgpr_write_b32 a33, 0
    v_accvgpr_write_b32 a34, 0
    v_accvgpr_write_b32 a35, 0
    v_accvgpr_write_b32 a36, 0
    v_accvgpr_write_b32 a37, 0
    v_accvgpr_write_b32 a38, 0
    v_accvgpr_write_b32 a39, 0
    v_accvgpr_write_b32 a40, 0
    v_accvgpr_write_b32 a41, 0
    v_accvgpr_write_b32 a42, 0
    v_accvgpr_write_b32 a43, 0
    v_accvgpr_write_b32 a44, 0
    v_accvgpr_write_b32 a45, 0
    v_accvgpr_write_b32 a46, 0
    v_accvgpr_write_b32 a47, 0
    v_accvgpr_write_b32 a48, 0
    v_accvgpr_write_b32 a49, 0
    v_accvgpr_write_b32 a50, 0
    v_accvgpr_write_b32 a51, 0
    v_accvgpr_write_b32 a52, 0
    v_accvgpr_write_b32 a53, 0
    v_accvgpr_write_b32 a54, 0
    v_accvgpr_write_b32 a55, 0
    v_accvgpr_write_b32 a56, 0
    v_accvgpr_write_b32 a57, 0
    v_accvgpr_write_b32 a58, 0
    v_accvgpr_write_b32 a59, 0
    v_accvgpr_write_b32 a60, 0
    v_accvgpr_write_b32 a61, 0
    v_accvgpr_write_b32 a62, 0
    v_accvgpr_write_b32 a63, 0
    v_accvgpr_write_b32 a64, 0
    v_accvgpr_write_b32 a65, 0
    v_accvgpr_write_b32 a66, 0
    v_accvgpr_write_b32 a67, 0
    v_accvgpr_write_b32 a68, 0
    v_accvgpr_write_b32 a69, 0
    v_accvgpr_write_b32 a70, 0
    v_accvgpr_write_b32 a71, 0
    v_accvgpr_write_b32 a72, 0
    v_accvgpr_write_b32 a73, 0
    v_accvgpr_write_b32 a74, 0
    v_accvgpr_write_b32 a75, 0
    v_accvgpr_write_b32 a76, 0
    v_accvgpr_write_b32 a77, 0
    v_accvgpr_write_b32 a78, 0
    v_accvgpr_write_b32 a79, 0
    s_cmp_ge_u32 s23, 640
    s_cbranch_scc1 qkv_a_kernel_nrm
    buffer_load_dwordx4 v[16:19], v8, s[8:11], s25 offen
    buffer_load_dwordx4 v[20:23], v9, s[8:11], s25 offen
    buffer_load_dwordx4 v[24:27], v10, s[8:11], s25 offen
    buffer_load_dwordx4 v[28:31], v11, s[8:11], s25 offen
    buffer_load_dwordx4 v[32:35], v7, s[8:11], s32 offen
    buffer_load_dwordx4 v[36:39], v7, s[8:11], s33 offen
    buffer_load_dwordx4 v[40:43], v7, s[8:11], s34 offen
    buffer_load_dwordx4 v[44:47], v7, s[8:11], s35 offen
    buffer_load_dwordx4 v[48:51], v7, s[8:11], s36 offen
    s_mov_b32 s28, 10
qkv_a_kernel_loop0:
    s_add_u32 s25, s25, 64
    s_add_u32 s32, s32, 1024
    s_add_u32 s33, s33, 1024
    s_add_u32 s34, s34, 1024
    s_add_u32 s35, s35, 1024
    s_add_u32 s36, s36, 1024
    buffer_load_dwordx4 v[52:55], v8, s[8:11], s25 offen
    buffer_load_dwordx4 v[56:59], v9, s[8:11], s25 offen
    buffer_load_dwordx4 v[60:63], v10, s[8:11], s25 offen
    buffer_load_dwordx4 v[64:67], v11, s[8:11], s25 offen
    buffer_load_dwordx4 v[68:71], v7, s[8:11], s32 offen
    buffer_load_dwordx4 v[72:75], v7, s[8:11], s33 offen
    buffer_load_dwordx4 v[76:79], v7, s[8:11], s34 offen
    buffer_load_dwordx4 v[80:83], v7, s[8:11], s35 offen
    buffer_load_dwordx4 v[84:87], v7, s[8:11], s36 offen
    s_waitcnt vmcnt(9)
    v_mfma_f32_16x16x32_bf16 a[0:3], v[32:35], v[16:19], a[0:3]
    v_mfma_f32_16x16x32_bf16 a[20:23], v[32:35], v[20:23], a[20:23]
    v_mfma_f32_16x16x32_bf16 a[40:43], v[32:35], v[24:27], a[40:43]
    v_mfma_f32_16x16x32_bf16 a[60:63], v[32:35], v[28:31], a[60:63]
    v_mfma_f32_16x16x32_bf16 a[4:7], v[36:39], v[16:19], a[4:7]
    v_mfma_f32_16x16x32_bf16 a[24:27], v[36:39], v[20:23], a[24:27]
    v_mfma_f32_16x16x32_bf16 a[44:47], v[36:39], v[24:27], a[44:47]
    v_mfma_f32_16x16x32_bf16 a[64:67], v[36:39], v[28:31], a[64:67]
    v_mfma_f32_16x16x32_bf16 a[8:11], v[40:43], v[16:19], a[8:11]
    v_mfma_f32_16x16x32_bf16 a[28:31], v[40:43], v[20:23], a[28:31]
    v_mfma_f32_16x16x32_bf16 a[48:51], v[40:43], v[24:27], a[48:51]
    v_mfma_f32_16x16x32_bf16 a[68:71], v[40:43], v[28:31], a[68:71]
    v_mfma_f32_16x16x32_bf16 a[12:15], v[44:47], v[16:19], a[12:15]
    v_mfma_f32_16x16x32_bf16 a[32:35], v[44:47], v[20:23], a[32:35]
    v_mfma_f32_16x16x32_bf16 a[52:55], v[44:47], v[24:27], a[52:55]
    v_mfma_f32_16x16x32_bf16 a[72:75], v[44:47], v[28:31], a[72:75]
    v_mfma_f32_16x16x32_bf16 a[16:19], v[48:51], v[16:19], a[16:19]
    v_mfma_f32_16x16x32_bf16 a[36:39], v[48:51], v[20:23], a[36:39]
    v_mfma_f32_16x16x32_bf16 a[56:59], v[48:51], v[24:27], a[56:59]
    v_mfma_f32_16x16x32_bf16 a[76:79], v[48:51], v[28:31], a[76:79]
    s_sub_u32 s28, s28, 1
    s_cmp_eq_u32 s28, 0
    s_cbranch_scc1 qkv_a_kernel_loop0_last
    s_add_u32 s25, s25, 64
    s_add_u32 s32, s32, 1024
    s_add_u32 s33, s33, 1024
    s_add_u32 s34, s34, 1024
    s_add_u32 s35, s35, 1024
    s_add_u32 s36, s36, 1024
    buffer_load_dwordx4 v[16:19], v8, s[8:11], s25 offen
    buffer_load_dwordx4 v[20:23], v9, s[8:11], s25 offen
    buffer_load_dwordx4 v[24:27], v10, s[8:11], s25 offen
    buffer_load_dwordx4 v[28:31], v11, s[8:11], s25 offen
    buffer_load_dwordx4 v[32:35], v7, s[8:11], s32 offen
    buffer_load_dwordx4 v[36:39], v7, s[8:11], s33 offen
    buffer_load_dwordx4 v[40:43], v7, s[8:11], s34 offen
    buffer_load_dwordx4 v[44:47], v7, s[8:11], s35 offen
    buffer_load_dwordx4 v[48:51], v7, s[8:11], s36 offen
    s_waitcnt vmcnt(9)
    v_mfma_f32_16x16x32_bf16 a[0:3], v[68:71], v[52:55], a[0:3]
    v_mfma_f32_16x16x32_bf16 a[20:23], v[68:71], v[56:59], a[20:23]
    v_mfma_f32_16x16x32_bf16 a[40:43], v[68:71], v[60:63], a[40:43]
    v_mfma_f32_16x16x32_bf16 a[60:63], v[68:71], v[64:67], a[60:63]
    v_mfma_f32_16x16x32_bf16 a[4:7], v[72:75], v[52:55], a[4:7]
    v_mfma_f32_16x16x32_bf16 a[24:27], v[72:75], v[56:59], a[24:27]
    v_mfma_f32_16x16x32_bf16 a[44:47], v[72:75], v[60:63], a[44:47]
    v_mfma_f32_16x16x32_bf16 a[64:67], v[72:75], v[64:67], a[64:67]
    v_mfma_f32_16x16x32_bf16 a[8:11], v[76:79], v[52:55], a[8:11]
    v_mfma_f32_16x16x32_bf16 a[28:31], v[76:79], v[56:59], a[28:31]
    v_mfma_f32_16x16x32_bf16 a[48:51], v[76:79], v[60:63], a[48:51]
    v_mfma_f32_16x16x32_bf16 a[68:71], v[76:79], v[64:67], a[68:71]
    v_mfma_f32_16x16x32_bf16 a[12:15], v[80:83], v[52:55], a[12:15]
    v_mfma_f32_16x16x32_bf16 a[32:35], v[80:83], v[56:59], a[32:35]
    v_mfma_f32_16x16x32_bf16 a[52:55], v[80:83], v[60:63], a[52:55]
    v_mfma_f32_16x16x32_bf16 a[72:75], v[80:83], v[64:67], a[72:75]
    v_mfma_f32_16x16x32_bf16 a[16:19], v[84:87], v[52:55], a[16:19]
    v_mfma_f32_16x16x32_bf16 a[36:39], v[84:87], v[56:59], a[36:39]
    v_mfma_f32_16x16x32_bf16 a[56:59], v[84:87], v[60:63], a[56:59]
    v_mfma_f32_16x16x32_bf16 a[76:79], v[84:87], v[64:67], a[76:79]
    s_branch qkv_a_kernel_loop0
qkv_a_kernel_loop0_last:
    s_waitcnt vmcnt(0)
    v_mfma_f32_16x16x32_bf16 a[0:3], v[68:71], v[52:55], a[0:3]
    v_mfma_f32_16x16x32_bf16 a[20:23], v[68:71], v[56:59], a[20:23]
    v_mfma_f32_16x16x32_bf16 a[40:43], v[68:71], v[60:63], a[40:43]
    v_mfma_f32_16x16x32_bf16 a[60:63], v[68:71], v[64:67], a[60:63]
    v_mfma_f32_16x16x32_bf16 a[4:7], v[72:75], v[52:55], a[4:7]
    v_mfma_f32_16x16x32_bf16 a[24:27], v[72:75], v[56:59], a[24:27]
    v_mfma_f32_16x16x32_bf16 a[44:47], v[72:75], v[60:63], a[44:47]
    v_mfma_f32_16x16x32_bf16 a[64:67], v[72:75], v[64:67], a[64:67]
    v_mfma_f32_16x16x32_bf16 a[8:11], v[76:79], v[52:55], a[8:11]
    v_mfma_f32_16x16x32_bf16 a[28:31], v[76:79], v[56:59], a[28:31]
    v_mfma_f32_16x16x32_bf16 a[48:51], v[76:79], v[60:63], a[48:51]
    v_mfma_f32_16x16x32_bf16 a[68:71], v[76:79], v[64:67], a[68:71]
    v_mfma_f32_16x16x32_bf16 a[12:15], v[80:83], v[52:55], a[12:15]
    v_mfma_f32_16x16x32_bf16 a[32:35], v[80:83], v[56:59], a[32:35]
    v_mfma_f32_16x16x32_bf16 a[52:55], v[80:83], v[60:63], a[52:55]
    v_mfma_f32_16x16x32_bf16 a[72:75], v[80:83], v[64:67], a[72:75]
    v_mfma_f32_16x16x32_bf16 a[16:19], v[84:87], v[52:55], a[16:19]
    v_mfma_f32_16x16x32_bf16 a[36:39], v[84:87], v[56:59], a[36:39]
    v_mfma_f32_16x16x32_bf16 a[56:59], v[84:87], v[60:63], a[56:59]
    v_mfma_f32_16x16x32_bf16 a[76:79], v[84:87], v[64:67], a[76:79]
    s_nop 7
    s_nop 7
    s_mov_b32 s24, 1280
    s_lshl_b32 s29, s23, 1
    s_add_u32 s29, s29, 8388608
    v_add_u32 v5, s22, v3
    v_mul_lo_u32 v5, v5, s24
    v_lshlrev_b32 v6, 3, v4
    v_add3_u32 v5, v5, v6, s29
    v_accvgpr_read_b32 v92, a0
    v_accvgpr_read_b32 v93, a1
    v_accvgpr_read_b32 v94, a2
    v_accvgpr_read_b32 v95, a3
    v_cvt_pk_bf16_f32 v96, v92, v93
    v_cvt_pk_bf16_f32 v97, v94, v95
    v_add_u32 v6, 0, v5
    buffer_store_dwordx2 v[96:97], v6, s[8:11], 0 offen
    v_accvgpr_read_b32 v92, a4
    v_accvgpr_read_b32 v93, a5
    v_accvgpr_read_b32 v94, a6
    v_accvgpr_read_b32 v95, a7
    v_cvt_pk_bf16_f32 v96, v92, v93
    v_cvt_pk_bf16_f32 v97, v94, v95
    v_add_u32 v6, 32, v5
    buffer_store_dwordx2 v[96:97], v6, s[8:11], 0 offen
    v_accvgpr_read_b32 v92, a8
    v_accvgpr_read_b32 v93, a9
    v_accvgpr_read_b32 v94, a10
    v_accvgpr_read_b32 v95, a11
    v_cvt_pk_bf16_f32 v96, v92, v93
    v_cvt_pk_bf16_f32 v97, v94, v95
    v_add_u32 v6, 64, v5
    buffer_store_dwordx2 v[96:97], v6, s[8:11], 0 offen
    v_accvgpr_read_b32 v92, a12
    v_accvgpr_read_b32 v93, a13
    v_accvgpr_read_b32 v94, a14
    v_accvgpr_read_b32 v95, a15
    v_cvt_pk_bf16_f32 v96, v92, v93
    v_cvt_pk_bf16_f32 v97, v94, v95
    v_add_u32 v6, 96, v5
    buffer_store_dwordx2 v[96:97], v6, s[8:11], 0 offen
    v_accvgpr_read_b32 v92, a16
    v_accvgpr_read_b32 v93, a17
    v_accvgpr_read_b32 v94, a18
    v_accvgpr_read_b32 v95, a19
    v_cvt_pk_bf16_f32 v96, v92, v93
    v_cvt_pk_bf16_f32 v97, v94, v95
    v_add_u32 v6, 128, v5
    buffer_store_dwordx2 v[96:97], v6, s[8:11], 0 offen
    v_accvgpr_read_b32 v92, a20
    v_accvgpr_read_b32 v93, a21
    v_accvgpr_read_b32 v94, a22
    v_accvgpr_read_b32 v95, a23
    v_cvt_pk_bf16_f32 v96, v92, v93
    v_cvt_pk_bf16_f32 v97, v94, v95
    v_add_u32 v6, 20480, v5
    buffer_store_dwordx2 v[96:97], v6, s[8:11], 0 offen
    v_accvgpr_read_b32 v92, a24
    v_accvgpr_read_b32 v93, a25
    v_accvgpr_read_b32 v94, a26
    v_accvgpr_read_b32 v95, a27
    v_cvt_pk_bf16_f32 v96, v92, v93
    v_cvt_pk_bf16_f32 v97, v94, v95
    v_add_u32 v6, 20512, v5
    buffer_store_dwordx2 v[96:97], v6, s[8:11], 0 offen
    v_accvgpr_read_b32 v92, a28
    v_accvgpr_read_b32 v93, a29
    v_accvgpr_read_b32 v94, a30
    v_accvgpr_read_b32 v95, a31
    v_cvt_pk_bf16_f32 v96, v92, v93
    v_cvt_pk_bf16_f32 v97, v94, v95
    v_add_u32 v6, 20544, v5
    buffer_store_dwordx2 v[96:97], v6, s[8:11], 0 offen
    v_accvgpr_read_b32 v92, a32
    v_accvgpr_read_b32 v93, a33
    v_accvgpr_read_b32 v94, a34
    v_accvgpr_read_b32 v95, a35
    v_cvt_pk_bf16_f32 v96, v92, v93
    v_cvt_pk_bf16_f32 v97, v94, v95
    v_add_u32 v6, 20576, v5
    buffer_store_dwordx2 v[96:97], v6, s[8:11], 0 offen
    v_accvgpr_read_b32 v92, a36
    v_accvgpr_read_b32 v93, a37
    v_accvgpr_read_b32 v94, a38
    v_accvgpr_read_b32 v95, a39
    v_cvt_pk_bf16_f32 v96, v92, v93
    v_cvt_pk_bf16_f32 v97, v94, v95
    v_add_u32 v6, 20608, v5
    buffer_store_dwordx2 v[96:97], v6, s[8:11], 0 offen
    v_accvgpr_read_b32 v92, a40
    v_accvgpr_read_b32 v93, a41
    v_accvgpr_read_b32 v94, a42
    v_accvgpr_read_b32 v95, a43
    v_cvt_pk_bf16_f32 v96, v92, v93
    v_cvt_pk_bf16_f32 v97, v94, v95
    v_add_u32 v6, 40960, v5
    buffer_store_dwordx2 v[96:97], v6, s[8:11], 0 offen
    v_accvgpr_read_b32 v92, a44
    v_accvgpr_read_b32 v93, a45
    v_accvgpr_read_b32 v94, a46
    v_accvgpr_read_b32 v95, a47
    v_cvt_pk_bf16_f32 v96, v92, v93
    v_cvt_pk_bf16_f32 v97, v94, v95
    v_add_u32 v6, 40992, v5
    buffer_store_dwordx2 v[96:97], v6, s[8:11], 0 offen
    v_accvgpr_read_b32 v92, a48
    v_accvgpr_read_b32 v93, a49
    v_accvgpr_read_b32 v94, a50
    v_accvgpr_read_b32 v95, a51
    v_cvt_pk_bf16_f32 v96, v92, v93
    v_cvt_pk_bf16_f32 v97, v94, v95
    v_add_u32 v6, 41024, v5
    buffer_store_dwordx2 v[96:97], v6, s[8:11], 0 offen
    v_accvgpr_read_b32 v92, a52
    v_accvgpr_read_b32 v93, a53
    v_accvgpr_read_b32 v94, a54
    v_accvgpr_read_b32 v95, a55
    v_cvt_pk_bf16_f32 v96, v92, v93
    v_cvt_pk_bf16_f32 v97, v94, v95
    v_add_u32 v6, 41056, v5
    buffer_store_dwordx2 v[96:97], v6, s[8:11], 0 offen
    v_accvgpr_read_b32 v92, a56
    v_accvgpr_read_b32 v93, a57
    v_accvgpr_read_b32 v94, a58
    v_accvgpr_read_b32 v95, a59
    v_cvt_pk_bf16_f32 v96, v92, v93
    v_cvt_pk_bf16_f32 v97, v94, v95
    v_add_u32 v6, 41088, v5
    buffer_store_dwordx2 v[96:97], v6, s[8:11], 0 offen
    v_accvgpr_read_b32 v92, a60
    v_accvgpr_read_b32 v93, a61
    v_accvgpr_read_b32 v94, a62
    v_accvgpr_read_b32 v95, a63
    v_cvt_pk_bf16_f32 v96, v92, v93
    v_cvt_pk_bf16_f32 v97, v94, v95
    v_add_u32 v6, 61440, v5
    buffer_store_dwordx2 v[96:97], v6, s[8:11], 0 offen
    v_accvgpr_read_b32 v92, a64
    v_accvgpr_read_b32 v93, a65
    v_accvgpr_read_b32 v94, a66
    v_accvgpr_read_b32 v95, a67
    v_cvt_pk_bf16_f32 v96, v92, v93
    v_cvt_pk_bf16_f32 v97, v94, v95
    v_add_u32 v6, 61472, v5
    buffer_store_dwordx2 v[96:97], v6, s[8:11], 0 offen
    v_accvgpr_read_b32 v92, a68
    v_accvgpr_read_b32 v93, a69
    v_accvgpr_read_b32 v94, a70
    v_accvgpr_read_b32 v95, a71
    v_cvt_pk_bf16_f32 v96, v92, v93
    v_cvt_pk_bf16_f32 v97, v94, v95
    v_add_u32 v6, 61504, v5
    buffer_store_dwordx2 v[96:97], v6, s[8:11], 0 offen
    v_accvgpr_read_b32 v92, a72
    v_accvgpr_read_b32 v93, a73
    v_accvgpr_read_b32 v94, a74
    v_accvgpr_read_b32 v95, a75
    v_cvt_pk_bf16_f32 v96, v92, v93
    v_cvt_pk_bf16_f32 v97, v94, v95
    v_add_u32 v6, 61536, v5
    buffer_store_dwordx2 v[96:97], v6, s[8:11], 0 offen
    v_accvgpr_read_b32 v92, a76
    v_accvgpr_read_b32 v93, a77
    v_accvgpr_read_b32 v94, a78
    v_accvgpr_read_b32 v95, a79
    v_cvt_pk_bf16_f32 v96, v92, v93
    v_cvt_pk_bf16_f32 v97, v94, v95
    v_add_u32 v6, 61568, v5
    buffer_store_dwordx2 v[96:97], v6, s[8:11], 0 offen
    s_branch qkv_a_kernel_end
qkv_a_kernel_nrm:
    buffer_load_dwordx4 v[16:19], v8, s[8:11], s25 offen
    buffer_load_dwordx4 v[20:23], v9, s[8:11], s25 offen
    buffer_load_dwordx4 v[24:27], v10, s[8:11], s25 offen
    buffer_load_dwordx4 v[28:31], v11, s[8:11], s25 offen
    buffer_load_dwordx4 v[32:35], v7, s[8:11], s32 offen
    buffer_load_dwordx4 v[36:39], v7, s[8:11], s33 offen
    buffer_load_dwordx4 v[40:43], v7, s[8:11], s34 offen
    buffer_load_dwordx4 v[44:47], v7, s[8:11], s35 offen
    buffer_load_dwordx4 v[48:51], v7, s[8:11], s36 offen
    s_mov_b32 s28, 10
qkv_a_kernel_loop1:
    s_add_u32 s25, s25, 64
    s_add_u32 s32, s32, 1024
    s_add_u32 s33, s33, 1024
    s_add_u32 s34, s34, 1024
    s_add_u32 s35, s35, 1024
    s_add_u32 s36, s36, 1024
    buffer_load_dwordx4 v[52:55], v8, s[8:11], s25 offen
    buffer_load_dwordx4 v[56:59], v9, s[8:11], s25 offen
    buffer_load_dwordx4 v[60:63], v10, s[8:11], s25 offen
    buffer_load_dwordx4 v[64:67], v11, s[8:11], s25 offen
    buffer_load_dwordx4 v[68:71], v7, s[8:11], s32 offen
    buffer_load_dwordx4 v[72:75], v7, s[8:11], s33 offen
    buffer_load_dwordx4 v[76:79], v7, s[8:11], s34 offen
    buffer_load_dwordx4 v[80:83], v7, s[8:11], s35 offen
    buffer_load_dwordx4 v[84:87], v7, s[8:11], s36 offen
    s_waitcnt vmcnt(9)
    v_mfma_f32_16x16x32_bf16 a[0:3], v[16:19], v[32:35], a[0:3]
    v_mfma_f32_16x16x32_bf16 a[20:23], v[20:23], v[32:35], a[20:23]
    v_mfma_f32_16x16x32_bf16 a[40:43], v[24:27], v[32:35], a[40:43]
    v_mfma_f32_16x16x32_bf16 a[60:63], v[28:31], v[32:35], a[60:63]
    v_mfma_f32_16x16x32_bf16 a[4:7], v[16:19], v[36:39], a[4:7]
    v_mfma_f32_16x16x32_bf16 a[24:27], v[20:23], v[36:39], a[24:27]
    v_mfma_f32_16x16x32_bf16 a[44:47], v[24:27], v[36:39], a[44:47]
    v_mfma_f32_16x16x32_bf16 a[64:67], v[28:31], v[36:39], a[64:67]
    v_mfma_f32_16x16x32_bf16 a[8:11], v[16:19], v[40:43], a[8:11]
    v_mfma_f32_16x16x32_bf16 a[28:31], v[20:23], v[40:43], a[28:31]
    v_mfma_f32_16x16x32_bf16 a[48:51], v[24:27], v[40:43], a[48:51]
    v_mfma_f32_16x16x32_bf16 a[68:71], v[28:31], v[40:43], a[68:71]
    v_mfma_f32_16x16x32_bf16 a[12:15], v[16:19], v[44:47], a[12:15]
    v_mfma_f32_16x16x32_bf16 a[32:35], v[20:23], v[44:47], a[32:35]
    v_mfma_f32_16x16x32_bf16 a[52:55], v[24:27], v[44:47], a[52:55]
    v_mfma_f32_16x16x32_bf16 a[72:75], v[28:31], v[44:47], a[72:75]
    v_mfma_f32_16x16x32_bf16 a[16:19], v[16:19], v[48:51], a[16:19]
    v_mfma_f32_16x16x32_bf16 a[36:39], v[20:23], v[48:51], a[36:39]
    v_mfma_f32_16x16x32_bf16 a[56:59], v[24:27], v[48:51], a[56:59]
    v_mfma_f32_16x16x32_bf16 a[76:79], v[28:31], v[48:51], a[76:79]
    s_sub_u32 s28, s28, 1
    s_cmp_eq_u32 s28, 0
    s_cbranch_scc1 qkv_a_kernel_loop1_last
    s_add_u32 s25, s25, 64
    s_add_u32 s32, s32, 1024
    s_add_u32 s33, s33, 1024
    s_add_u32 s34, s34, 1024
    s_add_u32 s35, s35, 1024
    s_add_u32 s36, s36, 1024
    buffer_load_dwordx4 v[16:19], v8, s[8:11], s25 offen
    buffer_load_dwordx4 v[20:23], v9, s[8:11], s25 offen
    buffer_load_dwordx4 v[24:27], v10, s[8:11], s25 offen
    buffer_load_dwordx4 v[28:31], v11, s[8:11], s25 offen
    buffer_load_dwordx4 v[32:35], v7, s[8:11], s32 offen
    buffer_load_dwordx4 v[36:39], v7, s[8:11], s33 offen
    buffer_load_dwordx4 v[40:43], v7, s[8:11], s34 offen
    buffer_load_dwordx4 v[44:47], v7, s[8:11], s35 offen
    buffer_load_dwordx4 v[48:51], v7, s[8:11], s36 offen
    s_waitcnt vmcnt(9)
    v_mfma_f32_16x16x32_bf16 a[0:3], v[52:55], v[68:71], a[0:3]
    v_mfma_f32_16x16x32_bf16 a[20:23], v[56:59], v[68:71], a[20:23]
    v_mfma_f32_16x16x32_bf16 a[40:43], v[60:63], v[68:71], a[40:43]
    v_mfma_f32_16x16x32_bf16 a[60:63], v[64:67], v[68:71], a[60:63]
    v_mfma_f32_16x16x32_bf16 a[4:7], v[52:55], v[72:75], a[4:7]
    v_mfma_f32_16x16x32_bf16 a[24:27], v[56:59], v[72:75], a[24:27]
    v_mfma_f32_16x16x32_bf16 a[44:47], v[60:63], v[72:75], a[44:47]
    v_mfma_f32_16x16x32_bf16 a[64:67], v[64:67], v[72:75], a[64:67]
    v_mfma_f32_16x16x32_bf16 a[8:11], v[52:55], v[76:79], a[8:11]
    v_mfma_f32_16x16x32_bf16 a[28:31], v[56:59], v[76:79], a[28:31]
    v_mfma_f32_16x16x32_bf16 a[48:51], v[60:63], v[76:79], a[48:51]
    v_mfma_f32_16x16x32_bf16 a[68:71], v[64:67], v[76:79], a[68:71]
    v_mfma_f32_16x16x32_bf16 a[12:15], v[52:55], v[80:83], a[12:15]
    v_mfma_f32_16x16x32_bf16 a[32:35], v[56:59], v[80:83], a[32:35]
    v_mfma_f32_16x16x32_bf16 a[52:55], v[60:63], v[80:83], a[52:55]
    v_mfma_f32_16x16x32_bf16 a[72:75], v[64:67], v[80:83], a[72:75]
    v_mfma_f32_16x16x32_bf16 a[16:19], v[52:55], v[84:87], a[16:19]
    v_mfma_f32_16x16x32_bf16 a[36:39], v[56:59], v[84:87], a[36:39]
    v_mfma_f32_16x16x32_bf16 a[56:59], v[60:63], v[84:87], a[56:59]
    v_mfma_f32_16x16x32_bf16 a[76:79], v[64:67], v[84:87], a[76:79]
    s_branch qkv_a_kernel_loop1
qkv_a_kernel_loop1_last:
    s_waitcnt vmcnt(0)
    v_mfma_f32_16x16x32_bf16 a[0:3], v[52:55], v[68:71], a[0:3]
    v_mfma_f32_16x16x32_bf16 a[20:23], v[56:59], v[68:71], a[20:23]
    v_mfma_f32_16x16x32_bf16 a[40:43], v[60:63], v[68:71], a[40:43]
    v_mfma_f32_16x16x32_bf16 a[60:63], v[64:67], v[68:71], a[60:63]
    v_mfma_f32_16x16x32_bf16 a[4:7], v[52:55], v[72:75], a[4:7]
    v_mfma_f32_16x16x32_bf16 a[24:27], v[56:59], v[72:75], a[24:27]
    v_mfma_f32_16x16x32_bf16 a[44:47], v[60:63], v[72:75], a[44:47]
    v_mfma_f32_16x16x32_bf16 a[64:67], v[64:67], v[72:75], a[64:67]
    v_mfma_f32_16x16x32_bf16 a[8:11], v[52:55], v[76:79], a[8:11]
    v_mfma_f32_16x16x32_bf16 a[28:31], v[56:59], v[76:79], a[28:31]
    v_mfma_f32_16x16x32_bf16 a[48:51], v[60:63], v[76:79], a[48:51]
    v_mfma_f32_16x16x32_bf16 a[68:71], v[64:67], v[76:79], a[68:71]
    v_mfma_f32_16x16x32_bf16 a[12:15], v[52:55], v[80:83], a[12:15]
    v_mfma_f32_16x16x32_bf16 a[32:35], v[56:59], v[80:83], a[32:35]
    v_mfma_f32_16x16x32_bf16 a[52:55], v[60:63], v[80:83], a[52:55]
    v_mfma_f32_16x16x32_bf16 a[72:75], v[64:67], v[80:83], a[72:75]
    v_mfma_f32_16x16x32_bf16 a[16:19], v[52:55], v[84:87], a[16:19]
    v_mfma_f32_16x16x32_bf16 a[36:39], v[56:59], v[84:87], a[36:39]
    v_mfma_f32_16x16x32_bf16 a[56:59], v[60:63], v[84:87], a[56:59]
    v_mfma_f32_16x16x32_bf16 a[76:79], v[64:67], v[84:87], a[76:79]
    s_nop 7
    s_nop 7
    s_sub_u32 s29, s23, 640
    v_add_u32 v5, s29, v3
    v_lshlrev_b32 v5, 11, v5
    v_lshlrev_b32 v6, 2, v4
    v_add3_u32 v5, v5, v6, s22
    v_lshlrev_b32 v5, 1, v5
    v_add_u32 v5, 12582912, v5
    v_accvgpr_read_b32 v92, a0
    v_accvgpr_read_b32 v93, a1
    v_accvgpr_read_b32 v94, a2
    v_accvgpr_read_b32 v95, a3
    v_cvt_pk_bf16_f32 v96, v92, v93
    v_cvt_pk_bf16_f32 v97, v94, v95
    v_add_u32 v6, 0, v5
    buffer_store_dwordx2 v[96:97], v6, s[8:11], 0 offen
    v_accvgpr_read_b32 v92, a4
    v_accvgpr_read_b32 v93, a5
    v_accvgpr_read_b32 v94, a6
    v_accvgpr_read_b32 v95, a7
    v_cvt_pk_bf16_f32 v96, v92, v93
    v_cvt_pk_bf16_f32 v97, v94, v95
    v_add_u32 v6, 65536, v5
    buffer_store_dwordx2 v[96:97], v6, s[8:11], 0 offen
    v_accvgpr_read_b32 v92, a8
    v_accvgpr_read_b32 v93, a9
    v_accvgpr_read_b32 v94, a10
    v_accvgpr_read_b32 v95, a11
    v_cvt_pk_bf16_f32 v96, v92, v93
    v_cvt_pk_bf16_f32 v97, v94, v95
    v_add_u32 v6, 131072, v5
    buffer_store_dwordx2 v[96:97], v6, s[8:11], 0 offen
    v_accvgpr_read_b32 v92, a12
    v_accvgpr_read_b32 v93, a13
    v_accvgpr_read_b32 v94, a14
    v_accvgpr_read_b32 v95, a15
    v_cvt_pk_bf16_f32 v96, v92, v93
    v_cvt_pk_bf16_f32 v97, v94, v95
    v_add_u32 v6, 196608, v5
    buffer_store_dwordx2 v[96:97], v6, s[8:11], 0 offen
    v_accvgpr_read_b32 v92, a16
    v_accvgpr_read_b32 v93, a17
    v_accvgpr_read_b32 v94, a18
    v_accvgpr_read_b32 v95, a19
    v_cvt_pk_bf16_f32 v96, v92, v93
    v_cvt_pk_bf16_f32 v97, v94, v95
    v_add_u32 v6, 262144, v5
    buffer_store_dwordx2 v[96:97], v6, s[8:11], 0 offen
    v_accvgpr_read_b32 v92, a20
    v_accvgpr_read_b32 v93, a21
    v_accvgpr_read_b32 v94, a22
    v_accvgpr_read_b32 v95, a23
    v_cvt_pk_bf16_f32 v96, v92, v93
    v_cvt_pk_bf16_f32 v97, v94, v95
    v_add_u32 v6, 32, v5
    buffer_store_dwordx2 v[96:97], v6, s[8:11], 0 offen
    v_accvgpr_read_b32 v92, a24
    v_accvgpr_read_b32 v93, a25
    v_accvgpr_read_b32 v94, a26
    v_accvgpr_read_b32 v95, a27
    v_cvt_pk_bf16_f32 v96, v92, v93
    v_cvt_pk_bf16_f32 v97, v94, v95
    v_add_u32 v6, 65568, v5
    buffer_store_dwordx2 v[96:97], v6, s[8:11], 0 offen
    v_accvgpr_read_b32 v92, a28
    v_accvgpr_read_b32 v93, a29
    v_accvgpr_read_b32 v94, a30
    v_accvgpr_read_b32 v95, a31
    v_cvt_pk_bf16_f32 v96, v92, v93
    v_cvt_pk_bf16_f32 v97, v94, v95
    v_add_u32 v6, 131104, v5
    buffer_store_dwordx2 v[96:97], v6, s[8:11], 0 offen
    v_accvgpr_read_b32 v92, a32
    v_accvgpr_read_b32 v93, a33
    v_accvgpr_read_b32 v94, a34
    v_accvgpr_read_b32 v95, a35
    v_cvt_pk_bf16_f32 v96, v92, v93
    v_cvt_pk_bf16_f32 v97, v94, v95
    v_add_u32 v6, 196640, v5
    buffer_store_dwordx2 v[96:97], v6, s[8:11], 0 offen
    v_accvgpr_read_b32 v92, a36
    v_accvgpr_read_b32 v93, a37
    v_accvgpr_read_b32 v94, a38
    v_accvgpr_read_b32 v95, a39
    v_cvt_pk_bf16_f32 v96, v92, v93
    v_cvt_pk_bf16_f32 v97, v94, v95
    v_add_u32 v6, 262176, v5
    buffer_store_dwordx2 v[96:97], v6, s[8:11], 0 offen
    v_accvgpr_read_b32 v92, a40
    v_accvgpr_read_b32 v93, a41
    v_accvgpr_read_b32 v94, a42
    v_accvgpr_read_b32 v95, a43
    v_cvt_pk_bf16_f32 v96, v92, v93
    v_cvt_pk_bf16_f32 v97, v94, v95
    v_add_u32 v6, 64, v5
    buffer_store_dwordx2 v[96:97], v6, s[8:11], 0 offen
    v_accvgpr_read_b32 v92, a44
    v_accvgpr_read_b32 v93, a45
    v_accvgpr_read_b32 v94, a46
    v_accvgpr_read_b32 v95, a47
    v_cvt_pk_bf16_f32 v96, v92, v93
    v_cvt_pk_bf16_f32 v97, v94, v95
    v_add_u32 v6, 65600, v5
    buffer_store_dwordx2 v[96:97], v6, s[8:11], 0 offen
    v_accvgpr_read_b32 v92, a48
    v_accvgpr_read_b32 v93, a49
    v_accvgpr_read_b32 v94, a50
    v_accvgpr_read_b32 v95, a51
    v_cvt_pk_bf16_f32 v96, v92, v93
    v_cvt_pk_bf16_f32 v97, v94, v95
    v_add_u32 v6, 131136, v5
    buffer_store_dwordx2 v[96:97], v6, s[8:11], 0 offen
    v_accvgpr_read_b32 v92, a52
    v_accvgpr_read_b32 v93, a53
    v_accvgpr_read_b32 v94, a54
    v_accvgpr_read_b32 v95, a55
    v_cvt_pk_bf16_f32 v96, v92, v93
    v_cvt_pk_bf16_f32 v97, v94, v95
    v_add_u32 v6, 196672, v5
    buffer_store_dwordx2 v[96:97], v6, s[8:11], 0 offen
    v_accvgpr_read_b32 v92, a56
    v_accvgpr_read_b32 v93, a57
    v_accvgpr_read_b32 v94, a58
    v_accvgpr_read_b32 v95, a59
    v_cvt_pk_bf16_f32 v96, v92, v93
    v_cvt_pk_bf16_f32 v97, v94, v95
    v_add_u32 v6, 262208, v5
    buffer_store_dwordx2 v[96:97], v6, s[8:11], 0 offen
    v_accvgpr_read_b32 v92, a60
    v_accvgpr_read_b32 v93, a61
    v_accvgpr_read_b32 v94, a62
    v_accvgpr_read_b32 v95, a63
    v_cvt_pk_bf16_f32 v96, v92, v93
    v_cvt_pk_bf16_f32 v97, v94, v95
    v_add_u32 v6, 96, v5
    buffer_store_dwordx2 v[96:97], v6, s[8:11], 0 offen
    v_accvgpr_read_b32 v92, a64
    v_accvgpr_read_b32 v93, a65
    v_accvgpr_read_b32 v94, a66
    v_accvgpr_read_b32 v95, a67
    v_cvt_pk_bf16_f32 v96, v92, v93
    v_cvt_pk_bf16_f32 v97, v94, v95
    v_add_u32 v6, 65632, v5
    buffer_store_dwordx2 v[96:97], v6, s[8:11], 0 offen
    v_accvgpr_read_b32 v92, a68
    v_accvgpr_read_b32 v93, a69
    v_accvgpr_read_b32 v94, a70
    v_accvgpr_read_b32 v95, a71
    v_cvt_pk_bf16_f32 v96, v92, v93
    v_cvt_pk_bf16_f32 v97, v94, v95
    v_add_u32 v6, 131168, v5
    buffer_store_dwordx2 v[96:97], v6, s[8:11], 0 offen
    v_accvgpr_read_b32 v92, a72
    v_accvgpr_read_b32 v93, a73
    v_accvgpr_read_b32 v94, a74
    v_accvgpr_read_b32 v95, a75
    v_cvt_pk_bf16_f32 v96, v92, v93
    v_cvt_pk_bf16_f32 v97, v94, v95
    v_add_u32 v6, 196704, v5
    buffer_store_dwordx2 v[96:97], v6, s[8:11], 0 offen
    v_accvgpr_read_b32 v92, a76
    v_accvgpr_read_b32 v93, a77
    v_accvgpr_read_b32 v94, a78
    v_accvgpr_read_b32 v95, a79
    v_cvt_pk_bf16_f32 v96, v92, v93
    v_cvt_pk_bf16_f32 v97, v94, v95
    v_add_u32 v6, 262240, v5
    buffer_store_dwordx2 v[96:97], v6, s[8:11], 0 offen
qkv_a_kernel_end:
    s_endpgm
.section .rodata,"a"
.p2align 6
.amdhsa_kernel qkv_a_kernel
  .amdhsa_next_free_vgpr 192
  .amdhsa_next_free_sgpr 64
  .amdhsa_accum_offset 112
  .amdhsa_group_segment_fixed_size 0
  .amdhsa_kernarg_size 104
  .amdhsa_user_sgpr_count 2
  .amdhsa_user_sgpr_kernarg_segment_ptr 1
  .amdhsa_system_sgpr_workgroup_id_x 1
.end_amdhsa_kernel
.text
.globl kvz_a1_kernel
.p2align 8
.type kvz_a1_kernel,@function
kvz_a1_kernel:
    v_lshrrev_b32 v1, 6, v0
    v_and_b32 v2, 63, v0
    s_nop 0
    v_readfirstlane_b32 s3, v1
    s_lshl_b32 s4, s2, 2
    s_add_u32 s4, s4, s3
    s_cmp_ge_u32 s4, 512
    s_cbranch_scc1 kvz_a1_kernel_end
    s_load_dwordx2 s[6:7], s[0:1], 96
    s_waitcnt lgkmcnt(0)
    s_mov_b32 s8, s6
    s_mov_b32 s9, s7
    s_mov_b32 s10, 268435456
    s_mov_b32 s11, 0x00020000
    s_lshr_b32 s5, s4, 4
    s_and_b32 s12, s4, 15
    s_mul_i32 s13, s5, 20
    v_and_b32 v3, 15, v2
    v_lshrrev_b32 v4, 4, v2
    s_lshl_b32 s14, s12, 7
    v_lshlrev_b32 v5, 3, v4
    v_add_u32 v5, s14, v5
    v_add_u32 v6, 0, v3
    v_min_u32 v8, 19, v6
    v_add_u32 v8, s13, v8
    v_lshlrev_b32 v8, 11, v8
    v_add_u32 v8, v8, v5
    v_lshlrev_b32 v8, 1, v8
    v_add_u32 v8, 12582912, v8
    v_add_u32 v10, 2621440, v8
    v_add_u32 v7, 16, v3
    v_min_u32 v9, 19, v7
    v_add_u32 v9, s13, v9
    v_lshlrev_b32 v9, 11, v9
    v_add_u32 v9, v9, v5
    v_lshlrev_b32 v9, 1, v9
    v_add_u32 v9, 12582912, v9
    v_add_u32 v11, 2621440, v9
    v_accvgpr_write_b32 a0, 0
    v_accvgpr_write_b32 a1, 0
    v_accvgpr_write_b32 a2, 0
    v_accvgpr_write_b32 a3, 0
    v_accvgpr_write_b32 a4, 0
    v_accvgpr_write_b32 a5, 0
    v_accvgpr_write_b32 a6, 0
    v_accvgpr_write_b32 a7, 0
    v_accvgpr_write_b32 a8, 0
    v_accvgpr_write_b32 a9, 0
    v_accvgpr_write_b32 a10, 0
    v_accvgpr_write_b32 a11, 0
    v_accvgpr_write_b32 a12, 0
    v_accvgpr_write_b32 a13, 0
    v_accvgpr_write_b32 a14, 0
    v_accvgpr_write_b32 a15, 0
    v_cmp_gt_u32 s[16:17], 20, v7
    v_cmp_eq_u32 s[18:19], 20, v7
    buffer_load_dwordx4 v[16:19], v8, s[8:11], 0 offen offset:0
    buffer_load_dwordx4 v[24:27], v10, s[8:11], 0 offen offset:0
    buffer_load_dwordx4 v[20:23], v9, s[8:11], 0 offen offset:0
    buffer_load_dwordx4 v[28:31], v11, s[8:11], 0 offen offset:0
    s_waitcnt vmcnt(0)
    v_lshlrev_b32 v32, 16, v16
    v_and_b32 v33, 0xffff0000, v16
    v_mul_f32 v36, 1.4426950408889634, v32
    v_exp_f32 v36, v36
    v_add_f32 v34, 1.0, v32
    v_cmp_lt_f32 vcc, 0, v32
    s_nop 1
    v_cndmask_b32 v34, v36, v34, vcc
    v_add_f32 v34, 0x358637bd, v34
    v_mul_f32 v36, 1.4426950408889634, v33
    v_exp_f32 v36, v36
    v_add_f32 v35, 1.0, v33
    v_cmp_lt_f32 vcc, 0, v33
    s_nop 1
    v_cndmask_b32 v35, v36, v35, vcc
    v_add_f32 v35, 0x358637bd, v35
    v_cvt_pk_bf16_f32 v16, v34, v35
    v_lshlrev_b32 v32, 16, v17
    v_and_b32 v33, 0xffff0000, v17
    v_mul_f32 v36, 1.4426950408889634, v32
    v_exp_f32 v36, v36
    v_add_f32 v34, 1.0, v32
    v_cmp_lt_f32 vcc, 0, v32
    s_nop 1
    v_cndmask_b32 v34, v36, v34, vcc
    v_add_f32 v34, 0x358637bd, v34
    v_mul_f32 v36, 1.4426950408889634, v33
    v_exp_f32 v36, v36
    v_add_f32 v35, 1.0, v33
    v_cmp_lt_f32 vcc, 0, v33
    s_nop 1
    v_cndmask_b32 v35, v36, v35, vcc
    v_add_f32 v35, 0x358637bd, v35
    v_cvt_pk_bf16_f32 v17, v34, v35
    v_lshlrev_b32 v32, 16, v18
    v_and_b32 v33, 0xffff0000, v18
    v_mul_f32 v36, 1.4426950408889634, v32
    v_exp_f32 v36, v36
    v_add_f32 v34, 1.0, v32
    v_cmp_lt_f32 vcc, 0, v32
    s_nop 1
    v_cndmask_b32 v34, v36, v34, vcc
    v_add_f32 v34, 0x358637bd, v34
    v_mul_f32 v36, 1.4426950408889634, v33
    v_exp_f32 v36, v36
    v_add_f32 v35, 1.0, v33
    v_cmp_lt_f32 vcc, 0, v33
    s_nop 1
    v_cndmask_b32 v35, v36, v35, vcc
    v_add_f32 v35, 0x358637bd, v35
    v_cvt_pk_bf16_f32 v18, v34, v35
    v_lshlrev_b32 v32, 16, v19
    v_and_b32 v33, 0xffff0000, v19
    v_mul_f32 v36, 1.4426950408889634, v32
    v_exp_f32 v36, v36
    v_add_f32 v34, 1.0, v32
    v_cmp_lt_f32 vcc, 0, v32
    s_nop 1
    v_cndmask_b32 v34, v36, v34, vcc
    v_add_f32 v34, 0x358637bd, v34
    v_mul_f32 v36, 1.4426950408889634, v33
    v_exp_f32 v36, v36
    v_add_f32 v35, 1.0, v33
    v_cmp_lt_f32 vcc, 0, v33
    s_nop 1
    v_cndmask_b32 v35, v36, v35, vcc
    v_add_f32 v35, 0x358637bd, v35
    v_cvt_pk_bf16_f32 v19, v34, v35
    v_lshlrev_b32 v32, 16, v20
    v_and_b32 v33, 0xffff0000, v20
    v_mul_f32 v36, 1.4426950408889634, v32
    v_exp_f32 v36, v36
    v_add_f32 v34, 1.0, v32
    v_cmp_lt_f32 vcc, 0, v32
    s_nop 1
    v_cndmask_b32 v34, v36, v34, vcc
    v_add_f32 v34, 0x358637bd, v34
    v_mul_f32 v36, 1.4426950408889634, v33
    v_exp_f32 v36, v36
    v_add_f32 v35, 1.0, v33
    v_cmp_lt_f32 vcc, 0, v33
    s_nop 1
    v_cndmask_b32 v35, v36, v35, vcc
    v_add_f32 v35, 0x358637bd, v35
    v_cvt_pk_bf16_f32 v20, v34, v35
    v_lshlrev_b32 v32, 16, v21
    v_and_b32 v33, 0xffff0000, v21
    v_mul_f32 v36, 1.4426950408889634, v32
    v_exp_f32 v36, v36
    v_add_f32 v34, 1.0, v32
    v_cmp_lt_f32 vcc, 0, v32
    s_nop 1
    v_cndmask_b32 v34, v36, v34, vcc
    v_add_f32 v34, 0x358637bd, v34
    v_mul_f32 v36, 1.4426950408889634, v33
    v_exp_f32 v36, v36
    v_add_f32 v35, 1.0, v33
    v_cmp_lt_f32 vcc, 0, v33
    s_nop 1
    v_cndmask_b32 v35, v36, v35, vcc
    v_add_f32 v35, 0x358637bd, v35
    v_cvt_pk_bf16_f32 v21, v34, v35
    v_lshlrev_b32 v32, 16, v22
    v_and_b32 v33, 0xffff0000, v22
    v_mul_f32 v36, 1.4426950408889634, v32
    v_exp_f32 v36, v36
    v_add_f32 v34, 1.0, v32
    v_cmp_lt_f32 vcc, 0, v32
    s_nop 1
    v_cndmask_b32 v34, v36, v34, vcc
    v_add_f32 v34, 0x358637bd, v34
    v_mul_f32 v36, 1.4426950408889634, v33
    v_exp_f32 v36, v36
    v_add_f32 v35, 1.0, v33
    v_cmp_lt_f32 vcc, 0, v33
    s_nop 1
    v_cndmask_b32 v35, v36, v35, vcc
    v_add_f32 v35, 0x358637bd, v35
    v_cvt_pk_bf16_f32 v22, v34, v35
    v_lshlrev_b32 v32, 16, v23
    v_and_b32 v33, 0xffff0000, v23
    v_mul_f32 v36, 1.4426950408889634, v32
    v_exp_f32 v36, v36
    v_add_f32 v34, 1.0, v32
    v_cmp_lt_f32 vcc, 0, v32
    s_nop 1
    v_cndmask_b32 v34, v36, v34, vcc
    v_add_f32 v34, 0x358637bd, v34
    v_mul_f32 v36, 1.4426950408889634, v33
    v_exp_f32 v36, v36
    v_add_f32 v35, 1.0, v33
    v_cmp_lt_f32 vcc, 0, v33
    s_nop 1
    v_cndmask_b32 v35, v36, v35, vcc
    v_add_f32 v35, 0x358637bd, v35
    v_cvt_pk_bf16_f32 v23, v34, v35
    v_mov_b32 v37, 0x3f803f80
    v_cndmask_b32 v20, 0, v20, s[16:17]
    v_cndmask_b32 v28, 0, v28, s[16:17]
    v_cndmask_b32 v28, v28, v37, s[18:19]
    v_cndmask_b32 v21, 0, v21, s[16:17]
    v_cndmask_b32 v29, 0, v29, s[16:17]
    v_cndmask_b32 v29, v29, v37, s[18:19]
    v_cndmask_b32 v22, 0, v22, s[16:17]
    v_cndmask_b32 v30, 0, v30, s[16:17]
    v_cndmask_b32 v30, v30, v37, s[18:19]
    v_cndmask_b32 v23, 0, v23, s[16:17]
    v_cndmask_b32 v31, 0, v31, s[16:17]
    v_cndmask_b32 v31, v31, v37, s[18:19]
    s_nop 1
    v_mfma_f32_16x16x32_bf16 a[0:3], v[24:27], v[16:19], a[0:3]
    v_mfma_f32_16x16x32_bf16 a[4:7], v[24:27], v[20:23], a[4:7]
    v_mfma_f32_16x16x32_bf16 a[8:11], v[28:31], v[16:19], a[8:11]
    v_mfma_f32_16x16x32_bf16 a[12:15], v[28:31], v[20:23], a[12:15]
    buffer_load_dwordx4 v[16:19], v8, s[8:11], 0 offen offset:64
    buffer_load_dwordx4 v[24:27], v10, s[8:11], 0 offen offset:64
    buffer_load_dwordx4 v[20:23], v9, s[8:11], 0 offen offset:64
    buffer_load_dwordx4 v[28:31], v11, s[8:11], 0 offen offset:64
    s_waitcnt vmcnt(0)
    v_lshlrev_b32 v32, 16, v16
    v_and_b32 v33, 0xffff0000, v16
    v_mul_f32 v36, 1.4426950408889634, v32
    v_exp_f32 v36, v36
    v_add_f32 v34, 1.0, v32
    v_cmp_lt_f32 vcc, 0, v32
    s_nop 1
    v_cndmask_b32 v34, v36, v34, vcc
    v_add_f32 v34, 0x358637bd, v34
    v_mul_f32 v36, 1.4426950408889634, v33
    v_exp_f32 v36, v36
    v_add_f32 v35, 1.0, v33
    v_cmp_lt_f32 vcc, 0, v33
    s_nop 1
    v_cndmask_b32 v35, v36, v35, vcc
    v_add_f32 v35, 0x358637bd, v35
    v_cvt_pk_bf16_f32 v16, v34, v35
    v_lshlrev_b32 v32, 16, v17
    v_and_b32 v33, 0xffff0000, v17
    v_mul_f32 v36, 1.4426950408889634, v32
    v_exp_f32 v36, v36
    v_add_f32 v34, 1.0, v32
    v_cmp_lt_f32 vcc, 0, v32
    s_nop 1
    v_cndmask_b32 v34, v36, v34, vcc
    v_add_f32 v34, 0x358637bd, v34
    v_mul_f32 v36, 1.4426950408889634, v33
    v_exp_f32 v36, v36
    v_add_f32 v35, 1.0, v33
    v_cmp_lt_f32 vcc, 0, v33
    s_nop 1
    v_cndmask_b32 v35, v36, v35, vcc
    v_add_f32 v35, 0x358637bd, v35
    v_cvt_pk_bf16_f32 v17, v34, v35
    v_lshlrev_b32 v32, 16, v18
    v_and_b32 v33, 0xffff0000, v18
    v_mul_f32 v36, 1.4426950408889634, v32
    v_exp_f32 v36, v36
    v_add_f32 v34, 1.0, v32
    v_cmp_lt_f32 vcc, 0, v32
    s_nop 1
    v_cndmask_b32 v34, v36, v34, vcc
    v_add_f32 v34, 0x358637bd, v34
    v_mul_f32 v36, 1.4426950408889634, v33
    v_exp_f32 v36, v36
    v_add_f32 v35, 1.0, v33
    v_cmp_lt_f32 vcc, 0, v33
    s_nop 1
    v_cndmask_b32 v35, v36, v35, vcc
    v_add_f32 v35, 0x358637bd, v35
    v_cvt_pk_bf16_f32 v18, v34, v35
    v_lshlrev_b32 v32, 16, v19
    v_and_b32 v33, 0xffff0000, v19
    v_mul_f32 v36, 1.4426950408889634, v32
    v_exp_f32 v36, v36
    v_add_f32 v34, 1.0, v32
    v_cmp_lt_f32 vcc, 0, v32
    s_nop 1
    v_cndmask_b32 v34, v36, v34, vcc
    v_add_f32 v34, 0x358637bd, v34
    v_mul_f32 v36, 1.4426950408889634, v33
    v_exp_f32 v36, v36
    v_add_f32 v35, 1.0, v33
    v_cmp_lt_f32 vcc, 0, v33
    s_nop 1
    v_cndmask_b32 v35, v36, v35, vcc
    v_add_f32 v35, 0x358637bd, v35
    v_cvt_pk_bf16_f32 v19, v34, v35
    v_lshlrev_b32 v32, 16, v20
    v_and_b32 v33, 0xffff0000, v20
    v_mul_f32 v36, 1.4426950408889634, v32
    v_exp_f32 v36, v36
    v_add_f32 v34, 1.0, v32
    v_cmp_lt_f32 vcc, 0, v32
    s_nop 1
    v_cndmask_b32 v34, v36, v34, vcc
    v_add_f32 v34, 0x358637bd, v34
    v_mul_f32 v36, 1.4426950408889634, v33
    v_exp_f32 v36, v36
    v_add_f32 v35, 1.0, v33
    v_cmp_lt_f32 vcc, 0, v33
    s_nop 1
    v_cndmask_b32 v35, v36, v35, vcc
    v_add_f32 v35, 0x358637bd, v35
    v_cvt_pk_bf16_f32 v20, v34, v35
    v_lshlrev_b32 v32, 16, v21
    v_and_b32 v33, 0xffff0000, v21
    v_mul_f32 v36, 1.4426950408889634, v32
    v_exp_f32 v36, v36
    v_add_f32 v34, 1.0, v32
    v_cmp_lt_f32 vcc, 0, v32
    s_nop 1
    v_cndmask_b32 v34, v36, v34, vcc
    v_add_f32 v34, 0x358637bd, v34
    v_mul_f32 v36, 1.4426950408889634, v33
    v_exp_f32 v36, v36
    v_add_f32 v35, 1.0, v33
    v_cmp_lt_f32 vcc, 0, v33
    s_nop 1
    v_cndmask_b32 v35, v36, v35, vcc
    v_add_f32 v35, 0x358637bd, v35
    v_cvt_pk_bf16_f32 v21, v34, v35
    v_lshlrev_b32 v32, 16, v22
    v_and_b32 v33, 0xffff0000, v22
    v_mul_f32 v36, 1.4426950408889634, v32
    v_exp_f32 v36, v36
    v_add_f32 v34, 1.0, v32
    v_cmp_lt_f32 vcc, 0, v32
    s_nop 1
    v_cndmask_b32 v34, v36, v34, vcc
    v_add_f32 v34, 0x358637bd, v34
    v_mul_f32 v36, 1.4426950408889634, v33
    v_exp_f32 v36, v36
    v_add_f32 v35, 1.0, v33
    v_cmp_lt_f32 vcc, 0, v33
    s_nop 1
    v_cndmask_b32 v35, v36, v35, vcc
    v_add_f32 v35, 0x358637bd, v35
    v_cvt_pk_bf16_f32 v22, v34, v35
    v_lshlrev_b32 v32, 16, v23
    v_and_b32 v33, 0xffff0000, v23
    v_mul_f32 v36, 1.4426950408889634, v32
    v_exp_f32 v36, v36
    v_add_f32 v34, 1.0, v32
    v_cmp_lt_f32 vcc, 0, v32
    s_nop 1
    v_cndmask_b32 v34, v36, v34, vcc
    v_add_f32 v34, 0x358637bd, v34
    v_mul_f32 v36, 1.4426950408889634, v33
    v_exp_f32 v36, v36
    v_add_f32 v35, 1.0, v33
    v_cmp_lt_f32 vcc, 0, v33
    s_nop 1
    v_cndmask_b32 v35, v36, v35, vcc
    v_add_f32 v35, 0x358637bd, v35
    v_cvt_pk_bf16_f32 v23, v34, v35
    v_mov_b32 v37, 0x3f803f80
    v_cndmask_b32 v20, 0, v20, s[16:17]
    v_cndmask_b32 v28, 0, v28, s[16:17]
    v_cndmask_b32 v28, v28, v37, s[18:19]
    v_cndmask_b32 v21, 0, v21, s[16:17]
    v_cndmask_b32 v29, 0, v29, s[16:17]
    v_cndmask_b32 v29, v29, v37, s[18:19]
    v_cndmask_b32 v22, 0, v22, s[16:17]
    v_cndmask_b32 v30, 0, v30, s[16:17]
    v_cndmask_b32 v30, v30, v37, s[18:19]
    v_cndmask_b32 v23, 0, v23, s[16:17]
    v_cndmask_b32 v31, 0, v31, s[16:17]
    v_cndmask_b32 v31, v31, v37, s[18:19]
    s_nop 1
    v_mfma_f32_16x16x32_bf16 a[0:3], v[24:27], v[16:19], a[0:3]
    v_mfma_f32_16x16x32_bf16 a[4:7], v[24:27], v[20:23], a[4:7]
    v_mfma_f32_16x16x32_bf16 a[8:11], v[28:31], v[16:19], a[8:11]
    v_mfma_f32_16x16x32_bf16 a[12:15], v[28:31], v[20:23], a[12:15]
    buffer_load_dwordx4 v[16:19], v8, s[8:11], 0 offen offset:128
    buffer_load_dwordx4 v[24:27], v10, s[8:11], 0 offen offset:128
    buffer_load_dwordx4 v[20:23], v9, s[8:11], 0 offen offset:128
    buffer_load_dwordx4 v[28:31], v11, s[8:11], 0 offen offset:128
    s_waitcnt vmcnt(0)
    v_lshlrev_b32 v32, 16, v16
    v_and_b32 v33, 0xffff0000, v16
    v_mul_f32 v36, 1.4426950408889634, v32
    v_exp_f32 v36, v36
    v_add_f32 v34, 1.0, v32
    v_cmp_lt_f32 vcc, 0, v32
    s_nop 1
    v_cndmask_b32 v34, v36, v34, vcc
    v_add_f32 v34, 0x358637bd, v34
    v_mul_f32 v36, 1.4426950408889634, v33
    v_exp_f32 v36, v36
    v_add_f32 v35, 1.0, v33
    v_cmp_lt_f32 vcc, 0, v33
    s_nop 1
    v_cndmask_b32 v35, v36, v35, vcc
    v_add_f32 v35, 0x358637bd, v35
    v_cvt_pk_bf16_f32 v16, v34, v35
    v_lshlrev_b32 v32, 16, v17
    v_and_b32 v33, 0xffff0000, v17
    v_mul_f32 v36, 1.4426950408889634, v32
    v_exp_f32 v36, v36
    v_add_f32 v34, 1.0, v32
    v_cmp_lt_f32 vcc, 0, v32
    s_nop 1
    v_cndmask_b32 v34, v36, v34, vcc
    v_add_f32 v34, 0x358637bd, v34
    v_mul_f32 v36, 1.4426950408889634, v33
    v_exp_f32 v36, v36
    v_add_f32 v35, 1.0, v33
    v_cmp_lt_f32 vcc, 0, v33
    s_nop 1
    v_cndmask_b32 v35, v36, v35, vcc
    v_add_f32 v35, 0x358637bd, v35
    v_cvt_pk_bf16_f32 v17, v34, v35
    v_lshlrev_b32 v32, 16, v18
    v_and_b32 v33, 0xffff0000, v18
    v_mul_f32 v36, 1.4426950408889634, v32
    v_exp_f32 v36, v36
    v_add_f32 v34, 1.0, v32
    v_cmp_lt_f32 vcc, 0, v32
    s_nop 1
    v_cndmask_b32 v34, v36, v34, vcc
    v_add_f32 v34, 0x358637bd, v34
    v_mul_f32 v36, 1.4426950408889634, v33
    v_exp_f32 v36, v36
    v_add_f32 v35, 1.0, v33
    v_cmp_lt_f32 vcc, 0, v33
    s_nop 1
    v_cndmask_b32 v35, v36, v35, vcc
    v_add_f32 v35, 0x358637bd, v35
    v_cvt_pk_bf16_f32 v18, v34, v35
    v_lshlrev_b32 v32, 16, v19
    v_and_b32 v33, 0xffff0000, v19
    v_mul_f32 v36, 1.4426950408889634, v32
    v_exp_f32 v36, v36
    v_add_f32 v34, 1.0, v32
    v_cmp_lt_f32 vcc, 0, v32
    s_nop 1
    v_cndmask_b32 v34, v36, v34, vcc
    v_add_f32 v34, 0x358637bd, v34
    v_mul_f32 v36, 1.4426950408889634, v33
    v_exp_f32 v36, v36
    v_add_f32 v35, 1.0, v33
    v_cmp_lt_f32 vcc, 0, v33
    s_nop 1
    v_cndmask_b32 v35, v36, v35, vcc
    v_add_f32 v35, 0x358637bd, v35
    v_cvt_pk_bf16_f32 v19, v34, v35
    v_lshlrev_b32 v32, 16, v20
    v_and_b32 v33, 0xffff0000, v20
    v_mul_f32 v36, 1.4426950408889634, v32
    v_exp_f32 v36, v36
    v_add_f32 v34, 1.0, v32
    v_cmp_lt_f32 vcc, 0, v32
    s_nop 1
    v_cndmask_b32 v34, v36, v34, vcc
    v_add_f32 v34, 0x358637bd, v34
    v_mul_f32 v36, 1.4426950408889634, v33
    v_exp_f32 v36, v36
    v_add_f32 v35, 1.0, v33
    v_cmp_lt_f32 vcc, 0, v33
    s_nop 1
    v_cndmask_b32 v35, v36, v35, vcc
    v_add_f32 v35, 0x358637bd, v35
    v_cvt_pk_bf16_f32 v20, v34, v35
    v_lshlrev_b32 v32, 16, v21
    v_and_b32 v33, 0xffff0000, v21
    v_mul_f32 v36, 1.4426950408889634, v32
    v_exp_f32 v36, v36
    v_add_f32 v34, 1.0, v32
    v_cmp_lt_f32 vcc, 0, v32
    s_nop 1
    v_cndmask_b32 v34, v36, v34, vcc
    v_add_f32 v34, 0x358637bd, v34
    v_mul_f32 v36, 1.4426950408889634, v33
    v_exp_f32 v36, v36
    v_add_f32 v35, 1.0, v33
    v_cmp_lt_f32 vcc, 0, v33
    s_nop 1
    v_cndmask_b32 v35, v36, v35, vcc
    v_add_f32 v35, 0x358637bd, v35
    v_cvt_pk_bf16_f32 v21, v34, v35
    v_lshlrev_b32 v32, 16, v22
    v_and_b32 v33, 0xffff0000, v22
    v_mul_f32 v36, 1.4426950408889634, v32
    v_exp_f32 v36, v36
    v_add_f32 v34, 1.0, v32
    v_cmp_lt_f32 vcc, 0, v32
    s_nop 1
    v_cndmask_b32 v34, v36, v34, vcc
    v_add_f32 v34, 0x358637bd, v34
    v_mul_f32 v36, 1.4426950408889634, v33
    v_exp_f32 v36, v36
    v_add_f32 v35, 1.0, v33
    v_cmp_lt_f32 vcc, 0, v33
    s_nop 1
    v_cndmask_b32 v35, v36, v35, vcc
    v_add_f32 v35, 0x358637bd, v35
    v_cvt_pk_bf16_f32 v22, v34, v35
    v_lshlrev_b32 v32, 16, v23
    v_and_b32 v33, 0xffff0000, v23
    v_mul_f32 v36, 1.4426950408889634, v32
    v_exp_f32 v36, v36
    v_add_f32 v34, 1.0, v32
    v_cmp_lt_f32 vcc, 0, v32
    s_nop 1
    v_cndmask_b32 v34, v36, v34, vcc
    v_add_f32 v34, 0x358637bd, v34
    v_mul_f32 v36, 1.4426950408889634, v33
    v_exp_f32 v36, v36
    v_add_f32 v35, 1.0, v33
    v_cmp_lt_f32 vcc, 0, v33
    s_nop 1
    v_cndmask_b32 v35, v36, v35, vcc
    v_add_f32 v35, 0x358637bd, v35
    v_cvt_pk_bf16_f32 v23, v34, v35
    v_mov_b32 v37, 0x3f803f80
    v_cndmask_b32 v20, 0, v20, s[16:17]
    v_cndmask_b32 v28, 0, v28, s[16:17]
    v_cndmask_b32 v28, v28, v37, s[18:19]
    v_cndmask_b32 v21, 0, v21, s[16:17]
    v_cndmask_b32 v29, 0, v29, s[16:17]
    v_cndmask_b32 v29, v29, v37, s[18:19]
    v_cndmask_b32 v22, 0, v22, s[16:17]
    v_cndmask_b32 v30, 0, v30, s[16:17]
    v_cndmask_b32 v30, v30, v37, s[18:19]
    v_cndmask_b32 v23, 0, v23, s[16:17]
    v_cndmask_b32 v31, 0, v31, s[16:17]
    v_cndmask_b32 v31, v31, v37, s[18:19]
    s_nop 1
    v_mfma_f32_16x16x32_bf16 a[0:3], v[24:27], v[16:19], a[0:3]
    v_mfma_f32_16x16x32_bf16 a[4:7], v[24:27], v[20:23], a[4:7]
    v_mfma_f32_16x16x32_bf16 a[8:11], v[28:31], v[16:19], a[8:11]
    v_mfma_f32_16x16x32_bf16 a[12:15], v[28:31], v[20:23], a[12:15]
    buffer_load_dwordx4 v[16:19], v8, s[8:11], 0 offen offset:192
    buffer_load_dwordx4 v[24:27], v10, s[8:11], 0 offen offset:192
    buffer_load_dwordx4 v[20:23], v9, s[8:11], 0 offen offset:192
    buffer_load_dwordx4 v[28:31], v11, s[8:11], 0 offen offset:192
    s_waitcnt vmcnt(0)
    v_lshlrev_b32 v32, 16, v16
    v_and_b32 v33, 0xffff0000, v16
    v_mul_f32 v36, 1.4426950408889634, v32
    v_exp_f32 v36, v36
    v_add_f32 v34, 1.0, v32
    v_cmp_lt_f32 vcc, 0, v32
    s_nop 1
    v_cndmask_b32 v34, v36, v34, vcc
    v_add_f32 v34, 0x358637bd, v34
    v_mul_f32 v36, 1.4426950408889634, v33
    v_exp_f32 v36, v36
    v_add_f32 v35, 1.0, v33
    v_cmp_lt_f32 vcc, 0, v33
    s_nop 1
    v_cndmask_b32 v35, v36, v35, vcc
    v_add_f32 v35, 0x358637bd, v35
    v_cvt_pk_bf16_f32 v16, v34, v35
    v_lshlrev_b32 v32, 16, v17
    v_and_b32 v33, 0xffff0000, v17
    v_mul_f32 v36, 1.4426950408889634, v32
    v_exp_f32 v36, v36
    v_add_f32 v34, 1.0, v32
    v_cmp_lt_f32 vcc, 0, v32
    s_nop 1
    v_cndmask_b32 v34, v36, v34, vcc
    v_add_f32 v34, 0x358637bd, v34
    v_mul_f32 v36, 1.4426950408889634, v33
    v_exp_f32 v36, v36
    v_add_f32 v35, 1.0, v33
    v_cmp_lt_f32 vcc, 0, v33
    s_nop 1
    v_cndmask_b32 v35, v36, v35, vcc
    v_add_f32 v35, 0x358637bd, v35
    v_cvt_pk_bf16_f32 v17, v34, v35
    v_lshlrev_b32 v32, 16, v18
    v_and_b32 v33, 0xffff0000, v18
    v_mul_f32 v36, 1.4426950408889634, v32
    v_exp_f32 v36, v36
    v_add_f32 v34, 1.0, v32
    v_cmp_lt_f32 vcc, 0, v32
    s_nop 1
    v_cndmask_b32 v34, v36, v34, vcc
    v_add_f32 v34, 0x358637bd, v34
    v_mul_f32 v36, 1.4426950408889634, v33
    v_exp_f32 v36, v36
    v_add_f32 v35, 1.0, v33
    v_cmp_lt_f32 vcc, 0, v33
    s_nop 1
    v_cndmask_b32 v35, v36, v35, vcc
    v_add_f32 v35, 0x358637bd, v35
    v_cvt_pk_bf16_f32 v18, v34, v35
    v_lshlrev_b32 v32, 16, v19
    v_and_b32 v33, 0xffff0000, v19
    v_mul_f32 v36, 1.4426950408889634, v32
    v_exp_f32 v36, v36
    v_add_f32 v34, 1.0, v32
    v_cmp_lt_f32 vcc, 0, v32
    s_nop 1
    v_cndmask_b32 v34, v36, v34, vcc
    v_add_f32 v34, 0x358637bd, v34
    v_mul_f32 v36, 1.4426950408889634, v33
    v_exp_f32 v36, v36
    v_add_f32 v35, 1.0, v33
    v_cmp_lt_f32 vcc, 0, v33
    s_nop 1
    v_cndmask_b32 v35, v36, v35, vcc
    v_add_f32 v35, 0x358637bd, v35
    v_cvt_pk_bf16_f32 v19, v34, v35
    v_lshlrev_b32 v32, 16, v20
    v_and_b32 v33, 0xffff0000, v20
    v_mul_f32 v36, 1.4426950408889634, v32
    v_exp_f32 v36, v36
    v_add_f32 v34, 1.0, v32
    v_cmp_lt_f32 vcc, 0, v32
    s_nop 1
    v_cndmask_b32 v34, v36, v34, vcc
    v_add_f32 v34, 0x358637bd, v34
    v_mul_f32 v36, 1.4426950408889634, v33
    v_exp_f32 v36, v36
    v_add_f32 v35, 1.0, v33
    v_cmp_lt_f32 vcc, 0, v33
    s_nop 1
    v_cndmask_b32 v35, v36, v35, vcc
    v_add_f32 v35, 0x358637bd, v35
    v_cvt_pk_bf16_f32 v20, v34, v35
    v_lshlrev_b32 v32, 16, v21
    v_and_b32 v33, 0xffff0000, v21
    v_mul_f32 v36, 1.4426950408889634, v32
    v_exp_f32 v36, v36
    v_add_f32 v34, 1.0, v32
    v_cmp_lt_f32 vcc, 0, v32
    s_nop 1
    v_cndmask_b32 v34, v36, v34, vcc
    v_add_f32 v34, 0x358637bd, v34
    v_mul_f32 v36, 1.4426950408889634, v33
    v_exp_f32 v36, v36
    v_add_f32 v35, 1.0, v33
    v_cmp_lt_f32 vcc, 0, v33
    s_nop 1
    v_cndmask_b32 v35, v36, v35, vcc
    v_add_f32 v35, 0x358637bd, v35
    v_cvt_pk_bf16_f32 v21, v34, v35
    v_lshlrev_b32 v32, 16, v22
    v_and_b32 v33, 0xffff0000, v22
    v_mul_f32 v36, 1.4426950408889634, v32
    v_exp_f32 v36, v36
    v_add_f32 v34, 1.0, v32
    v_cmp_lt_f32 vcc, 0, v32
    s_nop 1
    v_cndmask_b32 v34, v36, v34, vcc
    v_add_f32 v34, 0x358637bd, v34
    v_mul_f32 v36, 1.4426950408889634, v33
    v_exp_f32 v36, v36
    v_add_f32 v35, 1.0, v33
    v_cmp_lt_f32 vcc, 0, v33
    s_nop 1
    v_cndmask_b32 v35, v36, v35, vcc
    v_add_f32 v35, 0x358637bd, v35
    v_cvt_pk_bf16_f32 v22, v34, v35
    v_lshlrev_b32 v32, 16, v23
    v_and_b32 v33, 0xffff0000, v23
    v_mul_f32 v36, 1.4426950408889634, v32
    v_exp_f32 v36, v36
    v_add_f32 v34, 1.0, v32
    v_cmp_lt_f32 vcc, 0, v32
    s_nop 1
    v_cndmask_b32 v34, v36, v34, vcc
    v_add_f32 v34, 0x358637bd, v34
    v_mul_f32 v36, 1.4426950408889634, v33
    v_exp_f32 v36, v36
    v_add_f32 v35, 1.0, v33
    v_cmp_lt_f32 vcc, 0, v33
    s_nop 1
    v_cndmask_b32 v35, v36, v35, vcc
    v_add_f32 v35, 0x358637bd, v35
    v_cvt_pk_bf16_f32 v23, v34, v35
    v_mov_b32 v37, 0x3f803f80
    v_cndmask_b32 v20, 0, v20, s[16:17]
    v_cndmask_b32 v28, 0, v28, s[16:17]
    v_cndmask_b32 v28, v28, v37, s[18:19]
    v_cndmask_b32 v21, 0, v21, s[16:17]
    v_cndmask_b32 v29, 0, v29, s[16:17]
    v_cndmask_b32 v29, v29, v37, s[18:19]
    v_cndmask_b32 v22, 0, v22, s[16:17]
    v_cndmask_b32 v30, 0, v30, s[16:17]
    v_cndmask_b32 v30, v30, v37, s[18:19]
    v_cndmask_b32 v23, 0, v23, s[16:17]
    v_cndmask_b32 v31, 0, v31, s[16:17]
    v_cndmask_b32 v31, v31, v37, s[18:19]
    s_nop 1
    v_mfma_f32_16x16x32_bf16 a[0:3], v[24:27], v[16:19], a[0:3]
    v_mfma_f32_16x16x32_bf16 a[4:7], v[24:27], v[20:23], a[4:7]
    v_mfma_f32_16x16x32_bf16 a[8:11], v[28:31], v[16:19], a[8:11]
    v_mfma_f32_16x16x32_bf16 a[12:15], v[28:31], v[20:23], a[12:15]
    s_nop 7
    s_nop 7
    v_lshlrev_b32 v5, 2, v4
    v_lshlrev_b32 v5, 5, v5
    v_add_u32 v5, v5, v3
    v_lshlrev_b32 v5, 2, v5
    s_lshl_b32 s14, s5, 12
    s_add_u32 s14, s14, 23068672
    v_add_u32 v5, s14, v5
    v_accvgpr_read_b32 v40, a0
    v_accvgpr_read_b32 v41, a1
    v_accvgpr_read_b32 v42, a2
    v_accvgpr_read_b32 v43, a3
    buffer_atomic_add_f32 v40, v5, s[8:11], 0 offen offset:0
    buffer_atomic_add_f32 v41, v5, s[8:11], 0 offen offset:128
    buffer_atomic_add_f32 v42, v5, s[8:11], 0 offen offset:256
    buffer_atomic_add_f32 v43, v5, s[8:11], 0 offen offset:384
    v_accvgpr_read_b32 v40, a4
    v_accvgpr_read_b32 v41, a5
    v_accvgpr_read_b32 v42, a6
    v_accvgpr_read_b32 v43, a7
    buffer_atomic_add_f32 v40, v5, s[8:11], 0 offen offset:64
    buffer_atomic_add_f32 v41, v5, s[8:11], 0 offen offset:192
    buffer_atomic_add_f32 v42, v5, s[8:11], 0 offen offset:320
    buffer_atomic_add_f32 v43, v5, s[8:11], 0 offen offset:448
    v_accvgpr_read_b32 v40, a8
    v_accvgpr_read_b32 v41, a9
    v_accvgpr_read_b32 v42, a10
    v_accvgpr_read_b32 v43, a11
    buffer_atomic_add_f32 v40, v5, s[8:11], 0 offen offset:2048
    buffer_atomic_add_f32 v41, v5, s[8:11], 0 offen offset:2176
    buffer_atomic_add_f32 v42, v5, s[8:11], 0 offen offset:2304
    buffer_atomic_add_f32 v43, v5, s[8:11], 0 offen offset:2432
    v_accvgpr_read_b32 v40, a12
    v_accvgpr_read_b32 v41, a13
    v_accvgpr_read_b32 v42, a14
    v_accvgpr_read_b32 v43, a15
    buffer_atomic_add_f32 v40, v5, s[8:11], 0 offen offset:2112
    buffer_atomic_add_f32 v41, v5, s[8:11], 0 offen offset:2240
    buffer_atomic_add_f32 v42, v5, s[8:11], 0 offen offset:2368
    buffer_atomic_add_f32 v43, v5, s[8:11], 0 offen offset:2496
kvz_a1_kernel_end:
    s_endpgm
.section .rodata,"a"
.p2align 6
.amdhsa_kernel kvz_a1_kernel
  .amdhsa_next_free_vgpr 80
  .amdhsa_next_free_sgpr 40
  .amdhsa_accum_offset 64
  .amdhsa_group_segment_fixed_size 0
  .amdhsa_kernarg_size 104
  .amdhsa_user_sgpr_count 2
  .amdhsa_user_sgpr_kernarg_segment_ptr 1
  .amdhsa_system_sgpr_workgroup_id_x 1
.end_amdhsa_kernel
.text
.globl attn_a1_kernel
.p2align 8
.type attn_a1_kernel,@function
attn_a1_kernel:
    s_cmp_ge_u32 s2, 256
    s_cbranch_scc1 attn_a1_kernel_end
    s_load_dwordx2 s[6:7], s[0:1], 96
    s_waitcnt lgkmcnt(0)
    s_mov_b32 s8, s6
    s_mov_b32 s9, s7
    s_mov_b32 s10, 268435456
    s_mov_b32 s11, 0x00020000
    v_mov_b32 v1, v0
    v_add_u32 v2, 0, v1
    s_mov_b32 s12, 3121
    v_mul_lo_u32 v3, v2, s12
    v_lshrrev_b32 v3, 19, v3
    v_mul_u32_u24 v4, 168, v3
    v_sub_u32 v4, v2, v4
    v_lshlrev_b32 v5, 12, v3
    v_lshlrev_b32 v6, 4, v4
    v_add_u32 v5, v5, v6
    v_add_u32 v5, 23068672, v5
    buffer_load_dwordx4 v[8:11], v5, s[8:11], 0 offen
    v_mul_u32_u24 v7, 2688, v3
    v_add_u32 v7, v7, v6
    s_waitcnt vmcnt(0)
    ds_write_b128 v7, v[8:11]
    v_add_u32 v2, 256, v1
    s_mov_b32 s12, 3121
    v_mul_lo_u32 v3, v2, s12
    v_lshrrev_b32 v3, 19, v3
    v_mul_u32_u24 v4, 168, v3
    v_sub_u32 v4, v2, v4
    v_lshlrev_b32 v5, 12, v3
    v_lshlrev_b32 v6, 4, v4
    v_add_u32 v5, v5, v6
    v_add_u32 v5, 23068672, v5
    buffer_load_dwordx4 v[8:11], v5, s[8:11], 0 offen
    v_mul_u32_u24 v7, 2688, v3
    v_add_u32 v7, v7, v6
    s_waitcnt vmcnt(0)
    ds_write_b128 v7, v[8:11]
    v_add_u32 v2, 512, v1
    s_mov_b32 s12, 3121
    v_mul_lo_u32 v3, v2, s12
    v_lshrrev_b32 v3, 19, v3
    v_mul_u32_u24 v4, 168, v3
    v_sub_u32 v4, v2, v4
    v_lshlrev_b32 v5, 12, v3
    v_lshlrev_b32 v6, 4, v4
    v_add_u32 v5, v5, v6
    v_add_u32 v5, 23068672, v5
    buffer_load_dwordx4 v[8:11], v5, s[8:11], 0 offen
    v_mul_u32_u24 v7, 2688, v3
    v_add_u32 v7, v7, v6
    s_waitcnt vmcnt(0)
    ds_write_b128 v7, v[8:11]
    v_add_u32 v2, 768, v1
    s_mov_b32 s12, 3121
    v_mul_lo_u32 v3, v2, s12
    v_lshrrev_b32 v3, 19, v3
    v_mul_u32_u24 v4, 168, v3
    v_sub_u32 v4, v2, v4
    v_lshlrev_b32 v5, 12, v3
    v_lshlrev_b32 v6, 4, v4
    v_add_u32 v5, v5, v6
    v_add_u32 v5, 23068672, v5
    buffer_load_dwordx4 v[8:11], v5, s[8:11], 0 offen
    v_mul_u32_u24 v7, 2688, v3
    v_add_u32 v7, v7, v6
    s_waitcnt vmcnt(0)
    ds_write_b128 v7, v[8:11]
    v_add_u32 v2, 1024, v1
    s_mov_b32 s12, 3121
    v_mul_lo_u32 v3, v2, s12
    v_lshrrev_b32 v3, 19, v3
    v_mul_u32_u24 v4, 168, v3
    v_sub_u32 v4, v2, v4
    v_lshlrev_b32 v5, 12, v3
    v_lshlrev_b32 v6, 4, v4
    v_add_u32 v5, v5, v6
    v_add_u32 v5, 23068672, v5
    buffer_load_dwordx4 v[8:11], v5, s[8:11], 0 offen
    v_mul_u32_u24 v7, 2688, v3
    v_add_u32 v7, v7, v6
    s_waitcnt vmcnt(0)
    ds_write_b128 v7, v[8:11]
    v_add_u32 v2, 1280, v1
    s_mov_b32 s12, 3121
    v_mul_lo_u32 v3, v2, s12
    v_lshrrev_b32 v3, 19, v3
    v_mul_u32_u24 v4, 168, v3
    v_sub_u32 v4, v2, v4
    v_lshlrev_b32 v5, 12, v3
    v_lshlrev_b32 v6, 4, v4
    v_add_u32 v5, v5, v6
    v_add_u32 v5, 23068672, v5
    buffer_load_dwordx4 v[8:11], v5, s[8:11], 0 offen
    v_mul_u32_u24 v7, 2688, v3
    v_add_u32 v7, v7, v6
    s_waitcnt vmcnt(0)
    ds_write_b128 v7, v[8:11]
    v_add_u32 v2, 1536, v1
    s_mov_b32 s12, 3121
    v_mul_lo_u32 v3, v2, s12
    v_lshrrev_b32 v3, 19, v3
    v_mul_u32_u24 v4, 168, v3
    v_sub_u32 v4, v2, v4
    v_lshlrev_b32 v5, 12, v3
    v_lshlrev_b32 v6, 4, v4
    v_add_u32 v5, v5, v6
    v_add_u32 v5, 23068672, v5
    buffer_load_dwordx4 v[8:11], v5, s[8:11], 0 offen
    v_mul_u32_u24 v7, 2688, v3
    v_add_u32 v7, v7, v6
    s_waitcnt vmcnt(0)
    ds_write_b128 v7, v[8:11]
    v_add_u32 v2, 1792, v1
    s_mov_b32 s12, 3121
    v_mul_lo_u32 v3, v2, s12
    v_lshrrev_b32 v3, 19, v3
    v_mul_u32_u24 v4, 168, v3
    v_sub_u32 v4, v2, v4
    v_lshlrev_b32 v5, 12, v3
    v_lshlrev_b32 v6, 4, v4
    v_add_u32 v5, v5, v6
    v_add_u32 v5, 23068672, v5
    buffer_load_dwordx4 v[8:11], v5, s[8:11], 0 offen
    v_mul_u32_u24 v7, 2688, v3
    v_add_u32 v7, v7, v6
    s_waitcnt vmcnt(0)
    ds_write_b128 v7, v[8:11]
    v_add_u32 v2, 2048, v1
    s_mov_b32 s12, 3121
    v_mul_lo_u32 v3, v2, s12
    v_lshrrev_b32 v3, 19, v3
    v_mul_u32_u24 v4, 168, v3
    v_sub_u32 v4, v2, v4
    v_lshlrev_b32 v5, 12, v3
    v_lshlrev_b32 v6, 4, v4
    v_add_u32 v5, v5, v6
    v_add_u32 v5, 23068672, v5
    buffer_load_dwordx4 v[8:11], v5, s[8:11], 0 offen
    v_mul_u32_u24 v7, 2688, v3
    v_add_u32 v7, v7, v6
    s_waitcnt vmcnt(0)
    ds_write_b128 v7, v[8:11]
    v_add_u32 v2, 2304, v1
    s_mov_b32 s12, 3121
    v_mul_lo_u32 v3, v2, s12
    v_lshrrev_b32 v3, 19, v3
    v_mul_u32_u24 v4, 168, v3
    v_sub_u32 v4, v2, v4
    v_lshlrev_b32 v5, 12, v3
    v_lshlrev_b32 v6, 4, v4
    v_add_u32 v5, v5, v6
    v_add_u32 v5, 23068672, v5
    buffer_load_dwordx4 v[8:11], v5, s[8:11], 0 offen
    v_mul_u32_u24 v7, 2688, v3
    v_add_u32 v7, v7, v6
    s_waitcnt vmcnt(0)
    ds_write_b128 v7, v[8:11]
    v_add_u32 v2, 2560, v1
    s_mov_b32 s12, 3121
    v_mul_lo_u32 v3, v2, s12
    v_lshrrev_b32 v3, 19, v3
    v_mul_u32_u24 v4, 168, v3
    v_sub_u32 v4, v2, v4
    v_lshlrev_b32 v5, 12, v3
    v_lshlrev_b32 v6, 4, v4
    v_add_u32 v5, v5, v6
    v_add_u32 v5, 23068672, v5
    buffer_load_dwordx4 v[8:11], v5, s[8:11], 0 offen
    v_mul_u32_u24 v7, 2688, v3
    v_add_u32 v7, v7, v6
    s_waitcnt vmcnt(0)
    ds_write_b128 v7, v[8:11]
    v_add_u32 v2, 2816, v1
    s_mov_b32 s12, 3121
    v_mul_lo_u32 v3, v2, s12
    v_lshrrev_b32 v3, 19, v3
    v_mul_u32_u24 v4, 168, v3
    v_sub_u32 v4, v2, v4
    v_lshlrev_b32 v5, 12, v3
    v_lshlrev_b32 v6, 4, v4
    v_add_u32 v5, v5, v6
    v_add_u32 v5, 23068672, v5
    buffer_load_dwordx4 v[8:11], v5, s[8:11], 0 offen
    v_mul_u32_u24 v7, 2688, v3
    v_add_u32 v7, v7, v6
    s_waitcnt vmcnt(0)
    ds_write_b128 v7, v[8:11]
    v_add_u32 v2, 3072, v1
    s_mov_b32 s12, 3121
    v_mul_lo_u32 v3, v2, s12
    v_lshrrev_b32 v3, 19, v3
    v_mul_u32_u24 v4, 168, v3
    v_sub_u32 v4, v2, v4
    v_lshlrev_b32 v5, 12, v3
    v_lshlrev_b32 v6, 4, v4
    v_add_u32 v5, v5, v6
    v_add_u32 v5, 23068672, v5
    buffer_load_dwordx4 v[8:11], v5, s[8:11], 0 offen
    v_mul_u32_u24 v7, 2688, v3
    v_add_u32 v7, v7, v6
    s_waitcnt vmcnt(0)
    ds_write_b128 v7, v[8:11]
    v_add_u32 v2, 3328, v1
    s_mov_b32 s12, 3121
    v_mul_lo_u32 v3, v2, s12
    v_lshrrev_b32 v3, 19, v3
    v_mul_u32_u24 v4, 168, v3
    v_sub_u32 v4, v2, v4
    v_lshlrev_b32 v5, 12, v3
    v_lshlrev_b32 v6, 4, v4
    v_add_u32 v5, v5, v6
    v_add_u32 v5, 23068672, v5
    buffer_load_dwordx4 v[8:11], v5, s[8:11], 0 offen
    v_mul_u32_u24 v7, 2688, v3
    v_add_u32 v7, v7, v6
    s_waitcnt vmcnt(0)
    ds_write_b128 v7, v[8:11]
    v_add_u32 v2, 3584, v1
    s_mov_b32 s12, 3121
    v_mul_lo_u32 v3, v2, s12
    v_lshrrev_b32 v3, 19, v3
    v_mul_u32_u24 v4, 168, v3
    v_sub_u32 v4, v2, v4
    v_lshlrev_b32 v5, 12, v3
    v_lshlrev_b32 v6, 4, v4
    v_add_u32 v5, v5, v6
    v_add_u32 v5, 23068672, v5
    buffer_load_dwordx4 v[8:11], v5, s[8:11], 0 offen
    v_mul_u32_u24 v7, 2688, v3
    v_add_u32 v7, v7, v6
    s_waitcnt vmcnt(0)
    ds_write_b128 v7, v[8:11]
    v_add_u32 v2, 3840, v1
    s_mov_b32 s12, 3121
    v_mul_lo_u32 v3, v2, s12
    v_lshrrev_b32 v3, 19, v3
    v_mul_u32_u24 v4, 168, v3
    v_sub_u32 v4, v2, v4
    v_lshlrev_b32 v5, 12, v3
    v_lshlrev_b32 v6, 4, v4
    v_add_u32 v5, v5, v6
    v_add_u32 v5, 23068672, v5
    buffer_load_dwordx4 v[8:11], v5, s[8:11], 0 offen
    v_mul_u32_u24 v7, 2688, v3
    v_add_u32 v7, v7, v6
    s_waitcnt vmcnt(0)
    ds_write_b128 v7, v[8:11]
    v_add_u32 v2, 4096, v1
    s_mov_b32 s12, 3121
    v_mul_lo_u32 v3, v2, s12
    v_lshrrev_b32 v3, 19, v3
    v_mul_u32_u24 v4, 168, v3
    v_sub_u32 v4, v2, v4
    v_lshlrev_b32 v5, 12, v3
    v_lshlrev_b32 v6, 4, v4
    v_add_u32 v5, v5, v6
    v_add_u32 v5, 23068672, v5
    buffer_load_dwordx4 v[8:11], v5, s[8:11], 0 offen
    v_mul_u32_u24 v7, 2688, v3
    v_add_u32 v7, v7, v6
    s_waitcnt vmcnt(0)
    ds_write_b128 v7, v[8:11]
    v_add_u32 v2, 4352, v1
    s_mov_b32 s12, 3121
    v_mul_lo_u32 v3, v2, s12
    v_lshrrev_b32 v3, 19, v3
    v_mul_u32_u24 v4, 168, v3
    v_sub_u32 v4, v2, v4
    v_lshlrev_b32 v5, 12, v3
    v_lshlrev_b32 v6, 4, v4
    v_add_u32 v5, v5, v6
    v_add_u32 v5, 23068672, v5
    buffer_load_dwordx4 v[8:11], v5, s[8:11], 0 offen
    v_mul_u32_u24 v7, 2688, v3
    v_add_u32 v7, v7, v6
    s_waitcnt vmcnt(0)
    ds_write_b128 v7, v[8:11]
    v_add_u32 v2, 4608, v1
    s_mov_b32 s12, 3121
    v_mul_lo_u32 v3, v2, s12
    v_lshrrev_b32 v3, 19, v3
    v_mul_u32_u24 v4, 168, v3
    v_sub_u32 v4, v2, v4
    v_lshlrev_b32 v5, 12, v3
    v_lshlrev_b32 v6, 4, v4
    v_add_u32 v5, v5, v6
    v_add_u32 v5, 23068672, v5
    buffer_load_dwordx4 v[8:11], v5, s[8:11], 0 offen
    v_mul_u32_u24 v7, 2688, v3
    v_add_u32 v7, v7, v6
    s_waitcnt vmcnt(0)
    ds_write_b128 v7, v[8:11]
    v_add_u32 v2, 4864, v1
    s_mov_b32 s12, 3121
    v_mul_lo_u32 v3, v2, s12
    v_lshrrev_b32 v3, 19, v3
    v_mul_u32_u24 v4, 168, v3
    v_sub_u32 v4, v2, v4
    v_lshlrev_b32 v5, 12, v3
    v_lshlrev_b32 v6, 4, v4
    v_add_u32 v5, v5, v6
    v_add_u32 v5, 23068672, v5
    buffer_load_dwordx4 v[8:11], v5, s[8:11], 0 offen
    v_mul_u32_u24 v7, 2688, v3
    v_add_u32 v7, v7, v6
    s_waitcnt vmcnt(0)
    ds_write_b128 v7, v[8:11]
    v_add_u32 v2, 5120, v1
    s_mov_b32 s12, 3121
    v_mul_lo_u32 v3, v2, s12
    v_lshrrev_b32 v3, 19, v3
    v_mul_u32_u24 v4, 168, v3
    v_sub_u32 v4, v2, v4
    v_lshlrev_b32 v5, 12, v3
    v_lshlrev_b32 v6, 4, v4
    v_add_u32 v5, v5, v6
    v_add_u32 v5, 23068672, v5
    buffer_load_dwordx4 v[8:11], v5, s[8:11], 0 offen
    v_mul_u32_u24 v7, 2688, v3
    v_add_u32 v7, v7, v6
    s_waitcnt vmcnt(0)
    ds_write_b128 v7, v[8:11]
    s_waitcnt lgkmcnt(0)
    s_barrier
    v_and_b32 v2, 31, v0
    v_lshrrev_b32 v3, 5, v0
    s_lshl_b32 s12, s2, 3
    v_add_u32 v3, s12, v3
    v_mul_u32_u24 v4, 1280, v3
    v_mul_u32_u24 v5, 40, v2
    v_add_u32 v4, v4, v5
    v_add_u32 v6, 8388608, v4
    buffer_load_dwordx2 v[8:9], v6, s[8:11], 0 offen offset:0
    buffer_load_dwordx2 v[10:11], v6, s[8:11], 0 offen offset:8
    buffer_load_dwordx2 v[12:13], v6, s[8:11], 0 offen offset:16
    buffer_load_dwordx2 v[14:15], v6, s[8:11], 0 offen offset:24
    buffer_load_dwordx2 v[16:17], v6, s[8:11], 0 offen offset:32
    s_waitcnt vmcnt(0)
    v_lshlrev_b32 v40, 16, v8
    v_and_b32 v41, 0xffff0000, v8
    v_mul_f32 v44, 1.4426950408889634, v40
    v_exp_f32 v44, v44
    v_add_f32 v42, 1.0, v40
    v_cmp_lt_f32 vcc, 0, v40
    s_nop 1
    v_cndmask_b32 v42, v44, v42, vcc
    v_add_f32 v42, 0x358637bd, v42
    v_mul_f32 v44, 1.4426950408889634, v41
    v_exp_f32 v44, v44
    v_add_f32 v43, 1.0, v41
    v_cmp_lt_f32 vcc, 0, v41
    s_nop 1
    v_cndmask_b32 v43, v44, v43, vcc
    v_add_f32 v43, 0x358637bd, v43
    v_cvt_pk_bf16_f32 v45, v42, v43
    v_lshlrev_b32 v20, 16, v45
    v_and_b32 v21, 0xffff0000, v45
    v_lshlrev_b32 v40, 16, v9
    v_and_b32 v41, 0xffff0000, v9
    v_mul_f32 v44, 1.4426950408889634, v40
    v_exp_f32 v44, v44
    v_add_f32 v42, 1.0, v40
    v_cmp_lt_f32 vcc, 0, v40
    s_nop 1
    v_cndmask_b32 v42, v44, v42, vcc
    v_add_f32 v42, 0x358637bd, v42
    v_mul_f32 v44, 1.4426950408889634, v41
    v_exp_f32 v44, v44
    v_add_f32 v43, 1.0, v41
    v_cmp_lt_f32 vcc, 0, v41
    s_nop 1
    v_cndmask_b32 v43, v44, v43, vcc
    v_add_f32 v43, 0x358637bd, v43
    v_cvt_pk_bf16_f32 v45, v42, v43
    v_lshlrev_b32 v22, 16, v45
    v_and_b32 v23, 0xffff0000, v45
    v_lshlrev_b32 v40, 16, v10
    v_and_b32 v41, 0xffff0000, v10
    v_mul_f32 v44, 1.4426950408889634, v40
    v_exp_f32 v44, v44
    v_add_f32 v42, 1.0, v40
    v_cmp_lt_f32 vcc, 0, v40
    s_nop 1
    v_cndmask_b32 v42, v44, v42, vcc
    v_add_f32 v42, 0x358637bd, v42
    v_mul_f32 v44, 1.4426950408889634, v41
    v_exp_f32 v44, v44
    v_add_f32 v43, 1.0, v41
    v_cmp_lt_f32 vcc, 0, v41
    s_nop 1
    v_cndmask_b32 v43, v44, v43, vcc
    v_add_f32 v43, 0x358637bd, v43
    v_cvt_pk_bf16_f32 v45, v42, v43
    v_lshlrev_b32 v24, 16, v45
    v_and_b32 v25, 0xffff0000, v45
    v_lshlrev_b32 v40, 16, v11
    v_and_b32 v41, 0xffff0000, v11
    v_mul_f32 v44, 1.4426950408889634, v40
    v_exp_f32 v44, v44
    v_add_f32 v42, 1.0, v40
    v_cmp_lt_f32 vcc, 0, v40
    s_nop 1
    v_cndmask_b32 v42, v44, v42, vcc
    v_add_f32 v42, 0x358637bd, v42
    v_mul_f32 v44, 1.4426950408889634, v41
    v_exp_f32 v44, v44
    v_add_f32 v43, 1.0, v41
    v_cmp_lt_f32 vcc, 0, v41
    s_nop 1
    v_cndmask_b32 v43, v44, v43, vcc
    v_add_f32 v43, 0x358637bd, v43
    v_cvt_pk_bf16_f32 v45, v42, v43
    v_lshlrev_b32 v26, 16, v45
    v_and_b32 v27, 0xffff0000, v45
    v_lshlrev_b32 v40, 16, v12
    v_and_b32 v41, 0xffff0000, v12
    v_mul_f32 v44, 1.4426950408889634, v40
    v_exp_f32 v44, v44
    v_add_f32 v42, 1.0, v40
    v_cmp_lt_f32 vcc, 0, v40
    s_nop 1
    v_cndmask_b32 v42, v44, v42, vcc
    v_add_f32 v42, 0x358637bd, v42
    v_mul_f32 v44, 1.4426950408889634, v41
    v_exp_f32 v44, v44
    v_add_f32 v43, 1.0, v41
    v_cmp_lt_f32 vcc, 0, v41
    s_nop 1
    v_cndmask_b32 v43, v44, v43, vcc
    v_add_f32 v43, 0x358637bd, v43
    v_cvt_pk_bf16_f32 v45, v42, v43
    v_lshlrev_b32 v28, 16, v45
    v_and_b32 v29, 0xffff0000, v45
    v_lshlrev_b32 v40, 16, v13
    v_and_b32 v41, 0xffff0000, v13
    v_mul_f32 v44, 1.4426950408889634, v40
    v_exp_f32 v44, v44
    v_add_f32 v42, 1.0, v40
    v_cmp_lt_f32 vcc, 0, v40
    s_nop 1
    v_cndmask_b32 v42, v44, v42, vcc
    v_add_f32 v42, 0x358637bd, v42
    v_mul_f32 v44, 1.4426950408889634, v41
    v_exp_f32 v44, v44
    v_add_f32 v43, 1.0, v41
    v_cmp_lt_f32 vcc, 0, v41
    s_nop 1
    v_cndmask_b32 v43, v44, v43, vcc
    v_add_f32 v43, 0x358637bd, v43
    v_cvt_pk_bf16_f32 v45, v42, v43
    v_lshlrev_b32 v30, 16, v45
    v_and_b32 v31, 0xffff0000, v45
    v_lshlrev_b32 v40, 16, v14
    v_and_b32 v41, 0xffff0000, v14
    v_mul_f32 v44, 1.4426950408889634, v40
    v_exp_f32 v44, v44
    v_add_f32 v42, 1.0, v40
    v_cmp_lt_f32 vcc, 0, v40
    s_nop 1
    v_cndmask_b32 v42, v44, v42, vcc
    v_add_f32 v42, 0x358637bd, v42
    v_mul_f32 v44, 1.4426950408889634, v41
    v_exp_f32 v44, v44
    v_add_f32 v43, 1.0, v41
    v_cmp_lt_f32 vcc, 0, v41
    s_nop 1
    v_cndmask_b32 v43, v44, v43, vcc
    v_add_f32 v43, 0x358637bd, v43
    v_cvt_pk_bf16_f32 v45, v42, v43
    v_lshlrev_b32 v32, 16, v45
    v_and_b32 v33, 0xffff0000, v45
    v_lshlrev_b32 v40, 16, v15
    v_and_b32 v41, 0xffff0000, v15
    v_mul_f32 v44, 1.4426950408889634, v40
    v_exp_f32 v44, v44
    v_add_f32 v42, 1.0, v40
    v_cmp_lt_f32 vcc, 0, v40
    s_nop 1
    v_cndmask_b32 v42, v44, v42, vcc
    v_add_f32 v42, 0x358637bd, v42
    v_mul_f32 v44, 1.4426950408889634, v41
    v_exp_f32 v44, v44
    v_add_f32 v43, 1.0, v41
    v_cmp_lt_f32 vcc, 0, v41
    s_nop 1
    v_cndmask_b32 v43, v44, v43, vcc
    v_add_f32 v43, 0x358637bd, v43
    v_cvt_pk_bf16_f32 v45, v42, v43
    v_lshlrev_b32 v34, 16, v45
    v_and_b32 v35, 0xffff0000, v45
    v_lshlrev_b32 v40, 16, v16
    v_and_b32 v41, 0xffff0000, v16
    v_mul_f32 v44, 1.4426950408889634, v40
    v_exp_f32 v44, v44
    v_add_f32 v42, 1.0, v40
    v_cmp_lt_f32 vcc, 0, v40
    s_nop 1
    v_cndmask_b32 v42, v44, v42, vcc
    v_add_f32 v42, 0x358637bd, v42
    v_mul_f32 v44, 1.4426950408889634, v41
    v_exp_f32 v44, v44
    v_add_f32 v43, 1.0, v41
    v_cmp_lt_f32 vcc, 0, v41
    s_nop 1
    v_cndmask_b32 v43, v44, v43, vcc
    v_add_f32 v43, 0x358637bd, v43
    v_cvt_pk_bf16_f32 v45, v42, v43
    v_lshlrev_b32 v36, 16, v45
    v_and_b32 v37, 0xffff0000, v45
    v_lshlrev_b32 v40, 16, v17
    v_and_b32 v41, 0xffff0000, v17
    v_mul_f32 v44, 1.4426950408889634, v40
    v_exp_f32 v44, v44
    v_add_f32 v42, 1.0, v40
    v_cmp_lt_f32 vcc, 0, v40
    s_nop 1
    v_cndmask_b32 v42, v44, v42, vcc
    v_add_f32 v42, 0x358637bd, v42
    v_mul_f32 v44, 1.4426950408889634, v41
    v_exp_f32 v44, v44
    v_add_f32 v43, 1.0, v41
    v_cmp_lt_f32 vcc, 0, v41
    s_nop 1
    v_cndmask_b32 v43, v44, v43, vcc
    v_add_f32 v43, 0x358637bd, v43
    v_cvt_pk_bf16_f32 v45, v42, v43
    v_lshlrev_b32 v38, 16, v45
    v_and_b32 v39, 0xffff0000, v45
    v_mul_u32_u24 v7, 2688, v2
    ds_read_b128 v[72:75], v7 offset:0
    ds_read_b128 v[76:79], v7 offset:16
    ds_read_b128 v[80:83], v7 offset:32
    ds_read_b128 v[84:87], v7 offset:48
    ds_read_b128 v[88:91], v7 offset:64
    s_waitcnt lgkmcnt(0)
    v_mul_f32 v50, v20, v72
    v_fmac_f32 v50, v21, v73
    v_fmac_f32 v50, v22, v74
    v_fmac_f32 v50, v23, v75
    v_fmac_f32 v50, v24, v76
    v_fmac_f32 v50, v25, v77
    v_fmac_f32 v50, v26, v78
    v_fmac_f32 v50, v27, v79
    v_fmac_f32 v50, v28, v80
    v_fmac_f32 v50, v29, v81
    v_fmac_f32 v50, v30, v82
    v_fmac_f32 v50, v31, v83
    v_fmac_f32 v50, v32, v84
    v_fmac_f32 v50, v33, v85
    v_fmac_f32 v50, v34, v86
    v_fmac_f32 v50, v35, v87
    v_fmac_f32 v50, v36, v88
    v_fmac_f32 v50, v37, v89
    v_fmac_f32 v50, v38, v90
    v_fmac_f32 v50, v39, v91
    ds_read_b128 v[72:75], v7 offset:128
    ds_read_b128 v[76:79], v7 offset:144
    ds_read_b128 v[80:83], v7 offset:160
    ds_read_b128 v[84:87], v7 offset:176
    ds_read_b128 v[88:91], v7 offset:192
    s_waitcnt lgkmcnt(0)
    v_mul_f32 v51, v20, v72
    v_fmac_f32 v51, v21, v73
    v_fmac_f32 v51, v22, v74
    v_fmac_f32 v51, v23, v75
    v_fmac_f32 v51, v24, v76
    v_fmac_f32 v51, v25, v77
    v_fmac_f32 v51, v26, v78
    v_fmac_f32 v51, v27, v79
    v_fmac_f32 v51, v28, v80
    v_fmac_f32 v51, v29, v81
    v_fmac_f32 v51, v30, v82
    v_fmac_f32 v51, v31, v83
    v_fmac_f32 v51, v32, v84
    v_fmac_f32 v51, v33, v85
    v_fmac_f32 v51, v34, v86
    v_fmac_f32 v51, v35, v87
    v_fmac_f32 v51, v36, v88
    v_fmac_f32 v51, v37, v89
    v_fmac_f32 v51, v38, v90
    v_fmac_f32 v51, v39, v91
    ds_read_b128 v[72:75], v7 offset:256
    ds_read_b128 v[76:79], v7 offset:272
    ds_read_b128 v[80:83], v7 offset:288
    ds_read_b128 v[84:87], v7 offset:304
    ds_read_b128 v[88:91], v7 offset:320
    s_waitcnt lgkmcnt(0)
    v_mul_f32 v52, v20, v72
    v_fmac_f32 v52, v21, v73
    v_fmac_f32 v52, v22, v74
    v_fmac_f32 v52, v23, v75
    v_fmac_f32 v52, v24, v76
    v_fmac_f32 v52, v25, v77
    v_fmac_f32 v52, v26, v78
    v_fmac_f32 v52, v27, v79
    v_fmac_f32 v52, v28, v80
    v_fmac_f32 v52, v29, v81
    v_fmac_f32 v52, v30, v82
    v_fmac_f32 v52, v31, v83
    v_fmac_f32 v52, v32, v84
    v_fmac_f32 v52, v33, v85
    v_fmac_f32 v52, v34, v86
    v_fmac_f32 v52, v35, v87
    v_fmac_f32 v52, v36, v88
    v_fmac_f32 v52, v37, v89
    v_fmac_f32 v52, v38, v90
    v_fmac_f32 v52, v39, v91
    ds_read_b128 v[72:75], v7 offset:384
    ds_read_b128 v[76:79], v7 offset:400
    ds_read_b128 v[80:83], v7 offset:416
    ds_read_b128 v[84:87], v7 offset:432
    ds_read_b128 v[88:91], v7 offset:448
    s_waitcnt lgkmcnt(0)
    v_mul_f32 v53, v20, v72
    v_fmac_f32 v53, v21, v73
    v_fmac_f32 v53, v22, v74
    v_fmac_f32 v53, v23, v75
    v_fmac_f32 v53, v24, v76
    v_fmac_f32 v53, v25, v77
    v_fmac_f32 v53, v26, v78
    v_fmac_f32 v53, v27, v79
    v_fmac_f32 v53, v28, v80
    v_fmac_f32 v53, v29, v81
    v_fmac_f32 v53, v30, v82
    v_fmac_f32 v53, v31, v83
    v_fmac_f32 v53, v32, v84
    v_fmac_f32 v53, v33, v85
    v_fmac_f32 v53, v34, v86
    v_fmac_f32 v53, v35, v87
    v_fmac_f32 v53, v36, v88
    v_fmac_f32 v53, v37, v89
    v_fmac_f32 v53, v38, v90
    v_fmac_f32 v53, v39, v91
    ds_read_b128 v[72:75], v7 offset:512
    ds_read_b128 v[76:79], v7 offset:528
    ds_read_b128 v[80:83], v7 offset:544
    ds_read_b128 v[84:87], v7 offset:560
    ds_read_b128 v[88:91], v7 offset:576
    s_waitcnt lgkmcnt(0)
    v_mul_f32 v54, v20, v72
    v_fmac_f32 v54, v21, v73
    v_fmac_f32 v54, v22, v74
    v_fmac_f32 v54, v23, v75
    v_fmac_f32 v54, v24, v76
    v_fmac_f32 v54, v25, v77
    v_fmac_f32 v54, v26, v78
    v_fmac_f32 v54, v27, v79
    v_fmac_f32 v54, v28, v80
    v_fmac_f32 v54, v29, v81
    v_fmac_f32 v54, v30, v82
    v_fmac_f32 v54, v31, v83
    v_fmac_f32 v54, v32, v84
    v_fmac_f32 v54, v33, v85
    v_fmac_f32 v54, v34, v86
    v_fmac_f32 v54, v35, v87
    v_fmac_f32 v54, v36, v88
    v_fmac_f32 v54, v37, v89
    v_fmac_f32 v54, v38, v90
    v_fmac_f32 v54, v39, v91
    ds_read_b128 v[72:75], v7 offset:640
    ds_read_b128 v[76:79], v7 offset:656
    ds_read_b128 v[80:83], v7 offset:672
    ds_read_b128 v[84:87], v7 offset:688
    ds_read_b128 v[88:91], v7 offset:704
    s_waitcnt lgkmcnt(0)
    v_mul_f32 v55, v20, v72
    v_fmac_f32 v55, v21, v73
    v_fmac_f32 v55, v22, v74
    v_fmac_f32 v55, v23, v75
    v_fmac_f32 v55, v24, v76
    v_fmac_f32 v55, v25, v77
    v_fmac_f32 v55, v26, v78
    v_fmac_f32 v55, v27, v79
    v_fmac_f32 v55, v28, v80
    v_fmac_f32 v55, v29, v81
    v_fmac_f32 v55, v30, v82
    v_fmac_f32 v55, v31, v83
    v_fmac_f32 v55, v32, v84
    v_fmac_f32 v55, v33, v85
    v_fmac_f32 v55, v34, v86
    v_fmac_f32 v55, v35, v87
    v_fmac_f32 v55, v36, v88
    v_fmac_f32 v55, v37, v89
    v_fmac_f32 v55, v38, v90
    v_fmac_f32 v55, v39, v91
    ds_read_b128 v[72:75], v7 offset:768
    ds_read_b128 v[76:79], v7 offset:784
    ds_read_b128 v[80:83], v7 offset:800
    ds_read_b128 v[84:87], v7 offset:816
    ds_read_b128 v[88:91], v7 offset:832
    s_waitcnt lgkmcnt(0)
    v_mul_f32 v56, v20, v72
    v_fmac_f32 v56, v21, v73
    v_fmac_f32 v56, v22, v74
    v_fmac_f32 v56, v23, v75
    v_fmac_f32 v56, v24, v76
    v_fmac_f32 v56, v25, v77
    v_fmac_f32 v56, v26, v78
    v_fmac_f32 v56, v27, v79
    v_fmac_f32 v56, v28, v80
    v_fmac_f32 v56, v29, v81
    v_fmac_f32 v56, v30, v82
    v_fmac_f32 v56, v31, v83
    v_fmac_f32 v56, v32, v84
    v_fmac_f32 v56, v33, v85
    v_fmac_f32 v56, v34, v86
    v_fmac_f32 v56, v35, v87
    v_fmac_f32 v56, v36, v88
    v_fmac_f32 v56, v37, v89
    v_fmac_f32 v56, v38, v90
    v_fmac_f32 v56, v39, v91
    ds_read_b128 v[72:75], v7 offset:896
    ds_read_b128 v[76:79], v7 offset:912
    ds_read_b128 v[80:83], v7 offset:928
    ds_read_b128 v[84:87], v7 offset:944
    ds_read_b128 v[88:91], v7 offset:960
    s_waitcnt lgkmcnt(0)
    v_mul_f32 v57, v20, v72
    v_fmac_f32 v57, v21, v73
    v_fmac_f32 v57, v22, v74
    v_fmac_f32 v57, v23, v75
    v_fmac_f32 v57, v24, v76
    v_fmac_f32 v57, v25, v77
    v_fmac_f32 v57, v26, v78
    v_fmac_f32 v57, v27, v79
    v_fmac_f32 v57, v28, v80
    v_fmac_f32 v57, v29, v81
    v_fmac_f32 v57, v30, v82
    v_fmac_f32 v57, v31, v83
    v_fmac_f32 v57, v32, v84
    v_fmac_f32 v57, v33, v85
    v_fmac_f32 v57, v34, v86
    v_fmac_f32 v57, v35, v87
    v_fmac_f32 v57, v36, v88
    v_fmac_f32 v57, v37, v89
    v_fmac_f32 v57, v38, v90
    v_fmac_f32 v57, v39, v91
    ds_read_b128 v[72:75], v7 offset:1024
    ds_read_b128 v[76:79], v7 offset:1040
    ds_read_b128 v[80:83], v7 offset:1056
    ds_read_b128 v[84:87], v7 offset:1072
    ds_read_b128 v[88:91], v7 offset:1088
    s_waitcnt lgkmcnt(0)
    v_mul_f32 v58, v20, v72
    v_fmac_f32 v58, v21, v73
    v_fmac_f32 v58, v22, v74
    v_fmac_f32 v58, v23, v75
    v_fmac_f32 v58, v24, v76
    v_fmac_f32 v58, v25, v77
    v_fmac_f32 v58, v26, v78
    v_fmac_f32 v58, v27, v79
    v_fmac_f32 v58, v28, v80
    v_fmac_f32 v58, v29, v81
    v_fmac_f32 v58, v30, v82
    v_fmac_f32 v58, v31, v83
    v_fmac_f32 v58, v32, v84
    v_fmac_f32 v58, v33, v85
    v_fmac_f32 v58, v34, v86
    v_fmac_f32 v58, v35, v87
    v_fmac_f32 v58, v36, v88
    v_fmac_f32 v58, v37, v89
    v_fmac_f32 v58, v38, v90
    v_fmac_f32 v58, v39, v91
    ds_read_b128 v[72:75], v7 offset:1152
    ds_read_b128 v[76:79], v7 offset:1168
    ds_read_b128 v[80:83], v7 offset:1184
    ds_read_b128 v[84:87], v7 offset:1200
    ds_read_b128 v[88:91], v7 offset:1216
    s_waitcnt lgkmcnt(0)
    v_mul_f32 v59, v20, v72
    v_fmac_f32 v59, v21, v73
    v_fmac_f32 v59, v22, v74
    v_fmac_f32 v59, v23, v75
    v_fmac_f32 v59, v24, v76
    v_fmac_f32 v59, v25, v77
    v_fmac_f32 v59, v26, v78
    v_fmac_f32 v59, v27, v79
    v_fmac_f32 v59, v28, v80
    v_fmac_f32 v59, v29, v81
    v_fmac_f32 v59, v30, v82
    v_fmac_f32 v59, v31, v83
    v_fmac_f32 v59, v32, v84
    v_fmac_f32 v59, v33, v85
    v_fmac_f32 v59, v34, v86
    v_fmac_f32 v59, v35, v87
    v_fmac_f32 v59, v36, v88
    v_fmac_f32 v59, v37, v89
    v_fmac_f32 v59, v38, v90
    v_fmac_f32 v59, v39, v91
    ds_read_b128 v[72:75], v7 offset:1280
    ds_read_b128 v[76:79], v7 offset:1296
    ds_read_b128 v[80:83], v7 offset:1312
    ds_read_b128 v[84:87], v7 offset:1328
    ds_read_b128 v[88:91], v7 offset:1344
    s_waitcnt lgkmcnt(0)
    v_mul_f32 v60, v20, v72
    v_fmac_f32 v60, v21, v73
    v_fmac_f32 v60, v22, v74
    v_fmac_f32 v60, v23, v75
    v_fmac_f32 v60, v24, v76
    v_fmac_f32 v60, v25, v77
    v_fmac_f32 v60, v26, v78
    v_fmac_f32 v60, v27, v79
    v_fmac_f32 v60, v28, v80
    v_fmac_f32 v60, v29, v81
    v_fmac_f32 v60, v30, v82
    v_fmac_f32 v60, v31, v83
    v_fmac_f32 v60, v32, v84
    v_fmac_f32 v60, v33, v85
    v_fmac_f32 v60, v34, v86
    v_fmac_f32 v60, v35, v87
    v_fmac_f32 v60, v36, v88
    v_fmac_f32 v60, v37, v89
    v_fmac_f32 v60, v38, v90
    v_fmac_f32 v60, v39, v91
    ds_read_b128 v[72:75], v7 offset:1408
    ds_read_b128 v[76:79], v7 offset:1424
    ds_read_b128 v[80:83], v7 offset:1440
    ds_read_b128 v[84:87], v7 offset:1456
    ds_read_b128 v[88:91], v7 offset:1472
    s_waitcnt lgkmcnt(0)
    v_mul_f32 v61, v20, v72
    v_fmac_f32 v61, v21, v73
    v_fmac_f32 v61, v22, v74
    v_fmac_f32 v61, v23, v75
    v_fmac_f32 v61, v24, v76
    v_fmac_f32 v61, v25, v77
    v_fmac_f32 v61, v26, v78
    v_fmac_f32 v61, v27, v79
    v_fmac_f32 v61, v28, v80
    v_fmac_f32 v61, v29, v81
    v_fmac_f32 v61, v30, v82
    v_fmac_f32 v61, v31, v83
    v_fmac_f32 v61, v32, v84
    v_fmac_f32 v61, v33, v85
    v_fmac_f32 v61, v34, v86
    v_fmac_f32 v61, v35, v87
    v_fmac_f32 v61, v36, v88
    v_fmac_f32 v61, v37, v89
    v_fmac_f32 v61, v38, v90
    v_fmac_f32 v61, v39, v91
    ds_read_b128 v[72:75], v7 offset:1536
    ds_read_b128 v[76:79], v7 offset:1552
    ds_read_b128 v[80:83], v7 offset:1568
    ds_read_b128 v[84:87], v7 offset:1584
    ds_read_b128 v[88:91], v7 offset:1600
    s_waitcnt lgkmcnt(0)
    v_mul_f32 v62, v20, v72
    v_fmac_f32 v62, v21, v73
    v_fmac_f32 v62, v22, v74
    v_fmac_f32 v62, v23, v75
    v_fmac_f32 v62, v24, v76
    v_fmac_f32 v62, v25, v77
    v_fmac_f32 v62, v26, v78
    v_fmac_f32 v62, v27, v79
    v_fmac_f32 v62, v28, v80
    v_fmac_f32 v62, v29, v81
    v_fmac_f32 v62, v30, v82
    v_fmac_f32 v62, v31, v83
    v_fmac_f32 v62, v32, v84
    v_fmac_f32 v62, v33, v85
    v_fmac_f32 v62, v34, v86
    v_fmac_f32 v62, v35, v87
    v_fmac_f32 v62, v36, v88
    v_fmac_f32 v62, v37, v89
    v_fmac_f32 v62, v38, v90
    v_fmac_f32 v62, v39, v91
    ds_read_b128 v[72:75], v7 offset:1664
    ds_read_b128 v[76:79], v7 offset:1680
    ds_read_b128 v[80:83], v7 offset:1696
    ds_read_b128 v[84:87], v7 offset:1712
    ds_read_b128 v[88:91], v7 offset:1728
    s_waitcnt lgkmcnt(0)
    v_mul_f32 v63, v20, v72
    v_fmac_f32 v63, v21, v73
    v_fmac_f32 v63, v22, v74
    v_fmac_f32 v63, v23, v75
    v_fmac_f32 v63, v24, v76
    v_fmac_f32 v63, v25, v77
    v_fmac_f32 v63, v26, v78
    v_fmac_f32 v63, v27, v79
    v_fmac_f32 v63, v28, v80
    v_fmac_f32 v63, v29, v81
    v_fmac_f32 v63, v30, v82
    v_fmac_f32 v63, v31, v83
    v_fmac_f32 v63, v32, v84
    v_fmac_f32 v63, v33, v85
    v_fmac_f32 v63, v34, v86
    v_fmac_f32 v63, v35, v87
    v_fmac_f32 v63, v36, v88
    v_fmac_f32 v63, v37, v89
    v_fmac_f32 v63, v38, v90
    v_fmac_f32 v63, v39, v91
    ds_read_b128 v[72:75], v7 offset:1792
    ds_read_b128 v[76:79], v7 offset:1808
    ds_read_b128 v[80:83], v7 offset:1824
    ds_read_b128 v[84:87], v7 offset:1840
    ds_read_b128 v[88:91], v7 offset:1856
    s_waitcnt lgkmcnt(0)
    v_mul_f32 v64, v20, v72
    v_fmac_f32 v64, v21, v73
    v_fmac_f32 v64, v22, v74
    v_fmac_f32 v64, v23, v75
    v_fmac_f32 v64, v24, v76
    v_fmac_f32 v64, v25, v77
    v_fmac_f32 v64, v26, v78
    v_fmac_f32 v64, v27, v79
    v_fmac_f32 v64, v28, v80
    v_fmac_f32 v64, v29, v81
    v_fmac_f32 v64, v30, v82
    v_fmac_f32 v64, v31, v83
    v_fmac_f32 v64, v32, v84
    v_fmac_f32 v64, v33, v85
    v_fmac_f32 v64, v34, v86
    v_fmac_f32 v64, v35, v87
    v_fmac_f32 v64, v36, v88
    v_fmac_f32 v64, v37, v89
    v_fmac_f32 v64, v38, v90
    v_fmac_f32 v64, v39, v91
    ds_read_b128 v[72:75], v7 offset:1920
    ds_read_b128 v[76:79], v7 offset:1936
    ds_read_b128 v[80:83], v7 offset:1952
    ds_read_b128 v[84:87], v7 offset:1968
    ds_read_b128 v[88:91], v7 offset:1984
    s_waitcnt lgkmcnt(0)
    v_mul_f32 v65, v20, v72
    v_fmac_f32 v65, v21, v73
    v_fmac_f32 v65, v22, v74
    v_fmac_f32 v65, v23, v75
    v_fmac_f32 v65, v24, v76
    v_fmac_f32 v65, v25, v77
    v_fmac_f32 v65, v26, v78
    v_fmac_f32 v65, v27, v79
    v_fmac_f32 v65, v28, v80
    v_fmac_f32 v65, v29, v81
    v_fmac_f32 v65, v30, v82
    v_fmac_f32 v65, v31, v83
    v_fmac_f32 v65, v32, v84
    v_fmac_f32 v65, v33, v85
    v_fmac_f32 v65, v34, v86
    v_fmac_f32 v65, v35, v87
    v_fmac_f32 v65, v36, v88
    v_fmac_f32 v65, v37, v89
    v_fmac_f32 v65, v38, v90
    v_fmac_f32 v65, v39, v91
    ds_read_b128 v[72:75], v7 offset:2048
    ds_read_b128 v[76:79], v7 offset:2064
    ds_read_b128 v[80:83], v7 offset:2080
    ds_read_b128 v[84:87], v7 offset:2096
    ds_read_b128 v[88:91], v7 offset:2112
    s_waitcnt lgkmcnt(0)
    v_mul_f32 v66, v20, v72
    v_fmac_f32 v66, v21, v73
    v_fmac_f32 v66, v22, v74
    v_fmac_f32 v66, v23, v75
    v_fmac_f32 v66, v24, v76
    v_fmac_f32 v66, v25, v77
    v_fmac_f32 v66, v26, v78
    v_fmac_f32 v66, v27, v79
    v_fmac_f32 v66, v28, v80
    v_fmac_f32 v66, v29, v81
    v_fmac_f32 v66, v30, v82
    v_fmac_f32 v66, v31, v83
    v_fmac_f32 v66, v32, v84
    v_fmac_f32 v66, v33, v85
    v_fmac_f32 v66, v34, v86
    v_fmac_f32 v66, v35, v87
    v_fmac_f32 v66, v36, v88
    v_fmac_f32 v66, v37, v89
    v_fmac_f32 v66, v38, v90
    v_fmac_f32 v66, v39, v91
    ds_read_b128 v[72:75], v7 offset:2176
    ds_read_b128 v[76:79], v7 offset:2192
    ds_read_b128 v[80:83], v7 offset:2208
    ds_read_b128 v[84:87], v7 offset:2224
    ds_read_b128 v[88:91], v7 offset:2240
    s_waitcnt lgkmcnt(0)
    v_mul_f32 v67, v20, v72
    v_fmac_f32 v67, v21, v73
    v_fmac_f32 v67, v22, v74
    v_fmac_f32 v67, v23, v75
    v_fmac_f32 v67, v24, v76
    v_fmac_f32 v67, v25, v77
    v_fmac_f32 v67, v26, v78
    v_fmac_f32 v67, v27, v79
    v_fmac_f32 v67, v28, v80
    v_fmac_f32 v67, v29, v81
    v_fmac_f32 v67, v30, v82
    v_fmac_f32 v67, v31, v83
    v_fmac_f32 v67, v32, v84
    v_fmac_f32 v67, v33, v85
    v_fmac_f32 v67, v34, v86
    v_fmac_f32 v67, v35, v87
    v_fmac_f32 v67, v36, v88
    v_fmac_f32 v67, v37, v89
    v_fmac_f32 v67, v38, v90
    v_fmac_f32 v67, v39, v91
    ds_read_b128 v[72:75], v7 offset:2304
    ds_read_b128 v[76:79], v7 offset:2320
    ds_read_b128 v[80:83], v7 offset:2336
    ds_read_b128 v[84:87], v7 offset:2352
    ds_read_b128 v[88:91], v7 offset:2368
    s_waitcnt lgkmcnt(0)
    v_mul_f32 v68, v20, v72
    v_fmac_f32 v68, v21, v73
    v_fmac_f32 v68, v22, v74
    v_fmac_f32 v68, v23, v75
    v_fmac_f32 v68, v24, v76
    v_fmac_f32 v68, v25, v77
    v_fmac_f32 v68, v26, v78
    v_fmac_f32 v68, v27, v79
    v_fmac_f32 v68, v28, v80
    v_fmac_f32 v68, v29, v81
    v_fmac_f32 v68, v30, v82
    v_fmac_f32 v68, v31, v83
    v_fmac_f32 v68, v32, v84
    v_fmac_f32 v68, v33, v85
    v_fmac_f32 v68, v34, v86
    v_fmac_f32 v68, v35, v87
    v_fmac_f32 v68, v36, v88
    v_fmac_f32 v68, v37, v89
    v_fmac_f32 v68, v38, v90
    v_fmac_f32 v68, v39, v91
    ds_read_b128 v[72:75], v7 offset:2432
    ds_read_b128 v[76:79], v7 offset:2448
    ds_read_b128 v[80:83], v7 offset:2464
    ds_read_b128 v[84:87], v7 offset:2480
    ds_read_b128 v[88:91], v7 offset:2496
    s_waitcnt lgkmcnt(0)
    v_mul_f32 v69, v20, v72
    v_fmac_f32 v69, v21, v73
    v_fmac_f32 v69, v22, v74
    v_fmac_f32 v69, v23, v75
    v_fmac_f32 v69, v24, v76
    v_fmac_f32 v69, v25, v77
    v_fmac_f32 v69, v26, v78
    v_fmac_f32 v69, v27, v79
    v_fmac_f32 v69, v28, v80
    v_fmac_f32 v69, v29, v81
    v_fmac_f32 v69, v30, v82
    v_fmac_f32 v69, v31, v83
    v_fmac_f32 v69, v32, v84
    v_fmac_f32 v69, v33, v85
    v_fmac_f32 v69, v34, v86
    v_fmac_f32 v69, v35, v87
    v_fmac_f32 v69, v36, v88
    v_fmac_f32 v69, v37, v89
    v_fmac_f32 v69, v38, v90
    v_fmac_f32 v69, v39, v91
    ds_read_b128 v[72:75], v7 offset:2560
    ds_read_b128 v[76:79], v7 offset:2576
    ds_read_b128 v[80:83], v7 offset:2592
    ds_read_b128 v[84:87], v7 offset:2608
    ds_read_b128 v[88:91], v7 offset:2624
    s_waitcnt lgkmcnt(0)
    v_mul_f32 v70, v20, v72
    v_fmac_f32 v70, v21, v73
    v_fmac_f32 v70, v22, v74
    v_fmac_f32 v70, v23, v75
    v_fmac_f32 v70, v24, v76
    v_fmac_f32 v70, v25, v77
    v_fmac_f32 v70, v26, v78
    v_fmac_f32 v70, v27, v79
    v_fmac_f32 v70, v28, v80
    v_fmac_f32 v70, v29, v81
    v_fmac_f32 v70, v30, v82
    v_fmac_f32 v70, v31, v83
    v_fmac_f32 v70, v32, v84
    v_fmac_f32 v70, v33, v85
    v_fmac_f32 v70, v34, v86
    v_fmac_f32 v70, v35, v87
    v_fmac_f32 v70, v36, v88
    v_fmac_f32 v70, v37, v89
    v_fmac_f32 v70, v38, v90
    v_fmac_f32 v70, v39, v91
    v_add_f32 v70, 0x358637bd, v70
    v_rcp_f32 v70, v70
    s_nop 0
    v_mul_f32 v50, v50, v70
    v_mul_f32 v51, v51, v70
    v_mul_f32 v52, v52, v70
    v_mul_f32 v53, v53, v70
    v_mul_f32 v54, v54, v70
    v_mul_f32 v55, v55, v70
    v_mul_f32 v56, v56, v70
    v_mul_f32 v57, v57, v70
    v_mul_f32 v58, v58, v70
    v_mul_f32 v59, v59, v70
    v_mul_f32 v60, v60, v70
    v_mul_f32 v61, v61, v70
    v_mul_f32 v62, v62, v70
    v_mul_f32 v63, v63, v70
    v_mul_f32 v64, v64, v70
    v_mul_f32 v65, v65, v70
    v_mul_f32 v66, v66, v70
    v_mul_f32 v67, v67, v70
    v_mul_f32 v68, v68, v70
    v_mul_f32 v69, v69, v70
    v_cvt_pk_bf16_f32 v8, v50, v51
    v_cvt_pk_bf16_f32 v9, v52, v53
    v_cvt_pk_bf16_f32 v10, v54, v55
    v_cvt_pk_bf16_f32 v11, v56, v57
    v_cvt_pk_bf16_f32 v12, v58, v59
    v_cvt_pk_bf16_f32 v13, v60, v61
    v_cvt_pk_bf16_f32 v14, v62, v63
    v_cvt_pk_bf16_f32 v15, v64, v65
    v_cvt_pk_bf16_f32 v16, v66, v67
    v_cvt_pk_bf16_f32 v17, v68, v69
    v_add_u32 v6, 18874368, v4
    buffer_store_dwordx2 v[8:9], v6, s[8:11], 0 offen offset:0
    buffer_store_dwordx2 v[10:11], v6, s[8:11], 0 offen offset:8
    buffer_store_dwordx2 v[12:13], v6, s[8:11], 0 offen offset:16
    buffer_store_dwordx2 v[14:15], v6, s[8:11], 0 offen offset:24
    buffer_store_dwordx2 v[16:17], v6, s[8:11], 0 offen offset:32
attn_a1_kernel_end:
    s_endpgm
.section .rodata,"a"
.p2align 6
.amdhsa_kernel attn_a1_kernel
  .amdhsa_next_free_vgpr 96
  .amdhsa_next_free_sgpr 40
  .amdhsa_accum_offset 96
  .amdhsa_group_segment_fixed_size 0
  .amdhsa_kernarg_size 104
  .amdhsa_user_sgpr_count 2
  .amdhsa_user_sgpr_kernarg_segment_ptr 1
  .amdhsa_system_sgpr_workgroup_id_x 1
.end_amdhsa_kernel
.text
.globl wo_a1_kernel
.p2align 8
.type wo_a1_kernel,@function
wo_a1_kernel:
    v_lshrrev_b32 v1, 6, v0
    v_and_b32 v2, 63, v0
    s_nop 0
    v_readfirstlane_b32 s3, v1
    s_cmp_ge_u32 s2, 128
    s_cbranch_scc1 wo_a1_kernel_end
    s_load_dwordx2 s[4:5], s[0:1], 96
    s_load_dwordx2 s[6:7], s[0:1], 80
    s_load_dwordx2 s[42:43], s[0:1], 0
    s_mul_i32 s20, s2, 1
    s_lshr_b32 s20, s20, 3
    s_mul_i32 s21, s20, 8
    s_sub_u32 s21, s2, s21
    s_lshl_b32 s20, s20, 2
    s_add_u32 s20, s20, s3
    s_mul_i32 s22, s20, 32
    s_mul_i32 s23, s21, 80
    s_waitcnt lgkmcnt(0)
    s_mov_b32 s8, s4
    s_mov_b32 s9, s5
    s_mov_b32 s10, 268435456
    s_mov_b32 s11, 0x00020000
    v_and_b32 v3, 15, v2
    v_lshrrev_b32 v4, 4, v2
    s_mov_b32 s24, 1280
    v_add_u32 v5, s22, v3
    v_mul_lo_u32 v5, v5, s24
    v_lshlrev_b32 v6, 4, v4
    v_add_u32 v5, v5, v6
    v_add_u32 v5, 18874368, v5
    v_mov_b32 v8, v5
    v_add_u32 v9, 20480, v5
    v_lshlrev_b32 v7, 4, v2
    s_mov_b32 s25, 0
    s_mov_b32 s26, 0
    s_mul_i32 s27, s21, 102400
    s_add_u32 s27, s27, s26
    s_add_u32 s27, s27, 29360128
    s_add_u32 s32, s27, 0
    s_add_u32 s33, s27, 20480
    s_add_u32 s34, s27, 40960
    s_add_u32 s35, s27, 61440
    s_add_u32 s36, s27, 81920
    v_accvgpr_write_b32 a0, 0
    v_accvgpr_write_b32 a1, 0
    v_accvgpr_write_b32 a2, 0
    v_accvgpr_write_b32 a3, 0
    v_accvgpr_write_b32 a4, 0
    v_accvgpr_write_b32 a5, 0
    v_accvgpr_write_b32 a6, 0
    v_accvgpr_write_b32 a7, 0
    v_accvgpr_write_b32 a8, 0
    v_accvgpr_write_b32 a9, 0
    v_accvgpr_write_b32 a10, 0
    v_accvgpr_write_b32 a11, 0
    v_accvgpr_write_b32 a12, 0
    v_accvgpr_write_b32 a13, 0
    v_accvgpr_write_b32 a14, 0
    v_accvgpr_write_b32 a15, 0
    v_accvgpr_write_b32 a16, 0
    v_accvgpr_write_b32 a17, 0
    v_accvgpr_write_b32 a18, 0
    v_accvgpr_write_b32 a19, 0
    v_accvgpr_write_b32 a20, 0
    v_accvgpr_write_b32 a21, 0
    v_accvgpr_write_b32 a22, 0
    v_accvgpr_write_b32 a23, 0
    v_accvgpr_write_b32 a24, 0
    v_accvgpr_write_b32 a25, 0
    v_accvgpr_write_b32 a26, 0
    v_accvgpr_write_b32 a27, 0
    v_accvgpr_write_b32 a28, 0
    v_accvgpr_write_b32 a29, 0
    v_accvgpr_write_b32 a30, 0
    v_accvgpr_write_b32 a31, 0
    v_accvgpr_write_b32 a32, 0
    v_accvgpr_write_b32 a33, 0
    v_accvgpr_write_b32 a34, 0
    v_accvgpr_write_b32 a35, 0
    v_accvgpr_write_b32 a36, 0
    v_accvgpr_write_b32 a37, 0
    v_accvgpr_write_b32 a38, 0
    v_accvgpr_write_b32 a39, 0
    buffer_load_dwordx4 v[16:19], v8, s[8:11], s25 offen
    buffer_load_dwordx4 v[20:23], v9, s[8:11], s25 offen
    buffer_load_dwordx4 v[24:27], v7, s[8:11], s32 offen
    buffer_load_dwordx4 v[28:31], v7, s[8:11], s33 offen
    buffer_load_dwordx4 v[32:35], v7, s[8:11], s34 offen
    buffer_load_dwordx4 v[36:39], v7, s[8:11], s35 offen
    buffer_load_dwordx4 v[40:43], v7, s[8:11], s36 offen
    s_mov_b32 s28, 10
wo_a1_kernel_loop0:
    s_add_u32 s25, s25, 64
    s_add_u32 s32, s32, 1024
    s_add_u32 s33, s33, 1024
    s_add_u32 s34, s34, 1024
    s_add_u32 s35, s35, 1024
    s_add_u32 s36, s36, 1024
    buffer_load_dwordx4 v[44:47], v8, s[8:11], s25 offen
    buffer_load_dwordx4 v[48:51], v9, s[8:11], s25 offen
    buffer_load_dwordx4 v[52:55], v7, s[8:11], s32 offen
    buffer_load_dwordx4 v[56:59], v7, s[8:11], s33 offen
    buffer_load_dwordx4 v[60:63], v7, s[8:11], s34 offen
    buffer_load_dwordx4 v[64:67], v7, s[8:11], s35 offen
    buffer_load_dwordx4 v[68:71], v7, s[8:11], s36 offen
    s_waitcnt vmcnt(7)
    v_mfma_f32_16x16x32_bf16 a[0:3], v[24:27], v[16:19], a[0:3]
    v_mfma_f32_16x16x32_bf16 a[20:23], v[24:27], v[20:23], a[20:23]
    v_mfma_f32_16x16x32_bf16 a[4:7], v[28:31], v[16:19], a[4:7]
    v_mfma_f32_16x16x32_bf16 a[24:27], v[28:31], v[20:23], a[24:27]
    v_mfma_f32_16x16x32_bf16 a[8:11], v[32:35], v[16:19], a[8:11]
    v_mfma_f32_16x16x32_bf16 a[28:31], v[32:35], v[20:23], a[28:31]
    v_mfma_f32_16x16x32_bf16 a[12:15], v[36:39], v[16:19], a[12:15]
    v_mfma_f32_16x16x32_bf16 a[32:35], v[36:39], v[20:23], a[32:35]
    v_mfma_f32_16x16x32_bf16 a[16:19], v[40:43], v[16:19], a[16:19]
    v_mfma_f32_16x16x32_bf16 a[36:39], v[40:43], v[20:23], a[36:39]
    s_sub_u32 s28, s28, 1
    s_cmp_eq_u32 s28, 0
    s_cbranch_scc1 wo_a1_kernel_loop0_last
    s_add_u32 s25, s25, 64
    s_add_u32 s32, s32, 1024
    s_add_u32 s33, s33, 1024
    s_add_u32 s34, s34, 1024
    s_add_u32 s35, s35, 1024
    s_add_u32 s36, s36, 1024
    buffer_load_dwordx4 v[16:19], v8, s[8:11], s25 offen
    buffer_load_dwordx4 v[20:23], v9, s[8:11], s25 offen
    buffer_load_dwordx4 v[24:27], v7, s[8:11], s32 offen
    buffer_load_dwordx4 v[28:31], v7, s[8:11], s33 offen
    buffer_load_dwordx4 v[32:35], v7, s[8:11], s34 offen
    buffer_load_dwordx4 v[36:39], v7, s[8:11], s35 offen
    buffer_load_dwordx4 v[40:43], v7, s[8:11], s36 offen
    s_waitcnt vmcnt(7)
    v_mfma_f32_16x16x32_bf16 a[0:3], v[52:55], v[44:47], a[0:3]
    v_mfma_f32_16x16x32_bf16 a[20:23], v[52:55], v[48:51], a[20:23]
    v_mfma_f32_16x16x32_bf16 a[4:7], v[56:59], v[44:47], a[4:7]
    v_mfma_f32_16x16x32_bf16 a[24:27], v[56:59], v[48:51], a[24:27]
    v_mfma_f32_16x16x32_bf16 a[8:11], v[60:63], v[44:47], a[8:11]
    v_mfma_f32_16x16x32_bf16 a[28:31], v[60:63], v[48:51], a[28:31]
    v_mfma_f32_16x16x32_bf16 a[12:15], v[64:67], v[44:47], a[12:15]
    v_mfma_f32_16x16x32_bf16 a[32:35], v[64:67], v[48:51], a[32:35]
    v_mfma_f32_16x16x32_bf16 a[16:19], v[68:71], v[44:47], a[16:19]
    v_mfma_f32_16x16x32_bf16 a[36:39], v[68:71], v[48:51], a[36:39]
    s_branch wo_a1_kernel_loop0
wo_a1_kernel_loop0_last:
    s_waitcnt vmcnt(0)
    v_mfma_f32_16x16x32_bf16 a[0:3], v[52:55], v[44:47], a[0:3]
    v_mfma_f32_16x16x32_bf16 a[20:23], v[52:55], v[48:51], a[20:23]
    v_mfma_f32_16x16x32_bf16 a[4:7], v[56:59], v[44:47], a[4:7]
    v_mfma_f32_16x16x32_bf16 a[24:27], v[56:59], v[48:51], a[24:27]
    v_mfma_f32_16x16x32_bf16 a[8:11], v[60:63], v[44:47], a[8:11]
    v_mfma_f32_16x16x32_bf16 a[28:31], v[60:63], v[48:51], a[28:31]
    v_mfma_f32_16x16x32_bf16 a[12:15], v[64:67], v[44:47], a[12:15]
    v_mfma_f32_16x16x32_bf16 a[32:35], v[64:67], v[48:51], a[32:35]
    v_mfma_f32_16x16x32_bf16 a[16:19], v[68:71], v[44:47], a[16:19]
    v_mfma_f32_16x16x32_bf16 a[36:39], v[68:71], v[48:51], a[36:39]
    s_nop 7
    s_nop 7
    s_mov_b32 s44, s42
    s_mov_b32 s45, s43
    s_mov_b32 s46, 2621440
    s_mov_b32 s47, 0x00020000
    s_mov_b32 s24, 1280
    v_add_u32 v5, s22, v3
    v_mul_lo_u32 v5, v5, s24
    v_lshlrev_b32 v6, 3, v4
    s_lshl_b32 s29, s23, 1
    v_add3_u32 v5, v5, v6, s29
    v_add_u32 v6, 0, v5
    buffer_load_dwordx2 v[72:73], v6, s[44:47], 0 offen
    v_accvgpr_read_b32 v76, a0
    v_accvgpr_read_b32 v77, a1
    v_accvgpr_read_b32 v78, a2
    v_accvgpr_read_b32 v79, a3
    v_cvt_pk_bf16_f32 v80, v76, v77
    v_cvt_pk_bf16_f32 v81, v78, v79
    s_waitcnt vmcnt(0)
    v_lshlrev_b32 v76, 16, v80
    v_and_b32 v77, 0xffff0000, v80
    v_lshlrev_b32 v82, 16, v72
    v_and_b32 v83, 0xffff0000, v72
    v_add_f32 v76, v76, v82
    v_add_f32 v77, v77, v83
    v_lshlrev_b32 v78, 16, v81
    v_and_b32 v79, 0xffff0000, v81
    v_lshlrev_b32 v82, 16, v73
    v_and_b32 v83, 0xffff0000, v73
    v_add_f32 v78, v78, v82
    v_add_f32 v79, v79, v83
    v_cvt_pk_bf16_f32 v80, v76, v77
    v_cvt_pk_bf16_f32 v81, v78, v79
    v_add_u32 v6, 4194304, v5
    buffer_store_dwordx2 v[80:81], v6, s[8:11], 0 offen
    v_add_u32 v6, 32, v5
    buffer_load_dwordx2 v[72:73], v6, s[44:47], 0 offen
    v_accvgpr_read_b32 v76, a4
    v_accvgpr_read_b32 v77, a5
    v_accvgpr_read_b32 v78, a6
    v_accvgpr_read_b32 v79, a7
    v_cvt_pk_bf16_f32 v80, v76, v77
    v_cvt_pk_bf16_f32 v81, v78, v79
    s_waitcnt vmcnt(0)
    v_lshlrev_b32 v76, 16, v80
    v_and_b32 v77, 0xffff0000, v80
    v_lshlrev_b32 v82, 16, v72
    v_and_b32 v83, 0xffff0000, v72
    v_add_f32 v76, v76, v82
    v_add_f32 v77, v77, v83
    v_lshlrev_b32 v78, 16, v81
    v_and_b32 v79, 0xffff0000, v81
    v_lshlrev_b32 v82, 16, v73
    v_and_b32 v83, 0xffff0000, v73
    v_add_f32 v78, v78, v82
    v_add_f32 v79, v79, v83
    v_cvt_pk_bf16_f32 v80, v76, v77
    v_cvt_pk_bf16_f32 v81, v78, v79
    v_add_u32 v6, 4194336, v5
    buffer_store_dwordx2 v[80:81], v6, s[8:11], 0 offen
    v_add_u32 v6, 64, v5
    buffer_load_dwordx2 v[72:73], v6, s[44:47], 0 offen
    v_accvgpr_read_b32 v76, a8
    v_accvgpr_read_b32 v77, a9
    v_accvgpr_read_b32 v78, a10
    v_accvgpr_read_b32 v79, a11
    v_cvt_pk_bf16_f32 v80, v76, v77
    v_cvt_pk_bf16_f32 v81, v78, v79
    s_waitcnt vmcnt(0)
    v_lshlrev_b32 v76, 16, v80
    v_and_b32 v77, 0xffff0000, v80
    v_lshlrev_b32 v82, 16, v72
    v_and_b32 v83, 0xffff0000, v72
    v_add_f32 v76, v76, v82
    v_add_f32 v77, v77, v83
    v_lshlrev_b32 v78, 16, v81
    v_and_b32 v79, 0xffff0000, v81
    v_lshlrev_b32 v82, 16, v73
    v_and_b32 v83, 0xffff0000, v73
    v_add_f32 v78, v78, v82
    v_add_f32 v79, v79, v83
    v_cvt_pk_bf16_f32 v80, v76, v77
    v_cvt_pk_bf16_f32 v81, v78, v79
    v_add_u32 v6, 4194368, v5
    buffer_store_dwordx2 v[80:81], v6, s[8:11], 0 offen
    v_add_u32 v6, 96, v5
    buffer_load_dwordx2 v[72:73], v6, s[44:47], 0 offen
    v_accvgpr_read_b32 v76, a12
    v_accvgpr_read_b32 v77, a13
    v_accvgpr_read_b32 v78, a14
    v_accvgpr_read_b32 v79, a15
    v_cvt_pk_bf16_f32 v80, v76, v77
    v_cvt_pk_bf16_f32 v81, v78, v79
    s_waitcnt vmcnt(0)
    v_lshlrev_b32 v76, 16, v80
    v_and_b32 v77, 0xffff0000, v80
    v_lshlrev_b32 v82, 16, v72
    v_and_b32 v83, 0xffff0000, v72
    v_add_f32 v76, v76, v82
    v_add_f32 v77, v77, v83
    v_lshlrev_b32 v78, 16, v81
    v_and_b32 v79, 0xffff0000, v81
    v_lshlrev_b32 v82, 16, v73
    v_and_b32 v83, 0xffff0000, v73
    v_add_f32 v78, v78, v82
    v_add_f32 v79, v79, v83
    v_cvt_pk_bf16_f32 v80, v76, v77
    v_cvt_pk_bf16_f32 v81, v78, v79
    v_add_u32 v6, 4194400, v5
    buffer_store_dwordx2 v[80:81], v6, s[8:11], 0 offen
    v_add_u32 v6, 128, v5
    buffer_load_dwordx2 v[72:73], v6, s[44:47], 0 offen
    v_accvgpr_read_b32 v76, a16
    v_accvgpr_read_b32 v77, a17
    v_accvgpr_read_b32 v78, a18
    v_accvgpr_read_b32 v79, a19
    v_cvt_pk_bf16_f32 v80, v76, v77
    v_cvt_pk_bf16_f32 v81, v78, v79
    s_waitcnt vmcnt(0)
    v_lshlrev_b32 v76, 16, v80
    v_and_b32 v77, 0xffff0000, v80
    v_lshlrev_b32 v82, 16, v72
    v_and_b32 v83, 0xffff0000, v72
    v_add_f32 v76, v76, v82
    v_add_f32 v77, v77, v83
    v_lshlrev_b32 v78, 16, v81
    v_and_b32 v79, 0xffff0000, v81
    v_lshlrev_b32 v82, 16, v73
    v_and_b32 v83, 0xffff0000, v73
    v_add_f32 v78, v78, v82
    v_add_f32 v79, v79, v83
    v_cvt_pk_bf16_f32 v80, v76, v77
    v_cvt_pk_bf16_f32 v81, v78, v79
    v_add_u32 v6, 4194432, v5
    buffer_store_dwordx2 v[80:81], v6, s[8:11], 0 offen
    v_add_u32 v6, 20480, v5
    buffer_load_dwordx2 v[72:73], v6, s[44:47], 0 offen
    v_accvgpr_read_b32 v76, a20
    v_accvgpr_read_b32 v77, a21
    v_accvgpr_read_b32 v78, a22
    v_accvgpr_read_b32 v79, a23
    v_cvt_pk_bf16_f32 v80, v76, v77
    v_cvt_pk_bf16_f32 v81, v78, v79
    s_waitcnt vmcnt(0)
    v_lshlrev_b32 v76, 16, v80
    v_and_b32 v77, 0xffff0000, v80
    v_lshlrev_b32 v82, 16, v72
    v_and_b32 v83, 0xffff0000, v72
    v_add_f32 v76, v76, v82
    v_add_f32 v77, v77, v83
    v_lshlrev_b32 v78, 16, v81
    v_and_b32 v79, 0xffff0000, v81
    v_lshlrev_b32 v82, 16, v73
    v_and_b32 v83, 0xffff0000, v73
    v_add_f32 v78, v78, v82
    v_add_f32 v79, v79, v83
    v_cvt_pk_bf16_f32 v80, v76, v77
    v_cvt_pk_bf16_f32 v81, v78, v79
    v_add_u32 v6, 4214784, v5
    buffer_store_dwordx2 v[80:81], v6, s[8:11], 0 offen
    v_add_u32 v6, 20512, v5
    buffer_load_dwordx2 v[72:73], v6, s[44:47], 0 offen
    v_accvgpr_read_b32 v76, a24
    v_accvgpr_read_b32 v77, a25
    v_accvgpr_read_b32 v78, a26
    v_accvgpr_read_b32 v79, a27
    v_cvt_pk_bf16_f32 v80, v76, v77
    v_cvt_pk_bf16_f32 v81, v78, v79
    s_waitcnt vmcnt(0)
    v_lshlrev_b32 v76, 16, v80
    v_and_b32 v77, 0xffff0000, v80
    v_lshlrev_b32 v82, 16, v72
    v_and_b32 v83, 0xffff0000, v72
    v_add_f32 v76, v76, v82
    v_add_f32 v77, v77, v83
    v_lshlrev_b32 v78, 16, v81
    v_and_b32 v79, 0xffff0000, v81
    v_lshlrev_b32 v82, 16, v73
    v_and_b32 v83, 0xffff0000, v73
    v_add_f32 v78, v78, v82
    v_add_f32 v79, v79, v83
    v_cvt_pk_bf16_f32 v80, v76, v77
    v_cvt_pk_bf16_f32 v81, v78, v79
    v_add_u32 v6, 4214816, v5
    buffer_store_dwordx2 v[80:81], v6, s[8:11], 0 offen
    v_add_u32 v6, 20544, v5
    buffer_load_dwordx2 v[72:73], v6, s[44:47], 0 offen
    v_accvgpr_read_b32 v76, a28
    v_accvgpr_read_b32 v77, a29
    v_accvgpr_read_b32 v78, a30
    v_accvgpr_read_b32 v79, a31
    v_cvt_pk_bf16_f32 v80, v76, v77
    v_cvt_pk_bf16_f32 v81, v78, v79
    s_waitcnt vmcnt(0)
    v_lshlrev_b32 v76, 16, v80
    v_and_b32 v77, 0xffff0000, v80
    v_lshlrev_b32 v82, 16, v72
    v_and_b32 v83, 0xffff0000, v72
    v_add_f32 v76, v76, v82
    v_add_f32 v77, v77, v83
    v_lshlrev_b32 v78, 16, v81
    v_and_b32 v79, 0xffff0000, v81
    v_lshlrev_b32 v82, 16, v73
    v_and_b32 v83, 0xffff0000, v73
    v_add_f32 v78, v78, v82
    v_add_f32 v79, v79, v83
    v_cvt_pk_bf16_f32 v80, v76, v77
    v_cvt_pk_bf16_f32 v81, v78, v79
    v_add_u32 v6, 4214848, v5
    buffer_store_dwordx2 v[80:81], v6, s[8:11], 0 offen
    v_add_u32 v6, 20576, v5
    buffer_load_dwordx2 v[72:73], v6, s[44:47], 0 offen
    v_accvgpr_read_b32 v76, a32
    v_accvgpr_read_b32 v77, a33
    v_accvgpr_read_b32 v78, a34
    v_accvgpr_read_b32 v79, a35
    v_cvt_pk_bf16_f32 v80, v76, v77
    v_cvt_pk_bf16_f32 v81, v78, v79
    s_waitcnt vmcnt(0)
    v_lshlrev_b32 v76, 16, v80
    v_and_b32 v77, 0xffff0000, v80
    v_lshlrev_b32 v82, 16, v72
    v_and_b32 v83, 0xffff0000, v72
    v_add_f32 v76, v76, v82
    v_add_f32 v77, v77, v83
    v_lshlrev_b32 v78, 16, v81
    v_and_b32 v79, 0xffff0000, v81
    v_lshlrev_b32 v82, 16, v73
    v_and_b32 v83, 0xffff0000, v73
    v_add_f32 v78, v78, v82
    v_add_f32 v79, v79, v83
    v_cvt_pk_bf16_f32 v80, v76, v77
    v_cvt_pk_bf16_f32 v81, v78, v79
    v_add_u32 v6, 4214880, v5
    buffer_store_dwordx2 v[80:81], v6, s[8:11], 0 offen
    v_add_u32 v6, 20608, v5
    buffer_load_dwordx2 v[72:73], v6, s[44:47], 0 offen
    v_accvgpr_read_b32 v76, a36
    v_accvgpr_read_b32 v77, a37
    v_accvgpr_read_b32 v78, a38
    v_accvgpr_read_b32 v79, a39
    v_cvt_pk_bf16_f32 v80, v76, v77
    v_cvt_pk_bf16_f32 v81, v78, v79
    s_waitcnt vmcnt(0)
    v_lshlrev_b32 v76, 16, v80
    v_and_b32 v77, 0xffff0000, v80
    v_lshlrev_b32 v82, 16, v72
    v_and_b32 v83, 0xffff0000, v72
    v_add_f32 v76, v76, v82
    v_add_f32 v77, v77, v83
    v_lshlrev_b32 v78, 16, v81
    v_and_b32 v79, 0xffff0000, v81
    v_lshlrev_b32 v82, 16, v73
    v_and_b32 v83, 0xffff0000, v73
    v_add_f32 v78, v78, v82
    v_add_f32 v79, v79, v83
    v_cvt_pk_bf16_f32 v80, v76, v77
    v_cvt_pk_bf16_f32 v81, v78, v79
    v_add_u32 v6, 4214912, v5
    buffer_store_dwordx2 v[80:81], v6, s[8:11], 0 offen
wo_a1_kernel_end:
    s_endpgm
.section .rodata,"a"
.p2align 6
.amdhsa_kernel wo_a1_kernel
  .amdhsa_next_free_vgpr 136
  .amdhsa_next_free_sgpr 64
  .amdhsa_accum_offset 96
  .amdhsa_group_segment_fixed_size 0
  .amdhsa_kernarg_size 104
  .amdhsa_user_sgpr_count 2
  .amdhsa_user_sgpr_kernarg_segment_ptr 1
  .amdhsa_system_sgpr_workgroup_id_x 1
.end_amdhsa_kernel
.text
.globl lnf_kernel
.p2align 8
.type lnf_kernel,@function
lnf_kernel:
    s_cmp_ge_u32 s2, 128
    s_cbranch_scc1 lnf_kernel_end
    s_load_dwordx2 s[6:7], s[0:1], 96
    s_load_dwordx2 s[12:13], s[0:1], 96
    v_and_b32 v1, 63, v0
    v_lshrrev_b32 v4, 6, v0
    v_and_b32 v2, 15, v1
    v_lshrrev_b32 v3, 4, v1
    v_readfirstlane_b32 s3, v4
    s_waitcnt lgkmcnt(0)
    s_add_u32 s8, s6, 4194304
    s_addc_u32 s9, s7, 0
    s_mov_b32 s10, 2621440
    s_mov_b32 s11, 0x00020000
    s_add_u32 s16, s12, 59768832
    s_addc_u32 s17, s13, 0
    s_mov_b32 s18, 2621440
    s_mov_b32 s19, 0x00020000
    s_lshl_b32 s4, s2, 4
    v_add_u32 v5, s4, v2
    v_mul_u32_u24 v5, 1280, v5
    v_lshl_add_u32 v5, v3, 4, v5
    s_mul_i32 s5, s3, 320
    v_add_u32 v5, s5, v5
    buffer_load_dwordx4 v[8:11], v5, s[8:11], 0 offen offset:0
    buffer_load_dwordx4 v[12:15], v5, s[8:11], 0 offen offset:64
    buffer_load_dwordx4 v[16:19], v5, s[8:11], 0 offen offset:128
    buffer_load_dwordx4 v[20:23], v5, s[8:11], 0 offen offset:192
    buffer_load_dwordx4 v[24:27], v5, s[8:11], 0 offen offset:256
    v_lshlrev_b32 v6, 4, v2
    s_lshl_b32 s5, s3, 2
    v_add_u32 v7, s5, v6
    s_waitcnt vmcnt(0)
    v_lshlrev_b32 v28, 16, v8
    v_and_b32 v29, 0xffff0000, v8
    v_lshlrev_b32 v30, 16, v9
    v_and_b32 v31, 0xffff0000, v9
    v_lshlrev_b32 v32, 16, v10
    v_and_b32 v33, 0xffff0000, v10
    v_lshlrev_b32 v34, 16, v11
    v_and_b32 v35, 0xffff0000, v11
    v_lshlrev_b32 v36, 16, v12
    v_and_b32 v37, 0xffff0000, v12
    v_lshlrev_b32 v38, 16, v13
    v_and_b32 v39, 0xffff0000, v13
    v_lshlrev_b32 v40, 16, v14
    v_and_b32 v41, 0xffff0000, v14
    v_lshlrev_b32 v42, 16, v15
    v_and_b32 v43, 0xffff0000, v15
    v_lshlrev_b32 v44, 16, v16
    v_and_b32 v45, 0xffff0000, v16
    v_lshlrev_b32 v46, 16, v17
    v_and_b32 v47, 0xffff0000, v17
    v_lshlrev_b32 v48, 16, v18
    v_and_b32 v49, 0xffff0000, v18
    v_lshlrev_b32 v50, 16, v19
    v_and_b32 v51, 0xffff0000, v19
    v_lshlrev_b32 v52, 16, v20
    v_and_b32 v53, 0xffff0000, v20
    v_lshlrev_b32 v54, 16, v21
    v_and_b32 v55, 0xffff0000, v21
    v_lshlrev_b32 v56, 16, v22
    v_and_b32 v57, 0xffff0000, v22
    v_lshlrev_b32 v58, 16, v23
    v_and_b32 v59, 0xffff0000, v23
    v_lshlrev_b32 v60, 16, v24
    v_and_b32 v61, 0xffff0000, v24
    v_lshlrev_b32 v62, 16, v25
    v_and_b32 v63, 0xffff0000, v25
    v_lshlrev_b32 v64, 16, v26
    v_and_b32 v65, 0xffff0000, v26
    v_lshlrev_b32 v66, 16, v27
    v_and_b32 v67, 0xffff0000, v27
    v_add_f32 v68, v28, v29
    v_add_f32 v69, v30, v31
    v_add_f32 v68, v68, v32
    v_add_f32 v69, v69, v33
    v_add_f32 v68, v68, v34
    v_add_f32 v69, v69, v35
    v_add_f32 v68, v68, v36
    v_add_f32 v69, v69, v37
    v_add_f32 v68, v68, v38
    v_add_f32 v69, v69, v39
    v_add_f32 v68, v68, v40
    v_add_f32 v69, v69, v41
    v_add_f32 v68, v68, v42
    v_add_f32 v69, v69, v43
    v_add_f32 v68, v68, v44
    v_add_f32 v69, v69, v45
    v_add_f32 v68, v68, v46
    v_add_f32 v69, v69, v47
    v_add_f32 v68, v68, v48
    v_add_f32 v69, v69, v49
    v_add_f32 v68, v68, v50
    v_add_f32 v69, v69, v51
    v_add_f32 v68, v68, v52
    v_add_f32 v69, v69, v53
    v_add_f32 v68, v68, v54
    v_add_f32 v69, v69, v55
    v_add_f32 v68, v68, v56
    v_add_f32 v69, v69, v57
    v_add_f32 v68, v68, v58
    v_add_f32 v69, v69, v59
    v_add_f32 v68, v68, v60
    v_add_f32 v69, v69, v61
    v_add_f32 v68, v68, v62
    v_add_f32 v69, v69, v63
    v_add_f32 v68, v68, v64
    v_add_f32 v69, v69, v65
    v_add_f32 v68, v68, v66
    v_add_f32 v69, v69, v67
    v_add_f32 v68, v68, v69
    v_mov_b32 v69, v68
    s_nop 1
    v_permlane16_swap_b32 v68, v69
    v_add_f32 v68, v68, v69
    v_mov_b32 v69, v68
    s_nop 1
    v_permlane32_swap_b32 v68, v69
    v_add_f32 v68, v68, v69
    ds_write_b32 v7, v68 offset:0
    s_waitcnt lgkmcnt(0)
    s_barrier
    ds_read_b128 v[8:11], v6 offset:0
    s_waitcnt lgkmcnt(0)
    v_add_f32 v8, v8, v9
    v_add_f32 v10, v10, v11
    v_add_f32 v68, v8, v10
    v_mul_f32 v68, 0.0015625, v68
    v_sub_f32 v28, v28, v68
    v_sub_f32 v29, v29, v68
    v_sub_f32 v30, v30, v68
    v_sub_f32 v31, v31, v68
    v_sub_f32 v32, v32, v68
    v_sub_f32 v33, v33, v68
    v_sub_f32 v34, v34, v68
    v_sub_f32 v35, v35, v68
    v_sub_f32 v36, v36, v68
    v_sub_f32 v37, v37, v68
    v_sub_f32 v38, v38, v68
    v_sub_f32 v39, v39, v68
    v_sub_f32 v40, v40, v68
    v_sub_f32 v41, v41, v68
    v_sub_f32 v42, v42, v68
    v_sub_f32 v43, v43, v68
    v_sub_f32 v44, v44, v68
    v_sub_f32 v45, v45, v68
    v_sub_f32 v46, v46, v68
    v_sub_f32 v47, v47, v68
    v_sub_f32 v48, v48, v68
    v_sub_f32 v49, v49, v68
    v_sub_f32 v50, v50, v68
    v_sub_f32 v51, v51, v68
    v_sub_f32 v52, v52, v68
    v_sub_f32 v53, v53, v68
    v_sub_f32 v54, v54, v68
    v_sub_f32 v55, v55, v68
    v_sub_f32 v56, v56, v68
    v_sub_f32 v57, v57, v68
    v_sub_f32 v58, v58, v68
    v_sub_f32 v59, v59, v68
    v_sub_f32 v60, v60, v68
    v_sub_f32 v61, v61, v68
    v_sub_f32 v62, v62, v68
    v_sub_f32 v63, v63, v68
    v_sub_f32 v64, v64, v68
    v_sub_f32 v65, v65, v68
    v_sub_f32 v66, v66, v68
    v_sub_f32 v67, v67, v68
    v_mul_f32 v68, v28, v28
    v_mul_f32 v69, v29, v29
    v_fmac_f32 v68, v30, v30
    v_fmac_f32 v69, v31, v31
    v_fmac_f32 v68, v32, v32
    v_fmac_f32 v69, v33, v33
    v_fmac_f32 v68, v34, v34
    v_fmac_f32 v69, v35, v35
    v_fmac_f32 v68, v36, v36
    v_fmac_f32 v69, v37, v37
    v_fmac_f32 v68, v38, v38
    v_fmac_f32 v69, v39, v39
    v_fmac_f32 v68, v40, v40
    v_fmac_f32 v69, v41, v41
    v_fmac_f32 v68, v42, v42
    v_fmac_f32 v69, v43, v43
    v_fmac_f32 v68, v44, v44
    v_fmac_f32 v69, v45, v45
    v_fmac_f32 v68, v46, v46
    v_fmac_f32 v69, v47, v47
    v_fmac_f32 v68, v48, v48
    v_fmac_f32 v69, v49, v49
    v_fmac_f32 v68, v50, v50
    v_fmac_f32 v69, v51, v51
    v_fmac_f32 v68, v52, v52
    v_fmac_f32 v69, v53, v53
    v_fmac_f32 v68, v54, v54
    v_fmac_f32 v69, v55, v55
    v_fmac_f32 v68, v56, v56
    v_fmac_f32 v69, v57, v57
    v_fmac_f32 v68, v58, v58
    v_fmac_f32 v69, v59, v59
    v_fmac_f32 v68, v60, v60
    v_fmac_f32 v69, v61, v61
    v_fmac_f32 v68, v62, v62
    v_fmac_f32 v69, v63, v63
    v_fmac_f32 v68, v64, v64
    v_fmac_f32 v69, v65, v65
    v_fmac_f32 v68, v66, v66
    v_fmac_f32 v69, v67, v67
    v_add_f32 v68, v68, v69
    v_mov_b32 v69, v68
    s_nop 1
    v_permlane16_swap_b32 v68, v69
    v_add_f32 v68, v68, v69
    v_mov_b32 v69, v68
    s_nop 1
    v_permlane32_swap_b32 v68, v69
    v_add_f32 v68, v68, v69
    ds_write_b32 v7, v68 offset:256
    s_waitcnt lgkmcnt(0)
    s_barrier
    ds_read_b128 v[8:11], v6 offset:256
    s_waitcnt lgkmcnt(0)
    v_add_f32 v8, v8, v9
    v_add_f32 v10, v10, v11
    v_add_f32 v68, v8, v10
    v_mov_b32 v69, 0x3727c5ac
    v_fmac_f32 v69, 0.0015625, v68
    v_rsq_f32 v69, v69
    s_nop 0
    v_mul_f32 v28, v28, v69
    v_mul_f32 v29, v29, v69
    v_mul_f32 v30, v30, v69
    v_mul_f32 v31, v31, v69
    v_mul_f32 v32, v32, v69
    v_mul_f32 v33, v33, v69
    v_mul_f32 v34, v34, v69
    v_mul_f32 v35, v35, v69
    v_mul_f32 v36, v36, v69
    v_mul_f32 v37, v37, v69
    v_mul_f32 v38, v38, v69
    v_mul_f32 v39, v39, v69
    v_mul_f32 v40, v40, v69
    v_mul_f32 v41, v41, v69
    v_mul_f32 v42, v42, v69
    v_mul_f32 v43, v43, v69
    v_mul_f32 v44, v44, v69
    v_mul_f32 v45, v45, v69
    v_mul_f32 v46, v46, v69
    v_mul_f32 v47, v47, v69
    v_mul_f32 v48, v48, v69
    v_mul_f32 v49, v49, v69
    v_mul_f32 v50, v50, v69
    v_mul_f32 v51, v51, v69
    v_mul_f32 v52, v52, v69
    v_mul_f32 v53, v53, v69
    v_mul_f32 v54, v54, v69
    v_mul_f32 v55, v55, v69
    v_mul_f32 v56, v56, v69
    v_mul_f32 v57, v57, v69
    v_mul_f32 v58, v58, v69
    v_mul_f32 v59, v59, v69
    v_mul_f32 v60, v60, v69
    v_mul_f32 v61, v61, v69
    v_mul_f32 v62, v62, v69
    v_mul_f32 v63, v63, v69
    v_mul_f32 v64, v64, v69
    v_mul_f32 v65, v65, v69
    v_mul_f32 v66, v66, v69
    v_mul_f32 v67, v67, v69
    v_cvt_pk_bf16_f32 v8, v28, v29
    v_cvt_pk_bf16_f32 v9, v30, v31
    v_cvt_pk_bf16_f32 v10, v32, v33
    v_cvt_pk_bf16_f32 v11, v34, v35
    v_cvt_pk_bf16_f32 v12, v36, v37
    v_cvt_pk_bf16_f32 v13, v38, v39
    v_cvt_pk_bf16_f32 v14, v40, v41
    v_cvt_pk_bf16_f32 v15, v42, v43
    v_cvt_pk_bf16_f32 v16, v44, v45
    v_cvt_pk_bf16_f32 v17, v46, v47
    v_cvt_pk_bf16_f32 v18, v48, v49
    v_cvt_pk_bf16_f32 v19, v50, v51
    v_cvt_pk_bf16_f32 v20, v52, v53
    v_cvt_pk_bf16_f32 v21, v54, v55
    v_cvt_pk_bf16_f32 v22, v56, v57
    v_cvt_pk_bf16_f32 v23, v58, v59
    v_cvt_pk_bf16_f32 v24, v60, v61
    v_cvt_pk_bf16_f32 v25, v62, v63
    v_cvt_pk_bf16_f32 v26, v64, v65
    v_cvt_pk_bf16_f32 v27, v66, v67
    s_mul_i32 s4, s2, 20480
    s_mul_i32 s5, s3, 5120
    s_add_u32 s4, s4, s5
    v_lshlrev_b32 v5, 4, v1
    buffer_store_dwordx4 v[8:11], v5, s[16:19], s4 offen offset:0
    buffer_store_dwordx4 v[12:15], v5, s[16:19], s4 offen offset:1024
    buffer_store_dwordx4 v[16:19], v5, s[16:19], s4 offen offset:2048
    buffer_store_dwordx4 v[20:23], v5, s[16:19], s4 offen offset:3072
    s_add_u32 s4, s4, 4096
    buffer_store_dwordx4 v[24:27], v5, s[16:19], s4 offen offset:0
lnf_kernel_end:
    s_endpgm
.section .rodata,"a"
.p2align 6
.amdhsa_kernel lnf_kernel
  .amdhsa_next_free_vgpr 72
  .amdhsa_next_free_sgpr 40
  .amdhsa_accum_offset 72
  .amdhsa_group_segment_fixed_size 0
  .amdhsa_kernarg_size 104
  .amdhsa_user_sgpr_count 2
  .amdhsa_user_sgpr_kernarg_segment_ptr 1
  .amdhsa_system_sgpr_workgroup_id_x 1
.end_amdhsa_kernel
.text
.globl clr_kernel
.p2align 8
.type clr_kernel,@function
clr_kernel:
    s_cmp_ge_u32 s2, 1042
    s_cbranch_scc1 clr_kernel_end
    s_load_dwordx2 s[4:5], s[0:1], 96
    s_waitcnt lgkmcnt(0)
    s_add_u32 s8, s4, 117440512
    s_addc_u32 s9, s5, 0
    s_mov_b32 s10, 34136064
    s_mov_b32 s11, 0x00020000
    s_mul_i32 s12, s2, 32768
    v_lshlrev_b32 v1, 4, v0
    v_add_u32 v1, s12, v1
    v_mov_b32 v4, -1
    v_mov_b32 v5, -1
    v_mov_b32 v6, -1
    v_mov_b32 v7, -1
    s_mov_b32 s13, 0
    buffer_store_dwordx4 v[4:7], v1, s[8:11], s13 offen
    s_mov_b32 s13, 4096
    buffer_store_dwordx4 v[4:7], v1, s[8:11], s13 offen
    s_mov_b32 s13, 8192
    buffer_store_dwordx4 v[4:7], v1, s[8:11], s13 offen
    s_mov_b32 s13, 12288
    buffer_store_dwordx4 v[4:7], v1, s[8:11], s13 offen
    s_mov_b32 s13, 16384
    buffer_store_dwordx4 v[4:7], v1, s[8:11], s13 offen
    s_mov_b32 s13, 20480
    buffer_store_dwordx4 v[4:7], v1, s[8:11], s13 offen
    s_mov_b32 s13, 24576
    buffer_store_dwordx4 v[4:7], v1, s[8:11], s13 offen
    s_mov_b32 s13, 28672
    buffer_store_dwordx4 v[4:7], v1, s[8:11], s13 offen
clr_kernel_end:
    s_endpgm
.section .rodata,"a"
.p2align 6
.amdhsa_kernel clr_kernel
  .amdhsa_next_free_vgpr 16
  .amdhsa_next_free_sgpr 24
  .amdhsa_accum_offset 16
  .amdhsa_group_segment_fixed_size 0
  .amdhsa_kernarg_size 104
  .amdhsa_user_sgpr_count 2
  .amdhsa_user_sgpr_kernarg_segment_ptr 1
  .amdhsa_system_sgpr_workgroup_id_x 1
.end_amdhsa_kernel
.text
.globl chain1_kernel
.p2align 8
.type chain1_kernel,@function
chain1_kernel:
    s_cmp_ge_u32 s2, 232
    s_cbranch_scc1 chain1_kernel_end
    s_load_dwordx2 s[4:5], s[0:1], 96
    s_load_dwordx2 s[6:7], s[0:1], 32
    v_and_b32 v1, 63, v0
    v_lshrrev_b32 v4, 6, v0
    v_and_b32 v2, 15, v1
    v_lshrrev_b32 v3, 4, v1
    v_readfirstlane_b32 s3, v4
    s_mov_b32 s60, 131072
    s_waitcnt lgkmcnt(0)
    s_mov_b32 s8, s4
    s_mov_b32 s9, s5
    s_mov_b32 s10, 268435456
    s_mov_b32 s11, 0x00020000
    s_mov_b32 s20, s6
    s_mov_b32 s21, s7
    s_mov_b32 s22, 10240
    s_mov_b32 s23, 0x00020000
    s_cmp_ge_u32 s2, 200
    s_cbranch_scc1 chain1_kernel_roleO
    s_cmp_ge_u32 s2, 104
    s_cbranch_scc1 chain1_kernel_roleP
    s_cmp_ge_u32 s2, 64
    s_cbranch_scc1 chain1_kernel_roleR
    s_cmp_ge_u32 s2, 32
    s_cbranch_scc1 chain1_kernel_roleV
    s_mov_b32 s44, s2
    s_load_dwordx2 s[6:7], s[0:1], 40
    s_load_dwordx2 s[24:25], s[0:1], 48
    s_waitcnt lgkmcnt(0)
    s_mov_b32 s12, s6
    s_mov_b32 s13, s7
    s_mov_b32 s14, 7864320
    s_mov_b32 s15, 0x00020000
    s_mov_b32 s16, s24
    s_mov_b32 s17, s25
    s_mov_b32 s18, 7864320
    s_mov_b32 s19, 0x00020000
    v_add_u32 v16, 0, v0
    s_mov_b32 s24, 683
    v_mul_lo_u32 v17, v16, s24
    v_lshrrev_b32 v17, 14, v17
    v_mul_u32_u24 v18, 24, v17
    v_sub_u32 v18, v16, v18
    s_mov_b32 s24, 12288
    v_mul_lo_u32 v4, v17, s24
    v_lshl_add_u32 v4, v18, 4, v4
    v_mul_u32_u24 v10, 400, v17
    v_lshl_add_u32 v10, v18, 4, v10
    v_add_u32 v10, 106496, v10
    v_add_u32 v16, 256, v0
    s_mov_b32 s24, 683
    v_mul_lo_u32 v17, v16, s24
    v_lshrrev_b32 v17, 14, v17
    v_mul_u32_u24 v18, 24, v17
    v_sub_u32 v18, v16, v18
    s_mov_b32 s24, 12288
    v_mul_lo_u32 v5, v17, s24
    v_lshl_add_u32 v5, v18, 4, v5
    v_mul_u32_u24 v11, 400, v17
    v_lshl_add_u32 v11, v18, 4, v11
    v_add_u32 v11, 106496, v11
    v_add_u32 v16, 512, v0
    s_mov_b32 s24, 683
    v_mul_lo_u32 v17, v16, s24
    v_lshrrev_b32 v17, 14, v17
    v_mul_u32_u24 v18, 24, v17
    v_sub_u32 v18, v16, v18
    s_mov_b32 s24, 12288
    v_mul_lo_u32 v6, v17, s24
    v_lshl_add_u32 v6, v18, 4, v6
    v_mul_u32_u24 v12, 400, v17
    v_lshl_add_u32 v12, v18, 4, v12
    v_add_u32 v12, 106496, v12
    v_add_u32 v16, 768, v0
    s_mov_b32 s24, 683
    v_mul_lo_u32 v17, v16, s24
    v_lshrrev_b32 v17, 14, v17
    v_mul_u32_u24 v18, 24, v17
    v_sub_u32 v18, v16, v18
    s_mov_b32 s24, 12288
    v_mul_lo_u32 v7, v17, s24
    v_lshl_add_u32 v7, v18, 4, v7
    v_mul_u32_u24 v13, 400, v17
    v_lshl_add_u32 v13, v18, 4, v13
    v_add_u32 v13, 106496, v13
    v_add_u32 v16, 1024, v0
    s_mov_b32 s24, 683
    v_mul_lo_u32 v17, v16, s24
    v_lshrrev_b32 v17, 14, v17
    v_mul_u32_u24 v18, 24, v17
    v_sub_u32 v18, v16, v18
    s_mov_b32 s24, 12288
    v_mul_lo_u32 v8, v17, s24
    v_lshl_add_u32 v8, v18, 4, v8
    v_mul_u32_u24 v14, 400, v17
    v_lshl_add_u32 v14, v18, 4, v14
    v_add_u32 v14, 106496, v14
    v_add_u32 v16, 1280, v0
    s_mov_b32 s24, 683
    v_mul_lo_u32 v17, v16, s24
    v_lshrrev_b32 v17, 14, v17
    v_mul_u32_u24 v18, 24, v17
    v_sub_u32 v18, v16, v18
    s_mov_b32 s24, 12288
    v_mul_lo_u32 v9, v17, s24
    v_lshl_add_u32 v9, v18, 4, v9
    v_mul_u32_u24 v15, 400, v17
    v_lshl_add_u32 v15, v18, 4, v15
    v_add_u32 v15, 106496, v15
    v_lshrrev_b32 v17, 1, v3
    v_lshlrev_b32 v17, 4, v17
    v_and_b32 v18, 1, v3
    v_lshl_add_u32 v17, v18, 2, v17
    v_lshrrev_b32 v18, 2, v2
    v_and_b32 v19, 1, v18
    v_add_u32 v17, v17, v19
    v_lshrrev_b32 v18, 1, v18
    v_lshl_add_u32 v17, v18, 3, v17
    v_mul_u32_u24 v16, 400, v17
    v_and_b32 v18, 3, v2
    v_lshl_add_u32 v16, v18, 3, v16
    v_add_u32 v16, 106496, v16
    s_mul_i32 s24, s3, 96
    v_add_u32 v16, s24, v16
    v_lshlrev_b32 v17, 4, v1
    s_mul_i32 s24, s3, 20480
    s_add_u32 s24, s24, 24576
    v_add_u32 v17, s24, v17
    s_mul_i32 s45, s44, 384
    s_add_u32 s46, s45, 0
    buffer_load_dwordx4 v[24:27], v4, s[12:15], s46 offen
    buffer_load_dwordx4 v[28:31], v5, s[12:15], s46 offen
    buffer_load_dwordx4 v[32:35], v6, s[12:15], s46 offen
    buffer_load_dwordx4 v[36:39], v7, s[12:15], s46 offen
    buffer_load_dwordx4 v[40:43], v8, s[12:15], s46 offen
    buffer_load_dwordx4 v[44:47], v9, s[12:15], s46 offen
    s_add_u32 s46, s45, 0
    buffer_load_dwordx4 v[48:51], v4, s[16:19], s46 offen
    buffer_load_dwordx4 v[52:55], v5, s[16:19], s46 offen
    buffer_load_dwordx4 v[56:59], v6, s[16:19], s46 offen
    buffer_load_dwordx4 v[60:63], v7, s[16:19], s46 offen
    buffer_load_dwordx4 v[64:67], v8, s[16:19], s46 offen
    buffer_load_dwordx4 v[68:71], v9, s[16:19], s46 offen
    s_waitcnt vmcnt(6)
    ds_write_b128 v10, v[24:27]
    ds_write_b128 v11, v[28:31]
    ds_write_b128 v12, v[32:35]
    ds_write_b128 v13, v[36:39]
    ds_write_b128 v14, v[40:43]
    ds_write_b128 v15, v[44:47]
    s_add_u32 s46, s45, 786432
    buffer_load_dwordx4 v[72:75], v4, s[12:15], s46 offen
    buffer_load_dwordx4 v[76:79], v5, s[12:15], s46 offen
    buffer_load_dwordx4 v[80:83], v6, s[12:15], s46 offen
    buffer_load_dwordx4 v[84:87], v7, s[12:15], s46 offen
    buffer_load_dwordx4 v[88:91], v8, s[12:15], s46 offen
    buffer_load_dwordx4 v[92:95], v9, s[12:15], s46 offen
    s_waitcnt lgkmcnt(0)
    s_barrier
    ds_read_b64_tr_b16 a[0:1], v16 offset:0
    ds_read_b64_tr_b16 a[2:3], v16 offset:800
    ds_read_b64_tr_b16 a[4:5], v16 offset:12800
    ds_read_b64_tr_b16 a[6:7], v16 offset:13600
    ds_read_b64_tr_b16 a[80:81], v16 offset:32
    ds_read_b64_tr_b16 a[82:83], v16 offset:832
    ds_read_b64_tr_b16 a[84:85], v16 offset:12832
    ds_read_b64_tr_b16 a[86:87], v16 offset:13632
    ds_read_b64_tr_b16 a[160:161], v16 offset:64
    ds_read_b64_tr_b16 a[162:163], v16 offset:864
    ds_read_b64_tr_b16 a[164:165], v16 offset:12864
    ds_read_b64_tr_b16 a[166:167], v16 offset:13664
    s_waitcnt lgkmcnt(0)
    s_barrier
    s_waitcnt vmcnt(6)
    ds_write_b128 v10, v[48:51]
    ds_write_b128 v11, v[52:55]
    ds_write_b128 v12, v[56:59]
    ds_write_b128 v13, v[60:63]
    ds_write_b128 v14, v[64:67]
    ds_write_b128 v15, v[68:71]
    s_add_u32 s46, s45, 786432
    buffer_load_dwordx4 v[24:27], v4, s[16:19], s46 offen
    buffer_load_dwordx4 v[28:31], v5, s[16:19], s46 offen
    buffer_load_dwordx4 v[32:35], v6, s[16:19], s46 offen
    buffer_load_dwordx4 v[36:39], v7, s[16:19], s46 offen
    buffer_load_dwordx4 v[40:43], v8, s[16:19], s46 offen
    buffer_load_dwordx4 v[44:47], v9, s[16:19], s46 offen
    s_waitcnt lgkmcnt(0)
    s_barrier
    ds_read_b64_tr_b16 v[96:97], v16 offset:0
    ds_read_b64_tr_b16 v[98:99], v16 offset:800
    ds_read_b64_tr_b16 v[100:101], v16 offset:12800
    ds_read_b64_tr_b16 v[102:103], v16 offset:13600
    ds_read_b64_tr_b16 v[176:177], v16 offset:32
    ds_read_b64_tr_b16 v[178:179], v16 offset:832
    ds_read_b64_tr_b16 v[180:181], v16 offset:12832
    ds_read_b64_tr_b16 v[182:183], v16 offset:13632
    ds_read_b64_tr_b16 v[48:49], v16 offset:64
    ds_read_b64_tr_b16 v[50:51], v16 offset:864
    ds_read_b64_tr_b16 v[52:53], v16 offset:12864
    ds_read_b64_tr_b16 v[54:55], v16 offset:13664
    s_waitcnt lgkmcnt(0)
    ds_write_b128 v17, v[48:51] offset:0
    ds_write_b128 v17, v[52:55] offset:1024
    s_waitcnt lgkmcnt(0)
    s_barrier
    s_waitcnt vmcnt(6)
    ds_write_b128 v10, v[72:75]
    ds_write_b128 v11, v[76:79]
    ds_write_b128 v12, v[80:83]
    ds_write_b128 v13, v[84:87]
    ds_write_b128 v14, v[88:91]
    ds_write_b128 v15, v[92:95]
    s_add_u32 s46, s45, 1572864
    buffer_load_dwordx4 v[48:51], v4, s[12:15], s46 offen
    buffer_load_dwordx4 v[52:55], v5, s[12:15], s46 offen
    buffer_load_dwordx4 v[56:59], v6, s[12:15], s46 offen
    buffer_load_dwordx4 v[60:63], v7, s[12:15], s46 offen
    buffer_load_dwordx4 v[64:67], v8, s[12:15], s46 offen
    buffer_load_dwordx4 v[68:71], v9, s[12:15], s46 offen
    s_waitcnt lgkmcnt(0)
    s_barrier
    ds_read_b64_tr_b16 a[8:9], v16 offset:0
    ds_read_b64_tr_b16 a[10:11], v16 offset:800
    ds_read_b64_tr_b16 a[12:13], v16 offset:12800
    ds_read_b64_tr_b16 a[14:15], v16 offset:13600
    ds_read_b64_tr_b16 a[88:89], v16 offset:32
    ds_read_b64_tr_b16 a[90:91], v16 offset:832
    ds_read_b64_tr_b16 a[92:93], v16 offset:12832
    ds_read_b64_tr_b16 a[94:95], v16 offset:13632
    ds_read_b64_tr_b16 a[168:169], v16 offset:64
    ds_read_b64_tr_b16 a[170:171], v16 offset:864
    ds_read_b64_tr_b16 a[172:173], v16 offset:12864
    ds_read_b64_tr_b16 a[174:175], v16 offset:13664
    s_waitcnt lgkmcnt(0)
    s_barrier
    s_waitcnt vmcnt(6)
    ds_write_b128 v10, v[24:27]
    ds_write_b128 v11, v[28:31]
    ds_write_b128 v12, v[32:35]
    ds_write_b128 v13, v[36:39]
    ds_write_b128 v14, v[40:43]
    ds_write_b128 v15, v[44:47]
    s_add_u32 s46, s45, 1572864
    buffer_load_dwordx4 v[72:75], v4, s[16:19], s46 offen
    buffer_load_dwordx4 v[76:79], v5, s[16:19], s46 offen
    buffer_load_dwordx4 v[80:83], v6, s[16:19], s46 offen
    buffer_load_dwordx4 v[84:87], v7, s[16:19], s46 offen
    buffer_load_dwordx4 v[88:91], v8, s[16:19], s46 offen
    buffer_load_dwordx4 v[92:95], v9, s[16:19], s46 offen
    s_waitcnt lgkmcnt(0)
    s_barrier
    ds_read_b64_tr_b16 v[104:105], v16 offset:0
    ds_read_b64_tr_b16 v[106:107], v16 offset:800
    ds_read_b64_tr_b16 v[108:109], v16 offset:12800
    ds_read_b64_tr_b16 v[110:111], v16 offset:13600
    ds_read_b64_tr_b16 v[184:185], v16 offset:32
    ds_read_b64_tr_b16 v[186:187], v16 offset:832
    ds_read_b64_tr_b16 v[188:189], v16 offset:12832
    ds_read_b64_tr_b16 v[190:191], v16 offset:13632
    ds_read_b64_tr_b16 v[24:25], v16 offset:64
    ds_read_b64_tr_b16 v[26:27], v16 offset:864
    ds_read_b64_tr_b16 v[28:29], v16 offset:12864
    ds_read_b64_tr_b16 v[30:31], v16 offset:13664
    s_waitcnt lgkmcnt(0)
    ds_write_b128 v17, v[24:27] offset:2048
    ds_write_b128 v17, v[28:31] offset:3072
    s_waitcnt lgkmcnt(0)
    s_barrier
    s_waitcnt vmcnt(6)
    ds_write_b128 v10, v[48:51]
    ds_write_b128 v11, v[52:55]
    ds_write_b128 v12, v[56:59]
    ds_write_b128 v13, v[60:63]
    ds_write_b128 v14, v[64:67]
    ds_write_b128 v15, v[68:71]
    s_add_u32 s46, s45, 2359296
    buffer_load_dwordx4 v[24:27], v4, s[12:15], s46 offen
    buffer_load_dwordx4 v[28:31], v5, s[12:15], s46 offen
    buffer_load_dwordx4 v[32:35], v6, s[12:15], s46 offen
    buffer_load_dwordx4 v[36:39], v7, s[12:15], s46 offen
    buffer_load_dwordx4 v[40:43], v8, s[12:15], s46 offen
    buffer_load_dwordx4 v[44:47], v9, s[12:15], s46 offen
    s_waitcnt lgkmcnt(0)
    s_barrier
    ds_read_b64_tr_b16 a[16:17], v16 offset:0
    ds_read_b64_tr_b16 a[18:19], v16 offset:800
    ds_read_b64_tr_b16 a[20:21], v16 offset:12800
    ds_read_b64_tr_b16 a[22:23], v16 offset:13600
    ds_read_b64_tr_b16 a[96:97], v16 offset:32
    ds_read_b64_tr_b16 a[98:99], v16 offset:832
    ds_read_b64_tr_b16 a[100:101], v16 offset:12832
    ds_read_b64_tr_b16 a[102:103], v16 offset:13632
    ds_read_b64_tr_b16 a[176:177], v16 offset:64
    ds_read_b64_tr_b16 a[178:179], v16 offset:864
    ds_read_b64_tr_b16 a[180:181], v16 offset:12864
    ds_read_b64_tr_b16 a[182:183], v16 offset:13664
    s_waitcnt lgkmcnt(0)
    s_barrier
    s_waitcnt vmcnt(6)
    ds_write_b128 v10, v[72:75]
    ds_write_b128 v11, v[76:79]
    ds_write_b128 v12, v[80:83]
    ds_write_b128 v13, v[84:87]
    ds_write_b128 v14, v[88:91]
    ds_write_b128 v15, v[92:95]
    s_add_u32 s46, s45, 2359296
    buffer_load_dwordx4 v[48:51], v4, s[16:19], s46 offen
    buffer_load_dwordx4 v[52:55], v5, s[16:19], s46 offen
    buffer_load_dwordx4 v[56:59], v6, s[16:19], s46 offen
    buffer_load_dwordx4 v[60:63], v7, s[16:19], s46 offen
    buffer_load_dwordx4 v[64:67], v8, s[16:19], s46 offen
    buffer_load_dwordx4 v[68:71], v9, s[16:19], s46 offen
    s_waitcnt lgkmcnt(0)
    s_barrier
    ds_read_b64_tr_b16 v[112:113], v16 offset:0
    ds_read_b64_tr_b16 v[114:115], v16 offset:800
    ds_read_b64_tr_b16 v[116:117], v16 offset:12800
    ds_read_b64_tr_b16 v[118:119], v16 offset:13600
    ds_read_b64_tr_b16 v[192:193], v16 offset:32
    ds_read_b64_tr_b16 v[194:195], v16 offset:832
    ds_read_b64_tr_b16 v[196:197], v16 offset:12832
    ds_read_b64_tr_b16 v[198:199], v16 offset:13632
    ds_read_b64_tr_b16 v[72:73], v16 offset:64
    ds_read_b64_tr_b16 v[74:75], v16 offset:864
    ds_read_b64_tr_b16 v[76:77], v16 offset:12864
    ds_read_b64_tr_b16 v[78:79], v16 offset:13664
    s_waitcnt lgkmcnt(0)
    ds_write_b128 v17, v[72:75] offset:4096
    ds_write_b128 v17, v[76:79] offset:5120
    s_waitcnt lgkmcnt(0)
    s_barrier
    s_waitcnt vmcnt(6)
    ds_write_b128 v10, v[24:27]
    ds_write_b128 v11, v[28:31]
    ds_write_b128 v12, v[32:35]
    ds_write_b128 v13, v[36:39]
    ds_write_b128 v14, v[40:43]
    ds_write_b128 v15, v[44:47]
    s_add_u32 s46, s45, 3145728
    buffer_load_dwordx4 v[72:75], v4, s[12:15], s46 offen
    buffer_load_dwordx4 v[76:79], v5, s[12:15], s46 offen
    buffer_load_dwordx4 v[80:83], v6, s[12:15], s46 offen
    buffer_load_dwordx4 v[84:87], v7, s[12:15], s46 offen
    buffer_load_dwordx4 v[88:91], v8, s[12:15], s46 offen
    buffer_load_dwordx4 v[92:95], v9, s[12:15], s46 offen
    s_waitcnt lgkmcnt(0)
    s_barrier
    ds_read_b64_tr_b16 a[24:25], v16 offset:0
    ds_read_b64_tr_b16 a[26:27], v16 offset:800
    ds_read_b64_tr_b16 a[28:29], v16 offset:12800
    ds_read_b64_tr_b16 a[30:31], v16 offset:13600
    ds_read_b64_tr_b16 a[104:105], v16 offset:32
    ds_read_b64_tr_b16 a[106:107], v16 offset:832
    ds_read_b64_tr_b16 a[108:109], v16 offset:12832
    ds_read_b64_tr_b16 a[110:111], v16 offset:13632
    ds_read_b64_tr_b16 a[184:185], v16 offset:64
    ds_read_b64_tr_b16 a[186:187], v16 offset:864
    ds_read_b64_tr_b16 a[188:189], v16 offset:12864
    ds_read_b64_tr_b16 a[190:191], v16 offset:13664
    s_waitcnt lgkmcnt(0)
    s_barrier
    s_waitcnt vmcnt(6)
    ds_write_b128 v10, v[48:51]
    ds_write_b128 v11, v[52:55]
    ds_write_b128 v12, v[56:59]
    ds_write_b128 v13, v[60:63]
    ds_write_b128 v14, v[64:67]
    ds_write_b128 v15, v[68:71]
    s_add_u32 s46, s45, 3145728
    buffer_load_dwordx4 v[24:27], v4, s[16:19], s46 offen
    buffer_load_dwordx4 v[28:31], v5, s[16:19], s46 offen
    buffer_load_dwordx4 v[32:35], v6, s[16:19], s46 offen
    buffer_load_dwordx4 v[36:39], v7, s[16:19], s46 offen
    buffer_load_dwordx4 v[40:43], v8, s[16:19], s46 offen
    buffer_load_dwordx4 v[44:47], v9, s[16:19], s46 offen
    s_waitcnt lgkmcnt(0)
    s_barrier
    ds_read_b64_tr_b16 v[120:121], v16 offset:0
    ds_read_b64_tr_b16 v[122:123], v16 offset:800
    ds_read_b64_tr_b16 v[124:125], v16 offset:12800
    ds_read_b64_tr_b16 v[126:127], v16 offset:13600
    ds_read_b64_tr_b16 v[200:201], v16 offset:32
    ds_read_b64_tr_b16 v[202:203], v16 offset:832
    ds_read_b64_tr_b16 v[204:205], v16 offset:12832
    ds_read_b64_tr_b16 v[206:207], v16 offset:13632
    ds_read_b64_tr_b16 v[48:49], v16 offset:64
    ds_read_b64_tr_b16 v[50:51], v16 offset:864
    ds_read_b64_tr_b16 v[52:53], v16 offset:12864
    ds_read_b64_tr_b16 v[54:55], v16 offset:13664
    s_waitcnt lgkmcnt(0)
    ds_write_b128 v17, v[48:51] offset:6144
    ds_write_b128 v17, v[52:55] offset:7168
    s_waitcnt lgkmcnt(0)
    s_barrier
    s_waitcnt vmcnt(6)
    ds_write_b128 v10, v[72:75]
    ds_write_b128 v11, v[76:79]
    ds_write_b128 v12, v[80:83]
    ds_write_b128 v13, v[84:87]
    ds_write_b128 v14, v[88:91]
    ds_write_b128 v15, v[92:95]
    s_add_u32 s46, s45, 3932160
    buffer_load_dwordx4 v[48:51], v4, s[12:15], s46 offen
    buffer_load_dwordx4 v[52:55], v5, s[12:15], s46 offen
    buffer_load_dwordx4 v[56:59], v6, s[12:15], s46 offen
    buffer_load_dwordx4 v[60:63], v7, s[12:15], s46 offen
    buffer_load_dwordx4 v[64:67], v8, s[12:15], s46 offen
    buffer_load_dwordx4 v[68:71], v9, s[12:15], s46 offen
    s_waitcnt lgkmcnt(0)
    s_barrier
    ds_read_b64_tr_b16 a[32:33], v16 offset:0
    ds_read_b64_tr_b16 a[34:35], v16 offset:800
    ds_read_b64_tr_b16 a[36:37], v16 offset:12800
    ds_read_b64_tr_b16 a[38:39], v16 offset:13600
    ds_read_b64_tr_b16 a[112:113], v16 offset:32
    ds_read_b64_tr_b16 a[114:115], v16 offset:832
    ds_read_b64_tr_b16 a[116:117], v16 offset:12832
    ds_read_b64_tr_b16 a[118:119], v16 offset:13632
    ds_read_b64_tr_b16 a[192:193], v16 offset:64
    ds_read_b64_tr_b16 a[194:195], v16 offset:864
    ds_read_b64_tr_b16 a[196:197], v16 offset:12864
    ds_read_b64_tr_b16 a[198:199], v16 offset:13664
    s_waitcnt lgkmcnt(0)
    s_barrier
    s_waitcnt vmcnt(6)
    ds_write_b128 v10, v[24:27]
    ds_write_b128 v11, v[28:31]
    ds_write_b128 v12, v[32:35]
    ds_write_b128 v13, v[36:39]
    ds_write_b128 v14, v[40:43]
    ds_write_b128 v15, v[44:47]
    s_add_u32 s46, s45, 3932160
    buffer_load_dwordx4 v[72:75], v4, s[16:19], s46 offen
    buffer_load_dwordx4 v[76:79], v5, s[16:19], s46 offen
    buffer_load_dwordx4 v[80:83], v6, s[16:19], s46 offen
    buffer_load_dwordx4 v[84:87], v7, s[16:19], s46 offen
    buffer_load_dwordx4 v[88:91], v8, s[16:19], s46 offen
    buffer_load_dwordx4 v[92:95], v9, s[16:19], s46 offen
    s_waitcnt lgkmcnt(0)
    s_barrier
    ds_read_b64_tr_b16 v[128:129], v16 offset:0
    ds_read_b64_tr_b16 v[130:131], v16 offset:800
    ds_read_b64_tr_b16 v[132:133], v16 offset:12800
    ds_read_b64_tr_b16 v[134:135], v16 offset:13600
    ds_read_b64_tr_b16 v[208:209], v16 offset:32
    ds_read_b64_tr_b16 v[210:211], v16 offset:832
    ds_read_b64_tr_b16 v[212:213], v16 offset:12832
    ds_read_b64_tr_b16 v[214:215], v16 offset:13632
    ds_read_b64_tr_b16 v[24:25], v16 offset:64
    ds_read_b64_tr_b16 v[26:27], v16 offset:864
    ds_read_b64_tr_b16 v[28:29], v16 offset:12864
    ds_read_b64_tr_b16 v[30:31], v16 offset:13664
    s_waitcnt lgkmcnt(0)
    ds_write_b128 v17, v[24:27] offset:8192
    ds_write_b128 v17, v[28:31] offset:9216
    s_waitcnt lgkmcnt(0)
    s_barrier
    s_waitcnt vmcnt(6)
    ds_write_b128 v10, v[48:51]
    ds_write_b128 v11, v[52:55]
    ds_write_b128 v12, v[56:59]
    ds_write_b128 v13, v[60:63]
    ds_write_b128 v14, v[64:67]
    ds_write_b128 v15, v[68:71]
    s_add_u32 s46, s45, 4718592
    buffer_load_dwordx4 v[24:27], v4, s[12:15], s46 offen
    buffer_load_dwordx4 v[28:31], v5, s[12:15], s46 offen
    buffer_load_dwordx4 v[32:35], v6, s[12:15], s46 offen
    buffer_load_dwordx4 v[36:39], v7, s[12:15], s46 offen
    buffer_load_dwordx4 v[40:43], v8, s[12:15], s46 offen
    buffer_load_dwordx4 v[44:47], v9, s[12:15], s46 offen
    s_waitcnt lgkmcnt(0)
    s_barrier
    ds_read_b64_tr_b16 a[40:41], v16 offset:0
    ds_read_b64_tr_b16 a[42:43], v16 offset:800
    ds_read_b64_tr_b16 a[44:45], v16 offset:12800
    ds_read_b64_tr_b16 a[46:47], v16 offset:13600
    ds_read_b64_tr_b16 a[120:121], v16 offset:32
    ds_read_b64_tr_b16 a[122:123], v16 offset:832
    ds_read_b64_tr_b16 a[124:125], v16 offset:12832
    ds_read_b64_tr_b16 a[126:127], v16 offset:13632
    ds_read_b64_tr_b16 a[200:201], v16 offset:64
    ds_read_b64_tr_b16 a[202:203], v16 offset:864
    ds_read_b64_tr_b16 a[204:205], v16 offset:12864
    ds_read_b64_tr_b16 a[206:207], v16 offset:13664
    s_waitcnt lgkmcnt(0)
    s_barrier
    s_waitcnt vmcnt(6)
    ds_write_b128 v10, v[72:75]
    ds_write_b128 v11, v[76:79]
    ds_write_b128 v12, v[80:83]
    ds_write_b128 v13, v[84:87]
    ds_write_b128 v14, v[88:91]
    ds_write_b128 v15, v[92:95]
    s_add_u32 s46, s45, 4718592
    buffer_load_dwordx4 v[48:51], v4, s[16:19], s46 offen
    buffer_load_dwordx4 v[52:55], v5, s[16:19], s46 offen
    buffer_load_dwordx4 v[56:59], v6, s[16:19], s46 offen
    buffer_load_dwordx4 v[60:63], v7, s[16:19], s46 offen
    buffer_load_dwordx4 v[64:67], v8, s[16:19], s46 offen
    buffer_load_dwordx4 v[68:71], v9, s[16:19], s46 offen
    s_waitcnt lgkmcnt(0)
    s_barrier
    ds_read_b64_tr_b16 v[136:137], v16 offset:0
    ds_read_b64_tr_b16 v[138:139], v16 offset:800
    ds_read_b64_tr_b16 v[140:141], v16 offset:12800
    ds_read_b64_tr_b16 v[142:143], v16 offset:13600
    ds_read_b64_tr_b16 v[216:217], v16 offset:32
    ds_read_b64_tr_b16 v[218:219], v16 offset:832
    ds_read_b64_tr_b16 v[220:221], v16 offset:12832
    ds_read_b64_tr_b16 v[222:223], v16 offset:13632
    ds_read_b64_tr_b16 v[72:73], v16 offset:64
    ds_read_b64_tr_b16 v[74:75], v16 offset:864
    ds_read_b64_tr_b16 v[76:77], v16 offset:12864
    ds_read_b64_tr_b16 v[78:79], v16 offset:13664
    s_waitcnt lgkmcnt(0)
    ds_write_b128 v17, v[72:75] offset:10240
    ds_write_b128 v17, v[76:79] offset:11264
    s_waitcnt lgkmcnt(0)
    s_barrier
    s_waitcnt vmcnt(6)
    ds_write_b128 v10, v[24:27]
    ds_write_b128 v11, v[28:31]
    ds_write_b128 v12, v[32:35]
    ds_write_b128 v13, v[36:39]
    ds_write_b128 v14, v[40:43]
    ds_write_b128 v15, v[44:47]
    s_add_u32 s46, s45, 5505024
    buffer_load_dwordx4 v[72:75], v4, s[12:15], s46 offen
    buffer_load_dwordx4 v[76:79], v5, s[12:15], s46 offen
    buffer_load_dwordx4 v[80:83], v6, s[12:15], s46 offen
    buffer_load_dwordx4 v[84:87], v7, s[12:15], s46 offen
    buffer_load_dwordx4 v[88:91], v8, s[12:15], s46 offen
    buffer_load_dwordx4 v[92:95], v9, s[12:15], s46 offen
    s_waitcnt lgkmcnt(0)
    s_barrier
    ds_read_b64_tr_b16 a[48:49], v16 offset:0
    ds_read_b64_tr_b16 a[50:51], v16 offset:800
    ds_read_b64_tr_b16 a[52:53], v16 offset:12800
    ds_read_b64_tr_b16 a[54:55], v16 offset:13600
    ds_read_b64_tr_b16 a[128:129], v16 offset:32
    ds_read_b64_tr_b16 a[130:131], v16 offset:832
    ds_read_b64_tr_b16 a[132:133], v16 offset:12832
    ds_read_b64_tr_b16 a[134:135], v16 offset:13632
    ds_read_b64_tr_b16 a[208:209], v16 offset:64
    ds_read_b64_tr_b16 a[210:211], v16 offset:864
    ds_read_b64_tr_b16 a[212:213], v16 offset:12864
    ds_read_b64_tr_b16 a[214:215], v16 offset:13664
    s_waitcnt lgkmcnt(0)
    s_barrier
    s_waitcnt vmcnt(6)
    ds_write_b128 v10, v[48:51]
    ds_write_b128 v11, v[52:55]
    ds_write_b128 v12, v[56:59]
    ds_write_b128 v13, v[60:63]
    ds_write_b128 v14, v[64:67]
    ds_write_b128 v15, v[68:71]
    s_add_u32 s46, s45, 5505024
    buffer_load_dwordx4 v[24:27], v4, s[16:19], s46 offen
    buffer_load_dwordx4 v[28:31], v5, s[16:19], s46 offen
    buffer_load_dwordx4 v[32:35], v6, s[16:19], s46 offen
    buffer_load_dwordx4 v[36:39], v7, s[16:19], s46 offen
    buffer_load_dwordx4 v[40:43], v8, s[16:19], s46 offen
    buffer_load_dwordx4 v[44:47], v9, s[16:19], s46 offen
    s_waitcnt lgkmcnt(0)
    s_barrier
    ds_read_b64_tr_b16 v[144:145], v16 offset:0
    ds_read_b64_tr_b16 v[146:147], v16 offset:800
    ds_read_b64_tr_b16 v[148:149], v16 offset:12800
    ds_read_b64_tr_b16 v[150:151], v16 offset:13600
    ds_read_b64_tr_b16 v[224:225], v16 offset:32
    ds_read_b64_tr_b16 v[226:227], v16 offset:832
    ds_read_b64_tr_b16 v[228:229], v16 offset:12832
    ds_read_b64_tr_b16 v[230:231], v16 offset:13632
    ds_read_b64_tr_b16 v[48:49], v16 offset:64
    ds_read_b64_tr_b16 v[50:51], v16 offset:864
    ds_read_b64_tr_b16 v[52:53], v16 offset:12864
    ds_read_b64_tr_b16 v[54:55], v16 offset:13664
    s_waitcnt lgkmcnt(0)
    ds_write_b128 v17, v[48:51] offset:12288
    ds_write_b128 v17, v[52:55] offset:13312
    s_waitcnt lgkmcnt(0)
    s_barrier
    s_waitcnt vmcnt(6)
    ds_write_b128 v10, v[72:75]
    ds_write_b128 v11, v[76:79]
    ds_write_b128 v12, v[80:83]
    ds_write_b128 v13, v[84:87]
    ds_write_b128 v14, v[88:91]
    ds_write_b128 v15, v[92:95]
    s_add_u32 s46, s45, 6291456
    buffer_load_dwordx4 v[48:51], v4, s[12:15], s46 offen
    buffer_load_dwordx4 v[52:55], v5, s[12:15], s46 offen
    buffer_load_dwordx4 v[56:59], v6, s[12:15], s46 offen
    buffer_load_dwordx4 v[60:63], v7, s[12:15], s46 offen
    buffer_load_dwordx4 v[64:67], v8, s[12:15], s46 offen
    buffer_load_dwordx4 v[68:71], v9, s[12:15], s46 offen
    s_waitcnt lgkmcnt(0)
    s_barrier
    ds_read_b64_tr_b16 a[56:57], v16 offset:0
    ds_read_b64_tr_b16 a[58:59], v16 offset:800
    ds_read_b64_tr_b16 a[60:61], v16 offset:12800
    ds_read_b64_tr_b16 a[62:63], v16 offset:13600
    ds_read_b64_tr_b16 a[136:137], v16 offset:32
    ds_read_b64_tr_b16 a[138:139], v16 offset:832
    ds_read_b64_tr_b16 a[140:141], v16 offset:12832
    ds_read_b64_tr_b16 a[142:143], v16 offset:13632
    ds_read_b64_tr_b16 a[216:217], v16 offset:64
    ds_read_b64_tr_b16 a[218:219], v16 offset:864
    ds_read_b64_tr_b16 a[220:221], v16 offset:12864
    ds_read_b64_tr_b16 a[222:223], v16 offset:13664
    s_waitcnt lgkmcnt(0)
    s_barrier
    s_waitcnt vmcnt(6)
    ds_write_b128 v10, v[24:27]
    ds_write_b128 v11, v[28:31]
    ds_write_b128 v12, v[32:35]
    ds_write_b128 v13, v[36:39]
    ds_write_b128 v14, v[40:43]
    ds_write_b128 v15, v[44:47]
    s_add_u32 s46, s45, 6291456
    buffer_load_dwordx4 v[72:75], v4, s[16:19], s46 offen
    buffer_load_dwordx4 v[76:79], v5, s[16:19], s46 offen
    buffer_load_dwordx4 v[80:83], v6, s[16:19], s46 offen
    buffer_load_dwordx4 v[84:87], v7, s[16:19], s46 offen
    buffer_load_dwordx4 v[88:91], v8, s[16:19], s46 offen
    buffer_load_dwordx4 v[92:95], v9, s[16:19], s46 offen
    s_waitcnt lgkmcnt(0)
    s_barrier
    ds_read_b64_tr_b16 v[152:153], v16 offset:0
    ds_read_b64_tr_b16 v[154:155], v16 offset:800
    ds_read_b64_tr_b16 v[156:157], v16 offset:12800
    ds_read_b64_tr_b16 v[158:159], v16 offset:13600
    ds_read_b64_tr_b16 v[232:233], v16 offset:32
    ds_read_b64_tr_b16 v[234:235], v16 offset:832
    ds_read_b64_tr_b16 v[236:237], v16 offset:12832
    ds_read_b64_tr_b16 v[238:239], v16 offset:13632
    ds_read_b64_tr_b16 v[24:25], v16 offset:64
    ds_read_b64_tr_b16 v[26:27], v16 offset:864
    ds_read_b64_tr_b16 v[28:29], v16 offset:12864
    ds_read_b64_tr_b16 v[30:31], v16 offset:13664
    s_waitcnt lgkmcnt(0)
    ds_write_b128 v17, v[24:27] offset:14336
    ds_write_b128 v17, v[28:31] offset:15360
    s_waitcnt lgkmcnt(0)
    s_barrier
    s_waitcnt vmcnt(6)
    ds_write_b128 v10, v[48:51]
    ds_write_b128 v11, v[52:55]
    ds_write_b128 v12, v[56:59]
    ds_write_b128 v13, v[60:63]
    ds_write_b128 v14, v[64:67]
    ds_write_b128 v15, v[68:71]
    s_add_u32 s46, s45, 7077888
    buffer_load_dwordx4 v[24:27], v4, s[12:15], s46 offen
    buffer_load_dwordx4 v[28:31], v5, s[12:15], s46 offen
    buffer_load_dwordx4 v[32:35], v6, s[12:15], s46 offen
    buffer_load_dwordx4 v[36:39], v7, s[12:15], s46 offen
    buffer_load_dwordx4 v[40:43], v8, s[12:15], s46 offen
    buffer_load_dwordx4 v[44:47], v9, s[12:15], s46 offen
    s_waitcnt lgkmcnt(0)
    s_barrier
    ds_read_b64_tr_b16 a[64:65], v16 offset:0
    ds_read_b64_tr_b16 a[66:67], v16 offset:800
    ds_read_b64_tr_b16 a[68:69], v16 offset:12800
    ds_read_b64_tr_b16 a[70:71], v16 offset:13600
    ds_read_b64_tr_b16 a[144:145], v16 offset:32
    ds_read_b64_tr_b16 a[146:147], v16 offset:832
    ds_read_b64_tr_b16 a[148:149], v16 offset:12832
    ds_read_b64_tr_b16 a[150:151], v16 offset:13632
    ds_read_b64_tr_b16 a[224:225], v16 offset:64
    ds_read_b64_tr_b16 a[226:227], v16 offset:864
    ds_read_b64_tr_b16 a[228:229], v16 offset:12864
    ds_read_b64_tr_b16 a[230:231], v16 offset:13664
    s_waitcnt lgkmcnt(0)
    s_barrier
    s_waitcnt vmcnt(6)
    ds_write_b128 v10, v[72:75]
    ds_write_b128 v11, v[76:79]
    ds_write_b128 v12, v[80:83]
    ds_write_b128 v13, v[84:87]
    ds_write_b128 v14, v[88:91]
    ds_write_b128 v15, v[92:95]
    s_add_u32 s46, s45, 7077888
    buffer_load_dwordx4 v[48:51], v4, s[16:19], s46 offen
    buffer_load_dwordx4 v[52:55], v5, s[16:19], s46 offen
    buffer_load_dwordx4 v[56:59], v6, s[16:19], s46 offen
    buffer_load_dwordx4 v[60:63], v7, s[16:19], s46 offen
    buffer_load_dwordx4 v[64:67], v8, s[16:19], s46 offen
    buffer_load_dwordx4 v[68:71], v9, s[16:19], s46 offen
    s_waitcnt lgkmcnt(0)
    s_barrier
    ds_read_b64_tr_b16 v[160:161], v16 offset:0
    ds_read_b64_tr_b16 v[162:163], v16 offset:800
    ds_read_b64_tr_b16 v[164:165], v16 offset:12800
    ds_read_b64_tr_b16 v[166:167], v16 offset:13600
    ds_read_b64_tr_b16 v[240:241], v16 offset:32
    ds_read_b64_tr_b16 v[242:243], v16 offset:832
    ds_read_b64_tr_b16 v[244:245], v16 offset:12832
    ds_read_b64_tr_b16 v[246:247], v16 offset:13632
    ds_read_b64_tr_b16 v[72:73], v16 offset:64
    ds_read_b64_tr_b16 v[74:75], v16 offset:864
    ds_read_b64_tr_b16 v[76:77], v16 offset:12864
    ds_read_b64_tr_b16 v[78:79], v16 offset:13664
    s_waitcnt lgkmcnt(0)
    ds_write_b128 v17, v[72:75] offset:16384
    ds_write_b128 v17, v[76:79] offset:17408
    s_waitcnt lgkmcnt(0)
    s_barrier
    s_waitcnt vmcnt(6)
    ds_write_b128 v10, v[24:27]
    ds_write_b128 v11, v[28:31]
    ds_write_b128 v12, v[32:35]
    ds_write_b128 v13, v[36:39]
    ds_write_b128 v14, v[40:43]
    ds_write_b128 v15, v[44:47]
    s_waitcnt lgkmcnt(0)
    s_barrier
    ds_read_b64_tr_b16 a[72:73], v16 offset:0
    ds_read_b64_tr_b16 a[74:75], v16 offset:800
    ds_read_b64_tr_b16 a[76:77], v16 offset:12800
    ds_read_b64_tr_b16 a[78:79], v16 offset:13600
    ds_read_b64_tr_b16 a[152:153], v16 offset:32
    ds_read_b64_tr_b16 a[154:155], v16 offset:832
    ds_read_b64_tr_b16 a[156:157], v16 offset:12832
    ds_read_b64_tr_b16 a[158:159], v16 offset:13632
    ds_read_b64_tr_b16 a[232:233], v16 offset:64
    ds_read_b64_tr_b16 a[234:235], v16 offset:864
    ds_read_b64_tr_b16 a[236:237], v16 offset:12864
    ds_read_b64_tr_b16 a[238:239], v16 offset:13664
    s_waitcnt lgkmcnt(0)
    s_barrier
    s_waitcnt vmcnt(0)
    ds_write_b128 v10, v[48:51]
    ds_write_b128 v11, v[52:55]
    ds_write_b128 v12, v[56:59]
    ds_write_b128 v13, v[60:63]
    ds_write_b128 v14, v[64:67]
    ds_write_b128 v15, v[68:71]
    s_waitcnt lgkmcnt(0)
    s_barrier
    ds_read_b64_tr_b16 v[168:169], v16 offset:0
    ds_read_b64_tr_b16 v[170:171], v16 offset:800
    ds_read_b64_tr_b16 v[172:173], v16 offset:12800
    ds_read_b64_tr_b16 v[174:175], v16 offset:13600
    ds_read_b64_tr_b16 v[248:249], v16 offset:32
    ds_read_b64_tr_b16 v[250:251], v16 offset:832
    ds_read_b64_tr_b16 v[252:253], v16 offset:12832
    ds_read_b64_tr_b16 v[254:255], v16 offset:13632
    ds_read_b64_tr_b16 v[48:49], v16 offset:64
    ds_read_b64_tr_b16 v[50:51], v16 offset:864
    ds_read_b64_tr_b16 v[52:53], v16 offset:12864
    ds_read_b64_tr_b16 v[54:55], v16 offset:13664
    s_waitcnt lgkmcnt(0)
    ds_write_b128 v17, v[48:51] offset:18432
    ds_write_b128 v17, v[52:55] offset:19456
    s_waitcnt lgkmcnt(0)
    s_barrier
    v_mov_b32 v6, v17
    v_mov_b32 v30, 0xeeee
    v_mov_b32 v4, 0x4444
    v_cmp_gt_u32 vcc, 8, v2
    s_nop 1
    v_cndmask_b32 v4, v30, v4, vcc
    v_lshlrev_b32 v5, 4, v1
    s_lshl_b32 s24, s3, 10
    v_add_u32 v7, s24, v5
    s_lshl_b32 s24, s3, 9
    s_add_u32 s24, s24, 8192
    v_lshlrev_b32 v8, 3, v1
    v_add_u32 v8, s24, v8
    s_mul_i32 s24, s3, 1536
    s_add_u32 s24, s24, 10240
    v_lshlrev_b32 v9, 5, v2
    v_lshl_add_u32 v9, v3, 3, v9
    v_add_u32 v9, s24, v9
    v_lshrrev_b32 v30, 2, v2
    v_and_b32 v31, 3, v2
    v_lshl_add_u32 v11, v3, 2, v30
    v_lshlrev_b32 v11, 5, v11
    v_lshl_add_u32 v11, v31, 3, v11
    v_add_u32 v11, s24, v11
    v_add_u32 v33, 22528, v5
    s_mul_i32 s24, s3, 1408
    s_add_u32 s24, s24, 16384
    v_mul_u32_u24 v30, 176, v2
    v_add_u32 v30, s24, v30
    v_lshl_add_u32 v12, v3, 5, v30
    v_cmp_gt_u32 vcc, 8, v2
    s_nop 1
    v_cndmask_b32 v12, v33, v12, vcc
    v_lshl_add_u32 v13, v3, 4, v30
    v_add_u32 v13, 96, v13
    v_cmp_le_u32 s[24:25], 2, v3
    s_and_b64 vcc, vcc, s[24:25]
    v_cndmask_b32 v13, v33, v13, vcc
    s_mul_i32 s24, s3, 5632
    s_add_u32 s24, s24, 106496
    v_mul_u32_u24 v30, 176, v2
    v_add_u32 v30, s24, v30
    v_lshl_add_u32 v16, v3, 5, v30
    v_lshl_add_u32 v17, v3, 4, v30
    v_add_u32 v17, 96, v17
    v_add_u32 v18, 2816, v17
    v_cmp_le_u32 vcc, 2, v3
    s_nop 1
    v_cndmask_b32 v17, v33, v17, vcc
    v_cndmask_b32 v18, v33, v18, vcc
    v_lshrrev_b32 v30, 3, v1
    v_and_b32 v31, 7, v1
    v_min_u32 v32, 4, v31
    v_mul_u32_u24 v14, 176, v30
    v_lshl_add_u32 v14, v32, 5, v14
    s_mul_i32 s24, s3, 1408
    s_add_u32 s24, s24, 106496
    v_add_u32 v21, s24, v14
    v_add_u32 v14, 16384, v14
    v_cmp_gt_u32 s[50:51], 5, v31
    s_lshl_b32 s24, s3, 3
    v_add_u32 v32, s24, v30
    v_lshlrev_b32 v33, 2, v31
    v_sub_u32 v32, v32, v33
    v_mov_b32 v33, 100
    v_cmp_gt_u32 vcc, 4, v31
    s_nop 1
    v_cndmask_b32 v32, v33, v32, vcc
    v_cmp_le_i32 s[64:65], 0, v32
    v_cmp_le_i32 s[66:67], 1, v32
    v_cmp_le_i32 s[68:69], 2, v32
    v_cmp_le_i32 s[70:71], 3, v32
    v_cmp_le_i32 s[72:73], 16, v32
    v_cmp_le_i32 s[74:75], 17, v32
    v_cmp_le_i32 s[76:77], 18, v32
    v_cmp_le_i32 s[78:79], 19, v32
    s_lshr_b32 s24, s44, 1
    s_lshl_b32 s24, s24, 10
    s_and_b32 s25, s44, 1
    s_lshl_b32 s25, s25, 7
    s_add_u32 s24, s24, s25
    v_lshlrev_b32 v15, 8, v31
    v_lshl_add_u32 v15, v30, 4, v15
    v_add_u32 v15, s24, v15
    s_lshr_b32 s24, s44, 3
    s_lshl_b32 s24, s24, 10
    s_and_b32 s25, s44, 3
    s_lshl_b32 s25, s25, 8
    s_add_u32 s24, s24, s25
    s_lshr_b32 s25, s44, 2
    s_and_b32 s25, s25, 1
    s_lshl_b32 s25, s25, 7
    s_add_u32 s24, s24, s25
    s_add_u32 s24, s24, 16384
    v_lshlrev_b32 v32, 4, v30
    v_add_u32 v32, s24, v32
    v_cmp_eq_u32 vcc, 4, v31
    s_nop 1
    v_cndmask_b32 v15, v15, v32, vcc
    v_mov_b32 v32, 2146435072
    v_cndmask_b32 v15, v32, v15, s[50:51]
    s_mul_i32 s24, s3, 20480
    v_add_u32 v15, s24, v15
    s_cmp_lt_u32 s3, 1
    s_cselect_b32 s24, 0, 2146435072
    v_or_b32 v15, s24, v15
    s_and_b32 s24, s3, 1
    s_lshl_b32 s24, s24, 7
    s_lshr_b32 s25, s3, 1
    s_lshl_b32 s25, s25, 10
    s_add_u32 s24, s24, s25
    s_lshl_b32 s25, s44, 11
    s_add_u32 s25, s25, s24
    v_lshlrev_b32 v22, 8, v31
    v_lshl_add_u32 v22, v30, 4, v22
    v_add_u32 v22, s25, v22
    s_lshr_b32 s25, s44, 2
    s_lshl_b32 s25, s25, 11
    s_add_u32 s25, s25, s24
    s_and_b32 s26, s44, 3
    s_lshl_b32 s26, s26, 8
    s_add_u32 s25, s25, s26
    s_add_u32 s25, s25, 65536
    v_lshlrev_b32 v32, 4, v30
    v_add_u32 v32, s25, v32
    v_cmp_eq_u32 vcc, 4, v31
    s_nop 1
    v_cndmask_b32 v22, v22, v32, vcc
    v_mov_b32 v32, 2146435072
    v_cndmask_b32 v22, v32, v22, s[50:51]
    s_mul_i32 s24, s44, 12288
    s_mul_i32 s25, s3, 3072
    s_add_u32 s24, s24, s25
    v_add_u32 v19, s24, v5
    v_and_b32 v10, 1, v1
    v_lshlrev_b32 v10, 12, v10
    s_lshl_b32 s24, s44, 7
    s_add_u32 s24, s24, 151560192
    v_add_u32 v10, s24, v10
    v_add_u32 v48, 0, v0
    v_and_b32 v49, 7, v48
    v_mul_u32_u24 v49, 1280, v49
    v_lshrrev_b32 v50, 3, v48
    v_lshl_add_u32 v49, v50, 4, v49
    v_cmp_gt_u32 vcc, 640, v48
    v_mov_b32 v51, 2146435072
    s_nop 0
    v_cndmask_b32 v49, v51, v49, vcc
    buffer_load_dwordx4 v[52:55], v49, s[20:23], 0 offen
    v_lshlrev_b32 v48, 4, v48
    s_waitcnt vmcnt(0)
    s_and_saveexec_b64 s[30:31], vcc
    ds_write_b128 v48, v[52:55]
    s_mov_b64 exec, s[30:31]
    v_add_u32 v48, 256, v0
    v_and_b32 v49, 7, v48
    v_mul_u32_u24 v49, 1280, v49
    v_lshrrev_b32 v50, 3, v48
    v_lshl_add_u32 v49, v50, 4, v49
    v_cmp_gt_u32 vcc, 640, v48
    v_mov_b32 v51, 2146435072
    s_nop 0
    v_cndmask_b32 v49, v51, v49, vcc
    buffer_load_dwordx4 v[52:55], v49, s[20:23], 0 offen
    v_lshlrev_b32 v48, 4, v48
    s_waitcnt vmcnt(0)
    s_and_saveexec_b64 s[30:31], vcc
    ds_write_b128 v48, v[52:55]
    s_mov_b64 exec, s[30:31]
    v_add_u32 v48, 512, v0
    v_and_b32 v49, 7, v48
    v_mul_u32_u24 v49, 1280, v49
    v_lshrrev_b32 v50, 3, v48
    v_lshl_add_u32 v49, v50, 4, v49
    v_cmp_gt_u32 vcc, 640, v48
    v_mov_b32 v51, 2146435072
    s_nop 0
    v_cndmask_b32 v49, v51, v49, vcc
    buffer_load_dwordx4 v[52:55], v49, s[20:23], 0 offen
    v_lshlrev_b32 v48, 4, v48
    s_waitcnt vmcnt(0)
    s_and_saveexec_b64 s[30:31], vcc
    ds_write_b128 v48, v[52:55]
    s_mov_b64 exec, s[30:31]
    s_mov_b32 s40, 0
    s_mov_b32 s41, 92274688
    s_mov_b32 s42, 146317312
    s_mov_b32 s43, 141074432
    s_mov_b32 s45, 67108864
    s_mov_b32 s47, 138412032
    s_mov_b32 s62, -1
    s_mov_b32 s63, 1
    s_cmp_ge_i32 s62, s63
    s_cbranch_scc1 chain1_kernel_s_en0_ok
    s_mov_b32 s61, 0
chain1_kernel_s_en0:
    buffer_load_dword v48, v10, s[8:11], 0 offen sc1
    s_waitcnt vmcnt(0)
    v_readlane_b32 s62, v48, 0
    v_readlane_b32 s24, v48, 1
    s_min_i32 s62, s62, s24
    s_cmp_ge_i32 s62, s63
    s_cbranch_scc1 chain1_kernel_s_en0_ok
    s_add_u32 s61, s61, 1
    s_cmp_ge_u32 s61, s60
    s_cbranch_scc1 chain1_kernel_s_en0_to
    s_sleep 2
    s_branch chain1_kernel_s_en0
chain1_kernel_s_en0_to:
    s_mov_b32 s60, 1
chain1_kernel_s_en0_ok:
    buffer_load_dwordx4 a[240:243], v19, s[8:11], s41 offen offset:0 sc1
    buffer_load_dwordx4 a[244:247], v19, s[8:11], s41 offen offset:1024 sc1
    buffer_load_dwordx4 a[248:251], v19, s[8:11], s41 offen offset:2048 sc1
    s_waitcnt lgkmcnt(0)
    s_branch chain1_kernel_s_go
chain1_kernel_s_step:
    v_mov_b32 v24, 0
    v_mov_b32 v25, 0
    v_mov_b32 v26, 0
    v_mov_b32 v27, 0
    v_mov_b32 v28, 0
    v_mov_b32 v29, 0
    v_mov_b32 v30, 0
    v_mov_b32 v31, 0
    v_mov_b32 v32, 0
    v_mov_b32 v33, 0
    v_mov_b32 v34, 0
    v_mov_b32 v35, 0
    v_mov_b32 v36, 0
    v_mov_b32 v37, 0
    v_mov_b32 v38, 0
    v_mov_b32 v39, 0
    v_mov_b32 v40, 0
    v_mov_b32 v41, 0
    v_mov_b32 v42, 0
    v_mov_b32 v43, 0
    v_mov_b32 v44, 0
    v_mov_b32 v45, 0
    v_mov_b32 v46, 0
    v_mov_b32 v47, 0
    s_add_u32 s48, s47, 4096
    s_mov_b32 s61, 0
chain1_kernel_s_pm:
    buffer_load_dwordx4 v[48:51], v7, s[8:11], s47 offen sc1
    buffer_load_dwordx4 v[52:55], v7, s[8:11], s48 offen sc1
    buffer_load_dwordx2 v[56:57], v8, s[8:11], s47 offen sc1
    s_waitcnt vmcnt(0)
    v_max3_u32 v58, v48, v49, v50
    v_max3_u32 v58, v58, v51, v52
    v_max3_u32 v58, v58, v53, v54
    v_max3_u32 v58, v58, v55, v56
    v_max_u32 v58, v58, v57
    v_cmp_eq_u32 vcc, -1, v58
    s_add_u32 s61, s61, 1
    s_cbranch_vccz chain1_kernel_s_pm_out
    s_cmp_ge_u32 s61, s60
    s_cbranch_scc1 chain1_kernel_s_pm_to
    s_sleep 1
    s_branch chain1_kernel_s_pm
chain1_kernel_s_pm_to:
    s_mov_b32 s60, 1
chain1_kernel_s_pm_out:
    ds_write_b128 v7, v[48:51]
    ds_write_b128 v7, v[52:55] offset:4096
    ds_write_b64 v8, v[56:57]
    s_waitcnt lgkmcnt(0)
chain1_kernel_s_go2:
    s_barrier
    ds_read_b128 v[48:51], v5 offset:0
    ds_read_b128 v[68:71], v6 offset:0
    ds_read_b128 v[72:75], v6 offset:1024
    ds_read_b128 v[52:55], v5 offset:1024
    ds_read_b128 v[76:79], v6 offset:2048
    ds_read_b128 v[80:83], v6 offset:3072
    ds_read_b128 v[56:59], v5 offset:2048
    ds_read_b128 v[60:63], v5 offset:3072
    ds_read_b128 v[64:67], v5 offset:4096
    s_waitcnt lgkmcnt(8)
    v_smfmac_f32_16x16x64_bf16 v[24:27], v[48:51], a[0:7], v4
    v_smfmac_f32_16x16x64_bf16 v[28:31], v[48:51], a[80:87], v4
    ds_read_b128 v[84:87], v6 offset:4096
    ds_read_b128 v[88:91], v6 offset:5120
    v_smfmac_f32_16x16x64_bf16 v[32:35], v[48:51], a[160:167], v4
    v_smfmac_f32_16x16x64_bf16 v[36:39], v[48:51], v[96:103], v4
    v_smfmac_f32_16x16x64_bf16 v[40:43], v[48:51], v[176:183], v4
    s_waitcnt lgkmcnt(8)
    v_smfmac_f32_16x16x64_bf16 v[44:47], v[48:51], v[68:75], v4
    ds_read_b128 v[48:51], v5 offset:5120
    s_waitcnt lgkmcnt(8)
    v_smfmac_f32_16x16x64_bf16 v[24:27], v[52:55], a[8:15], v4
    v_smfmac_f32_16x16x64_bf16 v[28:31], v[52:55], a[88:95], v4
    ds_read_b128 v[68:71], v6 offset:6144
    ds_read_b128 v[72:75], v6 offset:7168
    v_smfmac_f32_16x16x64_bf16 v[32:35], v[52:55], a[168:175], v4
    v_smfmac_f32_16x16x64_bf16 v[36:39], v[52:55], v[104:111], v4
    v_smfmac_f32_16x16x64_bf16 v[40:43], v[52:55], v[184:191], v4
    s_waitcnt lgkmcnt(8)
    v_smfmac_f32_16x16x64_bf16 v[44:47], v[52:55], v[76:83], v4
    ds_read_b128 v[52:55], v5 offset:6144
    s_waitcnt lgkmcnt(8)
    v_smfmac_f32_16x16x64_bf16 v[24:27], v[56:59], a[16:23], v4
    v_smfmac_f32_16x16x64_bf16 v[28:31], v[56:59], a[96:103], v4
    ds_read_b128 v[76:79], v6 offset:8192
    ds_read_b128 v[80:83], v6 offset:9216
    v_smfmac_f32_16x16x64_bf16 v[32:35], v[56:59], a[176:183], v4
    v_smfmac_f32_16x16x64_bf16 v[36:39], v[56:59], v[112:119], v4
    v_smfmac_f32_16x16x64_bf16 v[40:43], v[56:59], v[192:199], v4
    s_waitcnt lgkmcnt(6)
    v_smfmac_f32_16x16x64_bf16 v[44:47], v[56:59], v[84:91], v4
    ds_read_b128 v[56:59], v5 offset:7168
    v_smfmac_f32_16x16x64_bf16 v[24:27], v[60:63], a[24:31], v4
    v_smfmac_f32_16x16x64_bf16 v[28:31], v[60:63], a[104:111], v4
    ds_read_b128 v[84:87], v6 offset:10240
    ds_read_b128 v[88:91], v6 offset:11264
    v_smfmac_f32_16x16x64_bf16 v[32:35], v[60:63], a[184:191], v4
    v_smfmac_f32_16x16x64_bf16 v[36:39], v[60:63], v[120:127], v4
    v_smfmac_f32_16x16x64_bf16 v[40:43], v[60:63], v[200:207], v4
    s_waitcnt lgkmcnt(6)
    v_smfmac_f32_16x16x64_bf16 v[44:47], v[60:63], v[68:75], v4
    ds_read_b128 v[60:63], v5 offset:8192
    v_smfmac_f32_16x16x64_bf16 v[24:27], v[64:67], a[32:39], v4
    v_smfmac_f32_16x16x64_bf16 v[28:31], v[64:67], a[112:119], v4
    ds_read_b128 v[68:71], v6 offset:12288
    ds_read_b128 v[72:75], v6 offset:13312
    v_smfmac_f32_16x16x64_bf16 v[32:35], v[64:67], a[192:199], v4
    v_smfmac_f32_16x16x64_bf16 v[36:39], v[64:67], v[128:135], v4
    v_smfmac_f32_16x16x64_bf16 v[40:43], v[64:67], v[208:215], v4
    s_waitcnt lgkmcnt(6)
    v_smfmac_f32_16x16x64_bf16 v[44:47], v[64:67], v[76:83], v4
    ds_read_b128 v[64:67], v5 offset:9216
    v_smfmac_f32_16x16x64_bf16 v[24:27], v[48:51], a[40:47], v4
    v_smfmac_f32_16x16x64_bf16 v[28:31], v[48:51], a[120:127], v4
    ds_read_b128 v[76:79], v6 offset:14336
    ds_read_b128 v[80:83], v6 offset:15360
    v_smfmac_f32_16x16x64_bf16 v[32:35], v[48:51], a[200:207], v4
    v_smfmac_f32_16x16x64_bf16 v[36:39], v[48:51], v[136:143], v4
    v_smfmac_f32_16x16x64_bf16 v[40:43], v[48:51], v[216:223], v4
    s_waitcnt lgkmcnt(6)
    v_smfmac_f32_16x16x64_bf16 v[44:47], v[48:51], v[84:91], v4
    v_smfmac_f32_16x16x64_bf16 v[24:27], v[52:55], a[48:55], v4
    v_smfmac_f32_16x16x64_bf16 v[28:31], v[52:55], a[128:135], v4
    ds_read_b128 v[84:87], v6 offset:16384
    ds_read_b128 v[88:91], v6 offset:17408
    v_smfmac_f32_16x16x64_bf16 v[32:35], v[52:55], a[208:215], v4
    v_smfmac_f32_16x16x64_bf16 v[36:39], v[52:55], v[144:151], v4
    v_smfmac_f32_16x16x64_bf16 v[40:43], v[52:55], v[224:231], v4
    s_waitcnt lgkmcnt(5)
    v_smfmac_f32_16x16x64_bf16 v[44:47], v[52:55], v[68:75], v4
    v_smfmac_f32_16x16x64_bf16 v[24:27], v[56:59], a[56:63], v4
    v_smfmac_f32_16x16x64_bf16 v[28:31], v[56:59], a[136:143], v4
    ds_read_b128 v[68:71], v6 offset:18432
    ds_read_b128 v[72:75], v6 offset:19456
    v_smfmac_f32_16x16x64_bf16 v[32:35], v[56:59], a[216:223], v4
    v_smfmac_f32_16x16x64_bf16 v[36:39], v[56:59], v[152:159], v4
    v_smfmac_f32_16x16x64_bf16 v[40:43], v[56:59], v[232:239], v4
    s_waitcnt lgkmcnt(4)
    v_smfmac_f32_16x16x64_bf16 v[44:47], v[56:59], v[76:83], v4
    v_smfmac_f32_16x16x64_bf16 v[24:27], v[60:63], a[64:71], v4
    v_smfmac_f32_16x16x64_bf16 v[28:31], v[60:63], a[144:151], v4
    v_smfmac_f32_16x16x64_bf16 v[32:35], v[60:63], a[224:231], v4
    v_smfmac_f32_16x16x64_bf16 v[36:39], v[60:63], v[160:167], v4
    v_smfmac_f32_16x16x64_bf16 v[40:43], v[60:63], v[240:247], v4
    s_waitcnt lgkmcnt(2)
    v_smfmac_f32_16x16x64_bf16 v[44:47], v[60:63], v[84:91], v4
    v_smfmac_f32_16x16x64_bf16 v[24:27], v[64:67], a[72:79], v4
    v_smfmac_f32_16x16x64_bf16 v[28:31], v[64:67], a[152:159], v4
    v_smfmac_f32_16x16x64_bf16 v[32:35], v[64:67], a[232:239], v4
    v_smfmac_f32_16x16x64_bf16 v[36:39], v[64:67], v[168:175], v4
    v_smfmac_f32_16x16x64_bf16 v[40:43], v[64:67], v[248:255], v4
    s_waitcnt lgkmcnt(0)
    v_smfmac_f32_16x16x64_bf16 v[44:47], v[64:67], v[68:75], v4
    buffer_load_dwordx4 v[80:83], v19, s[8:11], s45 offen offset:0 sc1
    buffer_load_dwordx4 v[84:87], v19, s[8:11], s45 offen offset:1024 sc1
    buffer_load_dwordx4 v[88:91], v19, s[8:11], s45 offen offset:2048 sc1
    s_nop 5
    v_permlane32_swap_b32 v24, v36
    v_permlane32_swap_b32 v25, v37
    v_permlane32_swap_b32 v26, v38
    v_permlane32_swap_b32 v27, v39
    v_add_f32 v24, v24, v36
    v_add_f32 v25, v25, v37
    v_add_f32 v26, v26, v38
    v_add_f32 v27, v27, v39
    v_cvt_pk_bf16_f32 v48, v24, v25
    v_cvt_pk_bf16_f32 v49, v26, v27
    ds_write_b64 v9, v[48:49] offset:0
    v_permlane32_swap_b32 v28, v40
    v_permlane32_swap_b32 v29, v41
    v_permlane32_swap_b32 v30, v42
    v_permlane32_swap_b32 v31, v43
    v_add_f32 v28, v28, v40
    v_add_f32 v29, v29, v41
    v_add_f32 v30, v30, v42
    v_add_f32 v31, v31, v43
    v_cvt_pk_bf16_f32 v50, v28, v29
    v_cvt_pk_bf16_f32 v51, v30, v31
    ds_write_b64 v9, v[50:51] offset:512
    v_permlane32_swap_b32 v32, v44
    v_permlane32_swap_b32 v33, v45
    v_permlane32_swap_b32 v34, v46
    v_permlane32_swap_b32 v35, v47
    v_add_f32 v32, v32, v44
    v_add_f32 v33, v33, v45
    v_add_f32 v34, v34, v46
    v_add_f32 v35, v35, v47
    v_cvt_pk_bf16_f32 v52, v32, v33
    v_cvt_pk_bf16_f32 v53, v34, v35
    ds_write_b64 v9, v[52:53] offset:1024
    s_waitcnt lgkmcnt(0)
    ds_read_b64_tr_b16 v[24:25], v11
    ds_read_b64_tr_b16 v[26:27], v11 offset:512
    ds_read_b64_tr_b16 v[28:29], v11 offset:1024
    s_waitcnt lgkmcnt(0)
    v_mfma_f32_16x16x32_bf16 v[64:67], a[240:243], v[24:27], 0
    v_mfma_f32_16x16x32_bf16 v[68:71], a[244:247], v[24:27], 0
    v_mfma_f32_16x16x32_bf16 v[72:75], v[24:27], v[24:27], 0
    s_nop 3
    v_mfma_f32_16x16x16_bf16 v[64:67], a[248:249], v[28:29], v[64:67]
    v_mfma_f32_16x16x16_bf16 v[68:71], a[250:251], v[28:29], v[68:71]
    v_mfma_f32_16x16x16_bf16 v[72:75], v[28:29], v[28:29], v[72:75]
    s_nop 5
    ds_write_b128 v12, v[64:67]
    ds_write_b128 v12, v[68:71] offset:16
    ds_write_b128 v13, v[72:75]
    s_waitcnt lgkmcnt(0)
    s_barrier
    ds_read_b128 v[48:51], v14 offset:0
    ds_read_b128 v[52:55], v14 offset:16
    ds_read_b128 v[56:59], v14 offset:1408
    ds_read_b128 v[60:63], v14 offset:1424
    ds_read_b128 v[64:67], v14 offset:2816
    ds_read_b128 v[68:71], v14 offset:2832
    ds_read_b128 v[72:75], v14 offset:4224
    ds_read_b128 v[76:79], v14 offset:4240
    s_waitcnt lgkmcnt(4)
    v_pk_add_f32 v[48:49], v[48:49], v[56:57]
    v_pk_add_f32 v[50:51], v[50:51], v[58:59]
    v_pk_add_f32 v[52:53], v[52:53], v[60:61]
    v_pk_add_f32 v[54:55], v[54:55], v[62:63]
    s_waitcnt lgkmcnt(0)
    v_pk_add_f32 v[64:65], v[64:65], v[72:73]
    v_pk_add_f32 v[66:67], v[66:67], v[74:75]
    v_pk_add_f32 v[68:69], v[68:69], v[76:77]
    v_pk_add_f32 v[70:71], v[70:71], v[78:79]
    v_pk_add_f32 v[48:49], v[48:49], v[64:65]
    v_pk_add_f32 v[50:51], v[50:51], v[66:67]
    v_pk_add_f32 v[52:53], v[52:53], v[68:69]
    v_pk_add_f32 v[54:55], v[54:55], v[70:71]
    v_max3_f32 v92, v48, v49, v50
    v_max3_f32 v92, v92, v51, v52
    v_max3_f32 v92, v92, v53, v54
    v_max_f32 v92, v92, v55
    v_mov_b32 v93, 0xff800000
    v_cndmask_b32 v92, v93, v92, s[50:51]
    s_nop 1
    v_max_f32 v92, v92, v92 quad_perm:[1,0,3,2] row_mask:0xf bank_mask:0xf
    s_nop 1
    v_max_f32 v92, v92, v92 quad_perm:[2,3,0,1] row_mask:0xf bank_mask:0xf
    s_nop 1
    v_max_f32 v92, v92, v92 row_half_mirror row_mask:0xf bank_mask:0xf
    s_mov_b32 s24, 0x3dd53b95
    v_mul_f32 v92, s24, v92
    v_fma_f32 v48, v48, s24, -v92
    v_fma_f32 v49, v49, s24, -v92
    v_fma_f32 v50, v50, s24, -v92
    v_fma_f32 v51, v51, s24, -v92
    v_fma_f32 v52, v52, s24, -v92
    v_fma_f32 v53, v53, s24, -v92
    v_fma_f32 v54, v54, s24, -v92
    v_fma_f32 v55, v55, s24, -v92
    v_exp_f32 v48, v48
    v_exp_f32 v49, v49
    v_exp_f32 v50, v50
    v_exp_f32 v51, v51
    v_exp_f32 v52, v52
    v_exp_f32 v53, v53
    v_exp_f32 v54, v54
    v_exp_f32 v55, v55
    v_add_f32 v92, v48, v49
    v_add_f32 v93, v50, v51
    v_add_f32 v92, v92, v52
    v_add_f32 v93, v93, v53
    v_add_f32 v92, v92, v54
    v_add_f32 v93, v93, v55
    v_add_f32 v92, v92, v93
    v_cndmask_b32 v92, 0, v92, s[50:51]
    s_nop 1
    v_add_f32 v92, v92, v92 quad_perm:[1,0,3,2] row_mask:0xf bank_mask:0xf
    s_nop 1
    v_add_f32 v92, v92, v92 quad_perm:[2,3,0,1] row_mask:0xf bank_mask:0xf
    s_nop 1
    v_add_f32 v92, v92, v92 row_half_mirror row_mask:0xf bank_mask:0xf
    v_rcp_f32 v92, v92
    s_nop 0
    v_mul_f32 v48, v48, v92
    v_mul_f32 v49, v49, v92
    v_mul_f32 v50, v50, v92
    v_mul_f32 v51, v51, v92
    v_mul_f32 v52, v52, v92
    v_mul_f32 v53, v53, v92
    v_mul_f32 v54, v54, v92
    v_mul_f32 v55, v55, v92
    v_cvt_pk_bf16_f32 v56, v48, v49
    v_cvt_pk_bf16_f32 v57, v50, v51
    v_cvt_pk_bf16_f32 v58, v52, v53
    v_cvt_pk_bf16_f32 v59, v54, v55
    v_min_u32 v56, -2, v56
    v_min_u32 v57, -2, v57
    v_min_u32 v58, -2, v58
    v_min_u32 v59, -2, v59
    buffer_store_dwordx4 v[56:59], v15, s[8:11], s43 offen sc1
    s_waitcnt vmcnt(1)
    v_mfma_f32_16x16x32_bf16 v[32:35], a[240:243], v[80:83], 0
    v_mfma_f32_16x16x32_bf16 v[40:43], a[244:247], v[80:83], 0
    v_mfma_f32_16x16x32_bf16 v[64:67], v[24:27], v[80:83], 0
    v_mfma_f32_16x16x32_bf16 v[36:39], a[240:243], v[84:87], 0
    v_mfma_f32_16x16x32_bf16 v[44:47], a[244:247], v[84:87], 0
    v_mfma_f32_16x16x32_bf16 v[68:71], v[24:27], v[84:87], 0
    s_nop 0
    v_mfma_f32_16x16x16_bf16 v[32:35], a[248:249], v[88:89], v[32:35]
    v_mfma_f32_16x16x16_bf16 v[40:43], a[250:251], v[88:89], v[40:43]
    v_mfma_f32_16x16x16_bf16 v[64:67], v[28:29], v[88:89], v[64:67]
    v_mfma_f32_16x16x16_bf16 v[36:39], a[248:249], v[90:91], v[36:39]
    v_mfma_f32_16x16x16_bf16 v[44:47], a[250:251], v[90:91], v[44:47]
    v_mfma_f32_16x16x16_bf16 v[68:71], v[28:29], v[90:91], v[68:71]
    s_nop 2
    ds_write_b128 v16, v[32:35] offset:0
    ds_write_b128 v16, v[40:43] offset:16
    ds_write_b128 v17, v[64:67]
    ds_write_b128 v16, v[36:39] offset:2816
    ds_write_b128 v16, v[44:47] offset:2832
    ds_write_b128 v18, v[68:71]
    s_add_u32 s40, s40, 1
    s_add_u32 s41, s41, 393216
    s_add_u32 s45, s45, 393216
    s_add_u32 s43, s43, 81920
    s_add_u32 s47, s47, 40960
    s_waitcnt lgkmcnt(0)
    s_barrier
    s_add_u32 s63, s40, 1
    s_min_u32 s63, s63, 64
    s_cmp_ge_i32 s62, s63
    s_cbranch_scc1 chain1_kernel_s_en_ok
    s_mov_b32 s61, 0
chain1_kernel_s_en:
    buffer_load_dword v48, v10, s[8:11], 0 offen sc1
    s_waitcnt vmcnt(0)
    v_readlane_b32 s62, v48, 0
    v_readlane_b32 s24, v48, 1
    s_min_i32 s62, s62, s24
    s_cmp_ge_i32 s62, s63
    s_cbranch_scc1 chain1_kernel_s_en_ok
    s_add_u32 s61, s61, 1
    s_cmp_ge_u32 s61, s60
    s_cbranch_scc1 chain1_kernel_s_en_to
    s_sleep 2
    s_branch chain1_kernel_s_en
chain1_kernel_s_en_to:
    s_mov_b32 s60, 1
chain1_kernel_s_en_ok:
    buffer_load_dwordx4 a[240:243], v19, s[8:11], s41 offen offset:0 sc1
    buffer_load_dwordx4 a[244:247], v19, s[8:11], s41 offen offset:1024 sc1
    buffer_load_dwordx4 a[248:251], v19, s[8:11], s41 offen offset:2048 sc1
    ds_read_b128 v[48:51], v21 offset:0
    ds_read_b128 v[52:55], v21 offset:16
    ds_read_b128 v[56:59], v21 offset:5632
    ds_read_b128 v[60:63], v21 offset:5648
    ds_read_b128 v[64:67], v21 offset:11264
    ds_read_b128 v[68:71], v21 offset:11280
    ds_read_b128 v[72:75], v21 offset:16896
    ds_read_b128 v[76:79], v21 offset:16912
    s_waitcnt lgkmcnt(4)
    v_pk_add_f32 v[48:49], v[48:49], v[56:57]
    v_pk_add_f32 v[50:51], v[50:51], v[58:59]
    v_pk_add_f32 v[52:53], v[52:53], v[60:61]
    v_pk_add_f32 v[54:55], v[54:55], v[62:63]
    s_waitcnt lgkmcnt(0)
    v_pk_add_f32 v[64:65], v[64:65], v[72:73]
    v_pk_add_f32 v[66:67], v[66:67], v[74:75]
    v_pk_add_f32 v[68:69], v[68:69], v[76:77]
    v_pk_add_f32 v[70:71], v[70:71], v[78:79]
    v_pk_add_f32 v[48:49], v[48:49], v[64:65]
    v_pk_add_f32 v[50:51], v[50:51], v[66:67]
    v_pk_add_f32 v[52:53], v[52:53], v[68:69]
    v_pk_add_f32 v[54:55], v[54:55], v[70:71]
    v_mov_b32 v93, 0xff800000
    v_cndmask_b32 v48, v93, v48, s[64:65]
    v_cndmask_b32 v49, v93, v49, s[66:67]
    v_cndmask_b32 v50, v93, v50, s[68:69]
    v_cndmask_b32 v51, v93, v51, s[70:71]
    v_cndmask_b32 v52, v93, v52, s[72:73]
    v_cndmask_b32 v53, v93, v53, s[74:75]
    v_cndmask_b32 v54, v93, v54, s[76:77]
    v_cndmask_b32 v55, v93, v55, s[78:79]
    v_max3_f32 v92, v48, v49, v50
    v_max3_f32 v92, v92, v51, v52
    v_max3_f32 v92, v92, v53, v54
    v_max_f32 v92, v92, v55
    v_mov_b32 v93, 0xff800000
    v_cndmask_b32 v92, v93, v92, s[50:51]
    s_nop 1
    v_max_f32 v92, v92, v92 quad_perm:[1,0,3,2] row_mask:0xf bank_mask:0xf
    s_nop 1
    v_max_f32 v92, v92, v92 quad_perm:[2,3,0,1] row_mask:0xf bank_mask:0xf
    s_nop 1
    v_max_f32 v92, v92, v92 row_half_mirror row_mask:0xf bank_mask:0xf
    s_mov_b32 s24, 0x3dd53b95
    v_mul_f32 v92, s24, v92
    v_fma_f32 v48, v48, s24, -v92
    v_fma_f32 v49, v49, s24, -v92
    v_fma_f32 v50, v50, s24, -v92
    v_fma_f32 v51, v51, s24, -v92
    v_fma_f32 v52, v52, s24, -v92
    v_fma_f32 v53, v53, s24, -v92
    v_fma_f32 v54, v54, s24, -v92
    v_fma_f32 v55, v55, s24, -v92
    v_exp_f32 v48, v48
    v_exp_f32 v49, v49
    v_exp_f32 v50, v50
    v_exp_f32 v51, v51
    v_exp_f32 v52, v52
    v_exp_f32 v53, v53
    v_exp_f32 v54, v54
    v_exp_f32 v55, v55
    v_add_f32 v92, v48, v49
    v_add_f32 v93, v50, v51
    v_add_f32 v92, v92, v52
    v_add_f32 v93, v93, v53
    v_add_f32 v92, v92, v54
    v_add_f32 v93, v93, v55
    v_add_f32 v92, v92, v93
    v_cndmask_b32 v92, 0, v92, s[50:51]
    s_nop 1
    v_add_f32 v92, v92, v92 quad_perm:[1,0,3,2] row_mask:0xf bank_mask:0xf
    s_nop 1
    v_add_f32 v92, v92, v92 quad_perm:[2,3,0,1] row_mask:0xf bank_mask:0xf
    s_nop 1
    v_add_f32 v92, v92, v92 row_half_mirror row_mask:0xf bank_mask:0xf
    v_rcp_f32 v92, v92
    s_nop 0
    v_mul_f32 v48, v48, v92
    v_mul_f32 v49, v49, v92
    v_mul_f32 v50, v50, v92
    v_mul_f32 v51, v51, v92
    v_mul_f32 v52, v52, v92
    v_mul_f32 v53, v53, v92
    v_mul_f32 v54, v54, v92
    v_mul_f32 v55, v55, v92
    v_cvt_pk_bf16_f32 v56, v48, v49
    v_cvt_pk_bf16_f32 v57, v50, v51
    v_cvt_pk_bf16_f32 v58, v52, v53
    v_cvt_pk_bf16_f32 v59, v54, v55
    v_min_u32 v56, -2, v56
    v_min_u32 v57, -2, v57
    v_min_u32 v58, -2, v58
    v_min_u32 v59, -2, v59
    buffer_store_dwordx4 v[56:59], v22, s[8:11], s42 offen sc1
    s_add_u32 s42, s42, 81920
    s_cmp_lt_u32 s40, 64
    s_cbranch_scc1 chain1_kernel_s_step
    s_branch chain1_kernel_end
chain1_kernel_s_go:
    v_mov_b32 v24, 0
    v_mov_b32 v25, 0
    v_mov_b32 v26, 0
    v_mov_b32 v27, 0
    v_mov_b32 v28, 0
    v_mov_b32 v29, 0
    v_mov_b32 v30, 0
    v_mov_b32 v31, 0
    v_mov_b32 v32, 0
    v_mov_b32 v33, 0
    v_mov_b32 v34, 0
    v_mov_b32 v35, 0
    v_mov_b32 v36, 0
    v_mov_b32 v37, 0
    v_mov_b32 v38, 0
    v_mov_b32 v39, 0
    v_mov_b32 v40, 0
    v_mov_b32 v41, 0
    v_mov_b32 v42, 0
    v_mov_b32 v43, 0
    v_mov_b32 v44, 0
    v_mov_b32 v45, 0
    v_mov_b32 v46, 0
    v_mov_b32 v47, 0
    s_waitcnt vmcnt(0)
    s_branch chain1_kernel_s_go2
chain1_kernel_roleV:
    s_sub_u32 s44, s2, 32
    s_load_dwordx2 s[6:7], s[0:1], 56
    s_load_dwordx2 s[24:25], s[0:1], 64
    s_waitcnt lgkmcnt(0)
    s_mov_b32 s12, s6
    s_mov_b32 s13, s7
    s_mov_b32 s14, 7864320
    s_mov_b32 s15, 0x00020000
    s_mov_b32 s16, s24
    s_mov_b32 s17, s25
    s_mov_b32 s18, 7864320
    s_mov_b32 s19, 0x00020000
    v_add_u32 v16, 0, v0
    s_mov_b32 s24, 683
    v_mul_lo_u32 v17, v16, s24
    v_lshrrev_b32 v17, 14, v17
    v_mul_u32_u24 v18, 24, v17
    v_sub_u32 v18, v16, v18
    s_mov_b32 s24, 12288
    v_mul_lo_u32 v4, v17, s24
    v_lshl_add_u32 v4, v18, 4, v4
    v_mul_u32_u24 v10, 400, v17
    v_lshl_add_u32 v10, v18, 4, v10
    v_add_u32 v10, 90112, v10
    v_add_u32 v16, 256, v0
    s_mov_b32 s24, 683
    v_mul_lo_u32 v17, v16, s24
    v_lshrrev_b32 v17, 14, v17
    v_mul_u32_u24 v18, 24, v17
    v_sub_u32 v18, v16, v18
    s_mov_b32 s24, 12288
    v_mul_lo_u32 v5, v17, s24
    v_lshl_add_u32 v5, v18, 4, v5
    v_mul_u32_u24 v11, 400, v17
    v_lshl_add_u32 v11, v18, 4, v11
    v_add_u32 v11, 90112, v11
    v_add_u32 v16, 512, v0
    s_mov_b32 s24, 683
    v_mul_lo_u32 v17, v16, s24
    v_lshrrev_b32 v17, 14, v17
    v_mul_u32_u24 v18, 24, v17
    v_sub_u32 v18, v16, v18
    s_mov_b32 s24, 12288
    v_mul_lo_u32 v6, v17, s24
    v_lshl_add_u32 v6, v18, 4, v6
    v_mul_u32_u24 v12, 400, v17
    v_lshl_add_u32 v12, v18, 4, v12
    v_add_u32 v12, 90112, v12
    v_add_u32 v16, 768, v0
    s_mov_b32 s24, 683
    v_mul_lo_u32 v17, v16, s24
    v_lshrrev_b32 v17, 14, v17
    v_mul_u32_u24 v18, 24, v17
    v_sub_u32 v18, v16, v18
    s_mov_b32 s24, 12288
    v_mul_lo_u32 v7, v17, s24
    v_lshl_add_u32 v7, v18, 4, v7
    v_mul_u32_u24 v13, 400, v17
    v_lshl_add_u32 v13, v18, 4, v13
    v_add_u32 v13, 90112, v13
    v_add_u32 v16, 1024, v0
    s_mov_b32 s24, 683
    v_mul_lo_u32 v17, v16, s24
    v_lshrrev_b32 v17, 14, v17
    v_mul_u32_u24 v18, 24, v17
    v_sub_u32 v18, v16, v18
    s_mov_b32 s24, 12288
    v_mul_lo_u32 v8, v17, s24
    v_lshl_add_u32 v8, v18, 4, v8
    v_mul_u32_u24 v14, 400, v17
    v_lshl_add_u32 v14, v18, 4, v14
    v_add_u32 v14, 90112, v14
    v_add_u32 v16, 1280, v0
    s_mov_b32 s24, 683
    v_mul_lo_u32 v17, v16, s24
    v_lshrrev_b32 v17, 14, v17
    v_mul_u32_u24 v18, 24, v17
    v_sub_u32 v18, v16, v18
    s_mov_b32 s24, 12288
    v_mul_lo_u32 v9, v17, s24
    v_lshl_add_u32 v9, v18, 4, v9
    v_mul_u32_u24 v15, 400, v17
    v_lshl_add_u32 v15, v18, 4, v15
    v_add_u32 v15, 90112, v15
    v_lshrrev_b32 v17, 1, v3
    v_lshlrev_b32 v17, 4, v17
    v_and_b32 v18, 1, v3
    v_lshl_add_u32 v17, v18, 2, v17
    v_lshrrev_b32 v18, 2, v2
    v_and_b32 v19, 1, v18
    v_add_u32 v17, v17, v19
    v_lshrrev_b32 v18, 1, v18
    v_lshl_add_u32 v17, v18, 3, v17
    v_mul_u32_u24 v16, 400, v17
    v_and_b32 v18, 3, v2
    v_lshl_add_u32 v16, v18, 3, v16
    v_add_u32 v16, 90112, v16
    s_mul_i32 s24, s3, 96
    v_add_u32 v16, s24, v16
    s_mul_i32 s45, s44, 384
    s_add_u32 s46, s45, 0
    buffer_load_dwordx4 v[24:27], v4, s[12:15], s46 offen
    buffer_load_dwordx4 v[28:31], v5, s[12:15], s46 offen
    buffer_load_dwordx4 v[32:35], v6, s[12:15], s46 offen
    buffer_load_dwordx4 v[36:39], v7, s[12:15], s46 offen
    buffer_load_dwordx4 v[40:43], v8, s[12:15], s46 offen
    buffer_load_dwordx4 v[44:47], v9, s[12:15], s46 offen
    s_add_u32 s46, s45, 786432
    buffer_load_dwordx4 v[48:51], v4, s[12:15], s46 offen
    buffer_load_dwordx4 v[52:55], v5, s[12:15], s46 offen
    buffer_load_dwordx4 v[56:59], v6, s[12:15], s46 offen
    buffer_load_dwordx4 v[60:63], v7, s[12:15], s46 offen
    buffer_load_dwordx4 v[64:67], v8, s[12:15], s46 offen
    buffer_load_dwordx4 v[68:71], v9, s[12:15], s46 offen
    s_waitcnt vmcnt(6)
    ds_write_b128 v10, v[24:27]
    ds_write_b128 v11, v[28:31]
    ds_write_b128 v12, v[32:35]
    ds_write_b128 v13, v[36:39]
    ds_write_b128 v14, v[40:43]
    ds_write_b128 v15, v[44:47]
    s_add_u32 s46, s45, 1572864
    buffer_load_dwordx4 v[72:75], v4, s[12:15], s46 offen
    buffer_load_dwordx4 v[76:79], v5, s[12:15], s46 offen
    buffer_load_dwordx4 v[80:83], v6, s[12:15], s46 offen
    buffer_load_dwordx4 v[84:87], v7, s[12:15], s46 offen
    buffer_load_dwordx4 v[88:91], v8, s[12:15], s46 offen
    buffer_load_dwordx4 v[92:95], v9, s[12:15], s46 offen
    s_waitcnt lgkmcnt(0)
    s_barrier
    ds_read_b64_tr_b16 a[0:1], v16 offset:0
    ds_read_b64_tr_b16 a[2:3], v16 offset:800
    ds_read_b64_tr_b16 a[4:5], v16 offset:12800
    ds_read_b64_tr_b16 a[6:7], v16 offset:13600
    ds_read_b64_tr_b16 a[80:81], v16 offset:32
    ds_read_b64_tr_b16 a[82:83], v16 offset:832
    ds_read_b64_tr_b16 a[84:85], v16 offset:12832
    ds_read_b64_tr_b16 a[86:87], v16 offset:13632
    ds_read_b64_tr_b16 a[160:161], v16 offset:64
    ds_read_b64_tr_b16 a[162:163], v16 offset:864
    ds_read_b64_tr_b16 a[164:165], v16 offset:12864
    ds_read_b64_tr_b16 a[166:167], v16 offset:13664
    s_waitcnt lgkmcnt(0)
    s_barrier
    s_waitcnt vmcnt(6)
    ds_write_b128 v10, v[48:51]
    ds_write_b128 v11, v[52:55]
    ds_write_b128 v12, v[56:59]
    ds_write_b128 v13, v[60:63]
    ds_write_b128 v14, v[64:67]
    ds_write_b128 v15, v[68:71]
    s_add_u32 s46, s45, 2359296
    buffer_load_dwordx4 v[24:27], v4, s[12:15], s46 offen
    buffer_load_dwordx4 v[28:31], v5, s[12:15], s46 offen
    buffer_load_dwordx4 v[32:35], v6, s[12:15], s46 offen
    buffer_load_dwordx4 v[36:39], v7, s[12:15], s46 offen
    buffer_load_dwordx4 v[40:43], v8, s[12:15], s46 offen
    buffer_load_dwordx4 v[44:47], v9, s[12:15], s46 offen
    s_waitcnt lgkmcnt(0)
    s_barrier
    ds_read_b64_tr_b16 a[8:9], v16 offset:0
    ds_read_b64_tr_b16 a[10:11], v16 offset:800
    ds_read_b64_tr_b16 a[12:13], v16 offset:12800
    ds_read_b64_tr_b16 a[14:15], v16 offset:13600
    ds_read_b64_tr_b16 a[88:89], v16 offset:32
    ds_read_b64_tr_b16 a[90:91], v16 offset:832
    ds_read_b64_tr_b16 a[92:93], v16 offset:12832
    ds_read_b64_tr_b16 a[94:95], v16 offset:13632
    ds_read_b64_tr_b16 a[168:169], v16 offset:64
    ds_read_b64_tr_b16 a[170:171], v16 offset:864
    ds_read_b64_tr_b16 a[172:173], v16 offset:12864
    ds_read_b64_tr_b16 a[174:175], v16 offset:13664
    s_waitcnt lgkmcnt(0)
    s_barrier
    s_waitcnt vmcnt(6)
    ds_write_b128 v10, v[72:75]
    ds_write_b128 v11, v[76:79]
    ds_write_b128 v12, v[80:83]
    ds_write_b128 v13, v[84:87]
    ds_write_b128 v14, v[88:91]
    ds_write_b128 v15, v[92:95]
    s_add_u32 s46, s45, 3145728
    buffer_load_dwordx4 v[48:51], v4, s[12:15], s46 offen
    buffer_load_dwordx4 v[52:55], v5, s[12:15], s46 offen
    buffer_load_dwordx4 v[56:59], v6, s[12:15], s46 offen
    buffer_load_dwordx4 v[60:63], v7, s[12:15], s46 offen
    buffer_load_dwordx4 v[64:67], v8, s[12:15], s46 offen
    buffer_load_dwordx4 v[68:71], v9, s[12:15], s46 offen
    s_waitcnt lgkmcnt(0)
    s_barrier
    ds_read_b64_tr_b16 a[16:17], v16 offset:0
    ds_read_b64_tr_b16 a[18:19], v16 offset:800
    ds_read_b64_tr_b16 a[20:21], v16 offset:12800
    ds_read_b64_tr_b16 a[22:23], v16 offset:13600
    ds_read_b64_tr_b16 a[96:97], v16 offset:32
    ds_read_b64_tr_b16 a[98:99], v16 offset:832
    ds_read_b64_tr_b16 a[100:101], v16 offset:12832
    ds_read_b64_tr_b16 a[102:103], v16 offset:13632
    ds_read_b64_tr_b16 a[176:177], v16 offset:64
    ds_read_b64_tr_b16 a[178:179], v16 offset:864
    ds_read_b64_tr_b16 a[180:181], v16 offset:12864
    ds_read_b64_tr_b16 a[182:183], v16 offset:13664
    s_waitcnt lgkmcnt(0)
    s_barrier
    s_waitcnt vmcnt(6)
    ds_write_b128 v10, v[24:27]
    ds_write_b128 v11, v[28:31]
    ds_write_b128 v12, v[32:35]
    ds_write_b128 v13, v[36:39]
    ds_write_b128 v14, v[40:43]
    ds_write_b128 v15, v[44:47]
    s_add_u32 s46, s45, 3932160
    buffer_load_dwordx4 v[72:75], v4, s[12:15], s46 offen
    buffer_load_dwordx4 v[76:79], v5, s[12:15], s46 offen
    buffer_load_dwordx4 v[80:83], v6, s[12:15], s46 offen
    buffer_load_dwordx4 v[84:87], v7, s[12:15], s46 offen
    buffer_load_dwordx4 v[88:91], v8, s[12:15], s46 offen
    buffer_load_dwordx4 v[92:95], v9, s[12:15], s46 offen
    s_waitcnt lgkmcnt(0)
    s_barrier
    ds_read_b64_tr_b16 a[24:25], v16 offset:0
    ds_read_b64_tr_b16 a[26:27], v16 offset:800
    ds_read_b64_tr_b16 a[28:29], v16 offset:12800
    ds_read_b64_tr_b16 a[30:31], v16 offset:13600
    ds_read_b64_tr_b16 a[104:105], v16 offset:32
    ds_read_b64_tr_b16 a[106:107], v16 offset:832
    ds_read_b64_tr_b16 a[108:109], v16 offset:12832
    ds_read_b64_tr_b16 a[110:111], v16 offset:13632
    ds_read_b64_tr_b16 a[184:185], v16 offset:64
    ds_read_b64_tr_b16 a[186:187], v16 offset:864
    ds_read_b64_tr_b16 a[188:189], v16 offset:12864
    ds_read_b64_tr_b16 a[190:191], v16 offset:13664
    s_waitcnt lgkmcnt(0)
    s_barrier
    s_waitcnt vmcnt(6)
    ds_write_b128 v10, v[48:51]
    ds_write_b128 v11, v[52:55]
    ds_write_b128 v12, v[56:59]
    ds_write_b128 v13, v[60:63]
    ds_write_b128 v14, v[64:67]
    ds_write_b128 v15, v[68:71]
    s_add_u32 s46, s45, 4718592
    buffer_load_dwordx4 v[24:27], v4, s[12:15], s46 offen
    buffer_load_dwordx4 v[28:31], v5, s[12:15], s46 offen
    buffer_load_dwordx4 v[32:35], v6, s[12:15], s46 offen
    buffer_load_dwordx4 v[36:39], v7, s[12:15], s46 offen
    buffer_load_dwordx4 v[40:43], v8, s[12:15], s46 offen
    buffer_load_dwordx4 v[44:47], v9, s[12:15], s46 offen
    s_waitcnt lgkmcnt(0)
    s_barrier
    ds_read_b64_tr_b16 a[32:33], v16 offset:0
    ds_read_b64_tr_b16 a[34:35], v16 offset:800
    ds_read_b64_tr_b16 a[36:37], v16 offset:12800
    ds_read_b64_tr_b16 a[38:39], v16 offset:13600
    ds_read_b64_tr_b16 a[112:113], v16 offset:32
    ds_read_b64_tr_b16 a[114:115], v16 offset:832
    ds_read_b64_tr_b16 a[116:117], v16 offset:12832
    ds_read_b64_tr_b16 a[118:119], v16 offset:13632
    ds_read_b64_tr_b16 a[192:193], v16 offset:64
    ds_read_b64_tr_b16 a[194:195], v16 offset:864
    ds_read_b64_tr_b16 a[196:197], v16 offset:12864
    ds_read_b64_tr_b16 a[198:199], v16 offset:13664
    s_waitcnt lgkmcnt(0)
    s_barrier
    s_waitcnt vmcnt(6)
    ds_write_b128 v10, v[72:75]
    ds_write_b128 v11, v[76:79]
    ds_write_b128 v12, v[80:83]
    ds_write_b128 v13, v[84:87]
    ds_write_b128 v14, v[88:91]
    ds_write_b128 v15, v[92:95]
    s_add_u32 s46, s45, 5505024
    buffer_load_dwordx4 v[48:51], v4, s[12:15], s46 offen
    buffer_load_dwordx4 v[52:55], v5, s[12:15], s46 offen
    buffer_load_dwordx4 v[56:59], v6, s[12:15], s46 offen
    buffer_load_dwordx4 v[60:63], v7, s[12:15], s46 offen
    buffer_load_dwordx4 v[64:67], v8, s[12:15], s46 offen
    buffer_load_dwordx4 v[68:71], v9, s[12:15], s46 offen
    s_waitcnt lgkmcnt(0)
    s_barrier
    ds_read_b64_tr_b16 a[40:41], v16 offset:0
    ds_read_b64_tr_b16 a[42:43], v16 offset:800
    ds_read_b64_tr_b16 a[44:45], v16 offset:12800
    ds_read_b64_tr_b16 a[46:47], v16 offset:13600
    ds_read_b64_tr_b16 a[120:121], v16 offset:32
    ds_read_b64_tr_b16 a[122:123], v16 offset:832
    ds_read_b64_tr_b16 a[124:125], v16 offset:12832
    ds_read_b64_tr_b16 a[126:127], v16 offset:13632
    ds_read_b64_tr_b16 a[200:201], v16 offset:64
    ds_read_b64_tr_b16 a[202:203], v16 offset:864
    ds_read_b64_tr_b16 a[204:205], v16 offset:12864
    ds_read_b64_tr_b16 a[206:207], v16 offset:13664
    s_waitcnt lgkmcnt(0)
    s_barrier
    s_waitcnt vmcnt(6)
    ds_write_b128 v10, v[24:27]
    ds_write_b128 v11, v[28:31]
    ds_write_b128 v12, v[32:35]
    ds_write_b128 v13, v[36:39]
    ds_write_b128 v14, v[40:43]
    ds_write_b128 v15, v[44:47]
    s_add_u32 s46, s45, 6291456
    buffer_load_dwordx4 v[72:75], v4, s[12:15], s46 offen
    buffer_load_dwordx4 v[76:79], v5, s[12:15], s46 offen
    buffer_load_dwordx4 v[80:83], v6, s[12:15], s46 offen
    buffer_load_dwordx4 v[84:87], v7, s[12:15], s46 offen
    buffer_load_dwordx4 v[88:91], v8, s[12:15], s46 offen
    buffer_load_dwordx4 v[92:95], v9, s[12:15], s46 offen
    s_waitcnt lgkmcnt(0)
    s_barrier
    ds_read_b64_tr_b16 a[48:49], v16 offset:0
    ds_read_b64_tr_b16 a[50:51], v16 offset:800
    ds_read_b64_tr_b16 a[52:53], v16 offset:12800
    ds_read_b64_tr_b16 a[54:55], v16 offset:13600
    ds_read_b64_tr_b16 a[128:129], v16 offset:32
    ds_read_b64_tr_b16 a[130:131], v16 offset:832
    ds_read_b64_tr_b16 a[132:133], v16 offset:12832
    ds_read_b64_tr_b16 a[134:135], v16 offset:13632
    ds_read_b64_tr_b16 a[208:209], v16 offset:64
    ds_read_b64_tr_b16 a[210:211], v16 offset:864
    ds_read_b64_tr_b16 a[212:213], v16 offset:12864
    ds_read_b64_tr_b16 a[214:215], v16 offset:13664
    s_waitcnt lgkmcnt(0)
    s_barrier
    s_waitcnt vmcnt(6)
    ds_write_b128 v10, v[48:51]
    ds_write_b128 v11, v[52:55]
    ds_write_b128 v12, v[56:59]
    ds_write_b128 v13, v[60:63]
    ds_write_b128 v14, v[64:67]
    ds_write_b128 v15, v[68:71]
    s_add_u32 s46, s45, 7077888
    buffer_load_dwordx4 v[24:27], v4, s[12:15], s46 offen
    buffer_load_dwordx4 v[28:31], v5, s[12:15], s46 offen
    buffer_load_dwordx4 v[32:35], v6, s[12:15], s46 offen
    buffer_load_dwordx4 v[36:39], v7, s[12:15], s46 offen
    buffer_load_dwordx4 v[40:43], v8, s[12:15], s46 offen
    buffer_load_dwordx4 v[44:47], v9, s[12:15], s46 offen
    s_waitcnt lgkmcnt(0)
    s_barrier
    ds_read_b64_tr_b16 a[56:57], v16 offset:0
    ds_read_b64_tr_b16 a[58:59], v16 offset:800
    ds_read_b64_tr_b16 a[60:61], v16 offset:12800
    ds_read_b64_tr_b16 a[62:63], v16 offset:13600
    ds_read_b64_tr_b16 a[136:137], v16 offset:32
    ds_read_b64_tr_b16 a[138:139], v16 offset:832
    ds_read_b64_tr_b16 a[140:141], v16 offset:12832
    ds_read_b64_tr_b16 a[142:143], v16 offset:13632
    ds_read_b64_tr_b16 a[216:217], v16 offset:64
    ds_read_b64_tr_b16 a[218:219], v16 offset:864
    ds_read_b64_tr_b16 a[220:221], v16 offset:12864
    ds_read_b64_tr_b16 a[222:223], v16 offset:13664
    s_waitcnt lgkmcnt(0)
    s_barrier
    s_waitcnt vmcnt(6)
    ds_write_b128 v10, v[72:75]
    ds_write_b128 v11, v[76:79]
    ds_write_b128 v12, v[80:83]
    ds_write_b128 v13, v[84:87]
    ds_write_b128 v14, v[88:91]
    ds_write_b128 v15, v[92:95]
    s_waitcnt lgkmcnt(0)
    s_barrier
    ds_read_b64_tr_b16 a[64:65], v16 offset:0
    ds_read_b64_tr_b16 a[66:67], v16 offset:800
    ds_read_b64_tr_b16 a[68:69], v16 offset:12800
    ds_read_b64_tr_b16 a[70:71], v16 offset:13600
    ds_read_b64_tr_b16 a[144:145], v16 offset:32
    ds_read_b64_tr_b16 a[146:147], v16 offset:832
    ds_read_b64_tr_b16 a[148:149], v16 offset:12832
    ds_read_b64_tr_b16 a[150:151], v16 offset:13632
    ds_read_b64_tr_b16 a[224:225], v16 offset:64
    ds_read_b64_tr_b16 a[226:227], v16 offset:864
    ds_read_b64_tr_b16 a[228:229], v16 offset:12864
    ds_read_b64_tr_b16 a[230:231], v16 offset:13664
    s_waitcnt lgkmcnt(0)
    s_barrier
    s_waitcnt vmcnt(0)
    ds_write_b128 v10, v[24:27]
    ds_write_b128 v11, v[28:31]
    ds_write_b128 v12, v[32:35]
    ds_write_b128 v13, v[36:39]
    ds_write_b128 v14, v[40:43]
    ds_write_b128 v15, v[44:47]
    s_waitcnt lgkmcnt(0)
    s_barrier
    ds_read_b64_tr_b16 a[72:73], v16 offset:0
    ds_read_b64_tr_b16 a[74:75], v16 offset:800
    ds_read_b64_tr_b16 a[76:77], v16 offset:12800
    ds_read_b64_tr_b16 a[78:79], v16 offset:13600
    ds_read_b64_tr_b16 a[152:153], v16 offset:32
    ds_read_b64_tr_b16 a[154:155], v16 offset:832
    ds_read_b64_tr_b16 a[156:157], v16 offset:12832
    ds_read_b64_tr_b16 a[158:159], v16 offset:13632
    ds_read_b64_tr_b16 a[232:233], v16 offset:64
    ds_read_b64_tr_b16 a[234:235], v16 offset:864
    ds_read_b64_tr_b16 a[236:237], v16 offset:12864
    ds_read_b64_tr_b16 a[238:239], v16 offset:13664
    s_waitcnt lgkmcnt(0)
    s_barrier
    v_add_u32 v64, 0, v0
    s_mov_b32 s24, 1639
    v_mul_lo_u32 v65, v64, s24
    v_lshrrev_b32 v65, 16, v65
    v_mul_u32_u24 v66, 40, v65
    v_sub_u32 v66, v64, v66
    s_mov_b32 s24, 1280
    v_mul_lo_u32 v4, v65, s24
    v_lshl_add_u32 v4, v66, 4, v4
    v_mul_u32_u24 v14, 656, v65
    v_lshl_add_u32 v14, v66, 4, v14
    v_add_u32 v14, 90112, v14
    v_add_u32 v64, 256, v0
    s_mov_b32 s24, 1639
    v_mul_lo_u32 v65, v64, s24
    v_lshrrev_b32 v65, 16, v65
    v_mul_u32_u24 v66, 40, v65
    v_sub_u32 v66, v64, v66
    s_mov_b32 s24, 1280
    v_mul_lo_u32 v5, v65, s24
    v_lshl_add_u32 v5, v66, 4, v5
    v_mul_u32_u24 v15, 656, v65
    v_lshl_add_u32 v15, v66, 4, v15
    v_add_u32 v15, 90112, v15
    v_add_u32 v64, 512, v0
    s_mov_b32 s24, 1639
    v_mul_lo_u32 v65, v64, s24
    v_lshrrev_b32 v65, 16, v65
    v_mul_u32_u24 v66, 40, v65
    v_sub_u32 v66, v64, v66
    s_mov_b32 s24, 1280
    v_mul_lo_u32 v6, v65, s24
    v_lshl_add_u32 v6, v66, 4, v6
    v_mul_u32_u24 v16, 656, v65
    v_lshl_add_u32 v16, v66, 4, v16
    v_add_u32 v16, 90112, v16
    v_add_u32 v64, 768, v0
    s_mov_b32 s24, 1639
    v_mul_lo_u32 v65, v64, s24
    v_lshrrev_b32 v65, 16, v65
    v_mul_u32_u24 v66, 40, v65
    v_sub_u32 v66, v64, v66
    s_mov_b32 s24, 1280
    v_mul_lo_u32 v7, v65, s24
    v_lshl_add_u32 v7, v66, 4, v7
    v_mul_u32_u24 v17, 656, v65
    v_lshl_add_u32 v17, v66, 4, v17
    v_add_u32 v17, 90112, v17
    v_add_u32 v64, 1024, v0
    s_mov_b32 s24, 1639
    v_mul_lo_u32 v65, v64, s24
    v_lshrrev_b32 v65, 16, v65
    v_mul_u32_u24 v66, 40, v65
    v_sub_u32 v66, v64, v66
    s_mov_b32 s24, 1280
    v_mul_lo_u32 v8, v65, s24
    v_lshl_add_u32 v8, v66, 4, v8
    v_mul_u32_u24 v18, 656, v65
    v_lshl_add_u32 v18, v66, 4, v18
    v_add_u32 v18, 90112, v18
    v_add_u32 v64, 1280, v0
    s_mov_b32 s24, 1639
    v_mul_lo_u32 v65, v64, s24
    v_lshrrev_b32 v65, 16, v65
    v_mul_u32_u24 v66, 40, v65
    v_sub_u32 v66, v64, v66
    s_mov_b32 s24, 1280
    v_mul_lo_u32 v9, v65, s24
    v_lshl_add_u32 v9, v66, 4, v9
    v_mul_u32_u24 v19, 656, v65
    v_lshl_add_u32 v19, v66, 4, v19
    v_add_u32 v19, 90112, v19
    v_add_u32 v64, 1536, v0
    s_mov_b32 s24, 1639
    v_mul_lo_u32 v65, v64, s24
    v_lshrrev_b32 v65, 16, v65
    v_mul_u32_u24 v66, 40, v65
    v_sub_u32 v66, v64, v66
    s_mov_b32 s24, 1280
    v_mul_lo_u32 v10, v65, s24
    v_lshl_add_u32 v10, v66, 4, v10
    v_mul_u32_u24 v20, 656, v65
    v_lshl_add_u32 v20, v66, 4, v20
    v_add_u32 v20, 90112, v20
    v_add_u32 v64, 1792, v0
    s_mov_b32 s24, 1639
    v_mul_lo_u32 v65, v64, s24
    v_lshrrev_b32 v65, 16, v65
    v_mul_u32_u24 v66, 40, v65
    v_sub_u32 v66, v64, v66
    s_mov_b32 s24, 1280
    v_mul_lo_u32 v11, v65, s24
    v_lshl_add_u32 v11, v66, 4, v11
    v_mul_u32_u24 v21, 656, v65
    v_lshl_add_u32 v21, v66, 4, v21
    v_add_u32 v21, 90112, v21
    v_add_u32 v64, 2048, v0
    s_mov_b32 s24, 1639
    v_mul_lo_u32 v65, v64, s24
    v_lshrrev_b32 v65, 16, v65
    v_mul_u32_u24 v66, 40, v65
    v_sub_u32 v66, v64, v66
    s_mov_b32 s24, 1280
    v_mul_lo_u32 v12, v65, s24
    v_lshl_add_u32 v12, v66, 4, v12
    v_mul_u32_u24 v22, 656, v65
    v_lshl_add_u32 v22, v66, 4, v22
    v_add_u32 v22, 90112, v22
    v_add_u32 v64, 2304, v0
    s_mov_b32 s24, 1639
    v_mul_lo_u32 v65, v64, s24
    v_lshrrev_b32 v65, 16, v65
    v_mul_u32_u24 v66, 40, v65
    v_sub_u32 v66, v64, v66
    s_mov_b32 s24, 1280
    v_mul_lo_u32 v13, v65, s24
    v_lshl_add_u32 v13, v66, 4, v13
    v_mul_u32_u24 v23, 656, v65
    v_lshl_add_u32 v23, v66, 4, v23
    v_add_u32 v23, 90112, v23
    v_lshrrev_b32 v64, 1, v3
    v_lshlrev_b32 v64, 4, v64
    v_and_b32 v65, 1, v3
    v_lshl_add_u32 v64, v65, 2, v64
    v_lshrrev_b32 v65, 2, v2
    v_and_b32 v66, 1, v65
    v_add_u32 v64, v64, v66
    v_lshrrev_b32 v65, 1, v65
    v_lshl_add_u32 v64, v65, 3, v64
    v_mul_u32_u24 v72, 656, v64
    v_and_b32 v65, 3, v2
    v_lshl_add_u32 v72, v65, 3, v72
    v_add_u32 v72, 90112, v72
    s_and_b32 s24, s3, 1
    s_mul_i32 s24, s24, 320
    v_add_u32 v72, s24, v72
    v_lshlrev_b32 v73, 4, v1
    s_mul_i32 s24, s3, 18432
    s_add_u32 s24, s24, 16384
    v_add_u32 v73, s24, v73
    s_mul_i32 s45, s44, 245760
    s_add_u32 s46, s45, 0
    buffer_load_dwordx4 v[24:27], v4, s[16:19], s46 offen
    buffer_load_dwordx4 v[28:31], v5, s[16:19], s46 offen
    buffer_load_dwordx4 v[32:35], v6, s[16:19], s46 offen
    buffer_load_dwordx4 v[36:39], v7, s[16:19], s46 offen
    buffer_load_dwordx4 v[40:43], v8, s[16:19], s46 offen
    buffer_load_dwordx4 v[44:47], v9, s[16:19], s46 offen
    buffer_load_dwordx4 v[48:51], v10, s[16:19], s46 offen
    buffer_load_dwordx4 v[52:55], v11, s[16:19], s46 offen
    buffer_load_dwordx4 v[56:59], v12, s[16:19], s46 offen
    buffer_load_dwordx4 v[60:63], v13, s[16:19], s46 offen
    s_waitcnt vmcnt(0)
    ds_write_b128 v14, v[24:27]
    ds_write_b128 v15, v[28:31]
    ds_write_b128 v16, v[32:35]
    ds_write_b128 v17, v[36:39]
    ds_write_b128 v18, v[40:43]
    ds_write_b128 v19, v[44:47]
    ds_write_b128 v20, v[48:51]
    ds_write_b128 v21, v[52:55]
    ds_write_b128 v22, v[56:59]
    ds_write_b128 v23, v[60:63]
    s_waitcnt lgkmcnt(0)
    s_barrier
    s_lshr_b32 s24, s3, 1
    s_cmp_eq_u32 s24, 0
    s_cbranch_scc0 chain1_kernel_wo1
    ds_read_b64_tr_b16 a[240:241], v72 offset:0
    ds_read_b64_tr_b16 a[242:243], v72 offset:1312
    ds_read_b64_tr_b16 a[244:245], v72 offset:20992
    ds_read_b64_tr_b16 a[246:247], v72 offset:22304
    ds_read_b64_tr_b16 v[112:113], v72 offset:32
    ds_read_b64_tr_b16 v[114:115], v72 offset:1344
    ds_read_b64_tr_b16 v[116:117], v72 offset:21024
    ds_read_b64_tr_b16 v[118:119], v72 offset:22336
    ds_read_b64_tr_b16 v[136:137], v72 offset:64
    ds_read_b64_tr_b16 v[138:139], v72 offset:1376
    ds_read_b64_tr_b16 v[140:141], v72 offset:21056
    ds_read_b64_tr_b16 v[142:143], v72 offset:22368
    ds_read_b64_tr_b16 v[160:161], v72 offset:96
    ds_read_b64_tr_b16 v[162:163], v72 offset:1408
    ds_read_b64_tr_b16 v[164:165], v72 offset:21088
    ds_read_b64_tr_b16 v[166:167], v72 offset:22400
    ds_read_b64_tr_b16 v[184:185], v72 offset:128
    ds_read_b64_tr_b16 v[186:187], v72 offset:1440
    ds_read_b64_tr_b16 v[188:189], v72 offset:21120
    ds_read_b64_tr_b16 v[190:191], v72 offset:22432
    ds_read_b64_tr_b16 v[208:209], v72 offset:160
    ds_read_b64_tr_b16 v[210:211], v72 offset:1472
    ds_read_b64_tr_b16 v[212:213], v72 offset:21152
    ds_read_b64_tr_b16 v[214:215], v72 offset:22464
    ds_read_b64_tr_b16 v[232:233], v72 offset:192
    ds_read_b64_tr_b16 v[234:235], v72 offset:1504
    ds_read_b64_tr_b16 v[236:237], v72 offset:21184
    ds_read_b64_tr_b16 v[238:239], v72 offset:22496
    ds_read_b64_tr_b16 v[64:65], v72 offset:224
    ds_read_b64_tr_b16 v[66:67], v72 offset:1536
    ds_read_b64_tr_b16 v[68:69], v72 offset:21216
    ds_read_b64_tr_b16 v[70:71], v72 offset:22528
    s_waitcnt lgkmcnt(0)
    ds_write_b128 v73, v[64:67] offset:0
    ds_write_b128 v73, v[68:71] offset:1024
    s_waitcnt lgkmcnt(0)
    ds_read_b64_tr_b16 v[64:65], v72 offset:256
    ds_read_b64_tr_b16 v[66:67], v72 offset:1568
    ds_read_b64_tr_b16 v[68:69], v72 offset:21248
    ds_read_b64_tr_b16 v[70:71], v72 offset:22560
    s_waitcnt lgkmcnt(0)
    ds_write_b128 v73, v[64:67] offset:6144
    ds_write_b128 v73, v[68:71] offset:7168
    s_waitcnt lgkmcnt(0)
    ds_read_b64_tr_b16 v[64:65], v72 offset:288
    ds_read_b64_tr_b16 v[66:67], v72 offset:1600
    ds_read_b64_tr_b16 v[68:69], v72 offset:21280
    ds_read_b64_tr_b16 v[70:71], v72 offset:22592
    s_waitcnt lgkmcnt(0)
    ds_write_b128 v73, v[64:67] offset:12288
    ds_write_b128 v73, v[68:71] offset:13312
    s_waitcnt lgkmcnt(0)
    s_waitcnt lgkmcnt(0)
chain1_kernel_wo1:
    s_barrier
    s_add_u32 s46, s45, 640
    buffer_load_dwordx4 v[24:27], v4, s[16:19], s46 offen
    buffer_load_dwordx4 v[28:31], v5, s[16:19], s46 offen
    buffer_load_dwordx4 v[32:35], v6, s[16:19], s46 offen
    buffer_load_dwordx4 v[36:39], v7, s[16:19], s46 offen
    buffer_load_dwordx4 v[40:43], v8, s[16:19], s46 offen
    buffer_load_dwordx4 v[44:47], v9, s[16:19], s46 offen
    buffer_load_dwordx4 v[48:51], v10, s[16:19], s46 offen
    buffer_load_dwordx4 v[52:55], v11, s[16:19], s46 offen
    buffer_load_dwordx4 v[56:59], v12, s[16:19], s46 offen
    buffer_load_dwordx4 v[60:63], v13, s[16:19], s46 offen
    s_waitcnt vmcnt(0)
    ds_write_b128 v14, v[24:27]
    ds_write_b128 v15, v[28:31]
    ds_write_b128 v16, v[32:35]
    ds_write_b128 v17, v[36:39]
    ds_write_b128 v18, v[40:43]
    ds_write_b128 v19, v[44:47]
    ds_write_b128 v20, v[48:51]
    ds_write_b128 v21, v[52:55]
    ds_write_b128 v22, v[56:59]
    ds_write_b128 v23, v[60:63]
    s_waitcnt lgkmcnt(0)
    s_barrier
    s_lshr_b32 s24, s3, 1
    s_cmp_eq_u32 s24, 1
    s_cbranch_scc0 chain1_kernel_wo2
    ds_read_b64_tr_b16 a[240:241], v72 offset:0
    ds_read_b64_tr_b16 a[242:243], v72 offset:1312
    ds_read_b64_tr_b16 a[244:245], v72 offset:20992
    ds_read_b64_tr_b16 a[246:247], v72 offset:22304
    ds_read_b64_tr_b16 v[112:113], v72 offset:32
    ds_read_b64_tr_b16 v[114:115], v72 offset:1344
    ds_read_b64_tr_b16 v[116:117], v72 offset:21024
    ds_read_b64_tr_b16 v[118:119], v72 offset:22336
    ds_read_b64_tr_b16 v[136:137], v72 offset:64
    ds_read_b64_tr_b16 v[138:139], v72 offset:1376
    ds_read_b64_tr_b16 v[140:141], v72 offset:21056
    ds_read_b64_tr_b16 v[142:143], v72 offset:22368
    ds_read_b64_tr_b16 v[160:161], v72 offset:96
    ds_read_b64_tr_b16 v[162:163], v72 offset:1408
    ds_read_b64_tr_b16 v[164:165], v72 offset:21088
    ds_read_b64_tr_b16 v[166:167], v72 offset:22400
    ds_read_b64_tr_b16 v[184:185], v72 offset:128
    ds_read_b64_tr_b16 v[186:187], v72 offset:1440
    ds_read_b64_tr_b16 v[188:189], v72 offset:21120
    ds_read_b64_tr_b16 v[190:191], v72 offset:22432
    ds_read_b64_tr_b16 v[208:209], v72 offset:160
    ds_read_b64_tr_b16 v[210:211], v72 offset:1472
    ds_read_b64_tr_b16 v[212:213], v72 offset:21152
    ds_read_b64_tr_b16 v[214:215], v72 offset:22464
    ds_read_b64_tr_b16 v[232:233], v72 offset:192
    ds_read_b64_tr_b16 v[234:235], v72 offset:1504
    ds_read_b64_tr_b16 v[236:237], v72 offset:21184
    ds_read_b64_tr_b16 v[238:239], v72 offset:22496
    ds_read_b64_tr_b16 v[64:65], v72 offset:224
    ds_read_b64_tr_b16 v[66:67], v72 offset:1536
    ds_read_b64_tr_b16 v[68:69], v72 offset:21216
    ds_read_b64_tr_b16 v[70:71], v72 offset:22528
    s_waitcnt lgkmcnt(0)
    ds_write_b128 v73, v[64:67] offset:0
    ds_write_b128 v73, v[68:71] offset:1024
    s_waitcnt lgkmcnt(0)
    ds_read_b64_tr_b16 v[64:65], v72 offset:256
    ds_read_b64_tr_b16 v[66:67], v72 offset:1568
    ds_read_b64_tr_b16 v[68:69], v72 offset:21248
    ds_read_b64_tr_b16 v[70:71], v72 offset:22560
    s_waitcnt lgkmcnt(0)
    ds_write_b128 v73, v[64:67] offset:6144
    ds_write_b128 v73, v[68:71] offset:7168
    s_waitcnt lgkmcnt(0)
    ds_read_b64_tr_b16 v[64:65], v72 offset:288
    ds_read_b64_tr_b16 v[66:67], v72 offset:1600
    ds_read_b64_tr_b16 v[68:69], v72 offset:21280
    ds_read_b64_tr_b16 v[70:71], v72 offset:22592
    s_waitcnt lgkmcnt(0)
    ds_write_b128 v73, v[64:67] offset:12288
    ds_write_b128 v73, v[68:71] offset:13312
    s_waitcnt lgkmcnt(0)
    s_waitcnt lgkmcnt(0)
chain1_kernel_wo2:
    s_barrier
    s_add_u32 s46, s45, 81920
    buffer_load_dwordx4 v[24:27], v4, s[16:19], s46 offen
    buffer_load_dwordx4 v[28:31], v5, s[16:19], s46 offen
    buffer_load_dwordx4 v[32:35], v6, s[16:19], s46 offen
    buffer_load_dwordx4 v[36:39], v7, s[16:19], s46 offen
    buffer_load_dwordx4 v[40:43], v8, s[16:19], s46 offen
    buffer_load_dwordx4 v[44:47], v9, s[16:19], s46 offen
    buffer_load_dwordx4 v[48:51], v10, s[16:19], s46 offen
    buffer_load_dwordx4 v[52:55], v11, s[16:19], s46 offen
    buffer_load_dwordx4 v[56:59], v12, s[16:19], s46 offen
    buffer_load_dwordx4 v[60:63], v13, s[16:19], s46 offen
    s_waitcnt vmcnt(0)
    ds_write_b128 v14, v[24:27]
    ds_write_b128 v15, v[28:31]
    ds_write_b128 v16, v[32:35]
    ds_write_b128 v17, v[36:39]
    ds_write_b128 v18, v[40:43]
    ds_write_b128 v19, v[44:47]
    ds_write_b128 v20, v[48:51]
    ds_write_b128 v21, v[52:55]
    ds_write_b128 v22, v[56:59]
    ds_write_b128 v23, v[60:63]
    s_waitcnt lgkmcnt(0)
    s_barrier
    s_lshr_b32 s24, s3, 1
    s_cmp_eq_u32 s24, 0
    s_cbranch_scc0 chain1_kernel_wo3
    ds_read_b64_tr_b16 a[248:249], v72 offset:0
    ds_read_b64_tr_b16 a[250:251], v72 offset:1312
    ds_read_b64_tr_b16 a[252:253], v72 offset:20992
    ds_read_b64_tr_b16 a[254:255], v72 offset:22304
    ds_read_b64_tr_b16 v[120:121], v72 offset:32
    ds_read_b64_tr_b16 v[122:123], v72 offset:1344
    ds_read_b64_tr_b16 v[124:125], v72 offset:21024
    ds_read_b64_tr_b16 v[126:127], v72 offset:22336
    ds_read_b64_tr_b16 v[144:145], v72 offset:64
    ds_read_b64_tr_b16 v[146:147], v72 offset:1376
    ds_read_b64_tr_b16 v[148:149], v72 offset:21056
    ds_read_b64_tr_b16 v[150:151], v72 offset:22368
    ds_read_b64_tr_b16 v[168:169], v72 offset:96
    ds_read_b64_tr_b16 v[170:171], v72 offset:1408
    ds_read_b64_tr_b16 v[172:173], v72 offset:21088
    ds_read_b64_tr_b16 v[174:175], v72 offset:22400
    ds_read_b64_tr_b16 v[192:193], v72 offset:128
    ds_read_b64_tr_b16 v[194:195], v72 offset:1440
    ds_read_b64_tr_b16 v[196:197], v72 offset:21120
    ds_read_b64_tr_b16 v[198:199], v72 offset:22432
    ds_read_b64_tr_b16 v[216:217], v72 offset:160
    ds_read_b64_tr_b16 v[218:219], v72 offset:1472
    ds_read_b64_tr_b16 v[220:221], v72 offset:21152
    ds_read_b64_tr_b16 v[222:223], v72 offset:22464
    ds_read_b64_tr_b16 v[240:241], v72 offset:192
    ds_read_b64_tr_b16 v[242:243], v72 offset:1504
    ds_read_b64_tr_b16 v[244:245], v72 offset:21184
    ds_read_b64_tr_b16 v[246:247], v72 offset:22496
    ds_read_b64_tr_b16 v[64:65], v72 offset:224
    ds_read_b64_tr_b16 v[66:67], v72 offset:1536
    ds_read_b64_tr_b16 v[68:69], v72 offset:21216
    ds_read_b64_tr_b16 v[70:71], v72 offset:22528
    s_waitcnt lgkmcnt(0)
    ds_write_b128 v73, v[64:67] offset:2048
    ds_write_b128 v73, v[68:71] offset:3072
    s_waitcnt lgkmcnt(0)
    ds_read_b64_tr_b16 v[64:65], v72 offset:256
    ds_read_b64_tr_b16 v[66:67], v72 offset:1568
    ds_read_b64_tr_b16 v[68:69], v72 offset:21248
    ds_read_b64_tr_b16 v[70:71], v72 offset:22560
    s_waitcnt lgkmcnt(0)
    ds_write_b128 v73, v[64:67] offset:8192
    ds_write_b128 v73, v[68:71] offset:9216
    s_waitcnt lgkmcnt(0)
    ds_read_b64_tr_b16 v[64:65], v72 offset:288
    ds_read_b64_tr_b16 v[66:67], v72 offset:1600
    ds_read_b64_tr_b16 v[68:69], v72 offset:21280
    ds_read_b64_tr_b16 v[70:71], v72 offset:22592
    s_waitcnt lgkmcnt(0)
    ds_write_b128 v73, v[64:67] offset:14336
    ds_write_b128 v73, v[68:71] offset:15360
    s_waitcnt lgkmcnt(0)
    s_waitcnt lgkmcnt(0)
chain1_kernel_wo3:
    s_barrier
    s_add_u32 s46, s45, 82560
    buffer_load_dwordx4 v[24:27], v4, s[16:19], s46 offen
    buffer_load_dwordx4 v[28:31], v5, s[16:19], s46 offen
    buffer_load_dwordx4 v[32:35], v6, s[16:19], s46 offen
    buffer_load_dwordx4 v[36:39], v7, s[16:19], s46 offen
    buffer_load_dwordx4 v[40:43], v8, s[16:19], s46 offen
    buffer_load_dwordx4 v[44:47], v9, s[16:19], s46 offen
    buffer_load_dwordx4 v[48:51], v10, s[16:19], s46 offen
    buffer_load_dwordx4 v[52:55], v11, s[16:19], s46 offen
    buffer_load_dwordx4 v[56:59], v12, s[16:19], s46 offen
    buffer_load_dwordx4 v[60:63], v13, s[16:19], s46 offen
    s_waitcnt vmcnt(0)
    ds_write_b128 v14, v[24:27]
    ds_write_b128 v15, v[28:31]
    ds_write_b128 v16, v[32:35]
    ds_write_b128 v17, v[36:39]
    ds_write_b128 v18, v[40:43]
    ds_write_b128 v19, v[44:47]
    ds_write_b128 v20, v[48:51]
    ds_write_b128 v21, v[52:55]
    ds_write_b128 v22, v[56:59]
    ds_write_b128 v23, v[60:63]
    s_waitcnt lgkmcnt(0)
    s_barrier
    s_lshr_b32 s24, s3, 1
    s_cmp_eq_u32 s24, 1
    s_cbranch_scc0 chain1_kernel_wo4
    ds_read_b64_tr_b16 a[248:249], v72 offset:0
    ds_read_b64_tr_b16 a[250:251], v72 offset:1312
    ds_read_b64_tr_b16 a[252:253], v72 offset:20992
    ds_read_b64_tr_b16 a[254:255], v72 offset:22304
    ds_read_b64_tr_b16 v[120:121], v72 offset:32
    ds_read_b64_tr_b16 v[122:123], v72 offset:1344
    ds_read_b64_tr_b16 v[124:125], v72 offset:21024
    ds_read_b64_tr_b16 v[126:127], v72 offset:22336
    ds_read_b64_tr_b16 v[144:145], v72 offset:64
    ds_read_b64_tr_b16 v[146:147], v72 offset:1376
    ds_read_b64_tr_b16 v[148:149], v72 offset:21056
    ds_read_b64_tr_b16 v[150:151], v72 offset:22368
    ds_read_b64_tr_b16 v[168:169], v72 offset:96
    ds_read_b64_tr_b16 v[170:171], v72 offset:1408
    ds_read_b64_tr_b16 v[172:173], v72 offset:21088
    ds_read_b64_tr_b16 v[174:175], v72 offset:22400
    ds_read_b64_tr_b16 v[192:193], v72 offset:128
    ds_read_b64_tr_b16 v[194:195], v72 offset:1440
    ds_read_b64_tr_b16 v[196:197], v72 offset:21120
    ds_read_b64_tr_b16 v[198:199], v72 offset:22432
    ds_read_b64_tr_b16 v[216:217], v72 offset:160
    ds_read_b64_tr_b16 v[218:219], v72 offset:1472
    ds_read_b64_tr_b16 v[220:221], v72 offset:21152
    ds_read_b64_tr_b16 v[222:223], v72 offset:22464
    ds_read_b64_tr_b16 v[240:241], v72 offset:192
    ds_read_b64_tr_b16 v[242:243], v72 offset:1504
    ds_read_b64_tr_b16 v[244:245], v72 offset:21184
    ds_read_b64_tr_b16 v[246:247], v72 offset:22496
    ds_read_b64_tr_b16 v[64:65], v72 offset:224
    ds_read_b64_tr_b16 v[66:67], v72 offset:1536
    ds_read_b64_tr_b16 v[68:69], v72 offset:21216
    ds_read_b64_tr_b16 v[70:71], v72 offset:22528
    s_waitcnt lgkmcnt(0)
    ds_write_b128 v73, v[64:67] offset:2048
    ds_write_b128 v73, v[68:71] offset:3072
    s_waitcnt lgkmcnt(0)
    ds_read_b64_tr_b16 v[64:65], v72 offset:256
    ds_read_b64_tr_b16 v[66:67], v72 offset:1568
    ds_read_b64_tr_b16 v[68:69], v72 offset:21248
    ds_read_b64_tr_b16 v[70:71], v72 offset:22560
    s_waitcnt lgkmcnt(0)
    ds_write_b128 v73, v[64:67] offset:8192
    ds_write_b128 v73, v[68:71] offset:9216
    s_waitcnt lgkmcnt(0)
    ds_read_b64_tr_b16 v[64:65], v72 offset:288
    ds_read_b64_tr_b16 v[66:67], v72 offset:1600
    ds_read_b64_tr_b16 v[68:69], v72 offset:21280
    ds_read_b64_tr_b16 v[70:71], v72 offset:22592
    s_waitcnt lgkmcnt(0)
    ds_write_b128 v73, v[64:67] offset:14336
    ds_write_b128 v73, v[68:71] offset:15360
    s_waitcnt lgkmcnt(0)
    s_waitcnt lgkmcnt(0)
chain1_kernel_wo4:
    s_barrier
    s_add_u32 s46, s45, 163840
    buffer_load_dwordx4 v[24:27], v4, s[16:19], s46 offen
    buffer_load_dwordx4 v[28:31], v5, s[16:19], s46 offen
    buffer_load_dwordx4 v[32:35], v6, s[16:19], s46 offen
    buffer_load_dwordx4 v[36:39], v7, s[16:19], s46 offen
    buffer_load_dwordx4 v[40:43], v8, s[16:19], s46 offen
    buffer_load_dwordx4 v[44:47], v9, s[16:19], s46 offen
    buffer_load_dwordx4 v[48:51], v10, s[16:19], s46 offen
    buffer_load_dwordx4 v[52:55], v11, s[16:19], s46 offen
    buffer_load_dwordx4 v[56:59], v12, s[16:19], s46 offen
    buffer_load_dwordx4 v[60:63], v13, s[16:19], s46 offen
    s_waitcnt vmcnt(0)
    ds_write_b128 v14, v[24:27]
    ds_write_b128 v15, v[28:31]
    ds_write_b128 v16, v[32:35]
    ds_write_b128 v17, v[36:39]
    ds_write_b128 v18, v[40:43]
    ds_write_b128 v19, v[44:47]
    ds_write_b128 v20, v[48:51]
    ds_write_b128 v21, v[52:55]
    ds_write_b128 v22, v[56:59]
    ds_write_b128 v23, v[60:63]
    s_waitcnt lgkmcnt(0)
    s_barrier
    s_lshr_b32 s24, s3, 1
    s_cmp_eq_u32 s24, 0
    s_cbranch_scc0 chain1_kernel_wo5
    ds_read_b64_tr_b16 v[104:105], v72 offset:0
    ds_read_b64_tr_b16 v[106:107], v72 offset:1312
    ds_read_b64_tr_b16 v[108:109], v72 offset:20992
    ds_read_b64_tr_b16 v[110:111], v72 offset:22304
    ds_read_b64_tr_b16 v[128:129], v72 offset:32
    ds_read_b64_tr_b16 v[130:131], v72 offset:1344
    ds_read_b64_tr_b16 v[132:133], v72 offset:21024
    ds_read_b64_tr_b16 v[134:135], v72 offset:22336
    ds_read_b64_tr_b16 v[152:153], v72 offset:64
    ds_read_b64_tr_b16 v[154:155], v72 offset:1376
    ds_read_b64_tr_b16 v[156:157], v72 offset:21056
    ds_read_b64_tr_b16 v[158:159], v72 offset:22368
    ds_read_b64_tr_b16 v[176:177], v72 offset:96
    ds_read_b64_tr_b16 v[178:179], v72 offset:1408
    ds_read_b64_tr_b16 v[180:181], v72 offset:21088
    ds_read_b64_tr_b16 v[182:183], v72 offset:22400
    ds_read_b64_tr_b16 v[200:201], v72 offset:128
    ds_read_b64_tr_b16 v[202:203], v72 offset:1440
    ds_read_b64_tr_b16 v[204:205], v72 offset:21120
    ds_read_b64_tr_b16 v[206:207], v72 offset:22432
    ds_read_b64_tr_b16 v[224:225], v72 offset:160
    ds_read_b64_tr_b16 v[226:227], v72 offset:1472
    ds_read_b64_tr_b16 v[228:229], v72 offset:21152
    ds_read_b64_tr_b16 v[230:231], v72 offset:22464
    ds_read_b64_tr_b16 v[248:249], v72 offset:192
    ds_read_b64_tr_b16 v[250:251], v72 offset:1504
    ds_read_b64_tr_b16 v[252:253], v72 offset:21184
    ds_read_b64_tr_b16 v[254:255], v72 offset:22496
    ds_read_b64_tr_b16 v[64:65], v72 offset:224
    ds_read_b64_tr_b16 v[66:67], v72 offset:1536
    ds_read_b64_tr_b16 v[68:69], v72 offset:21216
    ds_read_b64_tr_b16 v[70:71], v72 offset:22528
    s_waitcnt lgkmcnt(0)
    ds_write_b128 v73, v[64:67] offset:4096
    ds_write_b128 v73, v[68:71] offset:5120
    s_waitcnt lgkmcnt(0)
    ds_read_b64_tr_b16 v[64:65], v72 offset:256
    ds_read_b64_tr_b16 v[66:67], v72 offset:1568
    ds_read_b64_tr_b16 v[68:69], v72 offset:21248
    ds_read_b64_tr_b16 v[70:71], v72 offset:22560
    s_waitcnt lgkmcnt(0)
    ds_write_b128 v73, v[64:67] offset:10240
    ds_write_b128 v73, v[68:71] offset:11264
    s_waitcnt lgkmcnt(0)
    ds_read_b64_tr_b16 v[64:65], v72 offset:288
    ds_read_b64_tr_b16 v[66:67], v72 offset:1600
    ds_read_b64_tr_b16 v[68:69], v72 offset:21280
    ds_read_b64_tr_b16 v[70:71], v72 offset:22592
    s_waitcnt lgkmcnt(0)
    ds_write_b128 v73, v[64:67] offset:16384
    ds_write_b128 v73, v[68:71] offset:17408
    s_waitcnt lgkmcnt(0)
    s_waitcnt lgkmcnt(0)
chain1_kernel_wo5:
    s_barrier
    s_add_u32 s46, s45, 164480
    buffer_load_dwordx4 v[24:27], v4, s[16:19], s46 offen
    buffer_load_dwordx4 v[28:31], v5, s[16:19], s46 offen
    buffer_load_dwordx4 v[32:35], v6, s[16:19], s46 offen
    buffer_load_dwordx4 v[36:39], v7, s[16:19], s46 offen
    buffer_load_dwordx4 v[40:43], v8, s[16:19], s46 offen
    buffer_load_dwordx4 v[44:47], v9, s[16:19], s46 offen
    buffer_load_dwordx4 v[48:51], v10, s[16:19], s46 offen
    buffer_load_dwordx4 v[52:55], v11, s[16:19], s46 offen
    buffer_load_dwordx4 v[56:59], v12, s[16:19], s46 offen
    buffer_load_dwordx4 v[60:63], v13, s[16:19], s46 offen
    s_waitcnt vmcnt(0)
    ds_write_b128 v14, v[24:27]
    ds_write_b128 v15, v[28:31]
    ds_write_b128 v16, v[32:35]
    ds_write_b128 v17, v[36:39]
    ds_write_b128 v18, v[40:43]
    ds_write_b128 v19, v[44:47]
    ds_write_b128 v20, v[48:51]
    ds_write_b128 v21, v[52:55]
    ds_write_b128 v22, v[56:59]
    ds_write_b128 v23, v[60:63]
    s_waitcnt lgkmcnt(0)
    s_barrier
    s_lshr_b32 s24, s3, 1
    s_cmp_eq_u32 s24, 1
    s_cbranch_scc0 chain1_kernel_wo6
    ds_read_b64_tr_b16 v[104:105], v72 offset:0
    ds_read_b64_tr_b16 v[106:107], v72 offset:1312
    ds_read_b64_tr_b16 v[108:109], v72 offset:20992
    ds_read_b64_tr_b16 v[110:111], v72 offset:22304
    ds_read_b64_tr_b16 v[128:129], v72 offset:32
    ds_read_b64_tr_b16 v[130:131], v72 offset:1344
    ds_read_b64_tr_b16 v[132:133], v72 offset:21024
    ds_read_b64_tr_b16 v[134:135], v72 offset:22336
    ds_read_b64_tr_b16 v[152:153], v72 offset:64
    ds_read_b64_tr_b16 v[154:155], v72 offset:1376
    ds_read_b64_tr_b16 v[156:157], v72 offset:21056
    ds_read_b64_tr_b16 v[158:159], v72 offset:22368
    ds_read_b64_tr_b16 v[176:177], v72 offset:96
    ds_read_b64_tr_b16 v[178:179], v72 offset:1408
    ds_read_b64_tr_b16 v[180:181], v72 offset:21088
    ds_read_b64_tr_b16 v[182:183], v72 offset:22400
    ds_read_b64_tr_b16 v[200:201], v72 offset:128
    ds_read_b64_tr_b16 v[202:203], v72 offset:1440
    ds_read_b64_tr_b16 v[204:205], v72 offset:21120
    ds_read_b64_tr_b16 v[206:207], v72 offset:22432
    ds_read_b64_tr_b16 v[224:225], v72 offset:160
    ds_read_b64_tr_b16 v[226:227], v72 offset:1472
    ds_read_b64_tr_b16 v[228:229], v72 offset:21152
    ds_read_b64_tr_b16 v[230:231], v72 offset:22464
    ds_read_b64_tr_b16 v[248:249], v72 offset:192
    ds_read_b64_tr_b16 v[250:251], v72 offset:1504
    ds_read_b64_tr_b16 v[252:253], v72 offset:21184
    ds_read_b64_tr_b16 v[254:255], v72 offset:22496
    ds_read_b64_tr_b16 v[64:65], v72 offset:224
    ds_read_b64_tr_b16 v[66:67], v72 offset:1536
    ds_read_b64_tr_b16 v[68:69], v72 offset:21216
    ds_read_b64_tr_b16 v[70:71], v72 offset:22528
    s_waitcnt lgkmcnt(0)
    ds_write_b128 v73, v[64:67] offset:4096
    ds_write_b128 v73, v[68:71] offset:5120
    s_waitcnt lgkmcnt(0)
    ds_read_b64_tr_b16 v[64:65], v72 offset:256
    ds_read_b64_tr_b16 v[66:67], v72 offset:1568
    ds_read_b64_tr_b16 v[68:69], v72 offset:21248
    ds_read_b64_tr_b16 v[70:71], v72 offset:22560
    s_waitcnt lgkmcnt(0)
    ds_write_b128 v73, v[64:67] offset:10240
    ds_write_b128 v73, v[68:71] offset:11264
    s_waitcnt lgkmcnt(0)
    ds_read_b64_tr_b16 v[64:65], v72 offset:288
    ds_read_b64_tr_b16 v[66:67], v72 offset:1600
    ds_read_b64_tr_b16 v[68:69], v72 offset:21280
    ds_read_b64_tr_b16 v[70:71], v72 offset:22592
    s_waitcnt lgkmcnt(0)
    ds_write_b128 v73, v[64:67] offset:16384
    ds_write_b128 v73, v[68:71] offset:17408
    s_waitcnt lgkmcnt(0)
    s_waitcnt lgkmcnt(0)
chain1_kernel_wo6:
    s_barrier
    v_mov_b32 v6, v73
    v_mov_b32 v4, 0x4444
    v_mov_b32 v5, 0xeeee
    v_cmp_gt_u32 vcc, 8, v2
    s_nop 1
    v_cndmask_b32 v4, v5, v4, vcc
    v_lshlrev_b32 v5, 4, v1
    s_lshl_b32 s24, s3, 10
    v_add_u32 v7, s24, v5
    s_lshl_b32 s24, s3, 9
    s_add_u32 s24, s24, 8192
    v_lshlrev_b32 v8, 3, v1
    v_add_u32 v8, s24, v8
    v_and_b32 v64, 7, v2
    v_lshlrev_b32 v9, 5, v64
    v_lshrrev_b32 v64, 3, v2
    v_lshl_add_u32 v9, v64, 4, v9
    v_and_b32 v64, 1, v3
    v_lshl_add_u32 v9, v64, 3, v9
    s_mul_i32 s24, s3, 768
    s_add_u32 s24, s24, 10240
    v_add_u32 v9, s24, v9
    v_lshrrev_b32 v65, 1, v3
    v_lshl_add_u32 v10, v65, 8, v9
    v_lshrrev_b32 v64, 2, v2
    v_lshlrev_b32 v11, 5, v64
    v_and_b32 v64, 3, v2
    v_lshl_add_u32 v11, v64, 3, v11
    v_lshl_add_u32 v11, v3, 8, v11
    v_add_u32 v11, 10240, v11
    s_mul_i32 s24, s3, 10
    s_lshl_b32 s24, s24, 13
    s_lshl_b32 s25, s44, 8
    s_add_u32 s24, s24, s25
    v_lshlrev_b32 v14, 13, v3
    v_lshl_add_u32 v14, v2, 4, v14
    v_add_u32 v14, s24, v14
    v_lshrrev_b32 v64, 1, v3
    v_lshlrev_b32 v15, 13, v64
    v_lshl_add_u32 v15, v2, 4, v15
    v_add_u32 v15, s24, v15
    v_add_u32 v15, 65536, v15
    v_and_b32 v64, 1, v3
    v_cmp_eq_u32 vcc, 0, v64
    v_mov_b32 v64, 2146435072
    s_nop 0
    v_cndmask_b32 v15, v64, v15, vcc
    v_add_u32 v64, 0, v0
    v_and_b32 v65, 7, v64
    v_mul_u32_u24 v65, 1280, v65
    v_lshrrev_b32 v66, 3, v64
    v_lshl_add_u32 v65, v66, 4, v65
    v_cmp_gt_u32 vcc, 640, v64
    v_mov_b32 v67, 2146435072
    s_nop 0
    v_cndmask_b32 v65, v67, v65, vcc
    buffer_load_dwordx4 v[68:71], v65, s[20:23], 0 offen
    v_lshlrev_b32 v64, 4, v64
    s_waitcnt vmcnt(0)
    s_and_saveexec_b64 s[30:31], vcc
    ds_write_b128 v64, v[68:71]
    s_mov_b64 exec, s[30:31]
    v_add_u32 v64, 256, v0
    v_and_b32 v65, 7, v64
    v_mul_u32_u24 v65, 1280, v65
    v_lshrrev_b32 v66, 3, v64
    v_lshl_add_u32 v65, v66, 4, v65
    v_cmp_gt_u32 vcc, 640, v64
    v_mov_b32 v67, 2146435072
    s_nop 0
    v_cndmask_b32 v65, v67, v65, vcc
    buffer_load_dwordx4 v[68:71], v65, s[20:23], 0 offen
    v_lshlrev_b32 v64, 4, v64
    s_waitcnt vmcnt(0)
    s_and_saveexec_b64 s[30:31], vcc
    ds_write_b128 v64, v[68:71]
    s_mov_b64 exec, s[30:31]
    v_add_u32 v64, 512, v0
    v_and_b32 v65, 7, v64
    v_mul_u32_u24 v65, 1280, v65
    v_lshrrev_b32 v66, 3, v64
    v_lshl_add_u32 v65, v66, 4, v65
    v_cmp_gt_u32 vcc, 640, v64
    v_mov_b32 v67, 2146435072
    s_nop 0
    v_cndmask_b32 v65, v67, v65, vcc
    buffer_load_dwordx4 v[68:71], v65, s[20:23], 0 offen
    v_lshlrev_b32 v64, 4, v64
    s_waitcnt vmcnt(0)
    s_and_saveexec_b64 s[30:31], vcc
    ds_write_b128 v64, v[68:71]
    s_mov_b64 exec, s[30:31]
    s_mov_b32 s40, 0
    s_mov_b32 s43, 117440512
    s_mov_b32 s47, 138412032
    s_waitcnt lgkmcnt(0)
    s_branch chain1_kernel_v_go2
chain1_kernel_v_step:
    s_add_u32 s48, s47, 4096
    s_mov_b32 s61, 0
chain1_kernel_v_pm:
    buffer_load_dwordx4 v[16:19], v7, s[8:11], s47 offen sc1
    buffer_load_dwordx4 v[20:23], v7, s[8:11], s48 offen sc1
    buffer_load_dwordx2 v[24:25], v8, s[8:11], s47 offen sc1
    s_waitcnt vmcnt(0)
    v_max3_u32 v26, v16, v17, v18
    v_max3_u32 v26, v26, v19, v20
    v_max3_u32 v26, v26, v21, v22
    v_max3_u32 v26, v26, v23, v24
    v_max_u32 v26, v26, v25
    v_cmp_eq_u32 vcc, -1, v26
    s_add_u32 s61, s61, 1
    s_cbranch_vccz chain1_kernel_v_pm_out
    s_cmp_ge_u32 s61, s60
    s_cbranch_scc1 chain1_kernel_v_pm_to
    s_sleep 1
    s_branch chain1_kernel_v_pm
chain1_kernel_v_pm_to:
    s_mov_b32 s60, 1
chain1_kernel_v_pm_out:
    ds_write_b128 v7, v[16:19]
    ds_write_b128 v7, v[20:23] offset:4096
    ds_write_b64 v8, v[24:25]
    s_waitcnt lgkmcnt(0)
chain1_kernel_v_go2:
    s_barrier
    ds_read_b128 v[16:19], v5 offset:0
    ds_read_b128 v[20:23], v5 offset:1024
    ds_read_b128 v[24:27], v5 offset:2048
    ds_read_b128 v[28:31], v5 offset:3072
    ds_read_b128 v[32:35], v5 offset:4096
    ds_read_b128 v[36:39], v5 offset:5120
    ds_read_b128 v[40:43], v5 offset:6144
    ds_read_b128 v[44:47], v5 offset:7168
    ds_read_b128 v[48:51], v5 offset:8192
    ds_read_b128 v[52:55], v5 offset:9216
    v_mov_b32 v56, 0
    v_mov_b32 v57, 0
    v_mov_b32 v58, 0
    v_mov_b32 v59, 0
    v_mov_b32 v60, 0
    v_mov_b32 v61, 0
    v_mov_b32 v62, 0
    v_mov_b32 v63, 0
    v_mov_b32 v64, 0
    v_mov_b32 v65, 0
    v_mov_b32 v66, 0
    v_mov_b32 v67, 0
    s_waitcnt lgkmcnt(9)
    v_smfmac_f32_16x16x64_bf16 v[56:59], v[16:19], a[0:7], v4
    v_smfmac_f32_16x16x64_bf16 v[60:63], v[16:19], a[80:87], v4
    v_smfmac_f32_16x16x64_bf16 v[64:67], v[16:19], a[160:167], v4
    s_waitcnt lgkmcnt(8)
    v_smfmac_f32_16x16x64_bf16 v[56:59], v[20:23], a[8:15], v4
    v_smfmac_f32_16x16x64_bf16 v[60:63], v[20:23], a[88:95], v4
    v_smfmac_f32_16x16x64_bf16 v[64:67], v[20:23], a[168:175], v4
    s_waitcnt lgkmcnt(7)
    v_smfmac_f32_16x16x64_bf16 v[56:59], v[24:27], a[16:23], v4
    v_smfmac_f32_16x16x64_bf16 v[60:63], v[24:27], a[96:103], v4
    v_smfmac_f32_16x16x64_bf16 v[64:67], v[24:27], a[176:183], v4
    s_waitcnt lgkmcnt(6)
    v_smfmac_f32_16x16x64_bf16 v[56:59], v[28:31], a[24:31], v4
    v_smfmac_f32_16x16x64_bf16 v[60:63], v[28:31], a[104:111], v4
    v_smfmac_f32_16x16x64_bf16 v[64:67], v[28:31], a[184:191], v4
    s_waitcnt lgkmcnt(5)
    v_smfmac_f32_16x16x64_bf16 v[56:59], v[32:35], a[32:39], v4
    v_smfmac_f32_16x16x64_bf16 v[60:63], v[32:35], a[112:119], v4
    v_smfmac_f32_16x16x64_bf16 v[64:67], v[32:35], a[192:199], v4
    s_waitcnt lgkmcnt(4)
    v_smfmac_f32_16x16x64_bf16 v[56:59], v[36:39], a[40:47], v4
    v_smfmac_f32_16x16x64_bf16 v[60:63], v[36:39], a[120:127], v4
    v_smfmac_f32_16x16x64_bf16 v[64:67], v[36:39], a[200:207], v4
    s_waitcnt lgkmcnt(3)
    v_smfmac_f32_16x16x64_bf16 v[56:59], v[40:43], a[48:55], v4
    v_smfmac_f32_16x16x64_bf16 v[60:63], v[40:43], a[128:135], v4
    v_smfmac_f32_16x16x64_bf16 v[64:67], v[40:43], a[208:215], v4
    s_waitcnt lgkmcnt(2)
    v_smfmac_f32_16x16x64_bf16 v[56:59], v[44:47], a[56:63], v4
    v_smfmac_f32_16x16x64_bf16 v[60:63], v[44:47], a[136:143], v4
    v_smfmac_f32_16x16x64_bf16 v[64:67], v[44:47], a[216:223], v4
    s_waitcnt lgkmcnt(1)
    v_smfmac_f32_16x16x64_bf16 v[56:59], v[48:51], a[64:71], v4
    v_smfmac_f32_16x16x64_bf16 v[60:63], v[48:51], a[144:151], v4
    v_smfmac_f32_16x16x64_bf16 v[64:67], v[48:51], a[224:231], v4
    s_waitcnt lgkmcnt(0)
    v_smfmac_f32_16x16x64_bf16 v[56:59], v[52:55], a[72:79], v4
    v_smfmac_f32_16x16x64_bf16 v[60:63], v[52:55], a[152:159], v4
    v_smfmac_f32_16x16x64_bf16 v[64:67], v[52:55], a[232:239], v4
    ds_read_b128 v[80:83], v6 offset:0
    ds_read_b128 v[84:87], v6 offset:1024
    ds_read_b128 v[88:91], v6 offset:2048
    ds_read_b128 v[92:95], v6 offset:3072
    ds_read_b128 v[96:99], v6 offset:4096
    ds_read_b128 v[100:103], v6 offset:5120
    v_mov_b32 v16, 0
    v_mov_b32 v17, 0
    v_mov_b32 v18, 0
    v_mov_b32 v19, 0
    v_mov_b32 v20, 0
    v_mov_b32 v21, 0
    v_mov_b32 v22, 0
    v_mov_b32 v23, 0
    v_mov_b32 v24, 0
    v_mov_b32 v25, 0
    v_mov_b32 v26, 0
    v_mov_b32 v27, 0
    v_mov_b32 v28, 0
    v_mov_b32 v29, 0
    v_mov_b32 v30, 0
    v_mov_b32 v31, 0
    v_mov_b32 v32, 0
    v_mov_b32 v33, 0
    v_mov_b32 v34, 0
    v_mov_b32 v35, 0
    v_mov_b32 v36, 0
    v_mov_b32 v37, 0
    v_mov_b32 v38, 0
    v_mov_b32 v39, 0
    v_mov_b32 v40, 0
    v_mov_b32 v41, 0
    v_mov_b32 v42, 0
    v_mov_b32 v43, 0
    v_mov_b32 v44, 0
    v_mov_b32 v45, 0
    v_mov_b32 v46, 0
    v_mov_b32 v47, 0
    v_mov_b32 v48, 0
    v_mov_b32 v49, 0
    v_mov_b32 v50, 0
    v_mov_b32 v51, 0
    v_mov_b32 v52, 0
    v_mov_b32 v53, 0
    v_mov_b32 v54, 0
    v_mov_b32 v55, 0
    v_permlane32_swap_b32 v56, v60
    v_permlane32_swap_b32 v57, v61
    v_permlane32_swap_b32 v58, v62
    v_permlane32_swap_b32 v59, v63
    v_add_f32 v56, v56, v60
    v_add_f32 v57, v57, v61
    v_add_f32 v58, v58, v62
    v_add_f32 v59, v59, v63
    v_cvt_pk_bf16_f32 v68, v56, v57
    v_cvt_pk_bf16_f32 v69, v58, v59
    v_mov_b32 v60, v64
    v_mov_b32 v61, v65
    v_mov_b32 v62, v66
    v_mov_b32 v63, v67
    v_permlane32_swap_b32 v64, v60
    v_permlane32_swap_b32 v65, v61
    v_permlane32_swap_b32 v66, v62
    v_permlane32_swap_b32 v67, v63
    v_add_f32 v64, v64, v60
    v_add_f32 v65, v65, v61
    v_add_f32 v66, v66, v62
    v_add_f32 v67, v67, v63
    v_cvt_pk_bf16_f32 v70, v64, v65
    v_cvt_pk_bf16_f32 v71, v66, v67
    ds_write_b64 v10, v[68:69]
    ds_write_b64 v9, v[70:71] offset:512
    s_waitcnt lgkmcnt(0)
    s_barrier
    ds_read_b64_tr_b16 v[68:69], v11 offset:0
    ds_read_b64_tr_b16 v[70:71], v11 offset:128
    ds_read_b64_tr_b16 v[72:73], v11 offset:1024
    ds_read_b64_tr_b16 v[74:75], v11 offset:1152
    ds_read_b64_tr_b16 v[76:77], v11 offset:2048
    ds_read_b64_tr_b16 v[78:79], v11 offset:2176
    s_waitcnt lgkmcnt(4)
    v_smfmac_f32_16x16x64_bf16 v[16:19], v[68:71], a[240:247], v4
    v_smfmac_f32_16x16x64_bf16 v[20:23], v[68:71], v[112:119], v4
    v_smfmac_f32_16x16x64_bf16 v[24:27], v[68:71], v[136:143], v4
    v_smfmac_f32_16x16x64_bf16 v[28:31], v[68:71], v[160:167], v4
    s_waitcnt lgkmcnt(2)
    v_smfmac_f32_16x16x64_bf16 v[16:19], v[72:75], a[248:255], v4
    v_smfmac_f32_16x16x64_bf16 v[20:23], v[72:75], v[120:127], v4
    v_smfmac_f32_16x16x64_bf16 v[24:27], v[72:75], v[144:151], v4
    v_smfmac_f32_16x16x64_bf16 v[28:31], v[72:75], v[168:175], v4
    s_waitcnt lgkmcnt(0)
    v_smfmac_f32_16x16x64_bf16 v[16:19], v[76:79], v[104:111], v4
    v_smfmac_f32_16x16x64_bf16 v[20:23], v[76:79], v[128:135], v4
    v_smfmac_f32_16x16x64_bf16 v[24:27], v[76:79], v[152:159], v4
    v_smfmac_f32_16x16x64_bf16 v[28:31], v[76:79], v[176:183], v4
    v_smfmac_f32_16x16x64_bf16 v[32:35], v[68:71], v[184:191], v4
    v_smfmac_f32_16x16x64_bf16 v[36:39], v[68:71], v[208:215], v4
    v_smfmac_f32_16x16x64_bf16 v[40:43], v[68:71], v[232:239], v4
    v_smfmac_f32_16x16x64_bf16 v[44:47], v[68:71], v[80:87], v4
    ds_read_b128 v[80:83], v6 offset:6144
    ds_read_b128 v[84:87], v6 offset:7168
    v_smfmac_f32_16x16x64_bf16 v[32:35], v[72:75], v[192:199], v4
    v_smfmac_f32_16x16x64_bf16 v[36:39], v[72:75], v[216:223], v4
    v_smfmac_f32_16x16x64_bf16 v[40:43], v[72:75], v[240:247], v4
    v_smfmac_f32_16x16x64_bf16 v[44:47], v[72:75], v[88:95], v4
    ds_read_b128 v[88:91], v6 offset:8192
    ds_read_b128 v[92:95], v6 offset:9216
    v_smfmac_f32_16x16x64_bf16 v[32:35], v[76:79], v[200:207], v4
    v_smfmac_f32_16x16x64_bf16 v[36:39], v[76:79], v[224:231], v4
    v_smfmac_f32_16x16x64_bf16 v[40:43], v[76:79], v[248:255], v4
    v_smfmac_f32_16x16x64_bf16 v[44:47], v[76:79], v[96:103], v4
    ds_read_b128 v[96:99], v6 offset:10240
    ds_read_b128 v[100:103], v6 offset:11264
    v_permlane32_swap_b32 v16, v24
    v_permlane32_swap_b32 v17, v25
    v_permlane32_swap_b32 v18, v26
    v_permlane32_swap_b32 v19, v27
    v_add_f32 v16, v16, v24
    v_add_f32 v17, v17, v25
    v_add_f32 v18, v18, v26
    v_add_f32 v19, v19, v27
    v_permlane32_swap_b32 v20, v28
    v_permlane32_swap_b32 v21, v29
    v_permlane32_swap_b32 v22, v30
    v_permlane32_swap_b32 v23, v31
    v_add_f32 v20, v20, v28
    v_add_f32 v21, v21, v29
    v_add_f32 v22, v22, v30
    v_add_f32 v23, v23, v31
    v_cvt_pk_bf16_f32 v56, v16, v17
    v_cvt_pk_bf16_f32 v57, v18, v19
    v_cvt_pk_bf16_f32 v58, v20, v21
    v_cvt_pk_bf16_f32 v59, v22, v23
    s_nop 0
    v_permlane16_swap_b32 v56, v58
    v_permlane16_swap_b32 v57, v59
    v_min_u32 v56, -2, v56
    v_min_u32 v57, -2, v57
    v_min_u32 v58, -2, v58
    v_min_u32 v59, -2, v59
    buffer_store_dwordx4 v[56:59], v14, s[8:11], s43 offen sc1
    s_waitcnt lgkmcnt(4)
    v_smfmac_f32_16x16x64_bf16 v[48:51], v[68:71], v[80:87], v4
    ds_read_b128 v[80:83], v6 offset:12288
    ds_read_b128 v[84:87], v6 offset:13312
    s_waitcnt lgkmcnt(4)
    v_smfmac_f32_16x16x64_bf16 v[48:51], v[72:75], v[88:95], v4
    ds_read_b128 v[88:91], v6 offset:14336
    ds_read_b128 v[92:95], v6 offset:15360
    s_waitcnt lgkmcnt(4)
    v_smfmac_f32_16x16x64_bf16 v[48:51], v[76:79], v[96:103], v4
    ds_read_b128 v[96:99], v6 offset:16384
    ds_read_b128 v[100:103], v6 offset:17408
    v_permlane32_swap_b32 v32, v40
    v_permlane32_swap_b32 v33, v41
    v_permlane32_swap_b32 v34, v42
    v_permlane32_swap_b32 v35, v43
    v_add_f32 v32, v32, v40
    v_add_f32 v33, v33, v41
    v_add_f32 v34, v34, v42
    v_add_f32 v35, v35, v43
    v_permlane32_swap_b32 v36, v44
    v_permlane32_swap_b32 v37, v45
    v_permlane32_swap_b32 v38, v46
    v_permlane32_swap_b32 v39, v47
    v_add_f32 v36, v36, v44
    v_add_f32 v37, v37, v45
    v_add_f32 v38, v38, v46
    v_add_f32 v39, v39, v47
    v_cvt_pk_bf16_f32 v60, v32, v33
    v_cvt_pk_bf16_f32 v61, v34, v35
    v_cvt_pk_bf16_f32 v62, v36, v37
    v_cvt_pk_bf16_f32 v63, v38, v39
    s_nop 0
    v_permlane16_swap_b32 v60, v62
    v_permlane16_swap_b32 v61, v63
    v_min_u32 v60, -2, v60
    v_min_u32 v61, -2, v61
    v_min_u32 v62, -2, v62
    v_min_u32 v63, -2, v63
    s_add_u32 s49, s43, 32768
    buffer_store_dwordx4 v[60:63], v14, s[8:11], s49 offen sc1
    s_waitcnt lgkmcnt(4)
    v_smfmac_f32_16x16x64_bf16 v[52:55], v[68:71], v[80:87], v4
    s_waitcnt lgkmcnt(2)
    v_smfmac_f32_16x16x64_bf16 v[52:55], v[72:75], v[88:95], v4
    s_waitcnt lgkmcnt(0)
    v_smfmac_f32_16x16x64_bf16 v[52:55], v[76:79], v[96:103], v4
    s_nop 11
    v_permlane32_swap_b32 v48, v52
    v_permlane32_swap_b32 v49, v53
    v_permlane32_swap_b32 v50, v54
    v_permlane32_swap_b32 v51, v55
    v_add_f32 v48, v48, v52
    v_add_f32 v49, v49, v53
    v_add_f32 v50, v50, v54
    v_add_f32 v51, v51, v55
    v_cvt_pk_bf16_f32 v64, v48, v49
    v_cvt_pk_bf16_f32 v65, v50, v51
    v_mov_b32 v66, v64
    v_mov_b32 v67, v65
    s_nop 0
    v_permlane16_swap_b32 v64, v66
    v_permlane16_swap_b32 v65, v67
    v_min_u32 v64, -2, v64
    v_min_u32 v65, -2, v65
    v_min_u32 v66, -2, v66
    v_min_u32 v67, -2, v67
    buffer_store_dwordx4 v[64:67], v15, s[8:11], s43 offen sc1
    s_add_u32 s40, s40, 1
    s_add_u32 s43, s43, 327680
    s_add_u32 s47, s47, 40960
    s_cmp_lt_u32 s40, 64
    s_cbranch_scc1 chain1_kernel_v_step
    s_branch chain1_kernel_end
chain1_kernel_roleR:
    s_sub_u32 s44, s2, 64
    v_lshlrev_b32 v5, 4, v1
    s_lshl_b32 s24, s44, 15
    s_lshl_b32 s25, s3, 13
    s_add_u32 s24, s24, s25
    v_add_u32 v6, s24, v5
    v_add_u32 v7, 4096, v6
    s_lshl_b32 s24, s3, 12
    v_add_u32 v8, s24, v5
    s_lshl_b32 s24, s3, 10
    s_add_u32 s24, s24, 16384
    v_add_u32 v9, s24, v5
    s_lshl_b32 s24, s44, 13
    s_lshl_b32 s25, s3, 11
    s_add_u32 s24, s24, s25
    v_add_u32 v10, s24, v5
    v_and_b32 v204, 7, v2
    v_mul_u32_u24 v11, 80, v204
    v_lshl_add_u32 v11, v3, 4, v11
    s_mul_i32 s24, s3, 640
    v_add_u32 v11, s24, v11
    v_add_u32 v204, 8192, v5
    v_cmp_gt_u32 vcc, 8, v2
    s_nop 1
    v_cndmask_b32 v11, v204, v11, vcc
    v_and_b32 v204, 7, v2
    v_mul_u32_u24 v12, 80, v204
    v_lshrrev_b32 v204, 3, v2
    v_lshl_add_u32 v12, v204, 5, v12
    v_mul_u32_u24 v13, 10240, v3
    v_lshl_add_u32 v13, v2, 4, v13
    s_lshl_b32 s24, s44, 8
    v_add_u32 v13, s24, v13
    v_mov_b32 v204, 2146435072
    v_cmp_gt_u32 vcc, 1, v3
    s_nop 1
    v_cndmask_b32 v13, v204, v13, vcc
    v_cmp_le_u32 s[50:51], 8, v2
    s_lshl_b32 s24, s3, 14
    v_add_u32 v205, s24, v5
    v_add_u32 v212, 0, v205
    v_add_u32 v213, 4096, v205
    v_add_u32 v214, 8192, v205
    v_add_u32 v215, 12288, v205
    s_lshl_b32 s24, s3, 12
    s_add_u32 s24, s24, 65536
    v_add_u32 v216, s24, v5
    s_lshl_b32 s24, s3, 11
    s_add_u32 s24, s24, 16384
    v_add_u32 v217, s24, v5
    s_lshl_b32 s24, s3, 10
    s_add_u32 s24, s24, 16384
    v_add_u32 v218, s24, v5
    s_lshl_b32 s24, s3, 4
    v_add_u32 v219, s24, v2
    v_mul_u32_u24 v219, 1280, v219
    v_lshl_add_u32 v219, v3, 3, v219
    s_lshl_b32 s24, s44, 5
    v_add_u32 v219, s24, v219
    s_add_u32 s12, s4, 4194304
    s_addc_u32 s13, s5, 0
    s_mov_b32 s14, 2621440
    s_mov_b32 s15, 0x00020000
    s_add_u32 s16, s4, 4194304
    s_addc_u32 s17, s5, 0
    s_mov_b32 s18, 2621440
    s_mov_b32 s19, 0x00020000
    s_mov_b32 s40, 0
    s_mov_b32 s41, 184549376
    s_mov_b32 s43, 141074432
    s_mov_b32 s42, 117440512
    s_mov_b32 s45, 146317312
    s_mov_b32 s46, 0
    s_mov_b32 s47, 138452992
    v_and_b32 v252, 7, v1
    v_lshlrev_b32 v252, 7, v252
    s_lshl_b32 s24, s3, 10
    s_add_u32 s24, s24, 151572480
    v_add_u32 v252, s24, v252
    s_mov_b32 s62, -1
    s_mov_b32 s63, 1
    s_cmp_ge_i32 s62, s63
    s_cbranch_scc1 chain1_kernel_r_en0_ok
    s_mov_b32 s61, 0
chain1_kernel_r_en0:
    buffer_load_dword v253, v252, s[8:11], 0 offen sc1
    s_waitcnt vmcnt(0)
    v_readlane_b32 s62, v253, 0
    v_readlane_b32 s24, v253, 1
    s_min_i32 s62, s62, s24
    v_readlane_b32 s24, v253, 2
    s_min_i32 s62, s62, s24
    v_readlane_b32 s24, v253, 3
    s_min_i32 s62, s62, s24
    v_readlane_b32 s24, v253, 4
    s_min_i32 s62, s62, s24
    v_readlane_b32 s24, v253, 5
    s_min_i32 s62, s62, s24
    v_readlane_b32 s24, v253, 6
    s_min_i32 s62, s62, s24
    v_readlane_b32 s24, v253, 7
    s_min_i32 s62, s62, s24
    s_cmp_ge_i32 s62, s63
    s_cbranch_scc1 chain1_kernel_r_en0_ok
    s_add_u32 s61, s61, 1
    s_cmp_ge_u32 s61, s60
    s_cbranch_scc1 chain1_kernel_r_en0_to
    s_sleep 2
    s_branch chain1_kernel_r_en0
chain1_kernel_r_en0_to:
    s_mov_b32 s60, 1
chain1_kernel_r_en0_ok:
    buffer_load_dwordx4 v[48:51], v6, s[8:11], s41 offen offset:0 sc1
    buffer_load_dwordx4 v[52:55], v6, s[8:11], s41 offen offset:1024 sc1
    buffer_load_dwordx4 v[56:59], v6, s[8:11], s41 offen offset:2048 sc1
    buffer_load_dwordx4 v[60:63], v6, s[8:11], s41 offen offset:3072 sc1
    buffer_load_dwordx4 v[64:67], v7, s[8:11], s41 offen offset:0 sc1
    buffer_load_dwordx4 v[68:71], v7, s[8:11], s41 offen offset:1024 sc1
    buffer_load_dwordx4 v[72:75], v7, s[8:11], s41 offen offset:2048 sc1
    buffer_load_dwordx4 v[76:79], v7, s[8:11], s41 offen offset:3072 sc1
    s_add_u32 s41, s41, 1310720
    s_waitcnt vmcnt(0)
chain1_kernel_r_step:
    v_mov_b32 v16, v48
    v_mov_b32 v17, v49
    v_mov_b32 v18, v50
    v_mov_b32 v19, v51
    v_mov_b32 v20, v52
    v_mov_b32 v21, v53
    v_mov_b32 v22, v54
    v_mov_b32 v23, v55
    v_mov_b32 v24, v56
    v_mov_b32 v25, v57
    v_mov_b32 v26, v58
    v_mov_b32 v27, v59
    v_mov_b32 v28, v60
    v_mov_b32 v29, v61
    v_mov_b32 v30, v62
    v_mov_b32 v31, v63
    v_mov_b32 v32, v64
    v_mov_b32 v33, v65
    v_mov_b32 v34, v66
    v_mov_b32 v35, v67
    v_mov_b32 v36, v68
    v_mov_b32 v37, v69
    v_mov_b32 v38, v70
    v_mov_b32 v39, v71
    v_mov_b32 v40, v72
    v_mov_b32 v41, v73
    v_mov_b32 v42, v74
    v_mov_b32 v43, v75
    v_mov_b32 v44, v76
    v_mov_b32 v45, v77
    v_mov_b32 v46, v78
    v_mov_b32 v47, v79
    s_mov_b32 s61, 0
chain1_kernel_r_p:
    buffer_load_dwordx4 v[80:83], v8, s[8:11], s43 offen offset:0 sc1
    buffer_load_dwordx4 v[84:87], v8, s[8:11], s43 offen offset:1024 sc1
    buffer_load_dwordx4 v[88:91], v8, s[8:11], s43 offen offset:2048 sc1
    buffer_load_dwordx4 v[92:95], v8, s[8:11], s43 offen offset:3072 sc1
    buffer_load_dwordx4 v[96:99], v9, s[8:11], s43 offen sc1
    buffer_load_dwordx4 v[100:103], v10, s[8:11], s42 offen offset:0 sc1
    buffer_load_dwordx4 v[104:107], v10, s[8:11], s42 offen offset:1024 sc1
    s_waitcnt vmcnt(0)
    v_max3_u32 v204, v80, v81, v82
    v_max3_u32 v204, v204, v83, v84
    v_max3_u32 v204, v204, v85, v86
    v_max3_u32 v204, v204, v87, v88
    v_max3_u32 v204, v204, v89, v90
    v_max3_u32 v204, v204, v91, v92
    v_max3_u32 v204, v204, v93, v94
    v_max3_u32 v204, v204, v95, v96
    v_max3_u32 v204, v204, v97, v98
    v_max3_u32 v204, v204, v99, v100
    v_max3_u32 v204, v204, v101, v102
    v_max3_u32 v204, v204, v103, v104
    v_max3_u32 v204, v204, v105, v106
    v_max_u32 v204, v204, v107
    v_cmp_eq_u32 vcc, -1, v204
    s_add_u32 s61, s61, 1
    s_cbranch_vccz chain1_kernel_r_p_out
    s_cmp_ge_u32 s61, s60
    s_cbranch_scc1 chain1_kernel_r_p_to
    s_sleep 1
    s_branch chain1_kernel_r_p
chain1_kernel_r_p_to:
    s_mov_b32 s60, 1
chain1_kernel_r_p_out:
    v_mfma_f32_16x16x32_bf16 v[108:111], v[100:103], v[96:99], 0
    v_mfma_f32_16x16x32_bf16 v[112:115], v[104:107], v[96:99], 0
    v_mfma_f32_16x16x32_bf16 v[108:111], v[16:19], v[80:83], v[108:111]
    v_mfma_f32_16x16x32_bf16 v[112:115], v[20:23], v[80:83], v[112:115]
    v_mfma_f32_16x16x32_bf16 v[108:111], v[24:27], v[84:87], v[108:111]
    v_mfma_f32_16x16x32_bf16 v[112:115], v[28:31], v[84:87], v[112:115]
    v_mfma_f32_16x16x32_bf16 v[108:111], v[32:35], v[88:91], v[108:111]
    v_mfma_f32_16x16x32_bf16 v[112:115], v[36:39], v[88:91], v[112:115]
    v_mfma_f32_16x16x32_bf16 v[108:111], v[40:43], v[92:95], v[108:111]
    v_mfma_f32_16x16x32_bf16 v[112:115], v[44:47], v[92:95], v[112:115]
    s_and_b32 s24, s40, 1
    s_mul_i32 s24, s24, 2560
    v_add_u32 v14, s24, v11
    v_add_u32 v15, s24, v12
    s_nop 3
    v_cndmask_b32 v108, v108, v112, s[50:51]
    v_cndmask_b32 v109, v109, v113, s[50:51]
    v_cndmask_b32 v110, v110, v114, s[50:51]
    v_cndmask_b32 v111, v111, v115, s[50:51]
    v_add_f32 v108, v108, v108 row_ror:8 row_mask:0xf bank_mask:0xf
    v_add_f32 v109, v109, v109 row_ror:8 row_mask:0xf bank_mask:0xf
    v_add_f32 v110, v110, v110 row_ror:8 row_mask:0xf bank_mask:0xf
    v_add_f32 v111, v111, v111 row_ror:8 row_mask:0xf bank_mask:0xf
    ds_write_b128 v14, v[108:111]
    s_waitcnt lgkmcnt(0)
    s_barrier
    s_cmp_eq_u32 s3, 0
    s_cbranch_scc0 chain1_kernel_np7
    ds_read_b128 v[220:223], v15 offset:0
    ds_read_b128 v[224:227], v15 offset:16
    ds_read_b128 v[228:231], v15 offset:640
    ds_read_b128 v[232:235], v15 offset:656
    ds_read_b128 v[236:239], v15 offset:1280
    ds_read_b128 v[240:243], v15 offset:1296
    ds_read_b128 v[244:247], v15 offset:1920
    ds_read_b128 v[248:251], v15 offset:1936
    s_waitcnt lgkmcnt(4)
    v_pk_add_f32 v[220:221], v[220:221], v[228:229]
    v_pk_add_f32 v[222:223], v[222:223], v[230:231]
    v_pk_add_f32 v[224:225], v[224:225], v[232:233]
    v_pk_add_f32 v[226:227], v[226:227], v[234:235]
    s_waitcnt lgkmcnt(0)
    v_pk_add_f32 v[236:237], v[236:237], v[244:245]
    v_pk_add_f32 v[238:239], v[238:239], v[246:247]
    v_pk_add_f32 v[240:241], v[240:241], v[248:249]
    v_pk_add_f32 v[242:243], v[242:243], v[250:251]
    v_pk_add_f32 v[220:221], v[220:221], v[236:237]
    v_pk_add_f32 v[222:223], v[222:223], v[238:239]
    v_pk_add_f32 v[224:225], v[224:225], v[240:241]
    v_pk_add_f32 v[226:227], v[226:227], v[242:243]
    v_cvt_pk_bf16_f32 v228, v220, v221
    v_cvt_pk_bf16_f32 v229, v222, v223
    v_cvt_pk_bf16_f32 v230, v224, v225
    v_cvt_pk_bf16_f32 v231, v226, v227
    v_min_u32 v228, -2, v228
    v_min_u32 v229, -2, v229
    v_min_u32 v230, -2, v230
    v_min_u32 v231, -2, v231
    buffer_store_dwordx4 v[228:231], v13, s[8:11], s47 offen sc1
chain1_kernel_np7:
    s_add_u32 s63, s40, 2
    s_min_u32 s63, s63, 64
    s_cmp_ge_i32 s62, s63
    s_cbranch_scc1 chain1_kernel_r_en_ok
    s_mov_b32 s61, 0
chain1_kernel_r_en:
    buffer_load_dword v253, v252, s[8:11], 0 offen sc1
    s_waitcnt vmcnt(0)
    v_readlane_b32 s62, v253, 0
    v_readlane_b32 s24, v253, 1
    s_min_i32 s62, s62, s24
    v_readlane_b32 s24, v253, 2
    s_min_i32 s62, s62, s24
    v_readlane_b32 s24, v253, 3
    s_min_i32 s62, s62, s24
    v_readlane_b32 s24, v253, 4
    s_min_i32 s62, s62, s24
    v_readlane_b32 s24, v253, 5
    s_min_i32 s62, s62, s24
    v_readlane_b32 s24, v253, 6
    s_min_i32 s62, s62, s24
    v_readlane_b32 s24, v253, 7
    s_min_i32 s62, s62, s24
    s_cmp_ge_i32 s62, s63
    s_cbranch_scc1 chain1_kernel_r_en_ok
    s_add_u32 s61, s61, 1
    s_cmp_ge_u32 s61, s60
    s_cbranch_scc1 chain1_kernel_r_en_to
    s_sleep 2
    s_branch chain1_kernel_r_en
chain1_kernel_r_en_to:
    s_mov_b32 s60, 1
chain1_kernel_r_en_ok:
    buffer_load_dwordx4 v[48:51], v6, s[8:11], s41 offen offset:0 sc1
    buffer_load_dwordx4 v[52:55], v6, s[8:11], s41 offen offset:1024 sc1
    buffer_load_dwordx4 v[56:59], v6, s[8:11], s41 offen offset:2048 sc1
    buffer_load_dwordx4 v[60:63], v6, s[8:11], s41 offen offset:3072 sc1
    buffer_load_dwordx4 v[64:67], v7, s[8:11], s41 offen offset:0 sc1
    buffer_load_dwordx4 v[68:71], v7, s[8:11], s41 offen offset:1024 sc1
    buffer_load_dwordx4 v[72:75], v7, s[8:11], s41 offen offset:2048 sc1
    buffer_load_dwordx4 v[76:79], v7, s[8:11], s41 offen offset:3072 sc1
    s_add_u32 s41, s41, 1310720
    buffer_load_dwordx2 v[206:207], v219, s[16:19], s46 offen
    s_mov_b32 s61, 0
chain1_kernel_r_x:
    buffer_load_dwordx4 v[116:119], v212, s[8:11], s45 offen offset:0 sc1
    buffer_load_dwordx4 v[120:123], v212, s[8:11], s45 offen offset:1024 sc1
    buffer_load_dwordx4 v[124:127], v212, s[8:11], s45 offen offset:2048 sc1
    buffer_load_dwordx4 v[128:131], v212, s[8:11], s45 offen offset:3072 sc1
    buffer_load_dwordx4 v[132:135], v213, s[8:11], s45 offen offset:0 sc1
    buffer_load_dwordx4 v[136:139], v213, s[8:11], s45 offen offset:1024 sc1
    buffer_load_dwordx4 v[140:143], v213, s[8:11], s45 offen offset:2048 sc1
    buffer_load_dwordx4 v[144:147], v213, s[8:11], s45 offen offset:3072 sc1
    buffer_load_dwordx4 v[148:151], v214, s[8:11], s45 offen offset:0 sc1
    buffer_load_dwordx4 v[152:155], v214, s[8:11], s45 offen offset:1024 sc1
    buffer_load_dwordx4 v[156:159], v214, s[8:11], s45 offen offset:2048 sc1
    buffer_load_dwordx4 v[160:163], v214, s[8:11], s45 offen offset:3072 sc1
    buffer_load_dwordx4 v[164:167], v215, s[8:11], s45 offen offset:0 sc1
    buffer_load_dwordx4 v[168:171], v215, s[8:11], s45 offen offset:1024 sc1
    buffer_load_dwordx4 v[172:175], v215, s[8:11], s45 offen offset:2048 sc1
    buffer_load_dwordx4 v[176:179], v215, s[8:11], s45 offen offset:3072 sc1
    buffer_load_dwordx4 v[180:183], v216, s[8:11], s45 offen offset:0 sc1
    buffer_load_dwordx4 v[184:187], v216, s[8:11], s45 offen offset:1024 sc1
    buffer_load_dwordx4 v[188:191], v216, s[8:11], s45 offen offset:2048 sc1
    buffer_load_dwordx4 v[192:195], v216, s[8:11], s45 offen offset:3072 sc1
    s_waitcnt vmcnt(0)
    v_max3_u32 v204, v116, v117, v118
    v_max3_u32 v204, v204, v119, v120
    v_max3_u32 v204, v204, v121, v122
    v_max3_u32 v204, v204, v123, v124
    v_max3_u32 v204, v204, v125, v126
    v_max3_u32 v204, v204, v127, v128
    v_max3_u32 v204, v204, v129, v130
    v_max3_u32 v204, v204, v131, v132
    v_max3_u32 v204, v204, v133, v134
    v_max3_u32 v204, v204, v135, v136
    v_max3_u32 v204, v204, v137, v138
    v_max3_u32 v204, v204, v139, v140
    v_max3_u32 v204, v204, v141, v142
    v_max3_u32 v204, v204, v143, v144
    v_max3_u32 v204, v204, v145, v146
    v_max3_u32 v204, v204, v147, v148
    v_max3_u32 v204, v204, v149, v150
    v_max3_u32 v204, v204, v151, v152
    v_max3_u32 v204, v204, v153, v154
    v_max3_u32 v204, v204, v155, v156
    v_max3_u32 v204, v204, v157, v158
    v_max3_u32 v204, v204, v159, v160
    v_max3_u32 v204, v204, v161, v162
    v_max3_u32 v204, v204, v163, v164
    v_max3_u32 v204, v204, v165, v166
    v_max3_u32 v204, v204, v167, v168
    v_max3_u32 v204, v204, v169, v170
    v_max3_u32 v204, v204, v171, v172
    v_max3_u32 v204, v204, v173, v174
    v_max3_u32 v204, v204, v175, v176
    v_max3_u32 v204, v204, v177, v178
    v_max3_u32 v204, v204, v179, v180
    v_max3_u32 v204, v204, v181, v182
    v_max3_u32 v204, v204, v183, v184
    v_max3_u32 v204, v204, v185, v186
    v_max3_u32 v204, v204, v187, v188
    v_max3_u32 v204, v204, v189, v190
    v_max3_u32 v204, v204, v191, v192
    v_max3_u32 v204, v204, v193, v194
    v_max_u32 v204, v204, v195
    v_cmp_eq_u32 vcc, -1, v204
    s_add_u32 s61, s61, 1
    s_cbranch_vccz chain1_kernel_r_x_out
    s_cmp_ge_u32 s61, s60
    s_cbranch_scc1 chain1_kernel_r_x_to
    s_sleep 2
    s_branch chain1_kernel_r_x
chain1_kernel_r_x_to:
    s_mov_b32 s60, 1
chain1_kernel_r_x_out:
    v_mfma_f32_16x16x32_bf16 v[196:199], v[100:103], v[180:183], 0
    v_mfma_f32_16x16x32_bf16 v[200:203], v[100:103], v[184:187], 0
    v_mfma_f32_16x16x32_bf16 v[196:199], v[104:107], v[188:191], v[196:199]
    v_mfma_f32_16x16x32_bf16 v[200:203], v[104:107], v[192:195], v[200:203]
    v_mfma_f32_16x16x32_bf16 v[196:199], v[16:19], v[116:119], v[196:199]
    v_mfma_f32_16x16x32_bf16 v[200:203], v[16:19], v[120:123], v[200:203]
    v_mfma_f32_16x16x32_bf16 v[196:199], v[20:23], v[124:127], v[196:199]
    v_mfma_f32_16x16x32_bf16 v[200:203], v[20:23], v[128:131], v[200:203]
    v_mfma_f32_16x16x32_bf16 v[196:199], v[24:27], v[132:135], v[196:199]
    v_mfma_f32_16x16x32_bf16 v[200:203], v[24:27], v[136:139], v[200:203]
    v_mfma_f32_16x16x32_bf16 v[196:199], v[28:31], v[140:143], v[196:199]
    v_mfma_f32_16x16x32_bf16 v[200:203], v[28:31], v[144:147], v[200:203]
    v_mfma_f32_16x16x32_bf16 v[196:199], v[32:35], v[148:151], v[196:199]
    v_mfma_f32_16x16x32_bf16 v[200:203], v[32:35], v[152:155], v[200:203]
    v_mfma_f32_16x16x32_bf16 v[196:199], v[36:39], v[156:159], v[196:199]
    v_mfma_f32_16x16x32_bf16 v[200:203], v[36:39], v[160:163], v[200:203]
    v_mfma_f32_16x16x32_bf16 v[196:199], v[40:43], v[164:167], v[196:199]
    v_mfma_f32_16x16x32_bf16 v[200:203], v[40:43], v[168:171], v[200:203]
    v_mfma_f32_16x16x32_bf16 v[196:199], v[44:47], v[172:175], v[196:199]
    v_mfma_f32_16x16x32_bf16 v[200:203], v[44:47], v[176:179], v[200:203]
    s_nop 6
    ds_write_b128 v217, v[196:199] offset:0
    ds_write_b128 v217, v[200:203] offset:1024
    s_waitcnt lgkmcnt(0)
    s_barrier
    s_cmp_lt_u32 s3, 2
    s_cbranch_scc0 chain1_kernel_no8
    ds_read_b128 v[220:223], v218 offset:0
    ds_read_b128 v[224:227], v218 offset:2048
    ds_read_b128 v[228:231], v218 offset:4096
    ds_read_b128 v[232:235], v218 offset:6144
    s_waitcnt lgkmcnt(0)
    v_pk_add_f32 v[220:221], v[220:221], v[224:225]
    v_pk_add_f32 v[228:229], v[228:229], v[232:233]
    v_pk_add_f32 v[222:223], v[222:223], v[226:227]
    v_pk_add_f32 v[230:231], v[230:231], v[234:235]
    v_pk_add_f32 v[220:221], v[220:221], v[228:229]
    v_pk_add_f32 v[222:223], v[222:223], v[230:231]
    v_cvt_pk_bf16_f32 v224, v220, v221
    v_cvt_pk_bf16_f32 v225, v222, v223
    v_lshlrev_b32 v220, 16, v224
    v_and_b32 v221, 0xffff0000, v224
    v_lshlrev_b32 v226, 16, v206
    v_and_b32 v227, 0xffff0000, v206
    v_add_f32 v220, v220, v226
    v_add_f32 v221, v221, v227
    v_lshlrev_b32 v222, 16, v225
    v_and_b32 v223, 0xffff0000, v225
    v_lshlrev_b32 v226, 16, v207
    v_and_b32 v227, 0xffff0000, v207
    v_add_f32 v222, v222, v226
    v_add_f32 v223, v223, v227
    v_cvt_pk_bf16_f32 v224, v220, v221
    v_cvt_pk_bf16_f32 v225, v222, v223
    buffer_store_dwordx2 v[224:225], v219, s[12:15], s46 offen
chain1_kernel_no8:
    s_add_u32 s40, s40, 1
    s_add_u32 s42, s42, 327680
    s_add_u32 s43, s43, 81920
    s_add_u32 s45, s45, 81920
    s_add_u32 s46, s46, 40960
    s_add_u32 s47, s47, 40960
    s_cmp_lt_u32 s40, 64
    s_cbranch_scc1 chain1_kernel_r_step
    s_branch chain1_kernel_end
chain1_kernel_roleP:
    s_sub_u32 s44, s2, 104
    s_lshr_b32 s46, s44, 5
    s_and_b32 s44, s44, 31
    s_load_dwordx2 s[6:7], s[0:1], 40
    s_load_dwordx2 s[24:25], s[0:1], 48
    s_load_dwordx2 s[26:27], s[0:1], 56
    s_waitcnt lgkmcnt(0)
    s_cmp_eq_u32 s46, 1
    s_cselect_b32 s6, s24, s6
    s_cselect_b32 s7, s25, s7
    s_mov_b32 s43, 67108864
    s_cselect_b32 s43, 92274688, s43
    s_cmp_eq_u32 s46, 2
    s_cselect_b32 s6, s26, s6
    s_cselect_b32 s7, s27, s7
    s_cselect_b32 s43, 33554432, s43
    s_mov_b32 s12, s6
    s_mov_b32 s13, s7
    s_mov_b32 s14, 7864320
    s_mov_b32 s15, 0x00020000
    v_add_u32 v16, 0, v0
    s_mov_b32 s24, 683
    v_mul_lo_u32 v17, v16, s24
    v_lshrrev_b32 v17, 14, v17
    v_mul_u32_u24 v18, 24, v17
    v_sub_u32 v18, v16, v18
    s_mov_b32 s24, 12288
    v_mul_lo_u32 v4, v17, s24
    v_lshl_add_u32 v4, v18, 4, v4
    v_mul_u32_u24 v10, 400, v17
    v_lshl_add_u32 v10, v18, 4, v10
    v_add_u32 v10, 81920, v10
    v_add_u32 v16, 256, v0
    s_mov_b32 s24, 683
    v_mul_lo_u32 v17, v16, s24
    v_lshrrev_b32 v17, 14, v17
    v_mul_u32_u24 v18, 24, v17
    v_sub_u32 v18, v16, v18
    s_mov_b32 s24, 12288
    v_mul_lo_u32 v5, v17, s24
    v_lshl_add_u32 v5, v18, 4, v5
    v_mul_u32_u24 v11, 400, v17
    v_lshl_add_u32 v11, v18, 4, v11
    v_add_u32 v11, 81920, v11
    v_add_u32 v16, 512, v0
    s_mov_b32 s24, 683
    v_mul_lo_u32 v17, v16, s24
    v_lshrrev_b32 v17, 14, v17
    v_mul_u32_u24 v18, 24, v17
    v_sub_u32 v18, v16, v18
    s_mov_b32 s24, 12288
    v_mul_lo_u32 v6, v17, s24
    v_lshl_add_u32 v6, v18, 4, v6
    v_mul_u32_u24 v12, 400, v17
    v_lshl_add_u32 v12, v18, 4, v12
    v_add_u32 v12, 81920, v12
    v_add_u32 v16, 768, v0
    s_mov_b32 s24, 683
    v_mul_lo_u32 v17, v16, s24
    v_lshrrev_b32 v17, 14, v17
    v_mul_u32_u24 v18, 24, v17
    v_sub_u32 v18, v16, v18
    s_mov_b32 s24, 12288
    v_mul_lo_u32 v7, v17, s24
    v_lshl_add_u32 v7, v18, 4, v7
    v_mul_u32_u24 v13, 400, v17
    v_lshl_add_u32 v13, v18, 4, v13
    v_add_u32 v13, 81920, v13
    v_add_u32 v16, 1024, v0
    s_mov_b32 s24, 683
    v_mul_lo_u32 v17, v16, s24
    v_lshrrev_b32 v17, 14, v17
    v_mul_u32_u24 v18, 24, v17
    v_sub_u32 v18, v16, v18
    s_mov_b32 s24, 12288
    v_mul_lo_u32 v8, v17, s24
    v_lshl_add_u32 v8, v18, 4, v8
    v_mul_u32_u24 v14, 400, v17
    v_lshl_add_u32 v14, v18, 4, v14
    v_add_u32 v14, 81920, v14
    v_add_u32 v16, 1280, v0
    s_mov_b32 s24, 683
    v_mul_lo_u32 v17, v16, s24
    v_lshrrev_b32 v17, 14, v17
    v_mul_u32_u24 v18, 24, v17
    v_sub_u32 v18, v16, v18
    s_mov_b32 s24, 12288
    v_mul_lo_u32 v9, v17, s24
    v_lshl_add_u32 v9, v18, 4, v9
    v_mul_u32_u24 v15, 400, v17
    v_lshl_add_u32 v15, v18, 4, v15
    v_add_u32 v15, 81920, v15
    v_lshrrev_b32 v16, 2, v2
    v_lshl_add_u32 v16, v3, 3, v16
    v_mul_u32_u24 v0, 400, v16
    v_and_b32 v16, 3, v2
    v_lshl_add_u32 v0, v16, 3, v0
    s_mul_i32 s24, s3, 96
    s_add_u32 s24, s24, 81920
    v_add_u32 v0, s24, v0
    v_lshlrev_b32 v16, 4, v1
    s_mul_i32 s24, s3, 10240
    v_add_u32 v17, s24, v16
    v_add_u32 v18, 4096, v17
    v_add_u32 v19, 8192, v17
    s_mov_b32 s41, 59768832
    buffer_load_dwordx4 a[240:243], v17, s[8:11], s41 offen offset:0
    buffer_load_dwordx4 a[244:247], v17, s[8:11], s41 offen offset:1024
    buffer_load_dwordx4 a[248:251], v17, s[8:11], s41 offen offset:2048
    buffer_load_dwordx4 a[252:255], v17, s[8:11], s41 offen offset:3072
    buffer_load_dwordx4 v[20:23], v18, s[8:11], s41 offen offset:0
    buffer_load_dwordx4 v[24:27], v18, s[8:11], s41 offen offset:1024
    buffer_load_dwordx4 v[28:31], v18, s[8:11], s41 offen offset:2048
    buffer_load_dwordx4 v[32:35], v18, s[8:11], s41 offen offset:3072
    buffer_load_dwordx4 v[36:39], v19, s[8:11], s41 offen offset:0
    buffer_load_dwordx4 v[40:43], v19, s[8:11], s41 offen offset:1024
    s_mul_i32 s45, s44, 384
    s_add_u32 s47, s45, 0
    buffer_load_dwordx4 v[56:59], v4, s[12:15], s47 offen
    buffer_load_dwordx4 v[60:63], v5, s[12:15], s47 offen
    buffer_load_dwordx4 v[64:67], v6, s[12:15], s47 offen
    buffer_load_dwordx4 v[68:71], v7, s[12:15], s47 offen
    buffer_load_dwordx4 v[72:75], v8, s[12:15], s47 offen
    buffer_load_dwordx4 v[76:79], v9, s[12:15], s47 offen
    s_add_u32 s47, s45, 786432
    buffer_load_dwordx4 v[80:83], v4, s[12:15], s47 offen
    buffer_load_dwordx4 v[84:87], v5, s[12:15], s47 offen
    buffer_load_dwordx4 v[88:91], v6, s[12:15], s47 offen
    buffer_load_dwordx4 v[92:95], v7, s[12:15], s47 offen
    buffer_load_dwordx4 v[96:99], v8, s[12:15], s47 offen
    buffer_load_dwordx4 v[100:103], v9, s[12:15], s47 offen
    s_add_u32 s47, s45, 1572864
    buffer_load_dwordx4 v[104:107], v4, s[12:15], s47 offen
    buffer_load_dwordx4 v[108:111], v5, s[12:15], s47 offen
    buffer_load_dwordx4 v[112:115], v6, s[12:15], s47 offen
    buffer_load_dwordx4 v[116:119], v7, s[12:15], s47 offen
    buffer_load_dwordx4 v[120:123], v8, s[12:15], s47 offen
    buffer_load_dwordx4 v[124:127], v9, s[12:15], s47 offen
    s_add_u32 s47, s45, 2359296
    buffer_load_dwordx4 v[128:131], v4, s[12:15], s47 offen
    buffer_load_dwordx4 v[132:135], v5, s[12:15], s47 offen
    buffer_load_dwordx4 v[136:139], v6, s[12:15], s47 offen
    buffer_load_dwordx4 v[140:143], v7, s[12:15], s47 offen
    buffer_load_dwordx4 v[144:147], v8, s[12:15], s47 offen
    buffer_load_dwordx4 v[148:151], v9, s[12:15], s47 offen
    s_add_u32 s47, s45, 3145728
    buffer_load_dwordx4 v[152:155], v4, s[12:15], s47 offen
    buffer_load_dwordx4 v[156:159], v5, s[12:15], s47 offen
    buffer_load_dwordx4 v[160:163], v6, s[12:15], s47 offen
    buffer_load_dwordx4 v[164:167], v7, s[12:15], s47 offen
    buffer_load_dwordx4 v[168:171], v8, s[12:15], s47 offen
    buffer_load_dwordx4 v[172:175], v9, s[12:15], s47 offen
    s_add_u32 s47, s45, 3932160
    buffer_load_dwordx4 v[176:179], v4, s[12:15], s47 offen
    buffer_load_dwordx4 v[180:183], v5, s[12:15], s47 offen
    buffer_load_dwordx4 v[184:187], v6, s[12:15], s47 offen
    buffer_load_dwordx4 v[188:191], v7, s[12:15], s47 offen
    buffer_load_dwordx4 v[192:195], v8, s[12:15], s47 offen
    buffer_load_dwordx4 v[196:199], v9, s[12:15], s47 offen
    s_add_u32 s47, s45, 4718592
    buffer_load_dwordx4 v[200:203], v4, s[12:15], s47 offen
    buffer_load_dwordx4 v[204:207], v5, s[12:15], s47 offen
    buffer_load_dwordx4 v[208:211], v6, s[12:15], s47 offen
    buffer_load_dwordx4 v[212:215], v7, s[12:15], s47 offen
    buffer_load_dwordx4 v[216:219], v8, s[12:15], s47 offen
    buffer_load_dwordx4 v[220:223], v9, s[12:15], s47 offen
    s_add_u32 s47, s45, 5505024
    buffer_load_dwordx4 v[224:227], v4, s[12:15], s47 offen
    buffer_load_dwordx4 v[228:231], v5, s[12:15], s47 offen
    buffer_load_dwordx4 v[232:235], v6, s[12:15], s47 offen
    buffer_load_dwordx4 v[236:239], v7, s[12:15], s47 offen
    buffer_load_dwordx4 v[240:243], v8, s[12:15], s47 offen
    buffer_load_dwordx4 v[244:247], v9, s[12:15], s47 offen
    s_waitcnt vmcnt(42)
    ds_write_b128 v10, v[56:59] offset:0
    ds_write_b128 v11, v[60:63] offset:0
    ds_write_b128 v12, v[64:67] offset:0
    ds_write_b128 v13, v[68:71] offset:0
    ds_write_b128 v14, v[72:75] offset:0
    ds_write_b128 v15, v[76:79] offset:0
    ds_write_b128 v17, a[240:243] offset:0
    ds_write_b128 v17, a[244:247] offset:1024
    ds_write_b128 v17, a[248:251] offset:2048
    ds_write_b128 v17, a[252:255] offset:3072
    ds_write_b128 v17, v[20:23] offset:4096
    ds_write_b128 v17, v[24:27] offset:5120
    ds_write_b128 v17, v[28:31] offset:6144
    ds_write_b128 v17, v[32:35] offset:7168
    ds_write_b128 v17, v[36:39] offset:8192
    ds_write_b128 v17, v[40:43] offset:9216
    s_waitcnt lgkmcnt(0)
    s_add_u32 s47, s45, 6291456
    buffer_load_dwordx4 v[56:59], v4, s[12:15], s47 offen
    buffer_load_dwordx4 v[60:63], v5, s[12:15], s47 offen
    buffer_load_dwordx4 v[64:67], v6, s[12:15], s47 offen
    buffer_load_dwordx4 v[68:71], v7, s[12:15], s47 offen
    buffer_load_dwordx4 v[72:75], v8, s[12:15], s47 offen
    buffer_load_dwordx4 v[76:79], v9, s[12:15], s47 offen
    s_barrier
    ds_read_b64_tr_b16 a[0:1], v0 offset:0
    ds_read_b64_tr_b16 a[2:3], v0 offset:1600
    ds_read_b64_tr_b16 a[4:5], v0 offset:12800
    ds_read_b64_tr_b16 a[6:7], v0 offset:14400
    ds_read_b64_tr_b16 a[80:81], v0 offset:32
    ds_read_b64_tr_b16 a[82:83], v0 offset:1632
    ds_read_b64_tr_b16 a[84:85], v0 offset:12832
    ds_read_b64_tr_b16 a[86:87], v0 offset:14432
    ds_read_b64_tr_b16 a[160:161], v0 offset:64
    ds_read_b64_tr_b16 a[162:163], v0 offset:1664
    ds_read_b64_tr_b16 a[164:165], v0 offset:12864
    ds_read_b64_tr_b16 a[166:167], v0 offset:14464
    s_waitcnt vmcnt(42)
    ds_write_b128 v10, v[80:83] offset:25600
    ds_write_b128 v11, v[84:87] offset:25600
    ds_write_b128 v12, v[88:91] offset:25600
    ds_write_b128 v13, v[92:95] offset:25600
    ds_write_b128 v14, v[96:99] offset:25600
    ds_write_b128 v15, v[100:103] offset:25600
    s_waitcnt lgkmcnt(0)
    s_add_u32 s47, s45, 7077888
    buffer_load_dwordx4 v[80:83], v4, s[12:15], s47 offen
    buffer_load_dwordx4 v[84:87], v5, s[12:15], s47 offen
    buffer_load_dwordx4 v[88:91], v6, s[12:15], s47 offen
    buffer_load_dwordx4 v[92:95], v7, s[12:15], s47 offen
    buffer_load_dwordx4 v[96:99], v8, s[12:15], s47 offen
    buffer_load_dwordx4 v[100:103], v9, s[12:15], s47 offen
    s_barrier
    ds_read_b64_tr_b16 a[8:9], v0 offset:25600
    ds_read_b64_tr_b16 a[10:11], v0 offset:27200
    ds_read_b64_tr_b16 a[12:13], v0 offset:38400
    ds_read_b64_tr_b16 a[14:15], v0 offset:40000
    ds_read_b64_tr_b16 a[88:89], v0 offset:25632
    ds_read_b64_tr_b16 a[90:91], v0 offset:27232
    ds_read_b64_tr_b16 a[92:93], v0 offset:38432
    ds_read_b64_tr_b16 a[94:95], v0 offset:40032
    ds_read_b64_tr_b16 a[168:169], v0 offset:25664
    ds_read_b64_tr_b16 a[170:171], v0 offset:27264
    ds_read_b64_tr_b16 a[172:173], v0 offset:38464
    ds_read_b64_tr_b16 a[174:175], v0 offset:40064
    s_waitcnt vmcnt(42)
    ds_write_b128 v10, v[104:107] offset:0
    ds_write_b128 v11, v[108:111] offset:0
    ds_write_b128 v12, v[112:115] offset:0
    ds_write_b128 v13, v[116:119] offset:0
    ds_write_b128 v14, v[120:123] offset:0
    ds_write_b128 v15, v[124:127] offset:0
    s_waitcnt lgkmcnt(0)
    s_barrier
    ds_read_b64_tr_b16 a[16:17], v0 offset:0
    ds_read_b64_tr_b16 a[18:19], v0 offset:1600
    ds_read_b64_tr_b16 a[20:21], v0 offset:12800
    ds_read_b64_tr_b16 a[22:23], v0 offset:14400
    ds_read_b64_tr_b16 a[96:97], v0 offset:32
    ds_read_b64_tr_b16 a[98:99], v0 offset:1632
    ds_read_b64_tr_b16 a[100:101], v0 offset:12832
    ds_read_b64_tr_b16 a[102:103], v0 offset:14432
    ds_read_b64_tr_b16 a[176:177], v0 offset:64
    ds_read_b64_tr_b16 a[178:179], v0 offset:1664
    ds_read_b64_tr_b16 a[180:181], v0 offset:12864
    ds_read_b64_tr_b16 a[182:183], v0 offset:14464
    s_waitcnt vmcnt(36)
    ds_write_b128 v10, v[128:131] offset:25600
    ds_write_b128 v11, v[132:135] offset:25600
    ds_write_b128 v12, v[136:139] offset:25600
    ds_write_b128 v13, v[140:143] offset:25600
    ds_write_b128 v14, v[144:147] offset:25600
    ds_write_b128 v15, v[148:151] offset:25600
    s_waitcnt lgkmcnt(0)
    s_barrier
    ds_read_b64_tr_b16 a[24:25], v0 offset:25600
    ds_read_b64_tr_b16 a[26:27], v0 offset:27200
    ds_read_b64_tr_b16 a[28:29], v0 offset:38400
    ds_read_b64_tr_b16 a[30:31], v0 offset:40000
    ds_read_b64_tr_b16 a[104:105], v0 offset:25632
    ds_read_b64_tr_b16 a[106:107], v0 offset:27232
    ds_read_b64_tr_b16 a[108:109], v0 offset:38432
    ds_read_b64_tr_b16 a[110:111], v0 offset:40032
    ds_read_b64_tr_b16 a[184:185], v0 offset:25664
    ds_read_b64_tr_b16 a[186:187], v0 offset:27264
    ds_read_b64_tr_b16 a[188:189], v0 offset:38464
    ds_read_b64_tr_b16 a[190:191], v0 offset:40064
    s_waitcnt vmcnt(30)
    ds_write_b128 v10, v[152:155] offset:0
    ds_write_b128 v11, v[156:159] offset:0
    ds_write_b128 v12, v[160:163] offset:0
    ds_write_b128 v13, v[164:167] offset:0
    ds_write_b128 v14, v[168:171] offset:0
    ds_write_b128 v15, v[172:175] offset:0
    s_waitcnt lgkmcnt(0)
    s_barrier
    ds_read_b64_tr_b16 a[32:33], v0 offset:0
    ds_read_b64_tr_b16 a[34:35], v0 offset:1600
    ds_read_b64_tr_b16 a[36:37], v0 offset:12800
    ds_read_b64_tr_b16 a[38:39], v0 offset:14400
    ds_read_b64_tr_b16 a[112:113], v0 offset:32
    ds_read_b64_tr_b16 a[114:115], v0 offset:1632
    ds_read_b64_tr_b16 a[116:117], v0 offset:12832
    ds_read_b64_tr_b16 a[118:119], v0 offset:14432
    ds_read_b64_tr_b16 a[192:193], v0 offset:64
    ds_read_b64_tr_b16 a[194:195], v0 offset:1664
    ds_read_b64_tr_b16 a[196:197], v0 offset:12864
    ds_read_b64_tr_b16 a[198:199], v0 offset:14464
    s_waitcnt vmcnt(24)
    ds_write_b128 v10, v[176:179] offset:25600
    ds_write_b128 v11, v[180:183] offset:25600
    ds_write_b128 v12, v[184:187] offset:25600
    ds_write_b128 v13, v[188:191] offset:25600
    ds_write_b128 v14, v[192:195] offset:25600
    ds_write_b128 v15, v[196:199] offset:25600
    s_waitcnt lgkmcnt(0)
    s_barrier
    ds_read_b64_tr_b16 a[40:41], v0 offset:25600
    ds_read_b64_tr_b16 a[42:43], v0 offset:27200
    ds_read_b64_tr_b16 a[44:45], v0 offset:38400
    ds_read_b64_tr_b16 a[46:47], v0 offset:40000
    ds_read_b64_tr_b16 a[120:121], v0 offset:25632
    ds_read_b64_tr_b16 a[122:123], v0 offset:27232
    ds_read_b64_tr_b16 a[124:125], v0 offset:38432
    ds_read_b64_tr_b16 a[126:127], v0 offset:40032
    ds_read_b64_tr_b16 a[200:201], v0 offset:25664
    ds_read_b64_tr_b16 a[202:203], v0 offset:27264
    ds_read_b64_tr_b16 a[204:205], v0 offset:38464
    ds_read_b64_tr_b16 a[206:207], v0 offset:40064
    s_waitcnt vmcnt(18)
    ds_write_b128 v10, v[200:203] offset:0
    ds_write_b128 v11, v[204:207] offset:0
    ds_write_b128 v12, v[208:211] offset:0
    ds_write_b128 v13, v[212:215] offset:0
    ds_write_b128 v14, v[216:219] offset:0
    ds_write_b128 v15, v[220:223] offset:0
    s_waitcnt lgkmcnt(0)
    s_barrier
    ds_read_b64_tr_b16 a[48:49], v0 offset:0
    ds_read_b64_tr_b16 a[50:51], v0 offset:1600
    ds_read_b64_tr_b16 a[52:53], v0 offset:12800
    ds_read_b64_tr_b16 a[54:55], v0 offset:14400
    ds_read_b64_tr_b16 a[128:129], v0 offset:32
    ds_read_b64_tr_b16 a[130:131], v0 offset:1632
    ds_read_b64_tr_b16 a[132:133], v0 offset:12832
    ds_read_b64_tr_b16 a[134:135], v0 offset:14432
    ds_read_b64_tr_b16 a[208:209], v0 offset:64
    ds_read_b64_tr_b16 a[210:211], v0 offset:1664
    ds_read_b64_tr_b16 a[212:213], v0 offset:12864
    ds_read_b64_tr_b16 a[214:215], v0 offset:14464
    s_waitcnt vmcnt(12)
    ds_write_b128 v10, v[224:227] offset:25600
    ds_write_b128 v11, v[228:231] offset:25600
    ds_write_b128 v12, v[232:235] offset:25600
    ds_write_b128 v13, v[236:239] offset:25600
    ds_write_b128 v14, v[240:243] offset:25600
    ds_write_b128 v15, v[244:247] offset:25600
    s_waitcnt lgkmcnt(0)
    s_barrier
    ds_read_b64_tr_b16 a[56:57], v0 offset:25600
    ds_read_b64_tr_b16 a[58:59], v0 offset:27200
    ds_read_b64_tr_b16 a[60:61], v0 offset:38400
    ds_read_b64_tr_b16 a[62:63], v0 offset:40000
    ds_read_b64_tr_b16 a[136:137], v0 offset:25632
    ds_read_b64_tr_b16 a[138:139], v0 offset:27232
    ds_read_b64_tr_b16 a[140:141], v0 offset:38432
    ds_read_b64_tr_b16 a[142:143], v0 offset:40032
    ds_read_b64_tr_b16 a[216:217], v0 offset:25664
    ds_read_b64_tr_b16 a[218:219], v0 offset:27264
    ds_read_b64_tr_b16 a[220:221], v0 offset:38464
    ds_read_b64_tr_b16 a[222:223], v0 offset:40064
    s_waitcnt vmcnt(6)
    ds_write_b128 v10, v[56:59] offset:0
    ds_write_b128 v11, v[60:63] offset:0
    ds_write_b128 v12, v[64:67] offset:0
    ds_write_b128 v13, v[68:71] offset:0
    ds_write_b128 v14, v[72:75] offset:0
    ds_write_b128 v15, v[76:79] offset:0
    s_waitcnt lgkmcnt(0)
    s_barrier
    ds_read_b64_tr_b16 a[64:65], v0 offset:0
    ds_read_b64_tr_b16 a[66:67], v0 offset:1600
    ds_read_b64_tr_b16 a[68:69], v0 offset:12800
    ds_read_b64_tr_b16 a[70:71], v0 offset:14400
    ds_read_b64_tr_b16 a[144:145], v0 offset:32
    ds_read_b64_tr_b16 a[146:147], v0 offset:1632
    ds_read_b64_tr_b16 a[148:149], v0 offset:12832
    ds_read_b64_tr_b16 a[150:151], v0 offset:14432
    ds_read_b64_tr_b16 a[224:225], v0 offset:64
    ds_read_b64_tr_b16 a[226:227], v0 offset:1664
    ds_read_b64_tr_b16 a[228:229], v0 offset:12864
    ds_read_b64_tr_b16 a[230:231], v0 offset:14464
    s_waitcnt vmcnt(0)
    ds_write_b128 v10, v[80:83] offset:25600
    ds_write_b128 v11, v[84:87] offset:25600
    ds_write_b128 v12, v[88:91] offset:25600
    ds_write_b128 v13, v[92:95] offset:25600
    ds_write_b128 v14, v[96:99] offset:25600
    ds_write_b128 v15, v[100:103] offset:25600
    s_waitcnt lgkmcnt(0)
    s_barrier
    ds_read_b64_tr_b16 a[72:73], v0 offset:25600
    ds_read_b64_tr_b16 a[74:75], v0 offset:27200
    ds_read_b64_tr_b16 a[76:77], v0 offset:38400
    ds_read_b64_tr_b16 a[78:79], v0 offset:40000
    ds_read_b64_tr_b16 a[152:153], v0 offset:25632
    ds_read_b64_tr_b16 a[154:155], v0 offset:27232
    ds_read_b64_tr_b16 a[156:157], v0 offset:38432
    ds_read_b64_tr_b16 a[158:159], v0 offset:40032
    ds_read_b64_tr_b16 a[232:233], v0 offset:25664
    ds_read_b64_tr_b16 a[234:235], v0 offset:27264
    ds_read_b64_tr_b16 a[236:237], v0 offset:38464
    ds_read_b64_tr_b16 a[238:239], v0 offset:40064
    v_mov_b32 v6, v17
    v_mov_b32 v7, v18
    v_mov_b32 v8, v19
    v_lshlrev_b32 v5, 4, v1
    s_mul_i32 s24, s44, 12288
    s_mul_i32 s25, s3, 3072
    s_add_u32 s24, s24, s25
    v_add_u32 v11, s24, v5
    s_lshl_b32 s24, s46, 12
    s_lshl_b32 s25, s44, 7
    s_add_u32 s24, s24, s25
    s_add_u32 s24, s24, 151560192
    v_mov_b32 v14, s24
    v_mov_b32 v15, 2146435072
    v_cmp_eq_u32 vcc, 0, v1
    s_nop 1
    v_cndmask_b32 v14, v15, v14, vcc
    s_mov_b32 s40, 0
    s_mov_b32 s42, 0
    s_waitcnt lgkmcnt(0)
chain1_kernel_p_seg:
    v_add_u32 v9, s42, v5
    s_xor_b32 s42, s42, 40960
    v_add_u32 v10, s42, v6
    s_add_u32 s41, s41, 40960
    buffer_load_dwordx4 v[16:19], v6, s[8:11], s41 offen offset:0
    buffer_load_dwordx4 v[20:23], v6, s[8:11], s41 offen offset:1024
    buffer_load_dwordx4 v[24:27], v6, s[8:11], s41 offen offset:2048
    buffer_load_dwordx4 v[28:31], v6, s[8:11], s41 offen offset:3072
    buffer_load_dwordx4 v[32:35], v7, s[8:11], s41 offen offset:0
    buffer_load_dwordx4 v[36:39], v7, s[8:11], s41 offen offset:1024
    buffer_load_dwordx4 v[40:43], v7, s[8:11], s41 offen offset:2048
    buffer_load_dwordx4 v[44:47], v7, s[8:11], s41 offen offset:3072
    buffer_load_dwordx4 v[48:51], v8, s[8:11], s41 offen offset:0
    buffer_load_dwordx4 v[52:55], v8, s[8:11], s41 offen offset:1024
    ds_read_b128 v[56:59], v9 offset:0
    ds_read_b128 v[60:63], v9 offset:20480
    ds_read_b128 v[64:67], v9 offset:1024
    ds_read_b128 v[68:71], v9 offset:21504
    ds_read_b128 v[72:75], v9 offset:2048
    ds_read_b128 v[76:79], v9 offset:22528
    ds_read_b128 v[80:83], v9 offset:3072
    ds_read_b128 v[84:87], v9 offset:23552
    s_waitcnt lgkmcnt(6)
    v_mfma_f32_16x16x32_bf16 v[88:91], a[0:3], v[56:59], 0
    v_mfma_f32_16x16x32_bf16 v[92:95], a[80:83], v[56:59], 0
    v_mfma_f32_16x16x32_bf16 v[96:99], a[160:163], v[56:59], 0
    v_mfma_f32_16x16x32_bf16 v[100:103], a[0:3], v[60:63], 0
    v_mfma_f32_16x16x32_bf16 v[104:107], a[80:83], v[60:63], 0
    v_mfma_f32_16x16x32_bf16 v[108:111], a[160:163], v[60:63], 0
    ds_read_b128 v[56:59], v9 offset:4096
    ds_read_b128 v[60:63], v9 offset:24576
    s_waitcnt lgkmcnt(6)
    v_mfma_f32_16x16x32_bf16 v[88:91], a[4:7], v[64:67], v[88:91]
    v_mfma_f32_16x16x32_bf16 v[92:95], a[84:87], v[64:67], v[92:95]
    v_mfma_f32_16x16x32_bf16 v[96:99], a[164:167], v[64:67], v[96:99]
    v_mfma_f32_16x16x32_bf16 v[100:103], a[4:7], v[68:71], v[100:103]
    v_mfma_f32_16x16x32_bf16 v[104:107], a[84:87], v[68:71], v[104:107]
    v_mfma_f32_16x16x32_bf16 v[108:111], a[164:167], v[68:71], v[108:111]
    ds_read_b128 v[64:67], v9 offset:5120
    ds_read_b128 v[68:71], v9 offset:25600
    s_waitcnt lgkmcnt(6)
    v_mfma_f32_16x16x32_bf16 v[88:91], a[8:11], v[72:75], v[88:91]
    v_mfma_f32_16x16x32_bf16 v[92:95], a[88:91], v[72:75], v[92:95]
    v_mfma_f32_16x16x32_bf16 v[96:99], a[168:171], v[72:75], v[96:99]
    v_mfma_f32_16x16x32_bf16 v[100:103], a[8:11], v[76:79], v[100:103]
    v_mfma_f32_16x16x32_bf16 v[104:107], a[88:91], v[76:79], v[104:107]
    v_mfma_f32_16x16x32_bf16 v[108:111], a[168:171], v[76:79], v[108:111]
    ds_read_b128 v[72:75], v9 offset:6144
    ds_read_b128 v[76:79], v9 offset:26624
    s_waitcnt lgkmcnt(6)
    v_mfma_f32_16x16x32_bf16 v[88:91], a[12:15], v[80:83], v[88:91]
    v_mfma_f32_16x16x32_bf16 v[92:95], a[92:95], v[80:83], v[92:95]
    v_mfma_f32_16x16x32_bf16 v[96:99], a[172:175], v[80:83], v[96:99]
    v_mfma_f32_16x16x32_bf16 v[100:103], a[12:15], v[84:87], v[100:103]
    v_mfma_f32_16x16x32_bf16 v[104:107], a[92:95], v[84:87], v[104:107]
    v_mfma_f32_16x16x32_bf16 v[108:111], a[172:175], v[84:87], v[108:111]
    ds_read_b128 v[80:83], v9 offset:7168
    ds_read_b128 v[84:87], v9 offset:27648
    s_waitcnt lgkmcnt(6)
    v_mfma_f32_16x16x32_bf16 v[88:91], a[16:19], v[56:59], v[88:91]
    v_mfma_f32_16x16x32_bf16 v[92:95], a[96:99], v[56:59], v[92:95]
    v_mfma_f32_16x16x32_bf16 v[96:99], a[176:179], v[56:59], v[96:99]
    v_mfma_f32_16x16x32_bf16 v[100:103], a[16:19], v[60:63], v[100:103]
    v_mfma_f32_16x16x32_bf16 v[104:107], a[96:99], v[60:63], v[104:107]
    v_mfma_f32_16x16x32_bf16 v[108:111], a[176:179], v[60:63], v[108:111]
    ds_read_b128 v[56:59], v9 offset:8192
    ds_read_b128 v[60:63], v9 offset:28672
    s_waitcnt lgkmcnt(6)
    v_mfma_f32_16x16x32_bf16 v[88:91], a[20:23], v[64:67], v[88:91]
    v_mfma_f32_16x16x32_bf16 v[92:95], a[100:103], v[64:67], v[92:95]
    v_mfma_f32_16x16x32_bf16 v[96:99], a[180:183], v[64:67], v[96:99]
    v_mfma_f32_16x16x32_bf16 v[100:103], a[20:23], v[68:71], v[100:103]
    v_mfma_f32_16x16x32_bf16 v[104:107], a[100:103], v[68:71], v[104:107]
    v_mfma_f32_16x16x32_bf16 v[108:111], a[180:183], v[68:71], v[108:111]
    ds_read_b128 v[64:67], v9 offset:9216
    ds_read_b128 v[68:71], v9 offset:29696
    s_waitcnt lgkmcnt(6)
    v_mfma_f32_16x16x32_bf16 v[88:91], a[24:27], v[72:75], v[88:91]
    v_mfma_f32_16x16x32_bf16 v[92:95], a[104:107], v[72:75], v[92:95]
    v_mfma_f32_16x16x32_bf16 v[96:99], a[184:187], v[72:75], v[96:99]
    v_mfma_f32_16x16x32_bf16 v[100:103], a[24:27], v[76:79], v[100:103]
    v_mfma_f32_16x16x32_bf16 v[104:107], a[104:107], v[76:79], v[104:107]
    v_mfma_f32_16x16x32_bf16 v[108:111], a[184:187], v[76:79], v[108:111]
    ds_read_b128 v[72:75], v9 offset:10240
    ds_read_b128 v[76:79], v9 offset:30720
    s_waitcnt lgkmcnt(6)
    v_mfma_f32_16x16x32_bf16 v[88:91], a[28:31], v[80:83], v[88:91]
    v_mfma_f32_16x16x32_bf16 v[92:95], a[108:111], v[80:83], v[92:95]
    v_mfma_f32_16x16x32_bf16 v[96:99], a[188:191], v[80:83], v[96:99]
    v_mfma_f32_16x16x32_bf16 v[100:103], a[28:31], v[84:87], v[100:103]
    v_mfma_f32_16x16x32_bf16 v[104:107], a[108:111], v[84:87], v[104:107]
    v_mfma_f32_16x16x32_bf16 v[108:111], a[188:191], v[84:87], v[108:111]
    ds_read_b128 v[80:83], v9 offset:11264
    ds_read_b128 v[84:87], v9 offset:31744
    s_waitcnt lgkmcnt(6)
    v_mfma_f32_16x16x32_bf16 v[88:91], a[32:35], v[56:59], v[88:91]
    v_mfma_f32_16x16x32_bf16 v[92:95], a[112:115], v[56:59], v[92:95]
    v_mfma_f32_16x16x32_bf16 v[96:99], a[192:195], v[56:59], v[96:99]
    v_mfma_f32_16x16x32_bf16 v[100:103], a[32:35], v[60:63], v[100:103]
    v_mfma_f32_16x16x32_bf16 v[104:107], a[112:115], v[60:63], v[104:107]
    v_mfma_f32_16x16x32_bf16 v[108:111], a[192:195], v[60:63], v[108:111]
    ds_read_b128 v[56:59], v9 offset:12288
    ds_read_b128 v[60:63], v9 offset:32768
    s_waitcnt lgkmcnt(6)
    v_mfma_f32_16x16x32_bf16 v[88:91], a[36:39], v[64:67], v[88:91]
    v_mfma_f32_16x16x32_bf16 v[92:95], a[116:119], v[64:67], v[92:95]
    v_mfma_f32_16x16x32_bf16 v[96:99], a[196:199], v[64:67], v[96:99]
    v_mfma_f32_16x16x32_bf16 v[100:103], a[36:39], v[68:71], v[100:103]
    v_mfma_f32_16x16x32_bf16 v[104:107], a[116:119], v[68:71], v[104:107]
    v_mfma_f32_16x16x32_bf16 v[108:111], a[196:199], v[68:71], v[108:111]
    s_waitcnt vmcnt(10)
    s_barrier
    s_cmp_eq_u32 s3, 0
    s_cbranch_scc0 chain1_kernel_fp9
    v_mov_b32 v15, s40
    buffer_store_dword v15, v14, s[8:11], 0 offen sc1
chain1_kernel_fp9:
    ds_read_b128 v[64:67], v9 offset:13312
    ds_read_b128 v[68:71], v9 offset:33792
    s_waitcnt lgkmcnt(6)
    v_mfma_f32_16x16x32_bf16 v[88:91], a[40:43], v[72:75], v[88:91]
    v_mfma_f32_16x16x32_bf16 v[92:95], a[120:123], v[72:75], v[92:95]
    v_mfma_f32_16x16x32_bf16 v[96:99], a[200:203], v[72:75], v[96:99]
    v_mfma_f32_16x16x32_bf16 v[100:103], a[40:43], v[76:79], v[100:103]
    v_mfma_f32_16x16x32_bf16 v[104:107], a[120:123], v[76:79], v[104:107]
    v_mfma_f32_16x16x32_bf16 v[108:111], a[200:203], v[76:79], v[108:111]
    ds_read_b128 v[72:75], v9 offset:14336
    ds_read_b128 v[76:79], v9 offset:34816
    s_waitcnt lgkmcnt(6)
    v_mfma_f32_16x16x32_bf16 v[88:91], a[44:47], v[80:83], v[88:91]
    v_mfma_f32_16x16x32_bf16 v[92:95], a[124:127], v[80:83], v[92:95]
    v_mfma_f32_16x16x32_bf16 v[96:99], a[204:207], v[80:83], v[96:99]
    v_mfma_f32_16x16x32_bf16 v[100:103], a[44:47], v[84:87], v[100:103]
    v_mfma_f32_16x16x32_bf16 v[104:107], a[124:127], v[84:87], v[104:107]
    v_mfma_f32_16x16x32_bf16 v[108:111], a[204:207], v[84:87], v[108:111]
    ds_read_b128 v[80:83], v9 offset:15360
    ds_read_b128 v[84:87], v9 offset:35840
    s_waitcnt lgkmcnt(6)
    v_mfma_f32_16x16x32_bf16 v[88:91], a[48:51], v[56:59], v[88:91]
    v_mfma_f32_16x16x32_bf16 v[92:95], a[128:131], v[56:59], v[92:95]
    v_mfma_f32_16x16x32_bf16 v[96:99], a[208:211], v[56:59], v[96:99]
    v_mfma_f32_16x16x32_bf16 v[100:103], a[48:51], v[60:63], v[100:103]
    v_mfma_f32_16x16x32_bf16 v[104:107], a[128:131], v[60:63], v[104:107]
    v_mfma_f32_16x16x32_bf16 v[108:111], a[208:211], v[60:63], v[108:111]
    ds_read_b128 v[56:59], v9 offset:16384
    ds_read_b128 v[60:63], v9 offset:36864
    s_waitcnt lgkmcnt(6)
    v_mfma_f32_16x16x32_bf16 v[88:91], a[52:55], v[64:67], v[88:91]
    v_mfma_f32_16x16x32_bf16 v[92:95], a[132:135], v[64:67], v[92:95]
    v_mfma_f32_16x16x32_bf16 v[96:99], a[212:215], v[64:67], v[96:99]
    v_mfma_f32_16x16x32_bf16 v[100:103], a[52:55], v[68:71], v[100:103]
    v_mfma_f32_16x16x32_bf16 v[104:107], a[132:135], v[68:71], v[104:107]
    v_mfma_f32_16x16x32_bf16 v[108:111], a[212:215], v[68:71], v[108:111]
    ds_read_b128 v[64:67], v9 offset:17408
    ds_read_b128 v[68:71], v9 offset:37888
    s_waitcnt lgkmcnt(6)
    v_mfma_f32_16x16x32_bf16 v[88:91], a[56:59], v[72:75], v[88:91]
    v_mfma_f32_16x16x32_bf16 v[92:95], a[136:139], v[72:75], v[92:95]
    v_mfma_f32_16x16x32_bf16 v[96:99], a[216:219], v[72:75], v[96:99]
    v_mfma_f32_16x16x32_bf16 v[100:103], a[56:59], v[76:79], v[100:103]
    v_mfma_f32_16x16x32_bf16 v[104:107], a[136:139], v[76:79], v[104:107]
    v_mfma_f32_16x16x32_bf16 v[108:111], a[216:219], v[76:79], v[108:111]
    ds_read_b128 v[72:75], v9 offset:18432
    ds_read_b128 v[76:79], v9 offset:38912
    s_waitcnt lgkmcnt(6)
    v_mfma_f32_16x16x32_bf16 v[88:91], a[60:63], v[80:83], v[88:91]
    v_mfma_f32_16x16x32_bf16 v[92:95], a[140:143], v[80:83], v[92:95]
    v_mfma_f32_16x16x32_bf16 v[96:99], a[220:223], v[80:83], v[96:99]
    v_mfma_f32_16x16x32_bf16 v[100:103], a[60:63], v[84:87], v[100:103]
    v_mfma_f32_16x16x32_bf16 v[104:107], a[140:143], v[84:87], v[104:107]
    v_mfma_f32_16x16x32_bf16 v[108:111], a[220:223], v[84:87], v[108:111]
    ds_read_b128 v[80:83], v9 offset:19456
    ds_read_b128 v[84:87], v9 offset:39936
    s_waitcnt lgkmcnt(6)
    v_mfma_f32_16x16x32_bf16 v[88:91], a[64:67], v[56:59], v[88:91]
    v_mfma_f32_16x16x32_bf16 v[92:95], a[144:147], v[56:59], v[92:95]
    v_mfma_f32_16x16x32_bf16 v[96:99], a[224:227], v[56:59], v[96:99]
    v_mfma_f32_16x16x32_bf16 v[100:103], a[64:67], v[60:63], v[100:103]
    v_mfma_f32_16x16x32_bf16 v[104:107], a[144:147], v[60:63], v[104:107]
    v_mfma_f32_16x16x32_bf16 v[108:111], a[224:227], v[60:63], v[108:111]
    s_waitcnt lgkmcnt(4)
    v_mfma_f32_16x16x32_bf16 v[88:91], a[68:71], v[64:67], v[88:91]
    v_mfma_f32_16x16x32_bf16 v[92:95], a[148:151], v[64:67], v[92:95]
    v_mfma_f32_16x16x32_bf16 v[96:99], a[228:231], v[64:67], v[96:99]
    v_mfma_f32_16x16x32_bf16 v[100:103], a[68:71], v[68:71], v[100:103]
    v_mfma_f32_16x16x32_bf16 v[104:107], a[148:151], v[68:71], v[104:107]
    v_mfma_f32_16x16x32_bf16 v[108:111], a[228:231], v[68:71], v[108:111]
    s_waitcnt lgkmcnt(2)
    v_mfma_f32_16x16x32_bf16 v[88:91], a[72:75], v[72:75], v[88:91]
    v_mfma_f32_16x16x32_bf16 v[92:95], a[152:155], v[72:75], v[92:95]
    v_mfma_f32_16x16x32_bf16 v[96:99], a[232:235], v[72:75], v[96:99]
    v_mfma_f32_16x16x32_bf16 v[100:103], a[72:75], v[76:79], v[100:103]
    v_mfma_f32_16x16x32_bf16 v[104:107], a[152:155], v[76:79], v[104:107]
    v_mfma_f32_16x16x32_bf16 v[108:111], a[232:235], v[76:79], v[108:111]
    s_waitcnt lgkmcnt(0)
    v_mfma_f32_16x16x32_bf16 v[88:91], a[76:79], v[80:83], v[88:91]
    v_mfma_f32_16x16x32_bf16 v[92:95], a[156:159], v[80:83], v[92:95]
    v_mfma_f32_16x16x32_bf16 v[96:99], a[236:239], v[80:83], v[96:99]
    v_mfma_f32_16x16x32_bf16 v[100:103], a[76:79], v[84:87], v[100:103]
    v_mfma_f32_16x16x32_bf16 v[104:107], a[156:159], v[84:87], v[104:107]
    v_mfma_f32_16x16x32_bf16 v[108:111], a[236:239], v[84:87], v[108:111]
    s_nop 2
    v_cvt_pk_bf16_f32 v112, v88, v89
    v_cvt_pk_bf16_f32 v113, v90, v91
    v_cvt_pk_bf16_f32 v114, v92, v93
    v_cvt_pk_bf16_f32 v115, v94, v95
    v_cvt_pk_bf16_f32 v116, v100, v101
    v_cvt_pk_bf16_f32 v117, v102, v103
    v_cvt_pk_bf16_f32 v118, v104, v105
    v_cvt_pk_bf16_f32 v119, v106, v107
    v_cvt_pk_bf16_f32 v120, v96, v97
    v_cvt_pk_bf16_f32 v121, v98, v99
    v_cvt_pk_bf16_f32 v122, v108, v109
    v_cvt_pk_bf16_f32 v123, v110, v111
    buffer_store_dwordx4 v[112:115], v11, s[8:11], s43 offen offset:0 sc1
    buffer_store_dwordx4 v[116:119], v11, s[8:11], s43 offen offset:1024 sc1
    buffer_store_dwordx4 v[120:123], v11, s[8:11], s43 offen offset:2048 sc1
    s_waitcnt vmcnt(3)
    ds_write_b128 v10, v[16:19] offset:0
    ds_write_b128 v10, v[20:23] offset:1024
    ds_write_b128 v10, v[24:27] offset:2048
    ds_write_b128 v10, v[28:31] offset:3072
    ds_write_b128 v10, v[32:35] offset:4096
    ds_write_b128 v10, v[36:39] offset:5120
    ds_write_b128 v10, v[40:43] offset:6144
    ds_write_b128 v10, v[44:47] offset:7168
    ds_write_b128 v10, v[48:51] offset:8192
    ds_write_b128 v10, v[52:55] offset:9216
    s_add_u32 s40, s40, 1
    s_add_u32 s43, s43, 393216
    s_waitcnt lgkmcnt(0)
    s_barrier
    s_cmp_lt_u32 s40, 64
    s_cbranch_scc1 chain1_kernel_p_seg
    s_waitcnt vmcnt(0)
    s_barrier
    s_cmp_eq_u32 s3, 0
    s_cbranch_scc0 chain1_kernel_fp10
    v_mov_b32 v15, s40
    buffer_store_dword v15, v14, s[8:11], 0 offen sc1
chain1_kernel_fp10:
    s_branch chain1_kernel_end
chain1_kernel_roleO:
    s_sub_u32 s44, s2, 200
    s_load_dwordx2 s[6:7], s[0:1], 64
    s_waitcnt lgkmcnt(0)
    s_mov_b32 s12, s6
    s_mov_b32 s13, s7
    s_mov_b32 s14, 7864320
    s_mov_b32 s15, 0x00020000
    v_add_u32 v8, 0, v0
    s_mov_b32 s24, 3277
    v_mul_lo_u32 v9, v8, s24
    v_lshrrev_b32 v9, 18, v9
    v_mul_u32_u24 v10, 80, v9
    v_sub_u32 v10, v8, v10
    v_mul_u32_u24 v16, 1312, v9
    v_lshl_add_u32 v16, v10, 4, v16
    v_add_u32 v8, 256, v0
    s_mov_b32 s24, 3277
    v_mul_lo_u32 v9, v8, s24
    v_lshrrev_b32 v9, 18, v9
    v_mul_u32_u24 v10, 80, v9
    v_sub_u32 v10, v8, v10
    v_mul_u32_u24 v17, 1312, v9
    v_lshl_add_u32 v17, v10, 4, v17
    v_add_u32 v8, 512, v0
    s_mov_b32 s24, 3277
    v_mul_lo_u32 v9, v8, s24
    v_lshrrev_b32 v9, 18, v9
    v_mul_u32_u24 v10, 80, v9
    v_sub_u32 v10, v8, v10
    v_mul_u32_u24 v18, 1312, v9
    v_lshl_add_u32 v18, v10, 4, v18
    v_add_u32 v8, 768, v0
    s_mov_b32 s24, 3277
    v_mul_lo_u32 v9, v8, s24
    v_lshrrev_b32 v9, 18, v9
    v_mul_u32_u24 v10, 80, v9
    v_sub_u32 v10, v8, v10
    v_mul_u32_u24 v19, 1312, v9
    v_lshl_add_u32 v19, v10, 4, v19
    v_add_u32 v8, 1024, v0
    s_mov_b32 s24, 3277
    v_mul_lo_u32 v9, v8, s24
    v_lshrrev_b32 v9, 18, v9
    v_mul_u32_u24 v10, 80, v9
    v_sub_u32 v10, v8, v10
    v_mul_u32_u24 v20, 1312, v9
    v_lshl_add_u32 v20, v10, 4, v20
    v_add_u32 v8, 1280, v0
    s_mov_b32 s24, 3277
    v_mul_lo_u32 v9, v8, s24
    v_lshrrev_b32 v9, 18, v9
    v_mul_u32_u24 v10, 80, v9
    v_sub_u32 v10, v8, v10
    v_mul_u32_u24 v21, 1312, v9
    v_lshl_add_u32 v21, v10, 4, v21
    v_add_u32 v8, 1536, v0
    s_mov_b32 s24, 3277
    v_mul_lo_u32 v9, v8, s24
    v_lshrrev_b32 v9, 18, v9
    v_mul_u32_u24 v10, 80, v9
    v_sub_u32 v10, v8, v10
    v_mul_u32_u24 v22, 1312, v9
    v_lshl_add_u32 v22, v10, 4, v22
    v_add_u32 v8, 1792, v0
    s_mov_b32 s24, 3277
    v_mul_lo_u32 v9, v8, s24
    v_lshrrev_b32 v9, 18, v9
    v_mul_u32_u24 v10, 80, v9
    v_sub_u32 v10, v8, v10
    v_mul_u32_u24 v23, 1312, v9
    v_lshl_add_u32 v23, v10, 4, v23
    v_add_u32 v8, 2048, v0
    s_mov_b32 s24, 3277
    v_mul_lo_u32 v9, v8, s24
    v_lshrrev_b32 v9, 18, v9
    v_mul_u32_u24 v10, 80, v9
    v_sub_u32 v10, v8, v10
    v_mul_u32_u24 v24, 1312, v9
    v_lshl_add_u32 v24, v10, 4, v24
    v_add_u32 v8, 2304, v0
    s_mov_b32 s24, 3277
    v_mul_lo_u32 v9, v8, s24
    v_lshrrev_b32 v9, 18, v9
    v_mul_u32_u24 v10, 80, v9
    v_sub_u32 v10, v8, v10
    v_mul_u32_u24 v25, 1312, v9
    v_lshl_add_u32 v25, v10, 4, v25
    v_add_u32 v8, 2560, v0
    s_mov_b32 s24, 3277
    v_mul_lo_u32 v9, v8, s24
    v_lshrrev_b32 v9, 18, v9
    v_mul_u32_u24 v10, 80, v9
    v_sub_u32 v10, v8, v10
    v_mul_u32_u24 v26, 1312, v9
    v_lshl_add_u32 v26, v10, 4, v26
    v_add_u32 v8, 2816, v0
    s_mov_b32 s24, 3277
    v_mul_lo_u32 v9, v8, s24
    v_lshrrev_b32 v9, 18, v9
    v_mul_u32_u24 v10, 80, v9
    v_sub_u32 v10, v8, v10
    v_mul_u32_u24 v27, 1312, v9
    v_lshl_add_u32 v27, v10, 4, v27
    v_add_u32 v8, 3072, v0
    s_mov_b32 s24, 3277
    v_mul_lo_u32 v9, v8, s24
    v_lshrrev_b32 v9, 18, v9
    v_mul_u32_u24 v10, 80, v9
    v_sub_u32 v10, v8, v10
    v_mul_u32_u24 v28, 1312, v9
    v_lshl_add_u32 v28, v10, 4, v28
    v_add_u32 v8, 3328, v0
    s_mov_b32 s24, 3277
    v_mul_lo_u32 v9, v8, s24
    v_lshrrev_b32 v9, 18, v9
    v_mul_u32_u24 v10, 80, v9
    v_sub_u32 v10, v8, v10
    v_mul_u32_u24 v29, 1312, v9
    v_lshl_add_u32 v29, v10, 4, v29
    v_add_u32 v8, 3584, v0
    s_mov_b32 s24, 3277
    v_mul_lo_u32 v9, v8, s24
    v_lshrrev_b32 v9, 18, v9
    v_mul_u32_u24 v10, 80, v9
    v_sub_u32 v10, v8, v10
    v_mul_u32_u24 v30, 1312, v9
    v_lshl_add_u32 v30, v10, 4, v30
    v_add_u32 v8, 3840, v0
    s_mov_b32 s24, 3277
    v_mul_lo_u32 v9, v8, s24
    v_lshrrev_b32 v9, 18, v9
    v_mul_u32_u24 v10, 80, v9
    v_sub_u32 v10, v8, v10
    v_mul_u32_u24 v31, 1312, v9
    v_lshl_add_u32 v31, v10, 4, v31
    v_add_u32 v8, 4096, v0
    s_mov_b32 s24, 3277
    v_mul_lo_u32 v9, v8, s24
    v_lshrrev_b32 v9, 18, v9
    v_mul_u32_u24 v10, 80, v9
    v_sub_u32 v10, v8, v10
    v_mul_u32_u24 v32, 1312, v9
    v_lshl_add_u32 v32, v10, 4, v32
    v_add_u32 v8, 4352, v0
    s_mov_b32 s24, 3277
    v_mul_lo_u32 v9, v8, s24
    v_lshrrev_b32 v9, 18, v9
    v_mul_u32_u24 v10, 80, v9
    v_sub_u32 v10, v8, v10
    v_mul_u32_u24 v33, 1312, v9
    v_lshl_add_u32 v33, v10, 4, v33
    v_add_u32 v8, 4608, v0
    s_mov_b32 s24, 3277
    v_mul_lo_u32 v9, v8, s24
    v_lshrrev_b32 v9, 18, v9
    v_mul_u32_u24 v10, 80, v9
    v_sub_u32 v10, v8, v10
    v_mul_u32_u24 v34, 1312, v9
    v_lshl_add_u32 v34, v10, 4, v34
    v_add_u32 v8, 4864, v0
    s_mov_b32 s24, 3277
    v_mul_lo_u32 v9, v8, s24
    v_lshrrev_b32 v9, 18, v9
    v_mul_u32_u24 v10, 80, v9
    v_sub_u32 v10, v8, v10
    v_mul_u32_u24 v35, 1312, v9
    v_lshl_add_u32 v35, v10, 4, v35
    v_add_u32 v8, 5120, v0
    s_mov_b32 s24, 3277
    v_mul_lo_u32 v9, v8, s24
    v_lshrrev_b32 v9, 18, v9
    v_mul_u32_u24 v10, 80, v9
    v_sub_u32 v10, v8, v10
    v_mul_u32_u24 v36, 1312, v9
    v_lshl_add_u32 v36, v10, 4, v36
    v_add_u32 v8, 5376, v0
    s_mov_b32 s24, 3277
    v_mul_lo_u32 v9, v8, s24
    v_lshrrev_b32 v9, 18, v9
    v_mul_u32_u24 v10, 80, v9
    v_sub_u32 v10, v8, v10
    v_mul_u32_u24 v37, 1312, v9
    v_lshl_add_u32 v37, v10, 4, v37
    v_add_u32 v8, 5632, v0
    s_mov_b32 s24, 3277
    v_mul_lo_u32 v9, v8, s24
    v_lshrrev_b32 v9, 18, v9
    v_mul_u32_u24 v10, 80, v9
    v_sub_u32 v10, v8, v10
    v_mul_u32_u24 v38, 1312, v9
    v_lshl_add_u32 v38, v10, 4, v38
    v_add_u32 v8, 5888, v0
    s_mov_b32 s24, 3277
    v_mul_lo_u32 v9, v8, s24
    v_lshrrev_b32 v9, 18, v9
    v_mul_u32_u24 v10, 80, v9
    v_sub_u32 v10, v8, v10
    v_mul_u32_u24 v39, 1312, v9
    v_lshl_add_u32 v39, v10, 4, v39
    v_add_u32 v8, 6144, v0
    s_mov_b32 s24, 3277
    v_mul_lo_u32 v9, v8, s24
    v_lshrrev_b32 v9, 18, v9
    v_mul_u32_u24 v10, 80, v9
    v_sub_u32 v10, v8, v10
    v_mul_u32_u24 v40, 1312, v9
    v_lshl_add_u32 v40, v10, 4, v40
    v_add_u32 v8, 6400, v0
    s_mov_b32 s24, 3277
    v_mul_lo_u32 v9, v8, s24
    v_lshrrev_b32 v9, 18, v9
    v_mul_u32_u24 v10, 80, v9
    v_sub_u32 v10, v8, v10
    v_mul_u32_u24 v41, 1312, v9
    v_lshl_add_u32 v41, v10, 4, v41
    v_add_u32 v8, 6656, v0
    s_mov_b32 s24, 3277
    v_mul_lo_u32 v9, v8, s24
    v_lshrrev_b32 v9, 18, v9
    v_mul_u32_u24 v10, 80, v9
    v_sub_u32 v10, v8, v10
    v_mul_u32_u24 v42, 1312, v9
    v_lshl_add_u32 v42, v10, 4, v42
    v_add_u32 v8, 6912, v0
    s_mov_b32 s24, 3277
    v_mul_lo_u32 v9, v8, s24
    v_lshrrev_b32 v9, 18, v9
    v_mul_u32_u24 v10, 80, v9
    v_sub_u32 v10, v8, v10
    v_mul_u32_u24 v43, 1312, v9
    v_lshl_add_u32 v43, v10, 4, v43
    v_add_u32 v8, 7168, v0
    s_mov_b32 s24, 3277
    v_mul_lo_u32 v9, v8, s24
    v_lshrrev_b32 v9, 18, v9
    v_mul_u32_u24 v10, 80, v9
    v_sub_u32 v10, v8, v10
    v_mul_u32_u24 v44, 1312, v9
    v_lshl_add_u32 v44, v10, 4, v44
    v_add_u32 v8, 7424, v0
    s_mov_b32 s24, 3277
    v_mul_lo_u32 v9, v8, s24
    v_lshrrev_b32 v9, 18, v9
    v_mul_u32_u24 v10, 80, v9
    v_sub_u32 v10, v8, v10
    v_mul_u32_u24 v45, 1312, v9
    v_lshl_add_u32 v45, v10, 4, v45
    v_lshlrev_b32 v4, 4, v0
    s_mul_i32 s45, s44, 245760
    s_add_u32 s46, s45, 0
    buffer_load_dwordx4 v[48:51], v4, s[12:15], s46 offen
    s_add_u32 s46, s45, 4096
    buffer_load_dwordx4 v[52:55], v4, s[12:15], s46 offen
    s_add_u32 s46, s45, 8192
    buffer_load_dwordx4 v[56:59], v4, s[12:15], s46 offen
    s_add_u32 s46, s45, 12288
    buffer_load_dwordx4 v[60:63], v4, s[12:15], s46 offen
    s_add_u32 s46, s45, 16384
    buffer_load_dwordx4 v[64:67], v4, s[12:15], s46 offen
    s_add_u32 s46, s45, 20480
    buffer_load_dwordx4 v[68:71], v4, s[12:15], s46 offen
    s_add_u32 s46, s45, 24576
    buffer_load_dwordx4 v[72:75], v4, s[12:15], s46 offen
    s_add_u32 s46, s45, 28672
    buffer_load_dwordx4 v[76:79], v4, s[12:15], s46 offen
    s_add_u32 s46, s45, 32768
    buffer_load_dwordx4 v[80:83], v4, s[12:15], s46 offen
    s_add_u32 s46, s45, 36864
    buffer_load_dwordx4 v[84:87], v4, s[12:15], s46 offen
    s_add_u32 s46, s45, 40960
    buffer_load_dwordx4 v[88:91], v4, s[12:15], s46 offen
    s_add_u32 s46, s45, 45056
    buffer_load_dwordx4 v[92:95], v4, s[12:15], s46 offen
    s_add_u32 s46, s45, 49152
    buffer_load_dwordx4 v[96:99], v4, s[12:15], s46 offen
    s_add_u32 s46, s45, 53248
    buffer_load_dwordx4 v[100:103], v4, s[12:15], s46 offen
    s_add_u32 s46, s45, 57344
    buffer_load_dwordx4 v[104:107], v4, s[12:15], s46 offen
    s_add_u32 s46, s45, 61440
    buffer_load_dwordx4 v[108:111], v4, s[12:15], s46 offen
    s_add_u32 s46, s45, 65536
    buffer_load_dwordx4 v[112:115], v4, s[12:15], s46 offen
    s_add_u32 s46, s45, 69632
    buffer_load_dwordx4 v[116:119], v4, s[12:15], s46 offen
    s_add_u32 s46, s45, 73728
    buffer_load_dwordx4 v[120:123], v4, s[12:15], s46 offen
    s_add_u32 s46, s45, 77824
    buffer_load_dwordx4 v[124:127], v4, s[12:15], s46 offen
    s_add_u32 s46, s45, 81920
    buffer_load_dwordx4 v[128:131], v4, s[12:15], s46 offen
    s_add_u32 s46, s45, 86016
    buffer_load_dwordx4 v[132:135], v4, s[12:15], s46 offen
    s_add_u32 s46, s45, 90112
    buffer_load_dwordx4 v[136:139], v4, s[12:15], s46 offen
    s_add_u32 s46, s45, 94208
    buffer_load_dwordx4 v[140:143], v4, s[12:15], s46 offen
    s_add_u32 s46, s45, 98304
    buffer_load_dwordx4 v[144:147], v4, s[12:15], s46 offen
    s_add_u32 s46, s45, 102400
    buffer_load_dwordx4 v[148:151], v4, s[12:15], s46 offen
    s_add_u32 s46, s45, 106496
    buffer_load_dwordx4 v[152:155], v4, s[12:15], s46 offen
    s_add_u32 s46, s45, 110592
    buffer_load_dwordx4 v[156:159], v4, s[12:15], s46 offen
    s_add_u32 s46, s45, 114688
    buffer_load_dwordx4 v[160:163], v4, s[12:15], s46 offen
    s_add_u32 s46, s45, 118784
    buffer_load_dwordx4 v[164:167], v4, s[12:15], s46 offen
    s_add_u32 s46, s45, 122880
    buffer_load_dwordx4 v[168:171], v4, s[12:15], s46 offen
    s_add_u32 s46, s45, 126976
    buffer_load_dwordx4 v[172:175], v4, s[12:15], s46 offen
    s_add_u32 s46, s45, 131072
    buffer_load_dwordx4 v[176:179], v4, s[12:15], s46 offen
    s_add_u32 s46, s45, 135168
    buffer_load_dwordx4 v[180:183], v4, s[12:15], s46 offen
    s_add_u32 s46, s45, 139264
    buffer_load_dwordx4 v[184:187], v4, s[12:15], s46 offen
    s_add_u32 s46, s45, 143360
    buffer_load_dwordx4 v[188:191], v4, s[12:15], s46 offen
    s_add_u32 s46, s45, 147456
    buffer_load_dwordx4 v[192:195], v4, s[12:15], s46 offen
    s_add_u32 s46, s45, 151552
    buffer_load_dwordx4 v[196:199], v4, s[12:15], s46 offen
    s_add_u32 s46, s45, 155648
    buffer_load_dwordx4 v[200:203], v4, s[12:15], s46 offen
    s_add_u32 s46, s45, 159744
    buffer_load_dwordx4 v[204:207], v4, s[12:15], s46 offen
    s_add_u32 s46, s45, 163840
    buffer_load_dwordx4 v[208:211], v4, s[12:15], s46 offen
    s_add_u32 s46, s45, 167936
    buffer_load_dwordx4 v[212:215], v4, s[12:15], s46 offen
    s_add_u32 s46, s45, 172032
    buffer_load_dwordx4 v[216:219], v4, s[12:15], s46 offen
    s_add_u32 s46, s45, 176128
    buffer_load_dwordx4 v[220:223], v4, s[12:15], s46 offen
    s_add_u32 s46, s45, 180224
    buffer_load_dwordx4 v[224:227], v4, s[12:15], s46 offen
    s_add_u32 s46, s45, 184320
    buffer_load_dwordx4 v[228:231], v4, s[12:15], s46 offen
    s_add_u32 s46, s45, 188416
    buffer_load_dwordx4 v[232:235], v4, s[12:15], s46 offen
    s_add_u32 s46, s45, 192512
    buffer_load_dwordx4 v[236:239], v4, s[12:15], s46 offen
    s_add_u32 s46, s45, 196608
    buffer_load_dwordx4 v[240:243], v4, s[12:15], s46 offen
    s_add_u32 s46, s45, 200704
    buffer_load_dwordx4 v[244:247], v4, s[12:15], s46 offen
    s_add_u32 s46, s45, 204800
    buffer_load_dwordx4 v[248:251], v4, s[12:15], s46 offen
    s_add_u32 s46, s45, 208896
    buffer_load_dwordx4 v[252:255], v4, s[12:15], s46 offen
    v_lshrrev_b32 v8, 2, v2
    v_lshl_add_u32 v8, v3, 2, v8
    v_mul_u32_u24 v5, 1312, v8
    v_and_b32 v8, 3, v2
    v_lshl_add_u32 v5, v8, 3, v5
    s_mul_i32 s24, s3, 320
    v_add_u32 v5, s24, v5
    v_add_u32 v6, 62976, v5
    s_waitcnt vmcnt(22)
    ds_write_b128 v16, v[48:51]
    ds_write_b128 v17, v[52:55]
    ds_write_b128 v18, v[56:59]
    ds_write_b128 v19, v[60:63]
    ds_write_b128 v20, v[64:67]
    ds_write_b128 v21, v[68:71]
    ds_write_b128 v22, v[72:75]
    ds_write_b128 v23, v[76:79]
    ds_write_b128 v24, v[80:83]
    ds_write_b128 v25, v[84:87]
    ds_write_b128 v26, v[88:91]
    ds_write_b128 v27, v[92:95]
    ds_write_b128 v28, v[96:99]
    ds_write_b128 v29, v[100:103]
    ds_write_b128 v30, v[104:107]
    ds_write_b128 v31, v[108:111]
    ds_write_b128 v32, v[112:115]
    ds_write_b128 v33, v[116:119]
    ds_write_b128 v34, v[120:123]
    ds_write_b128 v35, v[124:127]
    ds_write_b128 v36, v[128:131]
    ds_write_b128 v37, v[132:135]
    ds_write_b128 v38, v[136:139]
    ds_write_b128 v39, v[140:143]
    ds_write_b128 v40, v[144:147]
    ds_write_b128 v41, v[148:151]
    ds_write_b128 v42, v[152:155]
    ds_write_b128 v43, v[156:159]
    ds_write_b128 v44, v[160:163]
    ds_write_b128 v45, v[164:167]
    s_waitcnt lgkmcnt(0)
    s_add_u32 s46, s45, 212992
    buffer_load_dwordx4 v[48:51], v4, s[12:15], s46 offen
    s_add_u32 s46, s45, 217088
    buffer_load_dwordx4 v[52:55], v4, s[12:15], s46 offen
    s_add_u32 s46, s45, 221184
    buffer_load_dwordx4 v[56:59], v4, s[12:15], s46 offen
    s_add_u32 s46, s45, 225280
    buffer_load_dwordx4 v[60:63], v4, s[12:15], s46 offen
    s_add_u32 s46, s45, 229376
    buffer_load_dwordx4 v[64:67], v4, s[12:15], s46 offen
    s_add_u32 s46, s45, 233472
    buffer_load_dwordx4 v[68:71], v4, s[12:15], s46 offen
    s_add_u32 s46, s45, 237568
    buffer_load_dwordx4 v[72:75], v4, s[12:15], s46 offen
    s_add_u32 s46, s45, 241664
    buffer_load_dwordx4 v[76:79], v4, s[12:15], s46 offen
    s_barrier
    ds_read_b64_tr_b16 a[0:1], v5 offset:0
    ds_read_b64_tr_b16 a[2:3], v5 offset:20992
    ds_read_b64_tr_b16 a[4:5], v6 offset:0
    ds_read_b64_tr_b16 a[6:7], v6 offset:20992
    ds_read_b64_tr_b16 a[16:17], v5 offset:41984
    ds_read_b64_tr_b16 a[18:19], v6 offset:41984
    ds_read_b64_tr_b16 a[24:25], v5 offset:32
    ds_read_b64_tr_b16 a[26:27], v5 offset:21024
    ds_read_b64_tr_b16 a[28:29], v6 offset:32
    ds_read_b64_tr_b16 a[30:31], v6 offset:21024
    ds_read_b64_tr_b16 a[40:41], v5 offset:42016
    ds_read_b64_tr_b16 a[42:43], v6 offset:42016
    ds_read_b64_tr_b16 a[48:49], v5 offset:64
    ds_read_b64_tr_b16 a[50:51], v5 offset:21056
    ds_read_b64_tr_b16 a[52:53], v6 offset:64
    ds_read_b64_tr_b16 a[54:55], v6 offset:21056
    ds_read_b64_tr_b16 a[64:65], v5 offset:42048
    ds_read_b64_tr_b16 a[66:67], v6 offset:42048
    ds_read_b64_tr_b16 a[72:73], v5 offset:96
    ds_read_b64_tr_b16 a[74:75], v5 offset:21088
    ds_read_b64_tr_b16 a[76:77], v6 offset:96
    ds_read_b64_tr_b16 a[78:79], v6 offset:21088
    ds_read_b64_tr_b16 a[88:89], v5 offset:42080
    ds_read_b64_tr_b16 a[90:91], v6 offset:42080
    ds_read_b64_tr_b16 a[96:97], v5 offset:128
    ds_read_b64_tr_b16 a[98:99], v5 offset:21120
    ds_read_b64_tr_b16 a[100:101], v6 offset:128
    ds_read_b64_tr_b16 a[102:103], v6 offset:21120
    ds_read_b64_tr_b16 a[112:113], v5 offset:42112
    ds_read_b64_tr_b16 a[114:115], v6 offset:42112
    ds_read_b64_tr_b16 a[120:121], v5 offset:160
    ds_read_b64_tr_b16 a[122:123], v5 offset:21152
    ds_read_b64_tr_b16 a[124:125], v6 offset:160
    ds_read_b64_tr_b16 a[126:127], v6 offset:21152
    ds_read_b64_tr_b16 a[136:137], v5 offset:42144
    ds_read_b64_tr_b16 a[138:139], v6 offset:42144
    ds_read_b64_tr_b16 a[144:145], v5 offset:192
    ds_read_b64_tr_b16 a[146:147], v5 offset:21184
    ds_read_b64_tr_b16 a[148:149], v6 offset:192
    ds_read_b64_tr_b16 a[150:151], v6 offset:21184
    ds_read_b64_tr_b16 a[160:161], v5 offset:42176
    ds_read_b64_tr_b16 a[162:163], v6 offset:42176
    ds_read_b64_tr_b16 a[168:169], v5 offset:224
    ds_read_b64_tr_b16 a[170:171], v5 offset:21216
    ds_read_b64_tr_b16 a[172:173], v6 offset:224
    ds_read_b64_tr_b16 a[174:175], v6 offset:21216
    ds_read_b64_tr_b16 a[184:185], v5 offset:42208
    ds_read_b64_tr_b16 a[186:187], v6 offset:42208
    ds_read_b64_tr_b16 a[192:193], v5 offset:256
    ds_read_b64_tr_b16 a[194:195], v5 offset:21248
    ds_read_b64_tr_b16 a[196:197], v6 offset:256
    ds_read_b64_tr_b16 a[198:199], v6 offset:21248
    ds_read_b64_tr_b16 a[208:209], v5 offset:42240
    ds_read_b64_tr_b16 a[210:211], v6 offset:42240
    ds_read_b64_tr_b16 a[216:217], v5 offset:288
    ds_read_b64_tr_b16 a[218:219], v5 offset:21280
    ds_read_b64_tr_b16 a[220:221], v6 offset:288
    ds_read_b64_tr_b16 a[222:223], v6 offset:21280
    ds_read_b64_tr_b16 a[232:233], v5 offset:42272
    ds_read_b64_tr_b16 a[234:235], v6 offset:42272
    s_waitcnt lgkmcnt(0)
    s_barrier
    s_waitcnt vmcnt(0)
    ds_write_b128 v16, v[168:171]
    ds_write_b128 v17, v[172:175]
    ds_write_b128 v18, v[176:179]
    ds_write_b128 v19, v[180:183]
    ds_write_b128 v20, v[184:187]
    ds_write_b128 v21, v[188:191]
    ds_write_b128 v22, v[192:195]
    ds_write_b128 v23, v[196:199]
    ds_write_b128 v24, v[200:203]
    ds_write_b128 v25, v[204:207]
    ds_write_b128 v26, v[208:211]
    ds_write_b128 v27, v[212:215]
    ds_write_b128 v28, v[216:219]
    ds_write_b128 v29, v[220:223]
    ds_write_b128 v30, v[224:227]
    ds_write_b128 v31, v[228:231]
    ds_write_b128 v32, v[232:235]
    ds_write_b128 v33, v[236:239]
    ds_write_b128 v34, v[240:243]
    ds_write_b128 v35, v[244:247]
    ds_write_b128 v36, v[248:251]
    ds_write_b128 v37, v[252:255]
    ds_write_b128 v38, v[48:51]
    ds_write_b128 v39, v[52:55]
    ds_write_b128 v40, v[56:59]
    ds_write_b128 v41, v[60:63]
    ds_write_b128 v42, v[64:67]
    ds_write_b128 v43, v[68:71]
    ds_write_b128 v44, v[72:75]
    ds_write_b128 v45, v[76:79]
    s_waitcnt lgkmcnt(0)
    s_barrier
    ds_read_b64_tr_b16 a[8:9], v5 offset:0
    ds_read_b64_tr_b16 a[10:11], v5 offset:20992
    ds_read_b64_tr_b16 a[12:13], v6 offset:0
    ds_read_b64_tr_b16 a[14:15], v6 offset:20992
    ds_read_b64_tr_b16 a[20:21], v5 offset:41984
    ds_read_b64_tr_b16 a[22:23], v6 offset:41984
    ds_read_b64_tr_b16 a[32:33], v5 offset:32
    ds_read_b64_tr_b16 a[34:35], v5 offset:21024
    ds_read_b64_tr_b16 a[36:37], v6 offset:32
    ds_read_b64_tr_b16 a[38:39], v6 offset:21024
    ds_read_b64_tr_b16 a[44:45], v5 offset:42016
    ds_read_b64_tr_b16 a[46:47], v6 offset:42016
    ds_read_b64_tr_b16 a[56:57], v5 offset:64
    ds_read_b64_tr_b16 a[58:59], v5 offset:21056
    ds_read_b64_tr_b16 a[60:61], v6 offset:64
    ds_read_b64_tr_b16 a[62:63], v6 offset:21056
    ds_read_b64_tr_b16 a[68:69], v5 offset:42048
    ds_read_b64_tr_b16 a[70:71], v6 offset:42048
    ds_read_b64_tr_b16 a[80:81], v5 offset:96
    ds_read_b64_tr_b16 a[82:83], v5 offset:21088
    ds_read_b64_tr_b16 a[84:85], v6 offset:96
    ds_read_b64_tr_b16 a[86:87], v6 offset:21088
    ds_read_b64_tr_b16 a[92:93], v5 offset:42080
    ds_read_b64_tr_b16 a[94:95], v6 offset:42080
    ds_read_b64_tr_b16 a[104:105], v5 offset:128
    ds_read_b64_tr_b16 a[106:107], v5 offset:21120
    ds_read_b64_tr_b16 a[108:109], v6 offset:128
    ds_read_b64_tr_b16 a[110:111], v6 offset:21120
    ds_read_b64_tr_b16 a[116:117], v5 offset:42112
    ds_read_b64_tr_b16 a[118:119], v6 offset:42112
    ds_read_b64_tr_b16 a[128:129], v5 offset:160
    ds_read_b64_tr_b16 a[130:131], v5 offset:21152
    ds_read_b64_tr_b16 a[132:133], v6 offset:160
    ds_read_b64_tr_b16 a[134:135], v6 offset:21152
    ds_read_b64_tr_b16 a[140:141], v5 offset:42144
    ds_read_b64_tr_b16 a[142:143], v6 offset:42144
    ds_read_b64_tr_b16 a[152:153], v5 offset:192
    ds_read_b64_tr_b16 a[154:155], v5 offset:21184
    ds_read_b64_tr_b16 a[156:157], v6 offset:192
    ds_read_b64_tr_b16 a[158:159], v6 offset:21184
    ds_read_b64_tr_b16 a[164:165], v5 offset:42176
    ds_read_b64_tr_b16 a[166:167], v6 offset:42176
    ds_read_b64_tr_b16 a[176:177], v5 offset:224
    ds_read_b64_tr_b16 a[178:179], v5 offset:21216
    ds_read_b64_tr_b16 a[180:181], v6 offset:224
    ds_read_b64_tr_b16 a[182:183], v6 offset:21216
    ds_read_b64_tr_b16 a[188:189], v5 offset:42208
    ds_read_b64_tr_b16 a[190:191], v6 offset:42208
    ds_read_b64_tr_b16 a[200:201], v5 offset:256
    ds_read_b64_tr_b16 a[202:203], v5 offset:21248
    ds_read_b64_tr_b16 a[204:205], v6 offset:256
    ds_read_b64_tr_b16 a[206:207], v6 offset:21248
    ds_read_b64_tr_b16 a[212:213], v5 offset:42240
    ds_read_b64_tr_b16 a[214:215], v6 offset:42240
    ds_read_b64_tr_b16 a[224:225], v5 offset:288
    ds_read_b64_tr_b16 a[226:227], v5 offset:21280
    ds_read_b64_tr_b16 a[228:229], v6 offset:288
    ds_read_b64_tr_b16 a[230:231], v6 offset:21280
    ds_read_b64_tr_b16 a[236:237], v5 offset:42272
    ds_read_b64_tr_b16 a[238:239], v6 offset:42272
    s_waitcnt lgkmcnt(0)
    s_barrier
    v_lshlrev_b32 v5, 4, v1
    s_mul_i32 s24, s44, 12288
    v_add_u32 v6, s24, v5
    v_add_u32 v7, 4096, v6
    v_add_u32 v8, 8192, v6
    s_mul_i32 s24, s3, 327680
    s_lshl_b32 s25, s44, 10
    s_add_u32 s24, s24, s25
    v_add_u32 v9, s24, v5
    s_mov_b32 s24, 12288
    s_lshl_b32 s25, s44, 7
    s_add_u32 s24, s24, s25
    s_add_u32 s24, s24, 151560192
    v_mov_b32 v14, s24
    v_mov_b32 v15, 2146435072
    v_cmp_eq_u32 vcc, 0, v1
    s_nop 1
    v_cndmask_b32 v14, v15, v14, vcc
    s_lshl_b32 s24, s44, 7
    s_add_u32 s24, s24, 151568384
    v_mov_b32 v10, s24
    s_mov_b32 s41, 33554432
    s_mov_b32 s43, 184549376
    s_mov_b32 s40, 0
    s_mov_b32 s62, -1
    s_mov_b32 s63, 1
    s_cmp_ge_i32 s62, s63
    s_cbranch_scc1 chain1_kernel_o_en0_ok
    s_mov_b32 s61, 0
chain1_kernel_o_en0:
    buffer_load_dword v11, v10, s[8:11], 0 offen sc1
    s_waitcnt vmcnt(0)
    v_readlane_b32 s62, v11, 0
    s_cmp_ge_i32 s62, s63
    s_cbranch_scc1 chain1_kernel_o_en0_ok
    s_add_u32 s61, s61, 1
    s_cmp_ge_u32 s61, s60
    s_cbranch_scc1 chain1_kernel_o_en0_to
    s_sleep 2
    s_branch chain1_kernel_o_en0
chain1_kernel_o_en0_to:
    s_mov_b32 s60, 1
chain1_kernel_o_en0_ok:
    buffer_load_dwordx4 v[16:19], v6, s[8:11], s41 offen offset:0 sc1
    buffer_load_dwordx4 v[20:23], v6, s[8:11], s41 offen offset:1024 sc1
    buffer_load_dwordx4 v[24:27], v6, s[8:11], s41 offen offset:2048 sc1
    buffer_load_dwordx4 v[28:31], v6, s[8:11], s41 offen offset:3072 sc1
    buffer_load_dwordx4 v[32:35], v7, s[8:11], s41 offen offset:0 sc1
    buffer_load_dwordx4 v[36:39], v7, s[8:11], s41 offen offset:1024 sc1
    buffer_load_dwordx4 v[40:43], v7, s[8:11], s41 offen offset:2048 sc1
    buffer_load_dwordx4 v[44:47], v7, s[8:11], s41 offen offset:3072 sc1
    buffer_load_dwordx4 v[48:51], v8, s[8:11], s41 offen offset:0 sc1
    buffer_load_dwordx4 v[52:55], v8, s[8:11], s41 offen offset:1024 sc1
    buffer_load_dwordx4 v[56:59], v8, s[8:11], s41 offen offset:2048 sc1
    buffer_load_dwordx4 v[60:63], v8, s[8:11], s41 offen offset:3072 sc1
    s_add_u32 s41, s41, 393216
    s_waitcnt vmcnt(0)
chain1_kernel_o_seg:
    v_swap_b32 v26, v36
    v_swap_b32 v27, v37
    v_swap_b32 v50, v60
    v_swap_b32 v51, v61
    v_mfma_f32_16x16x32_bf16 v[112:115], v[16:19], a[0:3], 0
    v_mfma_f32_16x16x32_bf16 v[116:119], v[20:23], a[0:3], 0
    v_mfma_f32_16x16x32_bf16 v[120:123], v[16:19], a[24:27], 0
    v_mfma_f32_16x16x32_bf16 v[124:127], v[20:23], a[24:27], 0
    v_mfma_f32_16x16x32_bf16 v[128:131], v[16:19], a[48:51], 0
    v_mfma_f32_16x16x32_bf16 v[132:135], v[20:23], a[48:51], 0
    v_mfma_f32_16x16x32_bf16 v[136:139], v[16:19], a[72:75], 0
    v_mfma_f32_16x16x32_bf16 v[140:143], v[20:23], a[72:75], 0
    v_mfma_f32_16x16x32_bf16 v[144:147], v[16:19], a[96:99], 0
    v_mfma_f32_16x16x32_bf16 v[148:151], v[20:23], a[96:99], 0
    v_mfma_f32_16x16x32_bf16 v[152:155], v[16:19], a[120:123], 0
    v_mfma_f32_16x16x32_bf16 v[156:159], v[20:23], a[120:123], 0
    v_mfma_f32_16x16x32_bf16 v[160:163], v[16:19], a[144:147], 0
    v_mfma_f32_16x16x32_bf16 v[164:167], v[20:23], a[144:147], 0
    v_mfma_f32_16x16x32_bf16 v[168:171], v[16:19], a[168:171], 0
    v_mfma_f32_16x16x32_bf16 v[172:175], v[20:23], a[168:171], 0
    v_mfma_f32_16x16x32_bf16 v[176:179], v[16:19], a[192:195], 0
    v_mfma_f32_16x16x32_bf16 v[180:183], v[20:23], a[192:195], 0
    v_mfma_f32_16x16x32_bf16 v[184:187], v[16:19], a[216:219], 0
    v_mfma_f32_16x16x32_bf16 v[188:191], v[20:23], a[216:219], 0
    v_mfma_f32_16x16x32_bf16 v[112:115], v[28:31], a[4:7], v[112:115]
    v_mfma_f32_16x16x32_bf16 v[116:119], v[32:35], a[4:7], v[116:119]
    v_mfma_f32_16x16x32_bf16 v[120:123], v[28:31], a[28:31], v[120:123]
    v_mfma_f32_16x16x32_bf16 v[124:127], v[32:35], a[28:31], v[124:127]
    v_mfma_f32_16x16x32_bf16 v[128:131], v[28:31], a[52:55], v[128:131]
    v_mfma_f32_16x16x32_bf16 v[132:135], v[32:35], a[52:55], v[132:135]
    v_mfma_f32_16x16x32_bf16 v[136:139], v[28:31], a[76:79], v[136:139]
    v_mfma_f32_16x16x32_bf16 v[140:143], v[32:35], a[76:79], v[140:143]
    v_mfma_f32_16x16x32_bf16 v[144:147], v[28:31], a[100:103], v[144:147]
    v_mfma_f32_16x16x32_bf16 v[148:151], v[32:35], a[100:103], v[148:151]
    v_mfma_f32_16x16x32_bf16 v[152:155], v[28:31], a[124:127], v[152:155]
    v_mfma_f32_16x16x32_bf16 v[156:159], v[32:35], a[124:127], v[156:159]
    v_mfma_f32_16x16x32_bf16 v[160:163], v[28:31], a[148:151], v[160:163]
    v_mfma_f32_16x16x32_bf16 v[164:167], v[32:35], a[148:151], v[164:167]
    v_mfma_f32_16x16x32_bf16 v[168:171], v[28:31], a[172:175], v[168:171]
    v_mfma_f32_16x16x32_bf16 v[172:175], v[32:35], a[172:175], v[172:175]
    v_mfma_f32_16x16x32_bf16 v[176:179], v[28:31], a[196:199], v[176:179]
    v_mfma_f32_16x16x32_bf16 v[180:183], v[32:35], a[196:199], v[180:183]
    v_mfma_f32_16x16x32_bf16 v[184:187], v[28:31], a[220:223], v[184:187]
    v_mfma_f32_16x16x32_bf16 v[188:191], v[32:35], a[220:223], v[188:191]
    v_mfma_f32_16x16x32_bf16 v[112:115], v[40:43], a[8:11], v[112:115]
    v_mfma_f32_16x16x32_bf16 v[116:119], v[44:47], a[8:11], v[116:119]
    v_mfma_f32_16x16x32_bf16 v[120:123], v[40:43], a[32:35], v[120:123]
    v_mfma_f32_16x16x32_bf16 v[124:127], v[44:47], a[32:35], v[124:127]
    v_mfma_f32_16x16x32_bf16 v[128:131], v[40:43], a[56:59], v[128:131]
    v_mfma_f32_16x16x32_bf16 v[132:135], v[44:47], a[56:59], v[132:135]
    v_mfma_f32_16x16x32_bf16 v[136:139], v[40:43], a[80:83], v[136:139]
    v_mfma_f32_16x16x32_bf16 v[140:143], v[44:47], a[80:83], v[140:143]
    v_mfma_f32_16x16x32_bf16 v[144:147], v[40:43], a[104:107], v[144:147]
    v_mfma_f32_16x16x32_bf16 v[148:151], v[44:47], a[104:107], v[148:151]
    v_mfma_f32_16x16x32_bf16 v[152:155], v[40:43], a[128:131], v[152:155]
    v_mfma_f32_16x16x32_bf16 v[156:159], v[44:47], a[128:131], v[156:159]
    v_mfma_f32_16x16x32_bf16 v[160:163], v[40:43], a[152:155], v[160:163]
    v_mfma_f32_16x16x32_bf16 v[164:167], v[44:47], a[152:155], v[164:167]
    v_mfma_f32_16x16x32_bf16 v[168:171], v[40:43], a[176:179], v[168:171]
    v_mfma_f32_16x16x32_bf16 v[172:175], v[44:47], a[176:179], v[172:175]
    v_mfma_f32_16x16x32_bf16 v[176:179], v[40:43], a[200:203], v[176:179]
    v_mfma_f32_16x16x32_bf16 v[180:183], v[44:47], a[200:203], v[180:183]
    v_mfma_f32_16x16x32_bf16 v[184:187], v[40:43], a[224:227], v[184:187]
    v_mfma_f32_16x16x32_bf16 v[188:191], v[44:47], a[224:227], v[188:191]
    s_waitcnt vmcnt(0)
    s_barrier
    s_cmp_eq_u32 s3, 0
    s_cbranch_scc0 chain1_kernel_fp11
    v_mov_b32 v15, s40
    buffer_store_dword v15, v14, s[8:11], 0 offen sc1
chain1_kernel_fp11:
    s_add_u32 s63, s40, 2
    s_min_u32 s63, s63, 64
    s_cmp_ge_i32 s62, s63
    s_cbranch_scc1 chain1_kernel_o_en1_ok
    s_mov_b32 s61, 0
chain1_kernel_o_en1:
    buffer_load_dword v11, v10, s[8:11], 0 offen sc1
    s_waitcnt vmcnt(0)
    v_readlane_b32 s62, v11, 0
    s_cmp_ge_i32 s62, s63
    s_cbranch_scc1 chain1_kernel_o_en1_ok
    s_add_u32 s61, s61, 1
    s_cmp_ge_u32 s61, s60
    s_cbranch_scc1 chain1_kernel_o_en1_to
    s_sleep 2
    s_branch chain1_kernel_o_en1
chain1_kernel_o_en1_to:
    s_mov_b32 s60, 1
chain1_kernel_o_en1_ok:
    buffer_load_dwordx4 v[64:67], v6, s[8:11], s41 offen offset:0 sc1
    buffer_load_dwordx4 v[68:71], v6, s[8:11], s41 offen offset:1024 sc1
    buffer_load_dwordx4 v[72:75], v6, s[8:11], s41 offen offset:2048 sc1
    buffer_load_dwordx4 v[76:79], v6, s[8:11], s41 offen offset:3072 sc1
    buffer_load_dwordx4 v[80:83], v7, s[8:11], s41 offen offset:0 sc1
    buffer_load_dwordx4 v[84:87], v7, s[8:11], s41 offen offset:1024 sc1
    buffer_load_dwordx4 v[88:91], v7, s[8:11], s41 offen offset:2048 sc1
    buffer_load_dwordx4 v[92:95], v7, s[8:11], s41 offen offset:3072 sc1
    buffer_load_dwordx4 v[96:99], v8, s[8:11], s41 offen offset:0 sc1
    buffer_load_dwordx4 v[100:103], v8, s[8:11], s41 offen offset:1024 sc1
    buffer_load_dwordx4 v[104:107], v8, s[8:11], s41 offen offset:2048 sc1
    buffer_load_dwordx4 v[108:111], v8, s[8:11], s41 offen offset:3072 sc1
    s_add_u32 s41, s41, 393216
    v_mfma_f32_16x16x32_bf16 v[112:115], v[52:55], a[12:15], v[112:115]
    v_mfma_f32_16x16x32_bf16 v[116:119], v[56:59], a[12:15], v[116:119]
    v_mfma_f32_16x16x32_bf16 v[120:123], v[52:55], a[36:39], v[120:123]
    v_mfma_f32_16x16x32_bf16 v[124:127], v[56:59], a[36:39], v[124:127]
    v_mfma_f32_16x16x32_bf16 v[128:131], v[52:55], a[60:63], v[128:131]
    v_mfma_f32_16x16x32_bf16 v[132:135], v[56:59], a[60:63], v[132:135]
    v_mfma_f32_16x16x32_bf16 v[136:139], v[52:55], a[84:87], v[136:139]
    v_mfma_f32_16x16x32_bf16 v[140:143], v[56:59], a[84:87], v[140:143]
    v_mfma_f32_16x16x32_bf16 v[144:147], v[52:55], a[108:111], v[144:147]
    v_mfma_f32_16x16x32_bf16 v[148:151], v[56:59], a[108:111], v[148:151]
    v_mfma_f32_16x16x32_bf16 v[152:155], v[52:55], a[132:135], v[152:155]
    v_mfma_f32_16x16x32_bf16 v[156:159], v[56:59], a[132:135], v[156:159]
    v_mfma_f32_16x16x32_bf16 v[160:163], v[52:55], a[156:159], v[160:163]
    v_mfma_f32_16x16x32_bf16 v[164:167], v[56:59], a[156:159], v[164:167]
    v_mfma_f32_16x16x32_bf16 v[168:171], v[52:55], a[180:183], v[168:171]
    v_mfma_f32_16x16x32_bf16 v[172:175], v[56:59], a[180:183], v[172:175]
    v_mfma_f32_16x16x32_bf16 v[176:179], v[52:55], a[204:207], v[176:179]
    v_mfma_f32_16x16x32_bf16 v[180:183], v[56:59], a[204:207], v[180:183]
    v_mfma_f32_16x16x32_bf16 v[184:187], v[52:55], a[228:231], v[184:187]
    v_mfma_f32_16x16x32_bf16 v[188:191], v[56:59], a[228:231], v[188:191]
    v_mfma_f32_16x16x32_bf16 v[112:115], v[24:27], a[16:19], v[112:115]
    v_mfma_f32_16x16x32_bf16 v[116:119], v[36:39], a[16:19], v[116:119]
    v_mfma_f32_16x16x32_bf16 v[120:123], v[24:27], a[40:43], v[120:123]
    v_mfma_f32_16x16x32_bf16 v[124:127], v[36:39], a[40:43], v[124:127]
    v_mfma_f32_16x16x32_bf16 v[128:131], v[24:27], a[64:67], v[128:131]
    v_mfma_f32_16x16x32_bf16 v[132:135], v[36:39], a[64:67], v[132:135]
    v_mfma_f32_16x16x32_bf16 v[136:139], v[24:27], a[88:91], v[136:139]
    v_mfma_f32_16x16x32_bf16 v[140:143], v[36:39], a[88:91], v[140:143]
    v_mfma_f32_16x16x32_bf16 v[144:147], v[24:27], a[112:115], v[144:147]
    v_mfma_f32_16x16x32_bf16 v[148:151], v[36:39], a[112:115], v[148:151]
    v_mfma_f32_16x16x32_bf16 v[152:155], v[24:27], a[136:139], v[152:155]
    v_mfma_f32_16x16x32_bf16 v[156:159], v[36:39], a[136:139], v[156:159]
    v_mfma_f32_16x16x32_bf16 v[160:163], v[24:27], a[160:163], v[160:163]
    v_mfma_f32_16x16x32_bf16 v[164:167], v[36:39], a[160:163], v[164:167]
    v_mfma_f32_16x16x32_bf16 v[168:171], v[24:27], a[184:187], v[168:171]
    v_mfma_f32_16x16x32_bf16 v[172:175], v[36:39], a[184:187], v[172:175]
    v_mfma_f32_16x16x32_bf16 v[176:179], v[24:27], a[208:211], v[176:179]
    v_mfma_f32_16x16x32_bf16 v[180:183], v[36:39], a[208:211], v[180:183]
    v_mfma_f32_16x16x32_bf16 v[184:187], v[24:27], a[232:235], v[184:187]
    v_mfma_f32_16x16x32_bf16 v[188:191], v[36:39], a[232:235], v[188:191]
    v_mfma_f32_16x16x32_bf16 v[112:115], v[48:51], a[20:23], v[112:115]
    v_mfma_f32_16x16x32_bf16 v[116:119], v[60:63], a[20:23], v[116:119]
    v_mfma_f32_16x16x32_bf16 v[120:123], v[48:51], a[44:47], v[120:123]
    v_mfma_f32_16x16x32_bf16 v[124:127], v[60:63], a[44:47], v[124:127]
    v_mfma_f32_16x16x32_bf16 v[128:131], v[48:51], a[68:71], v[128:131]
    v_mfma_f32_16x16x32_bf16 v[132:135], v[60:63], a[68:71], v[132:135]
    v_mfma_f32_16x16x32_bf16 v[136:139], v[48:51], a[92:95], v[136:139]
    v_mfma_f32_16x16x32_bf16 v[140:143], v[60:63], a[92:95], v[140:143]
    v_mfma_f32_16x16x32_bf16 v[144:147], v[48:51], a[116:119], v[144:147]
    v_mfma_f32_16x16x32_bf16 v[148:151], v[60:63], a[116:119], v[148:151]
    v_mfma_f32_16x16x32_bf16 v[152:155], v[48:51], a[140:143], v[152:155]
    v_mfma_f32_16x16x32_bf16 v[156:159], v[60:63], a[140:143], v[156:159]
    v_mfma_f32_16x16x32_bf16 v[160:163], v[48:51], a[164:167], v[160:163]
    v_mfma_f32_16x16x32_bf16 v[164:167], v[60:63], a[164:167], v[164:167]
    v_mfma_f32_16x16x32_bf16 v[168:171], v[48:51], a[188:191], v[168:171]
    v_mfma_f32_16x16x32_bf16 v[172:175], v[60:63], a[188:191], v[172:175]
    v_mfma_f32_16x16x32_bf16 v[176:179], v[48:51], a[212:215], v[176:179]
    v_mfma_f32_16x16x32_bf16 v[180:183], v[60:63], a[212:215], v[180:183]
    v_mfma_f32_16x16x32_bf16 v[184:187], v[48:51], a[236:239], v[184:187]
    v_mfma_f32_16x16x32_bf16 v[188:191], v[60:63], a[236:239], v[188:191]
    s_mov_b32 s46, s43
    v_cvt_pk_bf16_f32 v192, v112, v113
    v_cvt_pk_bf16_f32 v193, v114, v115
    v_cvt_pk_bf16_f32 v194, v116, v117
    v_cvt_pk_bf16_f32 v195, v118, v119
    buffer_store_dwordx4 v[192:195], v9, s[8:11], s46 offen sc1
    s_add_u32 s46, s46, 32768
    v_cvt_pk_bf16_f32 v196, v120, v121
    v_cvt_pk_bf16_f32 v197, v122, v123
    v_cvt_pk_bf16_f32 v198, v124, v125
    v_cvt_pk_bf16_f32 v199, v126, v127
    buffer_store_dwordx4 v[196:199], v9, s[8:11], s46 offen sc1
    s_add_u32 s46, s46, 32768
    v_cvt_pk_bf16_f32 v200, v128, v129
    v_cvt_pk_bf16_f32 v201, v130, v131
    v_cvt_pk_bf16_f32 v202, v132, v133
    v_cvt_pk_bf16_f32 v203, v134, v135
    buffer_store_dwordx4 v[200:203], v9, s[8:11], s46 offen sc1
    s_add_u32 s46, s46, 32768
    v_cvt_pk_bf16_f32 v204, v136, v137
    v_cvt_pk_bf16_f32 v205, v138, v139
    v_cvt_pk_bf16_f32 v206, v140, v141
    v_cvt_pk_bf16_f32 v207, v142, v143
    buffer_store_dwordx4 v[204:207], v9, s[8:11], s46 offen sc1
    s_add_u32 s46, s46, 32768
    v_cvt_pk_bf16_f32 v208, v144, v145
    v_cvt_pk_bf16_f32 v209, v146, v147
    v_cvt_pk_bf16_f32 v210, v148, v149
    v_cvt_pk_bf16_f32 v211, v150, v151
    buffer_store_dwordx4 v[208:211], v9, s[8:11], s46 offen sc1
    s_add_u32 s46, s46, 32768
    v_cvt_pk_bf16_f32 v212, v152, v153
    v_cvt_pk_bf16_f32 v213, v154, v155
    v_cvt_pk_bf16_f32 v214, v156, v157
    v_cvt_pk_bf16_f32 v215, v158, v159
    buffer_store_dwordx4 v[212:215], v9, s[8:11], s46 offen sc1
    s_add_u32 s46, s46, 32768
    v_cvt_pk_bf16_f32 v216, v160, v161
    v_cvt_pk_bf16_f32 v217, v162, v163
    v_cvt_pk_bf16_f32 v218, v164, v165
    v_cvt_pk_bf16_f32 v219, v166, v167
    buffer_store_dwordx4 v[216:219], v9, s[8:11], s46 offen sc1
    s_add_u32 s46, s46, 32768
    v_cvt_pk_bf16_f32 v220, v168, v169
    v_cvt_pk_bf16_f32 v221, v170, v171
    v_cvt_pk_bf16_f32 v222, v172, v173
    v_cvt_pk_bf16_f32 v223, v174, v175
    buffer_store_dwordx4 v[220:223], v9, s[8:11], s46 offen sc1
    s_add_u32 s46, s46, 32768
    v_cvt_pk_bf16_f32 v224, v176, v177
    v_cvt_pk_bf16_f32 v225, v178, v179
    v_cvt_pk_bf16_f32 v226, v180, v181
    v_cvt_pk_bf16_f32 v227, v182, v183
    buffer_store_dwordx4 v[224:227], v9, s[8:11], s46 offen sc1
    s_add_u32 s46, s46, 32768
    v_cvt_pk_bf16_f32 v228, v184, v185
    v_cvt_pk_bf16_f32 v229, v186, v187
    v_cvt_pk_bf16_f32 v230, v188, v189
    v_cvt_pk_bf16_f32 v231, v190, v191
    buffer_store_dwordx4 v[228:231], v9, s[8:11], s46 offen sc1
    s_waitcnt vmcnt(10)
    s_add_u32 s40, s40, 1
    s_add_u32 s43, s43, 1310720
    v_swap_b32 v74, v84
    v_swap_b32 v75, v85
    v_swap_b32 v98, v108
    v_swap_b32 v99, v109
    v_mfma_f32_16x16x32_bf16 v[112:115], v[64:67], a[0:3], 0
    v_mfma_f32_16x16x32_bf16 v[116:119], v[68:71], a[0:3], 0
    v_mfma_f32_16x16x32_bf16 v[120:123], v[64:67], a[24:27], 0
    v_mfma_f32_16x16x32_bf16 v[124:127], v[68:71], a[24:27], 0
    v_mfma_f32_16x16x32_bf16 v[128:131], v[64:67], a[48:51], 0
    v_mfma_f32_16x16x32_bf16 v[132:135], v[68:71], a[48:51], 0
    v_mfma_f32_16x16x32_bf16 v[136:139], v[64:67], a[72:75], 0
    v_mfma_f32_16x16x32_bf16 v[140:143], v[68:71], a[72:75], 0
    v_mfma_f32_16x16x32_bf16 v[144:147], v[64:67], a[96:99], 0
    v_mfma_f32_16x16x32_bf16 v[148:151], v[68:71], a[96:99], 0
    v_mfma_f32_16x16x32_bf16 v[152:155], v[64:67], a[120:123], 0
    v_mfma_f32_16x16x32_bf16 v[156:159], v[68:71], a[120:123], 0
    v_mfma_f32_16x16x32_bf16 v[160:163], v[64:67], a[144:147], 0
    v_mfma_f32_16x16x32_bf16 v[164:167], v[68:71], a[144:147], 0
    v_mfma_f32_16x16x32_bf16 v[168:171], v[64:67], a[168:171], 0
    v_mfma_f32_16x16x32_bf16 v[172:175], v[68:71], a[168:171], 0
    v_mfma_f32_16x16x32_bf16 v[176:179], v[64:67], a[192:195], 0
    v_mfma_f32_16x16x32_bf16 v[180:183], v[68:71], a[192:195], 0
    v_mfma_f32_16x16x32_bf16 v[184:187], v[64:67], a[216:219], 0
    v_mfma_f32_16x16x32_bf16 v[188:191], v[68:71], a[216:219], 0
    v_mfma_f32_16x16x32_bf16 v[112:115], v[76:79], a[4:7], v[112:115]
    v_mfma_f32_16x16x32_bf16 v[116:119], v[80:83], a[4:7], v[116:119]
    v_mfma_f32_16x16x32_bf16 v[120:123], v[76:79], a[28:31], v[120:123]
    v_mfma_f32_16x16x32_bf16 v[124:127], v[80:83], a[28:31], v[124:127]
    v_mfma_f32_16x16x32_bf16 v[128:131], v[76:79], a[52:55], v[128:131]
    v_mfma_f32_16x16x32_bf16 v[132:135], v[80:83], a[52:55], v[132:135]
    v_mfma_f32_16x16x32_bf16 v[136:139], v[76:79], a[76:79], v[136:139]
    v_mfma_f32_16x16x32_bf16 v[140:143], v[80:83], a[76:79], v[140:143]
    v_mfma_f32_16x16x32_bf16 v[144:147], v[76:79], a[100:103], v[144:147]
    v_mfma_f32_16x16x32_bf16 v[148:151], v[80:83], a[100:103], v[148:151]
    v_mfma_f32_16x16x32_bf16 v[152:155], v[76:79], a[124:127], v[152:155]
    v_mfma_f32_16x16x32_bf16 v[156:159], v[80:83], a[124:127], v[156:159]
    v_mfma_f32_16x16x32_bf16 v[160:163], v[76:79], a[148:151], v[160:163]
    v_mfma_f32_16x16x32_bf16 v[164:167], v[80:83], a[148:151], v[164:167]
    v_mfma_f32_16x16x32_bf16 v[168:171], v[76:79], a[172:175], v[168:171]
    v_mfma_f32_16x16x32_bf16 v[172:175], v[80:83], a[172:175], v[172:175]
    v_mfma_f32_16x16x32_bf16 v[176:179], v[76:79], a[196:199], v[176:179]
    v_mfma_f32_16x16x32_bf16 v[180:183], v[80:83], a[196:199], v[180:183]
    v_mfma_f32_16x16x32_bf16 v[184:187], v[76:79], a[220:223], v[184:187]
    v_mfma_f32_16x16x32_bf16 v[188:191], v[80:83], a[220:223], v[188:191]
    v_mfma_f32_16x16x32_bf16 v[112:115], v[88:91], a[8:11], v[112:115]
    v_mfma_f32_16x16x32_bf16 v[116:119], v[92:95], a[8:11], v[116:119]
    v_mfma_f32_16x16x32_bf16 v[120:123], v[88:91], a[32:35], v[120:123]
    v_mfma_f32_16x16x32_bf16 v[124:127], v[92:95], a[32:35], v[124:127]
    v_mfma_f32_16x16x32_bf16 v[128:131], v[88:91], a[56:59], v[128:131]
    v_mfma_f32_16x16x32_bf16 v[132:135], v[92:95], a[56:59], v[132:135]
    v_mfma_f32_16x16x32_bf16 v[136:139], v[88:91], a[80:83], v[136:139]
    v_mfma_f32_16x16x32_bf16 v[140:143], v[92:95], a[80:83], v[140:143]
    v_mfma_f32_16x16x32_bf16 v[144:147], v[88:91], a[104:107], v[144:147]
    v_mfma_f32_16x16x32_bf16 v[148:151], v[92:95], a[104:107], v[148:151]
    v_mfma_f32_16x16x32_bf16 v[152:155], v[88:91], a[128:131], v[152:155]
    v_mfma_f32_16x16x32_bf16 v[156:159], v[92:95], a[128:131], v[156:159]
    v_mfma_f32_16x16x32_bf16 v[160:163], v[88:91], a[152:155], v[160:163]
    v_mfma_f32_16x16x32_bf16 v[164:167], v[92:95], a[152:155], v[164:167]
    v_mfma_f32_16x16x32_bf16 v[168:171], v[88:91], a[176:179], v[168:171]
    v_mfma_f32_16x16x32_bf16 v[172:175], v[92:95], a[176:179], v[172:175]
    v_mfma_f32_16x16x32_bf16 v[176:179], v[88:91], a[200:203], v[176:179]
    v_mfma_f32_16x16x32_bf16 v[180:183], v[92:95], a[200:203], v[180:183]
    v_mfma_f32_16x16x32_bf16 v[184:187], v[88:91], a[224:227], v[184:187]
    v_mfma_f32_16x16x32_bf16 v[188:191], v[92:95], a[224:227], v[188:191]
    s_waitcnt vmcnt(0)
    s_barrier
    s_cmp_eq_u32 s3, 0
    s_cbranch_scc0 chain1_kernel_fp12
    v_mov_b32 v15, s40
    buffer_store_dword v15, v14, s[8:11], 0 offen sc1
chain1_kernel_fp12:
    s_add_u32 s63, s40, 2
    s_min_u32 s63, s63, 64
    s_cmp_ge_i32 s62, s63
    s_cbranch_scc1 chain1_kernel_o_en2_ok
    s_mov_b32 s61, 0
chain1_kernel_o_en2:
    buffer_load_dword v11, v10, s[8:11], 0 offen sc1
    s_waitcnt vmcnt(0)
    v_readlane_b32 s62, v11, 0
    s_cmp_ge_i32 s62, s63
    s_cbranch_scc1 chain1_kernel_o_en2_ok
    s_add_u32 s61, s61, 1
    s_cmp_ge_u32 s61, s60
    s_cbranch_scc1 chain1_kernel_o_en2_to
    s_sleep 2
    s_branch chain1_kernel_o_en2
chain1_kernel_o_en2_to:
    s_mov_b32 s60, 1
chain1_kernel_o_en2_ok:
    buffer_load_dwordx4 v[16:19], v6, s[8:11], s41 offen offset:0 sc1
    buffer_load_dwordx4 v[20:23], v6, s[8:11], s41 offen offset:1024 sc1
    buffer_load_dwordx4 v[24:27], v6, s[8:11], s41 offen offset:2048 sc1
    buffer_load_dwordx4 v[28:31], v6, s[8:11], s41 offen offset:3072 sc1
    buffer_load_dwordx4 v[32:35], v7, s[8:11], s41 offen offset:0 sc1
    buffer_load_dwordx4 v[36:39], v7, s[8:11], s41 offen offset:1024 sc1
    buffer_load_dwordx4 v[40:43], v7, s[8:11], s41 offen offset:2048 sc1
    buffer_load_dwordx4 v[44:47], v7, s[8:11], s41 offen offset:3072 sc1
    buffer_load_dwordx4 v[48:51], v8, s[8:11], s41 offen offset:0 sc1
    buffer_load_dwordx4 v[52:55], v8, s[8:11], s41 offen offset:1024 sc1
    buffer_load_dwordx4 v[56:59], v8, s[8:11], s41 offen offset:2048 sc1
    buffer_load_dwordx4 v[60:63], v8, s[8:11], s41 offen offset:3072 sc1
    s_add_u32 s41, s41, 393216
    v_mfma_f32_16x16x32_bf16 v[112:115], v[100:103], a[12:15], v[112:115]
    v_mfma_f32_16x16x32_bf16 v[116:119], v[104:107], a[12:15], v[116:119]
    v_mfma_f32_16x16x32_bf16 v[120:123], v[100:103], a[36:39], v[120:123]
    v_mfma_f32_16x16x32_bf16 v[124:127], v[104:107], a[36:39], v[124:127]
    v_mfma_f32_16x16x32_bf16 v[128:131], v[100:103], a[60:63], v[128:131]
    v_mfma_f32_16x16x32_bf16 v[132:135], v[104:107], a[60:63], v[132:135]
    v_mfma_f32_16x16x32_bf16 v[136:139], v[100:103], a[84:87], v[136:139]
    v_mfma_f32_16x16x32_bf16 v[140:143], v[104:107], a[84:87], v[140:143]
    v_mfma_f32_16x16x32_bf16 v[144:147], v[100:103], a[108:111], v[144:147]
    v_mfma_f32_16x16x32_bf16 v[148:151], v[104:107], a[108:111], v[148:151]
    v_mfma_f32_16x16x32_bf16 v[152:155], v[100:103], a[132:135], v[152:155]
    v_mfma_f32_16x16x32_bf16 v[156:159], v[104:107], a[132:135], v[156:159]
    v_mfma_f32_16x16x32_bf16 v[160:163], v[100:103], a[156:159], v[160:163]
    v_mfma_f32_16x16x32_bf16 v[164:167], v[104:107], a[156:159], v[164:167]
    v_mfma_f32_16x16x32_bf16 v[168:171], v[100:103], a[180:183], v[168:171]
    v_mfma_f32_16x16x32_bf16 v[172:175], v[104:107], a[180:183], v[172:175]
    v_mfma_f32_16x16x32_bf16 v[176:179], v[100:103], a[204:207], v[176:179]
    v_mfma_f32_16x16x32_bf16 v[180:183], v[104:107], a[204:207], v[180:183]
    v_mfma_f32_16x16x32_bf16 v[184:187], v[100:103], a[228:231], v[184:187]
    v_mfma_f32_16x16x32_bf16 v[188:191], v[104:107], a[228:231], v[188:191]
    v_mfma_f32_16x16x32_bf16 v[112:115], v[72:75], a[16:19], v[112:115]
    v_mfma_f32_16x16x32_bf16 v[116:119], v[84:87], a[16:19], v[116:119]
    v_mfma_f32_16x16x32_bf16 v[120:123], v[72:75], a[40:43], v[120:123]
    v_mfma_f32_16x16x32_bf16 v[124:127], v[84:87], a[40:43], v[124:127]
    v_mfma_f32_16x16x32_bf16 v[128:131], v[72:75], a[64:67], v[128:131]
    v_mfma_f32_16x16x32_bf16 v[132:135], v[84:87], a[64:67], v[132:135]
    v_mfma_f32_16x16x32_bf16 v[136:139], v[72:75], a[88:91], v[136:139]
    v_mfma_f32_16x16x32_bf16 v[140:143], v[84:87], a[88:91], v[140:143]
    v_mfma_f32_16x16x32_bf16 v[144:147], v[72:75], a[112:115], v[144:147]
    v_mfma_f32_16x16x32_bf16 v[148:151], v[84:87], a[112:115], v[148:151]
    v_mfma_f32_16x16x32_bf16 v[152:155], v[72:75], a[136:139], v[152:155]
    v_mfma_f32_16x16x32_bf16 v[156:159], v[84:87], a[136:139], v[156:159]
    v_mfma_f32_16x16x32_bf16 v[160:163], v[72:75], a[160:163], v[160:163]
    v_mfma_f32_16x16x32_bf16 v[164:167], v[84:87], a[160:163], v[164:167]
    v_mfma_f32_16x16x32_bf16 v[168:171], v[72:75], a[184:187], v[168:171]
    v_mfma_f32_16x16x32_bf16 v[172:175], v[84:87], a[184:187], v[172:175]
    v_mfma_f32_16x16x32_bf16 v[176:179], v[72:75], a[208:211], v[176:179]
    v_mfma_f32_16x16x32_bf16 v[180:183], v[84:87], a[208:211], v[180:183]
    v_mfma_f32_16x16x32_bf16 v[184:187], v[72:75], a[232:235], v[184:187]
    v_mfma_f32_16x16x32_bf16 v[188:191], v[84:87], a[232:235], v[188:191]
    v_mfma_f32_16x16x32_bf16 v[112:115], v[96:99], a[20:23], v[112:115]
    v_mfma_f32_16x16x32_bf16 v[116:119], v[108:111], a[20:23], v[116:119]
    v_mfma_f32_16x16x32_bf16 v[120:123], v[96:99], a[44:47], v[120:123]
    v_mfma_f32_16x16x32_bf16 v[124:127], v[108:111], a[44:47], v[124:127]
    v_mfma_f32_16x16x32_bf16 v[128:131], v[96:99], a[68:71], v[128:131]
    v_mfma_f32_16x16x32_bf16 v[132:135], v[108:111], a[68:71], v[132:135]
    v_mfma_f32_16x16x32_bf16 v[136:139], v[96:99], a[92:95], v[136:139]
    v_mfma_f32_16x16x32_bf16 v[140:143], v[108:111], a[92:95], v[140:143]
    v_mfma_f32_16x16x32_bf16 v[144:147], v[96:99], a[116:119], v[144:147]
    v_mfma_f32_16x16x32_bf16 v[148:151], v[108:111], a[116:119], v[148:151]
    v_mfma_f32_16x16x32_bf16 v[152:155], v[96:99], a[140:143], v[152:155]
    v_mfma_f32_16x16x32_bf16 v[156:159], v[108:111], a[140:143], v[156:159]
    v_mfma_f32_16x16x32_bf16 v[160:163], v[96:99], a[164:167], v[160:163]
    v_mfma_f32_16x16x32_bf16 v[164:167], v[108:111], a[164:167], v[164:167]
    v_mfma_f32_16x16x32_bf16 v[168:171], v[96:99], a[188:191], v[168:171]
    v_mfma_f32_16x16x32_bf16 v[172:175], v[108:111], a[188:191], v[172:175]
    v_mfma_f32_16x16x32_bf16 v[176:179], v[96:99], a[212:215], v[176:179]
    v_mfma_f32_16x16x32_bf16 v[180:183], v[108:111], a[212:215], v[180:183]
    v_mfma_f32_16x16x32_bf16 v[184:187], v[96:99], a[236:239], v[184:187]
    v_mfma_f32_16x16x32_bf16 v[188:191], v[108:111], a[236:239], v[188:191]
    s_mov_b32 s46, s43
    v_cvt_pk_bf16_f32 v192, v112, v113
    v_cvt_pk_bf16_f32 v193, v114, v115
    v_cvt_pk_bf16_f32 v194, v116, v117
    v_cvt_pk_bf16_f32 v195, v118, v119
    buffer_store_dwordx4 v[192:195], v9, s[8:11], s46 offen sc1
    s_add_u32 s46, s46, 32768
    v_cvt_pk_bf16_f32 v196, v120, v121
    v_cvt_pk_bf16_f32 v197, v122, v123
    v_cvt_pk_bf16_f32 v198, v124, v125
    v_cvt_pk_bf16_f32 v199, v126, v127
    buffer_store_dwordx4 v[196:199], v9, s[8:11], s46 offen sc1
    s_add_u32 s46, s46, 32768
    v_cvt_pk_bf16_f32 v200, v128, v129
    v_cvt_pk_bf16_f32 v201, v130, v131
    v_cvt_pk_bf16_f32 v202, v132, v133
    v_cvt_pk_bf16_f32 v203, v134, v135
    buffer_store_dwordx4 v[200:203], v9, s[8:11], s46 offen sc1
    s_add_u32 s46, s46, 32768
    v_cvt_pk_bf16_f32 v204, v136, v137
    v_cvt_pk_bf16_f32 v205, v138, v139
    v_cvt_pk_bf16_f32 v206, v140, v141
    v_cvt_pk_bf16_f32 v207, v142, v143
    buffer_store_dwordx4 v[204:207], v9, s[8:11], s46 offen sc1
    s_add_u32 s46, s46, 32768
    v_cvt_pk_bf16_f32 v208, v144, v145
    v_cvt_pk_bf16_f32 v209, v146, v147
    v_cvt_pk_bf16_f32 v210, v148, v149
    v_cvt_pk_bf16_f32 v211, v150, v151
    buffer_store_dwordx4 v[208:211], v9, s[8:11], s46 offen sc1
    s_add_u32 s46, s46, 32768
    v_cvt_pk_bf16_f32 v212, v152, v153
    v_cvt_pk_bf16_f32 v213, v154, v155
    v_cvt_pk_bf16_f32 v214, v156, v157
    v_cvt_pk_bf16_f32 v215, v158, v159
    buffer_store_dwordx4 v[212:215], v9, s[8:11], s46 offen sc1
    s_add_u32 s46, s46, 32768
    v_cvt_pk_bf16_f32 v216, v160, v161
    v_cvt_pk_bf16_f32 v217, v162, v163
    v_cvt_pk_bf16_f32 v218, v164, v165
    v_cvt_pk_bf16_f32 v219, v166, v167
    buffer_store_dwordx4 v[216:219], v9, s[8:11], s46 offen sc1
    s_add_u32 s46, s46, 32768
    v_cvt_pk_bf16_f32 v220, v168, v169
    v_cvt_pk_bf16_f32 v221, v170, v171
    v_cvt_pk_bf16_f32 v222, v172, v173
    v_cvt_pk_bf16_f32 v223, v174, v175
    buffer_store_dwordx4 v[220:223], v9, s[8:11], s46 offen sc1
    s_add_u32 s46, s46, 32768
    v_cvt_pk_bf16_f32 v224, v176, v177
    v_cvt_pk_bf16_f32 v225, v178, v179
    v_cvt_pk_bf16_f32 v226, v180, v181
    v_cvt_pk_bf16_f32 v227, v182, v183
    buffer_store_dwordx4 v[224:227], v9, s[8:11], s46 offen sc1
    s_add_u32 s46, s46, 32768
    v_cvt_pk_bf16_f32 v228, v184, v185
    v_cvt_pk_bf16_f32 v229, v186, v187
    v_cvt_pk_bf16_f32 v230, v188, v189
    v_cvt_pk_bf16_f32 v231, v190, v191
    buffer_store_dwordx4 v[228:231], v9, s[8:11], s46 offen sc1
    s_waitcnt vmcnt(10)
    s_add_u32 s40, s40, 1
    s_add_u32 s43, s43, 1310720
    s_cmp_lt_u32 s40, 64
    s_cbranch_scc1 chain1_kernel_o_seg
    s_waitcnt vmcnt(0)
    s_barrier
    s_cmp_eq_u32 s3, 0
    s_cbranch_scc0 chain1_kernel_fp13
    v_mov_b32 v15, s40
    buffer_store_dword v15, v14, s[8:11], 0 offen sc1
chain1_kernel_fp13:
    s_branch chain1_kernel_end
chain1_kernel_end:
    s_endpgm
.section .rodata,"a"
.p2align 6
.amdhsa_kernel chain1_kernel
  .amdhsa_next_free_vgpr 512
  .amdhsa_next_free_sgpr 100
  .amdhsa_accum_offset 256
  .amdhsa_group_segment_fixed_size 0
  .amdhsa_kernarg_size 104
  .amdhsa_user_sgpr_count 2
  .amdhsa_user_sgpr_kernarg_segment_ptr 1
  .amdhsa_system_sgpr_workgroup_id_x 1
.end_amdhsa_kernel
.text
.globl ln_a2_kernel
.p2align 8
.type ln_a2_kernel,@function
ln_a2_kernel:
    v_lshrrev_b32 v1, 6, v0
    v_and_b32 v2, 63, v0
    s_nop 0
    v_readfirstlane_b32 s3, v1
    s_lshl_b32 s4, s2, 2
    s_add_u32 s4, s4, s3
    s_cmp_ge_u32 s4, 2048
    s_cbranch_scc1 ln_a2_kernel_end
    s_load_dwordx2 s[6:7], s[0:1], 96
    s_load_dwordx2 s[12:13], s[0:1], 96
    s_waitcnt lgkmcnt(0)
    s_add_u32 s8, s6, 4194304
    s_addc_u32 s9, s7, 0
    s_mov_b32 s10, 2621440
    s_mov_b32 s11, 0x00020000
    s_mov_b32 s16, s12
    s_mov_b32 s17, s13
    s_mov_b32 s18, 2621440
    s_mov_b32 s19, 0x00020000
    s_mul_i32 s5, s4, 1280
    v_lshlrev_b32 v3, 2, v2
    v_add_u32 v3, s5, v3
    buffer_load_dword v4, v3, s[8:11], 0 offen offset:0
    buffer_load_dword v5, v3, s[8:11], 0 offen offset:256
    buffer_load_dword v6, v3, s[8:11], 0 offen offset:512
    buffer_load_dword v7, v3, s[8:11], 0 offen offset:768
    buffer_load_dword v8, v3, s[8:11], 0 offen offset:1024
    s_waitcnt vmcnt(0)
    v_lshlrev_b32 v10, 16, v4
    v_and_b32 v11, 0xffff0000, v4
    v_lshlrev_b32 v12, 16, v5
    v_and_b32 v13, 0xffff0000, v5
    v_lshlrev_b32 v14, 16, v6
    v_and_b32 v15, 0xffff0000, v6
    v_lshlrev_b32 v16, 16, v7
    v_and_b32 v17, 0xffff0000, v7
    v_lshlrev_b32 v18, 16, v8
    v_and_b32 v19, 0xffff0000, v8
    v_add_f32 v20, v10, v11
    v_add_f32 v20, v20, v12
    v_add_f32 v20, v20, v13
    v_add_f32 v20, v20, v14
    v_add_f32 v20, v20, v15
    v_add_f32 v20, v20, v16
    v_add_f32 v20, v20, v17
    v_add_f32 v20, v20, v18
    v_add_f32 v20, v20, v19
    s_nop 1
    v_add_f32 v21, v20, v20 quad_perm:[1,0,3,2] row_mask:0xf bank_mask:0xf
    s_nop 1
    v_add_f32 v21, v21, v21 quad_perm:[2,3,0,1] row_mask:0xf bank_mask:0xf
    s_nop 1
    v_add_f32 v21, v21, v21 row_half_mirror row_mask:0xf bank_mask:0xf
    s_nop 1
    v_add_f32 v21, v21, v21 row_mirror row_mask:0xf bank_mask:0xf
    s_nop 1
    v_readlane_b32 s24, v21, 0
    v_readlane_b32 s25, v21, 16
    v_readlane_b32 s26, v21, 32
    v_readlane_b32 s27, v21, 48
    s_nop 1
    v_mov_b32 v20, s24
    v_add_f32 v20, s25, v20
    v_add_f32 v20, s26, v20
    v_add_f32 v20, s27, v20
    v_mul_f32 v20, 0.0015625, v20
    v_sub_f32 v10, v10, v20
    v_sub_f32 v11, v11, v20
    v_sub_f32 v12, v12, v20
    v_sub_f32 v13, v13, v20
    v_sub_f32 v14, v14, v20
    v_sub_f32 v15, v15, v20
    v_sub_f32 v16, v16, v20
    v_sub_f32 v17, v17, v20
    v_sub_f32 v18, v18, v20
    v_sub_f32 v19, v19, v20
    v_mul_f32 v21, v10, v10
    v_fmac_f32 v21, v11, v11
    v_fmac_f32 v21, v12, v12
    v_fmac_f32 v21, v13, v13
    v_fmac_f32 v21, v14, v14
    v_fmac_f32 v21, v15, v15
    v_fmac_f32 v21, v16, v16
    v_fmac_f32 v21, v17, v17
    v_fmac_f32 v21, v18, v18
    v_fmac_f32 v21, v19, v19
    s_nop 1
    v_add_f32 v22, v21, v21 quad_perm:[1,0,3,2] row_mask:0xf bank_mask:0xf
    s_nop 1
    v_add_f32 v22, v22, v22 quad_perm:[2,3,0,1] row_mask:0xf bank_mask:0xf
    s_nop 1
    v_add_f32 v22, v22, v22 row_half_mirror row_mask:0xf bank_mask:0xf
    s_nop 1
    v_add_f32 v22, v22, v22 row_mirror row_mask:0xf bank_mask:0xf
    s_nop 1
    v_readlane_b32 s24, v22, 0
    v_readlane_b32 s25, v22, 16
    v_readlane_b32 s26, v22, 32
    v_readlane_b32 s27, v22, 48
    s_nop 1
    v_mov_b32 v21, s24
    v_add_f32 v21, s25, v21
    v_add_f32 v21, s26, v21
    v_add_f32 v21, s27, v21
    v_mov_b32 v22, 0x3727c5ac
    v_fmac_f32 v22, 0.0015625, v21
    v_rsq_f32 v22, v22
    s_nop 0
    v_mul_f32 v10, v10, v22
    v_mul_f32 v11, v11, v22
    v_mul_f32 v12, v12, v22
    v_mul_f32 v13, v13, v22
    v_mul_f32 v14, v14, v22
    v_mul_f32 v15, v15, v22
    v_mul_f32 v16, v16, v22
    v_mul_f32 v17, v17, v22
    v_mul_f32 v18, v18, v22
    v_mul_f32 v19, v19, v22
    v_cvt_pk_bf16_f32 v4, v10, v11
    v_cvt_pk_bf16_f32 v5, v12, v13
    v_cvt_pk_bf16_f32 v6, v14, v15
    v_cvt_pk_bf16_f32 v7, v16, v17
    v_cvt_pk_bf16_f32 v8, v18, v19
    buffer_store_dword v4, v3, s[16:19], 0 offen offset:0
    buffer_store_dword v5, v3, s[16:19], 0 offen offset:256
    buffer_store_dword v6, v3, s[16:19], 0 offen offset:512
    buffer_store_dword v7, v3, s[16:19], 0 offen offset:768
    buffer_store_dword v8, v3, s[16:19], 0 offen offset:1024
ln_a2_kernel_end:
    s_endpgm
.section .rodata,"a"
.p2align 6
.amdhsa_kernel ln_a2_kernel
  .amdhsa_next_free_vgpr 32
  .amdhsa_next_free_sgpr 40
  .amdhsa_accum_offset 32
  .amdhsa_group_segment_fixed_size 0
  .amdhsa_kernarg_size 104
  .amdhsa_user_sgpr_count 2
  .amdhsa_user_sgpr_kernarg_segment_ptr 1
  .amdhsa_system_sgpr_workgroup_id_x 1
.end_amdhsa_kernel
.text
.globl kvz_a2_kernel
.p2align 8
.type kvz_a2_kernel,@function
kvz_a2_kernel:
    v_lshrrev_b32 v1, 6, v0
    v_and_b32 v2, 63, v0
    s_nop 0
    v_readfirstlane_b32 s3, v1
    s_lshl_b32 s4, s2, 2
    s_add_u32 s4, s4, s3
    s_cmp_ge_u32 s4, 512
    s_cbranch_scc1 kvz_a2_kernel_end
    s_load_dwordx2 s[6:7], s[0:1], 96
    s_waitcnt lgkmcnt(0)
    s_mov_b32 s8, s6
    s_mov_b32 s9, s7
    s_mov_b32 s10, 268435456
    s_mov_b32 s11, 0x00020000
    s_lshr_b32 s5, s4, 4
    s_and_b32 s12, s4, 15
    s_mul_i32 s13, s5, 20
    v_and_b32 v3, 15, v2
    v_lshrrev_b32 v4, 4, v2
    s_lshl_b32 s14, s12, 7
    v_lshlrev_b32 v5, 3, v4
    v_add_u32 v5, s14, v5
    v_add_u32 v6, 0, v3
    v_min_u32 v8, 19, v6
    v_add_u32 v8, s13, v8
    v_lshlrev_b32 v8, 11, v8
    v_add_u32 v8, v8, v5
    v_lshlrev_b32 v8, 1, v8
    v_add_u32 v8, 12582912, v8
    v_add_u32 v10, 2621440, v8
    v_add_u32 v7, 16, v3
    v_min_u32 v9, 19, v7
    v_add_u32 v9, s13, v9
    v_lshlrev_b32 v9, 11, v9
    v_add_u32 v9, v9, v5
    v_lshlrev_b32 v9, 1, v9
    v_add_u32 v9, 12582912, v9
    v_add_u32 v11, 2621440, v9
    v_accvgpr_write_b32 a0, 0
    v_accvgpr_write_b32 a1, 0
    v_accvgpr_write_b32 a2, 0
    v_accvgpr_write_b32 a3, 0
    v_accvgpr_write_b32 a4, 0
    v_accvgpr_write_b32 a5, 0
    v_accvgpr_write_b32 a6, 0
    v_accvgpr_write_b32 a7, 0
    v_accvgpr_write_b32 a8, 0
    v_accvgpr_write_b32 a9, 0
    v_accvgpr_write_b32 a10, 0
    v_accvgpr_write_b32 a11, 0
    v_accvgpr_write_b32 a12, 0
    v_accvgpr_write_b32 a13, 0
    v_accvgpr_write_b32 a14, 0
    v_accvgpr_write_b32 a15, 0
    v_cmp_gt_u32 s[16:17], 20, v7
    v_cmp_eq_u32 s[18:19], 20, v7
    buffer_load_dwordx4 v[16:19], v8, s[8:11], 0 offen offset:0
    buffer_load_dwordx4 v[24:27], v10, s[8:11], 0 offen offset:0
    buffer_load_dwordx4 v[20:23], v9, s[8:11], 0 offen offset:0
    buffer_load_dwordx4 v[28:31], v11, s[8:11], 0 offen offset:0
    s_waitcnt vmcnt(0)
    v_lshlrev_b32 v32, 16, v16
    v_and_b32 v33, 0xffff0000, v16
    v_mul_f32 v36, 1.4426950408889634, v32
    v_exp_f32 v36, v36
    v_add_f32 v34, 1.0, v32
    v_cmp_lt_f32 vcc, 0, v32
    s_nop 1
    v_cndmask_b32 v34, v36, v34, vcc
    v_add_f32 v34, 0x358637bd, v34
    v_mul_f32 v36, 1.4426950408889634, v33
    v_exp_f32 v36, v36
    v_add_f32 v35, 1.0, v33
    v_cmp_lt_f32 vcc, 0, v33
    s_nop 1
    v_cndmask_b32 v35, v36, v35, vcc
    v_add_f32 v35, 0x358637bd, v35
    v_cvt_pk_bf16_f32 v16, v34, v35
    v_lshlrev_b32 v32, 16, v17
    v_and_b32 v33, 0xffff0000, v17
    v_mul_f32 v36, 1.4426950408889634, v32
    v_exp_f32 v36, v36
    v_add_f32 v34, 1.0, v32
    v_cmp_lt_f32 vcc, 0, v32
    s_nop 1
    v_cndmask_b32 v34, v36, v34, vcc
    v_add_f32 v34, 0x358637bd, v34
    v_mul_f32 v36, 1.4426950408889634, v33
    v_exp_f32 v36, v36
    v_add_f32 v35, 1.0, v33
    v_cmp_lt_f32 vcc, 0, v33
    s_nop 1
    v_cndmask_b32 v35, v36, v35, vcc
    v_add_f32 v35, 0x358637bd, v35
    v_cvt_pk_bf16_f32 v17, v34, v35
    v_lshlrev_b32 v32, 16, v18
    v_and_b32 v33, 0xffff0000, v18
    v_mul_f32 v36, 1.4426950408889634, v32
    v_exp_f32 v36, v36
    v_add_f32 v34, 1.0, v32
    v_cmp_lt_f32 vcc, 0, v32
    s_nop 1
    v_cndmask_b32 v34, v36, v34, vcc
    v_add_f32 v34, 0x358637bd, v34
    v_mul_f32 v36, 1.4426950408889634, v33
    v_exp_f32 v36, v36
    v_add_f32 v35, 1.0, v33
    v_cmp_lt_f32 vcc, 0, v33
    s_nop 1
    v_cndmask_b32 v35, v36, v35, vcc
    v_add_f32 v35, 0x358637bd, v35
    v_cvt_pk_bf16_f32 v18, v34, v35
    v_lshlrev_b32 v32, 16, v19
    v_and_b32 v33, 0xffff0000, v19
    v_mul_f32 v36, 1.4426950408889634, v32
    v_exp_f32 v36, v36
    v_add_f32 v34, 1.0, v32
    v_cmp_lt_f32 vcc, 0, v32
    s_nop 1
    v_cndmask_b32 v34, v36, v34, vcc
    v_add_f32 v34, 0x358637bd, v34
    v_mul_f32 v36, 1.4426950408889634, v33
    v_exp_f32 v36, v36
    v_add_f32 v35, 1.0, v33
    v_cmp_lt_f32 vcc, 0, v33
    s_nop 1
    v_cndmask_b32 v35, v36, v35, vcc
    v_add_f32 v35, 0x358637bd, v35
    v_cvt_pk_bf16_f32 v19, v34, v35
    v_lshlrev_b32 v32, 16, v20
    v_and_b32 v33, 0xffff0000, v20
    v_mul_f32 v36, 1.4426950408889634, v32
    v_exp_f32 v36, v36
    v_add_f32 v34, 1.0, v32
    v_cmp_lt_f32 vcc, 0, v32
    s_nop 1
    v_cndmask_b32 v34, v36, v34, vcc
    v_add_f32 v34, 0x358637bd, v34
    v_mul_f32 v36, 1.4426950408889634, v33
    v_exp_f32 v36, v36
    v_add_f32 v35, 1.0, v33
    v_cmp_lt_f32 vcc, 0, v33
    s_nop 1
    v_cndmask_b32 v35, v36, v35, vcc
    v_add_f32 v35, 0x358637bd, v35
    v_cvt_pk_bf16_f32 v20, v34, v35
    v_lshlrev_b32 v32, 16, v21
    v_and_b32 v33, 0xffff0000, v21
    v_mul_f32 v36, 1.4426950408889634, v32
    v_exp_f32 v36, v36
    v_add_f32 v34, 1.0, v32
    v_cmp_lt_f32 vcc, 0, v32
    s_nop 1
    v_cndmask_b32 v34, v36, v34, vcc
    v_add_f32 v34, 0x358637bd, v34
    v_mul_f32 v36, 1.4426950408889634, v33
    v_exp_f32 v36, v36
    v_add_f32 v35, 1.0, v33
    v_cmp_lt_f32 vcc, 0, v33
    s_nop 1
    v_cndmask_b32 v35, v36, v35, vcc
    v_add_f32 v35, 0x358637bd, v35
    v_cvt_pk_bf16_f32 v21, v34, v35
    v_lshlrev_b32 v32, 16, v22
    v_and_b32 v33, 0xffff0000, v22
    v_mul_f32 v36, 1.4426950408889634, v32
    v_exp_f32 v36, v36
    v_add_f32 v34, 1.0, v32
    v_cmp_lt_f32 vcc, 0, v32
    s_nop 1
    v_cndmask_b32 v34, v36, v34, vcc
    v_add_f32 v34, 0x358637bd, v34
    v_mul_f32 v36, 1.4426950408889634, v33
    v_exp_f32 v36, v36
    v_add_f32 v35, 1.0, v33
    v_cmp_lt_f32 vcc, 0, v33
    s_nop 1
    v_cndmask_b32 v35, v36, v35, vcc
    v_add_f32 v35, 0x358637bd, v35
    v_cvt_pk_bf16_f32 v22, v34, v35
    v_lshlrev_b32 v32, 16, v23
    v_and_b32 v33, 0xffff0000, v23
    v_mul_f32 v36, 1.4426950408889634, v32
    v_exp_f32 v36, v36
    v_add_f32 v34, 1.0, v32
    v_cmp_lt_f32 vcc, 0, v32
    s_nop 1
    v_cndmask_b32 v34, v36, v34, vcc
    v_add_f32 v34, 0x358637bd, v34
    v_mul_f32 v36, 1.4426950408889634, v33
    v_exp_f32 v36, v36
    v_add_f32 v35, 1.0, v33
    v_cmp_lt_f32 vcc, 0, v33
    s_nop 1
    v_cndmask_b32 v35, v36, v35, vcc
    v_add_f32 v35, 0x358637bd, v35
    v_cvt_pk_bf16_f32 v23, v34, v35
    v_mov_b32 v37, 0x3f803f80
    v_cndmask_b32 v20, 0, v20, s[16:17]
    v_cndmask_b32 v28, 0, v28, s[16:17]
    v_cndmask_b32 v28, v28, v37, s[18:19]
    v_cndmask_b32 v21, 0, v21, s[16:17]
    v_cndmask_b32 v29, 0, v29, s[16:17]
    v_cndmask_b32 v29, v29, v37, s[18:19]
    v_cndmask_b32 v22, 0, v22, s[16:17]
    v_cndmask_b32 v30, 0, v30, s[16:17]
    v_cndmask_b32 v30, v30, v37, s[18:19]
    v_cndmask_b32 v23, 0, v23, s[16:17]
    v_cndmask_b32 v31, 0, v31, s[16:17]
    v_cndmask_b32 v31, v31, v37, s[18:19]
    s_nop 1
    v_mfma_f32_16x16x32_bf16 a[0:3], v[24:27], v[16:19], a[0:3]
    v_mfma_f32_16x16x32_bf16 a[4:7], v[24:27], v[20:23], a[4:7]
    v_mfma_f32_16x16x32_bf16 a[8:11], v[28:31], v[16:19], a[8:11]
    v_mfma_f32_16x16x32_bf16 a[12:15], v[28:31], v[20:23], a[12:15]
    buffer_load_dwordx4 v[16:19], v8, s[8:11], 0 offen offset:64
    buffer_load_dwordx4 v[24:27], v10, s[8:11], 0 offen offset:64
    buffer_load_dwordx4 v[20:23], v9, s[8:11], 0 offen offset:64
    buffer_load_dwordx4 v[28:31], v11, s[8:11], 0 offen offset:64
    s_waitcnt vmcnt(0)
    v_lshlrev_b32 v32, 16, v16
    v_and_b32 v33, 0xffff0000, v16
    v_mul_f32 v36, 1.4426950408889634, v32
    v_exp_f32 v36, v36
    v_add_f32 v34, 1.0, v32
    v_cmp_lt_f32 vcc, 0, v32
    s_nop 1
    v_cndmask_b32 v34, v36, v34, vcc
    v_add_f32 v34, 0x358637bd, v34
    v_mul_f32 v36, 1.4426950408889634, v33
    v_exp_f32 v36, v36
    v_add_f32 v35, 1.0, v33
    v_cmp_lt_f32 vcc, 0, v33
    s_nop 1
    v_cndmask_b32 v35, v36, v35, vcc
    v_add_f32 v35, 0x358637bd, v35
    v_cvt_pk_bf16_f32 v16, v34, v35
    v_lshlrev_b32 v32, 16, v17
    v_and_b32 v33, 0xffff0000, v17
    v_mul_f32 v36, 1.4426950408889634, v32
    v_exp_f32 v36, v36
    v_add_f32 v34, 1.0, v32
    v_cmp_lt_f32 vcc, 0, v32
    s_nop 1
    v_cndmask_b32 v34, v36, v34, vcc
    v_add_f32 v34, 0x358637bd, v34
    v_mul_f32 v36, 1.4426950408889634, v33
    v_exp_f32 v36, v36
    v_add_f32 v35, 1.0, v33
    v_cmp_lt_f32 vcc, 0, v33
    s_nop 1
    v_cndmask_b32 v35, v36, v35, vcc
    v_add_f32 v35, 0x358637bd, v35
    v_cvt_pk_bf16_f32 v17, v34, v35
    v_lshlrev_b32 v32, 16, v18
    v_and_b32 v33, 0xffff0000, v18
    v_mul_f32 v36, 1.4426950408889634, v32
    v_exp_f32 v36, v36
    v_add_f32 v34, 1.0, v32
    v_cmp_lt_f32 vcc, 0, v32
    s_nop 1
    v_cndmask_b32 v34, v36, v34, vcc
    v_add_f32 v34, 0x358637bd, v34
    v_mul_f32 v36, 1.4426950408889634, v33
    v_exp_f32 v36, v36
    v_add_f32 v35, 1.0, v33
    v_cmp_lt_f32 vcc, 0, v33
    s_nop 1
    v_cndmask_b32 v35, v36, v35, vcc
    v_add_f32 v35, 0x358637bd, v35
    v_cvt_pk_bf16_f32 v18, v34, v35
    v_lshlrev_b32 v32, 16, v19
    v_and_b32 v33, 0xffff0000, v19
    v_mul_f32 v36, 1.4426950408889634, v32
    v_exp_f32 v36, v36
    v_add_f32 v34, 1.0, v32
    v_cmp_lt_f32 vcc, 0, v32
    s_nop 1
    v_cndmask_b32 v34, v36, v34, vcc
    v_add_f32 v34, 0x358637bd, v34
    v_mul_f32 v36, 1.4426950408889634, v33
    v_exp_f32 v36, v36
    v_add_f32 v35, 1.0, v33
    v_cmp_lt_f32 vcc, 0, v33
    s_nop 1
    v_cndmask_b32 v35, v36, v35, vcc
    v_add_f32 v35, 0x358637bd, v35
    v_cvt_pk_bf16_f32 v19, v34, v35
    v_lshlrev_b32 v32, 16, v20
    v_and_b32 v33, 0xffff0000, v20
    v_mul_f32 v36, 1.4426950408889634, v32
    v_exp_f32 v36, v36
    v_add_f32 v34, 1.0, v32
    v_cmp_lt_f32 vcc, 0, v32
    s_nop 1
    v_cndmask_b32 v34, v36, v34, vcc
    v_add_f32 v34, 0x358637bd, v34
    v_mul_f32 v36, 1.4426950408889634, v33
    v_exp_f32 v36, v36
    v_add_f32 v35, 1.0, v33
    v_cmp_lt_f32 vcc, 0, v33
    s_nop 1
    v_cndmask_b32 v35, v36, v35, vcc
    v_add_f32 v35, 0x358637bd, v35
    v_cvt_pk_bf16_f32 v20, v34, v35
    v_lshlrev_b32 v32, 16, v21
    v_and_b32 v33, 0xffff0000, v21
    v_mul_f32 v36, 1.4426950408889634, v32
    v_exp_f32 v36, v36
    v_add_f32 v34, 1.0, v32
    v_cmp_lt_f32 vcc, 0, v32
    s_nop 1
    v_cndmask_b32 v34, v36, v34, vcc
    v_add_f32 v34, 0x358637bd, v34
    v_mul_f32 v36, 1.4426950408889634, v33
    v_exp_f32 v36, v36
    v_add_f32 v35, 1.0, v33
    v_cmp_lt_f32 vcc, 0, v33
    s_nop 1
    v_cndmask_b32 v35, v36, v35, vcc
    v_add_f32 v35, 0x358637bd, v35
    v_cvt_pk_bf16_f32 v21, v34, v35
    v_lshlrev_b32 v32, 16, v22
    v_and_b32 v33, 0xffff0000, v22
    v_mul_f32 v36, 1.4426950408889634, v32
    v_exp_f32 v36, v36
    v_add_f32 v34, 1.0, v32
    v_cmp_lt_f32 vcc, 0, v32
    s_nop 1
    v_cndmask_b32 v34, v36, v34, vcc
    v_add_f32 v34, 0x358637bd, v34
    v_mul_f32 v36, 1.4426950408889634, v33
    v_exp_f32 v36, v36
    v_add_f32 v35, 1.0, v33
    v_cmp_lt_f32 vcc, 0, v33
    s_nop 1
    v_cndmask_b32 v35, v36, v35, vcc
    v_add_f32 v35, 0x358637bd, v35
    v_cvt_pk_bf16_f32 v22, v34, v35
    v_lshlrev_b32 v32, 16, v23
    v_and_b32 v33, 0xffff0000, v23
    v_mul_f32 v36, 1.4426950408889634, v32
    v_exp_f32 v36, v36
    v_add_f32 v34, 1.0, v32
    v_cmp_lt_f32 vcc, 0, v32
    s_nop 1
    v_cndmask_b32 v34, v36, v34, vcc
    v_add_f32 v34, 0x358637bd, v34
    v_mul_f32 v36, 1.4426950408889634, v33
    v_exp_f32 v36, v36
    v_add_f32 v35, 1.0, v33
    v_cmp_lt_f32 vcc, 0, v33
    s_nop 1
    v_cndmask_b32 v35, v36, v35, vcc
    v_add_f32 v35, 0x358637bd, v35
    v_cvt_pk_bf16_f32 v23, v34, v35
    v_mov_b32 v37, 0x3f803f80
    v_cndmask_b32 v20, 0, v20, s[16:17]
    v_cndmask_b32 v28, 0, v28, s[16:17]
    v_cndmask_b32 v28, v28, v37, s[18:19]
    v_cndmask_b32 v21, 0, v21, s[16:17]
    v_cndmask_b32 v29, 0, v29, s[16:17]
    v_cndmask_b32 v29, v29, v37, s[18:19]
    v_cndmask_b32 v22, 0, v22, s[16:17]
    v_cndmask_b32 v30, 0, v30, s[16:17]
    v_cndmask_b32 v30, v30, v37, s[18:19]
    v_cndmask_b32 v23, 0, v23, s[16:17]
    v_cndmask_b32 v31, 0, v31, s[16:17]
    v_cndmask_b32 v31, v31, v37, s[18:19]
    s_nop 1
    v_mfma_f32_16x16x32_bf16 a[0:3], v[24:27], v[16:19], a[0:3]
    v_mfma_f32_16x16x32_bf16 a[4:7], v[24:27], v[20:23], a[4:7]
    v_mfma_f32_16x16x32_bf16 a[8:11], v[28:31], v[16:19], a[8:11]
    v_mfma_f32_16x16x32_bf16 a[12:15], v[28:31], v[20:23], a[12:15]
    buffer_load_dwordx4 v[16:19], v8, s[8:11], 0 offen offset:128
    buffer_load_dwordx4 v[24:27], v10, s[8:11], 0 offen offset:128
    buffer_load_dwordx4 v[20:23], v9, s[8:11], 0 offen offset:128
    buffer_load_dwordx4 v[28:31], v11, s[8:11], 0 offen offset:128
    s_waitcnt vmcnt(0)
    v_lshlrev_b32 v32, 16, v16
    v_and_b32 v33, 0xffff0000, v16
    v_mul_f32 v36, 1.4426950408889634, v32
    v_exp_f32 v36, v36
    v_add_f32 v34, 1.0, v32
    v_cmp_lt_f32 vcc, 0, v32
    s_nop 1
    v_cndmask_b32 v34, v36, v34, vcc
    v_add_f32 v34, 0x358637bd, v34
    v_mul_f32 v36, 1.4426950408889634, v33
    v_exp_f32 v36, v36
    v_add_f32 v35, 1.0, v33
    v_cmp_lt_f32 vcc, 0, v33
    s_nop 1
    v_cndmask_b32 v35, v36, v35, vcc
    v_add_f32 v35, 0x358637bd, v35
    v_cvt_pk_bf16_f32 v16, v34, v35
    v_lshlrev_b32 v32, 16, v17
    v_and_b32 v33, 0xffff0000, v17
    v_mul_f32 v36, 1.4426950408889634, v32
    v_exp_f32 v36, v36
    v_add_f32 v34, 1.0, v32
    v_cmp_lt_f32 vcc, 0, v32
    s_nop 1
    v_cndmask_b32 v34, v36, v34, vcc
    v_add_f32 v34, 0x358637bd, v34
    v_mul_f32 v36, 1.4426950408889634, v33
    v_exp_f32 v36, v36
    v_add_f32 v35, 1.0, v33
    v_cmp_lt_f32 vcc, 0, v33
    s_nop 1
    v_cndmask_b32 v35, v36, v35, vcc
    v_add_f32 v35, 0x358637bd, v35
    v_cvt_pk_bf16_f32 v17, v34, v35
    v_lshlrev_b32 v32, 16, v18
    v_and_b32 v33, 0xffff0000, v18
    v_mul_f32 v36, 1.4426950408889634, v32
    v_exp_f32 v36, v36
    v_add_f32 v34, 1.0, v32
    v_cmp_lt_f32 vcc, 0, v32
    s_nop 1
    v_cndmask_b32 v34, v36, v34, vcc
    v_add_f32 v34, 0x358637bd, v34
    v_mul_f32 v36, 1.4426950408889634, v33
    v_exp_f32 v36, v36
    v_add_f32 v35, 1.0, v33
    v_cmp_lt_f32 vcc, 0, v33
    s_nop 1
    v_cndmask_b32 v35, v36, v35, vcc
    v_add_f32 v35, 0x358637bd, v35
    v_cvt_pk_bf16_f32 v18, v34, v35
    v_lshlrev_b32 v32, 16, v19
    v_and_b32 v33, 0xffff0000, v19
    v_mul_f32 v36, 1.4426950408889634, v32
    v_exp_f32 v36, v36
    v_add_f32 v34, 1.0, v32
    v_cmp_lt_f32 vcc, 0, v32
    s_nop 1
    v_cndmask_b32 v34, v36, v34, vcc
    v_add_f32 v34, 0x358637bd, v34
    v_mul_f32 v36, 1.4426950408889634, v33
    v_exp_f32 v36, v36
    v_add_f32 v35, 1.0, v33
    v_cmp_lt_f32 vcc, 0, v33
    s_nop 1
    v_cndmask_b32 v35, v36, v35, vcc
    v_add_f32 v35, 0x358637bd, v35
    v_cvt_pk_bf16_f32 v19, v34, v35
    v_lshlrev_b32 v32, 16, v20
    v_and_b32 v33, 0xffff0000, v20
    v_mul_f32 v36, 1.4426950408889634, v32
    v_exp_f32 v36, v36
    v_add_f32 v34, 1.0, v32
    v_cmp_lt_f32 vcc, 0, v32
    s_nop 1
    v_cndmask_b32 v34, v36, v34, vcc
    v_add_f32 v34, 0x358637bd, v34
    v_mul_f32 v36, 1.4426950408889634, v33
    v_exp_f32 v36, v36
    v_add_f32 v35, 1.0, v33
    v_cmp_lt_f32 vcc, 0, v33
    s_nop 1
    v_cndmask_b32 v35, v36, v35, vcc
    v_add_f32 v35, 0x358637bd, v35
    v_cvt_pk_bf16_f32 v20, v34, v35
    v_lshlrev_b32 v32, 16, v21
    v_and_b32 v33, 0xffff0000, v21
    v_mul_f32 v36, 1.4426950408889634, v32
    v_exp_f32 v36, v36
    v_add_f32 v34, 1.0, v32
    v_cmp_lt_f32 vcc, 0, v32
    s_nop 1
    v_cndmask_b32 v34, v36, v34, vcc
    v_add_f32 v34, 0x358637bd, v34
    v_mul_f32 v36, 1.4426950408889634, v33
    v_exp_f32 v36, v36
    v_add_f32 v35, 1.0, v33
    v_cmp_lt_f32 vcc, 0, v33
    s_nop 1
    v_cndmask_b32 v35, v36, v35, vcc
    v_add_f32 v35, 0x358637bd, v35
    v_cvt_pk_bf16_f32 v21, v34, v35
    v_lshlrev_b32 v32, 16, v22
    v_and_b32 v33, 0xffff0000, v22
    v_mul_f32 v36, 1.4426950408889634, v32
    v_exp_f32 v36, v36
    v_add_f32 v34, 1.0, v32
    v_cmp_lt_f32 vcc, 0, v32
    s_nop 1
    v_cndmask_b32 v34, v36, v34, vcc
    v_add_f32 v34, 0x358637bd, v34
    v_mul_f32 v36, 1.4426950408889634, v33
    v_exp_f32 v36, v36
    v_add_f32 v35, 1.0, v33
    v_cmp_lt_f32 vcc, 0, v33
    s_nop 1
    v_cndmask_b32 v35, v36, v35, vcc
    v_add_f32 v35, 0x358637bd, v35
    v_cvt_pk_bf16_f32 v22, v34, v35
    v_lshlrev_b32 v32, 16, v23
    v_and_b32 v33, 0xffff0000, v23
    v_mul_f32 v36, 1.4426950408889634, v32
    v_exp_f32 v36, v36
    v_add_f32 v34, 1.0, v32
    v_cmp_lt_f32 vcc, 0, v32
    s_nop 1
    v_cndmask_b32 v34, v36, v34, vcc
    v_add_f32 v34, 0x358637bd, v34
    v_mul_f32 v36, 1.4426950408889634, v33
    v_exp_f32 v36, v36
    v_add_f32 v35, 1.0, v33
    v_cmp_lt_f32 vcc, 0, v33
    s_nop 1
    v_cndmask_b32 v35, v36, v35, vcc
    v_add_f32 v35, 0x358637bd, v35
    v_cvt_pk_bf16_f32 v23, v34, v35
    v_mov_b32 v37, 0x3f803f80
    v_cndmask_b32 v20, 0, v20, s[16:17]
    v_cndmask_b32 v28, 0, v28, s[16:17]
    v_cndmask_b32 v28, v28, v37, s[18:19]
    v_cndmask_b32 v21, 0, v21, s[16:17]
    v_cndmask_b32 v29, 0, v29, s[16:17]
    v_cndmask_b32 v29, v29, v37, s[18:19]
    v_cndmask_b32 v22, 0, v22, s[16:17]
    v_cndmask_b32 v30, 0, v30, s[16:17]
    v_cndmask_b32 v30, v30, v37, s[18:19]
    v_cndmask_b32 v23, 0, v23, s[16:17]
    v_cndmask_b32 v31, 0, v31, s[16:17]
    v_cndmask_b32 v31, v31, v37, s[18:19]
    s_nop 1
    v_mfma_f32_16x16x32_bf16 a[0:3], v[24:27], v[16:19], a[0:3]
    v_mfma_f32_16x16x32_bf16 a[4:7], v[24:27], v[20:23], a[4:7]
    v_mfma_f32_16x16x32_bf16 a[8:11], v[28:31], v[16:19], a[8:11]
    v_mfma_f32_16x16x32_bf16 a[12:15], v[28:31], v[20:23], a[12:15]
    buffer_load_dwordx4 v[16:19], v8, s[8:11], 0 offen offset:192
    buffer_load_dwordx4 v[24:27], v10, s[8:11], 0 offen offset:192
    buffer_load_dwordx4 v[20:23], v9, s[8:11], 0 offen offset:192
    buffer_load_dwordx4 v[28:31], v11, s[8:11], 0 offen offset:192
    s_waitcnt vmcnt(0)
    v_lshlrev_b32 v32, 16, v16
    v_and_b32 v33, 0xffff0000, v16
    v_mul_f32 v36, 1.4426950408889634, v32
    v_exp_f32 v36, v36
    v_add_f32 v34, 1.0, v32
    v_cmp_lt_f32 vcc, 0, v32
    s_nop 1
    v_cndmask_b32 v34, v36, v34, vcc
    v_add_f32 v34, 0x358637bd, v34
    v_mul_f32 v36, 1.4426950408889634, v33
    v_exp_f32 v36, v36
    v_add_f32 v35, 1.0, v33
    v_cmp_lt_f32 vcc, 0, v33
    s_nop 1
    v_cndmask_b32 v35, v36, v35, vcc
    v_add_f32 v35, 0x358637bd, v35
    v_cvt_pk_bf16_f32 v16, v34, v35
    v_lshlrev_b32 v32, 16, v17
    v_and_b32 v33, 0xffff0000, v17
    v_mul_f32 v36, 1.4426950408889634, v32
    v_exp_f32 v36, v36
    v_add_f32 v34, 1.0, v32
    v_cmp_lt_f32 vcc, 0, v32
    s_nop 1
    v_cndmask_b32 v34, v36, v34, vcc
    v_add_f32 v34, 0x358637bd, v34
    v_mul_f32 v36, 1.4426950408889634, v33
    v_exp_f32 v36, v36
    v_add_f32 v35, 1.0, v33
    v_cmp_lt_f32 vcc, 0, v33
    s_nop 1
    v_cndmask_b32 v35, v36, v35, vcc
    v_add_f32 v35, 0x358637bd, v35
    v_cvt_pk_bf16_f32 v17, v34, v35
    v_lshlrev_b32 v32, 16, v18
    v_and_b32 v33, 0xffff0000, v18
    v_mul_f32 v36, 1.4426950408889634, v32
    v_exp_f32 v36, v36
    v_add_f32 v34, 1.0, v32
    v_cmp_lt_f32 vcc, 0, v32
    s_nop 1
    v_cndmask_b32 v34, v36, v34, vcc
    v_add_f32 v34, 0x358637bd, v34
    v_mul_f32 v36, 1.4426950408889634, v33
    v_exp_f32 v36, v36
    v_add_f32 v35, 1.0, v33
    v_cmp_lt_f32 vcc, 0, v33
    s_nop 1
    v_cndmask_b32 v35, v36, v35, vcc
    v_add_f32 v35, 0x358637bd, v35
    v_cvt_pk_bf16_f32 v18, v34, v35
    v_lshlrev_b32 v32, 16, v19
    v_and_b32 v33, 0xffff0000, v19
    v_mul_f32 v36, 1.4426950408889634, v32
    v_exp_f32 v36, v36
    v_add_f32 v34, 1.0, v32
    v_cmp_lt_f32 vcc, 0, v32
    s_nop 1
    v_cndmask_b32 v34, v36, v34, vcc
    v_add_f32 v34, 0x358637bd, v34
    v_mul_f32 v36, 1.4426950408889634, v33
    v_exp_f32 v36, v36
    v_add_f32 v35, 1.0, v33
    v_cmp_lt_f32 vcc, 0, v33
    s_nop 1
    v_cndmask_b32 v35, v36, v35, vcc
    v_add_f32 v35, 0x358637bd, v35
    v_cvt_pk_bf16_f32 v19, v34, v35
    v_lshlrev_b32 v32, 16, v20
    v_and_b32 v33, 0xffff0000, v20
    v_mul_f32 v36, 1.4426950408889634, v32
    v_exp_f32 v36, v36
    v_add_f32 v34, 1.0, v32
    v_cmp_lt_f32 vcc, 0, v32
    s_nop 1
    v_cndmask_b32 v34, v36, v34, vcc
    v_add_f32 v34, 0x358637bd, v34
    v_mul_f32 v36, 1.4426950408889634, v33
    v_exp_f32 v36, v36
    v_add_f32 v35, 1.0, v33
    v_cmp_lt_f32 vcc, 0, v33
    s_nop 1
    v_cndmask_b32 v35, v36, v35, vcc
    v_add_f32 v35, 0x358637bd, v35
    v_cvt_pk_bf16_f32 v20, v34, v35
    v_lshlrev_b32 v32, 16, v21
    v_and_b32 v33, 0xffff0000, v21
    v_mul_f32 v36, 1.4426950408889634, v32
    v_exp_f32 v36, v36
    v_add_f32 v34, 1.0, v32
    v_cmp_lt_f32 vcc, 0, v32
    s_nop 1
    v_cndmask_b32 v34, v36, v34, vcc
    v_add_f32 v34, 0x358637bd, v34
    v_mul_f32 v36, 1.4426950408889634, v33
    v_exp_f32 v36, v36
    v_add_f32 v35, 1.0, v33
    v_cmp_lt_f32 vcc, 0, v33
    s_nop 1
    v_cndmask_b32 v35, v36, v35, vcc
    v_add_f32 v35, 0x358637bd, v35
    v_cvt_pk_bf16_f32 v21, v34, v35
    v_lshlrev_b32 v32, 16, v22
    v_and_b32 v33, 0xffff0000, v22
    v_mul_f32 v36, 1.4426950408889634, v32
    v_exp_f32 v36, v36
    v_add_f32 v34, 1.0, v32
    v_cmp_lt_f32 vcc, 0, v32
    s_nop 1
    v_cndmask_b32 v34, v36, v34, vcc
    v_add_f32 v34, 0x358637bd, v34
    v_mul_f32 v36, 1.4426950408889634, v33
    v_exp_f32 v36, v36
    v_add_f32 v35, 1.0, v33
    v_cmp_lt_f32 vcc, 0, v33
    s_nop 1
    v_cndmask_b32 v35, v36, v35, vcc
    v_add_f32 v35, 0x358637bd, v35
    v_cvt_pk_bf16_f32 v22, v34, v35
    v_lshlrev_b32 v32, 16, v23
    v_and_b32 v33, 0xffff0000, v23
    v_mul_f32 v36, 1.4426950408889634, v32
    v_exp_f32 v36, v36
    v_add_f32 v34, 1.0, v32
    v_cmp_lt_f32 vcc, 0, v32
    s_nop 1
    v_cndmask_b32 v34, v36, v34, vcc
    v_add_f32 v34, 0x358637bd, v34
    v_mul_f32 v36, 1.4426950408889634, v33
    v_exp_f32 v36, v36
    v_add_f32 v35, 1.0, v33
    v_cmp_lt_f32 vcc, 0, v33
    s_nop 1
    v_cndmask_b32 v35, v36, v35, vcc
    v_add_f32 v35, 0x358637bd, v35
    v_cvt_pk_bf16_f32 v23, v34, v35
    v_mov_b32 v37, 0x3f803f80
    v_cndmask_b32 v20, 0, v20, s[16:17]
    v_cndmask_b32 v28, 0, v28, s[16:17]
    v_cndmask_b32 v28, v28, v37, s[18:19]
    v_cndmask_b32 v21, 0, v21, s[16:17]
    v_cndmask_b32 v29, 0, v29, s[16:17]
    v_cndmask_b32 v29, v29, v37, s[18:19]
    v_cndmask_b32 v22, 0, v22, s[16:17]
    v_cndmask_b32 v30, 0, v30, s[16:17]
    v_cndmask_b32 v30, v30, v37, s[18:19]
    v_cndmask_b32 v23, 0, v23, s[16:17]
    v_cndmask_b32 v31, 0, v31, s[16:17]
    v_cndmask_b32 v31, v31, v37, s[18:19]
    s_nop 1
    v_mfma_f32_16x16x32_bf16 a[0:3], v[24:27], v[16:19], a[0:3]
    v_mfma_f32_16x16x32_bf16 a[4:7], v[24:27], v[20:23], a[4:7]
    v_mfma_f32_16x16x32_bf16 a[8:11], v[28:31], v[16:19], a[8:11]
    v_mfma_f32_16x16x32_bf16 a[12:15], v[28:31], v[20:23], a[12:15]
    s_nop 7
    s_nop 7
    v_lshlrev_b32 v5, 2, v4
    v_lshlrev_b32 v5, 5, v5
    v_add_u32 v5, v5, v3
    v_lshlrev_b32 v5, 2, v5
    s_lshl_b32 s14, s5, 12
    s_add_u32 s14, s14, 23199744
    v_add_u32 v5, s14, v5
    v_accvgpr_read_b32 v40, a0
    v_accvgpr_read_b32 v41, a1
    v_accvgpr_read_b32 v42, a2
    v_accvgpr_read_b32 v43, a3
    buffer_atomic_add_f32 v40, v5, s[8:11], 0 offen offset:0
    buffer_atomic_add_f32 v41, v5, s[8:11], 0 offen offset:128
    buffer_atomic_add_f32 v42, v5, s[8:11], 0 offen offset:256
    buffer_atomic_add_f32 v43, v5, s[8:11], 0 offen offset:384
    v_accvgpr_read_b32 v40, a4
    v_accvgpr_read_b32 v41, a5
    v_accvgpr_read_b32 v42, a6
    v_accvgpr_read_b32 v43, a7
    buffer_atomic_add_f32 v40, v5, s[8:11], 0 offen offset:64
    buffer_atomic_add_f32 v41, v5, s[8:11], 0 offen offset:192
    buffer_atomic_add_f32 v42, v5, s[8:11], 0 offen offset:320
    buffer_atomic_add_f32 v43, v5, s[8:11], 0 offen offset:448
    v_accvgpr_read_b32 v40, a8
    v_accvgpr_read_b32 v41, a9
    v_accvgpr_read_b32 v42, a10
    v_accvgpr_read_b32 v43, a11
    buffer_atomic_add_f32 v40, v5, s[8:11], 0 offen offset:2048
    buffer_atomic_add_f32 v41, v5, s[8:11], 0 offen offset:2176
    buffer_atomic_add_f32 v42, v5, s[8:11], 0 offen offset:2304
    buffer_atomic_add_f32 v43, v5, s[8:11], 0 offen offset:2432
    v_accvgpr_read_b32 v40, a12
    v_accvgpr_read_b32 v41, a13
    v_accvgpr_read_b32 v42, a14
    v_accvgpr_read_b32 v43, a15
    buffer_atomic_add_f32 v40, v5, s[8:11], 0 offen offset:2112
    buffer_atomic_add_f32 v41, v5, s[8:11], 0 offen offset:2240
    buffer_atomic_add_f32 v42, v5, s[8:11], 0 offen offset:2368
    buffer_atomic_add_f32 v43, v5, s[8:11], 0 offen offset:2496
kvz_a2_kernel_end:
    s_endpgm
.section .rodata,"a"
.p2align 6
.amdhsa_kernel kvz_a2_kernel
  .amdhsa_next_free_vgpr 80
  .amdhsa_next_free_sgpr 40
  .amdhsa_accum_offset 64
  .amdhsa_group_segment_fixed_size 0
  .amdhsa_kernarg_size 104
  .amdhsa_user_sgpr_count 2
  .amdhsa_user_sgpr_kernarg_segment_ptr 1
  .amdhsa_system_sgpr_workgroup_id_x 1
.end_amdhsa_kernel
.text
.globl attn_a2_kernel
.p2align 8
.type attn_a2_kernel,@function
attn_a2_kernel:
    s_cmp_ge_u32 s2, 256
    s_cbranch_scc1 attn_a2_kernel_end
    s_load_dwordx2 s[6:7], s[0:1], 96
    s_waitcnt lgkmcnt(0)
    s_mov_b32 s8, s6
    s_mov_b32 s9, s7
    s_mov_b32 s10, 268435456
    s_mov_b32 s11, 0x00020000
    v_mov_b32 v1, v0
    v_add_u32 v2, 0, v1
    s_mov_b32 s12, 3121
    v_mul_lo_u32 v3, v2, s12
    v_lshrrev_b32 v3, 19, v3
    v_mul_u32_u24 v4, 168, v3
    v_sub_u32 v4, v2, v4
    v_lshlrev_b32 v5, 12, v3
    v_lshlrev_b32 v6, 4, v4
    v_add_u32 v5, v5, v6
    v_add_u32 v5, 23199744, v5
    buffer_load_dwordx4 v[8:11], v5, s[8:11], 0 offen
    v_mul_u32_u24 v7, 2688, v3
    v_add_u32 v7, v7, v6
    s_waitcnt vmcnt(0)
    ds_write_b128 v7, v[8:11]
    v_add_u32 v2, 256, v1
    s_mov_b32 s12, 3121
    v_mul_lo_u32 v3, v2, s12
    v_lshrrev_b32 v3, 19, v3
    v_mul_u32_u24 v4, 168, v3
    v_sub_u32 v4, v2, v4
    v_lshlrev_b32 v5, 12, v3
    v_lshlrev_b32 v6, 4, v4
    v_add_u32 v5, v5, v6
    v_add_u32 v5, 23199744, v5
    buffer_load_dwordx4 v[8:11], v5, s[8:11], 0 offen
    v_mul_u32_u24 v7, 2688, v3
    v_add_u32 v7, v7, v6
    s_waitcnt vmcnt(0)
    ds_write_b128 v7, v[8:11]
    v_add_u32 v2, 512, v1
    s_mov_b32 s12, 3121
    v_mul_lo_u32 v3, v2, s12
    v_lshrrev_b32 v3, 19, v3
    v_mul_u32_u24 v4, 168, v3
    v_sub_u32 v4, v2, v4
    v_lshlrev_b32 v5, 12, v3
    v_lshlrev_b32 v6, 4, v4
    v_add_u32 v5, v5, v6
    v_add_u32 v5, 23199744, v5
    buffer_load_dwordx4 v[8:11], v5, s[8:11], 0 offen
    v_mul_u32_u24 v7, 2688, v3
    v_add_u32 v7, v7, v6
    s_waitcnt vmcnt(0)
    ds_write_b128 v7, v[8:11]
    v_add_u32 v2, 768, v1
    s_mov_b32 s12, 3121
    v_mul_lo_u32 v3, v2, s12
    v_lshrrev_b32 v3, 19, v3
    v_mul_u32_u24 v4, 168, v3
    v_sub_u32 v4, v2, v4
    v_lshlrev_b32 v5, 12, v3
    v_lshlrev_b32 v6, 4, v4
    v_add_u32 v5, v5, v6
    v_add_u32 v5, 23199744, v5
    buffer_load_dwordx4 v[8:11], v5, s[8:11], 0 offen
    v_mul_u32_u24 v7, 2688, v3
    v_add_u32 v7, v7, v6
    s_waitcnt vmcnt(0)
    ds_write_b128 v7, v[8:11]
    v_add_u32 v2, 1024, v1
    s_mov_b32 s12, 3121
    v_mul_lo_u32 v3, v2, s12
    v_lshrrev_b32 v3, 19, v3
    v_mul_u32_u24 v4, 168, v3
    v_sub_u32 v4, v2, v4
    v_lshlrev_b32 v5, 12, v3
    v_lshlrev_b32 v6, 4, v4
    v_add_u32 v5, v5, v6
    v_add_u32 v5, 23199744, v5
    buffer_load_dwordx4 v[8:11], v5, s[8:11], 0 offen
    v_mul_u32_u24 v7, 2688, v3
    v_add_u32 v7, v7, v6
    s_waitcnt vmcnt(0)
    ds_write_b128 v7, v[8:11]
    v_add_u32 v2, 1280, v1
    s_mov_b32 s12, 3121
    v_mul_lo_u32 v3, v2, s12
    v_lshrrev_b32 v3, 19, v3
    v_mul_u32_u24 v4, 168, v3
    v_sub_u32 v4, v2, v4
    v_lshlrev_b32 v5, 12, v3
    v_lshlrev_b32 v6, 4, v4
    v_add_u32 v5, v5, v6
    v_add_u32 v5, 23199744, v5
    buffer_load_dwordx4 v[8:11], v5, s[8:11], 0 offen
    v_mul_u32_u24 v7, 2688, v3
    v_add_u32 v7, v7, v6
    s_waitcnt vmcnt(0)
    ds_write_b128 v7, v[8:11]
    v_add_u32 v2, 1536, v1
    s_mov_b32 s12, 3121
    v_mul_lo_u32 v3, v2, s12
    v_lshrrev_b32 v3, 19, v3
    v_mul_u32_u24 v4, 168, v3
    v_sub_u32 v4, v2, v4
    v_lshlrev_b32 v5, 12, v3
    v_lshlrev_b32 v6, 4, v4
    v_add_u32 v5, v5, v6
    v_add_u32 v5, 23199744, v5
    buffer_load_dwordx4 v[8:11], v5, s[8:11], 0 offen
    v_mul_u32_u24 v7, 2688, v3
    v_add_u32 v7, v7, v6
    s_waitcnt vmcnt(0)
    ds_write_b128 v7, v[8:11]
    v_add_u32 v2, 1792, v1
    s_mov_b32 s12, 3121
    v_mul_lo_u32 v3, v2, s12
    v_lshrrev_b32 v3, 19, v3
    v_mul_u32_u24 v4, 168, v3
    v_sub_u32 v4, v2, v4
    v_lshlrev_b32 v5, 12, v3
    v_lshlrev_b32 v6, 4, v4
    v_add_u32 v5, v5, v6
    v_add_u32 v5, 23199744, v5
    buffer_load_dwordx4 v[8:11], v5, s[8:11], 0 offen
    v_mul_u32_u24 v7, 2688, v3
    v_add_u32 v7, v7, v6
    s_waitcnt vmcnt(0)
    ds_write_b128 v7, v[8:11]
    v_add_u32 v2, 2048, v1
    s_mov_b32 s12, 3121
    v_mul_lo_u32 v3, v2, s12
    v_lshrrev_b32 v3, 19, v3
    v_mul_u32_u24 v4, 168, v3
    v_sub_u32 v4, v2, v4
    v_lshlrev_b32 v5, 12, v3
    v_lshlrev_b32 v6, 4, v4
    v_add_u32 v5, v5, v6
    v_add_u32 v5, 23199744, v5
    buffer_load_dwordx4 v[8:11], v5, s[8:11], 0 offen
    v_mul_u32_u24 v7, 2688, v3
    v_add_u32 v7, v7, v6
    s_waitcnt vmcnt(0)
    ds_write_b128 v7, v[8:11]
    v_add_u32 v2, 2304, v1
    s_mov_b32 s12, 3121
    v_mul_lo_u32 v3, v2, s12
    v_lshrrev_b32 v3, 19, v3
    v_mul_u32_u24 v4, 168, v3
    v_sub_u32 v4, v2, v4
    v_lshlrev_b32 v5, 12, v3
    v_lshlrev_b32 v6, 4, v4
    v_add_u32 v5, v5, v6
    v_add_u32 v5, 23199744, v5
    buffer_load_dwordx4 v[8:11], v5, s[8:11], 0 offen
    v_mul_u32_u24 v7, 2688, v3
    v_add_u32 v7, v7, v6
    s_waitcnt vmcnt(0)
    ds_write_b128 v7, v[8:11]
    v_add_u32 v2, 2560, v1
    s_mov_b32 s12, 3121
    v_mul_lo_u32 v3, v2, s12
    v_lshrrev_b32 v3, 19, v3
    v_mul_u32_u24 v4, 168, v3
    v_sub_u32 v4, v2, v4
    v_lshlrev_b32 v5, 12, v3
    v_lshlrev_b32 v6, 4, v4
    v_add_u32 v5, v5, v6
    v_add_u32 v5, 23199744, v5
    buffer_load_dwordx4 v[8:11], v5, s[8:11], 0 offen
    v_mul_u32_u24 v7, 2688, v3
    v_add_u32 v7, v7, v6
    s_waitcnt vmcnt(0)
    ds_write_b128 v7, v[8:11]
    v_add_u32 v2, 2816, v1
    s_mov_b32 s12, 3121
    v_mul_lo_u32 v3, v2, s12
    v_lshrrev_b32 v3, 19, v3
    v_mul_u32_u24 v4, 168, v3
    v_sub_u32 v4, v2, v4
    v_lshlrev_b32 v5, 12, v3
    v_lshlrev_b32 v6, 4, v4
    v_add_u32 v5, v5, v6
    v_add_u32 v5, 23199744, v5
    buffer_load_dwordx4 v[8:11], v5, s[8:11], 0 offen
    v_mul_u32_u24 v7, 2688, v3
    v_add_u32 v7, v7, v6
    s_waitcnt vmcnt(0)
    ds_write_b128 v7, v[8:11]
    v_add_u32 v2, 3072, v1
    s_mov_b32 s12, 3121
    v_mul_lo_u32 v3, v2, s12
    v_lshrrev_b32 v3, 19, v3
    v_mul_u32_u24 v4, 168, v3
    v_sub_u32 v4, v2, v4
    v_lshlrev_b32 v5, 12, v3
    v_lshlrev_b32 v6, 4, v4
    v_add_u32 v5, v5, v6
    v_add_u32 v5, 23199744, v5
    buffer_load_dwordx4 v[8:11], v5, s[8:11], 0 offen
    v_mul_u32_u24 v7, 2688, v3
    v_add_u32 v7, v7, v6
    s_waitcnt vmcnt(0)
    ds_write_b128 v7, v[8:11]
    v_add_u32 v2, 3328, v1
    s_mov_b32 s12, 3121
    v_mul_lo_u32 v3, v2, s12
    v_lshrrev_b32 v3, 19, v3
    v_mul_u32_u24 v4, 168, v3
    v_sub_u32 v4, v2, v4
    v_lshlrev_b32 v5, 12, v3
    v_lshlrev_b32 v6, 4, v4
    v_add_u32 v5, v5, v6
    v_add_u32 v5, 23199744, v5
    buffer_load_dwordx4 v[8:11], v5, s[8:11], 0 offen
    v_mul_u32_u24 v7, 2688, v3
    v_add_u32 v7, v7, v6
    s_waitcnt vmcnt(0)
    ds_write_b128 v7, v[8:11]
    v_add_u32 v2, 3584, v1
    s_mov_b32 s12, 3121
    v_mul_lo_u32 v3, v2, s12
    v_lshrrev_b32 v3, 19, v3
    v_mul_u32_u24 v4, 168, v3
    v_sub_u32 v4, v2, v4
    v_lshlrev_b32 v5, 12, v3
    v_lshlrev_b32 v6, 4, v4
    v_add_u32 v5, v5, v6
    v_add_u32 v5, 23199744, v5
    buffer_load_dwordx4 v[8:11], v5, s[8:11], 0 offen
    v_mul_u32_u24 v7, 2688, v3
    v_add_u32 v7, v7, v6
    s_waitcnt vmcnt(0)
    ds_write_b128 v7, v[8:11]
    v_add_u32 v2, 3840, v1
    s_mov_b32 s12, 3121
    v_mul_lo_u32 v3, v2, s12
    v_lshrrev_b32 v3, 19, v3
    v_mul_u32_u24 v4, 168, v3
    v_sub_u32 v4, v2, v4
    v_lshlrev_b32 v5, 12, v3
    v_lshlrev_b32 v6, 4, v4
    v_add_u32 v5, v5, v6
    v_add_u32 v5, 23199744, v5
    buffer_load_dwordx4 v[8:11], v5, s[8:11], 0 offen
    v_mul_u32_u24 v7, 2688, v3
    v_add_u32 v7, v7, v6
    s_waitcnt vmcnt(0)
    ds_write_b128 v7, v[8:11]
    v_add_u32 v2, 4096, v1
    s_mov_b32 s12, 3121
    v_mul_lo_u32 v3, v2, s12
    v_lshrrev_b32 v3, 19, v3
    v_mul_u32_u24 v4, 168, v3
    v_sub_u32 v4, v2, v4
    v_lshlrev_b32 v5, 12, v3
    v_lshlrev_b32 v6, 4, v4
    v_add_u32 v5, v5, v6
    v_add_u32 v5, 23199744, v5
    buffer_load_dwordx4 v[8:11], v5, s[8:11], 0 offen
    v_mul_u32_u24 v7, 2688, v3
    v_add_u32 v7, v7, v6
    s_waitcnt vmcnt(0)
    ds_write_b128 v7, v[8:11]
    v_add_u32 v2, 4352, v1
    s_mov_b32 s12, 3121
    v_mul_lo_u32 v3, v2, s12
    v_lshrrev_b32 v3, 19, v3
    v_mul_u32_u24 v4, 168, v3
    v_sub_u32 v4, v2, v4
    v_lshlrev_b32 v5, 12, v3
    v_lshlrev_b32 v6, 4, v4
    v_add_u32 v5, v5, v6
    v_add_u32 v5, 23199744, v5
    buffer_load_dwordx4 v[8:11], v5, s[8:11], 0 offen
    v_mul_u32_u24 v7, 2688, v3
    v_add_u32 v7, v7, v6
    s_waitcnt vmcnt(0)
    ds_write_b128 v7, v[8:11]
    v_add_u32 v2, 4608, v1
    s_mov_b32 s12, 3121
    v_mul_lo_u32 v3, v2, s12
    v_lshrrev_b32 v3, 19, v3
    v_mul_u32_u24 v4, 168, v3
    v_sub_u32 v4, v2, v4
    v_lshlrev_b32 v5, 12, v3
    v_lshlrev_b32 v6, 4, v4
    v_add_u32 v5, v5, v6
    v_add_u32 v5, 23199744, v5
    buffer_load_dwordx4 v[8:11], v5, s[8:11], 0 offen
    v_mul_u32_u24 v7, 2688, v3
    v_add_u32 v7, v7, v6
    s_waitcnt vmcnt(0)
    ds_write_b128 v7, v[8:11]
    v_add_u32 v2, 4864, v1
    s_mov_b32 s12, 3121
    v_mul_lo_u32 v3, v2, s12
    v_lshrrev_b32 v3, 19, v3
    v_mul_u32_u24 v4, 168, v3
    v_sub_u32 v4, v2, v4
    v_lshlrev_b32 v5, 12, v3
    v_lshlrev_b32 v6, 4, v4
    v_add_u32 v5, v5, v6
    v_add_u32 v5, 23199744, v5
    buffer_load_dwordx4 v[8:11], v5, s[8:11], 0 offen
    v_mul_u32_u24 v7, 2688, v3
    v_add_u32 v7, v7, v6
    s_waitcnt vmcnt(0)
    ds_write_b128 v7, v[8:11]
    v_add_u32 v2, 5120, v1
    s_mov_b32 s12, 3121
    v_mul_lo_u32 v3, v2, s12
    v_lshrrev_b32 v3, 19, v3
    v_mul_u32_u24 v4, 168, v3
    v_sub_u32 v4, v2, v4
    v_lshlrev_b32 v5, 12, v3
    v_lshlrev_b32 v6, 4, v4
    v_add_u32 v5, v5, v6
    v_add_u32 v5, 23199744, v5
    buffer_load_dwordx4 v[8:11], v5, s[8:11], 0 offen
    v_mul_u32_u24 v7, 2688, v3
    v_add_u32 v7, v7, v6
    s_waitcnt vmcnt(0)
    ds_write_b128 v7, v[8:11]
    s_waitcnt lgkmcnt(0)
    s_barrier
    v_and_b32 v2, 31, v0
    v_lshrrev_b32 v3, 5, v0
    s_lshl_b32 s12, s2, 3
    v_add_u32 v3, s12, v3
    v_mul_u32_u24 v4, 1280, v3
    v_mul_u32_u24 v5, 40, v2
    v_add_u32 v4, v4, v5
    v_add_u32 v6, 8388608, v4
    buffer_load_dwordx2 v[8:9], v6, s[8:11], 0 offen offset:0
    buffer_load_dwordx2 v[10:11], v6, s[8:11], 0 offen offset:8
    buffer_load_dwordx2 v[12:13], v6, s[8:11], 0 offen offset:16
    buffer_load_dwordx2 v[14:15], v6, s[8:11], 0 offen offset:24
    buffer_load_dwordx2 v[16:17], v6, s[8:11], 0 offen offset:32
    s_waitcnt vmcnt(0)
    v_lshlrev_b32 v40, 16, v8
    v_and_b32 v41, 0xffff0000, v8
    v_mul_f32 v44, 1.4426950408889634, v40
    v_exp_f32 v44, v44
    v_add_f32 v42, 1.0, v40
    v_cmp_lt_f32 vcc, 0, v40
    s_nop 1
    v_cndmask_b32 v42, v44, v42, vcc
    v_add_f32 v42, 0x358637bd, v42
    v_mul_f32 v44, 1.4426950408889634, v41
    v_exp_f32 v44, v44
    v_add_f32 v43, 1.0, v41
    v_cmp_lt_f32 vcc, 0, v41
    s_nop 1
    v_cndmask_b32 v43, v44, v43, vcc
    v_add_f32 v43, 0x358637bd, v43
    v_cvt_pk_bf16_f32 v45, v42, v43
    v_lshlrev_b32 v20, 16, v45
    v_and_b32 v21, 0xffff0000, v45
    v_lshlrev_b32 v40, 16, v9
    v_and_b32 v41, 0xffff0000, v9
    v_mul_f32 v44, 1.4426950408889634, v40
    v_exp_f32 v44, v44
    v_add_f32 v42, 1.0, v40
    v_cmp_lt_f32 vcc, 0, v40
    s_nop 1
    v_cndmask_b32 v42, v44, v42, vcc
    v_add_f32 v42, 0x358637bd, v42
    v_mul_f32 v44, 1.4426950408889634, v41
    v_exp_f32 v44, v44
    v_add_f32 v43, 1.0, v41
    v_cmp_lt_f32 vcc, 0, v41
    s_nop 1
    v_cndmask_b32 v43, v44, v43, vcc
    v_add_f32 v43, 0x358637bd, v43
    v_cvt_pk_bf16_f32 v45, v42, v43
    v_lshlrev_b32 v22, 16, v45
    v_and_b32 v23, 0xffff0000, v45
    v_lshlrev_b32 v40, 16, v10
    v_and_b32 v41, 0xffff0000, v10
    v_mul_f32 v44, 1.4426950408889634, v40
    v_exp_f32 v44, v44
    v_add_f32 v42, 1.0, v40
    v_cmp_lt_f32 vcc, 0, v40
    s_nop 1
    v_cndmask_b32 v42, v44, v42, vcc
    v_add_f32 v42, 0x358637bd, v42
    v_mul_f32 v44, 1.4426950408889634, v41
    v_exp_f32 v44, v44
    v_add_f32 v43, 1.0, v41
    v_cmp_lt_f32 vcc, 0, v41
    s_nop 1
    v_cndmask_b32 v43, v44, v43, vcc
    v_add_f32 v43, 0x358637bd, v43
    v_cvt_pk_bf16_f32 v45, v42, v43
    v_lshlrev_b32 v24, 16, v45
    v_and_b32 v25, 0xffff0000, v45
    v_lshlrev_b32 v40, 16, v11
    v_and_b32 v41, 0xffff0000, v11
    v_mul_f32 v44, 1.4426950408889634, v40
    v_exp_f32 v44, v44
    v_add_f32 v42, 1.0, v40
    v_cmp_lt_f32 vcc, 0, v40
    s_nop 1
    v_cndmask_b32 v42, v44, v42, vcc
    v_add_f32 v42, 0x358637bd, v42
    v_mul_f32 v44, 1.4426950408889634, v41
    v_exp_f32 v44, v44
    v_add_f32 v43, 1.0, v41
    v_cmp_lt_f32 vcc, 0, v41
    s_nop 1
    v_cndmask_b32 v43, v44, v43, vcc
    v_add_f32 v43, 0x358637bd, v43
    v_cvt_pk_bf16_f32 v45, v42, v43
    v_lshlrev_b32 v26, 16, v45
    v_and_b32 v27, 0xffff0000, v45
    v_lshlrev_b32 v40, 16, v12
    v_and_b32 v41, 0xffff0000, v12
    v_mul_f32 v44, 1.4426950408889634, v40
    v_exp_f32 v44, v44
    v_add_f32 v42, 1.0, v40
    v_cmp_lt_f32 vcc, 0, v40
    s_nop 1
    v_cndmask_b32 v42, v44, v42, vcc
    v_add_f32 v42, 0x358637bd, v42
    v_mul_f32 v44, 1.4426950408889634, v41
    v_exp_f32 v44, v44
    v_add_f32 v43, 1.0, v41
    v_cmp_lt_f32 vcc, 0, v41
    s_nop 1
    v_cndmask_b32 v43, v44, v43, vcc
    v_add_f32 v43, 0x358637bd, v43
    v_cvt_pk_bf16_f32 v45, v42, v43
    v_lshlrev_b32 v28, 16, v45
    v_and_b32 v29, 0xffff0000, v45
    v_lshlrev_b32 v40, 16, v13
    v_and_b32 v41, 0xffff0000, v13
    v_mul_f32 v44, 1.4426950408889634, v40
    v_exp_f32 v44, v44
    v_add_f32 v42, 1.0, v40
    v_cmp_lt_f32 vcc, 0, v40
    s_nop 1
    v_cndmask_b32 v42, v44, v42, vcc
    v_add_f32 v42, 0x358637bd, v42
    v_mul_f32 v44, 1.4426950408889634, v41
    v_exp_f32 v44, v44
    v_add_f32 v43, 1.0, v41
    v_cmp_lt_f32 vcc, 0, v41
    s_nop 1
    v_cndmask_b32 v43, v44, v43, vcc
    v_add_f32 v43, 0x358637bd, v43
    v_cvt_pk_bf16_f32 v45, v42, v43
    v_lshlrev_b32 v30, 16, v45
    v_and_b32 v31, 0xffff0000, v45
    v_lshlrev_b32 v40, 16, v14
    v_and_b32 v41, 0xffff0000, v14
    v_mul_f32 v44, 1.4426950408889634, v40
    v_exp_f32 v44, v44
    v_add_f32 v42, 1.0, v40
    v_cmp_lt_f32 vcc, 0, v40
    s_nop 1
    v_cndmask_b32 v42, v44, v42, vcc
    v_add_f32 v42, 0x358637bd, v42
    v_mul_f32 v44, 1.4426950408889634, v41
    v_exp_f32 v44, v44
    v_add_f32 v43, 1.0, v41
    v_cmp_lt_f32 vcc, 0, v41
    s_nop 1
    v_cndmask_b32 v43, v44, v43, vcc
    v_add_f32 v43, 0x358637bd, v43
    v_cvt_pk_bf16_f32 v45, v42, v43
    v_lshlrev_b32 v32, 16, v45
    v_and_b32 v33, 0xffff0000, v45
    v_lshlrev_b32 v40, 16, v15
    v_and_b32 v41, 0xffff0000, v15
    v_mul_f32 v44, 1.4426950408889634, v40
    v_exp_f32 v44, v44
    v_add_f32 v42, 1.0, v40
    v_cmp_lt_f32 vcc, 0, v40
    s_nop 1
    v_cndmask_b32 v42, v44, v42, vcc
    v_add_f32 v42, 0x358637bd, v42
    v_mul_f32 v44, 1.4426950408889634, v41
    v_exp_f32 v44, v44
    v_add_f32 v43, 1.0, v41
    v_cmp_lt_f32 vcc, 0, v41
    s_nop 1
    v_cndmask_b32 v43, v44, v43, vcc
    v_add_f32 v43, 0x358637bd, v43
    v_cvt_pk_bf16_f32 v45, v42, v43
    v_lshlrev_b32 v34, 16, v45
    v_and_b32 v35, 0xffff0000, v45
    v_lshlrev_b32 v40, 16, v16
    v_and_b32 v41, 0xffff0000, v16
    v_mul_f32 v44, 1.4426950408889634, v40
    v_exp_f32 v44, v44
    v_add_f32 v42, 1.0, v40
    v_cmp_lt_f32 vcc, 0, v40
    s_nop 1
    v_cndmask_b32 v42, v44, v42, vcc
    v_add_f32 v42, 0x358637bd, v42
    v_mul_f32 v44, 1.4426950408889634, v41
    v_exp_f32 v44, v44
    v_add_f32 v43, 1.0, v41
    v_cmp_lt_f32 vcc, 0, v41
    s_nop 1
    v_cndmask_b32 v43, v44, v43, vcc
    v_add_f32 v43, 0x358637bd, v43
    v_cvt_pk_bf16_f32 v45, v42, v43
    v_lshlrev_b32 v36, 16, v45
    v_and_b32 v37, 0xffff0000, v45
    v_lshlrev_b32 v40, 16, v17
    v_and_b32 v41, 0xffff0000, v17
    v_mul_f32 v44, 1.4426950408889634, v40
    v_exp_f32 v44, v44
    v_add_f32 v42, 1.0, v40
    v_cmp_lt_f32 vcc, 0, v40
    s_nop 1
    v_cndmask_b32 v42, v44, v42, vcc
    v_add_f32 v42, 0x358637bd, v42
    v_mul_f32 v44, 1.4426950408889634, v41
    v_exp_f32 v44, v44
    v_add_f32 v43, 1.0, v41
    v_cmp_lt_f32 vcc, 0, v41
    s_nop 1
    v_cndmask_b32 v43, v44, v43, vcc
    v_add_f32 v43, 0x358637bd, v43
    v_cvt_pk_bf16_f32 v45, v42, v43
    v_lshlrev_b32 v38, 16, v45
    v_and_b32 v39, 0xffff0000, v45
    v_mul_u32_u24 v7, 2688, v2
    ds_read_b128 v[72:75], v7 offset:0
    ds_read_b128 v[76:79], v7 offset:16
    ds_read_b128 v[80:83], v7 offset:32
    ds_read_b128 v[84:87], v7 offset:48
    ds_read_b128 v[88:91], v7 offset:64
    s_waitcnt lgkmcnt(0)
    v_mul_f32 v50, v20, v72
    v_fmac_f32 v50, v21, v73
    v_fmac_f32 v50, v22, v74
    v_fmac_f32 v50, v23, v75
    v_fmac_f32 v50, v24, v76
    v_fmac_f32 v50, v25, v77
    v_fmac_f32 v50, v26, v78
    v_fmac_f32 v50, v27, v79
    v_fmac_f32 v50, v28, v80
    v_fmac_f32 v50, v29, v81
    v_fmac_f32 v50, v30, v82
    v_fmac_f32 v50, v31, v83
    v_fmac_f32 v50, v32, v84
    v_fmac_f32 v50, v33, v85
    v_fmac_f32 v50, v34, v86
    v_fmac_f32 v50, v35, v87
    v_fmac_f32 v50, v36, v88
    v_fmac_f32 v50, v37, v89
    v_fmac_f32 v50, v38, v90
    v_fmac_f32 v50, v39, v91
    ds_read_b128 v[72:75], v7 offset:128
    ds_read_b128 v[76:79], v7 offset:144
    ds_read_b128 v[80:83], v7 offset:160
    ds_read_b128 v[84:87], v7 offset:176
    ds_read_b128 v[88:91], v7 offset:192
    s_waitcnt lgkmcnt(0)
    v_mul_f32 v51, v20, v72
    v_fmac_f32 v51, v21, v73
    v_fmac_f32 v51, v22, v74
    v_fmac_f32 v51, v23, v75
    v_fmac_f32 v51, v24, v76
    v_fmac_f32 v51, v25, v77
    v_fmac_f32 v51, v26, v78
    v_fmac_f32 v51, v27, v79
    v_fmac_f32 v51, v28, v80
    v_fmac_f32 v51, v29, v81
    v_fmac_f32 v51, v30, v82
    v_fmac_f32 v51, v31, v83
    v_fmac_f32 v51, v32, v84
    v_fmac_f32 v51, v33, v85
    v_fmac_f32 v51, v34, v86
    v_fmac_f32 v51, v35, v87
    v_fmac_f32 v51, v36, v88
    v_fmac_f32 v51, v37, v89
    v_fmac_f32 v51, v38, v90
    v_fmac_f32 v51, v39, v91
    ds_read_b128 v[72:75], v7 offset:256
    ds_read_b128 v[76:79], v7 offset:272
    ds_read_b128 v[80:83], v7 offset:288
    ds_read_b128 v[84:87], v7 offset:304
    ds_read_b128 v[88:91], v7 offset:320
    s_waitcnt lgkmcnt(0)
    v_mul_f32 v52, v20, v72
    v_fmac_f32 v52, v21, v73
    v_fmac_f32 v52, v22, v74
    v_fmac_f32 v52, v23, v75
    v_fmac_f32 v52, v24, v76
    v_fmac_f32 v52, v25, v77
    v_fmac_f32 v52, v26, v78
    v_fmac_f32 v52, v27, v79
    v_fmac_f32 v52, v28, v80
    v_fmac_f32 v52, v29, v81
    v_fmac_f32 v52, v30, v82
    v_fmac_f32 v52, v31, v83
    v_fmac_f32 v52, v32, v84
    v_fmac_f32 v52, v33, v85
    v_fmac_f32 v52, v34, v86
    v_fmac_f32 v52, v35, v87
    v_fmac_f32 v52, v36, v88
    v_fmac_f32 v52, v37, v89
    v_fmac_f32 v52, v38, v90
    v_fmac_f32 v52, v39, v91
    ds_read_b128 v[72:75], v7 offset:384
    ds_read_b128 v[76:79], v7 offset:400
    ds_read_b128 v[80:83], v7 offset:416
    ds_read_b128 v[84:87], v7 offset:432
    ds_read_b128 v[88:91], v7 offset:448
    s_waitcnt lgkmcnt(0)
    v_mul_f32 v53, v20, v72
    v_fmac_f32 v53, v21, v73
    v_fmac_f32 v53, v22, v74
    v_fmac_f32 v53, v23, v75
    v_fmac_f32 v53, v24, v76
    v_fmac_f32 v53, v25, v77
    v_fmac_f32 v53, v26, v78
    v_fmac_f32 v53, v27, v79
    v_fmac_f32 v53, v28, v80
    v_fmac_f32 v53, v29, v81
    v_fmac_f32 v53, v30, v82
    v_fmac_f32 v53, v31, v83
    v_fmac_f32 v53, v32, v84
    v_fmac_f32 v53, v33, v85
    v_fmac_f32 v53, v34, v86
    v_fmac_f32 v53, v35, v87
    v_fmac_f32 v53, v36, v88
    v_fmac_f32 v53, v37, v89
    v_fmac_f32 v53, v38, v90
    v_fmac_f32 v53, v39, v91
    ds_read_b128 v[72:75], v7 offset:512
    ds_read_b128 v[76:79], v7 offset:528
    ds_read_b128 v[80:83], v7 offset:544
    ds_read_b128 v[84:87], v7 offset:560
    ds_read_b128 v[88:91], v7 offset:576
    s_waitcnt lgkmcnt(0)
    v_mul_f32 v54, v20, v72
    v_fmac_f32 v54, v21, v73
    v_fmac_f32 v54, v22, v74
    v_fmac_f32 v54, v23, v75
    v_fmac_f32 v54, v24, v76
    v_fmac_f32 v54, v25, v77
    v_fmac_f32 v54, v26, v78
    v_fmac_f32 v54, v27, v79
    v_fmac_f32 v54, v28, v80
    v_fmac_f32 v54, v29, v81
    v_fmac_f32 v54, v30, v82
    v_fmac_f32 v54, v31, v83
    v_fmac_f32 v54, v32, v84
    v_fmac_f32 v54, v33, v85
    v_fmac_f32 v54, v34, v86
    v_fmac_f32 v54, v35, v87
    v_fmac_f32 v54, v36, v88
    v_fmac_f32 v54, v37, v89
    v_fmac_f32 v54, v38, v90
    v_fmac_f32 v54, v39, v91
    ds_read_b128 v[72:75], v7 offset:640
    ds_read_b128 v[76:79], v7 offset:656
    ds_read_b128 v[80:83], v7 offset:672
    ds_read_b128 v[84:87], v7 offset:688
    ds_read_b128 v[88:91], v7 offset:704
    s_waitcnt lgkmcnt(0)
    v_mul_f32 v55, v20, v72
    v_fmac_f32 v55, v21, v73
    v_fmac_f32 v55, v22, v74
    v_fmac_f32 v55, v23, v75
    v_fmac_f32 v55, v24, v76
    v_fmac_f32 v55, v25, v77
    v_fmac_f32 v55, v26, v78
    v_fmac_f32 v55, v27, v79
    v_fmac_f32 v55, v28, v80
    v_fmac_f32 v55, v29, v81
    v_fmac_f32 v55, v30, v82
    v_fmac_f32 v55, v31, v83
    v_fmac_f32 v55, v32, v84
    v_fmac_f32 v55, v33, v85
    v_fmac_f32 v55, v34, v86
    v_fmac_f32 v55, v35, v87
    v_fmac_f32 v55, v36, v88
    v_fmac_f32 v55, v37, v89
    v_fmac_f32 v55, v38, v90
    v_fmac_f32 v55, v39, v91
    ds_read_b128 v[72:75], v7 offset:768
    ds_read_b128 v[76:79], v7 offset:784
    ds_read_b128 v[80:83], v7 offset:800
    ds_read_b128 v[84:87], v7 offset:816
    ds_read_b128 v[88:91], v7 offset:832
    s_waitcnt lgkmcnt(0)
    v_mul_f32 v56, v20, v72
    v_fmac_f32 v56, v21, v73
    v_fmac_f32 v56, v22, v74
    v_fmac_f32 v56, v23, v75
    v_fmac_f32 v56, v24, v76
    v_fmac_f32 v56, v25, v77
    v_fmac_f32 v56, v26, v78
    v_fmac_f32 v56, v27, v79
    v_fmac_f32 v56, v28, v80
    v_fmac_f32 v56, v29, v81
    v_fmac_f32 v56, v30, v82
    v_fmac_f32 v56, v31, v83
    v_fmac_f32 v56, v32, v84
    v_fmac_f32 v56, v33, v85
    v_fmac_f32 v56, v34, v86
    v_fmac_f32 v56, v35, v87
    v_fmac_f32 v56, v36, v88
    v_fmac_f32 v56, v37, v89
    v_fmac_f32 v56, v38, v90
    v_fmac_f32 v56, v39, v91
    ds_read_b128 v[72:75], v7 offset:896
    ds_read_b128 v[76:79], v7 offset:912
    ds_read_b128 v[80:83], v7 offset:928
    ds_read_b128 v[84:87], v7 offset:944
    ds_read_b128 v[88:91], v7 offset:960
    s_waitcnt lgkmcnt(0)
    v_mul_f32 v57, v20, v72
    v_fmac_f32 v57, v21, v73
    v_fmac_f32 v57, v22, v74
    v_fmac_f32 v57, v23, v75
    v_fmac_f32 v57, v24, v76
    v_fmac_f32 v57, v25, v77
    v_fmac_f32 v57, v26, v78
    v_fmac_f32 v57, v27, v79
    v_fmac_f32 v57, v28, v80
    v_fmac_f32 v57, v29, v81
    v_fmac_f32 v57, v30, v82
    v_fmac_f32 v57, v31, v83
    v_fmac_f32 v57, v32, v84
    v_fmac_f32 v57, v33, v85
    v_fmac_f32 v57, v34, v86
    v_fmac_f32 v57, v35, v87
    v_fmac_f32 v57, v36, v88
    v_fmac_f32 v57, v37, v89
    v_fmac_f32 v57, v38, v90
    v_fmac_f32 v57, v39, v91
    ds_read_b128 v[72:75], v7 offset:1024
    ds_read_b128 v[76:79], v7 offset:1040
    ds_read_b128 v[80:83], v7 offset:1056
    ds_read_b128 v[84:87], v7 offset:1072
    ds_read_b128 v[88:91], v7 offset:1088
    s_waitcnt lgkmcnt(0)
    v_mul_f32 v58, v20, v72
    v_fmac_f32 v58, v21, v73
    v_fmac_f32 v58, v22, v74
    v_fmac_f32 v58, v23, v75
    v_fmac_f32 v58, v24, v76
    v_fmac_f32 v58, v25, v77
    v_fmac_f32 v58, v26, v78
    v_fmac_f32 v58, v27, v79
    v_fmac_f32 v58, v28, v80
    v_fmac_f32 v58, v29, v81
    v_fmac_f32 v58, v30, v82
    v_fmac_f32 v58, v31, v83
    v_fmac_f32 v58, v32, v84
    v_fmac_f32 v58, v33, v85
    v_fmac_f32 v58, v34, v86
    v_fmac_f32 v58, v35, v87
    v_fmac_f32 v58, v36, v88
    v_fmac_f32 v58, v37, v89
    v_fmac_f32 v58, v38, v90
    v_fmac_f32 v58, v39, v91
    ds_read_b128 v[72:75], v7 offset:1152
    ds_read_b128 v[76:79], v7 offset:1168
    ds_read_b128 v[80:83], v7 offset:1184
    ds_read_b128 v[84:87], v7 offset:1200
    ds_read_b128 v[88:91], v7 offset:1216
    s_waitcnt lgkmcnt(0)
    v_mul_f32 v59, v20, v72
    v_fmac_f32 v59, v21, v73
    v_fmac_f32 v59, v22, v74
    v_fmac_f32 v59, v23, v75
    v_fmac_f32 v59, v24, v76
    v_fmac_f32 v59, v25, v77
    v_fmac_f32 v59, v26, v78
    v_fmac_f32 v59, v27, v79
    v_fmac_f32 v59, v28, v80
    v_fmac_f32 v59, v29, v81
    v_fmac_f32 v59, v30, v82
    v_fmac_f32 v59, v31, v83
    v_fmac_f32 v59, v32, v84
    v_fmac_f32 v59, v33, v85
    v_fmac_f32 v59, v34, v86
    v_fmac_f32 v59, v35, v87
    v_fmac_f32 v59, v36, v88
    v_fmac_f32 v59, v37, v89
    v_fmac_f32 v59, v38, v90
    v_fmac_f32 v59, v39, v91
    ds_read_b128 v[72:75], v7 offset:1280
    ds_read_b128 v[76:79], v7 offset:1296
    ds_read_b128 v[80:83], v7 offset:1312
    ds_read_b128 v[84:87], v7 offset:1328
    ds_read_b128 v[88:91], v7 offset:1344
    s_waitcnt lgkmcnt(0)
    v_mul_f32 v60, v20, v72
    v_fmac_f32 v60, v21, v73
    v_fmac_f32 v60, v22, v74
    v_fmac_f32 v60, v23, v75
    v_fmac_f32 v60, v24, v76
    v_fmac_f32 v60, v25, v77
    v_fmac_f32 v60, v26, v78
    v_fmac_f32 v60, v27, v79
    v_fmac_f32 v60, v28, v80
    v_fmac_f32 v60, v29, v81
    v_fmac_f32 v60, v30, v82
    v_fmac_f32 v60, v31, v83
    v_fmac_f32 v60, v32, v84
    v_fmac_f32 v60, v33, v85
    v_fmac_f32 v60, v34, v86
    v_fmac_f32 v60, v35, v87
    v_fmac_f32 v60, v36, v88
    v_fmac_f32 v60, v37, v89
    v_fmac_f32 v60, v38, v90
    v_fmac_f32 v60, v39, v91
    ds_read_b128 v[72:75], v7 offset:1408
    ds_read_b128 v[76:79], v7 offset:1424
    ds_read_b128 v[80:83], v7 offset:1440
    ds_read_b128 v[84:87], v7 offset:1456
    ds_read_b128 v[88:91], v7 offset:1472
    s_waitcnt lgkmcnt(0)
    v_mul_f32 v61, v20, v72
    v_fmac_f32 v61, v21, v73
    v_fmac_f32 v61, v22, v74
    v_fmac_f32 v61, v23, v75
    v_fmac_f32 v61, v24, v76
    v_fmac_f32 v61, v25, v77
    v_fmac_f32 v61, v26, v78
    v_fmac_f32 v61, v27, v79
    v_fmac_f32 v61, v28, v80
    v_fmac_f32 v61, v29, v81
    v_fmac_f32 v61, v30, v82
    v_fmac_f32 v61, v31, v83
    v_fmac_f32 v61, v32, v84
    v_fmac_f32 v61, v33, v85
    v_fmac_f32 v61, v34, v86
    v_fmac_f32 v61, v35, v87
    v_fmac_f32 v61, v36, v88
    v_fmac_f32 v61, v37, v89
    v_fmac_f32 v61, v38, v90
    v_fmac_f32 v61, v39, v91
    ds_read_b128 v[72:75], v7 offset:1536
    ds_read_b128 v[76:79], v7 offset:1552
    ds_read_b128 v[80:83], v7 offset:1568
    ds_read_b128 v[84:87], v7 offset:1584
    ds_read_b128 v[88:91], v7 offset:1600
    s_waitcnt lgkmcnt(0)
    v_mul_f32 v62, v20, v72
    v_fmac_f32 v62, v21, v73
    v_fmac_f32 v62, v22, v74
    v_fmac_f32 v62, v23, v75
    v_fmac_f32 v62, v24, v76
    v_fmac_f32 v62, v25, v77
    v_fmac_f32 v62, v26, v78
    v_fmac_f32 v62, v27, v79
    v_fmac_f32 v62, v28, v80
    v_fmac_f32 v62, v29, v81
    v_fmac_f32 v62, v30, v82
    v_fmac_f32 v62, v31, v83
    v_fmac_f32 v62, v32, v84
    v_fmac_f32 v62, v33, v85
    v_fmac_f32 v62, v34, v86
    v_fmac_f32 v62, v35, v87
    v_fmac_f32 v62, v36, v88
    v_fmac_f32 v62, v37, v89
    v_fmac_f32 v62, v38, v90
    v_fmac_f32 v62, v39, v91
    ds_read_b128 v[72:75], v7 offset:1664
    ds_read_b128 v[76:79], v7 offset:1680
    ds_read_b128 v[80:83], v7 offset:1696
    ds_read_b128 v[84:87], v7 offset:1712
    ds_read_b128 v[88:91], v7 offset:1728
    s_waitcnt lgkmcnt(0)
    v_mul_f32 v63, v20, v72
    v_fmac_f32 v63, v21, v73
    v_fmac_f32 v63, v22, v74
    v_fmac_f32 v63, v23, v75
    v_fmac_f32 v63, v24, v76
    v_fmac_f32 v63, v25, v77
    v_fmac_f32 v63, v26, v78
    v_fmac_f32 v63, v27, v79
    v_fmac_f32 v63, v28, v80
    v_fmac_f32 v63, v29, v81
    v_fmac_f32 v63, v30, v82
    v_fmac_f32 v63, v31, v83
    v_fmac_f32 v63, v32, v84
    v_fmac_f32 v63, v33, v85
    v_fmac_f32 v63, v34, v86
    v_fmac_f32 v63, v35, v87
    v_fmac_f32 v63, v36, v88
    v_fmac_f32 v63, v37, v89
    v_fmac_f32 v63, v38, v90
    v_fmac_f32 v63, v39, v91
    ds_read_b128 v[72:75], v7 offset:1792
    ds_read_b128 v[76:79], v7 offset:1808
    ds_read_b128 v[80:83], v7 offset:1824
    ds_read_b128 v[84:87], v7 offset:1840
    ds_read_b128 v[88:91], v7 offset:1856
    s_waitcnt lgkmcnt(0)
    v_mul_f32 v64, v20, v72
    v_fmac_f32 v64, v21, v73
    v_fmac_f32 v64, v22, v74
    v_fmac_f32 v64, v23, v75
    v_fmac_f32 v64, v24, v76
    v_fmac_f32 v64, v25, v77
    v_fmac_f32 v64, v26, v78
    v_fmac_f32 v64, v27, v79
    v_fmac_f32 v64, v28, v80
    v_fmac_f32 v64, v29, v81
    v_fmac_f32 v64, v30, v82
    v_fmac_f32 v64, v31, v83
    v_fmac_f32 v64, v32, v84
    v_fmac_f32 v64, v33, v85
    v_fmac_f32 v64, v34, v86
    v_fmac_f32 v64, v35, v87
    v_fmac_f32 v64, v36, v88
    v_fmac_f32 v64, v37, v89
    v_fmac_f32 v64, v38, v90
    v_fmac_f32 v64, v39, v91
    ds_read_b128 v[72:75], v7 offset:1920
    ds_read_b128 v[76:79], v7 offset:1936
    ds_read_b128 v[80:83], v7 offset:1952
    ds_read_b128 v[84:87], v7 offset:1968
    ds_read_b128 v[88:91], v7 offset:1984
    s_waitcnt lgkmcnt(0)
    v_mul_f32 v65, v20, v72
    v_fmac_f32 v65, v21, v73
    v_fmac_f32 v65, v22, v74
    v_fmac_f32 v65, v23, v75
    v_fmac_f32 v65, v24, v76
    v_fmac_f32 v65, v25, v77
    v_fmac_f32 v65, v26, v78
    v_fmac_f32 v65, v27, v79
    v_fmac_f32 v65, v28, v80
    v_fmac_f32 v65, v29, v81
    v_fmac_f32 v65, v30, v82
    v_fmac_f32 v65, v31, v83
    v_fmac_f32 v65, v32, v84
    v_fmac_f32 v65, v33, v85
    v_fmac_f32 v65, v34, v86
    v_fmac_f32 v65, v35, v87
    v_fmac_f32 v65, v36, v88
    v_fmac_f32 v65, v37, v89
    v_fmac_f32 v65, v38, v90
    v_fmac_f32 v65, v39, v91
    ds_read_b128 v[72:75], v7 offset:2048
    ds_read_b128 v[76:79], v7 offset:2064
    ds_read_b128 v[80:83], v7 offset:2080
    ds_read_b128 v[84:87], v7 offset:2096
    ds_read_b128 v[88:91], v7 offset:2112
    s_waitcnt lgkmcnt(0)
    v_mul_f32 v66, v20, v72
    v_fmac_f32 v66, v21, v73
    v_fmac_f32 v66, v22, v74
    v_fmac_f32 v66, v23, v75
    v_fmac_f32 v66, v24, v76
    v_fmac_f32 v66, v25, v77
    v_fmac_f32 v66, v26, v78
    v_fmac_f32 v66, v27, v79
    v_fmac_f32 v66, v28, v80
    v_fmac_f32 v66, v29, v81
    v_fmac_f32 v66, v30, v82
    v_fmac_f32 v66, v31, v83
    v_fmac_f32 v66, v32, v84
    v_fmac_f32 v66, v33, v85
    v_fmac_f32 v66, v34, v86
    v_fmac_f32 v66, v35, v87
    v_fmac_f32 v66, v36, v88
    v_fmac_f32 v66, v37, v89
    v_fmac_f32 v66, v38, v90
    v_fmac_f32 v66, v39, v91
    ds_read_b128 v[72:75], v7 offset:2176
    ds_read_b128 v[76:79], v7 offset:2192
    ds_read_b128 v[80:83], v7 offset:2208
    ds_read_b128 v[84:87], v7 offset:2224
    ds_read_b128 v[88:91], v7 offset:2240
    s_waitcnt lgkmcnt(0)
    v_mul_f32 v67, v20, v72
    v_fmac_f32 v67, v21, v73
    v_fmac_f32 v67, v22, v74
    v_fmac_f32 v67, v23, v75
    v_fmac_f32 v67, v24, v76
    v_fmac_f32 v67, v25, v77
    v_fmac_f32 v67, v26, v78
    v_fmac_f32 v67, v27, v79
    v_fmac_f32 v67, v28, v80
    v_fmac_f32 v67, v29, v81
    v_fmac_f32 v67, v30, v82
    v_fmac_f32 v67, v31, v83
    v_fmac_f32 v67, v32, v84
    v_fmac_f32 v67, v33, v85
    v_fmac_f32 v67, v34, v86
    v_fmac_f32 v67, v35, v87
    v_fmac_f32 v67, v36, v88
    v_fmac_f32 v67, v37, v89
    v_fmac_f32 v67, v38, v90
    v_fmac_f32 v67, v39, v91
    ds_read_b128 v[72:75], v7 offset:2304
    ds_read_b128 v[76:79], v7 offset:2320
    ds_read_b128 v[80:83], v7 offset:2336
    ds_read_b128 v[84:87], v7 offset:2352
    ds_read_b128 v[88:91], v7 offset:2368
    s_waitcnt lgkmcnt(0)
    v_mul_f32 v68, v20, v72
    v_fmac_f32 v68, v21, v73
    v_fmac_f32 v68, v22, v74
    v_fmac_f32 v68, v23, v75
    v_fmac_f32 v68, v24, v76
    v_fmac_f32 v68, v25, v77
    v_fmac_f32 v68, v26, v78
    v_fmac_f32 v68, v27, v79
    v_fmac_f32 v68, v28, v80
    v_fmac_f32 v68, v29, v81
    v_fmac_f32 v68, v30, v82
    v_fmac_f32 v68, v31, v83
    v_fmac_f32 v68, v32, v84
    v_fmac_f32 v68, v33, v85
    v_fmac_f32 v68, v34, v86
    v_fmac_f32 v68, v35, v87
    v_fmac_f32 v68, v36, v88
    v_fmac_f32 v68, v37, v89
    v_fmac_f32 v68, v38, v90
    v_fmac_f32 v68, v39, v91
    ds_read_b128 v[72:75], v7 offset:2432
    ds_read_b128 v[76:79], v7 offset:2448
    ds_read_b128 v[80:83], v7 offset:2464
    ds_read_b128 v[84:87], v7 offset:2480
    ds_read_b128 v[88:91], v7 offset:2496
    s_waitcnt lgkmcnt(0)
    v_mul_f32 v69, v20, v72
    v_fmac_f32 v69, v21, v73
    v_fmac_f32 v69, v22, v74
    v_fmac_f32 v69, v23, v75
    v_fmac_f32 v69, v24, v76
    v_fmac_f32 v69, v25, v77
    v_fmac_f32 v69, v26, v78
    v_fmac_f32 v69, v27, v79
    v_fmac_f32 v69, v28, v80
    v_fmac_f32 v69, v29, v81
    v_fmac_f32 v69, v30, v82
    v_fmac_f32 v69, v31, v83
    v_fmac_f32 v69, v32, v84
    v_fmac_f32 v69, v33, v85
    v_fmac_f32 v69, v34, v86
    v_fmac_f32 v69, v35, v87
    v_fmac_f32 v69, v36, v88
    v_fmac_f32 v69, v37, v89
    v_fmac_f32 v69, v38, v90
    v_fmac_f32 v69, v39, v91
    ds_read_b128 v[72:75], v7 offset:2560
    ds_read_b128 v[76:79], v7 offset:2576
    ds_read_b128 v[80:83], v7 offset:2592
    ds_read_b128 v[84:87], v7 offset:2608
    ds_read_b128 v[88:91], v7 offset:2624
    s_waitcnt lgkmcnt(0)
    v_mul_f32 v70, v20, v72
    v_fmac_f32 v70, v21, v73
    v_fmac_f32 v70, v22, v74
    v_fmac_f32 v70, v23, v75
    v_fmac_f32 v70, v24, v76
    v_fmac_f32 v70, v25, v77
    v_fmac_f32 v70, v26, v78
    v_fmac_f32 v70, v27, v79
    v_fmac_f32 v70, v28, v80
    v_fmac_f32 v70, v29, v81
    v_fmac_f32 v70, v30, v82
    v_fmac_f32 v70, v31, v83
    v_fmac_f32 v70, v32, v84
    v_fmac_f32 v70, v33, v85
    v_fmac_f32 v70, v34, v86
    v_fmac_f32 v70, v35, v87
    v_fmac_f32 v70, v36, v88
    v_fmac_f32 v70, v37, v89
    v_fmac_f32 v70, v38, v90
    v_fmac_f32 v70, v39, v91
    v_add_f32 v70, 0x358637bd, v70
    v_rcp_f32 v70, v70
    s_nop 0
    v_mul_f32 v50, v50, v70
    v_mul_f32 v51, v51, v70
    v_mul_f32 v52, v52, v70
    v_mul_f32 v53, v53, v70
    v_mul_f32 v54, v54, v70
    v_mul_f32 v55, v55, v70
    v_mul_f32 v56, v56, v70
    v_mul_f32 v57, v57, v70
    v_mul_f32 v58, v58, v70
    v_mul_f32 v59, v59, v70
    v_mul_f32 v60, v60, v70
    v_mul_f32 v61, v61, v70
    v_mul_f32 v62, v62, v70
    v_mul_f32 v63, v63, v70
    v_mul_f32 v64, v64, v70
    v_mul_f32 v65, v65, v70
    v_mul_f32 v66, v66, v70
    v_mul_f32 v67, v67, v70
    v_mul_f32 v68, v68, v70
    v_mul_f32 v69, v69, v70
    v_cvt_pk_bf16_f32 v8, v50, v51
    v_cvt_pk_bf16_f32 v9, v52, v53
    v_cvt_pk_bf16_f32 v10, v54, v55
    v_cvt_pk_bf16_f32 v11, v56, v57
    v_cvt_pk_bf16_f32 v12, v58, v59
    v_cvt_pk_bf16_f32 v13, v60, v61
    v_cvt_pk_bf16_f32 v14, v62, v63
    v_cvt_pk_bf16_f32 v15, v64, v65
    v_cvt_pk_bf16_f32 v16, v66, v67
    v_cvt_pk_bf16_f32 v17, v68, v69
    v_add_u32 v6, 18874368, v4
    buffer_store_dwordx2 v[8:9], v6, s[8:11], 0 offen offset:0
    buffer_store_dwordx2 v[10:11], v6, s[8:11], 0 offen offset:8
    buffer_store_dwordx2 v[12:13], v6, s[8:11], 0 offen offset:16
    buffer_store_dwordx2 v[14:15], v6, s[8:11], 0 offen offset:24
    buffer_store_dwordx2 v[16:17], v6, s[8:11], 0 offen offset:32
attn_a2_kernel_end:
    s_endpgm
.section .rodata,"a"
.p2align 6
.amdhsa_kernel attn_a2_kernel
  .amdhsa_next_free_vgpr 96
  .amdhsa_next_free_sgpr 40
  .amdhsa_accum_offset 96
  .amdhsa_group_segment_fixed_size 0
  .amdhsa_kernarg_size 104
  .amdhsa_user_sgpr_count 2
  .amdhsa_user_sgpr_kernarg_segment_ptr 1
  .amdhsa_system_sgpr_workgroup_id_x 1
.end_amdhsa_kernel
.text
.globl wo_a2_kernel
.p2align 8
.type wo_a2_kernel,@function
wo_a2_kernel:
    v_lshrrev_b32 v1, 6, v0
    v_and_b32 v2, 63, v0
    s_nop 0
    v_readfirstlane_b32 s3, v1
    s_cmp_ge_u32 s2, 128
    s_cbranch_scc1 wo_a2_kernel_end
    s_load_dwordx2 s[4:5], s[0:1], 96
    s_load_dwordx2 s[6:7], s[0:1], 80
    s_mul_i32 s20, s2, 1
    s_lshr_b32 s20, s20, 3
    s_mul_i32 s21, s20, 8
    s_sub_u32 s21, s2, s21
    s_lshl_b32 s20, s20, 2
    s_add_u32 s20, s20, s3
    s_mul_i32 s22, s20, 32
    s_mul_i32 s23, s21, 80
    s_waitcnt lgkmcnt(0)
    s_mov_b32 s8, s4
    s_mov_b32 s9, s5
    s_mov_b32 s10, 268435456
    s_mov_b32 s11, 0x00020000
    v_and_b32 v3, 15, v2
    v_lshrrev_b32 v4, 4, v2
    s_mov_b32 s24, 1280
    v_add_u32 v5, s22, v3
    v_mul_lo_u32 v5, v5, s24
    v_lshlrev_b32 v6, 4, v4
    v_add_u32 v5, v5, v6
    v_add_u32 v5, 18874368, v5
    v_mov_b32 v8, v5
    v_add_u32 v9, 20480, v5
    v_lshlrev_b32 v7, 4, v2
    s_mov_b32 s25, 0
    s_mov_b32 s26, 0
    s_mul_i32 s27, s21, 102400
    s_add_u32 s27, s27, s26
    s_add_u32 s27, s27, 29360128
    s_add_u32 s32, s27, 0
    s_add_u32 s33, s27, 20480
    s_add_u32 s34, s27, 40960
    s_add_u32 s35, s27, 61440
    s_add_u32 s36, s27, 81920
    v_accvgpr_write_b32 a0, 0
    v_accvgpr_write_b32 a1, 0
    v_accvgpr_write_b32 a2, 0
    v_accvgpr_write_b32 a3, 0
    v_accvgpr_write_b32 a4, 0
    v_accvgpr_write_b32 a5, 0
    v_accvgpr_write_b32 a6, 0
    v_accvgpr_write_b32 a7, 0
    v_accvgpr_write_b32 a8, 0
    v_accvgpr_write_b32 a9, 0
    v_accvgpr_write_b32 a10, 0
    v_accvgpr_write_b32 a11, 0
    v_accvgpr_write_b32 a12, 0
    v_accvgpr_write_b32 a13, 0
    v_accvgpr_write_b32 a14, 0
    v_accvgpr_write_b32 a15, 0
    v_accvgpr_write_b32 a16, 0
    v_accvgpr_write_b32 a17, 0
    v_accvgpr_write_b32 a18, 0
    v_accvgpr_write_b32 a19, 0
    v_accvgpr_write_b32 a20, 0
    v_accvgpr_write_b32 a21, 0
    v_accvgpr_write_b32 a22, 0
    v_accvgpr_write_b32 a23, 0
    v_accvgpr_write_b32 a24, 0
    v_accvgpr_write_b32 a25, 0
    v_accvgpr_write_b32 a26, 0
    v_accvgpr_write_b32 a27, 0
    v_accvgpr_write_b32 a28, 0
    v_accvgpr_write_b32 a29, 0
    v_accvgpr_write_b32 a30, 0
    v_accvgpr_write_b32 a31, 0
    v_accvgpr_write_b32 a32, 0
    v_accvgpr_write_b32 a33, 0
    v_accvgpr_write_b32 a34, 0
    v_accvgpr_write_b32 a35, 0
    v_accvgpr_write_b32 a36, 0
    v_accvgpr_write_b32 a37, 0
    v_accvgpr_write_b32 a38, 0
    v_accvgpr_write_b32 a39, 0
    buffer_load_dwordx4 v[16:19], v8, s[8:11], s25 offen
    buffer_load_dwordx4 v[20:23], v9, s[8:11], s25 offen
    buffer_load_dwordx4 v[24:27], v7, s[8:11], s32 offen
    buffer_load_dwordx4 v[28:31], v7, s[8:11], s33 offen
    buffer_load_dwordx4 v[32:35], v7, s[8:11], s34 offen
    buffer_load_dwordx4 v[36:39], v7, s[8:11], s35 offen
    buffer_load_dwordx4 v[40:43], v7, s[8:11], s36 offen
    s_mov_b32 s28, 10
wo_a2_kernel_loop0:
    s_add_u32 s25, s25, 64
    s_add_u32 s32, s32, 1024
    s_add_u32 s33, s33, 1024
    s_add_u32 s34, s34, 1024
    s_add_u32 s35, s35, 1024
    s_add_u32 s36, s36, 1024
    buffer_load_dwordx4 v[44:47], v8, s[8:11], s25 offen
    buffer_load_dwordx4 v[48:51], v9, s[8:11], s25 offen
    buffer_load_dwordx4 v[52:55], v7, s[8:11], s32 offen
    buffer_load_dwordx4 v[56:59], v7, s[8:11], s33 offen
    buffer_load_dwordx4 v[60:63], v7, s[8:11], s34 offen
    buffer_load_dwordx4 v[64:67], v7, s[8:11], s35 offen
    buffer_load_dwordx4 v[68:71], v7, s[8:11], s36 offen
    s_waitcnt vmcnt(7)
    v_mfma_f32_16x16x32_bf16 a[0:3], v[24:27], v[16:19], a[0:3]
    v_mfma_f32_16x16x32_bf16 a[20:23], v[24:27], v[20:23], a[20:23]
    v_mfma_f32_16x16x32_bf16 a[4:7], v[28:31], v[16:19], a[4:7]
    v_mfma_f32_16x16x32_bf16 a[24:27], v[28:31], v[20:23], a[24:27]
    v_mfma_f32_16x16x32_bf16 a[8:11], v[32:35], v[16:19], a[8:11]
    v_mfma_f32_16x16x32_bf16 a[28:31], v[32:35], v[20:23], a[28:31]
    v_mfma_f32_16x16x32_bf16 a[12:15], v[36:39], v[16:19], a[12:15]
    v_mfma_f32_16x16x32_bf16 a[32:35], v[36:39], v[20:23], a[32:35]
    v_mfma_f32_16x16x32_bf16 a[16:19], v[40:43], v[16:19], a[16:19]
    v_mfma_f32_16x16x32_bf16 a[36:39], v[40:43], v[20:23], a[36:39]
    s_sub_u32 s28, s28, 1
    s_cmp_eq_u32 s28, 0
    s_cbranch_scc1 wo_a2_kernel_loop0_last
    s_add_u32 s25, s25, 64
    s_add_u32 s32, s32, 1024
    s_add_u32 s33, s33, 1024
    s_add_u32 s34, s34, 1024
    s_add_u32 s35, s35, 1024
    s_add_u32 s36, s36, 1024
    buffer_load_dwordx4 v[16:19], v8, s[8:11], s25 offen
    buffer_load_dwordx4 v[20:23], v9, s[8:11], s25 offen
    buffer_load_dwordx4 v[24:27], v7, s[8:11], s32 offen
    buffer_load_dwordx4 v[28:31], v7, s[8:11], s33 offen
    buffer_load_dwordx4 v[32:35], v7, s[8:11], s34 offen
    buffer_load_dwordx4 v[36:39], v7, s[8:11], s35 offen
    buffer_load_dwordx4 v[40:43], v7, s[8:11], s36 offen
    s_waitcnt vmcnt(7)
    v_mfma_f32_16x16x32_bf16 a[0:3], v[52:55], v[44:47], a[0:3]
    v_mfma_f32_16x16x32_bf16 a[20:23], v[52:55], v[48:51], a[20:23]
    v_mfma_f32_16x16x32_bf16 a[4:7], v[56:59], v[44:47], a[4:7]
    v_mfma_f32_16x16x32_bf16 a[24:27], v[56:59], v[48:51], a[24:27]
    v_mfma_f32_16x16x32_bf16 a[8:11], v[60:63], v[44:47], a[8:11]
    v_mfma_f32_16x16x32_bf16 a[28:31], v[60:63], v[48:51], a[28:31]
    v_mfma_f32_16x16x32_bf16 a[12:15], v[64:67], v[44:47], a[12:15]
    v_mfma_f32_16x16x32_bf16 a[32:35], v[64:67], v[48:51], a[32:35]
    v_mfma_f32_16x16x32_bf16 a[16:19], v[68:71], v[44:47], a[16:19]
    v_mfma_f32_16x16x32_bf16 a[36:39], v[68:71], v[48:51], a[36:39]
    s_branch wo_a2_kernel_loop0
wo_a2_kernel_loop0_last:
    s_waitcnt vmcnt(0)
    v_mfma_f32_16x16x32_bf16 a[0:3], v[52:55], v[44:47], a[0:3]
    v_mfma_f32_16x16x32_bf16 a[20:23], v[52:55], v[48:51], a[20:23]
    v_mfma_f32_16x16x32_bf16 a[4:7], v[56:59], v[44:47], a[4:7]
    v_mfma_f32_16x16x32_bf16 a[24:27], v[56:59], v[48:51], a[24:27]
    v_mfma_f32_16x16x32_bf16 a[8:11], v[60:63], v[44:47], a[8:11]
    v_mfma_f32_16x16x32_bf16 a[28:31], v[60:63], v[48:51], a[28:31]
    v_mfma_f32_16x16x32_bf16 a[12:15], v[64:67], v[44:47], a[12:15]
    v_mfma_f32_16x16x32_bf16 a[32:35], v[64:67], v[48:51], a[32:35]
    v_mfma_f32_16x16x32_bf16 a[16:19], v[68:71], v[44:47], a[16:19]
    v_mfma_f32_16x16x32_bf16 a[36:39], v[68:71], v[48:51], a[36:39]
    s_nop 7
    s_nop 7
    s_mov_b32 s24, 1280
    v_add_u32 v5, s22, v3
    v_mul_lo_u32 v5, v5, s24
    v_lshlrev_b32 v6, 3, v4
    s_lshl_b32 s29, s23, 1
    v_add3_u32 v5, v5, v6, s29
    v_add_u32 v6, 4194304, v5
    buffer_load_dwordx2 v[72:73], v6, s[8:11], 0 offen
    v_accvgpr_read_b32 v76, a0
    v_accvgpr_read_b32 v77, a1
    v_accvgpr_read_b32 v78, a2
    v_accvgpr_read_b32 v79, a3
    v_cvt_pk_bf16_f32 v80, v76, v77
    v_cvt_pk_bf16_f32 v81, v78, v79
    s_waitcnt vmcnt(0)
    v_lshlrev_b32 v76, 16, v80
    v_and_b32 v77, 0xffff0000, v80
    v_lshlrev_b32 v82, 16, v72
    v_and_b32 v83, 0xffff0000, v72
    v_add_f32 v76, v76, v82
    v_add_f32 v77, v77, v83
    v_lshlrev_b32 v78, 16, v81
    v_and_b32 v79, 0xffff0000, v81
    v_lshlrev_b32 v82, 16, v73
    v_and_b32 v83, 0xffff0000, v73
    v_add_f32 v78, v78, v82
    v_add_f32 v79, v79, v83
    v_cvt_pk_bf16_f32 v80, v76, v77
    v_cvt_pk_bf16_f32 v81, v78, v79
    v_add_u32 v6, 4194304, v5
    buffer_store_dwordx2 v[80:81], v6, s[8:11], 0 offen
    v_add_u32 v6, 4194336, v5
    buffer_load_dwordx2 v[72:73], v6, s[8:11], 0 offen
    v_accvgpr_read_b32 v76, a4
    v_accvgpr_read_b32 v77, a5
    v_accvgpr_read_b32 v78, a6
    v_accvgpr_read_b32 v79, a7
    v_cvt_pk_bf16_f32 v80, v76, v77
    v_cvt_pk_bf16_f32 v81, v78, v79
    s_waitcnt vmcnt(0)
    v_lshlrev_b32 v76, 16, v80
    v_and_b32 v77, 0xffff0000, v80
    v_lshlrev_b32 v82, 16, v72
    v_and_b32 v83, 0xffff0000, v72
    v_add_f32 v76, v76, v82
    v_add_f32 v77, v77, v83
    v_lshlrev_b32 v78, 16, v81
    v_and_b32 v79, 0xffff0000, v81
    v_lshlrev_b32 v82, 16, v73
    v_and_b32 v83, 0xffff0000, v73
    v_add_f32 v78, v78, v82
    v_add_f32 v79, v79, v83
    v_cvt_pk_bf16_f32 v80, v76, v77
    v_cvt_pk_bf16_f32 v81, v78, v79
    v_add_u32 v6, 4194336, v5
    buffer_store_dwordx2 v[80:81], v6, s[8:11], 0 offen
    v_add_u32 v6, 4194368, v5
    buffer_load_dwordx2 v[72:73], v6, s[8:11], 0 offen
    v_accvgpr_read_b32 v76, a8
    v_accvgpr_read_b32 v77, a9
    v_accvgpr_read_b32 v78, a10
    v_accvgpr_read_b32 v79, a11
    v_cvt_pk_bf16_f32 v80, v76, v77
    v_cvt_pk_bf16_f32 v81, v78, v79
    s_waitcnt vmcnt(0)
    v_lshlrev_b32 v76, 16, v80
    v_and_b32 v77, 0xffff0000, v80
    v_lshlrev_b32 v82, 16, v72
    v_and_b32 v83, 0xffff0000, v72
    v_add_f32 v76, v76, v82
    v_add_f32 v77, v77, v83
    v_lshlrev_b32 v78, 16, v81
    v_and_b32 v79, 0xffff0000, v81
    v_lshlrev_b32 v82, 16, v73
    v_and_b32 v83, 0xffff0000, v73
    v_add_f32 v78, v78, v82
    v_add_f32 v79, v79, v83
    v_cvt_pk_bf16_f32 v80, v76, v77
    v_cvt_pk_bf16_f32 v81, v78, v79
    v_add_u32 v6, 4194368, v5
    buffer_store_dwordx2 v[80:81], v6, s[8:11], 0 offen
    v_add_u32 v6, 4194400, v5
    buffer_load_dwordx2 v[72:73], v6, s[8:11], 0 offen
    v_accvgpr_read_b32 v76, a12
    v_accvgpr_read_b32 v77, a13
    v_accvgpr_read_b32 v78, a14
    v_accvgpr_read_b32 v79, a15
    v_cvt_pk_bf16_f32 v80, v76, v77
    v_cvt_pk_bf16_f32 v81, v78, v79
    s_waitcnt vmcnt(0)
    v_lshlrev_b32 v76, 16, v80
    v_and_b32 v77, 0xffff0000, v80
    v_lshlrev_b32 v82, 16, v72
    v_and_b32 v83, 0xffff0000, v72
    v_add_f32 v76, v76, v82
    v_add_f32 v77, v77, v83
    v_lshlrev_b32 v78, 16, v81
    v_and_b32 v79, 0xffff0000, v81
    v_lshlrev_b32 v82, 16, v73
    v_and_b32 v83, 0xffff0000, v73
    v_add_f32 v78, v78, v82
    v_add_f32 v79, v79, v83
    v_cvt_pk_bf16_f32 v80, v76, v77
    v_cvt_pk_bf16_f32 v81, v78, v79
    v_add_u32 v6, 4194400, v5
    buffer_store_dwordx2 v[80:81], v6, s[8:11], 0 offen
    v_add_u32 v6, 4194432, v5
    buffer_load_dwordx2 v[72:73], v6, s[8:11], 0 offen
    v_accvgpr_read_b32 v76, a16
    v_accvgpr_read_b32 v77, a17
    v_accvgpr_read_b32 v78, a18
    v_accvgpr_read_b32 v79, a19
    v_cvt_pk_bf16_f32 v80, v76, v77
    v_cvt_pk_bf16_f32 v81, v78, v79
    s_waitcnt vmcnt(0)
    v_lshlrev_b32 v76, 16, v80
    v_and_b32 v77, 0xffff0000, v80
    v_lshlrev_b32 v82, 16, v72
    v_and_b32 v83, 0xffff0000, v72
    v_add_f32 v76, v76, v82
    v_add_f32 v77, v77, v83
    v_lshlrev_b32 v78, 16, v81
    v_and_b32 v79, 0xffff0000, v81
    v_lshlrev_b32 v82, 16, v73
    v_and_b32 v83, 0xffff0000, v73
    v_add_f32 v78, v78, v82
    v_add_f32 v79, v79, v83
    v_cvt_pk_bf16_f32 v80, v76, v77
    v_cvt_pk_bf16_f32 v81, v78, v79
    v_add_u32 v6, 4194432, v5
    buffer_store_dwordx2 v[80:81], v6, s[8:11], 0 offen
    v_add_u32 v6, 4214784, v5
    buffer_load_dwordx2 v[72:73], v6, s[8:11], 0 offen
    v_accvgpr_read_b32 v76, a20
    v_accvgpr_read_b32 v77, a21
    v_accvgpr_read_b32 v78, a22
    v_accvgpr_read_b32 v79, a23
    v_cvt_pk_bf16_f32 v80, v76, v77
    v_cvt_pk_bf16_f32 v81, v78, v79
    s_waitcnt vmcnt(0)
    v_lshlrev_b32 v76, 16, v80
    v_and_b32 v77, 0xffff0000, v80
    v_lshlrev_b32 v82, 16, v72
    v_and_b32 v83, 0xffff0000, v72
    v_add_f32 v76, v76, v82
    v_add_f32 v77, v77, v83
    v_lshlrev_b32 v78, 16, v81
    v_and_b32 v79, 0xffff0000, v81
    v_lshlrev_b32 v82, 16, v73
    v_and_b32 v83, 0xffff0000, v73
    v_add_f32 v78, v78, v82
    v_add_f32 v79, v79, v83
    v_cvt_pk_bf16_f32 v80, v76, v77
    v_cvt_pk_bf16_f32 v81, v78, v79
    v_add_u32 v6, 4214784, v5
    buffer_store_dwordx2 v[80:81], v6, s[8:11], 0 offen
    v_add_u32 v6, 4214816, v5
    buffer_load_dwordx2 v[72:73], v6, s[8:11], 0 offen
    v_accvgpr_read_b32 v76, a24
    v_accvgpr_read_b32 v77, a25
    v_accvgpr_read_b32 v78, a26
    v_accvgpr_read_b32 v79, a27
    v_cvt_pk_bf16_f32 v80, v76, v77
    v_cvt_pk_bf16_f32 v81, v78, v79
    s_waitcnt vmcnt(0)
    v_lshlrev_b32 v76, 16, v80
    v_and_b32 v77, 0xffff0000, v80
    v_lshlrev_b32 v82, 16, v72
    v_and_b32 v83, 0xffff0000, v72
    v_add_f32 v76, v76, v82
    v_add_f32 v77, v77, v83
    v_lshlrev_b32 v78, 16, v81
    v_and_b32 v79, 0xffff0000, v81
    v_lshlrev_b32 v82, 16, v73
    v_and_b32 v83, 0xffff0000, v73
    v_add_f32 v78, v78, v82
    v_add_f32 v79, v79, v83
    v_cvt_pk_bf16_f32 v80, v76, v77
    v_cvt_pk_bf16_f32 v81, v78, v79
    v_add_u32 v6, 4214816, v5
    buffer_store_dwordx2 v[80:81], v6, s[8:11], 0 offen
    v_add_u32 v6, 4214848, v5
    buffer_load_dwordx2 v[72:73], v6, s[8:11], 0 offen
    v_accvgpr_read_b32 v76, a28
    v_accvgpr_read_b32 v77, a29
    v_accvgpr_read_b32 v78, a30
    v_accvgpr_read_b32 v79, a31
    v_cvt_pk_bf16_f32 v80, v76, v77
    v_cvt_pk_bf16_f32 v81, v78, v79
    s_waitcnt vmcnt(0)
    v_lshlrev_b32 v76, 16, v80
    v_and_b32 v77, 0xffff0000, v80
    v_lshlrev_b32 v82, 16, v72
    v_and_b32 v83, 0xffff0000, v72
    v_add_f32 v76, v76, v82
    v_add_f32 v77, v77, v83
    v_lshlrev_b32 v78, 16, v81
    v_and_b32 v79, 0xffff0000, v81
    v_lshlrev_b32 v82, 16, v73
    v_and_b32 v83, 0xffff0000, v73
    v_add_f32 v78, v78, v82
    v_add_f32 v79, v79, v83
    v_cvt_pk_bf16_f32 v80, v76, v77
    v_cvt_pk_bf16_f32 v81, v78, v79
    v_add_u32 v6, 4214848, v5
    buffer_store_dwordx2 v[80:81], v6, s[8:11], 0 offen
    v_add_u32 v6, 4214880, v5
    buffer_load_dwordx2 v[72:73], v6, s[8:11], 0 offen
    v_accvgpr_read_b32 v76, a32
    v_accvgpr_read_b32 v77, a33
    v_accvgpr_read_b32 v78, a34
    v_accvgpr_read_b32 v79, a35
    v_cvt_pk_bf16_f32 v80, v76, v77
    v_cvt_pk_bf16_f32 v81, v78, v79
    s_waitcnt vmcnt(0)
    v_lshlrev_b32 v76, 16, v80
    v_and_b32 v77, 0xffff0000, v80
    v_lshlrev_b32 v82, 16, v72
    v_and_b32 v83, 0xffff0000, v72
    v_add_f32 v76, v76, v82
    v_add_f32 v77, v77, v83
    v_lshlrev_b32 v78, 16, v81
    v_and_b32 v79, 0xffff0000, v81
    v_lshlrev_b32 v82, 16, v73
    v_and_b32 v83, 0xffff0000, v73
    v_add_f32 v78, v78, v82
    v_add_f32 v79, v79, v83
    v_cvt_pk_bf16_f32 v80, v76, v77
    v_cvt_pk_bf16_f32 v81, v78, v79
    v_add_u32 v6, 4214880, v5
    buffer_store_dwordx2 v[80:81], v6, s[8:11], 0 offen
    v_add_u32 v6, 4214912, v5
    buffer_load_dwordx2 v[72:73], v6, s[8:11], 0 offen
    v_accvgpr_read_b32 v76, a36
    v_accvgpr_read_b32 v77, a37
    v_accvgpr_read_b32 v78, a38
    v_accvgpr_read_b32 v79, a39
    v_cvt_pk_bf16_f32 v80, v76, v77
    v_cvt_pk_bf16_f32 v81, v78, v79
    s_waitcnt vmcnt(0)
    v_lshlrev_b32 v76, 16, v80
    v_and_b32 v77, 0xffff0000, v80
    v_lshlrev_b32 v82, 16, v72
    v_and_b32 v83, 0xffff0000, v72
    v_add_f32 v76, v76, v82
    v_add_f32 v77, v77, v83
    v_lshlrev_b32 v78, 16, v81
    v_and_b32 v79, 0xffff0000, v81
    v_lshlrev_b32 v82, 16, v73
    v_and_b32 v83, 0xffff0000, v73
    v_add_f32 v78, v78, v82
    v_add_f32 v79, v79, v83
    v_cvt_pk_bf16_f32 v80, v76, v77
    v_cvt_pk_bf16_f32 v81, v78, v79
    v_add_u32 v6, 4214912, v5
    buffer_store_dwordx2 v[80:81], v6, s[8:11], 0 offen
wo_a2_kernel_end:
    s_endpgm
.section .rodata,"a"
.p2align 6
.amdhsa_kernel wo_a2_kernel
  .amdhsa_next_free_vgpr 136
  .amdhsa_next_free_sgpr 64
  .amdhsa_accum_offset 96
  .amdhsa_group_segment_fixed_size 0
  .amdhsa_kernarg_size 104
  .amdhsa_user_sgpr_count 2
  .amdhsa_user_sgpr_kernarg_segment_ptr 1
  .amdhsa_system_sgpr_workgroup_id_x 1
.end_amdhsa_kernel
.text
.globl chain2_kernel
.p2align 8
.type chain2_kernel,@function
chain2_kernel:
    s_cmp_ge_u32 s2, 232
    s_cbranch_scc1 chain2_kernel_end
    s_load_dwordx2 s[4:5], s[0:1], 96
    s_load_dwordx2 s[6:7], s[0:1], 32
    v_and_b32 v1, 63, v0
    v_lshrrev_b32 v4, 6, v0
    v_and_b32 v2, 15, v1
    v_lshrrev_b32 v3, 4, v1
    v_readfirstlane_b32 s3, v4
    s_mov_b32 s60, 131072
    s_waitcnt lgkmcnt(0)
    s_mov_b32 s8, s4
    s_mov_b32 s9, s5
    s_mov_b32 s10, 268435456
    s_mov_b32 s11, 0x00020000
    s_mov_b32 s20, s6
    s_mov_b32 s21, s7
    s_mov_b32 s22, 10240
    s_mov_b32 s23, 0x00020000
    s_cmp_ge_u32 s2, 200
    s_cbranch_scc1 chain2_kernel_roleO
    s_cmp_ge_u32 s2, 104
    s_cbranch_scc1 chain2_kernel_roleP
    s_cmp_ge_u32 s2, 64
    s_cbranch_scc1 chain2_kernel_roleR
    s_cmp_ge_u32 s2, 32
    s_cbranch_scc1 chain2_kernel_roleV
    s_mov_b32 s44, s2
    s_load_dwordx2 s[6:7], s[0:1], 40
    s_load_dwordx2 s[24:25], s[0:1], 48
    s_waitcnt lgkmcnt(0)
    s_mov_b32 s12, s6
    s_mov_b32 s13, s7
    s_mov_b32 s14, 7864320
    s_mov_b32 s15, 0x00020000
    s_mov_b32 s16, s24
    s_mov_b32 s17, s25
    s_mov_b32 s18, 7864320
    s_mov_b32 s19, 0x00020000
    v_add_u32 v16, 0, v0
    s_mov_b32 s24, 683
    v_mul_lo_u32 v17, v16, s24
    v_lshrrev_b32 v17, 14, v17
    v_mul_u32_u24 v18, 24, v17
    v_sub_u32 v18, v16, v18
    s_mov_b32 s24, 12288
    v_mul_lo_u32 v4, v17, s24
    v_lshl_add_u32 v4, v18, 4, v4
    v_mul_u32_u24 v10, 400, v17
    v_lshl_add_u32 v10, v18, 4, v10
    v_add_u32 v10, 106496, v10
    v_add_u32 v16, 256, v0
    s_mov_b32 s24, 683
    v_mul_lo_u32 v17, v16, s24
    v_lshrrev_b32 v17, 14, v17
    v_mul_u32_u24 v18, 24, v17
    v_sub_u32 v18, v16, v18
    s_mov_b32 s24, 12288
    v_mul_lo_u32 v5, v17, s24
    v_lshl_add_u32 v5, v18, 4, v5
    v_mul_u32_u24 v11, 400, v17
    v_lshl_add_u32 v11, v18, 4, v11
    v_add_u32 v11, 106496, v11
    v_add_u32 v16, 512, v0
    s_mov_b32 s24, 683
    v_mul_lo_u32 v17, v16, s24
    v_lshrrev_b32 v17, 14, v17
    v_mul_u32_u24 v18, 24, v17
    v_sub_u32 v18, v16, v18
    s_mov_b32 s24, 12288
    v_mul_lo_u32 v6, v17, s24
    v_lshl_add_u32 v6, v18, 4, v6
    v_mul_u32_u24 v12, 400, v17
    v_lshl_add_u32 v12, v18, 4, v12
    v_add_u32 v12, 106496, v12
    v_add_u32 v16, 768, v0
    s_mov_b32 s24, 683
    v_mul_lo_u32 v17, v16, s24
    v_lshrrev_b32 v17, 14, v17
    v_mul_u32_u24 v18, 24, v17
    v_sub_u32 v18, v16, v18
    s_mov_b32 s24, 12288
    v_mul_lo_u32 v7, v17, s24
    v_lshl_add_u32 v7, v18, 4, v7
    v_mul_u32_u24 v13, 400, v17
    v_lshl_add_u32 v13, v18, 4, v13
    v_add_u32 v13, 106496, v13
    v_add_u32 v16, 1024, v0
    s_mov_b32 s24, 683
    v_mul_lo_u32 v17, v16, s24
    v_lshrrev_b32 v17, 14, v17
    v_mul_u32_u24 v18, 24, v17
    v_sub_u32 v18, v16, v18
    s_mov_b32 s24, 12288
    v_mul_lo_u32 v8, v17, s24
    v_lshl_add_u32 v8, v18, 4, v8
    v_mul_u32_u24 v14, 400, v17
    v_lshl_add_u32 v14, v18, 4, v14
    v_add_u32 v14, 106496, v14
    v_add_u32 v16, 1280, v0
    s_mov_b32 s24, 683
    v_mul_lo_u32 v17, v16, s24
    v_lshrrev_b32 v17, 14, v17
    v_mul_u32_u24 v18, 24, v17
    v_sub_u32 v18, v16, v18
    s_mov_b32 s24, 12288
    v_mul_lo_u32 v9, v17, s24
    v_lshl_add_u32 v9, v18, 4, v9
    v_mul_u32_u24 v15, 400, v17
    v_lshl_add_u32 v15, v18, 4, v15
    v_add_u32 v15, 106496, v15
    v_lshrrev_b32 v17, 1, v3
    v_lshlrev_b32 v17, 4, v17
    v_and_b32 v18, 1, v3
    v_lshl_add_u32 v17, v18, 2, v17
    v_lshrrev_b32 v18, 2, v2
    v_and_b32 v19, 1, v18
    v_add_u32 v17, v17, v19
    v_lshrrev_b32 v18, 1, v18
    v_lshl_add_u32 v17, v18, 3, v17
    v_mul_u32_u24 v16, 400, v17
    v_and_b32 v18, 3, v2
    v_lshl_add_u32 v16, v18, 3, v16
    v_add_u32 v16, 106496, v16
    s_mul_i32 s24, s3, 96
    v_add_u32 v16, s24, v16
    v_lshlrev_b32 v17, 4, v1
    s_mul_i32 s24, s3, 20480
    s_add_u32 s24, s24, 24576
    v_add_u32 v17, s24, v17
    s_mul_i32 s45, s44, 384
    s_add_u32 s46, s45, 0
    buffer_load_dwordx4 v[24:27], v4, s[12:15], s46 offen
    buffer_load_dwordx4 v[28:31], v5, s[12:15], s46 offen
    buffer_load_dwordx4 v[32:35], v6, s[12:15], s46 offen
    buffer_load_dwordx4 v[36:39], v7, s[12:15], s46 offen
    buffer_load_dwordx4 v[40:43], v8, s[12:15], s46 offen
    buffer_load_dwordx4 v[44:47], v9, s[12:15], s46 offen
    s_add_u32 s46, s45, 0
    buffer_load_dwordx4 v[48:51], v4, s[16:19], s46 offen
    buffer_load_dwordx4 v[52:55], v5, s[16:19], s46 offen
    buffer_load_dwordx4 v[56:59], v6, s[16:19], s46 offen
    buffer_load_dwordx4 v[60:63], v7, s[16:19], s46 offen
    buffer_load_dwordx4 v[64:67], v8, s[16:19], s46 offen
    buffer_load_dwordx4 v[68:71], v9, s[16:19], s46 offen
    s_waitcnt vmcnt(6)
    ds_write_b128 v10, v[24:27]
    ds_write_b128 v11, v[28:31]
    ds_write_b128 v12, v[32:35]
    ds_write_b128 v13, v[36:39]
    ds_write_b128 v14, v[40:43]
    ds_write_b128 v15, v[44:47]
    s_add_u32 s46, s45, 786432
    buffer_load_dwordx4 v[72:75], v4, s[12:15], s46 offen
    buffer_load_dwordx4 v[76:79], v5, s[12:15], s46 offen
    buffer_load_dwordx4 v[80:83], v6, s[12:15], s46 offen
    buffer_load_dwordx4 v[84:87], v7, s[12:15], s46 offen
    buffer_load_dwordx4 v[88:91], v8, s[12:15], s46 offen
    buffer_load_dwordx4 v[92:95], v9, s[12:15], s46 offen
    s_waitcnt lgkmcnt(0)
    s_barrier
    ds_read_b64_tr_b16 a[0:1], v16 offset:0
    ds_read_b64_tr_b16 a[2:3], v16 offset:800
    ds_read_b64_tr_b16 a[4:5], v16 offset:12800
    ds_read_b64_tr_b16 a[6:7], v16 offset:13600
    ds_read_b64_tr_b16 a[80:81], v16 offset:32
    ds_read_b64_tr_b16 a[82:83], v16 offset:832
    ds_read_b64_tr_b16 a[84:85], v16 offset:12832
    ds_read_b64_tr_b16 a[86:87], v16 offset:13632
    ds_read_b64_tr_b16 a[160:161], v16 offset:64
    ds_read_b64_tr_b16 a[162:163], v16 offset:864
    ds_read_b64_tr_b16 a[164:165], v16 offset:12864
    ds_read_b64_tr_b16 a[166:167], v16 offset:13664
    s_waitcnt lgkmcnt(0)
    s_barrier
    s_waitcnt vmcnt(6)
    ds_write_b128 v10, v[48:51]
    ds_write_b128 v11, v[52:55]
    ds_write_b128 v12, v[56:59]
    ds_write_b128 v13, v[60:63]
    ds_write_b128 v14, v[64:67]
    ds_write_b128 v15, v[68:71]
    s_add_u32 s46, s45, 786432
    buffer_load_dwordx4 v[24:27], v4, s[16:19], s46 offen
    buffer_load_dwordx4 v[28:31], v5, s[16:19], s46 offen
    buffer_load_dwordx4 v[32:35], v6, s[16:19], s46 offen
    buffer_load_dwordx4 v[36:39], v7, s[16:19], s46 offen
    buffer_load_dwordx4 v[40:43], v8, s[16:19], s46 offen
    buffer_load_dwordx4 v[44:47], v9, s[16:19], s46 offen
    s_waitcnt lgkmcnt(0)
    s_barrier
    ds_read_b64_tr_b16 v[96:97], v16 offset:0
    ds_read_b64_tr_b16 v[98:99], v16 offset:800
    ds_read_b64_tr_b16 v[100:101], v16 offset:12800
    ds_read_b64_tr_b16 v[102:103], v16 offset:13600
    ds_read_b64_tr_b16 v[176:177], v16 offset:32
    ds_read_b64_tr_b16 v[178:179], v16 offset:832
    ds_read_b64_tr_b16 v[180:181], v16 offset:12832
    ds_read_b64_tr_b16 v[182:183], v16 offset:13632
    ds_read_b64_tr_b16 v[48:49], v16 offset:64
    ds_read_b64_tr_b16 v[50:51], v16 offset:864
    ds_read_b64_tr_b16 v[52:53], v16 offset:12864
    ds_read_b64_tr_b16 v[54:55], v16 offset:13664
    s_waitcnt lgkmcnt(0)
    ds_write_b128 v17, v[48:51] offset:0
    ds_write_b128 v17, v[52:55] offset:1024
    s_waitcnt lgkmcnt(0)
    s_barrier
    s_waitcnt vmcnt(6)
    ds_write_b128 v10, v[72:75]
    ds_write_b128 v11, v[76:79]
    ds_write_b128 v12, v[80:83]
    ds_write_b128 v13, v[84:87]
    ds_write_b128 v14, v[88:91]
    ds_write_b128 v15, v[92:95]
    s_add_u32 s46, s45, 1572864
    buffer_load_dwordx4 v[48:51], v4, s[12:15], s46 offen
    buffer_load_dwordx4 v[52:55], v5, s[12:15], s46 offen
    buffer_load_dwordx4 v[56:59], v6, s[12:15], s46 offen
    buffer_load_dwordx4 v[60:63], v7, s[12:15], s46 offen
    buffer_load_dwordx4 v[64:67], v8, s[12:15], s46 offen
    buffer_load_dwordx4 v[68:71], v9, s[12:15], s46 offen
    s_waitcnt lgkmcnt(0)
    s_barrier
    ds_read_b64_tr_b16 a[8:9], v16 offset:0
    ds_read_b64_tr_b16 a[10:11], v16 offset:800
    ds_read_b64_tr_b16 a[12:13], v16 offset:12800
    ds_read_b64_tr_b16 a[14:15], v16 offset:13600
    ds_read_b64_tr_b16 a[88:89], v16 offset:32
    ds_read_b64_tr_b16 a[90:91], v16 offset:832
    ds_read_b64_tr_b16 a[92:93], v16 offset:12832
    ds_read_b64_tr_b16 a[94:95], v16 offset:13632
    ds_read_b64_tr_b16 a[168:169], v16 offset:64
    ds_read_b64_tr_b16 a[170:171], v16 offset:864
    ds_read_b64_tr_b16 a[172:173], v16 offset:12864
    ds_read_b64_tr_b16 a[174:175], v16 offset:13664
    s_waitcnt lgkmcnt(0)
    s_barrier
    s_waitcnt vmcnt(6)
    ds_write_b128 v10, v[24:27]
    ds_write_b128 v11, v[28:31]
    ds_write_b128 v12, v[32:35]
    ds_write_b128 v13, v[36:39]
    ds_write_b128 v14, v[40:43]
    ds_write_b128 v15, v[44:47]
    s_add_u32 s46, s45, 1572864
    buffer_load_dwordx4 v[72:75], v4, s[16:19], s46 offen
    buffer_load_dwordx4 v[76:79], v5, s[16:19], s46 offen
    buffer_load_dwordx4 v[80:83], v6, s[16:19], s46 offen
    buffer_load_dwordx4 v[84:87], v7, s[16:19], s46 offen
    buffer_load_dwordx4 v[88:91], v8, s[16:19], s46 offen
    buffer_load_dwordx4 v[92:95], v9, s[16:19], s46 offen
    s_waitcnt lgkmcnt(0)
    s_barrier
    ds_read_b64_tr_b16 v[104:105], v16 offset:0
    ds_read_b64_tr_b16 v[106:107], v16 offset:800
    ds_read_b64_tr_b16 v[108:109], v16 offset:12800
    ds_read_b64_tr_b16 v[110:111], v16 offset:13600
    ds_read_b64_tr_b16 v[184:185], v16 offset:32
    ds_read_b64_tr_b16 v[186:187], v16 offset:832
    ds_read_b64_tr_b16 v[188:189], v16 offset:12832
    ds_read_b64_tr_b16 v[190:191], v16 offset:13632
    ds_read_b64_tr_b16 v[24:25], v16 offset:64
    ds_read_b64_tr_b16 v[26:27], v16 offset:864
    ds_read_b64_tr_b16 v[28:29], v16 offset:12864
    ds_read_b64_tr_b16 v[30:31], v16 offset:13664
    s_waitcnt lgkmcnt(0)
    ds_write_b128 v17, v[24:27] offset:2048
    ds_write_b128 v17, v[28:31] offset:3072
    s_waitcnt lgkmcnt(0)
    s_barrier
    s_waitcnt vmcnt(6)
    ds_write_b128 v10, v[48:51]
    ds_write_b128 v11, v[52:55]
    ds_write_b128 v12, v[56:59]
    ds_write_b128 v13, v[60:63]
    ds_write_b128 v14, v[64:67]
    ds_write_b128 v15, v[68:71]
    s_add_u32 s46, s45, 2359296
    buffer_load_dwordx4 v[24:27], v4, s[12:15], s46 offen
    buffer_load_dwordx4 v[28:31], v5, s[12:15], s46 offen
    buffer_load_dwordx4 v[32:35], v6, s[12:15], s46 offen
    buffer_load_dwordx4 v[36:39], v7, s[12:15], s46 offen
    buffer_load_dwordx4 v[40:43], v8, s[12:15], s46 offen
    buffer_load_dwordx4 v[44:47], v9, s[12:15], s46 offen
    s_waitcnt lgkmcnt(0)
    s_barrier
    ds_read_b64_tr_b16 a[16:17], v16 offset:0
    ds_read_b64_tr_b16 a[18:19], v16 offset:800
    ds_read_b64_tr_b16 a[20:21], v16 offset:12800
    ds_read_b64_tr_b16 a[22:23], v16 offset:13600
    ds_read_b64_tr_b16 a[96:97], v16 offset:32
    ds_read_b64_tr_b16 a[98:99], v16 offset:832
    ds_read_b64_tr_b16 a[100:101], v16 offset:12832
    ds_read_b64_tr_b16 a[102:103], v16 offset:13632
    ds_read_b64_tr_b16 a[176:177], v16 offset:64
    ds_read_b64_tr_b16 a[178:179], v16 offset:864
    ds_read_b64_tr_b16 a[180:181], v16 offset:12864
    ds_read_b64_tr_b16 a[182:183], v16 offset:13664
    s_waitcnt lgkmcnt(0)
    s_barrier
    s_waitcnt vmcnt(6)
    ds_write_b128 v10, v[72:75]
    ds_write_b128 v11, v[76:79]
    ds_write_b128 v12, v[80:83]
    ds_write_b128 v13, v[84:87]
    ds_write_b128 v14, v[88:91]
    ds_write_b128 v15, v[92:95]
    s_add_u32 s46, s45, 2359296
    buffer_load_dwordx4 v[48:51], v4, s[16:19], s46 offen
    buffer_load_dwordx4 v[52:55], v5, s[16:19], s46 offen
    buffer_load_dwordx4 v[56:59], v6, s[16:19], s46 offen
    buffer_load_dwordx4 v[60:63], v7, s[16:19], s46 offen
    buffer_load_dwordx4 v[64:67], v8, s[16:19], s46 offen
    buffer_load_dwordx4 v[68:71], v9, s[16:19], s46 offen
    s_waitcnt lgkmcnt(0)
    s_barrier
    ds_read_b64_tr_b16 v[112:113], v16 offset:0
    ds_read_b64_tr_b16 v[114:115], v16 offset:800
    ds_read_b64_tr_b16 v[116:117], v16 offset:12800
    ds_read_b64_tr_b16 v[118:119], v16 offset:13600
    ds_read_b64_tr_b16 v[192:193], v16 offset:32
    ds_read_b64_tr_b16 v[194:195], v16 offset:832
    ds_read_b64_tr_b16 v[196:197], v16 offset:12832
    ds_read_b64_tr_b16 v[198:199], v16 offset:13632
    ds_read_b64_tr_b16 v[72:73], v16 offset:64
    ds_read_b64_tr_b16 v[74:75], v16 offset:864
    ds_read_b64_tr_b16 v[76:77], v16 offset:12864
    ds_read_b64_tr_b16 v[78:79], v16 offset:13664
    s_waitcnt lgkmcnt(0)
    ds_write_b128 v17, v[72:75] offset:4096
    ds_write_b128 v17, v[76:79] offset:5120
    s_waitcnt lgkmcnt(0)
    s_barrier
    s_waitcnt vmcnt(6)
    ds_write_b128 v10, v[24:27]
    ds_write_b128 v11, v[28:31]
    ds_write_b128 v12, v[32:35]
    ds_write_b128 v13, v[36:39]
    ds_write_b128 v14, v[40:43]
    ds_write_b128 v15, v[44:47]
    s_add_u32 s46, s45, 3145728
    buffer_load_dwordx4 v[72:75], v4, s[12:15], s46 offen
    buffer_load_dwordx4 v[76:79], v5, s[12:15], s46 offen
    buffer_load_dwordx4 v[80:83], v6, s[12:15], s46 offen
    buffer_load_dwordx4 v[84:87], v7, s[12:15], s46 offen
    buffer_load_dwordx4 v[88:91], v8, s[12:15], s46 offen
    buffer_load_dwordx4 v[92:95], v9, s[12:15], s46 offen
    s_waitcnt lgkmcnt(0)
    s_barrier
    ds_read_b64_tr_b16 a[24:25], v16 offset:0
    ds_read_b64_tr_b16 a[26:27], v16 offset:800
    ds_read_b64_tr_b16 a[28:29], v16 offset:12800
    ds_read_b64_tr_b16 a[30:31], v16 offset:13600
    ds_read_b64_tr_b16 a[104:105], v16 offset:32
    ds_read_b64_tr_b16 a[106:107], v16 offset:832
    ds_read_b64_tr_b16 a[108:109], v16 offset:12832
    ds_read_b64_tr_b16 a[110:111], v16 offset:13632
    ds_read_b64_tr_b16 a[184:185], v16 offset:64
    ds_read_b64_tr_b16 a[186:187], v16 offset:864
    ds_read_b64_tr_b16 a[188:189], v16 offset:12864
    ds_read_b64_tr_b16 a[190:191], v16 offset:13664
    s_waitcnt lgkmcnt(0)
    s_barrier
    s_waitcnt vmcnt(6)
    ds_write_b128 v10, v[48:51]
    ds_write_b128 v11, v[52:55]
    ds_write_b128 v12, v[56:59]
    ds_write_b128 v13, v[60:63]
    ds_write_b128 v14, v[64:67]
    ds_write_b128 v15, v[68:71]
    s_add_u32 s46, s45, 3145728
    buffer_load_dwordx4 v[24:27], v4, s[16:19], s46 offen
    buffer_load_dwordx4 v[28:31], v5, s[16:19], s46 offen
    buffer_load_dwordx4 v[32:35], v6, s[16:19], s46 offen
    buffer_load_dwordx4 v[36:39], v7, s[16:19], s46 offen
    buffer_load_dwordx4 v[40:43], v8, s[16:19], s46 offen
    buffer_load_dwordx4 v[44:47], v9, s[16:19], s46 offen
    s_waitcnt lgkmcnt(0)
    s_barrier
    ds_read_b64_tr_b16 v[120:121], v16 offset:0
    ds_read_b64_tr_b16 v[122:123], v16 offset:800
    ds_read_b64_tr_b16 v[124:125], v16 offset:12800
    ds_read_b64_tr_b16 v[126:127], v16 offset:13600
    ds_read_b64_tr_b16 v[200:201], v16 offset:32
    ds_read_b64_tr_b16 v[202:203], v16 offset:832
    ds_read_b64_tr_b16 v[204:205], v16 offset:12832
    ds_read_b64_tr_b16 v[206:207], v16 offset:13632
    ds_read_b64_tr_b16 v[48:49], v16 offset:64
    ds_read_b64_tr_b16 v[50:51], v16 offset:864
    ds_read_b64_tr_b16 v[52:53], v16 offset:12864
    ds_read_b64_tr_b16 v[54:55], v16 offset:13664
    s_waitcnt lgkmcnt(0)
    ds_write_b128 v17, v[48:51] offset:6144
    ds_write_b128 v17, v[52:55] offset:7168
    s_waitcnt lgkmcnt(0)
    s_barrier
    s_waitcnt vmcnt(6)
    ds_write_b128 v10, v[72:75]
    ds_write_b128 v11, v[76:79]
    ds_write_b128 v12, v[80:83]
    ds_write_b128 v13, v[84:87]
    ds_write_b128 v14, v[88:91]
    ds_write_b128 v15, v[92:95]
    s_add_u32 s46, s45, 3932160
    buffer_load_dwordx4 v[48:51], v4, s[12:15], s46 offen
    buffer_load_dwordx4 v[52:55], v5, s[12:15], s46 offen
    buffer_load_dwordx4 v[56:59], v6, s[12:15], s46 offen
    buffer_load_dwordx4 v[60:63], v7, s[12:15], s46 offen
    buffer_load_dwordx4 v[64:67], v8, s[12:15], s46 offen
    buffer_load_dwordx4 v[68:71], v9, s[12:15], s46 offen
    s_waitcnt lgkmcnt(0)
    s_barrier
    ds_read_b64_tr_b16 a[32:33], v16 offset:0
    ds_read_b64_tr_b16 a[34:35], v16 offset:800
    ds_read_b64_tr_b16 a[36:37], v16 offset:12800
    ds_read_b64_tr_b16 a[38:39], v16 offset:13600
    ds_read_b64_tr_b16 a[112:113], v16 offset:32
    ds_read_b64_tr_b16 a[114:115], v16 offset:832
    ds_read_b64_tr_b16 a[116:117], v16 offset:12832
    ds_read_b64_tr_b16 a[118:119], v16 offset:13632
    ds_read_b64_tr_b16 a[192:193], v16 offset:64
    ds_read_b64_tr_b16 a[194:195], v16 offset:864
    ds_read_b64_tr_b16 a[196:197], v16 offset:12864
    ds_read_b64_tr_b16 a[198:199], v16 offset:13664
    s_waitcnt lgkmcnt(0)
    s_barrier
    s_waitcnt vmcnt(6)
    ds_write_b128 v10, v[24:27]
    ds_write_b128 v11, v[28:31]
    ds_write_b128 v12, v[32:35]
    ds_write_b128 v13, v[36:39]
    ds_write_b128 v14, v[40:43]
    ds_write_b128 v15, v[44:47]
    s_add_u32 s46, s45, 3932160
    buffer_load_dwordx4 v[72:75], v4, s[16:19], s46 offen
    buffer_load_dwordx4 v[76:79], v5, s[16:19], s46 offen
    buffer_load_dwordx4 v[80:83], v6, s[16:19], s46 offen
    buffer_load_dwordx4 v[84:87], v7, s[16:19], s46 offen
    buffer_load_dwordx4 v[88:91], v8, s[16:19], s46 offen
    buffer_load_dwordx4 v[92:95], v9, s[16:19], s46 offen
    s_waitcnt lgkmcnt(0)
    s_barrier
    ds_read_b64_tr_b16 v[128:129], v16 offset:0
    ds_read_b64_tr_b16 v[130:131], v16 offset:800
    ds_read_b64_tr_b16 v[132:133], v16 offset:12800
    ds_read_b64_tr_b16 v[134:135], v16 offset:13600
    ds_read_b64_tr_b16 v[208:209], v16 offset:32
    ds_read_b64_tr_b16 v[210:211], v16 offset:832
    ds_read_b64_tr_b16 v[212:213], v16 offset:12832
    ds_read_b64_tr_b16 v[214:215], v16 offset:13632
    ds_read_b64_tr_b16 v[24:25], v16 offset:64
    ds_read_b64_tr_b16 v[26:27], v16 offset:864
    ds_read_b64_tr_b16 v[28:29], v16 offset:12864
    ds_read_b64_tr_b16 v[30:31], v16 offset:13664
    s_waitcnt lgkmcnt(0)
    ds_write_b128 v17, v[24:27] offset:8192
    ds_write_b128 v17, v[28:31] offset:9216
    s_waitcnt lgkmcnt(0)
    s_barrier
    s_waitcnt vmcnt(6)
    ds_write_b128 v10, v[48:51]
    ds_write_b128 v11, v[52:55]
    ds_write_b128 v12, v[56:59]
    ds_write_b128 v13, v[60:63]
    ds_write_b128 v14, v[64:67]
    ds_write_b128 v15, v[68:71]
    s_add_u32 s46, s45, 4718592
    buffer_load_dwordx4 v[24:27], v4, s[12:15], s46 offen
    buffer_load_dwordx4 v[28:31], v5, s[12:15], s46 offen
    buffer_load_dwordx4 v[32:35], v6, s[12:15], s46 offen
    buffer_load_dwordx4 v[36:39], v7, s[12:15], s46 offen
    buffer_load_dwordx4 v[40:43], v8, s[12:15], s46 offen
    buffer_load_dwordx4 v[44:47], v9, s[12:15], s46 offen
    s_waitcnt lgkmcnt(0)
    s_barrier
    ds_read_b64_tr_b16 a[40:41], v16 offset:0
    ds_read_b64_tr_b16 a[42:43], v16 offset:800
    ds_read_b64_tr_b16 a[44:45], v16 offset:12800
    ds_read_b64_tr_b16 a[46:47], v16 offset:13600
    ds_read_b64_tr_b16 a[120:121], v16 offset:32
    ds_read_b64_tr_b16 a[122:123], v16 offset:832
    ds_read_b64_tr_b16 a[124:125], v16 offset:12832
    ds_read_b64_tr_b16 a[126:127], v16 offset:13632
    ds_read_b64_tr_b16 a[200:201], v16 offset:64
    ds_read_b64_tr_b16 a[202:203], v16 offset:864
    ds_read_b64_tr_b16 a[204:205], v16 offset:12864
    ds_read_b64_tr_b16 a[206:207], v16 offset:13664
    s_waitcnt lgkmcnt(0)
    s_barrier
    s_waitcnt vmcnt(6)
    ds_write_b128 v10, v[72:75]
    ds_write_b128 v11, v[76:79]
    ds_write_b128 v12, v[80:83]
    ds_write_b128 v13, v[84:87]
    ds_write_b128 v14, v[88:91]
    ds_write_b128 v15, v[92:95]
    s_add_u32 s46, s45, 4718592
    buffer_load_dwordx4 v[48:51], v4, s[16:19], s46 offen
    buffer_load_dwordx4 v[52:55], v5, s[16:19], s46 offen
    buffer_load_dwordx4 v[56:59], v6, s[16:19], s46 offen
    buffer_load_dwordx4 v[60:63], v7, s[16:19], s46 offen
    buffer_load_dwordx4 v[64:67], v8, s[16:19], s46 offen
    buffer_load_dwordx4 v[68:71], v9, s[16:19], s46 offen
    s_waitcnt lgkmcnt(0)
    s_barrier
    ds_read_b64_tr_b16 v[136:137], v16 offset:0
    ds_read_b64_tr_b16 v[138:139], v16 offset:800
    ds_read_b64_tr_b16 v[140:141], v16 offset:12800
    ds_read_b64_tr_b16 v[142:143], v16 offset:13600
    ds_read_b64_tr_b16 v[216:217], v16 offset:32
    ds_read_b64_tr_b16 v[218:219], v16 offset:832
    ds_read_b64_tr_b16 v[220:221], v16 offset:12832
    ds_read_b64_tr_b16 v[222:223], v16 offset:13632
    ds_read_b64_tr_b16 v[72:73], v16 offset:64
    ds_read_b64_tr_b16 v[74:75], v16 offset:864
    ds_read_b64_tr_b16 v[76:77], v16 offset:12864
    ds_read_b64_tr_b16 v[78:79], v16 offset:13664
    s_waitcnt lgkmcnt(0)
    ds_write_b128 v17, v[72:75] offset:10240
    ds_write_b128 v17, v[76:79] offset:11264
    s_waitcnt lgkmcnt(0)
    s_barrier
    s_waitcnt vmcnt(6)
    ds_write_b128 v10, v[24:27]
    ds_write_b128 v11, v[28:31]
    ds_write_b128 v12, v[32:35]
    ds_write_b128 v13, v[36:39]
    ds_write_b128 v14, v[40:43]
    ds_write_b128 v15, v[44:47]
    s_add_u32 s46, s45, 5505024
    buffer_load_dwordx4 v[72:75], v4, s[12:15], s46 offen
    buffer_load_dwordx4 v[76:79], v5, s[12:15], s46 offen
    buffer_load_dwordx4 v[80:83], v6, s[12:15], s46 offen
    buffer_load_dwordx4 v[84:87], v7, s[12:15], s46 offen
    buffer_load_dwordx4 v[88:91], v8, s[12:15], s46 offen
    buffer_load_dwordx4 v[92:95], v9, s[12:15], s46 offen
    s_waitcnt lgkmcnt(0)
    s_barrier
    ds_read_b64_tr_b16 a[48:49], v16 offset:0
    ds_read_b64_tr_b16 a[50:51], v16 offset:800
    ds_read_b64_tr_b16 a[52:53], v16 offset:12800
    ds_read_b64_tr_b16 a[54:55], v16 offset:13600
    ds_read_b64_tr_b16 a[128:129], v16 offset:32
    ds_read_b64_tr_b16 a[130:131], v16 offset:832
    ds_read_b64_tr_b16 a[132:133], v16 offset:12832
    ds_read_b64_tr_b16 a[134:135], v16 offset:13632
    ds_read_b64_tr_b16 a[208:209], v16 offset:64
    ds_read_b64_tr_b16 a[210:211], v16 offset:864
    ds_read_b64_tr_b16 a[212:213], v16 offset:12864
    ds_read_b64_tr_b16 a[214:215], v16 offset:13664
    s_waitcnt lgkmcnt(0)
    s_barrier
    s_waitcnt vmcnt(6)
    ds_write_b128 v10, v[48:51]
    ds_write_b128 v11, v[52:55]
    ds_write_b128 v12, v[56:59]
    ds_write_b128 v13, v[60:63]
    ds_write_b128 v14, v[64:67]
    ds_write_b128 v15, v[68:71]
    s_add_u32 s46, s45, 5505024
    buffer_load_dwordx4 v[24:27], v4, s[16:19], s46 offen
    buffer_load_dwordx4 v[28:31], v5, s[16:19], s46 offen
    buffer_load_dwordx4 v[32:35], v6, s[16:19], s46 offen
    buffer_load_dwordx4 v[36:39], v7, s[16:19], s46 offen
    buffer_load_dwordx4 v[40:43], v8, s[16:19], s46 offen
    buffer_load_dwordx4 v[44:47], v9, s[16:19], s46 offen
    s_waitcnt lgkmcnt(0)
    s_barrier
    ds_read_b64_tr_b16 v[144:145], v16 offset:0
    ds_read_b64_tr_b16 v[146:147], v16 offset:800
    ds_read_b64_tr_b16 v[148:149], v16 offset:12800
    ds_read_b64_tr_b16 v[150:151], v16 offset:13600
    ds_read_b64_tr_b16 v[224:225], v16 offset:32
    ds_read_b64_tr_b16 v[226:227], v16 offset:832
    ds_read_b64_tr_b16 v[228:229], v16 offset:12832
    ds_read_b64_tr_b16 v[230:231], v16 offset:13632
    ds_read_b64_tr_b16 v[48:49], v16 offset:64
    ds_read_b64_tr_b16 v[50:51], v16 offset:864
    ds_read_b64_tr_b16 v[52:53], v16 offset:12864
    ds_read_b64_tr_b16 v[54:55], v16 offset:13664
    s_waitcnt lgkmcnt(0)
    ds_write_b128 v17, v[48:51] offset:12288
    ds_write_b128 v17, v[52:55] offset:13312
    s_waitcnt lgkmcnt(0)
    s_barrier
    s_waitcnt vmcnt(6)
    ds_write_b128 v10, v[72:75]
    ds_write_b128 v11, v[76:79]
    ds_write_b128 v12, v[80:83]
    ds_write_b128 v13, v[84:87]
    ds_write_b128 v14, v[88:91]
    ds_write_b128 v15, v[92:95]
    s_add_u32 s46, s45, 6291456
    buffer_load_dwordx4 v[48:51], v4, s[12:15], s46 offen
    buffer_load_dwordx4 v[52:55], v5, s[12:15], s46 offen
    buffer_load_dwordx4 v[56:59], v6, s[12:15], s46 offen
    buffer_load_dwordx4 v[60:63], v7, s[12:15], s46 offen
    buffer_load_dwordx4 v[64:67], v8, s[12:15], s46 offen
    buffer_load_dwordx4 v[68:71], v9, s[12:15], s46 offen
    s_waitcnt lgkmcnt(0)
    s_barrier
    ds_read_b64_tr_b16 a[56:57], v16 offset:0
    ds_read_b64_tr_b16 a[58:59], v16 offset:800
    ds_read_b64_tr_b16 a[60:61], v16 offset:12800
    ds_read_b64_tr_b16 a[62:63], v16 offset:13600
    ds_read_b64_tr_b16 a[136:137], v16 offset:32
    ds_read_b64_tr_b16 a[138:139], v16 offset:832
    ds_read_b64_tr_b16 a[140:141], v16 offset:12832
    ds_read_b64_tr_b16 a[142:143], v16 offset:13632
    ds_read_b64_tr_b16 a[216:217], v16 offset:64
    ds_read_b64_tr_b16 a[218:219], v16 offset:864
    ds_read_b64_tr_b16 a[220:221], v16 offset:12864
    ds_read_b64_tr_b16 a[222:223], v16 offset:13664
    s_waitcnt lgkmcnt(0)
    s_barrier
    s_waitcnt vmcnt(6)
    ds_write_b128 v10, v[24:27]
    ds_write_b128 v11, v[28:31]
    ds_write_b128 v12, v[32:35]
    ds_write_b128 v13, v[36:39]
    ds_write_b128 v14, v[40:43]
    ds_write_b128 v15, v[44:47]
    s_add_u32 s46, s45, 6291456
    buffer_load_dwordx4 v[72:75], v4, s[16:19], s46 offen
    buffer_load_dwordx4 v[76:79], v5, s[16:19], s46 offen
    buffer_load_dwordx4 v[80:83], v6, s[16:19], s46 offen
    buffer_load_dwordx4 v[84:87], v7, s[16:19], s46 offen
    buffer_load_dwordx4 v[88:91], v8, s[16:19], s46 offen
    buffer_load_dwordx4 v[92:95], v9, s[16:19], s46 offen
    s_waitcnt lgkmcnt(0)
    s_barrier
    ds_read_b64_tr_b16 v[152:153], v16 offset:0
    ds_read_b64_tr_b16 v[154:155], v16 offset:800
    ds_read_b64_tr_b16 v[156:157], v16 offset:12800
    ds_read_b64_tr_b16 v[158:159], v16 offset:13600
    ds_read_b64_tr_b16 v[232:233], v16 offset:32
    ds_read_b64_tr_b16 v[234:235], v16 offset:832
    ds_read_b64_tr_b16 v[236:237], v16 offset:12832
    ds_read_b64_tr_b16 v[238:239], v16 offset:13632
    ds_read_b64_tr_b16 v[24:25], v16 offset:64
    ds_read_b64_tr_b16 v[26:27], v16 offset:864
    ds_read_b64_tr_b16 v[28:29], v16 offset:12864
    ds_read_b64_tr_b16 v[30:31], v16 offset:13664
    s_waitcnt lgkmcnt(0)
    ds_write_b128 v17, v[24:27] offset:14336
    ds_write_b128 v17, v[28:31] offset:15360
    s_waitcnt lgkmcnt(0)
    s_barrier
    s_waitcnt vmcnt(6)
    ds_write_b128 v10, v[48:51]
    ds_write_b128 v11, v[52:55]
    ds_write_b128 v12, v[56:59]
    ds_write_b128 v13, v[60:63]
    ds_write_b128 v14, v[64:67]
    ds_write_b128 v15, v[68:71]
    s_add_u32 s46, s45, 7077888
    buffer_load_dwordx4 v[24:27], v4, s[12:15], s46 offen
    buffer_load_dwordx4 v[28:31], v5, s[12:15], s46 offen
    buffer_load_dwordx4 v[32:35], v6, s[12:15], s46 offen
    buffer_load_dwordx4 v[36:39], v7, s[12:15], s46 offen
    buffer_load_dwordx4 v[40:43], v8, s[12:15], s46 offen
    buffer_load_dwordx4 v[44:47], v9, s[12:15], s46 offen
    s_waitcnt lgkmcnt(0)
    s_barrier
    ds_read_b64_tr_b16 a[64:65], v16 offset:0
    ds_read_b64_tr_b16 a[66:67], v16 offset:800
    ds_read_b64_tr_b16 a[68:69], v16 offset:12800
    ds_read_b64_tr_b16 a[70:71], v16 offset:13600
    ds_read_b64_tr_b16 a[144:145], v16 offset:32
    ds_read_b64_tr_b16 a[146:147], v16 offset:832
    ds_read_b64_tr_b16 a[148:149], v16 offset:12832
    ds_read_b64_tr_b16 a[150:151], v16 offset:13632
    ds_read_b64_tr_b16 a[224:225], v16 offset:64
    ds_read_b64_tr_b16 a[226:227], v16 offset:864
    ds_read_b64_tr_b16 a[228:229], v16 offset:12864
    ds_read_b64_tr_b16 a[230:231], v16 offset:13664
    s_waitcnt lgkmcnt(0)
    s_barrier
    s_waitcnt vmcnt(6)
    ds_write_b128 v10, v[72:75]
    ds_write_b128 v11, v[76:79]
    ds_write_b128 v12, v[80:83]
    ds_write_b128 v13, v[84:87]
    ds_write_b128 v14, v[88:91]
    ds_write_b128 v15, v[92:95]
    s_add_u32 s46, s45, 7077888
    buffer_load_dwordx4 v[48:51], v4, s[16:19], s46 offen
    buffer_load_dwordx4 v[52:55], v5, s[16:19], s46 offen
    buffer_load_dwordx4 v[56:59], v6, s[16:19], s46 offen
    buffer_load_dwordx4 v[60:63], v7, s[16:19], s46 offen
    buffer_load_dwordx4 v[64:67], v8, s[16:19], s46 offen
    buffer_load_dwordx4 v[68:71], v9, s[16:19], s46 offen
    s_waitcnt lgkmcnt(0)
    s_barrier
    ds_read_b64_tr_b16 v[160:161], v16 offset:0
    ds_read_b64_tr_b16 v[162:163], v16 offset:800
    ds_read_b64_tr_b16 v[164:165], v16 offset:12800
    ds_read_b64_tr_b16 v[166:167], v16 offset:13600
    ds_read_b64_tr_b16 v[240:241], v16 offset:32
    ds_read_b64_tr_b16 v[242:243], v16 offset:832
    ds_read_b64_tr_b16 v[244:245], v16 offset:12832
    ds_read_b64_tr_b16 v[246:247], v16 offset:13632
    ds_read_b64_tr_b16 v[72:73], v16 offset:64
    ds_read_b64_tr_b16 v[74:75], v16 offset:864
    ds_read_b64_tr_b16 v[76:77], v16 offset:12864
    ds_read_b64_tr_b16 v[78:79], v16 offset:13664
    s_waitcnt lgkmcnt(0)
    ds_write_b128 v17, v[72:75] offset:16384
    ds_write_b128 v17, v[76:79] offset:17408
    s_waitcnt lgkmcnt(0)
    s_barrier
    s_waitcnt vmcnt(6)
    ds_write_b128 v10, v[24:27]
    ds_write_b128 v11, v[28:31]
    ds_write_b128 v12, v[32:35]
    ds_write_b128 v13, v[36:39]
    ds_write_b128 v14, v[40:43]
    ds_write_b128 v15, v[44:47]
    s_waitcnt lgkmcnt(0)
    s_barrier
    ds_read_b64_tr_b16 a[72:73], v16 offset:0
    ds_read_b64_tr_b16 a[74:75], v16 offset:800
    ds_read_b64_tr_b16 a[76:77], v16 offset:12800
    ds_read_b64_tr_b16 a[78:79], v16 offset:13600
    ds_read_b64_tr_b16 a[152:153], v16 offset:32
    ds_read_b64_tr_b16 a[154:155], v16 offset:832
    ds_read_b64_tr_b16 a[156:157], v16 offset:12832
    ds_read_b64_tr_b16 a[158:159], v16 offset:13632
    ds_read_b64_tr_b16 a[232:233], v16 offset:64
    ds_read_b64_tr_b16 a[234:235], v16 offset:864
    ds_read_b64_tr_b16 a[236:237], v16 offset:12864
    ds_read_b64_tr_b16 a[238:239], v16 offset:13664
    s_waitcnt lgkmcnt(0)
    s_barrier
    s_waitcnt vmcnt(0)
    ds_write_b128 v10, v[48:51]
    ds_write_b128 v11, v[52:55]
    ds_write_b128 v12, v[56:59]
    ds_write_b128 v13, v[60:63]
    ds_write_b128 v14, v[64:67]
    ds_write_b128 v15, v[68:71]
    s_waitcnt lgkmcnt(0)
    s_barrier
    ds_read_b64_tr_b16 v[168:169], v16 offset:0
    ds_read_b64_tr_b16 v[170:171], v16 offset:800
    ds_read_b64_tr_b16 v[172:173], v16 offset:12800
    ds_read_b64_tr_b16 v[174:175], v16 offset:13600
    ds_read_b64_tr_b16 v[248:249], v16 offset:32
    ds_read_b64_tr_b16 v[250:251], v16 offset:832
    ds_read_b64_tr_b16 v[252:253], v16 offset:12832
    ds_read_b64_tr_b16 v[254:255], v16 offset:13632
    ds_read_b64_tr_b16 v[48:49], v16 offset:64
    ds_read_b64_tr_b16 v[50:51], v16 offset:864
    ds_read_b64_tr_b16 v[52:53], v16 offset:12864
    ds_read_b64_tr_b16 v[54:55], v16 offset:13664
    s_waitcnt lgkmcnt(0)
    ds_write_b128 v17, v[48:51] offset:18432
    ds_write_b128 v17, v[52:55] offset:19456
    s_waitcnt lgkmcnt(0)
    s_barrier
    v_mov_b32 v6, v17
    v_mov_b32 v30, 0xeeee
    v_mov_b32 v4, 0x4444
    v_cmp_gt_u32 vcc, 8, v2
    s_nop 1
    v_cndmask_b32 v4, v30, v4, vcc
    v_lshlrev_b32 v5, 4, v1
    s_lshl_b32 s24, s3, 10
    v_add_u32 v7, s24, v5
    s_lshl_b32 s24, s3, 9
    s_add_u32 s24, s24, 8192
    v_lshlrev_b32 v8, 3, v1
    v_add_u32 v8, s24, v8
    s_mul_i32 s24, s3, 1536
    s_add_u32 s24, s24, 10240
    v_lshlrev_b32 v9, 5, v2
    v_lshl_add_u32 v9, v3, 3, v9
    v_add_u32 v9, s24, v9
    v_lshrrev_b32 v30, 2, v2
    v_and_b32 v31, 3, v2
    v_lshl_add_u32 v11, v3, 2, v30
    v_lshlrev_b32 v11, 5, v11
    v_lshl_add_u32 v11, v31, 3, v11
    v_add_u32 v11, s24, v11
    v_add_u32 v33, 22528, v5
    s_mul_i32 s24, s3, 1408
    s_add_u32 s24, s24, 16384
    v_mul_u32_u24 v30, 176, v2
    v_add_u32 v30, s24, v30
    v_lshl_add_u32 v12, v3, 5, v30
    v_cmp_gt_u32 vcc, 8, v2
    s_nop 1
    v_cndmask_b32 v12, v33, v12, vcc
    v_lshl_add_u32 v13, v3, 4, v30
    v_add_u32 v13, 96, v13
    v_cmp_le_u32 s[24:25], 2, v3
    s_and_b64 vcc, vcc, s[24:25]
    v_cndmask_b32 v13, v33, v13, vcc
    s_mul_i32 s24, s3, 5632
    s_add_u32 s24, s24, 106496
    v_mul_u32_u24 v30, 176, v2
    v_add_u32 v30, s24, v30
    v_lshl_add_u32 v16, v3, 5, v30
    v_lshl_add_u32 v17, v3, 4, v30
    v_add_u32 v17, 96, v17
    v_add_u32 v18, 2816, v17
    v_cmp_le_u32 vcc, 2, v3
    s_nop 1
    v_cndmask_b32 v17, v33, v17, vcc
    v_cndmask_b32 v18, v33, v18, vcc
    v_lshrrev_b32 v30, 3, v1
    v_and_b32 v31, 7, v1
    v_min_u32 v32, 4, v31
    v_mul_u32_u24 v14, 176, v30
    v_lshl_add_u32 v14, v32, 5, v14
    s_mul_i32 s24, s3, 1408
    s_add_u32 s24, s24, 106496
    v_add_u32 v21, s24, v14
    v_add_u32 v14, 16384, v14
    v_cmp_gt_u32 s[50:51], 5, v31
    s_lshl_b32 s24, s3, 3
    v_add_u32 v32, s24, v30
    v_lshlrev_b32 v33, 2, v31
    v_sub_u32 v32, v32, v33
    v_mov_b32 v33, 100
    v_cmp_gt_u32 vcc, 4, v31
    s_nop 1
    v_cndmask_b32 v32, v33, v32, vcc
    v_cmp_le_i32 s[64:65], 0, v32
    v_cmp_le_i32 s[66:67], 1, v32
    v_cmp_le_i32 s[68:69], 2, v32
    v_cmp_le_i32 s[70:71], 3, v32
    v_cmp_le_i32 s[72:73], 16, v32
    v_cmp_le_i32 s[74:75], 17, v32
    v_cmp_le_i32 s[76:77], 18, v32
    v_cmp_le_i32 s[78:79], 19, v32
    s_lshr_b32 s24, s44, 1
    s_lshl_b32 s24, s24, 10
    s_and_b32 s25, s44, 1
    s_lshl_b32 s25, s25, 7
    s_add_u32 s24, s24, s25
    v_lshlrev_b32 v15, 8, v31
    v_lshl_add_u32 v15, v30, 4, v15
    v_add_u32 v15, s24, v15
    s_lshr_b32 s24, s44, 3
    s_lshl_b32 s24, s24, 10
    s_and_b32 s25, s44, 3
    s_lshl_b32 s25, s25, 8
    s_add_u32 s24, s24, s25
    s_lshr_b32 s25, s44, 2
    s_and_b32 s25, s25, 1
    s_lshl_b32 s25, s25, 7
    s_add_u32 s24, s24, s25
    s_add_u32 s24, s24, 16384
    v_lshlrev_b32 v32, 4, v30
    v_add_u32 v32, s24, v32
    v_cmp_eq_u32 vcc, 4, v31
    s_nop 1
    v_cndmask_b32 v15, v15, v32, vcc
    v_mov_b32 v32, 2146435072
    v_cndmask_b32 v15, v32, v15, s[50:51]
    s_mul_i32 s24, s3, 20480
    v_add_u32 v15, s24, v15
    s_cmp_lt_u32 s3, 1
    s_cselect_b32 s24, 0, 2146435072
    v_or_b32 v15, s24, v15
    s_and_b32 s24, s3, 1
    s_lshl_b32 s24, s24, 7
    s_lshr_b32 s25, s3, 1
    s_lshl_b32 s25, s25, 10
    s_add_u32 s24, s24, s25
    s_lshl_b32 s25, s44, 11
    s_add_u32 s25, s25, s24
    v_lshlrev_b32 v22, 8, v31
    v_lshl_add_u32 v22, v30, 4, v22
    v_add_u32 v22, s25, v22
    s_lshr_b32 s25, s44, 2
    s_lshl_b32 s25, s25, 11
    s_add_u32 s25, s25, s24
    s_and_b32 s26, s44, 3
    s_lshl_b32 s26, s26, 8
    s_add_u32 s25, s25, s26
    s_add_u32 s25, s25, 65536
    v_lshlrev_b32 v32, 4, v30
    v_add_u32 v32, s25, v32
    v_cmp_eq_u32 vcc, 4, v31
    s_nop 1
    v_cndmask_b32 v22, v22, v32, vcc
    v_mov_b32 v32, 2146435072
    v_cndmask_b32 v22, v32, v22, s[50:51]
    s_mul_i32 s24, s44, 12288
    s_mul_i32 s25, s3, 3072
    s_add_u32 s24, s24, s25
    v_add_u32 v19, s24, v5
    v_and_b32 v10, 1, v1
    v_lshlrev_b32 v10, 12, v10
    s_lshl_b32 s24, s44, 7
    s_add_u32 s24, s24, 151560192
    v_add_u32 v10, s24, v10
    v_add_u32 v48, 0, v0
    v_and_b32 v49, 7, v48
    v_mul_u32_u24 v49, 1280, v49
    v_lshrrev_b32 v50, 3, v48
    v_lshl_add_u32 v49, v50, 4, v49
    v_cmp_gt_u32 vcc, 640, v48
    v_mov_b32 v51, 2146435072
    s_nop 0
    v_cndmask_b32 v49, v51, v49, vcc
    buffer_load_dwordx4 v[52:55], v49, s[20:23], 0 offen
    v_lshlrev_b32 v48, 4, v48
    s_waitcnt vmcnt(0)
    s_and_saveexec_b64 s[30:31], vcc
    ds_write_b128 v48, v[52:55]
    s_mov_b64 exec, s[30:31]
    v_add_u32 v48, 256, v0
    v_and_b32 v49, 7, v48
    v_mul_u32_u24 v49, 1280, v49
    v_lshrrev_b32 v50, 3, v48
    v_lshl_add_u32 v49, v50, 4, v49
    v_cmp_gt_u32 vcc, 640, v48
    v_mov_b32 v51, 2146435072
    s_nop 0
    v_cndmask_b32 v49, v51, v49, vcc
    buffer_load_dwordx4 v[52:55], v49, s[20:23], 0 offen
    v_lshlrev_b32 v48, 4, v48
    s_waitcnt vmcnt(0)
    s_and_saveexec_b64 s[30:31], vcc
    ds_write_b128 v48, v[52:55]
    s_mov_b64 exec, s[30:31]
    v_add_u32 v48, 512, v0
    v_and_b32 v49, 7, v48
    v_mul_u32_u24 v49, 1280, v49
    v_lshrrev_b32 v50, 3, v48
    v_lshl_add_u32 v49, v50, 4, v49
    v_cmp_gt_u32 vcc, 640, v48
    v_mov_b32 v51, 2146435072
    s_nop 0
    v_cndmask_b32 v49, v51, v49, vcc
    buffer_load_dwordx4 v[52:55], v49, s[20:23], 0 offen
    v_lshlrev_b32 v48, 4, v48
    s_waitcnt vmcnt(0)
    s_and_saveexec_b64 s[30:31], vcc
    ds_write_b128 v48, v[52:55]
    s_mov_b64 exec, s[30:31]
    s_mov_b32 s40, 0
    s_mov_b32 s41, 92274688
    s_mov_b32 s42, 146317312
    s_mov_b32 s43, 141074432
    s_mov_b32 s45, 67108864
    s_mov_b32 s47, 138412032
    s_mov_b32 s62, -1
    s_mov_b32 s63, 1
    s_cmp_ge_i32 s62, s63
    s_cbranch_scc1 chain2_kernel_s_en0_ok
    s_mov_b32 s61, 0
chain2_kernel_s_en0:
    buffer_load_dword v48, v10, s[8:11], 0 offen sc1
    s_waitcnt vmcnt(0)
    v_readlane_b32 s62, v48, 0
    v_readlane_b32 s24, v48, 1
    s_min_i32 s62, s62, s24
    s_cmp_ge_i32 s62, s63
    s_cbranch_scc1 chain2_kernel_s_en0_ok
    s_add_u32 s61, s61, 1
    s_cmp_ge_u32 s61, s60
    s_cbranch_scc1 chain2_kernel_s_en0_to
    s_sleep 2
    s_branch chain2_kernel_s_en0
chain2_kernel_s_en0_to:
    s_mov_b32 s60, 1
chain2_kernel_s_en0_ok:
    buffer_load_dwordx4 a[240:243], v19, s[8:11], s41 offen offset:0 sc1
    buffer_load_dwordx4 a[244:247], v19, s[8:11], s41 offen offset:1024 sc1
    buffer_load_dwordx4 a[248:251], v19, s[8:11], s41 offen offset:2048 sc1
    s_waitcnt lgkmcnt(0)
    s_branch chain2_kernel_s_go
chain2_kernel_s_step:
    v_mov_b32 v24, 0
    v_mov_b32 v25, 0
    v_mov_b32 v26, 0
    v_mov_b32 v27, 0
    v_mov_b32 v28, 0
    v_mov_b32 v29, 0
    v_mov_b32 v30, 0
    v_mov_b32 v31, 0
    v_mov_b32 v32, 0
    v_mov_b32 v33, 0
    v_mov_b32 v34, 0
    v_mov_b32 v35, 0
    v_mov_b32 v36, 0
    v_mov_b32 v37, 0
    v_mov_b32 v38, 0
    v_mov_b32 v39, 0
    v_mov_b32 v40, 0
    v_mov_b32 v41, 0
    v_mov_b32 v42, 0
    v_mov_b32 v43, 0
    v_mov_b32 v44, 0
    v_mov_b32 v45, 0
    v_mov_b32 v46, 0
    v_mov_b32 v47, 0
    s_add_u32 s48, s47, 4096
    s_mov_b32 s61, 0
chain2_kernel_s_pm:
    buffer_load_dwordx4 v[48:51], v7, s[8:11], s47 offen sc1
    buffer_load_dwordx4 v[52:55], v7, s[8:11], s48 offen sc1
    buffer_load_dwordx2 v[56:57], v8, s[8:11], s47 offen sc1
    s_waitcnt vmcnt(0)
    v_max3_u32 v58, v48, v49, v50
    v_max3_u32 v58, v58, v51, v52
    v_max3_u32 v58, v58, v53, v54
    v_max3_u32 v58, v58, v55, v56
    v_max_u32 v58, v58, v57
    v_cmp_eq_u32 vcc, -1, v58
    s_add_u32 s61, s61, 1
    s_cbranch_vccz chain2_kernel_s_pm_out
    s_cmp_ge_u32 s61, s60
    s_cbranch_scc1 chain2_kernel_s_pm_to
    s_sleep 1
    s_branch chain2_kernel_s_pm
chain2_kernel_s_pm_to:
    s_mov_b32 s60, 1
chain2_kernel_s_pm_out:
    ds_write_b128 v7, v[48:51]
    ds_write_b128 v7, v[52:55] offset:4096
    ds_write_b64 v8, v[56:57]
    s_waitcnt lgkmcnt(0)
chain2_kernel_s_go2:
    s_barrier
    ds_read_b128 v[48:51], v5 offset:0
    ds_read_b128 v[68:71], v6 offset:0
    ds_read_b128 v[72:75], v6 offset:1024
    ds_read_b128 v[52:55], v5 offset:1024
    ds_read_b128 v[76:79], v6 offset:2048
    ds_read_b128 v[80:83], v6 offset:3072
    ds_read_b128 v[56:59], v5 offset:2048
    ds_read_b128 v[60:63], v5 offset:3072
    ds_read_b128 v[64:67], v5 offset:4096
    s_waitcnt lgkmcnt(8)
    v_smfmac_f32_16x16x64_bf16 v[24:27], v[48:51], a[0:7], v4
    v_smfmac_f32_16x16x64_bf16 v[28:31], v[48:51], a[80:87], v4
    ds_read_b128 v[84:87], v6 offset:4096
    ds_read_b128 v[88:91], v6 offset:5120
    v_smfmac_f32_16x16x64_bf16 v[32:35], v[48:51], a[160:167], v4
    v_smfmac_f32_16x16x64_bf16 v[36:39], v[48:51], v[96:103], v4
    v_smfmac_f32_16x16x64_bf16 v[40:43], v[48:51], v[176:183], v4
    s_waitcnt lgkmcnt(8)
    v_smfmac_f32_16x16x64_bf16 v[44:47], v[48:51], v[68:75], v4
    ds_read_b128 v[48:51], v5 offset:5120
    s_waitcnt lgkmcnt(8)
    v_smfmac_f32_16x16x64_bf16 v[24:27], v[52:55], a[8:15], v4
    v_smfmac_f32_16x16x64_bf16 v[28:31], v[52:55], a[88:95], v4
    ds_read_b128 v[68:71], v6 offset:6144
    ds_read_b128 v[72:75], v6 offset:7168
    v_smfmac_f32_16x16x64_bf16 v[32:35], v[52:55], a[168:175], v4
    v_smfmac_f32_16x16x64_bf16 v[36:39], v[52:55], v[104:111], v4
    v_smfmac_f32_16x16x64_bf16 v[40:43], v[52:55], v[184:191], v4
    s_waitcnt lgkmcnt(8)
    v_smfmac_f32_16x16x64_bf16 v[44:47], v[52:55], v[76:83], v4
    ds_read_b128 v[52:55], v5 offset:6144
    s_waitcnt lgkmcnt(8)
    v_smfmac_f32_16x16x64_bf16 v[24:27], v[56:59], a[16:23], v4
    v_smfmac_f32_16x16x64_bf16 v[28:31], v[56:59], a[96:103], v4
    ds_read_b128 v[76:79], v6 offset:8192
    ds_read_b128 v[80:83], v6 offset:9216
    v_smfmac_f32_16x16x64_bf16 v[32:35], v[56:59], a[176:183], v4
    v_smfmac_f32_16x16x64_bf16 v[36:39], v[56:59], v[112:119], v4
    v_smfmac_f32_16x16x64_bf16 v[40:43], v[56:59], v[192:199], v4
    s_waitcnt lgkmcnt(6)
    v_smfmac_f32_16x16x64_bf16 v[44:47], v[56:59], v[84:91], v4
    ds_read_b128 v[56:59], v5 offset:7168
    v_smfmac_f32_16x16x64_bf16 v[24:27], v[60:63], a[24:31], v4
    v_smfmac_f32_16x16x64_bf16 v[28:31], v[60:63], a[104:111], v4
    ds_read_b128 v[84:87], v6 offset:10240
    ds_read_b128 v[88:91], v6 offset:11264
    v_smfmac_f32_16x16x64_bf16 v[32:35], v[60:63], a[184:191], v4
    v_smfmac_f32_16x16x64_bf16 v[36:39], v[60:63], v[120:127], v4
    v_smfmac_f32_16x16x64_bf16 v[40:43], v[60:63], v[200:207], v4
    s_waitcnt lgkmcnt(6)
    v_smfmac_f32_16x16x64_bf16 v[44:47], v[60:63], v[68:75], v4
    ds_read_b128 v[60:63], v5 offset:8192
    v_smfmac_f32_16x16x64_bf16 v[24:27], v[64:67], a[32:39], v4
    v_smfmac_f32_16x16x64_bf16 v[28:31], v[64:67], a[112:119], v4
    ds_read_b128 v[68:71], v6 offset:12288
    ds_read_b128 v[72:75], v6 offset:13312
    v_smfmac_f32_16x16x64_bf16 v[32:35], v[64:67], a[192:199], v4
    v_smfmac_f32_16x16x64_bf16 v[36:39], v[64:67], v[128:135], v4
    v_smfmac_f32_16x16x64_bf16 v[40:43], v[64:67], v[208:215], v4
    s_waitcnt lgkmcnt(6)
    v_smfmac_f32_16x16x64_bf16 v[44:47], v[64:67], v[76:83], v4
    ds_read_b128 v[64:67], v5 offset:9216
    v_smfmac_f32_16x16x64_bf16 v[24:27], v[48:51], a[40:47], v4
    v_smfmac_f32_16x16x64_bf16 v[28:31], v[48:51], a[120:127], v4
    ds_read_b128 v[76:79], v6 offset:14336
    ds_read_b128 v[80:83], v6 offset:15360
    v_smfmac_f32_16x16x64_bf16 v[32:35], v[48:51], a[200:207], v4
    v_smfmac_f32_16x16x64_bf16 v[36:39], v[48:51], v[136:143], v4
    v_smfmac_f32_16x16x64_bf16 v[40:43], v[48:51], v[216:223], v4
    s_waitcnt lgkmcnt(6)
    v_smfmac_f32_16x16x64_bf16 v[44:47], v[48:51], v[84:91], v4
    v_smfmac_f32_16x16x64_bf16 v[24:27], v[52:55], a[48:55], v4
    v_smfmac_f32_16x16x64_bf16 v[28:31], v[52:55], a[128:135], v4
    ds_read_b128 v[84:87], v6 offset:16384
    ds_read_b128 v[88:91], v6 offset:17408
    v_smfmac_f32_16x16x64_bf16 v[32:35], v[52:55], a[208:215], v4
    v_smfmac_f32_16x16x64_bf16 v[36:39], v[52:55], v[144:151], v4
    v_smfmac_f32_16x16x64_bf16 v[40:43], v[52:55], v[224:231], v4
    s_waitcnt lgkmcnt(5)
    v_smfmac_f32_16x16x64_bf16 v[44:47], v[52:55], v[68:75], v4
    v_smfmac_f32_16x16x64_bf16 v[24:27], v[56:59], a[56:63], v4
    v_smfmac_f32_16x16x64_bf16 v[28:31], v[56:59], a[136:143], v4
    ds_read_b128 v[68:71], v6 offset:18432
    ds_read_b128 v[72:75], v6 offset:19456
    v_smfmac_f32_16x16x64_bf16 v[32:35], v[56:59], a[216:223], v4
    v_smfmac_f32_16x16x64_bf16 v[36:39], v[56:59], v[152:159], v4
    v_smfmac_f32_16x16x64_bf16 v[40:43], v[56:59], v[232:239], v4
    s_waitcnt lgkmcnt(4)
    v_smfmac_f32_16x16x64_bf16 v[44:47], v[56:59], v[76:83], v4
    v_smfmac_f32_16x16x64_bf16 v[24:27], v[60:63], a[64:71], v4
    v_smfmac_f32_16x16x64_bf16 v[28:31], v[60:63], a[144:151], v4
    v_smfmac_f32_16x16x64_bf16 v[32:35], v[60:63], a[224:231], v4
    v_smfmac_f32_16x16x64_bf16 v[36:39], v[60:63], v[160:167], v4
    v_smfmac_f32_16x16x64_bf16 v[40:43], v[60:63], v[240:247], v4
    s_waitcnt lgkmcnt(2)
    v_smfmac_f32_16x16x64_bf16 v[44:47], v[60:63], v[84:91], v4
    v_smfmac_f32_16x16x64_bf16 v[24:27], v[64:67], a[72:79], v4
    v_smfmac_f32_16x16x64_bf16 v[28:31], v[64:67], a[152:159], v4
    v_smfmac_f32_16x16x64_bf16 v[32:35], v[64:67], a[232:239], v4
    v_smfmac_f32_16x16x64_bf16 v[36:39], v[64:67], v[168:175], v4
    v_smfmac_f32_16x16x64_bf16 v[40:43], v[64:67], v[248:255], v4
    s_waitcnt lgkmcnt(0)
    v_smfmac_f32_16x16x64_bf16 v[44:47], v[64:67], v[68:75], v4
    buffer_load_dwordx4 v[80:83], v19, s[8:11], s45 offen offset:0 sc1
    buffer_load_dwordx4 v[84:87], v19, s[8:11], s45 offen offset:1024 sc1
    buffer_load_dwordx4 v[88:91], v19, s[8:11], s45 offen offset:2048 sc1
    s_nop 5
    v_permlane32_swap_b32 v24, v36
    v_permlane32_swap_b32 v25, v37
    v_permlane32_swap_b32 v26, v38
    v_permlane32_swap_b32 v27, v39
    v_add_f32 v24, v24, v36
    v_add_f32 v25, v25, v37
    v_add_f32 v26, v26, v38
    v_add_f32 v27, v27, v39
    v_cvt_pk_bf16_f32 v48, v24, v25
    v_cvt_pk_bf16_f32 v49, v26, v27
    ds_write_b64 v9, v[48:49] offset:0
    v_permlane32_swap_b32 v28, v40
    v_permlane32_swap_b32 v29, v41
    v_permlane32_swap_b32 v30, v42
    v_permlane32_swap_b32 v31, v43
    v_add_f32 v28, v28, v40
    v_add_f32 v29, v29, v41
    v_add_f32 v30, v30, v42
    v_add_f32 v31, v31, v43
    v_cvt_pk_bf16_f32 v50, v28, v29
    v_cvt_pk_bf16_f32 v51, v30, v31
    ds_write_b64 v9, v[50:51] offset:512
    v_permlane32_swap_b32 v32, v44
    v_permlane32_swap_b32 v33, v45
    v_permlane32_swap_b32 v34, v46
    v_permlane32_swap_b32 v35, v47
    v_add_f32 v32, v32, v44
    v_add_f32 v33, v33, v45
    v_add_f32 v34, v34, v46
    v_add_f32 v35, v35, v47
    v_cvt_pk_bf16_f32 v52, v32, v33
    v_cvt_pk_bf16_f32 v53, v34, v35
    ds_write_b64 v9, v[52:53] offset:1024
    s_waitcnt lgkmcnt(0)
    ds_read_b64_tr_b16 v[24:25], v11
    ds_read_b64_tr_b16 v[26:27], v11 offset:512
    ds_read_b64_tr_b16 v[28:29], v11 offset:1024
    s_waitcnt lgkmcnt(0)
    v_mfma_f32_16x16x32_bf16 v[64:67], a[240:243], v[24:27], 0
    v_mfma_f32_16x16x32_bf16 v[68:71], a[244:247], v[24:27], 0
    v_mfma_f32_16x16x32_bf16 v[72:75], v[24:27], v[24:27], 0
    s_nop 3
    v_mfma_f32_16x16x16_bf16 v[64:67], a[248:249], v[28:29], v[64:67]
    v_mfma_f32_16x16x16_bf16 v[68:71], a[250:251], v[28:29], v[68:71]
    v_mfma_f32_16x16x16_bf16 v[72:75], v[28:29], v[28:29], v[72:75]
    s_nop 5
    ds_write_b128 v12, v[64:67]
    ds_write_b128 v12, v[68:71] offset:16
    ds_write_b128 v13, v[72:75]
    s_waitcnt lgkmcnt(0)
    s_barrier
    ds_read_b128 v[48:51], v14 offset:0
    ds_read_b128 v[52:55], v14 offset:16
    ds_read_b128 v[56:59], v14 offset:1408
    ds_read_b128 v[60:63], v14 offset:1424
    ds_read_b128 v[64:67], v14 offset:2816
    ds_read_b128 v[68:71], v14 offset:2832
    ds_read_b128 v[72:75], v14 offset:4224
    ds_read_b128 v[76:79], v14 offset:4240
    s_waitcnt lgkmcnt(4)
    v_pk_add_f32 v[48:49], v[48:49], v[56:57]
    v_pk_add_f32 v[50:51], v[50:51], v[58:59]
    v_pk_add_f32 v[52:53], v[52:53], v[60:61]
    v_pk_add_f32 v[54:55], v[54:55], v[62:63]
    s_waitcnt lgkmcnt(0)
    v_pk_add_f32 v[64:65], v[64:65], v[72:73]
    v_pk_add_f32 v[66:67], v[66:67], v[74:75]
    v_pk_add_f32 v[68:69], v[68:69], v[76:77]
    v_pk_add_f32 v[70:71], v[70:71], v[78:79]
    v_pk_add_f32 v[48:49], v[48:49], v[64:65]
    v_pk_add_f32 v[50:51], v[50:51], v[66:67]
    v_pk_add_f32 v[52:53], v[52:53], v[68:69]
    v_pk_add_f32 v[54:55], v[54:55], v[70:71]
    v_max3_f32 v92, v48, v49, v50
    v_max3_f32 v92, v92, v51, v52
    v_max3_f32 v92, v92, v53, v54
    v_max_f32 v92, v92, v55
    v_mov_b32 v93, 0xff800000
    v_cndmask_b32 v92, v93, v92, s[50:51]
    s_nop 1
    v_max_f32 v92, v92, v92 quad_perm:[1,0,3,2] row_mask:0xf bank_mask:0xf
    s_nop 1
    v_max_f32 v92, v92, v92 quad_perm:[2,3,0,1] row_mask:0xf bank_mask:0xf
    s_nop 1
    v_max_f32 v92, v92, v92 row_half_mirror row_mask:0xf bank_mask:0xf
    s_mov_b32 s24, 0x3dd53b95
    v_mul_f32 v92, s24, v92
    v_fma_f32 v48, v48, s24, -v92
    v_fma_f32 v49, v49, s24, -v92
    v_fma_f32 v50, v50, s24, -v92
    v_fma_f32 v51, v51, s24, -v92
    v_fma_f32 v52, v52, s24, -v92
    v_fma_f32 v53, v53, s24, -v92
    v_fma_f32 v54, v54, s24, -v92
    v_fma_f32 v55, v55, s24, -v92
    v_exp_f32 v48, v48
    v_exp_f32 v49, v49
    v_exp_f32 v50, v50
    v_exp_f32 v51, v51
    v_exp_f32 v52, v52
    v_exp_f32 v53, v53
    v_exp_f32 v54, v54
    v_exp_f32 v55, v55
    v_add_f32 v92, v48, v49
    v_add_f32 v93, v50, v51
    v_add_f32 v92, v92, v52
    v_add_f32 v93, v93, v53
    v_add_f32 v92, v92, v54
    v_add_f32 v93, v93, v55
    v_add_f32 v92, v92, v93
    v_cndmask_b32 v92, 0, v92, s[50:51]
    s_nop 1
    v_add_f32 v92, v92, v92 quad_perm:[1,0,3,2] row_mask:0xf bank_mask:0xf
    s_nop 1
    v_add_f32 v92, v92, v92 quad_perm:[2,3,0,1] row_mask:0xf bank_mask:0xf
    s_nop 1
    v_add_f32 v92, v92, v92 row_half_mirror row_mask:0xf bank_mask:0xf
    v_rcp_f32 v92, v92
    s_nop 0
    v_mul_f32 v48, v48, v92
    v_mul_f32 v49, v49, v92
    v_mul_f32 v50, v50, v92
    v_mul_f32 v51, v51, v92
    v_mul_f32 v52, v52, v92
    v_mul_f32 v53, v53, v92
    v_mul_f32 v54, v54, v92
    v_mul_f32 v55, v55, v92
    v_cvt_pk_bf16_f32 v56, v48, v49
    v_cvt_pk_bf16_f32 v57, v50, v51
    v_cvt_pk_bf16_f32 v58, v52, v53
    v_cvt_pk_bf16_f32 v59, v54, v55
    v_min_u32 v56, -2, v56
    v_min_u32 v57, -2, v57
    v_min_u32 v58, -2, v58
    v_min_u32 v59, -2, v59
    buffer_store_dwordx4 v[56:59], v15, s[8:11], s43 offen sc1
    s_waitcnt vmcnt(1)
    v_mfma_f32_16x16x32_bf16 v[32:35], a[240:243], v[80:83], 0
    v_mfma_f32_16x16x32_bf16 v[40:43], a[244:247], v[80:83], 0
    v_mfma_f32_16x16x32_bf16 v[64:67], v[24:27], v[80:83], 0
    v_mfma_f32_16x16x32_bf16 v[36:39], a[240:243], v[84:87], 0
    v_mfma_f32_16x16x32_bf16 v[44:47], a[244:247], v[84:87], 0
    v_mfma_f32_16x16x32_bf16 v[68:71], v[24:27], v[84:87], 0
    s_nop 0
    v_mfma_f32_16x16x16_bf16 v[32:35], a[248:249], v[88:89], v[32:35]
    v_mfma_f32_16x16x16_bf16 v[40:43], a[250:251], v[88:89], v[40:43]
    v_mfma_f32_16x16x16_bf16 v[64:67], v[28:29], v[88:89], v[64:67]
    v_mfma_f32_16x16x16_bf16 v[36:39], a[248:249], v[90:91], v[36:39]
    v_mfma_f32_16x16x16_bf16 v[44:47], a[250:251], v[90:91], v[44:47]
    v_mfma_f32_16x16x16_bf16 v[68:71], v[28:29], v[90:91], v[68:71]
    s_nop 2
    ds_write_b128 v16, v[32:35] offset:0
    ds_write_b128 v16, v[40:43] offset:16
    ds_write_b128 v17, v[64:67]
    ds_write_b128 v16, v[36:39] offset:2816
    ds_write_b128 v16, v[44:47] offset:2832
    ds_write_b128 v18, v[68:71]
    s_add_u32 s40, s40, 1
    s_add_u32 s41, s41, 393216
    s_add_u32 s45, s45, 393216
    s_add_u32 s43, s43, 81920
    s_add_u32 s47, s47, 40960
    s_waitcnt lgkmcnt(0)
    s_barrier
    s_add_u32 s63, s40, 1
    s_min_u32 s63, s63, 64
    s_cmp_ge_i32 s62, s63
    s_cbranch_scc1 chain2_kernel_s_en_ok
    s_mov_b32 s61, 0
chain2_kernel_s_en:
    buffer_load_dword v48, v10, s[8:11], 0 offen sc1
    s_waitcnt vmcnt(0)
    v_readlane_b32 s62, v48, 0
    v_readlane_b32 s24, v48, 1
    s_min_i32 s62, s62, s24
    s_cmp_ge_i32 s62, s63
    s_cbranch_scc1 chain2_kernel_s_en_ok
    s_add_u32 s61, s61, 1
    s_cmp_ge_u32 s61, s60
    s_cbranch_scc1 chain2_kernel_s_en_to
    s_sleep 2
    s_branch chain2_kernel_s_en
chain2_kernel_s_en_to:
    s_mov_b32 s60, 1
chain2_kernel_s_en_ok:
    buffer_load_dwordx4 a[240:243], v19, s[8:11], s41 offen offset:0 sc1
    buffer_load_dwordx4 a[244:247], v19, s[8:11], s41 offen offset:1024 sc1
    buffer_load_dwordx4 a[248:251], v19, s[8:11], s41 offen offset:2048 sc1
    ds_read_b128 v[48:51], v21 offset:0
    ds_read_b128 v[52:55], v21 offset:16
    ds_read_b128 v[56:59], v21 offset:5632
    ds_read_b128 v[60:63], v21 offset:5648
    ds_read_b128 v[64:67], v21 offset:11264
    ds_read_b128 v[68:71], v21 offset:11280
    ds_read_b128 v[72:75], v21 offset:16896
    ds_read_b128 v[76:79], v21 offset:16912
    s_waitcnt lgkmcnt(4)
    v_pk_add_f32 v[48:49], v[48:49], v[56:57]
    v_pk_add_f32 v[50:51], v[50:51], v[58:59]
    v_pk_add_f32 v[52:53], v[52:53], v[60:61]
    v_pk_add_f32 v[54:55], v[54:55], v[62:63]
    s_waitcnt lgkmcnt(0)
    v_pk_add_f32 v[64:65], v[64:65], v[72:73]
    v_pk_add_f32 v[66:67], v[66:67], v[74:75]
    v_pk_add_f32 v[68:69], v[68:69], v[76:77]
    v_pk_add_f32 v[70:71], v[70:71], v[78:79]
    v_pk_add_f32 v[48:49], v[48:49], v[64:65]
    v_pk_add_f32 v[50:51], v[50:51], v[66:67]
    v_pk_add_f32 v[52:53], v[52:53], v[68:69]
    v_pk_add_f32 v[54:55], v[54:55], v[70:71]
    v_mov_b32 v93, 0xff800000
    v_cndmask_b32 v48, v93, v48, s[64:65]
    v_cndmask_b32 v49, v93, v49, s[66:67]
    v_cndmask_b32 v50, v93, v50, s[68:69]
    v_cndmask_b32 v51, v93, v51, s[70:71]
    v_cndmask_b32 v52, v93, v52, s[72:73]
    v_cndmask_b32 v53, v93, v53, s[74:75]
    v_cndmask_b32 v54, v93, v54, s[76:77]
    v_cndmask_b32 v55, v93, v55, s[78:79]
    v_max3_f32 v92, v48, v49, v50
    v_max3_f32 v92, v92, v51, v52
    v_max3_f32 v92, v92, v53, v54
    v_max_f32 v92, v92, v55
    v_mov_b32 v93, 0xff800000
    v_cndmask_b32 v92, v93, v92, s[50:51]
    s_nop 1
    v_max_f32 v92, v92, v92 quad_perm:[1,0,3,2] row_mask:0xf bank_mask:0xf
    s_nop 1
    v_max_f32 v92, v92, v92 quad_perm:[2,3,0,1] row_mask:0xf bank_mask:0xf
    s_nop 1
    v_max_f32 v92, v92, v92 row_half_mirror row_mask:0xf bank_mask:0xf
    s_mov_b32 s24, 0x3dd53b95
    v_mul_f32 v92, s24, v92
    v_fma_f32 v48, v48, s24, -v92
    v_fma_f32 v49, v49, s24, -v92
    v_fma_f32 v50, v50, s24, -v92
    v_fma_f32 v51, v51, s24, -v92
    v_fma_f32 v52, v52, s24, -v92
    v_fma_f32 v53, v53, s24, -v92
    v_fma_f32 v54, v54, s24, -v92
    v_fma_f32 v55, v55, s24, -v92
    v_exp_f32 v48, v48
    v_exp_f32 v49, v49
    v_exp_f32 v50, v50
    v_exp_f32 v51, v51
    v_exp_f32 v52, v52
    v_exp_f32 v53, v53
    v_exp_f32 v54, v54
    v_exp_f32 v55, v55
    v_add_f32 v92, v48, v49
    v_add_f32 v93, v50, v51
    v_add_f32 v92, v92, v52
    v_add_f32 v93, v93, v53
    v_add_f32 v92, v92, v54
    v_add_f32 v93, v93, v55
    v_add_f32 v92, v92, v93
    v_cndmask_b32 v92, 0, v92, s[50:51]
    s_nop 1
    v_add_f32 v92, v92, v92 quad_perm:[1,0,3,2] row_mask:0xf bank_mask:0xf
    s_nop 1
    v_add_f32 v92, v92, v92 quad_perm:[2,3,0,1] row_mask:0xf bank_mask:0xf
    s_nop 1
    v_add_f32 v92, v92, v92 row_half_mirror row_mask:0xf bank_mask:0xf
    v_rcp_f32 v92, v92
    s_nop 0
    v_mul_f32 v48, v48, v92
    v_mul_f32 v49, v49, v92
    v_mul_f32 v50, v50, v92
    v_mul_f32 v51, v51, v92
    v_mul_f32 v52, v52, v92
    v_mul_f32 v53, v53, v92
    v_mul_f32 v54, v54, v92
    v_mul_f32 v55, v55, v92
    v_cvt_pk_bf16_f32 v56, v48, v49
    v_cvt_pk_bf16_f32 v57, v50, v51
    v_cvt_pk_bf16_f32 v58, v52, v53
    v_cvt_pk_bf16_f32 v59, v54, v55
    v_min_u32 v56, -2, v56
    v_min_u32 v57, -2, v57
    v_min_u32 v58, -2, v58
    v_min_u32 v59, -2, v59
    buffer_store_dwordx4 v[56:59], v22, s[8:11], s42 offen sc1
    s_add_u32 s42, s42, 81920
    s_cmp_lt_u32 s40, 64
    s_cbranch_scc1 chain2_kernel_s_step
    s_branch chain2_kernel_end
chain2_kernel_s_go:
    v_mov_b32 v24, 0
    v_mov_b32 v25, 0
    v_mov_b32 v26, 0
    v_mov_b32 v27, 0
    v_mov_b32 v28, 0
    v_mov_b32 v29, 0
    v_mov_b32 v30, 0
    v_mov_b32 v31, 0
    v_mov_b32 v32, 0
    v_mov_b32 v33, 0
    v_mov_b32 v34, 0
    v_mov_b32 v35, 0
    v_mov_b32 v36, 0
    v_mov_b32 v37, 0
    v_mov_b32 v38, 0
    v_mov_b32 v39, 0
    v_mov_b32 v40, 0
    v_mov_b32 v41, 0
    v_mov_b32 v42, 0
    v_mov_b32 v43, 0
    v_mov_b32 v44, 0
    v_mov_b32 v45, 0
    v_mov_b32 v46, 0
    v_mov_b32 v47, 0
    s_waitcnt vmcnt(0)
    s_branch chain2_kernel_s_go2
chain2_kernel_roleV:
    s_sub_u32 s44, s2, 32
    s_load_dwordx2 s[6:7], s[0:1], 56
    s_load_dwordx2 s[24:25], s[0:1], 64
    s_waitcnt lgkmcnt(0)
    s_mov_b32 s12, s6
    s_mov_b32 s13, s7
    s_mov_b32 s14, 7864320
    s_mov_b32 s15, 0x00020000
    s_mov_b32 s16, s24
    s_mov_b32 s17, s25
    s_mov_b32 s18, 7864320
    s_mov_b32 s19, 0x00020000
    v_add_u32 v16, 0, v0
    s_mov_b32 s24, 683
    v_mul_lo_u32 v17, v16, s24
    v_lshrrev_b32 v17, 14, v17
    v_mul_u32_u24 v18, 24, v17
    v_sub_u32 v18, v16, v18
    s_mov_b32 s24, 12288
    v_mul_lo_u32 v4, v17, s24
    v_lshl_add_u32 v4, v18, 4, v4
    v_mul_u32_u24 v10, 400, v17
    v_lshl_add_u32 v10, v18, 4, v10
    v_add_u32 v10, 90112, v10
    v_add_u32 v16, 256, v0
    s_mov_b32 s24, 683
    v_mul_lo_u32 v17, v16, s24
    v_lshrrev_b32 v17, 14, v17
    v_mul_u32_u24 v18, 24, v17
    v_sub_u32 v18, v16, v18
    s_mov_b32 s24, 12288
    v_mul_lo_u32 v5, v17, s24
    v_lshl_add_u32 v5, v18, 4, v5
    v_mul_u32_u24 v11, 400, v17
    v_lshl_add_u32 v11, v18, 4, v11
    v_add_u32 v11, 90112, v11
    v_add_u32 v16, 512, v0
    s_mov_b32 s24, 683
    v_mul_lo_u32 v17, v16, s24
    v_lshrrev_b32 v17, 14, v17
    v_mul_u32_u24 v18, 24, v17
    v_sub_u32 v18, v16, v18
    s_mov_b32 s24, 12288
    v_mul_lo_u32 v6, v17, s24
    v_lshl_add_u32 v6, v18, 4, v6
    v_mul_u32_u24 v12, 400, v17
    v_lshl_add_u32 v12, v18, 4, v12
    v_add_u32 v12, 90112, v12
    v_add_u32 v16, 768, v0
    s_mov_b32 s24, 683
    v_mul_lo_u32 v17, v16, s24
    v_lshrrev_b32 v17, 14, v17
    v_mul_u32_u24 v18, 24, v17
    v_sub_u32 v18, v16, v18
    s_mov_b32 s24, 12288
    v_mul_lo_u32 v7, v17, s24
    v_lshl_add_u32 v7, v18, 4, v7
    v_mul_u32_u24 v13, 400, v17
    v_lshl_add_u32 v13, v18, 4, v13
    v_add_u32 v13, 90112, v13
    v_add_u32 v16, 1024, v0
    s_mov_b32 s24, 683
    v_mul_lo_u32 v17, v16, s24
    v_lshrrev_b32 v17, 14, v17
    v_mul_u32_u24 v18, 24, v17
    v_sub_u32 v18, v16, v18
    s_mov_b32 s24, 12288
    v_mul_lo_u32 v8, v17, s24
    v_lshl_add_u32 v8, v18, 4, v8
    v_mul_u32_u24 v14, 400, v17
    v_lshl_add_u32 v14, v18, 4, v14
    v_add_u32 v14, 90112, v14
    v_add_u32 v16, 1280, v0
    s_mov_b32 s24, 683
    v_mul_lo_u32 v17, v16, s24
    v_lshrrev_b32 v17, 14, v17
    v_mul_u32_u24 v18, 24, v17
    v_sub_u32 v18, v16, v18
    s_mov_b32 s24, 12288
    v_mul_lo_u32 v9, v17, s24
    v_lshl_add_u32 v9, v18, 4, v9
    v_mul_u32_u24 v15, 400, v17
    v_lshl_add_u32 v15, v18, 4, v15
    v_add_u32 v15, 90112, v15
    v_lshrrev_b32 v17, 1, v3
    v_lshlrev_b32 v17, 4, v17
    v_and_b32 v18, 1, v3
    v_lshl_add_u32 v17, v18, 2, v17
    v_lshrrev_b32 v18, 2, v2
    v_and_b32 v19, 1, v18
    v_add_u32 v17, v17, v19
    v_lshrrev_b32 v18, 1, v18
    v_lshl_add_u32 v17, v18, 3, v17
    v_mul_u32_u24 v16, 400, v17
    v_and_b32 v18, 3, v2
    v_lshl_add_u32 v16, v18, 3, v16
    v_add_u32 v16, 90112, v16
    s_mul_i32 s24, s3, 96
    v_add_u32 v16, s24, v16
    s_mul_i32 s45, s44, 384
    s_add_u32 s46, s45, 0
    buffer_load_dwordx4 v[24:27], v4, s[12:15], s46 offen
    buffer_load_dwordx4 v[28:31], v5, s[12:15], s46 offen
    buffer_load_dwordx4 v[32:35], v6, s[12:15], s46 offen
    buffer_load_dwordx4 v[36:39], v7, s[12:15], s46 offen
    buffer_load_dwordx4 v[40:43], v8, s[12:15], s46 offen
    buffer_load_dwordx4 v[44:47], v9, s[12:15], s46 offen
    s_add_u32 s46, s45, 786432
    buffer_load_dwordx4 v[48:51], v4, s[12:15], s46 offen
    buffer_load_dwordx4 v[52:55], v5, s[12:15], s46 offen
    buffer_load_dwordx4 v[56:59], v6, s[12:15], s46 offen
    buffer_load_dwordx4 v[60:63], v7, s[12:15], s46 offen
    buffer_load_dwordx4 v[64:67], v8, s[12:15], s46 offen
    buffer_load_dwordx4 v[68:71], v9, s[12:15], s46 offen
    s_waitcnt vmcnt(6)
    ds_write_b128 v10, v[24:27]
    ds_write_b128 v11, v[28:31]
    ds_write_b128 v12, v[32:35]
    ds_write_b128 v13, v[36:39]
    ds_write_b128 v14, v[40:43]
    ds_write_b128 v15, v[44:47]
    s_add_u32 s46, s45, 1572864
    buffer_load_dwordx4 v[72:75], v4, s[12:15], s46 offen
    buffer_load_dwordx4 v[76:79], v5, s[12:15], s46 offen
    buffer_load_dwordx4 v[80:83], v6, s[12:15], s46 offen
    buffer_load_dwordx4 v[84:87], v7, s[12:15], s46 offen
    buffer_load_dwordx4 v[88:91], v8, s[12:15], s46 offen
    buffer_load_dwordx4 v[92:95], v9, s[12:15], s46 offen
    s_waitcnt lgkmcnt(0)
    s_barrier
    ds_read_b64_tr_b16 a[0:1], v16 offset:0
    ds_read_b64_tr_b16 a[2:3], v16 offset:800
    ds_read_b64_tr_b16 a[4:5], v16 offset:12800
    ds_read_b64_tr_b16 a[6:7], v16 offset:13600
    ds_read_b64_tr_b16 a[80:81], v16 offset:32
    ds_read_b64_tr_b16 a[82:83], v16 offset:832
    ds_read_b64_tr_b16 a[84:85], v16 offset:12832
    ds_read_b64_tr_b16 a[86:87], v16 offset:13632
    ds_read_b64_tr_b16 a[160:161], v16 offset:64
    ds_read_b64_tr_b16 a[162:163], v16 offset:864
    ds_read_b64_tr_b16 a[164:165], v16 offset:12864
    ds_read_b64_tr_b16 a[166:167], v16 offset:13664
    s_waitcnt lgkmcnt(0)
    s_barrier
    s_waitcnt vmcnt(6)
    ds_write_b128 v10, v[48:51]
    ds_write_b128 v11, v[52:55]
    ds_write_b128 v12, v[56:59]
    ds_write_b128 v13, v[60:63]
    ds_write_b128 v14, v[64:67]
    ds_write_b128 v15, v[68:71]
    s_add_u32 s46, s45, 2359296
    buffer_load_dwordx4 v[24:27], v4, s[12:15], s46 offen
    buffer_load_dwordx4 v[28:31], v5, s[12:15], s46 offen
    buffer_load_dwordx4 v[32:35], v6, s[12:15], s46 offen
    buffer_load_dwordx4 v[36:39], v7, s[12:15], s46 offen
    buffer_load_dwordx4 v[40:43], v8, s[12:15], s46 offen
    buffer_load_dwordx4 v[44:47], v9, s[12:15], s46 offen
    s_waitcnt lgkmcnt(0)
    s_barrier
    ds_read_b64_tr_b16 a[8:9], v16 offset:0
    ds_read_b64_tr_b16 a[10:11], v16 offset:800
    ds_read_b64_tr_b16 a[12:13], v16 offset:12800
    ds_read_b64_tr_b16 a[14:15], v16 offset:13600
    ds_read_b64_tr_b16 a[88:89], v16 offset:32
    ds_read_b64_tr_b16 a[90:91], v16 offset:832
    ds_read_b64_tr_b16 a[92:93], v16 offset:12832
    ds_read_b64_tr_b16 a[94:95], v16 offset:13632
    ds_read_b64_tr_b16 a[168:169], v16 offset:64
    ds_read_b64_tr_b16 a[170:171], v16 offset:864
    ds_read_b64_tr_b16 a[172:173], v16 offset:12864
    ds_read_b64_tr_b16 a[174:175], v16 offset:13664
    s_waitcnt lgkmcnt(0)
    s_barrier
    s_waitcnt vmcnt(6)
    ds_write_b128 v10, v[72:75]
    ds_write_b128 v11, v[76:79]
    ds_write_b128 v12, v[80:83]
    ds_write_b128 v13, v[84:87]
    ds_write_b128 v14, v[88:91]
    ds_write_b128 v15, v[92:95]
    s_add_u32 s46, s45, 3145728
    buffer_load_dwordx4 v[48:51], v4, s[12:15], s46 offen
    buffer_load_dwordx4 v[52:55], v5, s[12:15], s46 offen
    buffer_load_dwordx4 v[56:59], v6, s[12:15], s46 offen
    buffer_load_dwordx4 v[60:63], v7, s[12:15], s46 offen
    buffer_load_dwordx4 v[64:67], v8, s[12:15], s46 offen
    buffer_load_dwordx4 v[68:71], v9, s[12:15], s46 offen
    s_waitcnt lgkmcnt(0)
    s_barrier
    ds_read_b64_tr_b16 a[16:17], v16 offset:0
    ds_read_b64_tr_b16 a[18:19], v16 offset:800
    ds_read_b64_tr_b16 a[20:21], v16 offset:12800
    ds_read_b64_tr_b16 a[22:23], v16 offset:13600
    ds_read_b64_tr_b16 a[96:97], v16 offset:32
    ds_read_b64_tr_b16 a[98:99], v16 offset:832
    ds_read_b64_tr_b16 a[100:101], v16 offset:12832
    ds_read_b64_tr_b16 a[102:103], v16 offset:13632
    ds_read_b64_tr_b16 a[176:177], v16 offset:64
    ds_read_b64_tr_b16 a[178:179], v16 offset:864
    ds_read_b64_tr_b16 a[180:181], v16 offset:12864
    ds_read_b64_tr_b16 a[182:183], v16 offset:13664
    s_waitcnt lgkmcnt(0)
    s_barrier
    s_waitcnt vmcnt(6)
    ds_write_b128 v10, v[24:27]
    ds_write_b128 v11, v[28:31]
    ds_write_b128 v12, v[32:35]
    ds_write_b128 v13, v[36:39]
    ds_write_b128 v14, v[40:43]
    ds_write_b128 v15, v[44:47]
    s_add_u32 s46, s45, 3932160
    buffer_load_dwordx4 v[72:75], v4, s[12:15], s46 offen
    buffer_load_dwordx4 v[76:79], v5, s[12:15], s46 offen
    buffer_load_dwordx4 v[80:83], v6, s[12:15], s46 offen
    buffer_load_dwordx4 v[84:87], v7, s[12:15], s46 offen
    buffer_load_dwordx4 v[88:91], v8, s[12:15], s46 offen
    buffer_load_dwordx4 v[92:95], v9, s[12:15], s46 offen
    s_waitcnt lgkmcnt(0)
    s_barrier
    ds_read_b64_tr_b16 a[24:25], v16 offset:0
    ds_read_b64_tr_b16 a[26:27], v16 offset:800
    ds_read_b64_tr_b16 a[28:29], v16 offset:12800
    ds_read_b64_tr_b16 a[30:31], v16 offset:13600
    ds_read_b64_tr_b16 a[104:105], v16 offset:32
    ds_read_b64_tr_b16 a[106:107], v16 offset:832
    ds_read_b64_tr_b16 a[108:109], v16 offset:12832
    ds_read_b64_tr_b16 a[110:111], v16 offset:13632
    ds_read_b64_tr_b16 a[184:185], v16 offset:64
    ds_read_b64_tr_b16 a[186:187], v16 offset:864
    ds_read_b64_tr_b16 a[188:189], v16 offset:12864
    ds_read_b64_tr_b16 a[190:191], v16 offset:13664
    s_waitcnt lgkmcnt(0)
    s_barrier
    s_waitcnt vmcnt(6)
    ds_write_b128 v10, v[48:51]
    ds_write_b128 v11, v[52:55]
    ds_write_b128 v12, v[56:59]
    ds_write_b128 v13, v[60:63]
    ds_write_b128 v14, v[64:67]
    ds_write_b128 v15, v[68:71]
    s_add_u32 s46, s45, 4718592
    buffer_load_dwordx4 v[24:27], v4, s[12:15], s46 offen
    buffer_load_dwordx4 v[28:31], v5, s[12:15], s46 offen
    buffer_load_dwordx4 v[32:35], v6, s[12:15], s46 offen
    buffer_load_dwordx4 v[36:39], v7, s[12:15], s46 offen
    buffer_load_dwordx4 v[40:43], v8, s[12:15], s46 offen
    buffer_load_dwordx4 v[44:47], v9, s[12:15], s46 offen
    s_waitcnt lgkmcnt(0)
    s_barrier
    ds_read_b64_tr_b16 a[32:33], v16 offset:0
    ds_read_b64_tr_b16 a[34:35], v16 offset:800
    ds_read_b64_tr_b16 a[36:37], v16 offset:12800
    ds_read_b64_tr_b16 a[38:39], v16 offset:13600
    ds_read_b64_tr_b16 a[112:113], v16 offset:32
    ds_read_b64_tr_b16 a[114:115], v16 offset:832
    ds_read_b64_tr_b16 a[116:117], v16 offset:12832
    ds_read_b64_tr_b16 a[118:119], v16 offset:13632
    ds_read_b64_tr_b16 a[192:193], v16 offset:64
    ds_read_b64_tr_b16 a[194:195], v16 offset:864
    ds_read_b64_tr_b16 a[196:197], v16 offset:12864
    ds_read_b64_tr_b16 a[198:199], v16 offset:13664
    s_waitcnt lgkmcnt(0)
    s_barrier
    s_waitcnt vmcnt(6)
    ds_write_b128 v10, v[72:75]
    ds_write_b128 v11, v[76:79]
    ds_write_b128 v12, v[80:83]
    ds_write_b128 v13, v[84:87]
    ds_write_b128 v14, v[88:91]
    ds_write_b128 v15, v[92:95]
    s_add_u32 s46, s45, 5505024
    buffer_load_dwordx4 v[48:51], v4, s[12:15], s46 offen
    buffer_load_dwordx4 v[52:55], v5, s[12:15], s46 offen
    buffer_load_dwordx4 v[56:59], v6, s[12:15], s46 offen
    buffer_load_dwordx4 v[60:63], v7, s[12:15], s46 offen
    buffer_load_dwordx4 v[64:67], v8, s[12:15], s46 offen
    buffer_load_dwordx4 v[68:71], v9, s[12:15], s46 offen
    s_waitcnt lgkmcnt(0)
    s_barrier
    ds_read_b64_tr_b16 a[40:41], v16 offset:0
    ds_read_b64_tr_b16 a[42:43], v16 offset:800
    ds_read_b64_tr_b16 a[44:45], v16 offset:12800
    ds_read_b64_tr_b16 a[46:47], v16 offset:13600
    ds_read_b64_tr_b16 a[120:121], v16 offset:32
    ds_read_b64_tr_b16 a[122:123], v16 offset:832
    ds_read_b64_tr_b16 a[124:125], v16 offset:12832
    ds_read_b64_tr_b16 a[126:127], v16 offset:13632
    ds_read_b64_tr_b16 a[200:201], v16 offset:64
    ds_read_b64_tr_b16 a[202:203], v16 offset:864
    ds_read_b64_tr_b16 a[204:205], v16 offset:12864
    ds_read_b64_tr_b16 a[206:207], v16 offset:13664
    s_waitcnt lgkmcnt(0)
    s_barrier
    s_waitcnt vmcnt(6)
    ds_write_b128 v10, v[24:27]
    ds_write_b128 v11, v[28:31]
    ds_write_b128 v12, v[32:35]
    ds_write_b128 v13, v[36:39]
    ds_write_b128 v14, v[40:43]
    ds_write_b128 v15, v[44:47]
    s_add_u32 s46, s45, 6291456
    buffer_load_dwordx4 v[72:75], v4, s[12:15], s46 offen
    buffer_load_dwordx4 v[76:79], v5, s[12:15], s46 offen
    buffer_load_dwordx4 v[80:83], v6, s[12:15], s46 offen
    buffer_load_dwordx4 v[84:87], v7, s[12:15], s46 offen
    buffer_load_dwordx4 v[88:91], v8, s[12:15], s46 offen
    buffer_load_dwordx4 v[92:95], v9, s[12:15], s46 offen
    s_waitcnt lgkmcnt(0)
    s_barrier
    ds_read_b64_tr_b16 a[48:49], v16 offset:0
    ds_read_b64_tr_b16 a[50:51], v16 offset:800
    ds_read_b64_tr_b16 a[52:53], v16 offset:12800
    ds_read_b64_tr_b16 a[54:55], v16 offset:13600
    ds_read_b64_tr_b16 a[128:129], v16 offset:32
    ds_read_b64_tr_b16 a[130:131], v16 offset:832
    ds_read_b64_tr_b16 a[132:133], v16 offset:12832
    ds_read_b64_tr_b16 a[134:135], v16 offset:13632
    ds_read_b64_tr_b16 a[208:209], v16 offset:64
    ds_read_b64_tr_b16 a[210:211], v16 offset:864
    ds_read_b64_tr_b16 a[212:213], v16 offset:12864
    ds_read_b64_tr_b16 a[214:215], v16 offset:13664
    s_waitcnt lgkmcnt(0)
    s_barrier
    s_waitcnt vmcnt(6)
    ds_write_b128 v10, v[48:51]
    ds_write_b128 v11, v[52:55]
    ds_write_b128 v12, v[56:59]
    ds_write_b128 v13, v[60:63]
    ds_write_b128 v14, v[64:67]
    ds_write_b128 v15, v[68:71]
    s_add_u32 s46, s45, 7077888
    buffer_load_dwordx4 v[24:27], v4, s[12:15], s46 offen
    buffer_load_dwordx4 v[28:31], v5, s[12:15], s46 offen
    buffer_load_dwordx4 v[32:35], v6, s[12:15], s46 offen
    buffer_load_dwordx4 v[36:39], v7, s[12:15], s46 offen
    buffer_load_dwordx4 v[40:43], v8, s[12:15], s46 offen
    buffer_load_dwordx4 v[44:47], v9, s[12:15], s46 offen
    s_waitcnt lgkmcnt(0)
    s_barrier
    ds_read_b64_tr_b16 a[56:57], v16 offset:0
    ds_read_b64_tr_b16 a[58:59], v16 offset:800
    ds_read_b64_tr_b16 a[60:61], v16 offset:12800
    ds_read_b64_tr_b16 a[62:63], v16 offset:13600
    ds_read_b64_tr_b16 a[136:137], v16 offset:32
    ds_read_b64_tr_b16 a[138:139], v16 offset:832
    ds_read_b64_tr_b16 a[140:141], v16 offset:12832
    ds_read_b64_tr_b16 a[142:143], v16 offset:13632
    ds_read_b64_tr_b16 a[216:217], v16 offset:64
    ds_read_b64_tr_b16 a[218:219], v16 offset:864
    ds_read_b64_tr_b16 a[220:221], v16 offset:12864
    ds_read_b64_tr_b16 a[222:223], v16 offset:13664
    s_waitcnt lgkmcnt(0)
    s_barrier
    s_waitcnt vmcnt(6)
    ds_write_b128 v10, v[72:75]
    ds_write_b128 v11, v[76:79]
    ds_write_b128 v12, v[80:83]
    ds_write_b128 v13, v[84:87]
    ds_write_b128 v14, v[88:91]
    ds_write_b128 v15, v[92:95]
    s_waitcnt lgkmcnt(0)
    s_barrier
    ds_read_b64_tr_b16 a[64:65], v16 offset:0
    ds_read_b64_tr_b16 a[66:67], v16 offset:800
    ds_read_b64_tr_b16 a[68:69], v16 offset:12800
    ds_read_b64_tr_b16 a[70:71], v16 offset:13600
    ds_read_b64_tr_b16 a[144:145], v16 offset:32
    ds_read_b64_tr_b16 a[146:147], v16 offset:832
    ds_read_b64_tr_b16 a[148:149], v16 offset:12832
    ds_read_b64_tr_b16 a[150:151], v16 offset:13632
    ds_read_b64_tr_b16 a[224:225], v16 offset:64
    ds_read_b64_tr_b16 a[226:227], v16 offset:864
    ds_read_b64_tr_b16 a[228:229], v16 offset:12864
    ds_read_b64_tr_b16 a[230:231], v16 offset:13664
    s_waitcnt lgkmcnt(0)
    s_barrier
    s_waitcnt vmcnt(0)
    ds_write_b128 v10, v[24:27]
    ds_write_b128 v11, v[28:31]
    ds_write_b128 v12, v[32:35]
    ds_write_b128 v13, v[36:39]
    ds_write_b128 v14, v[40:43]
    ds_write_b128 v15, v[44:47]
    s_waitcnt lgkmcnt(0)
    s_barrier
    ds_read_b64_tr_b16 a[72:73], v16 offset:0
    ds_read_b64_tr_b16 a[74:75], v16 offset:800
    ds_read_b64_tr_b16 a[76:77], v16 offset:12800
    ds_read_b64_tr_b16 a[78:79], v16 offset:13600
    ds_read_b64_tr_b16 a[152:153], v16 offset:32
    ds_read_b64_tr_b16 a[154:155], v16 offset:832
    ds_read_b64_tr_b16 a[156:157], v16 offset:12832
    ds_read_b64_tr_b16 a[158:159], v16 offset:13632
    ds_read_b64_tr_b16 a[232:233], v16 offset:64
    ds_read_b64_tr_b16 a[234:235], v16 offset:864
    ds_read_b64_tr_b16 a[236:237], v16 offset:12864
    ds_read_b64_tr_b16 a[238:239], v16 offset:13664
    s_waitcnt lgkmcnt(0)
    s_barrier
    v_add_u32 v64, 0, v0
    s_mov_b32 s24, 1639
    v_mul_lo_u32 v65, v64, s24
    v_lshrrev_b32 v65, 16, v65
    v_mul_u32_u24 v66, 40, v65
    v_sub_u32 v66, v64, v66
    s_mov_b32 s24, 1280
    v_mul_lo_u32 v4, v65, s24
    v_lshl_add_u32 v4, v66, 4, v4
    v_mul_u32_u24 v14, 656, v65
    v_lshl_add_u32 v14, v66, 4, v14
    v_add_u32 v14, 90112, v14
    v_add_u32 v64, 256, v0
    s_mov_b32 s24, 1639
    v_mul_lo_u32 v65, v64, s24
    v_lshrrev_b32 v65, 16, v65
    v_mul_u32_u24 v66, 40, v65
    v_sub_u32 v66, v64, v66
    s_mov_b32 s24, 1280
    v_mul_lo_u32 v5, v65, s24
    v_lshl_add_u32 v5, v66, 4, v5
    v_mul_u32_u24 v15, 656, v65
    v_lshl_add_u32 v15, v66, 4, v15
    v_add_u32 v15, 90112, v15
    v_add_u32 v64, 512, v0
    s_mov_b32 s24, 1639
    v_mul_lo_u32 v65, v64, s24
    v_lshrrev_b32 v65, 16, v65
    v_mul_u32_u24 v66, 40, v65
    v_sub_u32 v66, v64, v66
    s_mov_b32 s24, 1280
    v_mul_lo_u32 v6, v65, s24
    v_lshl_add_u32 v6, v66, 4, v6
    v_mul_u32_u24 v16, 656, v65
    v_lshl_add_u32 v16, v66, 4, v16
    v_add_u32 v16, 90112, v16
    v_add_u32 v64, 768, v0
    s_mov_b32 s24, 1639
    v_mul_lo_u32 v65, v64, s24
    v_lshrrev_b32 v65, 16, v65
    v_mul_u32_u24 v66, 40, v65
    v_sub_u32 v66, v64, v66
    s_mov_b32 s24, 1280
    v_mul_lo_u32 v7, v65, s24
    v_lshl_add_u32 v7, v66, 4, v7
    v_mul_u32_u24 v17, 656, v65
    v_lshl_add_u32 v17, v66, 4, v17
    v_add_u32 v17, 90112, v17
    v_add_u32 v64, 1024, v0
    s_mov_b32 s24, 1639
    v_mul_lo_u32 v65, v64, s24
    v_lshrrev_b32 v65, 16, v65
    v_mul_u32_u24 v66, 40, v65
    v_sub_u32 v66, v64, v66
    s_mov_b32 s24, 1280
    v_mul_lo_u32 v8, v65, s24
    v_lshl_add_u32 v8, v66, 4, v8
    v_mul_u32_u24 v18, 656, v65
    v_lshl_add_u32 v18, v66, 4, v18
    v_add_u32 v18, 90112, v18
    v_add_u32 v64, 1280, v0
    s_mov_b32 s24, 1639
    v_mul_lo_u32 v65, v64, s24
    v_lshrrev_b32 v65, 16, v65
    v_mul_u32_u24 v66, 40, v65
    v_sub_u32 v66, v64, v66
    s_mov_b32 s24, 1280
    v_mul_lo_u32 v9, v65, s24
    v_lshl_add_u32 v9, v66, 4, v9
    v_mul_u32_u24 v19, 656, v65
    v_lshl_add_u32 v19, v66, 4, v19
    v_add_u32 v19, 90112, v19
    v_add_u32 v64, 1536, v0
    s_mov_b32 s24, 1639
    v_mul_lo_u32 v65, v64, s24
    v_lshrrev_b32 v65, 16, v65
    v_mul_u32_u24 v66, 40, v65
    v_sub_u32 v66, v64, v66
    s_mov_b32 s24, 1280
    v_mul_lo_u32 v10, v65, s24
    v_lshl_add_u32 v10, v66, 4, v10
    v_mul_u32_u24 v20, 656, v65
    v_lshl_add_u32 v20, v66, 4, v20
    v_add_u32 v20, 90112, v20
    v_add_u32 v64, 1792, v0
    s_mov_b32 s24, 1639
    v_mul_lo_u32 v65, v64, s24
    v_lshrrev_b32 v65, 16, v65
    v_mul_u32_u24 v66, 40, v65
    v_sub_u32 v66, v64, v66
    s_mov_b32 s24, 1280
    v_mul_lo_u32 v11, v65, s24
    v_lshl_add_u32 v11, v66, 4, v11
    v_mul_u32_u24 v21, 656, v65
    v_lshl_add_u32 v21, v66, 4, v21
    v_add_u32 v21, 90112, v21
    v_add_u32 v64, 2048, v0
    s_mov_b32 s24, 1639
    v_mul_lo_u32 v65, v64, s24
    v_lshrrev_b32 v65, 16, v65
    v_mul_u32_u24 v66, 40, v65
    v_sub_u32 v66, v64, v66
    s_mov_b32 s24, 1280
    v_mul_lo_u32 v12, v65, s24
    v_lshl_add_u32 v12, v66, 4, v12
    v_mul_u32_u24 v22, 656, v65
    v_lshl_add_u32 v22, v66, 4, v22
    v_add_u32 v22, 90112, v22
    v_add_u32 v64, 2304, v0
    s_mov_b32 s24, 1639
    v_mul_lo_u32 v65, v64, s24
    v_lshrrev_b32 v65, 16, v65
    v_mul_u32_u24 v66, 40, v65
    v_sub_u32 v66, v64, v66
    s_mov_b32 s24, 1280
    v_mul_lo_u32 v13, v65, s24
    v_lshl_add_u32 v13, v66, 4, v13
    v_mul_u32_u24 v23, 656, v65
    v_lshl_add_u32 v23, v66, 4, v23
    v_add_u32 v23, 90112, v23
    v_lshrrev_b32 v64, 1, v3
    v_lshlrev_b32 v64, 4, v64
    v_and_b32 v65, 1, v3
    v_lshl_add_u32 v64, v65, 2, v64
    v_lshrrev_b32 v65, 2, v2
    v_and_b32 v66, 1, v65
    v_add_u32 v64, v64, v66
    v_lshrrev_b32 v65, 1, v65
    v_lshl_add_u32 v64, v65, 3, v64
    v_mul_u32_u24 v72, 656, v64
    v_and_b32 v65, 3, v2
    v_lshl_add_u32 v72, v65, 3, v72
    v_add_u32 v72, 90112, v72
    s_and_b32 s24, s3, 1
    s_mul_i32 s24, s24, 320
    v_add_u32 v72, s24, v72
    v_lshlrev_b32 v73, 4, v1
    s_mul_i32 s24, s3, 18432
    s_add_u32 s24, s24, 16384
    v_add_u32 v73, s24, v73
    s_mul_i32 s45, s44, 245760
    s_add_u32 s46, s45, 0
    buffer_load_dwordx4 v[24:27], v4, s[16:19], s46 offen
    buffer_load_dwordx4 v[28:31], v5, s[16:19], s46 offen
    buffer_load_dwordx4 v[32:35], v6, s[16:19], s46 offen
    buffer_load_dwordx4 v[36:39], v7, s[16:19], s46 offen
    buffer_load_dwordx4 v[40:43], v8, s[16:19], s46 offen
    buffer_load_dwordx4 v[44:47], v9, s[16:19], s46 offen
    buffer_load_dwordx4 v[48:51], v10, s[16:19], s46 offen
    buffer_load_dwordx4 v[52:55], v11, s[16:19], s46 offen
    buffer_load_dwordx4 v[56:59], v12, s[16:19], s46 offen
    buffer_load_dwordx4 v[60:63], v13, s[16:19], s46 offen
    s_waitcnt vmcnt(0)
    ds_write_b128 v14, v[24:27]
    ds_write_b128 v15, v[28:31]
    ds_write_b128 v16, v[32:35]
    ds_write_b128 v17, v[36:39]
    ds_write_b128 v18, v[40:43]
    ds_write_b128 v19, v[44:47]
    ds_write_b128 v20, v[48:51]
    ds_write_b128 v21, v[52:55]
    ds_write_b128 v22, v[56:59]
    ds_write_b128 v23, v[60:63]
    s_waitcnt lgkmcnt(0)
    s_barrier
    s_lshr_b32 s24, s3, 1
    s_cmp_eq_u32 s24, 0
    s_cbranch_scc0 chain2_kernel_wo1
    ds_read_b64_tr_b16 a[240:241], v72 offset:0
    ds_read_b64_tr_b16 a[242:243], v72 offset:1312
    ds_read_b64_tr_b16 a[244:245], v72 offset:20992
    ds_read_b64_tr_b16 a[246:247], v72 offset:22304
    ds_read_b64_tr_b16 v[112:113], v72 offset:32
    ds_read_b64_tr_b16 v[114:115], v72 offset:1344
    ds_read_b64_tr_b16 v[116:117], v72 offset:21024
    ds_read_b64_tr_b16 v[118:119], v72 offset:22336
    ds_read_b64_tr_b16 v[136:137], v72 offset:64
    ds_read_b64_tr_b16 v[138:139], v72 offset:1376
    ds_read_b64_tr_b16 v[140:141], v72 offset:21056
    ds_read_b64_tr_b16 v[142:143], v72 offset:22368
    ds_read_b64_tr_b16 v[160:161], v72 offset:96
    ds_read_b64_tr_b16 v[162:163], v72 offset:1408
    ds_read_b64_tr_b16 v[164:165], v72 offset:21088
    ds_read_b64_tr_b16 v[166:167], v72 offset:22400
    ds_read_b64_tr_b16 v[184:185], v72 offset:128
    ds_read_b64_tr_b16 v[186:187], v72 offset:1440
    ds_read_b64_tr_b16 v[188:189], v72 offset:21120
    ds_read_b64_tr_b16 v[190:191], v72 offset:22432
    ds_read_b64_tr_b16 v[208:209], v72 offset:160
    ds_read_b64_tr_b16 v[210:211], v72 offset:1472
    ds_read_b64_tr_b16 v[212:213], v72 offset:21152
    ds_read_b64_tr_b16 v[214:215], v72 offset:22464
    ds_read_b64_tr_b16 v[232:233], v72 offset:192
    ds_read_b64_tr_b16 v[234:235], v72 offset:1504
    ds_read_b64_tr_b16 v[236:237], v72 offset:21184
    ds_read_b64_tr_b16 v[238:239], v72 offset:22496
    ds_read_b64_tr_b16 v[64:65], v72 offset:224
    ds_read_b64_tr_b16 v[66:67], v72 offset:1536
    ds_read_b64_tr_b16 v[68:69], v72 offset:21216
    ds_read_b64_tr_b16 v[70:71], v72 offset:22528
    s_waitcnt lgkmcnt(0)
    ds_write_b128 v73, v[64:67] offset:0
    ds_write_b128 v73, v[68:71] offset:1024
    s_waitcnt lgkmcnt(0)
    ds_read_b64_tr_b16 v[64:65], v72 offset:256
    ds_read_b64_tr_b16 v[66:67], v72 offset:1568
    ds_read_b64_tr_b16 v[68:69], v72 offset:21248
    ds_read_b64_tr_b16 v[70:71], v72 offset:22560
    s_waitcnt lgkmcnt(0)
    ds_write_b128 v73, v[64:67] offset:6144
    ds_write_b128 v73, v[68:71] offset:7168
    s_waitcnt lgkmcnt(0)
    ds_read_b64_tr_b16 v[64:65], v72 offset:288
    ds_read_b64_tr_b16 v[66:67], v72 offset:1600
    ds_read_b64_tr_b16 v[68:69], v72 offset:21280
    ds_read_b64_tr_b16 v[70:71], v72 offset:22592
    s_waitcnt lgkmcnt(0)
    ds_write_b128 v73, v[64:67] offset:12288
    ds_write_b128 v73, v[68:71] offset:13312
    s_waitcnt lgkmcnt(0)
    s_waitcnt lgkmcnt(0)
chain2_kernel_wo1:
    s_barrier
    s_add_u32 s46, s45, 640
    buffer_load_dwordx4 v[24:27], v4, s[16:19], s46 offen
    buffer_load_dwordx4 v[28:31], v5, s[16:19], s46 offen
    buffer_load_dwordx4 v[32:35], v6, s[16:19], s46 offen
    buffer_load_dwordx4 v[36:39], v7, s[16:19], s46 offen
    buffer_load_dwordx4 v[40:43], v8, s[16:19], s46 offen
    buffer_load_dwordx4 v[44:47], v9, s[16:19], s46 offen
    buffer_load_dwordx4 v[48:51], v10, s[16:19], s46 offen
    buffer_load_dwordx4 v[52:55], v11, s[16:19], s46 offen
    buffer_load_dwordx4 v[56:59], v12, s[16:19], s46 offen
    buffer_load_dwordx4 v[60:63], v13, s[16:19], s46 offen
    s_waitcnt vmcnt(0)
    ds_write_b128 v14, v[24:27]
    ds_write_b128 v15, v[28:31]
    ds_write_b128 v16, v[32:35]
    ds_write_b128 v17, v[36:39]
    ds_write_b128 v18, v[40:43]
    ds_write_b128 v19, v[44:47]
    ds_write_b128 v20, v[48:51]
    ds_write_b128 v21, v[52:55]
    ds_write_b128 v22, v[56:59]
    ds_write_b128 v23, v[60:63]
    s_waitcnt lgkmcnt(0)
    s_barrier
    s_lshr_b32 s24, s3, 1
    s_cmp_eq_u32 s24, 1
    s_cbranch_scc0 chain2_kernel_wo2
    ds_read_b64_tr_b16 a[240:241], v72 offset:0
    ds_read_b64_tr_b16 a[242:243], v72 offset:1312
    ds_read_b64_tr_b16 a[244:245], v72 offset:20992
    ds_read_b64_tr_b16 a[246:247], v72 offset:22304
    ds_read_b64_tr_b16 v[112:113], v72 offset:32
    ds_read_b64_tr_b16 v[114:115], v72 offset:1344
    ds_read_b64_tr_b16 v[116:117], v72 offset:21024
    ds_read_b64_tr_b16 v[118:119], v72 offset:22336
    ds_read_b64_tr_b16 v[136:137], v72 offset:64
    ds_read_b64_tr_b16 v[138:139], v72 offset:1376
    ds_read_b64_tr_b16 v[140:141], v72 offset:21056
    ds_read_b64_tr_b16 v[142:143], v72 offset:22368
    ds_read_b64_tr_b16 v[160:161], v72 offset:96
    ds_read_b64_tr_b16 v[162:163], v72 offset:1408
    ds_read_b64_tr_b16 v[164:165], v72 offset:21088
    ds_read_b64_tr_b16 v[166:167], v72 offset:22400
    ds_read_b64_tr_b16 v[184:185], v72 offset:128
    ds_read_b64_tr_b16 v[186:187], v72 offset:1440
    ds_read_b64_tr_b16 v[188:189], v72 offset:21120
    ds_read_b64_tr_b16 v[190:191], v72 offset:22432
    ds_read_b64_tr_b16 v[208:209], v72 offset:160
    ds_read_b64_tr_b16 v[210:211], v72 offset:1472
    ds_read_b64_tr_b16 v[212:213], v72 offset:21152
    ds_read_b64_tr_b16 v[214:215], v72 offset:22464
    ds_read_b64_tr_b16 v[232:233], v72 offset:192
    ds_read_b64_tr_b16 v[234:235], v72 offset:1504
    ds_read_b64_tr_b16 v[236:237], v72 offset:21184
    ds_read_b64_tr_b16 v[238:239], v72 offset:22496
    ds_read_b64_tr_b16 v[64:65], v72 offset:224
    ds_read_b64_tr_b16 v[66:67], v72 offset:1536
    ds_read_b64_tr_b16 v[68:69], v72 offset:21216
    ds_read_b64_tr_b16 v[70:71], v72 offset:22528
    s_waitcnt lgkmcnt(0)
    ds_write_b128 v73, v[64:67] offset:0
    ds_write_b128 v73, v[68:71] offset:1024
    s_waitcnt lgkmcnt(0)
    ds_read_b64_tr_b16 v[64:65], v72 offset:256
    ds_read_b64_tr_b16 v[66:67], v72 offset:1568
    ds_read_b64_tr_b16 v[68:69], v72 offset:21248
    ds_read_b64_tr_b16 v[70:71], v72 offset:22560
    s_waitcnt lgkmcnt(0)
    ds_write_b128 v73, v[64:67] offset:6144
    ds_write_b128 v73, v[68:71] offset:7168
    s_waitcnt lgkmcnt(0)
    ds_read_b64_tr_b16 v[64:65], v72 offset:288
    ds_read_b64_tr_b16 v[66:67], v72 offset:1600
    ds_read_b64_tr_b16 v[68:69], v72 offset:21280
    ds_read_b64_tr_b16 v[70:71], v72 offset:22592
    s_waitcnt lgkmcnt(0)
    ds_write_b128 v73, v[64:67] offset:12288
    ds_write_b128 v73, v[68:71] offset:13312
    s_waitcnt lgkmcnt(0)
    s_waitcnt lgkmcnt(0)
chain2_kernel_wo2:
    s_barrier
    s_add_u32 s46, s45, 81920
    buffer_load_dwordx4 v[24:27], v4, s[16:19], s46 offen
    buffer_load_dwordx4 v[28:31], v5, s[16:19], s46 offen
    buffer_load_dwordx4 v[32:35], v6, s[16:19], s46 offen
    buffer_load_dwordx4 v[36:39], v7, s[16:19], s46 offen
    buffer_load_dwordx4 v[40:43], v8, s[16:19], s46 offen
    buffer_load_dwordx4 v[44:47], v9, s[16:19], s46 offen
    buffer_load_dwordx4 v[48:51], v10, s[16:19], s46 offen
    buffer_load_dwordx4 v[52:55], v11, s[16:19], s46 offen
    buffer_load_dwordx4 v[56:59], v12, s[16:19], s46 offen
    buffer_load_dwordx4 v[60:63], v13, s[16:19], s46 offen
    s_waitcnt vmcnt(0)
    ds_write_b128 v14, v[24:27]
    ds_write_b128 v15, v[28:31]
    ds_write_b128 v16, v[32:35]
    ds_write_b128 v17, v[36:39]
    ds_write_b128 v18, v[40:43]
    ds_write_b128 v19, v[44:47]
    ds_write_b128 v20, v[48:51]
    ds_write_b128 v21, v[52:55]
    ds_write_b128 v22, v[56:59]
    ds_write_b128 v23, v[60:63]
    s_waitcnt lgkmcnt(0)
    s_barrier
    s_lshr_b32 s24, s3, 1
    s_cmp_eq_u32 s24, 0
    s_cbranch_scc0 chain2_kernel_wo3
    ds_read_b64_tr_b16 a[248:249], v72 offset:0
    ds_read_b64_tr_b16 a[250:251], v72 offset:1312
    ds_read_b64_tr_b16 a[252:253], v72 offset:20992
    ds_read_b64_tr_b16 a[254:255], v72 offset:22304
    ds_read_b64_tr_b16 v[120:121], v72 offset:32
    ds_read_b64_tr_b16 v[122:123], v72 offset:1344
    ds_read_b64_tr_b16 v[124:125], v72 offset:21024
    ds_read_b64_tr_b16 v[126:127], v72 offset:22336
    ds_read_b64_tr_b16 v[144:145], v72 offset:64
    ds_read_b64_tr_b16 v[146:147], v72 offset:1376
    ds_read_b64_tr_b16 v[148:149], v72 offset:21056
    ds_read_b64_tr_b16 v[150:151], v72 offset:22368
    ds_read_b64_tr_b16 v[168:169], v72 offset:96
    ds_read_b64_tr_b16 v[170:171], v72 offset:1408
    ds_read_b64_tr_b16 v[172:173], v72 offset:21088
    ds_read_b64_tr_b16 v[174:175], v72 offset:22400
    ds_read_b64_tr_b16 v[192:193], v72 offset:128
    ds_read_b64_tr_b16 v[194:195], v72 offset:1440
    ds_read_b64_tr_b16 v[196:197], v72 offset:21120
    ds_read_b64_tr_b16 v[198:199], v72 offset:22432
    ds_read_b64_tr_b16 v[216:217], v72 offset:160
    ds_read_b64_tr_b16 v[218:219], v72 offset:1472
    ds_read_b64_tr_b16 v[220:221], v72 offset:21152
    ds_read_b64_tr_b16 v[222:223], v72 offset:22464
    ds_read_b64_tr_b16 v[240:241], v72 offset:192
    ds_read_b64_tr_b16 v[242:243], v72 offset:1504
    ds_read_b64_tr_b16 v[244:245], v72 offset:21184
    ds_read_b64_tr_b16 v[246:247], v72 offset:22496
    ds_read_b64_tr_b16 v[64:65], v72 offset:224
    ds_read_b64_tr_b16 v[66:67], v72 offset:1536
    ds_read_b64_tr_b16 v[68:69], v72 offset:21216
    ds_read_b64_tr_b16 v[70:71], v72 offset:22528
    s_waitcnt lgkmcnt(0)
    ds_write_b128 v73, v[64:67] offset:2048
    ds_write_b128 v73, v[68:71] offset:3072
    s_waitcnt lgkmcnt(0)
    ds_read_b64_tr_b16 v[64:65], v72 offset:256
    ds_read_b64_tr_b16 v[66:67], v72 offset:1568
    ds_read_b64_tr_b16 v[68:69], v72 offset:21248
    ds_read_b64_tr_b16 v[70:71], v72 offset:22560
    s_waitcnt lgkmcnt(0)
    ds_write_b128 v73, v[64:67] offset:8192
    ds_write_b128 v73, v[68:71] offset:9216
    s_waitcnt lgkmcnt(0)
    ds_read_b64_tr_b16 v[64:65], v72 offset:288
    ds_read_b64_tr_b16 v[66:67], v72 offset:1600
    ds_read_b64_tr_b16 v[68:69], v72 offset:21280
    ds_read_b64_tr_b16 v[70:71], v72 offset:22592
    s_waitcnt lgkmcnt(0)
    ds_write_b128 v73, v[64:67] offset:14336
    ds_write_b128 v73, v[68:71] offset:15360
    s_waitcnt lgkmcnt(0)
    s_waitcnt lgkmcnt(0)
chain2_kernel_wo3:
    s_barrier
    s_add_u32 s46, s45, 82560
    buffer_load_dwordx4 v[24:27], v4, s[16:19], s46 offen
    buffer_load_dwordx4 v[28:31], v5, s[16:19], s46 offen
    buffer_load_dwordx4 v[32:35], v6, s[16:19], s46 offen
    buffer_load_dwordx4 v[36:39], v7, s[16:19], s46 offen
    buffer_load_dwordx4 v[40:43], v8, s[16:19], s46 offen
    buffer_load_dwordx4 v[44:47], v9, s[16:19], s46 offen
    buffer_load_dwordx4 v[48:51], v10, s[16:19], s46 offen
    buffer_load_dwordx4 v[52:55], v11, s[16:19], s46 offen
    buffer_load_dwordx4 v[56:59], v12, s[16:19], s46 offen
    buffer_load_dwordx4 v[60:63], v13, s[16:19], s46 offen
    s_waitcnt vmcnt(0)
    ds_write_b128 v14, v[24:27]
    ds_write_b128 v15, v[28:31]
    ds_write_b128 v16, v[32:35]
    ds_write_b128 v17, v[36:39]
    ds_write_b128 v18, v[40:43]
    ds_write_b128 v19, v[44:47]
    ds_write_b128 v20, v[48:51]
    ds_write_b128 v21, v[52:55]
    ds_write_b128 v22, v[56:59]
    ds_write_b128 v23, v[60:63]
    s_waitcnt lgkmcnt(0)
    s_barrier
    s_lshr_b32 s24, s3, 1
    s_cmp_eq_u32 s24, 1
    s_cbranch_scc0 chain2_kernel_wo4
    ds_read_b64_tr_b16 a[248:249], v72 offset:0
    ds_read_b64_tr_b16 a[250:251], v72 offset:1312
    ds_read_b64_tr_b16 a[252:253], v72 offset:20992
    ds_read_b64_tr_b16 a[254:255], v72 offset:22304
    ds_read_b64_tr_b16 v[120:121], v72 offset:32
    ds_read_b64_tr_b16 v[122:123], v72 offset:1344
    ds_read_b64_tr_b16 v[124:125], v72 offset:21024
    ds_read_b64_tr_b16 v[126:127], v72 offset:22336
    ds_read_b64_tr_b16 v[144:145], v72 offset:64
    ds_read_b64_tr_b16 v[146:147], v72 offset:1376
    ds_read_b64_tr_b16 v[148:149], v72 offset:21056
    ds_read_b64_tr_b16 v[150:151], v72 offset:22368
    ds_read_b64_tr_b16 v[168:169], v72 offset:96
    ds_read_b64_tr_b16 v[170:171], v72 offset:1408
    ds_read_b64_tr_b16 v[172:173], v72 offset:21088
    ds_read_b64_tr_b16 v[174:175], v72 offset:22400
    ds_read_b64_tr_b16 v[192:193], v72 offset:128
    ds_read_b64_tr_b16 v[194:195], v72 offset:1440
    ds_read_b64_tr_b16 v[196:197], v72 offset:21120
    ds_read_b64_tr_b16 v[198:199], v72 offset:22432
    ds_read_b64_tr_b16 v[216:217], v72 offset:160
    ds_read_b64_tr_b16 v[218:219], v72 offset:1472
    ds_read_b64_tr_b16 v[220:221], v72 offset:21152
    ds_read_b64_tr_b16 v[222:223], v72 offset:22464
    ds_read_b64_tr_b16 v[240:241], v72 offset:192
    ds_read_b64_tr_b16 v[242:243], v72 offset:1504
    ds_read_b64_tr_b16 v[244:245], v72 offset:21184
    ds_read_b64_tr_b16 v[246:247], v72 offset:22496
    ds_read_b64_tr_b16 v[64:65], v72 offset:224
    ds_read_b64_tr_b16 v[66:67], v72 offset:1536
    ds_read_b64_tr_b16 v[68:69], v72 offset:21216
    ds_read_b64_tr_b16 v[70:71], v72 offset:22528
    s_waitcnt lgkmcnt(0)
    ds_write_b128 v73, v[64:67] offset:2048
    ds_write_b128 v73, v[68:71] offset:3072
    s_waitcnt lgkmcnt(0)
    ds_read_b64_tr_b16 v[64:65], v72 offset:256
    ds_read_b64_tr_b16 v[66:67], v72 offset:1568
    ds_read_b64_tr_b16 v[68:69], v72 offset:21248
    ds_read_b64_tr_b16 v[70:71], v72 offset:22560
    s_waitcnt lgkmcnt(0)
    ds_write_b128 v73, v[64:67] offset:8192
    ds_write_b128 v73, v[68:71] offset:9216
    s_waitcnt lgkmcnt(0)
    ds_read_b64_tr_b16 v[64:65], v72 offset:288
    ds_read_b64_tr_b16 v[66:67], v72 offset:1600
    ds_read_b64_tr_b16 v[68:69], v72 offset:21280
    ds_read_b64_tr_b16 v[70:71], v72 offset:22592
    s_waitcnt lgkmcnt(0)
    ds_write_b128 v73, v[64:67] offset:14336
    ds_write_b128 v73, v[68:71] offset:15360
    s_waitcnt lgkmcnt(0)
    s_waitcnt lgkmcnt(0)
chain2_kernel_wo4:
    s_barrier
    s_add_u32 s46, s45, 163840
    buffer_load_dwordx4 v[24:27], v4, s[16:19], s46 offen
    buffer_load_dwordx4 v[28:31], v5, s[16:19], s46 offen
    buffer_load_dwordx4 v[32:35], v6, s[16:19], s46 offen
    buffer_load_dwordx4 v[36:39], v7, s[16:19], s46 offen
    buffer_load_dwordx4 v[40:43], v8, s[16:19], s46 offen
    buffer_load_dwordx4 v[44:47], v9, s[16:19], s46 offen
    buffer_load_dwordx4 v[48:51], v10, s[16:19], s46 offen
    buffer_load_dwordx4 v[52:55], v11, s[16:19], s46 offen
    buffer_load_dwordx4 v[56:59], v12, s[16:19], s46 offen
    buffer_load_dwordx4 v[60:63], v13, s[16:19], s46 offen
    s_waitcnt vmcnt(0)
    ds_write_b128 v14, v[24:27]
    ds_write_b128 v15, v[28:31]
    ds_write_b128 v16, v[32:35]
    ds_write_b128 v17, v[36:39]
    ds_write_b128 v18, v[40:43]
    ds_write_b128 v19, v[44:47]
    ds_write_b128 v20, v[48:51]
    ds_write_b128 v21, v[52:55]
    ds_write_b128 v22, v[56:59]
    ds_write_b128 v23, v[60:63]
    s_waitcnt lgkmcnt(0)
    s_barrier
    s_lshr_b32 s24, s3, 1
    s_cmp_eq_u32 s24, 0
    s_cbranch_scc0 chain2_kernel_wo5
    ds_read_b64_tr_b16 v[104:105], v72 offset:0
    ds_read_b64_tr_b16 v[106:107], v72 offset:1312
    ds_read_b64_tr_b16 v[108:109], v72 offset:20992
    ds_read_b64_tr_b16 v[110:111], v72 offset:22304
    ds_read_b64_tr_b16 v[128:129], v72 offset:32
    ds_read_b64_tr_b16 v[130:131], v72 offset:1344
    ds_read_b64_tr_b16 v[132:133], v72 offset:21024
    ds_read_b64_tr_b16 v[134:135], v72 offset:22336
    ds_read_b64_tr_b16 v[152:153], v72 offset:64
    ds_read_b64_tr_b16 v[154:155], v72 offset:1376
    ds_read_b64_tr_b16 v[156:157], v72 offset:21056
    ds_read_b64_tr_b16 v[158:159], v72 offset:22368
    ds_read_b64_tr_b16 v[176:177], v72 offset:96
    ds_read_b64_tr_b16 v[178:179], v72 offset:1408
    ds_read_b64_tr_b16 v[180:181], v72 offset:21088
    ds_read_b64_tr_b16 v[182:183], v72 offset:22400
    ds_read_b64_tr_b16 v[200:201], v72 offset:128
    ds_read_b64_tr_b16 v[202:203], v72 offset:1440
    ds_read_b64_tr_b16 v[204:205], v72 offset:21120
    ds_read_b64_tr_b16 v[206:207], v72 offset:22432
    ds_read_b64_tr_b16 v[224:225], v72 offset:160
    ds_read_b64_tr_b16 v[226:227], v72 offset:1472
    ds_read_b64_tr_b16 v[228:229], v72 offset:21152
    ds_read_b64_tr_b16 v[230:231], v72 offset:22464
    ds_read_b64_tr_b16 v[248:249], v72 offset:192
    ds_read_b64_tr_b16 v[250:251], v72 offset:1504
    ds_read_b64_tr_b16 v[252:253], v72 offset:21184
    ds_read_b64_tr_b16 v[254:255], v72 offset:22496
    ds_read_b64_tr_b16 v[64:65], v72 offset:224
    ds_read_b64_tr_b16 v[66:67], v72 offset:1536
    ds_read_b64_tr_b16 v[68:69], v72 offset:21216
    ds_read_b64_tr_b16 v[70:71], v72 offset:22528
    s_waitcnt lgkmcnt(0)
    ds_write_b128 v73, v[64:67] offset:4096
    ds_write_b128 v73, v[68:71] offset:5120
    s_waitcnt lgkmcnt(0)
    ds_read_b64_tr_b16 v[64:65], v72 offset:256
    ds_read_b64_tr_b16 v[66:67], v72 offset:1568
    ds_read_b64_tr_b16 v[68:69], v72 offset:21248
    ds_read_b64_tr_b16 v[70:71], v72 offset:22560
    s_waitcnt lgkmcnt(0)
    ds_write_b128 v73, v[64:67] offset:10240
    ds_write_b128 v73, v[68:71] offset:11264
    s_waitcnt lgkmcnt(0)
    ds_read_b64_tr_b16 v[64:65], v72 offset:288
    ds_read_b64_tr_b16 v[66:67], v72 offset:1600
    ds_read_b64_tr_b16 v[68:69], v72 offset:21280
    ds_read_b64_tr_b16 v[70:71], v72 offset:22592
    s_waitcnt lgkmcnt(0)
    ds_write_b128 v73, v[64:67] offset:16384
    ds_write_b128 v73, v[68:71] offset:17408
    s_waitcnt lgkmcnt(0)
    s_waitcnt lgkmcnt(0)
chain2_kernel_wo5:
    s_barrier
    s_add_u32 s46, s45, 164480
    buffer_load_dwordx4 v[24:27], v4, s[16:19], s46 offen
    buffer_load_dwordx4 v[28:31], v5, s[16:19], s46 offen
    buffer_load_dwordx4 v[32:35], v6, s[16:19], s46 offen
    buffer_load_dwordx4 v[36:39], v7, s[16:19], s46 offen
    buffer_load_dwordx4 v[40:43], v8, s[16:19], s46 offen
    buffer_load_dwordx4 v[44:47], v9, s[16:19], s46 offen
    buffer_load_dwordx4 v[48:51], v10, s[16:19], s46 offen
    buffer_load_dwordx4 v[52:55], v11, s[16:19], s46 offen
    buffer_load_dwordx4 v[56:59], v12, s[16:19], s46 offen
    buffer_load_dwordx4 v[60:63], v13, s[16:19], s46 offen
    s_waitcnt vmcnt(0)
    ds_write_b128 v14, v[24:27]
    ds_write_b128 v15, v[28:31]
    ds_write_b128 v16, v[32:35]
    ds_write_b128 v17, v[36:39]
    ds_write_b128 v18, v[40:43]
    ds_write_b128 v19, v[44:47]
    ds_write_b128 v20, v[48:51]
    ds_write_b128 v21, v[52:55]
    ds_write_b128 v22, v[56:59]
    ds_write_b128 v23, v[60:63]
    s_waitcnt lgkmcnt(0)
    s_barrier
    s_lshr_b32 s24, s3, 1
    s_cmp_eq_u32 s24, 1
    s_cbranch_scc0 chain2_kernel_wo6
    ds_read_b64_tr_b16 v[104:105], v72 offset:0
    ds_read_b64_tr_b16 v[106:107], v72 offset:1312
    ds_read_b64_tr_b16 v[108:109], v72 offset:20992
    ds_read_b64_tr_b16 v[110:111], v72 offset:22304
    ds_read_b64_tr_b16 v[128:129], v72 offset:32
    ds_read_b64_tr_b16 v[130:131], v72 offset:1344
    ds_read_b64_tr_b16 v[132:133], v72 offset:21024
    ds_read_b64_tr_b16 v[134:135], v72 offset:22336
    ds_read_b64_tr_b16 v[152:153], v72 offset:64
    ds_read_b64_tr_b16 v[154:155], v72 offset:1376
    ds_read_b64_tr_b16 v[156:157], v72 offset:21056
    ds_read_b64_tr_b16 v[158:159], v72 offset:22368
    ds_read_b64_tr_b16 v[176:177], v72 offset:96
    ds_read_b64_tr_b16 v[178:179], v72 offset:1408
    ds_read_b64_tr_b16 v[180:181], v72 offset:21088
    ds_read_b64_tr_b16 v[182:183], v72 offset:22400
    ds_read_b64_tr_b16 v[200:201], v72 offset:128
    ds_read_b64_tr_b16 v[202:203], v72 offset:1440
    ds_read_b64_tr_b16 v[204:205], v72 offset:21120
    ds_read_b64_tr_b16 v[206:207], v72 offset:22432
    ds_read_b64_tr_b16 v[224:225], v72 offset:160
    ds_read_b64_tr_b16 v[226:227], v72 offset:1472
    ds_read_b64_tr_b16 v[228:229], v72 offset:21152
    ds_read_b64_tr_b16 v[230:231], v72 offset:22464
    ds_read_b64_tr_b16 v[248:249], v72 offset:192
    ds_read_b64_tr_b16 v[250:251], v72 offset:1504
    ds_read_b64_tr_b16 v[252:253], v72 offset:21184
    ds_read_b64_tr_b16 v[254:255], v72 offset:22496
    ds_read_b64_tr_b16 v[64:65], v72 offset:224
    ds_read_b64_tr_b16 v[66:67], v72 offset:1536
    ds_read_b64_tr_b16 v[68:69], v72 offset:21216
    ds_read_b64_tr_b16 v[70:71], v72 offset:22528
    s_waitcnt lgkmcnt(0)
    ds_write_b128 v73, v[64:67] offset:4096
    ds_write_b128 v73, v[68:71] offset:5120
    s_waitcnt lgkmcnt(0)
    ds_read_b64_tr_b16 v[64:65], v72 offset:256
    ds_read_b64_tr_b16 v[66:67], v72 offset:1568
    ds_read_b64_tr_b16 v[68:69], v72 offset:21248
    ds_read_b64_tr_b16 v[70:71], v72 offset:22560
    s_waitcnt lgkmcnt(0)
    ds_write_b128 v73, v[64:67] offset:10240
    ds_write_b128 v73, v[68:71] offset:11264
    s_waitcnt lgkmcnt(0)
    ds_read_b64_tr_b16 v[64:65], v72 offset:288
    ds_read_b64_tr_b16 v[66:67], v72 offset:1600
    ds_read_b64_tr_b16 v[68:69], v72 offset:21280
    ds_read_b64_tr_b16 v[70:71], v72 offset:22592
    s_waitcnt lgkmcnt(0)
    ds_write_b128 v73, v[64:67] offset:16384
    ds_write_b128 v73, v[68:71] offset:17408
    s_waitcnt lgkmcnt(0)
    s_waitcnt lgkmcnt(0)
chain2_kernel_wo6:
    s_barrier
    v_mov_b32 v6, v73
    v_mov_b32 v4, 0x4444
    v_mov_b32 v5, 0xeeee
    v_cmp_gt_u32 vcc, 8, v2
    s_nop 1
    v_cndmask_b32 v4, v5, v4, vcc
    v_lshlrev_b32 v5, 4, v1
    s_lshl_b32 s24, s3, 10
    v_add_u32 v7, s24, v5
    s_lshl_b32 s24, s3, 9
    s_add_u32 s24, s24, 8192
    v_lshlrev_b32 v8, 3, v1
    v_add_u32 v8, s24, v8
    v_and_b32 v64, 7, v2
    v_lshlrev_b32 v9, 5, v64
    v_lshrrev_b32 v64, 3, v2
    v_lshl_add_u32 v9, v64, 4, v9
    v_and_b32 v64, 1, v3
    v_lshl_add_u32 v9, v64, 3, v9
    s_mul_i32 s24, s3, 768
    s_add_u32 s24, s24, 10240
    v_add_u32 v9, s24, v9
    v_lshrrev_b32 v65, 1, v3
    v_lshl_add_u32 v10, v65, 8, v9
    v_lshrrev_b32 v64, 2, v2
    v_lshlrev_b32 v11, 5, v64
    v_and_b32 v64, 3, v2
    v_lshl_add_u32 v11, v64, 3, v11
    v_lshl_add_u32 v11, v3, 8, v11
    v_add_u32 v11, 10240, v11
    s_mul_i32 s24, s3, 10
    s_lshl_b32 s24, s24, 13
    s_lshl_b32 s25, s44, 8
    s_add_u32 s24, s24, s25
    v_lshlrev_b32 v14, 13, v3
    v_lshl_add_u32 v14, v2, 4, v14
    v_add_u32 v14, s24, v14
    v_lshrrev_b32 v64, 1, v3
    v_lshlrev_b32 v15, 13, v64
    v_lshl_add_u32 v15, v2, 4, v15
    v_add_u32 v15, s24, v15
    v_add_u32 v15, 65536, v15
    v_and_b32 v64, 1, v3
    v_cmp_eq_u32 vcc, 0, v64
    v_mov_b32 v64, 2146435072
    s_nop 0
    v_cndmask_b32 v15, v64, v15, vcc
    v_add_u32 v64, 0, v0
    v_and_b32 v65, 7, v64
    v_mul_u32_u24 v65, 1280, v65
    v_lshrrev_b32 v66, 3, v64
    v_lshl_add_u32 v65, v66, 4, v65
    v_cmp_gt_u32 vcc, 640, v64
    v_mov_b32 v67, 2146435072
    s_nop 0
    v_cndmask_b32 v65, v67, v65, vcc
    buffer_load_dwordx4 v[68:71], v65, s[20:23], 0 offen
    v_lshlrev_b32 v64, 4, v64
    s_waitcnt vmcnt(0)
    s_and_saveexec_b64 s[30:31], vcc
    ds_write_b128 v64, v[68:71]
    s_mov_b64 exec, s[30:31]
    v_add_u32 v64, 256, v0
    v_and_b32 v65, 7, v64
    v_mul_u32_u24 v65, 1280, v65
    v_lshrrev_b32 v66, 3, v64
    v_lshl_add_u32 v65, v66, 4, v65
    v_cmp_gt_u32 vcc, 640, v64
    v_mov_b32 v67, 2146435072
    s_nop 0
    v_cndmask_b32 v65, v67, v65, vcc
    buffer_load_dwordx4 v[68:71], v65, s[20:23], 0 offen
    v_lshlrev_b32 v64, 4, v64
    s_waitcnt vmcnt(0)
    s_and_saveexec_b64 s[30:31], vcc
    ds_write_b128 v64, v[68:71]
    s_mov_b64 exec, s[30:31]
    v_add_u32 v64, 512, v0
    v_and_b32 v65, 7, v64
    v_mul_u32_u24 v65, 1280, v65
    v_lshrrev_b32 v66, 3, v64
    v_lshl_add_u32 v65, v66, 4, v65
    v_cmp_gt_u32 vcc, 640, v64
    v_mov_b32 v67, 2146435072
    s_nop 0
    v_cndmask_b32 v65, v67, v65, vcc
    buffer_load_dwordx4 v[68:71], v65, s[20:23], 0 offen
    v_lshlrev_b32 v64, 4, v64
    s_waitcnt vmcnt(0)
    s_and_saveexec_b64 s[30:31], vcc
    ds_write_b128 v64, v[68:71]
    s_mov_b64 exec, s[30:31]
    s_mov_b32 s40, 0
    s_mov_b32 s43, 117440512
    s_mov_b32 s47, 138412032
    s_waitcnt lgkmcnt(0)
    s_branch chain2_kernel_v_go2
chain2_kernel_v_step:
    s_add_u32 s48, s47, 4096
    s_mov_b32 s61, 0
chain2_kernel_v_pm:
    buffer_load_dwordx4 v[16:19], v7, s[8:11], s47 offen sc1
    buffer_load_dwordx4 v[20:23], v7, s[8:11], s48 offen sc1
    buffer_load_dwordx2 v[24:25], v8, s[8:11], s47 offen sc1
    s_waitcnt vmcnt(0)
    v_max3_u32 v26, v16, v17, v18
    v_max3_u32 v26, v26, v19, v20
    v_max3_u32 v26, v26, v21, v22
    v_max3_u32 v26, v26, v23, v24
    v_max_u32 v26, v26, v25
    v_cmp_eq_u32 vcc, -1, v26
    s_add_u32 s61, s61, 1
    s_cbranch_vccz chain2_kernel_v_pm_out
    s_cmp_ge_u32 s61, s60
    s_cbranch_scc1 chain2_kernel_v_pm_to
    s_sleep 1
    s_branch chain2_kernel_v_pm
chain2_kernel_v_pm_to:
    s_mov_b32 s60, 1
chain2_kernel_v_pm_out:
    ds_write_b128 v7, v[16:19]
    ds_write_b128 v7, v[20:23] offset:4096
    ds_write_b64 v8, v[24:25]
    s_waitcnt lgkmcnt(0)
chain2_kernel_v_go2:
    s_barrier
    ds_read_b128 v[16:19], v5 offset:0
    ds_read_b128 v[20:23], v5 offset:1024
    ds_read_b128 v[24:27], v5 offset:2048
    ds_read_b128 v[28:31], v5 offset:3072
    ds_read_b128 v[32:35], v5 offset:4096
    ds_read_b128 v[36:39], v5 offset:5120
    ds_read_b128 v[40:43], v5 offset:6144
    ds_read_b128 v[44:47], v5 offset:7168
    ds_read_b128 v[48:51], v5 offset:8192
    ds_read_b128 v[52:55], v5 offset:9216
    v_mov_b32 v56, 0
    v_mov_b32 v57, 0
    v_mov_b32 v58, 0
    v_mov_b32 v59, 0
    v_mov_b32 v60, 0
    v_mov_b32 v61, 0
    v_mov_b32 v62, 0
    v_mov_b32 v63, 0
    v_mov_b32 v64, 0
    v_mov_b32 v65, 0
    v_mov_b32 v66, 0
    v_mov_b32 v67, 0
    s_waitcnt lgkmcnt(9)
    v_smfmac_f32_16x16x64_bf16 v[56:59], v[16:19], a[0:7], v4
    v_smfmac_f32_16x16x64_bf16 v[60:63], v[16:19], a[80:87], v4
    v_smfmac_f32_16x16x64_bf16 v[64:67], v[16:19], a[160:167], v4
    s_waitcnt lgkmcnt(8)
    v_smfmac_f32_16x16x64_bf16 v[56:59], v[20:23], a[8:15], v4
    v_smfmac_f32_16x16x64_bf16 v[60:63], v[20:23], a[88:95], v4
    v_smfmac_f32_16x16x64_bf16 v[64:67], v[20:23], a[168:175], v4
    s_waitcnt lgkmcnt(7)
    v_smfmac_f32_16x16x64_bf16 v[56:59], v[24:27], a[16:23], v4
    v_smfmac_f32_16x16x64_bf16 v[60:63], v[24:27], a[96:103], v4
    v_smfmac_f32_16x16x64_bf16 v[64:67], v[24:27], a[176:183], v4
    s_waitcnt lgkmcnt(6)
    v_smfmac_f32_16x16x64_bf16 v[56:59], v[28:31], a[24:31], v4
    v_smfmac_f32_16x16x64_bf16 v[60:63], v[28:31], a[104:111], v4
    v_smfmac_f32_16x16x64_bf16 v[64:67], v[28:31], a[184:191], v4
    s_waitcnt lgkmcnt(5)
    v_smfmac_f32_16x16x64_bf16 v[56:59], v[32:35], a[32:39], v4
    v_smfmac_f32_16x16x64_bf16 v[60:63], v[32:35], a[112:119], v4
    v_smfmac_f32_16x16x64_bf16 v[64:67], v[32:35], a[192:199], v4
    s_waitcnt lgkmcnt(4)
    v_smfmac_f32_16x16x64_bf16 v[56:59], v[36:39], a[40:47], v4
    v_smfmac_f32_16x16x64_bf16 v[60:63], v[36:39], a[120:127], v4
    v_smfmac_f32_16x16x64_bf16 v[64:67], v[36:39], a[200:207], v4
    s_waitcnt lgkmcnt(3)
    v_smfmac_f32_16x16x64_bf16 v[56:59], v[40:43], a[48:55], v4
    v_smfmac_f32_16x16x64_bf16 v[60:63], v[40:43], a[128:135], v4
    v_smfmac_f32_16x16x64_bf16 v[64:67], v[40:43], a[208:215], v4
    s_waitcnt lgkmcnt(2)
    v_smfmac_f32_16x16x64_bf16 v[56:59], v[44:47], a[56:63], v4
    v_smfmac_f32_16x16x64_bf16 v[60:63], v[44:47], a[136:143], v4
    v_smfmac_f32_16x16x64_bf16 v[64:67], v[44:47], a[216:223], v4
    s_waitcnt lgkmcnt(1)
    v_smfmac_f32_16x16x64_bf16 v[56:59], v[48:51], a[64:71], v4
    v_smfmac_f32_16x16x64_bf16 v[60:63], v[48:51], a[144:151], v4
    v_smfmac_f32_16x16x64_bf16 v[64:67], v[48:51], a[224:231], v4
    s_waitcnt lgkmcnt(0)
    v_smfmac_f32_16x16x64_bf16 v[56:59], v[52:55], a[72:79], v4
    v_smfmac_f32_16x16x64_bf16 v[60:63], v[52:55], a[152:159], v4
    v_smfmac_f32_16x16x64_bf16 v[64:67], v[52:55], a[232:239], v4
    ds_read_b128 v[80:83], v6 offset:0
    ds_read_b128 v[84:87], v6 offset:1024
    ds_read_b128 v[88:91], v6 offset:2048
    ds_read_b128 v[92:95], v6 offset:3072
    ds_read_b128 v[96:99], v6 offset:4096
    ds_read_b128 v[100:103], v6 offset:5120
    v_mov_b32 v16, 0
    v_mov_b32 v17, 0
    v_mov_b32 v18, 0
    v_mov_b32 v19, 0
    v_mov_b32 v20, 0
    v_mov_b32 v21, 0
    v_mov_b32 v22, 0
    v_mov_b32 v23, 0
    v_mov_b32 v24, 0
    v_mov_b32 v25, 0
    v_mov_b32 v26, 0
    v_mov_b32 v27, 0
    v_mov_b32 v28, 0
    v_mov_b32 v29, 0
    v_mov_b32 v30, 0
    v_mov_b32 v31, 0
    v_mov_b32 v32, 0
    v_mov_b32 v33, 0
    v_mov_b32 v34, 0
    v_mov_b32 v35, 0
    v_mov_b32 v36, 0
    v_mov_b32 v37, 0
    v_mov_b32 v38, 0
    v_mov_b32 v39, 0
    v_mov_b32 v40, 0
    v_mov_b32 v41, 0
    v_mov_b32 v42, 0
    v_mov_b32 v43, 0
    v_mov_b32 v44, 0
    v_mov_b32 v45, 0
    v_mov_b32 v46, 0
    v_mov_b32 v47, 0
    v_mov_b32 v48, 0
    v_mov_b32 v49, 0
    v_mov_b32 v50, 0
    v_mov_b32 v51, 0
    v_mov_b32 v52, 0
    v_mov_b32 v53, 0
    v_mov_b32 v54, 0
    v_mov_b32 v55, 0
    v_permlane32_swap_b32 v56, v60
    v_permlane32_swap_b32 v57, v61
    v_permlane32_swap_b32 v58, v62
    v_permlane32_swap_b32 v59, v63
    v_add_f32 v56, v56, v60
    v_add_f32 v57, v57, v61
    v_add_f32 v58, v58, v62
    v_add_f32 v59, v59, v63
    v_cvt_pk_bf16_f32 v68, v56, v57
    v_cvt_pk_bf16_f32 v69, v58, v59
    v_mov_b32 v60, v64
    v_mov_b32 v61, v65
    v_mov_b32 v62, v66
    v_mov_b32 v63, v67
    v_permlane32_swap_b32 v64, v60
    v_permlane32_swap_b32 v65, v61
    v_permlane32_swap_b32 v66, v62
    v_permlane32_swap_b32 v67, v63
    v_add_f32 v64, v64, v60
    v_add_f32 v65, v65, v61
    v_add_f32 v66, v66, v62
    v_add_f32 v67, v67, v63
    v_cvt_pk_bf16_f32 v70, v64, v65
    v_cvt_pk_bf16_f32 v71, v66, v67
    ds_write_b64 v10, v[68:69]
    ds_write_b64 v9, v[70:71] offset:512
    s_waitcnt lgkmcnt(0)
    s_barrier
    ds_read_b64_tr_b16 v[68:69], v11 offset:0
    ds_read_b64_tr_b16 v[70:71], v11 offset:128
    ds_read_b64_tr_b16 v[72:73], v11 offset:1024
    ds_read_b64_tr_b16 v[74:75], v11 offset:1152
    ds_read_b64_tr_b16 v[76:77], v11 offset:2048
    ds_read_b64_tr_b16 v[78:79], v11 offset:2176
    s_waitcnt lgkmcnt(4)
    v_smfmac_f32_16x16x64_bf16 v[16:19], v[68:71], a[240:247], v4
    v_smfmac_f32_16x16x64_bf16 v[20:23], v[68:71], v[112:119], v4
    v_smfmac_f32_16x16x64_bf16 v[24:27], v[68:71], v[136:143], v4
    v_smfmac_f32_16x16x64_bf16 v[28:31], v[68:71], v[160:167], v4
    s_waitcnt lgkmcnt(2)
    v_smfmac_f32_16x16x64_bf16 v[16:19], v[72:75], a[248:255], v4
    v_smfmac_f32_16x16x64_bf16 v[20:23], v[72:75], v[120:127], v4
    v_smfmac_f32_16x16x64_bf16 v[24:27], v[72:75], v[144:151], v4
    v_smfmac_f32_16x16x64_bf16 v[28:31], v[72:75], v[168:175], v4
    s_waitcnt lgkmcnt(0)
    v_smfmac_f32_16x16x64_bf16 v[16:19], v[76:79], v[104:111], v4
    v_smfmac_f32_16x16x64_bf16 v[20:23], v[76:79], v[128:135], v4
    v_smfmac_f32_16x16x64_bf16 v[24:27], v[76:79], v[152:159], v4
    v_smfmac_f32_16x16x64_bf16 v[28:31], v[76:79], v[176:183], v4
    v_smfmac_f32_16x16x64_bf16 v[32:35], v[68:71], v[184:191], v4
    v_smfmac_f32_16x16x64_bf16 v[36:39], v[68:71], v[208:215], v4
    v_smfmac_f32_16x16x64_bf16 v[40:43], v[68:71], v[232:239], v4
    v_smfmac_f32_16x16x64_bf16 v[44:47], v[68:71], v[80:87], v4
    ds_read_b128 v[80:83], v6 offset:6144
    ds_read_b128 v[84:87], v6 offset:7168
    v_smfmac_f32_16x16x64_bf16 v[32:35], v[72:75], v[192:199], v4
    v_smfmac_f32_16x16x64_bf16 v[36:39], v[72:75], v[216:223], v4
    v_smfmac_f32_16x16x64_bf16 v[40:43], v[72:75], v[240:247], v4
    v_smfmac_f32_16x16x64_bf16 v[44:47], v[72:75], v[88:95], v4
    ds_read_b128 v[88:91], v6 offset:8192
    ds_read_b128 v[92:95], v6 offset:9216
    v_smfmac_f32_16x16x64_bf16 v[32:35], v[76:79], v[200:207], v4
    v_smfmac_f32_16x16x64_bf16 v[36:39], v[76:79], v[224:231], v4
    v_smfmac_f32_16x16x64_bf16 v[40:43], v[76:79], v[248:255], v4
    v_smfmac_f32_16x16x64_bf16 v[44:47], v[76:79], v[96:103], v4
    ds_read_b128 v[96:99], v6 offset:10240
    ds_read_b128 v[100:103], v6 offset:11264
    v_permlane32_swap_b32 v16, v24
    v_permlane32_swap_b32 v17, v25
    v_permlane32_swap_b32 v18, v26
    v_permlane32_swap_b32 v19, v27
    v_add_f32 v16, v16, v24
    v_add_f32 v17, v17, v25
    v_add_f32 v18, v18, v26
    v_add_f32 v19, v19, v27
    v_permlane32_swap_b32 v20, v28
    v_permlane32_swap_b32 v21, v29
    v_permlane32_swap_b32 v22, v30
    v_permlane32_swap_b32 v23, v31
    v_add_f32 v20, v20, v28
    v_add_f32 v21, v21, v29
    v_add_f32 v22, v22, v30
    v_add_f32 v23, v23, v31
    v_cvt_pk_bf16_f32 v56, v16, v17
    v_cvt_pk_bf16_f32 v57, v18, v19
    v_cvt_pk_bf16_f32 v58, v20, v21
    v_cvt_pk_bf16_f32 v59, v22, v23
    s_nop 0
    v_permlane16_swap_b32 v56, v58
    v_permlane16_swap_b32 v57, v59
    v_min_u32 v56, -2, v56
    v_min_u32 v57, -2, v57
    v_min_u32 v58, -2, v58
    v_min_u32 v59, -2, v59
    buffer_store_dwordx4 v[56:59], v14, s[8:11], s43 offen sc1
    s_waitcnt lgkmcnt(4)
    v_smfmac_f32_16x16x64_bf16 v[48:51], v[68:71], v[80:87], v4
    ds_read_b128 v[80:83], v6 offset:12288
    ds_read_b128 v[84:87], v6 offset:13312
    s_waitcnt lgkmcnt(4)
    v_smfmac_f32_16x16x64_bf16 v[48:51], v[72:75], v[88:95], v4
    ds_read_b128 v[88:91], v6 offset:14336
    ds_read_b128 v[92:95], v6 offset:15360
    s_waitcnt lgkmcnt(4)
    v_smfmac_f32_16x16x64_bf16 v[48:51], v[76:79], v[96:103], v4
    ds_read_b128 v[96:99], v6 offset:16384
    ds_read_b128 v[100:103], v6 offset:17408
    v_permlane32_swap_b32 v32, v40
    v_permlane32_swap_b32 v33, v41
    v_permlane32_swap_b32 v34, v42
    v_permlane32_swap_b32 v35, v43
    v_add_f32 v32, v32, v40
    v_add_f32 v33, v33, v41
    v_add_f32 v34, v34, v42
    v_add_f32 v35, v35, v43
    v_permlane32_swap_b32 v36, v44
    v_permlane32_swap_b32 v37, v45
    v_permlane32_swap_b32 v38, v46
    v_permlane32_swap_b32 v39, v47
    v_add_f32 v36, v36, v44
    v_add_f32 v37, v37, v45
    v_add_f32 v38, v38, v46
    v_add_f32 v39, v39, v47
    v_cvt_pk_bf16_f32 v60, v32, v33
    v_cvt_pk_bf16_f32 v61, v34, v35
    v_cvt_pk_bf16_f32 v62, v36, v37
    v_cvt_pk_bf16_f32 v63, v38, v39
    s_nop 0
    v_permlane16_swap_b32 v60, v62
    v_permlane16_swap_b32 v61, v63
    v_min_u32 v60, -2, v60
    v_min_u32 v61, -2, v61
    v_min_u32 v62, -2, v62
    v_min_u32 v63, -2, v63
    s_add_u32 s49, s43, 32768
    buffer_store_dwordx4 v[60:63], v14, s[8:11], s49 offen sc1
    s_waitcnt lgkmcnt(4)
    v_smfmac_f32_16x16x64_bf16 v[52:55], v[68:71], v[80:87], v4
    s_waitcnt lgkmcnt(2)
    v_smfmac_f32_16x16x64_bf16 v[52:55], v[72:75], v[88:95], v4
    s_waitcnt lgkmcnt(0)
    v_smfmac_f32_16x16x64_bf16 v[52:55], v[76:79], v[96:103], v4
    s_nop 11
    v_permlane32_swap_b32 v48, v52
    v_permlane32_swap_b32 v49, v53
    v_permlane32_swap_b32 v50, v54
    v_permlane32_swap_b32 v51, v55
    v_add_f32 v48, v48, v52
    v_add_f32 v49, v49, v53
    v_add_f32 v50, v50, v54
    v_add_f32 v51, v51, v55
    v_cvt_pk_bf16_f32 v64, v48, v49
    v_cvt_pk_bf16_f32 v65, v50, v51
    v_mov_b32 v66, v64
    v_mov_b32 v67, v65
    s_nop 0
    v_permlane16_swap_b32 v64, v66
    v_permlane16_swap_b32 v65, v67
    v_min_u32 v64, -2, v64
    v_min_u32 v65, -2, v65
    v_min_u32 v66, -2, v66
    v_min_u32 v67, -2, v67
    buffer_store_dwordx4 v[64:67], v15, s[8:11], s43 offen sc1
    s_add_u32 s40, s40, 1
    s_add_u32 s43, s43, 327680
    s_add_u32 s47, s47, 40960
    s_cmp_lt_u32 s40, 64
    s_cbranch_scc1 chain2_kernel_v_step
    s_branch chain2_kernel_end
chain2_kernel_roleR:
    s_sub_u32 s44, s2, 64
    v_lshlrev_b32 v5, 4, v1
    s_lshl_b32 s24, s44, 15
    s_lshl_b32 s25, s3, 13
    s_add_u32 s24, s24, s25
    v_add_u32 v6, s24, v5
    v_add_u32 v7, 4096, v6
    s_lshl_b32 s24, s3, 12
    v_add_u32 v8, s24, v5
    s_lshl_b32 s24, s3, 10
    s_add_u32 s24, s24, 16384
    v_add_u32 v9, s24, v5
    s_lshl_b32 s24, s44, 13
    s_lshl_b32 s25, s3, 11
    s_add_u32 s24, s24, s25
    v_add_u32 v10, s24, v5
    v_and_b32 v204, 7, v2
    v_mul_u32_u24 v11, 80, v204
    v_lshl_add_u32 v11, v3, 4, v11
    s_mul_i32 s24, s3, 640
    v_add_u32 v11, s24, v11
    v_add_u32 v204, 8192, v5
    v_cmp_gt_u32 vcc, 8, v2
    s_nop 1
    v_cndmask_b32 v11, v204, v11, vcc
    v_and_b32 v204, 7, v2
    v_mul_u32_u24 v12, 80, v204
    v_lshrrev_b32 v204, 3, v2
    v_lshl_add_u32 v12, v204, 5, v12
    v_mul_u32_u24 v13, 10240, v3
    v_lshl_add_u32 v13, v2, 4, v13
    s_lshl_b32 s24, s44, 8
    v_add_u32 v13, s24, v13
    v_mov_b32 v204, 2146435072
    v_cmp_gt_u32 vcc, 1, v3
    s_nop 1
    v_cndmask_b32 v13, v204, v13, vcc
    v_cmp_le_u32 s[50:51], 8, v2
    s_lshl_b32 s24, s3, 14
    v_add_u32 v205, s24, v5
    v_add_u32 v212, 0, v205
    v_add_u32 v213, 4096, v205
    v_add_u32 v214, 8192, v205
    v_add_u32 v215, 12288, v205
    s_lshl_b32 s24, s3, 12
    s_add_u32 s24, s24, 65536
    v_add_u32 v216, s24, v5
    s_lshl_b32 s24, s3, 11
    s_add_u32 s24, s24, 16384
    v_add_u32 v217, s24, v5
    s_lshl_b32 s24, s3, 10
    s_add_u32 s24, s24, 16384
    v_add_u32 v218, s24, v5
    s_lshl_b32 s24, s3, 4
    v_add_u32 v219, s24, v2
    v_mul_u32_u24 v219, 1280, v219
    v_lshl_add_u32 v219, v3, 3, v219
    s_lshl_b32 s24, s44, 5
    v_add_u32 v219, s24, v219
    s_load_dwordx2 s[26:27], s[0:1], 80
    s_waitcnt lgkmcnt(0)
    s_mov_b32 s12, s26
    s_mov_b32 s13, s27
    s_mov_b32 s14, 2621440
    s_mov_b32 s15, 0x00020000
    s_add_u32 s16, s4, 4194304
    s_addc_u32 s17, s5, 0
    s_mov_b32 s18, 2621440
    s_mov_b32 s19, 0x00020000
    s_mov_b32 s40, 0
    s_mov_b32 s41, 184549376
    s_mov_b32 s43, 141074432
    s_mov_b32 s42, 117440512
    s_mov_b32 s45, 146317312
    s_mov_b32 s46, 0
    s_mov_b32 s47, 138452992
    v_and_b32 v252, 7, v1
    v_lshlrev_b32 v252, 7, v252
    s_lshl_b32 s24, s3, 10
    s_add_u32 s24, s24, 151572480
    v_add_u32 v252, s24, v252
    s_mov_b32 s62, -1
    s_mov_b32 s63, 1
    s_cmp_ge_i32 s62, s63
    s_cbranch_scc1 chain2_kernel_r_en0_ok
    s_mov_b32 s61, 0
chain2_kernel_r_en0:
    buffer_load_dword v253, v252, s[8:11], 0 offen sc1
    s_waitcnt vmcnt(0)
    v_readlane_b32 s62, v253, 0
    v_readlane_b32 s24, v253, 1
    s_min_i32 s62, s62, s24
    v_readlane_b32 s24, v253, 2
    s_min_i32 s62, s62, s24
    v_readlane_b32 s24, v253, 3
    s_min_i32 s62, s62, s24
    v_readlane_b32 s24, v253, 4
    s_min_i32 s62, s62, s24
    v_readlane_b32 s24, v253, 5
    s_min_i32 s62, s62, s24
    v_readlane_b32 s24, v253, 6
    s_min_i32 s62, s62, s24
    v_readlane_b32 s24, v253, 7
    s_min_i32 s62, s62, s24
    s_cmp_ge_i32 s62, s63
    s_cbranch_scc1 chain2_kernel_r_en0_ok
    s_add_u32 s61, s61, 1
    s_cmp_ge_u32 s61, s60
    s_cbranch_scc1 chain2_kernel_r_en0_to
    s_sleep 2
    s_branch chain2_kernel_r_en0
chain2_kernel_r_en0_to:
    s_mov_b32 s60, 1
chain2_kernel_r_en0_ok:
    buffer_load_dwordx4 v[48:51], v6, s[8:11], s41 offen offset:0 sc1
    buffer_load_dwordx4 v[52:55], v6, s[8:11], s41 offen offset:1024 sc1
    buffer_load_dwordx4 v[56:59], v6, s[8:11], s41 offen offset:2048 sc1
    buffer_load_dwordx4 v[60:63], v6, s[8:11], s41 offen offset:3072 sc1
    buffer_load_dwordx4 v[64:67], v7, s[8:11], s41 offen offset:0 sc1
    buffer_load_dwordx4 v[68:71], v7, s[8:11], s41 offen offset:1024 sc1
    buffer_load_dwordx4 v[72:75], v7, s[8:11], s41 offen offset:2048 sc1
    buffer_load_dwordx4 v[76:79], v7, s[8:11], s41 offen offset:3072 sc1
    s_add_u32 s41, s41, 1310720
    s_waitcnt vmcnt(0)
chain2_kernel_r_step:
    v_mov_b32 v16, v48
    v_mov_b32 v17, v49
    v_mov_b32 v18, v50
    v_mov_b32 v19, v51
    v_mov_b32 v20, v52
    v_mov_b32 v21, v53
    v_mov_b32 v22, v54
    v_mov_b32 v23, v55
    v_mov_b32 v24, v56
    v_mov_b32 v25, v57
    v_mov_b32 v26, v58
    v_mov_b32 v27, v59
    v_mov_b32 v28, v60
    v_mov_b32 v29, v61
    v_mov_b32 v30, v62
    v_mov_b32 v31, v63
    v_mov_b32 v32, v64
    v_mov_b32 v33, v65
    v_mov_b32 v34, v66
    v_mov_b32 v35, v67
    v_mov_b32 v36, v68
    v_mov_b32 v37, v69
    v_mov_b32 v38, v70
    v_mov_b32 v39, v71
    v_mov_b32 v40, v72
    v_mov_b32 v41, v73
    v_mov_b32 v42, v74
    v_mov_b32 v43, v75
    v_mov_b32 v44, v76
    v_mov_b32 v45, v77
    v_mov_b32 v46, v78
    v_mov_b32 v47, v79
    s_mov_b32 s61, 0
chain2_kernel_r_p:
    buffer_load_dwordx4 v[80:83], v8, s[8:11], s43 offen offset:0 sc1
    buffer_load_dwordx4 v[84:87], v8, s[8:11], s43 offen offset:1024 sc1
    buffer_load_dwordx4 v[88:91], v8, s[8:11], s43 offen offset:2048 sc1
    buffer_load_dwordx4 v[92:95], v8, s[8:11], s43 offen offset:3072 sc1
    buffer_load_dwordx4 v[96:99], v9, s[8:11], s43 offen sc1
    buffer_load_dwordx4 v[100:103], v10, s[8:11], s42 offen offset:0 sc1
    buffer_load_dwordx4 v[104:107], v10, s[8:11], s42 offen offset:1024 sc1
    s_waitcnt vmcnt(0)
    v_max3_u32 v204, v80, v81, v82
    v_max3_u32 v204, v204, v83, v84
    v_max3_u32 v204, v204, v85, v86
    v_max3_u32 v204, v204, v87, v88
    v_max3_u32 v204, v204, v89, v90
    v_max3_u32 v204, v204, v91, v92
    v_max3_u32 v204, v204, v93, v94
    v_max3_u32 v204, v204, v95, v96
    v_max3_u32 v204, v204, v97, v98
    v_max3_u32 v204, v204, v99, v100
    v_max3_u32 v204, v204, v101, v102
    v_max3_u32 v204, v204, v103, v104
    v_max3_u32 v204, v204, v105, v106
    v_max_u32 v204, v204, v107
    v_cmp_eq_u32 vcc, -1, v204
    s_add_u32 s61, s61, 1
    s_cbranch_vccz chain2_kernel_r_p_out
    s_cmp_ge_u32 s61, s60
    s_cbranch_scc1 chain2_kernel_r_p_to
    s_sleep 1
    s_branch chain2_kernel_r_p
chain2_kernel_r_p_to:
    s_mov_b32 s60, 1
chain2_kernel_r_p_out:
    v_mfma_f32_16x16x32_bf16 v[108:111], v[100:103], v[96:99], 0
    v_mfma_f32_16x16x32_bf16 v[112:115], v[104:107], v[96:99], 0
    v_mfma_f32_16x16x32_bf16 v[108:111], v[16:19], v[80:83], v[108:111]
    v_mfma_f32_16x16x32_bf16 v[112:115], v[20:23], v[80:83], v[112:115]
    v_mfma_f32_16x16x32_bf16 v[108:111], v[24:27], v[84:87], v[108:111]
    v_mfma_f32_16x16x32_bf16 v[112:115], v[28:31], v[84:87], v[112:115]
    v_mfma_f32_16x16x32_bf16 v[108:111], v[32:35], v[88:91], v[108:111]
    v_mfma_f32_16x16x32_bf16 v[112:115], v[36:39], v[88:91], v[112:115]
    v_mfma_f32_16x16x32_bf16 v[108:111], v[40:43], v[92:95], v[108:111]
    v_mfma_f32_16x16x32_bf16 v[112:115], v[44:47], v[92:95], v[112:115]
    s_and_b32 s24, s40, 1
    s_mul_i32 s24, s24, 2560
    v_add_u32 v14, s24, v11
    v_add_u32 v15, s24, v12
    s_nop 3
    v_cndmask_b32 v108, v108, v112, s[50:51]
    v_cndmask_b32 v109, v109, v113, s[50:51]
    v_cndmask_b32 v110, v110, v114, s[50:51]
    v_cndmask_b32 v111, v111, v115, s[50:51]
    v_add_f32 v108, v108, v108 row_ror:8 row_mask:0xf bank_mask:0xf
    v_add_f32 v109, v109, v109 row_ror:8 row_mask:0xf bank_mask:0xf
    v_add_f32 v110, v110, v110 row_ror:8 row_mask:0xf bank_mask:0xf
    v_add_f32 v111, v111, v111 row_ror:8 row_mask:0xf bank_mask:0xf
    ds_write_b128 v14, v[108:111]
    s_waitcnt lgkmcnt(0)
    s_barrier
    s_cmp_eq_u32 s3, 0
    s_cbranch_scc0 chain2_kernel_np7
    ds_read_b128 v[220:223], v15 offset:0
    ds_read_b128 v[224:227], v15 offset:16
    ds_read_b128 v[228:231], v15 offset:640
    ds_read_b128 v[232:235], v15 offset:656
    ds_read_b128 v[236:239], v15 offset:1280
    ds_read_b128 v[240:243], v15 offset:1296
    ds_read_b128 v[244:247], v15 offset:1920
    ds_read_b128 v[248:251], v15 offset:1936
    s_waitcnt lgkmcnt(4)
    v_pk_add_f32 v[220:221], v[220:221], v[228:229]
    v_pk_add_f32 v[222:223], v[222:223], v[230:231]
    v_pk_add_f32 v[224:225], v[224:225], v[232:233]
    v_pk_add_f32 v[226:227], v[226:227], v[234:235]
    s_waitcnt lgkmcnt(0)
    v_pk_add_f32 v[236:237], v[236:237], v[244:245]
    v_pk_add_f32 v[238:239], v[238:239], v[246:247]
    v_pk_add_f32 v[240:241], v[240:241], v[248:249]
    v_pk_add_f32 v[242:243], v[242:243], v[250:251]
    v_pk_add_f32 v[220:221], v[220:221], v[236:237]
    v_pk_add_f32 v[222:223], v[222:223], v[238:239]
    v_pk_add_f32 v[224:225], v[224:225], v[240:241]
    v_pk_add_f32 v[226:227], v[226:227], v[242:243]
    v_cvt_pk_bf16_f32 v228, v220, v221
    v_cvt_pk_bf16_f32 v229, v222, v223
    v_cvt_pk_bf16_f32 v230, v224, v225
    v_cvt_pk_bf16_f32 v231, v226, v227
    v_min_u32 v228, -2, v228
    v_min_u32 v229, -2, v229
    v_min_u32 v230, -2, v230
    v_min_u32 v231, -2, v231
    buffer_store_dwordx4 v[228:231], v13, s[8:11], s47 offen sc1
chain2_kernel_np7:
    s_add_u32 s63, s40, 2
    s_min_u32 s63, s63, 64
    s_cmp_ge_i32 s62, s63
    s_cbranch_scc1 chain2_kernel_r_en_ok
    s_mov_b32 s61, 0
chain2_kernel_r_en:
    buffer_load_dword v253, v252, s[8:11], 0 offen sc1
    s_waitcnt vmcnt(0)
    v_readlane_b32 s62, v253, 0
    v_readlane_b32 s24, v253, 1
    s_min_i32 s62, s62, s24
    v_readlane_b32 s24, v253, 2
    s_min_i32 s62, s62, s24
    v_readlane_b32 s24, v253, 3
    s_min_i32 s62, s62, s24
    v_readlane_b32 s24, v253, 4
    s_min_i32 s62, s62, s24
    v_readlane_b32 s24, v253, 5
    s_min_i32 s62, s62, s24
    v_readlane_b32 s24, v253, 6
    s_min_i32 s62, s62, s24
    v_readlane_b32 s24, v253, 7
    s_min_i32 s62, s62, s24
    s_cmp_ge_i32 s62, s63
    s_cbranch_scc1 chain2_kernel_r_en_ok
    s_add_u32 s61, s61, 1
    s_cmp_ge_u32 s61, s60
    s_cbranch_scc1 chain2_kernel_r_en_to
    s_sleep 2
    s_branch chain2_kernel_r_en
chain2_kernel_r_en_to:
    s_mov_b32 s60, 1
chain2_kernel_r_en_ok:
    buffer_load_dwordx4 v[48:51], v6, s[8:11], s41 offen offset:0 sc1
    buffer_load_dwordx4 v[52:55], v6, s[8:11], s41 offen offset:1024 sc1
    buffer_load_dwordx4 v[56:59], v6, s[8:11], s41 offen offset:2048 sc1
    buffer_load_dwordx4 v[60:63], v6, s[8:11], s41 offen offset:3072 sc1
    buffer_load_dwordx4 v[64:67], v7, s[8:11], s41 offen offset:0 sc1
    buffer_load_dwordx4 v[68:71], v7, s[8:11], s41 offen offset:1024 sc1
    buffer_load_dwordx4 v[72:75], v7, s[8:11], s41 offen offset:2048 sc1
    buffer_load_dwordx4 v[76:79], v7, s[8:11], s41 offen offset:3072 sc1
    s_add_u32 s41, s41, 1310720
    buffer_load_dwordx2 v[206:207], v219, s[16:19], s46 offen
    s_mov_b32 s61, 0
chain2_kernel_r_x:
    buffer_load_dwordx4 v[116:119], v212, s[8:11], s45 offen offset:0 sc1
    buffer_load_dwordx4 v[120:123], v212, s[8:11], s45 offen offset:1024 sc1
    buffer_load_dwordx4 v[124:127], v212, s[8:11], s45 offen offset:2048 sc1
    buffer_load_dwordx4 v[128:131], v212, s[8:11], s45 offen offset:3072 sc1
    buffer_load_dwordx4 v[132:135], v213, s[8:11], s45 offen offset:0 sc1
    buffer_load_dwordx4 v[136:139], v213, s[8:11], s45 offen offset:1024 sc1
    buffer_load_dwordx4 v[140:143], v213, s[8:11], s45 offen offset:2048 sc1
    buffer_load_dwordx4 v[144:147], v213, s[8:11], s45 offen offset:3072 sc1
    buffer_load_dwordx4 v[148:151], v214, s[8:11], s45 offen offset:0 sc1
    buffer_load_dwordx4 v[152:155], v214, s[8:11], s45 offen offset:1024 sc1
    buffer_load_dwordx4 v[156:159], v214, s[8:11], s45 offen offset:2048 sc1
    buffer_load_dwordx4 v[160:163], v214, s[8:11], s45 offen offset:3072 sc1
    buffer_load_dwordx4 v[164:167], v215, s[8:11], s45 offen offset:0 sc1
    buffer_load_dwordx4 v[168:171], v215, s[8:11], s45 offen offset:1024 sc1
    buffer_load_dwordx4 v[172:175], v215, s[8:11], s45 offen offset:2048 sc1
    buffer_load_dwordx4 v[176:179], v215, s[8:11], s45 offen offset:3072 sc1
    buffer_load_dwordx4 v[180:183], v216, s[8:11], s45 offen offset:0 sc1
    buffer_load_dwordx4 v[184:187], v216, s[8:11], s45 offen offset:1024 sc1
    buffer_load_dwordx4 v[188:191], v216, s[8:11], s45 offen offset:2048 sc1
    buffer_load_dwordx4 v[192:195], v216, s[8:11], s45 offen offset:3072 sc1
    s_waitcnt vmcnt(0)
    v_max3_u32 v204, v116, v117, v118
    v_max3_u32 v204, v204, v119, v120
    v_max3_u32 v204, v204, v121, v122
    v_max3_u32 v204, v204, v123, v124
    v_max3_u32 v204, v204, v125, v126
    v_max3_u32 v204, v204, v127, v128
    v_max3_u32 v204, v204, v129, v130
    v_max3_u32 v204, v204, v131, v132
    v_max3_u32 v204, v204, v133, v134
    v_max3_u32 v204, v204, v135, v136
    v_max3_u32 v204, v204, v137, v138
    v_max3_u32 v204, v204, v139, v140
    v_max3_u32 v204, v204, v141, v142
    v_max3_u32 v204, v204, v143, v144
    v_max3_u32 v204, v204, v145, v146
    v_max3_u32 v204, v204, v147, v148
    v_max3_u32 v204, v204, v149, v150
    v_max3_u32 v204, v204, v151, v152
    v_max3_u32 v204, v204, v153, v154
    v_max3_u32 v204, v204, v155, v156
    v_max3_u32 v204, v204, v157, v158
    v_max3_u32 v204, v204, v159, v160
    v_max3_u32 v204, v204, v161, v162
    v_max3_u32 v204, v204, v163, v164
    v_max3_u32 v204, v204, v165, v166
    v_max3_u32 v204, v204, v167, v168
    v_max3_u32 v204, v204, v169, v170
    v_max3_u32 v204, v204, v171, v172
    v_max3_u32 v204, v204, v173, v174
    v_max3_u32 v204, v204, v175, v176
    v_max3_u32 v204, v204, v177, v178
    v_max3_u32 v204, v204, v179, v180
    v_max3_u32 v204, v204, v181, v182
    v_max3_u32 v204, v204, v183, v184
    v_max3_u32 v204, v204, v185, v186
    v_max3_u32 v204, v204, v187, v188
    v_max3_u32 v204, v204, v189, v190
    v_max3_u32 v204, v204, v191, v192
    v_max3_u32 v204, v204, v193, v194
    v_max_u32 v204, v204, v195
    v_cmp_eq_u32 vcc, -1, v204
    s_add_u32 s61, s61, 1
    s_cbranch_vccz chain2_kernel_r_x_out
    s_cmp_ge_u32 s61, s60
    s_cbranch_scc1 chain2_kernel_r_x_to
    s_sleep 2
    s_branch chain2_kernel_r_x
chain2_kernel_r_x_to:
    s_mov_b32 s60, 1
chain2_kernel_r_x_out:
    v_mfma_f32_16x16x32_bf16 v[196:199], v[100:103], v[180:183], 0
    v_mfma_f32_16x16x32_bf16 v[200:203], v[100:103], v[184:187], 0
    v_mfma_f32_16x16x32_bf16 v[196:199], v[104:107], v[188:191], v[196:199]
    v_mfma_f32_16x16x32_bf16 v[200:203], v[104:107], v[192:195], v[200:203]
    v_mfma_f32_16x16x32_bf16 v[196:199], v[16:19], v[116:119], v[196:199]
    v_mfma_f32_16x16x32_bf16 v[200:203], v[16:19], v[120:123], v[200:203]
    v_mfma_f32_16x16x32_bf16 v[196:199], v[20:23], v[124:127], v[196:199]
    v_mfma_f32_16x16x32_bf16 v[200:203], v[20:23], v[128:131], v[200:203]
    v_mfma_f32_16x16x32_bf16 v[196:199], v[24:27], v[132:135], v[196:199]
    v_mfma_f32_16x16x32_bf16 v[200:203], v[24:27], v[136:139], v[200:203]
    v_mfma_f32_16x16x32_bf16 v[196:199], v[28:31], v[140:143], v[196:199]
    v_mfma_f32_16x16x32_bf16 v[200:203], v[28:31], v[144:147], v[200:203]
    v_mfma_f32_16x16x32_bf16 v[196:199], v[32:35], v[148:151], v[196:199]
    v_mfma_f32_16x16x32_bf16 v[200:203], v[32:35], v[152:155], v[200:203]
    v_mfma_f32_16x16x32_bf16 v[196:199], v[36:39], v[156:159], v[196:199]
    v_mfma_f32_16x16x32_bf16 v[200:203], v[36:39], v[160:163], v[200:203]
    v_mfma_f32_16x16x32_bf16 v[196:199], v[40:43], v[164:167], v[196:199]
    v_mfma_f32_16x16x32_bf16 v[200:203], v[40:43], v[168:171], v[200:203]
    v_mfma_f32_16x16x32_bf16 v[196:199], v[44:47], v[172:175], v[196:199]
    v_mfma_f32_16x16x32_bf16 v[200:203], v[44:47], v[176:179], v[200:203]
    s_nop 6
    ds_write_b128 v217, v[196:199] offset:0
    ds_write_b128 v217, v[200:203] offset:1024
    s_waitcnt lgkmcnt(0)
    s_barrier
    s_cmp_lt_u32 s3, 2
    s_cbranch_scc0 chain2_kernel_no8
    ds_read_b128 v[220:223], v218 offset:0
    ds_read_b128 v[224:227], v218 offset:2048
    ds_read_b128 v[228:231], v218 offset:4096
    ds_read_b128 v[232:235], v218 offset:6144
    s_waitcnt lgkmcnt(0)
    v_pk_add_f32 v[220:221], v[220:221], v[224:225]
    v_pk_add_f32 v[228:229], v[228:229], v[232:233]
    v_pk_add_f32 v[222:223], v[222:223], v[226:227]
    v_pk_add_f32 v[230:231], v[230:231], v[234:235]
    v_pk_add_f32 v[220:221], v[220:221], v[228:229]
    v_pk_add_f32 v[222:223], v[222:223], v[230:231]
    v_cvt_pk_bf16_f32 v224, v220, v221
    v_cvt_pk_bf16_f32 v225, v222, v223
    v_lshlrev_b32 v220, 16, v224
    v_and_b32 v221, 0xffff0000, v224
    v_lshlrev_b32 v226, 16, v206
    v_and_b32 v227, 0xffff0000, v206
    v_add_f32 v220, v220, v226
    v_add_f32 v221, v221, v227
    v_lshlrev_b32 v222, 16, v225
    v_and_b32 v223, 0xffff0000, v225
    v_lshlrev_b32 v226, 16, v207
    v_and_b32 v227, 0xffff0000, v207
    v_add_f32 v222, v222, v226
    v_add_f32 v223, v223, v227
    v_cvt_pk_bf16_f32 v224, v220, v221
    v_cvt_pk_bf16_f32 v225, v222, v223
    buffer_store_dwordx2 v[224:225], v219, s[12:15], s46 offen
chain2_kernel_no8:
    s_add_u32 s40, s40, 1
    s_add_u32 s42, s42, 327680
    s_add_u32 s43, s43, 81920
    s_add_u32 s45, s45, 81920
    s_add_u32 s46, s46, 40960
    s_add_u32 s47, s47, 40960
    s_cmp_lt_u32 s40, 64
    s_cbranch_scc1 chain2_kernel_r_step
    s_branch chain2_kernel_end
chain2_kernel_roleP:
    s_sub_u32 s44, s2, 104
    s_lshr_b32 s46, s44, 5
    s_and_b32 s44, s44, 31
    s_load_dwordx2 s[6:7], s[0:1], 40
    s_load_dwordx2 s[24:25], s[0:1], 48
    s_load_dwordx2 s[26:27], s[0:1], 56
    s_waitcnt lgkmcnt(0)
    s_cmp_eq_u32 s46, 1
    s_cselect_b32 s6, s24, s6
    s_cselect_b32 s7, s25, s7
    s_mov_b32 s43, 67108864
    s_cselect_b32 s43, 92274688, s43
    s_cmp_eq_u32 s46, 2
    s_cselect_b32 s6, s26, s6
    s_cselect_b32 s7, s27, s7
    s_cselect_b32 s43, 33554432, s43
    s_mov_b32 s12, s6
    s_mov_b32 s13, s7
    s_mov_b32 s14, 7864320
    s_mov_b32 s15, 0x00020000
    v_add_u32 v16, 0, v0
    s_mov_b32 s24, 683
    v_mul_lo_u32 v17, v16, s24
    v_lshrrev_b32 v17, 14, v17
    v_mul_u32_u24 v18, 24, v17
    v_sub_u32 v18, v16, v18
    s_mov_b32 s24, 12288
    v_mul_lo_u32 v4, v17, s24
    v_lshl_add_u32 v4, v18, 4, v4
    v_mul_u32_u24 v10, 400, v17
    v_lshl_add_u32 v10, v18, 4, v10
    v_add_u32 v10, 81920, v10
    v_add_u32 v16, 256, v0
    s_mov_b32 s24, 683
    v_mul_lo_u32 v17, v16, s24
    v_lshrrev_b32 v17, 14, v17
    v_mul_u32_u24 v18, 24, v17
    v_sub_u32 v18, v16, v18
    s_mov_b32 s24, 12288
    v_mul_lo_u32 v5, v17, s24
    v_lshl_add_u32 v5, v18, 4, v5
    v_mul_u32_u24 v11, 400, v17
    v_lshl_add_u32 v11, v18, 4, v11
    v_add_u32 v11, 81920, v11
    v_add_u32 v16, 512, v0
    s_mov_b32 s24, 683
    v_mul_lo_u32 v17, v16, s24
    v_lshrrev_b32 v17, 14, v17
    v_mul_u32_u24 v18, 24, v17
    v_sub_u32 v18, v16, v18
    s_mov_b32 s24, 12288
    v_mul_lo_u32 v6, v17, s24
    v_lshl_add_u32 v6, v18, 4, v6
    v_mul_u32_u24 v12, 400, v17
    v_lshl_add_u32 v12, v18, 4, v12
    v_add_u32 v12, 81920, v12
    v_add_u32 v16, 768, v0
    s_mov_b32 s24, 683
    v_mul_lo_u32 v17, v16, s24
    v_lshrrev_b32 v17, 14, v17
    v_mul_u32_u24 v18, 24, v17
    v_sub_u32 v18, v16, v18
    s_mov_b32 s24, 12288
    v_mul_lo_u32 v7, v17, s24
    v_lshl_add_u32 v7, v18, 4, v7
    v_mul_u32_u24 v13, 400, v17
    v_lshl_add_u32 v13, v18, 4, v13
    v_add_u32 v13, 81920, v13
    v_add_u32 v16, 1024, v0
    s_mov_b32 s24, 683
    v_mul_lo_u32 v17, v16, s24
    v_lshrrev_b32 v17, 14, v17
    v_mul_u32_u24 v18, 24, v17
    v_sub_u32 v18, v16, v18
    s_mov_b32 s24, 12288
    v_mul_lo_u32 v8, v17, s24
    v_lshl_add_u32 v8, v18, 4, v8
    v_mul_u32_u24 v14, 400, v17
    v_lshl_add_u32 v14, v18, 4, v14
    v_add_u32 v14, 81920, v14
    v_add_u32 v16, 1280, v0
    s_mov_b32 s24, 683
    v_mul_lo_u32 v17, v16, s24
    v_lshrrev_b32 v17, 14, v17
    v_mul_u32_u24 v18, 24, v17
    v_sub_u32 v18, v16, v18
    s_mov_b32 s24, 12288
    v_mul_lo_u32 v9, v17, s24
    v_lshl_add_u32 v9, v18, 4, v9
    v_mul_u32_u24 v15, 400, v17
    v_lshl_add_u32 v15, v18, 4, v15
    v_add_u32 v15, 81920, v15
    v_lshrrev_b32 v16, 2, v2
    v_lshl_add_u32 v16, v3, 3, v16
    v_mul_u32_u24 v0, 400, v16
    v_and_b32 v16, 3, v2
    v_lshl_add_u32 v0, v16, 3, v0
    s_mul_i32 s24, s3, 96
    s_add_u32 s24, s24, 81920
    v_add_u32 v0, s24, v0
    v_lshlrev_b32 v16, 4, v1
    s_mul_i32 s24, s3, 10240
    v_add_u32 v17, s24, v16
    v_add_u32 v18, 4096, v17
    v_add_u32 v19, 8192, v17
    s_mov_b32 s41, 59768832
    buffer_load_dwordx4 a[240:243], v17, s[8:11], s41 offen offset:0
    buffer_load_dwordx4 a[244:247], v17, s[8:11], s41 offen offset:1024
    buffer_load_dwordx4 a[248:251], v17, s[8:11], s41 offen offset:2048
    buffer_load_dwordx4 a[252:255], v17, s[8:11], s41 offen offset:3072
    buffer_load_dwordx4 v[20:23], v18, s[8:11], s41 offen offset:0
    buffer_load_dwordx4 v[24:27], v18, s[8:11], s41 offen offset:1024
    buffer_load_dwordx4 v[28:31], v18, s[8:11], s41 offen offset:2048
    buffer_load_dwordx4 v[32:35], v18, s[8:11], s41 offen offset:3072
    buffer_load_dwordx4 v[36:39], v19, s[8:11], s41 offen offset:0
    buffer_load_dwordx4 v[40:43], v19, s[8:11], s41 offen offset:1024
    s_mul_i32 s45, s44, 384
    s_add_u32 s47, s45, 0
    buffer_load_dwordx4 v[56:59], v4, s[12:15], s47 offen
    buffer_load_dwordx4 v[60:63], v5, s[12:15], s47 offen
    buffer_load_dwordx4 v[64:67], v6, s[12:15], s47 offen
    buffer_load_dwordx4 v[68:71], v7, s[12:15], s47 offen
    buffer_load_dwordx4 v[72:75], v8, s[12:15], s47 offen
    buffer_load_dwordx4 v[76:79], v9, s[12:15], s47 offen
    s_add_u32 s47, s45, 786432
    buffer_load_dwordx4 v[80:83], v4, s[12:15], s47 offen
    buffer_load_dwordx4 v[84:87], v5, s[12:15], s47 offen
    buffer_load_dwordx4 v[88:91], v6, s[12:15], s47 offen
    buffer_load_dwordx4 v[92:95], v7, s[12:15], s47 offen
    buffer_load_dwordx4 v[96:99], v8, s[12:15], s47 offen
    buffer_load_dwordx4 v[100:103], v9, s[12:15], s47 offen
    s_add_u32 s47, s45, 1572864
    buffer_load_dwordx4 v[104:107], v4, s[12:15], s47 offen
    buffer_load_dwordx4 v[108:111], v5, s[12:15], s47 offen
    buffer_load_dwordx4 v[112:115], v6, s[12:15], s47 offen
    buffer_load_dwordx4 v[116:119], v7, s[12:15], s47 offen
    buffer_load_dwordx4 v[120:123], v8, s[12:15], s47 offen
    buffer_load_dwordx4 v[124:127], v9, s[12:15], s47 offen
    s_add_u32 s47, s45, 2359296
    buffer_load_dwordx4 v[128:131], v4, s[12:15], s47 offen
    buffer_load_dwordx4 v[132:135], v5, s[12:15], s47 offen
    buffer_load_dwordx4 v[136:139], v6, s[12:15], s47 offen
    buffer_load_dwordx4 v[140:143], v7, s[12:15], s47 offen
    buffer_load_dwordx4 v[144:147], v8, s[12:15], s47 offen
    buffer_load_dwordx4 v[148:151], v9, s[12:15], s47 offen
    s_add_u32 s47, s45, 3145728
    buffer_load_dwordx4 v[152:155], v4, s[12:15], s47 offen
    buffer_load_dwordx4 v[156:159], v5, s[12:15], s47 offen
    buffer_load_dwordx4 v[160:163], v6, s[12:15], s47 offen
    buffer_load_dwordx4 v[164:167], v7, s[12:15], s47 offen
    buffer_load_dwordx4 v[168:171], v8, s[12:15], s47 offen
    buffer_load_dwordx4 v[172:175], v9, s[12:15], s47 offen
    s_add_u32 s47, s45, 3932160
    buffer_load_dwordx4 v[176:179], v4, s[12:15], s47 offen
    buffer_load_dwordx4 v[180:183], v5, s[12:15], s47 offen
    buffer_load_dwordx4 v[184:187], v6, s[12:15], s47 offen
    buffer_load_dwordx4 v[188:191], v7, s[12:15], s47 offen
    buffer_load_dwordx4 v[192:195], v8, s[12:15], s47 offen
    buffer_load_dwordx4 v[196:199], v9, s[12:15], s47 offen
    s_add_u32 s47, s45, 4718592
    buffer_load_dwordx4 v[200:203], v4, s[12:15], s47 offen
    buffer_load_dwordx4 v[204:207], v5, s[12:15], s47 offen
    buffer_load_dwordx4 v[208:211], v6, s[12:15], s47 offen
    buffer_load_dwordx4 v[212:215], v7, s[12:15], s47 offen
    buffer_load_dwordx4 v[216:219], v8, s[12:15], s47 offen
    buffer_load_dwordx4 v[220:223], v9, s[12:15], s47 offen
    s_add_u32 s47, s45, 5505024
    buffer_load_dwordx4 v[224:227], v4, s[12:15], s47 offen
    buffer_load_dwordx4 v[228:231], v5, s[12:15], s47 offen
    buffer_load_dwordx4 v[232:235], v6, s[12:15], s47 offen
    buffer_load_dwordx4 v[236:239], v7, s[12:15], s47 offen
    buffer_load_dwordx4 v[240:243], v8, s[12:15], s47 offen
    buffer_load_dwordx4 v[244:247], v9, s[12:15], s47 offen
    s_waitcnt vmcnt(42)
    ds_write_b128 v10, v[56:59] offset:0
    ds_write_b128 v11, v[60:63] offset:0
    ds_write_b128 v12, v[64:67] offset:0
    ds_write_b128 v13, v[68:71] offset:0
    ds_write_b128 v14, v[72:75] offset:0
    ds_write_b128 v15, v[76:79] offset:0
    ds_write_b128 v17, a[240:243] offset:0
    ds_write_b128 v17, a[244:247] offset:1024
    ds_write_b128 v17, a[248:251] offset:2048
    ds_write_b128 v17, a[252:255] offset:3072
    ds_write_b128 v17, v[20:23] offset:4096
    ds_write_b128 v17, v[24:27] offset:5120
    ds_write_b128 v17, v[28:31] offset:6144
    ds_write_b128 v17, v[32:35] offset:7168
    ds_write_b128 v17, v[36:39] offset:8192
    ds_write_b128 v17, v[40:43] offset:9216
    s_waitcnt lgkmcnt(0)
    s_add_u32 s47, s45, 6291456
    buffer_load_dwordx4 v[56:59], v4, s[12:15], s47 offen
    buffer_load_dwordx4 v[60:63], v5, s[12:15], s47 offen
    buffer_load_dwordx4 v[64:67], v6, s[12:15], s47 offen
    buffer_load_dwordx4 v[68:71], v7, s[12:15], s47 offen
    buffer_load_dwordx4 v[72:75], v8, s[12:15], s47 offen
    buffer_load_dwordx4 v[76:79], v9, s[12:15], s47 offen
    s_barrier
    ds_read_b64_tr_b16 a[0:1], v0 offset:0
    ds_read_b64_tr_b16 a[2:3], v0 offset:1600
    ds_read_b64_tr_b16 a[4:5], v0 offset:12800
    ds_read_b64_tr_b16 a[6:7], v0 offset:14400
    ds_read_b64_tr_b16 a[80:81], v0 offset:32
    ds_read_b64_tr_b16 a[82:83], v0 offset:1632
    ds_read_b64_tr_b16 a[84:85], v0 offset:12832
    ds_read_b64_tr_b16 a[86:87], v0 offset:14432
    ds_read_b64_tr_b16 a[160:161], v0 offset:64
    ds_read_b64_tr_b16 a[162:163], v0 offset:1664
    ds_read_b64_tr_b16 a[164:165], v0 offset:12864
    ds_read_b64_tr_b16 a[166:167], v0 offset:14464
    s_waitcnt vmcnt(42)
    ds_write_b128 v10, v[80:83] offset:25600
    ds_write_b128 v11, v[84:87] offset:25600
    ds_write_b128 v12, v[88:91] offset:25600
    ds_write_b128 v13, v[92:95] offset:25600
    ds_write_b128 v14, v[96:99] offset:25600
    ds_write_b128 v15, v[100:103] offset:25600
    s_waitcnt lgkmcnt(0)
    s_add_u32 s47, s45, 7077888
    buffer_load_dwordx4 v[80:83], v4, s[12:15], s47 offen
    buffer_load_dwordx4 v[84:87], v5, s[12:15], s47 offen
    buffer_load_dwordx4 v[88:91], v6, s[12:15], s47 offen
    buffer_load_dwordx4 v[92:95], v7, s[12:15], s47 offen
    buffer_load_dwordx4 v[96:99], v8, s[12:15], s47 offen
    buffer_load_dwordx4 v[100:103], v9, s[12:15], s47 offen
    s_barrier
    ds_read_b64_tr_b16 a[8:9], v0 offset:25600
    ds_read_b64_tr_b16 a[10:11], v0 offset:27200
    ds_read_b64_tr_b16 a[12:13], v0 offset:38400
    ds_read_b64_tr_b16 a[14:15], v0 offset:40000
    ds_read_b64_tr_b16 a[88:89], v0 offset:25632
    ds_read_b64_tr_b16 a[90:91], v0 offset:27232
    ds_read_b64_tr_b16 a[92:93], v0 offset:38432
    ds_read_b64_tr_b16 a[94:95], v0 offset:40032
    ds_read_b64_tr_b16 a[168:169], v0 offset:25664
    ds_read_b64_tr_b16 a[170:171], v0 offset:27264
    ds_read_b64_tr_b16 a[172:173], v0 offset:38464
    ds_read_b64_tr_b16 a[174:175], v0 offset:40064
    s_waitcnt vmcnt(42)
    ds_write_b128 v10, v[104:107] offset:0
    ds_write_b128 v11, v[108:111] offset:0
    ds_write_b128 v12, v[112:115] offset:0
    ds_write_b128 v13, v[116:119] offset:0
    ds_write_b128 v14, v[120:123] offset:0
    ds_write_b128 v15, v[124:127] offset:0
    s_waitcnt lgkmcnt(0)
    s_barrier
    ds_read_b64_tr_b16 a[16:17], v0 offset:0
    ds_read_b64_tr_b16 a[18:19], v0 offset:1600
    ds_read_b64_tr_b16 a[20:21], v0 offset:12800
    ds_read_b64_tr_b16 a[22:23], v0 offset:14400
    ds_read_b64_tr_b16 a[96:97], v0 offset:32
    ds_read_b64_tr_b16 a[98:99], v0 offset:1632
    ds_read_b64_tr_b16 a[100:101], v0 offset:12832
    ds_read_b64_tr_b16 a[102:103], v0 offset:14432
    ds_read_b64_tr_b16 a[176:177], v0 offset:64
    ds_read_b64_tr_b16 a[178:179], v0 offset:1664
    ds_read_b64_tr_b16 a[180:181], v0 offset:12864
    ds_read_b64_tr_b16 a[182:183], v0 offset:14464
    s_waitcnt vmcnt(36)
    ds_write_b128 v10, v[128:131] offset:25600
    ds_write_b128 v11, v[132:135] offset:25600
    ds_write_b128 v12, v[136:139] offset:25600
    ds_write_b128 v13, v[140:143] offset:25600
    ds_write_b128 v14, v[144:147] offset:25600
    ds_write_b128 v15, v[148:151] offset:25600
    s_waitcnt lgkmcnt(0)
    s_barrier
    ds_read_b64_tr_b16 a[24:25], v0 offset:25600
    ds_read_b64_tr_b16 a[26:27], v0 offset:27200
    ds_read_b64_tr_b16 a[28:29], v0 offset:38400
    ds_read_b64_tr_b16 a[30:31], v0 offset:40000
    ds_read_b64_tr_b16 a[104:105], v0 offset:25632
    ds_read_b64_tr_b16 a[106:107], v0 offset:27232
    ds_read_b64_tr_b16 a[108:109], v0 offset:38432
    ds_read_b64_tr_b16 a[110:111], v0 offset:40032
    ds_read_b64_tr_b16 a[184:185], v0 offset:25664
    ds_read_b64_tr_b16 a[186:187], v0 offset:27264
    ds_read_b64_tr_b16 a[188:189], v0 offset:38464
    ds_read_b64_tr_b16 a[190:191], v0 offset:40064
    s_waitcnt vmcnt(30)
    ds_write_b128 v10, v[152:155] offset:0
    ds_write_b128 v11, v[156:159] offset:0
    ds_write_b128 v12, v[160:163] offset:0
    ds_write_b128 v13, v[164:167] offset:0
    ds_write_b128 v14, v[168:171] offset:0
    ds_write_b128 v15, v[172:175] offset:0
    s_waitcnt lgkmcnt(0)
    s_barrier
    ds_read_b64_tr_b16 a[32:33], v0 offset:0
    ds_read_b64_tr_b16 a[34:35], v0 offset:1600
    ds_read_b64_tr_b16 a[36:37], v0 offset:12800
    ds_read_b64_tr_b16 a[38:39], v0 offset:14400
    ds_read_b64_tr_b16 a[112:113], v0 offset:32
    ds_read_b64_tr_b16 a[114:115], v0 offset:1632
    ds_read_b64_tr_b16 a[116:117], v0 offset:12832
    ds_read_b64_tr_b16 a[118:119], v0 offset:14432
    ds_read_b64_tr_b16 a[192:193], v0 offset:64
    ds_read_b64_tr_b16 a[194:195], v0 offset:1664
    ds_read_b64_tr_b16 a[196:197], v0 offset:12864
    ds_read_b64_tr_b16 a[198:199], v0 offset:14464
    s_waitcnt vmcnt(24)
    ds_write_b128 v10, v[176:179] offset:25600
    ds_write_b128 v11, v[180:183] offset:25600
    ds_write_b128 v12, v[184:187] offset:25600
    ds_write_b128 v13, v[188:191] offset:25600
    ds_write_b128 v14, v[192:195] offset:25600
    ds_write_b128 v15, v[196:199] offset:25600
    s_waitcnt lgkmcnt(0)
    s_barrier
    ds_read_b64_tr_b16 a[40:41], v0 offset:25600
    ds_read_b64_tr_b16 a[42:43], v0 offset:27200
    ds_read_b64_tr_b16 a[44:45], v0 offset:38400
    ds_read_b64_tr_b16 a[46:47], v0 offset:40000
    ds_read_b64_tr_b16 a[120:121], v0 offset:25632
    ds_read_b64_tr_b16 a[122:123], v0 offset:27232
    ds_read_b64_tr_b16 a[124:125], v0 offset:38432
    ds_read_b64_tr_b16 a[126:127], v0 offset:40032
    ds_read_b64_tr_b16 a[200:201], v0 offset:25664
    ds_read_b64_tr_b16 a[202:203], v0 offset:27264
    ds_read_b64_tr_b16 a[204:205], v0 offset:38464
    ds_read_b64_tr_b16 a[206:207], v0 offset:40064
    s_waitcnt vmcnt(18)
    ds_write_b128 v10, v[200:203] offset:0
    ds_write_b128 v11, v[204:207] offset:0
    ds_write_b128 v12, v[208:211] offset:0
    ds_write_b128 v13, v[212:215] offset:0
    ds_write_b128 v14, v[216:219] offset:0
    ds_write_b128 v15, v[220:223] offset:0
    s_waitcnt lgkmcnt(0)
    s_barrier
    ds_read_b64_tr_b16 a[48:49], v0 offset:0
    ds_read_b64_tr_b16 a[50:51], v0 offset:1600
    ds_read_b64_tr_b16 a[52:53], v0 offset:12800
    ds_read_b64_tr_b16 a[54:55], v0 offset:14400
    ds_read_b64_tr_b16 a[128:129], v0 offset:32
    ds_read_b64_tr_b16 a[130:131], v0 offset:1632
    ds_read_b64_tr_b16 a[132:133], v0 offset:12832
    ds_read_b64_tr_b16 a[134:135], v0 offset:14432
    ds_read_b64_tr_b16 a[208:209], v0 offset:64
    ds_read_b64_tr_b16 a[210:211], v0 offset:1664
    ds_read_b64_tr_b16 a[212:213], v0 offset:12864
    ds_read_b64_tr_b16 a[214:215], v0 offset:14464
    s_waitcnt vmcnt(12)
    ds_write_b128 v10, v[224:227] offset:25600
    ds_write_b128 v11, v[228:231] offset:25600
    ds_write_b128 v12, v[232:235] offset:25600
    ds_write_b128 v13, v[236:239] offset:25600
    ds_write_b128 v14, v[240:243] offset:25600
    ds_write_b128 v15, v[244:247] offset:25600
    s_waitcnt lgkmcnt(0)
    s_barrier
    ds_read_b64_tr_b16 a[56:57], v0 offset:25600
    ds_read_b64_tr_b16 a[58:59], v0 offset:27200
    ds_read_b64_tr_b16 a[60:61], v0 offset:38400
    ds_read_b64_tr_b16 a[62:63], v0 offset:40000
    ds_read_b64_tr_b16 a[136:137], v0 offset:25632
    ds_read_b64_tr_b16 a[138:139], v0 offset:27232
    ds_read_b64_tr_b16 a[140:141], v0 offset:38432
    ds_read_b64_tr_b16 a[142:143], v0 offset:40032
    ds_read_b64_tr_b16 a[216:217], v0 offset:25664
    ds_read_b64_tr_b16 a[218:219], v0 offset:27264
    ds_read_b64_tr_b16 a[220:221], v0 offset:38464
    ds_read_b64_tr_b16 a[222:223], v0 offset:40064
    s_waitcnt vmcnt(6)
    ds_write_b128 v10, v[56:59] offset:0
    ds_write_b128 v11, v[60:63] offset:0
    ds_write_b128 v12, v[64:67] offset:0
    ds_write_b128 v13, v[68:71] offset:0
    ds_write_b128 v14, v[72:75] offset:0
    ds_write_b128 v15, v[76:79] offset:0
    s_waitcnt lgkmcnt(0)
    s_barrier
    ds_read_b64_tr_b16 a[64:65], v0 offset:0
    ds_read_b64_tr_b16 a[66:67], v0 offset:1600
    ds_read_b64_tr_b16 a[68:69], v0 offset:12800
    ds_read_b64_tr_b16 a[70:71], v0 offset:14400
    ds_read_b64_tr_b16 a[144:145], v0 offset:32
    ds_read_b64_tr_b16 a[146:147], v0 offset:1632
    ds_read_b64_tr_b16 a[148:149], v0 offset:12832
    ds_read_b64_tr_b16 a[150:151], v0 offset:14432
    ds_read_b64_tr_b16 a[224:225], v0 offset:64
    ds_read_b64_tr_b16 a[226:227], v0 offset:1664
    ds_read_b64_tr_b16 a[228:229], v0 offset:12864
    ds_read_b64_tr_b16 a[230:231], v0 offset:14464
    s_waitcnt vmcnt(0)
    ds_write_b128 v10, v[80:83] offset:25600
    ds_write_b128 v11, v[84:87] offset:25600
    ds_write_b128 v12, v[88:91] offset:25600
    ds_write_b128 v13, v[92:95] offset:25600
    ds_write_b128 v14, v[96:99] offset:25600
    ds_write_b128 v15, v[100:103] offset:25600
    s_waitcnt lgkmcnt(0)
    s_barrier
    ds_read_b64_tr_b16 a[72:73], v0 offset:25600
    ds_read_b64_tr_b16 a[74:75], v0 offset:27200
    ds_read_b64_tr_b16 a[76:77], v0 offset:38400
    ds_read_b64_tr_b16 a[78:79], v0 offset:40000
    ds_read_b64_tr_b16 a[152:153], v0 offset:25632
    ds_read_b64_tr_b16 a[154:155], v0 offset:27232
    ds_read_b64_tr_b16 a[156:157], v0 offset:38432
    ds_read_b64_tr_b16 a[158:159], v0 offset:40032
    ds_read_b64_tr_b16 a[232:233], v0 offset:25664
    ds_read_b64_tr_b16 a[234:235], v0 offset:27264
    ds_read_b64_tr_b16 a[236:237], v0 offset:38464
    ds_read_b64_tr_b16 a[238:239], v0 offset:40064
    v_mov_b32 v6, v17
    v_mov_b32 v7, v18
    v_mov_b32 v8, v19
    v_lshlrev_b32 v5, 4, v1
    s_mul_i32 s24, s44, 12288
    s_mul_i32 s25, s3, 3072
    s_add_u32 s24, s24, s25
    v_add_u32 v11, s24, v5
    s_lshl_b32 s24, s46, 12
    s_lshl_b32 s25, s44, 7
    s_add_u32 s24, s24, s25
    s_add_u32 s24, s24, 151560192
    v_mov_b32 v14, s24
    v_mov_b32 v15, 2146435072
    v_cmp_eq_u32 vcc, 0, v1
    s_nop 1
    v_cndmask_b32 v14, v15, v14, vcc
    s_mov_b32 s40, 0
    s_mov_b32 s42, 0
    s_waitcnt lgkmcnt(0)
chain2_kernel_p_seg:
    v_add_u32 v9, s42, v5
    s_xor_b32 s42, s42, 40960
    v_add_u32 v10, s42, v6
    s_add_u32 s41, s41, 40960
    buffer_load_dwordx4 v[16:19], v6, s[8:11], s41 offen offset:0
    buffer_load_dwordx4 v[20:23], v6, s[8:11], s41 offen offset:1024
    buffer_load_dwordx4 v[24:27], v6, s[8:11], s41 offen offset:2048
    buffer_load_dwordx4 v[28:31], v6, s[8:11], s41 offen offset:3072
    buffer_load_dwordx4 v[32:35], v7, s[8:11], s41 offen offset:0
    buffer_load_dwordx4 v[36:39], v7, s[8:11], s41 offen offset:1024
    buffer_load_dwordx4 v[40:43], v7, s[8:11], s41 offen offset:2048
    buffer_load_dwordx4 v[44:47], v7, s[8:11], s41 offen offset:3072
    buffer_load_dwordx4 v[48:51], v8, s[8:11], s41 offen offset:0
    buffer_load_dwordx4 v[52:55], v8, s[8:11], s41 offen offset:1024
    ds_read_b128 v[56:59], v9 offset:0
    ds_read_b128 v[60:63], v9 offset:20480
    ds_read_b128 v[64:67], v9 offset:1024
    ds_read_b128 v[68:71], v9 offset:21504
    ds_read_b128 v[72:75], v9 offset:2048
    ds_read_b128 v[76:79], v9 offset:22528
    ds_read_b128 v[80:83], v9 offset:3072
    ds_read_b128 v[84:87], v9 offset:23552
    s_waitcnt lgkmcnt(6)
    v_mfma_f32_16x16x32_bf16 v[88:91], a[0:3], v[56:59], 0
    v_mfma_f32_16x16x32_bf16 v[92:95], a[80:83], v[56:59], 0
    v_mfma_f32_16x16x32_bf16 v[96:99], a[160:163], v[56:59], 0
    v_mfma_f32_16x16x32_bf16 v[100:103], a[0:3], v[60:63], 0
    v_mfma_f32_16x16x32_bf16 v[104:107], a[80:83], v[60:63], 0
    v_mfma_f32_16x16x32_bf16 v[108:111], a[160:163], v[60:63], 0
    ds_read_b128 v[56:59], v9 offset:4096
    ds_read_b128 v[60:63], v9 offset:24576
    s_waitcnt lgkmcnt(6)
    v_mfma_f32_16x16x32_bf16 v[88:91], a[4:7], v[64:67], v[88:91]
    v_mfma_f32_16x16x32_bf16 v[92:95], a[84:87], v[64:67], v[92:95]
    v_mfma_f32_16x16x32_bf16 v[96:99], a[164:167], v[64:67], v[96:99]
    v_mfma_f32_16x16x32_bf16 v[100:103], a[4:7], v[68:71], v[100:103]
    v_mfma_f32_16x16x32_bf16 v[104:107], a[84:87], v[68:71], v[104:107]
    v_mfma_f32_16x16x32_bf16 v[108:111], a[164:167], v[68:71], v[108:111]
    ds_read_b128 v[64:67], v9 offset:5120
    ds_read_b128 v[68:71], v9 offset:25600
    s_waitcnt lgkmcnt(6)
    v_mfma_f32_16x16x32_bf16 v[88:91], a[8:11], v[72:75], v[88:91]
    v_mfma_f32_16x16x32_bf16 v[92:95], a[88:91], v[72:75], v[92:95]
    v_mfma_f32_16x16x32_bf16 v[96:99], a[168:171], v[72:75], v[96:99]
    v_mfma_f32_16x16x32_bf16 v[100:103], a[8:11], v[76:79], v[100:103]
    v_mfma_f32_16x16x32_bf16 v[104:107], a[88:91], v[76:79], v[104:107]
    v_mfma_f32_16x16x32_bf16 v[108:111], a[168:171], v[76:79], v[108:111]
    ds_read_b128 v[72:75], v9 offset:6144
    ds_read_b128 v[76:79], v9 offset:26624
    s_waitcnt lgkmcnt(6)
    v_mfma_f32_16x16x32_bf16 v[88:91], a[12:15], v[80:83], v[88:91]
    v_mfma_f32_16x16x32_bf16 v[92:95], a[92:95], v[80:83], v[92:95]
    v_mfma_f32_16x16x32_bf16 v[96:99], a[172:175], v[80:83], v[96:99]
    v_mfma_f32_16x16x32_bf16 v[100:103], a[12:15], v[84:87], v[100:103]
    v_mfma_f32_16x16x32_bf16 v[104:107], a[92:95], v[84:87], v[104:107]
    v_mfma_f32_16x16x32_bf16 v[108:111], a[172:175], v[84:87], v[108:111]
    ds_read_b128 v[80:83], v9 offset:7168
    ds_read_b128 v[84:87], v9 offset:27648
    s_waitcnt lgkmcnt(6)
    v_mfma_f32_16x16x32_bf16 v[88:91], a[16:19], v[56:59], v[88:91]
    v_mfma_f32_16x16x32_bf16 v[92:95], a[96:99], v[56:59], v[92:95]
    v_mfma_f32_16x16x32_bf16 v[96:99], a[176:179], v[56:59], v[96:99]
    v_mfma_f32_16x16x32_bf16 v[100:103], a[16:19], v[60:63], v[100:103]
    v_mfma_f32_16x16x32_bf16 v[104:107], a[96:99], v[60:63], v[104:107]
    v_mfma_f32_16x16x32_bf16 v[108:111], a[176:179], v[60:63], v[108:111]
    ds_read_b128 v[56:59], v9 offset:8192
    ds_read_b128 v[60:63], v9 offset:28672
    s_waitcnt lgkmcnt(6)
    v_mfma_f32_16x16x32_bf16 v[88:91], a[20:23], v[64:67], v[88:91]
    v_mfma_f32_16x16x32_bf16 v[92:95], a[100:103], v[64:67], v[92:95]
    v_mfma_f32_16x16x32_bf16 v[96:99], a[180:183], v[64:67], v[96:99]
    v_mfma_f32_16x16x32_bf16 v[100:103], a[20:23], v[68:71], v[100:103]
    v_mfma_f32_16x16x32_bf16 v[104:107], a[100:103], v[68:71], v[104:107]
    v_mfma_f32_16x16x32_bf16 v[108:111], a[180:183], v[68:71], v[108:111]
    ds_read_b128 v[64:67], v9 offset:9216
    ds_read_b128 v[68:71], v9 offset:29696
    s_waitcnt lgkmcnt(6)
    v_mfma_f32_16x16x32_bf16 v[88:91], a[24:27], v[72:75], v[88:91]
    v_mfma_f32_16x16x32_bf16 v[92:95], a[104:107], v[72:75], v[92:95]
    v_mfma_f32_16x16x32_bf16 v[96:99], a[184:187], v[72:75], v[96:99]
    v_mfma_f32_16x16x32_bf16 v[100:103], a[24:27], v[76:79], v[100:103]
    v_mfma_f32_16x16x32_bf16 v[104:107], a[104:107], v[76:79], v[104:107]
    v_mfma_f32_16x16x32_bf16 v[108:111], a[184:187], v[76:79], v[108:111]
    ds_read_b128 v[72:75], v9 offset:10240
    ds_read_b128 v[76:79], v9 offset:30720
    s_waitcnt lgkmcnt(6)
    v_mfma_f32_16x16x32_bf16 v[88:91], a[28:31], v[80:83], v[88:91]
    v_mfma_f32_16x16x32_bf16 v[92:95], a[108:111], v[80:83], v[92:95]
    v_mfma_f32_16x16x32_bf16 v[96:99], a[188:191], v[80:83], v[96:99]
    v_mfma_f32_16x16x32_bf16 v[100:103], a[28:31], v[84:87], v[100:103]
    v_mfma_f32_16x16x32_bf16 v[104:107], a[108:111], v[84:87], v[104:107]
    v_mfma_f32_16x16x32_bf16 v[108:111], a[188:191], v[84:87], v[108:111]
    ds_read_b128 v[80:83], v9 offset:11264
    ds_read_b128 v[84:87], v9 offset:31744
    s_waitcnt lgkmcnt(6)
    v_mfma_f32_16x16x32_bf16 v[88:91], a[32:35], v[56:59], v[88:91]
    v_mfma_f32_16x16x32_bf16 v[92:95], a[112:115], v[56:59], v[92:95]
    v_mfma_f32_16x16x32_bf16 v[96:99], a[192:195], v[56:59], v[96:99]
    v_mfma_f32_16x16x32_bf16 v[100:103], a[32:35], v[60:63], v[100:103]
    v_mfma_f32_16x16x32_bf16 v[104:107], a[112:115], v[60:63], v[104:107]
    v_mfma_f32_16x16x32_bf16 v[108:111], a[192:195], v[60:63], v[108:111]
    ds_read_b128 v[56:59], v9 offset:12288
    ds_read_b128 v[60:63], v9 offset:32768
    s_waitcnt lgkmcnt(6)
    v_mfma_f32_16x16x32_bf16 v[88:91], a[36:39], v[64:67], v[88:91]
    v_mfma_f32_16x16x32_bf16 v[92:95], a[116:119], v[64:67], v[92:95]
    v_mfma_f32_16x16x32_bf16 v[96:99], a[196:199], v[64:67], v[96:99]
    v_mfma_f32_16x16x32_bf16 v[100:103], a[36:39], v[68:71], v[100:103]
    v_mfma_f32_16x16x32_bf16 v[104:107], a[116:119], v[68:71], v[104:107]
    v_mfma_f32_16x16x32_bf16 v[108:111], a[196:199], v[68:71], v[108:111]
    s_waitcnt vmcnt(10)
    s_barrier
    s_cmp_eq_u32 s3, 0
    s_cbranch_scc0 chain2_kernel_fp9
    v_mov_b32 v15, s40
    buffer_store_dword v15, v14, s[8:11], 0 offen sc1
chain2_kernel_fp9:
    ds_read_b128 v[64:67], v9 offset:13312
    ds_read_b128 v[68:71], v9 offset:33792
    s_waitcnt lgkmcnt(6)
    v_mfma_f32_16x16x32_bf16 v[88:91], a[40:43], v[72:75], v[88:91]
    v_mfma_f32_16x16x32_bf16 v[92:95], a[120:123], v[72:75], v[92:95]
    v_mfma_f32_16x16x32_bf16 v[96:99], a[200:203], v[72:75], v[96:99]
    v_mfma_f32_16x16x32_bf16 v[100:103], a[40:43], v[76:79], v[100:103]
    v_mfma_f32_16x16x32_bf16 v[104:107], a[120:123], v[76:79], v[104:107]
    v_mfma_f32_16x16x32_bf16 v[108:111], a[200:203], v[76:79], v[108:111]
    ds_read_b128 v[72:75], v9 offset:14336
    ds_read_b128 v[76:79], v9 offset:34816
    s_waitcnt lgkmcnt(6)
    v_mfma_f32_16x16x32_bf16 v[88:91], a[44:47], v[80:83], v[88:91]
    v_mfma_f32_16x16x32_bf16 v[92:95], a[124:127], v[80:83], v[92:95]
    v_mfma_f32_16x16x32_bf16 v[96:99], a[204:207], v[80:83], v[96:99]
    v_mfma_f32_16x16x32_bf16 v[100:103], a[44:47], v[84:87], v[100:103]
    v_mfma_f32_16x16x32_bf16 v[104:107], a[124:127], v[84:87], v[104:107]
    v_mfma_f32_16x16x32_bf16 v[108:111], a[204:207], v[84:87], v[108:111]
    ds_read_b128 v[80:83], v9 offset:15360
    ds_read_b128 v[84:87], v9 offset:35840
    s_waitcnt lgkmcnt(6)
    v_mfma_f32_16x16x32_bf16 v[88:91], a[48:51], v[56:59], v[88:91]
    v_mfma_f32_16x16x32_bf16 v[92:95], a[128:131], v[56:59], v[92:95]
    v_mfma_f32_16x16x32_bf16 v[96:99], a[208:211], v[56:59], v[96:99]
    v_mfma_f32_16x16x32_bf16 v[100:103], a[48:51], v[60:63], v[100:103]
    v_mfma_f32_16x16x32_bf16 v[104:107], a[128:131], v[60:63], v[104:107]
    v_mfma_f32_16x16x32_bf16 v[108:111], a[208:211], v[60:63], v[108:111]
    ds_read_b128 v[56:59], v9 offset:16384
    ds_read_b128 v[60:63], v9 offset:36864
    s_waitcnt lgkmcnt(6)
    v_mfma_f32_16x16x32_bf16 v[88:91], a[52:55], v[64:67], v[88:91]
    v_mfma_f32_16x16x32_bf16 v[92:95], a[132:135], v[64:67], v[92:95]
    v_mfma_f32_16x16x32_bf16 v[96:99], a[212:215], v[64:67], v[96:99]
    v_mfma_f32_16x16x32_bf16 v[100:103], a[52:55], v[68:71], v[100:103]
    v_mfma_f32_16x16x32_bf16 v[104:107], a[132:135], v[68:71], v[104:107]
    v_mfma_f32_16x16x32_bf16 v[108:111], a[212:215], v[68:71], v[108:111]
    ds_read_b128 v[64:67], v9 offset:17408
    ds_read_b128 v[68:71], v9 offset:37888
    s_waitcnt lgkmcnt(6)
    v_mfma_f32_16x16x32_bf16 v[88:91], a[56:59], v[72:75], v[88:91]
    v_mfma_f32_16x16x32_bf16 v[92:95], a[136:139], v[72:75], v[92:95]
    v_mfma_f32_16x16x32_bf16 v[96:99], a[216:219], v[72:75], v[96:99]
    v_mfma_f32_16x16x32_bf16 v[100:103], a[56:59], v[76:79], v[100:103]
    v_mfma_f32_16x16x32_bf16 v[104:107], a[136:139], v[76:79], v[104:107]
    v_mfma_f32_16x16x32_bf16 v[108:111], a[216:219], v[76:79], v[108:111]
    ds_read_b128 v[72:75], v9 offset:18432
    ds_read_b128 v[76:79], v9 offset:38912
    s_waitcnt lgkmcnt(6)
    v_mfma_f32_16x16x32_bf16 v[88:91], a[60:63], v[80:83], v[88:91]
    v_mfma_f32_16x16x32_bf16 v[92:95], a[140:143], v[80:83], v[92:95]
    v_mfma_f32_16x16x32_bf16 v[96:99], a[220:223], v[80:83], v[96:99]
    v_mfma_f32_16x16x32_bf16 v[100:103], a[60:63], v[84:87], v[100:103]
    v_mfma_f32_16x16x32_bf16 v[104:107], a[140:143], v[84:87], v[104:107]
    v_mfma_f32_16x16x32_bf16 v[108:111], a[220:223], v[84:87], v[108:111]
    ds_read_b128 v[80:83], v9 offset:19456
    ds_read_b128 v[84:87], v9 offset:39936
    s_waitcnt lgkmcnt(6)
    v_mfma_f32_16x16x32_bf16 v[88:91], a[64:67], v[56:59], v[88:91]
    v_mfma_f32_16x16x32_bf16 v[92:95], a[144:147], v[56:59], v[92:95]
    v_mfma_f32_16x16x32_bf16 v[96:99], a[224:227], v[56:59], v[96:99]
    v_mfma_f32_16x16x32_bf16 v[100:103], a[64:67], v[60:63], v[100:103]
    v_mfma_f32_16x16x32_bf16 v[104:107], a[144:147], v[60:63], v[104:107]
    v_mfma_f32_16x16x32_bf16 v[108:111], a[224:227], v[60:63], v[108:111]
    s_waitcnt lgkmcnt(4)
    v_mfma_f32_16x16x32_bf16 v[88:91], a[68:71], v[64:67], v[88:91]
    v_mfma_f32_16x16x32_bf16 v[92:95], a[148:151], v[64:67], v[92:95]
    v_mfma_f32_16x16x32_bf16 v[96:99], a[228:231], v[64:67], v[96:99]
    v_mfma_f32_16x16x32_bf16 v[100:103], a[68:71], v[68:71], v[100:103]
    v_mfma_f32_16x16x32_bf16 v[104:107], a[148:151], v[68:71], v[104:107]
    v_mfma_f32_16x16x32_bf16 v[108:111], a[228:231], v[68:71], v[108:111]
    s_waitcnt lgkmcnt(2)
    v_mfma_f32_16x16x32_bf16 v[88:91], a[72:75], v[72:75], v[88:91]
    v_mfma_f32_16x16x32_bf16 v[92:95], a[152:155], v[72:75], v[92:95]
    v_mfma_f32_16x16x32_bf16 v[96:99], a[232:235], v[72:75], v[96:99]
    v_mfma_f32_16x16x32_bf16 v[100:103], a[72:75], v[76:79], v[100:103]
    v_mfma_f32_16x16x32_bf16 v[104:107], a[152:155], v[76:79], v[104:107]
    v_mfma_f32_16x16x32_bf16 v[108:111], a[232:235], v[76:79], v[108:111]
    s_waitcnt lgkmcnt(0)
    v_mfma_f32_16x16x32_bf16 v[88:91], a[76:79], v[80:83], v[88:91]
    v_mfma_f32_16x16x32_bf16 v[92:95], a[156:159], v[80:83], v[92:95]
    v_mfma_f32_16x16x32_bf16 v[96:99], a[236:239], v[80:83], v[96:99]
    v_mfma_f32_16x16x32_bf16 v[100:103], a[76:79], v[84:87], v[100:103]
    v_mfma_f32_16x16x32_bf16 v[104:107], a[156:159], v[84:87], v[104:107]
    v_mfma_f32_16x16x32_bf16 v[108:111], a[236:239], v[84:87], v[108:111]
    s_nop 2
    v_cvt_pk_bf16_f32 v112, v88, v89
    v_cvt_pk_bf16_f32 v113, v90, v91
    v_cvt_pk_bf16_f32 v114, v92, v93
    v_cvt_pk_bf16_f32 v115, v94, v95
    v_cvt_pk_bf16_f32 v116, v100, v101
    v_cvt_pk_bf16_f32 v117, v102, v103
    v_cvt_pk_bf16_f32 v118, v104, v105
    v_cvt_pk_bf16_f32 v119, v106, v107
    v_cvt_pk_bf16_f32 v120, v96, v97
    v_cvt_pk_bf16_f32 v121, v98, v99
    v_cvt_pk_bf16_f32 v122, v108, v109
    v_cvt_pk_bf16_f32 v123, v110, v111
    buffer_store_dwordx4 v[112:115], v11, s[8:11], s43 offen offset:0 sc1
    buffer_store_dwordx4 v[116:119], v11, s[8:11], s43 offen offset:1024 sc1
    buffer_store_dwordx4 v[120:123], v11, s[8:11], s43 offen offset:2048 sc1
    s_waitcnt vmcnt(3)
    ds_write_b128 v10, v[16:19] offset:0
    ds_write_b128 v10, v[20:23] offset:1024
    ds_write_b128 v10, v[24:27] offset:2048
    ds_write_b128 v10, v[28:31] offset:3072
    ds_write_b128 v10, v[32:35] offset:4096
    ds_write_b128 v10, v[36:39] offset:5120
    ds_write_b128 v10, v[40:43] offset:6144
    ds_write_b128 v10, v[44:47] offset:7168
    ds_write_b128 v10, v[48:51] offset:8192
    ds_write_b128 v10, v[52:55] offset:9216
    s_add_u32 s40, s40, 1
    s_add_u32 s43, s43, 393216
    s_waitcnt lgkmcnt(0)
    s_barrier
    s_cmp_lt_u32 s40, 64
    s_cbranch_scc1 chain2_kernel_p_seg
    s_waitcnt vmcnt(0)
    s_barrier
    s_cmp_eq_u32 s3, 0
    s_cbranch_scc0 chain2_kernel_fp10
    v_mov_b32 v15, s40
    buffer_store_dword v15, v14, s[8:11], 0 offen sc1
chain2_kernel_fp10:
    s_branch chain2_kernel_end
chain2_kernel_roleO:
    s_sub_u32 s44, s2, 200
    s_load_dwordx2 s[6:7], s[0:1], 64
    s_waitcnt lgkmcnt(0)
    s_mov_b32 s12, s6
    s_mov_b32 s13, s7
    s_mov_b32 s14, 7864320
    s_mov_b32 s15, 0x00020000
    v_add_u32 v8, 0, v0
    s_mov_b32 s24, 3277
    v_mul_lo_u32 v9, v8, s24
    v_lshrrev_b32 v9, 18, v9
    v_mul_u32_u24 v10, 80, v9
    v_sub_u32 v10, v8, v10
    v_mul_u32_u24 v16, 1312, v9
    v_lshl_add_u32 v16, v10, 4, v16
    v_add_u32 v8, 256, v0
    s_mov_b32 s24, 3277
    v_mul_lo_u32 v9, v8, s24
    v_lshrrev_b32 v9, 18, v9
    v_mul_u32_u24 v10, 80, v9
    v_sub_u32 v10, v8, v10
    v_mul_u32_u24 v17, 1312, v9
    v_lshl_add_u32 v17, v10, 4, v17
    v_add_u32 v8, 512, v0
    s_mov_b32 s24, 3277
    v_mul_lo_u32 v9, v8, s24
    v_lshrrev_b32 v9, 18, v9
    v_mul_u32_u24 v10, 80, v9
    v_sub_u32 v10, v8, v10
    v_mul_u32_u24 v18, 1312, v9
    v_lshl_add_u32 v18, v10, 4, v18
    v_add_u32 v8, 768, v0
    s_mov_b32 s24, 3277
    v_mul_lo_u32 v9, v8, s24
    v_lshrrev_b32 v9, 18, v9
    v_mul_u32_u24 v10, 80, v9
    v_sub_u32 v10, v8, v10
    v_mul_u32_u24 v19, 1312, v9
    v_lshl_add_u32 v19, v10, 4, v19
    v_add_u32 v8, 1024, v0
    s_mov_b32 s24, 3277
    v_mul_lo_u32 v9, v8, s24
    v_lshrrev_b32 v9, 18, v9
    v_mul_u32_u24 v10, 80, v9
    v_sub_u32 v10, v8, v10
    v_mul_u32_u24 v20, 1312, v9
    v_lshl_add_u32 v20, v10, 4, v20
    v_add_u32 v8, 1280, v0
    s_mov_b32 s24, 3277
    v_mul_lo_u32 v9, v8, s24
    v_lshrrev_b32 v9, 18, v9
    v_mul_u32_u24 v10, 80, v9
    v_sub_u32 v10, v8, v10
    v_mul_u32_u24 v21, 1312, v9
    v_lshl_add_u32 v21, v10, 4, v21
    v_add_u32 v8, 1536, v0
    s_mov_b32 s24, 3277
    v_mul_lo_u32 v9, v8, s24
    v_lshrrev_b32 v9, 18, v9
    v_mul_u32_u24 v10, 80, v9
    v_sub_u32 v10, v8, v10
    v_mul_u32_u24 v22, 1312, v9
    v_lshl_add_u32 v22, v10, 4, v22
    v_add_u32 v8, 1792, v0
    s_mov_b32 s24, 3277
    v_mul_lo_u32 v9, v8, s24
    v_lshrrev_b32 v9, 18, v9
    v_mul_u32_u24 v10, 80, v9
    v_sub_u32 v10, v8, v10
    v_mul_u32_u24 v23, 1312, v9
    v_lshl_add_u32 v23, v10, 4, v23
    v_add_u32 v8, 2048, v0
    s_mov_b32 s24, 3277
    v_mul_lo_u32 v9, v8, s24
    v_lshrrev_b32 v9, 18, v9
    v_mul_u32_u24 v10, 80, v9
    v_sub_u32 v10, v8, v10
    v_mul_u32_u24 v24, 1312, v9
    v_lshl_add_u32 v24, v10, 4, v24
    v_add_u32 v8, 2304, v0
    s_mov_b32 s24, 3277
    v_mul_lo_u32 v9, v8, s24
    v_lshrrev_b32 v9, 18, v9
    v_mul_u32_u24 v10, 80, v9
    v_sub_u32 v10, v8, v10
    v_mul_u32_u24 v25, 1312, v9
    v_lshl_add_u32 v25, v10, 4, v25
    v_add_u32 v8, 2560, v0
    s_mov_b32 s24, 3277
    v_mul_lo_u32 v9, v8, s24
    v_lshrrev_b32 v9, 18, v9
    v_mul_u32_u24 v10, 80, v9
    v_sub_u32 v10, v8, v10
    v_mul_u32_u24 v26, 1312, v9
    v_lshl_add_u32 v26, v10, 4, v26
    v_add_u32 v8, 2816, v0
    s_mov_b32 s24, 3277
    v_mul_lo_u32 v9, v8, s24
    v_lshrrev_b32 v9, 18, v9
    v_mul_u32_u24 v10, 80, v9
    v_sub_u32 v10, v8, v10
    v_mul_u32_u24 v27, 1312, v9
    v_lshl_add_u32 v27, v10, 4, v27
    v_add_u32 v8, 3072, v0
    s_mov_b32 s24, 3277
    v_mul_lo_u32 v9, v8, s24
    v_lshrrev_b32 v9, 18, v9
    v_mul_u32_u24 v10, 80, v9
    v_sub_u32 v10, v8, v10
    v_mul_u32_u24 v28, 1312, v9
    v_lshl_add_u32 v28, v10, 4, v28
    v_add_u32 v8, 3328, v0
    s_mov_b32 s24, 3277
    v_mul_lo_u32 v9, v8, s24
    v_lshrrev_b32 v9, 18, v9
    v_mul_u32_u24 v10, 80, v9
    v_sub_u32 v10, v8, v10
    v_mul_u32_u24 v29, 1312, v9
    v_lshl_add_u32 v29, v10, 4, v29
    v_add_u32 v8, 3584, v0
    s_mov_b32 s24, 3277
    v_mul_lo_u32 v9, v8, s24
    v_lshrrev_b32 v9, 18, v9
    v_mul_u32_u24 v10, 80, v9
    v_sub_u32 v10, v8, v10
    v_mul_u32_u24 v30, 1312, v9
    v_lshl_add_u32 v30, v10, 4, v30
    v_add_u32 v8, 3840, v0
    s_mov_b32 s24, 3277
    v_mul_lo_u32 v9, v8, s24
    v_lshrrev_b32 v9, 18, v9
    v_mul_u32_u24 v10, 80, v9
    v_sub_u32 v10, v8, v10
    v_mul_u32_u24 v31, 1312, v9
    v_lshl_add_u32 v31, v10, 4, v31
    v_add_u32 v8, 4096, v0
    s_mov_b32 s24, 3277
    v_mul_lo_u32 v9, v8, s24
    v_lshrrev_b32 v9, 18, v9
    v_mul_u32_u24 v10, 80, v9
    v_sub_u32 v10, v8, v10
    v_mul_u32_u24 v32, 1312, v9
    v_lshl_add_u32 v32, v10, 4, v32
    v_add_u32 v8, 4352, v0
    s_mov_b32 s24, 3277
    v_mul_lo_u32 v9, v8, s24
    v_lshrrev_b32 v9, 18, v9
    v_mul_u32_u24 v10, 80, v9
    v_sub_u32 v10, v8, v10
    v_mul_u32_u24 v33, 1312, v9
    v_lshl_add_u32 v33, v10, 4, v33
    v_add_u32 v8, 4608, v0
    s_mov_b32 s24, 3277
    v_mul_lo_u32 v9, v8, s24
    v_lshrrev_b32 v9, 18, v9
    v_mul_u32_u24 v10, 80, v9
    v_sub_u32 v10, v8, v10
    v_mul_u32_u24 v34, 1312, v9
    v_lshl_add_u32 v34, v10, 4, v34
    v_add_u32 v8, 4864, v0
    s_mov_b32 s24, 3277
    v_mul_lo_u32 v9, v8, s24
    v_lshrrev_b32 v9, 18, v9
    v_mul_u32_u24 v10, 80, v9
    v_sub_u32 v10, v8, v10
    v_mul_u32_u24 v35, 1312, v9
    v_lshl_add_u32 v35, v10, 4, v35
    v_add_u32 v8, 5120, v0
    s_mov_b32 s24, 3277
    v_mul_lo_u32 v9, v8, s24
    v_lshrrev_b32 v9, 18, v9
    v_mul_u32_u24 v10, 80, v9
    v_sub_u32 v10, v8, v10
    v_mul_u32_u24 v36, 1312, v9
    v_lshl_add_u32 v36, v10, 4, v36
    v_add_u32 v8, 5376, v0
    s_mov_b32 s24, 3277
    v_mul_lo_u32 v9, v8, s24
    v_lshrrev_b32 v9, 18, v9
    v_mul_u32_u24 v10, 80, v9
    v_sub_u32 v10, v8, v10
    v_mul_u32_u24 v37, 1312, v9
    v_lshl_add_u32 v37, v10, 4, v37
    v_add_u32 v8, 5632, v0
    s_mov_b32 s24, 3277
    v_mul_lo_u32 v9, v8, s24
    v_lshrrev_b32 v9, 18, v9
    v_mul_u32_u24 v10, 80, v9
    v_sub_u32 v10, v8, v10
    v_mul_u32_u24 v38, 1312, v9
    v_lshl_add_u32 v38, v10, 4, v38
    v_add_u32 v8, 5888, v0
    s_mov_b32 s24, 3277
    v_mul_lo_u32 v9, v8, s24
    v_lshrrev_b32 v9, 18, v9
    v_mul_u32_u24 v10, 80, v9
    v_sub_u32 v10, v8, v10
    v_mul_u32_u24 v39, 1312, v9
    v_lshl_add_u32 v39, v10, 4, v39
    v_add_u32 v8, 6144, v0
    s_mov_b32 s24, 3277
    v_mul_lo_u32 v9, v8, s24
    v_lshrrev_b32 v9, 18, v9
    v_mul_u32_u24 v10, 80, v9
    v_sub_u32 v10, v8, v10
    v_mul_u32_u24 v40, 1312, v9
    v_lshl_add_u32 v40, v10, 4, v40
    v_add_u32 v8, 6400, v0
    s_mov_b32 s24, 3277
    v_mul_lo_u32 v9, v8, s24
    v_lshrrev_b32 v9, 18, v9
    v_mul_u32_u24 v10, 80, v9
    v_sub_u32 v10, v8, v10
    v_mul_u32_u24 v41, 1312, v9
    v_lshl_add_u32 v41, v10, 4, v41
    v_add_u32 v8, 6656, v0
    s_mov_b32 s24, 3277
    v_mul_lo_u32 v9, v8, s24
    v_lshrrev_b32 v9, 18, v9
    v_mul_u32_u24 v10, 80, v9
    v_sub_u32 v10, v8, v10
    v_mul_u32_u24 v42, 1312, v9
    v_lshl_add_u32 v42, v10, 4, v42
    v_add_u32 v8, 6912, v0
    s_mov_b32 s24, 3277
    v_mul_lo_u32 v9, v8, s24
    v_lshrrev_b32 v9, 18, v9
    v_mul_u32_u24 v10, 80, v9
    v_sub_u32 v10, v8, v10
    v_mul_u32_u24 v43, 1312, v9
    v_lshl_add_u32 v43, v10, 4, v43
    v_add_u32 v8, 7168, v0
    s_mov_b32 s24, 3277
    v_mul_lo_u32 v9, v8, s24
    v_lshrrev_b32 v9, 18, v9
    v_mul_u32_u24 v10, 80, v9
    v_sub_u32 v10, v8, v10
    v_mul_u32_u24 v44, 1312, v9
    v_lshl_add_u32 v44, v10, 4, v44
    v_add_u32 v8, 7424, v0
    s_mov_b32 s24, 3277
    v_mul_lo_u32 v9, v8, s24
    v_lshrrev_b32 v9, 18, v9
    v_mul_u32_u24 v10, 80, v9
    v_sub_u32 v10, v8, v10
    v_mul_u32_u24 v45, 1312, v9
    v_lshl_add_u32 v45, v10, 4, v45
    v_lshlrev_b32 v4, 4, v0
    s_mul_i32 s45, s44, 245760
    s_add_u32 s46, s45, 0
    buffer_load_dwordx4 v[48:51], v4, s[12:15], s46 offen
    s_add_u32 s46, s45, 4096
    buffer_load_dwordx4 v[52:55], v4, s[12:15], s46 offen
    s_add_u32 s46, s45, 8192
    buffer_load_dwordx4 v[56:59], v4, s[12:15], s46 offen
    s_add_u32 s46, s45, 12288
    buffer_load_dwordx4 v[60:63], v4, s[12:15], s46 offen
    s_add_u32 s46, s45, 16384
    buffer_load_dwordx4 v[64:67], v4, s[12:15], s46 offen
    s_add_u32 s46, s45, 20480
    buffer_load_dwordx4 v[68:71], v4, s[12:15], s46 offen
    s_add_u32 s46, s45, 24576
    buffer_load_dwordx4 v[72:75], v4, s[12:15], s46 offen
    s_add_u32 s46, s45, 28672
    buffer_load_dwordx4 v[76:79], v4, s[12:15], s46 offen
    s_add_u32 s46, s45, 32768
    buffer_load_dwordx4 v[80:83], v4, s[12:15], s46 offen
    s_add_u32 s46, s45, 36864
    buffer_load_dwordx4 v[84:87], v4, s[12:15], s46 offen
    s_add_u32 s46, s45, 40960
    buffer_load_dwordx4 v[88:91], v4, s[12:15], s46 offen
    s_add_u32 s46, s45, 45056
    buffer_load_dwordx4 v[92:95], v4, s[12:15], s46 offen
    s_add_u32 s46, s45, 49152
    buffer_load_dwordx4 v[96:99], v4, s[12:15], s46 offen
    s_add_u32 s46, s45, 53248
    buffer_load_dwordx4 v[100:103], v4, s[12:15], s46 offen
    s_add_u32 s46, s45, 57344
    buffer_load_dwordx4 v[104:107], v4, s[12:15], s46 offen
    s_add_u32 s46, s45, 61440
    buffer_load_dwordx4 v[108:111], v4, s[12:15], s46 offen
    s_add_u32 s46, s45, 65536
    buffer_load_dwordx4 v[112:115], v4, s[12:15], s46 offen
    s_add_u32 s46, s45, 69632
    buffer_load_dwordx4 v[116:119], v4, s[12:15], s46 offen
    s_add_u32 s46, s45, 73728
    buffer_load_dwordx4 v[120:123], v4, s[12:15], s46 offen
    s_add_u32 s46, s45, 77824
    buffer_load_dwordx4 v[124:127], v4, s[12:15], s46 offen
    s_add_u32 s46, s45, 81920
    buffer_load_dwordx4 v[128:131], v4, s[12:15], s46 offen
    s_add_u32 s46, s45, 86016
    buffer_load_dwordx4 v[132:135], v4, s[12:15], s46 offen
    s_add_u32 s46, s45, 90112
    buffer_load_dwordx4 v[136:139], v4, s[12:15], s46 offen
    s_add_u32 s46, s45, 94208
    buffer_load_dwordx4 v[140:143], v4, s[12:15], s46 offen
    s_add_u32 s46, s45, 98304
    buffer_load_dwordx4 v[144:147], v4, s[12:15], s46 offen
    s_add_u32 s46, s45, 102400
    buffer_load_dwordx4 v[148:151], v4, s[12:15], s46 offen
    s_add_u32 s46, s45, 106496
    buffer_load_dwordx4 v[152:155], v4, s[12:15], s46 offen
    s_add_u32 s46, s45, 110592
    buffer_load_dwordx4 v[156:159], v4, s[12:15], s46 offen
    s_add_u32 s46, s45, 114688
    buffer_load_dwordx4 v[160:163], v4, s[12:15], s46 offen
    s_add_u32 s46, s45, 118784
    buffer_load_dwordx4 v[164:167], v4, s[12:15], s46 offen
    s_add_u32 s46, s45, 122880
    buffer_load_dwordx4 v[168:171], v4, s[12:15], s46 offen
    s_add_u32 s46, s45, 126976
    buffer_load_dwordx4 v[172:175], v4, s[12:15], s46 offen
    s_add_u32 s46, s45, 131072
    buffer_load_dwordx4 v[176:179], v4, s[12:15], s46 offen
    s_add_u32 s46, s45, 135168
    buffer_load_dwordx4 v[180:183], v4, s[12:15], s46 offen
    s_add_u32 s46, s45, 139264
    buffer_load_dwordx4 v[184:187], v4, s[12:15], s46 offen
    s_add_u32 s46, s45, 143360
    buffer_load_dwordx4 v[188:191], v4, s[12:15], s46 offen
    s_add_u32 s46, s45, 147456
    buffer_load_dwordx4 v[192:195], v4, s[12:15], s46 offen
    s_add_u32 s46, s45, 151552
    buffer_load_dwordx4 v[196:199], v4, s[12:15], s46 offen
    s_add_u32 s46, s45, 155648
    buffer_load_dwordx4 v[200:203], v4, s[12:15], s46 offen
    s_add_u32 s46, s45, 159744
    buffer_load_dwordx4 v[204:207], v4, s[12:15], s46 offen
    s_add_u32 s46, s45, 163840
    buffer_load_dwordx4 v[208:211], v4, s[12:15], s46 offen
    s_add_u32 s46, s45, 167936
    buffer_load_dwordx4 v[212:215], v4, s[12:15], s46 offen
    s_add_u32 s46, s45, 172032
    buffer_load_dwordx4 v[216:219], v4, s[12:15], s46 offen
    s_add_u32 s46, s45, 176128
    buffer_load_dwordx4 v[220:223], v4, s[12:15], s46 offen
    s_add_u32 s46, s45, 180224
    buffer_load_dwordx4 v[224:227], v4, s[12:15], s46 offen
    s_add_u32 s46, s45, 184320
    buffer_load_dwordx4 v[228:231], v4, s[12:15], s46 offen
    s_add_u32 s46, s45, 188416
    buffer_load_dwordx4 v[232:235], v4, s[12:15], s46 offen
    s_add_u32 s46, s45, 192512
    buffer_load_dwordx4 v[236:239], v4, s[12:15], s46 offen
    s_add_u32 s46, s45, 196608
    buffer_load_dwordx4 v[240:243], v4, s[12:15], s46 offen
    s_add_u32 s46, s45, 200704
    buffer_load_dwordx4 v[244:247], v4, s[12:15], s46 offen
    s_add_u32 s46, s45, 204800
    buffer_load_dwordx4 v[248:251], v4, s[12:15], s46 offen
    s_add_u32 s46, s45, 208896
    buffer_load_dwordx4 v[252:255], v4, s[12:15], s46 offen
    v_lshrrev_b32 v8, 2, v2
    v_lshl_add_u32 v8, v3, 2, v8
    v_mul_u32_u24 v5, 1312, v8
    v_and_b32 v8, 3, v2
    v_lshl_add_u32 v5, v8, 3, v5
    s_mul_i32 s24, s3, 320
    v_add_u32 v5, s24, v5
    v_add_u32 v6, 62976, v5
    s_waitcnt vmcnt(22)
    ds_write_b128 v16, v[48:51]
    ds_write_b128 v17, v[52:55]
    ds_write_b128 v18, v[56:59]
    ds_write_b128 v19, v[60:63]
    ds_write_b128 v20, v[64:67]
    ds_write_b128 v21, v[68:71]
    ds_write_b128 v22, v[72:75]
    ds_write_b128 v23, v[76:79]
    ds_write_b128 v24, v[80:83]
    ds_write_b128 v25, v[84:87]
    ds_write_b128 v26, v[88:91]
    ds_write_b128 v27, v[92:95]
    ds_write_b128 v28, v[96:99]
    ds_write_b128 v29, v[100:103]
    ds_write_b128 v30, v[104:107]
    ds_write_b128 v31, v[108:111]
    ds_write_b128 v32, v[112:115]
    ds_write_b128 v33, v[116:119]
    ds_write_b128 v34, v[120:123]
    ds_write_b128 v35, v[124:127]
    ds_write_b128 v36, v[128:131]
    ds_write_b128 v37, v[132:135]
    ds_write_b128 v38, v[136:139]
    ds_write_b128 v39, v[140:143]
    ds_write_b128 v40, v[144:147]
    ds_write_b128 v41, v[148:151]
    ds_write_b128 v42, v[152:155]
    ds_write_b128 v43, v[156:159]
    ds_write_b128 v44, v[160:163]
    ds_write_b128 v45, v[164:167]
    s_waitcnt lgkmcnt(0)
    s_add_u32 s46, s45, 212992
    buffer_load_dwordx4 v[48:51], v4, s[12:15], s46 offen
    s_add_u32 s46, s45, 217088
    buffer_load_dwordx4 v[52:55], v4, s[12:15], s46 offen
    s_add_u32 s46, s45, 221184
    buffer_load_dwordx4 v[56:59], v4, s[12:15], s46 offen
    s_add_u32 s46, s45, 225280
    buffer_load_dwordx4 v[60:63], v4, s[12:15], s46 offen
    s_add_u32 s46, s45, 229376
    buffer_load_dwordx4 v[64:67], v4, s[12:15], s46 offen
    s_add_u32 s46, s45, 233472
    buffer_load_dwordx4 v[68:71], v4, s[12:15], s46 offen
    s_add_u32 s46, s45, 237568
    buffer_load_dwordx4 v[72:75], v4, s[12:15], s46 offen
    s_add_u32 s46, s45, 241664
    buffer_load_dwordx4 v[76:79], v4, s[12:15], s46 offen
    s_barrier
    ds_read_b64_tr_b16 a[0:1], v5 offset:0
    ds_read_b64_tr_b16 a[2:3], v5 offset:20992
    ds_read_b64_tr_b16 a[4:5], v6 offset:0
    ds_read_b64_tr_b16 a[6:7], v6 offset:20992
    ds_read_b64_tr_b16 a[16:17], v5 offset:41984
    ds_read_b64_tr_b16 a[18:19], v6 offset:41984
    ds_read_b64_tr_b16 a[24:25], v5 offset:32
    ds_read_b64_tr_b16 a[26:27], v5 offset:21024
    ds_read_b64_tr_b16 a[28:29], v6 offset:32
    ds_read_b64_tr_b16 a[30:31], v6 offset:21024
    ds_read_b64_tr_b16 a[40:41], v5 offset:42016
    ds_read_b64_tr_b16 a[42:43], v6 offset:42016
    ds_read_b64_tr_b16 a[48:49], v5 offset:64
    ds_read_b64_tr_b16 a[50:51], v5 offset:21056
    ds_read_b64_tr_b16 a[52:53], v6 offset:64
    ds_read_b64_tr_b16 a[54:55], v6 offset:21056
    ds_read_b64_tr_b16 a[64:65], v5 offset:42048
    ds_read_b64_tr_b16 a[66:67], v6 offset:42048
    ds_read_b64_tr_b16 a[72:73], v5 offset:96
    ds_read_b64_tr_b16 a[74:75], v5 offset:21088
    ds_read_b64_tr_b16 a[76:77], v6 offset:96
    ds_read_b64_tr_b16 a[78:79], v6 offset:21088
    ds_read_b64_tr_b16 a[88:89], v5 offset:42080
    ds_read_b64_tr_b16 a[90:91], v6 offset:42080
    ds_read_b64_tr_b16 a[96:97], v5 offset:128
    ds_read_b64_tr_b16 a[98:99], v5 offset:21120
    ds_read_b64_tr_b16 a[100:101], v6 offset:128
    ds_read_b64_tr_b16 a[102:103], v6 offset:21120
    ds_read_b64_tr_b16 a[112:113], v5 offset:42112
    ds_read_b64_tr_b16 a[114:115], v6 offset:42112
    ds_read_b64_tr_b16 a[120:121], v5 offset:160
    ds_read_b64_tr_b16 a[122:123], v5 offset:21152
    ds_read_b64_tr_b16 a[124:125], v6 offset:160
    ds_read_b64_tr_b16 a[126:127], v6 offset:21152
    ds_read_b64_tr_b16 a[136:137], v5 offset:42144
    ds_read_b64_tr_b16 a[138:139], v6 offset:42144
    ds_read_b64_tr_b16 a[144:145], v5 offset:192
    ds_read_b64_tr_b16 a[146:147], v5 offset:21184
    ds_read_b64_tr_b16 a[148:149], v6 offset:192
    ds_read_b64_tr_b16 a[150:151], v6 offset:21184
    ds_read_b64_tr_b16 a[160:161], v5 offset:42176
    ds_read_b64_tr_b16 a[162:163], v6 offset:42176
    ds_read_b64_tr_b16 a[168:169], v5 offset:224
    ds_read_b64_tr_b16 a[170:171], v5 offset:21216
    ds_read_b64_tr_b16 a[172:173], v6 offset:224
    ds_read_b64_tr_b16 a[174:175], v6 offset:21216
    ds_read_b64_tr_b16 a[184:185], v5 offset:42208
    ds_read_b64_tr_b16 a[186:187], v6 offset:42208
    ds_read_b64_tr_b16 a[192:193], v5 offset:256
    ds_read_b64_tr_b16 a[194:195], v5 offset:21248
    ds_read_b64_tr_b16 a[196:197], v6 offset:256
    ds_read_b64_tr_b16 a[198:199], v6 offset:21248
    ds_read_b64_tr_b16 a[208:209], v5 offset:42240
    ds_read_b64_tr_b16 a[210:211], v6 offset:42240
    ds_read_b64_tr_b16 a[216:217], v5 offset:288
    ds_read_b64_tr_b16 a[218:219], v5 offset:21280
    ds_read_b64_tr_b16 a[220:221], v6 offset:288
    ds_read_b64_tr_b16 a[222:223], v6 offset:21280
    ds_read_b64_tr_b16 a[232:233], v5 offset:42272
    ds_read_b64_tr_b16 a[234:235], v6 offset:42272
    s_waitcnt lgkmcnt(0)
    s_barrier
    s_waitcnt vmcnt(0)
    ds_write_b128 v16, v[168:171]
    ds_write_b128 v17, v[172:175]
    ds_write_b128 v18, v[176:179]
    ds_write_b128 v19, v[180:183]
    ds_write_b128 v20, v[184:187]
    ds_write_b128 v21, v[188:191]
    ds_write_b128 v22, v[192:195]
    ds_write_b128 v23, v[196:199]
    ds_write_b128 v24, v[200:203]
    ds_write_b128 v25, v[204:207]
    ds_write_b128 v26, v[208:211]
    ds_write_b128 v27, v[212:215]
    ds_write_b128 v28, v[216:219]
    ds_write_b128 v29, v[220:223]
    ds_write_b128 v30, v[224:227]
    ds_write_b128 v31, v[228:231]
    ds_write_b128 v32, v[232:235]
    ds_write_b128 v33, v[236:239]
    ds_write_b128 v34, v[240:243]
    ds_write_b128 v35, v[244:247]
    ds_write_b128 v36, v[248:251]
    ds_write_b128 v37, v[252:255]
    ds_write_b128 v38, v[48:51]
    ds_write_b128 v39, v[52:55]
    ds_write_b128 v40, v[56:59]
    ds_write_b128 v41, v[60:63]
    ds_write_b128 v42, v[64:67]
    ds_write_b128 v43, v[68:71]
    ds_write_b128 v44, v[72:75]
    ds_write_b128 v45, v[76:79]
    s_waitcnt lgkmcnt(0)
    s_barrier
    ds_read_b64_tr_b16 a[8:9], v5 offset:0
    ds_read_b64_tr_b16 a[10:11], v5 offset:20992
    ds_read_b64_tr_b16 a[12:13], v6 offset:0
    ds_read_b64_tr_b16 a[14:15], v6 offset:20992
    ds_read_b64_tr_b16 a[20:21], v5 offset:41984
    ds_read_b64_tr_b16 a[22:23], v6 offset:41984
    ds_read_b64_tr_b16 a[32:33], v5 offset:32
    ds_read_b64_tr_b16 a[34:35], v5 offset:21024
    ds_read_b64_tr_b16 a[36:37], v6 offset:32
    ds_read_b64_tr_b16 a[38:39], v6 offset:21024
    ds_read_b64_tr_b16 a[44:45], v5 offset:42016
    ds_read_b64_tr_b16 a[46:47], v6 offset:42016
    ds_read_b64_tr_b16 a[56:57], v5 offset:64
    ds_read_b64_tr_b16 a[58:59], v5 offset:21056
    ds_read_b64_tr_b16 a[60:61], v6 offset:64
    ds_read_b64_tr_b16 a[62:63], v6 offset:21056
    ds_read_b64_tr_b16 a[68:69], v5 offset:42048
    ds_read_b64_tr_b16 a[70:71], v6 offset:42048
    ds_read_b64_tr_b16 a[80:81], v5 offset:96
    ds_read_b64_tr_b16 a[82:83], v5 offset:21088
    ds_read_b64_tr_b16 a[84:85], v6 offset:96
    ds_read_b64_tr_b16 a[86:87], v6 offset:21088
    ds_read_b64_tr_b16 a[92:93], v5 offset:42080
    ds_read_b64_tr_b16 a[94:95], v6 offset:42080
    ds_read_b64_tr_b16 a[104:105], v5 offset:128
    ds_read_b64_tr_b16 a[106:107], v5 offset:21120
    ds_read_b64_tr_b16 a[108:109], v6 offset:128
    ds_read_b64_tr_b16 a[110:111], v6 offset:21120
    ds_read_b64_tr_b16 a[116:117], v5 offset:42112
    ds_read_b64_tr_b16 a[118:119], v6 offset:42112
    ds_read_b64_tr_b16 a[128:129], v5 offset:160
    ds_read_b64_tr_b16 a[130:131], v5 offset:21152
    ds_read_b64_tr_b16 a[132:133], v6 offset:160
    ds_read_b64_tr_b16 a[134:135], v6 offset:21152
    ds_read_b64_tr_b16 a[140:141], v5 offset:42144
    ds_read_b64_tr_b16 a[142:143], v6 offset:42144
    ds_read_b64_tr_b16 a[152:153], v5 offset:192
    ds_read_b64_tr_b16 a[154:155], v5 offset:21184
    ds_read_b64_tr_b16 a[156:157], v6 offset:192
    ds_read_b64_tr_b16 a[158:159], v6 offset:21184
    ds_read_b64_tr_b16 a[164:165], v5 offset:42176
    ds_read_b64_tr_b16 a[166:167], v6 offset:42176
    ds_read_b64_tr_b16 a[176:177], v5 offset:224
    ds_read_b64_tr_b16 a[178:179], v5 offset:21216
    ds_read_b64_tr_b16 a[180:181], v6 offset:224
    ds_read_b64_tr_b16 a[182:183], v6 offset:21216
    ds_read_b64_tr_b16 a[188:189], v5 offset:42208
    ds_read_b64_tr_b16 a[190:191], v6 offset:42208
    ds_read_b64_tr_b16 a[200:201], v5 offset:256
    ds_read_b64_tr_b16 a[202:203], v5 offset:21248
    ds_read_b64_tr_b16 a[204:205], v6 offset:256
    ds_read_b64_tr_b16 a[206:207], v6 offset:21248
    ds_read_b64_tr_b16 a[212:213], v5 offset:42240
    ds_read_b64_tr_b16 a[214:215], v6 offset:42240
    ds_read_b64_tr_b16 a[224:225], v5 offset:288
    ds_read_b64_tr_b16 a[226:227], v5 offset:21280
    ds_read_b64_tr_b16 a[228:229], v6 offset:288
    ds_read_b64_tr_b16 a[230:231], v6 offset:21280
    ds_read_b64_tr_b16 a[236:237], v5 offset:42272
    ds_read_b64_tr_b16 a[238:239], v6 offset:42272
    s_waitcnt lgkmcnt(0)
    s_barrier
    v_lshlrev_b32 v5, 4, v1
    s_mul_i32 s24, s44, 12288
    v_add_u32 v6, s24, v5
    v_add_u32 v7, 4096, v6
    v_add_u32 v8, 8192, v6
    s_mul_i32 s24, s3, 327680
    s_lshl_b32 s25, s44, 10
    s_add_u32 s24, s24, s25
    v_add_u32 v9, s24, v5
    s_mov_b32 s24, 12288
    s_lshl_b32 s25, s44, 7
    s_add_u32 s24, s24, s25
    s_add_u32 s24, s24, 151560192
    v_mov_b32 v14, s24
    v_mov_b32 v15, 2146435072
    v_cmp_eq_u32 vcc, 0, v1
    s_nop 1
    v_cndmask_b32 v14, v15, v14, vcc
    s_lshl_b32 s24, s44, 7
    s_add_u32 s24, s24, 151568384
    v_mov_b32 v10, s24
    s_mov_b32 s41, 33554432
    s_mov_b32 s43, 184549376
    s_mov_b32 s40, 0
    s_mov_b32 s62, -1
    s_mov_b32 s63, 1
    s_cmp_ge_i32 s62, s63
    s_cbranch_scc1 chain2_kernel_o_en0_ok
    s_mov_b32 s61, 0
chain2_kernel_o_en0:
    buffer_load_dword v11, v10, s[8:11], 0 offen sc1
    s_waitcnt vmcnt(0)
    v_readlane_b32 s62, v11, 0
    s_cmp_ge_i32 s62, s63
    s_cbranch_scc1 chain2_kernel_o_en0_ok
    s_add_u32 s61, s61, 1
    s_cmp_ge_u32 s61, s60
    s_cbranch_scc1 chain2_kernel_o_en0_to
    s_sleep 2
    s_branch chain2_kernel_o_en0
chain2_kernel_o_en0_to:
    s_mov_b32 s60, 1
chain2_kernel_o_en0_ok:
    buffer_load_dwordx4 v[16:19], v6, s[8:11], s41 offen offset:0 sc1
    buffer_load_dwordx4 v[20:23], v6, s[8:11], s41 offen offset:1024 sc1
    buffer_load_dwordx4 v[24:27], v6, s[8:11], s41 offen offset:2048 sc1
    buffer_load_dwordx4 v[28:31], v6, s[8:11], s41 offen offset:3072 sc1
    buffer_load_dwordx4 v[32:35], v7, s[8:11], s41 offen offset:0 sc1
    buffer_load_dwordx4 v[36:39], v7, s[8:11], s41 offen offset:1024 sc1
    buffer_load_dwordx4 v[40:43], v7, s[8:11], s41 offen offset:2048 sc1
    buffer_load_dwordx4 v[44:47], v7, s[8:11], s41 offen offset:3072 sc1
    buffer_load_dwordx4 v[48:51], v8, s[8:11], s41 offen offset:0 sc1
    buffer_load_dwordx4 v[52:55], v8, s[8:11], s41 offen offset:1024 sc1
    buffer_load_dwordx4 v[56:59], v8, s[8:11], s41 offen offset:2048 sc1
    buffer_load_dwordx4 v[60:63], v8, s[8:11], s41 offen offset:3072 sc1
    s_add_u32 s41, s41, 393216
    s_waitcnt vmcnt(0)
chain2_kernel_o_seg:
    v_swap_b32 v26, v36
    v_swap_b32 v27, v37
    v_swap_b32 v50, v60
    v_swap_b32 v51, v61
    v_mfma_f32_16x16x32_bf16 v[112:115], v[16:19], a[0:3], 0
    v_mfma_f32_16x16x32_bf16 v[116:119], v[20:23], a[0:3], 0
    v_mfma_f32_16x16x32_bf16 v[120:123], v[16:19], a[24:27], 0
    v_mfma_f32_16x16x32_bf16 v[124:127], v[20:23], a[24:27], 0
    v_mfma_f32_16x16x32_bf16 v[128:131], v[16:19], a[48:51], 0
    v_mfma_f32_16x16x32_bf16 v[132:135], v[20:23], a[48:51], 0
    v_mfma_f32_16x16x32_bf16 v[136:139], v[16:19], a[72:75], 0
    v_mfma_f32_16x16x32_bf16 v[140:143], v[20:23], a[72:75], 0
    v_mfma_f32_16x16x32_bf16 v[144:147], v[16:19], a[96:99], 0
    v_mfma_f32_16x16x32_bf16 v[148:151], v[20:23], a[96:99], 0
    v_mfma_f32_16x16x32_bf16 v[152:155], v[16:19], a[120:123], 0
    v_mfma_f32_16x16x32_bf16 v[156:159], v[20:23], a[120:123], 0
    v_mfma_f32_16x16x32_bf16 v[160:163], v[16:19], a[144:147], 0
    v_mfma_f32_16x16x32_bf16 v[164:167], v[20:23], a[144:147], 0
    v_mfma_f32_16x16x32_bf16 v[168:171], v[16:19], a[168:171], 0
    v_mfma_f32_16x16x32_bf16 v[172:175], v[20:23], a[168:171], 0
    v_mfma_f32_16x16x32_bf16 v[176:179], v[16:19], a[192:195], 0
    v_mfma_f32_16x16x32_bf16 v[180:183], v[20:23], a[192:195], 0
    v_mfma_f32_16x16x32_bf16 v[184:187], v[16:19], a[216:219], 0
    v_mfma_f32_16x16x32_bf16 v[188:191], v[20:23], a[216:219], 0
    v_mfma_f32_16x16x32_bf16 v[112:115], v[28:31], a[4:7], v[112:115]
    v_mfma_f32_16x16x32_bf16 v[116:119], v[32:35], a[4:7], v[116:119]
    v_mfma_f32_16x16x32_bf16 v[120:123], v[28:31], a[28:31], v[120:123]
    v_mfma_f32_16x16x32_bf16 v[124:127], v[32:35], a[28:31], v[124:127]
    v_mfma_f32_16x16x32_bf16 v[128:131], v[28:31], a[52:55], v[128:131]
    v_mfma_f32_16x16x32_bf16 v[132:135], v[32:35], a[52:55], v[132:135]
    v_mfma_f32_16x16x32_bf16 v[136:139], v[28:31], a[76:79], v[136:139]
    v_mfma_f32_16x16x32_bf16 v[140:143], v[32:35], a[76:79], v[140:143]
    v_mfma_f32_16x16x32_bf16 v[144:147], v[28:31], a[100:103], v[144:147]
    v_mfma_f32_16x16x32_bf16 v[148:151], v[32:35], a[100:103], v[148:151]
    v_mfma_f32_16x16x32_bf16 v[152:155], v[28:31], a[124:127], v[152:155]
    v_mfma_f32_16x16x32_bf16 v[156:159], v[32:35], a[124:127], v[156:159]
    v_mfma_f32_16x16x32_bf16 v[160:163], v[28:31], a[148:151], v[160:163]
    v_mfma_f32_16x16x32_bf16 v[164:167], v[32:35], a[148:151], v[164:167]
    v_mfma_f32_16x16x32_bf16 v[168:171], v[28:31], a[172:175], v[168:171]
    v_mfma_f32_16x16x32_bf16 v[172:175], v[32:35], a[172:175], v[172:175]
    v_mfma_f32_16x16x32_bf16 v[176:179], v[28:31], a[196:199], v[176:179]
    v_mfma_f32_16x16x32_bf16 v[180:183], v[32:35], a[196:199], v[180:183]
    v_mfma_f32_16x16x32_bf16 v[184:187], v[28:31], a[220:223], v[184:187]
    v_mfma_f32_16x16x32_bf16 v[188:191], v[32:35], a[220:223], v[188:191]
    v_mfma_f32_16x16x32_bf16 v[112:115], v[40:43], a[8:11], v[112:115]
    v_mfma_f32_16x16x32_bf16 v[116:119], v[44:47], a[8:11], v[116:119]
    v_mfma_f32_16x16x32_bf16 v[120:123], v[40:43], a[32:35], v[120:123]
    v_mfma_f32_16x16x32_bf16 v[124:127], v[44:47], a[32:35], v[124:127]
    v_mfma_f32_16x16x32_bf16 v[128:131], v[40:43], a[56:59], v[128:131]
    v_mfma_f32_16x16x32_bf16 v[132:135], v[44:47], a[56:59], v[132:135]
    v_mfma_f32_16x16x32_bf16 v[136:139], v[40:43], a[80:83], v[136:139]
    v_mfma_f32_16x16x32_bf16 v[140:143], v[44:47], a[80:83], v[140:143]
    v_mfma_f32_16x16x32_bf16 v[144:147], v[40:43], a[104:107], v[144:147]
    v_mfma_f32_16x16x32_bf16 v[148:151], v[44:47], a[104:107], v[148:151]
    v_mfma_f32_16x16x32_bf16 v[152:155], v[40:43], a[128:131], v[152:155]
    v_mfma_f32_16x16x32_bf16 v[156:159], v[44:47], a[128:131], v[156:159]
    v_mfma_f32_16x16x32_bf16 v[160:163], v[40:43], a[152:155], v[160:163]
    v_mfma_f32_16x16x32_bf16 v[164:167], v[44:47], a[152:155], v[164:167]
    v_mfma_f32_16x16x32_bf16 v[168:171], v[40:43], a[176:179], v[168:171]
    v_mfma_f32_16x16x32_bf16 v[172:175], v[44:47], a[176:179], v[172:175]
    v_mfma_f32_16x16x32_bf16 v[176:179], v[40:43], a[200:203], v[176:179]
    v_mfma_f32_16x16x32_bf16 v[180:183], v[44:47], a[200:203], v[180:183]
    v_mfma_f32_16x16x32_bf16 v[184:187], v[40:43], a[224:227], v[184:187]
    v_mfma_f32_16x16x32_bf16 v[188:191], v[44:47], a[224:227], v[188:191]
    s_waitcnt vmcnt(0)
    s_barrier
    s_cmp_eq_u32 s3, 0
    s_cbranch_scc0 chain2_kernel_fp11
    v_mov_b32 v15, s40
    buffer_store_dword v15, v14, s[8:11], 0 offen sc1
chain2_kernel_fp11:
    s_add_u32 s63, s40, 2
    s_min_u32 s63, s63, 64
    s_cmp_ge_i32 s62, s63
    s_cbranch_scc1 chain2_kernel_o_en1_ok
    s_mov_b32 s61, 0
chain2_kernel_o_en1:
    buffer_load_dword v11, v10, s[8:11], 0 offen sc1
    s_waitcnt vmcnt(0)
    v_readlane_b32 s62, v11, 0
    s_cmp_ge_i32 s62, s63
    s_cbranch_scc1 chain2_kernel_o_en1_ok
    s_add_u32 s61, s61, 1
    s_cmp_ge_u32 s61, s60
    s_cbranch_scc1 chain2_kernel_o_en1_to
    s_sleep 2
    s_branch chain2_kernel_o_en1
chain2_kernel_o_en1_to:
    s_mov_b32 s60, 1
chain2_kernel_o_en1_ok:
    buffer_load_dwordx4 v[64:67], v6, s[8:11], s41 offen offset:0 sc1
    buffer_load_dwordx4 v[68:71], v6, s[8:11], s41 offen offset:1024 sc1
    buffer_load_dwordx4 v[72:75], v6, s[8:11], s41 offen offset:2048 sc1
    buffer_load_dwordx4 v[76:79], v6, s[8:11], s41 offen offset:3072 sc1
    buffer_load_dwordx4 v[80:83], v7, s[8:11], s41 offen offset:0 sc1
    buffer_load_dwordx4 v[84:87], v7, s[8:11], s41 offen offset:1024 sc1
    buffer_load_dwordx4 v[88:91], v7, s[8:11], s41 offen offset:2048 sc1
    buffer_load_dwordx4 v[92:95], v7, s[8:11], s41 offen offset:3072 sc1
    buffer_load_dwordx4 v[96:99], v8, s[8:11], s41 offen offset:0 sc1
    buffer_load_dwordx4 v[100:103], v8, s[8:11], s41 offen offset:1024 sc1
    buffer_load_dwordx4 v[104:107], v8, s[8:11], s41 offen offset:2048 sc1
    buffer_load_dwordx4 v[108:111], v8, s[8:11], s41 offen offset:3072 sc1
    s_add_u32 s41, s41, 393216
    v_mfma_f32_16x16x32_bf16 v[112:115], v[52:55], a[12:15], v[112:115]
    v_mfma_f32_16x16x32_bf16 v[116:119], v[56:59], a[12:15], v[116:119]
    v_mfma_f32_16x16x32_bf16 v[120:123], v[52:55], a[36:39], v[120:123]
    v_mfma_f32_16x16x32_bf16 v[124:127], v[56:59], a[36:39], v[124:127]
    v_mfma_f32_16x16x32_bf16 v[128:131], v[52:55], a[60:63], v[128:131]
    v_mfma_f32_16x16x32_bf16 v[132:135], v[56:59], a[60:63], v[132:135]
    v_mfma_f32_16x16x32_bf16 v[136:139], v[52:55], a[84:87], v[136:139]
    v_mfma_f32_16x16x32_bf16 v[140:143], v[56:59], a[84:87], v[140:143]
    v_mfma_f32_16x16x32_bf16 v[144:147], v[52:55], a[108:111], v[144:147]
    v_mfma_f32_16x16x32_bf16 v[148:151], v[56:59], a[108:111], v[148:151]
    v_mfma_f32_16x16x32_bf16 v[152:155], v[52:55], a[132:135], v[152:155]
    v_mfma_f32_16x16x32_bf16 v[156:159], v[56:59], a[132:135], v[156:159]
    v_mfma_f32_16x16x32_bf16 v[160:163], v[52:55], a[156:159], v[160:163]
    v_mfma_f32_16x16x32_bf16 v[164:167], v[56:59], a[156:159], v[164:167]
    v_mfma_f32_16x16x32_bf16 v[168:171], v[52:55], a[180:183], v[168:171]
    v_mfma_f32_16x16x32_bf16 v[172:175], v[56:59], a[180:183], v[172:175]
    v_mfma_f32_16x16x32_bf16 v[176:179], v[52:55], a[204:207], v[176:179]
    v_mfma_f32_16x16x32_bf16 v[180:183], v[56:59], a[204:207], v[180:183]
    v_mfma_f32_16x16x32_bf16 v[184:187], v[52:55], a[228:231], v[184:187]
    v_mfma_f32_16x16x32_bf16 v[188:191], v[56:59], a[228:231], v[188:191]
    v_mfma_f32_16x16x32_bf16 v[112:115], v[24:27], a[16:19], v[112:115]
    v_mfma_f32_16x16x32_bf16 v[116:119], v[36:39], a[16:19], v[116:119]
    v_mfma_f32_16x16x32_bf16 v[120:123], v[24:27], a[40:43], v[120:123]
    v_mfma_f32_16x16x32_bf16 v[124:127], v[36:39], a[40:43], v[124:127]
    v_mfma_f32_16x16x32_bf16 v[128:131], v[24:27], a[64:67], v[128:131]
    v_mfma_f32_16x16x32_bf16 v[132:135], v[36:39], a[64:67], v[132:135]
    v_mfma_f32_16x16x32_bf16 v[136:139], v[24:27], a[88:91], v[136:139]
    v_mfma_f32_16x16x32_bf16 v[140:143], v[36:39], a[88:91], v[140:143]
    v_mfma_f32_16x16x32_bf16 v[144:147], v[24:27], a[112:115], v[144:147]
    v_mfma_f32_16x16x32_bf16 v[148:151], v[36:39], a[112:115], v[148:151]
    v_mfma_f32_16x16x32_bf16 v[152:155], v[24:27], a[136:139], v[152:155]
    v_mfma_f32_16x16x32_bf16 v[156:159], v[36:39], a[136:139], v[156:159]
    v_mfma_f32_16x16x32_bf16 v[160:163], v[24:27], a[160:163], v[160:163]
    v_mfma_f32_16x16x32_bf16 v[164:167], v[36:39], a[160:163], v[164:167]
    v_mfma_f32_16x16x32_bf16 v[168:171], v[24:27], a[184:187], v[168:171]
    v_mfma_f32_16x16x32_bf16 v[172:175], v[36:39], a[184:187], v[172:175]
    v_mfma_f32_16x16x32_bf16 v[176:179], v[24:27], a[208:211], v[176:179]
    v_mfma_f32_16x16x32_bf16 v[180:183], v[36:39], a[208:211], v[180:183]
    v_mfma_f32_16x16x32_bf16 v[184:187], v[24:27], a[232:235], v[184:187]
    v_mfma_f32_16x16x32_bf16 v[188:191], v[36:39], a[232:235], v[188:191]
    v_mfma_f32_16x16x32_bf16 v[112:115], v[48:51], a[20:23], v[112:115]
    v_mfma_f32_16x16x32_bf16 v[116:119], v[60:63], a[20:23], v[116:119]
    v_mfma_f32_16x16x32_bf16 v[120:123], v[48:51], a[44:47], v[120:123]
    v_mfma_f32_16x16x32_bf16 v[124:127], v[60:63], a[44:47], v[124:127]
    v_mfma_f32_16x16x32_bf16 v[128:131], v[48:51], a[68:71], v[128:131]
    v_mfma_f32_16x16x32_bf16 v[132:135], v[60:63], a[68:71], v[132:135]
    v_mfma_f32_16x16x32_bf16 v[136:139], v[48:51], a[92:95], v[136:139]
    v_mfma_f32_16x16x32_bf16 v[140:143], v[60:63], a[92:95], v[140:143]
    v_mfma_f32_16x16x32_bf16 v[144:147], v[48:51], a[116:119], v[144:147]
    v_mfma_f32_16x16x32_bf16 v[148:151], v[60:63], a[116:119], v[148:151]
    v_mfma_f32_16x16x32_bf16 v[152:155], v[48:51], a[140:143], v[152:155]
    v_mfma_f32_16x16x32_bf16 v[156:159], v[60:63], a[140:143], v[156:159]
    v_mfma_f32_16x16x32_bf16 v[160:163], v[48:51], a[164:167], v[160:163]
    v_mfma_f32_16x16x32_bf16 v[164:167], v[60:63], a[164:167], v[164:167]
    v_mfma_f32_16x16x32_bf16 v[168:171], v[48:51], a[188:191], v[168:171]
    v_mfma_f32_16x16x32_bf16 v[172:175], v[60:63], a[188:191], v[172:175]
    v_mfma_f32_16x16x32_bf16 v[176:179], v[48:51], a[212:215], v[176:179]
    v_mfma_f32_16x16x32_bf16 v[180:183], v[60:63], a[212:215], v[180:183]
    v_mfma_f32_16x16x32_bf16 v[184:187], v[48:51], a[236:239], v[184:187]
    v_mfma_f32_16x16x32_bf16 v[188:191], v[60:63], a[236:239], v[188:191]
    s_mov_b32 s46, s43
    v_cvt_pk_bf16_f32 v192, v112, v113
    v_cvt_pk_bf16_f32 v193, v114, v115
    v_cvt_pk_bf16_f32 v194, v116, v117
    v_cvt_pk_bf16_f32 v195, v118, v119
    buffer_store_dwordx4 v[192:195], v9, s[8:11], s46 offen sc1
    s_add_u32 s46, s46, 32768
    v_cvt_pk_bf16_f32 v196, v120, v121
    v_cvt_pk_bf16_f32 v197, v122, v123
    v_cvt_pk_bf16_f32 v198, v124, v125
    v_cvt_pk_bf16_f32 v199, v126, v127
    buffer_store_dwordx4 v[196:199], v9, s[8:11], s46 offen sc1
    s_add_u32 s46, s46, 32768
    v_cvt_pk_bf16_f32 v200, v128, v129
    v_cvt_pk_bf16_f32 v201, v130, v131
    v_cvt_pk_bf16_f32 v202, v132, v133
    v_cvt_pk_bf16_f32 v203, v134, v135
    buffer_store_dwordx4 v[200:203], v9, s[8:11], s46 offen sc1
    s_add_u32 s46, s46, 32768
    v_cvt_pk_bf16_f32 v204, v136, v137
    v_cvt_pk_bf16_f32 v205, v138, v139
    v_cvt_pk_bf16_f32 v206, v140, v141
    v_cvt_pk_bf16_f32 v207, v142, v143
    buffer_store_dwordx4 v[204:207], v9, s[8:11], s46 offen sc1
    s_add_u32 s46, s46, 32768
    v_cvt_pk_bf16_f32 v208, v144, v145
    v_cvt_pk_bf16_f32 v209, v146, v147
    v_cvt_pk_bf16_f32 v210, v148, v149
    v_cvt_pk_bf16_f32 v211, v150, v151
    buffer_store_dwordx4 v[208:211], v9, s[8:11], s46 offen sc1
    s_add_u32 s46, s46, 32768
    v_cvt_pk_bf16_f32 v212, v152, v153
    v_cvt_pk_bf16_f32 v213, v154, v155
    v_cvt_pk_bf16_f32 v214, v156, v157
    v_cvt_pk_bf16_f32 v215, v158, v159
    buffer_store_dwordx4 v[212:215], v9, s[8:11], s46 offen sc1
    s_add_u32 s46, s46, 32768
    v_cvt_pk_bf16_f32 v216, v160, v161
    v_cvt_pk_bf16_f32 v217, v162, v163
    v_cvt_pk_bf16_f32 v218, v164, v165
    v_cvt_pk_bf16_f32 v219, v166, v167
    buffer_store_dwordx4 v[216:219], v9, s[8:11], s46 offen sc1
    s_add_u32 s46, s46, 32768
    v_cvt_pk_bf16_f32 v220, v168, v169
    v_cvt_pk_bf16_f32 v221, v170, v171
    v_cvt_pk_bf16_f32 v222, v172, v173
    v_cvt_pk_bf16_f32 v223, v174, v175
    buffer_store_dwordx4 v[220:223], v9, s[8:11], s46 offen sc1
    s_add_u32 s46, s46, 32768
    v_cvt_pk_bf16_f32 v224, v176, v177
    v_cvt_pk_bf16_f32 v225, v178, v179
    v_cvt_pk_bf16_f32 v226, v180, v181
    v_cvt_pk_bf16_f32 v227, v182, v183
    buffer_store_dwordx4 v[224:227], v9, s[8:11], s46 offen sc1
    s_add_u32 s46, s46, 32768
    v_cvt_pk_bf16_f32 v228, v184, v185
    v_cvt_pk_bf16_f32 v229, v186, v187
    v_cvt_pk_bf16_f32 v230, v188, v189
    v_cvt_pk_bf16_f32 v231, v190, v191
    buffer_store_dwordx4 v[228:231], v9, s[8:11], s46 offen sc1
    s_waitcnt vmcnt(10)
    s_add_u32 s40, s40, 1
    s_add_u32 s43, s43, 1310720
    v_swap_b32 v74, v84
    v_swap_b32 v75, v85
    v_swap_b32 v98, v108
    v_swap_b32 v99, v109
    v_mfma_f32_16x16x32_bf16 v[112:115], v[64:67], a[0:3], 0
    v_mfma_f32_16x16x32_bf16 v[116:119], v[68:71], a[0:3], 0
    v_mfma_f32_16x16x32_bf16 v[120:123], v[64:67], a[24:27], 0
    v_mfma_f32_16x16x32_bf16 v[124:127], v[68:71], a[24:27], 0
    v_mfma_f32_16x16x32_bf16 v[128:131], v[64:67], a[48:51], 0
    v_mfma_f32_16x16x32_bf16 v[132:135], v[68:71], a[48:51], 0
    v_mfma_f32_16x16x32_bf16 v[136:139], v[64:67], a[72:75], 0
    v_mfma_f32_16x16x32_bf16 v[140:143], v[68:71], a[72:75], 0
    v_mfma_f32_16x16x32_bf16 v[144:147], v[64:67], a[96:99], 0
    v_mfma_f32_16x16x32_bf16 v[148:151], v[68:71], a[96:99], 0
    v_mfma_f32_16x16x32_bf16 v[152:155], v[64:67], a[120:123], 0
    v_mfma_f32_16x16x32_bf16 v[156:159], v[68:71], a[120:123], 0
    v_mfma_f32_16x16x32_bf16 v[160:163], v[64:67], a[144:147], 0
    v_mfma_f32_16x16x32_bf16 v[164:167], v[68:71], a[144:147], 0
    v_mfma_f32_16x16x32_bf16 v[168:171], v[64:67], a[168:171], 0
    v_mfma_f32_16x16x32_bf16 v[172:175], v[68:71], a[168:171], 0
    v_mfma_f32_16x16x32_bf16 v[176:179], v[64:67], a[192:195], 0
    v_mfma_f32_16x16x32_bf16 v[180:183], v[68:71], a[192:195], 0
    v_mfma_f32_16x16x32_bf16 v[184:187], v[64:67], a[216:219], 0
    v_mfma_f32_16x16x32_bf16 v[188:191], v[68:71], a[216:219], 0
    v_mfma_f32_16x16x32_bf16 v[112:115], v[76:79], a[4:7], v[112:115]
    v_mfma_f32_16x16x32_bf16 v[116:119], v[80:83], a[4:7], v[116:119]
    v_mfma_f32_16x16x32_bf16 v[120:123], v[76:79], a[28:31], v[120:123]
    v_mfma_f32_16x16x32_bf16 v[124:127], v[80:83], a[28:31], v[124:127]
    v_mfma_f32_16x16x32_bf16 v[128:131], v[76:79], a[52:55], v[128:131]
    v_mfma_f32_16x16x32_bf16 v[132:135], v[80:83], a[52:55], v[132:135]
    v_mfma_f32_16x16x32_bf16 v[136:139], v[76:79], a[76:79], v[136:139]
    v_mfma_f32_16x16x32_bf16 v[140:143], v[80:83], a[76:79], v[140:143]
    v_mfma_f32_16x16x32_bf16 v[144:147], v[76:79], a[100:103], v[144:147]
    v_mfma_f32_16x16x32_bf16 v[148:151], v[80:83], a[100:103], v[148:151]
    v_mfma_f32_16x16x32_bf16 v[152:155], v[76:79], a[124:127], v[152:155]
    v_mfma_f32_16x16x32_bf16 v[156:159], v[80:83], a[124:127], v[156:159]
    v_mfma_f32_16x16x32_bf16 v[160:163], v[76:79], a[148:151], v[160:163]
    v_mfma_f32_16x16x32_bf16 v[164:167], v[80:83], a[148:151], v[164:167]
    v_mfma_f32_16x16x32_bf16 v[168:171], v[76:79], a[172:175], v[168:171]
    v_mfma_f32_16x16x32_bf16 v[172:175], v[80:83], a[172:175], v[172:175]
    v_mfma_f32_16x16x32_bf16 v[176:179], v[76:79], a[196:199], v[176:179]
    v_mfma_f32_16x16x32_bf16 v[180:183], v[80:83], a[196:199], v[180:183]
    v_mfma_f32_16x16x32_bf16 v[184:187], v[76:79], a[220:223], v[184:187]
    v_mfma_f32_16x16x32_bf16 v[188:191], v[80:83], a[220:223], v[188:191]
    v_mfma_f32_16x16x32_bf16 v[112:115], v[88:91], a[8:11], v[112:115]
    v_mfma_f32_16x16x32_bf16 v[116:119], v[92:95], a[8:11], v[116:119]
    v_mfma_f32_16x16x32_bf16 v[120:123], v[88:91], a[32:35], v[120:123]
    v_mfma_f32_16x16x32_bf16 v[124:127], v[92:95], a[32:35], v[124:127]
    v_mfma_f32_16x16x32_bf16 v[128:131], v[88:91], a[56:59], v[128:131]
    v_mfma_f32_16x16x32_bf16 v[132:135], v[92:95], a[56:59], v[132:135]
    v_mfma_f32_16x16x32_bf16 v[136:139], v[88:91], a[80:83], v[136:139]
    v_mfma_f32_16x16x32_bf16 v[140:143], v[92:95], a[80:83], v[140:143]
    v_mfma_f32_16x16x32_bf16 v[144:147], v[88:91], a[104:107], v[144:147]
    v_mfma_f32_16x16x32_bf16 v[148:151], v[92:95], a[104:107], v[148:151]
    v_mfma_f32_16x16x32_bf16 v[152:155], v[88:91], a[128:131], v[152:155]
    v_mfma_f32_16x16x32_bf16 v[156:159], v[92:95], a[128:131], v[156:159]
    v_mfma_f32_16x16x32_bf16 v[160:163], v[88:91], a[152:155], v[160:163]
    v_mfma_f32_16x16x32_bf16 v[164:167], v[92:95], a[152:155], v[164:167]
    v_mfma_f32_16x16x32_bf16 v[168:171], v[88:91], a[176:179], v[168:171]
    v_mfma_f32_16x16x32_bf16 v[172:175], v[92:95], a[176:179], v[172:175]
    v_mfma_f32_16x16x32_bf16 v[176:179], v[88:91], a[200:203], v[176:179]
    v_mfma_f32_16x16x32_bf16 v[180:183], v[92:95], a[200:203], v[180:183]
    v_mfma_f32_16x16x32_bf16 v[184:187], v[88:91], a[224:227], v[184:187]
    v_mfma_f32_16x16x32_bf16 v[188:191], v[92:95], a[224:227], v[188:191]
    s_waitcnt vmcnt(0)
    s_barrier
    s_cmp_eq_u32 s3, 0
    s_cbranch_scc0 chain2_kernel_fp12
    v_mov_b32 v15, s40
    buffer_store_dword v15, v14, s[8:11], 0 offen sc1
chain2_kernel_fp12:
    s_add_u32 s63, s40, 2
    s_min_u32 s63, s63, 64
    s_cmp_ge_i32 s62, s63
    s_cbranch_scc1 chain2_kernel_o_en2_ok
    s_mov_b32 s61, 0
chain2_kernel_o_en2:
    buffer_load_dword v11, v10, s[8:11], 0 offen sc1
    s_waitcnt vmcnt(0)
    v_readlane_b32 s62, v11, 0
    s_cmp_ge_i32 s62, s63
    s_cbranch_scc1 chain2_kernel_o_en2_ok
    s_add_u32 s61, s61, 1
    s_cmp_ge_u32 s61, s60
    s_cbranch_scc1 chain2_kernel_o_en2_to
    s_sleep 2
    s_branch chain2_kernel_o_en2
chain2_kernel_o_en2_to:
    s_mov_b32 s60, 1
chain2_kernel_o_en2_ok:
    buffer_load_dwordx4 v[16:19], v6, s[8:11], s41 offen offset:0 sc1
    buffer_load_dwordx4 v[20:23], v6, s[8:11], s41 offen offset:1024 sc1
    buffer_load_dwordx4 v[24:27], v6, s[8:11], s41 offen offset:2048 sc1
    buffer_load_dwordx4 v[28:31], v6, s[8:11], s41 offen offset:3072 sc1
    buffer_load_dwordx4 v[32:35], v7, s[8:11], s41 offen offset:0 sc1
    buffer_load_dwordx4 v[36:39], v7, s[8:11], s41 offen offset:1024 sc1
    buffer_load_dwordx4 v[40:43], v7, s[8:11], s41 offen offset:2048 sc1
    buffer_load_dwordx4 v[44:47], v7, s[8:11], s41 offen offset:3072 sc1
    buffer_load_dwordx4 v[48:51], v8, s[8:11], s41 offen offset:0 sc1
    buffer_load_dwordx4 v[52:55], v8, s[8:11], s41 offen offset:1024 sc1
    buffer_load_dwordx4 v[56:59], v8, s[8:11], s41 offen offset:2048 sc1
    buffer_load_dwordx4 v[60:63], v8, s[8:11], s41 offen offset:3072 sc1
    s_add_u32 s41, s41, 393216
    v_mfma_f32_16x16x32_bf16 v[112:115], v[100:103], a[12:15], v[112:115]
    v_mfma_f32_16x16x32_bf16 v[116:119], v[104:107], a[12:15], v[116:119]
    v_mfma_f32_16x16x32_bf16 v[120:123], v[100:103], a[36:39], v[120:123]
    v_mfma_f32_16x16x32_bf16 v[124:127], v[104:107], a[36:39], v[124:127]
    v_mfma_f32_16x16x32_bf16 v[128:131], v[100:103], a[60:63], v[128:131]
    v_mfma_f32_16x16x32_bf16 v[132:135], v[104:107], a[60:63], v[132:135]
    v_mfma_f32_16x16x32_bf16 v[136:139], v[100:103], a[84:87], v[136:139]
    v_mfma_f32_16x16x32_bf16 v[140:143], v[104:107], a[84:87], v[140:143]
    v_mfma_f32_16x16x32_bf16 v[144:147], v[100:103], a[108:111], v[144:147]
    v_mfma_f32_16x16x32_bf16 v[148:151], v[104:107], a[108:111], v[148:151]
    v_mfma_f32_16x16x32_bf16 v[152:155], v[100:103], a[132:135], v[152:155]
    v_mfma_f32_16x16x32_bf16 v[156:159], v[104:107], a[132:135], v[156:159]
    v_mfma_f32_16x16x32_bf16 v[160:163], v[100:103], a[156:159], v[160:163]
    v_mfma_f32_16x16x32_bf16 v[164:167], v[104:107], a[156:159], v[164:167]
    v_mfma_f32_16x16x32_bf16 v[168:171], v[100:103], a[180:183], v[168:171]
    v_mfma_f32_16x16x32_bf16 v[172:175], v[104:107], a[180:183], v[172:175]
    v_mfma_f32_16x16x32_bf16 v[176:179], v[100:103], a[204:207], v[176:179]
    v_mfma_f32_16x16x32_bf16 v[180:183], v[104:107], a[204:207], v[180:183]
    v_mfma_f32_16x16x32_bf16 v[184:187], v[100:103], a[228:231], v[184:187]
    v_mfma_f32_16x16x32_bf16 v[188:191], v[104:107], a[228:231], v[188:191]
    v_mfma_f32_16x16x32_bf16 v[112:115], v[72:75], a[16:19], v[112:115]
    v_mfma_f32_16x16x32_bf16 v[116:119], v[84:87], a[16:19], v[116:119]
    v_mfma_f32_16x16x32_bf16 v[120:123], v[72:75], a[40:43], v[120:123]
    v_mfma_f32_16x16x32_bf16 v[124:127], v[84:87], a[40:43], v[124:127]
    v_mfma_f32_16x16x32_bf16 v[128:131], v[72:75], a[64:67], v[128:131]
    v_mfma_f32_16x16x32_bf16 v[132:135], v[84:87], a[64:67], v[132:135]
    v_mfma_f32_16x16x32_bf16 v[136:139], v[72:75], a[88:91], v[136:139]
    v_mfma_f32_16x16x32_bf16 v[140:143], v[84:87], a[88:91], v[140:143]
    v_mfma_f32_16x16x32_bf16 v[144:147], v[72:75], a[112:115], v[144:147]
    v_mfma_f32_16x16x32_bf16 v[148:151], v[84:87], a[112:115], v[148:151]
    v_mfma_f32_16x16x32_bf16 v[152:155], v[72:75], a[136:139], v[152:155]
    v_mfma_f32_16x16x32_bf16 v[156:159], v[84:87], a[136:139], v[156:159]
    v_mfma_f32_16x16x32_bf16 v[160:163], v[72:75], a[160:163], v[160:163]
    v_mfma_f32_16x16x32_bf16 v[164:167], v[84:87], a[160:163], v[164:167]
    v_mfma_f32_16x16x32_bf16 v[168:171], v[72:75], a[184:187], v[168:171]
    v_mfma_f32_16x16x32_bf16 v[172:175], v[84:87], a[184:187], v[172:175]
    v_mfma_f32_16x16x32_bf16 v[176:179], v[72:75], a[208:211], v[176:179]
    v_mfma_f32_16x16x32_bf16 v[180:183], v[84:87], a[208:211], v[180:183]
    v_mfma_f32_16x16x32_bf16 v[184:187], v[72:75], a[232:235], v[184:187]
    v_mfma_f32_16x16x32_bf16 v[188:191], v[84:87], a[232:235], v[188:191]
    v_mfma_f32_16x16x32_bf16 v[112:115], v[96:99], a[20:23], v[112:115]
    v_mfma_f32_16x16x32_bf16 v[116:119], v[108:111], a[20:23], v[116:119]
    v_mfma_f32_16x16x32_bf16 v[120:123], v[96:99], a[44:47], v[120:123]
    v_mfma_f32_16x16x32_bf16 v[124:127], v[108:111], a[44:47], v[124:127]
    v_mfma_f32_16x16x32_bf16 v[128:131], v[96:99], a[68:71], v[128:131]
    v_mfma_f32_16x16x32_bf16 v[132:135], v[108:111], a[68:71], v[132:135]
    v_mfma_f32_16x16x32_bf16 v[136:139], v[96:99], a[92:95], v[136:139]
    v_mfma_f32_16x16x32_bf16 v[140:143], v[108:111], a[92:95], v[140:143]
    v_mfma_f32_16x16x32_bf16 v[144:147], v[96:99], a[116:119], v[144:147]
    v_mfma_f32_16x16x32_bf16 v[148:151], v[108:111], a[116:119], v[148:151]
    v_mfma_f32_16x16x32_bf16 v[152:155], v[96:99], a[140:143], v[152:155]
    v_mfma_f32_16x16x32_bf16 v[156:159], v[108:111], a[140:143], v[156:159]
    v_mfma_f32_16x16x32_bf16 v[160:163], v[96:99], a[164:167], v[160:163]
    v_mfma_f32_16x16x32_bf16 v[164:167], v[108:111], a[164:167], v[164:167]
    v_mfma_f32_16x16x32_bf16 v[168:171], v[96:99], a[188:191], v[168:171]
    v_mfma_f32_16x16x32_bf16 v[172:175], v[108:111], a[188:191], v[172:175]
    v_mfma_f32_16x16x32_bf16 v[176:179], v[96:99], a[212:215], v[176:179]
    v_mfma_f32_16x16x32_bf16 v[180:183], v[108:111], a[212:215], v[180:183]
    v_mfma_f32_16x16x32_bf16 v[184:187], v[96:99], a[236:239], v[184:187]
    v_mfma_f32_16x16x32_bf16 v[188:191], v[108:111], a[236:239], v[188:191]
    s_mov_b32 s46, s43
    v_cvt_pk_bf16_f32 v192, v112, v113
    v_cvt_pk_bf16_f32 v193, v114, v115
    v_cvt_pk_bf16_f32 v194, v116, v117
    v_cvt_pk_bf16_f32 v195, v118, v119
    buffer_store_dwordx4 v[192:195], v9, s[8:11], s46 offen sc1
    s_add_u32 s46, s46, 32768
    v_cvt_pk_bf16_f32 v196, v120, v121
    v_cvt_pk_bf16_f32 v197, v122, v123
    v_cvt_pk_bf16_f32 v198, v124, v125
    v_cvt_pk_bf16_f32 v199, v126, v127
    buffer_store_dwordx4 v[196:199], v9, s[8:11], s46 offen sc1
    s_add_u32 s46, s46, 32768
    v_cvt_pk_bf16_f32 v200, v128, v129
    v_cvt_pk_bf16_f32 v201, v130, v131
    v_cvt_pk_bf16_f32 v202, v132, v133
    v_cvt_pk_bf16_f32 v203, v134, v135
    buffer_store_dwordx4 v[200:203], v9, s[8:11], s46 offen sc1
    s_add_u32 s46, s46, 32768
    v_cvt_pk_bf16_f32 v204, v136, v137
    v_cvt_pk_bf16_f32 v205, v138, v139
    v_cvt_pk_bf16_f32 v206, v140, v141
    v_cvt_pk_bf16_f32 v207, v142, v143
    buffer_store_dwordx4 v[204:207], v9, s[8:11], s46 offen sc1
    s_add_u32 s46, s46, 32768
    v_cvt_pk_bf16_f32 v208, v144, v145
    v_cvt_pk_bf16_f32 v209, v146, v147
    v_cvt_pk_bf16_f32 v210, v148, v149
    v_cvt_pk_bf16_f32 v211, v150, v151
    buffer_store_dwordx4 v[208:211], v9, s[8:11], s46 offen sc1
    s_add_u32 s46, s46, 32768
    v_cvt_pk_bf16_f32 v212, v152, v153
    v_cvt_pk_bf16_f32 v213, v154, v155
    v_cvt_pk_bf16_f32 v214, v156, v157
    v_cvt_pk_bf16_f32 v215, v158, v159
    buffer_store_dwordx4 v[212:215], v9, s[8:11], s46 offen sc1
    s_add_u32 s46, s46, 32768
    v_cvt_pk_bf16_f32 v216, v160, v161
    v_cvt_pk_bf16_f32 v217, v162, v163
    v_cvt_pk_bf16_f32 v218, v164, v165
    v_cvt_pk_bf16_f32 v219, v166, v167
    buffer_store_dwordx4 v[216:219], v9, s[8:11], s46 offen sc1
    s_add_u32 s46, s46, 32768
    v_cvt_pk_bf16_f32 v220, v168, v169
    v_cvt_pk_bf16_f32 v221, v170, v171
    v_cvt_pk_bf16_f32 v222, v172, v173
    v_cvt_pk_bf16_f32 v223, v174, v175
    buffer_store_dwordx4 v[220:223], v9, s[8:11], s46 offen sc1
    s_add_u32 s46, s46, 32768
    v_cvt_pk_bf16_f32 v224, v176, v177
    v_cvt_pk_bf16_f32 v225, v178, v179
    v_cvt_pk_bf16_f32 v226, v180, v181
    v_cvt_pk_bf16_f32 v227, v182, v183
    buffer_store_dwordx4 v[224:227], v9, s[8:11], s46 offen sc1
    s_add_u32 s46, s46, 32768
    v_cvt_pk_bf16_f32 v228, v184, v185
    v_cvt_pk_bf16_f32 v229, v186, v187
    v_cvt_pk_bf16_f32 v230, v188, v189
    v_cvt_pk_bf16_f32 v231, v190, v191
    buffer_store_dwordx4 v[228:231], v9, s[8:11], s46 offen sc1
    s_waitcnt vmcnt(10)
    s_add_u32 s40, s40, 1
    s_add_u32 s43, s43, 1310720
    s_cmp_lt_u32 s40, 64
    s_cbranch_scc1 chain2_kernel_o_seg
    s_waitcnt vmcnt(0)
    s_barrier
    s_cmp_eq_u32 s3, 0
    s_cbranch_scc0 chain2_kernel_fp13
    v_mov_b32 v15, s40
    buffer_store_dword v15, v14, s[8:11], 0 offen sc1
chain2_kernel_fp13:
    s_branch chain2_kernel_end
chain2_kernel_end:
    s_endpgm
.section .rodata,"a"
.p2align 6
.amdhsa_kernel chain2_kernel
  .amdhsa_next_free_vgpr 512
  .amdhsa_next_free_sgpr 100
  .amdhsa_accum_offset 256
  .amdhsa_group_segment_fixed_size 0
  .amdhsa_kernarg_size 104
  .amdhsa_user_sgpr_count 2
  .amdhsa_user_sgpr_kernarg_segment_ptr 1
  .amdhsa_system_sgpr_workgroup_id_x 1
.end_amdhsa_kernel
```

```asm
; @launch kernel=pack_kernel grid=(864,1,1) block=(256,1,1) lds=0
; @launch kernel=ln_a1_kernel grid=(512,1,1) block=(256,1,1) lds=0
; @launch kernel=qkv_a_kernel grid=(192,1,1) block=(256,1,1) lds=0
; @launch kernel=kvz_a1_kernel grid=(128,1,1) block=(256,1,1) lds=0
; @launch kernel=attn_a1_kernel grid=(256,1,1) block=(256,1,1) lds=86016
; @launch kernel=wo_a1_kernel grid=(128,1,1) block=(256,1,1) lds=0
; @launch kernel=lnf_kernel grid=(128,1,1) block=(256,1,1) lds=512
; @launch kernel=clr_kernel grid=(1251,1,1) block=(256,1,1) lds=0
; @launch kernel=chain1_kernel grid=(232,1,1) block=(256,1,1) lds=135168
; @launch kernel=ln_a2_kernel grid=(512,1,1) block=(256,1,1) lds=0
; @launch kernel=qkv_a_kernel grid=(192,1,1) block=(256,1,1) lds=0
; @launch kernel=kvz_a2_kernel grid=(128,1,1) block=(256,1,1) lds=0
; @launch kernel=attn_a2_kernel grid=(256,1,1) block=(256,1,1) lds=86016
; @launch kernel=wo_a2_kernel grid=(128,1,1) block=(256,1,1) lds=0
; @launch kernel=lnf_kernel grid=(128,1,1) block=(256,1,1) lds=512
; @launch kernel=clr_kernel grid=(1251,1,1) block=(256,1,1) lds=0
; @launch kernel=chain2_kernel grid=(232,1,1) block=(256,1,1) lds=135168
.amdgcn_target "amdgcn-amd-amdhsa--gfx950"
.text
.globl pack_kernel
.p2align 8
.type pack_kernel,@function
pack_kernel:
    v_lshrrev_b32 v1, 6, v0
    v_and_b32 v2, 63, v0
    s_nop 0
    v_readfirstlane_b32 s3, v1
    s_lshl_b32 s4, s2, 2
    s_add_u32 s4, s4, s3
    s_load_dwordx2 s[6:7], s[0:1], 96
    s_waitcnt lgkmcnt(0)
    s_mov_b32 s8, s6
    s_mov_b32 s9, s7
    s_mov_b32 s10, 268435456
    s_mov_b32 s11, 0x00020000
    s_cmp_lt_u32 s4, 3200
    s_cbranch_scc1 pack_kernel_pk
    s_cmp_ge_u32 s4, 3456
    s_cbranch_scc1 pack_kernel_end
    s_sub_u32 s4, s4, 3200
    s_lshl_b32 s5, s4, 10
    v_lshlrev_b32 v3, 4, v2
    v_add_u32 v3, s5, v3
    v_add_u32 v4, 218103808, v3
    s_cmp_lt_u32 s5, 0
    s_cbranch_scc1 pack_kernel_clr
    v_add_u32 v4, 23068672, v3
pack_kernel_clr:
    v_mov_b32 v8, 0
    v_mov_b32 v9, 0
    v_mov_b32 v10, 0
    v_mov_b32 v11, 0
    buffer_store_dwordx4 v[8:11], v4, s[8:11], 0 offen
    s_branch pack_kernel_end
pack_kernel_pk:
    s_cmp_lt_u32 s4, 2400
    s_cbranch_scc0 pack_kernel_nx0
    s_sub_u32 s4, s4, 0
    s_load_dwordx2 s[12:13], s[0:1], 8
    s_mov_b32 s20, 1920
    s_mov_b32 s21, 20
    s_mov_b32 s22, 25165824
    s_mov_b32 s23, 2457600
    s_mul_i32 s24, s4, 1639
    s_lshr_b32 s24, s24, 15
    s_branch pack_kernel_go
pack_kernel_nx0:
    s_cmp_lt_u32 s4, 3200
    s_cbranch_scc0 pack_kernel_nx1
    s_sub_u32 s4, s4, 2400
    s_load_dwordx2 s[12:13], s[0:1], 16
    s_mov_b32 s20, 640
    s_mov_b32 s21, 20
    s_mov_b32 s22, 29360128
    s_mov_b32 s23, 819200
    s_mul_i32 s24, s4, 205
    s_lshr_b32 s24, s24, 12
    s_branch pack_kernel_go
pack_kernel_nx1:
    s_branch pack_kernel_end
pack_kernel_go:
    s_waitcnt lgkmcnt(0)
    s_mov_b32 s16, s12
    s_mov_b32 s17, s13
    s_mov_b32 s18, s23
    s_mov_b32 s19, 0x00020000
    s_mul_i32 s25, s24, s21
    s_sub_u32 s25, s4, s25
    v_lshrrev_b32 v3, 4, v2
    v_lshlrev_b32 v3, 3, v3
    s_lshl_b32 s26, s25, 5
    v_add_u32 v3, s26, v3
    v_mul_lo_u32 v3, v3, s20
    v_and_b32 v4, 15, v2
    s_lshl_b32 s27, s24, 4
    v_add3_u32 v3, v3, v4, s27
    v_lshlrev_b32 v3, 1, v3
    s_lshl_b32 s28, s20, 1
    s_mov_b32 s29, 0
    buffer_load_ushort v12, v3, s[16:19], s29 offen
    s_add_u32 s29, s29, s28
    buffer_load_ushort v13, v3, s[16:19], s29 offen
    s_add_u32 s29, s29, s28
    buffer_load_ushort v14, v3, s[16:19], s29 offen
    s_add_u32 s29, s29, s28
    buffer_load_ushort v15, v3, s[16:19], s29 offen
    s_add_u32 s29, s29, s28
    buffer_load_ushort v16, v3, s[16:19], s29 offen
    s_add_u32 s29, s29, s28
    buffer_load_ushort v17, v3, s[16:19], s29 offen
    s_add_u32 s29, s29, s28
    buffer_load_ushort v18, v3, s[16:19], s29 offen
    s_add_u32 s29, s29, s28
    buffer_load_ushort v19, v3, s[16:19], s29 offen
    s_lshl_b32 s5, s4, 10
    s_add_u32 s5, s5, s22
    v_lshlrev_b32 v5, 4, v2
    v_add_u32 v5, s5, v5
    s_waitcnt vmcnt(0)
    v_lshl_or_b32 v8, v13, 16, v12
    v_lshl_or_b32 v9, v15, 16, v14
    v_lshl_or_b32 v10, v17, 16, v16
    v_lshl_or_b32 v11, v19, 16, v18
    buffer_store_dwordx4 v[8:11], v5, s[8:11], 0 offen
pack_kernel_end:
    s_endpgm
.section .rodata,"a"
.p2align 6
.amdhsa_kernel pack_kernel
  .amdhsa_next_free_vgpr 24
  .amdhsa_next_free_sgpr 40
  .amdhsa_accum_offset 24
  .amdhsa_group_segment_fixed_size 0
  .amdhsa_kernarg_size 104
  .amdhsa_user_sgpr_count 2
  .amdhsa_user_sgpr_kernarg_segment_ptr 1
  .amdhsa_system_sgpr_workgroup_id_x 1
.end_amdhsa_kernel
.text
.globl ln_a1_kernel
.p2align 8
.type ln_a1_kernel,@function
ln_a1_kernel:
    v_lshrrev_b32 v1, 6, v0
    v_and_b32 v2, 63, v0
    s_nop 0
    v_readfirstlane_b32 s3, v1
    s_lshl_b32 s4, s2, 2
    s_add_u32 s4, s4, s3
    s_cmp_ge_u32 s4, 2048
    s_cbranch_scc1 ln_a1_kernel_end
    s_load_dwordx2 s[6:7], s[0:1], 0
    s_load_dwordx2 s[12:13], s[0:1], 96
    s_waitcnt lgkmcnt(0)
    s_mov_b32 s8, s6
    s_mov_b32 s9, s7
    s_mov_b32 s10, 2621440
    s_mov_b32 s11, 0x00020000
    s_mov_b32 s16, s12
    s_mov_b32 s17, s13
    s_mov_b32 s18, 2621440
    s_mov_b32 s19, 0x00020000
    s_mul_i32 s5, s4, 1280
    v_lshlrev_b32 v3, 2, v2
    v_add_u32 v3, s5, v3
    buffer_load_dword v4, v3, s[8:11], 0 offen offset:0
    buffer_load_dword v5, v3, s[8:11], 0 offen offset:256
    buffer_load_dword v6, v3, s[8:11], 0 offen offset:512
    buffer_load_dword v7, v3, s[8:11], 0 offen offset:768
    buffer_load_dword v8, v3, s[8:11], 0 offen offset:1024
    s_waitcnt vmcnt(0)
    v_lshlrev_b32 v10, 16, v4
    v_and_b32 v11, 0xffff0000, v4
    v_lshlrev_b32 v12, 16, v5
    v_and_b32 v13, 0xffff0000, v5
    v_lshlrev_b32 v14, 16, v6
    v_and_b32 v15, 0xffff0000, v6
    v_lshlrev_b32 v16, 16, v7
    v_and_b32 v17, 0xffff0000, v7
    v_lshlrev_b32 v18, 16, v8
    v_and_b32 v19, 0xffff0000, v8
    v_add_f32 v20, v10, v11
    v_add_f32 v20, v20, v12
    v_add_f32 v20, v20, v13
    v_add_f32 v20, v20, v14
    v_add_f32 v20, v20, v15
    v_add_f32 v20, v20, v16
    v_add_f32 v20, v20, v17
    v_add_f32 v20, v20, v18
    v_add_f32 v20, v20, v19
    s_nop 1
    v_add_f32 v21, v20, v20 quad_perm:[1,0,3,2] row_mask:0xf bank_mask:0xf
    s_nop 1
    v_add_f32 v21, v21, v21 quad_perm:[2,3,0,1] row_mask:0xf bank_mask:0xf
    s_nop 1
    v_add_f32 v21, v21, v21 row_half_mirror row_mask:0xf bank_mask:0xf
    s_nop 1
    v_add_f32 v21, v21, v21 row_mirror row_mask:0xf bank_mask:0xf
    s_nop 1
    v_readlane_b32 s24, v21, 0
    v_readlane_b32 s25, v21, 16
    v_readlane_b32 s26, v21, 32
    v_readlane_b32 s27, v21, 48
    s_nop 1
    v_mov_b32 v20, s24
    v_add_f32 v20, s25, v20
    v_add_f32 v20, s26, v20
    v_add_f32 v20, s27, v20
    v_mul_f32 v20, 0.0015625, v20
    v_sub_f32 v10, v10, v20
    v_sub_f32 v11, v11, v20
    v_sub_f32 v12, v12, v20
    v_sub_f32 v13, v13, v20
    v_sub_f32 v14, v14, v20
    v_sub_f32 v15, v15, v20
    v_sub_f32 v16, v16, v20
    v_sub_f32 v17, v17, v20
    v_sub_f32 v18, v18, v20
    v_sub_f32 v19, v19, v20
    v_mul_f32 v21, v10, v10
    v_fmac_f32 v21, v11, v11
    v_fmac_f32 v21, v12, v12
    v_fmac_f32 v21, v13, v13
    v_fmac_f32 v21, v14, v14
    v_fmac_f32 v21, v15, v15
    v_fmac_f32 v21, v16, v16
    v_fmac_f32 v21, v17, v17
    v_fmac_f32 v21, v18, v18
    v_fmac_f32 v21, v19, v19
    s_nop 1
    v_add_f32 v22, v21, v21 quad_perm:[1,0,3,2] row_mask:0xf bank_mask:0xf
    s_nop 1
    v_add_f32 v22, v22, v22 quad_perm:[2,3,0,1] row_mask:0xf bank_mask:0xf
    s_nop 1
    v_add_f32 v22, v22, v22 row_half_mirror row_mask:0xf bank_mask:0xf
    s_nop 1
    v_add_f32 v22, v22, v22 row_mirror row_mask:0xf bank_mask:0xf
    s_nop 1
    v_readlane_b32 s24, v22, 0
    v_readlane_b32 s25, v22, 16
    v_readlane_b32 s26, v22, 32
    v_readlane_b32 s27, v22, 48
    s_nop 1
    v_mov_b32 v21, s24
    v_add_f32 v21, s25, v21
    v_add_f32 v21, s26, v21
    v_add_f32 v21, s27, v21
    v_mov_b32 v22, 0x3727c5ac
    v_fmac_f32 v22, 0.0015625, v21
    v_rsq_f32 v22, v22
    s_nop 0
    v_mul_f32 v10, v10, v22
    v_mul_f32 v11, v11, v22
    v_mul_f32 v12, v12, v22
    v_mul_f32 v13, v13, v22
    v_mul_f32 v14, v14, v22
    v_mul_f32 v15, v15, v22
    v_mul_f32 v16, v16, v22
    v_mul_f32 v17, v17, v22
    v_mul_f32 v18, v18, v22
    v_mul_f32 v19, v19, v22
    v_cvt_pk_bf16_f32 v4, v10, v11
    v_cvt_pk_bf16_f32 v5, v12, v13
    v_cvt_pk_bf16_f32 v6, v14, v15
    v_cvt_pk_bf16_f32 v7, v16, v17
    v_cvt_pk_bf16_f32 v8, v18, v19
    buffer_store_dword v4, v3, s[16:19], 0 offen offset:0
    buffer_store_dword v5, v3, s[16:19], 0 offen offset:256
    buffer_store_dword v6, v3, s[16:19], 0 offen offset:512
    buffer_store_dword v7, v3, s[16:19], 0 offen offset:768
    buffer_store_dword v8, v3, s[16:19], 0 offen offset:1024
ln_a1_kernel_end:
    s_endpgm
.section .rodata,"a"
.p2align 6
.amdhsa_kernel ln_a1_kernel
  .amdhsa_next_free_vgpr 32
  .amdhsa_next_free_sgpr 40
  .amdhsa_accum_offset 32
  .amdhsa_group_segment_fixed_size 0
  .amdhsa_kernarg_size 104
  .amdhsa_user_sgpr_count 2
  .amdhsa_user_sgpr_kernarg_segment_ptr 1
  .amdhsa_system_sgpr_workgroup_id_x 1
.end_amdhsa_kernel
.text
.globl qkv_a_kernel
.p2align 8
.type qkv_a_kernel,@function
qkv_a_kernel:
    v_lshrrev_b32 v1, 6, v0
    v_and_b32 v2, 63, v0
    s_nop 0
    v_readfirstlane_b32 s3, v1
    s_cmp_ge_u32 s2, 192
    s_cbranch_scc1 qkv_a_kernel_end
    s_load_dwordx2 s[4:5], s[0:1], 96
    s_load_dwordx2 s[6:7], s[0:1], 80
    s_mul_i32 s20, s2, 171
    s_lshr_b32 s20, s20, 12
    s_mul_i32 s21, s20, 24
    s_sub_u32 s21, s2, s21
    s_lshl_b32 s20, s20, 2
    s_add_u32 s20, s20, s3
    s_mul_i32 s22, s20, 64
    s_mul_i32 s23, s21, 80
    s_waitcnt lgkmcnt(0)
    s_mov_b32 s8, s4
    s_mov_b32 s9, s5
    s_mov_b32 s10, 268435456
    s_mov_b32 s11, 0x00020000
    v_and_b32 v3, 15, v2
    v_lshrrev_b32 v4, 4, v2
    s_mov_b32 s24, 1280
    v_add_u32 v5, s22, v3
    v_mul_lo_u32 v5, v5, s24
    v_lshlrev_b32 v6, 4, v4
    v_add_u32 v5, v5, v6
    v_add_u32 v5, 0, v5
    v_mov_b32 v8, v5
    v_add_u32 v9, 20480, v5
    v_add_u32 v10, 40960, v5
    v_add_u32 v11, 61440, v5
    v_lshlrev_b32 v7, 4, v2
    s_mov_b32 s25, 0
    s_mov_b32 s26, 0
    s_mul_i32 s27, s21, 102400
    s_add_u32 s27, s27, s26
    s_add_u32 s27, s27, 25165824
    s_add_u32 s32, s27, 0
    s_add_u32 s33, s27, 20480
    s_add_u32 s34, s27, 40960
    s_add_u32 s35, s27, 61440
    s_add_u32 s36, s27, 81920
    v_accvgpr_write_b32 a0, 0
    v_accvgpr_write_b32 a1, 0
    v_accvgpr_write_b32 a2, 0
    v_accvgpr_write_b32 a3, 0
    v_accvgpr_write_b32 a4, 0
    v_accvgpr_write_b32 a5, 0
    v_accvgpr_write_b32 a6, 0
    v_accvgpr_write_b32 a7, 0
    v_accvgpr_write_b32 a8, 0
    v_accvgpr_write_b32 a9, 0
    v_accvgpr_write_b32 a10, 0
    v_accvgpr_write_b32 a11, 0
    v_accvgpr_write_b32 a12, 0
    v_accvgpr_write_b32 a13, 0
    v_accvgpr_write_b32 a14, 0
    v_accvgpr_write_b32 a15, 0
    v_accvgpr_write_b32 a16, 0
    v_accvgpr_write_b32 a17, 0
    v_accvgpr_write_b32 a18, 0
    v_accvgpr_write_b32 a19, 0
    v_accvgpr_write_b32 a20, 0
    v_accvgpr_write_b32 a21, 0
    v_accvgpr_write_b32 a22, 0
    v_accvgpr_write_b32 a23, 0
    v_accvgpr_write_b32 a24, 0
    v_accvgpr_write_b32 a25, 0
    v_accvgpr_write_b32 a26, 0
    v_accvgpr_write_b32 a27, 0
    v_accvgpr_write_b32 a28, 0
    v_accvgpr_write_b32 a29, 0
    v_accvgpr_write_b32 a30, 0
    v_accvgpr_write_b32 a31, 0
    v_accvgpr_write_b32 a32, 0
    v_accvgpr_write_b32 a33, 0
    v_accvgpr_write_b32 a34, 0
    v_accvgpr_write_b32 a35, 0
    v_accvgpr_write_b32 a36, 0
    v_accvgpr_write_b32 a37, 0
    v_accvgpr_write_b32 a38, 0
    v_accvgpr_write_b32 a39, 0
    v_accvgpr_write_b32 a40, 0
    v_accvgpr_write_b32 a41, 0
    v_accvgpr_write_b32 a42, 0
    v_accvgpr_write_b32 a43, 0
    v_accvgpr_write_b32 a44, 0
    v_accvgpr_write_b32 a45, 0
    v_accvgpr_write_b32 a46, 0
    v_accvgpr_write_b32 a47, 0
    v_accvgpr_write_b32 a48, 0
    v_accvgpr_write_b32 a49, 0
    v_accvgpr_write_b32 a50, 0
    v_accvgpr_write_b32 a51, 0
    v_accvgpr_write_b32 a52, 0
    v_accvgpr_write_b32 a53, 0
    v_accvgpr_write_b32 a54, 0
    v_accvgpr_write_b32 a55, 0
    v_accvgpr_write_b32 a56, 0
    v_accvgpr_write_b32 a57, 0
    v_accvgpr_write_b32 a58, 0
    v_accvgpr_write_b32 a59, 0
    v_accvgpr_write_b32 a60, 0
    v_accvgpr_write_b32 a61, 0
    v_accvgpr_write_b32 a62, 0
    v_accvgpr_write_b32 a63, 0
    v_accvgpr_write_b32 a64, 0
    v_accvgpr_write_b32 a65, 0
    v_accvgpr_write_b32 a66, 0
    v_accvgpr_write_b32 a67, 0
    v_accvgpr_write_b32 a68, 0
    v_accvgpr_write_b32 a69, 0
    v_accvgpr_write_b32 a70, 0
    v_accvgpr_write_b32 a71, 0
    v_accvgpr_write_b32 a72, 0
    v_accvgpr_write_b32 a73, 0
    v_accvgpr_write_b32 a74, 0
    v_accvgpr_write_b32 a75, 0
    v_accvgpr_write_b32 a76, 0
    v_accvgpr_write_b32 a77, 0
    v_accvgpr_write_b32 a78, 0
    v_accvgpr_write_b32 a79, 0
    s_cmp_ge_u32 s23, 640
    s_cbranch_scc1 qkv_a_kernel_nrm
    buffer_load_dwordx4 v[16:19], v8, s[8:11], s25 offen
    buffer_load_dwordx4 v[20:23], v9, s[8:11], s25 offen
    buffer_load_dwordx4 v[24:27], v10, s[8:11], s25 offen
    buffer_load_dwordx4 v[28:31], v11, s[8:11], s25 offen
    buffer_load_dwordx4 v[32:35], v7, s[8:11], s32 offen
    buffer_load_dwordx4 v[36:39], v7, s[8:11], s33 offen
    buffer_load_dwordx4 v[40:43], v7, s[8:11], s34 offen
    buffer_load_dwordx4 v[44:47], v7, s[8:11], s35 offen
    buffer_load_dwordx4 v[48:51], v7, s[8:11], s36 offen
    s_mov_b32 s28, 10
qkv_a_kernel_loop0:
    s_add_u32 s25, s25, 64
    s_add_u32 s32, s32, 1024
    s_add_u32 s33, s33, 1024
    s_add_u32 s34, s34, 1024
    s_add_u32 s35, s35, 1024
    s_add_u32 s36, s36, 1024
    buffer_load_dwordx4 v[52:55], v8, s[8:11], s25 offen
    buffer_load_dwordx4 v[56:59], v9, s[8:11], s25 offen
    buffer_load_dwordx4 v[60:63], v10, s[8:11], s25 offen
    buffer_load_dwordx4 v[64:67], v11, s[8:11], s25 offen
    buffer_load_dwordx4 v[68:71], v7, s[8:11], s32 offen
    buffer_load_dwordx4 v[72:75], v7, s[8:11], s33 offen
    buffer_load_dwordx4 v[76:79], v7, s[8:11], s34 offen
    buffer_load_dwordx4 v[80:83], v7, s[8:11], s35 offen
    buffer_load_dwordx4 v[84:87], v7, s[8:11], s36 offen
    s_waitcnt vmcnt(9)
    v_mfma_f32_16x16x32_bf16 a[0:3], v[32:35], v[16:19], a[0:3]
    v_mfma_f32_16x16x32_bf16 a[20:23], v[32:35], v[20:23], a[20:23]
    v_mfma_f32_16x16x32_bf16 a[40:43], v[32:35], v[24:27], a[40:43]
    v_mfma_f32_16x16x32_bf16 a[60:63], v[32:35], v[28:31], a[60:63]
    v_mfma_f32_16x16x32_bf16 a[4:7], v[36:39], v[16:19], a[4:7]
    v_mfma_f32_16x16x32_bf16 a[24:27], v[36:39], v[20:23], a[24:27]
    v_mfma_f32_16x16x32_bf16 a[44:47], v[36:39], v[24:27], a[44:47]
    v_mfma_f32_16x16x32_bf16 a[64:67], v[36:39], v[28:31], a[64:67]
    v_mfma_f32_16x16x32_bf16 a[8:11], v[40:43], v[16:19], a[8:11]
    v_mfma_f32_16x16x32_bf16 a[28:31], v[40:43], v[20:23], a[28:31]
    v_mfma_f32_16x16x32_bf16 a[48:51], v[40:43], v[24:27], a[48:51]
    v_mfma_f32_16x16x32_bf16 a[68:71], v[40:43], v[28:31], a[68:71]
    v_mfma_f32_16x16x32_bf16 a[12:15], v[44:47], v[16:19], a[12:15]
    v_mfma_f32_16x16x32_bf16 a[32:35], v[44:47], v[20:23], a[32:35]
    v_mfma_f32_16x16x32_bf16 a[52:55], v[44:47], v[24:27], a[52:55]
    v_mfma_f32_16x16x32_bf16 a[72:75], v[44:47], v[28:31], a[72:75]
    v_mfma_f32_16x16x32_bf16 a[16:19], v[48:51], v[16:19], a[16:19]
    v_mfma_f32_16x16x32_bf16 a[36:39], v[48:51], v[20:23], a[36:39]
    v_mfma_f32_16x16x32_bf16 a[56:59], v[48:51], v[24:27], a[56:59]
    v_mfma_f32_16x16x32_bf16 a[76:79], v[48:51], v[28:31], a[76:79]
    s_sub_u32 s28, s28, 1
    s_cmp_eq_u32 s28, 0
    s_cbranch_scc1 qkv_a_kernel_loop0_last
    s_add_u32 s25, s25, 64
    s_add_u32 s32, s32, 1024
    s_add_u32 s33, s33, 1024
    s_add_u32 s34, s34, 1024
    s_add_u32 s35, s35, 1024
    s_add_u32 s36, s36, 1024
    buffer_load_dwordx4 v[16:19], v8, s[8:11], s25 offen
    buffer_load_dwordx4 v[20:23], v9, s[8:11], s25 offen
    buffer_load_dwordx4 v[24:27], v10, s[8:11], s25 offen
    buffer_load_dwordx4 v[28:31], v11, s[8:11], s25 offen
    buffer_load_dwordx4 v[32:35], v7, s[8:11], s32 offen
    buffer_load_dwordx4 v[36:39], v7, s[8:11], s33 offen
    buffer_load_dwordx4 v[40:43], v7, s[8:11], s34 offen
    buffer_load_dwordx4 v[44:47], v7, s[8:11], s35 offen
    buffer_load_dwordx4 v[48:51], v7, s[8:11], s36 offen
    s_waitcnt vmcnt(9)
    v_mfma_f32_16x16x32_bf16 a[0:3], v[68:71], v[52:55], a[0:3]
    v_mfma_f32_16x16x32_bf16 a[20:23], v[68:71], v[56:59], a[20:23]
    v_mfma_f32_16x16x32_bf16 a[40:43], v[68:71], v[60:63], a[40:43]
    v_mfma_f32_16x16x32_bf16 a[60:63], v[68:71], v[64:67], a[60:63]
    v_mfma_f32_16x16x32_bf16 a[4:7], v[72:75], v[52:55], a[4:7]
    v_mfma_f32_16x16x32_bf16 a[24:27], v[72:75], v[56:59], a[24:27]
    v_mfma_f32_16x16x32_bf16 a[44:47], v[72:75], v[60:63], a[44:47]
    v_mfma_f32_16x16x32_bf16 a[64:67], v[72:75], v[64:67], a[64:67]
    v_mfma_f32_16x16x32_bf16 a[8:11], v[76:79], v[52:55], a[8:11]
    v_mfma_f32_16x16x32_bf16 a[28:31], v[76:79], v[56:59], a[28:31]
    v_mfma_f32_16x16x32_bf16 a[48:51], v[76:79], v[60:63], a[48:51]
    v_mfma_f32_16x16x32_bf16 a[68:71], v[76:79], v[64:67], a[68:71]
    v_mfma_f32_16x16x32_bf16 a[12:15], v[80:83], v[52:55], a[12:15]
    v_mfma_f32_16x16x32_bf16 a[32:35], v[80:83], v[56:59], a[32:35]
    v_mfma_f32_16x16x32_bf16 a[52:55], v[80:83], v[60:63], a[52:55]
    v_mfma_f32_16x16x32_bf16 a[72:75], v[80:83], v[64:67], a[72:75]
    v_mfma_f32_16x16x32_bf16 a[16:19], v[84:87], v[52:55], a[16:19]
    v_mfma_f32_16x16x32_bf16 a[36:39], v[84:87], v[56:59], a[36:39]
    v_mfma_f32_16x16x32_bf16 a[56:59], v[84:87], v[60:63], a[56:59]
    v_mfma_f32_16x16x32_bf16 a[76:79], v[84:87], v[64:67], a[76:79]
    s_branch qkv_a_kernel_loop0
qkv_a_kernel_loop0_last:
    s_waitcnt vmcnt(0)
    v_mfma_f32_16x16x32_bf16 a[0:3], v[68:71], v[52:55], a[0:3]
    v_mfma_f32_16x16x32_bf16 a[20:23], v[68:71], v[56:59], a[20:23]
    v_mfma_f32_16x16x32_bf16 a[40:43], v[68:71], v[60:63], a[40:43]
    v_mfma_f32_16x16x32_bf16 a[60:63], v[68:71], v[64:67], a[60:63]
    v_mfma_f32_16x16x32_bf16 a[4:7], v[72:75], v[52:55], a[4:7]
    v_mfma_f32_16x16x32_bf16 a[24:27], v[72:75], v[56:59], a[24:27]
    v_mfma_f32_16x16x32_bf16 a[44:47], v[72:75], v[60:63], a[44:47]
    v_mfma_f32_16x16x32_bf16 a[64:67], v[72:75], v[64:67], a[64:67]
    v_mfma_f32_16x16x32_bf16 a[8:11], v[76:79], v[52:55], a[8:11]
    v_mfma_f32_16x16x32_bf16 a[28:31], v[76:79], v[56:59], a[28:31]
    v_mfma_f32_16x16x32_bf16 a[48:51], v[76:79], v[60:63], a[48:51]
    v_mfma_f32_16x16x32_bf16 a[68:71], v[76:79], v[64:67], a[68:71]
    v_mfma_f32_16x16x32_bf16 a[12:15], v[80:83], v[52:55], a[12:15]
    v_mfma_f32_16x16x32_bf16 a[32:35], v[80:83], v[56:59], a[32:35]
    v_mfma_f32_16x16x32_bf16 a[52:55], v[80:83], v[60:63], a[52:55]
    v_mfma_f32_16x16x32_bf16 a[72:75], v[80:83], v[64:67], a[72:75]
    v_mfma_f32_16x16x32_bf16 a[16:19], v[84:87], v[52:55], a[16:19]
    v_mfma_f32_16x16x32_bf16 a[36:39], v[84:87], v[56:59], a[36:39]
    v_mfma_f32_16x16x32_bf16 a[56:59], v[84:87], v[60:63], a[56:59]
    v_mfma_f32_16x16x32_bf16 a[76:79], v[84:87], v[64:67], a[76:79]
    s_nop 7
    s_nop 7
    s_mov_b32 s24, 1280
    s_lshl_b32 s29, s23, 1
    s_add_u32 s29, s29, 8388608
    v_add_u32 v5, s22, v3
    v_mul_lo_u32 v5, v5, s24
    v_lshlrev_b32 v6, 3, v4
    v_add3_u32 v5, v5, v6, s29
    v_accvgpr_read_b32 v92, a0
    v_accvgpr_read_b32 v93, a1
    v_accvgpr_read_b32 v94, a2
    v_accvgpr_read_b32 v95, a3
    v_cvt_pk_bf16_f32 v96, v92, v93
    v_cvt_pk_bf16_f32 v97, v94, v95
    v_add_u32 v6, 0, v5
    buffer_store_dwordx2 v[96:97], v6, s[8:11], 0 offen
    v_accvgpr_read_b32 v92, a4
    v_accvgpr_read_b32 v93, a5
    v_accvgpr_read_b32 v94, a6
    v_accvgpr_read_b32 v95, a7
    v_cvt_pk_bf16_f32 v96, v92, v93
    v_cvt_pk_bf16_f32 v97, v94, v95
    v_add_u32 v6, 32, v5
    buffer_store_dwordx2 v[96:97], v6, s[8:11], 0 offen
    v_accvgpr_read_b32 v92, a8
    v_accvgpr_read_b32 v93, a9
    v_accvgpr_read_b32 v94, a10
    v_accvgpr_read_b32 v95, a11
    v_cvt_pk_bf16_f32 v96, v92, v93
    v_cvt_pk_bf16_f32 v97, v94, v95
    v_add_u32 v6, 64, v5
    buffer_store_dwordx2 v[96:97], v6, s[8:11], 0 offen
    v_accvgpr_read_b32 v92, a12
    v_accvgpr_read_b32 v93, a13
    v_accvgpr_read_b32 v94, a14
    v_accvgpr_read_b32 v95, a15
    v_cvt_pk_bf16_f32 v96, v92, v93
    v_cvt_pk_bf16_f32 v97, v94, v95
    v_add_u32 v6, 96, v5
    buffer_store_dwordx2 v[96:97], v6, s[8:11], 0 offen
    v_accvgpr_read_b32 v92, a16
    v_accvgpr_read_b32 v93, a17
    v_accvgpr_read_b32 v94, a18
    v_accvgpr_read_b32 v95, a19
    v_cvt_pk_bf16_f32 v96, v92, v93
    v_cvt_pk_bf16_f32 v97, v94, v95
    v_add_u32 v6, 128, v5
    buffer_store_dwordx2 v[96:97], v6, s[8:11], 0 offen
    v_accvgpr_read_b32 v92, a20
    v_accvgpr_read_b32 v93, a21
    v_accvgpr_read_b32 v94, a22
    v_accvgpr_read_b32 v95, a23
    v_cvt_pk_bf16_f32 v96, v92, v93
    v_cvt_pk_bf16_f32 v97, v94, v95
    v_add_u32 v6, 20480, v5
    buffer_store_dwordx2 v[96:97], v6, s[8:11], 0 offen
    v_accvgpr_read_b32 v92, a24
    v_accvgpr_read_b32 v93, a25
    v_accvgpr_read_b32 v94, a26
    v_accvgpr_read_b32 v95, a27
    v_cvt_pk_bf16_f32 v96, v92, v93
    v_cvt_pk_bf16_f32 v97, v94, v95
    v_add_u32 v6, 20512, v5
    buffer_store_dwordx2 v[96:97], v6, s[8:11], 0 offen
    v_accvgpr_read_b32 v92, a28
    v_accvgpr_read_b32 v93, a29
    v_accvgpr_read_b32 v94, a30
    v_accvgpr_read_b32 v95, a31
    v_cvt_pk_bf16_f32 v96, v92, v93
    v_cvt_pk_bf16_f32 v97, v94, v95
    v_add_u32 v6, 20544, v5
    buffer_store_dwordx2 v[96:97], v6, s[8:11], 0 offen
    v_accvgpr_read_b32 v92, a32
    v_accvgpr_read_b32 v93, a33
    v_accvgpr_read_b32 v94, a34
    v_accvgpr_read_b32 v95, a35
    v_cvt_pk_bf16_f32 v96, v92, v93
    v_cvt_pk_bf16_f32 v97, v94, v95
    v_add_u32 v6, 20576, v5
    buffer_store_dwordx2 v[96:97], v6, s[8:11], 0 offen
    v_accvgpr_read_b32 v92, a36
    v_accvgpr_read_b32 v93, a37
    v_accvgpr_read_b32 v94, a38
    v_accvgpr_read_b32 v95, a39
    v_cvt_pk_bf16_f32 v96, v92, v93
    v_cvt_pk_bf16_f32 v97, v94, v95
    v_add_u32 v6, 20608, v5
    buffer_store_dwordx2 v[96:97], v6, s[8:11], 0 offen
    v_accvgpr_read_b32 v92, a40
    v_accvgpr_read_b32 v93, a41
    v_accvgpr_read_b32 v94, a42
    v_accvgpr_read_b32 v95, a43
    v_cvt_pk_bf16_f32 v96, v92, v93
    v_cvt_pk_bf16_f32 v97, v94, v95
    v_add_u32 v6, 40960, v5
    buffer_store_dwordx2 v[96:97], v6, s[8:11], 0 offen
    v_accvgpr_read_b32 v92, a44
    v_accvgpr_read_b32 v93, a45
    v_accvgpr_read_b32 v94, a46
    v_accvgpr_read_b32 v95, a47
    v_cvt_pk_bf16_f32 v96, v92, v93
    v_cvt_pk_bf16_f32 v97, v94, v95
    v_add_u32 v6, 40992, v5
    buffer_store_dwordx2 v[96:97], v6, s[8:11], 0 offen
    v_accvgpr_read_b32 v92, a48
    v_accvgpr_read_b32 v93, a49
    v_accvgpr_read_b32 v94, a50
    v_accvgpr_read_b32 v95, a51
    v_cvt_pk_bf16_f32 v96, v92, v93
    v_cvt_pk_bf16_f32 v97, v94, v95
    v_add_u32 v6, 41024, v5
    buffer_store_dwordx2 v[96:97], v6, s[8:11], 0 offen
    v_accvgpr_read_b32 v92, a52
    v_accvgpr_read_b32 v93, a53
    v_accvgpr_read_b32 v94, a54
    v_accvgpr_read_b32 v95, a55
    v_cvt_pk_bf16_f32 v96, v92, v93
    v_cvt_pk_bf16_f32 v97, v94, v95
    v_add_u32 v6, 41056, v5
    buffer_store_dwordx2 v[96:97], v6, s[8:11], 0 offen
    v_accvgpr_read_b32 v92, a56
    v_accvgpr_read_b32 v93, a57
    v_accvgpr_read_b32 v94, a58
    v_accvgpr_read_b32 v95, a59
    v_cvt_pk_bf16_f32 v96, v92, v93
    v_cvt_pk_bf16_f32 v97, v94, v95
    v_add_u32 v6, 41088, v5
    buffer_store_dwordx2 v[96:97], v6, s[8:11], 0 offen
    v_accvgpr_read_b32 v92, a60
    v_accvgpr_read_b32 v93, a61
    v_accvgpr_read_b32 v94, a62
    v_accvgpr_read_b32 v95, a63
    v_cvt_pk_bf16_f32 v96, v92, v93
    v_cvt_pk_bf16_f32 v97, v94, v95
    v_add_u32 v6, 61440, v5
    buffer_store_dwordx2 v[96:97], v6, s[8:11], 0 offen
    v_accvgpr_read_b32 v92, a64
    v_accvgpr_read_b32 v93, a65
    v_accvgpr_read_b32 v94, a66
    v_accvgpr_read_b32 v95, a67
    v_cvt_pk_bf16_f32 v96, v92, v93
    v_cvt_pk_bf16_f32 v97, v94, v95
    v_add_u32 v6, 61472, v5
    buffer_store_dwordx2 v[96:97], v6, s[8:11], 0 offen
    v_accvgpr_read_b32 v92, a68
    v_accvgpr_read_b32 v93, a69
    v_accvgpr_read_b32 v94, a70
    v_accvgpr_read_b32 v95, a71
    v_cvt_pk_bf16_f32 v96, v92, v93
    v_cvt_pk_bf16_f32 v97, v94, v95
    v_add_u32 v6, 61504, v5
    buffer_store_dwordx2 v[96:97], v6, s[8:11], 0 offen
    v_accvgpr_read_b32 v92, a72
    v_accvgpr_read_b32 v93, a73
    v_accvgpr_read_b32 v94, a74
    v_accvgpr_read_b32 v95, a75
    v_cvt_pk_bf16_f32 v96, v92, v93
    v_cvt_pk_bf16_f32 v97, v94, v95
    v_add_u32 v6, 61536, v5
    buffer_store_dwordx2 v[96:97], v6, s[8:11], 0 offen
    v_accvgpr_read_b32 v92, a76
    v_accvgpr_read_b32 v93, a77
    v_accvgpr_read_b32 v94, a78
    v_accvgpr_read_b32 v95, a79
    v_cvt_pk_bf16_f32 v96, v92, v93
    v_cvt_pk_bf16_f32 v97, v94, v95
    v_add_u32 v6, 61568, v5
    buffer_store_dwordx2 v[96:97], v6, s[8:11], 0 offen
    s_branch qkv_a_kernel_end
qkv_a_kernel_nrm:
    buffer_load_dwordx4 v[16:19], v8, s[8:11], s25 offen
    buffer_load_dwordx4 v[20:23], v9, s[8:11], s25 offen
    buffer_load_dwordx4 v[24:27], v10, s[8:11], s25 offen
    buffer_load_dwordx4 v[28:31], v11, s[8:11], s25 offen
    buffer_load_dwordx4 v[32:35], v7, s[8:11], s32 offen
    buffer_load_dwordx4 v[36:39], v7, s[8:11], s33 offen
    buffer_load_dwordx4 v[40:43], v7, s[8:11], s34 offen
    buffer_load_dwordx4 v[44:47], v7, s[8:11], s35 offen
    buffer_load_dwordx4 v[48:51], v7, s[8:11], s36 offen
    s_mov_b32 s28, 10
qkv_a_kernel_loop1:
    s_add_u32 s25, s25, 64
    s_add_u32 s32, s32, 1024
    s_add_u32 s33, s33, 1024
    s_add_u32 s34, s34, 1024
    s_add_u32 s35, s35, 1024
    s_add_u32 s36, s36, 1024
    buffer_load_dwordx4 v[52:55], v8, s[8:11], s25 offen
    buffer_load_dwordx4 v[56:59], v9, s[8:11], s25 offen
    buffer_load_dwordx4 v[60:63], v10, s[8:11], s25 offen
    buffer_load_dwordx4 v[64:67], v11, s[8:11], s25 offen
    buffer_load_dwordx4 v[68:71], v7, s[8:11], s32 offen
    buffer_load_dwordx4 v[72:75], v7, s[8:11], s33 offen
    buffer_load_dwordx4 v[76:79], v7, s[8:11], s34 offen
    buffer_load_dwordx4 v[80:83], v7, s[8:11], s35 offen
    buffer_load_dwordx4 v[84:87], v7, s[8:11], s36 offen
    s_waitcnt vmcnt(9)
    v_mfma_f32_16x16x32_bf16 a[0:3], v[16:19], v[32:35], a[0:3]
    v_mfma_f32_16x16x32_bf16 a[20:23], v[20:23], v[32:35], a[20:23]
    v_mfma_f32_16x16x32_bf16 a[40:43], v[24:27], v[32:35], a[40:43]
    v_mfma_f32_16x16x32_bf16 a[60:63], v[28:31], v[32:35], a[60:63]
    v_mfma_f32_16x16x32_bf16 a[4:7], v[16:19], v[36:39], a[4:7]
    v_mfma_f32_16x16x32_bf16 a[24:27], v[20:23], v[36:39], a[24:27]
    v_mfma_f32_16x16x32_bf16 a[44:47], v[24:27], v[36:39], a[44:47]
    v_mfma_f32_16x16x32_bf16 a[64:67], v[28:31], v[36:39], a[64:67]
    v_mfma_f32_16x16x32_bf16 a[8:11], v[16:19], v[40:43], a[8:11]
    v_mfma_f32_16x16x32_bf16 a[28:31], v[20:23], v[40:43], a[28:31]
    v_mfma_f32_16x16x32_bf16 a[48:51], v[24:27], v[40:43], a[48:51]
    v_mfma_f32_16x16x32_bf16 a[68:71], v[28:31], v[40:43], a[68:71]
    v_mfma_f32_16x16x32_bf16 a[12:15], v[16:19], v[44:47], a[12:15]
    v_mfma_f32_16x16x32_bf16 a[32:35], v[20:23], v[44:47], a[32:35]
    v_mfma_f32_16x16x32_bf16 a[52:55], v[24:27], v[44:47], a[52:55]
    v_mfma_f32_16x16x32_bf16 a[72:75], v[28:31], v[44:47], a[72:75]
    v_mfma_f32_16x16x32_bf16 a[16:19], v[16:19], v[48:51], a[16:19]
    v_mfma_f32_16x16x32_bf16 a[36:39], v[20:23], v[48:51], a[36:39]
    v_mfma_f32_16x16x32_bf16 a[56:59], v[24:27], v[48:51], a[56:59]
    v_mfma_f32_16x16x32_bf16 a[76:79], v[28:31], v[48:51], a[76:79]
    s_sub_u32 s28, s28, 1
    s_cmp_eq_u32 s28, 0
    s_cbranch_scc1 qkv_a_kernel_loop1_last
    s_add_u32 s25, s25, 64
    s_add_u32 s32, s32, 1024
    s_add_u32 s33, s33, 1024
    s_add_u32 s34, s34, 1024
    s_add_u32 s35, s35, 1024
    s_add_u32 s36, s36, 1024
    buffer_load_dwordx4 v[16:19], v8, s[8:11], s25 offen
    buffer_load_dwordx4 v[20:23], v9, s[8:11], s25 offen
    buffer_load_dwordx4 v[24:27], v10, s[8:11], s25 offen
    buffer_load_dwordx4 v[28:31], v11, s[8:11], s25 offen
    buffer_load_dwordx4 v[32:35], v7, s[8:11], s32 offen
    buffer_load_dwordx4 v[36:39], v7, s[8:11], s33 offen
    buffer_load_dwordx4 v[40:43], v7, s[8:11], s34 offen
    buffer_load_dwordx4 v[44:47], v7, s[8:11], s35 offen
    buffer_load_dwordx4 v[48:51], v7, s[8:11], s36 offen
    s_waitcnt vmcnt(9)
    v_mfma_f32_16x16x32_bf16 a[0:3], v[52:55], v[68:71], a[0:3]
    v_mfma_f32_16x16x32_bf16 a[20:23], v[56:59], v[68:71], a[20:23]
    v_mfma_f32_16x16x32_bf16 a[40:43], v[60:63], v[68:71], a[40:43]
    v_mfma_f32_16x16x32_bf16 a[60:63], v[64:67], v[68:71], a[60:63]
    v_mfma_f32_16x16x32_bf16 a[4:7], v[52:55], v[72:75], a[4:7]
    v_mfma_f32_16x16x32_bf16 a[24:27], v[56:59], v[72:75], a[24:27]
    v_mfma_f32_16x16x32_bf16 a[44:47], v[60:63], v[72:75], a[44:47]
    v_mfma_f32_16x16x32_bf16 a[64:67], v[64:67], v[72:75], a[64:67]
    v_mfma_f32_16x16x32_bf16 a[8:11], v[52:55], v[76:79], a[8:11]
    v_mfma_f32_16x16x32_bf16 a[28:31], v[56:59], v[76:79], a[28:31]
    v_mfma_f32_16x16x32_bf16 a[48:51], v[60:63], v[76:79], a[48:51]
    v_mfma_f32_16x16x32_bf16 a[68:71], v[64:67], v[76:79], a[68:71]
    v_mfma_f32_16x16x32_bf16 a[12:15], v[52:55], v[80:83], a[12:15]
    v_mfma_f32_16x16x32_bf16 a[32:35], v[56:59], v[80:83], a[32:35]
    v_mfma_f32_16x16x32_bf16 a[52:55], v[60:63], v[80:83], a[52:55]
    v_mfma_f32_16x16x32_bf16 a[72:75], v[64:67], v[80:83], a[72:75]
    v_mfma_f32_16x16x32_bf16 a[16:19], v[52:55], v[84:87], a[16:19]
    v_mfma_f32_16x16x32_bf16 a[36:39], v[56:59], v[84:87], a[36:39]
    v_mfma_f32_16x16x32_bf16 a[56:59], v[60:63], v[84:87], a[56:59]
    v_mfma_f32_16x16x32_bf16 a[76:79], v[64:67], v[84:87], a[76:79]
    s_branch qkv_a_kernel_loop1
qkv_a_kernel_loop1_last:
    s_waitcnt vmcnt(0)
    v_mfma_f32_16x16x32_bf16 a[0:3], v[52:55], v[68:71], a[0:3]
    v_mfma_f32_16x16x32_bf16 a[20:23], v[56:59], v[68:71], a[20:23]
    v_mfma_f32_16x16x32_bf16 a[40:43], v[60:63], v[68:71], a[40:43]
    v_mfma_f32_16x16x32_bf16 a[60:63], v[64:67], v[68:71], a[60:63]
    v_mfma_f32_16x16x32_bf16 a[4:7], v[52:55], v[72:75], a[4:7]
    v_mfma_f32_16x16x32_bf16 a[24:27], v[56:59], v[72:75], a[24:27]
    v_mfma_f32_16x16x32_bf16 a[44:47], v[60:63], v[72:75], a[44:47]
    v_mfma_f32_16x16x32_bf16 a[64:67], v[64:67], v[72:75], a[64:67]
    v_mfma_f32_16x16x32_bf16 a[8:11], v[52:55], v[76:79], a[8:11]
    v_mfma_f32_16x16x32_bf16 a[28:31], v[56:59], v[76:79], a[28:31]
    v_mfma_f32_16x16x32_bf16 a[48:51], v[60:63], v[76:79], a[48:51]
    v_mfma_f32_16x16x32_bf16 a[68:71], v[64:67], v[76:79], a[68:71]
    v_mfma_f32_16x16x32_bf16 a[12:15], v[52:55], v[80:83], a[12:15]
    v_mfma_f32_16x16x32_bf16 a[32:35], v[56:59], v[80:83], a[32:35]
    v_mfma_f32_16x16x32_bf16 a[52:55], v[60:63], v[80:83], a[52:55]
    v_mfma_f32_16x16x32_bf16 a[72:75], v[64:67], v[80:83], a[72:75]
    v_mfma_f32_16x16x32_bf16 a[16:19], v[52:55], v[84:87], a[16:19]
    v_mfma_f32_16x16x32_bf16 a[36:39], v[56:59], v[84:87], a[36:39]
    v_mfma_f32_16x16x32_bf16 a[56:59], v[60:63], v[84:87], a[56:59]
    v_mfma_f32_16x16x32_bf16 a[76:79], v[64:67], v[84:87], a[76:79]
    s_nop 7
    s_nop 7
    s_sub_u32 s29, s23, 640
    v_add_u32 v5, s29, v3
    v_lshlrev_b32 v5, 11, v5
    v_lshlrev_b32 v6, 2, v4
    v_add3_u32 v5, v5, v6, s22
    v_lshlrev_b32 v5, 1, v5
    v_add_u32 v5, 12582912, v5
    v_accvgpr_read_b32 v92, a0
    v_accvgpr_read_b32 v93, a1
    v_accvgpr_read_b32 v94, a2
    v_accvgpr_read_b32 v95, a3
    v_cvt_pk_bf16_f32 v96, v92, v93
    v_cvt_pk_bf16_f32 v97, v94, v95
    v_add_u32 v6, 0, v5
    buffer_store_dwordx2 v[96:97], v6, s[8:11], 0 offen
    v_accvgpr_read_b32 v92, a4
    v_accvgpr_read_b32 v93, a5
    v_accvgpr_read_b32 v94, a6
    v_accvgpr_read_b32 v95, a7
    v_cvt_pk_bf16_f32 v96, v92, v93
    v_cvt_pk_bf16_f32 v97, v94, v95
    v_add_u32 v6, 65536, v5
    buffer_store_dwordx2 v[96:97], v6, s[8:11], 0 offen
    v_accvgpr_read_b32 v92, a8
    v_accvgpr_read_b32 v93, a9
    v_accvgpr_read_b32 v94, a10
    v_accvgpr_read_b32 v95, a11
    v_cvt_pk_bf16_f32 v96, v92, v93
    v_cvt_pk_bf16_f32 v97, v94, v95
    v_add_u32 v6, 131072, v5
    buffer_store_dwordx2 v[96:97], v6, s[8:11], 0 offen
    v_accvgpr_read_b32 v92, a12
    v_accvgpr_read_b32 v93, a13
    v_accvgpr_read_b32 v94, a14
    v_accvgpr_read_b32 v95, a15
    v_cvt_pk_bf16_f32 v96, v92, v93
    v_cvt_pk_bf16_f32 v97, v94, v95
    v_add_u32 v6, 196608, v5
    buffer_store_dwordx2 v[96:97], v6, s[8:11], 0 offen
    v_accvgpr_read_b32 v92, a16
    v_accvgpr_read_b32 v93, a17
    v_accvgpr_read_b32 v94, a18
    v_accvgpr_read_b32 v95, a19
    v_cvt_pk_bf16_f32 v96, v92, v93
    v_cvt_pk_bf16_f32 v97, v94, v95
    v_add_u32 v6, 262144, v5
    buffer_store_dwordx2 v[96:97], v6, s[8:11], 0 offen
    v_accvgpr_read_b32 v92, a20
    v_accvgpr_read_b32 v93, a21
    v_accvgpr_read_b32 v94, a22
    v_accvgpr_read_b32 v95, a23
    v_cvt_pk_bf16_f32 v96, v92, v93
    v_cvt_pk_bf16_f32 v97, v94, v95
    v_add_u32 v6, 32, v5
    buffer_store_dwordx2 v[96:97], v6, s[8:11], 0 offen
    v_accvgpr_read_b32 v92, a24
    v_accvgpr_read_b32 v93, a25
    v_accvgpr_read_b32 v94, a26
    v_accvgpr_read_b32 v95, a27
    v_cvt_pk_bf16_f32 v96, v92, v93
    v_cvt_pk_bf16_f32 v97, v94, v95
    v_add_u32 v6, 65568, v5
    buffer_store_dwordx2 v[96:97], v6, s[8:11], 0 offen
    v_accvgpr_read_b32 v92, a28
    v_accvgpr_read_b32 v93, a29
    v_accvgpr_read_b32 v94, a30
    v_accvgpr_read_b32 v95, a31
    v_cvt_pk_bf16_f32 v96, v92, v93
    v_cvt_pk_bf16_f32 v97, v94, v95
    v_add_u32 v6, 131104, v5
    buffer_store_dwordx2 v[96:97], v6, s[8:11], 0 offen
    v_accvgpr_read_b32 v92, a32
    v_accvgpr_read_b32 v93, a33
    v_accvgpr_read_b32 v94, a34
    v_accvgpr_read_b32 v95, a35
    v_cvt_pk_bf16_f32 v96, v92, v93
    v_cvt_pk_bf16_f32 v97, v94, v95
    v_add_u32 v6, 196640, v5
    buffer_store_dwordx2 v[96:97], v6, s[8:11], 0 offen
    v_accvgpr_read_b32 v92, a36
    v_accvgpr_read_b32 v93, a37
    v_accvgpr_read_b32 v94, a38
    v_accvgpr_read_b32 v95, a39
    v_cvt_pk_bf16_f32 v96, v92, v93
    v_cvt_pk_bf16_f32 v97, v94, v95
    v_add_u32 v6, 262176, v5
    buffer_store_dwordx2 v[96:97], v6, s[8:11], 0 offen
    v_accvgpr_read_b32 v92, a40
    v_accvgpr_read_b32 v93, a41
    v_accvgpr_read_b32 v94, a42
    v_accvgpr_read_b32 v95, a43
    v_cvt_pk_bf16_f32 v96, v92, v93
    v_cvt_pk_bf16_f32 v97, v94, v95
    v_add_u32 v6, 64, v5
    buffer_store_dwordx2 v[96:97], v6, s[8:11], 0 offen
    v_accvgpr_read_b32 v92, a44
    v_accvgpr_read_b32 v93, a45
    v_accvgpr_read_b32 v94, a46
    v_accvgpr_read_b32 v95, a47
    v_cvt_pk_bf16_f32 v96, v92, v93
    v_cvt_pk_bf16_f32 v97, v94, v95
    v_add_u32 v6, 65600, v5
    buffer_store_dwordx2 v[96:97], v6, s[8:11], 0 offen
    v_accvgpr_read_b32 v92, a48
    v_accvgpr_read_b32 v93, a49
    v_accvgpr_read_b32 v94, a50
    v_accvgpr_read_b32 v95, a51
    v_cvt_pk_bf16_f32 v96, v92, v93
    v_cvt_pk_bf16_f32 v97, v94, v95
    v_add_u32 v6, 131136, v5
    buffer_store_dwordx2 v[96:97], v6, s[8:11], 0 offen
    v_accvgpr_read_b32 v92, a52
    v_accvgpr_read_b32 v93, a53
    v_accvgpr_read_b32 v94, a54
    v_accvgpr_read_b32 v95, a55
    v_cvt_pk_bf16_f32 v96, v92, v93
    v_cvt_pk_bf16_f32 v97, v94, v95
    v_add_u32 v6, 196672, v5
    buffer_store_dwordx2 v[96:97], v6, s[8:11], 0 offen
    v_accvgpr_read_b32 v92, a56
    v_accvgpr_read_b32 v93, a57
    v_accvgpr_read_b32 v94, a58
    v_accvgpr_read_b32 v95, a59
    v_cvt_pk_bf16_f32 v96, v92, v93
    v_cvt_pk_bf16_f32 v97, v94, v95
    v_add_u32 v6, 262208, v5
    buffer_store_dwordx2 v[96:97], v6, s[8:11], 0 offen
    v_accvgpr_read_b32 v92, a60
    v_accvgpr_read_b32 v93, a61
    v_accvgpr_read_b32 v94, a62
    v_accvgpr_read_b32 v95, a63
    v_cvt_pk_bf16_f32 v96, v92, v93
    v_cvt_pk_bf16_f32 v97, v94, v95
    v_add_u32 v6, 96, v5
    buffer_store_dwordx2 v[96:97], v6, s[8:11], 0 offen
    v_accvgpr_read_b32 v92, a64
    v_accvgpr_read_b32 v93, a65
    v_accvgpr_read_b32 v94, a66
    v_accvgpr_read_b32 v95, a67
    v_cvt_pk_bf16_f32 v96, v92, v93
    v_cvt_pk_bf16_f32 v97, v94, v95
    v_add_u32 v6, 65632, v5
    buffer_store_dwordx2 v[96:97], v6, s[8:11], 0 offen
    v_accvgpr_read_b32 v92, a68
    v_accvgpr_read_b32 v93, a69
    v_accvgpr_read_b32 v94, a70
    v_accvgpr_read_b32 v95, a71
    v_cvt_pk_bf16_f32 v96, v92, v93
    v_cvt_pk_bf16_f32 v97, v94, v95
    v_add_u32 v6, 131168, v5
    buffer_store_dwordx2 v[96:97], v6, s[8:11], 0 offen
    v_accvgpr_read_b32 v92, a72
    v_accvgpr_read_b32 v93, a73
    v_accvgpr_read_b32 v94, a74
    v_accvgpr_read_b32 v95, a75
    v_cvt_pk_bf16_f32 v96, v92, v93
    v_cvt_pk_bf16_f32 v97, v94, v95
    v_add_u32 v6, 196704, v5
    buffer_store_dwordx2 v[96:97], v6, s[8:11], 0 offen
    v_accvgpr_read_b32 v92, a76
    v_accvgpr_read_b32 v93, a77
    v_accvgpr_read_b32 v94, a78
    v_accvgpr_read_b32 v95, a79
    v_cvt_pk_bf16_f32 v96, v92, v93
    v_cvt_pk_bf16_f32 v97, v94, v95
    v_add_u32 v6, 262240, v5
    buffer_store_dwordx2 v[96:97], v6, s[8:11], 0 offen
qkv_a_kernel_end:
    s_endpgm
.section .rodata,"a"
.p2align 6
.amdhsa_kernel qkv_a_kernel
  .amdhsa_next_free_vgpr 192
  .amdhsa_next_free_sgpr 64
  .amdhsa_accum_offset 112
  .amdhsa_group_segment_fixed_size 0
  .amdhsa_kernarg_size 104
  .amdhsa_user_sgpr_count 2
  .amdhsa_user_sgpr_kernarg_segment_ptr 1
  .amdhsa_system_sgpr_workgroup_id_x 1
.end_amdhsa_kernel
.text
.globl kvz_a1_kernel
.p2align 8
.type kvz_a1_kernel,@function
kvz_a1_kernel:
    v_lshrrev_b32 v1, 6, v0
    v_and_b32 v2, 63, v0
    s_nop 0
    v_readfirstlane_b32 s3, v1
    s_lshl_b32 s4, s2, 2
    s_add_u32 s4, s4, s3
    s_cmp_ge_u32 s4, 512
    s_cbranch_scc1 kvz_a1_kernel_end
    s_load_dwordx2 s[6:7], s[0:1], 96
    s_waitcnt lgkmcnt(0)
    s_mov_b32 s8, s6
    s_mov_b32 s9, s7
    s_mov_b32 s10, 268435456
    s_mov_b32 s11, 0x00020000
    s_lshr_b32 s5, s4, 4
    s_and_b32 s12, s4, 15
    s_mul_i32 s13, s5, 20
    v_and_b32 v3, 15, v2
    v_lshrrev_b32 v4, 4, v2
    s_lshl_b32 s14, s12, 7
    v_lshlrev_b32 v5, 3, v4
    v_add_u32 v5, s14, v5
    v_add_u32 v6, 0, v3
    v_min_u32 v8, 19, v6
    v_add_u32 v8, s13, v8
    v_lshlrev_b32 v8, 11, v8
    v_add_u32 v8, v8, v5
    v_lshlrev_b32 v8, 1, v8
    v_add_u32 v8, 12582912, v8
    v_add_u32 v10, 2621440, v8
    v_add_u32 v7, 16, v3
    v_min_u32 v9, 19, v7
    v_add_u32 v9, s13, v9
    v_lshlrev_b32 v9, 11, v9
    v_add_u32 v9, v9, v5
    v_lshlrev_b32 v9, 1, v9
    v_add_u32 v9, 12582912, v9
    v_add_u32 v11, 2621440, v9
    v_accvgpr_write_b32 a0, 0
    v_accvgpr_write_b32 a1, 0
    v_accvgpr_write_b32 a2, 0
    v_accvgpr_write_b32 a3, 0
    v_accvgpr_write_b32 a4, 0
    v_accvgpr_write_b32 a5, 0
    v_accvgpr_write_b32 a6, 0
    v_accvgpr_write_b32 a7, 0
    v_accvgpr_write_b32 a8, 0
    v_accvgpr_write_b32 a9, 0
    v_accvgpr_write_b32 a10, 0
    v_accvgpr_write_b32 a11, 0
    v_accvgpr_write_b32 a12, 0
    v_accvgpr_write_b32 a13, 0
    v_accvgpr_write_b32 a14, 0
    v_accvgpr_write_b32 a15, 0
    v_cmp_gt_u32 s[16:17], 20, v7
    v_cmp_eq_u32 s[18:19], 20, v7
    buffer_load_dwordx4 v[16:19], v8, s[8:11], 0 offen offset:0
    buffer_load_dwordx4 v[24:27], v10, s[8:11], 0 offen offset:0
    buffer_load_dwordx4 v[20:23], v9, s[8:11], 0 offen offset:0
    buffer_load_dwordx4 v[28:31], v11, s[8:11], 0 offen offset:0
    s_waitcnt vmcnt(0)
    v_lshlrev_b32 v32, 16, v16
    v_and_b32 v33, 0xffff0000, v16
    v_mul_f32 v36, 1.4426950408889634, v32
    v_exp_f32 v36, v36
    v_add_f32 v34, 1.0, v32
    v_cmp_lt_f32 vcc, 0, v32
    s_nop 1
    v_cndmask_b32 v34, v36, v34, vcc
    v_add_f32 v34, 0x358637bd, v34
    v_mul_f32 v36, 1.4426950408889634, v33
    v_exp_f32 v36, v36
    v_add_f32 v35, 1.0, v33
    v_cmp_lt_f32 vcc, 0, v33
    s_nop 1
    v_cndmask_b32 v35, v36, v35, vcc
    v_add_f32 v35, 0x358637bd, v35
    v_cvt_pk_bf16_f32 v16, v34, v35
    v_lshlrev_b32 v32, 16, v17
    v_and_b32 v33, 0xffff0000, v17
    v_mul_f32 v36, 1.4426950408889634, v32
    v_exp_f32 v36, v36
    v_add_f32 v34, 1.0, v32
    v_cmp_lt_f32 vcc, 0, v32
    s_nop 1
    v_cndmask_b32 v34, v36, v34, vcc
    v_add_f32 v34, 0x358637bd, v34
    v_mul_f32 v36, 1.4426950408889634, v33
    v_exp_f32 v36, v36
    v_add_f32 v35, 1.0, v33
    v_cmp_lt_f32 vcc, 0, v33
    s_nop 1
    v_cndmask_b32 v35, v36, v35, vcc
    v_add_f32 v35, 0x358637bd, v35
    v_cvt_pk_bf16_f32 v17, v34, v35
    v_lshlrev_b32 v32, 16, v18
    v_and_b32 v33, 0xffff0000, v18
    v_mul_f32 v36, 1.4426950408889634, v32
    v_exp_f32 v36, v36
    v_add_f32 v34, 1.0, v32
    v_cmp_lt_f32 vcc, 0, v32
    s_nop 1
    v_cndmask_b32 v34, v36, v34, vcc
    v_add_f32 v34, 0x358637bd, v34
    v_mul_f32 v36, 1.4426950408889634, v33
    v_exp_f32 v36, v36
    v_add_f32 v35, 1.0, v33
    v_cmp_lt_f32 vcc, 0, v33
    s_nop 1
    v_cndmask_b32 v35, v36, v35, vcc
    v_add_f32 v35, 0x358637bd, v35
    v_cvt_pk_bf16_f32 v18, v34, v35
    v_lshlrev_b32 v32, 16, v19
    v_and_b32 v33, 0xffff0000, v19
    v_mul_f32 v36, 1.4426950408889634, v32
    v_exp_f32 v36, v36
    v_add_f32 v34, 1.0, v32
    v_cmp_lt_f32 vcc, 0, v32
    s_nop 1
    v_cndmask_b32 v34, v36, v34, vcc
    v_add_f32 v34, 0x358637bd, v34
    v_mul_f32 v36, 1.4426950408889634, v33
    v_exp_f32 v36, v36
    v_add_f32 v35, 1.0, v33
    v_cmp_lt_f32 vcc, 0, v33
    s_nop 1
    v_cndmask_b32 v35, v36, v35, vcc
    v_add_f32 v35, 0x358637bd, v35
    v_cvt_pk_bf16_f32 v19, v34, v35
    v_lshlrev_b32 v32, 16, v20
    v_and_b32 v33, 0xffff0000, v20
    v_mul_f32 v36, 1.4426950408889634, v32
    v_exp_f32 v36, v36
    v_add_f32 v34, 1.0, v32
    v_cmp_lt_f32 vcc, 0, v32
    s_nop 1
    v_cndmask_b32 v34, v36, v34, vcc
    v_add_f32 v34, 0x358637bd, v34
    v_mul_f32 v36, 1.4426950408889634, v33
    v_exp_f32 v36, v36
    v_add_f32 v35, 1.0, v33
    v_cmp_lt_f32 vcc, 0, v33
    s_nop 1
    v_cndmask_b32 v35, v36, v35, vcc
    v_add_f32 v35, 0x358637bd, v35
    v_cvt_pk_bf16_f32 v20, v34, v35
    v_lshlrev_b32 v32, 16, v21
    v_and_b32 v33, 0xffff0000, v21
    v_mul_f32 v36, 1.4426950408889634, v32
    v_exp_f32 v36, v36
    v_add_f32 v34, 1.0, v32
    v_cmp_lt_f32 vcc, 0, v32
    s_nop 1
    v_cndmask_b32 v34, v36, v34, vcc
    v_add_f32 v34, 0x358637bd, v34
    v_mul_f32 v36, 1.4426950408889634, v33
    v_exp_f32 v36, v36
    v_add_f32 v35, 1.0, v33
    v_cmp_lt_f32 vcc, 0, v33
    s_nop 1
    v_cndmask_b32 v35, v36, v35, vcc
    v_add_f32 v35, 0x358637bd, v35
    v_cvt_pk_bf16_f32 v21, v34, v35
    v_lshlrev_b32 v32, 16, v22
    v_and_b32 v33, 0xffff0000, v22
    v_mul_f32 v36, 1.4426950408889634, v32
    v_exp_f32 v36, v36
    v_add_f32 v34, 1.0, v32
    v_cmp_lt_f32 vcc, 0, v32
    s_nop 1
    v_cndmask_b32 v34, v36, v34, vcc
    v_add_f32 v34, 0x358637bd, v34
    v_mul_f32 v36, 1.4426950408889634, v33
    v_exp_f32 v36, v36
    v_add_f32 v35, 1.0, v33
    v_cmp_lt_f32 vcc, 0, v33
    s_nop 1
    v_cndmask_b32 v35, v36, v35, vcc
    v_add_f32 v35, 0x358637bd, v35
    v_cvt_pk_bf16_f32 v22, v34, v35
    v_lshlrev_b32 v32, 16, v23
    v_and_b32 v33, 0xffff0000, v23
    v_mul_f32 v36, 1.4426950408889634, v32
    v_exp_f32 v36, v36
    v_add_f32 v34, 1.0, v32
    v_cmp_lt_f32 vcc, 0, v32
    s_nop 1
    v_cndmask_b32 v34, v36, v34, vcc
    v_add_f32 v34, 0x358637bd, v34
    v_mul_f32 v36, 1.4426950408889634, v33
    v_exp_f32 v36, v36
    v_add_f32 v35, 1.0, v33
    v_cmp_lt_f32 vcc, 0, v33
    s_nop 1
    v_cndmask_b32 v35, v36, v35, vcc
    v_add_f32 v35, 0x358637bd, v35
    v_cvt_pk_bf16_f32 v23, v34, v35
    v_mov_b32 v37, 0x3f803f80
    v_cndmask_b32 v20, 0, v20, s[16:17]
    v_cndmask_b32 v28, 0, v28, s[16:17]
    v_cndmask_b32 v28, v28, v37, s[18:19]
    v_cndmask_b32 v21, 0, v21, s[16:17]
    v_cndmask_b32 v29, 0, v29, s[16:17]
    v_cndmask_b32 v29, v29, v37, s[18:19]
    v_cndmask_b32 v22, 0, v22, s[16:17]
    v_cndmask_b32 v30, 0, v30, s[16:17]
    v_cndmask_b32 v30, v30, v37, s[18:19]
    v_cndmask_b32 v23, 0, v23, s[16:17]
    v_cndmask_b32 v31, 0, v31, s[16:17]
    v_cndmask_b32 v31, v31, v37, s[18:19]
    s_nop 1
    v_mfma_f32_16x16x32_bf16 a[0:3], v[24:27], v[16:19], a[0:3]
    v_mfma_f32_16x16x32_bf16 a[4:7], v[24:27], v[20:23], a[4:7]
    v_mfma_f32_16x16x32_bf16 a[8:11], v[28:31], v[16:19], a[8:11]
    v_mfma_f32_16x16x32_bf16 a[12:15], v[28:31], v[20:23], a[12:15]
    buffer_load_dwordx4 v[16:19], v8, s[8:11], 0 offen offset:64
    buffer_load_dwordx4 v[24:27], v10, s[8:11], 0 offen offset:64
    buffer_load_dwordx4 v[20:23], v9, s[8:11], 0 offen offset:64
    buffer_load_dwordx4 v[28:31], v11, s[8:11], 0 offen offset:64
    s_waitcnt vmcnt(0)
    v_lshlrev_b32 v32, 16, v16
    v_and_b32 v33, 0xffff0000, v16
    v_mul_f32 v36, 1.4426950408889634, v32
    v_exp_f32 v36, v36
    v_add_f32 v34, 1.0, v32
    v_cmp_lt_f32 vcc, 0, v32
    s_nop 1
    v_cndmask_b32 v34, v36, v34, vcc
    v_add_f32 v34, 0x358637bd, v34
    v_mul_f32 v36, 1.4426950408889634, v33
    v_exp_f32 v36, v36
    v_add_f32 v35, 1.0, v33
    v_cmp_lt_f32 vcc, 0, v33
    s_nop 1
    v_cndmask_b32 v35, v36, v35, vcc
    v_add_f32 v35, 0x358637bd, v35
    v_cvt_pk_bf16_f32 v16, v34, v35
    v_lshlrev_b32 v32, 16, v17
    v_and_b32 v33, 0xffff0000, v17
    v_mul_f32 v36, 1.4426950408889634, v32
    v_exp_f32 v36, v36
    v_add_f32 v34, 1.0, v32
    v_cmp_lt_f32 vcc, 0, v32
    s_nop 1
    v_cndmask_b32 v34, v36, v34, vcc
    v_add_f32 v34, 0x358637bd, v34
    v_mul_f32 v36, 1.4426950408889634, v33
    v_exp_f32 v36, v36
    v_add_f32 v35, 1.0, v33
    v_cmp_lt_f32 vcc, 0, v33
    s_nop 1
    v_cndmask_b32 v35, v36, v35, vcc
    v_add_f32 v35, 0x358637bd, v35
    v_cvt_pk_bf16_f32 v17, v34, v35
    v_lshlrev_b32 v32, 16, v18
    v_and_b32 v33, 0xffff0000, v18
    v_mul_f32 v36, 1.4426950408889634, v32
    v_exp_f32 v36, v36
    v_add_f32 v34, 1.0, v32
    v_cmp_lt_f32 vcc, 0, v32
    s_nop 1
    v_cndmask_b32 v34, v36, v34, vcc
    v_add_f32 v34, 0x358637bd, v34
    v_mul_f32 v36, 1.4426950408889634, v33
    v_exp_f32 v36, v36
    v_add_f32 v35, 1.0, v33
    v_cmp_lt_f32 vcc, 0, v33
    s_nop 1
    v_cndmask_b32 v35, v36, v35, vcc
    v_add_f32 v35, 0x358637bd, v35
    v_cvt_pk_bf16_f32 v18, v34, v35
    v_lshlrev_b32 v32, 16, v19
    v_and_b32 v33, 0xffff0000, v19
    v_mul_f32 v36, 1.4426950408889634, v32
    v_exp_f32 v36, v36
    v_add_f32 v34, 1.0, v32
    v_cmp_lt_f32 vcc, 0, v32
    s_nop 1
    v_cndmask_b32 v34, v36, v34, vcc
    v_add_f32 v34, 0x358637bd, v34
    v_mul_f32 v36, 1.4426950408889634, v33
    v_exp_f32 v36, v36
    v_add_f32 v35, 1.0, v33
    v_cmp_lt_f32 vcc, 0, v33
    s_nop 1
    v_cndmask_b32 v35, v36, v35, vcc
    v_add_f32 v35, 0x358637bd, v35
    v_cvt_pk_bf16_f32 v19, v34, v35
    v_lshlrev_b32 v32, 16, v20
    v_and_b32 v33, 0xffff0000, v20
    v_mul_f32 v36, 1.4426950408889634, v32
    v_exp_f32 v36, v36
    v_add_f32 v34, 1.0, v32
    v_cmp_lt_f32 vcc, 0, v32
    s_nop 1
    v_cndmask_b32 v34, v36, v34, vcc
    v_add_f32 v34, 0x358637bd, v34
    v_mul_f32 v36, 1.4426950408889634, v33
    v_exp_f32 v36, v36
    v_add_f32 v35, 1.0, v33
    v_cmp_lt_f32 vcc, 0, v33
    s_nop 1
    v_cndmask_b32 v35, v36, v35, vcc
    v_add_f32 v35, 0x358637bd, v35
    v_cvt_pk_bf16_f32 v20, v34, v35
    v_lshlrev_b32 v32, 16, v21
    v_and_b32 v33, 0xffff0000, v21
    v_mul_f32 v36, 1.4426950408889634, v32
    v_exp_f32 v36, v36
    v_add_f32 v34, 1.0, v32
    v_cmp_lt_f32 vcc, 0, v32
    s_nop 1
    v_cndmask_b32 v34, v36, v34, vcc
    v_add_f32 v34, 0x358637bd, v34
    v_mul_f32 v36, 1.4426950408889634, v33
    v_exp_f32 v36, v36
    v_add_f32 v35, 1.0, v33
    v_cmp_lt_f32 vcc, 0, v33
    s_nop 1
    v_cndmask_b32 v35, v36, v35, vcc
    v_add_f32 v35, 0x358637bd, v35
    v_cvt_pk_bf16_f32 v21, v34, v35
    v_lshlrev_b32 v32, 16, v22
    v_and_b32 v33, 0xffff0000, v22
    v_mul_f32 v36, 1.4426950408889634, v32
    v_exp_f32 v36, v36
    v_add_f32 v34, 1.0, v32
    v_cmp_lt_f32 vcc, 0, v32
    s_nop 1
    v_cndmask_b32 v34, v36, v34, vcc
    v_add_f32 v34, 0x358637bd, v34
    v_mul_f32 v36, 1.4426950408889634, v33
    v_exp_f32 v36, v36
    v_add_f32 v35, 1.0, v33
    v_cmp_lt_f32 vcc, 0, v33
    s_nop 1
    v_cndmask_b32 v35, v36, v35, vcc
    v_add_f32 v35, 0x358637bd, v35
    v_cvt_pk_bf16_f32 v22, v34, v35
    v_lshlrev_b32 v32, 16, v23
    v_and_b32 v33, 0xffff0000, v23
    v_mul_f32 v36, 1.4426950408889634, v32
    v_exp_f32 v36, v36
    v_add_f32 v34, 1.0, v32
    v_cmp_lt_f32 vcc, 0, v32
    s_nop 1
    v_cndmask_b32 v34, v36, v34, vcc
    v_add_f32 v34, 0x358637bd, v34
    v_mul_f32 v36, 1.4426950408889634, v33
    v_exp_f32 v36, v36
    v_add_f32 v35, 1.0, v33
    v_cmp_lt_f32 vcc, 0, v33
    s_nop 1
    v_cndmask_b32 v35, v36, v35, vcc
    v_add_f32 v35, 0x358637bd, v35
    v_cvt_pk_bf16_f32 v23, v34, v35
    v_mov_b32 v37, 0x3f803f80
    v_cndmask_b32 v20, 0, v20, s[16:17]
    v_cndmask_b32 v28, 0, v28, s[16:17]
    v_cndmask_b32 v28, v28, v37, s[18:19]
    v_cndmask_b32 v21, 0, v21, s[16:17]
    v_cndmask_b32 v29, 0, v29, s[16:17]
    v_cndmask_b32 v29, v29, v37, s[18:19]
    v_cndmask_b32 v22, 0, v22, s[16:17]
    v_cndmask_b32 v30, 0, v30, s[16:17]
    v_cndmask_b32 v30, v30, v37, s[18:19]
    v_cndmask_b32 v23, 0, v23, s[16:17]
    v_cndmask_b32 v31, 0, v31, s[16:17]
    v_cndmask_b32 v31, v31, v37, s[18:19]
    s_nop 1
    v_mfma_f32_16x16x32_bf16 a[0:3], v[24:27], v[16:19], a[0:3]
    v_mfma_f32_16x16x32_bf16 a[4:7], v[24:27], v[20:23], a[4:7]
    v_mfma_f32_16x16x32_bf16 a[8:11], v[28:31], v[16:19], a[8:11]
    v_mfma_f32_16x16x32_bf16 a[12:15], v[28:31], v[20:23], a[12:15]
    buffer_load_dwordx4 v[16:19], v8, s[8:11], 0 offen offset:128
    buffer_load_dwordx4 v[24:27], v10, s[8:11], 0 offen offset:128
    buffer_load_dwordx4 v[20:23], v9, s[8:11], 0 offen offset:128
    buffer_load_dwordx4 v[28:31], v11, s[8:11], 0 offen offset:128
    s_waitcnt vmcnt(0)
    v_lshlrev_b32 v32, 16, v16
    v_and_b32 v33, 0xffff0000, v16
    v_mul_f32 v36, 1.4426950408889634, v32
    v_exp_f32 v36, v36
    v_add_f32 v34, 1.0, v32
    v_cmp_lt_f32 vcc, 0, v32
    s_nop 1
    v_cndmask_b32 v34, v36, v34, vcc
    v_add_f32 v34, 0x358637bd, v34
    v_mul_f32 v36, 1.4426950408889634, v33
    v_exp_f32 v36, v36
    v_add_f32 v35, 1.0, v33
    v_cmp_lt_f32 vcc, 0, v33
    s_nop 1
    v_cndmask_b32 v35, v36, v35, vcc
    v_add_f32 v35, 0x358637bd, v35
    v_cvt_pk_bf16_f32 v16, v34, v35
    v_lshlrev_b32 v32, 16, v17
    v_and_b32 v33, 0xffff0000, v17
    v_mul_f32 v36, 1.4426950408889634, v32
    v_exp_f32 v36, v36
    v_add_f32 v34, 1.0, v32
    v_cmp_lt_f32 vcc, 0, v32
    s_nop 1
    v_cndmask_b32 v34, v36, v34, vcc
    v_add_f32 v34, 0x358637bd, v34
    v_mul_f32 v36, 1.4426950408889634, v33
    v_exp_f32 v36, v36
    v_add_f32 v35, 1.0, v33
    v_cmp_lt_f32 vcc, 0, v33
    s_nop 1
    v_cndmask_b32 v35, v36, v35, vcc
    v_add_f32 v35, 0x358637bd, v35
    v_cvt_pk_bf16_f32 v17, v34, v35
    v_lshlrev_b32 v32, 16, v18
    v_and_b32 v33, 0xffff0000, v18
    v_mul_f32 v36, 1.4426950408889634, v32
    v_exp_f32 v36, v36
    v_add_f32 v34, 1.0, v32
    v_cmp_lt_f32 vcc, 0, v32
    s_nop 1
    v_cndmask_b32 v34, v36, v34, vcc
    v_add_f32 v34, 0x358637bd, v34
    v_mul_f32 v36, 1.4426950408889634, v33
    v_exp_f32 v36, v36
    v_add_f32 v35, 1.0, v33
    v_cmp_lt_f32 vcc, 0, v33
    s_nop 1
    v_cndmask_b32 v35, v36, v35, vcc
    v_add_f32 v35, 0x358637bd, v35
    v_cvt_pk_bf16_f32 v18, v34, v35
    v_lshlrev_b32 v32, 16, v19
    v_and_b32 v33, 0xffff0000, v19
    v_mul_f32 v36, 1.4426950408889634, v32
    v_exp_f32 v36, v36
    v_add_f32 v34, 1.0, v32
    v_cmp_lt_f32 vcc, 0, v32
    s_nop 1
    v_cndmask_b32 v34, v36, v34, vcc
    v_add_f32 v34, 0x358637bd, v34
    v_mul_f32 v36, 1.4426950408889634, v33
    v_exp_f32 v36, v36
    v_add_f32 v35, 1.0, v33
    v_cmp_lt_f32 vcc, 0, v33
    s_nop 1
    v_cndmask_b32 v35, v36, v35, vcc
    v_add_f32 v35, 0x358637bd, v35
    v_cvt_pk_bf16_f32 v19, v34, v35
    v_lshlrev_b32 v32, 16, v20
    v_and_b32 v33, 0xffff0000, v20
    v_mul_f32 v36, 1.4426950408889634, v32
    v_exp_f32 v36, v36
    v_add_f32 v34, 1.0, v32
    v_cmp_lt_f32 vcc, 0, v32
    s_nop 1
    v_cndmask_b32 v34, v36, v34, vcc
    v_add_f32 v34, 0x358637bd, v34
    v_mul_f32 v36, 1.4426950408889634, v33
    v_exp_f32 v36, v36
    v_add_f32 v35, 1.0, v33
    v_cmp_lt_f32 vcc, 0, v33
    s_nop 1
    v_cndmask_b32 v35, v36, v35, vcc
    v_add_f32 v35, 0x358637bd, v35
    v_cvt_pk_bf16_f32 v20, v34, v35
    v_lshlrev_b32 v32, 16, v21
    v_and_b32 v33, 0xffff0000, v21
    v_mul_f32 v36, 1.4426950408889634, v32
    v_exp_f32 v36, v36
    v_add_f32 v34, 1.0, v32
    v_cmp_lt_f32 vcc, 0, v32
    s_nop 1
    v_cndmask_b32 v34, v36, v34, vcc
    v_add_f32 v34, 0x358637bd, v34
    v_mul_f32 v36, 1.4426950408889634, v33
    v_exp_f32 v36, v36
    v_add_f32 v35, 1.0, v33
    v_cmp_lt_f32 vcc, 0, v33
    s_nop 1
    v_cndmask_b32 v35, v36, v35, vcc
    v_add_f32 v35, 0x358637bd, v35
    v_cvt_pk_bf16_f32 v21, v34, v35
    v_lshlrev_b32 v32, 16, v22
    v_and_b32 v33, 0xffff0000, v22
    v_mul_f32 v36, 1.4426950408889634, v32
    v_exp_f32 v36, v36
    v_add_f32 v34, 1.0, v32
    v_cmp_lt_f32 vcc, 0, v32
    s_nop 1
    v_cndmask_b32 v34, v36, v34, vcc
    v_add_f32 v34, 0x358637bd, v34
    v_mul_f32 v36, 1.4426950408889634, v33
    v_exp_f32 v36, v36
    v_add_f32 v35, 1.0, v33
    v_cmp_lt_f32 vcc, 0, v33
    s_nop 1
    v_cndmask_b32 v35, v36, v35, vcc
    v_add_f32 v35, 0x358637bd, v35
    v_cvt_pk_bf16_f32 v22, v34, v35
    v_lshlrev_b32 v32, 16, v23
    v_and_b32 v33, 0xffff0000, v23
    v_mul_f32 v36, 1.4426950408889634, v32
    v_exp_f32 v36, v36
    v_add_f32 v34, 1.0, v32
    v_cmp_lt_f32 vcc, 0, v32
    s_nop 1
    v_cndmask_b32 v34, v36, v34, vcc
    v_add_f32 v34, 0x358637bd, v34
    v_mul_f32 v36, 1.4426950408889634, v33
    v_exp_f32 v36, v36
    v_add_f32 v35, 1.0, v33
    v_cmp_lt_f32 vcc, 0, v33
    s_nop 1
    v_cndmask_b32 v35, v36, v35, vcc
    v_add_f32 v35, 0x358637bd, v35
    v_cvt_pk_bf16_f32 v23, v34, v35
    v_mov_b32 v37, 0x3f803f80
    v_cndmask_b32 v20, 0, v20, s[16:17]
    v_cndmask_b32 v28, 0, v28, s[16:17]
    v_cndmask_b32 v28, v28, v37, s[18:19]
    v_cndmask_b32 v21, 0, v21, s[16:17]
    v_cndmask_b32 v29, 0, v29, s[16:17]
    v_cndmask_b32 v29, v29, v37, s[18:19]
    v_cndmask_b32 v22, 0, v22, s[16:17]
    v_cndmask_b32 v30, 0, v30, s[16:17]
    v_cndmask_b32 v30, v30, v37, s[18:19]
    v_cndmask_b32 v23, 0, v23, s[16:17]
    v_cndmask_b32 v31, 0, v31, s[16:17]
    v_cndmask_b32 v31, v31, v37, s[18:19]
    s_nop 1
    v_mfma_f32_16x16x32_bf16 a[0:3], v[24:27], v[16:19], a[0:3]
    v_mfma_f32_16x16x32_bf16 a[4:7], v[24:27], v[20:23], a[4:7]
    v_mfma_f32_16x16x32_bf16 a[8:11], v[28:31], v[16:19], a[8:11]
    v_mfma_f32_16x16x32_bf16 a[12:15], v[28:31], v[20:23], a[12:15]
    buffer_load_dwordx4 v[16:19], v8, s[8:11], 0 offen offset:192
    buffer_load_dwordx4 v[24:27], v10, s[8:11], 0 offen offset:192
    buffer_load_dwordx4 v[20:23], v9, s[8:11], 0 offen offset:192
    buffer_load_dwordx4 v[28:31], v11, s[8:11], 0 offen offset:192
    s_waitcnt vmcnt(0)
    v_lshlrev_b32 v32, 16, v16
    v_and_b32 v33, 0xffff0000, v16
    v_mul_f32 v36, 1.4426950408889634, v32
    v_exp_f32 v36, v36
    v_add_f32 v34, 1.0, v32
    v_cmp_lt_f32 vcc, 0, v32
    s_nop 1
    v_cndmask_b32 v34, v36, v34, vcc
    v_add_f32 v34, 0x358637bd, v34
    v_mul_f32 v36, 1.4426950408889634, v33
    v_exp_f32 v36, v36
    v_add_f32 v35, 1.0, v33
    v_cmp_lt_f32 vcc, 0, v33
    s_nop 1
    v_cndmask_b32 v35, v36, v35, vcc
    v_add_f32 v35, 0x358637bd, v35
    v_cvt_pk_bf16_f32 v16, v34, v35
    v_lshlrev_b32 v32, 16, v17
    v_and_b32 v33, 0xffff0000, v17
    v_mul_f32 v36, 1.4426950408889634, v32
    v_exp_f32 v36, v36
    v_add_f32 v34, 1.0, v32
    v_cmp_lt_f32 vcc, 0, v32
    s_nop 1
    v_cndmask_b32 v34, v36, v34, vcc
    v_add_f32 v34, 0x358637bd, v34
    v_mul_f32 v36, 1.4426950408889634, v33
    v_exp_f32 v36, v36
    v_add_f32 v35, 1.0, v33
    v_cmp_lt_f32 vcc, 0, v33
    s_nop 1
    v_cndmask_b32 v35, v36, v35, vcc
    v_add_f32 v35, 0x358637bd, v35
    v_cvt_pk_bf16_f32 v17, v34, v35
    v_lshlrev_b32 v32, 16, v18
    v_and_b32 v33, 0xffff0000, v18
    v_mul_f32 v36, 1.4426950408889634, v32
    v_exp_f32 v36, v36
    v_add_f32 v34, 1.0, v32
    v_cmp_lt_f32 vcc, 0, v32
    s_nop 1
    v_cndmask_b32 v34, v36, v34, vcc
    v_add_f32 v34, 0x358637bd, v34
    v_mul_f32 v36, 1.4426950408889634, v33
    v_exp_f32 v36, v36
    v_add_f32 v35, 1.0, v33
    v_cmp_lt_f32 vcc, 0, v33
    s_nop 1
    v_cndmask_b32 v35, v36, v35, vcc
    v_add_f32 v35, 0x358637bd, v35
    v_cvt_pk_bf16_f32 v18, v34, v35
    v_lshlrev_b32 v32, 16, v19
    v_and_b32 v33, 0xffff0000, v19
    v_mul_f32 v36, 1.4426950408889634, v32
    v_exp_f32 v36, v36
    v_add_f32 v34, 1.0, v32
    v_cmp_lt_f32 vcc, 0, v32
    s_nop 1
    v_cndmask_b32 v34, v36, v34, vcc
    v_add_f32 v34, 0x358637bd, v34
    v_mul_f32 v36, 1.4426950408889634, v33
    v_exp_f32 v36, v36
    v_add_f32 v35, 1.0, v33
    v_cmp_lt_f32 vcc, 0, v33
    s_nop 1
    v_cndmask_b32 v35, v36, v35, vcc
    v_add_f32 v35, 0x358637bd, v35
    v_cvt_pk_bf16_f32 v19, v34, v35
    v_lshlrev_b32 v32, 16, v20
    v_and_b32 v33, 0xffff0000, v20
    v_mul_f32 v36, 1.4426950408889634, v32
    v_exp_f32 v36, v36
    v_add_f32 v34, 1.0, v32
    v_cmp_lt_f32 vcc, 0, v32
    s_nop 1
    v_cndmask_b32 v34, v36, v34, vcc
    v_add_f32 v34, 0x358637bd, v34
    v_mul_f32 v36, 1.4426950408889634, v33
    v_exp_f32 v36, v36
    v_add_f32 v35, 1.0, v33
    v_cmp_lt_f32 vcc, 0, v33
    s_nop 1
    v_cndmask_b32 v35, v36, v35, vcc
    v_add_f32 v35, 0x358637bd, v35
    v_cvt_pk_bf16_f32 v20, v34, v35
    v_lshlrev_b32 v32, 16, v21
    v_and_b32 v33, 0xffff0000, v21
    v_mul_f32 v36, 1.4426950408889634, v32
    v_exp_f32 v36, v36
    v_add_f32 v34, 1.0, v32
    v_cmp_lt_f32 vcc, 0, v32
    s_nop 1
    v_cndmask_b32 v34, v36, v34, vcc
    v_add_f32 v34, 0x358637bd, v34
    v_mul_f32 v36, 1.4426950408889634, v33
    v_exp_f32 v36, v36
    v_add_f32 v35, 1.0, v33
    v_cmp_lt_f32 vcc, 0, v33
    s_nop 1
    v_cndmask_b32 v35, v36, v35, vcc
    v_add_f32 v35, 0x358637bd, v35
    v_cvt_pk_bf16_f32 v21, v34, v35
    v_lshlrev_b32 v32, 16, v22
    v_and_b32 v33, 0xffff0000, v22
    v_mul_f32 v36, 1.4426950408889634, v32
    v_exp_f32 v36, v36
    v_add_f32 v34, 1.0, v32
    v_cmp_lt_f32 vcc, 0, v32
    s_nop 1
    v_cndmask_b32 v34, v36, v34, vcc
    v_add_f32 v34, 0x358637bd, v34
    v_mul_f32 v36, 1.4426950408889634, v33
    v_exp_f32 v36, v36
    v_add_f32 v35, 1.0, v33
    v_cmp_lt_f32 vcc, 0, v33
    s_nop 1
    v_cndmask_b32 v35, v36, v35, vcc
    v_add_f32 v35, 0x358637bd, v35
    v_cvt_pk_bf16_f32 v22, v34, v35
    v_lshlrev_b32 v32, 16, v23
    v_and_b32 v33, 0xffff0000, v23
    v_mul_f32 v36, 1.4426950408889634, v32
    v_exp_f32 v36, v36
    v_add_f32 v34, 1.0, v32
    v_cmp_lt_f32 vcc, 0, v32
    s_nop 1
    v_cndmask_b32 v34, v36, v34, vcc
    v_add_f32 v34, 0x358637bd, v34
    v_mul_f32 v36, 1.4426950408889634, v33
    v_exp_f32 v36, v36
    v_add_f32 v35, 1.0, v33
    v_cmp_lt_f32 vcc, 0, v33
    s_nop 1
    v_cndmask_b32 v35, v36, v35, vcc
    v_add_f32 v35, 0x358637bd, v35
    v_cvt_pk_bf16_f32 v23, v34, v35
    v_mov_b32 v37, 0x3f803f80
    v_cndmask_b32 v20, 0, v20, s[16:17]
    v_cndmask_b32 v28, 0, v28, s[16:17]
    v_cndmask_b32 v28, v28, v37, s[18:19]
    v_cndmask_b32 v21, 0, v21, s[16:17]
    v_cndmask_b32 v29, 0, v29, s[16:17]
    v_cndmask_b32 v29, v29, v37, s[18:19]
    v_cndmask_b32 v22, 0, v22, s[16:17]
    v_cndmask_b32 v30, 0, v30, s[16:17]
    v_cndmask_b32 v30, v30, v37, s[18:19]
    v_cndmask_b32 v23, 0, v23, s[16:17]
    v_cndmask_b32 v31, 0, v31, s[16:17]
    v_cndmask_b32 v31, v31, v37, s[18:19]
    s_nop 1
    v_mfma_f32_16x16x32_bf16 a[0:3], v[24:27], v[16:19], a[0:3]
    v_mfma_f32_16x16x32_bf16 a[4:7], v[24:27], v[20:23], a[4:7]
    v_mfma_f32_16x16x32_bf16 a[8:11], v[28:31], v[16:19], a[8:11]
    v_mfma_f32_16x16x32_bf16 a[12:15], v[28:31], v[20:23], a[12:15]
    s_nop 7
    s_nop 7
    v_lshlrev_b32 v5, 2, v4
    v_lshlrev_b32 v5, 5, v5
    v_add_u32 v5, v5, v3
    v_lshlrev_b32 v5, 2, v5
    s_lshl_b32 s14, s5, 12
    s_add_u32 s14, s14, 23068672
    v_add_u32 v5, s14, v5
    v_accvgpr_read_b32 v40, a0
    v_accvgpr_read_b32 v41, a1
    v_accvgpr_read_b32 v42, a2
    v_accvgpr_read_b32 v43, a3
    buffer_atomic_add_f32 v40, v5, s[8:11], 0 offen offset:0
    buffer_atomic_add_f32 v41, v5, s[8:11], 0 offen offset:128
    buffer_atomic_add_f32 v42, v5, s[8:11], 0 offen offset:256
    buffer_atomic_add_f32 v43, v5, s[8:11], 0 offen offset:384
    v_accvgpr_read_b32 v40, a4
    v_accvgpr_read_b32 v41, a5
    v_accvgpr_read_b32 v42, a6
    v_accvgpr_read_b32 v43, a7
    buffer_atomic_add_f32 v40, v5, s[8:11], 0 offen offset:64
    buffer_atomic_add_f32 v41, v5, s[8:11], 0 offen offset:192
    buffer_atomic_add_f32 v42, v5, s[8:11], 0 offen offset:320
    buffer_atomic_add_f32 v43, v5, s[8:11], 0 offen offset:448
    v_accvgpr_read_b32 v40, a8
    v_accvgpr_read_b32 v41, a9
    v_accvgpr_read_b32 v42, a10
    v_accvgpr_read_b32 v43, a11
    buffer_atomic_add_f32 v40, v5, s[8:11], 0 offen offset:2048
    buffer_atomic_add_f32 v41, v5, s[8:11], 0 offen offset:2176
    buffer_atomic_add_f32 v42, v5, s[8:11], 0 offen offset:2304
    buffer_atomic_add_f32 v43, v5, s[8:11], 0 offen offset:2432
    v_accvgpr_read_b32 v40, a12
    v_accvgpr_read_b32 v41, a13
    v_accvgpr_read_b32 v42, a14
    v_accvgpr_read_b32 v43, a15
    buffer_atomic_add_f32 v40, v5, s[8:11], 0 offen offset:2112
    buffer_atomic_add_f32 v41, v5, s[8:11], 0 offen offset:2240
    buffer_atomic_add_f32 v42, v5, s[8:11], 0 offen offset:2368
    buffer_atomic_add_f32 v43, v5, s[8:11], 0 offen offset:2496
kvz_a1_kernel_end:
    s_endpgm
.section .rodata,"a"
.p2align 6
.amdhsa_kernel kvz_a1_kernel
  .amdhsa_next_free_vgpr 80
  .amdhsa_next_free_sgpr 40
  .amdhsa_accum_offset 64
  .amdhsa_group_segment_fixed_size 0
  .amdhsa_kernarg_size 104
  .amdhsa_user_sgpr_count 2
  .amdhsa_user_sgpr_kernarg_segment_ptr 1
  .amdhsa_system_sgpr_workgroup_id_x 1
.end_amdhsa_kernel
.text
.globl attn_a1_kernel
.p2align 8
.type attn_a1_kernel,@function
attn_a1_kernel:
    s_cmp_ge_u32 s2, 256
    s_cbranch_scc1 attn_a1_kernel_end
    s_load_dwordx2 s[6:7], s[0:1], 96
    s_waitcnt lgkmcnt(0)
    s_mov_b32 s8, s6
    s_mov_b32 s9, s7
    s_mov_b32 s10, 268435456
    s_mov_b32 s11, 0x00020000
    v_mov_b32 v1, v0
    v_add_u32 v2, 0, v1
    s_mov_b32 s12, 3121
    v_mul_lo_u32 v3, v2, s12
    v_lshrrev_b32 v3, 19, v3
    v_mul_u32_u24 v4, 168, v3
    v_sub_u32 v4, v2, v4
    v_lshlrev_b32 v5, 12, v3
    v_lshlrev_b32 v6, 4, v4
    v_add_u32 v5, v5, v6
    v_add_u32 v5, 23068672, v5
    buffer_load_dwordx4 v[8:11], v5, s[8:11], 0 offen
    v_mul_u32_u24 v7, 2688, v3
    v_add_u32 v7, v7, v6
    s_waitcnt vmcnt(0)
    ds_write_b128 v7, v[8:11]
    v_add_u32 v2, 256, v1
    s_mov_b32 s12, 3121
    v_mul_lo_u32 v3, v2, s12
    v_lshrrev_b32 v3, 19, v3
    v_mul_u32_u24 v4, 168, v3
    v_sub_u32 v4, v2, v4
    v_lshlrev_b32 v5, 12, v3
    v_lshlrev_b32 v6, 4, v4
    v_add_u32 v5, v5, v6
    v_add_u32 v5, 23068672, v5
    buffer_load_dwordx4 v[8:11], v5, s[8:11], 0 offen
    v_mul_u32_u24 v7, 2688, v3
    v_add_u32 v7, v7, v6
    s_waitcnt vmcnt(0)
    ds_write_b128 v7, v[8:11]
    v_add_u32 v2, 512, v1
    s_mov_b32 s12, 3121
    v_mul_lo_u32 v3, v2, s12
    v_lshrrev_b32 v3, 19, v3
    v_mul_u32_u24 v4, 168, v3
    v_sub_u32 v4, v2, v4
    v_lshlrev_b32 v5, 12, v3
    v_lshlrev_b32 v6, 4, v4
    v_add_u32 v5, v5, v6
    v_add_u32 v5, 23068672, v5
    buffer_load_dwordx4 v[8:11], v5, s[8:11], 0 offen
    v_mul_u32_u24 v7, 2688, v3
    v_add_u32 v7, v7, v6
    s_waitcnt vmcnt(0)
    ds_write_b128 v7, v[8:11]
    v_add_u32 v2, 768, v1
    s_mov_b32 s12, 3121
    v_mul_lo_u32 v3, v2, s12
    v_lshrrev_b32 v3, 19, v3
    v_mul_u32_u24 v4, 168, v3
    v_sub_u32 v4, v2, v4
    v_lshlrev_b32 v5, 12, v3
    v_lshlrev_b32 v6, 4, v4
    v_add_u32 v5, v5, v6
    v_add_u32 v5, 23068672, v5
    buffer_load_dwordx4 v[8:11], v5, s[8:11], 0 offen
    v_mul_u32_u24 v7, 2688, v3
    v_add_u32 v7, v7, v6
    s_waitcnt vmcnt(0)
    ds_write_b128 v7, v[8:11]
    v_add_u32 v2, 1024, v1
    s_mov_b32 s12, 3121
    v_mul_lo_u32 v3, v2, s12
    v_lshrrev_b32 v3, 19, v3
    v_mul_u32_u24 v4, 168, v3
    v_sub_u32 v4, v2, v4
    v_lshlrev_b32 v5, 12, v3
    v_lshlrev_b32 v6, 4, v4
    v_add_u32 v5, v5, v6
    v_add_u32 v5, 23068672, v5
    buffer_load_dwordx4 v[8:11], v5, s[8:11], 0 offen
    v_mul_u32_u24 v7, 2688, v3
    v_add_u32 v7, v7, v6
    s_waitcnt vmcnt(0)
    ds_write_b128 v7, v[8:11]
    v_add_u32 v2, 1280, v1
    s_mov_b32 s12, 3121
    v_mul_lo_u32 v3, v2, s12
    v_lshrrev_b32 v3, 19, v3
    v_mul_u32_u24 v4, 168, v3
    v_sub_u32 v4, v2, v4
    v_lshlrev_b32 v5, 12, v3
    v_lshlrev_b32 v6, 4, v4
    v_add_u32 v5, v5, v6
    v_add_u32 v5, 23068672, v5
    buffer_load_dwordx4 v[8:11], v5, s[8:11], 0 offen
    v_mul_u32_u24 v7, 2688, v3
    v_add_u32 v7, v7, v6
    s_waitcnt vmcnt(0)
    ds_write_b128 v7, v[8:11]
    v_add_u32 v2, 1536, v1
    s_mov_b32 s12, 3121
    v_mul_lo_u32 v3, v2, s12
    v_lshrrev_b32 v3, 19, v3
    v_mul_u32_u24 v4, 168, v3
    v_sub_u32 v4, v2, v4
    v_lshlrev_b32 v5, 12, v3
    v_lshlrev_b32 v6, 4, v4
    v_add_u32 v5, v5, v6
    v_add_u32 v5, 23068672, v5
    buffer_load_dwordx4 v[8:11], v5, s[8:11], 0 offen
    v_mul_u32_u24 v7, 2688, v3
    v_add_u32 v7, v7, v6
    s_waitcnt vmcnt(0)
    ds_write_b128 v7, v[8:11]
    v_add_u32 v2, 1792, v1
    s_mov_b32 s12, 3121
    v_mul_lo_u32 v3, v2, s12
    v_lshrrev_b32 v3, 19, v3
    v_mul_u32_u24 v4, 168, v3
    v_sub_u32 v4, v2, v4
    v_lshlrev_b32 v5, 12, v3
    v_lshlrev_b32 v6, 4, v4
    v_add_u32 v5, v5, v6
    v_add_u32 v5, 23068672, v5
    buffer_load_dwordx4 v[8:11], v5, s[8:11], 0 offen
    v_mul_u32_u24 v7, 2688, v3
    v_add_u32 v7, v7, v6
    s_waitcnt vmcnt(0)
    ds_write_b128 v7, v[8:11]
    v_add_u32 v2, 2048, v1
    s_mov_b32 s12, 3121
    v_mul_lo_u32 v3, v2, s12
    v_lshrrev_b32 v3, 19, v3
    v_mul_u32_u24 v4, 168, v3
    v_sub_u32 v4, v2, v4
    v_lshlrev_b32 v5, 12, v3
    v_lshlrev_b32 v6, 4, v4
    v_add_u32 v5, v5, v6
    v_add_u32 v5, 23068672, v5
    buffer_load_dwordx4 v[8:11], v5, s[8:11], 0 offen
    v_mul_u32_u24 v7, 2688, v3
    v_add_u32 v7, v7, v6
    s_waitcnt vmcnt(0)
    ds_write_b128 v7, v[8:11]
    v_add_u32 v2, 2304, v1
    s_mov_b32 s12, 3121
    v_mul_lo_u32 v3, v2, s12
    v_lshrrev_b32 v3, 19, v3
    v_mul_u32_u24 v4, 168, v3
    v_sub_u32 v4, v2, v4
    v_lshlrev_b32 v5, 12, v3
    v_lshlrev_b32 v6, 4, v4
    v_add_u32 v5, v5, v6
    v_add_u32 v5, 23068672, v5
    buffer_load_dwordx4 v[8:11], v5, s[8:11], 0 offen
    v_mul_u32_u24 v7, 2688, v3
    v_add_u32 v7, v7, v6
    s_waitcnt vmcnt(0)
    ds_write_b128 v7, v[8:11]
    v_add_u32 v2, 2560, v1
    s_mov_b32 s12, 3121
    v_mul_lo_u32 v3, v2, s12
    v_lshrrev_b32 v3, 19, v3
    v_mul_u32_u24 v4, 168, v3
    v_sub_u32 v4, v2, v4
    v_lshlrev_b32 v5, 12, v3
    v_lshlrev_b32 v6, 4, v4
    v_add_u32 v5, v5, v6
    v_add_u32 v5, 23068672, v5
    buffer_load_dwordx4 v[8:11], v5, s[8:11], 0 offen
    v_mul_u32_u24 v7, 2688, v3
    v_add_u32 v7, v7, v6
    s_waitcnt vmcnt(0)
    ds_write_b128 v7, v[8:11]
    v_add_u32 v2, 2816, v1
    s_mov_b32 s12, 3121
    v_mul_lo_u32 v3, v2, s12
    v_lshrrev_b32 v3, 19, v3
    v_mul_u32_u24 v4, 168, v3
    v_sub_u32 v4, v2, v4
    v_lshlrev_b32 v5, 12, v3
    v_lshlrev_b32 v6, 4, v4
    v_add_u32 v5, v5, v6
    v_add_u32 v5, 23068672, v5
    buffer_load_dwordx4 v[8:11], v5, s[8:11], 0 offen
    v_mul_u32_u24 v7, 2688, v3
    v_add_u32 v7, v7, v6
    s_waitcnt vmcnt(0)
    ds_write_b128 v7, v[8:11]
    v_add_u32 v2, 3072, v1
    s_mov_b32 s12, 3121
    v_mul_lo_u32 v3, v2, s12
    v_lshrrev_b32 v3, 19, v3
    v_mul_u32_u24 v4, 168, v3
    v_sub_u32 v4, v2, v4
    v_lshlrev_b32 v5, 12, v3
    v_lshlrev_b32 v6, 4, v4
    v_add_u32 v5, v5, v6
    v_add_u32 v5, 23068672, v5
    buffer_load_dwordx4 v[8:11], v5, s[8:11], 0 offen
    v_mul_u32_u24 v7, 2688, v3
    v_add_u32 v7, v7, v6
    s_waitcnt vmcnt(0)
    ds_write_b128 v7, v[8:11]
    v_add_u32 v2, 3328, v1
    s_mov_b32 s12, 3121
    v_mul_lo_u32 v3, v2, s12
    v_lshrrev_b32 v3, 19, v3
    v_mul_u32_u24 v4, 168, v3
    v_sub_u32 v4, v2, v4
    v_lshlrev_b32 v5, 12, v3
    v_lshlrev_b32 v6, 4, v4
    v_add_u32 v5, v5, v6
    v_add_u32 v5, 23068672, v5
    buffer_load_dwordx4 v[8:11], v5, s[8:11], 0 offen
    v_mul_u32_u24 v7, 2688, v3
    v_add_u32 v7, v7, v6
    s_waitcnt vmcnt(0)
    ds_write_b128 v7, v[8:11]
    v_add_u32 v2, 3584, v1
    s_mov_b32 s12, 3121
    v_mul_lo_u32 v3, v2, s12
    v_lshrrev_b32 v3, 19, v3
    v_mul_u32_u24 v4, 168, v3
    v_sub_u32 v4, v2, v4
    v_lshlrev_b32 v5, 12, v3
    v_lshlrev_b32 v6, 4, v4
    v_add_u32 v5, v5, v6
    v_add_u32 v5, 23068672, v5
    buffer_load_dwordx4 v[8:11], v5, s[8:11], 0 offen
    v_mul_u32_u24 v7, 2688, v3
    v_add_u32 v7, v7, v6
    s_waitcnt vmcnt(0)
    ds_write_b128 v7, v[8:11]
    v_add_u32 v2, 3840, v1
    s_mov_b32 s12, 3121
    v_mul_lo_u32 v3, v2, s12
    v_lshrrev_b32 v3, 19, v3
    v_mul_u32_u24 v4, 168, v3
    v_sub_u32 v4, v2, v4
    v_lshlrev_b32 v5, 12, v3
    v_lshlrev_b32 v6, 4, v4
    v_add_u32 v5, v5, v6
    v_add_u32 v5, 23068672, v5
    buffer_load_dwordx4 v[8:11], v5, s[8:11], 0 offen
    v_mul_u32_u24 v7, 2688, v3
    v_add_u32 v7, v7, v6
    s_waitcnt vmcnt(0)
    ds_write_b128 v7, v[8:11]
    v_add_u32 v2, 4096, v1
    s_mov_b32 s12, 3121
    v_mul_lo_u32 v3, v2, s12
    v_lshrrev_b32 v3, 19, v3
    v_mul_u32_u24 v4, 168, v3
    v_sub_u32 v4, v2, v4
    v_lshlrev_b32 v5, 12, v3
    v_lshlrev_b32 v6, 4, v4
    v_add_u32 v5, v5, v6
    v_add_u32 v5, 23068672, v5
    buffer_load_dwordx4 v[8:11], v5, s[8:11], 0 offen
    v_mul_u32_u24 v7, 2688, v3
    v_add_u32 v7, v7, v6
    s_waitcnt vmcnt(0)
    ds_write_b128 v7, v[8:11]
    v_add_u32 v2, 4352, v1
    s_mov_b32 s12, 3121
    v_mul_lo_u32 v3, v2, s12
    v_lshrrev_b32 v3, 19, v3
    v_mul_u32_u24 v4, 168, v3
    v_sub_u32 v4, v2, v4
    v_lshlrev_b32 v5, 12, v3
    v_lshlrev_b32 v6, 4, v4
    v_add_u32 v5, v5, v6
    v_add_u32 v5, 23068672, v5
    buffer_load_dwordx4 v[8:11], v5, s[8:11], 0 offen
    v_mul_u32_u24 v7, 2688, v3
    v_add_u32 v7, v7, v6
    s_waitcnt vmcnt(0)
    ds_write_b128 v7, v[8:11]
    v_add_u32 v2, 4608, v1
    s_mov_b32 s12, 3121
    v_mul_lo_u32 v3, v2, s12
    v_lshrrev_b32 v3, 19, v3
    v_mul_u32_u24 v4, 168, v3
    v_sub_u32 v4, v2, v4
    v_lshlrev_b32 v5, 12, v3
    v_lshlrev_b32 v6, 4, v4
    v_add_u32 v5, v5, v6
    v_add_u32 v5, 23068672, v5
    buffer_load_dwordx4 v[8:11], v5, s[8:11], 0 offen
    v_mul_u32_u24 v7, 2688, v3
    v_add_u32 v7, v7, v6
    s_waitcnt vmcnt(0)
    ds_write_b128 v7, v[8:11]
    v_add_u32 v2, 4864, v1
    s_mov_b32 s12, 3121
    v_mul_lo_u32 v3, v2, s12
    v_lshrrev_b32 v3, 19, v3
    v_mul_u32_u24 v4, 168, v3
    v_sub_u32 v4, v2, v4
    v_lshlrev_b32 v5, 12, v3
    v_lshlrev_b32 v6, 4, v4
    v_add_u32 v5, v5, v6
    v_add_u32 v5, 23068672, v5
    buffer_load_dwordx4 v[8:11], v5, s[8:11], 0 offen
    v_mul_u32_u24 v7, 2688, v3
    v_add_u32 v7, v7, v6
    s_waitcnt vmcnt(0)
    ds_write_b128 v7, v[8:11]
    v_add_u32 v2, 5120, v1
    s_mov_b32 s12, 3121
    v_mul_lo_u32 v3, v2, s12
    v_lshrrev_b32 v3, 19, v3
    v_mul_u32_u24 v4, 168, v3
    v_sub_u32 v4, v2, v4
    v_lshlrev_b32 v5, 12, v3
    v_lshlrev_b32 v6, 4, v4
    v_add_u32 v5, v5, v6
    v_add_u32 v5, 23068672, v5
    buffer_load_dwordx4 v[8:11], v5, s[8:11], 0 offen
    v_mul_u32_u24 v7, 2688, v3
    v_add_u32 v7, v7, v6
    s_waitcnt vmcnt(0)
    ds_write_b128 v7, v[8:11]
    s_waitcnt lgkmcnt(0)
    s_barrier
    v_and_b32 v2, 31, v0
    v_lshrrev_b32 v3, 5, v0
    s_lshl_b32 s12, s2, 3
    v_add_u32 v3, s12, v3
    v_mul_u32_u24 v4, 1280, v3
    v_mul_u32_u24 v5, 40, v2
    v_add_u32 v4, v4, v5
    v_add_u32 v6, 8388608, v4
    buffer_load_dwordx2 v[8:9], v6, s[8:11], 0 offen offset:0
    buffer_load_dwordx2 v[10:11], v6, s[8:11], 0 offen offset:8
    buffer_load_dwordx2 v[12:13], v6, s[8:11], 0 offen offset:16
    buffer_load_dwordx2 v[14:15], v6, s[8:11], 0 offen offset:24
    buffer_load_dwordx2 v[16:17], v6, s[8:11], 0 offen offset:32
    s_waitcnt vmcnt(0)
    v_lshlrev_b32 v40, 16, v8
    v_and_b32 v41, 0xffff0000, v8
    v_mul_f32 v44, 1.4426950408889634, v40
    v_exp_f32 v44, v44
    v_add_f32 v42, 1.0, v40
    v_cmp_lt_f32 vcc, 0, v40
    s_nop 1
    v_cndmask_b32 v42, v44, v42, vcc
    v_add_f32 v42, 0x358637bd, v42
    v_mul_f32 v44, 1.4426950408889634, v41
    v_exp_f32 v44, v44
    v_add_f32 v43, 1.0, v41
    v_cmp_lt_f32 vcc, 0, v41
    s_nop 1
    v_cndmask_b32 v43, v44, v43, vcc
    v_add_f32 v43, 0x358637bd, v43
    v_cvt_pk_bf16_f32 v45, v42, v43
    v_lshlrev_b32 v20, 16, v45
    v_and_b32 v21, 0xffff0000, v45
    v_lshlrev_b32 v40, 16, v9
    v_and_b32 v41, 0xffff0000, v9
    v_mul_f32 v44, 1.4426950408889634, v40
    v_exp_f32 v44, v44
    v_add_f32 v42, 1.0, v40
    v_cmp_lt_f32 vcc, 0, v40
    s_nop 1
    v_cndmask_b32 v42, v44, v42, vcc
    v_add_f32 v42, 0x358637bd, v42
    v_mul_f32 v44, 1.4426950408889634, v41
    v_exp_f32 v44, v44
    v_add_f32 v43, 1.0, v41
    v_cmp_lt_f32 vcc, 0, v41
    s_nop 1
    v_cndmask_b32 v43, v44, v43, vcc
    v_add_f32 v43, 0x358637bd, v43
    v_cvt_pk_bf16_f32 v45, v42, v43
    v_lshlrev_b32 v22, 16, v45
    v_and_b32 v23, 0xffff0000, v45
    v_lshlrev_b32 v40, 16, v10
    v_and_b32 v41, 0xffff0000, v10
    v_mul_f32 v44, 1.4426950408889634, v40
    v_exp_f32 v44, v44
    v_add_f32 v42, 1.0, v40
    v_cmp_lt_f32 vcc, 0, v40
    s_nop 1
    v_cndmask_b32 v42, v44, v42, vcc
    v_add_f32 v42, 0x358637bd, v42
    v_mul_f32 v44, 1.4426950408889634, v41
    v_exp_f32 v44, v44
    v_add_f32 v43, 1.0, v41
    v_cmp_lt_f32 vcc, 0, v41
    s_nop 1
    v_cndmask_b32 v43, v44, v43, vcc
    v_add_f32 v43, 0x358637bd, v43
    v_cvt_pk_bf16_f32 v45, v42, v43
    v_lshlrev_b32 v24, 16, v45
    v_and_b32 v25, 0xffff0000, v45
    v_lshlrev_b32 v40, 16, v11
    v_and_b32 v41, 0xffff0000, v11
    v_mul_f32 v44, 1.4426950408889634, v40
    v_exp_f32 v44, v44
    v_add_f32 v42, 1.0, v40
    v_cmp_lt_f32 vcc, 0, v40
    s_nop 1
    v_cndmask_b32 v42, v44, v42, vcc
    v_add_f32 v42, 0x358637bd, v42
    v_mul_f32 v44, 1.4426950408889634, v41
    v_exp_f32 v44, v44
    v_add_f32 v43, 1.0, v41
    v_cmp_lt_f32 vcc, 0, v41
    s_nop 1
    v_cndmask_b32 v43, v44, v43, vcc
    v_add_f32 v43, 0x358637bd, v43
    v_cvt_pk_bf16_f32 v45, v42, v43
    v_lshlrev_b32 v26, 16, v45
    v_and_b32 v27, 0xffff0000, v45
    v_lshlrev_b32 v40, 16, v12
    v_and_b32 v41, 0xffff0000, v12
    v_mul_f32 v44, 1.4426950408889634, v40
    v_exp_f32 v44, v44
    v_add_f32 v42, 1.0, v40
    v_cmp_lt_f32 vcc, 0, v40
    s_nop 1
    v_cndmask_b32 v42, v44, v42, vcc
    v_add_f32 v42, 0x358637bd, v42
    v_mul_f32 v44, 1.4426950408889634, v41
    v_exp_f32 v44, v44
    v_add_f32 v43, 1.0, v41
    v_cmp_lt_f32 vcc, 0, v41
    s_nop 1
    v_cndmask_b32 v43, v44, v43, vcc
    v_add_f32 v43, 0x358637bd, v43
    v_cvt_pk_bf16_f32 v45, v42, v43
    v_lshlrev_b32 v28, 16, v45
    v_and_b32 v29, 0xffff0000, v45
    v_lshlrev_b32 v40, 16, v13
    v_and_b32 v41, 0xffff0000, v13
    v_mul_f32 v44, 1.4426950408889634, v40
    v_exp_f32 v44, v44
    v_add_f32 v42, 1.0, v40
    v_cmp_lt_f32 vcc, 0, v40
    s_nop 1
    v_cndmask_b32 v42, v44, v42, vcc
    v_add_f32 v42, 0x358637bd, v42
    v_mul_f32 v44, 1.4426950408889634, v41
    v_exp_f32 v44, v44
    v_add_f32 v43, 1.0, v41
    v_cmp_lt_f32 vcc, 0, v41
    s_nop 1
    v_cndmask_b32 v43, v44, v43, vcc
    v_add_f32 v43, 0x358637bd, v43
    v_cvt_pk_bf16_f32 v45, v42, v43
    v_lshlrev_b32 v30, 16, v45
    v_and_b32 v31, 0xffff0000, v45
    v_lshlrev_b32 v40, 16, v14
    v_and_b32 v41, 0xffff0000, v14
    v_mul_f32 v44, 1.4426950408889634, v40
    v_exp_f32 v44, v44
    v_add_f32 v42, 1.0, v40
    v_cmp_lt_f32 vcc, 0, v40
    s_nop 1
    v_cndmask_b32 v42, v44, v42, vcc
    v_add_f32 v42, 0x358637bd, v42
    v_mul_f32 v44, 1.4426950408889634, v41
    v_exp_f32 v44, v44
    v_add_f32 v43, 1.0, v41
    v_cmp_lt_f32 vcc, 0, v41
    s_nop 1
    v_cndmask_b32 v43, v44, v43, vcc
    v_add_f32 v43, 0x358637bd, v43
    v_cvt_pk_bf16_f32 v45, v42, v43
    v_lshlrev_b32 v32, 16, v45
    v_and_b32 v33, 0xffff0000, v45
    v_lshlrev_b32 v40, 16, v15
    v_and_b32 v41, 0xffff0000, v15
    v_mul_f32 v44, 1.4426950408889634, v40
    v_exp_f32 v44, v44
    v_add_f32 v42, 1.0, v40
    v_cmp_lt_f32 vcc, 0, v40
    s_nop 1
    v_cndmask_b32 v42, v44, v42, vcc
    v_add_f32 v42, 0x358637bd, v42
    v_mul_f32 v44, 1.4426950408889634, v41
    v_exp_f32 v44, v44
    v_add_f32 v43, 1.0, v41
    v_cmp_lt_f32 vcc, 0, v41
    s_nop 1
    v_cndmask_b32 v43, v44, v43, vcc
    v_add_f32 v43, 0x358637bd, v43
    v_cvt_pk_bf16_f32 v45, v42, v43
    v_lshlrev_b32 v34, 16, v45
    v_and_b32 v35, 0xffff0000, v45
    v_lshlrev_b32 v40, 16, v16
    v_and_b32 v41, 0xffff0000, v16
    v_mul_f32 v44, 1.4426950408889634, v40
    v_exp_f32 v44, v44
    v_add_f32 v42, 1.0, v40
    v_cmp_lt_f32 vcc, 0, v40
    s_nop 1
    v_cndmask_b32 v42, v44, v42, vcc
    v_add_f32 v42, 0x358637bd, v42
    v_mul_f32 v44, 1.4426950408889634, v41
    v_exp_f32 v44, v44
    v_add_f32 v43, 1.0, v41
    v_cmp_lt_f32 vcc, 0, v41
    s_nop 1
    v_cndmask_b32 v43, v44, v43, vcc
    v_add_f32 v43, 0x358637bd, v43
    v_cvt_pk_bf16_f32 v45, v42, v43
    v_lshlrev_b32 v36, 16, v45
    v_and_b32 v37, 0xffff0000, v45
    v_lshlrev_b32 v40, 16, v17
    v_and_b32 v41, 0xffff0000, v17
    v_mul_f32 v44, 1.4426950408889634, v40
    v_exp_f32 v44, v44
    v_add_f32 v42, 1.0, v40
    v_cmp_lt_f32 vcc, 0, v40
    s_nop 1
    v_cndmask_b32 v42, v44, v42, vcc
    v_add_f32 v42, 0x358637bd, v42
    v_mul_f32 v44, 1.4426950408889634, v41
    v_exp_f32 v44, v44
    v_add_f32 v43, 1.0, v41
    v_cmp_lt_f32 vcc, 0, v41
    s_nop 1
    v_cndmask_b32 v43, v44, v43, vcc
    v_add_f32 v43, 0x358637bd, v43
    v_cvt_pk_bf16_f32 v45, v42, v43
    v_lshlrev_b32 v38, 16, v45
    v_and_b32 v39, 0xffff0000, v45
    v_mul_u32_u24 v7, 2688, v2
    ds_read_b128 v[72:75], v7 offset:0
    ds_read_b128 v[76:79], v7 offset:16
    ds_read_b128 v[80:83], v7 offset:32
    ds_read_b128 v[84:87], v7 offset:48
    ds_read_b128 v[88:91], v7 offset:64
    s_waitcnt lgkmcnt(0)
    v_mul_f32 v50, v20, v72
    v_fmac_f32 v50, v21, v73
    v_fmac_f32 v50, v22, v74
    v_fmac_f32 v50, v23, v75
    v_fmac_f32 v50, v24, v76
    v_fmac_f32 v50, v25, v77
    v_fmac_f32 v50, v26, v78
    v_fmac_f32 v50, v27, v79
    v_fmac_f32 v50, v28, v80
    v_fmac_f32 v50, v29, v81
    v_fmac_f32 v50, v30, v82
    v_fmac_f32 v50, v31, v83
    v_fmac_f32 v50, v32, v84
    v_fmac_f32 v50, v33, v85
    v_fmac_f32 v50, v34, v86
    v_fmac_f32 v50, v35, v87
    v_fmac_f32 v50, v36, v88
    v_fmac_f32 v50, v37, v89
    v_fmac_f32 v50, v38, v90
    v_fmac_f32 v50, v39, v91
    ds_read_b128 v[72:75], v7 offset:128
    ds_read_b128 v[76:79], v7 offset:144
    ds_read_b128 v[80:83], v7 offset:160
    ds_read_b128 v[84:87], v7 offset:176
    ds_read_b128 v[88:91], v7 offset:192
    s_waitcnt lgkmcnt(0)
    v_mul_f32 v51, v20, v72
    v_fmac_f32 v51, v21, v73
    v_fmac_f32 v51, v22, v74
    v_fmac_f32 v51, v23, v75
    v_fmac_f32 v51, v24, v76
    v_fmac_f32 v51, v25, v77
    v_fmac_f32 v51, v26, v78
    v_fmac_f32 v51, v27, v79
    v_fmac_f32 v51, v28, v80
    v_fmac_f32 v51, v29, v81
    v_fmac_f32 v51, v30, v82
    v_fmac_f32 v51, v31, v83
    v_fmac_f32 v51, v32, v84
    v_fmac_f32 v51, v33, v85
    v_fmac_f32 v51, v34, v86
    v_fmac_f32 v51, v35, v87
    v_fmac_f32 v51, v36, v88
    v_fmac_f32 v51, v37, v89
    v_fmac_f32 v51, v38, v90
    v_fmac_f32 v51, v39, v91
    ds_read_b128 v[72:75], v7 offset:256
    ds_read_b128 v[76:79], v7 offset:272
    ds_read_b128 v[80:83], v7 offset:288
    ds_read_b128 v[84:87], v7 offset:304
    ds_read_b128 v[88:91], v7 offset:320
    s_waitcnt lgkmcnt(0)
    v_mul_f32 v52, v20, v72
    v_fmac_f32 v52, v21, v73
    v_fmac_f32 v52, v22, v74
    v_fmac_f32 v52, v23, v75
    v_fmac_f32 v52, v24, v76
    v_fmac_f32 v52, v25, v77
    v_fmac_f32 v52, v26, v78
    v_fmac_f32 v52, v27, v79
    v_fmac_f32 v52, v28, v80
    v_fmac_f32 v52, v29, v81
    v_fmac_f32 v52, v30, v82
    v_fmac_f32 v52, v31, v83
    v_fmac_f32 v52, v32, v84
    v_fmac_f32 v52, v33, v85
    v_fmac_f32 v52, v34, v86
    v_fmac_f32 v52, v35, v87
    v_fmac_f32 v52, v36, v88
    v_fmac_f32 v52, v37, v89
    v_fmac_f32 v52, v38, v90
    v_fmac_f32 v52, v39, v91
    ds_read_b128 v[72:75], v7 offset:384
    ds_read_b128 v[76:79], v7 offset:400
    ds_read_b128 v[80:83], v7 offset:416
    ds_read_b128 v[84:87], v7 offset:432
    ds_read_b128 v[88:91], v7 offset:448
    s_waitcnt lgkmcnt(0)
    v_mul_f32 v53, v20, v72
    v_fmac_f32 v53, v21, v73
    v_fmac_f32 v53, v22, v74
    v_fmac_f32 v53, v23, v75
    v_fmac_f32 v53, v24, v76
    v_fmac_f32 v53, v25, v77
    v_fmac_f32 v53, v26, v78
    v_fmac_f32 v53, v27, v79
    v_fmac_f32 v53, v28, v80
    v_fmac_f32 v53, v29, v81
    v_fmac_f32 v53, v30, v82
    v_fmac_f32 v53, v31, v83
    v_fmac_f32 v53, v32, v84
    v_fmac_f32 v53, v33, v85
    v_fmac_f32 v53, v34, v86
    v_fmac_f32 v53, v35, v87
    v_fmac_f32 v53, v36, v88
    v_fmac_f32 v53, v37, v89
    v_fmac_f32 v53, v38, v90
    v_fmac_f32 v53, v39, v91
    ds_read_b128 v[72:75], v7 offset:512
    ds_read_b128 v[76:79], v7 offset:528
    ds_read_b128 v[80:83], v7 offset:544
    ds_read_b128 v[84:87], v7 offset:560
    ds_read_b128 v[88:91], v7 offset:576
    s_waitcnt lgkmcnt(0)
    v_mul_f32 v54, v20, v72
    v_fmac_f32 v54, v21, v73
    v_fmac_f32 v54, v22, v74
    v_fmac_f32 v54, v23, v75
    v_fmac_f32 v54, v24, v76
    v_fmac_f32 v54, v25, v77
    v_fmac_f32 v54, v26, v78
    v_fmac_f32 v54, v27, v79
    v_fmac_f32 v54, v28, v80
    v_fmac_f32 v54, v29, v81
    v_fmac_f32 v54, v30, v82
    v_fmac_f32 v54, v31, v83
    v_fmac_f32 v54, v32, v84
    v_fmac_f32 v54, v33, v85
    v_fmac_f32 v54, v34, v86
    v_fmac_f32 v54, v35, v87
    v_fmac_f32 v54, v36, v88
    v_fmac_f32 v54, v37, v89
    v_fmac_f32 v54, v38, v90
    v_fmac_f32 v54, v39, v91
    ds_read_b128 v[72:75], v7 offset:640
    ds_read_b128 v[76:79], v7 offset:656
    ds_read_b128 v[80:83], v7 offset:672
    ds_read_b128 v[84:87], v7 offset:688
    ds_read_b128 v[88:91], v7 offset:704
    s_waitcnt lgkmcnt(0)
    v_mul_f32 v55, v20, v72
    v_fmac_f32 v55, v21, v73
    v_fmac_f32 v55, v22, v74
    v_fmac_f32 v55, v23, v75
    v_fmac_f32 v55, v24, v76
    v_fmac_f32 v55, v25, v77
    v_fmac_f32 v55, v26, v78
    v_fmac_f32 v55, v27, v79
    v_fmac_f32 v55, v28, v80
    v_fmac_f32 v55, v29, v81
    v_fmac_f32 v55, v30, v82
    v_fmac_f32 v55, v31, v83
    v_fmac_f32 v55, v32, v84
    v_fmac_f32 v55, v33, v85
    v_fmac_f32 v55, v34, v86
    v_fmac_f32 v55, v35, v87
    v_fmac_f32 v55, v36, v88
    v_fmac_f32 v55, v37, v89
    v_fmac_f32 v55, v38, v90
    v_fmac_f32 v55, v39, v91
    ds_read_b128 v[72:75], v7 offset:768
    ds_read_b128 v[76:79], v7 offset:784
    ds_read_b128 v[80:83], v7 offset:800
    ds_read_b128 v[84:87], v7 offset:816
    ds_read_b128 v[88:91], v7 offset:832
    s_waitcnt lgkmcnt(0)
    v_mul_f32 v56, v20, v72
    v_fmac_f32 v56, v21, v73
    v_fmac_f32 v56, v22, v74
    v_fmac_f32 v56, v23, v75
    v_fmac_f32 v56, v24, v76
    v_fmac_f32 v56, v25, v77
    v_fmac_f32 v56, v26, v78
    v_fmac_f32 v56, v27, v79
    v_fmac_f32 v56, v28, v80
    v_fmac_f32 v56, v29, v81
    v_fmac_f32 v56, v30, v82
    v_fmac_f32 v56, v31, v83
    v_fmac_f32 v56, v32, v84
    v_fmac_f32 v56, v33, v85
    v_fmac_f32 v56, v34, v86
    v_fmac_f32 v56, v35, v87
    v_fmac_f32 v56, v36, v88
    v_fmac_f32 v56, v37, v89
    v_fmac_f32 v56, v38, v90
    v_fmac_f32 v56, v39, v91
    ds_read_b128 v[72:75], v7 offset:896
    ds_read_b128 v[76:79], v7 offset:912
    ds_read_b128 v[80:83], v7 offset:928
    ds_read_b128 v[84:87], v7 offset:944
    ds_read_b128 v[88:91], v7 offset:960
    s_waitcnt lgkmcnt(0)
    v_mul_f32 v57, v20, v72
    v_fmac_f32 v57, v21, v73
    v_fmac_f32 v57, v22, v74
    v_fmac_f32 v57, v23, v75
    v_fmac_f32 v57, v24, v76
    v_fmac_f32 v57, v25, v77
    v_fmac_f32 v57, v26, v78
    v_fmac_f32 v57, v27, v79
    v_fmac_f32 v57, v28, v80
    v_fmac_f32 v57, v29, v81
    v_fmac_f32 v57, v30, v82
    v_fmac_f32 v57, v31, v83
    v_fmac_f32 v57, v32, v84
    v_fmac_f32 v57, v33, v85
    v_fmac_f32 v57, v34, v86
    v_fmac_f32 v57, v35, v87
    v_fmac_f32 v57, v36, v88
    v_fmac_f32 v57, v37, v89
    v_fmac_f32 v57, v38, v90
    v_fmac_f32 v57, v39, v91
    ds_read_b128 v[72:75], v7 offset:1024
    ds_read_b128 v[76:79], v7 offset:1040
    ds_read_b128 v[80:83], v7 offset:1056
    ds_read_b128 v[84:87], v7 offset:1072
    ds_read_b128 v[88:91], v7 offset:1088
    s_waitcnt lgkmcnt(0)
    v_mul_f32 v58, v20, v72
    v_fmac_f32 v58, v21, v73
    v_fmac_f32 v58, v22, v74
    v_fmac_f32 v58, v23, v75
    v_fmac_f32 v58, v24, v76
    v_fmac_f32 v58, v25, v77
    v_fmac_f32 v58, v26, v78
    v_fmac_f32 v58, v27, v79
    v_fmac_f32 v58, v28, v80
    v_fmac_f32 v58, v29, v81
    v_fmac_f32 v58, v30, v82
    v_fmac_f32 v58, v31, v83
    v_fmac_f32 v58, v32, v84
    v_fmac_f32 v58, v33, v85
    v_fmac_f32 v58, v34, v86
    v_fmac_f32 v58, v35, v87
    v_fmac_f32 v58, v36, v88
    v_fmac_f32 v58, v37, v89
    v_fmac_f32 v58, v38, v90
    v_fmac_f32 v58, v39, v91
    ds_read_b128 v[72:75], v7 offset:1152
    ds_read_b128 v[76:79], v7 offset:1168
    ds_read_b128 v[80:83], v7 offset:1184
    ds_read_b128 v[84:87], v7 offset:1200
    ds_read_b128 v[88:91], v7 offset:1216
    s_waitcnt lgkmcnt(0)
    v_mul_f32 v59, v20, v72
    v_fmac_f32 v59, v21, v73
    v_fmac_f32 v59, v22, v74
    v_fmac_f32 v59, v23, v75
    v_fmac_f32 v59, v24, v76
    v_fmac_f32 v59, v25, v77
    v_fmac_f32 v59, v26, v78
    v_fmac_f32 v59, v27, v79
    v_fmac_f32 v59, v28, v80
    v_fmac_f32 v59, v29, v81
    v_fmac_f32 v59, v30, v82
    v_fmac_f32 v59, v31, v83
    v_fmac_f32 v59, v32, v84
    v_fmac_f32 v59, v33, v85
    v_fmac_f32 v59, v34, v86
    v_fmac_f32 v59, v35, v87
    v_fmac_f32 v59, v36, v88
    v_fmac_f32 v59, v37, v89
    v_fmac_f32 v59, v38, v90
    v_fmac_f32 v59, v39, v91
    ds_read_b128 v[72:75], v7 offset:1280
    ds_read_b128 v[76:79], v7 offset:1296
    ds_read_b128 v[80:83], v7 offset:1312
    ds_read_b128 v[84:87], v7 offset:1328
    ds_read_b128 v[88:91], v7 offset:1344
    s_waitcnt lgkmcnt(0)
    v_mul_f32 v60, v20, v72
    v_fmac_f32 v60, v21, v73
    v_fmac_f32 v60, v22, v74
    v_fmac_f32 v60, v23, v75
    v_fmac_f32 v60, v24, v76
    v_fmac_f32 v60, v25, v77
    v_fmac_f32 v60, v26, v78
    v_fmac_f32 v60, v27, v79
    v_fmac_f32 v60, v28, v80
    v_fmac_f32 v60, v29, v81
    v_fmac_f32 v60, v30, v82
    v_fmac_f32 v60, v31, v83
    v_fmac_f32 v60, v32, v84
    v_fmac_f32 v60, v33, v85
    v_fmac_f32 v60, v34, v86
    v_fmac_f32 v60, v35, v87
    v_fmac_f32 v60, v36, v88
    v_fmac_f32 v60, v37, v89
    v_fmac_f32 v60, v38, v90
    v_fmac_f32 v60, v39, v91
    ds_read_b128 v[72:75], v7 offset:1408
    ds_read_b128 v[76:79], v7 offset:1424
    ds_read_b128 v[80:83], v7 offset:1440
    ds_read_b128 v[84:87], v7 offset:1456
    ds_read_b128 v[88:91], v7 offset:1472
    s_waitcnt lgkmcnt(0)
    v_mul_f32 v61, v20, v72
    v_fmac_f32 v61, v21, v73
    v_fmac_f32 v61, v22, v74
    v_fmac_f32 v61, v23, v75
    v_fmac_f32 v61, v24, v76
    v_fmac_f32 v61, v25, v77
    v_fmac_f32 v61, v26, v78
    v_fmac_f32 v61, v27, v79
    v_fmac_f32 v61, v28, v80
    v_fmac_f32 v61, v29, v81
    v_fmac_f32 v61, v30, v82
    v_fmac_f32 v61, v31, v83
    v_fmac_f32 v61, v32, v84
    v_fmac_f32 v61, v33, v85
    v_fmac_f32 v61, v34, v86
    v_fmac_f32 v61, v35, v87
    v_fmac_f32 v61, v36, v88
    v_fmac_f32 v61, v37, v89
    v_fmac_f32 v61, v38, v90
    v_fmac_f32 v61, v39, v91
    ds_read_b128 v[72:75], v7 offset:1536
    ds_read_b128 v[76:79], v7 offset:1552
    ds_read_b128 v[80:83], v7 offset:1568
    ds_read_b128 v[84:87], v7 offset:1584
    ds_read_b128 v[88:91], v7 offset:1600
    s_waitcnt lgkmcnt(0)
    v_mul_f32 v62, v20, v72
    v_fmac_f32 v62, v21, v73
    v_fmac_f32 v62, v22, v74
    v_fmac_f32 v62, v23, v75
    v_fmac_f32 v62, v24, v76
    v_fmac_f32 v62, v25, v77
    v_fmac_f32 v62, v26, v78
    v_fmac_f32 v62, v27, v79
    v_fmac_f32 v62, v28, v80
    v_fmac_f32 v62, v29, v81
    v_fmac_f32 v62, v30, v82
    v_fmac_f32 v62, v31, v83
    v_fmac_f32 v62, v32, v84
    v_fmac_f32 v62, v33, v85
    v_fmac_f32 v62, v34, v86
    v_fmac_f32 v62, v35, v87
    v_fmac_f32 v62, v36, v88
    v_fmac_f32 v62, v37, v89
    v_fmac_f32 v62, v38, v90
    v_fmac_f32 v62, v39, v91
    ds_read_b128 v[72:75], v7 offset:1664
    ds_read_b128 v[76:79], v7 offset:1680
    ds_read_b128 v[80:83], v7 offset:1696
    ds_read_b128 v[84:87], v7 offset:1712
    ds_read_b128 v[88:91], v7 offset:1728
    s_waitcnt lgkmcnt(0)
    v_mul_f32 v63, v20, v72
    v_fmac_f32 v63, v21, v73
    v_fmac_f32 v63, v22, v74
    v_fmac_f32 v63, v23, v75
    v_fmac_f32 v63, v24, v76
    v_fmac_f32 v63, v25, v77
    v_fmac_f32 v63, v26, v78
    v_fmac_f32 v63, v27, v79
    v_fmac_f32 v63, v28, v80
    v_fmac_f32 v63, v29, v81
    v_fmac_f32 v63, v30, v82
    v_fmac_f32 v63, v31, v83
    v_fmac_f32 v63, v32, v84
    v_fmac_f32 v63, v33, v85
    v_fmac_f32 v63, v34, v86
    v_fmac_f32 v63, v35, v87
    v_fmac_f32 v63, v36, v88
    v_fmac_f32 v63, v37, v89
    v_fmac_f32 v63, v38, v90
    v_fmac_f32 v63, v39, v91
    ds_read_b128 v[72:75], v7 offset:1792
    ds_read_b128 v[76:79], v7 offset:1808
    ds_read_b128 v[80:83], v7 offset:1824
    ds_read_b128 v[84:87], v7 offset:1840
    ds_read_b128 v[88:91], v7 offset:1856
    s_waitcnt lgkmcnt(0)
    v_mul_f32 v64, v20, v72
    v_fmac_f32 v64, v21, v73
    v_fmac_f32 v64, v22, v74
    v_fmac_f32 v64, v23, v75
    v_fmac_f32 v64, v24, v76
    v_fmac_f32 v64, v25, v77
    v_fmac_f32 v64, v26, v78
    v_fmac_f32 v64, v27, v79
    v_fmac_f32 v64, v28, v80
    v_fmac_f32 v64, v29, v81
    v_fmac_f32 v64, v30, v82
    v_fmac_f32 v64, v31, v83
    v_fmac_f32 v64, v32, v84
    v_fmac_f32 v64, v33, v85
    v_fmac_f32 v64, v34, v86
    v_fmac_f32 v64, v35, v87
    v_fmac_f32 v64, v36, v88
    v_fmac_f32 v64, v37, v89
    v_fmac_f32 v64, v38, v90
    v_fmac_f32 v64, v39, v91
    ds_read_b128 v[72:75], v7 offset:1920
    ds_read_b128 v[76:79], v7 offset:1936
    ds_read_b128 v[80:83], v7 offset:1952
    ds_read_b128 v[84:87], v7 offset:1968
    ds_read_b128 v[88:91], v7 offset:1984
    s_waitcnt lgkmcnt(0)
    v_mul_f32 v65, v20, v72
    v_fmac_f32 v65, v21, v73
    v_fmac_f32 v65, v22, v74
    v_fmac_f32 v65, v23, v75
    v_fmac_f32 v65, v24, v76
    v_fmac_f32 v65, v25, v77
    v_fmac_f32 v65, v26, v78
    v_fmac_f32 v65, v27, v79
    v_fmac_f32 v65, v28, v80
    v_fmac_f32 v65, v29, v81
    v_fmac_f32 v65, v30, v82
    v_fmac_f32 v65, v31, v83
    v_fmac_f32 v65, v32, v84
    v_fmac_f32 v65, v33, v85
    v_fmac_f32 v65, v34, v86
    v_fmac_f32 v65, v35, v87
    v_fmac_f32 v65, v36, v88
    v_fmac_f32 v65, v37, v89
    v_fmac_f32 v65, v38, v90
    v_fmac_f32 v65, v39, v91
    ds_read_b128 v[72:75], v7 offset:2048
    ds_read_b128 v[76:79], v7 offset:2064
    ds_read_b128 v[80:83], v7 offset:2080
    ds_read_b128 v[84:87], v7 offset:2096
    ds_read_b128 v[88:91], v7 offset:2112
    s_waitcnt lgkmcnt(0)
    v_mul_f32 v66, v20, v72
    v_fmac_f32 v66, v21, v73
    v_fmac_f32 v66, v22, v74
    v_fmac_f32 v66, v23, v75
    v_fmac_f32 v66, v24, v76
    v_fmac_f32 v66, v25, v77
    v_fmac_f32 v66, v26, v78
    v_fmac_f32 v66, v27, v79
    v_fmac_f32 v66, v28, v80
    v_fmac_f32 v66, v29, v81
    v_fmac_f32 v66, v30, v82
    v_fmac_f32 v66, v31, v83
    v_fmac_f32 v66, v32, v84
    v_fmac_f32 v66, v33, v85
    v_fmac_f32 v66, v34, v86
    v_fmac_f32 v66, v35, v87
    v_fmac_f32 v66, v36, v88
    v_fmac_f32 v66, v37, v89
    v_fmac_f32 v66, v38, v90
    v_fmac_f32 v66, v39, v91
    ds_read_b128 v[72:75], v7 offset:2176
    ds_read_b128 v[76:79], v7 offset:2192
    ds_read_b128 v[80:83], v7 offset:2208
    ds_read_b128 v[84:87], v7 offset:2224
    ds_read_b128 v[88:91], v7 offset:2240
    s_waitcnt lgkmcnt(0)
    v_mul_f32 v67, v20, v72
    v_fmac_f32 v67, v21, v73
    v_fmac_f32 v67, v22, v74
    v_fmac_f32 v67, v23, v75
    v_fmac_f32 v67, v24, v76
    v_fmac_f32 v67, v25, v77
    v_fmac_f32 v67, v26, v78
    v_fmac_f32 v67, v27, v79
    v_fmac_f32 v67, v28, v80
    v_fmac_f32 v67, v29, v81
    v_fmac_f32 v67, v30, v82
    v_fmac_f32 v67, v31, v83
    v_fmac_f32 v67, v32, v84
    v_fmac_f32 v67, v33, v85
    v_fmac_f32 v67, v34, v86
    v_fmac_f32 v67, v35, v87
    v_fmac_f32 v67, v36, v88
    v_fmac_f32 v67, v37, v89
    v_fmac_f32 v67, v38, v90
    v_fmac_f32 v67, v39, v91
    ds_read_b128 v[72:75], v7 offset:2304
    ds_read_b128 v[76:79], v7 offset:2320
    ds_read_b128 v[80:83], v7 offset:2336
    ds_read_b128 v[84:87], v7 offset:2352
    ds_read_b128 v[88:91], v7 offset:2368
    s_waitcnt lgkmcnt(0)
    v_mul_f32 v68, v20, v72
    v_fmac_f32 v68, v21, v73
    v_fmac_f32 v68, v22, v74
    v_fmac_f32 v68, v23, v75
    v_fmac_f32 v68, v24, v76
    v_fmac_f32 v68, v25, v77
    v_fmac_f32 v68, v26, v78
    v_fmac_f32 v68, v27, v79
    v_fmac_f32 v68, v28, v80
    v_fmac_f32 v68, v29, v81
    v_fmac_f32 v68, v30, v82
    v_fmac_f32 v68, v31, v83
    v_fmac_f32 v68, v32, v84
    v_fmac_f32 v68, v33, v85
    v_fmac_f32 v68, v34, v86
    v_fmac_f32 v68, v35, v87
    v_fmac_f32 v68, v36, v88
    v_fmac_f32 v68, v37, v89
    v_fmac_f32 v68, v38, v90
    v_fmac_f32 v68, v39, v91
    ds_read_b128 v[72:75], v7 offset:2432
    ds_read_b128 v[76:79], v7 offset:2448
    ds_read_b128 v[80:83], v7 offset:2464
    ds_read_b128 v[84:87], v7 offset:2480
    ds_read_b128 v[88:91], v7 offset:2496
    s_waitcnt lgkmcnt(0)
    v_mul_f32 v69, v20, v72
    v_fmac_f32 v69, v21, v73
    v_fmac_f32 v69, v22, v74
    v_fmac_f32 v69, v23, v75
    v_fmac_f32 v69, v24, v76
    v_fmac_f32 v69, v25, v77
    v_fmac_f32 v69, v26, v78
    v_fmac_f32 v69, v27, v79
    v_fmac_f32 v69, v28, v80
    v_fmac_f32 v69, v29, v81
    v_fmac_f32 v69, v30, v82
    v_fmac_f32 v69, v31, v83
    v_fmac_f32 v69, v32, v84
    v_fmac_f32 v69, v33, v85
    v_fmac_f32 v69, v34, v86
    v_fmac_f32 v69, v35, v87
    v_fmac_f32 v69, v36, v88
    v_fmac_f32 v69, v37, v89
    v_fmac_f32 v69, v38, v90
    v_fmac_f32 v69, v39, v91
    ds_read_b128 v[72:75], v7 offset:2560
    ds_read_b128 v[76:79], v7 offset:2576
    ds_read_b128 v[80:83], v7 offset:2592
    ds_read_b128 v[84:87], v7 offset:2608
    ds_read_b128 v[88:91], v7 offset:2624
    s_waitcnt lgkmcnt(0)
    v_mul_f32 v70, v20, v72
    v_fmac_f32 v70, v21, v73
    v_fmac_f32 v70, v22, v74
    v_fmac_f32 v70, v23, v75
    v_fmac_f32 v70, v24, v76
    v_fmac_f32 v70, v25, v77
    v_fmac_f32 v70, v26, v78
    v_fmac_f32 v70, v27, v79
    v_fmac_f32 v70, v28, v80
    v_fmac_f32 v70, v29, v81
    v_fmac_f32 v70, v30, v82
    v_fmac_f32 v70, v31, v83
    v_fmac_f32 v70, v32, v84
    v_fmac_f32 v70, v33, v85
    v_fmac_f32 v70, v34, v86
    v_fmac_f32 v70, v35, v87
    v_fmac_f32 v70, v36, v88
    v_fmac_f32 v70, v37, v89
    v_fmac_f32 v70, v38, v90
    v_fmac_f32 v70, v39, v91
    v_add_f32 v70, 0x358637bd, v70
    v_rcp_f32 v70, v70
    s_nop 0
    v_mul_f32 v50, v50, v70
    v_mul_f32 v51, v51, v70
    v_mul_f32 v52, v52, v70
    v_mul_f32 v53, v53, v70
    v_mul_f32 v54, v54, v70
    v_mul_f32 v55, v55, v70
    v_mul_f32 v56, v56, v70
    v_mul_f32 v57, v57, v70
    v_mul_f32 v58, v58, v70
    v_mul_f32 v59, v59, v70
    v_mul_f32 v60, v60, v70
    v_mul_f32 v61, v61, v70
    v_mul_f32 v62, v62, v70
    v_mul_f32 v63, v63, v70
    v_mul_f32 v64, v64, v70
    v_mul_f32 v65, v65, v70
    v_mul_f32 v66, v66, v70
    v_mul_f32 v67, v67, v70
    v_mul_f32 v68, v68, v70
    v_mul_f32 v69, v69, v70
    v_cvt_pk_bf16_f32 v8, v50, v51
    v_cvt_pk_bf16_f32 v9, v52, v53
    v_cvt_pk_bf16_f32 v10, v54, v55
    v_cvt_pk_bf16_f32 v11, v56, v57
    v_cvt_pk_bf16_f32 v12, v58, v59
    v_cvt_pk_bf16_f32 v13, v60, v61
    v_cvt_pk_bf16_f32 v14, v62, v63
    v_cvt_pk_bf16_f32 v15, v64, v65
    v_cvt_pk_bf16_f32 v16, v66, v67
    v_cvt_pk_bf16_f32 v17, v68, v69
    v_add_u32 v6, 18874368, v4
    buffer_store_dwordx2 v[8:9], v6, s[8:11], 0 offen offset:0
    buffer_store_dwordx2 v[10:11], v6, s[8:11], 0 offen offset:8
    buffer_store_dwordx2 v[12:13], v6, s[8:11], 0 offen offset:16
    buffer_store_dwordx2 v[14:15], v6, s[8:11], 0 offen offset:24
    buffer_store_dwordx2 v[16:17], v6, s[8:11], 0 offen offset:32
attn_a1_kernel_end:
    s_endpgm
.section .rodata,"a"
.p2align 6
.amdhsa_kernel attn_a1_kernel
  .amdhsa_next_free_vgpr 96
  .amdhsa_next_free_sgpr 40
  .amdhsa_accum_offset 96
  .amdhsa_group_segment_fixed_size 0
  .amdhsa_kernarg_size 104
  .amdhsa_user_sgpr_count 2
  .amdhsa_user_sgpr_kernarg_segment_ptr 1
  .amdhsa_system_sgpr_workgroup_id_x 1
.end_amdhsa_kernel
.text
.globl wo_a1_kernel
.p2align 8
.type wo_a1_kernel,@function
wo_a1_kernel:
    v_lshrrev_b32 v1, 6, v0
    v_and_b32 v2, 63, v0
    s_nop 0
    v_readfirstlane_b32 s3, v1
    s_cmp_ge_u32 s2, 128
    s_cbranch_scc1 wo_a1_kernel_end
    s_load_dwordx2 s[4:5], s[0:1], 96
    s_load_dwordx2 s[6:7], s[0:1], 80
    s_load_dwordx2 s[42:43], s[0:1], 0
    s_mul_i32 s20, s2, 1
    s_lshr_b32 s20, s20, 3
    s_mul_i32 s21, s20, 8
    s_sub_u32 s21, s2, s21
    s_lshl_b32 s20, s20, 2
    s_add_u32 s20, s20, s3
    s_mul_i32 s22, s20, 32
    s_mul_i32 s23, s21, 80
    s_waitcnt lgkmcnt(0)
    s_mov_b32 s8, s4
    s_mov_b32 s9, s5
    s_mov_b32 s10, 268435456
    s_mov_b32 s11, 0x00020000
    v_and_b32 v3, 15, v2
    v_lshrrev_b32 v4, 4, v2
    s_mov_b32 s24, 1280
    v_add_u32 v5, s22, v3
    v_mul_lo_u32 v5, v5, s24
    v_lshlrev_b32 v6, 4, v4
    v_add_u32 v5, v5, v6
    v_add_u32 v5, 18874368, v5
    v_mov_b32 v8, v5
    v_add_u32 v9, 20480, v5
    v_lshlrev_b32 v7, 4, v2
    s_mov_b32 s25, 0
    s_mov_b32 s26, 0
    s_mul_i32 s27, s21, 102400
    s_add_u32 s27, s27, s26
    s_add_u32 s27, s27, 29360128
    s_add_u32 s32, s27, 0
    s_add_u32 s33, s27, 20480
    s_add_u32 s34, s27, 40960
    s_add_u32 s35, s27, 61440
    s_add_u32 s36, s27, 81920
    v_accvgpr_write_b32 a0, 0
    v_accvgpr_write_b32 a1, 0
    v_accvgpr_write_b32 a2, 0
    v_accvgpr_write_b32 a3, 0
    v_accvgpr_write_b32 a4, 0
    v_accvgpr_write_b32 a5, 0
    v_accvgpr_write_b32 a6, 0
    v_accvgpr_write_b32 a7, 0
    v_accvgpr_write_b32 a8, 0
    v_accvgpr_write_b32 a9, 0
    v_accvgpr_write_b32 a10, 0
    v_accvgpr_write_b32 a11, 0
    v_accvgpr_write_b32 a12, 0
    v_accvgpr_write_b32 a13, 0
    v_accvgpr_write_b32 a14, 0
    v_accvgpr_write_b32 a15, 0
    v_accvgpr_write_b32 a16, 0
    v_accvgpr_write_b32 a17, 0
    v_accvgpr_write_b32 a18, 0
    v_accvgpr_write_b32 a19, 0
    v_accvgpr_write_b32 a20, 0
    v_accvgpr_write_b32 a21, 0
    v_accvgpr_write_b32 a22, 0
    v_accvgpr_write_b32 a23, 0
    v_accvgpr_write_b32 a24, 0
    v_accvgpr_write_b32 a25, 0
    v_accvgpr_write_b32 a26, 0
    v_accvgpr_write_b32 a27, 0
    v_accvgpr_write_b32 a28, 0
    v_accvgpr_write_b32 a29, 0
    v_accvgpr_write_b32 a30, 0
    v_accvgpr_write_b32 a31, 0
    v_accvgpr_write_b32 a32, 0
    v_accvgpr_write_b32 a33, 0
    v_accvgpr_write_b32 a34, 0
    v_accvgpr_write_b32 a35, 0
    v_accvgpr_write_b32 a36, 0
    v_accvgpr_write_b32 a37, 0
    v_accvgpr_write_b32 a38, 0
    v_accvgpr_write_b32 a39, 0
    buffer_load_dwordx4 v[16:19], v8, s[8:11], s25 offen
    buffer_load_dwordx4 v[20:23], v9, s[8:11], s25 offen
    buffer_load_dwordx4 v[24:27], v7, s[8:11], s32 offen
    buffer_load_dwordx4 v[28:31], v7, s[8:11], s33 offen
    buffer_load_dwordx4 v[32:35], v7, s[8:11], s34 offen
    buffer_load_dwordx4 v[36:39], v7, s[8:11], s35 offen
    buffer_load_dwordx4 v[40:43], v7, s[8:11], s36 offen
    s_mov_b32 s28, 10
wo_a1_kernel_loop0:
    s_add_u32 s25, s25, 64
    s_add_u32 s32, s32, 1024
    s_add_u32 s33, s33, 1024
    s_add_u32 s34, s34, 1024
    s_add_u32 s35, s35, 1024
    s_add_u32 s36, s36, 1024
    buffer_load_dwordx4 v[44:47], v8, s[8:11], s25 offen
    buffer_load_dwordx4 v[48:51], v9, s[8:11], s25 offen
    buffer_load_dwordx4 v[52:55], v7, s[8:11], s32 offen
    buffer_load_dwordx4 v[56:59], v7, s[8:11], s33 offen
    buffer_load_dwordx4 v[60:63], v7, s[8:11], s34 offen
    buffer_load_dwordx4 v[64:67], v7, s[8:11], s35 offen
    buffer_load_dwordx4 v[68:71], v7, s[8:11], s36 offen
    s_waitcnt vmcnt(7)
    v_mfma_f32_16x16x32_bf16 a[0:3], v[24:27], v[16:19], a[0:3]
    v_mfma_f32_16x16x32_bf16 a[20:23], v[24:27], v[20:23], a[20:23]
    v_mfma_f32_16x16x32_bf16 a[4:7], v[28:31], v[16:19], a[4:7]
    v_mfma_f32_16x16x32_bf16 a[24:27], v[28:31], v[20:23], a[24:27]
    v_mfma_f32_16x16x32_bf16 a[8:11], v[32:35], v[16:19], a[8:11]
    v_mfma_f32_16x16x32_bf16 a[28:31], v[32:35], v[20:23], a[28:31]
    v_mfma_f32_16x16x32_bf16 a[12:15], v[36:39], v[16:19], a[12:15]
    v_mfma_f32_16x16x32_bf16 a[32:35], v[36:39], v[20:23], a[32:35]
    v_mfma_f32_16x16x32_bf16 a[16:19], v[40:43], v[16:19], a[16:19]
    v_mfma_f32_16x16x32_bf16 a[36:39], v[40:43], v[20:23], a[36:39]
    s_sub_u32 s28, s28, 1
    s_cmp_eq_u32 s28, 0
    s_cbranch_scc1 wo_a1_kernel_loop0_last
    s_add_u32 s25, s25, 64
    s_add_u32 s32, s32, 1024
    s_add_u32 s33, s33, 1024
    s_add_u32 s34, s34, 1024
    s_add_u32 s35, s35, 1024
    s_add_u32 s36, s36, 1024
    buffer_load_dwordx4 v[16:19], v8, s[8:11], s25 offen
    buffer_load_dwordx4 v[20:23], v9, s[8:11], s25 offen
    buffer_load_dwordx4 v[24:27], v7, s[8:11], s32 offen
    buffer_load_dwordx4 v[28:31], v7, s[8:11], s33 offen
    buffer_load_dwordx4 v[32:35], v7, s[8:11], s34 offen
    buffer_load_dwordx4 v[36:39], v7, s[8:11], s35 offen
    buffer_load_dwordx4 v[40:43], v7, s[8:11], s36 offen
    s_waitcnt vmcnt(7)
    v_mfma_f32_16x16x32_bf16 a[0:3], v[52:55], v[44:47], a[0:3]
    v_mfma_f32_16x16x32_bf16 a[20:23], v[52:55], v[48:51], a[20:23]
    v_mfma_f32_16x16x32_bf16 a[4:7], v[56:59], v[44:47], a[4:7]
    v_mfma_f32_16x16x32_bf16 a[24:27], v[56:59], v[48:51], a[24:27]
    v_mfma_f32_16x16x32_bf16 a[8:11], v[60:63], v[44:47], a[8:11]
    v_mfma_f32_16x16x32_bf16 a[28:31], v[60:63], v[48:51], a[28:31]
    v_mfma_f32_16x16x32_bf16 a[12:15], v[64:67], v[44:47], a[12:15]
    v_mfma_f32_16x16x32_bf16 a[32:35], v[64:67], v[48:51], a[32:35]
    v_mfma_f32_16x16x32_bf16 a[16:19], v[68:71], v[44:47], a[16:19]
    v_mfma_f32_16x16x32_bf16 a[36:39], v[68:71], v[48:51], a[36:39]
    s_branch wo_a1_kernel_loop0
wo_a1_kernel_loop0_last:
    s_waitcnt vmcnt(0)
    v_mfma_f32_16x16x32_bf16 a[0:3], v[52:55], v[44:47], a[0:3]
    v_mfma_f32_16x16x32_bf16 a[20:23], v[52:55], v[48:51], a[20:23]
    v_mfma_f32_16x16x32_bf16 a[4:7], v[56:59], v[44:47], a[4:7]
    v_mfma_f32_16x16x32_bf16 a[24:27], v[56:59], v[48:51], a[24:27]
    v_mfma_f32_16x16x32_bf16 a[8:11], v[60:63], v[44:47], a[8:11]
    v_mfma_f32_16x16x32_bf16 a[28:31], v[60:63], v[48:51], a[28:31]
    v_mfma_f32_16x16x32_bf16 a[12:15], v[64:67], v[44:47], a[12:15]
    v_mfma_f32_16x16x32_bf16 a[32:35], v[64:67], v[48:51], a[32:35]
    v_mfma_f32_16x16x32_bf16 a[16:19], v[68:71], v[44:47], a[16:19]
    v_mfma_f32_16x16x32_bf16 a[36:39], v[68:71], v[48:51], a[36:39]
    s_nop 7
    s_nop 7
    s_mov_b32 s44, s42
    s_mov_b32 s45, s43
    s_mov_b32 s46, 2621440
    s_mov_b32 s47, 0x00020000
    s_mov_b32 s24, 1280
    v_add_u32 v5, s22, v3
    v_mul_lo_u32 v5, v5, s24
    v_lshlrev_b32 v6, 3, v4
    s_lshl_b32 s29, s23, 1
    v_add3_u32 v5, v5, v6, s29
    v_add_u32 v6, 0, v5
    buffer_load_dwordx2 v[72:73], v6, s[44:47], 0 offen
    v_accvgpr_read_b32 v76, a0
    v_accvgpr_read_b32 v77, a1
    v_accvgpr_read_b32 v78, a2
    v_accvgpr_read_b32 v79, a3
    v_cvt_pk_bf16_f32 v80, v76, v77
    v_cvt_pk_bf16_f32 v81, v78, v79
    s_waitcnt vmcnt(0)
    v_lshlrev_b32 v76, 16, v80
    v_and_b32 v77, 0xffff0000, v80
    v_lshlrev_b32 v82, 16, v72
    v_and_b32 v83, 0xffff0000, v72
    v_add_f32 v76, v76, v82
    v_add_f32 v77, v77, v83
    v_lshlrev_b32 v78, 16, v81
    v_and_b32 v79, 0xffff0000, v81
    v_lshlrev_b32 v82, 16, v73
    v_and_b32 v83, 0xffff0000, v73
    v_add_f32 v78, v78, v82
    v_add_f32 v79, v79, v83
    v_cvt_pk_bf16_f32 v80, v76, v77
    v_cvt_pk_bf16_f32 v81, v78, v79
    v_add_u32 v6, 4194304, v5
    buffer_store_dwordx2 v[80:81], v6, s[8:11], 0 offen
    v_add_u32 v6, 32, v5
    buffer_load_dwordx2 v[72:73], v6, s[44:47], 0 offen
    v_accvgpr_read_b32 v76, a4
    v_accvgpr_read_b32 v77, a5
    v_accvgpr_read_b32 v78, a6
    v_accvgpr_read_b32 v79, a7
    v_cvt_pk_bf16_f32 v80, v76, v77
    v_cvt_pk_bf16_f32 v81, v78, v79
    s_waitcnt vmcnt(0)
    v_lshlrev_b32 v76, 16, v80
    v_and_b32 v77, 0xffff0000, v80
    v_lshlrev_b32 v82, 16, v72
    v_and_b32 v83, 0xffff0000, v72
    v_add_f32 v76, v76, v82
    v_add_f32 v77, v77, v83
    v_lshlrev_b32 v78, 16, v81
    v_and_b32 v79, 0xffff0000, v81
    v_lshlrev_b32 v82, 16, v73
    v_and_b32 v83, 0xffff0000, v73
    v_add_f32 v78, v78, v82
    v_add_f32 v79, v79, v83
    v_cvt_pk_bf16_f32 v80, v76, v77
    v_cvt_pk_bf16_f32 v81, v78, v79
    v_add_u32 v6, 4194336, v5
    buffer_store_dwordx2 v[80:81], v6, s[8:11], 0 offen
    v_add_u32 v6, 64, v5
    buffer_load_dwordx2 v[72:73], v6, s[44:47], 0 offen
    v_accvgpr_read_b32 v76, a8
    v_accvgpr_read_b32 v77, a9
    v_accvgpr_read_b32 v78, a10
    v_accvgpr_read_b32 v79, a11
    v_cvt_pk_bf16_f32 v80, v76, v77
    v_cvt_pk_bf16_f32 v81, v78, v79
    s_waitcnt vmcnt(0)
    v_lshlrev_b32 v76, 16, v80
    v_and_b32 v77, 0xffff0000, v80
    v_lshlrev_b32 v82, 16, v72
    v_and_b32 v83, 0xffff0000, v72
    v_add_f32 v76, v76, v82
    v_add_f32 v77, v77, v83
    v_lshlrev_b32 v78, 16, v81
    v_and_b32 v79, 0xffff0000, v81
    v_lshlrev_b32 v82, 16, v73
    v_and_b32 v83, 0xffff0000, v73
    v_add_f32 v78, v78, v82
    v_add_f32 v79, v79, v83
    v_cvt_pk_bf16_f32 v80, v76, v77
    v_cvt_pk_bf16_f32 v81, v78, v79
    v_add_u32 v6, 4194368, v5
    buffer_store_dwordx2 v[80:81], v6, s[8:11], 0 offen
    v_add_u32 v6, 96, v5
    buffer_load_dwordx2 v[72:73], v6, s[44:47], 0 offen
    v_accvgpr_read_b32 v76, a12
    v_accvgpr_read_b32 v77, a13
    v_accvgpr_read_b32 v78, a14
    v_accvgpr_read_b32 v79, a15
    v_cvt_pk_bf16_f32 v80, v76, v77
    v_cvt_pk_bf16_f32 v81, v78, v79
    s_waitcnt vmcnt(0)
    v_lshlrev_b32 v76, 16, v80
    v_and_b32 v77, 0xffff0000, v80
    v_lshlrev_b32 v82, 16, v72
    v_and_b32 v83, 0xffff0000, v72
    v_add_f32 v76, v76, v82
    v_add_f32 v77, v77, v83
    v_lshlrev_b32 v78, 16, v81
    v_and_b32 v79, 0xffff0000, v81
    v_lshlrev_b32 v82, 16, v73
    v_and_b32 v83, 0xffff0000, v73
    v_add_f32 v78, v78, v82
    v_add_f32 v79, v79, v83
    v_cvt_pk_bf16_f32 v80, v76, v77
    v_cvt_pk_bf16_f32 v81, v78, v79
    v_add_u32 v6, 4194400, v5
    buffer_store_dwordx2 v[80:81], v6, s[8:11], 0 offen
    v_add_u32 v6, 128, v5
    buffer_load_dwordx2 v[72:73], v6, s[44:47], 0 offen
    v_accvgpr_read_b32 v76, a16
    v_accvgpr_read_b32 v77, a17
    v_accvgpr_read_b32 v78, a18
    v_accvgpr_read_b32 v79, a19
    v_cvt_pk_bf16_f32 v80, v76, v77
    v_cvt_pk_bf16_f32 v81, v78, v79
    s_waitcnt vmcnt(0)
    v_lshlrev_b32 v76, 16, v80
    v_and_b32 v77, 0xffff0000, v80
    v_lshlrev_b32 v82, 16, v72
    v_and_b32 v83, 0xffff0000, v72
    v_add_f32 v76, v76, v82
    v_add_f32 v77, v77, v83
    v_lshlrev_b32 v78, 16, v81
    v_and_b32 v79, 0xffff0000, v81
    v_lshlrev_b32 v82, 16, v73
    v_and_b32 v83, 0xffff0000, v73
    v_add_f32 v78, v78, v82
    v_add_f32 v79, v79, v83
    v_cvt_pk_bf16_f32 v80, v76, v77
    v_cvt_pk_bf16_f32 v81, v78, v79
    v_add_u32 v6, 4194432, v5
    buffer_store_dwordx2 v[80:81], v6, s[8:11], 0 offen
    v_add_u32 v6, 20480, v5
    buffer_load_dwordx2 v[72:73], v6, s[44:47], 0 offen
    v_accvgpr_read_b32 v76, a20
    v_accvgpr_read_b32 v77, a21
    v_accvgpr_read_b32 v78, a22
    v_accvgpr_read_b32 v79, a23
    v_cvt_pk_bf16_f32 v80, v76, v77
    v_cvt_pk_bf16_f32 v81, v78, v79
    s_waitcnt vmcnt(0)
    v_lshlrev_b32 v76, 16, v80
    v_and_b32 v77, 0xffff0000, v80
    v_lshlrev_b32 v82, 16, v72
    v_and_b32 v83, 0xffff0000, v72
    v_add_f32 v76, v76, v82
    v_add_f32 v77, v77, v83
    v_lshlrev_b32 v78, 16, v81
    v_and_b32 v79, 0xffff0000, v81
    v_lshlrev_b32 v82, 16, v73
    v_and_b32 v83, 0xffff0000, v73
    v_add_f32 v78, v78, v82
    v_add_f32 v79, v79, v83
    v_cvt_pk_bf16_f32 v80, v76, v77
    v_cvt_pk_bf16_f32 v81, v78, v79
    v_add_u32 v6, 4214784, v5
    buffer_store_dwordx2 v[80:81], v6, s[8:11], 0 offen
    v_add_u32 v6, 20512, v5
    buffer_load_dwordx2 v[72:73], v6, s[44:47], 0 offen
    v_accvgpr_read_b32 v76, a24
    v_accvgpr_read_b32 v77, a25
    v_accvgpr_read_b32 v78, a26
    v_accvgpr_read_b32 v79, a27
    v_cvt_pk_bf16_f32 v80, v76, v77
    v_cvt_pk_bf16_f32 v81, v78, v79
    s_waitcnt vmcnt(0)
    v_lshlrev_b32 v76, 16, v80
    v_and_b32 v77, 0xffff0000, v80
    v_lshlrev_b32 v82, 16, v72
    v_and_b32 v83, 0xffff0000, v72
    v_add_f32 v76, v76, v82
    v_add_f32 v77, v77, v83
    v_lshlrev_b32 v78, 16, v81
    v_and_b32 v79, 0xffff0000, v81
    v_lshlrev_b32 v82, 16, v73
    v_and_b32 v83, 0xffff0000, v73
    v_add_f32 v78, v78, v82
    v_add_f32 v79, v79, v83
    v_cvt_pk_bf16_f32 v80, v76, v77
    v_cvt_pk_bf16_f32 v81, v78, v79
    v_add_u32 v6, 4214816, v5
    buffer_store_dwordx2 v[80:81], v6, s[8:11], 0 offen
    v_add_u32 v6, 20544, v5
    buffer_load_dwordx2 v[72:73], v6, s[44:47], 0 offen
    v_accvgpr_read_b32 v76, a28
    v_accvgpr_read_b32 v77, a29
    v_accvgpr_read_b32 v78, a30
    v_accvgpr_read_b32 v79, a31
    v_cvt_pk_bf16_f32 v80, v76, v77
    v_cvt_pk_bf16_f32 v81, v78, v79
    s_waitcnt vmcnt(0)
    v_lshlrev_b32 v76, 16, v80
    v_and_b32 v77, 0xffff0000, v80
    v_lshlrev_b32 v82, 16, v72
    v_and_b32 v83, 0xffff0000, v72
    v_add_f32 v76, v76, v82
    v_add_f32 v77, v77, v83
    v_lshlrev_b32 v78, 16, v81
    v_and_b32 v79, 0xffff0000, v81
    v_lshlrev_b32 v82, 16, v73
    v_and_b32 v83, 0xffff0000, v73
    v_add_f32 v78, v78, v82
    v_add_f32 v79, v79, v83
    v_cvt_pk_bf16_f32 v80, v76, v77
    v_cvt_pk_bf16_f32 v81, v78, v79
    v_add_u32 v6, 4214848, v5
    buffer_store_dwordx2 v[80:81], v6, s[8:11], 0 offen
    v_add_u32 v6, 20576, v5
    buffer_load_dwordx2 v[72:73], v6, s[44:47], 0 offen
    v_accvgpr_read_b32 v76, a32
    v_accvgpr_read_b32 v77, a33
    v_accvgpr_read_b32 v78, a34
    v_accvgpr_read_b32 v79, a35
    v_cvt_pk_bf16_f32 v80, v76, v77
    v_cvt_pk_bf16_f32 v81, v78, v79
    s_waitcnt vmcnt(0)
    v_lshlrev_b32 v76, 16, v80
    v_and_b32 v77, 0xffff0000, v80
    v_lshlrev_b32 v82, 16, v72
    v_and_b32 v83, 0xffff0000, v72
    v_add_f32 v76, v76, v82
    v_add_f32 v77, v77, v83
    v_lshlrev_b32 v78, 16, v81
    v_and_b32 v79, 0xffff0000, v81
    v_lshlrev_b32 v82, 16, v73
    v_and_b32 v83, 0xffff0000, v73
    v_add_f32 v78, v78, v82
    v_add_f32 v79, v79, v83
    v_cvt_pk_bf16_f32 v80, v76, v77
    v_cvt_pk_bf16_f32 v81, v78, v79
    v_add_u32 v6, 4214880, v5
    buffer_store_dwordx2 v[80:81], v6, s[8:11], 0 offen
    v_add_u32 v6, 20608, v5
    buffer_load_dwordx2 v[72:73], v6, s[44:47], 0 offen
    v_accvgpr_read_b32 v76, a36
    v_accvgpr_read_b32 v77, a37
    v_accvgpr_read_b32 v78, a38
    v_accvgpr_read_b32 v79, a39
    v_cvt_pk_bf16_f32 v80, v76, v77
    v_cvt_pk_bf16_f32 v81, v78, v79
    s_waitcnt vmcnt(0)
    v_lshlrev_b32 v76, 16, v80
    v_and_b32 v77, 0xffff0000, v80
    v_lshlrev_b32 v82, 16, v72
    v_and_b32 v83, 0xffff0000, v72
    v_add_f32 v76, v76, v82
    v_add_f32 v77, v77, v83
    v_lshlrev_b32 v78, 16, v81
    v_and_b32 v79, 0xffff0000, v81
    v_lshlrev_b32 v82, 16, v73
    v_and_b32 v83, 0xffff0000, v73
    v_add_f32 v78, v78, v82
    v_add_f32 v79, v79, v83
    v_cvt_pk_bf16_f32 v80, v76, v77
    v_cvt_pk_bf16_f32 v81, v78, v79
    v_add_u32 v6, 4214912, v5
    buffer_store_dwordx2 v[80:81], v6, s[8:11], 0 offen
wo_a1_kernel_end:
    s_endpgm
.section .rodata,"a"
.p2align 6
.amdhsa_kernel wo_a1_kernel
  .amdhsa_next_free_vgpr 136
  .amdhsa_next_free_sgpr 64
  .amdhsa_accum_offset 96
  .amdhsa_group_segment_fixed_size 0
  .amdhsa_kernarg_size 104
  .amdhsa_user_sgpr_count 2
  .amdhsa_user_sgpr_kernarg_segment_ptr 1
  .amdhsa_system_sgpr_workgroup_id_x 1
.end_amdhsa_kernel
.text
.globl lnf_kernel
.p2align 8
.type lnf_kernel,@function
lnf_kernel:
    s_cmp_ge_u32 s2, 128
    s_cbranch_scc1 lnf_kernel_end
    s_load_dwordx2 s[6:7], s[0:1], 96
    s_load_dwordx2 s[12:13], s[0:1], 96
    v_and_b32 v1, 63, v0
    v_lshrrev_b32 v4, 6, v0
    v_and_b32 v2, 15, v1
    v_lshrrev_b32 v3, 4, v1
    v_readfirstlane_b32 s3, v4
    s_waitcnt lgkmcnt(0)
    s_add_u32 s8, s6, 4194304
    s_addc_u32 s9, s7, 0
    s_mov_b32 s10, 2621440
    s_mov_b32 s11, 0x00020000
    s_add_u32 s16, s12, 59768832
    s_addc_u32 s17, s13, 0
    s_mov_b32 s18, 2621440
    s_mov_b32 s19, 0x00020000
    s_lshl_b32 s4, s2, 4
    v_add_u32 v5, s4, v2
    v_mul_u32_u24 v5, 1280, v5
    v_lshl_add_u32 v5, v3, 4, v5
    s_mul_i32 s5, s3, 320
    v_add_u32 v5, s5, v5
    buffer_load_dwordx4 v[8:11], v5, s[8:11], 0 offen offset:0
    buffer_load_dwordx4 v[12:15], v5, s[8:11], 0 offen offset:64
    buffer_load_dwordx4 v[16:19], v5, s[8:11], 0 offen offset:128
    buffer_load_dwordx4 v[20:23], v5, s[8:11], 0 offen offset:192
    buffer_load_dwordx4 v[24:27], v5, s[8:11], 0 offen offset:256
    v_lshlrev_b32 v6, 4, v2
    s_lshl_b32 s5, s3, 2
    v_add_u32 v7, s5, v6
    s_waitcnt vmcnt(0)
    v_lshlrev_b32 v28, 16, v8
    v_and_b32 v29, 0xffff0000, v8
    v_lshlrev_b32 v30, 16, v9
    v_and_b32 v31, 0xffff0000, v9
    v_lshlrev_b32 v32, 16, v10
    v_and_b32 v33, 0xffff0000, v10
    v_lshlrev_b32 v34, 16, v11
    v_and_b32 v35, 0xffff0000, v11
    v_lshlrev_b32 v36, 16, v12
    v_and_b32 v37, 0xffff0000, v12
    v_lshlrev_b32 v38, 16, v13
    v_and_b32 v39, 0xffff0000, v13
    v_lshlrev_b32 v40, 16, v14
    v_and_b32 v41, 0xffff0000, v14
    v_lshlrev_b32 v42, 16, v15
    v_and_b32 v43, 0xffff0000, v15
    v_lshlrev_b32 v44, 16, v16
    v_and_b32 v45, 0xffff0000, v16
    v_lshlrev_b32 v46, 16, v17
    v_and_b32 v47, 0xffff0000, v17
    v_lshlrev_b32 v48, 16, v18
    v_and_b32 v49, 0xffff0000, v18
    v_lshlrev_b32 v50, 16, v19
    v_and_b32 v51, 0xffff0000, v19
    v_lshlrev_b32 v52, 16, v20
    v_and_b32 v53, 0xffff0000, v20
    v_lshlrev_b32 v54, 16, v21
    v_and_b32 v55, 0xffff0000, v21
    v_lshlrev_b32 v56, 16, v22
    v_and_b32 v57, 0xffff0000, v22
    v_lshlrev_b32 v58, 16, v23
    v_and_b32 v59, 0xffff0000, v23
    v_lshlrev_b32 v60, 16, v24
    v_and_b32 v61, 0xffff0000, v24
    v_lshlrev_b32 v62, 16, v25
    v_and_b32 v63, 0xffff0000, v25
    v_lshlrev_b32 v64, 16, v26
    v_and_b32 v65, 0xffff0000, v26
    v_lshlrev_b32 v66, 16, v27
    v_and_b32 v67, 0xffff0000, v27
    v_add_f32 v68, v28, v29
    v_add_f32 v69, v30, v31
    v_add_f32 v68, v68, v32
    v_add_f32 v69, v69, v33
    v_add_f32 v68, v68, v34
    v_add_f32 v69, v69, v35
    v_add_f32 v68, v68, v36
    v_add_f32 v69, v69, v37
    v_add_f32 v68, v68, v38
    v_add_f32 v69, v69, v39
    v_add_f32 v68, v68, v40
    v_add_f32 v69, v69, v41
    v_add_f32 v68, v68, v42
    v_add_f32 v69, v69, v43
    v_add_f32 v68, v68, v44
    v_add_f32 v69, v69, v45
    v_add_f32 v68, v68, v46
    v_add_f32 v69, v69, v47
    v_add_f32 v68, v68, v48
    v_add_f32 v69, v69, v49
    v_add_f32 v68, v68, v50
    v_add_f32 v69, v69, v51
    v_add_f32 v68, v68, v52
    v_add_f32 v69, v69, v53
    v_add_f32 v68, v68, v54
    v_add_f32 v69, v69, v55
    v_add_f32 v68, v68, v56
    v_add_f32 v69, v69, v57
    v_add_f32 v68, v68, v58
    v_add_f32 v69, v69, v59
    v_add_f32 v68, v68, v60
    v_add_f32 v69, v69, v61
    v_add_f32 v68, v68, v62
    v_add_f32 v69, v69, v63
    v_add_f32 v68, v68, v64
    v_add_f32 v69, v69, v65
    v_add_f32 v68, v68, v66
    v_add_f32 v69, v69, v67
    v_add_f32 v68, v68, v69
    v_mov_b32 v69, v68
    s_nop 1
    v_permlane16_swap_b32 v68, v69
    v_add_f32 v68, v68, v69
    v_mov_b32 v69, v68
    s_nop 1
    v_permlane32_swap_b32 v68, v69
    v_add_f32 v68, v68, v69
    ds_write_b32 v7, v68 offset:0
    s_waitcnt lgkmcnt(0)
    s_barrier
    ds_read_b128 v[8:11], v6 offset:0
    s_waitcnt lgkmcnt(0)
    v_add_f32 v8, v8, v9
    v_add_f32 v10, v10, v11
    v_add_f32 v68, v8, v10
    v_mul_f32 v68, 0.0015625, v68
    v_sub_f32 v28, v28, v68
    v_sub_f32 v29, v29, v68
    v_sub_f32 v30, v30, v68
    v_sub_f32 v31, v31, v68
    v_sub_f32 v32, v32, v68
    v_sub_f32 v33, v33, v68
    v_sub_f32 v34, v34, v68
    v_sub_f32 v35, v35, v68
    v_sub_f32 v36, v36, v68
    v_sub_f32 v37, v37, v68
    v_sub_f32 v38, v38, v68
    v_sub_f32 v39, v39, v68
    v_sub_f32 v40, v40, v68
    v_sub_f32 v41, v41, v68
    v_sub_f32 v42, v42, v68
    v_sub_f32 v43, v43, v68
    v_sub_f32 v44, v44, v68
    v_sub_f32 v45, v45, v68
    v_sub_f32 v46, v46, v68
    v_sub_f32 v47, v47, v68
    v_sub_f32 v48, v48, v68
    v_sub_f32 v49, v49, v68
    v_sub_f32 v50, v50, v68
    v_sub_f32 v51, v51, v68
    v_sub_f32 v52, v52, v68
    v_sub_f32 v53, v53, v68
    v_sub_f32 v54, v54, v68
    v_sub_f32 v55, v55, v68
    v_sub_f32 v56, v56, v68
    v_sub_f32 v57, v57, v68
    v_sub_f32 v58, v58, v68
    v_sub_f32 v59, v59, v68
    v_sub_f32 v60, v60, v68
    v_sub_f32 v61, v61, v68
    v_sub_f32 v62, v62, v68
    v_sub_f32 v63, v63, v68
    v_sub_f32 v64, v64, v68
    v_sub_f32 v65, v65, v68
    v_sub_f32 v66, v66, v68
    v_sub_f32 v67, v67, v68
    v_mul_f32 v68, v28, v28
    v_mul_f32 v69, v29, v29
    v_fmac_f32 v68, v30, v30
    v_fmac_f32 v69, v31, v31
    v_fmac_f32 v68, v32, v32
    v_fmac_f32 v69, v33, v33
    v_fmac_f32 v68, v34, v34
    v_fmac_f32 v69, v35, v35
    v_fmac_f32 v68, v36, v36
    v_fmac_f32 v69, v37, v37
    v_fmac_f32 v68, v38, v38
    v_fmac_f32 v69, v39, v39
    v_fmac_f32 v68, v40, v40
    v_fmac_f32 v69, v41, v41
    v_fmac_f32 v68, v42, v42
    v_fmac_f32 v69, v43, v43
    v_fmac_f32 v68, v44, v44
    v_fmac_f32 v69, v45, v45
    v_fmac_f32 v68, v46, v46
    v_fmac_f32 v69, v47, v47
    v_fmac_f32 v68, v48, v48
    v_fmac_f32 v69, v49, v49
    v_fmac_f32 v68, v50, v50
    v_fmac_f32 v69, v51, v51
    v_fmac_f32 v68, v52, v52
    v_fmac_f32 v69, v53, v53
    v_fmac_f32 v68, v54, v54
    v_fmac_f32 v69, v55, v55
    v_fmac_f32 v68, v56, v56
    v_fmac_f32 v69, v57, v57
    v_fmac_f32 v68, v58, v58
    v_fmac_f32 v69, v59, v59
    v_fmac_f32 v68, v60, v60
    v_fmac_f32 v69, v61, v61
    v_fmac_f32 v68, v62, v62
    v_fmac_f32 v69, v63, v63
    v_fmac_f32 v68, v64, v64
    v_fmac_f32 v69, v65, v65
    v_fmac_f32 v68, v66, v66
    v_fmac_f32 v69, v67, v67
    v_add_f32 v68, v68, v69
    v_mov_b32 v69, v68
    s_nop 1
    v_permlane16_swap_b32 v68, v69
    v_add_f32 v68, v68, v69
    v_mov_b32 v69, v68
    s_nop 1
    v_permlane32_swap_b32 v68, v69
    v_add_f32 v68, v68, v69
    ds_write_b32 v7, v68 offset:256
    s_waitcnt lgkmcnt(0)
    s_barrier
    ds_read_b128 v[8:11], v6 offset:256
    s_waitcnt lgkmcnt(0)
    v_add_f32 v8, v8, v9
    v_add_f32 v10, v10, v11
    v_add_f32 v68, v8, v10
    v_mov_b32 v69, 0x3727c5ac
    v_fmac_f32 v69, 0.0015625, v68
    v_rsq_f32 v69, v69
    s_nop 0
    v_mul_f32 v28, v28, v69
    v_mul_f32 v29, v29, v69
    v_mul_f32 v30, v30, v69
    v_mul_f32 v31, v31, v69
    v_mul_f32 v32, v32, v69
    v_mul_f32 v33, v33, v69
    v_mul_f32 v34, v34, v69
    v_mul_f32 v35, v35, v69
    v_mul_f32 v36, v36, v69
    v_mul_f32 v37, v37, v69
    v_mul_f32 v38, v38, v69
    v_mul_f32 v39, v39, v69
    v_mul_f32 v40, v40, v69
    v_mul_f32 v41, v41, v69
    v_mul_f32 v42, v42, v69
    v_mul_f32 v43, v43, v69
    v_mul_f32 v44, v44, v69
    v_mul_f32 v45, v45, v69
    v_mul_f32 v46, v46, v69
    v_mul_f32 v47, v47, v69
    v_mul_f32 v48, v48, v69
    v_mul_f32 v49, v49, v69
    v_mul_f32 v50, v50, v69
    v_mul_f32 v51, v51, v69
    v_mul_f32 v52, v52, v69
    v_mul_f32 v53, v53, v69
    v_mul_f32 v54, v54, v69
    v_mul_f32 v55, v55, v69
    v_mul_f32 v56, v56, v69
    v_mul_f32 v57, v57, v69
    v_mul_f32 v58, v58, v69
    v_mul_f32 v59, v59, v69
    v_mul_f32 v60, v60, v69
    v_mul_f32 v61, v61, v69
    v_mul_f32 v62, v62, v69
    v_mul_f32 v63, v63, v69
    v_mul_f32 v64, v64, v69
    v_mul_f32 v65, v65, v69
    v_mul_f32 v66, v66, v69
    v_mul_f32 v67, v67, v69
    v_cvt_pk_bf16_f32 v8, v28, v29
    v_cvt_pk_bf16_f32 v9, v30, v31
    v_cvt_pk_bf16_f32 v10, v32, v33
    v_cvt_pk_bf16_f32 v11, v34, v35
    v_cvt_pk_bf16_f32 v12, v36, v37
    v_cvt_pk_bf16_f32 v13, v38, v39
    v_cvt_pk_bf16_f32 v14, v40, v41
    v_cvt_pk_bf16_f32 v15, v42, v43
    v_cvt_pk_bf16_f32 v16, v44, v45
    v_cvt_pk_bf16_f32 v17, v46, v47
    v_cvt_pk_bf16_f32 v18, v48, v49
    v_cvt_pk_bf16_f32 v19, v50, v51
    v_cvt_pk_bf16_f32 v20, v52, v53
    v_cvt_pk_bf16_f32 v21, v54, v55
    v_cvt_pk_bf16_f32 v22, v56, v57
    v_cvt_pk_bf16_f32 v23, v58, v59
    v_cvt_pk_bf16_f32 v24, v60, v61
    v_cvt_pk_bf16_f32 v25, v62, v63
    v_cvt_pk_bf16_f32 v26, v64, v65
    v_cvt_pk_bf16_f32 v27, v66, v67
    s_mul_i32 s4, s2, 20480
    s_mul_i32 s5, s3, 5120
    s_add_u32 s4, s4, s5
    v_lshlrev_b32 v5, 4, v1
    buffer_store_dwordx4 v[8:11], v5, s[16:19], s4 offen offset:0
    buffer_store_dwordx4 v[12:15], v5, s[16:19], s4 offen offset:1024
    buffer_store_dwordx4 v[16:19], v5, s[16:19], s4 offen offset:2048
    buffer_store_dwordx4 v[20:23], v5, s[16:19], s4 offen offset:3072
    s_add_u32 s4, s4, 4096
    buffer_store_dwordx4 v[24:27], v5, s[16:19], s4 offen offset:0
lnf_kernel_end:
    s_endpgm
.section .rodata,"a"
.p2align 6
.amdhsa_kernel lnf_kernel
  .amdhsa_next_free_vgpr 72
  .amdhsa_next_free_sgpr 40
  .amdhsa_accum_offset 72
  .amdhsa_group_segment_fixed_size 0
  .amdhsa_kernarg_size 104
  .amdhsa_user_sgpr_count 2
  .amdhsa_user_sgpr_kernarg_segment_ptr 1
  .amdhsa_system_sgpr_workgroup_id_x 1
.end_amdhsa_kernel
.text
.globl clr_kernel
.p2align 8
.type clr_kernel,@function
clr_kernel:
    s_cmp_ge_u32 s2, 1251
    s_cbranch_scc1 clr_kernel_end
    s_load_dwordx2 s[4:5], s[0:1], 96
    s_waitcnt lgkmcnt(0)
    s_add_u32 s8, s4, 117440512
    s_addc_u32 s9, s5, 0
    s_mov_b32 s10, 40992768
    s_mov_b32 s11, 0x00020000
    s_mul_i32 s12, s2, 32768
    v_lshlrev_b32 v1, 4, v0
    v_add_u32 v1, s12, v1
    v_mov_b32 v4, -1
    v_mov_b32 v5, -1
    v_mov_b32 v6, -1
    v_mov_b32 v7, -1
    s_mov_b32 s13, 0
    buffer_store_dwordx4 v[4:7], v1, s[8:11], s13 offen
    s_mov_b32 s13, 4096
    buffer_store_dwordx4 v[4:7], v1, s[8:11], s13 offen
    s_mov_b32 s13, 8192
    buffer_store_dwordx4 v[4:7], v1, s[8:11], s13 offen
    s_mov_b32 s13, 12288
    buffer_store_dwordx4 v[4:7], v1, s[8:11], s13 offen
    s_mov_b32 s13, 16384
    buffer_store_dwordx4 v[4:7], v1, s[8:11], s13 offen
    s_mov_b32 s13, 20480
    buffer_store_dwordx4 v[4:7], v1, s[8:11], s13 offen
    s_mov_b32 s13, 24576
    buffer_store_dwordx4 v[4:7], v1, s[8:11], s13 offen
    s_mov_b32 s13, 28672
    buffer_store_dwordx4 v[4:7], v1, s[8:11], s13 offen
clr_kernel_end:
    s_endpgm
.section .rodata,"a"
.p2align 6
.amdhsa_kernel clr_kernel
  .amdhsa_next_free_vgpr 16
  .amdhsa_next_free_sgpr 24
  .amdhsa_accum_offset 16
  .amdhsa_group_segment_fixed_size 0
  .amdhsa_kernarg_size 104
  .amdhsa_user_sgpr_count 2
  .amdhsa_user_sgpr_kernarg_segment_ptr 1
  .amdhsa_system_sgpr_workgroup_id_x 1
.end_amdhsa_kernel
.text
.globl chain1_kernel
.p2align 8
.type chain1_kernel,@function
chain1_kernel:
    s_cmp_ge_u32 s2, 232
    s_cbranch_scc1 chain1_kernel_end
    s_load_dwordx2 s[4:5], s[0:1], 96
    s_load_dwordx2 s[6:7], s[0:1], 32
    v_and_b32 v1, 63, v0
    v_lshrrev_b32 v4, 6, v0
    v_and_b32 v2, 15, v1
    v_lshrrev_b32 v3, 4, v1
    v_readfirstlane_b32 s3, v4
    s_mov_b32 s60, 131072
    s_waitcnt lgkmcnt(0)
    s_mov_b32 s8, s4
    s_mov_b32 s9, s5
    s_mov_b32 s10, 268435456
    s_mov_b32 s11, 0x00020000
    s_mov_b32 s20, s6
    s_mov_b32 s21, s7
    s_mov_b32 s22, 10240
    s_mov_b32 s23, 0x00020000
    s_cmp_ge_u32 s2, 200
    s_cbranch_scc1 chain1_kernel_roleO
    s_cmp_ge_u32 s2, 104
    s_cbranch_scc1 chain1_kernel_roleP
    s_cmp_ge_u32 s2, 64
    s_cbranch_scc1 chain1_kernel_roleR
    s_cmp_ge_u32 s2, 32
    s_cbranch_scc1 chain1_kernel_roleV
    s_mov_b32 s44, s2
    s_load_dwordx2 s[6:7], s[0:1], 40
    s_load_dwordx2 s[24:25], s[0:1], 48
    s_waitcnt lgkmcnt(0)
    s_mov_b32 s12, s6
    s_mov_b32 s13, s7
    s_mov_b32 s14, 7864320
    s_mov_b32 s15, 0x00020000
    s_mov_b32 s16, s24
    s_mov_b32 s17, s25
    s_mov_b32 s18, 7864320
    s_mov_b32 s19, 0x00020000
    v_add_u32 v16, 0, v0
    s_mov_b32 s24, 683
    v_mul_lo_u32 v17, v16, s24
    v_lshrrev_b32 v17, 14, v17
    v_mul_u32_u24 v18, 24, v17
    v_sub_u32 v18, v16, v18
    s_mov_b32 s24, 12288
    v_mul_lo_u32 v4, v17, s24
    v_lshl_add_u32 v4, v18, 4, v4
    v_mul_u32_u24 v10, 400, v17
    v_lshl_add_u32 v10, v18, 4, v10
    v_add_u32 v10, 106496, v10
    v_add_u32 v16, 256, v0
    s_mov_b32 s24, 683
    v_mul_lo_u32 v17, v16, s24
    v_lshrrev_b32 v17, 14, v17
    v_mul_u32_u24 v18, 24, v17
    v_sub_u32 v18, v16, v18
    s_mov_b32 s24, 12288
    v_mul_lo_u32 v5, v17, s24
    v_lshl_add_u32 v5, v18, 4, v5
    v_mul_u32_u24 v11, 400, v17
    v_lshl_add_u32 v11, v18, 4, v11
    v_add_u32 v11, 106496, v11
    v_add_u32 v16, 512, v0
    s_mov_b32 s24, 683
    v_mul_lo_u32 v17, v16, s24
    v_lshrrev_b32 v17, 14, v17
    v_mul_u32_u24 v18, 24, v17
    v_sub_u32 v18, v16, v18
    s_mov_b32 s24, 12288
    v_mul_lo_u32 v6, v17, s24
    v_lshl_add_u32 v6, v18, 4, v6
    v_mul_u32_u24 v12, 400, v17
    v_lshl_add_u32 v12, v18, 4, v12
    v_add_u32 v12, 106496, v12
    v_add_u32 v16, 768, v0
    s_mov_b32 s24, 683
    v_mul_lo_u32 v17, v16, s24
    v_lshrrev_b32 v17, 14, v17
    v_mul_u32_u24 v18, 24, v17
    v_sub_u32 v18, v16, v18
    s_mov_b32 s24, 12288
    v_mul_lo_u32 v7, v17, s24
    v_lshl_add_u32 v7, v18, 4, v7
    v_mul_u32_u24 v13, 400, v17
    v_lshl_add_u32 v13, v18, 4, v13
    v_add_u32 v13, 106496, v13
    v_add_u32 v16, 1024, v0
    s_mov_b32 s24, 683
    v_mul_lo_u32 v17, v16, s24
    v_lshrrev_b32 v17, 14, v17
    v_mul_u32_u24 v18, 24, v17
    v_sub_u32 v18, v16, v18
    s_mov_b32 s24, 12288
    v_mul_lo_u32 v8, v17, s24
    v_lshl_add_u32 v8, v18, 4, v8
    v_mul_u32_u24 v14, 400, v17
    v_lshl_add_u32 v14, v18, 4, v14
    v_add_u32 v14, 106496, v14
    v_add_u32 v16, 1280, v0
    s_mov_b32 s24, 683
    v_mul_lo_u32 v17, v16, s24
    v_lshrrev_b32 v17, 14, v17
    v_mul_u32_u24 v18, 24, v17
    v_sub_u32 v18, v16, v18
    s_mov_b32 s24, 12288
    v_mul_lo_u32 v9, v17, s24
    v_lshl_add_u32 v9, v18, 4, v9
    v_mul_u32_u24 v15, 400, v17
    v_lshl_add_u32 v15, v18, 4, v15
    v_add_u32 v15, 106496, v15
    v_lshrrev_b32 v17, 1, v3
    v_lshlrev_b32 v17, 4, v17
    v_and_b32 v18, 1, v3
    v_lshl_add_u32 v17, v18, 2, v17
    v_lshrrev_b32 v18, 2, v2
    v_and_b32 v19, 1, v18
    v_add_u32 v17, v17, v19
    v_lshrrev_b32 v18, 1, v18
    v_lshl_add_u32 v17, v18, 3, v17
    v_mul_u32_u24 v16, 400, v17
    v_and_b32 v18, 3, v2
    v_lshl_add_u32 v16, v18, 3, v16
    v_add_u32 v16, 106496, v16
    s_mul_i32 s24, s3, 96
    v_add_u32 v16, s24, v16
    v_lshlrev_b32 v17, 4, v1
    s_mul_i32 s24, s3, 20480
    s_add_u32 s24, s24, 24576
    v_add_u32 v17, s24, v17
    s_mul_i32 s45, s44, 384
    s_add_u32 s46, s45, 0
    buffer_load_dwordx4 v[24:27], v4, s[12:15], s46 offen
    buffer_load_dwordx4 v[28:31], v5, s[12:15], s46 offen
    buffer_load_dwordx4 v[32:35], v6, s[12:15], s46 offen
    buffer_load_dwordx4 v[36:39], v7, s[12:15], s46 offen
    buffer_load_dwordx4 v[40:43], v8, s[12:15], s46 offen
    buffer_load_dwordx4 v[44:47], v9, s[12:15], s46 offen
    s_add_u32 s46, s45, 0
    buffer_load_dwordx4 v[48:51], v4, s[16:19], s46 offen
    buffer_load_dwordx4 v[52:55], v5, s[16:19], s46 offen
    buffer_load_dwordx4 v[56:59], v6, s[16:19], s46 offen
    buffer_load_dwordx4 v[60:63], v7, s[16:19], s46 offen
    buffer_load_dwordx4 v[64:67], v8, s[16:19], s46 offen
    buffer_load_dwordx4 v[68:71], v9, s[16:19], s46 offen
    s_waitcnt vmcnt(6)
    ds_write_b128 v10, v[24:27]
    ds_write_b128 v11, v[28:31]
    ds_write_b128 v12, v[32:35]
    ds_write_b128 v13, v[36:39]
    ds_write_b128 v14, v[40:43]
    ds_write_b128 v15, v[44:47]
    s_add_u32 s46, s45, 786432
    buffer_load_dwordx4 v[72:75], v4, s[12:15], s46 offen
    buffer_load_dwordx4 v[76:79], v5, s[12:15], s46 offen
    buffer_load_dwordx4 v[80:83], v6, s[12:15], s46 offen
    buffer_load_dwordx4 v[84:87], v7, s[12:15], s46 offen
    buffer_load_dwordx4 v[88:91], v8, s[12:15], s46 offen
    buffer_load_dwordx4 v[92:95], v9, s[12:15], s46 offen
    s_waitcnt lgkmcnt(0)
    s_barrier
    ds_read_b64_tr_b16 a[0:1], v16 offset:0
    ds_read_b64_tr_b16 a[2:3], v16 offset:800
    ds_read_b64_tr_b16 a[4:5], v16 offset:12800
    ds_read_b64_tr_b16 a[6:7], v16 offset:13600
    ds_read_b64_tr_b16 a[80:81], v16 offset:32
    ds_read_b64_tr_b16 a[82:83], v16 offset:832
    ds_read_b64_tr_b16 a[84:85], v16 offset:12832
    ds_read_b64_tr_b16 a[86:87], v16 offset:13632
    ds_read_b64_tr_b16 a[160:161], v16 offset:64
    ds_read_b64_tr_b16 a[162:163], v16 offset:864
    ds_read_b64_tr_b16 a[164:165], v16 offset:12864
    ds_read_b64_tr_b16 a[166:167], v16 offset:13664
    s_waitcnt lgkmcnt(0)
    s_barrier
    s_waitcnt vmcnt(6)
    ds_write_b128 v10, v[48:51]
    ds_write_b128 v11, v[52:55]
    ds_write_b128 v12, v[56:59]
    ds_write_b128 v13, v[60:63]
    ds_write_b128 v14, v[64:67]
    ds_write_b128 v15, v[68:71]
    s_add_u32 s46, s45, 786432
    buffer_load_dwordx4 v[24:27], v4, s[16:19], s46 offen
    buffer_load_dwordx4 v[28:31], v5, s[16:19], s46 offen
    buffer_load_dwordx4 v[32:35], v6, s[16:19], s46 offen
    buffer_load_dwordx4 v[36:39], v7, s[16:19], s46 offen
    buffer_load_dwordx4 v[40:43], v8, s[16:19], s46 offen
    buffer_load_dwordx4 v[44:47], v9, s[16:19], s46 offen
    s_waitcnt lgkmcnt(0)
    s_barrier
    ds_read_b64_tr_b16 v[96:97], v16 offset:0
    ds_read_b64_tr_b16 v[98:99], v16 offset:800
    ds_read_b64_tr_b16 v[100:101], v16 offset:12800
    ds_read_b64_tr_b16 v[102:103], v16 offset:13600
    ds_read_b64_tr_b16 v[176:177], v16 offset:32
    ds_read_b64_tr_b16 v[178:179], v16 offset:832
    ds_read_b64_tr_b16 v[180:181], v16 offset:12832
    ds_read_b64_tr_b16 v[182:183], v16 offset:13632
    ds_read_b64_tr_b16 v[48:49], v16 offset:64
    ds_read_b64_tr_b16 v[50:51], v16 offset:864
    ds_read_b64_tr_b16 v[52:53], v16 offset:12864
    ds_read_b64_tr_b16 v[54:55], v16 offset:13664
    s_waitcnt lgkmcnt(0)
    ds_write_b128 v17, v[48:51] offset:0
    ds_write_b128 v17, v[52:55] offset:1024
    s_waitcnt lgkmcnt(0)
    s_barrier
    s_waitcnt vmcnt(6)
    ds_write_b128 v10, v[72:75]
    ds_write_b128 v11, v[76:79]
    ds_write_b128 v12, v[80:83]
    ds_write_b128 v13, v[84:87]
    ds_write_b128 v14, v[88:91]
    ds_write_b128 v15, v[92:95]
    s_add_u32 s46, s45, 1572864
    buffer_load_dwordx4 v[48:51], v4, s[12:15], s46 offen
    buffer_load_dwordx4 v[52:55], v5, s[12:15], s46 offen
    buffer_load_dwordx4 v[56:59], v6, s[12:15], s46 offen
    buffer_load_dwordx4 v[60:63], v7, s[12:15], s46 offen
    buffer_load_dwordx4 v[64:67], v8, s[12:15], s46 offen
    buffer_load_dwordx4 v[68:71], v9, s[12:15], s46 offen
    s_waitcnt lgkmcnt(0)
    s_barrier
    ds_read_b64_tr_b16 a[8:9], v16 offset:0
    ds_read_b64_tr_b16 a[10:11], v16 offset:800
    ds_read_b64_tr_b16 a[12:13], v16 offset:12800
    ds_read_b64_tr_b16 a[14:15], v16 offset:13600
    ds_read_b64_tr_b16 a[88:89], v16 offset:32
    ds_read_b64_tr_b16 a[90:91], v16 offset:832
    ds_read_b64_tr_b16 a[92:93], v16 offset:12832
    ds_read_b64_tr_b16 a[94:95], v16 offset:13632
    ds_read_b64_tr_b16 a[168:169], v16 offset:64
    ds_read_b64_tr_b16 a[170:171], v16 offset:864
    ds_read_b64_tr_b16 a[172:173], v16 offset:12864
    ds_read_b64_tr_b16 a[174:175], v16 offset:13664
    s_waitcnt lgkmcnt(0)
    s_barrier
    s_waitcnt vmcnt(6)
    ds_write_b128 v10, v[24:27]
    ds_write_b128 v11, v[28:31]
    ds_write_b128 v12, v[32:35]
    ds_write_b128 v13, v[36:39]
    ds_write_b128 v14, v[40:43]
    ds_write_b128 v15, v[44:47]
    s_add_u32 s46, s45, 1572864
    buffer_load_dwordx4 v[72:75], v4, s[16:19], s46 offen
    buffer_load_dwordx4 v[76:79], v5, s[16:19], s46 offen
    buffer_load_dwordx4 v[80:83], v6, s[16:19], s46 offen
    buffer_load_dwordx4 v[84:87], v7, s[16:19], s46 offen
    buffer_load_dwordx4 v[88:91], v8, s[16:19], s46 offen
    buffer_load_dwordx4 v[92:95], v9, s[16:19], s46 offen
    s_waitcnt lgkmcnt(0)
    s_barrier
    ds_read_b64_tr_b16 v[104:105], v16 offset:0
    ds_read_b64_tr_b16 v[106:107], v16 offset:800
    ds_read_b64_tr_b16 v[108:109], v16 offset:12800
    ds_read_b64_tr_b16 v[110:111], v16 offset:13600
    ds_read_b64_tr_b16 v[184:185], v16 offset:32
    ds_read_b64_tr_b16 v[186:187], v16 offset:832
    ds_read_b64_tr_b16 v[188:189], v16 offset:12832
    ds_read_b64_tr_b16 v[190:191], v16 offset:13632
    ds_read_b64_tr_b16 v[24:25], v16 offset:64
    ds_read_b64_tr_b16 v[26:27], v16 offset:864
    ds_read_b64_tr_b16 v[28:29], v16 offset:12864
    ds_read_b64_tr_b16 v[30:31], v16 offset:13664
    s_waitcnt lgkmcnt(0)
    ds_write_b128 v17, v[24:27] offset:2048
    ds_write_b128 v17, v[28:31] offset:3072
    s_waitcnt lgkmcnt(0)
    s_barrier
    s_waitcnt vmcnt(6)
    ds_write_b128 v10, v[48:51]
    ds_write_b128 v11, v[52:55]
    ds_write_b128 v12, v[56:59]
    ds_write_b128 v13, v[60:63]
    ds_write_b128 v14, v[64:67]
    ds_write_b128 v15, v[68:71]
    s_add_u32 s46, s45, 2359296
    buffer_load_dwordx4 v[24:27], v4, s[12:15], s46 offen
    buffer_load_dwordx4 v[28:31], v5, s[12:15], s46 offen
    buffer_load_dwordx4 v[32:35], v6, s[12:15], s46 offen
    buffer_load_dwordx4 v[36:39], v7, s[12:15], s46 offen
    buffer_load_dwordx4 v[40:43], v8, s[12:15], s46 offen
    buffer_load_dwordx4 v[44:47], v9, s[12:15], s46 offen
    s_waitcnt lgkmcnt(0)
    s_barrier
    ds_read_b64_tr_b16 a[16:17], v16 offset:0
    ds_read_b64_tr_b16 a[18:19], v16 offset:800
    ds_read_b64_tr_b16 a[20:21], v16 offset:12800
    ds_read_b64_tr_b16 a[22:23], v16 offset:13600
    ds_read_b64_tr_b16 a[96:97], v16 offset:32
    ds_read_b64_tr_b16 a[98:99], v16 offset:832
    ds_read_b64_tr_b16 a[100:101], v16 offset:12832
    ds_read_b64_tr_b16 a[102:103], v16 offset:13632
    ds_read_b64_tr_b16 a[176:177], v16 offset:64
    ds_read_b64_tr_b16 a[178:179], v16 offset:864
    ds_read_b64_tr_b16 a[180:181], v16 offset:12864
    ds_read_b64_tr_b16 a[182:183], v16 offset:13664
    s_waitcnt lgkmcnt(0)
    s_barrier
    s_waitcnt vmcnt(6)
    ds_write_b128 v10, v[72:75]
    ds_write_b128 v11, v[76:79]
    ds_write_b128 v12, v[80:83]
    ds_write_b128 v13, v[84:87]
    ds_write_b128 v14, v[88:91]
    ds_write_b128 v15, v[92:95]
    s_add_u32 s46, s45, 2359296
    buffer_load_dwordx4 v[48:51], v4, s[16:19], s46 offen
    buffer_load_dwordx4 v[52:55], v5, s[16:19], s46 offen
    buffer_load_dwordx4 v[56:59], v6, s[16:19], s46 offen
    buffer_load_dwordx4 v[60:63], v7, s[16:19], s46 offen
    buffer_load_dwordx4 v[64:67], v8, s[16:19], s46 offen
    buffer_load_dwordx4 v[68:71], v9, s[16:19], s46 offen
    s_waitcnt lgkmcnt(0)
    s_barrier
    ds_read_b64_tr_b16 v[112:113], v16 offset:0
    ds_read_b64_tr_b16 v[114:115], v16 offset:800
    ds_read_b64_tr_b16 v[116:117], v16 offset:12800
    ds_read_b64_tr_b16 v[118:119], v16 offset:13600
    ds_read_b64_tr_b16 v[192:193], v16 offset:32
    ds_read_b64_tr_b16 v[194:195], v16 offset:832
    ds_read_b64_tr_b16 v[196:197], v16 offset:12832
    ds_read_b64_tr_b16 v[198:199], v16 offset:13632
    ds_read_b64_tr_b16 v[72:73], v16 offset:64
    ds_read_b64_tr_b16 v[74:75], v16 offset:864
    ds_read_b64_tr_b16 v[76:77], v16 offset:12864
    ds_read_b64_tr_b16 v[78:79], v16 offset:13664
    s_waitcnt lgkmcnt(0)
    ds_write_b128 v17, v[72:75] offset:4096
    ds_write_b128 v17, v[76:79] offset:5120
    s_waitcnt lgkmcnt(0)
    s_barrier
    s_waitcnt vmcnt(6)
    ds_write_b128 v10, v[24:27]
    ds_write_b128 v11, v[28:31]
    ds_write_b128 v12, v[32:35]
    ds_write_b128 v13, v[36:39]
    ds_write_b128 v14, v[40:43]
    ds_write_b128 v15, v[44:47]
    s_add_u32 s46, s45, 3145728
    buffer_load_dwordx4 v[72:75], v4, s[12:15], s46 offen
    buffer_load_dwordx4 v[76:79], v5, s[12:15], s46 offen
    buffer_load_dwordx4 v[80:83], v6, s[12:15], s46 offen
    buffer_load_dwordx4 v[84:87], v7, s[12:15], s46 offen
    buffer_load_dwordx4 v[88:91], v8, s[12:15], s46 offen
    buffer_load_dwordx4 v[92:95], v9, s[12:15], s46 offen
    s_waitcnt lgkmcnt(0)
    s_barrier
    ds_read_b64_tr_b16 a[24:25], v16 offset:0
    ds_read_b64_tr_b16 a[26:27], v16 offset:800
    ds_read_b64_tr_b16 a[28:29], v16 offset:12800
    ds_read_b64_tr_b16 a[30:31], v16 offset:13600
    ds_read_b64_tr_b16 a[104:105], v16 offset:32
    ds_read_b64_tr_b16 a[106:107], v16 offset:832
    ds_read_b64_tr_b16 a[108:109], v16 offset:12832
    ds_read_b64_tr_b16 a[110:111], v16 offset:13632
    ds_read_b64_tr_b16 a[184:185], v16 offset:64
    ds_read_b64_tr_b16 a[186:187], v16 offset:864
    ds_read_b64_tr_b16 a[188:189], v16 offset:12864
    ds_read_b64_tr_b16 a[190:191], v16 offset:13664
    s_waitcnt lgkmcnt(0)
    s_barrier
    s_waitcnt vmcnt(6)
    ds_write_b128 v10, v[48:51]
    ds_write_b128 v11, v[52:55]
    ds_write_b128 v12, v[56:59]
    ds_write_b128 v13, v[60:63]
    ds_write_b128 v14, v[64:67]
    ds_write_b128 v15, v[68:71]
    s_add_u32 s46, s45, 3145728
    buffer_load_dwordx4 v[24:27], v4, s[16:19], s46 offen
    buffer_load_dwordx4 v[28:31], v5, s[16:19], s46 offen
    buffer_load_dwordx4 v[32:35], v6, s[16:19], s46 offen
    buffer_load_dwordx4 v[36:39], v7, s[16:19], s46 offen
    buffer_load_dwordx4 v[40:43], v8, s[16:19], s46 offen
    buffer_load_dwordx4 v[44:47], v9, s[16:19], s46 offen
    s_waitcnt lgkmcnt(0)
    s_barrier
    ds_read_b64_tr_b16 v[120:121], v16 offset:0
    ds_read_b64_tr_b16 v[122:123], v16 offset:800
    ds_read_b64_tr_b16 v[124:125], v16 offset:12800
    ds_read_b64_tr_b16 v[126:127], v16 offset:13600
    ds_read_b64_tr_b16 v[200:201], v16 offset:32
    ds_read_b64_tr_b16 v[202:203], v16 offset:832
    ds_read_b64_tr_b16 v[204:205], v16 offset:12832
    ds_read_b64_tr_b16 v[206:207], v16 offset:13632
    ds_read_b64_tr_b16 v[48:49], v16 offset:64
    ds_read_b64_tr_b16 v[50:51], v16 offset:864
    ds_read_b64_tr_b16 v[52:53], v16 offset:12864
    ds_read_b64_tr_b16 v[54:55], v16 offset:13664
    s_waitcnt lgkmcnt(0)
    ds_write_b128 v17, v[48:51] offset:6144
    ds_write_b128 v17, v[52:55] offset:7168
    s_waitcnt lgkmcnt(0)
    s_barrier
    s_waitcnt vmcnt(6)
    ds_write_b128 v10, v[72:75]
    ds_write_b128 v11, v[76:79]
    ds_write_b128 v12, v[80:83]
    ds_write_b128 v13, v[84:87]
    ds_write_b128 v14, v[88:91]
    ds_write_b128 v15, v[92:95]
    s_add_u32 s46, s45, 3932160
    buffer_load_dwordx4 v[48:51], v4, s[12:15], s46 offen
    buffer_load_dwordx4 v[52:55], v5, s[12:15], s46 offen
    buffer_load_dwordx4 v[56:59], v6, s[12:15], s46 offen
    buffer_load_dwordx4 v[60:63], v7, s[12:15], s46 offen
    buffer_load_dwordx4 v[64:67], v8, s[12:15], s46 offen
    buffer_load_dwordx4 v[68:71], v9, s[12:15], s46 offen
    s_waitcnt lgkmcnt(0)
    s_barrier
    ds_read_b64_tr_b16 a[32:33], v16 offset:0
    ds_read_b64_tr_b16 a[34:35], v16 offset:800
    ds_read_b64_tr_b16 a[36:37], v16 offset:12800
    ds_read_b64_tr_b16 a[38:39], v16 offset:13600
    ds_read_b64_tr_b16 a[112:113], v16 offset:32
    ds_read_b64_tr_b16 a[114:115], v16 offset:832
    ds_read_b64_tr_b16 a[116:117], v16 offset:12832
    ds_read_b64_tr_b16 a[118:119], v16 offset:13632
    ds_read_b64_tr_b16 a[192:193], v16 offset:64
    ds_read_b64_tr_b16 a[194:195], v16 offset:864
    ds_read_b64_tr_b16 a[196:197], v16 offset:12864
    ds_read_b64_tr_b16 a[198:199], v16 offset:13664
    s_waitcnt lgkmcnt(0)
    s_barrier
    s_waitcnt vmcnt(6)
    ds_write_b128 v10, v[24:27]
    ds_write_b128 v11, v[28:31]
    ds_write_b128 v12, v[32:35]
    ds_write_b128 v13, v[36:39]
    ds_write_b128 v14, v[40:43]
    ds_write_b128 v15, v[44:47]
    s_add_u32 s46, s45, 3932160
    buffer_load_dwordx4 v[72:75], v4, s[16:19], s46 offen
    buffer_load_dwordx4 v[76:79], v5, s[16:19], s46 offen
    buffer_load_dwordx4 v[80:83], v6, s[16:19], s46 offen
    buffer_load_dwordx4 v[84:87], v7, s[16:19], s46 offen
    buffer_load_dwordx4 v[88:91], v8, s[16:19], s46 offen
    buffer_load_dwordx4 v[92:95], v9, s[16:19], s46 offen
    s_waitcnt lgkmcnt(0)
    s_barrier
    ds_read_b64_tr_b16 v[128:129], v16 offset:0
    ds_read_b64_tr_b16 v[130:131], v16 offset:800
    ds_read_b64_tr_b16 v[132:133], v16 offset:12800
    ds_read_b64_tr_b16 v[134:135], v16 offset:13600
    ds_read_b64_tr_b16 v[208:209], v16 offset:32
    ds_read_b64_tr_b16 v[210:211], v16 offset:832
    ds_read_b64_tr_b16 v[212:213], v16 offset:12832
    ds_read_b64_tr_b16 v[214:215], v16 offset:13632
    ds_read_b64_tr_b16 v[24:25], v16 offset:64
    ds_read_b64_tr_b16 v[26:27], v16 offset:864
    ds_read_b64_tr_b16 v[28:29], v16 offset:12864
    ds_read_b64_tr_b16 v[30:31], v16 offset:13664
    s_waitcnt lgkmcnt(0)
    ds_write_b128 v17, v[24:27] offset:8192
    ds_write_b128 v17, v[28:31] offset:9216
    s_waitcnt lgkmcnt(0)
    s_barrier
    s_waitcnt vmcnt(6)
    ds_write_b128 v10, v[48:51]
    ds_write_b128 v11, v[52:55]
    ds_write_b128 v12, v[56:59]
    ds_write_b128 v13, v[60:63]
    ds_write_b128 v14, v[64:67]
    ds_write_b128 v15, v[68:71]
    s_add_u32 s46, s45, 4718592
    buffer_load_dwordx4 v[24:27], v4, s[12:15], s46 offen
    buffer_load_dwordx4 v[28:31], v5, s[12:15], s46 offen
    buffer_load_dwordx4 v[32:35], v6, s[12:15], s46 offen
    buffer_load_dwordx4 v[36:39], v7, s[12:15], s46 offen
    buffer_load_dwordx4 v[40:43], v8, s[12:15], s46 offen
    buffer_load_dwordx4 v[44:47], v9, s[12:15], s46 offen
    s_waitcnt lgkmcnt(0)
    s_barrier
    ds_read_b64_tr_b16 a[40:41], v16 offset:0
    ds_read_b64_tr_b16 a[42:43], v16 offset:800
    ds_read_b64_tr_b16 a[44:45], v16 offset:12800
    ds_read_b64_tr_b16 a[46:47], v16 offset:13600
    ds_read_b64_tr_b16 a[120:121], v16 offset:32
    ds_read_b64_tr_b16 a[122:123], v16 offset:832
    ds_read_b64_tr_b16 a[124:125], v16 offset:12832
    ds_read_b64_tr_b16 a[126:127], v16 offset:13632
    ds_read_b64_tr_b16 a[200:201], v16 offset:64
    ds_read_b64_tr_b16 a[202:203], v16 offset:864
    ds_read_b64_tr_b16 a[204:205], v16 offset:12864
    ds_read_b64_tr_b16 a[206:207], v16 offset:13664
    s_waitcnt lgkmcnt(0)
    s_barrier
    s_waitcnt vmcnt(6)
    ds_write_b128 v10, v[72:75]
    ds_write_b128 v11, v[76:79]
    ds_write_b128 v12, v[80:83]
    ds_write_b128 v13, v[84:87]
    ds_write_b128 v14, v[88:91]
    ds_write_b128 v15, v[92:95]
    s_add_u32 s46, s45, 4718592
    buffer_load_dwordx4 v[48:51], v4, s[16:19], s46 offen
    buffer_load_dwordx4 v[52:55], v5, s[16:19], s46 offen
    buffer_load_dwordx4 v[56:59], v6, s[16:19], s46 offen
    buffer_load_dwordx4 v[60:63], v7, s[16:19], s46 offen
    buffer_load_dwordx4 v[64:67], v8, s[16:19], s46 offen
    buffer_load_dwordx4 v[68:71], v9, s[16:19], s46 offen
    s_waitcnt lgkmcnt(0)
    s_barrier
    ds_read_b64_tr_b16 v[136:137], v16 offset:0
    ds_read_b64_tr_b16 v[138:139], v16 offset:800
    ds_read_b64_tr_b16 v[140:141], v16 offset:12800
    ds_read_b64_tr_b16 v[142:143], v16 offset:13600
    ds_read_b64_tr_b16 v[216:217], v16 offset:32
    ds_read_b64_tr_b16 v[218:219], v16 offset:832
    ds_read_b64_tr_b16 v[220:221], v16 offset:12832
    ds_read_b64_tr_b16 v[222:223], v16 offset:13632
    ds_read_b64_tr_b16 v[72:73], v16 offset:64
    ds_read_b64_tr_b16 v[74:75], v16 offset:864
    ds_read_b64_tr_b16 v[76:77], v16 offset:12864
    ds_read_b64_tr_b16 v[78:79], v16 offset:13664
    s_waitcnt lgkmcnt(0)
    ds_write_b128 v17, v[72:75] offset:10240
    ds_write_b128 v17, v[76:79] offset:11264
    s_waitcnt lgkmcnt(0)
    s_barrier
    s_waitcnt vmcnt(6)
    ds_write_b128 v10, v[24:27]
    ds_write_b128 v11, v[28:31]
    ds_write_b128 v12, v[32:35]
    ds_write_b128 v13, v[36:39]
    ds_write_b128 v14, v[40:43]
    ds_write_b128 v15, v[44:47]
    s_add_u32 s46, s45, 5505024
    buffer_load_dwordx4 v[72:75], v4, s[12:15], s46 offen
    buffer_load_dwordx4 v[76:79], v5, s[12:15], s46 offen
    buffer_load_dwordx4 v[80:83], v6, s[12:15], s46 offen
    buffer_load_dwordx4 v[84:87], v7, s[12:15], s46 offen
    buffer_load_dwordx4 v[88:91], v8, s[12:15], s46 offen
    buffer_load_dwordx4 v[92:95], v9, s[12:15], s46 offen
    s_waitcnt lgkmcnt(0)
    s_barrier
    ds_read_b64_tr_b16 a[48:49], v16 offset:0
    ds_read_b64_tr_b16 a[50:51], v16 offset:800
    ds_read_b64_tr_b16 a[52:53], v16 offset:12800
    ds_read_b64_tr_b16 a[54:55], v16 offset:13600
    ds_read_b64_tr_b16 a[128:129], v16 offset:32
    ds_read_b64_tr_b16 a[130:131], v16 offset:832
    ds_read_b64_tr_b16 a[132:133], v16 offset:12832
    ds_read_b64_tr_b16 a[134:135], v16 offset:13632
    ds_read_b64_tr_b16 a[208:209], v16 offset:64
    ds_read_b64_tr_b16 a[210:211], v16 offset:864
    ds_read_b64_tr_b16 a[212:213], v16 offset:12864
    ds_read_b64_tr_b16 a[214:215], v16 offset:13664
    s_waitcnt lgkmcnt(0)
    s_barrier
    s_waitcnt vmcnt(6)
    ds_write_b128 v10, v[48:51]
    ds_write_b128 v11, v[52:55]
    ds_write_b128 v12, v[56:59]
    ds_write_b128 v13, v[60:63]
    ds_write_b128 v14, v[64:67]
    ds_write_b128 v15, v[68:71]
    s_add_u32 s46, s45, 5505024
    buffer_load_dwordx4 v[24:27], v4, s[16:19], s46 offen
    buffer_load_dwordx4 v[28:31], v5, s[16:19], s46 offen
    buffer_load_dwordx4 v[32:35], v6, s[16:19], s46 offen
    buffer_load_dwordx4 v[36:39], v7, s[16:19], s46 offen
    buffer_load_dwordx4 v[40:43], v8, s[16:19], s46 offen
    buffer_load_dwordx4 v[44:47], v9, s[16:19], s46 offen
    s_waitcnt lgkmcnt(0)
    s_barrier
    ds_read_b64_tr_b16 v[144:145], v16 offset:0
    ds_read_b64_tr_b16 v[146:147], v16 offset:800
    ds_read_b64_tr_b16 v[148:149], v16 offset:12800
    ds_read_b64_tr_b16 v[150:151], v16 offset:13600
    ds_read_b64_tr_b16 v[224:225], v16 offset:32
    ds_read_b64_tr_b16 v[226:227], v16 offset:832
    ds_read_b64_tr_b16 v[228:229], v16 offset:12832
    ds_read_b64_tr_b16 v[230:231], v16 offset:13632
    ds_read_b64_tr_b16 v[48:49], v16 offset:64
    ds_read_b64_tr_b16 v[50:51], v16 offset:864
    ds_read_b64_tr_b16 v[52:53], v16 offset:12864
    ds_read_b64_tr_b16 v[54:55], v16 offset:13664
    s_waitcnt lgkmcnt(0)
    ds_write_b128 v17, v[48:51] offset:12288
    ds_write_b128 v17, v[52:55] offset:13312
    s_waitcnt lgkmcnt(0)
    s_barrier
    s_waitcnt vmcnt(6)
    ds_write_b128 v10, v[72:75]
    ds_write_b128 v11, v[76:79]
    ds_write_b128 v12, v[80:83]
    ds_write_b128 v13, v[84:87]
    ds_write_b128 v14, v[88:91]
    ds_write_b128 v15, v[92:95]
    s_add_u32 s46, s45, 6291456
    buffer_load_dwordx4 v[48:51], v4, s[12:15], s46 offen
    buffer_load_dwordx4 v[52:55], v5, s[12:15], s46 offen
    buffer_load_dwordx4 v[56:59], v6, s[12:15], s46 offen
    buffer_load_dwordx4 v[60:63], v7, s[12:15], s46 offen
    buffer_load_dwordx4 v[64:67], v8, s[12:15], s46 offen
    buffer_load_dwordx4 v[68:71], v9, s[12:15], s46 offen
    s_waitcnt lgkmcnt(0)
    s_barrier
    ds_read_b64_tr_b16 a[56:57], v16 offset:0
    ds_read_b64_tr_b16 a[58:59], v16 offset:800
    ds_read_b64_tr_b16 a[60:61], v16 offset:12800
    ds_read_b64_tr_b16 a[62:63], v16 offset:13600
    ds_read_b64_tr_b16 a[136:137], v16 offset:32
    ds_read_b64_tr_b16 a[138:139], v16 offset:832
    ds_read_b64_tr_b16 a[140:141], v16 offset:12832
    ds_read_b64_tr_b16 a[142:143], v16 offset:13632
    ds_read_b64_tr_b16 a[216:217], v16 offset:64
    ds_read_b64_tr_b16 a[218:219], v16 offset:864
    ds_read_b64_tr_b16 a[220:221], v16 offset:12864
    ds_read_b64_tr_b16 a[222:223], v16 offset:13664
    s_waitcnt lgkmcnt(0)
    s_barrier
    s_waitcnt vmcnt(6)
    ds_write_b128 v10, v[24:27]
    ds_write_b128 v11, v[28:31]
    ds_write_b128 v12, v[32:35]
    ds_write_b128 v13, v[36:39]
    ds_write_b128 v14, v[40:43]
    ds_write_b128 v15, v[44:47]
    s_add_u32 s46, s45, 6291456
    buffer_load_dwordx4 v[72:75], v4, s[16:19], s46 offen
    buffer_load_dwordx4 v[76:79], v5, s[16:19], s46 offen
    buffer_load_dwordx4 v[80:83], v6, s[16:19], s46 offen
    buffer_load_dwordx4 v[84:87], v7, s[16:19], s46 offen
    buffer_load_dwordx4 v[88:91], v8, s[16:19], s46 offen
    buffer_load_dwordx4 v[92:95], v9, s[16:19], s46 offen
    s_waitcnt lgkmcnt(0)
    s_barrier
    ds_read_b64_tr_b16 v[152:153], v16 offset:0
    ds_read_b64_tr_b16 v[154:155], v16 offset:800
    ds_read_b64_tr_b16 v[156:157], v16 offset:12800
    ds_read_b64_tr_b16 v[158:159], v16 offset:13600
    ds_read_b64_tr_b16 v[232:233], v16 offset:32
    ds_read_b64_tr_b16 v[234:235], v16 offset:832
    ds_read_b64_tr_b16 v[236:237], v16 offset:12832
    ds_read_b64_tr_b16 v[238:239], v16 offset:13632
    ds_read_b64_tr_b16 v[24:25], v16 offset:64
    ds_read_b64_tr_b16 v[26:27], v16 offset:864
    ds_read_b64_tr_b16 v[28:29], v16 offset:12864
    ds_read_b64_tr_b16 v[30:31], v16 offset:13664
    s_waitcnt lgkmcnt(0)
    ds_write_b128 v17, v[24:27] offset:14336
    ds_write_b128 v17, v[28:31] offset:15360
    s_waitcnt lgkmcnt(0)
    s_barrier
    s_waitcnt vmcnt(6)
    ds_write_b128 v10, v[48:51]
    ds_write_b128 v11, v[52:55]
    ds_write_b128 v12, v[56:59]
    ds_write_b128 v13, v[60:63]
    ds_write_b128 v14, v[64:67]
    ds_write_b128 v15, v[68:71]
    s_add_u32 s46, s45, 7077888
    buffer_load_dwordx4 v[24:27], v4, s[12:15], s46 offen
    buffer_load_dwordx4 v[28:31], v5, s[12:15], s46 offen
    buffer_load_dwordx4 v[32:35], v6, s[12:15], s46 offen
    buffer_load_dwordx4 v[36:39], v7, s[12:15], s46 offen
    buffer_load_dwordx4 v[40:43], v8, s[12:15], s46 offen
    buffer_load_dwordx4 v[44:47], v9, s[12:15], s46 offen
    s_waitcnt lgkmcnt(0)
    s_barrier
    ds_read_b64_tr_b16 a[64:65], v16 offset:0
    ds_read_b64_tr_b16 a[66:67], v16 offset:800
    ds_read_b64_tr_b16 a[68:69], v16 offset:12800
    ds_read_b64_tr_b16 a[70:71], v16 offset:13600
    ds_read_b64_tr_b16 a[144:145], v16 offset:32
    ds_read_b64_tr_b16 a[146:147], v16 offset:832
    ds_read_b64_tr_b16 a[148:149], v16 offset:12832
    ds_read_b64_tr_b16 a[150:151], v16 offset:13632
    ds_read_b64_tr_b16 a[224:225], v16 offset:64
    ds_read_b64_tr_b16 a[226:227], v16 offset:864
    ds_read_b64_tr_b16 a[228:229], v16 offset:12864
    ds_read_b64_tr_b16 a[230:231], v16 offset:13664
    s_waitcnt lgkmcnt(0)
    s_barrier
    s_waitcnt vmcnt(6)
    ds_write_b128 v10, v[72:75]
    ds_write_b128 v11, v[76:79]
    ds_write_b128 v12, v[80:83]
    ds_write_b128 v13, v[84:87]
    ds_write_b128 v14, v[88:91]
    ds_write_b128 v15, v[92:95]
    s_add_u32 s46, s45, 7077888
    buffer_load_dwordx4 v[48:51], v4, s[16:19], s46 offen
    buffer_load_dwordx4 v[52:55], v5, s[16:19], s46 offen
    buffer_load_dwordx4 v[56:59], v6, s[16:19], s46 offen
    buffer_load_dwordx4 v[60:63], v7, s[16:19], s46 offen
    buffer_load_dwordx4 v[64:67], v8, s[16:19], s46 offen
    buffer_load_dwordx4 v[68:71], v9, s[16:19], s46 offen
    s_waitcnt lgkmcnt(0)
    s_barrier
    ds_read_b64_tr_b16 v[160:161], v16 offset:0
    ds_read_b64_tr_b16 v[162:163], v16 offset:800
    ds_read_b64_tr_b16 v[164:165], v16 offset:12800
    ds_read_b64_tr_b16 v[166:167], v16 offset:13600
    ds_read_b64_tr_b16 v[240:241], v16 offset:32
    ds_read_b64_tr_b16 v[242:243], v16 offset:832
    ds_read_b64_tr_b16 v[244:245], v16 offset:12832
    ds_read_b64_tr_b16 v[246:247], v16 offset:13632
    ds_read_b64_tr_b16 v[72:73], v16 offset:64
    ds_read_b64_tr_b16 v[74:75], v16 offset:864
    ds_read_b64_tr_b16 v[76:77], v16 offset:12864
    ds_read_b64_tr_b16 v[78:79], v16 offset:13664
    s_waitcnt lgkmcnt(0)
    ds_write_b128 v17, v[72:75] offset:16384
    ds_write_b128 v17, v[76:79] offset:17408
    s_waitcnt lgkmcnt(0)
    s_barrier
    s_waitcnt vmcnt(6)
    ds_write_b128 v10, v[24:27]
    ds_write_b128 v11, v[28:31]
    ds_write_b128 v12, v[32:35]
    ds_write_b128 v13, v[36:39]
    ds_write_b128 v14, v[40:43]
    ds_write_b128 v15, v[44:47]
    s_waitcnt lgkmcnt(0)
    s_barrier
    ds_read_b64_tr_b16 a[72:73], v16 offset:0
    ds_read_b64_tr_b16 a[74:75], v16 offset:800
    ds_read_b64_tr_b16 a[76:77], v16 offset:12800
    ds_read_b64_tr_b16 a[78:79], v16 offset:13600
    ds_read_b64_tr_b16 a[152:153], v16 offset:32
    ds_read_b64_tr_b16 a[154:155], v16 offset:832
    ds_read_b64_tr_b16 a[156:157], v16 offset:12832
    ds_read_b64_tr_b16 a[158:159], v16 offset:13632
    ds_read_b64_tr_b16 a[232:233], v16 offset:64
    ds_read_b64_tr_b16 a[234:235], v16 offset:864
    ds_read_b64_tr_b16 a[236:237], v16 offset:12864
    ds_read_b64_tr_b16 a[238:239], v16 offset:13664
    s_waitcnt lgkmcnt(0)
    s_barrier
    s_waitcnt vmcnt(0)
    ds_write_b128 v10, v[48:51]
    ds_write_b128 v11, v[52:55]
    ds_write_b128 v12, v[56:59]
    ds_write_b128 v13, v[60:63]
    ds_write_b128 v14, v[64:67]
    ds_write_b128 v15, v[68:71]
    s_waitcnt lgkmcnt(0)
    s_barrier
    ds_read_b64_tr_b16 v[168:169], v16 offset:0
    ds_read_b64_tr_b16 v[170:171], v16 offset:800
    ds_read_b64_tr_b16 v[172:173], v16 offset:12800
    ds_read_b64_tr_b16 v[174:175], v16 offset:13600
    ds_read_b64_tr_b16 v[248:249], v16 offset:32
    ds_read_b64_tr_b16 v[250:251], v16 offset:832
    ds_read_b64_tr_b16 v[252:253], v16 offset:12832
    ds_read_b64_tr_b16 v[254:255], v16 offset:13632
    ds_read_b64_tr_b16 v[48:49], v16 offset:64
    ds_read_b64_tr_b16 v[50:51], v16 offset:864
    ds_read_b64_tr_b16 v[52:53], v16 offset:12864
    ds_read_b64_tr_b16 v[54:55], v16 offset:13664
    s_waitcnt lgkmcnt(0)
    ds_write_b128 v17, v[48:51] offset:18432
    ds_write_b128 v17, v[52:55] offset:19456
    s_waitcnt lgkmcnt(0)
    s_barrier
    v_mov_b32 v6, v17
    v_mov_b32 v30, 0xeeee
    v_mov_b32 v4, 0x4444
    v_cmp_gt_u32 vcc, 8, v2
    s_nop 1
    v_cndmask_b32 v4, v30, v4, vcc
    v_lshlrev_b32 v5, 4, v1
    s_lshl_b32 s24, s3, 10
    v_add_u32 v7, s24, v5
    s_lshl_b32 s24, s3, 9
    s_add_u32 s24, s24, 8192
    v_lshlrev_b32 v8, 3, v1
    v_add_u32 v8, s24, v8
    s_mul_i32 s24, s3, 1536
    s_add_u32 s24, s24, 10240
    v_lshlrev_b32 v9, 5, v2
    v_lshl_add_u32 v9, v3, 3, v9
    v_add_u32 v9, s24, v9
    v_lshrrev_b32 v30, 2, v2
    v_and_b32 v31, 3, v2
    v_lshl_add_u32 v11, v3, 2, v30
    v_lshlrev_b32 v11, 5, v11
    v_lshl_add_u32 v11, v31, 3, v11
    v_add_u32 v11, s24, v11
    v_add_u32 v33, 22528, v5
    s_mul_i32 s24, s3, 1408
    s_add_u32 s24, s24, 16384
    v_mul_u32_u24 v30, 176, v2
    v_add_u32 v30, s24, v30
    v_lshl_add_u32 v12, v3, 5, v30
    v_cmp_gt_u32 vcc, 8, v2
    s_nop 1
    v_cndmask_b32 v12, v33, v12, vcc
    v_lshl_add_u32 v13, v3, 4, v30
    v_add_u32 v13, 96, v13
    v_cmp_le_u32 s[24:25], 2, v3
    s_and_b64 vcc, vcc, s[24:25]
    v_cndmask_b32 v13, v33, v13, vcc
    s_mul_i32 s24, s3, 5632
    s_add_u32 s24, s24, 106496
    v_mul_u32_u24 v30, 176, v2
    v_add_u32 v30, s24, v30
    v_lshl_add_u32 v16, v3, 5, v30
    v_lshl_add_u32 v17, v3, 4, v30
    v_add_u32 v17, 96, v17
    v_add_u32 v18, 2816, v17
    v_cmp_le_u32 vcc, 2, v3
    s_nop 1
    v_cndmask_b32 v17, v33, v17, vcc
    v_cndmask_b32 v18, v33, v18, vcc
    v_lshrrev_b32 v30, 3, v1
    v_and_b32 v31, 7, v1
    v_min_u32 v32, 4, v31
    v_mul_u32_u24 v14, 176, v30
    v_lshl_add_u32 v14, v32, 5, v14
    s_mul_i32 s24, s3, 1408
    s_add_u32 s24, s24, 106496
    v_add_u32 v21, s24, v14
    v_add_u32 v14, 16384, v14
    v_cmp_gt_u32 s[50:51], 5, v31
    s_lshl_b32 s24, s3, 3
    v_add_u32 v32, s24, v30
    v_lshlrev_b32 v33, 2, v31
    v_sub_u32 v32, v32, v33
    v_mov_b32 v33, 100
    v_cmp_gt_u32 vcc, 4, v31
    s_nop 1
    v_cndmask_b32 v32, v33, v32, vcc
    v_cmp_le_i32 s[64:65], 0, v32
    v_cmp_le_i32 s[66:67], 1, v32
    v_cmp_le_i32 s[68:69], 2, v32
    v_cmp_le_i32 s[70:71], 3, v32
    v_cmp_le_i32 s[72:73], 16, v32
    v_cmp_le_i32 s[74:75], 17, v32
    v_cmp_le_i32 s[76:77], 18, v32
    v_cmp_le_i32 s[78:79], 19, v32
    s_lshr_b32 s24, s44, 1
    s_lshl_b32 s24, s24, 10
    s_and_b32 s25, s44, 1
    s_lshl_b32 s25, s25, 7
    s_add_u32 s24, s24, s25
    v_lshlrev_b32 v15, 8, v31
    v_lshl_add_u32 v15, v30, 4, v15
    v_add_u32 v15, s24, v15
    s_lshr_b32 s24, s44, 3
    s_lshl_b32 s24, s24, 10
    s_and_b32 s25, s44, 3
    s_lshl_b32 s25, s25, 8
    s_add_u32 s24, s24, s25
    s_lshr_b32 s25, s44, 2
    s_and_b32 s25, s25, 1
    s_lshl_b32 s25, s25, 7
    s_add_u32 s24, s24, s25
    s_add_u32 s24, s24, 16384
    v_lshlrev_b32 v32, 4, v30
    v_add_u32 v32, s24, v32
    v_cmp_eq_u32 vcc, 4, v31
    s_nop 1
    v_cndmask_b32 v15, v15, v32, vcc
    v_mov_b32 v32, 2146435072
    v_cndmask_b32 v15, v32, v15, s[50:51]
    s_mul_i32 s24, s3, 20480
    v_add_u32 v15, s24, v15
    s_cmp_lt_u32 s3, 1
    s_cselect_b32 s24, 0, 2146435072
    v_or_b32 v15, s24, v15
    s_and_b32 s24, s3, 1
    s_lshl_b32 s24, s24, 7
    s_lshr_b32 s25, s3, 1
    s_lshl_b32 s25, s25, 10
    s_add_u32 s24, s24, s25
    s_lshl_b32 s25, s44, 11
    s_add_u32 s25, s25, s24
    v_lshlrev_b32 v22, 8, v31
    v_lshl_add_u32 v22, v30, 4, v22
    v_add_u32 v22, s25, v22
    s_lshr_b32 s25, s44, 2
    s_lshl_b32 s25, s25, 11
    s_add_u32 s25, s25, s24
    s_and_b32 s26, s44, 3
    s_lshl_b32 s26, s26, 8
    s_add_u32 s25, s25, s26
    s_add_u32 s25, s25, 65536
    v_lshlrev_b32 v32, 4, v30
    v_add_u32 v32, s25, v32
    v_cmp_eq_u32 vcc, 4, v31
    s_nop 1
    v_cndmask_b32 v22, v22, v32, vcc
    v_mov_b32 v32, 2146435072
    v_cndmask_b32 v22, v32, v22, s[50:51]
    s_mul_i32 s24, s44, 12288
    s_mul_i32 s25, s3, 3072
    s_add_u32 s24, s24, s25
    v_add_u32 v19, s24, v5
    v_and_b32 v10, 1, v1
    v_lshlrev_b32 v10, 12, v10
    s_lshl_b32 s24, s44, 7
    s_add_u32 s24, s24, 151560192
    v_add_u32 v10, s24, v10
    s_and_b32 s24, s2, 15
    s_mul_i32 s25, s3, 16
    s_add_u32 s24, s24, s25
    s_lshl_b32 s24, s24, 7
    v_mov_b32 v23, s24
    s_lshr_b32 s25, s44, 3
    s_mul_i32 s24, s25, 8
    v_add_u32 v20, s24, v1
    v_lshlrev_b32 v20, 7, v20
    v_mov_b32 v30, 2146435072
    v_cmp_le_u32 vcc, 8, v1
    s_nop 1
    v_cndmask_b32 v20, v20, v30, vcc
    s_cmp_eq_u32 s3, 0
    s_cselect_b32 s24, 0, 2146435072
    v_or_b32 v20, s24, v20
    s_mov_b32 s48, 151576576
    s_mov_b32 s49, 154238976
    v_add_u32 v48, 0, v0
    v_and_b32 v49, 7, v48
    v_mul_u32_u24 v49, 1280, v49
    v_lshrrev_b32 v50, 3, v48
    v_lshl_add_u32 v49, v50, 4, v49
    v_cmp_gt_u32 vcc, 640, v48
    v_mov_b32 v51, 2146435072
    s_nop 0
    v_cndmask_b32 v49, v51, v49, vcc
    buffer_load_dwordx4 v[52:55], v49, s[20:23], 0 offen
    v_lshlrev_b32 v48, 4, v48
    s_waitcnt vmcnt(0)
    s_and_saveexec_b64 s[30:31], vcc
    ds_write_b128 v48, v[52:55]
    s_mov_b64 exec, s[30:31]
    v_add_u32 v48, 256, v0
    v_and_b32 v49, 7, v48
    v_mul_u32_u24 v49, 1280, v49
    v_lshrrev_b32 v50, 3, v48
    v_lshl_add_u32 v49, v50, 4, v49
    v_cmp_gt_u32 vcc, 640, v48
    v_mov_b32 v51, 2146435072
    s_nop 0
    v_cndmask_b32 v49, v51, v49, vcc
    buffer_load_dwordx4 v[52:55], v49, s[20:23], 0 offen
    v_lshlrev_b32 v48, 4, v48
    s_waitcnt vmcnt(0)
    s_and_saveexec_b64 s[30:31], vcc
    ds_write_b128 v48, v[52:55]
    s_mov_b64 exec, s[30:31]
    v_add_u32 v48, 512, v0
    v_and_b32 v49, 7, v48
    v_mul_u32_u24 v49, 1280, v49
    v_lshrrev_b32 v50, 3, v48
    v_lshl_add_u32 v49, v50, 4, v49
    v_cmp_gt_u32 vcc, 640, v48
    v_mov_b32 v51, 2146435072
    s_nop 0
    v_cndmask_b32 v49, v51, v49, vcc
    buffer_load_dwordx4 v[52:55], v49, s[20:23], 0 offen
    v_lshlrev_b32 v48, 4, v48
    s_waitcnt vmcnt(0)
    s_and_saveexec_b64 s[30:31], vcc
    ds_write_b128 v48, v[52:55]
    s_mov_b64 exec, s[30:31]
    v_mov_b32 v0, 1
    s_mov_b32 s40, 0
    s_mov_b32 s54, 5
    s_mov_b32 s41, 92274688
    s_mov_b32 s42, 146317312
    s_mov_b32 s43, 141074432
    s_mov_b32 s45, 67108864
    s_mov_b32 s47, 138412032
    s_mov_b32 s62, -1
    s_mov_b32 s63, 1
    s_cmp_ge_i32 s62, s63
    s_cbranch_scc1 chain1_kernel_s_en0_ok
    s_mov_b32 s61, 0
chain1_kernel_s_en0:
    buffer_load_dword v48, v10, s[8:11], 0 offen sc1
    s_waitcnt vmcnt(0)
    v_readlane_b32 s62, v48, 0
    v_readlane_b32 s24, v48, 1
    s_min_i32 s62, s62, s24
    s_cmp_ge_i32 s62, s63
    s_cbranch_scc1 chain1_kernel_s_en0_ok
    s_add_u32 s61, s61, 1
    s_cmp_ge_u32 s61, s60
    s_cbranch_scc1 chain1_kernel_s_en0_to
    s_sleep 2
    s_branch chain1_kernel_s_en0
chain1_kernel_s_en0_to:
    s_mov_b32 s60, 1
chain1_kernel_s_en0_ok:
    buffer_load_dwordx4 a[240:243], v19, s[8:11], s41 offen offset:0 sc1
    buffer_load_dwordx4 a[244:247], v19, s[8:11], s41 offen offset:1024 sc1
    buffer_load_dwordx4 a[248:251], v19, s[8:11], s41 offen offset:2048 sc1
    s_waitcnt lgkmcnt(0)
    s_branch chain1_kernel_s_go
chain1_kernel_s_step:
    v_mov_b32 v24, 0
    v_mov_b32 v25, 0
    v_mov_b32 v26, 0
    v_mov_b32 v27, 0
    v_mov_b32 v28, 0
    v_mov_b32 v29, 0
    v_mov_b32 v30, 0
    v_mov_b32 v31, 0
    v_mov_b32 v32, 0
    v_mov_b32 v33, 0
    v_mov_b32 v34, 0
    v_mov_b32 v35, 0
    v_mov_b32 v36, 0
    v_mov_b32 v37, 0
    v_mov_b32 v38, 0
    v_mov_b32 v39, 0
    v_mov_b32 v40, 0
    v_mov_b32 v41, 0
    v_mov_b32 v42, 0
    v_mov_b32 v43, 0
    v_mov_b32 v44, 0
    v_mov_b32 v45, 0
    v_mov_b32 v46, 0
    v_mov_b32 v47, 0
    s_add_u32 s46, s47, 4096
    s_add_u32 s63, s40, 1
    s_cmp_ge_i32 s62, s63
    s_cbranch_scc1 chain1_kernel_s_en_ok
    s_mov_b32 s61, 0
chain1_kernel_s_en:
    buffer_load_dword v48, v10, s[8:11], 0 offen sc1
    s_waitcnt vmcnt(0)
    v_readlane_b32 s62, v48, 0
    v_readlane_b32 s24, v48, 1
    s_min_i32 s62, s62, s24
    s_cmp_ge_i32 s62, s63
    s_cbranch_scc1 chain1_kernel_s_en_ok
    s_add_u32 s61, s61, 1
    s_cmp_ge_u32 s61, s60
    s_cbranch_scc1 chain1_kernel_s_en_to
    s_sleep 2
    s_branch chain1_kernel_s_en
chain1_kernel_s_en_to:
    s_mov_b32 s60, 1
chain1_kernel_s_en_ok:
    s_sleep 5
    s_mov_b64 exec, 1
    s_mov_b32 s61, 0
    v_mov_b32 v83, 0
    buffer_atomic_add v83, v23, s[8:11], s48 offen sc0
    s_sleep 2
    v_mov_b32 v94, 0
    buffer_atomic_add v94, v23, s[8:11], s48 offen sc0
    s_sleep 2
    v_mov_b32 v95, 0
    buffer_atomic_add v95, v23, s[8:11], s48 offen sc0
    s_sleep 2
chain1_kernel_s_pr:
    v_mov_b32 v82, 0
    buffer_atomic_add v82, v23, s[8:11], s48 offen sc0
    s_waitcnt vmcnt(3)
    v_cmp_le_i32 vcc, 9, v83
    s_add_u32 s61, s61, 1
    s_cbranch_vccnz chain1_kernel_s_pr_out
    s_sleep 2
    v_mov_b32 v83, 0
    buffer_atomic_add v83, v23, s[8:11], s48 offen sc0
    s_waitcnt vmcnt(3)
    v_cmp_le_i32 vcc, 9, v94
    s_add_u32 s61, s61, 1
    s_cbranch_vccnz chain1_kernel_s_pr_out
    s_sleep 2
    v_mov_b32 v94, 0
    buffer_atomic_add v94, v23, s[8:11], s48 offen sc0
    s_waitcnt vmcnt(3)
    v_cmp_le_i32 vcc, 9, v95
    s_add_u32 s61, s61, 1
    s_cbranch_vccnz chain1_kernel_s_pr_out
    s_sleep 2
    v_mov_b32 v95, 0
    buffer_atomic_add v95, v23, s[8:11], s48 offen sc0
    s_waitcnt vmcnt(3)
    v_cmp_le_i32 vcc, 9, v82
    s_add_u32 s61, s61, 1
    s_cbranch_vccnz chain1_kernel_s_pr_out
    s_sleep 2
    s_cmp_ge_u32 s61, s60
    s_cbranch_scc0 chain1_kernel_s_pr
    s_mov_b32 s60, 1
chain1_kernel_s_pr_out:
    s_mov_b64 exec, -1
    buffer_load_dwordx4 v[84:87], v7, s[8:11], s47 offen sc1
    buffer_load_dwordx4 v[88:91], v7, s[8:11], s46 offen sc1
    buffer_load_dwordx2 v[92:93], v8, s[8:11], s47 offen sc1
    buffer_load_dwordx4 a[240:243], v19, s[8:11], s41 offen offset:0 sc1
    buffer_load_dwordx4 a[244:247], v19, s[8:11], s41 offen offset:1024 sc1
    buffer_load_dwordx4 a[248:251], v19, s[8:11], s41 offen offset:2048 sc1
    ds_read_b128 v[48:51], v21 offset:0
    ds_read_b128 v[52:55], v21 offset:16
    ds_read_b128 v[56:59], v21 offset:5632
    ds_read_b128 v[60:63], v21 offset:5648
    ds_read_b128 v[64:67], v21 offset:11264
    ds_read_b128 v[68:71], v21 offset:11280
    ds_read_b128 v[72:75], v21 offset:16896
    ds_read_b128 v[76:79], v21 offset:16912
    s_waitcnt lgkmcnt(4)
    v_pk_add_f32 v[48:49], v[48:49], v[56:57]
    v_pk_add_f32 v[50:51], v[50:51], v[58:59]
    v_pk_add_f32 v[52:53], v[52:53], v[60:61]
    v_pk_add_f32 v[54:55], v[54:55], v[62:63]
    s_waitcnt lgkmcnt(0)
    v_pk_add_f32 v[64:65], v[64:65], v[72:73]
    v_pk_add_f32 v[66:67], v[66:67], v[74:75]
    v_pk_add_f32 v[68:69], v[68:69], v[76:77]
    v_pk_add_f32 v[70:71], v[70:71], v[78:79]
    v_pk_add_f32 v[48:49], v[48:49], v[64:65]
    v_pk_add_f32 v[50:51], v[50:51], v[66:67]
    v_pk_add_f32 v[52:53], v[52:53], v[68:69]
    v_pk_add_f32 v[54:55], v[54:55], v[70:71]
    v_mov_b32 v81, 0xff800000
    v_cndmask_b32 v48, v81, v48, s[64:65]
    v_cndmask_b32 v49, v81, v49, s[66:67]
    v_cndmask_b32 v50, v81, v50, s[68:69]
    v_cndmask_b32 v51, v81, v51, s[70:71]
    v_cndmask_b32 v52, v81, v52, s[72:73]
    v_cndmask_b32 v53, v81, v53, s[74:75]
    v_cndmask_b32 v54, v81, v54, s[76:77]
    v_cndmask_b32 v55, v81, v55, s[78:79]
    v_max3_f32 v80, v48, v49, v50
    v_max3_f32 v80, v80, v51, v52
    v_max3_f32 v80, v80, v53, v54
    v_max_f32 v80, v80, v55
    v_mov_b32 v81, 0xff800000
    v_cndmask_b32 v80, v81, v80, s[50:51]
    s_nop 1
    v_max_f32 v80, v80, v80 quad_perm:[1,0,3,2] row_mask:0xf bank_mask:0xf
    s_nop 1
    v_max_f32 v80, v80, v80 quad_perm:[2,3,0,1] row_mask:0xf bank_mask:0xf
    s_nop 1
    v_max_f32 v80, v80, v80 row_half_mirror row_mask:0xf bank_mask:0xf
    s_mov_b32 s24, 0x3dd53b95
    v_mul_f32 v80, s24, v80
    v_fma_f32 v48, v48, s24, -v80
    v_fma_f32 v49, v49, s24, -v80
    v_fma_f32 v50, v50, s24, -v80
    v_fma_f32 v51, v51, s24, -v80
    v_fma_f32 v52, v52, s24, -v80
    v_fma_f32 v53, v53, s24, -v80
    v_fma_f32 v54, v54, s24, -v80
    v_fma_f32 v55, v55, s24, -v80
    v_exp_f32 v48, v48
    v_exp_f32 v49, v49
    v_exp_f32 v50, v50
    v_exp_f32 v51, v51
    v_exp_f32 v52, v52
    v_exp_f32 v53, v53
    v_exp_f32 v54, v54
    v_exp_f32 v55, v55
    v_add_f32 v80, v48, v49
    v_add_f32 v81, v50, v51
    v_add_f32 v80, v80, v52
    v_add_f32 v81, v81, v53
    v_add_f32 v80, v80, v54
    v_add_f32 v81, v81, v55
    v_add_f32 v80, v80, v81
    v_cndmask_b32 v80, 0, v80, s[50:51]
    s_nop 1
    v_add_f32 v80, v80, v80 quad_perm:[1,0,3,2] row_mask:0xf bank_mask:0xf
    s_nop 1
    v_add_f32 v80, v80, v80 quad_perm:[2,3,0,1] row_mask:0xf bank_mask:0xf
    s_nop 1
    v_add_f32 v80, v80, v80 row_half_mirror row_mask:0xf bank_mask:0xf
    v_rcp_f32 v80, v80
    s_nop 0
    v_mul_f32 v48, v48, v80
    v_mul_f32 v49, v49, v80
    v_mul_f32 v50, v50, v80
    v_mul_f32 v51, v51, v80
    v_mul_f32 v52, v52, v80
    v_mul_f32 v53, v53, v80
    v_mul_f32 v54, v54, v80
    v_mul_f32 v55, v55, v80
    v_cvt_pk_bf16_f32 v56, v48, v49
    v_cvt_pk_bf16_f32 v57, v50, v51
    v_cvt_pk_bf16_f32 v58, v52, v53
    v_cvt_pk_bf16_f32 v59, v54, v55
    v_min_u32 v56, -2, v56
    v_min_u32 v57, -2, v57
    v_min_u32 v58, -2, v58
    v_min_u32 v59, -2, v59
    buffer_store_dwordx4 v[56:59], v22, s[8:11], s42 offen sc1
    s_add_u32 s42, s42, 81920
    s_waitcnt vmcnt(4)
    v_max3_u32 v58, v84, v85, v86
    v_max3_u32 v58, v58, v87, v88
    v_max3_u32 v58, v58, v89, v90
    v_max3_u32 v58, v58, v91, v92
    v_max_u32 v58, v58, v93
    v_cmp_eq_u32 vcc, -1, v58
    s_cbranch_vccz chain1_kernel_s_pm_out
    s_mov_b32 s61, 0
chain1_kernel_s_pm:
    buffer_load_dwordx4 v[84:87], v7, s[8:11], s47 offen sc1
    buffer_load_dwordx4 v[88:91], v7, s[8:11], s46 offen sc1
    buffer_load_dwordx2 v[92:93], v8, s[8:11], s47 offen sc1
    s_waitcnt vmcnt(0)
    v_max3_u32 v58, v84, v85, v86
    v_max3_u32 v58, v58, v87, v88
    v_max3_u32 v58, v58, v89, v90
    v_max3_u32 v58, v58, v91, v92
    v_max_u32 v58, v58, v93
    v_cmp_eq_u32 vcc, -1, v58
    s_add_u32 s61, s61, 1
    s_cbranch_vccz chain1_kernel_s_pm_out
    s_cmp_ge_u32 s61, s60
    s_cbranch_scc1 chain1_kernel_s_pm_to
    s_sleep 1
    s_branch chain1_kernel_s_pm
chain1_kernel_s_pm_to:
    s_mov_b32 s60, 1
chain1_kernel_s_pm_out:
    ds_write_b128 v7, v[84:87]
    ds_write_b128 v7, v[88:91] offset:4096
    ds_write_b64 v8, v[92:93]
    s_waitcnt lgkmcnt(0)
chain1_kernel_s_go2:
    s_barrier
    ds_read_b128 v[48:51], v5 offset:0
    ds_read_b128 v[68:71], v6 offset:0
    ds_read_b128 v[72:75], v6 offset:1024
    ds_read_b128 v[52:55], v5 offset:1024
    ds_read_b128 v[76:79], v6 offset:2048
    ds_read_b128 v[80:83], v6 offset:3072
    ds_read_b128 v[56:59], v5 offset:2048
    ds_read_b128 v[60:63], v5 offset:3072
    ds_read_b128 v[64:67], v5 offset:4096
    s_waitcnt lgkmcnt(8)
    v_smfmac_f32_16x16x64_bf16 v[24:27], v[48:51], a[0:7], v4
    v_smfmac_f32_16x16x64_bf16 v[28:31], v[48:51], a[80:87], v4
    v_smfmac_f32_16x16x64_bf16 v[32:35], v[48:51], a[160:167], v4
    v_smfmac_f32_16x16x64_bf16 v[36:39], v[48:51], v[96:103], v4
    v_smfmac_f32_16x16x64_bf16 v[40:43], v[48:51], v[176:183], v4
    s_waitcnt lgkmcnt(6)
    v_smfmac_f32_16x16x64_bf16 v[44:47], v[48:51], v[68:75], v4
    ds_read_b128 v[68:71], v6 offset:4096
    ds_read_b128 v[72:75], v6 offset:5120
    ds_read_b128 v[48:51], v5 offset:5120
    s_waitcnt lgkmcnt(8)
    v_smfmac_f32_16x16x64_bf16 v[24:27], v[52:55], a[8:15], v4
    v_smfmac_f32_16x16x64_bf16 v[28:31], v[52:55], a[88:95], v4
    v_smfmac_f32_16x16x64_bf16 v[32:35], v[52:55], a[168:175], v4
    v_smfmac_f32_16x16x64_bf16 v[36:39], v[52:55], v[104:111], v4
    v_smfmac_f32_16x16x64_bf16 v[40:43], v[52:55], v[184:191], v4
    s_waitcnt lgkmcnt(6)
    v_smfmac_f32_16x16x64_bf16 v[44:47], v[52:55], v[76:83], v4
    ds_read_b128 v[76:79], v6 offset:6144
    ds_read_b128 v[80:83], v6 offset:7168
    ds_read_b128 v[52:55], v5 offset:6144
    s_waitcnt lgkmcnt(8)
    v_smfmac_f32_16x16x64_bf16 v[24:27], v[56:59], a[16:23], v4
    v_smfmac_f32_16x16x64_bf16 v[28:31], v[56:59], a[96:103], v4
    v_smfmac_f32_16x16x64_bf16 v[32:35], v[56:59], a[176:183], v4
    v_smfmac_f32_16x16x64_bf16 v[36:39], v[56:59], v[112:119], v4
    v_smfmac_f32_16x16x64_bf16 v[40:43], v[56:59], v[192:199], v4
    s_waitcnt lgkmcnt(4)
    v_smfmac_f32_16x16x64_bf16 v[44:47], v[56:59], v[68:75], v4
    ds_read_b128 v[68:71], v6 offset:8192
    ds_read_b128 v[72:75], v6 offset:9216
    ds_read_b128 v[56:59], v5 offset:7168
    v_smfmac_f32_16x16x64_bf16 v[24:27], v[60:63], a[24:31], v4
    v_smfmac_f32_16x16x64_bf16 v[28:31], v[60:63], a[104:111], v4
    v_smfmac_f32_16x16x64_bf16 v[32:35], v[60:63], a[184:191], v4
    v_smfmac_f32_16x16x64_bf16 v[36:39], v[60:63], v[120:127], v4
    v_smfmac_f32_16x16x64_bf16 v[40:43], v[60:63], v[200:207], v4
    s_waitcnt lgkmcnt(4)
    v_smfmac_f32_16x16x64_bf16 v[44:47], v[60:63], v[76:83], v4
    ds_read_b128 v[76:79], v6 offset:10240
    ds_read_b128 v[80:83], v6 offset:11264
    ds_read_b128 v[60:63], v5 offset:8192
    v_smfmac_f32_16x16x64_bf16 v[24:27], v[64:67], a[32:39], v4
    v_smfmac_f32_16x16x64_bf16 v[28:31], v[64:67], a[112:119], v4
    v_smfmac_f32_16x16x64_bf16 v[32:35], v[64:67], a[192:199], v4
    v_smfmac_f32_16x16x64_bf16 v[36:39], v[64:67], v[128:135], v4
    v_smfmac_f32_16x16x64_bf16 v[40:43], v[64:67], v[208:215], v4
    s_waitcnt lgkmcnt(4)
    v_smfmac_f32_16x16x64_bf16 v[44:47], v[64:67], v[68:75], v4
    ds_read_b128 v[68:71], v6 offset:12288
    ds_read_b128 v[72:75], v6 offset:13312
    ds_read_b128 v[64:67], v5 offset:9216
    v_smfmac_f32_16x16x64_bf16 v[24:27], v[48:51], a[40:47], v4
    v_smfmac_f32_16x16x64_bf16 v[28:31], v[48:51], a[120:127], v4
    v_smfmac_f32_16x16x64_bf16 v[32:35], v[48:51], a[200:207], v4
    v_smfmac_f32_16x16x64_bf16 v[36:39], v[48:51], v[136:143], v4
    v_smfmac_f32_16x16x64_bf16 v[40:43], v[48:51], v[216:223], v4
    s_waitcnt lgkmcnt(4)
    v_smfmac_f32_16x16x64_bf16 v[44:47], v[48:51], v[76:83], v4
    ds_read_b128 v[76:79], v6 offset:14336
    ds_read_b128 v[80:83], v6 offset:15360
    v_smfmac_f32_16x16x64_bf16 v[24:27], v[52:55], a[48:55], v4
    v_smfmac_f32_16x16x64_bf16 v[28:31], v[52:55], a[128:135], v4
    v_smfmac_f32_16x16x64_bf16 v[32:35], v[52:55], a[208:215], v4
    v_smfmac_f32_16x16x64_bf16 v[36:39], v[52:55], v[144:151], v4
    v_smfmac_f32_16x16x64_bf16 v[40:43], v[52:55], v[224:231], v4
    s_waitcnt lgkmcnt(3)
    v_smfmac_f32_16x16x64_bf16 v[44:47], v[52:55], v[68:75], v4
    ds_read_b128 v[68:71], v6 offset:16384
    ds_read_b128 v[72:75], v6 offset:17408
    v_smfmac_f32_16x16x64_bf16 v[24:27], v[56:59], a[56:63], v4
    v_smfmac_f32_16x16x64_bf16 v[28:31], v[56:59], a[136:143], v4
    v_smfmac_f32_16x16x64_bf16 v[32:35], v[56:59], a[216:223], v4
    v_smfmac_f32_16x16x64_bf16 v[36:39], v[56:59], v[152:159], v4
    v_smfmac_f32_16x16x64_bf16 v[40:43], v[56:59], v[232:239], v4
    s_waitcnt lgkmcnt(2)
    v_smfmac_f32_16x16x64_bf16 v[44:47], v[56:59], v[76:83], v4
    ds_read_b128 v[76:79], v6 offset:18432
    ds_read_b128 v[80:83], v6 offset:19456
    v_smfmac_f32_16x16x64_bf16 v[24:27], v[60:63], a[64:71], v4
    v_smfmac_f32_16x16x64_bf16 v[28:31], v[60:63], a[144:151], v4
    v_smfmac_f32_16x16x64_bf16 v[32:35], v[60:63], a[224:231], v4
    v_smfmac_f32_16x16x64_bf16 v[36:39], v[60:63], v[160:167], v4
    v_smfmac_f32_16x16x64_bf16 v[40:43], v[60:63], v[240:247], v4
    s_waitcnt lgkmcnt(2)
    v_smfmac_f32_16x16x64_bf16 v[44:47], v[60:63], v[68:75], v4
    v_smfmac_f32_16x16x64_bf16 v[24:27], v[64:67], a[72:79], v4
    v_smfmac_f32_16x16x64_bf16 v[28:31], v[64:67], a[152:159], v4
    v_smfmac_f32_16x16x64_bf16 v[32:35], v[64:67], a[232:239], v4
    v_smfmac_f32_16x16x64_bf16 v[36:39], v[64:67], v[168:175], v4
    v_smfmac_f32_16x16x64_bf16 v[40:43], v[64:67], v[248:255], v4
    s_waitcnt lgkmcnt(0)
    v_smfmac_f32_16x16x64_bf16 v[44:47], v[64:67], v[76:83], v4
    buffer_load_dwordx4 v[80:83], v19, s[8:11], s45 offen offset:0 sc1
    buffer_load_dwordx4 v[84:87], v19, s[8:11], s45 offen offset:1024 sc1
    buffer_load_dwordx4 v[88:91], v19, s[8:11], s45 offen offset:2048 sc1
    s_waitcnt vmcnt(3)
    s_nop 4
    v_permlane32_swap_b32 v24, v36
    v_permlane32_swap_b32 v25, v37
    v_permlane32_swap_b32 v26, v38
    v_permlane32_swap_b32 v27, v39
    v_add_f32 v24, v24, v36
    v_add_f32 v25, v25, v37
    v_add_f32 v26, v26, v38
    v_add_f32 v27, v27, v39
    v_cvt_pk_bf16_f32 v48, v24, v25
    v_cvt_pk_bf16_f32 v49, v26, v27
    ds_write_b64 v9, v[48:49] offset:0
    v_permlane32_swap_b32 v28, v40
    v_permlane32_swap_b32 v29, v41
    v_permlane32_swap_b32 v30, v42
    v_permlane32_swap_b32 v31, v43
    v_add_f32 v28, v28, v40
    v_add_f32 v29, v29, v41
    v_add_f32 v30, v30, v42
    v_add_f32 v31, v31, v43
    v_cvt_pk_bf16_f32 v50, v28, v29
    v_cvt_pk_bf16_f32 v51, v30, v31
    ds_write_b64 v9, v[50:51] offset:512
    v_permlane32_swap_b32 v32, v44
    v_permlane32_swap_b32 v33, v45
    v_permlane32_swap_b32 v34, v46
    v_permlane32_swap_b32 v35, v47
    v_add_f32 v32, v32, v44
    v_add_f32 v33, v33, v45
    v_add_f32 v34, v34, v46
    v_add_f32 v35, v35, v47
    v_cvt_pk_bf16_f32 v52, v32, v33
    v_cvt_pk_bf16_f32 v53, v34, v35
    ds_write_b64 v9, v[52:53] offset:1024
    s_waitcnt lgkmcnt(0)
    ds_read_b64_tr_b16 v[24:25], v11
    ds_read_b64_tr_b16 v[26:27], v11 offset:512
    ds_read_b64_tr_b16 v[28:29], v11 offset:1024
    s_waitcnt lgkmcnt(0)
    v_mfma_f32_16x16x32_bf16 v[64:67], a[240:243], v[24:27], 0
    v_mfma_f32_16x16x32_bf16 v[68:71], a[244:247], v[24:27], 0
    v_mfma_f32_16x16x32_bf16 v[72:75], v[24:27], v[24:27], 0
    s_nop 3
    v_mfma_f32_16x16x16_bf16 v[64:67], a[248:249], v[28:29], v[64:67]
    v_mfma_f32_16x16x16_bf16 v[68:71], a[250:251], v[28:29], v[68:71]
    v_mfma_f32_16x16x16_bf16 v[72:75], v[28:29], v[28:29], v[72:75]
    s_nop 5
    ds_write_b128 v12, v[64:67]
    ds_write_b128 v12, v[68:71] offset:16
    ds_write_b128 v13, v[72:75]
    s_waitcnt lgkmcnt(0)
    s_barrier
    buffer_atomic_add v0, v20, s[8:11], s49 offen
    ds_read_b128 v[48:51], v14 offset:0
    ds_read_b128 v[52:55], v14 offset:16
    ds_read_b128 v[56:59], v14 offset:1408
    ds_read_b128 v[60:63], v14 offset:1424
    ds_read_b128 v[64:67], v14 offset:2816
    ds_read_b128 v[68:71], v14 offset:2832
    ds_read_b128 v[72:75], v14 offset:4224
    ds_read_b128 v[76:79], v14 offset:4240
    s_waitcnt lgkmcnt(4)
    v_pk_add_f32 v[48:49], v[48:49], v[56:57]
    v_pk_add_f32 v[50:51], v[50:51], v[58:59]
    v_pk_add_f32 v[52:53], v[52:53], v[60:61]
    v_pk_add_f32 v[54:55], v[54:55], v[62:63]
    s_waitcnt lgkmcnt(0)
    v_pk_add_f32 v[64:65], v[64:65], v[72:73]
    v_pk_add_f32 v[66:67], v[66:67], v[74:75]
    v_pk_add_f32 v[68:69], v[68:69], v[76:77]
    v_pk_add_f32 v[70:71], v[70:71], v[78:79]
    v_pk_add_f32 v[48:49], v[48:49], v[64:65]
    v_pk_add_f32 v[50:51], v[50:51], v[66:67]
    v_pk_add_f32 v[52:53], v[52:53], v[68:69]
    v_pk_add_f32 v[54:55], v[54:55], v[70:71]
    v_max3_f32 v92, v48, v49, v50
    v_max3_f32 v92, v92, v51, v52
    v_max3_f32 v92, v92, v53, v54
    v_max_f32 v92, v92, v55
    v_mov_b32 v93, 0xff800000
    v_cndmask_b32 v92, v93, v92, s[50:51]
    s_nop 1
    v_max_f32 v92, v92, v92 quad_perm:[1,0,3,2] row_mask:0xf bank_mask:0xf
    s_nop 1
    v_max_f32 v92, v92, v92 quad_perm:[2,3,0,1] row_mask:0xf bank_mask:0xf
    s_nop 1
    v_max_f32 v92, v92, v92 row_half_mirror row_mask:0xf bank_mask:0xf
    s_mov_b32 s24, 0x3dd53b95
    v_mul_f32 v92, s24, v92
    v_fma_f32 v48, v48, s24, -v92
    v_fma_f32 v49, v49, s24, -v92
    v_fma_f32 v50, v50, s24, -v92
    v_fma_f32 v51, v51, s24, -v92
    v_fma_f32 v52, v52, s24, -v92
    v_fma_f32 v53, v53, s24, -v92
    v_fma_f32 v54, v54, s24, -v92
    v_fma_f32 v55, v55, s24, -v92
    v_exp_f32 v48, v48
    v_exp_f32 v49, v49
    v_exp_f32 v50, v50
    v_exp_f32 v51, v51
    v_exp_f32 v52, v52
    v_exp_f32 v53, v53
    v_exp_f32 v54, v54
    v_exp_f32 v55, v55
    v_add_f32 v92, v48, v49
    v_add_f32 v93, v50, v51
    v_add_f32 v92, v92, v52
    v_add_f32 v93, v93, v53
    v_add_f32 v92, v92, v54
    v_add_f32 v93, v93, v55
    v_add_f32 v92, v92, v93
    v_cndmask_b32 v92, 0, v92, s[50:51]
    s_nop 1
    v_add_f32 v92, v92, v92 quad_perm:[1,0,3,2] row_mask:0xf bank_mask:0xf
    s_nop 1
    v_add_f32 v92, v92, v92 quad_perm:[2,3,0,1] row_mask:0xf bank_mask:0xf
    s_nop 1
    v_add_f32 v92, v92, v92 row_half_mirror row_mask:0xf bank_mask:0xf
    v_rcp_f32 v92, v92
    s_nop 0
    v_mul_f32 v48, v48, v92
    v_mul_f32 v49, v49, v92
    v_mul_f32 v50, v50, v92
    v_mul_f32 v51, v51, v92
    v_mul_f32 v52, v52, v92
    v_mul_f32 v53, v53, v92
    v_mul_f32 v54, v54, v92
    v_mul_f32 v55, v55, v92
    v_cvt_pk_bf16_f32 v56, v48, v49
    v_cvt_pk_bf16_f32 v57, v50, v51
    v_cvt_pk_bf16_f32 v58, v52, v53
    v_cvt_pk_bf16_f32 v59, v54, v55
    v_min_u32 v56, -2, v56
    v_min_u32 v57, -2, v57
    v_min_u32 v58, -2, v58
    v_min_u32 v59, -2, v59
    buffer_store_dwordx4 v[56:59], v15, s[8:11], s43 offen sc1
    s_waitcnt vmcnt(2)
    v_mfma_f32_16x16x32_bf16 v[32:35], a[240:243], v[80:83], 0
    v_mfma_f32_16x16x32_bf16 v[40:43], a[244:247], v[80:83], 0
    v_mfma_f32_16x16x32_bf16 v[64:67], v[24:27], v[80:83], 0
    v_mfma_f32_16x16x32_bf16 v[36:39], a[240:243], v[84:87], 0
    v_mfma_f32_16x16x32_bf16 v[44:47], a[244:247], v[84:87], 0
    v_mfma_f32_16x16x32_bf16 v[68:71], v[24:27], v[84:87], 0
    s_nop 0
    v_mfma_f32_16x16x16_bf16 v[32:35], a[248:249], v[88:89], v[32:35]
    v_mfma_f32_16x16x16_bf16 v[40:43], a[250:251], v[88:89], v[40:43]
    v_mfma_f32_16x16x16_bf16 v[64:67], v[28:29], v[88:89], v[64:67]
    v_mfma_f32_16x16x16_bf16 v[36:39], a[248:249], v[90:91], v[36:39]
    v_mfma_f32_16x16x16_bf16 v[44:47], a[250:251], v[90:91], v[44:47]
    v_mfma_f32_16x16x16_bf16 v[68:71], v[28:29], v[90:91], v[68:71]
    s_nop 2
    ds_write_b128 v16, v[32:35] offset:0
    ds_write_b128 v16, v[40:43] offset:16
    ds_write_b128 v17, v[64:67]
    ds_write_b128 v16, v[36:39] offset:2816
    ds_write_b128 v16, v[44:47] offset:2832
    ds_write_b128 v18, v[68:71]
    s_add_u32 s40, s40, 1
    s_add_u32 s41, s41, 393216
    s_add_u32 s45, s45, 393216
    s_add_u32 s43, s43, 81920
    s_add_u32 s47, s47, 40960
    s_add_u32 s48, s48, 8192
    s_add_u32 s49, s49, 4096
    s_waitcnt lgkmcnt(0)
    s_barrier
    s_cmp_lt_u32 s40, 64
    s_cbranch_scc1 chain1_kernel_s_step
    ds_read_b128 v[48:51], v21 offset:0
    ds_read_b128 v[52:55], v21 offset:16
    ds_read_b128 v[56:59], v21 offset:5632
    ds_read_b128 v[60:63], v21 offset:5648
    ds_read_b128 v[64:67], v21 offset:11264
    ds_read_b128 v[68:71], v21 offset:11280
    ds_read_b128 v[72:75], v21 offset:16896
    ds_read_b128 v[76:79], v21 offset:16912
    s_waitcnt lgkmcnt(4)
    v_pk_add_f32 v[48:49], v[48:49], v[56:57]
    v_pk_add_f32 v[50:51], v[50:51], v[58:59]
    v_pk_add_f32 v[52:53], v[52:53], v[60:61]
    v_pk_add_f32 v[54:55], v[54:55], v[62:63]
    s_waitcnt lgkmcnt(0)
    v_pk_add_f32 v[64:65], v[64:65], v[72:73]
    v_pk_add_f32 v[66:67], v[66:67], v[74:75]
    v_pk_add_f32 v[68:69], v[68:69], v[76:77]
    v_pk_add_f32 v[70:71], v[70:71], v[78:79]
    v_pk_add_f32 v[48:49], v[48:49], v[64:65]
    v_pk_add_f32 v[50:51], v[50:51], v[66:67]
    v_pk_add_f32 v[52:53], v[52:53], v[68:69]
    v_pk_add_f32 v[54:55], v[54:55], v[70:71]
    v_mov_b32 v81, 0xff800000
    v_cndmask_b32 v48, v81, v48, s[64:65]
    v_cndmask_b32 v49, v81, v49, s[66:67]
    v_cndmask_b32 v50, v81, v50, s[68:69]
    v_cndmask_b32 v51, v81, v51, s[70:71]
    v_cndmask_b32 v52, v81, v52, s[72:73]
    v_cndmask_b32 v53, v81, v53, s[74:75]
    v_cndmask_b32 v54, v81, v54, s[76:77]
    v_cndmask_b32 v55, v81, v55, s[78:79]
    v_max3_f32 v80, v48, v49, v50
    v_max3_f32 v80, v80, v51, v52
    v_max3_f32 v80, v80, v53, v54
    v_max_f32 v80, v80, v55
    v_mov_b32 v81, 0xff800000
    v_cndmask_b32 v80, v81, v80, s[50:51]
    s_nop 1
    v_max_f32 v80, v80, v80 quad_perm:[1,0,3,2] row_mask:0xf bank_mask:0xf
    s_nop 1
    v_max_f32 v80, v80, v80 quad_perm:[2,3,0,1] row_mask:0xf bank_mask:0xf
    s_nop 1
    v_max_f32 v80, v80, v80 row_half_mirror row_mask:0xf bank_mask:0xf
    s_mov_b32 s24, 0x3dd53b95
    v_mul_f32 v80, s24, v80
    v_fma_f32 v48, v48, s24, -v80
    v_fma_f32 v49, v49, s24, -v80
    v_fma_f32 v50, v50, s24, -v80
    v_fma_f32 v51, v51, s24, -v80
    v_fma_f32 v52, v52, s24, -v80
    v_fma_f32 v53, v53, s24, -v80
    v_fma_f32 v54, v54, s24, -v80
    v_fma_f32 v55, v55, s24, -v80
    v_exp_f32 v48, v48
    v_exp_f32 v49, v49
    v_exp_f32 v50, v50
    v_exp_f32 v51, v51
    v_exp_f32 v52, v52
    v_exp_f32 v53, v53
    v_exp_f32 v54, v54
    v_exp_f32 v55, v55
    v_add_f32 v80, v48, v49
    v_add_f32 v81, v50, v51
    v_add_f32 v80, v80, v52
    v_add_f32 v81, v81, v53
    v_add_f32 v80, v80, v54
    v_add_f32 v81, v81, v55
    v_add_f32 v80, v80, v81
    v_cndmask_b32 v80, 0, v80, s[50:51]
    s_nop 1
    v_add_f32 v80, v80, v80 quad_perm:[1,0,3,2] row_mask:0xf bank_mask:0xf
    s_nop 1
    v_add_f32 v80, v80, v80 quad_perm:[2,3,0,1] row_mask:0xf bank_mask:0xf
    s_nop 1
    v_add_f32 v80, v80, v80 row_half_mirror row_mask:0xf bank_mask:0xf
    v_rcp_f32 v80, v80
    s_nop 0
    v_mul_f32 v48, v48, v80
    v_mul_f32 v49, v49, v80
    v_mul_f32 v50, v50, v80
    v_mul_f32 v51, v51, v80
    v_mul_f32 v52, v52, v80
    v_mul_f32 v53, v53, v80
    v_mul_f32 v54, v54, v80
    v_mul_f32 v55, v55, v80
    v_cvt_pk_bf16_f32 v56, v48, v49
    v_cvt_pk_bf16_f32 v57, v50, v51
    v_cvt_pk_bf16_f32 v58, v52, v53
    v_cvt_pk_bf16_f32 v59, v54, v55
    v_min_u32 v56, -2, v56
    v_min_u32 v57, -2, v57
    v_min_u32 v58, -2, v58
    v_min_u32 v59, -2, v59
    buffer_store_dwordx4 v[56:59], v22, s[8:11], s42 offen sc1
    s_add_u32 s42, s42, 81920
    s_branch chain1_kernel_end
chain1_kernel_s_go:
    v_mov_b32 v24, 0
    v_mov_b32 v25, 0
    v_mov_b32 v26, 0
    v_mov_b32 v27, 0
    v_mov_b32 v28, 0
    v_mov_b32 v29, 0
    v_mov_b32 v30, 0
    v_mov_b32 v31, 0
    v_mov_b32 v32, 0
    v_mov_b32 v33, 0
    v_mov_b32 v34, 0
    v_mov_b32 v35, 0
    v_mov_b32 v36, 0
    v_mov_b32 v37, 0
    v_mov_b32 v38, 0
    v_mov_b32 v39, 0
    v_mov_b32 v40, 0
    v_mov_b32 v41, 0
    v_mov_b32 v42, 0
    v_mov_b32 v43, 0
    v_mov_b32 v44, 0
    v_mov_b32 v45, 0
    v_mov_b32 v46, 0
    v_mov_b32 v47, 0
    s_waitcnt vmcnt(0)
    s_branch chain1_kernel_s_go2
chain1_kernel_roleV:
    s_sub_u32 s44, s2, 32
    s_load_dwordx2 s[6:7], s[0:1], 56
    s_load_dwordx2 s[24:25], s[0:1], 64
    s_waitcnt lgkmcnt(0)
    s_mov_b32 s12, s6
    s_mov_b32 s13, s7
    s_mov_b32 s14, 7864320
    s_mov_b32 s15, 0x00020000
    s_mov_b32 s16, s24
    s_mov_b32 s17, s25
    s_mov_b32 s18, 7864320
    s_mov_b32 s19, 0x00020000
    v_add_u32 v16, 0, v0
    s_mov_b32 s24, 683
    v_mul_lo_u32 v17, v16, s24
    v_lshrrev_b32 v17, 14, v17
    v_mul_u32_u24 v18, 24, v17
    v_sub_u32 v18, v16, v18
    s_mov_b32 s24, 12288
    v_mul_lo_u32 v4, v17, s24
    v_lshl_add_u32 v4, v18, 4, v4
    v_mul_u32_u24 v10, 400, v17
    v_lshl_add_u32 v10, v18, 4, v10
    v_add_u32 v10, 90112, v10
    v_add_u32 v16, 256, v0
    s_mov_b32 s24, 683
    v_mul_lo_u32 v17, v16, s24
    v_lshrrev_b32 v17, 14, v17
    v_mul_u32_u24 v18, 24, v17
    v_sub_u32 v18, v16, v18
    s_mov_b32 s24, 12288
    v_mul_lo_u32 v5, v17, s24
    v_lshl_add_u32 v5, v18, 4, v5
    v_mul_u32_u24 v11, 400, v17
    v_lshl_add_u32 v11, v18, 4, v11
    v_add_u32 v11, 90112, v11
    v_add_u32 v16, 512, v0
    s_mov_b32 s24, 683
    v_mul_lo_u32 v17, v16, s24
    v_lshrrev_b32 v17, 14, v17
    v_mul_u32_u24 v18, 24, v17
    v_sub_u32 v18, v16, v18
    s_mov_b32 s24, 12288
    v_mul_lo_u32 v6, v17, s24
    v_lshl_add_u32 v6, v18, 4, v6
    v_mul_u32_u24 v12, 400, v17
    v_lshl_add_u32 v12, v18, 4, v12
    v_add_u32 v12, 90112, v12
    v_add_u32 v16, 768, v0
    s_mov_b32 s24, 683
    v_mul_lo_u32 v17, v16, s24
    v_lshrrev_b32 v17, 14, v17
    v_mul_u32_u24 v18, 24, v17
    v_sub_u32 v18, v16, v18
    s_mov_b32 s24, 12288
    v_mul_lo_u32 v7, v17, s24
    v_lshl_add_u32 v7, v18, 4, v7
    v_mul_u32_u24 v13, 400, v17
    v_lshl_add_u32 v13, v18, 4, v13
    v_add_u32 v13, 90112, v13
    v_add_u32 v16, 1024, v0
    s_mov_b32 s24, 683
    v_mul_lo_u32 v17, v16, s24
    v_lshrrev_b32 v17, 14, v17
    v_mul_u32_u24 v18, 24, v17
    v_sub_u32 v18, v16, v18
    s_mov_b32 s24, 12288
    v_mul_lo_u32 v8, v17, s24
    v_lshl_add_u32 v8, v18, 4, v8
    v_mul_u32_u24 v14, 400, v17
    v_lshl_add_u32 v14, v18, 4, v14
    v_add_u32 v14, 90112, v14
    v_add_u32 v16, 1280, v0
    s_mov_b32 s24, 683
    v_mul_lo_u32 v17, v16, s24
    v_lshrrev_b32 v17, 14, v17
    v_mul_u32_u24 v18, 24, v17
    v_sub_u32 v18, v16, v18
    s_mov_b32 s24, 12288
    v_mul_lo_u32 v9, v17, s24
    v_lshl_add_u32 v9, v18, 4, v9
    v_mul_u32_u24 v15, 400, v17
    v_lshl_add_u32 v15, v18, 4, v15
    v_add_u32 v15, 90112, v15
    v_lshrrev_b32 v17, 1, v3
    v_lshlrev_b32 v17, 4, v17
    v_and_b32 v18, 1, v3
    v_lshl_add_u32 v17, v18, 2, v17
    v_lshrrev_b32 v18, 2, v2
    v_and_b32 v19, 1, v18
    v_add_u32 v17, v17, v19
    v_lshrrev_b32 v18, 1, v18
    v_lshl_add_u32 v17, v18, 3, v17
    v_mul_u32_u24 v16, 400, v17
    v_and_b32 v18, 3, v2
    v_lshl_add_u32 v16, v18, 3, v16
    v_add_u32 v16, 90112, v16
    s_mul_i32 s24, s3, 96
    v_add_u32 v16, s24, v16
    s_mul_i32 s45, s44, 384
    s_add_u32 s46, s45, 0
    buffer_load_dwordx4 v[24:27], v4, s[12:15], s46 offen
    buffer_load_dwordx4 v[28:31], v5, s[12:15], s46 offen
    buffer_load_dwordx4 v[32:35], v6, s[12:15], s46 offen
    buffer_load_dwordx4 v[36:39], v7, s[12:15], s46 offen
    buffer_load_dwordx4 v[40:43], v8, s[12:15], s46 offen
    buffer_load_dwordx4 v[44:47], v9, s[12:15], s46 offen
    s_add_u32 s46, s45, 786432
    buffer_load_dwordx4 v[48:51], v4, s[12:15], s46 offen
    buffer_load_dwordx4 v[52:55], v5, s[12:15], s46 offen
    buffer_load_dwordx4 v[56:59], v6, s[12:15], s46 offen
    buffer_load_dwordx4 v[60:63], v7, s[12:15], s46 offen
    buffer_load_dwordx4 v[64:67], v8, s[12:15], s46 offen
    buffer_load_dwordx4 v[68:71], v9, s[12:15], s46 offen
    s_waitcnt vmcnt(6)
    ds_write_b128 v10, v[24:27]
    ds_write_b128 v11, v[28:31]
    ds_write_b128 v12, v[32:35]
    ds_write_b128 v13, v[36:39]
    ds_write_b128 v14, v[40:43]
    ds_write_b128 v15, v[44:47]
    s_add_u32 s46, s45, 1572864
    buffer_load_dwordx4 v[72:75], v4, s[12:15], s46 offen
    buffer_load_dwordx4 v[76:79], v5, s[12:15], s46 offen
    buffer_load_dwordx4 v[80:83], v6, s[12:15], s46 offen
    buffer_load_dwordx4 v[84:87], v7, s[12:15], s46 offen
    buffer_load_dwordx4 v[88:91], v8, s[12:15], s46 offen
    buffer_load_dwordx4 v[92:95], v9, s[12:15], s46 offen
    s_waitcnt lgkmcnt(0)
    s_barrier
    ds_read_b64_tr_b16 a[0:1], v16 offset:0
    ds_read_b64_tr_b16 a[2:3], v16 offset:800
    ds_read_b64_tr_b16 a[4:5], v16 offset:12800
    ds_read_b64_tr_b16 a[6:7], v16 offset:13600
    ds_read_b64_tr_b16 a[80:81], v16 offset:32
    ds_read_b64_tr_b16 a[82:83], v16 offset:832
    ds_read_b64_tr_b16 a[84:85], v16 offset:12832
    ds_read_b64_tr_b16 a[86:87], v16 offset:13632
    ds_read_b64_tr_b16 a[160:161], v16 offset:64
    ds_read_b64_tr_b16 a[162:163], v16 offset:864
    ds_read_b64_tr_b16 a[164:165], v16 offset:12864
    ds_read_b64_tr_b16 a[166:167], v16 offset:13664
    s_waitcnt lgkmcnt(0)
    s_barrier
    s_waitcnt vmcnt(6)
    ds_write_b128 v10, v[48:51]
    ds_write_b128 v11, v[52:55]
    ds_write_b128 v12, v[56:59]
    ds_write_b128 v13, v[60:63]
    ds_write_b128 v14, v[64:67]
    ds_write_b128 v15, v[68:71]
    s_add_u32 s46, s45, 2359296
    buffer_load_dwordx4 v[24:27], v4, s[12:15], s46 offen
    buffer_load_dwordx4 v[28:31], v5, s[12:15], s46 offen
    buffer_load_dwordx4 v[32:35], v6, s[12:15], s46 offen
    buffer_load_dwordx4 v[36:39], v7, s[12:15], s46 offen
    buffer_load_dwordx4 v[40:43], v8, s[12:15], s46 offen
    buffer_load_dwordx4 v[44:47], v9, s[12:15], s46 offen
    s_waitcnt lgkmcnt(0)
    s_barrier
    ds_read_b64_tr_b16 a[8:9], v16 offset:0
    ds_read_b64_tr_b16 a[10:11], v16 offset:800
    ds_read_b64_tr_b16 a[12:13], v16 offset:12800
    ds_read_b64_tr_b16 a[14:15], v16 offset:13600
    ds_read_b64_tr_b16 a[88:89], v16 offset:32
    ds_read_b64_tr_b16 a[90:91], v16 offset:832
    ds_read_b64_tr_b16 a[92:93], v16 offset:12832
    ds_read_b64_tr_b16 a[94:95], v16 offset:13632
    ds_read_b64_tr_b16 a[168:169], v16 offset:64
    ds_read_b64_tr_b16 a[170:171], v16 offset:864
    ds_read_b64_tr_b16 a[172:173], v16 offset:12864
    ds_read_b64_tr_b16 a[174:175], v16 offset:13664
    s_waitcnt lgkmcnt(0)
    s_barrier
    s_waitcnt vmcnt(6)
    ds_write_b128 v10, v[72:75]
    ds_write_b128 v11, v[76:79]
    ds_write_b128 v12, v[80:83]
    ds_write_b128 v13, v[84:87]
    ds_write_b128 v14, v[88:91]
    ds_write_b128 v15, v[92:95]
    s_add_u32 s46, s45, 3145728
    buffer_load_dwordx4 v[48:51], v4, s[12:15], s46 offen
    buffer_load_dwordx4 v[52:55], v5, s[12:15], s46 offen
    buffer_load_dwordx4 v[56:59], v6, s[12:15], s46 offen
    buffer_load_dwordx4 v[60:63], v7, s[12:15], s46 offen
    buffer_load_dwordx4 v[64:67], v8, s[12:15], s46 offen
    buffer_load_dwordx4 v[68:71], v9, s[12:15], s46 offen
    s_waitcnt lgkmcnt(0)
    s_barrier
    ds_read_b64_tr_b16 a[16:17], v16 offset:0
    ds_read_b64_tr_b16 a[18:19], v16 offset:800
    ds_read_b64_tr_b16 a[20:21], v16 offset:12800
    ds_read_b64_tr_b16 a[22:23], v16 offset:13600
    ds_read_b64_tr_b16 a[96:97], v16 offset:32
    ds_read_b64_tr_b16 a[98:99], v16 offset:832
    ds_read_b64_tr_b16 a[100:101], v16 offset:12832
    ds_read_b64_tr_b16 a[102:103], v16 offset:13632
    ds_read_b64_tr_b16 a[176:177], v16 offset:64
    ds_read_b64_tr_b16 a[178:179], v16 offset:864
    ds_read_b64_tr_b16 a[180:181], v16 offset:12864
    ds_read_b64_tr_b16 a[182:183], v16 offset:13664
    s_waitcnt lgkmcnt(0)
    s_barrier
    s_waitcnt vmcnt(6)
    ds_write_b128 v10, v[24:27]
    ds_write_b128 v11, v[28:31]
    ds_write_b128 v12, v[32:35]
    ds_write_b128 v13, v[36:39]
    ds_write_b128 v14, v[40:43]
    ds_write_b128 v15, v[44:47]
    s_add_u32 s46, s45, 3932160
    buffer_load_dwordx4 v[72:75], v4, s[12:15], s46 offen
    buffer_load_dwordx4 v[76:79], v5, s[12:15], s46 offen
    buffer_load_dwordx4 v[80:83], v6, s[12:15], s46 offen
    buffer_load_dwordx4 v[84:87], v7, s[12:15], s46 offen
    buffer_load_dwordx4 v[88:91], v8, s[12:15], s46 offen
    buffer_load_dwordx4 v[92:95], v9, s[12:15], s46 offen
    s_waitcnt lgkmcnt(0)
    s_barrier
    ds_read_b64_tr_b16 a[24:25], v16 offset:0
    ds_read_b64_tr_b16 a[26:27], v16 offset:800
    ds_read_b64_tr_b16 a[28:29], v16 offset:12800
    ds_read_b64_tr_b16 a[30:31], v16 offset:13600
    ds_read_b64_tr_b16 a[104:105], v16 offset:32
    ds_read_b64_tr_b16 a[106:107], v16 offset:832
    ds_read_b64_tr_b16 a[108:109], v16 offset:12832
    ds_read_b64_tr_b16 a[110:111], v16 offset:13632
    ds_read_b64_tr_b16 a[184:185], v16 offset:64
    ds_read_b64_tr_b16 a[186:187], v16 offset:864
    ds_read_b64_tr_b16 a[188:189], v16 offset:12864
    ds_read_b64_tr_b16 a[190:191], v16 offset:13664
    s_waitcnt lgkmcnt(0)
    s_barrier
    s_waitcnt vmcnt(6)
    ds_write_b128 v10, v[48:51]
    ds_write_b128 v11, v[52:55]
    ds_write_b128 v12, v[56:59]
    ds_write_b128 v13, v[60:63]
    ds_write_b128 v14, v[64:67]
    ds_write_b128 v15, v[68:71]
    s_add_u32 s46, s45, 4718592
    buffer_load_dwordx4 v[24:27], v4, s[12:15], s46 offen
    buffer_load_dwordx4 v[28:31], v5, s[12:15], s46 offen
    buffer_load_dwordx4 v[32:35], v6, s[12:15], s46 offen
    buffer_load_dwordx4 v[36:39], v7, s[12:15], s46 offen
    buffer_load_dwordx4 v[40:43], v8, s[12:15], s46 offen
    buffer_load_dwordx4 v[44:47], v9, s[12:15], s46 offen
    s_waitcnt lgkmcnt(0)
    s_barrier
    ds_read_b64_tr_b16 a[32:33], v16 offset:0
    ds_read_b64_tr_b16 a[34:35], v16 offset:800
    ds_read_b64_tr_b16 a[36:37], v16 offset:12800
    ds_read_b64_tr_b16 a[38:39], v16 offset:13600
    ds_read_b64_tr_b16 a[112:113], v16 offset:32
    ds_read_b64_tr_b16 a[114:115], v16 offset:832
    ds_read_b64_tr_b16 a[116:117], v16 offset:12832
    ds_read_b64_tr_b16 a[118:119], v16 offset:13632
    ds_read_b64_tr_b16 a[192:193], v16 offset:64
    ds_read_b64_tr_b16 a[194:195], v16 offset:864
    ds_read_b64_tr_b16 a[196:197], v16 offset:12864
    ds_read_b64_tr_b16 a[198:199], v16 offset:13664
    s_waitcnt lgkmcnt(0)
    s_barrier
    s_waitcnt vmcnt(6)
    ds_write_b128 v10, v[72:75]
    ds_write_b128 v11, v[76:79]
    ds_write_b128 v12, v[80:83]
    ds_write_b128 v13, v[84:87]
    ds_write_b128 v14, v[88:91]
    ds_write_b128 v15, v[92:95]
    s_add_u32 s46, s45, 5505024
    buffer_load_dwordx4 v[48:51], v4, s[12:15], s46 offen
    buffer_load_dwordx4 v[52:55], v5, s[12:15], s46 offen
    buffer_load_dwordx4 v[56:59], v6, s[12:15], s46 offen
    buffer_load_dwordx4 v[60:63], v7, s[12:15], s46 offen
    buffer_load_dwordx4 v[64:67], v8, s[12:15], s46 offen
    buffer_load_dwordx4 v[68:71], v9, s[12:15], s46 offen
    s_waitcnt lgkmcnt(0)
    s_barrier
    ds_read_b64_tr_b16 a[40:41], v16 offset:0
    ds_read_b64_tr_b16 a[42:43], v16 offset:800
    ds_read_b64_tr_b16 a[44:45], v16 offset:12800
    ds_read_b64_tr_b16 a[46:47], v16 offset:13600
    ds_read_b64_tr_b16 a[120:121], v16 offset:32
    ds_read_b64_tr_b16 a[122:123], v16 offset:832
    ds_read_b64_tr_b16 a[124:125], v16 offset:12832
    ds_read_b64_tr_b16 a[126:127], v16 offset:13632
    ds_read_b64_tr_b16 a[200:201], v16 offset:64
    ds_read_b64_tr_b16 a[202:203], v16 offset:864
    ds_read_b64_tr_b16 a[204:205], v16 offset:12864
    ds_read_b64_tr_b16 a[206:207], v16 offset:13664
    s_waitcnt lgkmcnt(0)
    s_barrier
    s_waitcnt vmcnt(6)
    ds_write_b128 v10, v[24:27]
    ds_write_b128 v11, v[28:31]
    ds_write_b128 v12, v[32:35]
    ds_write_b128 v13, v[36:39]
    ds_write_b128 v14, v[40:43]
    ds_write_b128 v15, v[44:47]
    s_add_u32 s46, s45, 6291456
    buffer_load_dwordx4 v[72:75], v4, s[12:15], s46 offen
    buffer_load_dwordx4 v[76:79], v5, s[12:15], s46 offen
    buffer_load_dwordx4 v[80:83], v6, s[12:15], s46 offen
    buffer_load_dwordx4 v[84:87], v7, s[12:15], s46 offen
    buffer_load_dwordx4 v[88:91], v8, s[12:15], s46 offen
    buffer_load_dwordx4 v[92:95], v9, s[12:15], s46 offen
    s_waitcnt lgkmcnt(0)
    s_barrier
    ds_read_b64_tr_b16 a[48:49], v16 offset:0
    ds_read_b64_tr_b16 a[50:51], v16 offset:800
    ds_read_b64_tr_b16 a[52:53], v16 offset:12800
    ds_read_b64_tr_b16 a[54:55], v16 offset:13600
    ds_read_b64_tr_b16 a[128:129], v16 offset:32
    ds_read_b64_tr_b16 a[130:131], v16 offset:832
    ds_read_b64_tr_b16 a[132:133], v16 offset:12832
    ds_read_b64_tr_b16 a[134:135], v16 offset:13632
    ds_read_b64_tr_b16 a[208:209], v16 offset:64
    ds_read_b64_tr_b16 a[210:211], v16 offset:864
    ds_read_b64_tr_b16 a[212:213], v16 offset:12864
    ds_read_b64_tr_b16 a[214:215], v16 offset:13664
    s_waitcnt lgkmcnt(0)
    s_barrier
    s_waitcnt vmcnt(6)
    ds_write_b128 v10, v[48:51]
    ds_write_b128 v11, v[52:55]
    ds_write_b128 v12, v[56:59]
    ds_write_b128 v13, v[60:63]
    ds_write_b128 v14, v[64:67]
    ds_write_b128 v15, v[68:71]
    s_add_u32 s46, s45, 7077888
    buffer_load_dwordx4 v[24:27], v4, s[12:15], s46 offen
    buffer_load_dwordx4 v[28:31], v5, s[12:15], s46 offen
    buffer_load_dwordx4 v[32:35], v6, s[12:15], s46 offen
    buffer_load_dwordx4 v[36:39], v7, s[12:15], s46 offen
    buffer_load_dwordx4 v[40:43], v8, s[12:15], s46 offen
    buffer_load_dwordx4 v[44:47], v9, s[12:15], s46 offen
    s_waitcnt lgkmcnt(0)
    s_barrier
    ds_read_b64_tr_b16 a[56:57], v16 offset:0
    ds_read_b64_tr_b16 a[58:59], v16 offset:800
    ds_read_b64_tr_b16 a[60:61], v16 offset:12800
    ds_read_b64_tr_b16 a[62:63], v16 offset:13600
    ds_read_b64_tr_b16 a[136:137], v16 offset:32
    ds_read_b64_tr_b16 a[138:139], v16 offset:832
    ds_read_b64_tr_b16 a[140:141], v16 offset:12832
    ds_read_b64_tr_b16 a[142:143], v16 offset:13632
    ds_read_b64_tr_b16 a[216:217], v16 offset:64
    ds_read_b64_tr_b16 a[218:219], v16 offset:864
    ds_read_b64_tr_b16 a[220:221], v16 offset:12864
    ds_read_b64_tr_b16 a[222:223], v16 offset:13664
    s_waitcnt lgkmcnt(0)
    s_barrier
    s_waitcnt vmcnt(6)
    ds_write_b128 v10, v[72:75]
    ds_write_b128 v11, v[76:79]
    ds_write_b128 v12, v[80:83]
    ds_write_b128 v13, v[84:87]
    ds_write_b128 v14, v[88:91]
    ds_write_b128 v15, v[92:95]
    s_waitcnt lgkmcnt(0)
    s_barrier
    ds_read_b64_tr_b16 a[64:65], v16 offset:0
    ds_read_b64_tr_b16 a[66:67], v16 offset:800
    ds_read_b64_tr_b16 a[68:69], v16 offset:12800
    ds_read_b64_tr_b16 a[70:71], v16 offset:13600
    ds_read_b64_tr_b16 a[144:145], v16 offset:32
    ds_read_b64_tr_b16 a[146:147], v16 offset:832
    ds_read_b64_tr_b16 a[148:149], v16 offset:12832
    ds_read_b64_tr_b16 a[150:151], v16 offset:13632
    ds_read_b64_tr_b16 a[224:225], v16 offset:64
    ds_read_b64_tr_b16 a[226:227], v16 offset:864
    ds_read_b64_tr_b16 a[228:229], v16 offset:12864
    ds_read_b64_tr_b16 a[230:231], v16 offset:13664
    s_waitcnt lgkmcnt(0)
    s_barrier
    s_waitcnt vmcnt(0)
    ds_write_b128 v10, v[24:27]
    ds_write_b128 v11, v[28:31]
    ds_write_b128 v12, v[32:35]
    ds_write_b128 v13, v[36:39]
    ds_write_b128 v14, v[40:43]
    ds_write_b128 v15, v[44:47]
    s_waitcnt lgkmcnt(0)
    s_barrier
    ds_read_b64_tr_b16 a[72:73], v16 offset:0
    ds_read_b64_tr_b16 a[74:75], v16 offset:800
    ds_read_b64_tr_b16 a[76:77], v16 offset:12800
    ds_read_b64_tr_b16 a[78:79], v16 offset:13600
    ds_read_b64_tr_b16 a[152:153], v16 offset:32
    ds_read_b64_tr_b16 a[154:155], v16 offset:832
    ds_read_b64_tr_b16 a[156:157], v16 offset:12832
    ds_read_b64_tr_b16 a[158:159], v16 offset:13632
    ds_read_b64_tr_b16 a[232:233], v16 offset:64
    ds_read_b64_tr_b16 a[234:235], v16 offset:864
    ds_read_b64_tr_b16 a[236:237], v16 offset:12864
    ds_read_b64_tr_b16 a[238:239], v16 offset:13664
    s_waitcnt lgkmcnt(0)
    s_barrier
    v_add_u32 v64, 0, v0
    s_mov_b32 s24, 1639
    v_mul_lo_u32 v65, v64, s24
    v_lshrrev_b32 v65, 16, v65
    v_mul_u32_u24 v66, 40, v65
    v_sub_u32 v66, v64, v66
    s_mov_b32 s24, 1280
    v_mul_lo_u32 v4, v65, s24
    v_lshl_add_u32 v4, v66, 4, v4
    v_mul_u32_u24 v14, 656, v65
    v_lshl_add_u32 v14, v66, 4, v14
    v_add_u32 v14, 90112, v14
    v_add_u32 v64, 256, v0
    s_mov_b32 s24, 1639
    v_mul_lo_u32 v65, v64, s24
    v_lshrrev_b32 v65, 16, v65
    v_mul_u32_u24 v66, 40, v65
    v_sub_u32 v66, v64, v66
    s_mov_b32 s24, 1280
    v_mul_lo_u32 v5, v65, s24
    v_lshl_add_u32 v5, v66, 4, v5
    v_mul_u32_u24 v15, 656, v65
    v_lshl_add_u32 v15, v66, 4, v15
    v_add_u32 v15, 90112, v15
    v_add_u32 v64, 512, v0
    s_mov_b32 s24, 1639
    v_mul_lo_u32 v65, v64, s24
    v_lshrrev_b32 v65, 16, v65
    v_mul_u32_u24 v66, 40, v65
    v_sub_u32 v66, v64, v66
    s_mov_b32 s24, 1280
    v_mul_lo_u32 v6, v65, s24
    v_lshl_add_u32 v6, v66, 4, v6
    v_mul_u32_u24 v16, 656, v65
    v_lshl_add_u32 v16, v66, 4, v16
    v_add_u32 v16, 90112, v16
    v_add_u32 v64, 768, v0
    s_mov_b32 s24, 1639
    v_mul_lo_u32 v65, v64, s24
    v_lshrrev_b32 v65, 16, v65
    v_mul_u32_u24 v66, 40, v65
    v_sub_u32 v66, v64, v66
    s_mov_b32 s24, 1280
    v_mul_lo_u32 v7, v65, s24
    v_lshl_add_u32 v7, v66, 4, v7
    v_mul_u32_u24 v17, 656, v65
    v_lshl_add_u32 v17, v66, 4, v17
    v_add_u32 v17, 90112, v17
    v_add_u32 v64, 1024, v0
    s_mov_b32 s24, 1639
    v_mul_lo_u32 v65, v64, s24
    v_lshrrev_b32 v65, 16, v65
    v_mul_u32_u24 v66, 40, v65
    v_sub_u32 v66, v64, v66
    s_mov_b32 s24, 1280
    v_mul_lo_u32 v8, v65, s24
    v_lshl_add_u32 v8, v66, 4, v8
    v_mul_u32_u24 v18, 656, v65
    v_lshl_add_u32 v18, v66, 4, v18
    v_add_u32 v18, 90112, v18
    v_add_u32 v64, 1280, v0
    s_mov_b32 s24, 1639
    v_mul_lo_u32 v65, v64, s24
    v_lshrrev_b32 v65, 16, v65
    v_mul_u32_u24 v66, 40, v65
    v_sub_u32 v66, v64, v66
    s_mov_b32 s24, 1280
    v_mul_lo_u32 v9, v65, s24
    v_lshl_add_u32 v9, v66, 4, v9
    v_mul_u32_u24 v19, 656, v65
    v_lshl_add_u32 v19, v66, 4, v19
    v_add_u32 v19, 90112, v19
    v_add_u32 v64, 1536, v0
    s_mov_b32 s24, 1639
    v_mul_lo_u32 v65, v64, s24
    v_lshrrev_b32 v65, 16, v65
    v_mul_u32_u24 v66, 40, v65
    v_sub_u32 v66, v64, v66
    s_mov_b32 s24, 1280
    v_mul_lo_u32 v10, v65, s24
    v_lshl_add_u32 v10, v66, 4, v10
    v_mul_u32_u24 v20, 656, v65
    v_lshl_add_u32 v20, v66, 4, v20
    v_add_u32 v20, 90112, v20
    v_add_u32 v64, 1792, v0
    s_mov_b32 s24, 1639
    v_mul_lo_u32 v65, v64, s24
    v_lshrrev_b32 v65, 16, v65
    v_mul_u32_u24 v66, 40, v65
    v_sub_u32 v66, v64, v66
    s_mov_b32 s24, 1280
    v_mul_lo_u32 v11, v65, s24
    v_lshl_add_u32 v11, v66, 4, v11
    v_mul_u32_u24 v21, 656, v65
    v_lshl_add_u32 v21, v66, 4, v21
    v_add_u32 v21, 90112, v21
    v_add_u32 v64, 2048, v0
    s_mov_b32 s24, 1639
    v_mul_lo_u32 v65, v64, s24
    v_lshrrev_b32 v65, 16, v65
    v_mul_u32_u24 v66, 40, v65
    v_sub_u32 v66, v64, v66
    s_mov_b32 s24, 1280
    v_mul_lo_u32 v12, v65, s24
    v_lshl_add_u32 v12, v66, 4, v12
    v_mul_u32_u24 v22, 656, v65
    v_lshl_add_u32 v22, v66, 4, v22
    v_add_u32 v22, 90112, v22
    v_add_u32 v64, 2304, v0
    s_mov_b32 s24, 1639
    v_mul_lo_u32 v65, v64, s24
    v_lshrrev_b32 v65, 16, v65
    v_mul_u32_u24 v66, 40, v65
    v_sub_u32 v66, v64, v66
    s_mov_b32 s24, 1280
    v_mul_lo_u32 v13, v65, s24
    v_lshl_add_u32 v13, v66, 4, v13
    v_mul_u32_u24 v23, 656, v65
    v_lshl_add_u32 v23, v66, 4, v23
    v_add_u32 v23, 90112, v23
    v_lshrrev_b32 v64, 1, v3
    v_lshlrev_b32 v64, 4, v64
    v_and_b32 v65, 1, v3
    v_lshl_add_u32 v64, v65, 2, v64
    v_lshrrev_b32 v65, 2, v2
    v_and_b32 v66, 1, v65
    v_add_u32 v64, v64, v66
    v_lshrrev_b32 v65, 1, v65
    v_lshl_add_u32 v64, v65, 3, v64
    v_mul_u32_u24 v72, 656, v64
    v_and_b32 v65, 3, v2
    v_lshl_add_u32 v72, v65, 3, v72
    v_add_u32 v72, 90112, v72
    s_and_b32 s24, s3, 1
    s_mul_i32 s24, s24, 320
    v_add_u32 v72, s24, v72
    v_lshlrev_b32 v73, 4, v1
    s_mul_i32 s24, s3, 18432
    s_add_u32 s24, s24, 16384
    v_add_u32 v73, s24, v73
    s_mul_i32 s45, s44, 245760
    s_add_u32 s46, s45, 0
    buffer_load_dwordx4 v[24:27], v4, s[16:19], s46 offen
    buffer_load_dwordx4 v[28:31], v5, s[16:19], s46 offen
    buffer_load_dwordx4 v[32:35], v6, s[16:19], s46 offen
    buffer_load_dwordx4 v[36:39], v7, s[16:19], s46 offen
    buffer_load_dwordx4 v[40:43], v8, s[16:19], s46 offen
    buffer_load_dwordx4 v[44:47], v9, s[16:19], s46 offen
    buffer_load_dwordx4 v[48:51], v10, s[16:19], s46 offen
    buffer_load_dwordx4 v[52:55], v11, s[16:19], s46 offen
    buffer_load_dwordx4 v[56:59], v12, s[16:19], s46 offen
    buffer_load_dwordx4 v[60:63], v13, s[16:19], s46 offen
    s_waitcnt vmcnt(0)
    ds_write_b128 v14, v[24:27]
    ds_write_b128 v15, v[28:31]
    ds_write_b128 v16, v[32:35]
    ds_write_b128 v17, v[36:39]
    ds_write_b128 v18, v[40:43]
    ds_write_b128 v19, v[44:47]
    ds_write_b128 v20, v[48:51]
    ds_write_b128 v21, v[52:55]
    ds_write_b128 v22, v[56:59]
    ds_write_b128 v23, v[60:63]
    s_waitcnt lgkmcnt(0)
    s_barrier
    s_lshr_b32 s24, s3, 1
    s_cmp_eq_u32 s24, 0
    s_cbranch_scc0 chain1_kernel_wo1
    ds_read_b64_tr_b16 a[240:241], v72 offset:0
    ds_read_b64_tr_b16 a[242:243], v72 offset:1312
    ds_read_b64_tr_b16 a[244:245], v72 offset:20992
    ds_read_b64_tr_b16 a[246:247], v72 offset:22304
    ds_read_b64_tr_b16 v[112:113], v72 offset:32
    ds_read_b64_tr_b16 v[114:115], v72 offset:1344
    ds_read_b64_tr_b16 v[116:117], v72 offset:21024
    ds_read_b64_tr_b16 v[118:119], v72 offset:22336
    ds_read_b64_tr_b16 v[136:137], v72 offset:64
    ds_read_b64_tr_b16 v[138:139], v72 offset:1376
    ds_read_b64_tr_b16 v[140:141], v72 offset:21056
    ds_read_b64_tr_b16 v[142:143], v72 offset:22368
    ds_read_b64_tr_b16 v[160:161], v72 offset:96
    ds_read_b64_tr_b16 v[162:163], v72 offset:1408
    ds_read_b64_tr_b16 v[164:165], v72 offset:21088
    ds_read_b64_tr_b16 v[166:167], v72 offset:22400
    ds_read_b64_tr_b16 v[184:185], v72 offset:128
    ds_read_b64_tr_b16 v[186:187], v72 offset:1440
    ds_read_b64_tr_b16 v[188:189], v72 offset:21120
    ds_read_b64_tr_b16 v[190:191], v72 offset:22432
    ds_read_b64_tr_b16 v[208:209], v72 offset:160
    ds_read_b64_tr_b16 v[210:211], v72 offset:1472
    ds_read_b64_tr_b16 v[212:213], v72 offset:21152
    ds_read_b64_tr_b16 v[214:215], v72 offset:22464
    ds_read_b64_tr_b16 v[232:233], v72 offset:192
    ds_read_b64_tr_b16 v[234:235], v72 offset:1504
    ds_read_b64_tr_b16 v[236:237], v72 offset:21184
    ds_read_b64_tr_b16 v[238:239], v72 offset:22496
    ds_read_b64_tr_b16 v[64:65], v72 offset:224
    ds_read_b64_tr_b16 v[66:67], v72 offset:1536
    ds_read_b64_tr_b16 v[68:69], v72 offset:21216
    ds_read_b64_tr_b16 v[70:71], v72 offset:22528
    s_waitcnt lgkmcnt(0)
    ds_write_b128 v73, v[64:67] offset:0
    ds_write_b128 v73, v[68:71] offset:1024
    s_waitcnt lgkmcnt(0)
    ds_read_b64_tr_b16 v[64:65], v72 offset:256
    ds_read_b64_tr_b16 v[66:67], v72 offset:1568
    ds_read_b64_tr_b16 v[68:69], v72 offset:21248
    ds_read_b64_tr_b16 v[70:71], v72 offset:22560
    s_waitcnt lgkmcnt(0)
    ds_write_b128 v73, v[64:67] offset:6144
    ds_write_b128 v73, v[68:71] offset:7168
    s_waitcnt lgkmcnt(0)
    ds_read_b64_tr_b16 v[64:65], v72 offset:288
    ds_read_b64_tr_b16 v[66:67], v72 offset:1600
    ds_read_b64_tr_b16 v[68:69], v72 offset:21280
    ds_read_b64_tr_b16 v[70:71], v72 offset:22592
    s_waitcnt lgkmcnt(0)
    ds_write_b128 v73, v[64:67] offset:12288
    ds_write_b128 v73, v[68:71] offset:13312
    s_waitcnt lgkmcnt(0)
    s_waitcnt lgkmcnt(0)
chain1_kernel_wo1:
    s_barrier
    s_add_u32 s46, s45, 640
    buffer_load_dwordx4 v[24:27], v4, s[16:19], s46 offen
    buffer_load_dwordx4 v[28:31], v5, s[16:19], s46 offen
    buffer_load_dwordx4 v[32:35], v6, s[16:19], s46 offen
    buffer_load_dwordx4 v[36:39], v7, s[16:19], s46 offen
    buffer_load_dwordx4 v[40:43], v8, s[16:19], s46 offen
    buffer_load_dwordx4 v[44:47], v9, s[16:19], s46 offen
    buffer_load_dwordx4 v[48:51], v10, s[16:19], s46 offen
    buffer_load_dwordx4 v[52:55], v11, s[16:19], s46 offen
    buffer_load_dwordx4 v[56:59], v12, s[16:19], s46 offen
    buffer_load_dwordx4 v[60:63], v13, s[16:19], s46 offen
    s_waitcnt vmcnt(0)
    ds_write_b128 v14, v[24:27]
    ds_write_b128 v15, v[28:31]
    ds_write_b128 v16, v[32:35]
    ds_write_b128 v17, v[36:39]
    ds_write_b128 v18, v[40:43]
    ds_write_b128 v19, v[44:47]
    ds_write_b128 v20, v[48:51]
    ds_write_b128 v21, v[52:55]
    ds_write_b128 v22, v[56:59]
    ds_write_b128 v23, v[60:63]
    s_waitcnt lgkmcnt(0)
    s_barrier
    s_lshr_b32 s24, s3, 1
    s_cmp_eq_u32 s24, 1
    s_cbranch_scc0 chain1_kernel_wo2
    ds_read_b64_tr_b16 a[240:241], v72 offset:0
    ds_read_b64_tr_b16 a[242:243], v72 offset:1312
    ds_read_b64_tr_b16 a[244:245], v72 offset:20992
    ds_read_b64_tr_b16 a[246:247], v72 offset:22304
    ds_read_b64_tr_b16 v[112:113], v72 offset:32
    ds_read_b64_tr_b16 v[114:115], v72 offset:1344
    ds_read_b64_tr_b16 v[116:117], v72 offset:21024
    ds_read_b64_tr_b16 v[118:119], v72 offset:22336
    ds_read_b64_tr_b16 v[136:137], v72 offset:64
    ds_read_b64_tr_b16 v[138:139], v72 offset:1376
    ds_read_b64_tr_b16 v[140:141], v72 offset:21056
    ds_read_b64_tr_b16 v[142:143], v72 offset:22368
    ds_read_b64_tr_b16 v[160:161], v72 offset:96
    ds_read_b64_tr_b16 v[162:163], v72 offset:1408
    ds_read_b64_tr_b16 v[164:165], v72 offset:21088
    ds_read_b64_tr_b16 v[166:167], v72 offset:22400
    ds_read_b64_tr_b16 v[184:185], v72 offset:128
    ds_read_b64_tr_b16 v[186:187], v72 offset:1440
    ds_read_b64_tr_b16 v[188:189], v72 offset:21120
    ds_read_b64_tr_b16 v[190:191], v72 offset:22432
    ds_read_b64_tr_b16 v[208:209], v72 offset:160
    ds_read_b64_tr_b16 v[210:211], v72 offset:1472
    ds_read_b64_tr_b16 v[212:213], v72 offset:21152
    ds_read_b64_tr_b16 v[214:215], v72 offset:22464
    ds_read_b64_tr_b16 v[232:233], v72 offset:192
    ds_read_b64_tr_b16 v[234:235], v72 offset:1504
    ds_read_b64_tr_b16 v[236:237], v72 offset:21184
    ds_read_b64_tr_b16 v[238:239], v72 offset:22496
    ds_read_b64_tr_b16 v[64:65], v72 offset:224
    ds_read_b64_tr_b16 v[66:67], v72 offset:1536
    ds_read_b64_tr_b16 v[68:69], v72 offset:21216
    ds_read_b64_tr_b16 v[70:71], v72 offset:22528
    s_waitcnt lgkmcnt(0)
    ds_write_b128 v73, v[64:67] offset:0
    ds_write_b128 v73, v[68:71] offset:1024
    s_waitcnt lgkmcnt(0)
    ds_read_b64_tr_b16 v[64:65], v72 offset:256
    ds_read_b64_tr_b16 v[66:67], v72 offset:1568
    ds_read_b64_tr_b16 v[68:69], v72 offset:21248
    ds_read_b64_tr_b16 v[70:71], v72 offset:22560
    s_waitcnt lgkmcnt(0)
    ds_write_b128 v73, v[64:67] offset:6144
    ds_write_b128 v73, v[68:71] offset:7168
    s_waitcnt lgkmcnt(0)
    ds_read_b64_tr_b16 v[64:65], v72 offset:288
    ds_read_b64_tr_b16 v[66:67], v72 offset:1600
    ds_read_b64_tr_b16 v[68:69], v72 offset:21280
    ds_read_b64_tr_b16 v[70:71], v72 offset:22592
    s_waitcnt lgkmcnt(0)
    ds_write_b128 v73, v[64:67] offset:12288
    ds_write_b128 v73, v[68:71] offset:13312
    s_waitcnt lgkmcnt(0)
    s_waitcnt lgkmcnt(0)
chain1_kernel_wo2:
    s_barrier
    s_add_u32 s46, s45, 81920
    buffer_load_dwordx4 v[24:27], v4, s[16:19], s46 offen
    buffer_load_dwordx4 v[28:31], v5, s[16:19], s46 offen
    buffer_load_dwordx4 v[32:35], v6, s[16:19], s46 offen
    buffer_load_dwordx4 v[36:39], v7, s[16:19], s46 offen
    buffer_load_dwordx4 v[40:43], v8, s[16:19], s46 offen
    buffer_load_dwordx4 v[44:47], v9, s[16:19], s46 offen
    buffer_load_dwordx4 v[48:51], v10, s[16:19], s46 offen
    buffer_load_dwordx4 v[52:55], v11, s[16:19], s46 offen
    buffer_load_dwordx4 v[56:59], v12, s[16:19], s46 offen
    buffer_load_dwordx4 v[60:63], v13, s[16:19], s46 offen
    s_waitcnt vmcnt(0)
    ds_write_b128 v14, v[24:27]
    ds_write_b128 v15, v[28:31]
    ds_write_b128 v16, v[32:35]
    ds_write_b128 v17, v[36:39]
    ds_write_b128 v18, v[40:43]
    ds_write_b128 v19, v[44:47]
    ds_write_b128 v20, v[48:51]
    ds_write_b128 v21, v[52:55]
    ds_write_b128 v22, v[56:59]
    ds_write_b128 v23, v[60:63]
    s_waitcnt lgkmcnt(0)
    s_barrier
    s_lshr_b32 s24, s3, 1
    s_cmp_eq_u32 s24, 0
    s_cbranch_scc0 chain1_kernel_wo3
    ds_read_b64_tr_b16 a[248:249], v72 offset:0
    ds_read_b64_tr_b16 a[250:251], v72 offset:1312
    ds_read_b64_tr_b16 a[252:253], v72 offset:20992
    ds_read_b64_tr_b16 a[254:255], v72 offset:22304
    ds_read_b64_tr_b16 v[120:121], v72 offset:32
    ds_read_b64_tr_b16 v[122:123], v72 offset:1344
    ds_read_b64_tr_b16 v[124:125], v72 offset:21024
    ds_read_b64_tr_b16 v[126:127], v72 offset:22336
    ds_read_b64_tr_b16 v[144:145], v72 offset:64
    ds_read_b64_tr_b16 v[146:147], v72 offset:1376
    ds_read_b64_tr_b16 v[148:149], v72 offset:21056
    ds_read_b64_tr_b16 v[150:151], v72 offset:22368
    ds_read_b64_tr_b16 v[168:169], v72 offset:96
    ds_read_b64_tr_b16 v[170:171], v72 offset:1408
    ds_read_b64_tr_b16 v[172:173], v72 offset:21088
    ds_read_b64_tr_b16 v[174:175], v72 offset:22400
    ds_read_b64_tr_b16 v[192:193], v72 offset:128
    ds_read_b64_tr_b16 v[194:195], v72 offset:1440
    ds_read_b64_tr_b16 v[196:197], v72 offset:21120
    ds_read_b64_tr_b16 v[198:199], v72 offset:22432
    ds_read_b64_tr_b16 v[216:217], v72 offset:160
    ds_read_b64_tr_b16 v[218:219], v72 offset:1472
    ds_read_b64_tr_b16 v[220:221], v72 offset:21152
    ds_read_b64_tr_b16 v[222:223], v72 offset:22464
    ds_read_b64_tr_b16 v[240:241], v72 offset:192
    ds_read_b64_tr_b16 v[242:243], v72 offset:1504
    ds_read_b64_tr_b16 v[244:245], v72 offset:21184
    ds_read_b64_tr_b16 v[246:247], v72 offset:22496
    ds_read_b64_tr_b16 v[64:65], v72 offset:224
    ds_read_b64_tr_b16 v[66:67], v72 offset:1536
    ds_read_b64_tr_b16 v[68:69], v72 offset:21216
    ds_read_b64_tr_b16 v[70:71], v72 offset:22528
    s_waitcnt lgkmcnt(0)
    ds_write_b128 v73, v[64:67] offset:2048
    ds_write_b128 v73, v[68:71] offset:3072
    s_waitcnt lgkmcnt(0)
    ds_read_b64_tr_b16 v[64:65], v72 offset:256
    ds_read_b64_tr_b16 v[66:67], v72 offset:1568
    ds_read_b64_tr_b16 v[68:69], v72 offset:21248
    ds_read_b64_tr_b16 v[70:71], v72 offset:22560
    s_waitcnt lgkmcnt(0)
    ds_write_b128 v73, v[64:67] offset:8192
    ds_write_b128 v73, v[68:71] offset:9216
    s_waitcnt lgkmcnt(0)
    ds_read_b64_tr_b16 v[64:65], v72 offset:288
    ds_read_b64_tr_b16 v[66:67], v72 offset:1600
    ds_read_b64_tr_b16 v[68:69], v72 offset:21280
    ds_read_b64_tr_b16 v[70:71], v72 offset:22592
    s_waitcnt lgkmcnt(0)
    ds_write_b128 v73, v[64:67] offset:14336
    ds_write_b128 v73, v[68:71] offset:15360
    s_waitcnt lgkmcnt(0)
    s_waitcnt lgkmcnt(0)
chain1_kernel_wo3:
    s_barrier
    s_add_u32 s46, s45, 82560
    buffer_load_dwordx4 v[24:27], v4, s[16:19], s46 offen
    buffer_load_dwordx4 v[28:31], v5, s[16:19], s46 offen
    buffer_load_dwordx4 v[32:35], v6, s[16:19], s46 offen
    buffer_load_dwordx4 v[36:39], v7, s[16:19], s46 offen
    buffer_load_dwordx4 v[40:43], v8, s[16:19], s46 offen
    buffer_load_dwordx4 v[44:47], v9, s[16:19], s46 offen
    buffer_load_dwordx4 v[48:51], v10, s[16:19], s46 offen
    buffer_load_dwordx4 v[52:55], v11, s[16:19], s46 offen
    buffer_load_dwordx4 v[56:59], v12, s[16:19], s46 offen
    buffer_load_dwordx4 v[60:63], v13, s[16:19], s46 offen
    s_waitcnt vmcnt(0)
    ds_write_b128 v14, v[24:27]
    ds_write_b128 v15, v[28:31]
    ds_write_b128 v16, v[32:35]
    ds_write_b128 v17, v[36:39]
    ds_write_b128 v18, v[40:43]
    ds_write_b128 v19, v[44:47]
    ds_write_b128 v20, v[48:51]
    ds_write_b128 v21, v[52:55]
    ds_write_b128 v22, v[56:59]
    ds_write_b128 v23, v[60:63]
    s_waitcnt lgkmcnt(0)
    s_barrier
    s_lshr_b32 s24, s3, 1
    s_cmp_eq_u32 s24, 1
    s_cbranch_scc0 chain1_kernel_wo4
    ds_read_b64_tr_b16 a[248:249], v72 offset:0
    ds_read_b64_tr_b16 a[250:251], v72 offset:1312
    ds_read_b64_tr_b16 a[252:253], v72 offset:20992
    ds_read_b64_tr_b16 a[254:255], v72 offset:22304
    ds_read_b64_tr_b16 v[120:121], v72 offset:32
    ds_read_b64_tr_b16 v[122:123], v72 offset:1344
    ds_read_b64_tr_b16 v[124:125], v72 offset:21024
    ds_read_b64_tr_b16 v[126:127], v72 offset:22336
    ds_read_b64_tr_b16 v[144:145], v72 offset:64
    ds_read_b64_tr_b16 v[146:147], v72 offset:1376
    ds_read_b64_tr_b16 v[148:149], v72 offset:21056
    ds_read_b64_tr_b16 v[150:151], v72 offset:22368
    ds_read_b64_tr_b16 v[168:169], v72 offset:96
    ds_read_b64_tr_b16 v[170:171], v72 offset:1408
    ds_read_b64_tr_b16 v[172:173], v72 offset:21088
    ds_read_b64_tr_b16 v[174:175], v72 offset:22400
    ds_read_b64_tr_b16 v[192:193], v72 offset:128
    ds_read_b64_tr_b16 v[194:195], v72 offset:1440
    ds_read_b64_tr_b16 v[196:197], v72 offset:21120
    ds_read_b64_tr_b16 v[198:199], v72 offset:22432
    ds_read_b64_tr_b16 v[216:217], v72 offset:160
    ds_read_b64_tr_b16 v[218:219], v72 offset:1472
    ds_read_b64_tr_b16 v[220:221], v72 offset:21152
    ds_read_b64_tr_b16 v[222:223], v72 offset:22464
    ds_read_b64_tr_b16 v[240:241], v72 offset:192
    ds_read_b64_tr_b16 v[242:243], v72 offset:1504
    ds_read_b64_tr_b16 v[244:245], v72 offset:21184
    ds_read_b64_tr_b16 v[246:247], v72 offset:22496
    ds_read_b64_tr_b16 v[64:65], v72 offset:224
    ds_read_b64_tr_b16 v[66:67], v72 offset:1536
    ds_read_b64_tr_b16 v[68:69], v72 offset:21216
    ds_read_b64_tr_b16 v[70:71], v72 offset:22528
    s_waitcnt lgkmcnt(0)
    ds_write_b128 v73, v[64:67] offset:2048
    ds_write_b128 v73, v[68:71] offset:3072
    s_waitcnt lgkmcnt(0)
    ds_read_b64_tr_b16 v[64:65], v72 offset:256
    ds_read_b64_tr_b16 v[66:67], v72 offset:1568
    ds_read_b64_tr_b16 v[68:69], v72 offset:21248
    ds_read_b64_tr_b16 v[70:71], v72 offset:22560
    s_waitcnt lgkmcnt(0)
    ds_write_b128 v73, v[64:67] offset:8192
    ds_write_b128 v73, v[68:71] offset:9216
    s_waitcnt lgkmcnt(0)
    ds_read_b64_tr_b16 v[64:65], v72 offset:288
    ds_read_b64_tr_b16 v[66:67], v72 offset:1600
    ds_read_b64_tr_b16 v[68:69], v72 offset:21280
    ds_read_b64_tr_b16 v[70:71], v72 offset:22592
    s_waitcnt lgkmcnt(0)
    ds_write_b128 v73, v[64:67] offset:14336
    ds_write_b128 v73, v[68:71] offset:15360
    s_waitcnt lgkmcnt(0)
    s_waitcnt lgkmcnt(0)
chain1_kernel_wo4:
    s_barrier
    s_add_u32 s46, s45, 163840
    buffer_load_dwordx4 v[24:27], v4, s[16:19], s46 offen
    buffer_load_dwordx4 v[28:31], v5, s[16:19], s46 offen
    buffer_load_dwordx4 v[32:35], v6, s[16:19], s46 offen
    buffer_load_dwordx4 v[36:39], v7, s[16:19], s46 offen
    buffer_load_dwordx4 v[40:43], v8, s[16:19], s46 offen
    buffer_load_dwordx4 v[44:47], v9, s[16:19], s46 offen
    buffer_load_dwordx4 v[48:51], v10, s[16:19], s46 offen
    buffer_load_dwordx4 v[52:55], v11, s[16:19], s46 offen
    buffer_load_dwordx4 v[56:59], v12, s[16:19], s46 offen
    buffer_load_dwordx4 v[60:63], v13, s[16:19], s46 offen
    s_waitcnt vmcnt(0)
    ds_write_b128 v14, v[24:27]
    ds_write_b128 v15, v[28:31]
    ds_write_b128 v16, v[32:35]
    ds_write_b128 v17, v[36:39]
    ds_write_b128 v18, v[40:43]
    ds_write_b128 v19, v[44:47]
    ds_write_b128 v20, v[48:51]
    ds_write_b128 v21, v[52:55]
    ds_write_b128 v22, v[56:59]
    ds_write_b128 v23, v[60:63]
    s_waitcnt lgkmcnt(0)
    s_barrier
    s_lshr_b32 s24, s3, 1
    s_cmp_eq_u32 s24, 0
    s_cbranch_scc0 chain1_kernel_wo5
    ds_read_b64_tr_b16 v[104:105], v72 offset:0
    ds_read_b64_tr_b16 v[106:107], v72 offset:1312
    ds_read_b64_tr_b16 v[108:109], v72 offset:20992
    ds_read_b64_tr_b16 v[110:111], v72 offset:22304
    ds_read_b64_tr_b16 v[128:129], v72 offset:32
    ds_read_b64_tr_b16 v[130:131], v72 offset:1344
    ds_read_b64_tr_b16 v[132:133], v72 offset:21024
    ds_read_b64_tr_b16 v[134:135], v72 offset:22336
    ds_read_b64_tr_b16 v[152:153], v72 offset:64
    ds_read_b64_tr_b16 v[154:155], v72 offset:1376
    ds_read_b64_tr_b16 v[156:157], v72 offset:21056
    ds_read_b64_tr_b16 v[158:159], v72 offset:22368
    ds_read_b64_tr_b16 v[176:177], v72 offset:96
    ds_read_b64_tr_b16 v[178:179], v72 offset:1408
    ds_read_b64_tr_b16 v[180:181], v72 offset:21088
    ds_read_b64_tr_b16 v[182:183], v72 offset:22400
    ds_read_b64_tr_b16 v[200:201], v72 offset:128
    ds_read_b64_tr_b16 v[202:203], v72 offset:1440
    ds_read_b64_tr_b16 v[204:205], v72 offset:21120
    ds_read_b64_tr_b16 v[206:207], v72 offset:22432
    ds_read_b64_tr_b16 v[224:225], v72 offset:160
    ds_read_b64_tr_b16 v[226:227], v72 offset:1472
    ds_read_b64_tr_b16 v[228:229], v72 offset:21152
    ds_read_b64_tr_b16 v[230:231], v72 offset:22464
    ds_read_b64_tr_b16 v[248:249], v72 offset:192
    ds_read_b64_tr_b16 v[250:251], v72 offset:1504
    ds_read_b64_tr_b16 v[252:253], v72 offset:21184
    ds_read_b64_tr_b16 v[254:255], v72 offset:22496
    ds_read_b64_tr_b16 v[64:65], v72 offset:224
    ds_read_b64_tr_b16 v[66:67], v72 offset:1536
    ds_read_b64_tr_b16 v[68:69], v72 offset:21216
    ds_read_b64_tr_b16 v[70:71], v72 offset:22528
    s_waitcnt lgkmcnt(0)
    ds_write_b128 v73, v[64:67] offset:4096
    ds_write_b128 v73, v[68:71] offset:5120
    s_waitcnt lgkmcnt(0)
    ds_read_b64_tr_b16 v[64:65], v72 offset:256
    ds_read_b64_tr_b16 v[66:67], v72 offset:1568
    ds_read_b64_tr_b16 v[68:69], v72 offset:21248
    ds_read_b64_tr_b16 v[70:71], v72 offset:22560
    s_waitcnt lgkmcnt(0)
    ds_write_b128 v73, v[64:67] offset:10240
    ds_write_b128 v73, v[68:71] offset:11264
    s_waitcnt lgkmcnt(0)
    ds_read_b64_tr_b16 v[64:65], v72 offset:288
    ds_read_b64_tr_b16 v[66:67], v72 offset:1600
    ds_read_b64_tr_b16 v[68:69], v72 offset:21280
    ds_read_b64_tr_b16 v[70:71], v72 offset:22592
    s_waitcnt lgkmcnt(0)
    ds_write_b128 v73, v[64:67] offset:16384
    ds_write_b128 v73, v[68:71] offset:17408
    s_waitcnt lgkmcnt(0)
    s_waitcnt lgkmcnt(0)
chain1_kernel_wo5:
    s_barrier
    s_add_u32 s46, s45, 164480
    buffer_load_dwordx4 v[24:27], v4, s[16:19], s46 offen
    buffer_load_dwordx4 v[28:31], v5, s[16:19], s46 offen
    buffer_load_dwordx4 v[32:35], v6, s[16:19], s46 offen
    buffer_load_dwordx4 v[36:39], v7, s[16:19], s46 offen
    buffer_load_dwordx4 v[40:43], v8, s[16:19], s46 offen
    buffer_load_dwordx4 v[44:47], v9, s[16:19], s46 offen
    buffer_load_dwordx4 v[48:51], v10, s[16:19], s46 offen
    buffer_load_dwordx4 v[52:55], v11, s[16:19], s46 offen
    buffer_load_dwordx4 v[56:59], v12, s[16:19], s46 offen
    buffer_load_dwordx4 v[60:63], v13, s[16:19], s46 offen
    s_waitcnt vmcnt(0)
    ds_write_b128 v14, v[24:27]
    ds_write_b128 v15, v[28:31]
    ds_write_b128 v16, v[32:35]
    ds_write_b128 v17, v[36:39]
    ds_write_b128 v18, v[40:43]
    ds_write_b128 v19, v[44:47]
    ds_write_b128 v20, v[48:51]
    ds_write_b128 v21, v[52:55]
    ds_write_b128 v22, v[56:59]
    ds_write_b128 v23, v[60:63]
    s_waitcnt lgkmcnt(0)
    s_barrier
    s_lshr_b32 s24, s3, 1
    s_cmp_eq_u32 s24, 1
    s_cbranch_scc0 chain1_kernel_wo6
    ds_read_b64_tr_b16 v[104:105], v72 offset:0
    ds_read_b64_tr_b16 v[106:107], v72 offset:1312
    ds_read_b64_tr_b16 v[108:109], v72 offset:20992
    ds_read_b64_tr_b16 v[110:111], v72 offset:22304
    ds_read_b64_tr_b16 v[128:129], v72 offset:32
    ds_read_b64_tr_b16 v[130:131], v72 offset:1344
    ds_read_b64_tr_b16 v[132:133], v72 offset:21024
    ds_read_b64_tr_b16 v[134:135], v72 offset:22336
    ds_read_b64_tr_b16 v[152:153], v72 offset:64
    ds_read_b64_tr_b16 v[154:155], v72 offset:1376
    ds_read_b64_tr_b16 v[156:157], v72 offset:21056
    ds_read_b64_tr_b16 v[158:159], v72 offset:22368
    ds_read_b64_tr_b16 v[176:177], v72 offset:96
    ds_read_b64_tr_b16 v[178:179], v72 offset:1408
    ds_read_b64_tr_b16 v[180:181], v72 offset:21088
    ds_read_b64_tr_b16 v[182:183], v72 offset:22400
    ds_read_b64_tr_b16 v[200:201], v72 offset:128
    ds_read_b64_tr_b16 v[202:203], v72 offset:1440
    ds_read_b64_tr_b16 v[204:205], v72 offset:21120
    ds_read_b64_tr_b16 v[206:207], v72 offset:22432
    ds_read_b64_tr_b16 v[224:225], v72 offset:160
    ds_read_b64_tr_b16 v[226:227], v72 offset:1472
    ds_read_b64_tr_b16 v[228:229], v72 offset:21152
    ds_read_b64_tr_b16 v[230:231], v72 offset:22464
    ds_read_b64_tr_b16 v[248:249], v72 offset:192
    ds_read_b64_tr_b16 v[250:251], v72 offset:1504
    ds_read_b64_tr_b16 v[252:253], v72 offset:21184
    ds_read_b64_tr_b16 v[254:255], v72 offset:22496
    ds_read_b64_tr_b16 v[64:65], v72 offset:224
    ds_read_b64_tr_b16 v[66:67], v72 offset:1536
    ds_read_b64_tr_b16 v[68:69], v72 offset:21216
    ds_read_b64_tr_b16 v[70:71], v72 offset:22528
    s_waitcnt lgkmcnt(0)
    ds_write_b128 v73, v[64:67] offset:4096
    ds_write_b128 v73, v[68:71] offset:5120
    s_waitcnt lgkmcnt(0)
    ds_read_b64_tr_b16 v[64:65], v72 offset:256
    ds_read_b64_tr_b16 v[66:67], v72 offset:1568
    ds_read_b64_tr_b16 v[68:69], v72 offset:21248
    ds_read_b64_tr_b16 v[70:71], v72 offset:22560
    s_waitcnt lgkmcnt(0)
    ds_write_b128 v73, v[64:67] offset:10240
    ds_write_b128 v73, v[68:71] offset:11264
    s_waitcnt lgkmcnt(0)
    ds_read_b64_tr_b16 v[64:65], v72 offset:288
    ds_read_b64_tr_b16 v[66:67], v72 offset:1600
    ds_read_b64_tr_b16 v[68:69], v72 offset:21280
    ds_read_b64_tr_b16 v[70:71], v72 offset:22592
    s_waitcnt lgkmcnt(0)
    ds_write_b128 v73, v[64:67] offset:16384
    ds_write_b128 v73, v[68:71] offset:17408
    s_waitcnt lgkmcnt(0)
    s_waitcnt lgkmcnt(0)
chain1_kernel_wo6:
    s_barrier
    v_mov_b32 v6, v73
    v_mov_b32 v4, 0x4444
    v_mov_b32 v5, 0xeeee
    v_cmp_gt_u32 vcc, 8, v2
    s_nop 1
    v_cndmask_b32 v4, v5, v4, vcc
    v_lshlrev_b32 v5, 4, v1
    s_lshl_b32 s24, s3, 10
    v_add_u32 v7, s24, v5
    s_lshl_b32 s24, s3, 9
    s_add_u32 s24, s24, 8192
    v_lshlrev_b32 v8, 3, v1
    v_add_u32 v8, s24, v8
    v_and_b32 v64, 7, v2
    v_lshlrev_b32 v9, 5, v64
    v_lshrrev_b32 v64, 3, v2
    v_lshl_add_u32 v9, v64, 4, v9
    v_and_b32 v64, 1, v3
    v_lshl_add_u32 v9, v64, 3, v9
    s_mul_i32 s24, s3, 768
    s_add_u32 s24, s24, 10240
    v_add_u32 v9, s24, v9
    v_lshrrev_b32 v65, 1, v3
    v_lshl_add_u32 v10, v65, 8, v9
    v_lshrrev_b32 v64, 2, v2
    v_lshlrev_b32 v11, 5, v64
    v_and_b32 v64, 3, v2
    v_lshl_add_u32 v11, v64, 3, v11
    v_lshl_add_u32 v11, v3, 8, v11
    v_add_u32 v11, 10240, v11
    s_mul_i32 s24, s3, 10
    s_lshl_b32 s24, s24, 13
    s_lshl_b32 s25, s44, 8
    s_add_u32 s24, s24, s25
    v_lshlrev_b32 v14, 13, v3
    v_lshl_add_u32 v14, v2, 4, v14
    v_add_u32 v14, s24, v14
    v_lshrrev_b32 v64, 1, v3
    v_lshlrev_b32 v15, 13, v64
    v_lshl_add_u32 v15, v2, 4, v15
    v_add_u32 v15, s24, v15
    v_add_u32 v15, 65536, v15
    v_and_b32 v64, 1, v3
    v_cmp_eq_u32 vcc, 0, v64
    v_mov_b32 v64, 2146435072
    s_nop 0
    v_cndmask_b32 v15, v64, v15, vcc
    s_and_b32 s24, s2, 15
    s_mul_i32 s25, s3, 16
    s_add_u32 s24, s24, s25
    s_lshl_b32 s24, s24, 7
    v_mov_b32 v12, s24
    s_lshr_b32 s25, s44, 3
    s_mul_i32 s24, s25, 8
    v_add_u32 v13, s24, v1
    v_lshlrev_b32 v13, 7, v13
    v_mov_b32 v64, 2146435072
    v_cmp_le_u32 vcc, 8, v1
    s_nop 1
    v_cndmask_b32 v13, v13, v64, vcc
    s_cmp_eq_u32 s3, 0
    s_cselect_b32 s24, 0, 2146435072
    v_or_b32 v13, s24, v13
    s_mov_b32 s45, 151576576
    s_mov_b32 s42, 154238976
    v_add_u32 v64, 0, v0
    v_and_b32 v65, 7, v64
    v_mul_u32_u24 v65, 1280, v65
    v_lshrrev_b32 v66, 3, v64
    v_lshl_add_u32 v65, v66, 4, v65
    v_cmp_gt_u32 vcc, 640, v64
    v_mov_b32 v67, 2146435072
    s_nop 0
    v_cndmask_b32 v65, v67, v65, vcc
    buffer_load_dwordx4 v[68:71], v65, s[20:23], 0 offen
    v_lshlrev_b32 v64, 4, v64
    s_waitcnt vmcnt(0)
    s_and_saveexec_b64 s[30:31], vcc
    ds_write_b128 v64, v[68:71]
    s_mov_b64 exec, s[30:31]
    v_add_u32 v64, 256, v0
    v_and_b32 v65, 7, v64
    v_mul_u32_u24 v65, 1280, v65
    v_lshrrev_b32 v66, 3, v64
    v_lshl_add_u32 v65, v66, 4, v65
    v_cmp_gt_u32 vcc, 640, v64
    v_mov_b32 v67, 2146435072
    s_nop 0
    v_cndmask_b32 v65, v67, v65, vcc
    buffer_load_dwordx4 v[68:71], v65, s[20:23], 0 offen
    v_lshlrev_b32 v64, 4, v64
    s_waitcnt vmcnt(0)
    s_and_saveexec_b64 s[30:31], vcc
    ds_write_b128 v64, v[68:71]
    s_mov_b64 exec, s[30:31]
    v_add_u32 v64, 512, v0
    v_and_b32 v65, 7, v64
    v_mul_u32_u24 v65, 1280, v65
    v_lshrrev_b32 v66, 3, v64
    v_lshl_add_u32 v65, v66, 4, v65
    v_cmp_gt_u32 vcc, 640, v64
    v_mov_b32 v67, 2146435072
    s_nop 0
    v_cndmask_b32 v65, v67, v65, vcc
    buffer_load_dwordx4 v[68:71], v65, s[20:23], 0 offen
    v_lshlrev_b32 v64, 4, v64
    s_waitcnt vmcnt(0)
    s_and_saveexec_b64 s[30:31], vcc
    ds_write_b128 v64, v[68:71]
    s_mov_b64 exec, s[30:31]
    v_mov_b32 v0, 1
    s_mov_b32 s40, 0
    s_mov_b32 s43, 117440512
    s_mov_b32 s54, 20
    s_mov_b32 s47, 138412032
    s_waitcnt lgkmcnt(0)
    s_branch chain1_kernel_v_go2
chain1_kernel_v_step:
    s_add_u32 s48, s47, 4096
    s_sleep 20
    s_mov_b64 exec, 1
    s_mov_b32 s61, 0
    v_mov_b32 v81, 0
    buffer_atomic_add v81, v12, s[8:11], s45 offen sc0
    s_sleep 2
    v_mov_b32 v82, 0
    buffer_atomic_add v82, v12, s[8:11], s45 offen sc0
    s_sleep 2
    v_mov_b32 v83, 0
    buffer_atomic_add v83, v12, s[8:11], s45 offen sc0
    s_sleep 2
chain1_kernel_v_pr:
    v_mov_b32 v80, 0
    buffer_atomic_add v80, v12, s[8:11], s45 offen sc0
    s_waitcnt vmcnt(3)
    v_cmp_le_i32 vcc, 9, v81
    s_add_u32 s61, s61, 1
    s_cbranch_vccnz chain1_kernel_v_pr_out
    s_sleep 2
    v_mov_b32 v81, 0
    buffer_atomic_add v81, v12, s[8:11], s45 offen sc0
    s_waitcnt vmcnt(3)
    v_cmp_le_i32 vcc, 9, v82
    s_add_u32 s61, s61, 1
    s_cbranch_vccnz chain1_kernel_v_pr_out
    s_sleep 2
    v_mov_b32 v82, 0
    buffer_atomic_add v82, v12, s[8:11], s45 offen sc0
    s_waitcnt vmcnt(3)
    v_cmp_le_i32 vcc, 9, v83
    s_add_u32 s61, s61, 1
    s_cbranch_vccnz chain1_kernel_v_pr_out
    s_sleep 2
    v_mov_b32 v83, 0
    buffer_atomic_add v83, v12, s[8:11], s45 offen sc0
    s_waitcnt vmcnt(3)
    v_cmp_le_i32 vcc, 9, v80
    s_add_u32 s61, s61, 1
    s_cbranch_vccnz chain1_kernel_v_pr_out
    s_sleep 2
    s_cmp_ge_u32 s61, s60
    s_cbranch_scc0 chain1_kernel_v_pr
    s_mov_b32 s60, 1
chain1_kernel_v_pr_out:
    s_mov_b64 exec, -1
    buffer_load_dwordx4 v[68:71], v7, s[8:11], s47 offen sc1
    buffer_load_dwordx4 v[72:75], v7, s[8:11], s48 offen sc1
    buffer_load_dwordx2 v[76:77], v8, s[8:11], s47 offen sc1
    s_waitcnt vmcnt(0)
    v_max3_u32 v26, v68, v69, v70
    v_max3_u32 v26, v26, v71, v72
    v_max3_u32 v26, v26, v73, v74
    v_max3_u32 v26, v26, v75, v76
    v_max_u32 v26, v26, v77
    v_cmp_eq_u32 vcc, -1, v26
    s_cbranch_vccz chain1_kernel_v_pm_out
    s_mov_b32 s61, 0
chain1_kernel_v_pm:
    buffer_load_dwordx4 v[68:71], v7, s[8:11], s47 offen sc1
    buffer_load_dwordx4 v[72:75], v7, s[8:11], s48 offen sc1
    buffer_load_dwordx2 v[76:77], v8, s[8:11], s47 offen sc1
    s_waitcnt vmcnt(0)
    v_max3_u32 v26, v68, v69, v70
    v_max3_u32 v26, v26, v71, v72
    v_max3_u32 v26, v26, v73, v74
    v_max3_u32 v26, v26, v75, v76
    v_max_u32 v26, v26, v77
    v_cmp_eq_u32 vcc, -1, v26
    s_add_u32 s61, s61, 1
    s_cbranch_vccz chain1_kernel_v_pm_out
    s_cmp_ge_u32 s61, s60
    s_cbranch_scc1 chain1_kernel_v_pm_to
    s_sleep 1
    s_branch chain1_kernel_v_pm
chain1_kernel_v_pm_to:
    s_mov_b32 s60, 1
chain1_kernel_v_pm_out:
    ds_write_b128 v7, v[68:71]
    ds_write_b128 v7, v[72:75] offset:4096
    ds_write_b64 v8, v[76:77]
    s_waitcnt lgkmcnt(0)
chain1_kernel_v_go2:
    s_barrier
    ds_read_b128 v[16:19], v5 offset:0
    ds_read_b128 v[20:23], v5 offset:1024
    ds_read_b128 v[24:27], v5 offset:2048
    ds_read_b128 v[28:31], v5 offset:3072
    ds_read_b128 v[32:35], v5 offset:4096
    ds_read_b128 v[36:39], v5 offset:5120
    ds_read_b128 v[40:43], v5 offset:6144
    ds_read_b128 v[44:47], v5 offset:7168
    ds_read_b128 v[48:51], v5 offset:8192
    ds_read_b128 v[52:55], v5 offset:9216
    v_mov_b32 v56, 0
    v_mov_b32 v57, 0
    v_mov_b32 v58, 0
    v_mov_b32 v59, 0
    v_mov_b32 v60, 0
    v_mov_b32 v61, 0
    v_mov_b32 v62, 0
    v_mov_b32 v63, 0
    v_mov_b32 v64, 0
    v_mov_b32 v65, 0
    v_mov_b32 v66, 0
    v_mov_b32 v67, 0
    s_waitcnt lgkmcnt(9)
    v_smfmac_f32_16x16x64_bf16 v[56:59], v[16:19], a[0:7], v4
    v_smfmac_f32_16x16x64_bf16 v[60:63], v[16:19], a[80:87], v4
    v_smfmac_f32_16x16x64_bf16 v[64:67], v[16:19], a[160:167], v4
    s_waitcnt lgkmcnt(8)
    v_smfmac_f32_16x16x64_bf16 v[56:59], v[20:23], a[8:15], v4
    v_smfmac_f32_16x16x64_bf16 v[60:63], v[20:23], a[88:95], v4
    v_smfmac_f32_16x16x64_bf16 v[64:67], v[20:23], a[168:175], v4
    s_waitcnt lgkmcnt(7)
    v_smfmac_f32_16x16x64_bf16 v[56:59], v[24:27], a[16:23], v4
    v_smfmac_f32_16x16x64_bf16 v[60:63], v[24:27], a[96:103], v4
    v_smfmac_f32_16x16x64_bf16 v[64:67], v[24:27], a[176:183], v4
    s_waitcnt lgkmcnt(6)
    v_smfmac_f32_16x16x64_bf16 v[56:59], v[28:31], a[24:31], v4
    v_smfmac_f32_16x16x64_bf16 v[60:63], v[28:31], a[104:111], v4
    v_smfmac_f32_16x16x64_bf16 v[64:67], v[28:31], a[184:191], v4
    s_waitcnt lgkmcnt(5)
    v_smfmac_f32_16x16x64_bf16 v[56:59], v[32:35], a[32:39], v4
    v_smfmac_f32_16x16x64_bf16 v[60:63], v[32:35], a[112:119], v4
    v_smfmac_f32_16x16x64_bf16 v[64:67], v[32:35], a[192:199], v4
    s_waitcnt lgkmcnt(4)
    v_smfmac_f32_16x16x64_bf16 v[56:59], v[36:39], a[40:47], v4
    v_smfmac_f32_16x16x64_bf16 v[60:63], v[36:39], a[120:127], v4
    v_smfmac_f32_16x16x64_bf16 v[64:67], v[36:39], a[200:207], v4
    s_waitcnt lgkmcnt(3)
    v_smfmac_f32_16x16x64_bf16 v[56:59], v[40:43], a[48:55], v4
    v_smfmac_f32_16x16x64_bf16 v[60:63], v[40:43], a[128:135], v4
    v_smfmac_f32_16x16x64_bf16 v[64:67], v[40:43], a[208:215], v4
    s_waitcnt lgkmcnt(2)
    v_smfmac_f32_16x16x64_bf16 v[56:59], v[44:47], a[56:63], v4
    v_smfmac_f32_16x16x64_bf16 v[60:63], v[44:47], a[136:143], v4
    v_smfmac_f32_16x16x64_bf16 v[64:67], v[44:47], a[216:223], v4
    s_waitcnt lgkmcnt(1)
    v_smfmac_f32_16x16x64_bf16 v[56:59], v[48:51], a[64:71], v4
    v_smfmac_f32_16x16x64_bf16 v[60:63], v[48:51], a[144:151], v4
    v_smfmac_f32_16x16x64_bf16 v[64:67], v[48:51], a[224:231], v4
    s_waitcnt lgkmcnt(0)
    v_smfmac_f32_16x16x64_bf16 v[56:59], v[52:55], a[72:79], v4
    v_smfmac_f32_16x16x64_bf16 v[60:63], v[52:55], a[152:159], v4
    v_smfmac_f32_16x16x64_bf16 v[64:67], v[52:55], a[232:239], v4
    ds_read_b128 v[80:83], v6 offset:0
    ds_read_b128 v[84:87], v6 offset:1024
    ds_read_b128 v[88:91], v6 offset:2048
    ds_read_b128 v[92:95], v6 offset:3072
    ds_read_b128 v[96:99], v6 offset:4096
    ds_read_b128 v[100:103], v6 offset:5120
    s_waitcnt vmcnt(0)
    v_mov_b32 v16, 0
    v_mov_b32 v17, 0
    v_mov_b32 v18, 0
    v_mov_b32 v19, 0
    v_mov_b32 v20, 0
    v_mov_b32 v21, 0
    v_mov_b32 v22, 0
    v_mov_b32 v23, 0
    v_mov_b32 v24, 0
    v_mov_b32 v25, 0
    v_mov_b32 v26, 0
    v_mov_b32 v27, 0
    v_mov_b32 v28, 0
    v_mov_b32 v29, 0
    v_mov_b32 v30, 0
    v_mov_b32 v31, 0
    v_mov_b32 v32, 0
    v_mov_b32 v33, 0
    v_mov_b32 v34, 0
    v_mov_b32 v35, 0
    v_mov_b32 v36, 0
    v_mov_b32 v37, 0
    v_mov_b32 v38, 0
    v_mov_b32 v39, 0
    v_mov_b32 v40, 0
    v_mov_b32 v41, 0
    v_mov_b32 v42, 0
    v_mov_b32 v43, 0
    v_mov_b32 v44, 0
    v_mov_b32 v45, 0
    v_mov_b32 v46, 0
    v_mov_b32 v47, 0
    v_mov_b32 v48, 0
    v_mov_b32 v49, 0
    v_mov_b32 v50, 0
    v_mov_b32 v51, 0
    v_mov_b32 v52, 0
    v_mov_b32 v53, 0
    v_mov_b32 v54, 0
    v_mov_b32 v55, 0
    v_permlane32_swap_b32 v56, v60
    v_permlane32_swap_b32 v57, v61
    v_permlane32_swap_b32 v58, v62
    v_permlane32_swap_b32 v59, v63
    v_add_f32 v56, v56, v60
    v_add_f32 v57, v57, v61
    v_add_f32 v58, v58, v62
    v_add_f32 v59, v59, v63
    v_cvt_pk_bf16_f32 v68, v56, v57
    v_cvt_pk_bf16_f32 v69, v58, v59
    v_mov_b32 v60, v64
    v_mov_b32 v61, v65
    v_mov_b32 v62, v66
    v_mov_b32 v63, v67
    v_permlane32_swap_b32 v64, v60
    v_permlane32_swap_b32 v65, v61
    v_permlane32_swap_b32 v66, v62
    v_permlane32_swap_b32 v67, v63
    v_add_f32 v64, v64, v60
    v_add_f32 v65, v65, v61
    v_add_f32 v66, v66, v62
    v_add_f32 v67, v67, v63
    v_cvt_pk_bf16_f32 v70, v64, v65
    v_cvt_pk_bf16_f32 v71, v66, v67
    ds_write_b64 v10, v[68:69]
    ds_write_b64 v9, v[70:71] offset:512
    s_waitcnt lgkmcnt(0)
    s_barrier
    ds_read_b64_tr_b16 v[68:69], v11 offset:0
    ds_read_b64_tr_b16 v[70:71], v11 offset:128
    ds_read_b64_tr_b16 v[72:73], v11 offset:1024
    ds_read_b64_tr_b16 v[74:75], v11 offset:1152
    ds_read_b64_tr_b16 v[76:77], v11 offset:2048
    ds_read_b64_tr_b16 v[78:79], v11 offset:2176
    s_waitcnt lgkmcnt(4)
    v_smfmac_f32_16x16x64_bf16 v[16:19], v[68:71], a[240:247], v4
    v_smfmac_f32_16x16x64_bf16 v[20:23], v[68:71], v[112:119], v4
    v_smfmac_f32_16x16x64_bf16 v[24:27], v[68:71], v[136:143], v4
    v_smfmac_f32_16x16x64_bf16 v[28:31], v[68:71], v[160:167], v4
    s_waitcnt lgkmcnt(2)
    v_smfmac_f32_16x16x64_bf16 v[16:19], v[72:75], a[248:255], v4
    v_smfmac_f32_16x16x64_bf16 v[20:23], v[72:75], v[120:127], v4
    v_smfmac_f32_16x16x64_bf16 v[24:27], v[72:75], v[144:151], v4
    v_smfmac_f32_16x16x64_bf16 v[28:31], v[72:75], v[168:175], v4
    s_waitcnt lgkmcnt(0)
    v_smfmac_f32_16x16x64_bf16 v[16:19], v[76:79], v[104:111], v4
    v_smfmac_f32_16x16x64_bf16 v[20:23], v[76:79], v[128:135], v4
    v_smfmac_f32_16x16x64_bf16 v[24:27], v[76:79], v[152:159], v4
    v_smfmac_f32_16x16x64_bf16 v[28:31], v[76:79], v[176:183], v4
    v_smfmac_f32_16x16x64_bf16 v[32:35], v[68:71], v[184:191], v4
    v_smfmac_f32_16x16x64_bf16 v[36:39], v[68:71], v[208:215], v4
    v_smfmac_f32_16x16x64_bf16 v[40:43], v[68:71], v[232:239], v4
    v_smfmac_f32_16x16x64_bf16 v[44:47], v[68:71], v[80:87], v4
    ds_read_b128 v[80:83], v6 offset:6144
    ds_read_b128 v[84:87], v6 offset:7168
    v_smfmac_f32_16x16x64_bf16 v[32:35], v[72:75], v[192:199], v4
    v_smfmac_f32_16x16x64_bf16 v[36:39], v[72:75], v[216:223], v4
    v_smfmac_f32_16x16x64_bf16 v[40:43], v[72:75], v[240:247], v4
    v_smfmac_f32_16x16x64_bf16 v[44:47], v[72:75], v[88:95], v4
    ds_read_b128 v[88:91], v6 offset:8192
    ds_read_b128 v[92:95], v6 offset:9216
    v_smfmac_f32_16x16x64_bf16 v[32:35], v[76:79], v[200:207], v4
    v_smfmac_f32_16x16x64_bf16 v[36:39], v[76:79], v[224:231], v4
    v_smfmac_f32_16x16x64_bf16 v[40:43], v[76:79], v[248:255], v4
    v_smfmac_f32_16x16x64_bf16 v[44:47], v[76:79], v[96:103], v4
    ds_read_b128 v[96:99], v6 offset:10240
    ds_read_b128 v[100:103], v6 offset:11264
    v_permlane32_swap_b32 v16, v24
    v_permlane32_swap_b32 v17, v25
    v_permlane32_swap_b32 v18, v26
    v_permlane32_swap_b32 v19, v27
    v_add_f32 v16, v16, v24
    v_add_f32 v17, v17, v25
    v_add_f32 v18, v18, v26
    v_add_f32 v19, v19, v27
    v_permlane32_swap_b32 v20, v28
    v_permlane32_swap_b32 v21, v29
    v_permlane32_swap_b32 v22, v30
    v_permlane32_swap_b32 v23, v31
    v_add_f32 v20, v20, v28
    v_add_f32 v21, v21, v29
    v_add_f32 v22, v22, v30
    v_add_f32 v23, v23, v31
    v_cvt_pk_bf16_f32 v56, v16, v17
    v_cvt_pk_bf16_f32 v57, v18, v19
    v_cvt_pk_bf16_f32 v58, v20, v21
    v_cvt_pk_bf16_f32 v59, v22, v23
    s_nop 0
    v_permlane16_swap_b32 v56, v58
    v_permlane16_swap_b32 v57, v59
    v_min_u32 v56, -2, v56
    v_min_u32 v57, -2, v57
    v_min_u32 v58, -2, v58
    v_min_u32 v59, -2, v59
    buffer_store_dwordx4 v[56:59], v14, s[8:11], s43 offen sc1
    s_waitcnt lgkmcnt(4)
    v_smfmac_f32_16x16x64_bf16 v[48:51], v[68:71], v[80:87], v4
    ds_read_b128 v[80:83], v6 offset:12288
    ds_read_b128 v[84:87], v6 offset:13312
    s_waitcnt lgkmcnt(4)
    v_smfmac_f32_16x16x64_bf16 v[48:51], v[72:75], v[88:95], v4
    ds_read_b128 v[88:91], v6 offset:14336
    ds_read_b128 v[92:95], v6 offset:15360
    s_waitcnt lgkmcnt(4)
    v_smfmac_f32_16x16x64_bf16 v[48:51], v[76:79], v[96:103], v4
    ds_read_b128 v[96:99], v6 offset:16384
    ds_read_b128 v[100:103], v6 offset:17408
    v_permlane32_swap_b32 v32, v40
    v_permlane32_swap_b32 v33, v41
    v_permlane32_swap_b32 v34, v42
    v_permlane32_swap_b32 v35, v43
    v_add_f32 v32, v32, v40
    v_add_f32 v33, v33, v41
    v_add_f32 v34, v34, v42
    v_add_f32 v35, v35, v43
    v_permlane32_swap_b32 v36, v44
    v_permlane32_swap_b32 v37, v45
    v_permlane32_swap_b32 v38, v46
    v_permlane32_swap_b32 v39, v47
    v_add_f32 v36, v36, v44
    v_add_f32 v37, v37, v45
    v_add_f32 v38, v38, v46
    v_add_f32 v39, v39, v47
    v_cvt_pk_bf16_f32 v60, v32, v33
    v_cvt_pk_bf16_f32 v61, v34, v35
    v_cvt_pk_bf16_f32 v62, v36, v37
    v_cvt_pk_bf16_f32 v63, v38, v39
    s_nop 0
    v_permlane16_swap_b32 v60, v62
    v_permlane16_swap_b32 v61, v63
    v_min_u32 v60, -2, v60
    v_min_u32 v61, -2, v61
    v_min_u32 v62, -2, v62
    v_min_u32 v63, -2, v63
    s_add_u32 s49, s43, 32768
    buffer_store_dwordx4 v[60:63], v14, s[8:11], s49 offen sc1
    s_waitcnt lgkmcnt(4)
    v_smfmac_f32_16x16x64_bf16 v[52:55], v[68:71], v[80:87], v4
    s_waitcnt lgkmcnt(2)
    v_smfmac_f32_16x16x64_bf16 v[52:55], v[72:75], v[88:95], v4
    s_waitcnt lgkmcnt(0)
    v_smfmac_f32_16x16x64_bf16 v[52:55], v[76:79], v[96:103], v4
    s_nop 11
    v_permlane32_swap_b32 v48, v52
    v_permlane32_swap_b32 v49, v53
    v_permlane32_swap_b32 v50, v54
    v_permlane32_swap_b32 v51, v55
    v_add_f32 v48, v48, v52
    v_add_f32 v49, v49, v53
    v_add_f32 v50, v50, v54
    v_add_f32 v51, v51, v55
    v_cvt_pk_bf16_f32 v64, v48, v49
    v_cvt_pk_bf16_f32 v65, v50, v51
    v_mov_b32 v66, v64
    v_mov_b32 v67, v65
    s_nop 0
    v_permlane16_swap_b32 v64, v66
    v_permlane16_swap_b32 v65, v67
    v_min_u32 v64, -2, v64
    v_min_u32 v65, -2, v65
    v_min_u32 v66, -2, v66
    v_min_u32 v67, -2, v67
    buffer_store_dwordx4 v[64:67], v15, s[8:11], s43 offen sc1
    s_add_u32 s40, s40, 1
    s_add_u32 s43, s43, 327680
    s_add_u32 s47, s47, 40960
    s_add_u32 s45, s45, 8192
    s_add_u32 s42, s42, 4096
    s_cmp_lt_u32 s40, 64
    s_cbranch_scc1 chain1_kernel_v_step
    s_branch chain1_kernel_end
chain1_kernel_roleR:
    s_sub_u32 s44, s2, 64
    v_lshlrev_b32 v5, 4, v1
    s_lshl_b32 s24, s44, 15
    s_lshl_b32 s25, s3, 13
    s_add_u32 s24, s24, s25
    v_add_u32 v6, s24, v5
    v_add_u32 v7, 4096, v6
    s_lshl_b32 s24, s3, 12
    v_add_u32 v8, s24, v5
    s_lshl_b32 s24, s3, 10
    s_add_u32 s24, s24, 16384
    v_add_u32 v9, s24, v5
    s_lshl_b32 s24, s44, 13
    s_lshl_b32 s25, s3, 11
    s_add_u32 s24, s24, s25
    v_add_u32 v10, s24, v5
    v_and_b32 v204, 7, v2
    v_mul_u32_u24 v11, 80, v204
    v_lshl_add_u32 v11, v3, 4, v11
    s_mul_i32 s24, s3, 640
    v_add_u32 v11, s24, v11
    v_add_u32 v204, 8192, v5
    v_cmp_gt_u32 vcc, 8, v2
    s_nop 1
    v_cndmask_b32 v11, v204, v11, vcc
    v_and_b32 v204, 7, v2
    v_mul_u32_u24 v12, 80, v204
    v_lshrrev_b32 v204, 3, v2
    v_lshl_add_u32 v12, v204, 5, v12
    v_mul_u32_u24 v13, 10240, v3
    v_lshl_add_u32 v13, v2, 4, v13
    s_lshl_b32 s24, s44, 8
    v_add_u32 v13, s24, v13
    v_mov_b32 v204, 2146435072
    v_cmp_gt_u32 vcc, 1, v3
    s_nop 1
    v_cndmask_b32 v13, v204, v13, vcc
    v_cmp_le_u32 s[50:51], 8, v2
    s_and_b32 s25, s44, 15
    s_lshr_b32 s25, s25, 2
    s_sub_u32 s26, s44, 32
    s_lshr_b32 s26, s26, 1
    s_cmp_ge_u32 s44, 32
    s_cselect_b32 s25, s26, s25
    s_mul_i32 s24, s25, 16
    v_add_u32 v120, s24, v1
    v_lshlrev_b32 v120, 7, v120
    v_mov_b32 v204, 2146435072
    v_cmp_le_u32 vcc, 16, v1
    s_nop 1
    v_cndmask_b32 v120, v120, v204, vcc
    s_and_b32 s24, s44, 7
    s_mul_i32 s25, s3, 8
    s_add_u32 s24, s24, s25
    s_lshl_b32 s24, s24, 7
    v_mov_b32 v125, s24
    s_lshl_b32 s24, s3, 3
    v_and_b32 v204, 7, v1
    v_add_u32 v121, s24, v204
    v_add_u32 v204, 32, v121
    v_cmp_le_u32 vcc, 8, v1
    s_nop 1
    v_cndmask_b32 v121, v121, v204, vcc
    v_lshlrev_b32 v121, 7, v121
    v_mov_b32 v204, 2146435072
    v_cmp_le_u32 vcc, 8, v1
    s_nop 1
    v_cndmask_b32 v121, v121, v204, vcc
    v_mov_b32 v122, 12288
    v_mov_b32 v123, 0
    ds_write_b32 v122, v123
    v_mov_b32 v123, 1
    s_waitcnt lgkmcnt(0)
    s_barrier
    s_mov_b32 s45, 154238976
    s_mov_b32 s46, 151584768
    s_mov_b32 s40, 0
    s_mov_b32 s54, 10
    s_mov_b32 s41, 184549376
    s_mov_b32 s43, 141074432
    s_mov_b32 s42, 117440512
    s_mov_b32 s47, 138452992
    v_and_b32 v252, 7, v1
    v_lshlrev_b32 v252, 7, v252
    s_lshl_b32 s24, s3, 10
    s_add_u32 s24, s24, 151572480
    v_add_u32 v252, s24, v252
    s_mov_b32 s62, -1
    s_mov_b32 s63, 1
    s_cmp_ge_i32 s62, s63
    s_cbranch_scc1 chain1_kernel_r_en0_ok
    s_mov_b32 s61, 0
chain1_kernel_r_en0:
    buffer_load_dword v253, v252, s[8:11], 0 offen sc1
    s_waitcnt vmcnt(0)
    v_readlane_b32 s62, v253, 0
    v_readlane_b32 s24, v253, 1
    s_min_i32 s62, s62, s24
    v_readlane_b32 s24, v253, 2
    s_min_i32 s62, s62, s24
    v_readlane_b32 s24, v253, 3
    s_min_i32 s62, s62, s24
    v_readlane_b32 s24, v253, 4
    s_min_i32 s62, s62, s24
    v_readlane_b32 s24, v253, 5
    s_min_i32 s62, s62, s24
    v_readlane_b32 s24, v253, 6
    s_min_i32 s62, s62, s24
    v_readlane_b32 s24, v253, 7
    s_min_i32 s62, s62, s24
    s_cmp_ge_i32 s62, s63
    s_cbranch_scc1 chain1_kernel_r_en0_ok
    s_add_u32 s61, s61, 1
    s_cmp_ge_u32 s61, s60
    s_cbranch_scc1 chain1_kernel_r_en0_to
    s_sleep 2
    s_branch chain1_kernel_r_en0
chain1_kernel_r_en0_to:
    s_mov_b32 s60, 1
chain1_kernel_r_en0_ok:
    buffer_load_dwordx4 v[48:51], v6, s[8:11], s41 offen offset:0 sc1
    buffer_load_dwordx4 v[52:55], v6, s[8:11], s41 offen offset:1024 sc1
    buffer_load_dwordx4 v[56:59], v6, s[8:11], s41 offen offset:2048 sc1
    buffer_load_dwordx4 v[60:63], v6, s[8:11], s41 offen offset:3072 sc1
    buffer_load_dwordx4 v[64:67], v7, s[8:11], s41 offen offset:0 sc1
    buffer_load_dwordx4 v[68:71], v7, s[8:11], s41 offen offset:1024 sc1
    buffer_load_dwordx4 v[72:75], v7, s[8:11], s41 offen offset:2048 sc1
    buffer_load_dwordx4 v[76:79], v7, s[8:11], s41 offen offset:3072 sc1
    s_add_u32 s41, s41, 1310720
    s_waitcnt vmcnt(0)
chain1_kernel_r_step:
    s_waitcnt vmcnt(0)
    v_mov_b32 v16, v48
    v_mov_b32 v17, v49
    v_mov_b32 v18, v50
    v_mov_b32 v19, v51
    v_mov_b32 v20, v52
    v_mov_b32 v21, v53
    v_mov_b32 v22, v54
    v_mov_b32 v23, v55
    v_mov_b32 v24, v56
    v_mov_b32 v25, v57
    v_mov_b32 v26, v58
    v_mov_b32 v27, v59
    v_mov_b32 v28, v60
    v_mov_b32 v29, v61
    v_mov_b32 v30, v62
    v_mov_b32 v31, v63
    v_mov_b32 v32, v64
    v_mov_b32 v33, v65
    v_mov_b32 v34, v66
    v_mov_b32 v35, v67
    v_mov_b32 v36, v68
    v_mov_b32 v37, v69
    v_mov_b32 v38, v70
    v_mov_b32 v39, v71
    v_mov_b32 v40, v72
    v_mov_b32 v41, v73
    v_mov_b32 v42, v74
    v_mov_b32 v43, v75
    v_mov_b32 v44, v76
    v_mov_b32 v45, v77
    v_mov_b32 v46, v78
    v_mov_b32 v47, v79
    s_sleep 10
    s_mov_b64 exec, 1
    s_mov_b32 s61, 0
    v_mov_b32 v117, 0
    buffer_atomic_add v117, v125, s[8:11], s45 offen sc0
    s_sleep 2
    v_mov_b32 v118, 0
    buffer_atomic_add v118, v125, s[8:11], s45 offen sc0
    s_sleep 2
    v_mov_b32 v119, 0
    buffer_atomic_add v119, v125, s[8:11], s45 offen sc0
    s_sleep 2
chain1_kernel_r_pr:
    v_mov_b32 v116, 0
    buffer_atomic_add v116, v125, s[8:11], s45 offen sc0
    s_waitcnt vmcnt(3)
    v_cmp_le_i32 vcc, 7, v117
    s_add_u32 s61, s61, 1
    s_cbranch_vccnz chain1_kernel_r_pr_out
    s_sleep 2
    v_mov_b32 v117, 0
    buffer_atomic_add v117, v125, s[8:11], s45 offen sc0
    s_waitcnt vmcnt(3)
    v_cmp_le_i32 vcc, 7, v118
    s_add_u32 s61, s61, 1
    s_cbranch_vccnz chain1_kernel_r_pr_out
    s_sleep 2
    v_mov_b32 v118, 0
    buffer_atomic_add v118, v125, s[8:11], s45 offen sc0
    s_waitcnt vmcnt(3)
    v_cmp_le_i32 vcc, 7, v119
    s_add_u32 s61, s61, 1
    s_cbranch_vccnz chain1_kernel_r_pr_out
    s_sleep 2
    v_mov_b32 v119, 0
    buffer_atomic_add v119, v125, s[8:11], s45 offen sc0
    s_waitcnt vmcnt(3)
    v_cmp_le_i32 vcc, 7, v116
    s_add_u32 s61, s61, 1
    s_cbranch_vccnz chain1_kernel_r_pr_out
    s_sleep 2
    s_cmp_ge_u32 s61, s60
    s_cbranch_scc0 chain1_kernel_r_pr
    s_mov_b32 s60, 1
chain1_kernel_r_pr_out:
    s_mov_b64 exec, -1
    buffer_load_dwordx4 v[100:103], v10, s[8:11], s42 offen offset:0 sc1
    buffer_load_dwordx4 v[104:107], v10, s[8:11], s42 offen offset:1024 sc1
    buffer_load_dwordx4 v[80:83], v8, s[8:11], s43 offen offset:0 sc1
    buffer_load_dwordx4 v[84:87], v8, s[8:11], s43 offen offset:1024 sc1
    buffer_load_dwordx4 v[88:91], v8, s[8:11], s43 offen offset:2048 sc1
    buffer_load_dwordx4 v[92:95], v8, s[8:11], s43 offen offset:3072 sc1
    buffer_load_dwordx4 v[96:99], v9, s[8:11], s43 offen sc1
    s_waitcnt vmcnt(0)
    v_max3_u32 v204, v80, v81, v82
    v_max3_u32 v204, v204, v83, v84
    v_max3_u32 v204, v204, v85, v86
    v_max3_u32 v204, v204, v87, v88
    v_max3_u32 v204, v204, v89, v90
    v_max3_u32 v204, v204, v91, v92
    v_max3_u32 v204, v204, v93, v94
    v_max3_u32 v204, v204, v95, v96
    v_max3_u32 v204, v204, v97, v98
    v_max3_u32 v204, v204, v99, v100
    v_max3_u32 v204, v204, v101, v102
    v_max3_u32 v204, v204, v103, v104
    v_max3_u32 v204, v204, v105, v106
    v_max_u32 v204, v204, v107
    v_cmp_eq_u32 vcc, -1, v204
    s_cbranch_vccz chain1_kernel_r_p_out
    s_mov_b32 s61, 0
chain1_kernel_r_p:
    buffer_load_dwordx4 v[100:103], v10, s[8:11], s42 offen offset:0 sc1
    buffer_load_dwordx4 v[104:107], v10, s[8:11], s42 offen offset:1024 sc1
    buffer_load_dwordx4 v[80:83], v8, s[8:11], s43 offen offset:0 sc1
    buffer_load_dwordx4 v[84:87], v8, s[8:11], s43 offen offset:1024 sc1
    buffer_load_dwordx4 v[88:91], v8, s[8:11], s43 offen offset:2048 sc1
    buffer_load_dwordx4 v[92:95], v8, s[8:11], s43 offen offset:3072 sc1
    buffer_load_dwordx4 v[96:99], v9, s[8:11], s43 offen sc1
    s_waitcnt vmcnt(0)
    v_max3_u32 v204, v80, v81, v82
    v_max3_u32 v204, v204, v83, v84
    v_max3_u32 v204, v204, v85, v86
    v_max3_u32 v204, v204, v87, v88
    v_max3_u32 v204, v204, v89, v90
    v_max3_u32 v204, v204, v91, v92
    v_max3_u32 v204, v204, v93, v94
    v_max3_u32 v204, v204, v95, v96
    v_max3_u32 v204, v204, v97, v98
    v_max3_u32 v204, v204, v99, v100
    v_max3_u32 v204, v204, v101, v102
    v_max3_u32 v204, v204, v103, v104
    v_max3_u32 v204, v204, v105, v106
    v_max_u32 v204, v204, v107
    v_cmp_eq_u32 vcc, -1, v204
    s_add_u32 s61, s61, 1
    s_cbranch_vccz chain1_kernel_r_p_out
    s_cmp_ge_u32 s61, s60
    s_cbranch_scc1 chain1_kernel_r_p_to
    s_sleep 1
    s_branch chain1_kernel_r_p
chain1_kernel_r_p_to:
    s_mov_b32 s60, 1
chain1_kernel_r_p_out:
    s_mov_b64 exec, 1
    ds_add_rtn_u32 v124, v122, v123
    s_mov_b64 exec, -1
    v_mfma_f32_16x16x32_bf16 v[108:111], v[100:103], v[96:99], 0
    v_mfma_f32_16x16x32_bf16 v[112:115], v[104:107], v[96:99], 0
    v_mfma_f32_16x16x32_bf16 v[108:111], v[16:19], v[80:83], v[108:111]
    v_mfma_f32_16x16x32_bf16 v[112:115], v[20:23], v[80:83], v[112:115]
    s_waitcnt lgkmcnt(0)
    v_readfirstlane_b32 s24, v124
    s_and_b32 s24, s24, 3
    s_cmp_eq_u32 s24, 3
    s_cbranch_scc0 chain1_kernel_nh7
    buffer_atomic_add v123, v120, s[8:11], s46 offen
chain1_kernel_nh7:
    v_mfma_f32_16x16x32_bf16 v[108:111], v[24:27], v[84:87], v[108:111]
    v_mfma_f32_16x16x32_bf16 v[112:115], v[28:31], v[84:87], v[112:115]
    v_mfma_f32_16x16x32_bf16 v[108:111], v[32:35], v[88:91], v[108:111]
    v_mfma_f32_16x16x32_bf16 v[112:115], v[36:39], v[88:91], v[112:115]
    v_mfma_f32_16x16x32_bf16 v[108:111], v[40:43], v[92:95], v[108:111]
    v_mfma_f32_16x16x32_bf16 v[112:115], v[44:47], v[92:95], v[112:115]
    s_and_b32 s24, s40, 1
    s_mul_i32 s24, s24, 2560
    v_add_u32 v14, s24, v11
    v_add_u32 v15, s24, v12
    s_nop 3
    v_cndmask_b32 v108, v108, v112, s[50:51]
    v_cndmask_b32 v109, v109, v113, s[50:51]
    v_cndmask_b32 v110, v110, v114, s[50:51]
    v_cndmask_b32 v111, v111, v115, s[50:51]
    v_add_f32 v108, v108, v108 row_ror:8 row_mask:0xf bank_mask:0xf
    v_add_f32 v109, v109, v109 row_ror:8 row_mask:0xf bank_mask:0xf
    v_add_f32 v110, v110, v110 row_ror:8 row_mask:0xf bank_mask:0xf
    v_add_f32 v111, v111, v111 row_ror:8 row_mask:0xf bank_mask:0xf
    ds_write_b128 v14, v[108:111]
    s_waitcnt lgkmcnt(0)
    s_barrier
    s_cmp_eq_u32 s3, 0
    s_cbranch_scc0 chain1_kernel_np8
    ds_read_b128 v[220:223], v15 offset:0
    ds_read_b128 v[224:227], v15 offset:16
    ds_read_b128 v[228:231], v15 offset:640
    ds_read_b128 v[232:235], v15 offset:656
    ds_read_b128 v[236:239], v15 offset:1280
    ds_read_b128 v[240:243], v15 offset:1296
    ds_read_b128 v[244:247], v15 offset:1920
    ds_read_b128 v[248:251], v15 offset:1936
    s_waitcnt lgkmcnt(4)
    v_pk_add_f32 v[220:221], v[220:221], v[228:229]
    v_pk_add_f32 v[222:223], v[222:223], v[230:231]
    v_pk_add_f32 v[224:225], v[224:225], v[232:233]
    v_pk_add_f32 v[226:227], v[226:227], v[234:235]
    s_waitcnt lgkmcnt(0)
    v_pk_add_f32 v[236:237], v[236:237], v[244:245]
    v_pk_add_f32 v[238:239], v[238:239], v[246:247]
    v_pk_add_f32 v[240:241], v[240:241], v[248:249]
    v_pk_add_f32 v[242:243], v[242:243], v[250:251]
    v_pk_add_f32 v[220:221], v[220:221], v[236:237]
    v_pk_add_f32 v[222:223], v[222:223], v[238:239]
    v_pk_add_f32 v[224:225], v[224:225], v[240:241]
    v_pk_add_f32 v[226:227], v[226:227], v[242:243]
    v_cvt_pk_bf16_f32 v228, v220, v221
    v_cvt_pk_bf16_f32 v229, v222, v223
    v_cvt_pk_bf16_f32 v230, v224, v225
    v_cvt_pk_bf16_f32 v231, v226, v227
    v_min_u32 v228, -2, v228
    v_min_u32 v229, -2, v229
    v_min_u32 v230, -2, v230
    v_min_u32 v231, -2, v231
    buffer_store_dwordx4 v[228:231], v13, s[8:11], s47 offen sc1
chain1_kernel_np8:
    s_add_u32 s63, s40, 2
    s_min_u32 s63, s63, 64
    s_sleep 20
    s_cmp_ge_i32 s62, s63
    s_cbranch_scc1 chain1_kernel_r_en_ok
    s_mov_b32 s61, 0
chain1_kernel_r_en:
    buffer_load_dword v253, v252, s[8:11], 0 offen sc1
    s_waitcnt vmcnt(0)
    v_readlane_b32 s62, v253, 0
    v_readlane_b32 s24, v253, 1
    s_min_i32 s62, s62, s24
    v_readlane_b32 s24, v253, 2
    s_min_i32 s62, s62, s24
    v_readlane_b32 s24, v253, 3
    s_min_i32 s62, s62, s24
    v_readlane_b32 s24, v253, 4
    s_min_i32 s62, s62, s24
    v_readlane_b32 s24, v253, 5
    s_min_i32 s62, s62, s24
    v_readlane_b32 s24, v253, 6
    s_min_i32 s62, s62, s24
    v_readlane_b32 s24, v253, 7
    s_min_i32 s62, s62, s24
    s_cmp_ge_i32 s62, s63
    s_cbranch_scc1 chain1_kernel_r_en_ok
    s_add_u32 s61, s61, 1
    s_cmp_ge_u32 s61, s60
    s_cbranch_scc1 chain1_kernel_r_en_to
    s_sleep 2
    s_branch chain1_kernel_r_en
chain1_kernel_r_en_to:
    s_mov_b32 s60, 1
chain1_kernel_r_en_ok:
    buffer_load_dwordx4 v[48:51], v6, s[8:11], s41 offen offset:0 sc1
    buffer_load_dwordx4 v[52:55], v6, s[8:11], s41 offen offset:1024 sc1
    buffer_load_dwordx4 v[56:59], v6, s[8:11], s41 offen offset:2048 sc1
    buffer_load_dwordx4 v[60:63], v6, s[8:11], s41 offen offset:3072 sc1
    buffer_load_dwordx4 v[64:67], v7, s[8:11], s41 offen offset:0 sc1
    buffer_load_dwordx4 v[68:71], v7, s[8:11], s41 offen offset:1024 sc1
    buffer_load_dwordx4 v[72:75], v7, s[8:11], s41 offen offset:2048 sc1
    buffer_load_dwordx4 v[76:79], v7, s[8:11], s41 offen offset:3072 sc1
    s_add_u32 s41, s41, 1310720
    s_add_u32 s40, s40, 1
    s_add_u32 s42, s42, 327680
    s_add_u32 s43, s43, 81920
    s_add_u32 s47, s47, 40960
    s_add_u32 s45, s45, 4096
    s_add_u32 s46, s46, 8192
    s_cmp_lt_u32 s40, 64
    s_cbranch_scc1 chain1_kernel_r_step
    s_branch chain1_kernel_end
chain1_kernel_roleP:
    s_sub_u32 s44, s2, 104
    s_lshr_b32 s46, s44, 5
    s_and_b32 s44, s44, 31
    s_load_dwordx2 s[6:7], s[0:1], 40
    s_load_dwordx2 s[24:25], s[0:1], 48
    s_load_dwordx2 s[26:27], s[0:1], 56
    s_waitcnt lgkmcnt(0)
    s_cmp_eq_u32 s46, 1
    s_cselect_b32 s6, s24, s6
    s_cselect_b32 s7, s25, s7
    s_mov_b32 s43, 67108864
    s_cselect_b32 s43, 92274688, s43
    s_cmp_eq_u32 s46, 2
    s_cselect_b32 s6, s26, s6
    s_cselect_b32 s7, s27, s7
    s_cselect_b32 s43, 33554432, s43
    s_mov_b32 s12, s6
    s_mov_b32 s13, s7
    s_mov_b32 s14, 7864320
    s_mov_b32 s15, 0x00020000
    v_add_u32 v16, 0, v0
    s_mov_b32 s24, 683
    v_mul_lo_u32 v17, v16, s24
    v_lshrrev_b32 v17, 14, v17
    v_mul_u32_u24 v18, 24, v17
    v_sub_u32 v18, v16, v18
    s_mov_b32 s24, 12288
    v_mul_lo_u32 v4, v17, s24
    v_lshl_add_u32 v4, v18, 4, v4
    v_mul_u32_u24 v10, 400, v17
    v_lshl_add_u32 v10, v18, 4, v10
    v_add_u32 v10, 81920, v10
    v_add_u32 v16, 256, v0
    s_mov_b32 s24, 683
    v_mul_lo_u32 v17, v16, s24
    v_lshrrev_b32 v17, 14, v17
    v_mul_u32_u24 v18, 24, v17
    v_sub_u32 v18, v16, v18
    s_mov_b32 s24, 12288
    v_mul_lo_u32 v5, v17, s24
    v_lshl_add_u32 v5, v18, 4, v5
    v_mul_u32_u24 v11, 400, v17
    v_lshl_add_u32 v11, v18, 4, v11
    v_add_u32 v11, 81920, v11
    v_add_u32 v16, 512, v0
    s_mov_b32 s24, 683
    v_mul_lo_u32 v17, v16, s24
    v_lshrrev_b32 v17, 14, v17
    v_mul_u32_u24 v18, 24, v17
    v_sub_u32 v18, v16, v18
    s_mov_b32 s24, 12288
    v_mul_lo_u32 v6, v17, s24
    v_lshl_add_u32 v6, v18, 4, v6
    v_mul_u32_u24 v12, 400, v17
    v_lshl_add_u32 v12, v18, 4, v12
    v_add_u32 v12, 81920, v12
    v_add_u32 v16, 768, v0
    s_mov_b32 s24, 683
    v_mul_lo_u32 v17, v16, s24
    v_lshrrev_b32 v17, 14, v17
    v_mul_u32_u24 v18, 24, v17
    v_sub_u32 v18, v16, v18
    s_mov_b32 s24, 12288
    v_mul_lo_u32 v7, v17, s24
    v_lshl_add_u32 v7, v18, 4, v7
    v_mul_u32_u24 v13, 400, v17
    v_lshl_add_u32 v13, v18, 4, v13
    v_add_u32 v13, 81920, v13
    v_add_u32 v16, 1024, v0
    s_mov_b32 s24, 683
    v_mul_lo_u32 v17, v16, s24
    v_lshrrev_b32 v17, 14, v17
    v_mul_u32_u24 v18, 24, v17
    v_sub_u32 v18, v16, v18
    s_mov_b32 s24, 12288
    v_mul_lo_u32 v8, v17, s24
    v_lshl_add_u32 v8, v18, 4, v8
    v_mul_u32_u24 v14, 400, v17
    v_lshl_add_u32 v14, v18, 4, v14
    v_add_u32 v14, 81920, v14
    v_add_u32 v16, 1280, v0
    s_mov_b32 s24, 683
    v_mul_lo_u32 v17, v16, s24
    v_lshrrev_b32 v17, 14, v17
    v_mul_u32_u24 v18, 24, v17
    v_sub_u32 v18, v16, v18
    s_mov_b32 s24, 12288
    v_mul_lo_u32 v9, v17, s24
    v_lshl_add_u32 v9, v18, 4, v9
    v_mul_u32_u24 v15, 400, v17
    v_lshl_add_u32 v15, v18, 4, v15
    v_add_u32 v15, 81920, v15
    v_lshrrev_b32 v16, 2, v2
    v_lshl_add_u32 v16, v3, 3, v16
    v_mul_u32_u24 v0, 400, v16
    v_and_b32 v16, 3, v2
    v_lshl_add_u32 v0, v16, 3, v0
    s_mul_i32 s24, s3, 96
    s_add_u32 s24, s24, 81920
    v_add_u32 v0, s24, v0
    v_lshlrev_b32 v16, 4, v1
    s_mul_i32 s24, s3, 10240
    v_add_u32 v17, s24, v16
    v_add_u32 v18, 4096, v17
    v_add_u32 v19, 8192, v17
    s_mov_b32 s41, 59768832
    buffer_load_dwordx4 a[240:243], v17, s[8:11], s41 offen offset:0
    buffer_load_dwordx4 a[244:247], v17, s[8:11], s41 offen offset:1024
    buffer_load_dwordx4 a[248:251], v17, s[8:11], s41 offen offset:2048
    buffer_load_dwordx4 a[252:255], v17, s[8:11], s41 offen offset:3072
    buffer_load_dwordx4 v[20:23], v18, s[8:11], s41 offen offset:0
    buffer_load_dwordx4 v[24:27], v18, s[8:11], s41 offen offset:1024
    buffer_load_dwordx4 v[28:31], v18, s[8:11], s41 offen offset:2048
    buffer_load_dwordx4 v[32:35], v18, s[8:11], s41 offen offset:3072
    buffer_load_dwordx4 v[36:39], v19, s[8:11], s41 offen offset:0
    buffer_load_dwordx4 v[40:43], v19, s[8:11], s41 offen offset:1024
    s_mul_i32 s45, s44, 384
    s_add_u32 s47, s45, 0
    buffer_load_dwordx4 v[56:59], v4, s[12:15], s47 offen
    buffer_load_dwordx4 v[60:63], v5, s[12:15], s47 offen
    buffer_load_dwordx4 v[64:67], v6, s[12:15], s47 offen
    buffer_load_dwordx4 v[68:71], v7, s[12:15], s47 offen
    buffer_load_dwordx4 v[72:75], v8, s[12:15], s47 offen
    buffer_load_dwordx4 v[76:79], v9, s[12:15], s47 offen
    s_add_u32 s47, s45, 786432
    buffer_load_dwordx4 v[80:83], v4, s[12:15], s47 offen
    buffer_load_dwordx4 v[84:87], v5, s[12:15], s47 offen
    buffer_load_dwordx4 v[88:91], v6, s[12:15], s47 offen
    buffer_load_dwordx4 v[92:95], v7, s[12:15], s47 offen
    buffer_load_dwordx4 v[96:99], v8, s[12:15], s47 offen
    buffer_load_dwordx4 v[100:103], v9, s[12:15], s47 offen
    s_add_u32 s47, s45, 1572864
    buffer_load_dwordx4 v[104:107], v4, s[12:15], s47 offen
    buffer_load_dwordx4 v[108:111], v5, s[12:15], s47 offen
    buffer_load_dwordx4 v[112:115], v6, s[12:15], s47 offen
    buffer_load_dwordx4 v[116:119], v7, s[12:15], s47 offen
    buffer_load_dwordx4 v[120:123], v8, s[12:15], s47 offen
    buffer_load_dwordx4 v[124:127], v9, s[12:15], s47 offen
    s_add_u32 s47, s45, 2359296
    buffer_load_dwordx4 v[128:131], v4, s[12:15], s47 offen
    buffer_load_dwordx4 v[132:135], v5, s[12:15], s47 offen
    buffer_load_dwordx4 v[136:139], v6, s[12:15], s47 offen
    buffer_load_dwordx4 v[140:143], v7, s[12:15], s47 offen
    buffer_load_dwordx4 v[144:147], v8, s[12:15], s47 offen
    buffer_load_dwordx4 v[148:151], v9, s[12:15], s47 offen
    s_add_u32 s47, s45, 3145728
    buffer_load_dwordx4 v[152:155], v4, s[12:15], s47 offen
    buffer_load_dwordx4 v[156:159], v5, s[12:15], s47 offen
    buffer_load_dwordx4 v[160:163], v6, s[12:15], s47 offen
    buffer_load_dwordx4 v[164:167], v7, s[12:15], s47 offen
    buffer_load_dwordx4 v[168:171], v8, s[12:15], s47 offen
    buffer_load_dwordx4 v[172:175], v9, s[12:15], s47 offen
    s_add_u32 s47, s45, 3932160
    buffer_load_dwordx4 v[176:179], v4, s[12:15], s47 offen
    buffer_load_dwordx4 v[180:183], v5, s[12:15], s47 offen
    buffer_load_dwordx4 v[184:187], v6, s[12:15], s47 offen
    buffer_load_dwordx4 v[188:191], v7, s[12:15], s47 offen
    buffer_load_dwordx4 v[192:195], v8, s[12:15], s47 offen
    buffer_load_dwordx4 v[196:199], v9, s[12:15], s47 offen
    s_add_u32 s47, s45, 4718592
    buffer_load_dwordx4 v[200:203], v4, s[12:15], s47 offen
    buffer_load_dwordx4 v[204:207], v5, s[12:15], s47 offen
    buffer_load_dwordx4 v[208:211], v6, s[12:15], s47 offen
    buffer_load_dwordx4 v[212:215], v7, s[12:15], s47 offen
    buffer_load_dwordx4 v[216:219], v8, s[12:15], s47 offen
    buffer_load_dwordx4 v[220:223], v9, s[12:15], s47 offen
    s_add_u32 s47, s45, 5505024
    buffer_load_dwordx4 v[224:227], v4, s[12:15], s47 offen
    buffer_load_dwordx4 v[228:231], v5, s[12:15], s47 offen
    buffer_load_dwordx4 v[232:235], v6, s[12:15], s47 offen
    buffer_load_dwordx4 v[236:239], v7, s[12:15], s47 offen
    buffer_load_dwordx4 v[240:243], v8, s[12:15], s47 offen
    buffer_load_dwordx4 v[244:247], v9, s[12:15], s47 offen
    s_waitcnt vmcnt(42)
    ds_write_b128 v10, v[56:59] offset:0
    ds_write_b128 v11, v[60:63] offset:0
    ds_write_b128 v12, v[64:67] offset:0
    ds_write_b128 v13, v[68:71] offset:0
    ds_write_b128 v14, v[72:75] offset:0
    ds_write_b128 v15, v[76:79] offset:0
    ds_write_b128 v17, a[240:243] offset:0
    ds_write_b128 v17, a[244:247] offset:1024
    ds_write_b128 v17, a[248:251] offset:2048
    ds_write_b128 v17, a[252:255] offset:3072
    ds_write_b128 v17, v[20:23] offset:4096
    ds_write_b128 v17, v[24:27] offset:5120
    ds_write_b128 v17, v[28:31] offset:6144
    ds_write_b128 v17, v[32:35] offset:7168
    ds_write_b128 v17, v[36:39] offset:8192
    ds_write_b128 v17, v[40:43] offset:9216
    s_waitcnt lgkmcnt(0)
    s_add_u32 s47, s45, 6291456
    buffer_load_dwordx4 v[56:59], v4, s[12:15], s47 offen
    buffer_load_dwordx4 v[60:63], v5, s[12:15], s47 offen
    buffer_load_dwordx4 v[64:67], v6, s[12:15], s47 offen
    buffer_load_dwordx4 v[68:71], v7, s[12:15], s47 offen
    buffer_load_dwordx4 v[72:75], v8, s[12:15], s47 offen
    buffer_load_dwordx4 v[76:79], v9, s[12:15], s47 offen
    s_barrier
    ds_read_b64_tr_b16 a[0:1], v0 offset:0
    ds_read_b64_tr_b16 a[2:3], v0 offset:1600
    ds_read_b64_tr_b16 a[4:5], v0 offset:12800
    ds_read_b64_tr_b16 a[6:7], v0 offset:14400
    ds_read_b64_tr_b16 a[80:81], v0 offset:32
    ds_read_b64_tr_b16 a[82:83], v0 offset:1632
    ds_read_b64_tr_b16 a[84:85], v0 offset:12832
    ds_read_b64_tr_b16 a[86:87], v0 offset:14432
    ds_read_b64_tr_b16 a[160:161], v0 offset:64
    ds_read_b64_tr_b16 a[162:163], v0 offset:1664
    ds_read_b64_tr_b16 a[164:165], v0 offset:12864
    ds_read_b64_tr_b16 a[166:167], v0 offset:14464
    s_waitcnt vmcnt(42)
    ds_write_b128 v10, v[80:83] offset:25600
    ds_write_b128 v11, v[84:87] offset:25600
    ds_write_b128 v12, v[88:91] offset:25600
    ds_write_b128 v13, v[92:95] offset:25600
    ds_write_b128 v14, v[96:99] offset:25600
    ds_write_b128 v15, v[100:103] offset:25600
    s_waitcnt lgkmcnt(0)
    s_add_u32 s47, s45, 7077888
    buffer_load_dwordx4 v[80:83], v4, s[12:15], s47 offen
    buffer_load_dwordx4 v[84:87], v5, s[12:15], s47 offen
    buffer_load_dwordx4 v[88:91], v6, s[12:15], s47 offen
    buffer_load_dwordx4 v[92:95], v7, s[12:15], s47 offen
    buffer_load_dwordx4 v[96:99], v8, s[12:15], s47 offen
    buffer_load_dwordx4 v[100:103], v9, s[12:15], s47 offen
    s_barrier
    ds_read_b64_tr_b16 a[8:9], v0 offset:25600
    ds_read_b64_tr_b16 a[10:11], v0 offset:27200
    ds_read_b64_tr_b16 a[12:13], v0 offset:38400
    ds_read_b64_tr_b16 a[14:15], v0 offset:40000
    ds_read_b64_tr_b16 a[88:89], v0 offset:25632
    ds_read_b64_tr_b16 a[90:91], v0 offset:27232
    ds_read_b64_tr_b16 a[92:93], v0 offset:38432
    ds_read_b64_tr_b16 a[94:95], v0 offset:40032
    ds_read_b64_tr_b16 a[168:169], v0 offset:25664
    ds_read_b64_tr_b16 a[170:171], v0 offset:27264
    ds_read_b64_tr_b16 a[172:173], v0 offset:38464
    ds_read_b64_tr_b16 a[174:175], v0 offset:40064
    s_waitcnt vmcnt(42)
    ds_write_b128 v10, v[104:107] offset:0
    ds_write_b128 v11, v[108:111] offset:0
    ds_write_b128 v12, v[112:115] offset:0
    ds_write_b128 v13, v[116:119] offset:0
    ds_write_b128 v14, v[120:123] offset:0
    ds_write_b128 v15, v[124:127] offset:0
    s_waitcnt lgkmcnt(0)
    s_barrier
    ds_read_b64_tr_b16 a[16:17], v0 offset:0
    ds_read_b64_tr_b16 a[18:19], v0 offset:1600
    ds_read_b64_tr_b16 a[20:21], v0 offset:12800
    ds_read_b64_tr_b16 a[22:23], v0 offset:14400
    ds_read_b64_tr_b16 a[96:97], v0 offset:32
    ds_read_b64_tr_b16 a[98:99], v0 offset:1632
    ds_read_b64_tr_b16 a[100:101], v0 offset:12832
    ds_read_b64_tr_b16 a[102:103], v0 offset:14432
    ds_read_b64_tr_b16 a[176:177], v0 offset:64
    ds_read_b64_tr_b16 a[178:179], v0 offset:1664
    ds_read_b64_tr_b16 a[180:181], v0 offset:12864
    ds_read_b64_tr_b16 a[182:183], v0 offset:14464
    s_waitcnt vmcnt(36)
    ds_write_b128 v10, v[128:131] offset:25600
    ds_write_b128 v11, v[132:135] offset:25600
    ds_write_b128 v12, v[136:139] offset:25600
    ds_write_b128 v13, v[140:143] offset:25600
    ds_write_b128 v14, v[144:147] offset:25600
    ds_write_b128 v15, v[148:151] offset:25600
    s_waitcnt lgkmcnt(0)
    s_barrier
    ds_read_b64_tr_b16 a[24:25], v0 offset:25600
    ds_read_b64_tr_b16 a[26:27], v0 offset:27200
    ds_read_b64_tr_b16 a[28:29], v0 offset:38400
    ds_read_b64_tr_b16 a[30:31], v0 offset:40000
    ds_read_b64_tr_b16 a[104:105], v0 offset:25632
    ds_read_b64_tr_b16 a[106:107], v0 offset:27232
    ds_read_b64_tr_b16 a[108:109], v0 offset:38432
    ds_read_b64_tr_b16 a[110:111], v0 offset:40032
    ds_read_b64_tr_b16 a[184:185], v0 offset:25664
    ds_read_b64_tr_b16 a[186:187], v0 offset:27264
    ds_read_b64_tr_b16 a[188:189], v0 offset:38464
    ds_read_b64_tr_b16 a[190:191], v0 offset:40064
    s_waitcnt vmcnt(30)
    ds_write_b128 v10, v[152:155] offset:0
    ds_write_b128 v11, v[156:159] offset:0
    ds_write_b128 v12, v[160:163] offset:0
    ds_write_b128 v13, v[164:167] offset:0
    ds_write_b128 v14, v[168:171] offset:0
    ds_write_b128 v15, v[172:175] offset:0
    s_waitcnt lgkmcnt(0)
    s_barrier
    ds_read_b64_tr_b16 a[32:33], v0 offset:0
    ds_read_b64_tr_b16 a[34:35], v0 offset:1600
    ds_read_b64_tr_b16 a[36:37], v0 offset:12800
    ds_read_b64_tr_b16 a[38:39], v0 offset:14400
    ds_read_b64_tr_b16 a[112:113], v0 offset:32
    ds_read_b64_tr_b16 a[114:115], v0 offset:1632
    ds_read_b64_tr_b16 a[116:117], v0 offset:12832
    ds_read_b64_tr_b16 a[118:119], v0 offset:14432
    ds_read_b64_tr_b16 a[192:193], v0 offset:64
    ds_read_b64_tr_b16 a[194:195], v0 offset:1664
    ds_read_b64_tr_b16 a[196:197], v0 offset:12864
    ds_read_b64_tr_b16 a[198:199], v0 offset:14464
    s_waitcnt vmcnt(24)
    ds_write_b128 v10, v[176:179] offset:25600
    ds_write_b128 v11, v[180:183] offset:25600
    ds_write_b128 v12, v[184:187] offset:25600
    ds_write_b128 v13, v[188:191] offset:25600
    ds_write_b128 v14, v[192:195] offset:25600
    ds_write_b128 v15, v[196:199] offset:25600
    s_waitcnt lgkmcnt(0)
    s_barrier
    ds_read_b64_tr_b16 a[40:41], v0 offset:25600
    ds_read_b64_tr_b16 a[42:43], v0 offset:27200
    ds_read_b64_tr_b16 a[44:45], v0 offset:38400
    ds_read_b64_tr_b16 a[46:47], v0 offset:40000
    ds_read_b64_tr_b16 a[120:121], v0 offset:25632
    ds_read_b64_tr_b16 a[122:123], v0 offset:27232
    ds_read_b64_tr_b16 a[124:125], v0 offset:38432
    ds_read_b64_tr_b16 a[126:127], v0 offset:40032
    ds_read_b64_tr_b16 a[200:201], v0 offset:25664
    ds_read_b64_tr_b16 a[202:203], v0 offset:27264
    ds_read_b64_tr_b16 a[204:205], v0 offset:38464
    ds_read_b64_tr_b16 a[206:207], v0 offset:40064
    s_waitcnt vmcnt(18)
    ds_write_b128 v10, v[200:203] offset:0
    ds_write_b128 v11, v[204:207] offset:0
    ds_write_b128 v12, v[208:211] offset:0
    ds_write_b128 v13, v[212:215] offset:0
    ds_write_b128 v14, v[216:219] offset:0
    ds_write_b128 v15, v[220:223] offset:0
    s_waitcnt lgkmcnt(0)
    s_barrier
    ds_read_b64_tr_b16 a[48:49], v0 offset:0
    ds_read_b64_tr_b16 a[50:51], v0 offset:1600
    ds_read_b64_tr_b16 a[52:53], v0 offset:12800
    ds_read_b64_tr_b16 a[54:55], v0 offset:14400
    ds_read_b64_tr_b16 a[128:129], v0 offset:32
    ds_read_b64_tr_b16 a[130:131], v0 offset:1632
    ds_read_b64_tr_b16 a[132:133], v0 offset:12832
    ds_read_b64_tr_b16 a[134:135], v0 offset:14432
    ds_read_b64_tr_b16 a[208:209], v0 offset:64
    ds_read_b64_tr_b16 a[210:211], v0 offset:1664
    ds_read_b64_tr_b16 a[212:213], v0 offset:12864
    ds_read_b64_tr_b16 a[214:215], v0 offset:14464
    s_waitcnt vmcnt(12)
    ds_write_b128 v10, v[224:227] offset:25600
    ds_write_b128 v11, v[228:231] offset:25600
    ds_write_b128 v12, v[232:235] offset:25600
    ds_write_b128 v13, v[236:239] offset:25600
    ds_write_b128 v14, v[240:243] offset:25600
    ds_write_b128 v15, v[244:247] offset:25600
    s_waitcnt lgkmcnt(0)
    s_barrier
    ds_read_b64_tr_b16 a[56:57], v0 offset:25600
    ds_read_b64_tr_b16 a[58:59], v0 offset:27200
    ds_read_b64_tr_b16 a[60:61], v0 offset:38400
    ds_read_b64_tr_b16 a[62:63], v0 offset:40000
    ds_read_b64_tr_b16 a[136:137], v0 offset:25632
    ds_read_b64_tr_b16 a[138:139], v0 offset:27232
    ds_read_b64_tr_b16 a[140:141], v0 offset:38432
    ds_read_b64_tr_b16 a[142:143], v0 offset:40032
    ds_read_b64_tr_b16 a[216:217], v0 offset:25664
    ds_read_b64_tr_b16 a[218:219], v0 offset:27264
    ds_read_b64_tr_b16 a[220:221], v0 offset:38464
    ds_read_b64_tr_b16 a[222:223], v0 offset:40064
    s_waitcnt vmcnt(6)
    ds_write_b128 v10, v[56:59] offset:0
    ds_write_b128 v11, v[60:63] offset:0
    ds_write_b128 v12, v[64:67] offset:0
    ds_write_b128 v13, v[68:71] offset:0
    ds_write_b128 v14, v[72:75] offset:0
    ds_write_b128 v15, v[76:79] offset:0
    s_waitcnt lgkmcnt(0)
    s_barrier
    ds_read_b64_tr_b16 a[64:65], v0 offset:0
    ds_read_b64_tr_b16 a[66:67], v0 offset:1600
    ds_read_b64_tr_b16 a[68:69], v0 offset:12800
    ds_read_b64_tr_b16 a[70:71], v0 offset:14400
    ds_read_b64_tr_b16 a[144:145], v0 offset:32
    ds_read_b64_tr_b16 a[146:147], v0 offset:1632
    ds_read_b64_tr_b16 a[148:149], v0 offset:12832
    ds_read_b64_tr_b16 a[150:151], v0 offset:14432
    ds_read_b64_tr_b16 a[224:225], v0 offset:64
    ds_read_b64_tr_b16 a[226:227], v0 offset:1664
    ds_read_b64_tr_b16 a[228:229], v0 offset:12864
    ds_read_b64_tr_b16 a[230:231], v0 offset:14464
    s_waitcnt vmcnt(0)
    ds_write_b128 v10, v[80:83] offset:25600
    ds_write_b128 v11, v[84:87] offset:25600
    ds_write_b128 v12, v[88:91] offset:25600
    ds_write_b128 v13, v[92:95] offset:25600
    ds_write_b128 v14, v[96:99] offset:25600
    ds_write_b128 v15, v[100:103] offset:25600
    s_waitcnt lgkmcnt(0)
    s_barrier
    ds_read_b64_tr_b16 a[72:73], v0 offset:25600
    ds_read_b64_tr_b16 a[74:75], v0 offset:27200
    ds_read_b64_tr_b16 a[76:77], v0 offset:38400
    ds_read_b64_tr_b16 a[78:79], v0 offset:40000
    ds_read_b64_tr_b16 a[152:153], v0 offset:25632
    ds_read_b64_tr_b16 a[154:155], v0 offset:27232
    ds_read_b64_tr_b16 a[156:157], v0 offset:38432
    ds_read_b64_tr_b16 a[158:159], v0 offset:40032
    ds_read_b64_tr_b16 a[232:233], v0 offset:25664
    ds_read_b64_tr_b16 a[234:235], v0 offset:27264
    ds_read_b64_tr_b16 a[236:237], v0 offset:38464
    ds_read_b64_tr_b16 a[238:239], v0 offset:40064
    v_mov_b32 v6, v17
    v_mov_b32 v7, v18
    v_mov_b32 v8, v19
    v_lshlrev_b32 v5, 4, v1
    s_mul_i32 s24, s44, 12288
    s_mul_i32 s25, s3, 3072
    s_add_u32 s24, s24, s25
    v_add_u32 v11, s24, v5
    s_lshl_b32 s24, s46, 12
    s_lshl_b32 s25, s44, 7
    s_add_u32 s24, s24, s25
    s_add_u32 s24, s24, 151560192
    v_mov_b32 v14, s24
    v_mov_b32 v15, 2146435072
    v_cmp_eq_u32 vcc, 0, v1
    s_nop 1
    v_cndmask_b32 v14, v15, v14, vcc
    s_mov_b32 s40, 0
    s_mov_b32 s42, 0
    s_waitcnt lgkmcnt(0)
chain1_kernel_p_seg:
    v_add_u32 v9, s42, v5
    s_xor_b32 s42, s42, 40960
    v_add_u32 v10, s42, v6
    s_add_u32 s41, s41, 40960
    buffer_load_dwordx4 v[16:19], v6, s[8:11], s41 offen offset:0
    buffer_load_dwordx4 v[20:23], v6, s[8:11], s41 offen offset:1024
    buffer_load_dwordx4 v[24:27], v6, s[8:11], s41 offen offset:2048
    buffer_load_dwordx4 v[28:31], v6, s[8:11], s41 offen offset:3072
    buffer_load_dwordx4 v[32:35], v7, s[8:11], s41 offen offset:0
    buffer_load_dwordx4 v[36:39], v7, s[8:11], s41 offen offset:1024
    buffer_load_dwordx4 v[40:43], v7, s[8:11], s41 offen offset:2048
    buffer_load_dwordx4 v[44:47], v7, s[8:11], s41 offen offset:3072
    buffer_load_dwordx4 v[48:51], v8, s[8:11], s41 offen offset:0
    buffer_load_dwordx4 v[52:55], v8, s[8:11], s41 offen offset:1024
    ds_read_b128 v[56:59], v9 offset:0
    ds_read_b128 v[60:63], v9 offset:20480
    ds_read_b128 v[64:67], v9 offset:1024
    ds_read_b128 v[68:71], v9 offset:21504
    ds_read_b128 v[72:75], v9 offset:2048
    ds_read_b128 v[76:79], v9 offset:22528
    ds_read_b128 v[80:83], v9 offset:3072
    ds_read_b128 v[84:87], v9 offset:23552
    s_waitcnt lgkmcnt(6)
    v_mfma_f32_16x16x32_bf16 v[88:91], a[0:3], v[56:59], 0
    v_mfma_f32_16x16x32_bf16 v[92:95], a[80:83], v[56:59], 0
    v_mfma_f32_16x16x32_bf16 v[96:99], a[160:163], v[56:59], 0
    v_mfma_f32_16x16x32_bf16 v[100:103], a[0:3], v[60:63], 0
    v_mfma_f32_16x16x32_bf16 v[104:107], a[80:83], v[60:63], 0
    v_mfma_f32_16x16x32_bf16 v[108:111], a[160:163], v[60:63], 0
    ds_read_b128 v[56:59], v9 offset:4096
    ds_read_b128 v[60:63], v9 offset:24576
    s_waitcnt lgkmcnt(6)
    v_mfma_f32_16x16x32_bf16 v[88:91], a[4:7], v[64:67], v[88:91]
    v_mfma_f32_16x16x32_bf16 v[92:95], a[84:87], v[64:67], v[92:95]
    v_mfma_f32_16x16x32_bf16 v[96:99], a[164:167], v[64:67], v[96:99]
    v_mfma_f32_16x16x32_bf16 v[100:103], a[4:7], v[68:71], v[100:103]
    v_mfma_f32_16x16x32_bf16 v[104:107], a[84:87], v[68:71], v[104:107]
    v_mfma_f32_16x16x32_bf16 v[108:111], a[164:167], v[68:71], v[108:111]
    ds_read_b128 v[64:67], v9 offset:5120
    ds_read_b128 v[68:71], v9 offset:25600
    s_waitcnt lgkmcnt(6)
    v_mfma_f32_16x16x32_bf16 v[88:91], a[8:11], v[72:75], v[88:91]
    v_mfma_f32_16x16x32_bf16 v[92:95], a[88:91], v[72:75], v[92:95]
    v_mfma_f32_16x16x32_bf16 v[96:99], a[168:171], v[72:75], v[96:99]
    v_mfma_f32_16x16x32_bf16 v[100:103], a[8:11], v[76:79], v[100:103]
    v_mfma_f32_16x16x32_bf16 v[104:107], a[88:91], v[76:79], v[104:107]
    v_mfma_f32_16x16x32_bf16 v[108:111], a[168:171], v[76:79], v[108:111]
    ds_read_b128 v[72:75], v9 offset:6144
    ds_read_b128 v[76:79], v9 offset:26624
    s_waitcnt lgkmcnt(6)
    v_mfma_f32_16x16x32_bf16 v[88:91], a[12:15], v[80:83], v[88:91]
    v_mfma_f32_16x16x32_bf16 v[92:95], a[92:95], v[80:83], v[92:95]
    v_mfma_f32_16x16x32_bf16 v[96:99], a[172:175], v[80:83], v[96:99]
    v_mfma_f32_16x16x32_bf16 v[100:103], a[12:15], v[84:87], v[100:103]
    v_mfma_f32_16x16x32_bf16 v[104:107], a[92:95], v[84:87], v[104:107]
    v_mfma_f32_16x16x32_bf16 v[108:111], a[172:175], v[84:87], v[108:111]
    ds_read_b128 v[80:83], v9 offset:7168
    ds_read_b128 v[84:87], v9 offset:27648
    s_waitcnt lgkmcnt(6)
    v_mfma_f32_16x16x32_bf16 v[88:91], a[16:19], v[56:59], v[88:91]
    v_mfma_f32_16x16x32_bf16 v[92:95], a[96:99], v[56:59], v[92:95]
    v_mfma_f32_16x16x32_bf16 v[96:99], a[176:179], v[56:59], v[96:99]
    v_mfma_f32_16x16x32_bf16 v[100:103], a[16:19], v[60:63], v[100:103]
    v_mfma_f32_16x16x32_bf16 v[104:107], a[96:99], v[60:63], v[104:107]
    v_mfma_f32_16x16x32_bf16 v[108:111], a[176:179], v[60:63], v[108:111]
    ds_read_b128 v[56:59], v9 offset:8192
    ds_read_b128 v[60:63], v9 offset:28672
    s_waitcnt lgkmcnt(6)
    v_mfma_f32_16x16x32_bf16 v[88:91], a[20:23], v[64:67], v[88:91]
    v_mfma_f32_16x16x32_bf16 v[92:95], a[100:103], v[64:67], v[92:95]
    v_mfma_f32_16x16x32_bf16 v[96:99], a[180:183], v[64:67], v[96:99]
    v_mfma_f32_16x16x32_bf16 v[100:103], a[20:23], v[68:71], v[100:103]
    v_mfma_f32_16x16x32_bf16 v[104:107], a[100:103], v[68:71], v[104:107]
    v_mfma_f32_16x16x32_bf16 v[108:111], a[180:183], v[68:71], v[108:111]
    ds_read_b128 v[64:67], v9 offset:9216
    ds_read_b128 v[68:71], v9 offset:29696
    s_waitcnt lgkmcnt(6)
    v_mfma_f32_16x16x32_bf16 v[88:91], a[24:27], v[72:75], v[88:91]
    v_mfma_f32_16x16x32_bf16 v[92:95], a[104:107], v[72:75], v[92:95]
    v_mfma_f32_16x16x32_bf16 v[96:99], a[184:187], v[72:75], v[96:99]
    v_mfma_f32_16x16x32_bf16 v[100:103], a[24:27], v[76:79], v[100:103]
    v_mfma_f32_16x16x32_bf16 v[104:107], a[104:107], v[76:79], v[104:107]
    v_mfma_f32_16x16x32_bf16 v[108:111], a[184:187], v[76:79], v[108:111]
    ds_read_b128 v[72:75], v9 offset:10240
    ds_read_b128 v[76:79], v9 offset:30720
    s_waitcnt lgkmcnt(6)
    v_mfma_f32_16x16x32_bf16 v[88:91], a[28:31], v[80:83], v[88:91]
    v_mfma_f32_16x16x32_bf16 v[92:95], a[108:111], v[80:83], v[92:95]
    v_mfma_f32_16x16x32_bf16 v[96:99], a[188:191], v[80:83], v[96:99]
    v_mfma_f32_16x16x32_bf16 v[100:103], a[28:31], v[84:87], v[100:103]
    v_mfma_f32_16x16x32_bf16 v[104:107], a[108:111], v[84:87], v[104:107]
    v_mfma_f32_16x16x32_bf16 v[108:111], a[188:191], v[84:87], v[108:111]
    ds_read_b128 v[80:83], v9 offset:11264
    ds_read_b128 v[84:87], v9 offset:31744
    s_waitcnt lgkmcnt(6)
    v_mfma_f32_16x16x32_bf16 v[88:91], a[32:35], v[56:59], v[88:91]
    v_mfma_f32_16x16x32_bf16 v[92:95], a[112:115], v[56:59], v[92:95]
    v_mfma_f32_16x16x32_bf16 v[96:99], a[192:195], v[56:59], v[96:99]
    v_mfma_f32_16x16x32_bf16 v[100:103], a[32:35], v[60:63], v[100:103]
    v_mfma_f32_16x16x32_bf16 v[104:107], a[112:115], v[60:63], v[104:107]
    v_mfma_f32_16x16x32_bf16 v[108:111], a[192:195], v[60:63], v[108:111]
    ds_read_b128 v[56:59], v9 offset:12288
    ds_read_b128 v[60:63], v9 offset:32768
    s_waitcnt lgkmcnt(6)
    v_mfma_f32_16x16x32_bf16 v[88:91], a[36:39], v[64:67], v[88:91]
    v_mfma_f32_16x16x32_bf16 v[92:95], a[116:119], v[64:67], v[92:95]
    v_mfma_f32_16x16x32_bf16 v[96:99], a[196:199], v[64:67], v[96:99]
    v_mfma_f32_16x16x32_bf16 v[100:103], a[36:39], v[68:71], v[100:103]
    v_mfma_f32_16x16x32_bf16 v[104:107], a[116:119], v[68:71], v[104:107]
    v_mfma_f32_16x16x32_bf16 v[108:111], a[196:199], v[68:71], v[108:111]
    s_waitcnt vmcnt(10)
    s_barrier
    s_cmp_eq_u32 s3, 0
    s_cbranch_scc0 chain1_kernel_fp9
    v_mov_b32 v15, s40
    buffer_store_dword v15, v14, s[8:11], 0 offen sc1
chain1_kernel_fp9:
    ds_read_b128 v[64:67], v9 offset:13312
    ds_read_b128 v[68:71], v9 offset:33792
    s_waitcnt lgkmcnt(6)
    v_mfma_f32_16x16x32_bf16 v[88:91], a[40:43], v[72:75], v[88:91]
    v_mfma_f32_16x16x32_bf16 v[92:95], a[120:123], v[72:75], v[92:95]
    v_mfma_f32_16x16x32_bf16 v[96:99], a[200:203], v[72:75], v[96:99]
    v_mfma_f32_16x16x32_bf16 v[100:103], a[40:43], v[76:79], v[100:103]
    v_mfma_f32_16x16x32_bf16 v[104:107], a[120:123], v[76:79], v[104:107]
    v_mfma_f32_16x16x32_bf16 v[108:111], a[200:203], v[76:79], v[108:111]
    ds_read_b128 v[72:75], v9 offset:14336
    ds_read_b128 v[76:79], v9 offset:34816
    s_waitcnt lgkmcnt(6)
    v_mfma_f32_16x16x32_bf16 v[88:91], a[44:47], v[80:83], v[88:91]
    v_mfma_f32_16x16x32_bf16 v[92:95], a[124:127], v[80:83], v[92:95]
    v_mfma_f32_16x16x32_bf16 v[96:99], a[204:207], v[80:83], v[96:99]
    v_mfma_f32_16x16x32_bf16 v[100:103], a[44:47], v[84:87], v[100:103]
    v_mfma_f32_16x16x32_bf16 v[104:107], a[124:127], v[84:87], v[104:107]
    v_mfma_f32_16x16x32_bf16 v[108:111], a[204:207], v[84:87], v[108:111]
    ds_read_b128 v[80:83], v9 offset:15360
    ds_read_b128 v[84:87], v9 offset:35840
    s_waitcnt lgkmcnt(6)
    v_mfma_f32_16x16x32_bf16 v[88:91], a[48:51], v[56:59], v[88:91]
    v_mfma_f32_16x16x32_bf16 v[92:95], a[128:131], v[56:59], v[92:95]
    v_mfma_f32_16x16x32_bf16 v[96:99], a[208:211], v[56:59], v[96:99]
    v_mfma_f32_16x16x32_bf16 v[100:103], a[48:51], v[60:63], v[100:103]
    v_mfma_f32_16x16x32_bf16 v[104:107], a[128:131], v[60:63], v[104:107]
    v_mfma_f32_16x16x32_bf16 v[108:111], a[208:211], v[60:63], v[108:111]
    ds_read_b128 v[56:59], v9 offset:16384
    ds_read_b128 v[60:63], v9 offset:36864
    s_waitcnt lgkmcnt(6)
    v_mfma_f32_16x16x32_bf16 v[88:91], a[52:55], v[64:67], v[88:91]
    v_mfma_f32_16x16x32_bf16 v[92:95], a[132:135], v[64:67], v[92:95]
    v_mfma_f32_16x16x32_bf16 v[96:99], a[212:215], v[64:67], v[96:99]
    v_mfma_f32_16x16x32_bf16 v[100:103], a[52:55], v[68:71], v[100:103]
    v_mfma_f32_16x16x32_bf16 v[104:107], a[132:135], v[68:71], v[104:107]
    v_mfma_f32_16x16x32_bf16 v[108:111], a[212:215], v[68:71], v[108:111]
    ds_read_b128 v[64:67], v9 offset:17408
    ds_read_b128 v[68:71], v9 offset:37888
    s_waitcnt lgkmcnt(6)
    v_mfma_f32_16x16x32_bf16 v[88:91], a[56:59], v[72:75], v[88:91]
    v_mfma_f32_16x16x32_bf16 v[92:95], a[136:139], v[72:75], v[92:95]
    v_mfma_f32_16x16x32_bf16 v[96:99], a[216:219], v[72:75], v[96:99]
    v_mfma_f32_16x16x32_bf16 v[100:103], a[56:59], v[76:79], v[100:103]
    v_mfma_f32_16x16x32_bf16 v[104:107], a[136:139], v[76:79], v[104:107]
    v_mfma_f32_16x16x32_bf16 v[108:111], a[216:219], v[76:79], v[108:111]
    ds_read_b128 v[72:75], v9 offset:18432
    ds_read_b128 v[76:79], v9 offset:38912
    s_waitcnt lgkmcnt(6)
    v_mfma_f32_16x16x32_bf16 v[88:91], a[60:63], v[80:83], v[88:91]
    v_mfma_f32_16x16x32_bf16 v[92:95], a[140:143], v[80:83], v[92:95]
    v_mfma_f32_16x16x32_bf16 v[96:99], a[220:223], v[80:83], v[96:99]
    v_mfma_f32_16x16x32_bf16 v[100:103], a[60:63], v[84:87], v[100:103]
    v_mfma_f32_16x16x32_bf16 v[104:107], a[140:143], v[84:87], v[104:107]
    v_mfma_f32_16x16x32_bf16 v[108:111], a[220:223], v[84:87], v[108:111]
    ds_read_b128 v[80:83], v9 offset:19456
    ds_read_b128 v[84:87], v9 offset:39936
    s_waitcnt lgkmcnt(6)
    v_mfma_f32_16x16x32_bf16 v[88:91], a[64:67], v[56:59], v[88:91]
    v_mfma_f32_16x16x32_bf16 v[92:95], a[144:147], v[56:59], v[92:95]
    v_mfma_f32_16x16x32_bf16 v[96:99], a[224:227], v[56:59], v[96:99]
    v_mfma_f32_16x16x32_bf16 v[100:103], a[64:67], v[60:63], v[100:103]
    v_mfma_f32_16x16x32_bf16 v[104:107], a[144:147], v[60:63], v[104:107]
    v_mfma_f32_16x16x32_bf16 v[108:111], a[224:227], v[60:63], v[108:111]
    s_waitcnt lgkmcnt(4)
    v_mfma_f32_16x16x32_bf16 v[88:91], a[68:71], v[64:67], v[88:91]
    v_mfma_f32_16x16x32_bf16 v[92:95], a[148:151], v[64:67], v[92:95]
    v_mfma_f32_16x16x32_bf16 v[96:99], a[228:231], v[64:67], v[96:99]
    v_mfma_f32_16x16x32_bf16 v[100:103], a[68:71], v[68:71], v[100:103]
    v_mfma_f32_16x16x32_bf16 v[104:107], a[148:151], v[68:71], v[104:107]
    v_mfma_f32_16x16x32_bf16 v[108:111], a[228:231], v[68:71], v[108:111]
    s_waitcnt lgkmcnt(2)
    v_mfma_f32_16x16x32_bf16 v[88:91], a[72:75], v[72:75], v[88:91]
    v_mfma_f32_16x16x32_bf16 v[92:95], a[152:155], v[72:75], v[92:95]
    v_mfma_f32_16x16x32_bf16 v[96:99], a[232:235], v[72:75], v[96:99]
    v_mfma_f32_16x16x32_bf16 v[100:103], a[72:75], v[76:79], v[100:103]
    v_mfma_f32_16x16x32_bf16 v[104:107], a[152:155], v[76:79], v[104:107]
    v_mfma_f32_16x16x32_bf16 v[108:111], a[232:235], v[76:79], v[108:111]
    s_waitcnt lgkmcnt(0)
    v_mfma_f32_16x16x32_bf16 v[88:91], a[76:79], v[80:83], v[88:91]
    v_mfma_f32_16x16x32_bf16 v[92:95], a[156:159], v[80:83], v[92:95]
    v_mfma_f32_16x16x32_bf16 v[96:99], a[236:239], v[80:83], v[96:99]
    v_mfma_f32_16x16x32_bf16 v[100:103], a[76:79], v[84:87], v[100:103]
    v_mfma_f32_16x16x32_bf16 v[104:107], a[156:159], v[84:87], v[104:107]
    v_mfma_f32_16x16x32_bf16 v[108:111], a[236:239], v[84:87], v[108:111]
    s_nop 2
    v_cvt_pk_bf16_f32 v112, v88, v89
    v_cvt_pk_bf16_f32 v113, v90, v91
    v_cvt_pk_bf16_f32 v114, v92, v93
    v_cvt_pk_bf16_f32 v115, v94, v95
    v_cvt_pk_bf16_f32 v116, v100, v101
    v_cvt_pk_bf16_f32 v117, v102, v103
    v_cvt_pk_bf16_f32 v118, v104, v105
    v_cvt_pk_bf16_f32 v119, v106, v107
    v_cvt_pk_bf16_f32 v120, v96, v97
    v_cvt_pk_bf16_f32 v121, v98, v99
    v_cvt_pk_bf16_f32 v122, v108, v109
    v_cvt_pk_bf16_f32 v123, v110, v111
    buffer_store_dwordx4 v[112:115], v11, s[8:11], s43 offen offset:0 sc1
    buffer_store_dwordx4 v[116:119], v11, s[8:11], s43 offen offset:1024 sc1
    buffer_store_dwordx4 v[120:123], v11, s[8:11], s43 offen offset:2048 sc1
    s_waitcnt vmcnt(3)
    ds_write_b128 v10, v[16:19] offset:0
    ds_write_b128 v10, v[20:23] offset:1024
    ds_write_b128 v10, v[24:27] offset:2048
    ds_write_b128 v10, v[28:31] offset:3072
    ds_write_b128 v10, v[32:35] offset:4096
    ds_write_b128 v10, v[36:39] offset:5120
    ds_write_b128 v10, v[40:43] offset:6144
    ds_write_b128 v10, v[44:47] offset:7168
    ds_write_b128 v10, v[48:51] offset:8192
    ds_write_b128 v10, v[52:55] offset:9216
    s_add_u32 s40, s40, 1
    s_add_u32 s43, s43, 393216
    s_waitcnt lgkmcnt(0)
    s_barrier
    s_cmp_lt_u32 s40, 64
    s_cbranch_scc1 chain1_kernel_p_seg
    s_waitcnt vmcnt(0)
    s_barrier
    s_cmp_eq_u32 s3, 0
    s_cbranch_scc0 chain1_kernel_fp10
    v_mov_b32 v15, s40
    buffer_store_dword v15, v14, s[8:11], 0 offen sc1
chain1_kernel_fp10:
    s_sub_u32 s44, s2, 104
    s_cmp_ge_u32 s44, 80
    s_cbranch_scc1 chain1_kernel_end
    s_mul_i32 s40, s44, 205
    s_lshr_b32 s40, s40, 12
    s_mul_i32 s24, s40, 20
    s_sub_u32 s44, s44, s24
    v_lshlrev_b32 v5, 4, v1
    s_lshl_b32 s24, s44, 16
    s_lshl_b32 s25, s3, 13
    s_add_u32 s24, s24, s25
    v_add_u32 v6, s24, v5
    v_add_u32 v7, 4096, v6
    s_lshl_b32 s24, s44, 14
    s_lshl_b32 s25, s3, 11
    s_add_u32 s24, s24, s25
    v_add_u32 v10, s24, v5
    s_lshl_b32 s24, s3, 14
    v_add_u32 v193, s24, v5
    v_add_u32 v212, 0, v193
    v_add_u32 v213, 4096, v193
    v_add_u32 v214, 8192, v193
    v_add_u32 v215, 12288, v193
    s_lshl_b32 s24, s3, 12
    s_add_u32 s24, s24, 65536
    v_add_u32 v216, s24, v5
    s_lshl_b32 s24, s3, 12
    s_add_u32 s24, s24, 0
    v_add_u32 v217, s24, v5
    s_lshl_b32 s24, s3, 10
    s_add_u32 s24, s24, 0
    v_add_u32 v218, s24, v5
    s_and_b32 s24, s3, 1
    s_lshl_b32 s24, s24, 4
    v_add_u32 v219, s24, v2
    v_mul_u32_u24 v219, 1280, v219
    v_lshl_add_u32 v219, v3, 3, v219
    s_lshr_b32 s24, s3, 1
    s_lshl_b32 s25, s44, 1
    s_add_u32 s24, s24, s25
    s_lshl_b32 s24, s24, 5
    v_add_u32 v219, s24, v219
    s_add_u32 s12, s4, 4194304
    s_addc_u32 s13, s5, 0
    s_mov_b32 s14, 2621440
    s_mov_b32 s15, 0x00020000
    s_add_u32 s16, s4, 4194304
    s_addc_u32 s17, s5, 0
    s_mov_b32 s18, 2621440
    s_mov_b32 s19, 0x00020000
    s_mul_i32 s41, s40, 1310720
    s_add_u32 s41, s41, 184549376
    s_mul_i32 s42, s40, 327680
    s_add_u32 s42, s42, 117440512
    s_mul_i32 s45, s40, 81920
    s_add_u32 s45, s45, 146317312
    s_mul_i32 s46, s40, 40960
    v_and_b32 v252, 7, v1
    v_lshlrev_b32 v252, 7, v252
    s_lshl_b32 s24, s3, 10
    s_add_u32 s24, s24, 151572480
    v_add_u32 v252, s24, v252
    s_mov_b32 s62, -1
chain1_kernel_x_seg:
    s_add_u32 s63, s40, 1
    s_cmp_ge_i32 s62, s63
    s_cbranch_scc1 chain1_kernel_x_en_ok
    s_mov_b32 s61, 0
chain1_kernel_x_en:
    buffer_load_dword v253, v252, s[8:11], 0 offen sc1
    s_waitcnt vmcnt(0)
    v_readlane_b32 s62, v253, 0
    v_readlane_b32 s24, v253, 1
    s_min_i32 s62, s62, s24
    v_readlane_b32 s24, v253, 2
    s_min_i32 s62, s62, s24
    v_readlane_b32 s24, v253, 3
    s_min_i32 s62, s62, s24
    v_readlane_b32 s24, v253, 4
    s_min_i32 s62, s62, s24
    v_readlane_b32 s24, v253, 5
    s_min_i32 s62, s62, s24
    v_readlane_b32 s24, v253, 6
    s_min_i32 s62, s62, s24
    v_readlane_b32 s24, v253, 7
    s_min_i32 s62, s62, s24
    s_cmp_ge_i32 s62, s63
    s_cbranch_scc1 chain1_kernel_x_en_ok
    s_add_u32 s61, s61, 1
    s_cmp_ge_u32 s61, s60
    s_cbranch_scc1 chain1_kernel_x_en_to
    s_sleep 2
    s_branch chain1_kernel_x_en
chain1_kernel_x_en_to:
    s_mov_b32 s60, 1
chain1_kernel_x_en_ok:
    s_add_u32 s52, s41, 32768
    buffer_load_dwordx4 v[16:19], v6, s[8:11], s41 offen offset:0 sc1
    buffer_load_dwordx4 v[20:23], v6, s[8:11], s41 offen offset:1024 sc1
    buffer_load_dwordx4 v[24:27], v6, s[8:11], s41 offen offset:2048 sc1
    buffer_load_dwordx4 v[28:31], v6, s[8:11], s41 offen offset:3072 sc1
    buffer_load_dwordx4 v[32:35], v7, s[8:11], s41 offen offset:0 sc1
    buffer_load_dwordx4 v[36:39], v7, s[8:11], s41 offen offset:1024 sc1
    buffer_load_dwordx4 v[40:43], v7, s[8:11], s41 offen offset:2048 sc1
    buffer_load_dwordx4 v[44:47], v7, s[8:11], s41 offen offset:3072 sc1
    buffer_load_dwordx4 v[48:51], v6, s[8:11], s52 offen offset:0 sc1
    buffer_load_dwordx4 v[52:55], v6, s[8:11], s52 offen offset:1024 sc1
    buffer_load_dwordx4 v[56:59], v6, s[8:11], s52 offen offset:2048 sc1
    buffer_load_dwordx4 v[60:63], v6, s[8:11], s52 offen offset:3072 sc1
    buffer_load_dwordx4 v[64:67], v7, s[8:11], s52 offen offset:0 sc1
    buffer_load_dwordx4 v[68:71], v7, s[8:11], s52 offen offset:1024 sc1
    buffer_load_dwordx4 v[72:75], v7, s[8:11], s52 offen offset:2048 sc1
    buffer_load_dwordx4 v[76:79], v7, s[8:11], s52 offen offset:3072 sc1
    buffer_load_dwordx2 v[194:195], v219, s[16:19], s46 offen
    s_mov_b32 s61, 0
chain1_kernel_x_p0:
    buffer_load_dwordx4 v[140:143], v215, s[8:11], s45 offen offset:3072 sc1
    s_waitcnt vmcnt(0)
    v_max3_u32 v192, v140, v141, v142
    v_max_u32 v192, v192, v143
    v_cmp_eq_u32 vcc, -1, v192
    s_add_u32 s61, s61, 1
    s_cbranch_vccz chain1_kernel_x_p0_out
    s_cmp_ge_u32 s61, s60
    s_cbranch_scc1 chain1_kernel_x_p0_to
    s_sleep 8
    s_branch chain1_kernel_x_p0
chain1_kernel_x_p0_to:
    s_mov_b32 s60, 1
chain1_kernel_x_p0_out:
    s_mov_b32 s61, 0
chain1_kernel_x_p1:
    buffer_load_dwordx4 v[80:83], v212, s[8:11], s45 offen offset:0 sc1
    buffer_load_dwordx4 v[84:87], v212, s[8:11], s45 offen offset:1024 sc1
    buffer_load_dwordx4 v[88:91], v212, s[8:11], s45 offen offset:2048 sc1
    buffer_load_dwordx4 v[92:95], v212, s[8:11], s45 offen offset:3072 sc1
    buffer_load_dwordx4 v[96:99], v213, s[8:11], s45 offen offset:0 sc1
    buffer_load_dwordx4 v[100:103], v213, s[8:11], s45 offen offset:1024 sc1
    buffer_load_dwordx4 v[104:107], v213, s[8:11], s45 offen offset:2048 sc1
    buffer_load_dwordx4 v[108:111], v213, s[8:11], s45 offen offset:3072 sc1
    buffer_load_dwordx4 v[112:115], v214, s[8:11], s45 offen offset:0 sc1
    buffer_load_dwordx4 v[116:119], v214, s[8:11], s45 offen offset:1024 sc1
    buffer_load_dwordx4 v[120:123], v214, s[8:11], s45 offen offset:2048 sc1
    buffer_load_dwordx4 v[124:127], v214, s[8:11], s45 offen offset:3072 sc1
    buffer_load_dwordx4 v[128:131], v215, s[8:11], s45 offen offset:0 sc1
    buffer_load_dwordx4 v[132:135], v215, s[8:11], s45 offen offset:1024 sc1
    buffer_load_dwordx4 v[136:139], v215, s[8:11], s45 offen offset:2048 sc1
    buffer_load_dwordx4 v[140:143], v215, s[8:11], s45 offen offset:3072 sc1
    buffer_load_dwordx4 v[144:147], v216, s[8:11], s45 offen offset:0 sc1
    buffer_load_dwordx4 v[148:151], v216, s[8:11], s45 offen offset:1024 sc1
    buffer_load_dwordx4 v[152:155], v216, s[8:11], s45 offen offset:2048 sc1
    buffer_load_dwordx4 v[156:159], v216, s[8:11], s45 offen offset:3072 sc1
    s_waitcnt vmcnt(0)
    v_max3_u32 v192, v80, v81, v82
    v_max3_u32 v192, v192, v83, v84
    v_max3_u32 v192, v192, v85, v86
    v_max3_u32 v192, v192, v87, v88
    v_max3_u32 v192, v192, v89, v90
    v_max3_u32 v192, v192, v91, v92
    v_max3_u32 v192, v192, v93, v94
    v_max3_u32 v192, v192, v95, v96
    v_max3_u32 v192, v192, v97, v98
    v_max3_u32 v192, v192, v99, v100
    v_max3_u32 v192, v192, v101, v102
    v_max3_u32 v192, v192, v103, v104
    v_max3_u32 v192, v192, v105, v106
    v_max3_u32 v192, v192, v107, v108
    v_max3_u32 v192, v192, v109, v110
    v_max3_u32 v192, v192, v111, v112
    v_max3_u32 v192, v192, v113, v114
    v_max3_u32 v192, v192, v115, v116
    v_max3_u32 v192, v192, v117, v118
    v_max3_u32 v192, v192, v119, v120
    v_max3_u32 v192, v192, v121, v122
    v_max3_u32 v192, v192, v123, v124
    v_max3_u32 v192, v192, v125, v126
    v_max3_u32 v192, v192, v127, v128
    v_max3_u32 v192, v192, v129, v130
    v_max3_u32 v192, v192, v131, v132
    v_max3_u32 v192, v192, v133, v134
    v_max3_u32 v192, v192, v135, v136
    v_max3_u32 v192, v192, v137, v138
    v_max3_u32 v192, v192, v139, v140
    v_max3_u32 v192, v192, v141, v142
    v_max3_u32 v192, v192, v143, v144
    v_max3_u32 v192, v192, v145, v146
    v_max3_u32 v192, v192, v147, v148
    v_max3_u32 v192, v192, v149, v150
    v_max3_u32 v192, v192, v151, v152
    v_max3_u32 v192, v192, v153, v154
    v_max3_u32 v192, v192, v155, v156
    v_max3_u32 v192, v192, v157, v158
    v_max_u32 v192, v192, v159
    v_cmp_eq_u32 vcc, -1, v192
    s_add_u32 s61, s61, 1
    s_cbranch_vccz chain1_kernel_x_p1_out
    s_cmp_ge_u32 s61, s60
    s_cbranch_scc1 chain1_kernel_x_p1_to
    s_sleep 2
    s_branch chain1_kernel_x_p1
chain1_kernel_x_p1_to:
    s_mov_b32 s60, 1
chain1_kernel_x_p1_out:
    s_add_u32 s53, s42, 8192
    s_mov_b32 s61, 0
chain1_kernel_x_v:
    buffer_load_dwordx4 v[160:163], v10, s[8:11], s42 offen offset:0 sc1
    buffer_load_dwordx4 v[164:167], v10, s[8:11], s42 offen offset:1024 sc1
    buffer_load_dwordx4 v[168:171], v10, s[8:11], s53 offen offset:0 sc1
    buffer_load_dwordx4 v[172:175], v10, s[8:11], s53 offen offset:1024 sc1
    s_waitcnt vmcnt(0)
    v_max3_u32 v192, v160, v161, v162
    v_max3_u32 v192, v192, v163, v164
    v_max3_u32 v192, v192, v165, v166
    v_max3_u32 v192, v192, v167, v168
    v_max3_u32 v192, v192, v169, v170
    v_max3_u32 v192, v192, v171, v172
    v_max3_u32 v192, v192, v173, v174
    v_max_u32 v192, v192, v175
    v_cmp_eq_u32 vcc, -1, v192
    s_add_u32 s61, s61, 1
    s_cbranch_vccz chain1_kernel_x_v_out
    s_cmp_ge_u32 s61, s60
    s_cbranch_scc1 chain1_kernel_x_v_to
    s_sleep 2
    s_branch chain1_kernel_x_v
chain1_kernel_x_v_to:
    s_mov_b32 s60, 1
chain1_kernel_x_v_out:
    v_mfma_f32_16x16x32_bf16 v[176:179], v[16:19], v[80:83], 0
    v_mfma_f32_16x16x32_bf16 v[180:183], v[16:19], v[84:87], 0
    v_mfma_f32_16x16x32_bf16 v[184:187], v[48:51], v[80:83], 0
    v_mfma_f32_16x16x32_bf16 v[188:191], v[48:51], v[84:87], 0
    v_mfma_f32_16x16x32_bf16 v[176:179], v[20:23], v[88:91], v[176:179]
    v_mfma_f32_16x16x32_bf16 v[180:183], v[20:23], v[92:95], v[180:183]
    v_mfma_f32_16x16x32_bf16 v[184:187], v[52:55], v[88:91], v[184:187]
    v_mfma_f32_16x16x32_bf16 v[188:191], v[52:55], v[92:95], v[188:191]
    v_mfma_f32_16x16x32_bf16 v[176:179], v[24:27], v[96:99], v[176:179]
    v_mfma_f32_16x16x32_bf16 v[180:183], v[24:27], v[100:103], v[180:183]
    v_mfma_f32_16x16x32_bf16 v[184:187], v[56:59], v[96:99], v[184:187]
    v_mfma_f32_16x16x32_bf16 v[188:191], v[56:59], v[100:103], v[188:191]
    v_mfma_f32_16x16x32_bf16 v[176:179], v[28:31], v[104:107], v[176:179]
    v_mfma_f32_16x16x32_bf16 v[180:183], v[28:31], v[108:111], v[180:183]
    v_mfma_f32_16x16x32_bf16 v[184:187], v[60:63], v[104:107], v[184:187]
    v_mfma_f32_16x16x32_bf16 v[188:191], v[60:63], v[108:111], v[188:191]
    v_mfma_f32_16x16x32_bf16 v[176:179], v[32:35], v[112:115], v[176:179]
    v_mfma_f32_16x16x32_bf16 v[180:183], v[32:35], v[116:119], v[180:183]
    v_mfma_f32_16x16x32_bf16 v[184:187], v[64:67], v[112:115], v[184:187]
    v_mfma_f32_16x16x32_bf16 v[188:191], v[64:67], v[116:119], v[188:191]
    v_mfma_f32_16x16x32_bf16 v[176:179], v[36:39], v[120:123], v[176:179]
    v_mfma_f32_16x16x32_bf16 v[180:183], v[36:39], v[124:127], v[180:183]
    v_mfma_f32_16x16x32_bf16 v[184:187], v[68:71], v[120:123], v[184:187]
    v_mfma_f32_16x16x32_bf16 v[188:191], v[68:71], v[124:127], v[188:191]
    v_mfma_f32_16x16x32_bf16 v[176:179], v[40:43], v[128:131], v[176:179]
    v_mfma_f32_16x16x32_bf16 v[180:183], v[40:43], v[132:135], v[180:183]
    v_mfma_f32_16x16x32_bf16 v[184:187], v[72:75], v[128:131], v[184:187]
    v_mfma_f32_16x16x32_bf16 v[188:191], v[72:75], v[132:135], v[188:191]
    v_mfma_f32_16x16x32_bf16 v[176:179], v[44:47], v[136:139], v[176:179]
    v_mfma_f32_16x16x32_bf16 v[180:183], v[44:47], v[140:143], v[180:183]
    v_mfma_f32_16x16x32_bf16 v[184:187], v[76:79], v[136:139], v[184:187]
    v_mfma_f32_16x16x32_bf16 v[188:191], v[76:79], v[140:143], v[188:191]
    v_mfma_f32_16x16x32_bf16 v[176:179], v[160:163], v[144:147], v[176:179]
    v_mfma_f32_16x16x32_bf16 v[180:183], v[160:163], v[148:151], v[180:183]
    v_mfma_f32_16x16x32_bf16 v[184:187], v[168:171], v[144:147], v[184:187]
    v_mfma_f32_16x16x32_bf16 v[188:191], v[168:171], v[148:151], v[188:191]
    v_mfma_f32_16x16x32_bf16 v[176:179], v[164:167], v[152:155], v[176:179]
    v_mfma_f32_16x16x32_bf16 v[180:183], v[164:167], v[156:159], v[180:183]
    v_mfma_f32_16x16x32_bf16 v[184:187], v[172:175], v[152:155], v[184:187]
    v_mfma_f32_16x16x32_bf16 v[188:191], v[172:175], v[156:159], v[188:191]
    s_lshr_b32 s24, s40, 2
    s_and_b32 s24, s24, 1
    s_lshl_b32 s24, s24, 14
    v_add_u32 v14, s24, v217
    v_add_u32 v15, s24, v218
    ds_write_b128 v14, v[176:179] offset:0
    ds_write_b128 v14, v[180:183] offset:1024
    ds_write_b128 v14, v[184:187] offset:2048
    ds_write_b128 v14, v[188:191] offset:3072
    s_waitcnt lgkmcnt(0)
    s_barrier
    ds_read_b128 v[196:199], v15 offset:0
    ds_read_b128 v[200:203], v15 offset:4096
    ds_read_b128 v[204:207], v15 offset:8192
    ds_read_b128 v[208:211], v15 offset:12288
    s_waitcnt lgkmcnt(0)
    v_pk_add_f32 v[196:197], v[196:197], v[200:201]
    v_pk_add_f32 v[204:205], v[204:205], v[208:209]
    v_pk_add_f32 v[198:199], v[198:199], v[202:203]
    v_pk_add_f32 v[206:207], v[206:207], v[210:211]
    v_pk_add_f32 v[196:197], v[196:197], v[204:205]
    v_pk_add_f32 v[198:199], v[198:199], v[206:207]
    v_cvt_pk_bf16_f32 v200, v196, v197
    v_cvt_pk_bf16_f32 v201, v198, v199
    v_lshlrev_b32 v196, 16, v200
    v_and_b32 v197, 0xffff0000, v200
    v_lshlrev_b32 v202, 16, v194
    v_and_b32 v203, 0xffff0000, v194
    v_add_f32 v196, v196, v202
    v_add_f32 v197, v197, v203
    v_lshlrev_b32 v198, 16, v201
    v_and_b32 v199, 0xffff0000, v201
    v_lshlrev_b32 v202, 16, v195
    v_and_b32 v203, 0xffff0000, v195
    v_add_f32 v198, v198, v202
    v_add_f32 v199, v199, v203
    v_cvt_pk_bf16_f32 v200, v196, v197
    v_cvt_pk_bf16_f32 v201, v198, v199
    buffer_store_dwordx2 v[200:201], v219, s[12:15], s46 offen
    s_add_u32 s40, s40, 4
    s_add_u32 s41, s41, 5242880
    s_add_u32 s42, s42, 1310720
    s_add_u32 s45, s45, 327680
    s_add_u32 s46, s46, 163840
    s_cmp_lt_u32 s40, 64
    s_cbranch_scc1 chain1_kernel_x_seg
    s_branch chain1_kernel_end
chain1_kernel_roleO:
    s_sub_u32 s44, s2, 200
    s_load_dwordx2 s[6:7], s[0:1], 64
    s_waitcnt lgkmcnt(0)
    s_mov_b32 s12, s6
    s_mov_b32 s13, s7
    s_mov_b32 s14, 7864320
    s_mov_b32 s15, 0x00020000
    v_add_u32 v8, 0, v0
    s_mov_b32 s24, 3277
    v_mul_lo_u32 v9, v8, s24
    v_lshrrev_b32 v9, 18, v9
    v_mul_u32_u24 v10, 80, v9
    v_sub_u32 v10, v8, v10
    v_mul_u32_u24 v16, 1312, v9
    v_lshl_add_u32 v16, v10, 4, v16
    v_add_u32 v8, 256, v0
    s_mov_b32 s24, 3277
    v_mul_lo_u32 v9, v8, s24
    v_lshrrev_b32 v9, 18, v9
    v_mul_u32_u24 v10, 80, v9
    v_sub_u32 v10, v8, v10
    v_mul_u32_u24 v17, 1312, v9
    v_lshl_add_u32 v17, v10, 4, v17
    v_add_u32 v8, 512, v0
    s_mov_b32 s24, 3277
    v_mul_lo_u32 v9, v8, s24
    v_lshrrev_b32 v9, 18, v9
    v_mul_u32_u24 v10, 80, v9
    v_sub_u32 v10, v8, v10
    v_mul_u32_u24 v18, 1312, v9
    v_lshl_add_u32 v18, v10, 4, v18
    v_add_u32 v8, 768, v0
    s_mov_b32 s24, 3277
    v_mul_lo_u32 v9, v8, s24
    v_lshrrev_b32 v9, 18, v9
    v_mul_u32_u24 v10, 80, v9
    v_sub_u32 v10, v8, v10
    v_mul_u32_u24 v19, 1312, v9
    v_lshl_add_u32 v19, v10, 4, v19
    v_add_u32 v8, 1024, v0
    s_mov_b32 s24, 3277
    v_mul_lo_u32 v9, v8, s24
    v_lshrrev_b32 v9, 18, v9
    v_mul_u32_u24 v10, 80, v9
    v_sub_u32 v10, v8, v10
    v_mul_u32_u24 v20, 1312, v9
    v_lshl_add_u32 v20, v10, 4, v20
    v_add_u32 v8, 1280, v0
    s_mov_b32 s24, 3277
    v_mul_lo_u32 v9, v8, s24
    v_lshrrev_b32 v9, 18, v9
    v_mul_u32_u24 v10, 80, v9
    v_sub_u32 v10, v8, v10
    v_mul_u32_u24 v21, 1312, v9
    v_lshl_add_u32 v21, v10, 4, v21
    v_add_u32 v8, 1536, v0
    s_mov_b32 s24, 3277
    v_mul_lo_u32 v9, v8, s24
    v_lshrrev_b32 v9, 18, v9
    v_mul_u32_u24 v10, 80, v9
    v_sub_u32 v10, v8, v10
    v_mul_u32_u24 v22, 1312, v9
    v_lshl_add_u32 v22, v10, 4, v22
    v_add_u32 v8, 1792, v0
    s_mov_b32 s24, 3277
    v_mul_lo_u32 v9, v8, s24
    v_lshrrev_b32 v9, 18, v9
    v_mul_u32_u24 v10, 80, v9
    v_sub_u32 v10, v8, v10
    v_mul_u32_u24 v23, 1312, v9
    v_lshl_add_u32 v23, v10, 4, v23
    v_add_u32 v8, 2048, v0
    s_mov_b32 s24, 3277
    v_mul_lo_u32 v9, v8, s24
    v_lshrrev_b32 v9, 18, v9
    v_mul_u32_u24 v10, 80, v9
    v_sub_u32 v10, v8, v10
    v_mul_u32_u24 v24, 1312, v9
    v_lshl_add_u32 v24, v10, 4, v24
    v_add_u32 v8, 2304, v0
    s_mov_b32 s24, 3277
    v_mul_lo_u32 v9, v8, s24
    v_lshrrev_b32 v9, 18, v9
    v_mul_u32_u24 v10, 80, v9
    v_sub_u32 v10, v8, v10
    v_mul_u32_u24 v25, 1312, v9
    v_lshl_add_u32 v25, v10, 4, v25
    v_add_u32 v8, 2560, v0
    s_mov_b32 s24, 3277
    v_mul_lo_u32 v9, v8, s24
    v_lshrrev_b32 v9, 18, v9
    v_mul_u32_u24 v10, 80, v9
    v_sub_u32 v10, v8, v10
    v_mul_u32_u24 v26, 1312, v9
    v_lshl_add_u32 v26, v10, 4, v26
    v_add_u32 v8, 2816, v0
    s_mov_b32 s24, 3277
    v_mul_lo_u32 v9, v8, s24
    v_lshrrev_b32 v9, 18, v9
    v_mul_u32_u24 v10, 80, v9
    v_sub_u32 v10, v8, v10
    v_mul_u32_u24 v27, 1312, v9
    v_lshl_add_u32 v27, v10, 4, v27
    v_add_u32 v8, 3072, v0
    s_mov_b32 s24, 3277
    v_mul_lo_u32 v9, v8, s24
    v_lshrrev_b32 v9, 18, v9
    v_mul_u32_u24 v10, 80, v9
    v_sub_u32 v10, v8, v10
    v_mul_u32_u24 v28, 1312, v9
    v_lshl_add_u32 v28, v10, 4, v28
    v_add_u32 v8, 3328, v0
    s_mov_b32 s24, 3277
    v_mul_lo_u32 v9, v8, s24
    v_lshrrev_b32 v9, 18, v9
    v_mul_u32_u24 v10, 80, v9
    v_sub_u32 v10, v8, v10
    v_mul_u32_u24 v29, 1312, v9
    v_lshl_add_u32 v29, v10, 4, v29
    v_add_u32 v8, 3584, v0
    s_mov_b32 s24, 3277
    v_mul_lo_u32 v9, v8, s24
    v_lshrrev_b32 v9, 18, v9
    v_mul_u32_u24 v10, 80, v9
    v_sub_u32 v10, v8, v10
    v_mul_u32_u24 v30, 1312, v9
    v_lshl_add_u32 v30, v10, 4, v30
    v_add_u32 v8, 3840, v0
    s_mov_b32 s24, 3277
    v_mul_lo_u32 v9, v8, s24
    v_lshrrev_b32 v9, 18, v9
    v_mul_u32_u24 v10, 80, v9
    v_sub_u32 v10, v8, v10
    v_mul_u32_u24 v31, 1312, v9
    v_lshl_add_u32 v31, v10, 4, v31
    v_add_u32 v8, 4096, v0
    s_mov_b32 s24, 3277
    v_mul_lo_u32 v9, v8, s24
    v_lshrrev_b32 v9, 18, v9
    v_mul_u32_u24 v10, 80, v9
    v_sub_u32 v10, v8, v10
    v_mul_u32_u24 v32, 1312, v9
    v_lshl_add_u32 v32, v10, 4, v32
    v_add_u32 v8, 4352, v0
    s_mov_b32 s24, 3277
    v_mul_lo_u32 v9, v8, s24
    v_lshrrev_b32 v9, 18, v9
    v_mul_u32_u24 v10, 80, v9
    v_sub_u32 v10, v8, v10
    v_mul_u32_u24 v33, 1312, v9
    v_lshl_add_u32 v33, v10, 4, v33
    v_add_u32 v8, 4608, v0
    s_mov_b32 s24, 3277
    v_mul_lo_u32 v9, v8, s24
    v_lshrrev_b32 v9, 18, v9
    v_mul_u32_u24 v10, 80, v9
    v_sub_u32 v10, v8, v10
    v_mul_u32_u24 v34, 1312, v9
    v_lshl_add_u32 v34, v10, 4, v34
    v_add_u32 v8, 4864, v0
    s_mov_b32 s24, 3277
    v_mul_lo_u32 v9, v8, s24
    v_lshrrev_b32 v9, 18, v9
    v_mul_u32_u24 v10, 80, v9
    v_sub_u32 v10, v8, v10
    v_mul_u32_u24 v35, 1312, v9
    v_lshl_add_u32 v35, v10, 4, v35
    v_add_u32 v8, 5120, v0
    s_mov_b32 s24, 3277
    v_mul_lo_u32 v9, v8, s24
    v_lshrrev_b32 v9, 18, v9
    v_mul_u32_u24 v10, 80, v9
    v_sub_u32 v10, v8, v10
    v_mul_u32_u24 v36, 1312, v9
    v_lshl_add_u32 v36, v10, 4, v36
    v_add_u32 v8, 5376, v0
    s_mov_b32 s24, 3277
    v_mul_lo_u32 v9, v8, s24
    v_lshrrev_b32 v9, 18, v9
    v_mul_u32_u24 v10, 80, v9
    v_sub_u32 v10, v8, v10
    v_mul_u32_u24 v37, 1312, v9
    v_lshl_add_u32 v37, v10, 4, v37
    v_add_u32 v8, 5632, v0
    s_mov_b32 s24, 3277
    v_mul_lo_u32 v9, v8, s24
    v_lshrrev_b32 v9, 18, v9
    v_mul_u32_u24 v10, 80, v9
    v_sub_u32 v10, v8, v10
    v_mul_u32_u24 v38, 1312, v9
    v_lshl_add_u32 v38, v10, 4, v38
    v_add_u32 v8, 5888, v0
    s_mov_b32 s24, 3277
    v_mul_lo_u32 v9, v8, s24
    v_lshrrev_b32 v9, 18, v9
    v_mul_u32_u24 v10, 80, v9
    v_sub_u32 v10, v8, v10
    v_mul_u32_u24 v39, 1312, v9
    v_lshl_add_u32 v39, v10, 4, v39
    v_add_u32 v8, 6144, v0
    s_mov_b32 s24, 3277
    v_mul_lo_u32 v9, v8, s24
    v_lshrrev_b32 v9, 18, v9
    v_mul_u32_u24 v10, 80, v9
    v_sub_u32 v10, v8, v10
    v_mul_u32_u24 v40, 1312, v9
    v_lshl_add_u32 v40, v10, 4, v40
    v_add_u32 v8, 6400, v0
    s_mov_b32 s24, 3277
    v_mul_lo_u32 v9, v8, s24
    v_lshrrev_b32 v9, 18, v9
    v_mul_u32_u24 v10, 80, v9
    v_sub_u32 v10, v8, v10
    v_mul_u32_u24 v41, 1312, v9
    v_lshl_add_u32 v41, v10, 4, v41
    v_add_u32 v8, 6656, v0
    s_mov_b32 s24, 3277
    v_mul_lo_u32 v9, v8, s24
    v_lshrrev_b32 v9, 18, v9
    v_mul_u32_u24 v10, 80, v9
    v_sub_u32 v10, v8, v10
    v_mul_u32_u24 v42, 1312, v9
    v_lshl_add_u32 v42, v10, 4, v42
    v_add_u32 v8, 6912, v0
    s_mov_b32 s24, 3277
    v_mul_lo_u32 v9, v8, s24
    v_lshrrev_b32 v9, 18, v9
    v_mul_u32_u24 v10, 80, v9
    v_sub_u32 v10, v8, v10
    v_mul_u32_u24 v43, 1312, v9
    v_lshl_add_u32 v43, v10, 4, v43
    v_add_u32 v8, 7168, v0
    s_mov_b32 s24, 3277
    v_mul_lo_u32 v9, v8, s24
    v_lshrrev_b32 v9, 18, v9
    v_mul_u32_u24 v10, 80, v9
    v_sub_u32 v10, v8, v10
    v_mul_u32_u24 v44, 1312, v9
    v_lshl_add_u32 v44, v10, 4, v44
    v_add_u32 v8, 7424, v0
    s_mov_b32 s24, 3277
    v_mul_lo_u32 v9, v8, s24
    v_lshrrev_b32 v9, 18, v9
    v_mul_u32_u24 v10, 80, v9
    v_sub_u32 v10, v8, v10
    v_mul_u32_u24 v45, 1312, v9
    v_lshl_add_u32 v45, v10, 4, v45
    v_lshlrev_b32 v4, 4, v0
    s_mul_i32 s45, s44, 245760
    s_add_u32 s46, s45, 0
    buffer_load_dwordx4 v[48:51], v4, s[12:15], s46 offen
    s_add_u32 s46, s45, 4096
    buffer_load_dwordx4 v[52:55], v4, s[12:15], s46 offen
    s_add_u32 s46, s45, 8192
    buffer_load_dwordx4 v[56:59], v4, s[12:15], s46 offen
    s_add_u32 s46, s45, 12288
    buffer_load_dwordx4 v[60:63], v4, s[12:15], s46 offen
    s_add_u32 s46, s45, 16384
    buffer_load_dwordx4 v[64:67], v4, s[12:15], s46 offen
    s_add_u32 s46, s45, 20480
    buffer_load_dwordx4 v[68:71], v4, s[12:15], s46 offen
    s_add_u32 s46, s45, 24576
    buffer_load_dwordx4 v[72:75], v4, s[12:15], s46 offen
    s_add_u32 s46, s45, 28672
    buffer_load_dwordx4 v[76:79], v4, s[12:15], s46 offen
    s_add_u32 s46, s45, 32768
    buffer_load_dwordx4 v[80:83], v4, s[12:15], s46 offen
    s_add_u32 s46, s45, 36864
    buffer_load_dwordx4 v[84:87], v4, s[12:15], s46 offen
    s_add_u32 s46, s45, 40960
    buffer_load_dwordx4 v[88:91], v4, s[12:15], s46 offen
    s_add_u32 s46, s45, 45056
    buffer_load_dwordx4 v[92:95], v4, s[12:15], s46 offen
    s_add_u32 s46, s45, 49152
    buffer_load_dwordx4 v[96:99], v4, s[12:15], s46 offen
    s_add_u32 s46, s45, 53248
    buffer_load_dwordx4 v[100:103], v4, s[12:15], s46 offen
    s_add_u32 s46, s45, 57344
    buffer_load_dwordx4 v[104:107], v4, s[12:15], s46 offen
    s_add_u32 s46, s45, 61440
    buffer_load_dwordx4 v[108:111], v4, s[12:15], s46 offen
    s_add_u32 s46, s45, 65536
    buffer_load_dwordx4 v[112:115], v4, s[12:15], s46 offen
    s_add_u32 s46, s45, 69632
    buffer_load_dwordx4 v[116:119], v4, s[12:15], s46 offen
    s_add_u32 s46, s45, 73728
    buffer_load_dwordx4 v[120:123], v4, s[12:15], s46 offen
    s_add_u32 s46, s45, 77824
    buffer_load_dwordx4 v[124:127], v4, s[12:15], s46 offen
    s_add_u32 s46, s45, 81920
    buffer_load_dwordx4 v[128:131], v4, s[12:15], s46 offen
    s_add_u32 s46, s45, 86016
    buffer_load_dwordx4 v[132:135], v4, s[12:15], s46 offen
    s_add_u32 s46, s45, 90112
    buffer_load_dwordx4 v[136:139], v4, s[12:15], s46 offen
    s_add_u32 s46, s45, 94208
    buffer_load_dwordx4 v[140:143], v4, s[12:15], s46 offen
    s_add_u32 s46, s45, 98304
    buffer_load_dwordx4 v[144:147], v4, s[12:15], s46 offen
    s_add_u32 s46, s45, 102400
    buffer_load_dwordx4 v[148:151], v4, s[12:15], s46 offen
    s_add_u32 s46, s45, 106496
    buffer_load_dwordx4 v[152:155], v4, s[12:15], s46 offen
    s_add_u32 s46, s45, 110592
    buffer_load_dwordx4 v[156:159], v4, s[12:15], s46 offen
    s_add_u32 s46, s45, 114688
    buffer_load_dwordx4 v[160:163], v4, s[12:15], s46 offen
    s_add_u32 s46, s45, 118784
    buffer_load_dwordx4 v[164:167], v4, s[12:15], s46 offen
    s_add_u32 s46, s45, 122880
    buffer_load_dwordx4 v[168:171], v4, s[12:15], s46 offen
    s_add_u32 s46, s45, 126976
    buffer_load_dwordx4 v[172:175], v4, s[12:15], s46 offen
    s_add_u32 s46, s45, 131072
    buffer_load_dwordx4 v[176:179], v4, s[12:15], s46 offen
    s_add_u32 s46, s45, 135168
    buffer_load_dwordx4 v[180:183], v4, s[12:15], s46 offen
    s_add_u32 s46, s45, 139264
    buffer_load_dwordx4 v[184:187], v4, s[12:15], s46 offen
    s_add_u32 s46, s45, 143360
    buffer_load_dwordx4 v[188:191], v4, s[12:15], s46 offen
    s_add_u32 s46, s45, 147456
    buffer_load_dwordx4 v[192:195], v4, s[12:15], s46 offen
    s_add_u32 s46, s45, 151552
    buffer_load_dwordx4 v[196:199], v4, s[12:15], s46 offen
    s_add_u32 s46, s45, 155648
    buffer_load_dwordx4 v[200:203], v4, s[12:15], s46 offen
    s_add_u32 s46, s45, 159744
    buffer_load_dwordx4 v[204:207], v4, s[12:15], s46 offen
    s_add_u32 s46, s45, 163840
    buffer_load_dwordx4 v[208:211], v4, s[12:15], s46 offen
    s_add_u32 s46, s45, 167936
    buffer_load_dwordx4 v[212:215], v4, s[12:15], s46 offen
    s_add_u32 s46, s45, 172032
    buffer_load_dwordx4 v[216:219], v4, s[12:15], s46 offen
    s_add_u32 s46, s45, 176128
    buffer_load_dwordx4 v[220:223], v4, s[12:15], s46 offen
    s_add_u32 s46, s45, 180224
    buffer_load_dwordx4 v[224:227], v4, s[12:15], s46 offen
    s_add_u32 s46, s45, 184320
    buffer_load_dwordx4 v[228:231], v4, s[12:15], s46 offen
    s_add_u32 s46, s45, 188416
    buffer_load_dwordx4 v[232:235], v4, s[12:15], s46 offen
    s_add_u32 s46, s45, 192512
    buffer_load_dwordx4 v[236:239], v4, s[12:15], s46 offen
    s_add_u32 s46, s45, 196608
    buffer_load_dwordx4 v[240:243], v4, s[12:15], s46 offen
    s_add_u32 s46, s45, 200704
    buffer_load_dwordx4 v[244:247], v4, s[12:15], s46 offen
    s_add_u32 s46, s45, 204800
    buffer_load_dwordx4 v[248:251], v4, s[12:15], s46 offen
    s_add_u32 s46, s45, 208896
    buffer_load_dwordx4 v[252:255], v4, s[12:15], s46 offen
    v_lshrrev_b32 v8, 2, v2
    v_lshl_add_u32 v8, v3, 2, v8
    v_mul_u32_u24 v5, 1312, v8
    v_and_b32 v8, 3, v2
    v_lshl_add_u32 v5, v8, 3, v5
    s_mul_i32 s24, s3, 320
    v_add_u32 v5, s24, v5
    v_add_u32 v6, 62976, v5
    s_waitcnt vmcnt(22)
    ds_write_b128 v16, v[48:51]
    ds_write_b128 v17, v[52:55]
    ds_write_b128 v18, v[56:59]
    ds_write_b128 v19, v[60:63]
    ds_write_b128 v20, v[64:67]
    ds_write_b128 v21, v[68:71]
    ds_write_b128 v22, v[72:75]
    ds_write_b128 v23, v[76:79]
    ds_write_b128 v24, v[80:83]
    ds_write_b128 v25, v[84:87]
    ds_write_b128 v26, v[88:91]
    ds_write_b128 v27, v[92:95]
    ds_write_b128 v28, v[96:99]
    ds_write_b128 v29, v[100:103]
    ds_write_b128 v30, v[104:107]
    ds_write_b128 v31, v[108:111]
    ds_write_b128 v32, v[112:115]
    ds_write_b128 v33, v[116:119]
    ds_write_b128 v34, v[120:123]
    ds_write_b128 v35, v[124:127]
    ds_write_b128 v36, v[128:131]
    ds_write_b128 v37, v[132:135]
    ds_write_b128 v38, v[136:139]
    ds_write_b128 v39, v[140:143]
    ds_write_b128 v40, v[144:147]
    ds_write_b128 v41, v[148:151]
    ds_write_b128 v42, v[152:155]
    ds_write_b128 v43, v[156:159]
    ds_write_b128 v44, v[160:163]
    ds_write_b128 v45, v[164:167]
    s_waitcnt lgkmcnt(0)
    s_add_u32 s46, s45, 212992
    buffer_load_dwordx4 v[48:51], v4, s[12:15], s46 offen
    s_add_u32 s46, s45, 217088
    buffer_load_dwordx4 v[52:55], v4, s[12:15], s46 offen
    s_add_u32 s46, s45, 221184
    buffer_load_dwordx4 v[56:59], v4, s[12:15], s46 offen
    s_add_u32 s46, s45, 225280
    buffer_load_dwordx4 v[60:63], v4, s[12:15], s46 offen
    s_add_u32 s46, s45, 229376
    buffer_load_dwordx4 v[64:67], v4, s[12:15], s46 offen
    s_add_u32 s46, s45, 233472
    buffer_load_dwordx4 v[68:71], v4, s[12:15], s46 offen
    s_add_u32 s46, s45, 237568
    buffer_load_dwordx4 v[72:75], v4, s[12:15], s46 offen
    s_add_u32 s46, s45, 241664
    buffer_load_dwordx4 v[76:79], v4, s[12:15], s46 offen
    s_barrier
    ds_read_b64_tr_b16 a[0:1], v5 offset:0
    ds_read_b64_tr_b16 a[2:3], v5 offset:20992
    ds_read_b64_tr_b16 a[4:5], v6 offset:0
    ds_read_b64_tr_b16 a[6:7], v6 offset:20992
    ds_read_b64_tr_b16 a[16:17], v5 offset:41984
    ds_read_b64_tr_b16 a[18:19], v6 offset:41984
    ds_read_b64_tr_b16 a[24:25], v5 offset:32
    ds_read_b64_tr_b16 a[26:27], v5 offset:21024
    ds_read_b64_tr_b16 a[28:29], v6 offset:32
    ds_read_b64_tr_b16 a[30:31], v6 offset:21024
    ds_read_b64_tr_b16 a[40:41], v5 offset:42016
    ds_read_b64_tr_b16 a[42:43], v6 offset:42016
    ds_read_b64_tr_b16 a[48:49], v5 offset:64
    ds_read_b64_tr_b16 a[50:51], v5 offset:21056
    ds_read_b64_tr_b16 a[52:53], v6 offset:64
    ds_read_b64_tr_b16 a[54:55], v6 offset:21056
    ds_read_b64_tr_b16 a[64:65], v5 offset:42048
    ds_read_b64_tr_b16 a[66:67], v6 offset:42048
    ds_read_b64_tr_b16 a[72:73], v5 offset:96
    ds_read_b64_tr_b16 a[74:75], v5 offset:21088
    ds_read_b64_tr_b16 a[76:77], v6 offset:96
    ds_read_b64_tr_b16 a[78:79], v6 offset:21088
    ds_read_b64_tr_b16 a[88:89], v5 offset:42080
    ds_read_b64_tr_b16 a[90:91], v6 offset:42080
    ds_read_b64_tr_b16 a[96:97], v5 offset:128
    ds_read_b64_tr_b16 a[98:99], v5 offset:21120
    ds_read_b64_tr_b16 a[100:101], v6 offset:128
    ds_read_b64_tr_b16 a[102:103], v6 offset:21120
    ds_read_b64_tr_b16 a[112:113], v5 offset:42112
    ds_read_b64_tr_b16 a[114:115], v6 offset:42112
    ds_read_b64_tr_b16 a[120:121], v5 offset:160
    ds_read_b64_tr_b16 a[122:123], v5 offset:21152
    ds_read_b64_tr_b16 a[124:125], v6 offset:160
    ds_read_b64_tr_b16 a[126:127], v6 offset:21152
    ds_read_b64_tr_b16 a[136:137], v5 offset:42144
    ds_read_b64_tr_b16 a[138:139], v6 offset:42144
    ds_read_b64_tr_b16 a[144:145], v5 offset:192
    ds_read_b64_tr_b16 a[146:147], v5 offset:21184
    ds_read_b64_tr_b16 a[148:149], v6 offset:192
    ds_read_b64_tr_b16 a[150:151], v6 offset:21184
    ds_read_b64_tr_b16 a[160:161], v5 offset:42176
    ds_read_b64_tr_b16 a[162:163], v6 offset:42176
    ds_read_b64_tr_b16 a[168:169], v5 offset:224
    ds_read_b64_tr_b16 a[170:171], v5 offset:21216
    ds_read_b64_tr_b16 a[172:173], v6 offset:224
    ds_read_b64_tr_b16 a[174:175], v6 offset:21216
    ds_read_b64_tr_b16 a[184:185], v5 offset:42208
    ds_read_b64_tr_b16 a[186:187], v6 offset:42208
    ds_read_b64_tr_b16 a[192:193], v5 offset:256
    ds_read_b64_tr_b16 a[194:195], v5 offset:21248
    ds_read_b64_tr_b16 a[196:197], v6 offset:256
    ds_read_b64_tr_b16 a[198:199], v6 offset:21248
    ds_read_b64_tr_b16 a[208:209], v5 offset:42240
    ds_read_b64_tr_b16 a[210:211], v6 offset:42240
    ds_read_b64_tr_b16 a[216:217], v5 offset:288
    ds_read_b64_tr_b16 a[218:219], v5 offset:21280
    ds_read_b64_tr_b16 a[220:221], v6 offset:288
    ds_read_b64_tr_b16 a[222:223], v6 offset:21280
    ds_read_b64_tr_b16 a[232:233], v5 offset:42272
    ds_read_b64_tr_b16 a[234:235], v6 offset:42272
    s_waitcnt lgkmcnt(0)
    s_barrier
    s_waitcnt vmcnt(0)
    ds_write_b128 v16, v[168:171]
    ds_write_b128 v17, v[172:175]
    ds_write_b128 v18, v[176:179]
    ds_write_b128 v19, v[180:183]
    ds_write_b128 v20, v[184:187]
    ds_write_b128 v21, v[188:191]
    ds_write_b128 v22, v[192:195]
    ds_write_b128 v23, v[196:199]
    ds_write_b128 v24, v[200:203]
    ds_write_b128 v25, v[204:207]
    ds_write_b128 v26, v[208:211]
    ds_write_b128 v27, v[212:215]
    ds_write_b128 v28, v[216:219]
    ds_write_b128 v29, v[220:223]
    ds_write_b128 v30, v[224:227]
    ds_write_b128 v31, v[228:231]
    ds_write_b128 v32, v[232:235]
    ds_write_b128 v33, v[236:239]
    ds_write_b128 v34, v[240:243]
    ds_write_b128 v35, v[244:247]
    ds_write_b128 v36, v[248:251]
    ds_write_b128 v37, v[252:255]
    ds_write_b128 v38, v[48:51]
    ds_write_b128 v39, v[52:55]
    ds_write_b128 v40, v[56:59]
    ds_write_b128 v41, v[60:63]
    ds_write_b128 v42, v[64:67]
    ds_write_b128 v43, v[68:71]
    ds_write_b128 v44, v[72:75]
    ds_write_b128 v45, v[76:79]
    s_waitcnt lgkmcnt(0)
    s_barrier
    ds_read_b64_tr_b16 a[8:9], v5 offset:0
    ds_read_b64_tr_b16 a[10:11], v5 offset:20992
    ds_read_b64_tr_b16 a[12:13], v6 offset:0
    ds_read_b64_tr_b16 a[14:15], v6 offset:20992
    ds_read_b64_tr_b16 a[20:21], v5 offset:41984
    ds_read_b64_tr_b16 a[22:23], v6 offset:41984
    ds_read_b64_tr_b16 a[32:33], v5 offset:32
    ds_read_b64_tr_b16 a[34:35], v5 offset:21024
    ds_read_b64_tr_b16 a[36:37], v6 offset:32
    ds_read_b64_tr_b16 a[38:39], v6 offset:21024
    ds_read_b64_tr_b16 a[44:45], v5 offset:42016
    ds_read_b64_tr_b16 a[46:47], v6 offset:42016
    ds_read_b64_tr_b16 a[56:57], v5 offset:64
    ds_read_b64_tr_b16 a[58:59], v5 offset:21056
    ds_read_b64_tr_b16 a[60:61], v6 offset:64
    ds_read_b64_tr_b16 a[62:63], v6 offset:21056
    ds_read_b64_tr_b16 a[68:69], v5 offset:42048
    ds_read_b64_tr_b16 a[70:71], v6 offset:42048
    ds_read_b64_tr_b16 a[80:81], v5 offset:96
    ds_read_b64_tr_b16 a[82:83], v5 offset:21088
    ds_read_b64_tr_b16 a[84:85], v6 offset:96
    ds_read_b64_tr_b16 a[86:87], v6 offset:21088
    ds_read_b64_tr_b16 a[92:93], v5 offset:42080
    ds_read_b64_tr_b16 a[94:95], v6 offset:42080
    ds_read_b64_tr_b16 a[104:105], v5 offset:128
    ds_read_b64_tr_b16 a[106:107], v5 offset:21120
    ds_read_b64_tr_b16 a[108:109], v6 offset:128
    ds_read_b64_tr_b16 a[110:111], v6 offset:21120
    ds_read_b64_tr_b16 a[116:117], v5 offset:42112
    ds_read_b64_tr_b16 a[118:119], v6 offset:42112
    ds_read_b64_tr_b16 a[128:129], v5 offset:160
    ds_read_b64_tr_b16 a[130:131], v5 offset:21152
    ds_read_b64_tr_b16 a[132:133], v6 offset:160
    ds_read_b64_tr_b16 a[134:135], v6 offset:21152
    ds_read_b64_tr_b16 a[140:141], v5 offset:42144
    ds_read_b64_tr_b16 a[142:143], v6 offset:42144
    ds_read_b64_tr_b16 a[152:153], v5 offset:192
    ds_read_b64_tr_b16 a[154:155], v5 offset:21184
    ds_read_b64_tr_b16 a[156:157], v6 offset:192
    ds_read_b64_tr_b16 a[158:159], v6 offset:21184
    ds_read_b64_tr_b16 a[164:165], v5 offset:42176
    ds_read_b64_tr_b16 a[166:167], v6 offset:42176
    ds_read_b64_tr_b16 a[176:177], v5 offset:224
    ds_read_b64_tr_b16 a[178:179], v5 offset:21216
    ds_read_b64_tr_b16 a[180:181], v6 offset:224
    ds_read_b64_tr_b16 a[182:183], v6 offset:21216
    ds_read_b64_tr_b16 a[188:189], v5 offset:42208
    ds_read_b64_tr_b16 a[190:191], v6 offset:42208
    ds_read_b64_tr_b16 a[200:201], v5 offset:256
    ds_read_b64_tr_b16 a[202:203], v5 offset:21248
    ds_read_b64_tr_b16 a[204:205], v6 offset:256
    ds_read_b64_tr_b16 a[206:207], v6 offset:21248
    ds_read_b64_tr_b16 a[212:213], v5 offset:42240
    ds_read_b64_tr_b16 a[214:215], v6 offset:42240
    ds_read_b64_tr_b16 a[224:225], v5 offset:288
    ds_read_b64_tr_b16 a[226:227], v5 offset:21280
    ds_read_b64_tr_b16 a[228:229], v6 offset:288
    ds_read_b64_tr_b16 a[230:231], v6 offset:21280
    ds_read_b64_tr_b16 a[236:237], v5 offset:42272
    ds_read_b64_tr_b16 a[238:239], v6 offset:42272
    s_waitcnt lgkmcnt(0)
    s_barrier
    v_lshlrev_b32 v5, 4, v1
    s_mul_i32 s24, s44, 12288
    v_add_u32 v6, s24, v5
    v_add_u32 v7, 4096, v6
    v_add_u32 v8, 8192, v6
    s_mul_i32 s24, s3, 327680
    s_lshl_b32 s25, s44, 10
    s_add_u32 s24, s24, s25
    v_add_u32 v9, s24, v5
    s_mov_b32 s24, 12288
    s_lshl_b32 s25, s44, 7
    s_add_u32 s24, s24, s25
    s_add_u32 s24, s24, 151560192
    v_mov_b32 v14, s24
    v_mov_b32 v15, 2146435072
    v_cmp_eq_u32 vcc, 0, v1
    s_nop 1
    v_cndmask_b32 v14, v15, v14, vcc
    s_lshl_b32 s24, s44, 7
    s_add_u32 s24, s24, 151568384
    v_mov_b32 v10, s24
    s_mov_b32 s41, 33554432
    s_mov_b32 s43, 184549376
    s_mov_b32 s40, 0
    s_mov_b32 s62, -1
    s_mov_b32 s63, 1
    s_cmp_ge_i32 s62, s63
    s_cbranch_scc1 chain1_kernel_o_en0_ok
    s_mov_b32 s61, 0
chain1_kernel_o_en0:
    buffer_load_dword v11, v10, s[8:11], 0 offen sc1
    s_waitcnt vmcnt(0)
    v_readlane_b32 s62, v11, 0
    s_cmp_ge_i32 s62, s63
    s_cbranch_scc1 chain1_kernel_o_en0_ok
    s_add_u32 s61, s61, 1
    s_cmp_ge_u32 s61, s60
    s_cbranch_scc1 chain1_kernel_o_en0_to
    s_sleep 2
    s_branch chain1_kernel_o_en0
chain1_kernel_o_en0_to:
    s_mov_b32 s60, 1
chain1_kernel_o_en0_ok:
    buffer_load_dwordx4 v[16:19], v6, s[8:11], s41 offen offset:0 sc1
    buffer_load_dwordx4 v[20:23], v6, s[8:11], s41 offen offset:1024 sc1
    buffer_load_dwordx4 v[24:27], v6, s[8:11], s41 offen offset:2048 sc1
    buffer_load_dwordx4 v[28:31], v6, s[8:11], s41 offen offset:3072 sc1
    buffer_load_dwordx4 v[32:35], v7, s[8:11], s41 offen offset:0 sc1
    buffer_load_dwordx4 v[36:39], v7, s[8:11], s41 offen offset:1024 sc1
    buffer_load_dwordx4 v[40:43], v7, s[8:11], s41 offen offset:2048 sc1
    buffer_load_dwordx4 v[44:47], v7, s[8:11], s41 offen offset:3072 sc1
    buffer_load_dwordx4 v[48:51], v8, s[8:11], s41 offen offset:0 sc1
    buffer_load_dwordx4 v[52:55], v8, s[8:11], s41 offen offset:1024 sc1
    buffer_load_dwordx4 v[56:59], v8, s[8:11], s41 offen offset:2048 sc1
    buffer_load_dwordx4 v[60:63], v8, s[8:11], s41 offen offset:3072 sc1
    s_add_u32 s41, s41, 393216
    s_waitcnt vmcnt(0)
chain1_kernel_o_seg:
    v_swap_b32 v26, v36
    v_swap_b32 v27, v37
    v_swap_b32 v50, v60
    v_swap_b32 v51, v61
    v_mfma_f32_16x16x32_bf16 v[112:115], v[16:19], a[0:3], 0
    v_mfma_f32_16x16x32_bf16 v[116:119], v[20:23], a[0:3], 0
    v_mfma_f32_16x16x32_bf16 v[120:123], v[16:19], a[24:27], 0
    v_mfma_f32_16x16x32_bf16 v[124:127], v[20:23], a[24:27], 0
    v_mfma_f32_16x16x32_bf16 v[128:131], v[16:19], a[48:51], 0
    v_mfma_f32_16x16x32_bf16 v[132:135], v[20:23], a[48:51], 0
    v_mfma_f32_16x16x32_bf16 v[136:139], v[16:19], a[72:75], 0
    v_mfma_f32_16x16x32_bf16 v[140:143], v[20:23], a[72:75], 0
    v_mfma_f32_16x16x32_bf16 v[144:147], v[16:19], a[96:99], 0
    v_mfma_f32_16x16x32_bf16 v[148:151], v[20:23], a[96:99], 0
    v_mfma_f32_16x16x32_bf16 v[152:155], v[16:19], a[120:123], 0
    v_mfma_f32_16x16x32_bf16 v[156:159], v[20:23], a[120:123], 0
    v_mfma_f32_16x16x32_bf16 v[160:163], v[16:19], a[144:147], 0
    v_mfma_f32_16x16x32_bf16 v[164:167], v[20:23], a[144:147], 0
    v_mfma_f32_16x16x32_bf16 v[168:171], v[16:19], a[168:171], 0
    v_mfma_f32_16x16x32_bf16 v[172:175], v[20:23], a[168:171], 0
    v_mfma_f32_16x16x32_bf16 v[176:179], v[16:19], a[192:195], 0
    v_mfma_f32_16x16x32_bf16 v[180:183], v[20:23], a[192:195], 0
    v_mfma_f32_16x16x32_bf16 v[184:187], v[16:19], a[216:219], 0
    v_mfma_f32_16x16x32_bf16 v[188:191], v[20:23], a[216:219], 0
    v_mfma_f32_16x16x32_bf16 v[112:115], v[28:31], a[4:7], v[112:115]
    v_mfma_f32_16x16x32_bf16 v[116:119], v[32:35], a[4:7], v[116:119]
    v_mfma_f32_16x16x32_bf16 v[120:123], v[28:31], a[28:31], v[120:123]
    v_mfma_f32_16x16x32_bf16 v[124:127], v[32:35], a[28:31], v[124:127]
    v_mfma_f32_16x16x32_bf16 v[128:131], v[28:31], a[52:55], v[128:131]
    v_mfma_f32_16x16x32_bf16 v[132:135], v[32:35], a[52:55], v[132:135]
    v_mfma_f32_16x16x32_bf16 v[136:139], v[28:31], a[76:79], v[136:139]
    v_mfma_f32_16x16x32_bf16 v[140:143], v[32:35], a[76:79], v[140:143]
    v_mfma_f32_16x16x32_bf16 v[144:147], v[28:31], a[100:103], v[144:147]
    v_mfma_f32_16x16x32_bf16 v[148:151], v[32:35], a[100:103], v[148:151]
    v_mfma_f32_16x16x32_bf16 v[152:155], v[28:31], a[124:127], v[152:155]
    v_mfma_f32_16x16x32_bf16 v[156:159], v[32:35], a[124:127], v[156:159]
    v_mfma_f32_16x16x32_bf16 v[160:163], v[28:31], a[148:151], v[160:163]
    v_mfma_f32_16x16x32_bf16 v[164:167], v[32:35], a[148:151], v[164:167]
    v_mfma_f32_16x16x32_bf16 v[168:171], v[28:31], a[172:175], v[168:171]
    v_mfma_f32_16x16x32_bf16 v[172:175], v[32:35], a[172:175], v[172:175]
    v_mfma_f32_16x16x32_bf16 v[176:179], v[28:31], a[196:199], v[176:179]
    v_mfma_f32_16x16x32_bf16 v[180:183], v[32:35], a[196:199], v[180:183]
    v_mfma_f32_16x16x32_bf16 v[184:187], v[28:31], a[220:223], v[184:187]
    v_mfma_f32_16x16x32_bf16 v[188:191], v[32:35], a[220:223], v[188:191]
    v_mfma_f32_16x16x32_bf16 v[112:115], v[40:43], a[8:11], v[112:115]
    v_mfma_f32_16x16x32_bf16 v[116:119], v[44:47], a[8:11], v[116:119]
    v_mfma_f32_16x16x32_bf16 v[120:123], v[40:43], a[32:35], v[120:123]
    v_mfma_f32_16x16x32_bf16 v[124:127], v[44:47], a[32:35], v[124:127]
    v_mfma_f32_16x16x32_bf16 v[128:131], v[40:43], a[56:59], v[128:131]
    v_mfma_f32_16x16x32_bf16 v[132:135], v[44:47], a[56:59], v[132:135]
    v_mfma_f32_16x16x32_bf16 v[136:139], v[40:43], a[80:83], v[136:139]
    v_mfma_f32_16x16x32_bf16 v[140:143], v[44:47], a[80:83], v[140:143]
    v_mfma_f32_16x16x32_bf16 v[144:147], v[40:43], a[104:107], v[144:147]
    v_mfma_f32_16x16x32_bf16 v[148:151], v[44:47], a[104:107], v[148:151]
    v_mfma_f32_16x16x32_bf16 v[152:155], v[40:43], a[128:131], v[152:155]
    v_mfma_f32_16x16x32_bf16 v[156:159], v[44:47], a[128:131], v[156:159]
    v_mfma_f32_16x16x32_bf16 v[160:163], v[40:43], a[152:155], v[160:163]
    v_mfma_f32_16x16x32_bf16 v[164:167], v[44:47], a[152:155], v[164:167]
    v_mfma_f32_16x16x32_bf16 v[168:171], v[40:43], a[176:179], v[168:171]
    v_mfma_f32_16x16x32_bf16 v[172:175], v[44:47], a[176:179], v[172:175]
    v_mfma_f32_16x16x32_bf16 v[176:179], v[40:43], a[200:203], v[176:179]
    v_mfma_f32_16x16x32_bf16 v[180:183], v[44:47], a[200:203], v[180:183]
    v_mfma_f32_16x16x32_bf16 v[184:187], v[40:43], a[224:227], v[184:187]
    v_mfma_f32_16x16x32_bf16 v[188:191], v[44:47], a[224:227], v[188:191]
    s_waitcnt vmcnt(0)
    s_barrier
    s_cmp_eq_u32 s3, 0
    s_cbranch_scc0 chain1_kernel_fp11
    v_mov_b32 v15, s40
    buffer_store_dword v15, v14, s[8:11], 0 offen sc1
chain1_kernel_fp11:
    s_add_u32 s63, s40, 2
    s_min_u32 s63, s63, 64
    s_cmp_ge_i32 s62, s63
    s_cbranch_scc1 chain1_kernel_o_en1_ok
    s_mov_b32 s61, 0
chain1_kernel_o_en1:
    buffer_load_dword v11, v10, s[8:11], 0 offen sc1
    s_waitcnt vmcnt(0)
    v_readlane_b32 s62, v11, 0
    s_cmp_ge_i32 s62, s63
    s_cbranch_scc1 chain1_kernel_o_en1_ok
    s_add_u32 s61, s61, 1
    s_cmp_ge_u32 s61, s60
    s_cbranch_scc1 chain1_kernel_o_en1_to
    s_sleep 2
    s_branch chain1_kernel_o_en1
chain1_kernel_o_en1_to:
    s_mov_b32 s60, 1
chain1_kernel_o_en1_ok:
    buffer_load_dwordx4 v[64:67], v6, s[8:11], s41 offen offset:0 sc1
    buffer_load_dwordx4 v[68:71], v6, s[8:11], s41 offen offset:1024 sc1
    buffer_load_dwordx4 v[72:75], v6, s[8:11], s41 offen offset:2048 sc1
    buffer_load_dwordx4 v[76:79], v6, s[8:11], s41 offen offset:3072 sc1
    buffer_load_dwordx4 v[80:83], v7, s[8:11], s41 offen offset:0 sc1
    buffer_load_dwordx4 v[84:87], v7, s[8:11], s41 offen offset:1024 sc1
    buffer_load_dwordx4 v[88:91], v7, s[8:11], s41 offen offset:2048 sc1
    buffer_load_dwordx4 v[92:95], v7, s[8:11], s41 offen offset:3072 sc1
    buffer_load_dwordx4 v[96:99], v8, s[8:11], s41 offen offset:0 sc1
    buffer_load_dwordx4 v[100:103], v8, s[8:11], s41 offen offset:1024 sc1
    buffer_load_dwordx4 v[104:107], v8, s[8:11], s41 offen offset:2048 sc1
    buffer_load_dwordx4 v[108:111], v8, s[8:11], s41 offen offset:3072 sc1
    s_add_u32 s41, s41, 393216
    v_mfma_f32_16x16x32_bf16 v[112:115], v[52:55], a[12:15], v[112:115]
    v_mfma_f32_16x16x32_bf16 v[116:119], v[56:59], a[12:15], v[116:119]
    v_mfma_f32_16x16x32_bf16 v[120:123], v[52:55], a[36:39], v[120:123]
    v_mfma_f32_16x16x32_bf16 v[124:127], v[56:59], a[36:39], v[124:127]
    v_mfma_f32_16x16x32_bf16 v[128:131], v[52:55], a[60:63], v[128:131]
    v_mfma_f32_16x16x32_bf16 v[132:135], v[56:59], a[60:63], v[132:135]
    v_mfma_f32_16x16x32_bf16 v[136:139], v[52:55], a[84:87], v[136:139]
    v_mfma_f32_16x16x32_bf16 v[140:143], v[56:59], a[84:87], v[140:143]
    v_mfma_f32_16x16x32_bf16 v[144:147], v[52:55], a[108:111], v[144:147]
    v_mfma_f32_16x16x32_bf16 v[148:151], v[56:59], a[108:111], v[148:151]
    v_mfma_f32_16x16x32_bf16 v[152:155], v[52:55], a[132:135], v[152:155]
    v_mfma_f32_16x16x32_bf16 v[156:159], v[56:59], a[132:135], v[156:159]
    v_mfma_f32_16x16x32_bf16 v[160:163], v[52:55], a[156:159], v[160:163]
    v_mfma_f32_16x16x32_bf16 v[164:167], v[56:59], a[156:159], v[164:167]
    v_mfma_f32_16x16x32_bf16 v[168:171], v[52:55], a[180:183], v[168:171]
    v_mfma_f32_16x16x32_bf16 v[172:175], v[56:59], a[180:183], v[172:175]
    v_mfma_f32_16x16x32_bf16 v[176:179], v[52:55], a[204:207], v[176:179]
    v_mfma_f32_16x16x32_bf16 v[180:183], v[56:59], a[204:207], v[180:183]
    v_mfma_f32_16x16x32_bf16 v[184:187], v[52:55], a[228:231], v[184:187]
    v_mfma_f32_16x16x32_bf16 v[188:191], v[56:59], a[228:231], v[188:191]
    v_mfma_f32_16x16x32_bf16 v[112:115], v[24:27], a[16:19], v[112:115]
    v_mfma_f32_16x16x32_bf16 v[116:119], v[36:39], a[16:19], v[116:119]
    v_mfma_f32_16x16x32_bf16 v[120:123], v[24:27], a[40:43], v[120:123]
    v_mfma_f32_16x16x32_bf16 v[124:127], v[36:39], a[40:43], v[124:127]
    v_mfma_f32_16x16x32_bf16 v[128:131], v[24:27], a[64:67], v[128:131]
    v_mfma_f32_16x16x32_bf16 v[132:135], v[36:39], a[64:67], v[132:135]
    v_mfma_f32_16x16x32_bf16 v[136:139], v[24:27], a[88:91], v[136:139]
    v_mfma_f32_16x16x32_bf16 v[140:143], v[36:39], a[88:91], v[140:143]
    v_mfma_f32_16x16x32_bf16 v[144:147], v[24:27], a[112:115], v[144:147]
    v_mfma_f32_16x16x32_bf16 v[148:151], v[36:39], a[112:115], v[148:151]
    v_mfma_f32_16x16x32_bf16 v[152:155], v[24:27], a[136:139], v[152:155]
    v_mfma_f32_16x16x32_bf16 v[156:159], v[36:39], a[136:139], v[156:159]
    v_mfma_f32_16x16x32_bf16 v[160:163], v[24:27], a[160:163], v[160:163]
    v_mfma_f32_16x16x32_bf16 v[164:167], v[36:39], a[160:163], v[164:167]
    v_mfma_f32_16x16x32_bf16 v[168:171], v[24:27], a[184:187], v[168:171]
    v_mfma_f32_16x16x32_bf16 v[172:175], v[36:39], a[184:187], v[172:175]
    v_mfma_f32_16x16x32_bf16 v[176:179], v[24:27], a[208:211], v[176:179]
    v_mfma_f32_16x16x32_bf16 v[180:183], v[36:39], a[208:211], v[180:183]
    v_mfma_f32_16x16x32_bf16 v[184:187], v[24:27], a[232:235], v[184:187]
    v_mfma_f32_16x16x32_bf16 v[188:191], v[36:39], a[232:235], v[188:191]
    v_mfma_f32_16x16x32_bf16 v[112:115], v[48:51], a[20:23], v[112:115]
    v_mfma_f32_16x16x32_bf16 v[116:119], v[60:63], a[20:23], v[116:119]
    v_mfma_f32_16x16x32_bf16 v[120:123], v[48:51], a[44:47], v[120:123]
    v_mfma_f32_16x16x32_bf16 v[124:127], v[60:63], a[44:47], v[124:127]
    v_mfma_f32_16x16x32_bf16 v[128:131], v[48:51], a[68:71], v[128:131]
    v_mfma_f32_16x16x32_bf16 v[132:135], v[60:63], a[68:71], v[132:135]
    v_mfma_f32_16x16x32_bf16 v[136:139], v[48:51], a[92:95], v[136:139]
    v_mfma_f32_16x16x32_bf16 v[140:143], v[60:63], a[92:95], v[140:143]
    v_mfma_f32_16x16x32_bf16 v[144:147], v[48:51], a[116:119], v[144:147]
    v_mfma_f32_16x16x32_bf16 v[148:151], v[60:63], a[116:119], v[148:151]
    v_mfma_f32_16x16x32_bf16 v[152:155], v[48:51], a[140:143], v[152:155]
    v_mfma_f32_16x16x32_bf16 v[156:159], v[60:63], a[140:143], v[156:159]
    v_mfma_f32_16x16x32_bf16 v[160:163], v[48:51], a[164:167], v[160:163]
    v_mfma_f32_16x16x32_bf16 v[164:167], v[60:63], a[164:167], v[164:167]
    v_mfma_f32_16x16x32_bf16 v[168:171], v[48:51], a[188:191], v[168:171]
    v_mfma_f32_16x16x32_bf16 v[172:175], v[60:63], a[188:191], v[172:175]
    v_mfma_f32_16x16x32_bf16 v[176:179], v[48:51], a[212:215], v[176:179]
    v_mfma_f32_16x16x32_bf16 v[180:183], v[60:63], a[212:215], v[180:183]
    v_mfma_f32_16x16x32_bf16 v[184:187], v[48:51], a[236:239], v[184:187]
    v_mfma_f32_16x16x32_bf16 v[188:191], v[60:63], a[236:239], v[188:191]
    s_mov_b32 s46, s43
    v_cvt_pk_bf16_f32 v192, v112, v113
    v_cvt_pk_bf16_f32 v193, v114, v115
    v_cvt_pk_bf16_f32 v194, v116, v117
    v_cvt_pk_bf16_f32 v195, v118, v119
    buffer_store_dwordx4 v[192:195], v9, s[8:11], s46 offen sc1
    s_add_u32 s46, s46, 32768
    v_cvt_pk_bf16_f32 v196, v120, v121
    v_cvt_pk_bf16_f32 v197, v122, v123
    v_cvt_pk_bf16_f32 v198, v124, v125
    v_cvt_pk_bf16_f32 v199, v126, v127
    buffer_store_dwordx4 v[196:199], v9, s[8:11], s46 offen sc1
    s_add_u32 s46, s46, 32768
    v_cvt_pk_bf16_f32 v200, v128, v129
    v_cvt_pk_bf16_f32 v201, v130, v131
    v_cvt_pk_bf16_f32 v202, v132, v133
    v_cvt_pk_bf16_f32 v203, v134, v135
    buffer_store_dwordx4 v[200:203], v9, s[8:11], s46 offen sc1
    s_add_u32 s46, s46, 32768
    v_cvt_pk_bf16_f32 v204, v136, v137
    v_cvt_pk_bf16_f32 v205, v138, v139
    v_cvt_pk_bf16_f32 v206, v140, v141
    v_cvt_pk_bf16_f32 v207, v142, v143
    buffer_store_dwordx4 v[204:207], v9, s[8:11], s46 offen sc1
    s_add_u32 s46, s46, 32768
    v_cvt_pk_bf16_f32 v208, v144, v145
    v_cvt_pk_bf16_f32 v209, v146, v147
    v_cvt_pk_bf16_f32 v210, v148, v149
    v_cvt_pk_bf16_f32 v211, v150, v151
    buffer_store_dwordx4 v[208:211], v9, s[8:11], s46 offen sc1
    s_add_u32 s46, s46, 32768
    v_cvt_pk_bf16_f32 v212, v152, v153
    v_cvt_pk_bf16_f32 v213, v154, v155
    v_cvt_pk_bf16_f32 v214, v156, v157
    v_cvt_pk_bf16_f32 v215, v158, v159
    buffer_store_dwordx4 v[212:215], v9, s[8:11], s46 offen sc1
    s_add_u32 s46, s46, 32768
    v_cvt_pk_bf16_f32 v216, v160, v161
    v_cvt_pk_bf16_f32 v217, v162, v163
    v_cvt_pk_bf16_f32 v218, v164, v165
    v_cvt_pk_bf16_f32 v219, v166, v167
    buffer_store_dwordx4 v[216:219], v9, s[8:11], s46 offen sc1
    s_add_u32 s46, s46, 32768
    v_cvt_pk_bf16_f32 v220, v168, v169
    v_cvt_pk_bf16_f32 v221, v170, v171
    v_cvt_pk_bf16_f32 v222, v172, v173
    v_cvt_pk_bf16_f32 v223, v174, v175
    buffer_store_dwordx4 v[220:223], v9, s[8:11], s46 offen sc1
    s_add_u32 s46, s46, 32768
    v_cvt_pk_bf16_f32 v224, v176, v177
    v_cvt_pk_bf16_f32 v225, v178, v179
    v_cvt_pk_bf16_f32 v226, v180, v181
    v_cvt_pk_bf16_f32 v227, v182, v183
    buffer_store_dwordx4 v[224:227], v9, s[8:11], s46 offen sc1
    s_add_u32 s46, s46, 32768
    v_cvt_pk_bf16_f32 v228, v184, v185
    v_cvt_pk_bf16_f32 v229, v186, v187
    v_cvt_pk_bf16_f32 v230, v188, v189
    v_cvt_pk_bf16_f32 v231, v190, v191
    buffer_store_dwordx4 v[228:231], v9, s[8:11], s46 offen sc1
    s_waitcnt vmcnt(10)
    s_add_u32 s40, s40, 1
    s_add_u32 s43, s43, 1310720
    v_swap_b32 v74, v84
    v_swap_b32 v75, v85
    v_swap_b32 v98, v108
    v_swap_b32 v99, v109
    v_mfma_f32_16x16x32_bf16 v[112:115], v[64:67], a[0:3], 0
    v_mfma_f32_16x16x32_bf16 v[116:119], v[68:71], a[0:3], 0
    v_mfma_f32_16x16x32_bf16 v[120:123], v[64:67], a[24:27], 0
    v_mfma_f32_16x16x32_bf16 v[124:127], v[68:71], a[24:27], 0
    v_mfma_f32_16x16x32_bf16 v[128:131], v[64:67], a[48:51], 0
    v_mfma_f32_16x16x32_bf16 v[132:135], v[68:71], a[48:51], 0
    v_mfma_f32_16x16x32_bf16 v[136:139], v[64:67], a[72:75], 0
    v_mfma_f32_16x16x32_bf16 v[140:143], v[68:71], a[72:75], 0
    v_mfma_f32_16x16x32_bf16 v[144:147], v[64:67], a[96:99], 0
    v_mfma_f32_16x16x32_bf16 v[148:151], v[68:71], a[96:99], 0
    v_mfma_f32_16x16x32_bf16 v[152:155], v[64:67], a[120:123], 0
    v_mfma_f32_16x16x32_bf16 v[156:159], v[68:71], a[120:123], 0
    v_mfma_f32_16x16x32_bf16 v[160:163], v[64:67], a[144:147], 0
    v_mfma_f32_16x16x32_bf16 v[164:167], v[68:71], a[144:147], 0
    v_mfma_f32_16x16x32_bf16 v[168:171], v[64:67], a[168:171], 0
    v_mfma_f32_16x16x32_bf16 v[172:175], v[68:71], a[168:171], 0
    v_mfma_f32_16x16x32_bf16 v[176:179], v[64:67], a[192:195], 0
    v_mfma_f32_16x16x32_bf16 v[180:183], v[68:71], a[192:195], 0
    v_mfma_f32_16x16x32_bf16 v[184:187], v[64:67], a[216:219], 0
    v_mfma_f32_16x16x32_bf16 v[188:191], v[68:71], a[216:219], 0
    v_mfma_f32_16x16x32_bf16 v[112:115], v[76:79], a[4:7], v[112:115]
    v_mfma_f32_16x16x32_bf16 v[116:119], v[80:83], a[4:7], v[116:119]
    v_mfma_f32_16x16x32_bf16 v[120:123], v[76:79], a[28:31], v[120:123]
    v_mfma_f32_16x16x32_bf16 v[124:127], v[80:83], a[28:31], v[124:127]
    v_mfma_f32_16x16x32_bf16 v[128:131], v[76:79], a[52:55], v[128:131]
    v_mfma_f32_16x16x32_bf16 v[132:135], v[80:83], a[52:55], v[132:135]
    v_mfma_f32_16x16x32_bf16 v[136:139], v[76:79], a[76:79], v[136:139]
    v_mfma_f32_16x16x32_bf16 v[140:143], v[80:83], a[76:79], v[140:143]
    v_mfma_f32_16x16x32_bf16 v[144:147], v[76:79], a[100:103], v[144:147]
    v_mfma_f32_16x16x32_bf16 v[148:151], v[80:83], a[100:103], v[148:151]
    v_mfma_f32_16x16x32_bf16 v[152:155], v[76:79], a[124:127], v[152:155]
    v_mfma_f32_16x16x32_bf16 v[156:159], v[80:83], a[124:127], v[156:159]
    v_mfma_f32_16x16x32_bf16 v[160:163], v[76:79], a[148:151], v[160:163]
    v_mfma_f32_16x16x32_bf16 v[164:167], v[80:83], a[148:151], v[164:167]
    v_mfma_f32_16x16x32_bf16 v[168:171], v[76:79], a[172:175], v[168:171]
    v_mfma_f32_16x16x32_bf16 v[172:175], v[80:83], a[172:175], v[172:175]
    v_mfma_f32_16x16x32_bf16 v[176:179], v[76:79], a[196:199], v[176:179]
    v_mfma_f32_16x16x32_bf16 v[180:183], v[80:83], a[196:199], v[180:183]
    v_mfma_f32_16x16x32_bf16 v[184:187], v[76:79], a[220:223], v[184:187]
    v_mfma_f32_16x16x32_bf16 v[188:191], v[80:83], a[220:223], v[188:191]
    v_mfma_f32_16x16x32_bf16 v[112:115], v[88:91], a[8:11], v[112:115]
    v_mfma_f32_16x16x32_bf16 v[116:119], v[92:95], a[8:11], v[116:119]
    v_mfma_f32_16x16x32_bf16 v[120:123], v[88:91], a[32:35], v[120:123]
    v_mfma_f32_16x16x32_bf16 v[124:127], v[92:95], a[32:35], v[124:127]
    v_mfma_f32_16x16x32_bf16 v[128:131], v[88:91], a[56:59], v[128:131]
    v_mfma_f32_16x16x32_bf16 v[132:135], v[92:95], a[56:59], v[132:135]
    v_mfma_f32_16x16x32_bf16 v[136:139], v[88:91], a[80:83], v[136:139]
    v_mfma_f32_16x16x32_bf16 v[140:143], v[92:95], a[80:83], v[140:143]
    v_mfma_f32_16x16x32_bf16 v[144:147], v[88:91], a[104:107], v[144:147]
    v_mfma_f32_16x16x32_bf16 v[148:151], v[92:95], a[104:107], v[148:151]
    v_mfma_f32_16x16x32_bf16 v[152:155], v[88:91], a[128:131], v[152:155]
    v_mfma_f32_16x16x32_bf16 v[156:159], v[92:95], a[128:131], v[156:159]
    v_mfma_f32_16x16x32_bf16 v[160:163], v[88:91], a[152:155], v[160:163]
    v_mfma_f32_16x16x32_bf16 v[164:167], v[92:95], a[152:155], v[164:167]
    v_mfma_f32_16x16x32_bf16 v[168:171], v[88:91], a[176:179], v[168:171]
    v_mfma_f32_16x16x32_bf16 v[172:175], v[92:95], a[176:179], v[172:175]
    v_mfma_f32_16x16x32_bf16 v[176:179], v[88:91], a[200:203], v[176:179]
    v_mfma_f32_16x16x32_bf16 v[180:183], v[92:95], a[200:203], v[180:183]
    v_mfma_f32_16x16x32_bf16 v[184:187], v[88:91], a[224:227], v[184:187]
    v_mfma_f32_16x16x32_bf16 v[188:191], v[92:95], a[224:227], v[188:191]
    s_waitcnt vmcnt(0)
    s_barrier
    s_cmp_eq_u32 s3, 0
    s_cbranch_scc0 chain1_kernel_fp12
    v_mov_b32 v15, s40
    buffer_store_dword v15, v14, s[8:11], 0 offen sc1
chain1_kernel_fp12:
    s_add_u32 s63, s40, 2
    s_min_u32 s63, s63, 64
    s_cmp_ge_i32 s62, s63
    s_cbranch_scc1 chain1_kernel_o_en2_ok
    s_mov_b32 s61, 0
chain1_kernel_o_en2:
    buffer_load_dword v11, v10, s[8:11], 0 offen sc1
    s_waitcnt vmcnt(0)
    v_readlane_b32 s62, v11, 0
    s_cmp_ge_i32 s62, s63
    s_cbranch_scc1 chain1_kernel_o_en2_ok
    s_add_u32 s61, s61, 1
    s_cmp_ge_u32 s61, s60
    s_cbranch_scc1 chain1_kernel_o_en2_to
    s_sleep 2
    s_branch chain1_kernel_o_en2
chain1_kernel_o_en2_to:
    s_mov_b32 s60, 1
chain1_kernel_o_en2_ok:
    buffer_load_dwordx4 v[16:19], v6, s[8:11], s41 offen offset:0 sc1
    buffer_load_dwordx4 v[20:23], v6, s[8:11], s41 offen offset:1024 sc1
    buffer_load_dwordx4 v[24:27], v6, s[8:11], s41 offen offset:2048 sc1
    buffer_load_dwordx4 v[28:31], v6, s[8:11], s41 offen offset:3072 sc1
    buffer_load_dwordx4 v[32:35], v7, s[8:11], s41 offen offset:0 sc1
    buffer_load_dwordx4 v[36:39], v7, s[8:11], s41 offen offset:1024 sc1
    buffer_load_dwordx4 v[40:43], v7, s[8:11], s41 offen offset:2048 sc1
    buffer_load_dwordx4 v[44:47], v7, s[8:11], s41 offen offset:3072 sc1
    buffer_load_dwordx4 v[48:51], v8, s[8:11], s41 offen offset:0 sc1
    buffer_load_dwordx4 v[52:55], v8, s[8:11], s41 offen offset:1024 sc1
    buffer_load_dwordx4 v[56:59], v8, s[8:11], s41 offen offset:2048 sc1
    buffer_load_dwordx4 v[60:63], v8, s[8:11], s41 offen offset:3072 sc1
    s_add_u32 s41, s41, 393216
    v_mfma_f32_16x16x32_bf16 v[112:115], v[100:103], a[12:15], v[112:115]
    v_mfma_f32_16x16x32_bf16 v[116:119], v[104:107], a[12:15], v[116:119]
    v_mfma_f32_16x16x32_bf16 v[120:123], v[100:103], a[36:39], v[120:123]
    v_mfma_f32_16x16x32_bf16 v[124:127], v[104:107], a[36:39], v[124:127]
    v_mfma_f32_16x16x32_bf16 v[128:131], v[100:103], a[60:63], v[128:131]
    v_mfma_f32_16x16x32_bf16 v[132:135], v[104:107], a[60:63], v[132:135]
    v_mfma_f32_16x16x32_bf16 v[136:139], v[100:103], a[84:87], v[136:139]
    v_mfma_f32_16x16x32_bf16 v[140:143], v[104:107], a[84:87], v[140:143]
    v_mfma_f32_16x16x32_bf16 v[144:147], v[100:103], a[108:111], v[144:147]
    v_mfma_f32_16x16x32_bf16 v[148:151], v[104:107], a[108:111], v[148:151]
    v_mfma_f32_16x16x32_bf16 v[152:155], v[100:103], a[132:135], v[152:155]
    v_mfma_f32_16x16x32_bf16 v[156:159], v[104:107], a[132:135], v[156:159]
    v_mfma_f32_16x16x32_bf16 v[160:163], v[100:103], a[156:159], v[160:163]
    v_mfma_f32_16x16x32_bf16 v[164:167], v[104:107], a[156:159], v[164:167]
    v_mfma_f32_16x16x32_bf16 v[168:171], v[100:103], a[180:183], v[168:171]
    v_mfma_f32_16x16x32_bf16 v[172:175], v[104:107], a[180:183], v[172:175]
    v_mfma_f32_16x16x32_bf16 v[176:179], v[100:103], a[204:207], v[176:179]
    v_mfma_f32_16x16x32_bf16 v[180:183], v[104:107], a[204:207], v[180:183]
    v_mfma_f32_16x16x32_bf16 v[184:187], v[100:103], a[228:231], v[184:187]
    v_mfma_f32_16x16x32_bf16 v[188:191], v[104:107], a[228:231], v[188:191]
    v_mfma_f32_16x16x32_bf16 v[112:115], v[72:75], a[16:19], v[112:115]
    v_mfma_f32_16x16x32_bf16 v[116:119], v[84:87], a[16:19], v[116:119]
    v_mfma_f32_16x16x32_bf16 v[120:123], v[72:75], a[40:43], v[120:123]
    v_mfma_f32_16x16x32_bf16 v[124:127], v[84:87], a[40:43], v[124:127]
    v_mfma_f32_16x16x32_bf16 v[128:131], v[72:75], a[64:67], v[128:131]
    v_mfma_f32_16x16x32_bf16 v[132:135], v[84:87], a[64:67], v[132:135]
    v_mfma_f32_16x16x32_bf16 v[136:139], v[72:75], a[88:91], v[136:139]
    v_mfma_f32_16x16x32_bf16 v[140:143], v[84:87], a[88:91], v[140:143]
    v_mfma_f32_16x16x32_bf16 v[144:147], v[72:75], a[112:115], v[144:147]
    v_mfma_f32_16x16x32_bf16 v[148:151], v[84:87], a[112:115], v[148:151]
    v_mfma_f32_16x16x32_bf16 v[152:155], v[72:75], a[136:139], v[152:155]
    v_mfma_f32_16x16x32_bf16 v[156:159], v[84:87], a[136:139], v[156:159]
    v_mfma_f32_16x16x32_bf16 v[160:163], v[72:75], a[160:163], v[160:163]
    v_mfma_f32_16x16x32_bf16 v[164:167], v[84:87], a[160:163], v[164:167]
    v_mfma_f32_16x16x32_bf16 v[168:171], v[72:75], a[184:187], v[168:171]
    v_mfma_f32_16x16x32_bf16 v[172:175], v[84:87], a[184:187], v[172:175]
    v_mfma_f32_16x16x32_bf16 v[176:179], v[72:75], a[208:211], v[176:179]
    v_mfma_f32_16x16x32_bf16 v[180:183], v[84:87], a[208:211], v[180:183]
    v_mfma_f32_16x16x32_bf16 v[184:187], v[72:75], a[232:235], v[184:187]
    v_mfma_f32_16x16x32_bf16 v[188:191], v[84:87], a[232:235], v[188:191]
    v_mfma_f32_16x16x32_bf16 v[112:115], v[96:99], a[20:23], v[112:115]
    v_mfma_f32_16x16x32_bf16 v[116:119], v[108:111], a[20:23], v[116:119]
    v_mfma_f32_16x16x32_bf16 v[120:123], v[96:99], a[44:47], v[120:123]
    v_mfma_f32_16x16x32_bf16 v[124:127], v[108:111], a[44:47], v[124:127]
    v_mfma_f32_16x16x32_bf16 v[128:131], v[96:99], a[68:71], v[128:131]
    v_mfma_f32_16x16x32_bf16 v[132:135], v[108:111], a[68:71], v[132:135]
    v_mfma_f32_16x16x32_bf16 v[136:139], v[96:99], a[92:95], v[136:139]
    v_mfma_f32_16x16x32_bf16 v[140:143], v[108:111], a[92:95], v[140:143]
    v_mfma_f32_16x16x32_bf16 v[144:147], v[96:99], a[116:119], v[144:147]
    v_mfma_f32_16x16x32_bf16 v[148:151], v[108:111], a[116:119], v[148:151]
    v_mfma_f32_16x16x32_bf16 v[152:155], v[96:99], a[140:143], v[152:155]
    v_mfma_f32_16x16x32_bf16 v[156:159], v[108:111], a[140:143], v[156:159]
    v_mfma_f32_16x16x32_bf16 v[160:163], v[96:99], a[164:167], v[160:163]
    v_mfma_f32_16x16x32_bf16 v[164:167], v[108:111], a[164:167], v[164:167]
    v_mfma_f32_16x16x32_bf16 v[168:171], v[96:99], a[188:191], v[168:171]
    v_mfma_f32_16x16x32_bf16 v[172:175], v[108:111], a[188:191], v[172:175]
    v_mfma_f32_16x16x32_bf16 v[176:179], v[96:99], a[212:215], v[176:179]
    v_mfma_f32_16x16x32_bf16 v[180:183], v[108:111], a[212:215], v[180:183]
    v_mfma_f32_16x16x32_bf16 v[184:187], v[96:99], a[236:239], v[184:187]
    v_mfma_f32_16x16x32_bf16 v[188:191], v[108:111], a[236:239], v[188:191]
    s_mov_b32 s46, s43
    v_cvt_pk_bf16_f32 v192, v112, v113
    v_cvt_pk_bf16_f32 v193, v114, v115
    v_cvt_pk_bf16_f32 v194, v116, v117
    v_cvt_pk_bf16_f32 v195, v118, v119
    buffer_store_dwordx4 v[192:195], v9, s[8:11], s46 offen sc1
    s_add_u32 s46, s46, 32768
    v_cvt_pk_bf16_f32 v196, v120, v121
    v_cvt_pk_bf16_f32 v197, v122, v123
    v_cvt_pk_bf16_f32 v198, v124, v125
    v_cvt_pk_bf16_f32 v199, v126, v127
    buffer_store_dwordx4 v[196:199], v9, s[8:11], s46 offen sc1
    s_add_u32 s46, s46, 32768
    v_cvt_pk_bf16_f32 v200, v128, v129
    v_cvt_pk_bf16_f32 v201, v130, v131
    v_cvt_pk_bf16_f32 v202, v132, v133
    v_cvt_pk_bf16_f32 v203, v134, v135
    buffer_store_dwordx4 v[200:203], v9, s[8:11], s46 offen sc1
    s_add_u32 s46, s46, 32768
    v_cvt_pk_bf16_f32 v204, v136, v137
    v_cvt_pk_bf16_f32 v205, v138, v139
    v_cvt_pk_bf16_f32 v206, v140, v141
    v_cvt_pk_bf16_f32 v207, v142, v143
    buffer_store_dwordx4 v[204:207], v9, s[8:11], s46 offen sc1
    s_add_u32 s46, s46, 32768
    v_cvt_pk_bf16_f32 v208, v144, v145
    v_cvt_pk_bf16_f32 v209, v146, v147
    v_cvt_pk_bf16_f32 v210, v148, v149
    v_cvt_pk_bf16_f32 v211, v150, v151
    buffer_store_dwordx4 v[208:211], v9, s[8:11], s46 offen sc1
    s_add_u32 s46, s46, 32768
    v_cvt_pk_bf16_f32 v212, v152, v153
    v_cvt_pk_bf16_f32 v213, v154, v155
    v_cvt_pk_bf16_f32 v214, v156, v157
    v_cvt_pk_bf16_f32 v215, v158, v159
    buffer_store_dwordx4 v[212:215], v9, s[8:11], s46 offen sc1
    s_add_u32 s46, s46, 32768
    v_cvt_pk_bf16_f32 v216, v160, v161
    v_cvt_pk_bf16_f32 v217, v162, v163
    v_cvt_pk_bf16_f32 v218, v164, v165
    v_cvt_pk_bf16_f32 v219, v166, v167
    buffer_store_dwordx4 v[216:219], v9, s[8:11], s46 offen sc1
    s_add_u32 s46, s46, 32768
    v_cvt_pk_bf16_f32 v220, v168, v169
    v_cvt_pk_bf16_f32 v221, v170, v171
    v_cvt_pk_bf16_f32 v222, v172, v173
    v_cvt_pk_bf16_f32 v223, v174, v175
    buffer_store_dwordx4 v[220:223], v9, s[8:11], s46 offen sc1
    s_add_u32 s46, s46, 32768
    v_cvt_pk_bf16_f32 v224, v176, v177
    v_cvt_pk_bf16_f32 v225, v178, v179
    v_cvt_pk_bf16_f32 v226, v180, v181
    v_cvt_pk_bf16_f32 v227, v182, v183
    buffer_store_dwordx4 v[224:227], v9, s[8:11], s46 offen sc1
    s_add_u32 s46, s46, 32768
    v_cvt_pk_bf16_f32 v228, v184, v185
    v_cvt_pk_bf16_f32 v229, v186, v187
    v_cvt_pk_bf16_f32 v230, v188, v189
    v_cvt_pk_bf16_f32 v231, v190, v191
    buffer_store_dwordx4 v[228:231], v9, s[8:11], s46 offen sc1
    s_waitcnt vmcnt(10)
    s_add_u32 s40, s40, 1
    s_add_u32 s43, s43, 1310720
    s_cmp_lt_u32 s40, 64
    s_cbranch_scc1 chain1_kernel_o_seg
    s_waitcnt vmcnt(0)
    s_barrier
    s_cmp_eq_u32 s3, 0
    s_cbranch_scc0 chain1_kernel_fp13
    v_mov_b32 v15, s40
    buffer_store_dword v15, v14, s[8:11], 0 offen sc1
chain1_kernel_fp13:
    s_branch chain1_kernel_end
chain1_kernel_end:
    s_endpgm
.section .rodata,"a"
.p2align 6
.amdhsa_kernel chain1_kernel
  .amdhsa_next_free_vgpr 512
  .amdhsa_next_free_sgpr 100
  .amdhsa_accum_offset 256
  .amdhsa_group_segment_fixed_size 0
  .amdhsa_kernarg_size 104
  .amdhsa_user_sgpr_count 2
  .amdhsa_user_sgpr_kernarg_segment_ptr 1
  .amdhsa_system_sgpr_workgroup_id_x 1
.end_amdhsa_kernel
.text
.globl ln_a2_kernel
.p2align 8
.type ln_a2_kernel,@function
ln_a2_kernel:
    v_lshrrev_b32 v1, 6, v0
    v_and_b32 v2, 63, v0
    s_nop 0
    v_readfirstlane_b32 s3, v1
    s_lshl_b32 s4, s2, 2
    s_add_u32 s4, s4, s3
    s_cmp_ge_u32 s4, 2048
    s_cbranch_scc1 ln_a2_kernel_end
    s_load_dwordx2 s[6:7], s[0:1], 96
    s_load_dwordx2 s[12:13], s[0:1], 96
    s_waitcnt lgkmcnt(0)
    s_add_u32 s8, s6, 4194304
    s_addc_u32 s9, s7, 0
    s_mov_b32 s10, 2621440
    s_mov_b32 s11, 0x00020000
    s_mov_b32 s16, s12
    s_mov_b32 s17, s13
    s_mov_b32 s18, 2621440
    s_mov_b32 s19, 0x00020000
    s_mul_i32 s5, s4, 1280
    v_lshlrev_b32 v3, 2, v2
    v_add_u32 v3, s5, v3
    buffer_load_dword v4, v3, s[8:11], 0 offen offset:0
    buffer_load_dword v5, v3, s[8:11], 0 offen offset:256
    buffer_load_dword v6, v3, s[8:11], 0 offen offset:512
    buffer_load_dword v7, v3, s[8:11], 0 offen offset:768
    buffer_load_dword v8, v3, s[8:11], 0 offen offset:1024
    s_waitcnt vmcnt(0)
    v_lshlrev_b32 v10, 16, v4
    v_and_b32 v11, 0xffff0000, v4
    v_lshlrev_b32 v12, 16, v5
    v_and_b32 v13, 0xffff0000, v5
    v_lshlrev_b32 v14, 16, v6
    v_and_b32 v15, 0xffff0000, v6
    v_lshlrev_b32 v16, 16, v7
    v_and_b32 v17, 0xffff0000, v7
    v_lshlrev_b32 v18, 16, v8
    v_and_b32 v19, 0xffff0000, v8
    v_add_f32 v20, v10, v11
    v_add_f32 v20, v20, v12
    v_add_f32 v20, v20, v13
    v_add_f32 v20, v20, v14
    v_add_f32 v20, v20, v15
    v_add_f32 v20, v20, v16
    v_add_f32 v20, v20, v17
    v_add_f32 v20, v20, v18
    v_add_f32 v20, v20, v19
    s_nop 1
    v_add_f32 v21, v20, v20 quad_perm:[1,0,3,2] row_mask:0xf bank_mask:0xf
    s_nop 1
    v_add_f32 v21, v21, v21 quad_perm:[2,3,0,1] row_mask:0xf bank_mask:0xf
    s_nop 1
    v_add_f32 v21, v21, v21 row_half_mirror row_mask:0xf bank_mask:0xf
    s_nop 1
    v_add_f32 v21, v21, v21 row_mirror row_mask:0xf bank_mask:0xf
    s_nop 1
    v_readlane_b32 s24, v21, 0
    v_readlane_b32 s25, v21, 16
    v_readlane_b32 s26, v21, 32
    v_readlane_b32 s27, v21, 48
    s_nop 1
    v_mov_b32 v20, s24
    v_add_f32 v20, s25, v20
    v_add_f32 v20, s26, v20
    v_add_f32 v20, s27, v20
    v_mul_f32 v20, 0.0015625, v20
    v_sub_f32 v10, v10, v20
    v_sub_f32 v11, v11, v20
    v_sub_f32 v12, v12, v20
    v_sub_f32 v13, v13, v20
    v_sub_f32 v14, v14, v20
    v_sub_f32 v15, v15, v20
    v_sub_f32 v16, v16, v20
    v_sub_f32 v17, v17, v20
    v_sub_f32 v18, v18, v20
    v_sub_f32 v19, v19, v20
    v_mul_f32 v21, v10, v10
    v_fmac_f32 v21, v11, v11
    v_fmac_f32 v21, v12, v12
    v_fmac_f32 v21, v13, v13
    v_fmac_f32 v21, v14, v14
    v_fmac_f32 v21, v15, v15
    v_fmac_f32 v21, v16, v16
    v_fmac_f32 v21, v17, v17
    v_fmac_f32 v21, v18, v18
    v_fmac_f32 v21, v19, v19
    s_nop 1
    v_add_f32 v22, v21, v21 quad_perm:[1,0,3,2] row_mask:0xf bank_mask:0xf
    s_nop 1
    v_add_f32 v22, v22, v22 quad_perm:[2,3,0,1] row_mask:0xf bank_mask:0xf
    s_nop 1
    v_add_f32 v22, v22, v22 row_half_mirror row_mask:0xf bank_mask:0xf
    s_nop 1
    v_add_f32 v22, v22, v22 row_mirror row_mask:0xf bank_mask:0xf
    s_nop 1
    v_readlane_b32 s24, v22, 0
    v_readlane_b32 s25, v22, 16
    v_readlane_b32 s26, v22, 32
    v_readlane_b32 s27, v22, 48
    s_nop 1
    v_mov_b32 v21, s24
    v_add_f32 v21, s25, v21
    v_add_f32 v21, s26, v21
    v_add_f32 v21, s27, v21
    v_mov_b32 v22, 0x3727c5ac
    v_fmac_f32 v22, 0.0015625, v21
    v_rsq_f32 v22, v22
    s_nop 0
    v_mul_f32 v10, v10, v22
    v_mul_f32 v11, v11, v22
    v_mul_f32 v12, v12, v22
    v_mul_f32 v13, v13, v22
    v_mul_f32 v14, v14, v22
    v_mul_f32 v15, v15, v22
    v_mul_f32 v16, v16, v22
    v_mul_f32 v17, v17, v22
    v_mul_f32 v18, v18, v22
    v_mul_f32 v19, v19, v22
    v_cvt_pk_bf16_f32 v4, v10, v11
    v_cvt_pk_bf16_f32 v5, v12, v13
    v_cvt_pk_bf16_f32 v6, v14, v15
    v_cvt_pk_bf16_f32 v7, v16, v17
    v_cvt_pk_bf16_f32 v8, v18, v19
    buffer_store_dword v4, v3, s[16:19], 0 offen offset:0
    buffer_store_dword v5, v3, s[16:19], 0 offen offset:256
    buffer_store_dword v6, v3, s[16:19], 0 offen offset:512
    buffer_store_dword v7, v3, s[16:19], 0 offen offset:768
    buffer_store_dword v8, v3, s[16:19], 0 offen offset:1024
ln_a2_kernel_end:
    s_endpgm
.section .rodata,"a"
.p2align 6
.amdhsa_kernel ln_a2_kernel
  .amdhsa_next_free_vgpr 32
  .amdhsa_next_free_sgpr 40
  .amdhsa_accum_offset 32
  .amdhsa_group_segment_fixed_size 0
  .amdhsa_kernarg_size 104
  .amdhsa_user_sgpr_count 2
  .amdhsa_user_sgpr_kernarg_segment_ptr 1
  .amdhsa_system_sgpr_workgroup_id_x 1
.end_amdhsa_kernel
.text
.globl kvz_a2_kernel
.p2align 8
.type kvz_a2_kernel,@function
kvz_a2_kernel:
    v_lshrrev_b32 v1, 6, v0
    v_and_b32 v2, 63, v0
    s_nop 0
    v_readfirstlane_b32 s3, v1
    s_lshl_b32 s4, s2, 2
    s_add_u32 s4, s4, s3
    s_cmp_ge_u32 s4, 512
    s_cbranch_scc1 kvz_a2_kernel_end
    s_load_dwordx2 s[6:7], s[0:1], 96
    s_waitcnt lgkmcnt(0)
    s_mov_b32 s8, s6
    s_mov_b32 s9, s7
    s_mov_b32 s10, 268435456
    s_mov_b32 s11, 0x00020000
    s_lshr_b32 s5, s4, 4
    s_and_b32 s12, s4, 15
    s_mul_i32 s13, s5, 20
    v_and_b32 v3, 15, v2
    v_lshrrev_b32 v4, 4, v2
    s_lshl_b32 s14, s12, 7
    v_lshlrev_b32 v5, 3, v4
    v_add_u32 v5, s14, v5
    v_add_u32 v6, 0, v3
    v_min_u32 v8, 19, v6
    v_add_u32 v8, s13, v8
    v_lshlrev_b32 v8, 11, v8
    v_add_u32 v8, v8, v5
    v_lshlrev_b32 v8, 1, v8
    v_add_u32 v8, 12582912, v8
    v_add_u32 v10, 2621440, v8
    v_add_u32 v7, 16, v3
    v_min_u32 v9, 19, v7
    v_add_u32 v9, s13, v9
    v_lshlrev_b32 v9, 11, v9
    v_add_u32 v9, v9, v5
    v_lshlrev_b32 v9, 1, v9
    v_add_u32 v9, 12582912, v9
    v_add_u32 v11, 2621440, v9
    v_accvgpr_write_b32 a0, 0
    v_accvgpr_write_b32 a1, 0
    v_accvgpr_write_b32 a2, 0
    v_accvgpr_write_b32 a3, 0
    v_accvgpr_write_b32 a4, 0
    v_accvgpr_write_b32 a5, 0
    v_accvgpr_write_b32 a6, 0
    v_accvgpr_write_b32 a7, 0
    v_accvgpr_write_b32 a8, 0
    v_accvgpr_write_b32 a9, 0
    v_accvgpr_write_b32 a10, 0
    v_accvgpr_write_b32 a11, 0
    v_accvgpr_write_b32 a12, 0
    v_accvgpr_write_b32 a13, 0
    v_accvgpr_write_b32 a14, 0
    v_accvgpr_write_b32 a15, 0
    v_cmp_gt_u32 s[16:17], 20, v7
    v_cmp_eq_u32 s[18:19], 20, v7
    buffer_load_dwordx4 v[16:19], v8, s[8:11], 0 offen offset:0
    buffer_load_dwordx4 v[24:27], v10, s[8:11], 0 offen offset:0
    buffer_load_dwordx4 v[20:23], v9, s[8:11], 0 offen offset:0
    buffer_load_dwordx4 v[28:31], v11, s[8:11], 0 offen offset:0
    s_waitcnt vmcnt(0)
    v_lshlrev_b32 v32, 16, v16
    v_and_b32 v33, 0xffff0000, v16
    v_mul_f32 v36, 1.4426950408889634, v32
    v_exp_f32 v36, v36
    v_add_f32 v34, 1.0, v32
    v_cmp_lt_f32 vcc, 0, v32
    s_nop 1
    v_cndmask_b32 v34, v36, v34, vcc
    v_add_f32 v34, 0x358637bd, v34
    v_mul_f32 v36, 1.4426950408889634, v33
    v_exp_f32 v36, v36
    v_add_f32 v35, 1.0, v33
    v_cmp_lt_f32 vcc, 0, v33
    s_nop 1
    v_cndmask_b32 v35, v36, v35, vcc
    v_add_f32 v35, 0x358637bd, v35
    v_cvt_pk_bf16_f32 v16, v34, v35
    v_lshlrev_b32 v32, 16, v17
    v_and_b32 v33, 0xffff0000, v17
    v_mul_f32 v36, 1.4426950408889634, v32
    v_exp_f32 v36, v36
    v_add_f32 v34, 1.0, v32
    v_cmp_lt_f32 vcc, 0, v32
    s_nop 1
    v_cndmask_b32 v34, v36, v34, vcc
    v_add_f32 v34, 0x358637bd, v34
    v_mul_f32 v36, 1.4426950408889634, v33
    v_exp_f32 v36, v36
    v_add_f32 v35, 1.0, v33
    v_cmp_lt_f32 vcc, 0, v33
    s_nop 1
    v_cndmask_b32 v35, v36, v35, vcc
    v_add_f32 v35, 0x358637bd, v35
    v_cvt_pk_bf16_f32 v17, v34, v35
    v_lshlrev_b32 v32, 16, v18
    v_and_b32 v33, 0xffff0000, v18
    v_mul_f32 v36, 1.4426950408889634, v32
    v_exp_f32 v36, v36
    v_add_f32 v34, 1.0, v32
    v_cmp_lt_f32 vcc, 0, v32
    s_nop 1
    v_cndmask_b32 v34, v36, v34, vcc
    v_add_f32 v34, 0x358637bd, v34
    v_mul_f32 v36, 1.4426950408889634, v33
    v_exp_f32 v36, v36
    v_add_f32 v35, 1.0, v33
    v_cmp_lt_f32 vcc, 0, v33
    s_nop 1
    v_cndmask_b32 v35, v36, v35, vcc
    v_add_f32 v35, 0x358637bd, v35
    v_cvt_pk_bf16_f32 v18, v34, v35
    v_lshlrev_b32 v32, 16, v19
    v_and_b32 v33, 0xffff0000, v19
    v_mul_f32 v36, 1.4426950408889634, v32
    v_exp_f32 v36, v36
    v_add_f32 v34, 1.0, v32
    v_cmp_lt_f32 vcc, 0, v32
    s_nop 1
    v_cndmask_b32 v34, v36, v34, vcc
    v_add_f32 v34, 0x358637bd, v34
    v_mul_f32 v36, 1.4426950408889634, v33
    v_exp_f32 v36, v36
    v_add_f32 v35, 1.0, v33
    v_cmp_lt_f32 vcc, 0, v33
    s_nop 1
    v_cndmask_b32 v35, v36, v35, vcc
    v_add_f32 v35, 0x358637bd, v35
    v_cvt_pk_bf16_f32 v19, v34, v35
    v_lshlrev_b32 v32, 16, v20
    v_and_b32 v33, 0xffff0000, v20
    v_mul_f32 v36, 1.4426950408889634, v32
    v_exp_f32 v36, v36
    v_add_f32 v34, 1.0, v32
    v_cmp_lt_f32 vcc, 0, v32
    s_nop 1
    v_cndmask_b32 v34, v36, v34, vcc
    v_add_f32 v34, 0x358637bd, v34
    v_mul_f32 v36, 1.4426950408889634, v33
    v_exp_f32 v36, v36
    v_add_f32 v35, 1.0, v33
    v_cmp_lt_f32 vcc, 0, v33
    s_nop 1
    v_cndmask_b32 v35, v36, v35, vcc
    v_add_f32 v35, 0x358637bd, v35
    v_cvt_pk_bf16_f32 v20, v34, v35
    v_lshlrev_b32 v32, 16, v21
    v_and_b32 v33, 0xffff0000, v21
    v_mul_f32 v36, 1.4426950408889634, v32
    v_exp_f32 v36, v36
    v_add_f32 v34, 1.0, v32
    v_cmp_lt_f32 vcc, 0, v32
    s_nop 1
    v_cndmask_b32 v34, v36, v34, vcc
    v_add_f32 v34, 0x358637bd, v34
    v_mul_f32 v36, 1.4426950408889634, v33
    v_exp_f32 v36, v36
    v_add_f32 v35, 1.0, v33
    v_cmp_lt_f32 vcc, 0, v33
    s_nop 1
    v_cndmask_b32 v35, v36, v35, vcc
    v_add_f32 v35, 0x358637bd, v35
    v_cvt_pk_bf16_f32 v21, v34, v35
    v_lshlrev_b32 v32, 16, v22
    v_and_b32 v33, 0xffff0000, v22
    v_mul_f32 v36, 1.4426950408889634, v32
    v_exp_f32 v36, v36
    v_add_f32 v34, 1.0, v32
    v_cmp_lt_f32 vcc, 0, v32
    s_nop 1
    v_cndmask_b32 v34, v36, v34, vcc
    v_add_f32 v34, 0x358637bd, v34
    v_mul_f32 v36, 1.4426950408889634, v33
    v_exp_f32 v36, v36
    v_add_f32 v35, 1.0, v33
    v_cmp_lt_f32 vcc, 0, v33
    s_nop 1
    v_cndmask_b32 v35, v36, v35, vcc
    v_add_f32 v35, 0x358637bd, v35
    v_cvt_pk_bf16_f32 v22, v34, v35
    v_lshlrev_b32 v32, 16, v23
    v_and_b32 v33, 0xffff0000, v23
    v_mul_f32 v36, 1.4426950408889634, v32
    v_exp_f32 v36, v36
    v_add_f32 v34, 1.0, v32
    v_cmp_lt_f32 vcc, 0, v32
    s_nop 1
    v_cndmask_b32 v34, v36, v34, vcc
    v_add_f32 v34, 0x358637bd, v34
    v_mul_f32 v36, 1.4426950408889634, v33
    v_exp_f32 v36, v36
    v_add_f32 v35, 1.0, v33
    v_cmp_lt_f32 vcc, 0, v33
    s_nop 1
    v_cndmask_b32 v35, v36, v35, vcc
    v_add_f32 v35, 0x358637bd, v35
    v_cvt_pk_bf16_f32 v23, v34, v35
    v_mov_b32 v37, 0x3f803f80
    v_cndmask_b32 v20, 0, v20, s[16:17]
    v_cndmask_b32 v28, 0, v28, s[16:17]
    v_cndmask_b32 v28, v28, v37, s[18:19]
    v_cndmask_b32 v21, 0, v21, s[16:17]
    v_cndmask_b32 v29, 0, v29, s[16:17]
    v_cndmask_b32 v29, v29, v37, s[18:19]
    v_cndmask_b32 v22, 0, v22, s[16:17]
    v_cndmask_b32 v30, 0, v30, s[16:17]
    v_cndmask_b32 v30, v30, v37, s[18:19]
    v_cndmask_b32 v23, 0, v23, s[16:17]
    v_cndmask_b32 v31, 0, v31, s[16:17]
    v_cndmask_b32 v31, v31, v37, s[18:19]
    s_nop 1
    v_mfma_f32_16x16x32_bf16 a[0:3], v[24:27], v[16:19], a[0:3]
    v_mfma_f32_16x16x32_bf16 a[4:7], v[24:27], v[20:23], a[4:7]
    v_mfma_f32_16x16x32_bf16 a[8:11], v[28:31], v[16:19], a[8:11]
    v_mfma_f32_16x16x32_bf16 a[12:15], v[28:31], v[20:23], a[12:15]
    buffer_load_dwordx4 v[16:19], v8, s[8:11], 0 offen offset:64
    buffer_load_dwordx4 v[24:27], v10, s[8:11], 0 offen offset:64
    buffer_load_dwordx4 v[20:23], v9, s[8:11], 0 offen offset:64
    buffer_load_dwordx4 v[28:31], v11, s[8:11], 0 offen offset:64
    s_waitcnt vmcnt(0)
    v_lshlrev_b32 v32, 16, v16
    v_and_b32 v33, 0xffff0000, v16
    v_mul_f32 v36, 1.4426950408889634, v32
    v_exp_f32 v36, v36
    v_add_f32 v34, 1.0, v32
    v_cmp_lt_f32 vcc, 0, v32
    s_nop 1
    v_cndmask_b32 v34, v36, v34, vcc
    v_add_f32 v34, 0x358637bd, v34
    v_mul_f32 v36, 1.4426950408889634, v33
    v_exp_f32 v36, v36
    v_add_f32 v35, 1.0, v33
    v_cmp_lt_f32 vcc, 0, v33
    s_nop 1
    v_cndmask_b32 v35, v36, v35, vcc
    v_add_f32 v35, 0x358637bd, v35
    v_cvt_pk_bf16_f32 v16, v34, v35
    v_lshlrev_b32 v32, 16, v17
    v_and_b32 v33, 0xffff0000, v17
    v_mul_f32 v36, 1.4426950408889634, v32
    v_exp_f32 v36, v36
    v_add_f32 v34, 1.0, v32
    v_cmp_lt_f32 vcc, 0, v32
    s_nop 1
    v_cndmask_b32 v34, v36, v34, vcc
    v_add_f32 v34, 0x358637bd, v34
    v_mul_f32 v36, 1.4426950408889634, v33
    v_exp_f32 v36, v36
    v_add_f32 v35, 1.0, v33
    v_cmp_lt_f32 vcc, 0, v33
    s_nop 1
    v_cndmask_b32 v35, v36, v35, vcc
    v_add_f32 v35, 0x358637bd, v35
    v_cvt_pk_bf16_f32 v17, v34, v35
    v_lshlrev_b32 v32, 16, v18
    v_and_b32 v33, 0xffff0000, v18
    v_mul_f32 v36, 1.4426950408889634, v32
    v_exp_f32 v36, v36
    v_add_f32 v34, 1.0, v32
    v_cmp_lt_f32 vcc, 0, v32
    s_nop 1
    v_cndmask_b32 v34, v36, v34, vcc
    v_add_f32 v34, 0x358637bd, v34
    v_mul_f32 v36, 1.4426950408889634, v33
    v_exp_f32 v36, v36
    v_add_f32 v35, 1.0, v33
    v_cmp_lt_f32 vcc, 0, v33
    s_nop 1
    v_cndmask_b32 v35, v36, v35, vcc
    v_add_f32 v35, 0x358637bd, v35
    v_cvt_pk_bf16_f32 v18, v34, v35
    v_lshlrev_b32 v32, 16, v19
    v_and_b32 v33, 0xffff0000, v19
    v_mul_f32 v36, 1.4426950408889634, v32
    v_exp_f32 v36, v36
    v_add_f32 v34, 1.0, v32
    v_cmp_lt_f32 vcc, 0, v32
    s_nop 1
    v_cndmask_b32 v34, v36, v34, vcc
    v_add_f32 v34, 0x358637bd, v34
    v_mul_f32 v36, 1.4426950408889634, v33
    v_exp_f32 v36, v36
    v_add_f32 v35, 1.0, v33
    v_cmp_lt_f32 vcc, 0, v33
    s_nop 1
    v_cndmask_b32 v35, v36, v35, vcc
    v_add_f32 v35, 0x358637bd, v35
    v_cvt_pk_bf16_f32 v19, v34, v35
    v_lshlrev_b32 v32, 16, v20
    v_and_b32 v33, 0xffff0000, v20
    v_mul_f32 v36, 1.4426950408889634, v32
    v_exp_f32 v36, v36
    v_add_f32 v34, 1.0, v32
    v_cmp_lt_f32 vcc, 0, v32
    s_nop 1
    v_cndmask_b32 v34, v36, v34, vcc
    v_add_f32 v34, 0x358637bd, v34
    v_mul_f32 v36, 1.4426950408889634, v33
    v_exp_f32 v36, v36
    v_add_f32 v35, 1.0, v33
    v_cmp_lt_f32 vcc, 0, v33
    s_nop 1
    v_cndmask_b32 v35, v36, v35, vcc
    v_add_f32 v35, 0x358637bd, v35
    v_cvt_pk_bf16_f32 v20, v34, v35
    v_lshlrev_b32 v32, 16, v21
    v_and_b32 v33, 0xffff0000, v21
    v_mul_f32 v36, 1.4426950408889634, v32
    v_exp_f32 v36, v36
    v_add_f32 v34, 1.0, v32
    v_cmp_lt_f32 vcc, 0, v32
    s_nop 1
    v_cndmask_b32 v34, v36, v34, vcc
    v_add_f32 v34, 0x358637bd, v34
    v_mul_f32 v36, 1.4426950408889634, v33
    v_exp_f32 v36, v36
    v_add_f32 v35, 1.0, v33
    v_cmp_lt_f32 vcc, 0, v33
    s_nop 1
    v_cndmask_b32 v35, v36, v35, vcc
    v_add_f32 v35, 0x358637bd, v35
    v_cvt_pk_bf16_f32 v21, v34, v35
    v_lshlrev_b32 v32, 16, v22
    v_and_b32 v33, 0xffff0000, v22
    v_mul_f32 v36, 1.4426950408889634, v32
    v_exp_f32 v36, v36
    v_add_f32 v34, 1.0, v32
    v_cmp_lt_f32 vcc, 0, v32
    s_nop 1
    v_cndmask_b32 v34, v36, v34, vcc
    v_add_f32 v34, 0x358637bd, v34
    v_mul_f32 v36, 1.4426950408889634, v33
    v_exp_f32 v36, v36
    v_add_f32 v35, 1.0, v33
    v_cmp_lt_f32 vcc, 0, v33
    s_nop 1
    v_cndmask_b32 v35, v36, v35, vcc
    v_add_f32 v35, 0x358637bd, v35
    v_cvt_pk_bf16_f32 v22, v34, v35
    v_lshlrev_b32 v32, 16, v23
    v_and_b32 v33, 0xffff0000, v23
    v_mul_f32 v36, 1.4426950408889634, v32
    v_exp_f32 v36, v36
    v_add_f32 v34, 1.0, v32
    v_cmp_lt_f32 vcc, 0, v32
    s_nop 1
    v_cndmask_b32 v34, v36, v34, vcc
    v_add_f32 v34, 0x358637bd, v34
    v_mul_f32 v36, 1.4426950408889634, v33
    v_exp_f32 v36, v36
    v_add_f32 v35, 1.0, v33
    v_cmp_lt_f32 vcc, 0, v33
    s_nop 1
    v_cndmask_b32 v35, v36, v35, vcc
    v_add_f32 v35, 0x358637bd, v35
    v_cvt_pk_bf16_f32 v23, v34, v35
    v_mov_b32 v37, 0x3f803f80
    v_cndmask_b32 v20, 0, v20, s[16:17]
    v_cndmask_b32 v28, 0, v28, s[16:17]
    v_cndmask_b32 v28, v28, v37, s[18:19]
    v_cndmask_b32 v21, 0, v21, s[16:17]
    v_cndmask_b32 v29, 0, v29, s[16:17]
    v_cndmask_b32 v29, v29, v37, s[18:19]
    v_cndmask_b32 v22, 0, v22, s[16:17]
    v_cndmask_b32 v30, 0, v30, s[16:17]
    v_cndmask_b32 v30, v30, v37, s[18:19]
    v_cndmask_b32 v23, 0, v23, s[16:17]
    v_cndmask_b32 v31, 0, v31, s[16:17]
    v_cndmask_b32 v31, v31, v37, s[18:19]
    s_nop 1
    v_mfma_f32_16x16x32_bf16 a[0:3], v[24:27], v[16:19], a[0:3]
    v_mfma_f32_16x16x32_bf16 a[4:7], v[24:27], v[20:23], a[4:7]
    v_mfma_f32_16x16x32_bf16 a[8:11], v[28:31], v[16:19], a[8:11]
    v_mfma_f32_16x16x32_bf16 a[12:15], v[28:31], v[20:23], a[12:15]
    buffer_load_dwordx4 v[16:19], v8, s[8:11], 0 offen offset:128
    buffer_load_dwordx4 v[24:27], v10, s[8:11], 0 offen offset:128
    buffer_load_dwordx4 v[20:23], v9, s[8:11], 0 offen offset:128
    buffer_load_dwordx4 v[28:31], v11, s[8:11], 0 offen offset:128
    s_waitcnt vmcnt(0)
    v_lshlrev_b32 v32, 16, v16
    v_and_b32 v33, 0xffff0000, v16
    v_mul_f32 v36, 1.4426950408889634, v32
    v_exp_f32 v36, v36
    v_add_f32 v34, 1.0, v32
    v_cmp_lt_f32 vcc, 0, v32
    s_nop 1
    v_cndmask_b32 v34, v36, v34, vcc
    v_add_f32 v34, 0x358637bd, v34
    v_mul_f32 v36, 1.4426950408889634, v33
    v_exp_f32 v36, v36
    v_add_f32 v35, 1.0, v33
    v_cmp_lt_f32 vcc, 0, v33
    s_nop 1
    v_cndmask_b32 v35, v36, v35, vcc
    v_add_f32 v35, 0x358637bd, v35
    v_cvt_pk_bf16_f32 v16, v34, v35
    v_lshlrev_b32 v32, 16, v17
    v_and_b32 v33, 0xffff0000, v17
    v_mul_f32 v36, 1.4426950408889634, v32
    v_exp_f32 v36, v36
    v_add_f32 v34, 1.0, v32
    v_cmp_lt_f32 vcc, 0, v32
    s_nop 1
    v_cndmask_b32 v34, v36, v34, vcc
    v_add_f32 v34, 0x358637bd, v34
    v_mul_f32 v36, 1.4426950408889634, v33
    v_exp_f32 v36, v36
    v_add_f32 v35, 1.0, v33
    v_cmp_lt_f32 vcc, 0, v33
    s_nop 1
    v_cndmask_b32 v35, v36, v35, vcc
    v_add_f32 v35, 0x358637bd, v35
    v_cvt_pk_bf16_f32 v17, v34, v35
    v_lshlrev_b32 v32, 16, v18
    v_and_b32 v33, 0xffff0000, v18
    v_mul_f32 v36, 1.4426950408889634, v32
    v_exp_f32 v36, v36
    v_add_f32 v34, 1.0, v32
    v_cmp_lt_f32 vcc, 0, v32
    s_nop 1
    v_cndmask_b32 v34, v36, v34, vcc
    v_add_f32 v34, 0x358637bd, v34
    v_mul_f32 v36, 1.4426950408889634, v33
    v_exp_f32 v36, v36
    v_add_f32 v35, 1.0, v33
    v_cmp_lt_f32 vcc, 0, v33
    s_nop 1
    v_cndmask_b32 v35, v36, v35, vcc
    v_add_f32 v35, 0x358637bd, v35
    v_cvt_pk_bf16_f32 v18, v34, v35
    v_lshlrev_b32 v32, 16, v19
    v_and_b32 v33, 0xffff0000, v19
    v_mul_f32 v36, 1.4426950408889634, v32
    v_exp_f32 v36, v36
    v_add_f32 v34, 1.0, v32
    v_cmp_lt_f32 vcc, 0, v32
    s_nop 1
    v_cndmask_b32 v34, v36, v34, vcc
    v_add_f32 v34, 0x358637bd, v34
    v_mul_f32 v36, 1.4426950408889634, v33
    v_exp_f32 v36, v36
    v_add_f32 v35, 1.0, v33
    v_cmp_lt_f32 vcc, 0, v33
    s_nop 1
    v_cndmask_b32 v35, v36, v35, vcc
    v_add_f32 v35, 0x358637bd, v35
    v_cvt_pk_bf16_f32 v19, v34, v35
    v_lshlrev_b32 v32, 16, v20
    v_and_b32 v33, 0xffff0000, v20
    v_mul_f32 v36, 1.4426950408889634, v32
    v_exp_f32 v36, v36
    v_add_f32 v34, 1.0, v32
    v_cmp_lt_f32 vcc, 0, v32
    s_nop 1
    v_cndmask_b32 v34, v36, v34, vcc
    v_add_f32 v34, 0x358637bd, v34
    v_mul_f32 v36, 1.4426950408889634, v33
    v_exp_f32 v36, v36
    v_add_f32 v35, 1.0, v33
    v_cmp_lt_f32 vcc, 0, v33
    s_nop 1
    v_cndmask_b32 v35, v36, v35, vcc
    v_add_f32 v35, 0x358637bd, v35
    v_cvt_pk_bf16_f32 v20, v34, v35
    v_lshlrev_b32 v32, 16, v21
    v_and_b32 v33, 0xffff0000, v21
    v_mul_f32 v36, 1.4426950408889634, v32
    v_exp_f32 v36, v36
    v_add_f32 v34, 1.0, v32
    v_cmp_lt_f32 vcc, 0, v32
    s_nop 1
    v_cndmask_b32 v34, v36, v34, vcc
    v_add_f32 v34, 0x358637bd, v34
    v_mul_f32 v36, 1.4426950408889634, v33
    v_exp_f32 v36, v36
    v_add_f32 v35, 1.0, v33
    v_cmp_lt_f32 vcc, 0, v33
    s_nop 1
    v_cndmask_b32 v35, v36, v35, vcc
    v_add_f32 v35, 0x358637bd, v35
    v_cvt_pk_bf16_f32 v21, v34, v35
    v_lshlrev_b32 v32, 16, v22
    v_and_b32 v33, 0xffff0000, v22
    v_mul_f32 v36, 1.4426950408889634, v32
    v_exp_f32 v36, v36
    v_add_f32 v34, 1.0, v32
    v_cmp_lt_f32 vcc, 0, v32
    s_nop 1
    v_cndmask_b32 v34, v36, v34, vcc
    v_add_f32 v34, 0x358637bd, v34
    v_mul_f32 v36, 1.4426950408889634, v33
    v_exp_f32 v36, v36
    v_add_f32 v35, 1.0, v33
    v_cmp_lt_f32 vcc, 0, v33
    s_nop 1
    v_cndmask_b32 v35, v36, v35, vcc
    v_add_f32 v35, 0x358637bd, v35
    v_cvt_pk_bf16_f32 v22, v34, v35
    v_lshlrev_b32 v32, 16, v23
    v_and_b32 v33, 0xffff0000, v23
    v_mul_f32 v36, 1.4426950408889634, v32
    v_exp_f32 v36, v36
    v_add_f32 v34, 1.0, v32
    v_cmp_lt_f32 vcc, 0, v32
    s_nop 1
    v_cndmask_b32 v34, v36, v34, vcc
    v_add_f32 v34, 0x358637bd, v34
    v_mul_f32 v36, 1.4426950408889634, v33
    v_exp_f32 v36, v36
    v_add_f32 v35, 1.0, v33
    v_cmp_lt_f32 vcc, 0, v33
    s_nop 1
    v_cndmask_b32 v35, v36, v35, vcc
    v_add_f32 v35, 0x358637bd, v35
    v_cvt_pk_bf16_f32 v23, v34, v35
    v_mov_b32 v37, 0x3f803f80
    v_cndmask_b32 v20, 0, v20, s[16:17]
    v_cndmask_b32 v28, 0, v28, s[16:17]
    v_cndmask_b32 v28, v28, v37, s[18:19]
    v_cndmask_b32 v21, 0, v21, s[16:17]
    v_cndmask_b32 v29, 0, v29, s[16:17]
    v_cndmask_b32 v29, v29, v37, s[18:19]
    v_cndmask_b32 v22, 0, v22, s[16:17]
    v_cndmask_b32 v30, 0, v30, s[16:17]
    v_cndmask_b32 v30, v30, v37, s[18:19]
    v_cndmask_b32 v23, 0, v23, s[16:17]
    v_cndmask_b32 v31, 0, v31, s[16:17]
    v_cndmask_b32 v31, v31, v37, s[18:19]
    s_nop 1
    v_mfma_f32_16x16x32_bf16 a[0:3], v[24:27], v[16:19], a[0:3]
    v_mfma_f32_16x16x32_bf16 a[4:7], v[24:27], v[20:23], a[4:7]
    v_mfma_f32_16x16x32_bf16 a[8:11], v[28:31], v[16:19], a[8:11]
    v_mfma_f32_16x16x32_bf16 a[12:15], v[28:31], v[20:23], a[12:15]
    buffer_load_dwordx4 v[16:19], v8, s[8:11], 0 offen offset:192
    buffer_load_dwordx4 v[24:27], v10, s[8:11], 0 offen offset:192
    buffer_load_dwordx4 v[20:23], v9, s[8:11], 0 offen offset:192
    buffer_load_dwordx4 v[28:31], v11, s[8:11], 0 offen offset:192
    s_waitcnt vmcnt(0)
    v_lshlrev_b32 v32, 16, v16
    v_and_b32 v33, 0xffff0000, v16
    v_mul_f32 v36, 1.4426950408889634, v32
    v_exp_f32 v36, v36
    v_add_f32 v34, 1.0, v32
    v_cmp_lt_f32 vcc, 0, v32
    s_nop 1
    v_cndmask_b32 v34, v36, v34, vcc
    v_add_f32 v34, 0x358637bd, v34
    v_mul_f32 v36, 1.4426950408889634, v33
    v_exp_f32 v36, v36
    v_add_f32 v35, 1.0, v33
    v_cmp_lt_f32 vcc, 0, v33
    s_nop 1
    v_cndmask_b32 v35, v36, v35, vcc
    v_add_f32 v35, 0x358637bd, v35
    v_cvt_pk_bf16_f32 v16, v34, v35
    v_lshlrev_b32 v32, 16, v17
    v_and_b32 v33, 0xffff0000, v17
    v_mul_f32 v36, 1.4426950408889634, v32
    v_exp_f32 v36, v36
    v_add_f32 v34, 1.0, v32
    v_cmp_lt_f32 vcc, 0, v32
    s_nop 1
    v_cndmask_b32 v34, v36, v34, vcc
    v_add_f32 v34, 0x358637bd, v34
    v_mul_f32 v36, 1.4426950408889634, v33
    v_exp_f32 v36, v36
    v_add_f32 v35, 1.0, v33
    v_cmp_lt_f32 vcc, 0, v33
    s_nop 1
    v_cndmask_b32 v35, v36, v35, vcc
    v_add_f32 v35, 0x358637bd, v35
    v_cvt_pk_bf16_f32 v17, v34, v35
    v_lshlrev_b32 v32, 16, v18
    v_and_b32 v33, 0xffff0000, v18
    v_mul_f32 v36, 1.4426950408889634, v32
    v_exp_f32 v36, v36
    v_add_f32 v34, 1.0, v32
    v_cmp_lt_f32 vcc, 0, v32
    s_nop 1
    v_cndmask_b32 v34, v36, v34, vcc
    v_add_f32 v34, 0x358637bd, v34
    v_mul_f32 v36, 1.4426950408889634, v33
    v_exp_f32 v36, v36
    v_add_f32 v35, 1.0, v33
    v_cmp_lt_f32 vcc, 0, v33
    s_nop 1
    v_cndmask_b32 v35, v36, v35, vcc
    v_add_f32 v35, 0x358637bd, v35
    v_cvt_pk_bf16_f32 v18, v34, v35
    v_lshlrev_b32 v32, 16, v19
    v_and_b32 v33, 0xffff0000, v19
    v_mul_f32 v36, 1.4426950408889634, v32
    v_exp_f32 v36, v36
    v_add_f32 v34, 1.0, v32
    v_cmp_lt_f32 vcc, 0, v32
    s_nop 1
    v_cndmask_b32 v34, v36, v34, vcc
    v_add_f32 v34, 0x358637bd, v34
    v_mul_f32 v36, 1.4426950408889634, v33
    v_exp_f32 v36, v36
    v_add_f32 v35, 1.0, v33
    v_cmp_lt_f32 vcc, 0, v33
    s_nop 1
    v_cndmask_b32 v35, v36, v35, vcc
    v_add_f32 v35, 0x358637bd, v35
    v_cvt_pk_bf16_f32 v19, v34, v35
    v_lshlrev_b32 v32, 16, v20
    v_and_b32 v33, 0xffff0000, v20
    v_mul_f32 v36, 1.4426950408889634, v32
    v_exp_f32 v36, v36
    v_add_f32 v34, 1.0, v32
    v_cmp_lt_f32 vcc, 0, v32
    s_nop 1
    v_cndmask_b32 v34, v36, v34, vcc
    v_add_f32 v34, 0x358637bd, v34
    v_mul_f32 v36, 1.4426950408889634, v33
    v_exp_f32 v36, v36
    v_add_f32 v35, 1.0, v33
    v_cmp_lt_f32 vcc, 0, v33
    s_nop 1
    v_cndmask_b32 v35, v36, v35, vcc
    v_add_f32 v35, 0x358637bd, v35
    v_cvt_pk_bf16_f32 v20, v34, v35
    v_lshlrev_b32 v32, 16, v21
    v_and_b32 v33, 0xffff0000, v21
    v_mul_f32 v36, 1.4426950408889634, v32
    v_exp_f32 v36, v36
    v_add_f32 v34, 1.0, v32
    v_cmp_lt_f32 vcc, 0, v32
    s_nop 1
    v_cndmask_b32 v34, v36, v34, vcc
    v_add_f32 v34, 0x358637bd, v34
    v_mul_f32 v36, 1.4426950408889634, v33
    v_exp_f32 v36, v36
    v_add_f32 v35, 1.0, v33
    v_cmp_lt_f32 vcc, 0, v33
    s_nop 1
    v_cndmask_b32 v35, v36, v35, vcc
    v_add_f32 v35, 0x358637bd, v35
    v_cvt_pk_bf16_f32 v21, v34, v35
    v_lshlrev_b32 v32, 16, v22
    v_and_b32 v33, 0xffff0000, v22
    v_mul_f32 v36, 1.4426950408889634, v32
    v_exp_f32 v36, v36
    v_add_f32 v34, 1.0, v32
    v_cmp_lt_f32 vcc, 0, v32
    s_nop 1
    v_cndmask_b32 v34, v36, v34, vcc
    v_add_f32 v34, 0x358637bd, v34
    v_mul_f32 v36, 1.4426950408889634, v33
    v_exp_f32 v36, v36
    v_add_f32 v35, 1.0, v33
    v_cmp_lt_f32 vcc, 0, v33
    s_nop 1
    v_cndmask_b32 v35, v36, v35, vcc
    v_add_f32 v35, 0x358637bd, v35
    v_cvt_pk_bf16_f32 v22, v34, v35
    v_lshlrev_b32 v32, 16, v23
    v_and_b32 v33, 0xffff0000, v23
    v_mul_f32 v36, 1.4426950408889634, v32
    v_exp_f32 v36, v36
    v_add_f32 v34, 1.0, v32
    v_cmp_lt_f32 vcc, 0, v32
    s_nop 1
    v_cndmask_b32 v34, v36, v34, vcc
    v_add_f32 v34, 0x358637bd, v34
    v_mul_f32 v36, 1.4426950408889634, v33
    v_exp_f32 v36, v36
    v_add_f32 v35, 1.0, v33
    v_cmp_lt_f32 vcc, 0, v33
    s_nop 1
    v_cndmask_b32 v35, v36, v35, vcc
    v_add_f32 v35, 0x358637bd, v35
    v_cvt_pk_bf16_f32 v23, v34, v35
    v_mov_b32 v37, 0x3f803f80
    v_cndmask_b32 v20, 0, v20, s[16:17]
    v_cndmask_b32 v28, 0, v28, s[16:17]
    v_cndmask_b32 v28, v28, v37, s[18:19]
    v_cndmask_b32 v21, 0, v21, s[16:17]
    v_cndmask_b32 v29, 0, v29, s[16:17]
    v_cndmask_b32 v29, v29, v37, s[18:19]
    v_cndmask_b32 v22, 0, v22, s[16:17]
    v_cndmask_b32 v30, 0, v30, s[16:17]
    v_cndmask_b32 v30, v30, v37, s[18:19]
    v_cndmask_b32 v23, 0, v23, s[16:17]
    v_cndmask_b32 v31, 0, v31, s[16:17]
    v_cndmask_b32 v31, v31, v37, s[18:19]
    s_nop 1
    v_mfma_f32_16x16x32_bf16 a[0:3], v[24:27], v[16:19], a[0:3]
    v_mfma_f32_16x16x32_bf16 a[4:7], v[24:27], v[20:23], a[4:7]
    v_mfma_f32_16x16x32_bf16 a[8:11], v[28:31], v[16:19], a[8:11]
    v_mfma_f32_16x16x32_bf16 a[12:15], v[28:31], v[20:23], a[12:15]
    s_nop 7
    s_nop 7
    v_lshlrev_b32 v5, 2, v4
    v_lshlrev_b32 v5, 5, v5
    v_add_u32 v5, v5, v3
    v_lshlrev_b32 v5, 2, v5
    s_lshl_b32 s14, s5, 12
    s_add_u32 s14, s14, 23199744
    v_add_u32 v5, s14, v5
    v_accvgpr_read_b32 v40, a0
    v_accvgpr_read_b32 v41, a1
    v_accvgpr_read_b32 v42, a2
    v_accvgpr_read_b32 v43, a3
    buffer_atomic_add_f32 v40, v5, s[8:11], 0 offen offset:0
    buffer_atomic_add_f32 v41, v5, s[8:11], 0 offen offset:128
    buffer_atomic_add_f32 v42, v5, s[8:11], 0 offen offset:256
    buffer_atomic_add_f32 v43, v5, s[8:11], 0 offen offset:384
    v_accvgpr_read_b32 v40, a4
    v_accvgpr_read_b32 v41, a5
    v_accvgpr_read_b32 v42, a6
    v_accvgpr_read_b32 v43, a7
    buffer_atomic_add_f32 v40, v5, s[8:11], 0 offen offset:64
    buffer_atomic_add_f32 v41, v5, s[8:11], 0 offen offset:192
    buffer_atomic_add_f32 v42, v5, s[8:11], 0 offen offset:320
    buffer_atomic_add_f32 v43, v5, s[8:11], 0 offen offset:448
    v_accvgpr_read_b32 v40, a8
    v_accvgpr_read_b32 v41, a9
    v_accvgpr_read_b32 v42, a10
    v_accvgpr_read_b32 v43, a11
    buffer_atomic_add_f32 v40, v5, s[8:11], 0 offen offset:2048
    buffer_atomic_add_f32 v41, v5, s[8:11], 0 offen offset:2176
    buffer_atomic_add_f32 v42, v5, s[8:11], 0 offen offset:2304
    buffer_atomic_add_f32 v43, v5, s[8:11], 0 offen offset:2432
    v_accvgpr_read_b32 v40, a12
    v_accvgpr_read_b32 v41, a13
    v_accvgpr_read_b32 v42, a14
    v_accvgpr_read_b32 v43, a15
    buffer_atomic_add_f32 v40, v5, s[8:11], 0 offen offset:2112
    buffer_atomic_add_f32 v41, v5, s[8:11], 0 offen offset:2240
    buffer_atomic_add_f32 v42, v5, s[8:11], 0 offen offset:2368
    buffer_atomic_add_f32 v43, v5, s[8:11], 0 offen offset:2496
kvz_a2_kernel_end:
    s_endpgm
.section .rodata,"a"
.p2align 6
.amdhsa_kernel kvz_a2_kernel
  .amdhsa_next_free_vgpr 80
  .amdhsa_next_free_sgpr 40
  .amdhsa_accum_offset 64
  .amdhsa_group_segment_fixed_size 0
  .amdhsa_kernarg_size 104
  .amdhsa_user_sgpr_count 2
  .amdhsa_user_sgpr_kernarg_segment_ptr 1
  .amdhsa_system_sgpr_workgroup_id_x 1
.end_amdhsa_kernel
.text
.globl attn_a2_kernel
.p2align 8
.type attn_a2_kernel,@function
attn_a2_kernel:
    s_cmp_ge_u32 s2, 256
    s_cbranch_scc1 attn_a2_kernel_end
    s_load_dwordx2 s[6:7], s[0:1], 96
    s_waitcnt lgkmcnt(0)
    s_mov_b32 s8, s6
    s_mov_b32 s9, s7
    s_mov_b32 s10, 268435456
    s_mov_b32 s11, 0x00020000
    v_mov_b32 v1, v0
    v_add_u32 v2, 0, v1
    s_mov_b32 s12, 3121
    v_mul_lo_u32 v3, v2, s12
    v_lshrrev_b32 v3, 19, v3
    v_mul_u32_u24 v4, 168, v3
    v_sub_u32 v4, v2, v4
    v_lshlrev_b32 v5, 12, v3
    v_lshlrev_b32 v6, 4, v4
    v_add_u32 v5, v5, v6
    v_add_u32 v5, 23199744, v5
    buffer_load_dwordx4 v[8:11], v5, s[8:11], 0 offen
    v_mul_u32_u24 v7, 2688, v3
    v_add_u32 v7, v7, v6
    s_waitcnt vmcnt(0)
    ds_write_b128 v7, v[8:11]
    v_add_u32 v2, 256, v1
    s_mov_b32 s12, 3121
    v_mul_lo_u32 v3, v2, s12
    v_lshrrev_b32 v3, 19, v3
    v_mul_u32_u24 v4, 168, v3
    v_sub_u32 v4, v2, v4
    v_lshlrev_b32 v5, 12, v3
    v_lshlrev_b32 v6, 4, v4
    v_add_u32 v5, v5, v6
    v_add_u32 v5, 23199744, v5
    buffer_load_dwordx4 v[8:11], v5, s[8:11], 0 offen
    v_mul_u32_u24 v7, 2688, v3
    v_add_u32 v7, v7, v6
    s_waitcnt vmcnt(0)
    ds_write_b128 v7, v[8:11]
    v_add_u32 v2, 512, v1
    s_mov_b32 s12, 3121
    v_mul_lo_u32 v3, v2, s12
    v_lshrrev_b32 v3, 19, v3
    v_mul_u32_u24 v4, 168, v3
    v_sub_u32 v4, v2, v4
    v_lshlrev_b32 v5, 12, v3
    v_lshlrev_b32 v6, 4, v4
    v_add_u32 v5, v5, v6
    v_add_u32 v5, 23199744, v5
    buffer_load_dwordx4 v[8:11], v5, s[8:11], 0 offen
    v_mul_u32_u24 v7, 2688, v3
    v_add_u32 v7, v7, v6
    s_waitcnt vmcnt(0)
    ds_write_b128 v7, v[8:11]
    v_add_u32 v2, 768, v1
    s_mov_b32 s12, 3121
    v_mul_lo_u32 v3, v2, s12
    v_lshrrev_b32 v3, 19, v3
    v_mul_u32_u24 v4, 168, v3
    v_sub_u32 v4, v2, v4
    v_lshlrev_b32 v5, 12, v3
    v_lshlrev_b32 v6, 4, v4
    v_add_u32 v5, v5, v6
    v_add_u32 v5, 23199744, v5
    buffer_load_dwordx4 v[8:11], v5, s[8:11], 0 offen
    v_mul_u32_u24 v7, 2688, v3
    v_add_u32 v7, v7, v6
    s_waitcnt vmcnt(0)
    ds_write_b128 v7, v[8:11]
    v_add_u32 v2, 1024, v1
    s_mov_b32 s12, 3121
    v_mul_lo_u32 v3, v2, s12
    v_lshrrev_b32 v3, 19, v3
    v_mul_u32_u24 v4, 168, v3
    v_sub_u32 v4, v2, v4
    v_lshlrev_b32 v5, 12, v3
    v_lshlrev_b32 v6, 4, v4
    v_add_u32 v5, v5, v6
    v_add_u32 v5, 23199744, v5
    buffer_load_dwordx4 v[8:11], v5, s[8:11], 0 offen
    v_mul_u32_u24 v7, 2688, v3
    v_add_u32 v7, v7, v6
    s_waitcnt vmcnt(0)
    ds_write_b128 v7, v[8:11]
    v_add_u32 v2, 1280, v1
    s_mov_b32 s12, 3121
    v_mul_lo_u32 v3, v2, s12
    v_lshrrev_b32 v3, 19, v3
    v_mul_u32_u24 v4, 168, v3
    v_sub_u32 v4, v2, v4
    v_lshlrev_b32 v5, 12, v3
    v_lshlrev_b32 v6, 4, v4
    v_add_u32 v5, v5, v6
    v_add_u32 v5, 23199744, v5
    buffer_load_dwordx4 v[8:11], v5, s[8:11], 0 offen
    v_mul_u32_u24 v7, 2688, v3
    v_add_u32 v7, v7, v6
    s_waitcnt vmcnt(0)
    ds_write_b128 v7, v[8:11]
    v_add_u32 v2, 1536, v1
    s_mov_b32 s12, 3121
    v_mul_lo_u32 v3, v2, s12
    v_lshrrev_b32 v3, 19, v3
    v_mul_u32_u24 v4, 168, v3
    v_sub_u32 v4, v2, v4
    v_lshlrev_b32 v5, 12, v3
    v_lshlrev_b32 v6, 4, v4
    v_add_u32 v5, v5, v6
    v_add_u32 v5, 23199744, v5
    buffer_load_dwordx4 v[8:11], v5, s[8:11], 0 offen
    v_mul_u32_u24 v7, 2688, v3
    v_add_u32 v7, v7, v6
    s_waitcnt vmcnt(0)
    ds_write_b128 v7, v[8:11]
    v_add_u32 v2, 1792, v1
    s_mov_b32 s12, 3121
    v_mul_lo_u32 v3, v2, s12
    v_lshrrev_b32 v3, 19, v3
    v_mul_u32_u24 v4, 168, v3
    v_sub_u32 v4, v2, v4
    v_lshlrev_b32 v5, 12, v3
    v_lshlrev_b32 v6, 4, v4
    v_add_u32 v5, v5, v6
    v_add_u32 v5, 23199744, v5
    buffer_load_dwordx4 v[8:11], v5, s[8:11], 0 offen
    v_mul_u32_u24 v7, 2688, v3
    v_add_u32 v7, v7, v6
    s_waitcnt vmcnt(0)
    ds_write_b128 v7, v[8:11]
    v_add_u32 v2, 2048, v1
    s_mov_b32 s12, 3121
    v_mul_lo_u32 v3, v2, s12
    v_lshrrev_b32 v3, 19, v3
    v_mul_u32_u24 v4, 168, v3
    v_sub_u32 v4, v2, v4
    v_lshlrev_b32 v5, 12, v3
    v_lshlrev_b32 v6, 4, v4
    v_add_u32 v5, v5, v6
    v_add_u32 v5, 23199744, v5
    buffer_load_dwordx4 v[8:11], v5, s[8:11], 0 offen
    v_mul_u32_u24 v7, 2688, v3
    v_add_u32 v7, v7, v6
    s_waitcnt vmcnt(0)
    ds_write_b128 v7, v[8:11]
    v_add_u32 v2, 2304, v1
    s_mov_b32 s12, 3121
    v_mul_lo_u32 v3, v2, s12
    v_lshrrev_b32 v3, 19, v3
    v_mul_u32_u24 v4, 168, v3
    v_sub_u32 v4, v2, v4
    v_lshlrev_b32 v5, 12, v3
    v_lshlrev_b32 v6, 4, v4
    v_add_u32 v5, v5, v6
    v_add_u32 v5, 23199744, v5
    buffer_load_dwordx4 v[8:11], v5, s[8:11], 0 offen
    v_mul_u32_u24 v7, 2688, v3
    v_add_u32 v7, v7, v6
    s_waitcnt vmcnt(0)
    ds_write_b128 v7, v[8:11]
    v_add_u32 v2, 2560, v1
    s_mov_b32 s12, 3121
    v_mul_lo_u32 v3, v2, s12
    v_lshrrev_b32 v3, 19, v3
    v_mul_u32_u24 v4, 168, v3
    v_sub_u32 v4, v2, v4
    v_lshlrev_b32 v5, 12, v3
    v_lshlrev_b32 v6, 4, v4
    v_add_u32 v5, v5, v6
    v_add_u32 v5, 23199744, v5
    buffer_load_dwordx4 v[8:11], v5, s[8:11], 0 offen
    v_mul_u32_u24 v7, 2688, v3
    v_add_u32 v7, v7, v6
    s_waitcnt vmcnt(0)
    ds_write_b128 v7, v[8:11]
    v_add_u32 v2, 2816, v1
    s_mov_b32 s12, 3121
    v_mul_lo_u32 v3, v2, s12
    v_lshrrev_b32 v3, 19, v3
    v_mul_u32_u24 v4, 168, v3
    v_sub_u32 v4, v2, v4
    v_lshlrev_b32 v5, 12, v3
    v_lshlrev_b32 v6, 4, v4
    v_add_u32 v5, v5, v6
    v_add_u32 v5, 23199744, v5
    buffer_load_dwordx4 v[8:11], v5, s[8:11], 0 offen
    v_mul_u32_u24 v7, 2688, v3
    v_add_u32 v7, v7, v6
    s_waitcnt vmcnt(0)
    ds_write_b128 v7, v[8:11]
    v_add_u32 v2, 3072, v1
    s_mov_b32 s12, 3121
    v_mul_lo_u32 v3, v2, s12
    v_lshrrev_b32 v3, 19, v3
    v_mul_u32_u24 v4, 168, v3
    v_sub_u32 v4, v2, v4
    v_lshlrev_b32 v5, 12, v3
    v_lshlrev_b32 v6, 4, v4
    v_add_u32 v5, v5, v6
    v_add_u32 v5, 23199744, v5
    buffer_load_dwordx4 v[8:11], v5, s[8:11], 0 offen
    v_mul_u32_u24 v7, 2688, v3
    v_add_u32 v7, v7, v6
    s_waitcnt vmcnt(0)
    ds_write_b128 v7, v[8:11]
    v_add_u32 v2, 3328, v1
    s_mov_b32 s12, 3121
    v_mul_lo_u32 v3, v2, s12
    v_lshrrev_b32 v3, 19, v3
    v_mul_u32_u24 v4, 168, v3
    v_sub_u32 v4, v2, v4
    v_lshlrev_b32 v5, 12, v3
    v_lshlrev_b32 v6, 4, v4
    v_add_u32 v5, v5, v6
    v_add_u32 v5, 23199744, v5
    buffer_load_dwordx4 v[8:11], v5, s[8:11], 0 offen
    v_mul_u32_u24 v7, 2688, v3
    v_add_u32 v7, v7, v6
    s_waitcnt vmcnt(0)
    ds_write_b128 v7, v[8:11]
    v_add_u32 v2, 3584, v1
    s_mov_b32 s12, 3121
    v_mul_lo_u32 v3, v2, s12
    v_lshrrev_b32 v3, 19, v3
    v_mul_u32_u24 v4, 168, v3
    v_sub_u32 v4, v2, v4
    v_lshlrev_b32 v5, 12, v3
    v_lshlrev_b32 v6, 4, v4
    v_add_u32 v5, v5, v6
    v_add_u32 v5, 23199744, v5
    buffer_load_dwordx4 v[8:11], v5, s[8:11], 0 offen
    v_mul_u32_u24 v7, 2688, v3
    v_add_u32 v7, v7, v6
    s_waitcnt vmcnt(0)
    ds_write_b128 v7, v[8:11]
    v_add_u32 v2, 3840, v1
    s_mov_b32 s12, 3121
    v_mul_lo_u32 v3, v2, s12
    v_lshrrev_b32 v3, 19, v3
    v_mul_u32_u24 v4, 168, v3
    v_sub_u32 v4, v2, v4
    v_lshlrev_b32 v5, 12, v3
    v_lshlrev_b32 v6, 4, v4
    v_add_u32 v5, v5, v6
    v_add_u32 v5, 23199744, v5
    buffer_load_dwordx4 v[8:11], v5, s[8:11], 0 offen
    v_mul_u32_u24 v7, 2688, v3
    v_add_u32 v7, v7, v6
    s_waitcnt vmcnt(0)
    ds_write_b128 v7, v[8:11]
    v_add_u32 v2, 4096, v1
    s_mov_b32 s12, 3121
    v_mul_lo_u32 v3, v2, s12
    v_lshrrev_b32 v3, 19, v3
    v_mul_u32_u24 v4, 168, v3
    v_sub_u32 v4, v2, v4
    v_lshlrev_b32 v5, 12, v3
    v_lshlrev_b32 v6, 4, v4
    v_add_u32 v5, v5, v6
    v_add_u32 v5, 23199744, v5
    buffer_load_dwordx4 v[8:11], v5, s[8:11], 0 offen
    v_mul_u32_u24 v7, 2688, v3
    v_add_u32 v7, v7, v6
    s_waitcnt vmcnt(0)
    ds_write_b128 v7, v[8:11]
    v_add_u32 v2, 4352, v1
    s_mov_b32 s12, 3121
    v_mul_lo_u32 v3, v2, s12
    v_lshrrev_b32 v3, 19, v3
    v_mul_u32_u24 v4, 168, v3
    v_sub_u32 v4, v2, v4
    v_lshlrev_b32 v5, 12, v3
    v_lshlrev_b32 v6, 4, v4
    v_add_u32 v5, v5, v6
    v_add_u32 v5, 23199744, v5
    buffer_load_dwordx4 v[8:11], v5, s[8:11], 0 offen
    v_mul_u32_u24 v7, 2688, v3
    v_add_u32 v7, v7, v6
    s_waitcnt vmcnt(0)
    ds_write_b128 v7, v[8:11]
    v_add_u32 v2, 4608, v1
    s_mov_b32 s12, 3121
    v_mul_lo_u32 v3, v2, s12
    v_lshrrev_b32 v3, 19, v3
    v_mul_u32_u24 v4, 168, v3
    v_sub_u32 v4, v2, v4
    v_lshlrev_b32 v5, 12, v3
    v_lshlrev_b32 v6, 4, v4
    v_add_u32 v5, v5, v6
    v_add_u32 v5, 23199744, v5
    buffer_load_dwordx4 v[8:11], v5, s[8:11], 0 offen
    v_mul_u32_u24 v7, 2688, v3
    v_add_u32 v7, v7, v6
    s_waitcnt vmcnt(0)
    ds_write_b128 v7, v[8:11]
    v_add_u32 v2, 4864, v1
    s_mov_b32 s12, 3121
    v_mul_lo_u32 v3, v2, s12
    v_lshrrev_b32 v3, 19, v3
    v_mul_u32_u24 v4, 168, v3
    v_sub_u32 v4, v2, v4
    v_lshlrev_b32 v5, 12, v3
    v_lshlrev_b32 v6, 4, v4
    v_add_u32 v5, v5, v6
    v_add_u32 v5, 23199744, v5
    buffer_load_dwordx4 v[8:11], v5, s[8:11], 0 offen
    v_mul_u32_u24 v7, 2688, v3
    v_add_u32 v7, v7, v6
    s_waitcnt vmcnt(0)
    ds_write_b128 v7, v[8:11]
    v_add_u32 v2, 5120, v1
    s_mov_b32 s12, 3121
    v_mul_lo_u32 v3, v2, s12
    v_lshrrev_b32 v3, 19, v3
    v_mul_u32_u24 v4, 168, v3
    v_sub_u32 v4, v2, v4
    v_lshlrev_b32 v5, 12, v3
    v_lshlrev_b32 v6, 4, v4
    v_add_u32 v5, v5, v6
    v_add_u32 v5, 23199744, v5
    buffer_load_dwordx4 v[8:11], v5, s[8:11], 0 offen
    v_mul_u32_u24 v7, 2688, v3
    v_add_u32 v7, v7, v6
    s_waitcnt vmcnt(0)
    ds_write_b128 v7, v[8:11]
    s_waitcnt lgkmcnt(0)
    s_barrier
    v_and_b32 v2, 31, v0
    v_lshrrev_b32 v3, 5, v0
    s_lshl_b32 s12, s2, 3
    v_add_u32 v3, s12, v3
    v_mul_u32_u24 v4, 1280, v3
    v_mul_u32_u24 v5, 40, v2
    v_add_u32 v4, v4, v5
    v_add_u32 v6, 8388608, v4
    buffer_load_dwordx2 v[8:9], v6, s[8:11], 0 offen offset:0
    buffer_load_dwordx2 v[10:11], v6, s[8:11], 0 offen offset:8
    buffer_load_dwordx2 v[12:13], v6, s[8:11], 0 offen offset:16
    buffer_load_dwordx2 v[14:15], v6, s[8:11], 0 offen offset:24
    buffer_load_dwordx2 v[16:17], v6, s[8:11], 0 offen offset:32
    s_waitcnt vmcnt(0)
    v_lshlrev_b32 v40, 16, v8
    v_and_b32 v41, 0xffff0000, v8
    v_mul_f32 v44, 1.4426950408889634, v40
    v_exp_f32 v44, v44
    v_add_f32 v42, 1.0, v40
    v_cmp_lt_f32 vcc, 0, v40
    s_nop 1
    v_cndmask_b32 v42, v44, v42, vcc
    v_add_f32 v42, 0x358637bd, v42
    v_mul_f32 v44, 1.4426950408889634, v41
    v_exp_f32 v44, v44
    v_add_f32 v43, 1.0, v41
    v_cmp_lt_f32 vcc, 0, v41
    s_nop 1
    v_cndmask_b32 v43, v44, v43, vcc
    v_add_f32 v43, 0x358637bd, v43
    v_cvt_pk_bf16_f32 v45, v42, v43
    v_lshlrev_b32 v20, 16, v45
    v_and_b32 v21, 0xffff0000, v45
    v_lshlrev_b32 v40, 16, v9
    v_and_b32 v41, 0xffff0000, v9
    v_mul_f32 v44, 1.4426950408889634, v40
    v_exp_f32 v44, v44
    v_add_f32 v42, 1.0, v40
    v_cmp_lt_f32 vcc, 0, v40
    s_nop 1
    v_cndmask_b32 v42, v44, v42, vcc
    v_add_f32 v42, 0x358637bd, v42
    v_mul_f32 v44, 1.4426950408889634, v41
    v_exp_f32 v44, v44
    v_add_f32 v43, 1.0, v41
    v_cmp_lt_f32 vcc, 0, v41
    s_nop 1
    v_cndmask_b32 v43, v44, v43, vcc
    v_add_f32 v43, 0x358637bd, v43
    v_cvt_pk_bf16_f32 v45, v42, v43
    v_lshlrev_b32 v22, 16, v45
    v_and_b32 v23, 0xffff0000, v45
    v_lshlrev_b32 v40, 16, v10
    v_and_b32 v41, 0xffff0000, v10
    v_mul_f32 v44, 1.4426950408889634, v40
    v_exp_f32 v44, v44
    v_add_f32 v42, 1.0, v40
    v_cmp_lt_f32 vcc, 0, v40
    s_nop 1
    v_cndmask_b32 v42, v44, v42, vcc
    v_add_f32 v42, 0x358637bd, v42
    v_mul_f32 v44, 1.4426950408889634, v41
    v_exp_f32 v44, v44
    v_add_f32 v43, 1.0, v41
    v_cmp_lt_f32 vcc, 0, v41
    s_nop 1
    v_cndmask_b32 v43, v44, v43, vcc
    v_add_f32 v43, 0x358637bd, v43
    v_cvt_pk_bf16_f32 v45, v42, v43
    v_lshlrev_b32 v24, 16, v45
    v_and_b32 v25, 0xffff0000, v45
    v_lshlrev_b32 v40, 16, v11
    v_and_b32 v41, 0xffff0000, v11
    v_mul_f32 v44, 1.4426950408889634, v40
    v_exp_f32 v44, v44
    v_add_f32 v42, 1.0, v40
    v_cmp_lt_f32 vcc, 0, v40
    s_nop 1
    v_cndmask_b32 v42, v44, v42, vcc
    v_add_f32 v42, 0x358637bd, v42
    v_mul_f32 v44, 1.4426950408889634, v41
    v_exp_f32 v44, v44
    v_add_f32 v43, 1.0, v41
    v_cmp_lt_f32 vcc, 0, v41
    s_nop 1
    v_cndmask_b32 v43, v44, v43, vcc
    v_add_f32 v43, 0x358637bd, v43
    v_cvt_pk_bf16_f32 v45, v42, v43
    v_lshlrev_b32 v26, 16, v45
    v_and_b32 v27, 0xffff0000, v45
    v_lshlrev_b32 v40, 16, v12
    v_and_b32 v41, 0xffff0000, v12
    v_mul_f32 v44, 1.4426950408889634, v40
    v_exp_f32 v44, v44
    v_add_f32 v42, 1.0, v40
    v_cmp_lt_f32 vcc, 0, v40
    s_nop 1
    v_cndmask_b32 v42, v44, v42, vcc
    v_add_f32 v42, 0x358637bd, v42
    v_mul_f32 v44, 1.4426950408889634, v41
    v_exp_f32 v44, v44
    v_add_f32 v43, 1.0, v41
    v_cmp_lt_f32 vcc, 0, v41
    s_nop 1
    v_cndmask_b32 v43, v44, v43, vcc
    v_add_f32 v43, 0x358637bd, v43
    v_cvt_pk_bf16_f32 v45, v42, v43
    v_lshlrev_b32 v28, 16, v45
    v_and_b32 v29, 0xffff0000, v45
    v_lshlrev_b32 v40, 16, v13
    v_and_b32 v41, 0xffff0000, v13
    v_mul_f32 v44, 1.4426950408889634, v40
    v_exp_f32 v44, v44
    v_add_f32 v42, 1.0, v40
    v_cmp_lt_f32 vcc, 0, v40
    s_nop 1
    v_cndmask_b32 v42, v44, v42, vcc
    v_add_f32 v42, 0x358637bd, v42
    v_mul_f32 v44, 1.4426950408889634, v41
    v_exp_f32 v44, v44
    v_add_f32 v43, 1.0, v41
    v_cmp_lt_f32 vcc, 0, v41
    s_nop 1
    v_cndmask_b32 v43, v44, v43, vcc
    v_add_f32 v43, 0x358637bd, v43
    v_cvt_pk_bf16_f32 v45, v42, v43
    v_lshlrev_b32 v30, 16, v45
    v_and_b32 v31, 0xffff0000, v45
    v_lshlrev_b32 v40, 16, v14
    v_and_b32 v41, 0xffff0000, v14
    v_mul_f32 v44, 1.4426950408889634, v40
    v_exp_f32 v44, v44
    v_add_f32 v42, 1.0, v40
    v_cmp_lt_f32 vcc, 0, v40
    s_nop 1
    v_cndmask_b32 v42, v44, v42, vcc
    v_add_f32 v42, 0x358637bd, v42
    v_mul_f32 v44, 1.4426950408889634, v41
    v_exp_f32 v44, v44
    v_add_f32 v43, 1.0, v41
    v_cmp_lt_f32 vcc, 0, v41
    s_nop 1
    v_cndmask_b32 v43, v44, v43, vcc
    v_add_f32 v43, 0x358637bd, v43
    v_cvt_pk_bf16_f32 v45, v42, v43
    v_lshlrev_b32 v32, 16, v45
    v_and_b32 v33, 0xffff0000, v45
    v_lshlrev_b32 v40, 16, v15
    v_and_b32 v41, 0xffff0000, v15
    v_mul_f32 v44, 1.4426950408889634, v40
    v_exp_f32 v44, v44
    v_add_f32 v42, 1.0, v40
    v_cmp_lt_f32 vcc, 0, v40
    s_nop 1
    v_cndmask_b32 v42, v44, v42, vcc
    v_add_f32 v42, 0x358637bd, v42
    v_mul_f32 v44, 1.4426950408889634, v41
    v_exp_f32 v44, v44
    v_add_f32 v43, 1.0, v41
    v_cmp_lt_f32 vcc, 0, v41
    s_nop 1
    v_cndmask_b32 v43, v44, v43, vcc
    v_add_f32 v43, 0x358637bd, v43
    v_cvt_pk_bf16_f32 v45, v42, v43
    v_lshlrev_b32 v34, 16, v45
    v_and_b32 v35, 0xffff0000, v45
    v_lshlrev_b32 v40, 16, v16
    v_and_b32 v41, 0xffff0000, v16
    v_mul_f32 v44, 1.4426950408889634, v40
    v_exp_f32 v44, v44
    v_add_f32 v42, 1.0, v40
    v_cmp_lt_f32 vcc, 0, v40
    s_nop 1
    v_cndmask_b32 v42, v44, v42, vcc
    v_add_f32 v42, 0x358637bd, v42
    v_mul_f32 v44, 1.4426950408889634, v41
    v_exp_f32 v44, v44
    v_add_f32 v43, 1.0, v41
    v_cmp_lt_f32 vcc, 0, v41
    s_nop 1
    v_cndmask_b32 v43, v44, v43, vcc
    v_add_f32 v43, 0x358637bd, v43
    v_cvt_pk_bf16_f32 v45, v42, v43
    v_lshlrev_b32 v36, 16, v45
    v_and_b32 v37, 0xffff0000, v45
    v_lshlrev_b32 v40, 16, v17
    v_and_b32 v41, 0xffff0000, v17
    v_mul_f32 v44, 1.4426950408889634, v40
    v_exp_f32 v44, v44
    v_add_f32 v42, 1.0, v40
    v_cmp_lt_f32 vcc, 0, v40
    s_nop 1
    v_cndmask_b32 v42, v44, v42, vcc
    v_add_f32 v42, 0x358637bd, v42
    v_mul_f32 v44, 1.4426950408889634, v41
    v_exp_f32 v44, v44
    v_add_f32 v43, 1.0, v41
    v_cmp_lt_f32 vcc, 0, v41
    s_nop 1
    v_cndmask_b32 v43, v44, v43, vcc
    v_add_f32 v43, 0x358637bd, v43
    v_cvt_pk_bf16_f32 v45, v42, v43
    v_lshlrev_b32 v38, 16, v45
    v_and_b32 v39, 0xffff0000, v45
    v_mul_u32_u24 v7, 2688, v2
    ds_read_b128 v[72:75], v7 offset:0
    ds_read_b128 v[76:79], v7 offset:16
    ds_read_b128 v[80:83], v7 offset:32
    ds_read_b128 v[84:87], v7 offset:48
    ds_read_b128 v[88:91], v7 offset:64
    s_waitcnt lgkmcnt(0)
    v_mul_f32 v50, v20, v72
    v_fmac_f32 v50, v21, v73
    v_fmac_f32 v50, v22, v74
    v_fmac_f32 v50, v23, v75
    v_fmac_f32 v50, v24, v76
    v_fmac_f32 v50, v25, v77
    v_fmac_f32 v50, v26, v78
    v_fmac_f32 v50, v27, v79
    v_fmac_f32 v50, v28, v80
    v_fmac_f32 v50, v29, v81
    v_fmac_f32 v50, v30, v82
    v_fmac_f32 v50, v31, v83
    v_fmac_f32 v50, v32, v84
    v_fmac_f32 v50, v33, v85
    v_fmac_f32 v50, v34, v86
    v_fmac_f32 v50, v35, v87
    v_fmac_f32 v50, v36, v88
    v_fmac_f32 v50, v37, v89
    v_fmac_f32 v50, v38, v90
    v_fmac_f32 v50, v39, v91
    ds_read_b128 v[72:75], v7 offset:128
    ds_read_b128 v[76:79], v7 offset:144
    ds_read_b128 v[80:83], v7 offset:160
    ds_read_b128 v[84:87], v7 offset:176
    ds_read_b128 v[88:91], v7 offset:192
    s_waitcnt lgkmcnt(0)
    v_mul_f32 v51, v20, v72
    v_fmac_f32 v51, v21, v73
    v_fmac_f32 v51, v22, v74
    v_fmac_f32 v51, v23, v75
    v_fmac_f32 v51, v24, v76
    v_fmac_f32 v51, v25, v77
    v_fmac_f32 v51, v26, v78
    v_fmac_f32 v51, v27, v79
    v_fmac_f32 v51, v28, v80
    v_fmac_f32 v51, v29, v81
    v_fmac_f32 v51, v30, v82
    v_fmac_f32 v51, v31, v83
    v_fmac_f32 v51, v32, v84
    v_fmac_f32 v51, v33, v85
    v_fmac_f32 v51, v34, v86
    v_fmac_f32 v51, v35, v87
    v_fmac_f32 v51, v36, v88
    v_fmac_f32 v51, v37, v89
    v_fmac_f32 v51, v38, v90
    v_fmac_f32 v51, v39, v91
    ds_read_b128 v[72:75], v7 offset:256
    ds_read_b128 v[76:79], v7 offset:272
    ds_read_b128 v[80:83], v7 offset:288
    ds_read_b128 v[84:87], v7 offset:304
    ds_read_b128 v[88:91], v7 offset:320
    s_waitcnt lgkmcnt(0)
    v_mul_f32 v52, v20, v72
    v_fmac_f32 v52, v21, v73
    v_fmac_f32 v52, v22, v74
    v_fmac_f32 v52, v23, v75
    v_fmac_f32 v52, v24, v76
    v_fmac_f32 v52, v25, v77
    v_fmac_f32 v52, v26, v78
    v_fmac_f32 v52, v27, v79
    v_fmac_f32 v52, v28, v80
    v_fmac_f32 v52, v29, v81
    v_fmac_f32 v52, v30, v82
    v_fmac_f32 v52, v31, v83
    v_fmac_f32 v52, v32, v84
    v_fmac_f32 v52, v33, v85
    v_fmac_f32 v52, v34, v86
    v_fmac_f32 v52, v35, v87
    v_fmac_f32 v52, v36, v88
    v_fmac_f32 v52, v37, v89
    v_fmac_f32 v52, v38, v90
    v_fmac_f32 v52, v39, v91
    ds_read_b128 v[72:75], v7 offset:384
    ds_read_b128 v[76:79], v7 offset:400
    ds_read_b128 v[80:83], v7 offset:416
    ds_read_b128 v[84:87], v7 offset:432
    ds_read_b128 v[88:91], v7 offset:448
    s_waitcnt lgkmcnt(0)
    v_mul_f32 v53, v20, v72
    v_fmac_f32 v53, v21, v73
    v_fmac_f32 v53, v22, v74
    v_fmac_f32 v53, v23, v75
    v_fmac_f32 v53, v24, v76
    v_fmac_f32 v53, v25, v77
    v_fmac_f32 v53, v26, v78
    v_fmac_f32 v53, v27, v79
    v_fmac_f32 v53, v28, v80
    v_fmac_f32 v53, v29, v81
    v_fmac_f32 v53, v30, v82
    v_fmac_f32 v53, v31, v83
    v_fmac_f32 v53, v32, v84
    v_fmac_f32 v53, v33, v85
    v_fmac_f32 v53, v34, v86
    v_fmac_f32 v53, v35, v87
    v_fmac_f32 v53, v36, v88
    v_fmac_f32 v53, v37, v89
    v_fmac_f32 v53, v38, v90
    v_fmac_f32 v53, v39, v91
    ds_read_b128 v[72:75], v7 offset:512
    ds_read_b128 v[76:79], v7 offset:528
    ds_read_b128 v[80:83], v7 offset:544
    ds_read_b128 v[84:87], v7 offset:560
    ds_read_b128 v[88:91], v7 offset:576
    s_waitcnt lgkmcnt(0)
    v_mul_f32 v54, v20, v72
    v_fmac_f32 v54, v21, v73
    v_fmac_f32 v54, v22, v74
    v_fmac_f32 v54, v23, v75
    v_fmac_f32 v54, v24, v76
    v_fmac_f32 v54, v25, v77
    v_fmac_f32 v54, v26, v78
    v_fmac_f32 v54, v27, v79
    v_fmac_f32 v54, v28, v80
    v_fmac_f32 v54, v29, v81
    v_fmac_f32 v54, v30, v82
    v_fmac_f32 v54, v31, v83
    v_fmac_f32 v54, v32, v84
    v_fmac_f32 v54, v33, v85
    v_fmac_f32 v54, v34, v86
    v_fmac_f32 v54, v35, v87
    v_fmac_f32 v54, v36, v88
    v_fmac_f32 v54, v37, v89
    v_fmac_f32 v54, v38, v90
    v_fmac_f32 v54, v39, v91
    ds_read_b128 v[72:75], v7 offset:640
    ds_read_b128 v[76:79], v7 offset:656
    ds_read_b128 v[80:83], v7 offset:672
    ds_read_b128 v[84:87], v7 offset:688
    ds_read_b128 v[88:91], v7 offset:704
    s_waitcnt lgkmcnt(0)
    v_mul_f32 v55, v20, v72
    v_fmac_f32 v55, v21, v73
    v_fmac_f32 v55, v22, v74
    v_fmac_f32 v55, v23, v75
    v_fmac_f32 v55, v24, v76
    v_fmac_f32 v55, v25, v77
    v_fmac_f32 v55, v26, v78
    v_fmac_f32 v55, v27, v79
    v_fmac_f32 v55, v28, v80
    v_fmac_f32 v55, v29, v81
    v_fmac_f32 v55, v30, v82
    v_fmac_f32 v55, v31, v83
    v_fmac_f32 v55, v32, v84
    v_fmac_f32 v55, v33, v85
    v_fmac_f32 v55, v34, v86
    v_fmac_f32 v55, v35, v87
    v_fmac_f32 v55, v36, v88
    v_fmac_f32 v55, v37, v89
    v_fmac_f32 v55, v38, v90
    v_fmac_f32 v55, v39, v91
    ds_read_b128 v[72:75], v7 offset:768
    ds_read_b128 v[76:79], v7 offset:784
    ds_read_b128 v[80:83], v7 offset:800
    ds_read_b128 v[84:87], v7 offset:816
    ds_read_b128 v[88:91], v7 offset:832
    s_waitcnt lgkmcnt(0)
    v_mul_f32 v56, v20, v72
    v_fmac_f32 v56, v21, v73
    v_fmac_f32 v56, v22, v74
    v_fmac_f32 v56, v23, v75
    v_fmac_f32 v56, v24, v76
    v_fmac_f32 v56, v25, v77
    v_fmac_f32 v56, v26, v78
    v_fmac_f32 v56, v27, v79
    v_fmac_f32 v56, v28, v80
    v_fmac_f32 v56, v29, v81
    v_fmac_f32 v56, v30, v82
    v_fmac_f32 v56, v31, v83
    v_fmac_f32 v56, v32, v84
    v_fmac_f32 v56, v33, v85
    v_fmac_f32 v56, v34, v86
    v_fmac_f32 v56, v35, v87
    v_fmac_f32 v56, v36, v88
    v_fmac_f32 v56, v37, v89
    v_fmac_f32 v56, v38, v90
    v_fmac_f32 v56, v39, v91
    ds_read_b128 v[72:75], v7 offset:896
    ds_read_b128 v[76:79], v7 offset:912
    ds_read_b128 v[80:83], v7 offset:928
    ds_read_b128 v[84:87], v7 offset:944
    ds_read_b128 v[88:91], v7 offset:960
    s_waitcnt lgkmcnt(0)
    v_mul_f32 v57, v20, v72
    v_fmac_f32 v57, v21, v73
    v_fmac_f32 v57, v22, v74
    v_fmac_f32 v57, v23, v75
    v_fmac_f32 v57, v24, v76
    v_fmac_f32 v57, v25, v77
    v_fmac_f32 v57, v26, v78
    v_fmac_f32 v57, v27, v79
    v_fmac_f32 v57, v28, v80
    v_fmac_f32 v57, v29, v81
    v_fmac_f32 v57, v30, v82
    v_fmac_f32 v57, v31, v83
    v_fmac_f32 v57, v32, v84
    v_fmac_f32 v57, v33, v85
    v_fmac_f32 v57, v34, v86
    v_fmac_f32 v57, v35, v87
    v_fmac_f32 v57, v36, v88
    v_fmac_f32 v57, v37, v89
    v_fmac_f32 v57, v38, v90
    v_fmac_f32 v57, v39, v91
    ds_read_b128 v[72:75], v7 offset:1024
    ds_read_b128 v[76:79], v7 offset:1040
    ds_read_b128 v[80:83], v7 offset:1056
    ds_read_b128 v[84:87], v7 offset:1072
    ds_read_b128 v[88:91], v7 offset:1088
    s_waitcnt lgkmcnt(0)
    v_mul_f32 v58, v20, v72
    v_fmac_f32 v58, v21, v73
    v_fmac_f32 v58, v22, v74
    v_fmac_f32 v58, v23, v75
    v_fmac_f32 v58, v24, v76
    v_fmac_f32 v58, v25, v77
    v_fmac_f32 v58, v26, v78
    v_fmac_f32 v58, v27, v79
    v_fmac_f32 v58, v28, v80
    v_fmac_f32 v58, v29, v81
    v_fmac_f32 v58, v30, v82
    v_fmac_f32 v58, v31, v83
    v_fmac_f32 v58, v32, v84
    v_fmac_f32 v58, v33, v85
    v_fmac_f32 v58, v34, v86
    v_fmac_f32 v58, v35, v87
    v_fmac_f32 v58, v36, v88
    v_fmac_f32 v58, v37, v89
    v_fmac_f32 v58, v38, v90
    v_fmac_f32 v58, v39, v91
    ds_read_b128 v[72:75], v7 offset:1152
    ds_read_b128 v[76:79], v7 offset:1168
    ds_read_b128 v[80:83], v7 offset:1184
    ds_read_b128 v[84:87], v7 offset:1200
    ds_read_b128 v[88:91], v7 offset:1216
    s_waitcnt lgkmcnt(0)
    v_mul_f32 v59, v20, v72
    v_fmac_f32 v59, v21, v73
    v_fmac_f32 v59, v22, v74
    v_fmac_f32 v59, v23, v75
    v_fmac_f32 v59, v24, v76
    v_fmac_f32 v59, v25, v77
    v_fmac_f32 v59, v26, v78
    v_fmac_f32 v59, v27, v79
    v_fmac_f32 v59, v28, v80
    v_fmac_f32 v59, v29, v81
    v_fmac_f32 v59, v30, v82
    v_fmac_f32 v59, v31, v83
    v_fmac_f32 v59, v32, v84
    v_fmac_f32 v59, v33, v85
    v_fmac_f32 v59, v34, v86
    v_fmac_f32 v59, v35, v87
    v_fmac_f32 v59, v36, v88
    v_fmac_f32 v59, v37, v89
    v_fmac_f32 v59, v38, v90
    v_fmac_f32 v59, v39, v91
    ds_read_b128 v[72:75], v7 offset:1280
    ds_read_b128 v[76:79], v7 offset:1296
    ds_read_b128 v[80:83], v7 offset:1312
    ds_read_b128 v[84:87], v7 offset:1328
    ds_read_b128 v[88:91], v7 offset:1344
    s_waitcnt lgkmcnt(0)
    v_mul_f32 v60, v20, v72
    v_fmac_f32 v60, v21, v73
    v_fmac_f32 v60, v22, v74
    v_fmac_f32 v60, v23, v75
    v_fmac_f32 v60, v24, v76
    v_fmac_f32 v60, v25, v77
    v_fmac_f32 v60, v26, v78
    v_fmac_f32 v60, v27, v79
    v_fmac_f32 v60, v28, v80
    v_fmac_f32 v60, v29, v81
    v_fmac_f32 v60, v30, v82
    v_fmac_f32 v60, v31, v83
    v_fmac_f32 v60, v32, v84
    v_fmac_f32 v60, v33, v85
    v_fmac_f32 v60, v34, v86
    v_fmac_f32 v60, v35, v87
    v_fmac_f32 v60, v36, v88
    v_fmac_f32 v60, v37, v89
    v_fmac_f32 v60, v38, v90
    v_fmac_f32 v60, v39, v91
    ds_read_b128 v[72:75], v7 offset:1408
    ds_read_b128 v[76:79], v7 offset:1424
    ds_read_b128 v[80:83], v7 offset:1440
    ds_read_b128 v[84:87], v7 offset:1456
    ds_read_b128 v[88:91], v7 offset:1472
    s_waitcnt lgkmcnt(0)
    v_mul_f32 v61, v20, v72
    v_fmac_f32 v61, v21, v73
    v_fmac_f32 v61, v22, v74
    v_fmac_f32 v61, v23, v75
    v_fmac_f32 v61, v24, v76
    v_fmac_f32 v61, v25, v77
    v_fmac_f32 v61, v26, v78
    v_fmac_f32 v61, v27, v79
    v_fmac_f32 v61, v28, v80
    v_fmac_f32 v61, v29, v81
    v_fmac_f32 v61, v30, v82
    v_fmac_f32 v61, v31, v83
    v_fmac_f32 v61, v32, v84
    v_fmac_f32 v61, v33, v85
    v_fmac_f32 v61, v34, v86
    v_fmac_f32 v61, v35, v87
    v_fmac_f32 v61, v36, v88
    v_fmac_f32 v61, v37, v89
    v_fmac_f32 v61, v38, v90
    v_fmac_f32 v61, v39, v91
    ds_read_b128 v[72:75], v7 offset:1536
    ds_read_b128 v[76:79], v7 offset:1552
    ds_read_b128 v[80:83], v7 offset:1568
    ds_read_b128 v[84:87], v7 offset:1584
    ds_read_b128 v[88:91], v7 offset:1600
    s_waitcnt lgkmcnt(0)
    v_mul_f32 v62, v20, v72
    v_fmac_f32 v62, v21, v73
    v_fmac_f32 v62, v22, v74
    v_fmac_f32 v62, v23, v75
    v_fmac_f32 v62, v24, v76
    v_fmac_f32 v62, v25, v77
    v_fmac_f32 v62, v26, v78
    v_fmac_f32 v62, v27, v79
    v_fmac_f32 v62, v28, v80
    v_fmac_f32 v62, v29, v81
    v_fmac_f32 v62, v30, v82
    v_fmac_f32 v62, v31, v83
    v_fmac_f32 v62, v32, v84
    v_fmac_f32 v62, v33, v85
    v_fmac_f32 v62, v34, v86
    v_fmac_f32 v62, v35, v87
    v_fmac_f32 v62, v36, v88
    v_fmac_f32 v62, v37, v89
    v_fmac_f32 v62, v38, v90
    v_fmac_f32 v62, v39, v91
    ds_read_b128 v[72:75], v7 offset:1664
    ds_read_b128 v[76:79], v7 offset:1680
    ds_read_b128 v[80:83], v7 offset:1696
    ds_read_b128 v[84:87], v7 offset:1712
    ds_read_b128 v[88:91], v7 offset:1728
    s_waitcnt lgkmcnt(0)
    v_mul_f32 v63, v20, v72
    v_fmac_f32 v63, v21, v73
    v_fmac_f32 v63, v22, v74
    v_fmac_f32 v63, v23, v75
    v_fmac_f32 v63, v24, v76
    v_fmac_f32 v63, v25, v77
    v_fmac_f32 v63, v26, v78
    v_fmac_f32 v63, v27, v79
    v_fmac_f32 v63, v28, v80
    v_fmac_f32 v63, v29, v81
    v_fmac_f32 v63, v30, v82
    v_fmac_f32 v63, v31, v83
    v_fmac_f32 v63, v32, v84
    v_fmac_f32 v63, v33, v85
    v_fmac_f32 v63, v34, v86
    v_fmac_f32 v63, v35, v87
    v_fmac_f32 v63, v36, v88
    v_fmac_f32 v63, v37, v89
    v_fmac_f32 v63, v38, v90
    v_fmac_f32 v63, v39, v91
    ds_read_b128 v[72:75], v7 offset:1792
    ds_read_b128 v[76:79], v7 offset:1808
    ds_read_b128 v[80:83], v7 offset:1824
    ds_read_b128 v[84:87], v7 offset:1840
    ds_read_b128 v[88:91], v7 offset:1856
    s_waitcnt lgkmcnt(0)
    v_mul_f32 v64, v20, v72
    v_fmac_f32 v64, v21, v73
    v_fmac_f32 v64, v22, v74
    v_fmac_f32 v64, v23, v75
    v_fmac_f32 v64, v24, v76
    v_fmac_f32 v64, v25, v77
    v_fmac_f32 v64, v26, v78
    v_fmac_f32 v64, v27, v79
    v_fmac_f32 v64, v28, v80
    v_fmac_f32 v64, v29, v81
    v_fmac_f32 v64, v30, v82
    v_fmac_f32 v64, v31, v83
    v_fmac_f32 v64, v32, v84
    v_fmac_f32 v64, v33, v85
    v_fmac_f32 v64, v34, v86
    v_fmac_f32 v64, v35, v87
    v_fmac_f32 v64, v36, v88
    v_fmac_f32 v64, v37, v89
    v_fmac_f32 v64, v38, v90
    v_fmac_f32 v64, v39, v91
    ds_read_b128 v[72:75], v7 offset:1920
    ds_read_b128 v[76:79], v7 offset:1936
    ds_read_b128 v[80:83], v7 offset:1952
    ds_read_b128 v[84:87], v7 offset:1968
    ds_read_b128 v[88:91], v7 offset:1984
    s_waitcnt lgkmcnt(0)
    v_mul_f32 v65, v20, v72
    v_fmac_f32 v65, v21, v73
    v_fmac_f32 v65, v22, v74
    v_fmac_f32 v65, v23, v75
    v_fmac_f32 v65, v24, v76
    v_fmac_f32 v65, v25, v77
    v_fmac_f32 v65, v26, v78
    v_fmac_f32 v65, v27, v79
    v_fmac_f32 v65, v28, v80
    v_fmac_f32 v65, v29, v81
    v_fmac_f32 v65, v30, v82
    v_fmac_f32 v65, v31, v83
    v_fmac_f32 v65, v32, v84
    v_fmac_f32 v65, v33, v85
    v_fmac_f32 v65, v34, v86
    v_fmac_f32 v65, v35, v87
    v_fmac_f32 v65, v36, v88
    v_fmac_f32 v65, v37, v89
    v_fmac_f32 v65, v38, v90
    v_fmac_f32 v65, v39, v91
    ds_read_b128 v[72:75], v7 offset:2048
    ds_read_b128 v[76:79], v7 offset:2064
    ds_read_b128 v[80:83], v7 offset:2080
    ds_read_b128 v[84:87], v7 offset:2096
    ds_read_b128 v[88:91], v7 offset:2112
    s_waitcnt lgkmcnt(0)
    v_mul_f32 v66, v20, v72
    v_fmac_f32 v66, v21, v73
    v_fmac_f32 v66, v22, v74
    v_fmac_f32 v66, v23, v75
    v_fmac_f32 v66, v24, v76
    v_fmac_f32 v66, v25, v77
    v_fmac_f32 v66, v26, v78
    v_fmac_f32 v66, v27, v79
    v_fmac_f32 v66, v28, v80
    v_fmac_f32 v66, v29, v81
    v_fmac_f32 v66, v30, v82
    v_fmac_f32 v66, v31, v83
    v_fmac_f32 v66, v32, v84
    v_fmac_f32 v66, v33, v85
    v_fmac_f32 v66, v34, v86
    v_fmac_f32 v66, v35, v87
    v_fmac_f32 v66, v36, v88
    v_fmac_f32 v66, v37, v89
    v_fmac_f32 v66, v38, v90
    v_fmac_f32 v66, v39, v91
    ds_read_b128 v[72:75], v7 offset:2176
    ds_read_b128 v[76:79], v7 offset:2192
    ds_read_b128 v[80:83], v7 offset:2208
    ds_read_b128 v[84:87], v7 offset:2224
    ds_read_b128 v[88:91], v7 offset:2240
    s_waitcnt lgkmcnt(0)
    v_mul_f32 v67, v20, v72
    v_fmac_f32 v67, v21, v73
    v_fmac_f32 v67, v22, v74
    v_fmac_f32 v67, v23, v75
    v_fmac_f32 v67, v24, v76
    v_fmac_f32 v67, v25, v77
    v_fmac_f32 v67, v26, v78
    v_fmac_f32 v67, v27, v79
    v_fmac_f32 v67, v28, v80
    v_fmac_f32 v67, v29, v81
    v_fmac_f32 v67, v30, v82
    v_fmac_f32 v67, v31, v83
    v_fmac_f32 v67, v32, v84
    v_fmac_f32 v67, v33, v85
    v_fmac_f32 v67, v34, v86
    v_fmac_f32 v67, v35, v87
    v_fmac_f32 v67, v36, v88
    v_fmac_f32 v67, v37, v89
    v_fmac_f32 v67, v38, v90
    v_fmac_f32 v67, v39, v91
    ds_read_b128 v[72:75], v7 offset:2304
    ds_read_b128 v[76:79], v7 offset:2320
    ds_read_b128 v[80:83], v7 offset:2336
    ds_read_b128 v[84:87], v7 offset:2352
    ds_read_b128 v[88:91], v7 offset:2368
    s_waitcnt lgkmcnt(0)
    v_mul_f32 v68, v20, v72
    v_fmac_f32 v68, v21, v73
    v_fmac_f32 v68, v22, v74
    v_fmac_f32 v68, v23, v75
    v_fmac_f32 v68, v24, v76
    v_fmac_f32 v68, v25, v77
    v_fmac_f32 v68, v26, v78
    v_fmac_f32 v68, v27, v79
    v_fmac_f32 v68, v28, v80
    v_fmac_f32 v68, v29, v81
    v_fmac_f32 v68, v30, v82
    v_fmac_f32 v68, v31, v83
    v_fmac_f32 v68, v32, v84
    v_fmac_f32 v68, v33, v85
    v_fmac_f32 v68, v34, v86
    v_fmac_f32 v68, v35, v87
    v_fmac_f32 v68, v36, v88
    v_fmac_f32 v68, v37, v89
    v_fmac_f32 v68, v38, v90
    v_fmac_f32 v68, v39, v91
    ds_read_b128 v[72:75], v7 offset:2432
    ds_read_b128 v[76:79], v7 offset:2448
    ds_read_b128 v[80:83], v7 offset:2464
    ds_read_b128 v[84:87], v7 offset:2480
    ds_read_b128 v[88:91], v7 offset:2496
    s_waitcnt lgkmcnt(0)
    v_mul_f32 v69, v20, v72
    v_fmac_f32 v69, v21, v73
    v_fmac_f32 v69, v22, v74
    v_fmac_f32 v69, v23, v75
    v_fmac_f32 v69, v24, v76
    v_fmac_f32 v69, v25, v77
    v_fmac_f32 v69, v26, v78
    v_fmac_f32 v69, v27, v79
    v_fmac_f32 v69, v28, v80
    v_fmac_f32 v69, v29, v81
    v_fmac_f32 v69, v30, v82
    v_fmac_f32 v69, v31, v83
    v_fmac_f32 v69, v32, v84
    v_fmac_f32 v69, v33, v85
    v_fmac_f32 v69, v34, v86
    v_fmac_f32 v69, v35, v87
    v_fmac_f32 v69, v36, v88
    v_fmac_f32 v69, v37, v89
    v_fmac_f32 v69, v38, v90
    v_fmac_f32 v69, v39, v91
    ds_read_b128 v[72:75], v7 offset:2560
    ds_read_b128 v[76:79], v7 offset:2576
    ds_read_b128 v[80:83], v7 offset:2592
    ds_read_b128 v[84:87], v7 offset:2608
    ds_read_b128 v[88:91], v7 offset:2624
    s_waitcnt lgkmcnt(0)
    v_mul_f32 v70, v20, v72
    v_fmac_f32 v70, v21, v73
    v_fmac_f32 v70, v22, v74
    v_fmac_f32 v70, v23, v75
    v_fmac_f32 v70, v24, v76
    v_fmac_f32 v70, v25, v77
    v_fmac_f32 v70, v26, v78
    v_fmac_f32 v70, v27, v79
    v_fmac_f32 v70, v28, v80
    v_fmac_f32 v70, v29, v81
    v_fmac_f32 v70, v30, v82
    v_fmac_f32 v70, v31, v83
    v_fmac_f32 v70, v32, v84
    v_fmac_f32 v70, v33, v85
    v_fmac_f32 v70, v34, v86
    v_fmac_f32 v70, v35, v87
    v_fmac_f32 v70, v36, v88
    v_fmac_f32 v70, v37, v89
    v_fmac_f32 v70, v38, v90
    v_fmac_f32 v70, v39, v91
    v_add_f32 v70, 0x358637bd, v70
    v_rcp_f32 v70, v70
    s_nop 0
    v_mul_f32 v50, v50, v70
    v_mul_f32 v51, v51, v70
    v_mul_f32 v52, v52, v70
    v_mul_f32 v53, v53, v70
    v_mul_f32 v54, v54, v70
    v_mul_f32 v55, v55, v70
    v_mul_f32 v56, v56, v70
    v_mul_f32 v57, v57, v70
    v_mul_f32 v58, v58, v70
    v_mul_f32 v59, v59, v70
    v_mul_f32 v60, v60, v70
    v_mul_f32 v61, v61, v70
    v_mul_f32 v62, v62, v70
    v_mul_f32 v63, v63, v70
    v_mul_f32 v64, v64, v70
    v_mul_f32 v65, v65, v70
    v_mul_f32 v66, v66, v70
    v_mul_f32 v67, v67, v70
    v_mul_f32 v68, v68, v70
    v_mul_f32 v69, v69, v70
    v_cvt_pk_bf16_f32 v8, v50, v51
    v_cvt_pk_bf16_f32 v9, v52, v53
    v_cvt_pk_bf16_f32 v10, v54, v55
    v_cvt_pk_bf16_f32 v11, v56, v57
    v_cvt_pk_bf16_f32 v12, v58, v59
    v_cvt_pk_bf16_f32 v13, v60, v61
    v_cvt_pk_bf16_f32 v14, v62, v63
    v_cvt_pk_bf16_f32 v15, v64, v65
    v_cvt_pk_bf16_f32 v16, v66, v67
    v_cvt_pk_bf16_f32 v17, v68, v69
    v_add_u32 v6, 18874368, v4
    buffer_store_dwordx2 v[8:9], v6, s[8:11], 0 offen offset:0
    buffer_store_dwordx2 v[10:11], v6, s[8:11], 0 offen offset:8
    buffer_store_dwordx2 v[12:13], v6, s[8:11], 0 offen offset:16
    buffer_store_dwordx2 v[14:15], v6, s[8:11], 0 offen offset:24
    buffer_store_dwordx2 v[16:17], v6, s[8:11], 0 offen offset:32
attn_a2_kernel_end:
    s_endpgm
.section .rodata,"a"
.p2align 6
.amdhsa_kernel attn_a2_kernel
  .amdhsa_next_free_vgpr 96
  .amdhsa_next_free_sgpr 40
  .amdhsa_accum_offset 96
  .amdhsa_group_segment_fixed_size 0
  .amdhsa_kernarg_size 104
  .amdhsa_user_sgpr_count 2
  .amdhsa_user_sgpr_kernarg_segment_ptr 1
  .amdhsa_system_sgpr_workgroup_id_x 1
.end_amdhsa_kernel
.text
.globl wo_a2_kernel
.p2align 8
.type wo_a2_kernel,@function
wo_a2_kernel:
    v_lshrrev_b32 v1, 6, v0
    v_and_b32 v2, 63, v0
    s_nop 0
    v_readfirstlane_b32 s3, v1
    s_cmp_ge_u32 s2, 128
    s_cbranch_scc1 wo_a2_kernel_end
    s_load_dwordx2 s[4:5], s[0:1], 96
    s_load_dwordx2 s[6:7], s[0:1], 80
    s_mul_i32 s20, s2, 1
    s_lshr_b32 s20, s20, 3
    s_mul_i32 s21, s20, 8
    s_sub_u32 s21, s2, s21
    s_lshl_b32 s20, s20, 2
    s_add_u32 s20, s20, s3
    s_mul_i32 s22, s20, 32
    s_mul_i32 s23, s21, 80
    s_waitcnt lgkmcnt(0)
    s_mov_b32 s8, s4
    s_mov_b32 s9, s5
    s_mov_b32 s10, 268435456
    s_mov_b32 s11, 0x00020000
    v_and_b32 v3, 15, v2
    v_lshrrev_b32 v4, 4, v2
    s_mov_b32 s24, 1280
    v_add_u32 v5, s22, v3
    v_mul_lo_u32 v5, v5, s24
    v_lshlrev_b32 v6, 4, v4
    v_add_u32 v5, v5, v6
    v_add_u32 v5, 18874368, v5
    v_mov_b32 v8, v5
    v_add_u32 v9, 20480, v5
    v_lshlrev_b32 v7, 4, v2
    s_mov_b32 s25, 0
    s_mov_b32 s26, 0
    s_mul_i32 s27, s21, 102400
    s_add_u32 s27, s27, s26
    s_add_u32 s27, s27, 29360128
    s_add_u32 s32, s27, 0
    s_add_u32 s33, s27, 20480
    s_add_u32 s34, s27, 40960
    s_add_u32 s35, s27, 61440
    s_add_u32 s36, s27, 81920
    v_accvgpr_write_b32 a0, 0
    v_accvgpr_write_b32 a1, 0
    v_accvgpr_write_b32 a2, 0
    v_accvgpr_write_b32 a3, 0
    v_accvgpr_write_b32 a4, 0
    v_accvgpr_write_b32 a5, 0
    v_accvgpr_write_b32 a6, 0
    v_accvgpr_write_b32 a7, 0
    v_accvgpr_write_b32 a8, 0
    v_accvgpr_write_b32 a9, 0
    v_accvgpr_write_b32 a10, 0
    v_accvgpr_write_b32 a11, 0
    v_accvgpr_write_b32 a12, 0
    v_accvgpr_write_b32 a13, 0
    v_accvgpr_write_b32 a14, 0
    v_accvgpr_write_b32 a15, 0
    v_accvgpr_write_b32 a16, 0
    v_accvgpr_write_b32 a17, 0
    v_accvgpr_write_b32 a18, 0
    v_accvgpr_write_b32 a19, 0
    v_accvgpr_write_b32 a20, 0
    v_accvgpr_write_b32 a21, 0
    v_accvgpr_write_b32 a22, 0
    v_accvgpr_write_b32 a23, 0
    v_accvgpr_write_b32 a24, 0
    v_accvgpr_write_b32 a25, 0
    v_accvgpr_write_b32 a26, 0
    v_accvgpr_write_b32 a27, 0
    v_accvgpr_write_b32 a28, 0
    v_accvgpr_write_b32 a29, 0
    v_accvgpr_write_b32 a30, 0
    v_accvgpr_write_b32 a31, 0
    v_accvgpr_write_b32 a32, 0
    v_accvgpr_write_b32 a33, 0
    v_accvgpr_write_b32 a34, 0
    v_accvgpr_write_b32 a35, 0
    v_accvgpr_write_b32 a36, 0
    v_accvgpr_write_b32 a37, 0
    v_accvgpr_write_b32 a38, 0
    v_accvgpr_write_b32 a39, 0
    buffer_load_dwordx4 v[16:19], v8, s[8:11], s25 offen
    buffer_load_dwordx4 v[20:23], v9, s[8:11], s25 offen
    buffer_load_dwordx4 v[24:27], v7, s[8:11], s32 offen
    buffer_load_dwordx4 v[28:31], v7, s[8:11], s33 offen
    buffer_load_dwordx4 v[32:35], v7, s[8:11], s34 offen
    buffer_load_dwordx4 v[36:39], v7, s[8:11], s35 offen
    buffer_load_dwordx4 v[40:43], v7, s[8:11], s36 offen
    s_mov_b32 s28, 10
wo_a2_kernel_loop0:
    s_add_u32 s25, s25, 64
    s_add_u32 s32, s32, 1024
    s_add_u32 s33, s33, 1024
    s_add_u32 s34, s34, 1024
    s_add_u32 s35, s35, 1024
    s_add_u32 s36, s36, 1024
    buffer_load_dwordx4 v[44:47], v8, s[8:11], s25 offen
    buffer_load_dwordx4 v[48:51], v9, s[8:11], s25 offen
    buffer_load_dwordx4 v[52:55], v7, s[8:11], s32 offen
    buffer_load_dwordx4 v[56:59], v7, s[8:11], s33 offen
    buffer_load_dwordx4 v[60:63], v7, s[8:11], s34 offen
    buffer_load_dwordx4 v[64:67], v7, s[8:11], s35 offen
    buffer_load_dwordx4 v[68:71], v7, s[8:11], s36 offen
    s_waitcnt vmcnt(7)
    v_mfma_f32_16x16x32_bf16 a[0:3], v[24:27], v[16:19], a[0:3]
    v_mfma_f32_16x16x32_bf16 a[20:23], v[24:27], v[20:23], a[20:23]
    v_mfma_f32_16x16x32_bf16 a[4:7], v[28:31], v[16:19], a[4:7]
    v_mfma_f32_16x16x32_bf16 a[24:27], v[28:31], v[20:23], a[24:27]
    v_mfma_f32_16x16x32_bf16 a[8:11], v[32:35], v[16:19], a[8:11]
    v_mfma_f32_16x16x32_bf16 a[28:31], v[32:35], v[20:23], a[28:31]
    v_mfma_f32_16x16x32_bf16 a[12:15], v[36:39], v[16:19], a[12:15]
    v_mfma_f32_16x16x32_bf16 a[32:35], v[36:39], v[20:23], a[32:35]
    v_mfma_f32_16x16x32_bf16 a[16:19], v[40:43], v[16:19], a[16:19]
    v_mfma_f32_16x16x32_bf16 a[36:39], v[40:43], v[20:23], a[36:39]
    s_sub_u32 s28, s28, 1
    s_cmp_eq_u32 s28, 0
    s_cbranch_scc1 wo_a2_kernel_loop0_last
    s_add_u32 s25, s25, 64
    s_add_u32 s32, s32, 1024
    s_add_u32 s33, s33, 1024
    s_add_u32 s34, s34, 1024
    s_add_u32 s35, s35, 1024
    s_add_u32 s36, s36, 1024
    buffer_load_dwordx4 v[16:19], v8, s[8:11], s25 offen
    buffer_load_dwordx4 v[20:23], v9, s[8:11], s25 offen
    buffer_load_dwordx4 v[24:27], v7, s[8:11], s32 offen
    buffer_load_dwordx4 v[28:31], v7, s[8:11], s33 offen
    buffer_load_dwordx4 v[32:35], v7, s[8:11], s34 offen
    buffer_load_dwordx4 v[36:39], v7, s[8:11], s35 offen
    buffer_load_dwordx4 v[40:43], v7, s[8:11], s36 offen
    s_waitcnt vmcnt(7)
    v_mfma_f32_16x16x32_bf16 a[0:3], v[52:55], v[44:47], a[0:3]
    v_mfma_f32_16x16x32_bf16 a[20:23], v[52:55], v[48:51], a[20:23]
    v_mfma_f32_16x16x32_bf16 a[4:7], v[56:59], v[44:47], a[4:7]
    v_mfma_f32_16x16x32_bf16 a[24:27], v[56:59], v[48:51], a[24:27]
    v_mfma_f32_16x16x32_bf16 a[8:11], v[60:63], v[44:47], a[8:11]
    v_mfma_f32_16x16x32_bf16 a[28:31], v[60:63], v[48:51], a[28:31]
    v_mfma_f32_16x16x32_bf16 a[12:15], v[64:67], v[44:47], a[12:15]
    v_mfma_f32_16x16x32_bf16 a[32:35], v[64:67], v[48:51], a[32:35]
    v_mfma_f32_16x16x32_bf16 a[16:19], v[68:71], v[44:47], a[16:19]
    v_mfma_f32_16x16x32_bf16 a[36:39], v[68:71], v[48:51], a[36:39]
    s_branch wo_a2_kernel_loop0
wo_a2_kernel_loop0_last:
    s_waitcnt vmcnt(0)
    v_mfma_f32_16x16x32_bf16 a[0:3], v[52:55], v[44:47], a[0:3]
    v_mfma_f32_16x16x32_bf16 a[20:23], v[52:55], v[48:51], a[20:23]
    v_mfma_f32_16x16x32_bf16 a[4:7], v[56:59], v[44:47], a[4:7]
    v_mfma_f32_16x16x32_bf16 a[24:27], v[56:59], v[48:51], a[24:27]
    v_mfma_f32_16x16x32_bf16 a[8:11], v[60:63], v[44:47], a[8:11]
    v_mfma_f32_16x16x32_bf16 a[28:31], v[60:63], v[48:51], a[28:31]
    v_mfma_f32_16x16x32_bf16 a[12:15], v[64:67], v[44:47], a[12:15]
    v_mfma_f32_16x16x32_bf16 a[32:35], v[64:67], v[48:51], a[32:35]
    v_mfma_f32_16x16x32_bf16 a[16:19], v[68:71], v[44:47], a[16:19]
    v_mfma_f32_16x16x32_bf16 a[36:39], v[68:71], v[48:51], a[36:39]
    s_nop 7
    s_nop 7
    s_mov_b32 s24, 1280
    v_add_u32 v5, s22, v3
    v_mul_lo_u32 v5, v5, s24
    v_lshlrev_b32 v6, 3, v4
    s_lshl_b32 s29, s23, 1
    v_add3_u32 v5, v5, v6, s29
    v_add_u32 v6, 4194304, v5
    buffer_load_dwordx2 v[72:73], v6, s[8:11], 0 offen
    v_accvgpr_read_b32 v76, a0
    v_accvgpr_read_b32 v77, a1
    v_accvgpr_read_b32 v78, a2
    v_accvgpr_read_b32 v79, a3
    v_cvt_pk_bf16_f32 v80, v76, v77
    v_cvt_pk_bf16_f32 v81, v78, v79
    s_waitcnt vmcnt(0)
    v_lshlrev_b32 v76, 16, v80
    v_and_b32 v77, 0xffff0000, v80
    v_lshlrev_b32 v82, 16, v72
    v_and_b32 v83, 0xffff0000, v72
    v_add_f32 v76, v76, v82
    v_add_f32 v77, v77, v83
    v_lshlrev_b32 v78, 16, v81
    v_and_b32 v79, 0xffff0000, v81
    v_lshlrev_b32 v82, 16, v73
    v_and_b32 v83, 0xffff0000, v73
    v_add_f32 v78, v78, v82
    v_add_f32 v79, v79, v83
    v_cvt_pk_bf16_f32 v80, v76, v77
    v_cvt_pk_bf16_f32 v81, v78, v79
    v_add_u32 v6, 4194304, v5
    buffer_store_dwordx2 v[80:81], v6, s[8:11], 0 offen
    v_add_u32 v6, 4194336, v5
    buffer_load_dwordx2 v[72:73], v6, s[8:11], 0 offen
    v_accvgpr_read_b32 v76, a4
    v_accvgpr_read_b32 v77, a5
    v_accvgpr_read_b32 v78, a6
    v_accvgpr_read_b32 v79, a7
    v_cvt_pk_bf16_f32 v80, v76, v77
    v_cvt_pk_bf16_f32 v81, v78, v79
    s_waitcnt vmcnt(0)
    v_lshlrev_b32 v76, 16, v80
    v_and_b32 v77, 0xffff0000, v80
    v_lshlrev_b32 v82, 16, v72
    v_and_b32 v83, 0xffff0000, v72
    v_add_f32 v76, v76, v82
    v_add_f32 v77, v77, v83
    v_lshlrev_b32 v78, 16, v81
    v_and_b32 v79, 0xffff0000, v81
    v_lshlrev_b32 v82, 16, v73
    v_and_b32 v83, 0xffff0000, v73
    v_add_f32 v78, v78, v82
    v_add_f32 v79, v79, v83
    v_cvt_pk_bf16_f32 v80, v76, v77
    v_cvt_pk_bf16_f32 v81, v78, v79
    v_add_u32 v6, 4194336, v5
    buffer_store_dwordx2 v[80:81], v6, s[8:11], 0 offen
    v_add_u32 v6, 4194368, v5
    buffer_load_dwordx2 v[72:73], v6, s[8:11], 0 offen
    v_accvgpr_read_b32 v76, a8
    v_accvgpr_read_b32 v77, a9
    v_accvgpr_read_b32 v78, a10
    v_accvgpr_read_b32 v79, a11
    v_cvt_pk_bf16_f32 v80, v76, v77
    v_cvt_pk_bf16_f32 v81, v78, v79
    s_waitcnt vmcnt(0)
    v_lshlrev_b32 v76, 16, v80
    v_and_b32 v77, 0xffff0000, v80
    v_lshlrev_b32 v82, 16, v72
    v_and_b32 v83, 0xffff0000, v72
    v_add_f32 v76, v76, v82
    v_add_f32 v77, v77, v83
    v_lshlrev_b32 v78, 16, v81
    v_and_b32 v79, 0xffff0000, v81
    v_lshlrev_b32 v82, 16, v73
    v_and_b32 v83, 0xffff0000, v73
    v_add_f32 v78, v78, v82
    v_add_f32 v79, v79, v83
    v_cvt_pk_bf16_f32 v80, v76, v77
    v_cvt_pk_bf16_f32 v81, v78, v79
    v_add_u32 v6, 4194368, v5
    buffer_store_dwordx2 v[80:81], v6, s[8:11], 0 offen
    v_add_u32 v6, 4194400, v5
    buffer_load_dwordx2 v[72:73], v6, s[8:11], 0 offen
    v_accvgpr_read_b32 v76, a12
    v_accvgpr_read_b32 v77, a13
    v_accvgpr_read_b32 v78, a14
    v_accvgpr_read_b32 v79, a15
    v_cvt_pk_bf16_f32 v80, v76, v77
    v_cvt_pk_bf16_f32 v81, v78, v79
    s_waitcnt vmcnt(0)
    v_lshlrev_b32 v76, 16, v80
    v_and_b32 v77, 0xffff0000, v80
    v_lshlrev_b32 v82, 16, v72
    v_and_b32 v83, 0xffff0000, v72
    v_add_f32 v76, v76, v82
    v_add_f32 v77, v77, v83
    v_lshlrev_b32 v78, 16, v81
    v_and_b32 v79, 0xffff0000, v81
    v_lshlrev_b32 v82, 16, v73
    v_and_b32 v83, 0xffff0000, v73
    v_add_f32 v78, v78, v82
    v_add_f32 v79, v79, v83
    v_cvt_pk_bf16_f32 v80, v76, v77
    v_cvt_pk_bf16_f32 v81, v78, v79
    v_add_u32 v6, 4194400, v5
    buffer_store_dwordx2 v[80:81], v6, s[8:11], 0 offen
    v_add_u32 v6, 4194432, v5
    buffer_load_dwordx2 v[72:73], v6, s[8:11], 0 offen
    v_accvgpr_read_b32 v76, a16
    v_accvgpr_read_b32 v77, a17
    v_accvgpr_read_b32 v78, a18
    v_accvgpr_read_b32 v79, a19
    v_cvt_pk_bf16_f32 v80, v76, v77
    v_cvt_pk_bf16_f32 v81, v78, v79
    s_waitcnt vmcnt(0)
    v_lshlrev_b32 v76, 16, v80
    v_and_b32 v77, 0xffff0000, v80
    v_lshlrev_b32 v82, 16, v72
    v_and_b32 v83, 0xffff0000, v72
    v_add_f32 v76, v76, v82
    v_add_f32 v77, v77, v83
    v_lshlrev_b32 v78, 16, v81
    v_and_b32 v79, 0xffff0000, v81
    v_lshlrev_b32 v82, 16, v73
    v_and_b32 v83, 0xffff0000, v73
    v_add_f32 v78, v78, v82
    v_add_f32 v79, v79, v83
    v_cvt_pk_bf16_f32 v80, v76, v77
    v_cvt_pk_bf16_f32 v81, v78, v79
    v_add_u32 v6, 4194432, v5
    buffer_store_dwordx2 v[80:81], v6, s[8:11], 0 offen
    v_add_u32 v6, 4214784, v5
    buffer_load_dwordx2 v[72:73], v6, s[8:11], 0 offen
    v_accvgpr_read_b32 v76, a20
    v_accvgpr_read_b32 v77, a21
    v_accvgpr_read_b32 v78, a22
    v_accvgpr_read_b32 v79, a23
    v_cvt_pk_bf16_f32 v80, v76, v77
    v_cvt_pk_bf16_f32 v81, v78, v79
    s_waitcnt vmcnt(0)
    v_lshlrev_b32 v76, 16, v80
    v_and_b32 v77, 0xffff0000, v80
    v_lshlrev_b32 v82, 16, v72
    v_and_b32 v83, 0xffff0000, v72
    v_add_f32 v76, v76, v82
    v_add_f32 v77, v77, v83
    v_lshlrev_b32 v78, 16, v81
    v_and_b32 v79, 0xffff0000, v81
    v_lshlrev_b32 v82, 16, v73
    v_and_b32 v83, 0xffff0000, v73
    v_add_f32 v78, v78, v82
    v_add_f32 v79, v79, v83
    v_cvt_pk_bf16_f32 v80, v76, v77
    v_cvt_pk_bf16_f32 v81, v78, v79
    v_add_u32 v6, 4214784, v5
    buffer_store_dwordx2 v[80:81], v6, s[8:11], 0 offen
    v_add_u32 v6, 4214816, v5
    buffer_load_dwordx2 v[72:73], v6, s[8:11], 0 offen
    v_accvgpr_read_b32 v76, a24
    v_accvgpr_read_b32 v77, a25
    v_accvgpr_read_b32 v78, a26
    v_accvgpr_read_b32 v79, a27
    v_cvt_pk_bf16_f32 v80, v76, v77
    v_cvt_pk_bf16_f32 v81, v78, v79
    s_waitcnt vmcnt(0)
    v_lshlrev_b32 v76, 16, v80
    v_and_b32 v77, 0xffff0000, v80
    v_lshlrev_b32 v82, 16, v72
    v_and_b32 v83, 0xffff0000, v72
    v_add_f32 v76, v76, v82
    v_add_f32 v77, v77, v83
    v_lshlrev_b32 v78, 16, v81
    v_and_b32 v79, 0xffff0000, v81
    v_lshlrev_b32 v82, 16, v73
    v_and_b32 v83, 0xffff0000, v73
    v_add_f32 v78, v78, v82
    v_add_f32 v79, v79, v83
    v_cvt_pk_bf16_f32 v80, v76, v77
    v_cvt_pk_bf16_f32 v81, v78, v79
    v_add_u32 v6, 4214816, v5
    buffer_store_dwordx2 v[80:81], v6, s[8:11], 0 offen
    v_add_u32 v6, 4214848, v5
    buffer_load_dwordx2 v[72:73], v6, s[8:11], 0 offen
    v_accvgpr_read_b32 v76, a28
    v_accvgpr_read_b32 v77, a29
    v_accvgpr_read_b32 v78, a30
    v_accvgpr_read_b32 v79, a31
    v_cvt_pk_bf16_f32 v80, v76, v77
    v_cvt_pk_bf16_f32 v81, v78, v79
    s_waitcnt vmcnt(0)
    v_lshlrev_b32 v76, 16, v80
    v_and_b32 v77, 0xffff0000, v80
    v_lshlrev_b32 v82, 16, v72
    v_and_b32 v83, 0xffff0000, v72
    v_add_f32 v76, v76, v82
    v_add_f32 v77, v77, v83
    v_lshlrev_b32 v78, 16, v81
    v_and_b32 v79, 0xffff0000, v81
    v_lshlrev_b32 v82, 16, v73
    v_and_b32 v83, 0xffff0000, v73
    v_add_f32 v78, v78, v82
    v_add_f32 v79, v79, v83
    v_cvt_pk_bf16_f32 v80, v76, v77
    v_cvt_pk_bf16_f32 v81, v78, v79
    v_add_u32 v6, 4214848, v5
    buffer_store_dwordx2 v[80:81], v6, s[8:11], 0 offen
    v_add_u32 v6, 4214880, v5
    buffer_load_dwordx2 v[72:73], v6, s[8:11], 0 offen
    v_accvgpr_read_b32 v76, a32
    v_accvgpr_read_b32 v77, a33
    v_accvgpr_read_b32 v78, a34
    v_accvgpr_read_b32 v79, a35
    v_cvt_pk_bf16_f32 v80, v76, v77
    v_cvt_pk_bf16_f32 v81, v78, v79
    s_waitcnt vmcnt(0)
    v_lshlrev_b32 v76, 16, v80
    v_and_b32 v77, 0xffff0000, v80
    v_lshlrev_b32 v82, 16, v72
    v_and_b32 v83, 0xffff0000, v72
    v_add_f32 v76, v76, v82
    v_add_f32 v77, v77, v83
    v_lshlrev_b32 v78, 16, v81
    v_and_b32 v79, 0xffff0000, v81
    v_lshlrev_b32 v82, 16, v73
    v_and_b32 v83, 0xffff0000, v73
    v_add_f32 v78, v78, v82
    v_add_f32 v79, v79, v83
    v_cvt_pk_bf16_f32 v80, v76, v77
    v_cvt_pk_bf16_f32 v81, v78, v79
    v_add_u32 v6, 4214880, v5
    buffer_store_dwordx2 v[80:81], v6, s[8:11], 0 offen
    v_add_u32 v6, 4214912, v5
    buffer_load_dwordx2 v[72:73], v6, s[8:11], 0 offen
    v_accvgpr_read_b32 v76, a36
    v_accvgpr_read_b32 v77, a37
    v_accvgpr_read_b32 v78, a38
    v_accvgpr_read_b32 v79, a39
    v_cvt_pk_bf16_f32 v80, v76, v77
    v_cvt_pk_bf16_f32 v81, v78, v79
    s_waitcnt vmcnt(0)
    v_lshlrev_b32 v76, 16, v80
    v_and_b32 v77, 0xffff0000, v80
    v_lshlrev_b32 v82, 16, v72
    v_and_b32 v83, 0xffff0000, v72
    v_add_f32 v76, v76, v82
    v_add_f32 v77, v77, v83
    v_lshlrev_b32 v78, 16, v81
    v_and_b32 v79, 0xffff0000, v81
    v_lshlrev_b32 v82, 16, v73
    v_and_b32 v83, 0xffff0000, v73
    v_add_f32 v78, v78, v82
    v_add_f32 v79, v79, v83
    v_cvt_pk_bf16_f32 v80, v76, v77
    v_cvt_pk_bf16_f32 v81, v78, v79
    v_add_u32 v6, 4214912, v5
    buffer_store_dwordx2 v[80:81], v6, s[8:11], 0 offen
wo_a2_kernel_end:
    s_endpgm
.section .rodata,"a"
.p2align 6
.amdhsa_kernel wo_a2_kernel
  .amdhsa_next_free_vgpr 136
  .amdhsa_next_free_sgpr 64
  .amdhsa_accum_offset 96
  .amdhsa_group_segment_fixed_size 0
  .amdhsa_kernarg_size 104
  .amdhsa_user_sgpr_count 2
  .amdhsa_user_sgpr_kernarg_segment_ptr 1
  .amdhsa_system_sgpr_workgroup_id_x 1
.end_amdhsa_kernel
.text
.globl chain2_kernel
.p2align 8
.type chain2_kernel,@function
chain2_kernel:
    s_cmp_ge_u32 s2, 232
    s_cbranch_scc1 chain2_kernel_end
    s_load_dwordx2 s[4:5], s[0:1], 96
    s_load_dwordx2 s[6:7], s[0:1], 32
    v_and_b32 v1, 63, v0
    v_lshrrev_b32 v4, 6, v0
    v_and_b32 v2, 15, v1
    v_lshrrev_b32 v3, 4, v1
    v_readfirstlane_b32 s3, v4
    s_mov_b32 s60, 131072
    s_waitcnt lgkmcnt(0)
    s_mov_b32 s8, s4
    s_mov_b32 s9, s5
    s_mov_b32 s10, 268435456
    s_mov_b32 s11, 0x00020000
    s_mov_b32 s20, s6
    s_mov_b32 s21, s7
    s_mov_b32 s22, 10240
    s_mov_b32 s23, 0x00020000
    s_cmp_ge_u32 s2, 200
    s_cbranch_scc1 chain2_kernel_roleO
    s_cmp_ge_u32 s2, 104
    s_cbranch_scc1 chain2_kernel_roleP
    s_cmp_ge_u32 s2, 64
    s_cbranch_scc1 chain2_kernel_roleR
    s_cmp_ge_u32 s2, 32
    s_cbranch_scc1 chain2_kernel_roleV
    s_mov_b32 s44, s2
    s_load_dwordx2 s[6:7], s[0:1], 40
    s_load_dwordx2 s[24:25], s[0:1], 48
    s_waitcnt lgkmcnt(0)
    s_mov_b32 s12, s6
    s_mov_b32 s13, s7
    s_mov_b32 s14, 7864320
    s_mov_b32 s15, 0x00020000
    s_mov_b32 s16, s24
    s_mov_b32 s17, s25
    s_mov_b32 s18, 7864320
    s_mov_b32 s19, 0x00020000
    v_add_u32 v16, 0, v0
    s_mov_b32 s24, 683
    v_mul_lo_u32 v17, v16, s24
    v_lshrrev_b32 v17, 14, v17
    v_mul_u32_u24 v18, 24, v17
    v_sub_u32 v18, v16, v18
    s_mov_b32 s24, 12288
    v_mul_lo_u32 v4, v17, s24
    v_lshl_add_u32 v4, v18, 4, v4
    v_mul_u32_u24 v10, 400, v17
    v_lshl_add_u32 v10, v18, 4, v10
    v_add_u32 v10, 106496, v10
    v_add_u32 v16, 256, v0
    s_mov_b32 s24, 683
    v_mul_lo_u32 v17, v16, s24
    v_lshrrev_b32 v17, 14, v17
    v_mul_u32_u24 v18, 24, v17
    v_sub_u32 v18, v16, v18
    s_mov_b32 s24, 12288
    v_mul_lo_u32 v5, v17, s24
    v_lshl_add_u32 v5, v18, 4, v5
    v_mul_u32_u24 v11, 400, v17
    v_lshl_add_u32 v11, v18, 4, v11
    v_add_u32 v11, 106496, v11
    v_add_u32 v16, 512, v0
    s_mov_b32 s24, 683
    v_mul_lo_u32 v17, v16, s24
    v_lshrrev_b32 v17, 14, v17
    v_mul_u32_u24 v18, 24, v17
    v_sub_u32 v18, v16, v18
    s_mov_b32 s24, 12288
    v_mul_lo_u32 v6, v17, s24
    v_lshl_add_u32 v6, v18, 4, v6
    v_mul_u32_u24 v12, 400, v17
    v_lshl_add_u32 v12, v18, 4, v12
    v_add_u32 v12, 106496, v12
    v_add_u32 v16, 768, v0
    s_mov_b32 s24, 683
    v_mul_lo_u32 v17, v16, s24
    v_lshrrev_b32 v17, 14, v17
    v_mul_u32_u24 v18, 24, v17
    v_sub_u32 v18, v16, v18
    s_mov_b32 s24, 12288
    v_mul_lo_u32 v7, v17, s24
    v_lshl_add_u32 v7, v18, 4, v7
    v_mul_u32_u24 v13, 400, v17
    v_lshl_add_u32 v13, v18, 4, v13
    v_add_u32 v13, 106496, v13
    v_add_u32 v16, 1024, v0
    s_mov_b32 s24, 683
    v_mul_lo_u32 v17, v16, s24
    v_lshrrev_b32 v17, 14, v17
    v_mul_u32_u24 v18, 24, v17
    v_sub_u32 v18, v16, v18
    s_mov_b32 s24, 12288
    v_mul_lo_u32 v8, v17, s24
    v_lshl_add_u32 v8, v18, 4, v8
    v_mul_u32_u24 v14, 400, v17
    v_lshl_add_u32 v14, v18, 4, v14
    v_add_u32 v14, 106496, v14
    v_add_u32 v16, 1280, v0
    s_mov_b32 s24, 683
    v_mul_lo_u32 v17, v16, s24
    v_lshrrev_b32 v17, 14, v17
    v_mul_u32_u24 v18, 24, v17
    v_sub_u32 v18, v16, v18
    s_mov_b32 s24, 12288
    v_mul_lo_u32 v9, v17, s24
    v_lshl_add_u32 v9, v18, 4, v9
    v_mul_u32_u24 v15, 400, v17
    v_lshl_add_u32 v15, v18, 4, v15
    v_add_u32 v15, 106496, v15
    v_lshrrev_b32 v17, 1, v3
    v_lshlrev_b32 v17, 4, v17
    v_and_b32 v18, 1, v3
    v_lshl_add_u32 v17, v18, 2, v17
    v_lshrrev_b32 v18, 2, v2
    v_and_b32 v19, 1, v18
    v_add_u32 v17, v17, v19
    v_lshrrev_b32 v18, 1, v18
    v_lshl_add_u32 v17, v18, 3, v17
    v_mul_u32_u24 v16, 400, v17
    v_and_b32 v18, 3, v2
    v_lshl_add_u32 v16, v18, 3, v16
    v_add_u32 v16, 106496, v16
    s_mul_i32 s24, s3, 96
    v_add_u32 v16, s24, v16
    v_lshlrev_b32 v17, 4, v1
    s_mul_i32 s24, s3, 20480
    s_add_u32 s24, s24, 24576
    v_add_u32 v17, s24, v17
    s_mul_i32 s45, s44, 384
    s_add_u32 s46, s45, 0
    buffer_load_dwordx4 v[24:27], v4, s[12:15], s46 offen
    buffer_load_dwordx4 v[28:31], v5, s[12:15], s46 offen
    buffer_load_dwordx4 v[32:35], v6, s[12:15], s46 offen
    buffer_load_dwordx4 v[36:39], v7, s[12:15], s46 offen
    buffer_load_dwordx4 v[40:43], v8, s[12:15], s46 offen
    buffer_load_dwordx4 v[44:47], v9, s[12:15], s46 offen
    s_add_u32 s46, s45, 0
    buffer_load_dwordx4 v[48:51], v4, s[16:19], s46 offen
    buffer_load_dwordx4 v[52:55], v5, s[16:19], s46 offen
    buffer_load_dwordx4 v[56:59], v6, s[16:19], s46 offen
    buffer_load_dwordx4 v[60:63], v7, s[16:19], s46 offen
    buffer_load_dwordx4 v[64:67], v8, s[16:19], s46 offen
    buffer_load_dwordx4 v[68:71], v9, s[16:19], s46 offen
    s_waitcnt vmcnt(6)
    ds_write_b128 v10, v[24:27]
    ds_write_b128 v11, v[28:31]
    ds_write_b128 v12, v[32:35]
    ds_write_b128 v13, v[36:39]
    ds_write_b128 v14, v[40:43]
    ds_write_b128 v15, v[44:47]
    s_add_u32 s46, s45, 786432
    buffer_load_dwordx4 v[72:75], v4, s[12:15], s46 offen
    buffer_load_dwordx4 v[76:79], v5, s[12:15], s46 offen
    buffer_load_dwordx4 v[80:83], v6, s[12:15], s46 offen
    buffer_load_dwordx4 v[84:87], v7, s[12:15], s46 offen
    buffer_load_dwordx4 v[88:91], v8, s[12:15], s46 offen
    buffer_load_dwordx4 v[92:95], v9, s[12:15], s46 offen
    s_waitcnt lgkmcnt(0)
    s_barrier
    ds_read_b64_tr_b16 a[0:1], v16 offset:0
    ds_read_b64_tr_b16 a[2:3], v16 offset:800
    ds_read_b64_tr_b16 a[4:5], v16 offset:12800
    ds_read_b64_tr_b16 a[6:7], v16 offset:13600
    ds_read_b64_tr_b16 a[80:81], v16 offset:32
    ds_read_b64_tr_b16 a[82:83], v16 offset:832
    ds_read_b64_tr_b16 a[84:85], v16 offset:12832
    ds_read_b64_tr_b16 a[86:87], v16 offset:13632
    ds_read_b64_tr_b16 a[160:161], v16 offset:64
    ds_read_b64_tr_b16 a[162:163], v16 offset:864
    ds_read_b64_tr_b16 a[164:165], v16 offset:12864
    ds_read_b64_tr_b16 a[166:167], v16 offset:13664
    s_waitcnt lgkmcnt(0)
    s_barrier
    s_waitcnt vmcnt(6)
    ds_write_b128 v10, v[48:51]
    ds_write_b128 v11, v[52:55]
    ds_write_b128 v12, v[56:59]
    ds_write_b128 v13, v[60:63]
    ds_write_b128 v14, v[64:67]
    ds_write_b128 v15, v[68:71]
    s_add_u32 s46, s45, 786432
    buffer_load_dwordx4 v[24:27], v4, s[16:19], s46 offen
    buffer_load_dwordx4 v[28:31], v5, s[16:19], s46 offen
    buffer_load_dwordx4 v[32:35], v6, s[16:19], s46 offen
    buffer_load_dwordx4 v[36:39], v7, s[16:19], s46 offen
    buffer_load_dwordx4 v[40:43], v8, s[16:19], s46 offen
    buffer_load_dwordx4 v[44:47], v9, s[16:19], s46 offen
    s_waitcnt lgkmcnt(0)
    s_barrier
    ds_read_b64_tr_b16 v[96:97], v16 offset:0
    ds_read_b64_tr_b16 v[98:99], v16 offset:800
    ds_read_b64_tr_b16 v[100:101], v16 offset:12800
    ds_read_b64_tr_b16 v[102:103], v16 offset:13600
    ds_read_b64_tr_b16 v[176:177], v16 offset:32
    ds_read_b64_tr_b16 v[178:179], v16 offset:832
    ds_read_b64_tr_b16 v[180:181], v16 offset:12832
    ds_read_b64_tr_b16 v[182:183], v16 offset:13632
    ds_read_b64_tr_b16 v[48:49], v16 offset:64
    ds_read_b64_tr_b16 v[50:51], v16 offset:864
    ds_read_b64_tr_b16 v[52:53], v16 offset:12864
    ds_read_b64_tr_b16 v[54:55], v16 offset:13664
    s_waitcnt lgkmcnt(0)
    ds_write_b128 v17, v[48:51] offset:0
    ds_write_b128 v17, v[52:55] offset:1024
    s_waitcnt lgkmcnt(0)
    s_barrier
    s_waitcnt vmcnt(6)
    ds_write_b128 v10, v[72:75]
    ds_write_b128 v11, v[76:79]
    ds_write_b128 v12, v[80:83]
    ds_write_b128 v13, v[84:87]
    ds_write_b128 v14, v[88:91]
    ds_write_b128 v15, v[92:95]
    s_add_u32 s46, s45, 1572864
    buffer_load_dwordx4 v[48:51], v4, s[12:15], s46 offen
    buffer_load_dwordx4 v[52:55], v5, s[12:15], s46 offen
    buffer_load_dwordx4 v[56:59], v6, s[12:15], s46 offen
    buffer_load_dwordx4 v[60:63], v7, s[12:15], s46 offen
    buffer_load_dwordx4 v[64:67], v8, s[12:15], s46 offen
    buffer_load_dwordx4 v[68:71], v9, s[12:15], s46 offen
    s_waitcnt lgkmcnt(0)
    s_barrier
    ds_read_b64_tr_b16 a[8:9], v16 offset:0
    ds_read_b64_tr_b16 a[10:11], v16 offset:800
    ds_read_b64_tr_b16 a[12:13], v16 offset:12800
    ds_read_b64_tr_b16 a[14:15], v16 offset:13600
    ds_read_b64_tr_b16 a[88:89], v16 offset:32
    ds_read_b64_tr_b16 a[90:91], v16 offset:832
    ds_read_b64_tr_b16 a[92:93], v16 offset:12832
    ds_read_b64_tr_b16 a[94:95], v16 offset:13632
    ds_read_b64_tr_b16 a[168:169], v16 offset:64
    ds_read_b64_tr_b16 a[170:171], v16 offset:864
    ds_read_b64_tr_b16 a[172:173], v16 offset:12864
    ds_read_b64_tr_b16 a[174:175], v16 offset:13664
    s_waitcnt lgkmcnt(0)
    s_barrier
    s_waitcnt vmcnt(6)
    ds_write_b128 v10, v[24:27]
    ds_write_b128 v11, v[28:31]
    ds_write_b128 v12, v[32:35]
    ds_write_b128 v13, v[36:39]
    ds_write_b128 v14, v[40:43]
    ds_write_b128 v15, v[44:47]
    s_add_u32 s46, s45, 1572864
    buffer_load_dwordx4 v[72:75], v4, s[16:19], s46 offen
    buffer_load_dwordx4 v[76:79], v5, s[16:19], s46 offen
    buffer_load_dwordx4 v[80:83], v6, s[16:19], s46 offen
    buffer_load_dwordx4 v[84:87], v7, s[16:19], s46 offen
    buffer_load_dwordx4 v[88:91], v8, s[16:19], s46 offen
    buffer_load_dwordx4 v[92:95], v9, s[16:19], s46 offen
    s_waitcnt lgkmcnt(0)
    s_barrier
    ds_read_b64_tr_b16 v[104:105], v16 offset:0
    ds_read_b64_tr_b16 v[106:107], v16 offset:800
    ds_read_b64_tr_b16 v[108:109], v16 offset:12800
    ds_read_b64_tr_b16 v[110:111], v16 offset:13600
    ds_read_b64_tr_b16 v[184:185], v16 offset:32
    ds_read_b64_tr_b16 v[186:187], v16 offset:832
    ds_read_b64_tr_b16 v[188:189], v16 offset:12832
    ds_read_b64_tr_b16 v[190:191], v16 offset:13632
    ds_read_b64_tr_b16 v[24:25], v16 offset:64
    ds_read_b64_tr_b16 v[26:27], v16 offset:864
    ds_read_b64_tr_b16 v[28:29], v16 offset:12864
    ds_read_b64_tr_b16 v[30:31], v16 offset:13664
    s_waitcnt lgkmcnt(0)
    ds_write_b128 v17, v[24:27] offset:2048
    ds_write_b128 v17, v[28:31] offset:3072
    s_waitcnt lgkmcnt(0)
    s_barrier
    s_waitcnt vmcnt(6)
    ds_write_b128 v10, v[48:51]
    ds_write_b128 v11, v[52:55]
    ds_write_b128 v12, v[56:59]
    ds_write_b128 v13, v[60:63]
    ds_write_b128 v14, v[64:67]
    ds_write_b128 v15, v[68:71]
    s_add_u32 s46, s45, 2359296
    buffer_load_dwordx4 v[24:27], v4, s[12:15], s46 offen
    buffer_load_dwordx4 v[28:31], v5, s[12:15], s46 offen
    buffer_load_dwordx4 v[32:35], v6, s[12:15], s46 offen
    buffer_load_dwordx4 v[36:39], v7, s[12:15], s46 offen
    buffer_load_dwordx4 v[40:43], v8, s[12:15], s46 offen
    buffer_load_dwordx4 v[44:47], v9, s[12:15], s46 offen
    s_waitcnt lgkmcnt(0)
    s_barrier
    ds_read_b64_tr_b16 a[16:17], v16 offset:0
    ds_read_b64_tr_b16 a[18:19], v16 offset:800
    ds_read_b64_tr_b16 a[20:21], v16 offset:12800
    ds_read_b64_tr_b16 a[22:23], v16 offset:13600
    ds_read_b64_tr_b16 a[96:97], v16 offset:32
    ds_read_b64_tr_b16 a[98:99], v16 offset:832
    ds_read_b64_tr_b16 a[100:101], v16 offset:12832
    ds_read_b64_tr_b16 a[102:103], v16 offset:13632
    ds_read_b64_tr_b16 a[176:177], v16 offset:64
    ds_read_b64_tr_b16 a[178:179], v16 offset:864
    ds_read_b64_tr_b16 a[180:181], v16 offset:12864
    ds_read_b64_tr_b16 a[182:183], v16 offset:13664
    s_waitcnt lgkmcnt(0)
    s_barrier
    s_waitcnt vmcnt(6)
    ds_write_b128 v10, v[72:75]
    ds_write_b128 v11, v[76:79]
    ds_write_b128 v12, v[80:83]
    ds_write_b128 v13, v[84:87]
    ds_write_b128 v14, v[88:91]
    ds_write_b128 v15, v[92:95]
    s_add_u32 s46, s45, 2359296
    buffer_load_dwordx4 v[48:51], v4, s[16:19], s46 offen
    buffer_load_dwordx4 v[52:55], v5, s[16:19], s46 offen
    buffer_load_dwordx4 v[56:59], v6, s[16:19], s46 offen
    buffer_load_dwordx4 v[60:63], v7, s[16:19], s46 offen
    buffer_load_dwordx4 v[64:67], v8, s[16:19], s46 offen
    buffer_load_dwordx4 v[68:71], v9, s[16:19], s46 offen
    s_waitcnt lgkmcnt(0)
    s_barrier
    ds_read_b64_tr_b16 v[112:113], v16 offset:0
    ds_read_b64_tr_b16 v[114:115], v16 offset:800
    ds_read_b64_tr_b16 v[116:117], v16 offset:12800
    ds_read_b64_tr_b16 v[118:119], v16 offset:13600
    ds_read_b64_tr_b16 v[192:193], v16 offset:32
    ds_read_b64_tr_b16 v[194:195], v16 offset:832
    ds_read_b64_tr_b16 v[196:197], v16 offset:12832
    ds_read_b64_tr_b16 v[198:199], v16 offset:13632
    ds_read_b64_tr_b16 v[72:73], v16 offset:64
    ds_read_b64_tr_b16 v[74:75], v16 offset:864
    ds_read_b64_tr_b16 v[76:77], v16 offset:12864
    ds_read_b64_tr_b16 v[78:79], v16 offset:13664
    s_waitcnt lgkmcnt(0)
    ds_write_b128 v17, v[72:75] offset:4096
    ds_write_b128 v17, v[76:79] offset:5120
    s_waitcnt lgkmcnt(0)
    s_barrier
    s_waitcnt vmcnt(6)
    ds_write_b128 v10, v[24:27]
    ds_write_b128 v11, v[28:31]
    ds_write_b128 v12, v[32:35]
    ds_write_b128 v13, v[36:39]
    ds_write_b128 v14, v[40:43]
    ds_write_b128 v15, v[44:47]
    s_add_u32 s46, s45, 3145728
    buffer_load_dwordx4 v[72:75], v4, s[12:15], s46 offen
    buffer_load_dwordx4 v[76:79], v5, s[12:15], s46 offen
    buffer_load_dwordx4 v[80:83], v6, s[12:15], s46 offen
    buffer_load_dwordx4 v[84:87], v7, s[12:15], s46 offen
    buffer_load_dwordx4 v[88:91], v8, s[12:15], s46 offen
    buffer_load_dwordx4 v[92:95], v9, s[12:15], s46 offen
    s_waitcnt lgkmcnt(0)
    s_barrier
    ds_read_b64_tr_b16 a[24:25], v16 offset:0
    ds_read_b64_tr_b16 a[26:27], v16 offset:800
    ds_read_b64_tr_b16 a[28:29], v16 offset:12800
    ds_read_b64_tr_b16 a[30:31], v16 offset:13600
    ds_read_b64_tr_b16 a[104:105], v16 offset:32
    ds_read_b64_tr_b16 a[106:107], v16 offset:832
    ds_read_b64_tr_b16 a[108:109], v16 offset:12832
    ds_read_b64_tr_b16 a[110:111], v16 offset:13632
    ds_read_b64_tr_b16 a[184:185], v16 offset:64
    ds_read_b64_tr_b16 a[186:187], v16 offset:864
    ds_read_b64_tr_b16 a[188:189], v16 offset:12864
    ds_read_b64_tr_b16 a[190:191], v16 offset:13664
    s_waitcnt lgkmcnt(0)
    s_barrier
    s_waitcnt vmcnt(6)
    ds_write_b128 v10, v[48:51]
    ds_write_b128 v11, v[52:55]
    ds_write_b128 v12, v[56:59]
    ds_write_b128 v13, v[60:63]
    ds_write_b128 v14, v[64:67]
    ds_write_b128 v15, v[68:71]
    s_add_u32 s46, s45, 3145728
    buffer_load_dwordx4 v[24:27], v4, s[16:19], s46 offen
    buffer_load_dwordx4 v[28:31], v5, s[16:19], s46 offen
    buffer_load_dwordx4 v[32:35], v6, s[16:19], s46 offen
    buffer_load_dwordx4 v[36:39], v7, s[16:19], s46 offen
    buffer_load_dwordx4 v[40:43], v8, s[16:19], s46 offen
    buffer_load_dwordx4 v[44:47], v9, s[16:19], s46 offen
    s_waitcnt lgkmcnt(0)
    s_barrier
    ds_read_b64_tr_b16 v[120:121], v16 offset:0
    ds_read_b64_tr_b16 v[122:123], v16 offset:800
    ds_read_b64_tr_b16 v[124:125], v16 offset:12800
    ds_read_b64_tr_b16 v[126:127], v16 offset:13600
    ds_read_b64_tr_b16 v[200:201], v16 offset:32
    ds_read_b64_tr_b16 v[202:203], v16 offset:832
    ds_read_b64_tr_b16 v[204:205], v16 offset:12832
    ds_read_b64_tr_b16 v[206:207], v16 offset:13632
    ds_read_b64_tr_b16 v[48:49], v16 offset:64
    ds_read_b64_tr_b16 v[50:51], v16 offset:864
    ds_read_b64_tr_b16 v[52:53], v16 offset:12864
    ds_read_b64_tr_b16 v[54:55], v16 offset:13664
    s_waitcnt lgkmcnt(0)
    ds_write_b128 v17, v[48:51] offset:6144
    ds_write_b128 v17, v[52:55] offset:7168
    s_waitcnt lgkmcnt(0)
    s_barrier
    s_waitcnt vmcnt(6)
    ds_write_b128 v10, v[72:75]
    ds_write_b128 v11, v[76:79]
    ds_write_b128 v12, v[80:83]
    ds_write_b128 v13, v[84:87]
    ds_write_b128 v14, v[88:91]
    ds_write_b128 v15, v[92:95]
    s_add_u32 s46, s45, 3932160
    buffer_load_dwordx4 v[48:51], v4, s[12:15], s46 offen
    buffer_load_dwordx4 v[52:55], v5, s[12:15], s46 offen
    buffer_load_dwordx4 v[56:59], v6, s[12:15], s46 offen
    buffer_load_dwordx4 v[60:63], v7, s[12:15], s46 offen
    buffer_load_dwordx4 v[64:67], v8, s[12:15], s46 offen
    buffer_load_dwordx4 v[68:71], v9, s[12:15], s46 offen
    s_waitcnt lgkmcnt(0)
    s_barrier
    ds_read_b64_tr_b16 a[32:33], v16 offset:0
    ds_read_b64_tr_b16 a[34:35], v16 offset:800
    ds_read_b64_tr_b16 a[36:37], v16 offset:12800
    ds_read_b64_tr_b16 a[38:39], v16 offset:13600
    ds_read_b64_tr_b16 a[112:113], v16 offset:32
    ds_read_b64_tr_b16 a[114:115], v16 offset:832
    ds_read_b64_tr_b16 a[116:117], v16 offset:12832
    ds_read_b64_tr_b16 a[118:119], v16 offset:13632
    ds_read_b64_tr_b16 a[192:193], v16 offset:64
    ds_read_b64_tr_b16 a[194:195], v16 offset:864
    ds_read_b64_tr_b16 a[196:197], v16 offset:12864
    ds_read_b64_tr_b16 a[198:199], v16 offset:13664
    s_waitcnt lgkmcnt(0)
    s_barrier
    s_waitcnt vmcnt(6)
    ds_write_b128 v10, v[24:27]
    ds_write_b128 v11, v[28:31]
    ds_write_b128 v12, v[32:35]
    ds_write_b128 v13, v[36:39]
    ds_write_b128 v14, v[40:43]
    ds_write_b128 v15, v[44:47]
    s_add_u32 s46, s45, 3932160
    buffer_load_dwordx4 v[72:75], v4, s[16:19], s46 offen
    buffer_load_dwordx4 v[76:79], v5, s[16:19], s46 offen
    buffer_load_dwordx4 v[80:83], v6, s[16:19], s46 offen
    buffer_load_dwordx4 v[84:87], v7, s[16:19], s46 offen
    buffer_load_dwordx4 v[88:91], v8, s[16:19], s46 offen
    buffer_load_dwordx4 v[92:95], v9, s[16:19], s46 offen
    s_waitcnt lgkmcnt(0)
    s_barrier
    ds_read_b64_tr_b16 v[128:129], v16 offset:0
    ds_read_b64_tr_b16 v[130:131], v16 offset:800
    ds_read_b64_tr_b16 v[132:133], v16 offset:12800
    ds_read_b64_tr_b16 v[134:135], v16 offset:13600
    ds_read_b64_tr_b16 v[208:209], v16 offset:32
    ds_read_b64_tr_b16 v[210:211], v16 offset:832
    ds_read_b64_tr_b16 v[212:213], v16 offset:12832
    ds_read_b64_tr_b16 v[214:215], v16 offset:13632
    ds_read_b64_tr_b16 v[24:25], v16 offset:64
    ds_read_b64_tr_b16 v[26:27], v16 offset:864
    ds_read_b64_tr_b16 v[28:29], v16 offset:12864
    ds_read_b64_tr_b16 v[30:31], v16 offset:13664
    s_waitcnt lgkmcnt(0)
    ds_write_b128 v17, v[24:27] offset:8192
    ds_write_b128 v17, v[28:31] offset:9216
    s_waitcnt lgkmcnt(0)
    s_barrier
    s_waitcnt vmcnt(6)
    ds_write_b128 v10, v[48:51]
    ds_write_b128 v11, v[52:55]
    ds_write_b128 v12, v[56:59]
    ds_write_b128 v13, v[60:63]
    ds_write_b128 v14, v[64:67]
    ds_write_b128 v15, v[68:71]
    s_add_u32 s46, s45, 4718592
    buffer_load_dwordx4 v[24:27], v4, s[12:15], s46 offen
    buffer_load_dwordx4 v[28:31], v5, s[12:15], s46 offen
    buffer_load_dwordx4 v[32:35], v6, s[12:15], s46 offen
    buffer_load_dwordx4 v[36:39], v7, s[12:15], s46 offen
    buffer_load_dwordx4 v[40:43], v8, s[12:15], s46 offen
    buffer_load_dwordx4 v[44:47], v9, s[12:15], s46 offen
    s_waitcnt lgkmcnt(0)
    s_barrier
    ds_read_b64_tr_b16 a[40:41], v16 offset:0
    ds_read_b64_tr_b16 a[42:43], v16 offset:800
    ds_read_b64_tr_b16 a[44:45], v16 offset:12800
    ds_read_b64_tr_b16 a[46:47], v16 offset:13600
    ds_read_b64_tr_b16 a[120:121], v16 offset:32
    ds_read_b64_tr_b16 a[122:123], v16 offset:832
    ds_read_b64_tr_b16 a[124:125], v16 offset:12832
    ds_read_b64_tr_b16 a[126:127], v16 offset:13632
    ds_read_b64_tr_b16 a[200:201], v16 offset:64
    ds_read_b64_tr_b16 a[202:203], v16 offset:864
    ds_read_b64_tr_b16 a[204:205], v16 offset:12864
    ds_read_b64_tr_b16 a[206:207], v16 offset:13664
    s_waitcnt lgkmcnt(0)
    s_barrier
    s_waitcnt vmcnt(6)
    ds_write_b128 v10, v[72:75]
    ds_write_b128 v11, v[76:79]
    ds_write_b128 v12, v[80:83]
    ds_write_b128 v13, v[84:87]
    ds_write_b128 v14, v[88:91]
    ds_write_b128 v15, v[92:95]
    s_add_u32 s46, s45, 4718592
    buffer_load_dwordx4 v[48:51], v4, s[16:19], s46 offen
    buffer_load_dwordx4 v[52:55], v5, s[16:19], s46 offen
    buffer_load_dwordx4 v[56:59], v6, s[16:19], s46 offen
    buffer_load_dwordx4 v[60:63], v7, s[16:19], s46 offen
    buffer_load_dwordx4 v[64:67], v8, s[16:19], s46 offen
    buffer_load_dwordx4 v[68:71], v9, s[16:19], s46 offen
    s_waitcnt lgkmcnt(0)
    s_barrier
    ds_read_b64_tr_b16 v[136:137], v16 offset:0
    ds_read_b64_tr_b16 v[138:139], v16 offset:800
    ds_read_b64_tr_b16 v[140:141], v16 offset:12800
    ds_read_b64_tr_b16 v[142:143], v16 offset:13600
    ds_read_b64_tr_b16 v[216:217], v16 offset:32
    ds_read_b64_tr_b16 v[218:219], v16 offset:832
    ds_read_b64_tr_b16 v[220:221], v16 offset:12832
    ds_read_b64_tr_b16 v[222:223], v16 offset:13632
    ds_read_b64_tr_b16 v[72:73], v16 offset:64
    ds_read_b64_tr_b16 v[74:75], v16 offset:864
    ds_read_b64_tr_b16 v[76:77], v16 offset:12864
    ds_read_b64_tr_b16 v[78:79], v16 offset:13664
    s_waitcnt lgkmcnt(0)
    ds_write_b128 v17, v[72:75] offset:10240
    ds_write_b128 v17, v[76:79] offset:11264
    s_waitcnt lgkmcnt(0)
    s_barrier
    s_waitcnt vmcnt(6)
    ds_write_b128 v10, v[24:27]
    ds_write_b128 v11, v[28:31]
    ds_write_b128 v12, v[32:35]
    ds_write_b128 v13, v[36:39]
    ds_write_b128 v14, v[40:43]
    ds_write_b128 v15, v[44:47]
    s_add_u32 s46, s45, 5505024
    buffer_load_dwordx4 v[72:75], v4, s[12:15], s46 offen
    buffer_load_dwordx4 v[76:79], v5, s[12:15], s46 offen
    buffer_load_dwordx4 v[80:83], v6, s[12:15], s46 offen
    buffer_load_dwordx4 v[84:87], v7, s[12:15], s46 offen
    buffer_load_dwordx4 v[88:91], v8, s[12:15], s46 offen
    buffer_load_dwordx4 v[92:95], v9, s[12:15], s46 offen
    s_waitcnt lgkmcnt(0)
    s_barrier
    ds_read_b64_tr_b16 a[48:49], v16 offset:0
    ds_read_b64_tr_b16 a[50:51], v16 offset:800
    ds_read_b64_tr_b16 a[52:53], v16 offset:12800
    ds_read_b64_tr_b16 a[54:55], v16 offset:13600
    ds_read_b64_tr_b16 a[128:129], v16 offset:32
    ds_read_b64_tr_b16 a[130:131], v16 offset:832
    ds_read_b64_tr_b16 a[132:133], v16 offset:12832
    ds_read_b64_tr_b16 a[134:135], v16 offset:13632
    ds_read_b64_tr_b16 a[208:209], v16 offset:64
    ds_read_b64_tr_b16 a[210:211], v16 offset:864
    ds_read_b64_tr_b16 a[212:213], v16 offset:12864
    ds_read_b64_tr_b16 a[214:215], v16 offset:13664
    s_waitcnt lgkmcnt(0)
    s_barrier
    s_waitcnt vmcnt(6)
    ds_write_b128 v10, v[48:51]
    ds_write_b128 v11, v[52:55]
    ds_write_b128 v12, v[56:59]
    ds_write_b128 v13, v[60:63]
    ds_write_b128 v14, v[64:67]
    ds_write_b128 v15, v[68:71]
    s_add_u32 s46, s45, 5505024
    buffer_load_dwordx4 v[24:27], v4, s[16:19], s46 offen
    buffer_load_dwordx4 v[28:31], v5, s[16:19], s46 offen
    buffer_load_dwordx4 v[32:35], v6, s[16:19], s46 offen
    buffer_load_dwordx4 v[36:39], v7, s[16:19], s46 offen
    buffer_load_dwordx4 v[40:43], v8, s[16:19], s46 offen
    buffer_load_dwordx4 v[44:47], v9, s[16:19], s46 offen
    s_waitcnt lgkmcnt(0)
    s_barrier
    ds_read_b64_tr_b16 v[144:145], v16 offset:0
    ds_read_b64_tr_b16 v[146:147], v16 offset:800
    ds_read_b64_tr_b16 v[148:149], v16 offset:12800
    ds_read_b64_tr_b16 v[150:151], v16 offset:13600
    ds_read_b64_tr_b16 v[224:225], v16 offset:32
    ds_read_b64_tr_b16 v[226:227], v16 offset:832
    ds_read_b64_tr_b16 v[228:229], v16 offset:12832
    ds_read_b64_tr_b16 v[230:231], v16 offset:13632
    ds_read_b64_tr_b16 v[48:49], v16 offset:64
    ds_read_b64_tr_b16 v[50:51], v16 offset:864
    ds_read_b64_tr_b16 v[52:53], v16 offset:12864
    ds_read_b64_tr_b16 v[54:55], v16 offset:13664
    s_waitcnt lgkmcnt(0)
    ds_write_b128 v17, v[48:51] offset:12288
    ds_write_b128 v17, v[52:55] offset:13312
    s_waitcnt lgkmcnt(0)
    s_barrier
    s_waitcnt vmcnt(6)
    ds_write_b128 v10, v[72:75]
    ds_write_b128 v11, v[76:79]
    ds_write_b128 v12, v[80:83]
    ds_write_b128 v13, v[84:87]
    ds_write_b128 v14, v[88:91]
    ds_write_b128 v15, v[92:95]
    s_add_u32 s46, s45, 6291456
    buffer_load_dwordx4 v[48:51], v4, s[12:15], s46 offen
    buffer_load_dwordx4 v[52:55], v5, s[12:15], s46 offen
    buffer_load_dwordx4 v[56:59], v6, s[12:15], s46 offen
    buffer_load_dwordx4 v[60:63], v7, s[12:15], s46 offen
    buffer_load_dwordx4 v[64:67], v8, s[12:15], s46 offen
    buffer_load_dwordx4 v[68:71], v9, s[12:15], s46 offen
    s_waitcnt lgkmcnt(0)
    s_barrier
    ds_read_b64_tr_b16 a[56:57], v16 offset:0
    ds_read_b64_tr_b16 a[58:59], v16 offset:800
    ds_read_b64_tr_b16 a[60:61], v16 offset:12800
    ds_read_b64_tr_b16 a[62:63], v16 offset:13600
    ds_read_b64_tr_b16 a[136:137], v16 offset:32
    ds_read_b64_tr_b16 a[138:139], v16 offset:832
    ds_read_b64_tr_b16 a[140:141], v16 offset:12832
    ds_read_b64_tr_b16 a[142:143], v16 offset:13632
    ds_read_b64_tr_b16 a[216:217], v16 offset:64
    ds_read_b64_tr_b16 a[218:219], v16 offset:864
    ds_read_b64_tr_b16 a[220:221], v16 offset:12864
    ds_read_b64_tr_b16 a[222:223], v16 offset:13664
    s_waitcnt lgkmcnt(0)
    s_barrier
    s_waitcnt vmcnt(6)
    ds_write_b128 v10, v[24:27]
    ds_write_b128 v11, v[28:31]
    ds_write_b128 v12, v[32:35]
    ds_write_b128 v13, v[36:39]
    ds_write_b128 v14, v[40:43]
    ds_write_b128 v15, v[44:47]
    s_add_u32 s46, s45, 6291456
    buffer_load_dwordx4 v[72:75], v4, s[16:19], s46 offen
    buffer_load_dwordx4 v[76:79], v5, s[16:19], s46 offen
    buffer_load_dwordx4 v[80:83], v6, s[16:19], s46 offen
    buffer_load_dwordx4 v[84:87], v7, s[16:19], s46 offen
    buffer_load_dwordx4 v[88:91], v8, s[16:19], s46 offen
    buffer_load_dwordx4 v[92:95], v9, s[16:19], s46 offen
    s_waitcnt lgkmcnt(0)
    s_barrier
    ds_read_b64_tr_b16 v[152:153], v16 offset:0
    ds_read_b64_tr_b16 v[154:155], v16 offset:800
    ds_read_b64_tr_b16 v[156:157], v16 offset:12800
    ds_read_b64_tr_b16 v[158:159], v16 offset:13600
    ds_read_b64_tr_b16 v[232:233], v16 offset:32
    ds_read_b64_tr_b16 v[234:235], v16 offset:832
    ds_read_b64_tr_b16 v[236:237], v16 offset:12832
    ds_read_b64_tr_b16 v[238:239], v16 offset:13632
    ds_read_b64_tr_b16 v[24:25], v16 offset:64
    ds_read_b64_tr_b16 v[26:27], v16 offset:864
    ds_read_b64_tr_b16 v[28:29], v16 offset:12864
    ds_read_b64_tr_b16 v[30:31], v16 offset:13664
    s_waitcnt lgkmcnt(0)
    ds_write_b128 v17, v[24:27] offset:14336
    ds_write_b128 v17, v[28:31] offset:15360
    s_waitcnt lgkmcnt(0)
    s_barrier
    s_waitcnt vmcnt(6)
    ds_write_b128 v10, v[48:51]
    ds_write_b128 v11, v[52:55]
    ds_write_b128 v12, v[56:59]
    ds_write_b128 v13, v[60:63]
    ds_write_b128 v14, v[64:67]
    ds_write_b128 v15, v[68:71]
    s_add_u32 s46, s45, 7077888
    buffer_load_dwordx4 v[24:27], v4, s[12:15], s46 offen
    buffer_load_dwordx4 v[28:31], v5, s[12:15], s46 offen
    buffer_load_dwordx4 v[32:35], v6, s[12:15], s46 offen
    buffer_load_dwordx4 v[36:39], v7, s[12:15], s46 offen
    buffer_load_dwordx4 v[40:43], v8, s[12:15], s46 offen
    buffer_load_dwordx4 v[44:47], v9, s[12:15], s46 offen
    s_waitcnt lgkmcnt(0)
    s_barrier
    ds_read_b64_tr_b16 a[64:65], v16 offset:0
    ds_read_b64_tr_b16 a[66:67], v16 offset:800
    ds_read_b64_tr_b16 a[68:69], v16 offset:12800
    ds_read_b64_tr_b16 a[70:71], v16 offset:13600
    ds_read_b64_tr_b16 a[144:145], v16 offset:32
    ds_read_b64_tr_b16 a[146:147], v16 offset:832
    ds_read_b64_tr_b16 a[148:149], v16 offset:12832
    ds_read_b64_tr_b16 a[150:151], v16 offset:13632
    ds_read_b64_tr_b16 a[224:225], v16 offset:64
    ds_read_b64_tr_b16 a[226:227], v16 offset:864
    ds_read_b64_tr_b16 a[228:229], v16 offset:12864
    ds_read_b64_tr_b16 a[230:231], v16 offset:13664
    s_waitcnt lgkmcnt(0)
    s_barrier
    s_waitcnt vmcnt(6)
    ds_write_b128 v10, v[72:75]
    ds_write_b128 v11, v[76:79]
    ds_write_b128 v12, v[80:83]
    ds_write_b128 v13, v[84:87]
    ds_write_b128 v14, v[88:91]
    ds_write_b128 v15, v[92:95]
    s_add_u32 s46, s45, 7077888
    buffer_load_dwordx4 v[48:51], v4, s[16:19], s46 offen
    buffer_load_dwordx4 v[52:55], v5, s[16:19], s46 offen
    buffer_load_dwordx4 v[56:59], v6, s[16:19], s46 offen
    buffer_load_dwordx4 v[60:63], v7, s[16:19], s46 offen
    buffer_load_dwordx4 v[64:67], v8, s[16:19], s46 offen
    buffer_load_dwordx4 v[68:71], v9, s[16:19], s46 offen
    s_waitcnt lgkmcnt(0)
    s_barrier
    ds_read_b64_tr_b16 v[160:161], v16 offset:0
    ds_read_b64_tr_b16 v[162:163], v16 offset:800
    ds_read_b64_tr_b16 v[164:165], v16 offset:12800
    ds_read_b64_tr_b16 v[166:167], v16 offset:13600
    ds_read_b64_tr_b16 v[240:241], v16 offset:32
    ds_read_b64_tr_b16 v[242:243], v16 offset:832
    ds_read_b64_tr_b16 v[244:245], v16 offset:12832
    ds_read_b64_tr_b16 v[246:247], v16 offset:13632
    ds_read_b64_tr_b16 v[72:73], v16 offset:64
    ds_read_b64_tr_b16 v[74:75], v16 offset:864
    ds_read_b64_tr_b16 v[76:77], v16 offset:12864
    ds_read_b64_tr_b16 v[78:79], v16 offset:13664
    s_waitcnt lgkmcnt(0)
    ds_write_b128 v17, v[72:75] offset:16384
    ds_write_b128 v17, v[76:79] offset:17408
    s_waitcnt lgkmcnt(0)
    s_barrier
    s_waitcnt vmcnt(6)
    ds_write_b128 v10, v[24:27]
    ds_write_b128 v11, v[28:31]
    ds_write_b128 v12, v[32:35]
    ds_write_b128 v13, v[36:39]
    ds_write_b128 v14, v[40:43]
    ds_write_b128 v15, v[44:47]
    s_waitcnt lgkmcnt(0)
    s_barrier
    ds_read_b64_tr_b16 a[72:73], v16 offset:0
    ds_read_b64_tr_b16 a[74:75], v16 offset:800
    ds_read_b64_tr_b16 a[76:77], v16 offset:12800
    ds_read_b64_tr_b16 a[78:79], v16 offset:13600
    ds_read_b64_tr_b16 a[152:153], v16 offset:32
    ds_read_b64_tr_b16 a[154:155], v16 offset:832
    ds_read_b64_tr_b16 a[156:157], v16 offset:12832
    ds_read_b64_tr_b16 a[158:159], v16 offset:13632
    ds_read_b64_tr_b16 a[232:233], v16 offset:64
    ds_read_b64_tr_b16 a[234:235], v16 offset:864
    ds_read_b64_tr_b16 a[236:237], v16 offset:12864
    ds_read_b64_tr_b16 a[238:239], v16 offset:13664
    s_waitcnt lgkmcnt(0)
    s_barrier
    s_waitcnt vmcnt(0)
    ds_write_b128 v10, v[48:51]
    ds_write_b128 v11, v[52:55]
    ds_write_b128 v12, v[56:59]
    ds_write_b128 v13, v[60:63]
    ds_write_b128 v14, v[64:67]
    ds_write_b128 v15, v[68:71]
    s_waitcnt lgkmcnt(0)
    s_barrier
    ds_read_b64_tr_b16 v[168:169], v16 offset:0
    ds_read_b64_tr_b16 v[170:171], v16 offset:800
    ds_read_b64_tr_b16 v[172:173], v16 offset:12800
    ds_read_b64_tr_b16 v[174:175], v16 offset:13600
    ds_read_b64_tr_b16 v[248:249], v16 offset:32
    ds_read_b64_tr_b16 v[250:251], v16 offset:832
    ds_read_b64_tr_b16 v[252:253], v16 offset:12832
    ds_read_b64_tr_b16 v[254:255], v16 offset:13632
    ds_read_b64_tr_b16 v[48:49], v16 offset:64
    ds_read_b64_tr_b16 v[50:51], v16 offset:864
    ds_read_b64_tr_b16 v[52:53], v16 offset:12864
    ds_read_b64_tr_b16 v[54:55], v16 offset:13664
    s_waitcnt lgkmcnt(0)
    ds_write_b128 v17, v[48:51] offset:18432
    ds_write_b128 v17, v[52:55] offset:19456
    s_waitcnt lgkmcnt(0)
    s_barrier
    v_mov_b32 v6, v17
    v_mov_b32 v30, 0xeeee
    v_mov_b32 v4, 0x4444
    v_cmp_gt_u32 vcc, 8, v2
    s_nop 1
    v_cndmask_b32 v4, v30, v4, vcc
    v_lshlrev_b32 v5, 4, v1
    s_lshl_b32 s24, s3, 10
    v_add_u32 v7, s24, v5
    s_lshl_b32 s24, s3, 9
    s_add_u32 s24, s24, 8192
    v_lshlrev_b32 v8, 3, v1
    v_add_u32 v8, s24, v8
    s_mul_i32 s24, s3, 1536
    s_add_u32 s24, s24, 10240
    v_lshlrev_b32 v9, 5, v2
    v_lshl_add_u32 v9, v3, 3, v9
    v_add_u32 v9, s24, v9
    v_lshrrev_b32 v30, 2, v2
    v_and_b32 v31, 3, v2
    v_lshl_add_u32 v11, v3, 2, v30
    v_lshlrev_b32 v11, 5, v11
    v_lshl_add_u32 v11, v31, 3, v11
    v_add_u32 v11, s24, v11
    v_add_u32 v33, 22528, v5
    s_mul_i32 s24, s3, 1408
    s_add_u32 s24, s24, 16384
    v_mul_u32_u24 v30, 176, v2
    v_add_u32 v30, s24, v30
    v_lshl_add_u32 v12, v3, 5, v30
    v_cmp_gt_u32 vcc, 8, v2
    s_nop 1
    v_cndmask_b32 v12, v33, v12, vcc
    v_lshl_add_u32 v13, v3, 4, v30
    v_add_u32 v13, 96, v13
    v_cmp_le_u32 s[24:25], 2, v3
    s_and_b64 vcc, vcc, s[24:25]
    v_cndmask_b32 v13, v33, v13, vcc
    s_mul_i32 s24, s3, 5632
    s_add_u32 s24, s24, 106496
    v_mul_u32_u24 v30, 176, v2
    v_add_u32 v30, s24, v30
    v_lshl_add_u32 v16, v3, 5, v30
    v_lshl_add_u32 v17, v3, 4, v30
    v_add_u32 v17, 96, v17
    v_add_u32 v18, 2816, v17
    v_cmp_le_u32 vcc, 2, v3
    s_nop 1
    v_cndmask_b32 v17, v33, v17, vcc
    v_cndmask_b32 v18, v33, v18, vcc
    v_lshrrev_b32 v30, 3, v1
    v_and_b32 v31, 7, v1
    v_min_u32 v32, 4, v31
    v_mul_u32_u24 v14, 176, v30
    v_lshl_add_u32 v14, v32, 5, v14
    s_mul_i32 s24, s3, 1408
    s_add_u32 s24, s24, 106496
    v_add_u32 v21, s24, v14
    v_add_u32 v14, 16384, v14
    v_cmp_gt_u32 s[50:51], 5, v31
    s_lshl_b32 s24, s3, 3
    v_add_u32 v32, s24, v30
    v_lshlrev_b32 v33, 2, v31
    v_sub_u32 v32, v32, v33
    v_mov_b32 v33, 100
    v_cmp_gt_u32 vcc, 4, v31
    s_nop 1
    v_cndmask_b32 v32, v33, v32, vcc
    v_cmp_le_i32 s[64:65], 0, v32
    v_cmp_le_i32 s[66:67], 1, v32
    v_cmp_le_i32 s[68:69], 2, v32
    v_cmp_le_i32 s[70:71], 3, v32
    v_cmp_le_i32 s[72:73], 16, v32
    v_cmp_le_i32 s[74:75], 17, v32
    v_cmp_le_i32 s[76:77], 18, v32
    v_cmp_le_i32 s[78:79], 19, v32
    s_lshr_b32 s24, s44, 1
    s_lshl_b32 s24, s24, 10
    s_and_b32 s25, s44, 1
    s_lshl_b32 s25, s25, 7
    s_add_u32 s24, s24, s25
    v_lshlrev_b32 v15, 8, v31
    v_lshl_add_u32 v15, v30, 4, v15
    v_add_u32 v15, s24, v15
    s_lshr_b32 s24, s44, 3
    s_lshl_b32 s24, s24, 10
    s_and_b32 s25, s44, 3
    s_lshl_b32 s25, s25, 8
    s_add_u32 s24, s24, s25
    s_lshr_b32 s25, s44, 2
    s_and_b32 s25, s25, 1
    s_lshl_b32 s25, s25, 7
    s_add_u32 s24, s24, s25
    s_add_u32 s24, s24, 16384
    v_lshlrev_b32 v32, 4, v30
    v_add_u32 v32, s24, v32
    v_cmp_eq_u32 vcc, 4, v31
    s_nop 1
    v_cndmask_b32 v15, v15, v32, vcc
    v_mov_b32 v32, 2146435072
    v_cndmask_b32 v15, v32, v15, s[50:51]
    s_mul_i32 s24, s3, 20480
    v_add_u32 v15, s24, v15
    s_cmp_lt_u32 s3, 1
    s_cselect_b32 s24, 0, 2146435072
    v_or_b32 v15, s24, v15
    s_and_b32 s24, s3, 1
    s_lshl_b32 s24, s24, 7
    s_lshr_b32 s25, s3, 1
    s_lshl_b32 s25, s25, 10
    s_add_u32 s24, s24, s25
    s_lshl_b32 s25, s44, 11
    s_add_u32 s25, s25, s24
    v_lshlrev_b32 v22, 8, v31
    v_lshl_add_u32 v22, v30, 4, v22
    v_add_u32 v22, s25, v22
    s_lshr_b32 s25, s44, 2
    s_lshl_b32 s25, s25, 11
    s_add_u32 s25, s25, s24
    s_and_b32 s26, s44, 3
    s_lshl_b32 s26, s26, 8
    s_add_u32 s25, s25, s26
    s_add_u32 s25, s25, 65536
    v_lshlrev_b32 v32, 4, v30
    v_add_u32 v32, s25, v32
    v_cmp_eq_u32 vcc, 4, v31
    s_nop 1
    v_cndmask_b32 v22, v22, v32, vcc
    v_mov_b32 v32, 2146435072
    v_cndmask_b32 v22, v32, v22, s[50:51]
    s_mul_i32 s24, s44, 12288
    s_mul_i32 s25, s3, 3072
    s_add_u32 s24, s24, s25
    v_add_u32 v19, s24, v5
    v_and_b32 v10, 1, v1
    v_lshlrev_b32 v10, 12, v10
    s_lshl_b32 s24, s44, 7
    s_add_u32 s24, s24, 151560192
    v_add_u32 v10, s24, v10
    s_and_b32 s24, s2, 15
    s_mul_i32 s25, s3, 16
    s_add_u32 s24, s24, s25
    s_lshl_b32 s24, s24, 7
    v_mov_b32 v23, s24
    s_lshr_b32 s25, s44, 3
    s_mul_i32 s24, s25, 8
    v_add_u32 v20, s24, v1
    v_lshlrev_b32 v20, 7, v20
    v_mov_b32 v30, 2146435072
    v_cmp_le_u32 vcc, 8, v1
    s_nop 1
    v_cndmask_b32 v20, v20, v30, vcc
    s_cmp_eq_u32 s3, 0
    s_cselect_b32 s24, 0, 2146435072
    v_or_b32 v20, s24, v20
    s_mov_b32 s48, 151576576
    s_mov_b32 s49, 154238976
    v_add_u32 v48, 0, v0
    v_and_b32 v49, 7, v48
    v_mul_u32_u24 v49, 1280, v49
    v_lshrrev_b32 v50, 3, v48
    v_lshl_add_u32 v49, v50, 4, v49
    v_cmp_gt_u32 vcc, 640, v48
    v_mov_b32 v51, 2146435072
    s_nop 0
    v_cndmask_b32 v49, v51, v49, vcc
    buffer_load_dwordx4 v[52:55], v49, s[20:23], 0 offen
    v_lshlrev_b32 v48, 4, v48
    s_waitcnt vmcnt(0)
    s_and_saveexec_b64 s[30:31], vcc
    ds_write_b128 v48, v[52:55]
    s_mov_b64 exec, s[30:31]
    v_add_u32 v48, 256, v0
    v_and_b32 v49, 7, v48
    v_mul_u32_u24 v49, 1280, v49
    v_lshrrev_b32 v50, 3, v48
    v_lshl_add_u32 v49, v50, 4, v49
    v_cmp_gt_u32 vcc, 640, v48
    v_mov_b32 v51, 2146435072
    s_nop 0
    v_cndmask_b32 v49, v51, v49, vcc
    buffer_load_dwordx4 v[52:55], v49, s[20:23], 0 offen
    v_lshlrev_b32 v48, 4, v48
    s_waitcnt vmcnt(0)
    s_and_saveexec_b64 s[30:31], vcc
    ds_write_b128 v48, v[52:55]
    s_mov_b64 exec, s[30:31]
    v_add_u32 v48, 512, v0
    v_and_b32 v49, 7, v48
    v_mul_u32_u24 v49, 1280, v49
    v_lshrrev_b32 v50, 3, v48
    v_lshl_add_u32 v49, v50, 4, v49
    v_cmp_gt_u32 vcc, 640, v48
    v_mov_b32 v51, 2146435072
    s_nop 0
    v_cndmask_b32 v49, v51, v49, vcc
    buffer_load_dwordx4 v[52:55], v49, s[20:23], 0 offen
    v_lshlrev_b32 v48, 4, v48
    s_waitcnt vmcnt(0)
    s_and_saveexec_b64 s[30:31], vcc
    ds_write_b128 v48, v[52:55]
    s_mov_b64 exec, s[30:31]
    v_mov_b32 v0, 1
    s_mov_b32 s40, 0
    s_mov_b32 s54, 5
    s_mov_b32 s41, 92274688
    s_mov_b32 s42, 146317312
    s_mov_b32 s43, 141074432
    s_mov_b32 s45, 67108864
    s_mov_b32 s47, 138412032
    s_mov_b32 s62, -1
    s_mov_b32 s63, 1
    s_cmp_ge_i32 s62, s63
    s_cbranch_scc1 chain2_kernel_s_en0_ok
    s_mov_b32 s61, 0
chain2_kernel_s_en0:
    buffer_load_dword v48, v10, s[8:11], 0 offen sc1
    s_waitcnt vmcnt(0)
    v_readlane_b32 s62, v48, 0
    v_readlane_b32 s24, v48, 1
    s_min_i32 s62, s62, s24
    s_cmp_ge_i32 s62, s63
    s_cbranch_scc1 chain2_kernel_s_en0_ok
    s_add_u32 s61, s61, 1
    s_cmp_ge_u32 s61, s60
    s_cbranch_scc1 chain2_kernel_s_en0_to
    s_sleep 2
    s_branch chain2_kernel_s_en0
chain2_kernel_s_en0_to:
    s_mov_b32 s60, 1
chain2_kernel_s_en0_ok:
    buffer_load_dwordx4 a[240:243], v19, s[8:11], s41 offen offset:0 sc1
    buffer_load_dwordx4 a[244:247], v19, s[8:11], s41 offen offset:1024 sc1
    buffer_load_dwordx4 a[248:251], v19, s[8:11], s41 offen offset:2048 sc1
    s_waitcnt lgkmcnt(0)
    s_branch chain2_kernel_s_go
chain2_kernel_s_step:
    v_mov_b32 v24, 0
    v_mov_b32 v25, 0
    v_mov_b32 v26, 0
    v_mov_b32 v27, 0
    v_mov_b32 v28, 0
    v_mov_b32 v29, 0
    v_mov_b32 v30, 0
    v_mov_b32 v31, 0
    v_mov_b32 v32, 0
    v_mov_b32 v33, 0
    v_mov_b32 v34, 0
    v_mov_b32 v35, 0
    v_mov_b32 v36, 0
    v_mov_b32 v37, 0
    v_mov_b32 v38, 0
    v_mov_b32 v39, 0
    v_mov_b32 v40, 0
    v_mov_b32 v41, 0
    v_mov_b32 v42, 0
    v_mov_b32 v43, 0
    v_mov_b32 v44, 0
    v_mov_b32 v45, 0
    v_mov_b32 v46, 0
    v_mov_b32 v47, 0
    s_add_u32 s46, s47, 4096
    s_add_u32 s63, s40, 1
    s_cmp_ge_i32 s62, s63
    s_cbranch_scc1 chain2_kernel_s_en_ok
    s_mov_b32 s61, 0
chain2_kernel_s_en:
    buffer_load_dword v48, v10, s[8:11], 0 offen sc1
    s_waitcnt vmcnt(0)
    v_readlane_b32 s62, v48, 0
    v_readlane_b32 s24, v48, 1
    s_min_i32 s62, s62, s24
    s_cmp_ge_i32 s62, s63
    s_cbranch_scc1 chain2_kernel_s_en_ok
    s_add_u32 s61, s61, 1
    s_cmp_ge_u32 s61, s60
    s_cbranch_scc1 chain2_kernel_s_en_to
    s_sleep 2
    s_branch chain2_kernel_s_en
chain2_kernel_s_en_to:
    s_mov_b32 s60, 1
chain2_kernel_s_en_ok:
    s_sleep 5
    s_mov_b64 exec, 1
    s_mov_b32 s61, 0
    v_mov_b32 v83, 0
    buffer_atomic_add v83, v23, s[8:11], s48 offen sc0
    s_sleep 2
    v_mov_b32 v94, 0
    buffer_atomic_add v94, v23, s[8:11], s48 offen sc0
    s_sleep 2
    v_mov_b32 v95, 0
    buffer_atomic_add v95, v23, s[8:11], s48 offen sc0
    s_sleep 2
chain2_kernel_s_pr:
    v_mov_b32 v82, 0
    buffer_atomic_add v82, v23, s[8:11], s48 offen sc0
    s_waitcnt vmcnt(3)
    v_cmp_le_i32 vcc, 9, v83
    s_add_u32 s61, s61, 1
    s_cbranch_vccnz chain2_kernel_s_pr_out
    s_sleep 2
    v_mov_b32 v83, 0
    buffer_atomic_add v83, v23, s[8:11], s48 offen sc0
    s_waitcnt vmcnt(3)
    v_cmp_le_i32 vcc, 9, v94
    s_add_u32 s61, s61, 1
    s_cbranch_vccnz chain2_kernel_s_pr_out
    s_sleep 2
    v_mov_b32 v94, 0
    buffer_atomic_add v94, v23, s[8:11], s48 offen sc0
    s_waitcnt vmcnt(3)
    v_cmp_le_i32 vcc, 9, v95
    s_add_u32 s61, s61, 1
    s_cbranch_vccnz chain2_kernel_s_pr_out
    s_sleep 2
    v_mov_b32 v95, 0
    buffer_atomic_add v95, v23, s[8:11], s48 offen sc0
    s_waitcnt vmcnt(3)
    v_cmp_le_i32 vcc, 9, v82
    s_add_u32 s61, s61, 1
    s_cbranch_vccnz chain2_kernel_s_pr_out
    s_sleep 2
    s_cmp_ge_u32 s61, s60
    s_cbranch_scc0 chain2_kernel_s_pr
    s_mov_b32 s60, 1
chain2_kernel_s_pr_out:
    s_mov_b64 exec, -1
    buffer_load_dwordx4 v[84:87], v7, s[8:11], s47 offen sc1
    buffer_load_dwordx4 v[88:91], v7, s[8:11], s46 offen sc1
    buffer_load_dwordx2 v[92:93], v8, s[8:11], s47 offen sc1
    buffer_load_dwordx4 a[240:243], v19, s[8:11], s41 offen offset:0 sc1
    buffer_load_dwordx4 a[244:247], v19, s[8:11], s41 offen offset:1024 sc1
    buffer_load_dwordx4 a[248:251], v19, s[8:11], s41 offen offset:2048 sc1
    ds_read_b128 v[48:51], v21 offset:0
    ds_read_b128 v[52:55], v21 offset:16
    ds_read_b128 v[56:59], v21 offset:5632
    ds_read_b128 v[60:63], v21 offset:5648
    ds_read_b128 v[64:67], v21 offset:11264
    ds_read_b128 v[68:71], v21 offset:11280
    ds_read_b128 v[72:75], v21 offset:16896
    ds_read_b128 v[76:79], v21 offset:16912
    s_waitcnt lgkmcnt(4)
    v_pk_add_f32 v[48:49], v[48:49], v[56:57]
    v_pk_add_f32 v[50:51], v[50:51], v[58:59]
    v_pk_add_f32 v[52:53], v[52:53], v[60:61]
    v_pk_add_f32 v[54:55], v[54:55], v[62:63]
    s_waitcnt lgkmcnt(0)
    v_pk_add_f32 v[64:65], v[64:65], v[72:73]
    v_pk_add_f32 v[66:67], v[66:67], v[74:75]
    v_pk_add_f32 v[68:69], v[68:69], v[76:77]
    v_pk_add_f32 v[70:71], v[70:71], v[78:79]
    v_pk_add_f32 v[48:49], v[48:49], v[64:65]
    v_pk_add_f32 v[50:51], v[50:51], v[66:67]
    v_pk_add_f32 v[52:53], v[52:53], v[68:69]
    v_pk_add_f32 v[54:55], v[54:55], v[70:71]
    v_mov_b32 v81, 0xff800000
    v_cndmask_b32 v48, v81, v48, s[64:65]
    v_cndmask_b32 v49, v81, v49, s[66:67]
    v_cndmask_b32 v50, v81, v50, s[68:69]
    v_cndmask_b32 v51, v81, v51, s[70:71]
    v_cndmask_b32 v52, v81, v52, s[72:73]
    v_cndmask_b32 v53, v81, v53, s[74:75]
    v_cndmask_b32 v54, v81, v54, s[76:77]
    v_cndmask_b32 v55, v81, v55, s[78:79]
    v_max3_f32 v80, v48, v49, v50
    v_max3_f32 v80, v80, v51, v52
    v_max3_f32 v80, v80, v53, v54
    v_max_f32 v80, v80, v55
    v_mov_b32 v81, 0xff800000
    v_cndmask_b32 v80, v81, v80, s[50:51]
    s_nop 1
    v_max_f32 v80, v80, v80 quad_perm:[1,0,3,2] row_mask:0xf bank_mask:0xf
    s_nop 1
    v_max_f32 v80, v80, v80 quad_perm:[2,3,0,1] row_mask:0xf bank_mask:0xf
    s_nop 1
    v_max_f32 v80, v80, v80 row_half_mirror row_mask:0xf bank_mask:0xf
    s_mov_b32 s24, 0x3dd53b95
    v_mul_f32 v80, s24, v80
    v_fma_f32 v48, v48, s24, -v80
    v_fma_f32 v49, v49, s24, -v80
    v_fma_f32 v50, v50, s24, -v80
    v_fma_f32 v51, v51, s24, -v80
    v_fma_f32 v52, v52, s24, -v80
    v_fma_f32 v53, v53, s24, -v80
    v_fma_f32 v54, v54, s24, -v80
    v_fma_f32 v55, v55, s24, -v80
    v_exp_f32 v48, v48
    v_exp_f32 v49, v49
    v_exp_f32 v50, v50
    v_exp_f32 v51, v51
    v_exp_f32 v52, v52
    v_exp_f32 v53, v53
    v_exp_f32 v54, v54
    v_exp_f32 v55, v55
    v_add_f32 v80, v48, v49
    v_add_f32 v81, v50, v51
    v_add_f32 v80, v80, v52
    v_add_f32 v81, v81, v53
    v_add_f32 v80, v80, v54
    v_add_f32 v81, v81, v55
    v_add_f32 v80, v80, v81
    v_cndmask_b32 v80, 0, v80, s[50:51]
    s_nop 1
    v_add_f32 v80, v80, v80 quad_perm:[1,0,3,2] row_mask:0xf bank_mask:0xf
    s_nop 1
    v_add_f32 v80, v80, v80 quad_perm:[2,3,0,1] row_mask:0xf bank_mask:0xf
    s_nop 1
    v_add_f32 v80, v80, v80 row_half_mirror row_mask:0xf bank_mask:0xf
    v_rcp_f32 v80, v80
    s_nop 0
    v_mul_f32 v48, v48, v80
    v_mul_f32 v49, v49, v80
    v_mul_f32 v50, v50, v80
    v_mul_f32 v51, v51, v80
    v_mul_f32 v52, v52, v80
    v_mul_f32 v53, v53, v80
    v_mul_f32 v54, v54, v80
    v_mul_f32 v55, v55, v80
    v_cvt_pk_bf16_f32 v56, v48, v49
    v_cvt_pk_bf16_f32 v57, v50, v51
    v_cvt_pk_bf16_f32 v58, v52, v53
    v_cvt_pk_bf16_f32 v59, v54, v55
    v_min_u32 v56, -2, v56
    v_min_u32 v57, -2, v57
    v_min_u32 v58, -2, v58
    v_min_u32 v59, -2, v59
    buffer_store_dwordx4 v[56:59], v22, s[8:11], s42 offen sc1
    s_add_u32 s42, s42, 81920
    s_waitcnt vmcnt(4)
    v_max3_u32 v58, v84, v85, v86
    v_max3_u32 v58, v58, v87, v88
    v_max3_u32 v58, v58, v89, v90
    v_max3_u32 v58, v58, v91, v92
    v_max_u32 v58, v58, v93
    v_cmp_eq_u32 vcc, -1, v58
    s_cbranch_vccz chain2_kernel_s_pm_out
    s_mov_b32 s61, 0
chain2_kernel_s_pm:
    buffer_load_dwordx4 v[84:87], v7, s[8:11], s47 offen sc1
    buffer_load_dwordx4 v[88:91], v7, s[8:11], s46 offen sc1
    buffer_load_dwordx2 v[92:93], v8, s[8:11], s47 offen sc1
    s_waitcnt vmcnt(0)
    v_max3_u32 v58, v84, v85, v86
    v_max3_u32 v58, v58, v87, v88
    v_max3_u32 v58, v58, v89, v90
    v_max3_u32 v58, v58, v91, v92
    v_max_u32 v58, v58, v93
    v_cmp_eq_u32 vcc, -1, v58
    s_add_u32 s61, s61, 1
    s_cbranch_vccz chain2_kernel_s_pm_out
    s_cmp_ge_u32 s61, s60
    s_cbranch_scc1 chain2_kernel_s_pm_to
    s_sleep 1
    s_branch chain2_kernel_s_pm
chain2_kernel_s_pm_to:
    s_mov_b32 s60, 1
chain2_kernel_s_pm_out:
    ds_write_b128 v7, v[84:87]
    ds_write_b128 v7, v[88:91] offset:4096
    ds_write_b64 v8, v[92:93]
    s_waitcnt lgkmcnt(0)
chain2_kernel_s_go2:
    s_barrier
    ds_read_b128 v[48:51], v5 offset:0
    ds_read_b128 v[68:71], v6 offset:0
    ds_read_b128 v[72:75], v6 offset:1024
    ds_read_b128 v[52:55], v5 offset:1024
    ds_read_b128 v[76:79], v6 offset:2048
    ds_read_b128 v[80:83], v6 offset:3072
    ds_read_b128 v[56:59], v5 offset:2048
    ds_read_b128 v[60:63], v5 offset:3072
    ds_read_b128 v[64:67], v5 offset:4096
    s_waitcnt lgkmcnt(8)
    v_smfmac_f32_16x16x64_bf16 v[24:27], v[48:51], a[0:7], v4
    v_smfmac_f32_16x16x64_bf16 v[28:31], v[48:51], a[80:87], v4
    v_smfmac_f32_16x16x64_bf16 v[32:35], v[48:51], a[160:167], v4
    v_smfmac_f32_16x16x64_bf16 v[36:39], v[48:51], v[96:103], v4
    v_smfmac_f32_16x16x64_bf16 v[40:43], v[48:51], v[176:183], v4
    s_waitcnt lgkmcnt(6)
    v_smfmac_f32_16x16x64_bf16 v[44:47], v[48:51], v[68:75], v4
    ds_read_b128 v[68:71], v6 offset:4096
    ds_read_b128 v[72:75], v6 offset:5120
    ds_read_b128 v[48:51], v5 offset:5120
    s_waitcnt lgkmcnt(8)
    v_smfmac_f32_16x16x64_bf16 v[24:27], v[52:55], a[8:15], v4
    v_smfmac_f32_16x16x64_bf16 v[28:31], v[52:55], a[88:95], v4
    v_smfmac_f32_16x16x64_bf16 v[32:35], v[52:55], a[168:175], v4
    v_smfmac_f32_16x16x64_bf16 v[36:39], v[52:55], v[104:111], v4
    v_smfmac_f32_16x16x64_bf16 v[40:43], v[52:55], v[184:191], v4
    s_waitcnt lgkmcnt(6)
    v_smfmac_f32_16x16x64_bf16 v[44:47], v[52:55], v[76:83], v4
    ds_read_b128 v[76:79], v6 offset:6144
    ds_read_b128 v[80:83], v6 offset:7168
    ds_read_b128 v[52:55], v5 offset:6144
    s_waitcnt lgkmcnt(8)
    v_smfmac_f32_16x16x64_bf16 v[24:27], v[56:59], a[16:23], v4
    v_smfmac_f32_16x16x64_bf16 v[28:31], v[56:59], a[96:103], v4
    v_smfmac_f32_16x16x64_bf16 v[32:35], v[56:59], a[176:183], v4
    v_smfmac_f32_16x16x64_bf16 v[36:39], v[56:59], v[112:119], v4
    v_smfmac_f32_16x16x64_bf16 v[40:43], v[56:59], v[192:199], v4
    s_waitcnt lgkmcnt(4)
    v_smfmac_f32_16x16x64_bf16 v[44:47], v[56:59], v[68:75], v4
    ds_read_b128 v[68:71], v6 offset:8192
    ds_read_b128 v[72:75], v6 offset:9216
    ds_read_b128 v[56:59], v5 offset:7168
    v_smfmac_f32_16x16x64_bf16 v[24:27], v[60:63], a[24:31], v4
    v_smfmac_f32_16x16x64_bf16 v[28:31], v[60:63], a[104:111], v4
    v_smfmac_f32_16x16x64_bf16 v[32:35], v[60:63], a[184:191], v4
    v_smfmac_f32_16x16x64_bf16 v[36:39], v[60:63], v[120:127], v4
    v_smfmac_f32_16x16x64_bf16 v[40:43], v[60:63], v[200:207], v4
    s_waitcnt lgkmcnt(4)
    v_smfmac_f32_16x16x64_bf16 v[44:47], v[60:63], v[76:83], v4
    ds_read_b128 v[76:79], v6 offset:10240
    ds_read_b128 v[80:83], v6 offset:11264
    ds_read_b128 v[60:63], v5 offset:8192
    v_smfmac_f32_16x16x64_bf16 v[24:27], v[64:67], a[32:39], v4
    v_smfmac_f32_16x16x64_bf16 v[28:31], v[64:67], a[112:119], v4
    v_smfmac_f32_16x16x64_bf16 v[32:35], v[64:67], a[192:199], v4
    v_smfmac_f32_16x16x64_bf16 v[36:39], v[64:67], v[128:135], v4
    v_smfmac_f32_16x16x64_bf16 v[40:43], v[64:67], v[208:215], v4
    s_waitcnt lgkmcnt(4)
    v_smfmac_f32_16x16x64_bf16 v[44:47], v[64:67], v[68:75], v4
    ds_read_b128 v[68:71], v6 offset:12288
    ds_read_b128 v[72:75], v6 offset:13312
    ds_read_b128 v[64:67], v5 offset:9216
    v_smfmac_f32_16x16x64_bf16 v[24:27], v[48:51], a[40:47], v4
    v_smfmac_f32_16x16x64_bf16 v[28:31], v[48:51], a[120:127], v4
    v_smfmac_f32_16x16x64_bf16 v[32:35], v[48:51], a[200:207], v4
    v_smfmac_f32_16x16x64_bf16 v[36:39], v[48:51], v[136:143], v4
    v_smfmac_f32_16x16x64_bf16 v[40:43], v[48:51], v[216:223], v4
    s_waitcnt lgkmcnt(4)
    v_smfmac_f32_16x16x64_bf16 v[44:47], v[48:51], v[76:83], v4
    ds_read_b128 v[76:79], v6 offset:14336
    ds_read_b128 v[80:83], v6 offset:15360
    v_smfmac_f32_16x16x64_bf16 v[24:27], v[52:55], a[48:55], v4
    v_smfmac_f32_16x16x64_bf16 v[28:31], v[52:55], a[128:135], v4
    v_smfmac_f32_16x16x64_bf16 v[32:35], v[52:55], a[208:215], v4
    v_smfmac_f32_16x16x64_bf16 v[36:39], v[52:55], v[144:151], v4
    v_smfmac_f32_16x16x64_bf16 v[40:43], v[52:55], v[224:231], v4
    s_waitcnt lgkmcnt(3)
    v_smfmac_f32_16x16x64_bf16 v[44:47], v[52:55], v[68:75], v4
    ds_read_b128 v[68:71], v6 offset:16384
    ds_read_b128 v[72:75], v6 offset:17408
    v_smfmac_f32_16x16x64_bf16 v[24:27], v[56:59], a[56:63], v4
    v_smfmac_f32_16x16x64_bf16 v[28:31], v[56:59], a[136:143], v4
    v_smfmac_f32_16x16x64_bf16 v[32:35], v[56:59], a[216:223], v4
    v_smfmac_f32_16x16x64_bf16 v[36:39], v[56:59], v[152:159], v4
    v_smfmac_f32_16x16x64_bf16 v[40:43], v[56:59], v[232:239], v4
    s_waitcnt lgkmcnt(2)
    v_smfmac_f32_16x16x64_bf16 v[44:47], v[56:59], v[76:83], v4
    ds_read_b128 v[76:79], v6 offset:18432
    ds_read_b128 v[80:83], v6 offset:19456
    v_smfmac_f32_16x16x64_bf16 v[24:27], v[60:63], a[64:71], v4
    v_smfmac_f32_16x16x64_bf16 v[28:31], v[60:63], a[144:151], v4
    v_smfmac_f32_16x16x64_bf16 v[32:35], v[60:63], a[224:231], v4
    v_smfmac_f32_16x16x64_bf16 v[36:39], v[60:63], v[160:167], v4
    v_smfmac_f32_16x16x64_bf16 v[40:43], v[60:63], v[240:247], v4
    s_waitcnt lgkmcnt(2)
    v_smfmac_f32_16x16x64_bf16 v[44:47], v[60:63], v[68:75], v4
    v_smfmac_f32_16x16x64_bf16 v[24:27], v[64:67], a[72:79], v4
    v_smfmac_f32_16x16x64_bf16 v[28:31], v[64:67], a[152:159], v4
    v_smfmac_f32_16x16x64_bf16 v[32:35], v[64:67], a[232:239], v4
    v_smfmac_f32_16x16x64_bf16 v[36:39], v[64:67], v[168:175], v4
    v_smfmac_f32_16x16x64_bf16 v[40:43], v[64:67], v[248:255], v4
    s_waitcnt lgkmcnt(0)
    v_smfmac_f32_16x16x64_bf16 v[44:47], v[64:67], v[76:83], v4
    buffer_load_dwordx4 v[80:83], v19, s[8:11], s45 offen offset:0 sc1
    buffer_load_dwordx4 v[84:87], v19, s[8:11], s45 offen offset:1024 sc1
    buffer_load_dwordx4 v[88:91], v19, s[8:11], s45 offen offset:2048 sc1
    s_waitcnt vmcnt(3)
    s_nop 4
    v_permlane32_swap_b32 v24, v36
    v_permlane32_swap_b32 v25, v37
    v_permlane32_swap_b32 v26, v38
    v_permlane32_swap_b32 v27, v39
    v_add_f32 v24, v24, v36
    v_add_f32 v25, v25, v37
    v_add_f32 v26, v26, v38
    v_add_f32 v27, v27, v39
    v_cvt_pk_bf16_f32 v48, v24, v25
    v_cvt_pk_bf16_f32 v49, v26, v27
    ds_write_b64 v9, v[48:49] offset:0
    v_permlane32_swap_b32 v28, v40
    v_permlane32_swap_b32 v29, v41
    v_permlane32_swap_b32 v30, v42
    v_permlane32_swap_b32 v31, v43
    v_add_f32 v28, v28, v40
    v_add_f32 v29, v29, v41
    v_add_f32 v30, v30, v42
    v_add_f32 v31, v31, v43
    v_cvt_pk_bf16_f32 v50, v28, v29
    v_cvt_pk_bf16_f32 v51, v30, v31
    ds_write_b64 v9, v[50:51] offset:512
    v_permlane32_swap_b32 v32, v44
    v_permlane32_swap_b32 v33, v45
    v_permlane32_swap_b32 v34, v46
    v_permlane32_swap_b32 v35, v47
    v_add_f32 v32, v32, v44
    v_add_f32 v33, v33, v45
    v_add_f32 v34, v34, v46
    v_add_f32 v35, v35, v47
    v_cvt_pk_bf16_f32 v52, v32, v33
    v_cvt_pk_bf16_f32 v53, v34, v35
    ds_write_b64 v9, v[52:53] offset:1024
    s_waitcnt lgkmcnt(0)
    ds_read_b64_tr_b16 v[24:25], v11
    ds_read_b64_tr_b16 v[26:27], v11 offset:512
    ds_read_b64_tr_b16 v[28:29], v11 offset:1024
    s_waitcnt lgkmcnt(0)
    v_mfma_f32_16x16x32_bf16 v[64:67], a[240:243], v[24:27], 0
    v_mfma_f32_16x16x32_bf16 v[68:71], a[244:247], v[24:27], 0
    v_mfma_f32_16x16x32_bf16 v[72:75], v[24:27], v[24:27], 0
    s_nop 3
    v_mfma_f32_16x16x16_bf16 v[64:67], a[248:249], v[28:29], v[64:67]
    v_mfma_f32_16x16x16_bf16 v[68:71], a[250:251], v[28:29], v[68:71]
    v_mfma_f32_16x16x16_bf16 v[72:75], v[28:29], v[28:29], v[72:75]
    s_nop 5
    ds_write_b128 v12, v[64:67]
    ds_write_b128 v12, v[68:71] offset:16
    ds_write_b128 v13, v[72:75]
    s_waitcnt lgkmcnt(0)
    s_barrier
    buffer_atomic_add v0, v20, s[8:11], s49 offen
    ds_read_b128 v[48:51], v14 offset:0
    ds_read_b128 v[52:55], v14 offset:16
    ds_read_b128 v[56:59], v14 offset:1408
    ds_read_b128 v[60:63], v14 offset:1424
    ds_read_b128 v[64:67], v14 offset:2816
    ds_read_b128 v[68:71], v14 offset:2832
    ds_read_b128 v[72:75], v14 offset:4224
    ds_read_b128 v[76:79], v14 offset:4240
    s_waitcnt lgkmcnt(4)
    v_pk_add_f32 v[48:49], v[48:49], v[56:57]
    v_pk_add_f32 v[50:51], v[50:51], v[58:59]
    v_pk_add_f32 v[52:53], v[52:53], v[60:61]
    v_pk_add_f32 v[54:55], v[54:55], v[62:63]
    s_waitcnt lgkmcnt(0)
    v_pk_add_f32 v[64:65], v[64:65], v[72:73]
    v_pk_add_f32 v[66:67], v[66:67], v[74:75]
    v_pk_add_f32 v[68:69], v[68:69], v[76:77]
    v_pk_add_f32 v[70:71], v[70:71], v[78:79]
    v_pk_add_f32 v[48:49], v[48:49], v[64:65]
    v_pk_add_f32 v[50:51], v[50:51], v[66:67]
    v_pk_add_f32 v[52:53], v[52:53], v[68:69]
    v_pk_add_f32 v[54:55], v[54:55], v[70:71]
    v_max3_f32 v92, v48, v49, v50
    v_max3_f32 v92, v92, v51, v52
    v_max3_f32 v92, v92, v53, v54
    v_max_f32 v92, v92, v55
    v_mov_b32 v93, 0xff800000
    v_cndmask_b32 v92, v93, v92, s[50:51]
    s_nop 1
    v_max_f32 v92, v92, v92 quad_perm:[1,0,3,2] row_mask:0xf bank_mask:0xf
    s_nop 1
    v_max_f32 v92, v92, v92 quad_perm:[2,3,0,1] row_mask:0xf bank_mask:0xf
    s_nop 1
    v_max_f32 v92, v92, v92 row_half_mirror row_mask:0xf bank_mask:0xf
    s_mov_b32 s24, 0x3dd53b95
    v_mul_f32 v92, s24, v92
    v_fma_f32 v48, v48, s24, -v92
    v_fma_f32 v49, v49, s24, -v92
    v_fma_f32 v50, v50, s24, -v92
    v_fma_f32 v51, v51, s24, -v92
    v_fma_f32 v52, v52, s24, -v92
    v_fma_f32 v53, v53, s24, -v92
    v_fma_f32 v54, v54, s24, -v92
    v_fma_f32 v55, v55, s24, -v92
    v_exp_f32 v48, v48
    v_exp_f32 v49, v49
    v_exp_f32 v50, v50
    v_exp_f32 v51, v51
    v_exp_f32 v52, v52
    v_exp_f32 v53, v53
    v_exp_f32 v54, v54
    v_exp_f32 v55, v55
    v_add_f32 v92, v48, v49
    v_add_f32 v93, v50, v51
    v_add_f32 v92, v92, v52
    v_add_f32 v93, v93, v53
    v_add_f32 v92, v92, v54
    v_add_f32 v93, v93, v55
    v_add_f32 v92, v92, v93
    v_cndmask_b32 v92, 0, v92, s[50:51]
    s_nop 1
    v_add_f32 v92, v92, v92 quad_perm:[1,0,3,2] row_mask:0xf bank_mask:0xf
    s_nop 1
    v_add_f32 v92, v92, v92 quad_perm:[2,3,0,1] row_mask:0xf bank_mask:0xf
    s_nop 1
    v_add_f32 v92, v92, v92 row_half_mirror row_mask:0xf bank_mask:0xf
    v_rcp_f32 v92, v92
    s_nop 0
    v_mul_f32 v48, v48, v92
    v_mul_f32 v49, v49, v92
    v_mul_f32 v50, v50, v92
    v_mul_f32 v51, v51, v92
    v_mul_f32 v52, v52, v92
    v_mul_f32 v53, v53, v92
    v_mul_f32 v54, v54, v92
    v_mul_f32 v55, v55, v92
    v_cvt_pk_bf16_f32 v56, v48, v49
    v_cvt_pk_bf16_f32 v57, v50, v51
    v_cvt_pk_bf16_f32 v58, v52, v53
    v_cvt_pk_bf16_f32 v59, v54, v55
    v_min_u32 v56, -2, v56
    v_min_u32 v57, -2, v57
    v_min_u32 v58, -2, v58
    v_min_u32 v59, -2, v59
    buffer_store_dwordx4 v[56:59], v15, s[8:11], s43 offen sc1
    s_waitcnt vmcnt(2)
    v_mfma_f32_16x16x32_bf16 v[32:35], a[240:243], v[80:83], 0
    v_mfma_f32_16x16x32_bf16 v[40:43], a[244:247], v[80:83], 0
    v_mfma_f32_16x16x32_bf16 v[64:67], v[24:27], v[80:83], 0
    v_mfma_f32_16x16x32_bf16 v[36:39], a[240:243], v[84:87], 0
    v_mfma_f32_16x16x32_bf16 v[44:47], a[244:247], v[84:87], 0
    v_mfma_f32_16x16x32_bf16 v[68:71], v[24:27], v[84:87], 0
    s_nop 0
    v_mfma_f32_16x16x16_bf16 v[32:35], a[248:249], v[88:89], v[32:35]
    v_mfma_f32_16x16x16_bf16 v[40:43], a[250:251], v[88:89], v[40:43]
    v_mfma_f32_16x16x16_bf16 v[64:67], v[28:29], v[88:89], v[64:67]
    v_mfma_f32_16x16x16_bf16 v[36:39], a[248:249], v[90:91], v[36:39]
    v_mfma_f32_16x16x16_bf16 v[44:47], a[250:251], v[90:91], v[44:47]
    v_mfma_f32_16x16x16_bf16 v[68:71], v[28:29], v[90:91], v[68:71]
    s_nop 2
    ds_write_b128 v16, v[32:35] offset:0
    ds_write_b128 v16, v[40:43] offset:16
    ds_write_b128 v17, v[64:67]
    ds_write_b128 v16, v[36:39] offset:2816
    ds_write_b128 v16, v[44:47] offset:2832
    ds_write_b128 v18, v[68:71]
    s_add_u32 s40, s40, 1
    s_add_u32 s41, s41, 393216
    s_add_u32 s45, s45, 393216
    s_add_u32 s43, s43, 81920
    s_add_u32 s47, s47, 40960
    s_add_u32 s48, s48, 8192
    s_add_u32 s49, s49, 4096
    s_waitcnt lgkmcnt(0)
    s_barrier
    s_cmp_lt_u32 s40, 64
    s_cbranch_scc1 chain2_kernel_s_step
    ds_read_b128 v[48:51], v21 offset:0
    ds_read_b128 v[52:55], v21 offset:16
    ds_read_b128 v[56:59], v21 offset:5632
    ds_read_b128 v[60:63], v21 offset:5648
    ds_read_b128 v[64:67], v21 offset:11264
    ds_read_b128 v[68:71], v21 offset:11280
    ds_read_b128 v[72:75], v21 offset:16896
    ds_read_b128 v[76:79], v21 offset:16912
    s_waitcnt lgkmcnt(4)
    v_pk_add_f32 v[48:49], v[48:49], v[56:57]
    v_pk_add_f32 v[50:51], v[50:51], v[58:59]
    v_pk_add_f32 v[52:53], v[52:53], v[60:61]
    v_pk_add_f32 v[54:55], v[54:55], v[62:63]
    s_waitcnt lgkmcnt(0)
    v_pk_add_f32 v[64:65], v[64:65], v[72:73]
    v_pk_add_f32 v[66:67], v[66:67], v[74:75]
    v_pk_add_f32 v[68:69], v[68:69], v[76:77]
    v_pk_add_f32 v[70:71], v[70:71], v[78:79]
    v_pk_add_f32 v[48:49], v[48:49], v[64:65]
    v_pk_add_f32 v[50:51], v[50:51], v[66:67]
    v_pk_add_f32 v[52:53], v[52:53], v[68:69]
    v_pk_add_f32 v[54:55], v[54:55], v[70:71]
    v_mov_b32 v81, 0xff800000
    v_cndmask_b32 v48, v81, v48, s[64:65]
    v_cndmask_b32 v49, v81, v49, s[66:67]
    v_cndmask_b32 v50, v81, v50, s[68:69]
    v_cndmask_b32 v51, v81, v51, s[70:71]
    v_cndmask_b32 v52, v81, v52, s[72:73]
    v_cndmask_b32 v53, v81, v53, s[74:75]
    v_cndmask_b32 v54, v81, v54, s[76:77]
    v_cndmask_b32 v55, v81, v55, s[78:79]
    v_max3_f32 v80, v48, v49, v50
    v_max3_f32 v80, v80, v51, v52
    v_max3_f32 v80, v80, v53, v54
    v_max_f32 v80, v80, v55
    v_mov_b32 v81, 0xff800000
    v_cndmask_b32 v80, v81, v80, s[50:51]
    s_nop 1
    v_max_f32 v80, v80, v80 quad_perm:[1,0,3,2] row_mask:0xf bank_mask:0xf
    s_nop 1
    v_max_f32 v80, v80, v80 quad_perm:[2,3,0,1] row_mask:0xf bank_mask:0xf
    s_nop 1
    v_max_f32 v80, v80, v80 row_half_mirror row_mask:0xf bank_mask:0xf
    s_mov_b32 s24, 0x3dd53b95
    v_mul_f32 v80, s24, v80
    v_fma_f32 v48, v48, s24, -v80
    v_fma_f32 v49, v49, s24, -v80
    v_fma_f32 v50, v50, s24, -v80
    v_fma_f32 v51, v51, s24, -v80
    v_fma_f32 v52, v52, s24, -v80
    v_fma_f32 v53, v53, s24, -v80
    v_fma_f32 v54, v54, s24, -v80
    v_fma_f32 v55, v55, s24, -v80
    v_exp_f32 v48, v48
    v_exp_f32 v49, v49
    v_exp_f32 v50, v50
    v_exp_f32 v51, v51
    v_exp_f32 v52, v52
    v_exp_f32 v53, v53
    v_exp_f32 v54, v54
    v_exp_f32 v55, v55
    v_add_f32 v80, v48, v49
    v_add_f32 v81, v50, v51
    v_add_f32 v80, v80, v52
    v_add_f32 v81, v81, v53
    v_add_f32 v80, v80, v54
    v_add_f32 v81, v81, v55
    v_add_f32 v80, v80, v81
    v_cndmask_b32 v80, 0, v80, s[50:51]
    s_nop 1
    v_add_f32 v80, v80, v80 quad_perm:[1,0,3,2] row_mask:0xf bank_mask:0xf
    s_nop 1
    v_add_f32 v80, v80, v80 quad_perm:[2,3,0,1] row_mask:0xf bank_mask:0xf
    s_nop 1
    v_add_f32 v80, v80, v80 row_half_mirror row_mask:0xf bank_mask:0xf
    v_rcp_f32 v80, v80
    s_nop 0
    v_mul_f32 v48, v48, v80
    v_mul_f32 v49, v49, v80
    v_mul_f32 v50, v50, v80
    v_mul_f32 v51, v51, v80
    v_mul_f32 v52, v52, v80
    v_mul_f32 v53, v53, v80
    v_mul_f32 v54, v54, v80
    v_mul_f32 v55, v55, v80
    v_cvt_pk_bf16_f32 v56, v48, v49
    v_cvt_pk_bf16_f32 v57, v50, v51
    v_cvt_pk_bf16_f32 v58, v52, v53
    v_cvt_pk_bf16_f32 v59, v54, v55
    v_min_u32 v56, -2, v56
    v_min_u32 v57, -2, v57
    v_min_u32 v58, -2, v58
    v_min_u32 v59, -2, v59
    buffer_store_dwordx4 v[56:59], v22, s[8:11], s42 offen sc1
    s_add_u32 s42, s42, 81920
    s_branch chain2_kernel_end
chain2_kernel_s_go:
    v_mov_b32 v24, 0
    v_mov_b32 v25, 0
    v_mov_b32 v26, 0
    v_mov_b32 v27, 0
    v_mov_b32 v28, 0
    v_mov_b32 v29, 0
    v_mov_b32 v30, 0
    v_mov_b32 v31, 0
    v_mov_b32 v32, 0
    v_mov_b32 v33, 0
    v_mov_b32 v34, 0
    v_mov_b32 v35, 0
    v_mov_b32 v36, 0
    v_mov_b32 v37, 0
    v_mov_b32 v38, 0
    v_mov_b32 v39, 0
    v_mov_b32 v40, 0
    v_mov_b32 v41, 0
    v_mov_b32 v42, 0
    v_mov_b32 v43, 0
    v_mov_b32 v44, 0
    v_mov_b32 v45, 0
    v_mov_b32 v46, 0
    v_mov_b32 v47, 0
    s_waitcnt vmcnt(0)
    s_branch chain2_kernel_s_go2
chain2_kernel_roleV:
    s_sub_u32 s44, s2, 32
    s_load_dwordx2 s[6:7], s[0:1], 56
    s_load_dwordx2 s[24:25], s[0:1], 64
    s_waitcnt lgkmcnt(0)
    s_mov_b32 s12, s6
    s_mov_b32 s13, s7
    s_mov_b32 s14, 7864320
    s_mov_b32 s15, 0x00020000
    s_mov_b32 s16, s24
    s_mov_b32 s17, s25
    s_mov_b32 s18, 7864320
    s_mov_b32 s19, 0x00020000
    v_add_u32 v16, 0, v0
    s_mov_b32 s24, 683
    v_mul_lo_u32 v17, v16, s24
    v_lshrrev_b32 v17, 14, v17
    v_mul_u32_u24 v18, 24, v17
    v_sub_u32 v18, v16, v18
    s_mov_b32 s24, 12288
    v_mul_lo_u32 v4, v17, s24
    v_lshl_add_u32 v4, v18, 4, v4
    v_mul_u32_u24 v10, 400, v17
    v_lshl_add_u32 v10, v18, 4, v10
    v_add_u32 v10, 90112, v10
    v_add_u32 v16, 256, v0
    s_mov_b32 s24, 683
    v_mul_lo_u32 v17, v16, s24
    v_lshrrev_b32 v17, 14, v17
    v_mul_u32_u24 v18, 24, v17
    v_sub_u32 v18, v16, v18
    s_mov_b32 s24, 12288
    v_mul_lo_u32 v5, v17, s24
    v_lshl_add_u32 v5, v18, 4, v5
    v_mul_u32_u24 v11, 400, v17
    v_lshl_add_u32 v11, v18, 4, v11
    v_add_u32 v11, 90112, v11
    v_add_u32 v16, 512, v0
    s_mov_b32 s24, 683
    v_mul_lo_u32 v17, v16, s24
    v_lshrrev_b32 v17, 14, v17
    v_mul_u32_u24 v18, 24, v17
    v_sub_u32 v18, v16, v18
    s_mov_b32 s24, 12288
    v_mul_lo_u32 v6, v17, s24
    v_lshl_add_u32 v6, v18, 4, v6
    v_mul_u32_u24 v12, 400, v17
    v_lshl_add_u32 v12, v18, 4, v12
    v_add_u32 v12, 90112, v12
    v_add_u32 v16, 768, v0
    s_mov_b32 s24, 683
    v_mul_lo_u32 v17, v16, s24
    v_lshrrev_b32 v17, 14, v17
    v_mul_u32_u24 v18, 24, v17
    v_sub_u32 v18, v16, v18
    s_mov_b32 s24, 12288
    v_mul_lo_u32 v7, v17, s24
    v_lshl_add_u32 v7, v18, 4, v7
    v_mul_u32_u24 v13, 400, v17
    v_lshl_add_u32 v13, v18, 4, v13
    v_add_u32 v13, 90112, v13
    v_add_u32 v16, 1024, v0
    s_mov_b32 s24, 683
    v_mul_lo_u32 v17, v16, s24
    v_lshrrev_b32 v17, 14, v17
    v_mul_u32_u24 v18, 24, v17
    v_sub_u32 v18, v16, v18
    s_mov_b32 s24, 12288
    v_mul_lo_u32 v8, v17, s24
    v_lshl_add_u32 v8, v18, 4, v8
    v_mul_u32_u24 v14, 400, v17
    v_lshl_add_u32 v14, v18, 4, v14
    v_add_u32 v14, 90112, v14
    v_add_u32 v16, 1280, v0
    s_mov_b32 s24, 683
    v_mul_lo_u32 v17, v16, s24
    v_lshrrev_b32 v17, 14, v17
    v_mul_u32_u24 v18, 24, v17
    v_sub_u32 v18, v16, v18
    s_mov_b32 s24, 12288
    v_mul_lo_u32 v9, v17, s24
    v_lshl_add_u32 v9, v18, 4, v9
    v_mul_u32_u24 v15, 400, v17
    v_lshl_add_u32 v15, v18, 4, v15
    v_add_u32 v15, 90112, v15
    v_lshrrev_b32 v17, 1, v3
    v_lshlrev_b32 v17, 4, v17
    v_and_b32 v18, 1, v3
    v_lshl_add_u32 v17, v18, 2, v17
    v_lshrrev_b32 v18, 2, v2
    v_and_b32 v19, 1, v18
    v_add_u32 v17, v17, v19
    v_lshrrev_b32 v18, 1, v18
    v_lshl_add_u32 v17, v18, 3, v17
    v_mul_u32_u24 v16, 400, v17
    v_and_b32 v18, 3, v2
    v_lshl_add_u32 v16, v18, 3, v16
    v_add_u32 v16, 90112, v16
    s_mul_i32 s24, s3, 96
    v_add_u32 v16, s24, v16
    s_mul_i32 s45, s44, 384
    s_add_u32 s46, s45, 0
    buffer_load_dwordx4 v[24:27], v4, s[12:15], s46 offen
    buffer_load_dwordx4 v[28:31], v5, s[12:15], s46 offen
    buffer_load_dwordx4 v[32:35], v6, s[12:15], s46 offen
    buffer_load_dwordx4 v[36:39], v7, s[12:15], s46 offen
    buffer_load_dwordx4 v[40:43], v8, s[12:15], s46 offen
    buffer_load_dwordx4 v[44:47], v9, s[12:15], s46 offen
    s_add_u32 s46, s45, 786432
    buffer_load_dwordx4 v[48:51], v4, s[12:15], s46 offen
    buffer_load_dwordx4 v[52:55], v5, s[12:15], s46 offen
    buffer_load_dwordx4 v[56:59], v6, s[12:15], s46 offen
    buffer_load_dwordx4 v[60:63], v7, s[12:15], s46 offen
    buffer_load_dwordx4 v[64:67], v8, s[12:15], s46 offen
    buffer_load_dwordx4 v[68:71], v9, s[12:15], s46 offen
    s_waitcnt vmcnt(6)
    ds_write_b128 v10, v[24:27]
    ds_write_b128 v11, v[28:31]
    ds_write_b128 v12, v[32:35]
    ds_write_b128 v13, v[36:39]
    ds_write_b128 v14, v[40:43]
    ds_write_b128 v15, v[44:47]
    s_add_u32 s46, s45, 1572864
    buffer_load_dwordx4 v[72:75], v4, s[12:15], s46 offen
    buffer_load_dwordx4 v[76:79], v5, s[12:15], s46 offen
    buffer_load_dwordx4 v[80:83], v6, s[12:15], s46 offen
    buffer_load_dwordx4 v[84:87], v7, s[12:15], s46 offen
    buffer_load_dwordx4 v[88:91], v8, s[12:15], s46 offen
    buffer_load_dwordx4 v[92:95], v9, s[12:15], s46 offen
    s_waitcnt lgkmcnt(0)
    s_barrier
    ds_read_b64_tr_b16 a[0:1], v16 offset:0
    ds_read_b64_tr_b16 a[2:3], v16 offset:800
    ds_read_b64_tr_b16 a[4:5], v16 offset:12800
    ds_read_b64_tr_b16 a[6:7], v16 offset:13600
    ds_read_b64_tr_b16 a[80:81], v16 offset:32
    ds_read_b64_tr_b16 a[82:83], v16 offset:832
    ds_read_b64_tr_b16 a[84:85], v16 offset:12832
    ds_read_b64_tr_b16 a[86:87], v16 offset:13632
    ds_read_b64_tr_b16 a[160:161], v16 offset:64
    ds_read_b64_tr_b16 a[162:163], v16 offset:864
    ds_read_b64_tr_b16 a[164:165], v16 offset:12864
    ds_read_b64_tr_b16 a[166:167], v16 offset:13664
    s_waitcnt lgkmcnt(0)
    s_barrier
    s_waitcnt vmcnt(6)
    ds_write_b128 v10, v[48:51]
    ds_write_b128 v11, v[52:55]
    ds_write_b128 v12, v[56:59]
    ds_write_b128 v13, v[60:63]
    ds_write_b128 v14, v[64:67]
    ds_write_b128 v15, v[68:71]
    s_add_u32 s46, s45, 2359296
    buffer_load_dwordx4 v[24:27], v4, s[12:15], s46 offen
    buffer_load_dwordx4 v[28:31], v5, s[12:15], s46 offen
    buffer_load_dwordx4 v[32:35], v6, s[12:15], s46 offen
    buffer_load_dwordx4 v[36:39], v7, s[12:15], s46 offen
    buffer_load_dwordx4 v[40:43], v8, s[12:15], s46 offen
    buffer_load_dwordx4 v[44:47], v9, s[12:15], s46 offen
    s_waitcnt lgkmcnt(0)
    s_barrier
    ds_read_b64_tr_b16 a[8:9], v16 offset:0
    ds_read_b64_tr_b16 a[10:11], v16 offset:800
    ds_read_b64_tr_b16 a[12:13], v16 offset:12800
    ds_read_b64_tr_b16 a[14:15], v16 offset:13600
    ds_read_b64_tr_b16 a[88:89], v16 offset:32
    ds_read_b64_tr_b16 a[90:91], v16 offset:832
    ds_read_b64_tr_b16 a[92:93], v16 offset:12832
    ds_read_b64_tr_b16 a[94:95], v16 offset:13632
    ds_read_b64_tr_b16 a[168:169], v16 offset:64
    ds_read_b64_tr_b16 a[170:171], v16 offset:864
    ds_read_b64_tr_b16 a[172:173], v16 offset:12864
    ds_read_b64_tr_b16 a[174:175], v16 offset:13664
    s_waitcnt lgkmcnt(0)
    s_barrier
    s_waitcnt vmcnt(6)
    ds_write_b128 v10, v[72:75]
    ds_write_b128 v11, v[76:79]
    ds_write_b128 v12, v[80:83]
    ds_write_b128 v13, v[84:87]
    ds_write_b128 v14, v[88:91]
    ds_write_b128 v15, v[92:95]
    s_add_u32 s46, s45, 3145728
    buffer_load_dwordx4 v[48:51], v4, s[12:15], s46 offen
    buffer_load_dwordx4 v[52:55], v5, s[12:15], s46 offen
    buffer_load_dwordx4 v[56:59], v6, s[12:15], s46 offen
    buffer_load_dwordx4 v[60:63], v7, s[12:15], s46 offen
    buffer_load_dwordx4 v[64:67], v8, s[12:15], s46 offen
    buffer_load_dwordx4 v[68:71], v9, s[12:15], s46 offen
    s_waitcnt lgkmcnt(0)
    s_barrier
    ds_read_b64_tr_b16 a[16:17], v16 offset:0
    ds_read_b64_tr_b16 a[18:19], v16 offset:800
    ds_read_b64_tr_b16 a[20:21], v16 offset:12800
    ds_read_b64_tr_b16 a[22:23], v16 offset:13600
    ds_read_b64_tr_b16 a[96:97], v16 offset:32
    ds_read_b64_tr_b16 a[98:99], v16 offset:832
    ds_read_b64_tr_b16 a[100:101], v16 offset:12832
    ds_read_b64_tr_b16 a[102:103], v16 offset:13632
    ds_read_b64_tr_b16 a[176:177], v16 offset:64
    ds_read_b64_tr_b16 a[178:179], v16 offset:864
    ds_read_b64_tr_b16 a[180:181], v16 offset:12864
    ds_read_b64_tr_b16 a[182:183], v16 offset:13664
    s_waitcnt lgkmcnt(0)
    s_barrier
    s_waitcnt vmcnt(6)
    ds_write_b128 v10, v[24:27]
    ds_write_b128 v11, v[28:31]
    ds_write_b128 v12, v[32:35]
    ds_write_b128 v13, v[36:39]
    ds_write_b128 v14, v[40:43]
    ds_write_b128 v15, v[44:47]
    s_add_u32 s46, s45, 3932160
    buffer_load_dwordx4 v[72:75], v4, s[12:15], s46 offen
    buffer_load_dwordx4 v[76:79], v5, s[12:15], s46 offen
    buffer_load_dwordx4 v[80:83], v6, s[12:15], s46 offen
    buffer_load_dwordx4 v[84:87], v7, s[12:15], s46 offen
    buffer_load_dwordx4 v[88:91], v8, s[12:15], s46 offen
    buffer_load_dwordx4 v[92:95], v9, s[12:15], s46 offen
    s_waitcnt lgkmcnt(0)
    s_barrier
    ds_read_b64_tr_b16 a[24:25], v16 offset:0
    ds_read_b64_tr_b16 a[26:27], v16 offset:800
    ds_read_b64_tr_b16 a[28:29], v16 offset:12800
    ds_read_b64_tr_b16 a[30:31], v16 offset:13600
    ds_read_b64_tr_b16 a[104:105], v16 offset:32
    ds_read_b64_tr_b16 a[106:107], v16 offset:832
    ds_read_b64_tr_b16 a[108:109], v16 offset:12832
    ds_read_b64_tr_b16 a[110:111], v16 offset:13632
    ds_read_b64_tr_b16 a[184:185], v16 offset:64
    ds_read_b64_tr_b16 a[186:187], v16 offset:864
    ds_read_b64_tr_b16 a[188:189], v16 offset:12864
    ds_read_b64_tr_b16 a[190:191], v16 offset:13664
    s_waitcnt lgkmcnt(0)
    s_barrier
    s_waitcnt vmcnt(6)
    ds_write_b128 v10, v[48:51]
    ds_write_b128 v11, v[52:55]
    ds_write_b128 v12, v[56:59]
    ds_write_b128 v13, v[60:63]
    ds_write_b128 v14, v[64:67]
    ds_write_b128 v15, v[68:71]
    s_add_u32 s46, s45, 4718592
    buffer_load_dwordx4 v[24:27], v4, s[12:15], s46 offen
    buffer_load_dwordx4 v[28:31], v5, s[12:15], s46 offen
    buffer_load_dwordx4 v[32:35], v6, s[12:15], s46 offen
    buffer_load_dwordx4 v[36:39], v7, s[12:15], s46 offen
    buffer_load_dwordx4 v[40:43], v8, s[12:15], s46 offen
    buffer_load_dwordx4 v[44:47], v9, s[12:15], s46 offen
    s_waitcnt lgkmcnt(0)
    s_barrier
    ds_read_b64_tr_b16 a[32:33], v16 offset:0
    ds_read_b64_tr_b16 a[34:35], v16 offset:800
    ds_read_b64_tr_b16 a[36:37], v16 offset:12800
    ds_read_b64_tr_b16 a[38:39], v16 offset:13600
    ds_read_b64_tr_b16 a[112:113], v16 offset:32
    ds_read_b64_tr_b16 a[114:115], v16 offset:832
    ds_read_b64_tr_b16 a[116:117], v16 offset:12832
    ds_read_b64_tr_b16 a[118:119], v16 offset:13632
    ds_read_b64_tr_b16 a[192:193], v16 offset:64
    ds_read_b64_tr_b16 a[194:195], v16 offset:864
    ds_read_b64_tr_b16 a[196:197], v16 offset:12864
    ds_read_b64_tr_b16 a[198:199], v16 offset:13664
    s_waitcnt lgkmcnt(0)
    s_barrier
    s_waitcnt vmcnt(6)
    ds_write_b128 v10, v[72:75]
    ds_write_b128 v11, v[76:79]
    ds_write_b128 v12, v[80:83]
    ds_write_b128 v13, v[84:87]
    ds_write_b128 v14, v[88:91]
    ds_write_b128 v15, v[92:95]
    s_add_u32 s46, s45, 5505024
    buffer_load_dwordx4 v[48:51], v4, s[12:15], s46 offen
    buffer_load_dwordx4 v[52:55], v5, s[12:15], s46 offen
    buffer_load_dwordx4 v[56:59], v6, s[12:15], s46 offen
    buffer_load_dwordx4 v[60:63], v7, s[12:15], s46 offen
    buffer_load_dwordx4 v[64:67], v8, s[12:15], s46 offen
    buffer_load_dwordx4 v[68:71], v9, s[12:15], s46 offen
    s_waitcnt lgkmcnt(0)
    s_barrier
    ds_read_b64_tr_b16 a[40:41], v16 offset:0
    ds_read_b64_tr_b16 a[42:43], v16 offset:800
    ds_read_b64_tr_b16 a[44:45], v16 offset:12800
    ds_read_b64_tr_b16 a[46:47], v16 offset:13600
    ds_read_b64_tr_b16 a[120:121], v16 offset:32
    ds_read_b64_tr_b16 a[122:123], v16 offset:832
    ds_read_b64_tr_b16 a[124:125], v16 offset:12832
    ds_read_b64_tr_b16 a[126:127], v16 offset:13632
    ds_read_b64_tr_b16 a[200:201], v16 offset:64
    ds_read_b64_tr_b16 a[202:203], v16 offset:864
    ds_read_b64_tr_b16 a[204:205], v16 offset:12864
    ds_read_b64_tr_b16 a[206:207], v16 offset:13664
    s_waitcnt lgkmcnt(0)
    s_barrier
    s_waitcnt vmcnt(6)
    ds_write_b128 v10, v[24:27]
    ds_write_b128 v11, v[28:31]
    ds_write_b128 v12, v[32:35]
    ds_write_b128 v13, v[36:39]
    ds_write_b128 v14, v[40:43]
    ds_write_b128 v15, v[44:47]
    s_add_u32 s46, s45, 6291456
    buffer_load_dwordx4 v[72:75], v4, s[12:15], s46 offen
    buffer_load_dwordx4 v[76:79], v5, s[12:15], s46 offen
    buffer_load_dwordx4 v[80:83], v6, s[12:15], s46 offen
    buffer_load_dwordx4 v[84:87], v7, s[12:15], s46 offen
    buffer_load_dwordx4 v[88:91], v8, s[12:15], s46 offen
    buffer_load_dwordx4 v[92:95], v9, s[12:15], s46 offen
    s_waitcnt lgkmcnt(0)
    s_barrier
    ds_read_b64_tr_b16 a[48:49], v16 offset:0
    ds_read_b64_tr_b16 a[50:51], v16 offset:800
    ds_read_b64_tr_b16 a[52:53], v16 offset:12800
    ds_read_b64_tr_b16 a[54:55], v16 offset:13600
    ds_read_b64_tr_b16 a[128:129], v16 offset:32
    ds_read_b64_tr_b16 a[130:131], v16 offset:832
    ds_read_b64_tr_b16 a[132:133], v16 offset:12832
    ds_read_b64_tr_b16 a[134:135], v16 offset:13632
    ds_read_b64_tr_b16 a[208:209], v16 offset:64
    ds_read_b64_tr_b16 a[210:211], v16 offset:864
    ds_read_b64_tr_b16 a[212:213], v16 offset:12864
    ds_read_b64_tr_b16 a[214:215], v16 offset:13664
    s_waitcnt lgkmcnt(0)
    s_barrier
    s_waitcnt vmcnt(6)
    ds_write_b128 v10, v[48:51]
    ds_write_b128 v11, v[52:55]
    ds_write_b128 v12, v[56:59]
    ds_write_b128 v13, v[60:63]
    ds_write_b128 v14, v[64:67]
    ds_write_b128 v15, v[68:71]
    s_add_u32 s46, s45, 7077888
    buffer_load_dwordx4 v[24:27], v4, s[12:15], s46 offen
    buffer_load_dwordx4 v[28:31], v5, s[12:15], s46 offen
    buffer_load_dwordx4 v[32:35], v6, s[12:15], s46 offen
    buffer_load_dwordx4 v[36:39], v7, s[12:15], s46 offen
    buffer_load_dwordx4 v[40:43], v8, s[12:15], s46 offen
    buffer_load_dwordx4 v[44:47], v9, s[12:15], s46 offen
    s_waitcnt lgkmcnt(0)
    s_barrier
    ds_read_b64_tr_b16 a[56:57], v16 offset:0
    ds_read_b64_tr_b16 a[58:59], v16 offset:800
    ds_read_b64_tr_b16 a[60:61], v16 offset:12800
    ds_read_b64_tr_b16 a[62:63], v16 offset:13600
    ds_read_b64_tr_b16 a[136:137], v16 offset:32
    ds_read_b64_tr_b16 a[138:139], v16 offset:832
    ds_read_b64_tr_b16 a[140:141], v16 offset:12832
    ds_read_b64_tr_b16 a[142:143], v16 offset:13632
    ds_read_b64_tr_b16 a[216:217], v16 offset:64
    ds_read_b64_tr_b16 a[218:219], v16 offset:864
    ds_read_b64_tr_b16 a[220:221], v16 offset:12864
    ds_read_b64_tr_b16 a[222:223], v16 offset:13664
    s_waitcnt lgkmcnt(0)
    s_barrier
    s_waitcnt vmcnt(6)
    ds_write_b128 v10, v[72:75]
    ds_write_b128 v11, v[76:79]
    ds_write_b128 v12, v[80:83]
    ds_write_b128 v13, v[84:87]
    ds_write_b128 v14, v[88:91]
    ds_write_b128 v15, v[92:95]
    s_waitcnt lgkmcnt(0)
    s_barrier
    ds_read_b64_tr_b16 a[64:65], v16 offset:0
    ds_read_b64_tr_b16 a[66:67], v16 offset:800
    ds_read_b64_tr_b16 a[68:69], v16 offset:12800
    ds_read_b64_tr_b16 a[70:71], v16 offset:13600
    ds_read_b64_tr_b16 a[144:145], v16 offset:32
    ds_read_b64_tr_b16 a[146:147], v16 offset:832
    ds_read_b64_tr_b16 a[148:149], v16 offset:12832
    ds_read_b64_tr_b16 a[150:151], v16 offset:13632
    ds_read_b64_tr_b16 a[224:225], v16 offset:64
    ds_read_b64_tr_b16 a[226:227], v16 offset:864
    ds_read_b64_tr_b16 a[228:229], v16 offset:12864
    ds_read_b64_tr_b16 a[230:231], v16 offset:13664
    s_waitcnt lgkmcnt(0)
    s_barrier
    s_waitcnt vmcnt(0)
    ds_write_b128 v10, v[24:27]
    ds_write_b128 v11, v[28:31]
    ds_write_b128 v12, v[32:35]
    ds_write_b128 v13, v[36:39]
    ds_write_b128 v14, v[40:43]
    ds_write_b128 v15, v[44:47]
    s_waitcnt lgkmcnt(0)
    s_barrier
    ds_read_b64_tr_b16 a[72:73], v16 offset:0
    ds_read_b64_tr_b16 a[74:75], v16 offset:800
    ds_read_b64_tr_b16 a[76:77], v16 offset:12800
    ds_read_b64_tr_b16 a[78:79], v16 offset:13600
    ds_read_b64_tr_b16 a[152:153], v16 offset:32
    ds_read_b64_tr_b16 a[154:155], v16 offset:832
    ds_read_b64_tr_b16 a[156:157], v16 offset:12832
    ds_read_b64_tr_b16 a[158:159], v16 offset:13632
    ds_read_b64_tr_b16 a[232:233], v16 offset:64
    ds_read_b64_tr_b16 a[234:235], v16 offset:864
    ds_read_b64_tr_b16 a[236:237], v16 offset:12864
    ds_read_b64_tr_b16 a[238:239], v16 offset:13664
    s_waitcnt lgkmcnt(0)
    s_barrier
    v_add_u32 v64, 0, v0
    s_mov_b32 s24, 1639
    v_mul_lo_u32 v65, v64, s24
    v_lshrrev_b32 v65, 16, v65
    v_mul_u32_u24 v66, 40, v65
    v_sub_u32 v66, v64, v66
    s_mov_b32 s24, 1280
    v_mul_lo_u32 v4, v65, s24
    v_lshl_add_u32 v4, v66, 4, v4
    v_mul_u32_u24 v14, 656, v65
    v_lshl_add_u32 v14, v66, 4, v14
    v_add_u32 v14, 90112, v14
    v_add_u32 v64, 256, v0
    s_mov_b32 s24, 1639
    v_mul_lo_u32 v65, v64, s24
    v_lshrrev_b32 v65, 16, v65
    v_mul_u32_u24 v66, 40, v65
    v_sub_u32 v66, v64, v66
    s_mov_b32 s24, 1280
    v_mul_lo_u32 v5, v65, s24
    v_lshl_add_u32 v5, v66, 4, v5
    v_mul_u32_u24 v15, 656, v65
    v_lshl_add_u32 v15, v66, 4, v15
    v_add_u32 v15, 90112, v15
    v_add_u32 v64, 512, v0
    s_mov_b32 s24, 1639
    v_mul_lo_u32 v65, v64, s24
    v_lshrrev_b32 v65, 16, v65
    v_mul_u32_u24 v66, 40, v65
    v_sub_u32 v66, v64, v66
    s_mov_b32 s24, 1280
    v_mul_lo_u32 v6, v65, s24
    v_lshl_add_u32 v6, v66, 4, v6
    v_mul_u32_u24 v16, 656, v65
    v_lshl_add_u32 v16, v66, 4, v16
    v_add_u32 v16, 90112, v16
    v_add_u32 v64, 768, v0
    s_mov_b32 s24, 1639
    v_mul_lo_u32 v65, v64, s24
    v_lshrrev_b32 v65, 16, v65
    v_mul_u32_u24 v66, 40, v65
    v_sub_u32 v66, v64, v66
    s_mov_b32 s24, 1280
    v_mul_lo_u32 v7, v65, s24
    v_lshl_add_u32 v7, v66, 4, v7
    v_mul_u32_u24 v17, 656, v65
    v_lshl_add_u32 v17, v66, 4, v17
    v_add_u32 v17, 90112, v17
    v_add_u32 v64, 1024, v0
    s_mov_b32 s24, 1639
    v_mul_lo_u32 v65, v64, s24
    v_lshrrev_b32 v65, 16, v65
    v_mul_u32_u24 v66, 40, v65
    v_sub_u32 v66, v64, v66
    s_mov_b32 s24, 1280
    v_mul_lo_u32 v8, v65, s24
    v_lshl_add_u32 v8, v66, 4, v8
    v_mul_u32_u24 v18, 656, v65
    v_lshl_add_u32 v18, v66, 4, v18
    v_add_u32 v18, 90112, v18
    v_add_u32 v64, 1280, v0
    s_mov_b32 s24, 1639
    v_mul_lo_u32 v65, v64, s24
    v_lshrrev_b32 v65, 16, v65
    v_mul_u32_u24 v66, 40, v65
    v_sub_u32 v66, v64, v66
    s_mov_b32 s24, 1280
    v_mul_lo_u32 v9, v65, s24
    v_lshl_add_u32 v9, v66, 4, v9
    v_mul_u32_u24 v19, 656, v65
    v_lshl_add_u32 v19, v66, 4, v19
    v_add_u32 v19, 90112, v19
    v_add_u32 v64, 1536, v0
    s_mov_b32 s24, 1639
    v_mul_lo_u32 v65, v64, s24
    v_lshrrev_b32 v65, 16, v65
    v_mul_u32_u24 v66, 40, v65
    v_sub_u32 v66, v64, v66
    s_mov_b32 s24, 1280
    v_mul_lo_u32 v10, v65, s24
    v_lshl_add_u32 v10, v66, 4, v10
    v_mul_u32_u24 v20, 656, v65
    v_lshl_add_u32 v20, v66, 4, v20
    v_add_u32 v20, 90112, v20
    v_add_u32 v64, 1792, v0
    s_mov_b32 s24, 1639
    v_mul_lo_u32 v65, v64, s24
    v_lshrrev_b32 v65, 16, v65
    v_mul_u32_u24 v66, 40, v65
    v_sub_u32 v66, v64, v66
    s_mov_b32 s24, 1280
    v_mul_lo_u32 v11, v65, s24
    v_lshl_add_u32 v11, v66, 4, v11
    v_mul_u32_u24 v21, 656, v65
    v_lshl_add_u32 v21, v66, 4, v21
    v_add_u32 v21, 90112, v21
    v_add_u32 v64, 2048, v0
    s_mov_b32 s24, 1639
    v_mul_lo_u32 v65, v64, s24
    v_lshrrev_b32 v65, 16, v65
    v_mul_u32_u24 v66, 40, v65
    v_sub_u32 v66, v64, v66
    s_mov_b32 s24, 1280
    v_mul_lo_u32 v12, v65, s24
    v_lshl_add_u32 v12, v66, 4, v12
    v_mul_u32_u24 v22, 656, v65
    v_lshl_add_u32 v22, v66, 4, v22
    v_add_u32 v22, 90112, v22
    v_add_u32 v64, 2304, v0
    s_mov_b32 s24, 1639
    v_mul_lo_u32 v65, v64, s24
    v_lshrrev_b32 v65, 16, v65
    v_mul_u32_u24 v66, 40, v65
    v_sub_u32 v66, v64, v66
    s_mov_b32 s24, 1280
    v_mul_lo_u32 v13, v65, s24
    v_lshl_add_u32 v13, v66, 4, v13
    v_mul_u32_u24 v23, 656, v65
    v_lshl_add_u32 v23, v66, 4, v23
    v_add_u32 v23, 90112, v23
    v_lshrrev_b32 v64, 1, v3
    v_lshlrev_b32 v64, 4, v64
    v_and_b32 v65, 1, v3
    v_lshl_add_u32 v64, v65, 2, v64
    v_lshrrev_b32 v65, 2, v2
    v_and_b32 v66, 1, v65
    v_add_u32 v64, v64, v66
    v_lshrrev_b32 v65, 1, v65
    v_lshl_add_u32 v64, v65, 3, v64
    v_mul_u32_u24 v72, 656, v64
    v_and_b32 v65, 3, v2
    v_lshl_add_u32 v72, v65, 3, v72
    v_add_u32 v72, 90112, v72
    s_and_b32 s24, s3, 1
    s_mul_i32 s24, s24, 320
    v_add_u32 v72, s24, v72
    v_lshlrev_b32 v73, 4, v1
    s_mul_i32 s24, s3, 18432
    s_add_u32 s24, s24, 16384
    v_add_u32 v73, s24, v73
    s_mul_i32 s45, s44, 245760
    s_add_u32 s46, s45, 0
    buffer_load_dwordx4 v[24:27], v4, s[16:19], s46 offen
    buffer_load_dwordx4 v[28:31], v5, s[16:19], s46 offen
    buffer_load_dwordx4 v[32:35], v6, s[16:19], s46 offen
    buffer_load_dwordx4 v[36:39], v7, s[16:19], s46 offen
    buffer_load_dwordx4 v[40:43], v8, s[16:19], s46 offen
    buffer_load_dwordx4 v[44:47], v9, s[16:19], s46 offen
    buffer_load_dwordx4 v[48:51], v10, s[16:19], s46 offen
    buffer_load_dwordx4 v[52:55], v11, s[16:19], s46 offen
    buffer_load_dwordx4 v[56:59], v12, s[16:19], s46 offen
    buffer_load_dwordx4 v[60:63], v13, s[16:19], s46 offen
    s_waitcnt vmcnt(0)
    ds_write_b128 v14, v[24:27]
    ds_write_b128 v15, v[28:31]
    ds_write_b128 v16, v[32:35]
    ds_write_b128 v17, v[36:39]
    ds_write_b128 v18, v[40:43]
    ds_write_b128 v19, v[44:47]
    ds_write_b128 v20, v[48:51]
    ds_write_b128 v21, v[52:55]
    ds_write_b128 v22, v[56:59]
    ds_write_b128 v23, v[60:63]
    s_waitcnt lgkmcnt(0)
    s_barrier
    s_lshr_b32 s24, s3, 1
    s_cmp_eq_u32 s24, 0
    s_cbranch_scc0 chain2_kernel_wo1
    ds_read_b64_tr_b16 a[240:241], v72 offset:0
    ds_read_b64_tr_b16 a[242:243], v72 offset:1312
    ds_read_b64_tr_b16 a[244:245], v72 offset:20992
    ds_read_b64_tr_b16 a[246:247], v72 offset:22304
    ds_read_b64_tr_b16 v[112:113], v72 offset:32
    ds_read_b64_tr_b16 v[114:115], v72 offset:1344
    ds_read_b64_tr_b16 v[116:117], v72 offset:21024
    ds_read_b64_tr_b16 v[118:119], v72 offset:22336
    ds_read_b64_tr_b16 v[136:137], v72 offset:64
    ds_read_b64_tr_b16 v[138:139], v72 offset:1376
    ds_read_b64_tr_b16 v[140:141], v72 offset:21056
    ds_read_b64_tr_b16 v[142:143], v72 offset:22368
    ds_read_b64_tr_b16 v[160:161], v72 offset:96
    ds_read_b64_tr_b16 v[162:163], v72 offset:1408
    ds_read_b64_tr_b16 v[164:165], v72 offset:21088
    ds_read_b64_tr_b16 v[166:167], v72 offset:22400
    ds_read_b64_tr_b16 v[184:185], v72 offset:128
    ds_read_b64_tr_b16 v[186:187], v72 offset:1440
    ds_read_b64_tr_b16 v[188:189], v72 offset:21120
    ds_read_b64_tr_b16 v[190:191], v72 offset:22432
    ds_read_b64_tr_b16 v[208:209], v72 offset:160
    ds_read_b64_tr_b16 v[210:211], v72 offset:1472
    ds_read_b64_tr_b16 v[212:213], v72 offset:21152
    ds_read_b64_tr_b16 v[214:215], v72 offset:22464
    ds_read_b64_tr_b16 v[232:233], v72 offset:192
    ds_read_b64_tr_b16 v[234:235], v72 offset:1504
    ds_read_b64_tr_b16 v[236:237], v72 offset:21184
    ds_read_b64_tr_b16 v[238:239], v72 offset:22496
    ds_read_b64_tr_b16 v[64:65], v72 offset:224
    ds_read_b64_tr_b16 v[66:67], v72 offset:1536
    ds_read_b64_tr_b16 v[68:69], v72 offset:21216
    ds_read_b64_tr_b16 v[70:71], v72 offset:22528
    s_waitcnt lgkmcnt(0)
    ds_write_b128 v73, v[64:67] offset:0
    ds_write_b128 v73, v[68:71] offset:1024
    s_waitcnt lgkmcnt(0)
    ds_read_b64_tr_b16 v[64:65], v72 offset:256
    ds_read_b64_tr_b16 v[66:67], v72 offset:1568
    ds_read_b64_tr_b16 v[68:69], v72 offset:21248
    ds_read_b64_tr_b16 v[70:71], v72 offset:22560
    s_waitcnt lgkmcnt(0)
    ds_write_b128 v73, v[64:67] offset:6144
    ds_write_b128 v73, v[68:71] offset:7168
    s_waitcnt lgkmcnt(0)
    ds_read_b64_tr_b16 v[64:65], v72 offset:288
    ds_read_b64_tr_b16 v[66:67], v72 offset:1600
    ds_read_b64_tr_b16 v[68:69], v72 offset:21280
    ds_read_b64_tr_b16 v[70:71], v72 offset:22592
    s_waitcnt lgkmcnt(0)
    ds_write_b128 v73, v[64:67] offset:12288
    ds_write_b128 v73, v[68:71] offset:13312
    s_waitcnt lgkmcnt(0)
    s_waitcnt lgkmcnt(0)
chain2_kernel_wo1:
    s_barrier
    s_add_u32 s46, s45, 640
    buffer_load_dwordx4 v[24:27], v4, s[16:19], s46 offen
    buffer_load_dwordx4 v[28:31], v5, s[16:19], s46 offen
    buffer_load_dwordx4 v[32:35], v6, s[16:19], s46 offen
    buffer_load_dwordx4 v[36:39], v7, s[16:19], s46 offen
    buffer_load_dwordx4 v[40:43], v8, s[16:19], s46 offen
    buffer_load_dwordx4 v[44:47], v9, s[16:19], s46 offen
    buffer_load_dwordx4 v[48:51], v10, s[16:19], s46 offen
    buffer_load_dwordx4 v[52:55], v11, s[16:19], s46 offen
    buffer_load_dwordx4 v[56:59], v12, s[16:19], s46 offen
    buffer_load_dwordx4 v[60:63], v13, s[16:19], s46 offen
    s_waitcnt vmcnt(0)
    ds_write_b128 v14, v[24:27]
    ds_write_b128 v15, v[28:31]
    ds_write_b128 v16, v[32:35]
    ds_write_b128 v17, v[36:39]
    ds_write_b128 v18, v[40:43]
    ds_write_b128 v19, v[44:47]
    ds_write_b128 v20, v[48:51]
    ds_write_b128 v21, v[52:55]
    ds_write_b128 v22, v[56:59]
    ds_write_b128 v23, v[60:63]
    s_waitcnt lgkmcnt(0)
    s_barrier
    s_lshr_b32 s24, s3, 1
    s_cmp_eq_u32 s24, 1
    s_cbranch_scc0 chain2_kernel_wo2
    ds_read_b64_tr_b16 a[240:241], v72 offset:0
    ds_read_b64_tr_b16 a[242:243], v72 offset:1312
    ds_read_b64_tr_b16 a[244:245], v72 offset:20992
    ds_read_b64_tr_b16 a[246:247], v72 offset:22304
    ds_read_b64_tr_b16 v[112:113], v72 offset:32
    ds_read_b64_tr_b16 v[114:115], v72 offset:1344
    ds_read_b64_tr_b16 v[116:117], v72 offset:21024
    ds_read_b64_tr_b16 v[118:119], v72 offset:22336
    ds_read_b64_tr_b16 v[136:137], v72 offset:64
    ds_read_b64_tr_b16 v[138:139], v72 offset:1376
    ds_read_b64_tr_b16 v[140:141], v72 offset:21056
    ds_read_b64_tr_b16 v[142:143], v72 offset:22368
    ds_read_b64_tr_b16 v[160:161], v72 offset:96
    ds_read_b64_tr_b16 v[162:163], v72 offset:1408
    ds_read_b64_tr_b16 v[164:165], v72 offset:21088
    ds_read_b64_tr_b16 v[166:167], v72 offset:22400
    ds_read_b64_tr_b16 v[184:185], v72 offset:128
    ds_read_b64_tr_b16 v[186:187], v72 offset:1440
    ds_read_b64_tr_b16 v[188:189], v72 offset:21120
    ds_read_b64_tr_b16 v[190:191], v72 offset:22432
    ds_read_b64_tr_b16 v[208:209], v72 offset:160
    ds_read_b64_tr_b16 v[210:211], v72 offset:1472
    ds_read_b64_tr_b16 v[212:213], v72 offset:21152
    ds_read_b64_tr_b16 v[214:215], v72 offset:22464
    ds_read_b64_tr_b16 v[232:233], v72 offset:192
    ds_read_b64_tr_b16 v[234:235], v72 offset:1504
    ds_read_b64_tr_b16 v[236:237], v72 offset:21184
    ds_read_b64_tr_b16 v[238:239], v72 offset:22496
    ds_read_b64_tr_b16 v[64:65], v72 offset:224
    ds_read_b64_tr_b16 v[66:67], v72 offset:1536
    ds_read_b64_tr_b16 v[68:69], v72 offset:21216
    ds_read_b64_tr_b16 v[70:71], v72 offset:22528
    s_waitcnt lgkmcnt(0)
    ds_write_b128 v73, v[64:67] offset:0
    ds_write_b128 v73, v[68:71] offset:1024
    s_waitcnt lgkmcnt(0)
    ds_read_b64_tr_b16 v[64:65], v72 offset:256
    ds_read_b64_tr_b16 v[66:67], v72 offset:1568
    ds_read_b64_tr_b16 v[68:69], v72 offset:21248
    ds_read_b64_tr_b16 v[70:71], v72 offset:22560
    s_waitcnt lgkmcnt(0)
    ds_write_b128 v73, v[64:67] offset:6144
    ds_write_b128 v73, v[68:71] offset:7168
    s_waitcnt lgkmcnt(0)
    ds_read_b64_tr_b16 v[64:65], v72 offset:288
    ds_read_b64_tr_b16 v[66:67], v72 offset:1600
    ds_read_b64_tr_b16 v[68:69], v72 offset:21280
    ds_read_b64_tr_b16 v[70:71], v72 offset:22592
    s_waitcnt lgkmcnt(0)
    ds_write_b128 v73, v[64:67] offset:12288
    ds_write_b128 v73, v[68:71] offset:13312
    s_waitcnt lgkmcnt(0)
    s_waitcnt lgkmcnt(0)
chain2_kernel_wo2:
    s_barrier
    s_add_u32 s46, s45, 81920
    buffer_load_dwordx4 v[24:27], v4, s[16:19], s46 offen
    buffer_load_dwordx4 v[28:31], v5, s[16:19], s46 offen
    buffer_load_dwordx4 v[32:35], v6, s[16:19], s46 offen
    buffer_load_dwordx4 v[36:39], v7, s[16:19], s46 offen
    buffer_load_dwordx4 v[40:43], v8, s[16:19], s46 offen
    buffer_load_dwordx4 v[44:47], v9, s[16:19], s46 offen
    buffer_load_dwordx4 v[48:51], v10, s[16:19], s46 offen
    buffer_load_dwordx4 v[52:55], v11, s[16:19], s46 offen
    buffer_load_dwordx4 v[56:59], v12, s[16:19], s46 offen
    buffer_load_dwordx4 v[60:63], v13, s[16:19], s46 offen
    s_waitcnt vmcnt(0)
    ds_write_b128 v14, v[24:27]
    ds_write_b128 v15, v[28:31]
    ds_write_b128 v16, v[32:35]
    ds_write_b128 v17, v[36:39]
    ds_write_b128 v18, v[40:43]
    ds_write_b128 v19, v[44:47]
    ds_write_b128 v20, v[48:51]
    ds_write_b128 v21, v[52:55]
    ds_write_b128 v22, v[56:59]
    ds_write_b128 v23, v[60:63]
    s_waitcnt lgkmcnt(0)
    s_barrier
    s_lshr_b32 s24, s3, 1
    s_cmp_eq_u32 s24, 0
    s_cbranch_scc0 chain2_kernel_wo3
    ds_read_b64_tr_b16 a[248:249], v72 offset:0
    ds_read_b64_tr_b16 a[250:251], v72 offset:1312
    ds_read_b64_tr_b16 a[252:253], v72 offset:20992
    ds_read_b64_tr_b16 a[254:255], v72 offset:22304
    ds_read_b64_tr_b16 v[120:121], v72 offset:32
    ds_read_b64_tr_b16 v[122:123], v72 offset:1344
    ds_read_b64_tr_b16 v[124:125], v72 offset:21024
    ds_read_b64_tr_b16 v[126:127], v72 offset:22336
    ds_read_b64_tr_b16 v[144:145], v72 offset:64
    ds_read_b64_tr_b16 v[146:147], v72 offset:1376
    ds_read_b64_tr_b16 v[148:149], v72 offset:21056
    ds_read_b64_tr_b16 v[150:151], v72 offset:22368
    ds_read_b64_tr_b16 v[168:169], v72 offset:96
    ds_read_b64_tr_b16 v[170:171], v72 offset:1408
    ds_read_b64_tr_b16 v[172:173], v72 offset:21088
    ds_read_b64_tr_b16 v[174:175], v72 offset:22400
    ds_read_b64_tr_b16 v[192:193], v72 offset:128
    ds_read_b64_tr_b16 v[194:195], v72 offset:1440
    ds_read_b64_tr_b16 v[196:197], v72 offset:21120
    ds_read_b64_tr_b16 v[198:199], v72 offset:22432
    ds_read_b64_tr_b16 v[216:217], v72 offset:160
    ds_read_b64_tr_b16 v[218:219], v72 offset:1472
    ds_read_b64_tr_b16 v[220:221], v72 offset:21152
    ds_read_b64_tr_b16 v[222:223], v72 offset:22464
    ds_read_b64_tr_b16 v[240:241], v72 offset:192
    ds_read_b64_tr_b16 v[242:243], v72 offset:1504
    ds_read_b64_tr_b16 v[244:245], v72 offset:21184
    ds_read_b64_tr_b16 v[246:247], v72 offset:22496
    ds_read_b64_tr_b16 v[64:65], v72 offset:224
    ds_read_b64_tr_b16 v[66:67], v72 offset:1536
    ds_read_b64_tr_b16 v[68:69], v72 offset:21216
    ds_read_b64_tr_b16 v[70:71], v72 offset:22528
    s_waitcnt lgkmcnt(0)
    ds_write_b128 v73, v[64:67] offset:2048
    ds_write_b128 v73, v[68:71] offset:3072
    s_waitcnt lgkmcnt(0)
    ds_read_b64_tr_b16 v[64:65], v72 offset:256
    ds_read_b64_tr_b16 v[66:67], v72 offset:1568
    ds_read_b64_tr_b16 v[68:69], v72 offset:21248
    ds_read_b64_tr_b16 v[70:71], v72 offset:22560
    s_waitcnt lgkmcnt(0)
    ds_write_b128 v73, v[64:67] offset:8192
    ds_write_b128 v73, v[68:71] offset:9216
    s_waitcnt lgkmcnt(0)
    ds_read_b64_tr_b16 v[64:65], v72 offset:288
    ds_read_b64_tr_b16 v[66:67], v72 offset:1600
    ds_read_b64_tr_b16 v[68:69], v72 offset:21280
    ds_read_b64_tr_b16 v[70:71], v72 offset:22592
    s_waitcnt lgkmcnt(0)
    ds_write_b128 v73, v[64:67] offset:14336
    ds_write_b128 v73, v[68:71] offset:15360
    s_waitcnt lgkmcnt(0)
    s_waitcnt lgkmcnt(0)
chain2_kernel_wo3:
    s_barrier
    s_add_u32 s46, s45, 82560
    buffer_load_dwordx4 v[24:27], v4, s[16:19], s46 offen
    buffer_load_dwordx4 v[28:31], v5, s[16:19], s46 offen
    buffer_load_dwordx4 v[32:35], v6, s[16:19], s46 offen
    buffer_load_dwordx4 v[36:39], v7, s[16:19], s46 offen
    buffer_load_dwordx4 v[40:43], v8, s[16:19], s46 offen
    buffer_load_dwordx4 v[44:47], v9, s[16:19], s46 offen
    buffer_load_dwordx4 v[48:51], v10, s[16:19], s46 offen
    buffer_load_dwordx4 v[52:55], v11, s[16:19], s46 offen
    buffer_load_dwordx4 v[56:59], v12, s[16:19], s46 offen
    buffer_load_dwordx4 v[60:63], v13, s[16:19], s46 offen
    s_waitcnt vmcnt(0)
    ds_write_b128 v14, v[24:27]
    ds_write_b128 v15, v[28:31]
    ds_write_b128 v16, v[32:35]
    ds_write_b128 v17, v[36:39]
    ds_write_b128 v18, v[40:43]
    ds_write_b128 v19, v[44:47]
    ds_write_b128 v20, v[48:51]
    ds_write_b128 v21, v[52:55]
    ds_write_b128 v22, v[56:59]
    ds_write_b128 v23, v[60:63]
    s_waitcnt lgkmcnt(0)
    s_barrier
    s_lshr_b32 s24, s3, 1
    s_cmp_eq_u32 s24, 1
    s_cbranch_scc0 chain2_kernel_wo4
    ds_read_b64_tr_b16 a[248:249], v72 offset:0
    ds_read_b64_tr_b16 a[250:251], v72 offset:1312
    ds_read_b64_tr_b16 a[252:253], v72 offset:20992
    ds_read_b64_tr_b16 a[254:255], v72 offset:22304
    ds_read_b64_tr_b16 v[120:121], v72 offset:32
    ds_read_b64_tr_b16 v[122:123], v72 offset:1344
    ds_read_b64_tr_b16 v[124:125], v72 offset:21024
    ds_read_b64_tr_b16 v[126:127], v72 offset:22336
    ds_read_b64_tr_b16 v[144:145], v72 offset:64
    ds_read_b64_tr_b16 v[146:147], v72 offset:1376
    ds_read_b64_tr_b16 v[148:149], v72 offset:21056
    ds_read_b64_tr_b16 v[150:151], v72 offset:22368
    ds_read_b64_tr_b16 v[168:169], v72 offset:96
    ds_read_b64_tr_b16 v[170:171], v72 offset:1408
    ds_read_b64_tr_b16 v[172:173], v72 offset:21088
    ds_read_b64_tr_b16 v[174:175], v72 offset:22400
    ds_read_b64_tr_b16 v[192:193], v72 offset:128
    ds_read_b64_tr_b16 v[194:195], v72 offset:1440
    ds_read_b64_tr_b16 v[196:197], v72 offset:21120
    ds_read_b64_tr_b16 v[198:199], v72 offset:22432
    ds_read_b64_tr_b16 v[216:217], v72 offset:160
    ds_read_b64_tr_b16 v[218:219], v72 offset:1472
    ds_read_b64_tr_b16 v[220:221], v72 offset:21152
    ds_read_b64_tr_b16 v[222:223], v72 offset:22464
    ds_read_b64_tr_b16 v[240:241], v72 offset:192
    ds_read_b64_tr_b16 v[242:243], v72 offset:1504
    ds_read_b64_tr_b16 v[244:245], v72 offset:21184
    ds_read_b64_tr_b16 v[246:247], v72 offset:22496
    ds_read_b64_tr_b16 v[64:65], v72 offset:224
    ds_read_b64_tr_b16 v[66:67], v72 offset:1536
    ds_read_b64_tr_b16 v[68:69], v72 offset:21216
    ds_read_b64_tr_b16 v[70:71], v72 offset:22528
    s_waitcnt lgkmcnt(0)
    ds_write_b128 v73, v[64:67] offset:2048
    ds_write_b128 v73, v[68:71] offset:3072
    s_waitcnt lgkmcnt(0)
    ds_read_b64_tr_b16 v[64:65], v72 offset:256
    ds_read_b64_tr_b16 v[66:67], v72 offset:1568
    ds_read_b64_tr_b16 v[68:69], v72 offset:21248
    ds_read_b64_tr_b16 v[70:71], v72 offset:22560
    s_waitcnt lgkmcnt(0)
    ds_write_b128 v73, v[64:67] offset:8192
    ds_write_b128 v73, v[68:71] offset:9216
    s_waitcnt lgkmcnt(0)
    ds_read_b64_tr_b16 v[64:65], v72 offset:288
    ds_read_b64_tr_b16 v[66:67], v72 offset:1600
    ds_read_b64_tr_b16 v[68:69], v72 offset:21280
    ds_read_b64_tr_b16 v[70:71], v72 offset:22592
    s_waitcnt lgkmcnt(0)
    ds_write_b128 v73, v[64:67] offset:14336
    ds_write_b128 v73, v[68:71] offset:15360
    s_waitcnt lgkmcnt(0)
    s_waitcnt lgkmcnt(0)
chain2_kernel_wo4:
    s_barrier
    s_add_u32 s46, s45, 163840
    buffer_load_dwordx4 v[24:27], v4, s[16:19], s46 offen
    buffer_load_dwordx4 v[28:31], v5, s[16:19], s46 offen
    buffer_load_dwordx4 v[32:35], v6, s[16:19], s46 offen
    buffer_load_dwordx4 v[36:39], v7, s[16:19], s46 offen
    buffer_load_dwordx4 v[40:43], v8, s[16:19], s46 offen
    buffer_load_dwordx4 v[44:47], v9, s[16:19], s46 offen
    buffer_load_dwordx4 v[48:51], v10, s[16:19], s46 offen
    buffer_load_dwordx4 v[52:55], v11, s[16:19], s46 offen
    buffer_load_dwordx4 v[56:59], v12, s[16:19], s46 offen
    buffer_load_dwordx4 v[60:63], v13, s[16:19], s46 offen
    s_waitcnt vmcnt(0)
    ds_write_b128 v14, v[24:27]
    ds_write_b128 v15, v[28:31]
    ds_write_b128 v16, v[32:35]
    ds_write_b128 v17, v[36:39]
    ds_write_b128 v18, v[40:43]
    ds_write_b128 v19, v[44:47]
    ds_write_b128 v20, v[48:51]
    ds_write_b128 v21, v[52:55]
    ds_write_b128 v22, v[56:59]
    ds_write_b128 v23, v[60:63]
    s_waitcnt lgkmcnt(0)
    s_barrier
    s_lshr_b32 s24, s3, 1
    s_cmp_eq_u32 s24, 0
    s_cbranch_scc0 chain2_kernel_wo5
    ds_read_b64_tr_b16 v[104:105], v72 offset:0
    ds_read_b64_tr_b16 v[106:107], v72 offset:1312
    ds_read_b64_tr_b16 v[108:109], v72 offset:20992
    ds_read_b64_tr_b16 v[110:111], v72 offset:22304
    ds_read_b64_tr_b16 v[128:129], v72 offset:32
    ds_read_b64_tr_b16 v[130:131], v72 offset:1344
    ds_read_b64_tr_b16 v[132:133], v72 offset:21024
    ds_read_b64_tr_b16 v[134:135], v72 offset:22336
    ds_read_b64_tr_b16 v[152:153], v72 offset:64
    ds_read_b64_tr_b16 v[154:155], v72 offset:1376
    ds_read_b64_tr_b16 v[156:157], v72 offset:21056
    ds_read_b64_tr_b16 v[158:159], v72 offset:22368
    ds_read_b64_tr_b16 v[176:177], v72 offset:96
    ds_read_b64_tr_b16 v[178:179], v72 offset:1408
    ds_read_b64_tr_b16 v[180:181], v72 offset:21088
    ds_read_b64_tr_b16 v[182:183], v72 offset:22400
    ds_read_b64_tr_b16 v[200:201], v72 offset:128
    ds_read_b64_tr_b16 v[202:203], v72 offset:1440
    ds_read_b64_tr_b16 v[204:205], v72 offset:21120
    ds_read_b64_tr_b16 v[206:207], v72 offset:22432
    ds_read_b64_tr_b16 v[224:225], v72 offset:160
    ds_read_b64_tr_b16 v[226:227], v72 offset:1472
    ds_read_b64_tr_b16 v[228:229], v72 offset:21152
    ds_read_b64_tr_b16 v[230:231], v72 offset:22464
    ds_read_b64_tr_b16 v[248:249], v72 offset:192
    ds_read_b64_tr_b16 v[250:251], v72 offset:1504
    ds_read_b64_tr_b16 v[252:253], v72 offset:21184
    ds_read_b64_tr_b16 v[254:255], v72 offset:22496
    ds_read_b64_tr_b16 v[64:65], v72 offset:224
    ds_read_b64_tr_b16 v[66:67], v72 offset:1536
    ds_read_b64_tr_b16 v[68:69], v72 offset:21216
    ds_read_b64_tr_b16 v[70:71], v72 offset:22528
    s_waitcnt lgkmcnt(0)
    ds_write_b128 v73, v[64:67] offset:4096
    ds_write_b128 v73, v[68:71] offset:5120
    s_waitcnt lgkmcnt(0)
    ds_read_b64_tr_b16 v[64:65], v72 offset:256
    ds_read_b64_tr_b16 v[66:67], v72 offset:1568
    ds_read_b64_tr_b16 v[68:69], v72 offset:21248
    ds_read_b64_tr_b16 v[70:71], v72 offset:22560
    s_waitcnt lgkmcnt(0)
    ds_write_b128 v73, v[64:67] offset:10240
    ds_write_b128 v73, v[68:71] offset:11264
    s_waitcnt lgkmcnt(0)
    ds_read_b64_tr_b16 v[64:65], v72 offset:288
    ds_read_b64_tr_b16 v[66:67], v72 offset:1600
    ds_read_b64_tr_b16 v[68:69], v72 offset:21280
    ds_read_b64_tr_b16 v[70:71], v72 offset:22592
    s_waitcnt lgkmcnt(0)
    ds_write_b128 v73, v[64:67] offset:16384
    ds_write_b128 v73, v[68:71] offset:17408
    s_waitcnt lgkmcnt(0)
    s_waitcnt lgkmcnt(0)
chain2_kernel_wo5:
    s_barrier
    s_add_u32 s46, s45, 164480
    buffer_load_dwordx4 v[24:27], v4, s[16:19], s46 offen
    buffer_load_dwordx4 v[28:31], v5, s[16:19], s46 offen
    buffer_load_dwordx4 v[32:35], v6, s[16:19], s46 offen
    buffer_load_dwordx4 v[36:39], v7, s[16:19], s46 offen
    buffer_load_dwordx4 v[40:43], v8, s[16:19], s46 offen
    buffer_load_dwordx4 v[44:47], v9, s[16:19], s46 offen
    buffer_load_dwordx4 v[48:51], v10, s[16:19], s46 offen
    buffer_load_dwordx4 v[52:55], v11, s[16:19], s46 offen
    buffer_load_dwordx4 v[56:59], v12, s[16:19], s46 offen
    buffer_load_dwordx4 v[60:63], v13, s[16:19], s46 offen
    s_waitcnt vmcnt(0)
    ds_write_b128 v14, v[24:27]
    ds_write_b128 v15, v[28:31]
    ds_write_b128 v16, v[32:35]
    ds_write_b128 v17, v[36:39]
    ds_write_b128 v18, v[40:43]
    ds_write_b128 v19, v[44:47]
    ds_write_b128 v20, v[48:51]
    ds_write_b128 v21, v[52:55]
    ds_write_b128 v22, v[56:59]
    ds_write_b128 v23, v[60:63]
    s_waitcnt lgkmcnt(0)
    s_barrier
    s_lshr_b32 s24, s3, 1
    s_cmp_eq_u32 s24, 1
    s_cbranch_scc0 chain2_kernel_wo6
    ds_read_b64_tr_b16 v[104:105], v72 offset:0
    ds_read_b64_tr_b16 v[106:107], v72 offset:1312
    ds_read_b64_tr_b16 v[108:109], v72 offset:20992
    ds_read_b64_tr_b16 v[110:111], v72 offset:22304
    ds_read_b64_tr_b16 v[128:129], v72 offset:32
    ds_read_b64_tr_b16 v[130:131], v72 offset:1344
    ds_read_b64_tr_b16 v[132:133], v72 offset:21024
    ds_read_b64_tr_b16 v[134:135], v72 offset:22336
    ds_read_b64_tr_b16 v[152:153], v72 offset:64
    ds_read_b64_tr_b16 v[154:155], v72 offset:1376
    ds_read_b64_tr_b16 v[156:157], v72 offset:21056
    ds_read_b64_tr_b16 v[158:159], v72 offset:22368
    ds_read_b64_tr_b16 v[176:177], v72 offset:96
    ds_read_b64_tr_b16 v[178:179], v72 offset:1408
    ds_read_b64_tr_b16 v[180:181], v72 offset:21088
    ds_read_b64_tr_b16 v[182:183], v72 offset:22400
    ds_read_b64_tr_b16 v[200:201], v72 offset:128
    ds_read_b64_tr_b16 v[202:203], v72 offset:1440
    ds_read_b64_tr_b16 v[204:205], v72 offset:21120
    ds_read_b64_tr_b16 v[206:207], v72 offset:22432
    ds_read_b64_tr_b16 v[224:225], v72 offset:160
    ds_read_b64_tr_b16 v[226:227], v72 offset:1472
    ds_read_b64_tr_b16 v[228:229], v72 offset:21152
    ds_read_b64_tr_b16 v[230:231], v72 offset:22464
    ds_read_b64_tr_b16 v[248:249], v72 offset:192
    ds_read_b64_tr_b16 v[250:251], v72 offset:1504
    ds_read_b64_tr_b16 v[252:253], v72 offset:21184
    ds_read_b64_tr_b16 v[254:255], v72 offset:22496
    ds_read_b64_tr_b16 v[64:65], v72 offset:224
    ds_read_b64_tr_b16 v[66:67], v72 offset:1536
    ds_read_b64_tr_b16 v[68:69], v72 offset:21216
    ds_read_b64_tr_b16 v[70:71], v72 offset:22528
    s_waitcnt lgkmcnt(0)
    ds_write_b128 v73, v[64:67] offset:4096
    ds_write_b128 v73, v[68:71] offset:5120
    s_waitcnt lgkmcnt(0)
    ds_read_b64_tr_b16 v[64:65], v72 offset:256
    ds_read_b64_tr_b16 v[66:67], v72 offset:1568
    ds_read_b64_tr_b16 v[68:69], v72 offset:21248
    ds_read_b64_tr_b16 v[70:71], v72 offset:22560
    s_waitcnt lgkmcnt(0)
    ds_write_b128 v73, v[64:67] offset:10240
    ds_write_b128 v73, v[68:71] offset:11264
    s_waitcnt lgkmcnt(0)
    ds_read_b64_tr_b16 v[64:65], v72 offset:288
    ds_read_b64_tr_b16 v[66:67], v72 offset:1600
    ds_read_b64_tr_b16 v[68:69], v72 offset:21280
    ds_read_b64_tr_b16 v[70:71], v72 offset:22592
    s_waitcnt lgkmcnt(0)
    ds_write_b128 v73, v[64:67] offset:16384
    ds_write_b128 v73, v[68:71] offset:17408
    s_waitcnt lgkmcnt(0)
    s_waitcnt lgkmcnt(0)
chain2_kernel_wo6:
    s_barrier
    v_mov_b32 v6, v73
    v_mov_b32 v4, 0x4444
    v_mov_b32 v5, 0xeeee
    v_cmp_gt_u32 vcc, 8, v2
    s_nop 1
    v_cndmask_b32 v4, v5, v4, vcc
    v_lshlrev_b32 v5, 4, v1
    s_lshl_b32 s24, s3, 10
    v_add_u32 v7, s24, v5
    s_lshl_b32 s24, s3, 9
    s_add_u32 s24, s24, 8192
    v_lshlrev_b32 v8, 3, v1
    v_add_u32 v8, s24, v8
    v_and_b32 v64, 7, v2
    v_lshlrev_b32 v9, 5, v64
    v_lshrrev_b32 v64, 3, v2
    v_lshl_add_u32 v9, v64, 4, v9
    v_and_b32 v64, 1, v3
    v_lshl_add_u32 v9, v64, 3, v9
    s_mul_i32 s24, s3, 768
    s_add_u32 s24, s24, 10240
    v_add_u32 v9, s24, v9
    v_lshrrev_b32 v65, 1, v3
    v_lshl_add_u32 v10, v65, 8, v9
    v_lshrrev_b32 v64, 2, v2
    v_lshlrev_b32 v11, 5, v64
    v_and_b32 v64, 3, v2
    v_lshl_add_u32 v11, v64, 3, v11
    v_lshl_add_u32 v11, v3, 8, v11
    v_add_u32 v11, 10240, v11
    s_mul_i32 s24, s3, 10
    s_lshl_b32 s24, s24, 13
    s_lshl_b32 s25, s44, 8
    s_add_u32 s24, s24, s25
    v_lshlrev_b32 v14, 13, v3
    v_lshl_add_u32 v14, v2, 4, v14
    v_add_u32 v14, s24, v14
    v_lshrrev_b32 v64, 1, v3
    v_lshlrev_b32 v15, 13, v64
    v_lshl_add_u32 v15, v2, 4, v15
    v_add_u32 v15, s24, v15
    v_add_u32 v15, 65536, v15
    v_and_b32 v64, 1, v3
    v_cmp_eq_u32 vcc, 0, v64
    v_mov_b32 v64, 2146435072
    s_nop 0
    v_cndmask_b32 v15, v64, v15, vcc
    s_and_b32 s24, s2, 15
    s_mul_i32 s25, s3, 16
    s_add_u32 s24, s24, s25
    s_lshl_b32 s24, s24, 7
    v_mov_b32 v12, s24
    s_lshr_b32 s25, s44, 3
    s_mul_i32 s24, s25, 8
    v_add_u32 v13, s24, v1
    v_lshlrev_b32 v13, 7, v13
    v_mov_b32 v64, 2146435072
    v_cmp_le_u32 vcc, 8, v1
    s_nop 1
    v_cndmask_b32 v13, v13, v64, vcc
    s_cmp_eq_u32 s3, 0
    s_cselect_b32 s24, 0, 2146435072
    v_or_b32 v13, s24, v13
    s_mov_b32 s45, 151576576
    s_mov_b32 s42, 154238976
    v_add_u32 v64, 0, v0
    v_and_b32 v65, 7, v64
    v_mul_u32_u24 v65, 1280, v65
    v_lshrrev_b32 v66, 3, v64
    v_lshl_add_u32 v65, v66, 4, v65
    v_cmp_gt_u32 vcc, 640, v64
    v_mov_b32 v67, 2146435072
    s_nop 0
    v_cndmask_b32 v65, v67, v65, vcc
    buffer_load_dwordx4 v[68:71], v65, s[20:23], 0 offen
    v_lshlrev_b32 v64, 4, v64
    s_waitcnt vmcnt(0)
    s_and_saveexec_b64 s[30:31], vcc
    ds_write_b128 v64, v[68:71]
    s_mov_b64 exec, s[30:31]
    v_add_u32 v64, 256, v0
    v_and_b32 v65, 7, v64
    v_mul_u32_u24 v65, 1280, v65
    v_lshrrev_b32 v66, 3, v64
    v_lshl_add_u32 v65, v66, 4, v65
    v_cmp_gt_u32 vcc, 640, v64
    v_mov_b32 v67, 2146435072
    s_nop 0
    v_cndmask_b32 v65, v67, v65, vcc
    buffer_load_dwordx4 v[68:71], v65, s[20:23], 0 offen
    v_lshlrev_b32 v64, 4, v64
    s_waitcnt vmcnt(0)
    s_and_saveexec_b64 s[30:31], vcc
    ds_write_b128 v64, v[68:71]
    s_mov_b64 exec, s[30:31]
    v_add_u32 v64, 512, v0
    v_and_b32 v65, 7, v64
    v_mul_u32_u24 v65, 1280, v65
    v_lshrrev_b32 v66, 3, v64
    v_lshl_add_u32 v65, v66, 4, v65
    v_cmp_gt_u32 vcc, 640, v64
    v_mov_b32 v67, 2146435072
    s_nop 0
    v_cndmask_b32 v65, v67, v65, vcc
    buffer_load_dwordx4 v[68:71], v65, s[20:23], 0 offen
    v_lshlrev_b32 v64, 4, v64
    s_waitcnt vmcnt(0)
    s_and_saveexec_b64 s[30:31], vcc
    ds_write_b128 v64, v[68:71]
    s_mov_b64 exec, s[30:31]
    v_mov_b32 v0, 1
    s_mov_b32 s40, 0
    s_mov_b32 s43, 117440512
    s_mov_b32 s54, 20
    s_mov_b32 s47, 138412032
    s_waitcnt lgkmcnt(0)
    s_branch chain2_kernel_v_go2
chain2_kernel_v_step:
    s_add_u32 s48, s47, 4096
    s_sleep 20
    s_mov_b64 exec, 1
    s_mov_b32 s61, 0
    v_mov_b32 v81, 0
    buffer_atomic_add v81, v12, s[8:11], s45 offen sc0
    s_sleep 2
    v_mov_b32 v82, 0
    buffer_atomic_add v82, v12, s[8:11], s45 offen sc0
    s_sleep 2
    v_mov_b32 v83, 0
    buffer_atomic_add v83, v12, s[8:11], s45 offen sc0
    s_sleep 2
chain2_kernel_v_pr:
    v_mov_b32 v80, 0
    buffer_atomic_add v80, v12, s[8:11], s45 offen sc0
    s_waitcnt vmcnt(3)
    v_cmp_le_i32 vcc, 9, v81
    s_add_u32 s61, s61, 1
    s_cbranch_vccnz chain2_kernel_v_pr_out
    s_sleep 2
    v_mov_b32 v81, 0
    buffer_atomic_add v81, v12, s[8:11], s45 offen sc0
    s_waitcnt vmcnt(3)
    v_cmp_le_i32 vcc, 9, v82
    s_add_u32 s61, s61, 1
    s_cbranch_vccnz chain2_kernel_v_pr_out
    s_sleep 2
    v_mov_b32 v82, 0
    buffer_atomic_add v82, v12, s[8:11], s45 offen sc0
    s_waitcnt vmcnt(3)
    v_cmp_le_i32 vcc, 9, v83
    s_add_u32 s61, s61, 1
    s_cbranch_vccnz chain2_kernel_v_pr_out
    s_sleep 2
    v_mov_b32 v83, 0
    buffer_atomic_add v83, v12, s[8:11], s45 offen sc0
    s_waitcnt vmcnt(3)
    v_cmp_le_i32 vcc, 9, v80
    s_add_u32 s61, s61, 1
    s_cbranch_vccnz chain2_kernel_v_pr_out
    s_sleep 2
    s_cmp_ge_u32 s61, s60
    s_cbranch_scc0 chain2_kernel_v_pr
    s_mov_b32 s60, 1
chain2_kernel_v_pr_out:
    s_mov_b64 exec, -1
    buffer_load_dwordx4 v[68:71], v7, s[8:11], s47 offen sc1
    buffer_load_dwordx4 v[72:75], v7, s[8:11], s48 offen sc1
    buffer_load_dwordx2 v[76:77], v8, s[8:11], s47 offen sc1
    s_waitcnt vmcnt(0)
    v_max3_u32 v26, v68, v69, v70
    v_max3_u32 v26, v26, v71, v72
    v_max3_u32 v26, v26, v73, v74
    v_max3_u32 v26, v26, v75, v76
    v_max_u32 v26, v26, v77
    v_cmp_eq_u32 vcc, -1, v26
    s_cbranch_vccz chain2_kernel_v_pm_out
    s_mov_b32 s61, 0
chain2_kernel_v_pm:
    buffer_load_dwordx4 v[68:71], v7, s[8:11], s47 offen sc1
    buffer_load_dwordx4 v[72:75], v7, s[8:11], s48 offen sc1
    buffer_load_dwordx2 v[76:77], v8, s[8:11], s47 offen sc1
    s_waitcnt vmcnt(0)
    v_max3_u32 v26, v68, v69, v70
    v_max3_u32 v26, v26, v71, v72
    v_max3_u32 v26, v26, v73, v74
    v_max3_u32 v26, v26, v75, v76
    v_max_u32 v26, v26, v77
    v_cmp_eq_u32 vcc, -1, v26
    s_add_u32 s61, s61, 1
    s_cbranch_vccz chain2_kernel_v_pm_out
    s_cmp_ge_u32 s61, s60
    s_cbranch_scc1 chain2_kernel_v_pm_to
    s_sleep 1
    s_branch chain2_kernel_v_pm
chain2_kernel_v_pm_to:
    s_mov_b32 s60, 1
chain2_kernel_v_pm_out:
    ds_write_b128 v7, v[68:71]
    ds_write_b128 v7, v[72:75] offset:4096
    ds_write_b64 v8, v[76:77]
    s_waitcnt lgkmcnt(0)
chain2_kernel_v_go2:
    s_barrier
    ds_read_b128 v[16:19], v5 offset:0
    ds_read_b128 v[20:23], v5 offset:1024
    ds_read_b128 v[24:27], v5 offset:2048
    ds_read_b128 v[28:31], v5 offset:3072
    ds_read_b128 v[32:35], v5 offset:4096
    ds_read_b128 v[36:39], v5 offset:5120
    ds_read_b128 v[40:43], v5 offset:6144
    ds_read_b128 v[44:47], v5 offset:7168
    ds_read_b128 v[48:51], v5 offset:8192
    ds_read_b128 v[52:55], v5 offset:9216
    v_mov_b32 v56, 0
    v_mov_b32 v57, 0
    v_mov_b32 v58, 0
    v_mov_b32 v59, 0
    v_mov_b32 v60, 0
    v_mov_b32 v61, 0
    v_mov_b32 v62, 0
    v_mov_b32 v63, 0
    v_mov_b32 v64, 0
    v_mov_b32 v65, 0
    v_mov_b32 v66, 0
    v_mov_b32 v67, 0
    s_waitcnt lgkmcnt(9)
    v_smfmac_f32_16x16x64_bf16 v[56:59], v[16:19], a[0:7], v4
    v_smfmac_f32_16x16x64_bf16 v[60:63], v[16:19], a[80:87], v4
    v_smfmac_f32_16x16x64_bf16 v[64:67], v[16:19], a[160:167], v4
    s_waitcnt lgkmcnt(8)
    v_smfmac_f32_16x16x64_bf16 v[56:59], v[20:23], a[8:15], v4
    v_smfmac_f32_16x16x64_bf16 v[60:63], v[20:23], a[88:95], v4
    v_smfmac_f32_16x16x64_bf16 v[64:67], v[20:23], a[168:175], v4
    s_waitcnt lgkmcnt(7)
    v_smfmac_f32_16x16x64_bf16 v[56:59], v[24:27], a[16:23], v4
    v_smfmac_f32_16x16x64_bf16 v[60:63], v[24:27], a[96:103], v4
    v_smfmac_f32_16x16x64_bf16 v[64:67], v[24:27], a[176:183], v4
    s_waitcnt lgkmcnt(6)
    v_smfmac_f32_16x16x64_bf16 v[56:59], v[28:31], a[24:31], v4
    v_smfmac_f32_16x16x64_bf16 v[60:63], v[28:31], a[104:111], v4
    v_smfmac_f32_16x16x64_bf16 v[64:67], v[28:31], a[184:191], v4
    s_waitcnt lgkmcnt(5)
    v_smfmac_f32_16x16x64_bf16 v[56:59], v[32:35], a[32:39], v4
    v_smfmac_f32_16x16x64_bf16 v[60:63], v[32:35], a[112:119], v4
    v_smfmac_f32_16x16x64_bf16 v[64:67], v[32:35], a[192:199], v4
    s_waitcnt lgkmcnt(4)
    v_smfmac_f32_16x16x64_bf16 v[56:59], v[36:39], a[40:47], v4
    v_smfmac_f32_16x16x64_bf16 v[60:63], v[36:39], a[120:127], v4
    v_smfmac_f32_16x16x64_bf16 v[64:67], v[36:39], a[200:207], v4
    s_waitcnt lgkmcnt(3)
    v_smfmac_f32_16x16x64_bf16 v[56:59], v[40:43], a[48:55], v4
    v_smfmac_f32_16x16x64_bf16 v[60:63], v[40:43], a[128:135], v4
    v_smfmac_f32_16x16x64_bf16 v[64:67], v[40:43], a[208:215], v4
    s_waitcnt lgkmcnt(2)
    v_smfmac_f32_16x16x64_bf16 v[56:59], v[44:47], a[56:63], v4
    v_smfmac_f32_16x16x64_bf16 v[60:63], v[44:47], a[136:143], v4
    v_smfmac_f32_16x16x64_bf16 v[64:67], v[44:47], a[216:223], v4
    s_waitcnt lgkmcnt(1)
    v_smfmac_f32_16x16x64_bf16 v[56:59], v[48:51], a[64:71], v4
    v_smfmac_f32_16x16x64_bf16 v[60:63], v[48:51], a[144:151], v4
    v_smfmac_f32_16x16x64_bf16 v[64:67], v[48:51], a[224:231], v4
    s_waitcnt lgkmcnt(0)
    v_smfmac_f32_16x16x64_bf16 v[56:59], v[52:55], a[72:79], v4
    v_smfmac_f32_16x16x64_bf16 v[60:63], v[52:55], a[152:159], v4
    v_smfmac_f32_16x16x64_bf16 v[64:67], v[52:55], a[232:239], v4
    ds_read_b128 v[80:83], v6 offset:0
    ds_read_b128 v[84:87], v6 offset:1024
    ds_read_b128 v[88:91], v6 offset:2048
    ds_read_b128 v[92:95], v6 offset:3072
    ds_read_b128 v[96:99], v6 offset:4096
    ds_read_b128 v[100:103], v6 offset:5120
    s_waitcnt vmcnt(0)
    v_mov_b32 v16, 0
    v_mov_b32 v17, 0
    v_mov_b32 v18, 0
    v_mov_b32 v19, 0
    v_mov_b32 v20, 0
    v_mov_b32 v21, 0
    v_mov_b32 v22, 0
    v_mov_b32 v23, 0
    v_mov_b32 v24, 0
    v_mov_b32 v25, 0
    v_mov_b32 v26, 0
    v_mov_b32 v27, 0
    v_mov_b32 v28, 0
    v_mov_b32 v29, 0
    v_mov_b32 v30, 0
    v_mov_b32 v31, 0
    v_mov_b32 v32, 0
    v_mov_b32 v33, 0
    v_mov_b32 v34, 0
    v_mov_b32 v35, 0
    v_mov_b32 v36, 0
    v_mov_b32 v37, 0
    v_mov_b32 v38, 0
    v_mov_b32 v39, 0
    v_mov_b32 v40, 0
    v_mov_b32 v41, 0
    v_mov_b32 v42, 0
    v_mov_b32 v43, 0
    v_mov_b32 v44, 0
    v_mov_b32 v45, 0
    v_mov_b32 v46, 0
    v_mov_b32 v47, 0
    v_mov_b32 v48, 0
    v_mov_b32 v49, 0
    v_mov_b32 v50, 0
    v_mov_b32 v51, 0
    v_mov_b32 v52, 0
    v_mov_b32 v53, 0
    v_mov_b32 v54, 0
    v_mov_b32 v55, 0
    v_permlane32_swap_b32 v56, v60
    v_permlane32_swap_b32 v57, v61
    v_permlane32_swap_b32 v58, v62
    v_permlane32_swap_b32 v59, v63
    v_add_f32 v56, v56, v60
    v_add_f32 v57, v57, v61
    v_add_f32 v58, v58, v62
    v_add_f32 v59, v59, v63
    v_cvt_pk_bf16_f32 v68, v56, v57
    v_cvt_pk_bf16_f32 v69, v58, v59
    v_mov_b32 v60, v64
    v_mov_b32 v61, v65
    v_mov_b32 v62, v66
    v_mov_b32 v63, v67
    v_permlane32_swap_b32 v64, v60
    v_permlane32_swap_b32 v65, v61
    v_permlane32_swap_b32 v66, v62
    v_permlane32_swap_b32 v67, v63
    v_add_f32 v64, v64, v60
    v_add_f32 v65, v65, v61
    v_add_f32 v66, v66, v62
    v_add_f32 v67, v67, v63
    v_cvt_pk_bf16_f32 v70, v64, v65
    v_cvt_pk_bf16_f32 v71, v66, v67
    ds_write_b64 v10, v[68:69]
    ds_write_b64 v9, v[70:71] offset:512
    s_waitcnt lgkmcnt(0)
    s_barrier
    ds_read_b64_tr_b16 v[68:69], v11 offset:0
    ds_read_b64_tr_b16 v[70:71], v11 offset:128
    ds_read_b64_tr_b16 v[72:73], v11 offset:1024
    ds_read_b64_tr_b16 v[74:75], v11 offset:1152
    ds_read_b64_tr_b16 v[76:77], v11 offset:2048
    ds_read_b64_tr_b16 v[78:79], v11 offset:2176
    s_waitcnt lgkmcnt(4)
    v_smfmac_f32_16x16x64_bf16 v[16:19], v[68:71], a[240:247], v4
    v_smfmac_f32_16x16x64_bf16 v[20:23], v[68:71], v[112:119], v4
    v_smfmac_f32_16x16x64_bf16 v[24:27], v[68:71], v[136:143], v4
    v_smfmac_f32_16x16x64_bf16 v[28:31], v[68:71], v[160:167], v4
    s_waitcnt lgkmcnt(2)
    v_smfmac_f32_16x16x64_bf16 v[16:19], v[72:75], a[248:255], v4
    v_smfmac_f32_16x16x64_bf16 v[20:23], v[72:75], v[120:127], v4
    v_smfmac_f32_16x16x64_bf16 v[24:27], v[72:75], v[144:151], v4
    v_smfmac_f32_16x16x64_bf16 v[28:31], v[72:75], v[168:175], v4
    s_waitcnt lgkmcnt(0)
    v_smfmac_f32_16x16x64_bf16 v[16:19], v[76:79], v[104:111], v4
    v_smfmac_f32_16x16x64_bf16 v[20:23], v[76:79], v[128:135], v4
    v_smfmac_f32_16x16x64_bf16 v[24:27], v[76:79], v[152:159], v4
    v_smfmac_f32_16x16x64_bf16 v[28:31], v[76:79], v[176:183], v4
    v_smfmac_f32_16x16x64_bf16 v[32:35], v[68:71], v[184:191], v4
    v_smfmac_f32_16x16x64_bf16 v[36:39], v[68:71], v[208:215], v4
    v_smfmac_f32_16x16x64_bf16 v[40:43], v[68:71], v[232:239], v4
    v_smfmac_f32_16x16x64_bf16 v[44:47], v[68:71], v[80:87], v4
    ds_read_b128 v[80:83], v6 offset:6144
    ds_read_b128 v[84:87], v6 offset:7168
    v_smfmac_f32_16x16x64_bf16 v[32:35], v[72:75], v[192:199], v4
    v_smfmac_f32_16x16x64_bf16 v[36:39], v[72:75], v[216:223], v4
    v_smfmac_f32_16x16x64_bf16 v[40:43], v[72:75], v[240:247], v4
    v_smfmac_f32_16x16x64_bf16 v[44:47], v[72:75], v[88:95], v4
    ds_read_b128 v[88:91], v6 offset:8192
    ds_read_b128 v[92:95], v6 offset:9216
    v_smfmac_f32_16x16x64_bf16 v[32:35], v[76:79], v[200:207], v4
    v_smfmac_f32_16x16x64_bf16 v[36:39], v[76:79], v[224:231], v4
    v_smfmac_f32_16x16x64_bf16 v[40:43], v[76:79], v[248:255], v4
    v_smfmac_f32_16x16x64_bf16 v[44:47], v[76:79], v[96:103], v4
    ds_read_b128 v[96:99], v6 offset:10240
    ds_read_b128 v[100:103], v6 offset:11264
    v_permlane32_swap_b32 v16, v24
    v_permlane32_swap_b32 v17, v25
    v_permlane32_swap_b32 v18, v26
    v_permlane32_swap_b32 v19, v27
    v_add_f32 v16, v16, v24
    v_add_f32 v17, v17, v25
    v_add_f32 v18, v18, v26
    v_add_f32 v19, v19, v27
    v_permlane32_swap_b32 v20, v28
    v_permlane32_swap_b32 v21, v29
    v_permlane32_swap_b32 v22, v30
    v_permlane32_swap_b32 v23, v31
    v_add_f32 v20, v20, v28
    v_add_f32 v21, v21, v29
    v_add_f32 v22, v22, v30
    v_add_f32 v23, v23, v31
    v_cvt_pk_bf16_f32 v56, v16, v17
    v_cvt_pk_bf16_f32 v57, v18, v19
    v_cvt_pk_bf16_f32 v58, v20, v21
    v_cvt_pk_bf16_f32 v59, v22, v23
    s_nop 0
    v_permlane16_swap_b32 v56, v58
    v_permlane16_swap_b32 v57, v59
    v_min_u32 v56, -2, v56
    v_min_u32 v57, -2, v57
    v_min_u32 v58, -2, v58
    v_min_u32 v59, -2, v59
    buffer_store_dwordx4 v[56:59], v14, s[8:11], s43 offen sc1
    s_waitcnt lgkmcnt(4)
    v_smfmac_f32_16x16x64_bf16 v[48:51], v[68:71], v[80:87], v4
    ds_read_b128 v[80:83], v6 offset:12288
    ds_read_b128 v[84:87], v6 offset:13312
    s_waitcnt lgkmcnt(4)
    v_smfmac_f32_16x16x64_bf16 v[48:51], v[72:75], v[88:95], v4
    ds_read_b128 v[88:91], v6 offset:14336
    ds_read_b128 v[92:95], v6 offset:15360
    s_waitcnt lgkmcnt(4)
    v_smfmac_f32_16x16x64_bf16 v[48:51], v[76:79], v[96:103], v4
    ds_read_b128 v[96:99], v6 offset:16384
    ds_read_b128 v[100:103], v6 offset:17408
    v_permlane32_swap_b32 v32, v40
    v_permlane32_swap_b32 v33, v41
    v_permlane32_swap_b32 v34, v42
    v_permlane32_swap_b32 v35, v43
    v_add_f32 v32, v32, v40
    v_add_f32 v33, v33, v41
    v_add_f32 v34, v34, v42
    v_add_f32 v35, v35, v43
    v_permlane32_swap_b32 v36, v44
    v_permlane32_swap_b32 v37, v45
    v_permlane32_swap_b32 v38, v46
    v_permlane32_swap_b32 v39, v47
    v_add_f32 v36, v36, v44
    v_add_f32 v37, v37, v45
    v_add_f32 v38, v38, v46
    v_add_f32 v39, v39, v47
    v_cvt_pk_bf16_f32 v60, v32, v33
    v_cvt_pk_bf16_f32 v61, v34, v35
    v_cvt_pk_bf16_f32 v62, v36, v37
    v_cvt_pk_bf16_f32 v63, v38, v39
    s_nop 0
    v_permlane16_swap_b32 v60, v62
    v_permlane16_swap_b32 v61, v63
    v_min_u32 v60, -2, v60
    v_min_u32 v61, -2, v61
    v_min_u32 v62, -2, v62
    v_min_u32 v63, -2, v63
    s_add_u32 s49, s43, 32768
    buffer_store_dwordx4 v[60:63], v14, s[8:11], s49 offen sc1
    s_waitcnt lgkmcnt(4)
    v_smfmac_f32_16x16x64_bf16 v[52:55], v[68:71], v[80:87], v4
    s_waitcnt lgkmcnt(2)
    v_smfmac_f32_16x16x64_bf16 v[52:55], v[72:75], v[88:95], v4
    s_waitcnt lgkmcnt(0)
    v_smfmac_f32_16x16x64_bf16 v[52:55], v[76:79], v[96:103], v4
    s_nop 11
    v_permlane32_swap_b32 v48, v52
    v_permlane32_swap_b32 v49, v53
    v_permlane32_swap_b32 v50, v54
    v_permlane32_swap_b32 v51, v55
    v_add_f32 v48, v48, v52
    v_add_f32 v49, v49, v53
    v_add_f32 v50, v50, v54
    v_add_f32 v51, v51, v55
    v_cvt_pk_bf16_f32 v64, v48, v49
    v_cvt_pk_bf16_f32 v65, v50, v51
    v_mov_b32 v66, v64
    v_mov_b32 v67, v65
    s_nop 0
    v_permlane16_swap_b32 v64, v66
    v_permlane16_swap_b32 v65, v67
    v_min_u32 v64, -2, v64
    v_min_u32 v65, -2, v65
    v_min_u32 v66, -2, v66
    v_min_u32 v67, -2, v67
    buffer_store_dwordx4 v[64:67], v15, s[8:11], s43 offen sc1
    s_add_u32 s40, s40, 1
    s_add_u32 s43, s43, 327680
    s_add_u32 s47, s47, 40960
    s_add_u32 s45, s45, 8192
    s_add_u32 s42, s42, 4096
    s_cmp_lt_u32 s40, 64
    s_cbranch_scc1 chain2_kernel_v_step
    s_branch chain2_kernel_end
chain2_kernel_roleR:
    s_sub_u32 s44, s2, 64
    v_lshlrev_b32 v5, 4, v1
    s_lshl_b32 s24, s44, 15
    s_lshl_b32 s25, s3, 13
    s_add_u32 s24, s24, s25
    v_add_u32 v6, s24, v5
    v_add_u32 v7, 4096, v6
    s_lshl_b32 s24, s3, 12
    v_add_u32 v8, s24, v5
    s_lshl_b32 s24, s3, 10
    s_add_u32 s24, s24, 16384
    v_add_u32 v9, s24, v5
    s_lshl_b32 s24, s44, 13
    s_lshl_b32 s25, s3, 11
    s_add_u32 s24, s24, s25
    v_add_u32 v10, s24, v5
    v_and_b32 v204, 7, v2
    v_mul_u32_u24 v11, 80, v204
    v_lshl_add_u32 v11, v3, 4, v11
    s_mul_i32 s24, s3, 640
    v_add_u32 v11, s24, v11
    v_add_u32 v204, 8192, v5
    v_cmp_gt_u32 vcc, 8, v2
    s_nop 1
    v_cndmask_b32 v11, v204, v11, vcc
    v_and_b32 v204, 7, v2
    v_mul_u32_u24 v12, 80, v204
    v_lshrrev_b32 v204, 3, v2
    v_lshl_add_u32 v12, v204, 5, v12
    v_mul_u32_u24 v13, 10240, v3
    v_lshl_add_u32 v13, v2, 4, v13
    s_lshl_b32 s24, s44, 8
    v_add_u32 v13, s24, v13
    v_mov_b32 v204, 2146435072
    v_cmp_gt_u32 vcc, 1, v3
    s_nop 1
    v_cndmask_b32 v13, v204, v13, vcc
    v_cmp_le_u32 s[50:51], 8, v2
    s_and_b32 s25, s44, 15
    s_lshr_b32 s25, s25, 2
    s_sub_u32 s26, s44, 32
    s_lshr_b32 s26, s26, 1
    s_cmp_ge_u32 s44, 32
    s_cselect_b32 s25, s26, s25
    s_mul_i32 s24, s25, 16
    v_add_u32 v120, s24, v1
    v_lshlrev_b32 v120, 7, v120
    v_mov_b32 v204, 2146435072
    v_cmp_le_u32 vcc, 16, v1
    s_nop 1
    v_cndmask_b32 v120, v120, v204, vcc
    s_and_b32 s24, s44, 7
    s_mul_i32 s25, s3, 8
    s_add_u32 s24, s24, s25
    s_lshl_b32 s24, s24, 7
    v_mov_b32 v125, s24
    s_lshl_b32 s24, s3, 3
    v_and_b32 v204, 7, v1
    v_add_u32 v121, s24, v204
    v_add_u32 v204, 32, v121
    v_cmp_le_u32 vcc, 8, v1
    s_nop 1
    v_cndmask_b32 v121, v121, v204, vcc
    v_lshlrev_b32 v121, 7, v121
    v_mov_b32 v204, 2146435072
    v_cmp_le_u32 vcc, 8, v1
    s_nop 1
    v_cndmask_b32 v121, v121, v204, vcc
    v_mov_b32 v122, 12288
    v_mov_b32 v123, 0
    ds_write_b32 v122, v123
    v_mov_b32 v123, 1
    s_waitcnt lgkmcnt(0)
    s_barrier
    s_mov_b32 s45, 154238976
    s_mov_b32 s46, 151584768
    s_mov_b32 s40, 0
    s_mov_b32 s54, 10
    s_mov_b32 s41, 184549376
    s_mov_b32 s43, 141074432
    s_mov_b32 s42, 117440512
    s_mov_b32 s47, 138452992
    v_and_b32 v252, 7, v1
    v_lshlrev_b32 v252, 7, v252
    s_lshl_b32 s24, s3, 10
    s_add_u32 s24, s24, 151572480
    v_add_u32 v252, s24, v252
    s_mov_b32 s62, -1
    s_mov_b32 s63, 1
    s_cmp_ge_i32 s62, s63
    s_cbranch_scc1 chain2_kernel_r_en0_ok
    s_mov_b32 s61, 0
chain2_kernel_r_en0:
    buffer_load_dword v253, v252, s[8:11], 0 offen sc1
    s_waitcnt vmcnt(0)
    v_readlane_b32 s62, v253, 0
    v_readlane_b32 s24, v253, 1
    s_min_i32 s62, s62, s24
    v_readlane_b32 s24, v253, 2
    s_min_i32 s62, s62, s24
    v_readlane_b32 s24, v253, 3
    s_min_i32 s62, s62, s24
    v_readlane_b32 s24, v253, 4
    s_min_i32 s62, s62, s24
    v_readlane_b32 s24, v253, 5
    s_min_i32 s62, s62, s24
    v_readlane_b32 s24, v253, 6
    s_min_i32 s62, s62, s24
    v_readlane_b32 s24, v253, 7
    s_min_i32 s62, s62, s24
    s_cmp_ge_i32 s62, s63
    s_cbranch_scc1 chain2_kernel_r_en0_ok
    s_add_u32 s61, s61, 1
    s_cmp_ge_u32 s61, s60
    s_cbranch_scc1 chain2_kernel_r_en0_to
    s_sleep 2
    s_branch chain2_kernel_r_en0
chain2_kernel_r_en0_to:
    s_mov_b32 s60, 1
chain2_kernel_r_en0_ok:
    buffer_load_dwordx4 v[48:51], v6, s[8:11], s41 offen offset:0 sc1
    buffer_load_dwordx4 v[52:55], v6, s[8:11], s41 offen offset:1024 sc1
    buffer_load_dwordx4 v[56:59], v6, s[8:11], s41 offen offset:2048 sc1
    buffer_load_dwordx4 v[60:63], v6, s[8:11], s41 offen offset:3072 sc1
    buffer_load_dwordx4 v[64:67], v7, s[8:11], s41 offen offset:0 sc1
    buffer_load_dwordx4 v[68:71], v7, s[8:11], s41 offen offset:1024 sc1
    buffer_load_dwordx4 v[72:75], v7, s[8:11], s41 offen offset:2048 sc1
    buffer_load_dwordx4 v[76:79], v7, s[8:11], s41 offen offset:3072 sc1
    s_add_u32 s41, s41, 1310720
    s_waitcnt vmcnt(0)
chain2_kernel_r_step:
    s_waitcnt vmcnt(0)
    v_mov_b32 v16, v48
    v_mov_b32 v17, v49
    v_mov_b32 v18, v50
    v_mov_b32 v19, v51
    v_mov_b32 v20, v52
    v_mov_b32 v21, v53
    v_mov_b32 v22, v54
    v_mov_b32 v23, v55
    v_mov_b32 v24, v56
    v_mov_b32 v25, v57
    v_mov_b32 v26, v58
    v_mov_b32 v27, v59
    v_mov_b32 v28, v60
    v_mov_b32 v29, v61
    v_mov_b32 v30, v62
    v_mov_b32 v31, v63
    v_mov_b32 v32, v64
    v_mov_b32 v33, v65
    v_mov_b32 v34, v66
    v_mov_b32 v35, v67
    v_mov_b32 v36, v68
    v_mov_b32 v37, v69
    v_mov_b32 v38, v70
    v_mov_b32 v39, v71
    v_mov_b32 v40, v72
    v_mov_b32 v41, v73
    v_mov_b32 v42, v74
    v_mov_b32 v43, v75
    v_mov_b32 v44, v76
    v_mov_b32 v45, v77
    v_mov_b32 v46, v78
    v_mov_b32 v47, v79
    s_sleep 10
    s_mov_b64 exec, 1
    s_mov_b32 s61, 0
    v_mov_b32 v117, 0
    buffer_atomic_add v117, v125, s[8:11], s45 offen sc0
    s_sleep 2
    v_mov_b32 v118, 0
    buffer_atomic_add v118, v125, s[8:11], s45 offen sc0
    s_sleep 2
    v_mov_b32 v119, 0
    buffer_atomic_add v119, v125, s[8:11], s45 offen sc0
    s_sleep 2
chain2_kernel_r_pr:
    v_mov_b32 v116, 0
    buffer_atomic_add v116, v125, s[8:11], s45 offen sc0
    s_waitcnt vmcnt(3)
    v_cmp_le_i32 vcc, 7, v117
    s_add_u32 s61, s61, 1
    s_cbranch_vccnz chain2_kernel_r_pr_out
    s_sleep 2
    v_mov_b32 v117, 0
    buffer_atomic_add v117, v125, s[8:11], s45 offen sc0
    s_waitcnt vmcnt(3)
    v_cmp_le_i32 vcc, 7, v118
    s_add_u32 s61, s61, 1
    s_cbranch_vccnz chain2_kernel_r_pr_out
    s_sleep 2
    v_mov_b32 v118, 0
    buffer_atomic_add v118, v125, s[8:11], s45 offen sc0
    s_waitcnt vmcnt(3)
    v_cmp_le_i32 vcc, 7, v119
    s_add_u32 s61, s61, 1
    s_cbranch_vccnz chain2_kernel_r_pr_out
    s_sleep 2
    v_mov_b32 v119, 0
    buffer_atomic_add v119, v125, s[8:11], s45 offen sc0
    s_waitcnt vmcnt(3)
    v_cmp_le_i32 vcc, 7, v116
    s_add_u32 s61, s61, 1
    s_cbranch_vccnz chain2_kernel_r_pr_out
    s_sleep 2
    s_cmp_ge_u32 s61, s60
    s_cbranch_scc0 chain2_kernel_r_pr
    s_mov_b32 s60, 1
chain2_kernel_r_pr_out:
    s_mov_b64 exec, -1
    buffer_load_dwordx4 v[100:103], v10, s[8:11], s42 offen offset:0 sc1
    buffer_load_dwordx4 v[104:107], v10, s[8:11], s42 offen offset:1024 sc1
    buffer_load_dwordx4 v[80:83], v8, s[8:11], s43 offen offset:0 sc1
    buffer_load_dwordx4 v[84:87], v8, s[8:11], s43 offen offset:1024 sc1
    buffer_load_dwordx4 v[88:91], v8, s[8:11], s43 offen offset:2048 sc1
    buffer_load_dwordx4 v[92:95], v8, s[8:11], s43 offen offset:3072 sc1
    buffer_load_dwordx4 v[96:99], v9, s[8:11], s43 offen sc1
    s_waitcnt vmcnt(0)
    v_max3_u32 v204, v80, v81, v82
    v_max3_u32 v204, v204, v83, v84
    v_max3_u32 v204, v204, v85, v86
    v_max3_u32 v204, v204, v87, v88
    v_max3_u32 v204, v204, v89, v90
    v_max3_u32 v204, v204, v91, v92
    v_max3_u32 v204, v204, v93, v94
    v_max3_u32 v204, v204, v95, v96
    v_max3_u32 v204, v204, v97, v98
    v_max3_u32 v204, v204, v99, v100
    v_max3_u32 v204, v204, v101, v102
    v_max3_u32 v204, v204, v103, v104
    v_max3_u32 v204, v204, v105, v106
    v_max_u32 v204, v204, v107
    v_cmp_eq_u32 vcc, -1, v204
    s_cbranch_vccz chain2_kernel_r_p_out
    s_mov_b32 s61, 0
chain2_kernel_r_p:
    buffer_load_dwordx4 v[100:103], v10, s[8:11], s42 offen offset:0 sc1
    buffer_load_dwordx4 v[104:107], v10, s[8:11], s42 offen offset:1024 sc1
    buffer_load_dwordx4 v[80:83], v8, s[8:11], s43 offen offset:0 sc1
    buffer_load_dwordx4 v[84:87], v8, s[8:11], s43 offen offset:1024 sc1
    buffer_load_dwordx4 v[88:91], v8, s[8:11], s43 offen offset:2048 sc1
    buffer_load_dwordx4 v[92:95], v8, s[8:11], s43 offen offset:3072 sc1
    buffer_load_dwordx4 v[96:99], v9, s[8:11], s43 offen sc1
    s_waitcnt vmcnt(0)
    v_max3_u32 v204, v80, v81, v82
    v_max3_u32 v204, v204, v83, v84
    v_max3_u32 v204, v204, v85, v86
    v_max3_u32 v204, v204, v87, v88
    v_max3_u32 v204, v204, v89, v90
    v_max3_u32 v204, v204, v91, v92
    v_max3_u32 v204, v204, v93, v94
    v_max3_u32 v204, v204, v95, v96
    v_max3_u32 v204, v204, v97, v98
    v_max3_u32 v204, v204, v99, v100
    v_max3_u32 v204, v204, v101, v102
    v_max3_u32 v204, v204, v103, v104
    v_max3_u32 v204, v204, v105, v106
    v_max_u32 v204, v204, v107
    v_cmp_eq_u32 vcc, -1, v204
    s_add_u32 s61, s61, 1
    s_cbranch_vccz chain2_kernel_r_p_out
    s_cmp_ge_u32 s61, s60
    s_cbranch_scc1 chain2_kernel_r_p_to
    s_sleep 1
    s_branch chain2_kernel_r_p
chain2_kernel_r_p_to:
    s_mov_b32 s60, 1
chain2_kernel_r_p_out:
    s_mov_b64 exec, 1
    ds_add_rtn_u32 v124, v122, v123
    s_mov_b64 exec, -1
    v_mfma_f32_16x16x32_bf16 v[108:111], v[100:103], v[96:99], 0
    v_mfma_f32_16x16x32_bf16 v[112:115], v[104:107], v[96:99], 0
    v_mfma_f32_16x16x32_bf16 v[108:111], v[16:19], v[80:83], v[108:111]
    v_mfma_f32_16x16x32_bf16 v[112:115], v[20:23], v[80:83], v[112:115]
    s_waitcnt lgkmcnt(0)
    v_readfirstlane_b32 s24, v124
    s_and_b32 s24, s24, 3
    s_cmp_eq_u32 s24, 3
    s_cbranch_scc0 chain2_kernel_nh7
    buffer_atomic_add v123, v120, s[8:11], s46 offen
chain2_kernel_nh7:
    v_mfma_f32_16x16x32_bf16 v[108:111], v[24:27], v[84:87], v[108:111]
    v_mfma_f32_16x16x32_bf16 v[112:115], v[28:31], v[84:87], v[112:115]
    v_mfma_f32_16x16x32_bf16 v[108:111], v[32:35], v[88:91], v[108:111]
    v_mfma_f32_16x16x32_bf16 v[112:115], v[36:39], v[88:91], v[112:115]
    v_mfma_f32_16x16x32_bf16 v[108:111], v[40:43], v[92:95], v[108:111]
    v_mfma_f32_16x16x32_bf16 v[112:115], v[44:47], v[92:95], v[112:115]
    s_and_b32 s24, s40, 1
    s_mul_i32 s24, s24, 2560
    v_add_u32 v14, s24, v11
    v_add_u32 v15, s24, v12
    s_nop 3
    v_cndmask_b32 v108, v108, v112, s[50:51]
    v_cndmask_b32 v109, v109, v113, s[50:51]
    v_cndmask_b32 v110, v110, v114, s[50:51]
    v_cndmask_b32 v111, v111, v115, s[50:51]
    v_add_f32 v108, v108, v108 row_ror:8 row_mask:0xf bank_mask:0xf
    v_add_f32 v109, v109, v109 row_ror:8 row_mask:0xf bank_mask:0xf
    v_add_f32 v110, v110, v110 row_ror:8 row_mask:0xf bank_mask:0xf
    v_add_f32 v111, v111, v111 row_ror:8 row_mask:0xf bank_mask:0xf
    ds_write_b128 v14, v[108:111]
    s_waitcnt lgkmcnt(0)
    s_barrier
    s_cmp_eq_u32 s3, 0
    s_cbranch_scc0 chain2_kernel_np8
    ds_read_b128 v[220:223], v15 offset:0
    ds_read_b128 v[224:227], v15 offset:16
    ds_read_b128 v[228:231], v15 offset:640
    ds_read_b128 v[232:235], v15 offset:656
    ds_read_b128 v[236:239], v15 offset:1280
    ds_read_b128 v[240:243], v15 offset:1296
    ds_read_b128 v[244:247], v15 offset:1920
    ds_read_b128 v[248:251], v15 offset:1936
    s_waitcnt lgkmcnt(4)
    v_pk_add_f32 v[220:221], v[220:221], v[228:229]
    v_pk_add_f32 v[222:223], v[222:223], v[230:231]
    v_pk_add_f32 v[224:225], v[224:225], v[232:233]
    v_pk_add_f32 v[226:227], v[226:227], v[234:235]
    s_waitcnt lgkmcnt(0)
    v_pk_add_f32 v[236:237], v[236:237], v[244:245]
    v_pk_add_f32 v[238:239], v[238:239], v[246:247]
    v_pk_add_f32 v[240:241], v[240:241], v[248:249]
    v_pk_add_f32 v[242:243], v[242:243], v[250:251]
    v_pk_add_f32 v[220:221], v[220:221], v[236:237]
    v_pk_add_f32 v[222:223], v[222:223], v[238:239]
    v_pk_add_f32 v[224:225], v[224:225], v[240:241]
    v_pk_add_f32 v[226:227], v[226:227], v[242:243]
    v_cvt_pk_bf16_f32 v228, v220, v221
    v_cvt_pk_bf16_f32 v229, v222, v223
    v_cvt_pk_bf16_f32 v230, v224, v225
    v_cvt_pk_bf16_f32 v231, v226, v227
    v_min_u32 v228, -2, v228
    v_min_u32 v229, -2, v229
    v_min_u32 v230, -2, v230
    v_min_u32 v231, -2, v231
    buffer_store_dwordx4 v[228:231], v13, s[8:11], s47 offen sc1
chain2_kernel_np8:
    s_add_u32 s63, s40, 2
    s_min_u32 s63, s63, 64
    s_sleep 20
    s_cmp_ge_i32 s62, s63
    s_cbranch_scc1 chain2_kernel_r_en_ok
    s_mov_b32 s61, 0
chain2_kernel_r_en:
    buffer_load_dword v253, v252, s[8:11], 0 offen sc1
    s_waitcnt vmcnt(0)
    v_readlane_b32 s62, v253, 0
    v_readlane_b32 s24, v253, 1
    s_min_i32 s62, s62, s24
    v_readlane_b32 s24, v253, 2
    s_min_i32 s62, s62, s24
    v_readlane_b32 s24, v253, 3
    s_min_i32 s62, s62, s24
    v_readlane_b32 s24, v253, 4
    s_min_i32 s62, s62, s24
    v_readlane_b32 s24, v253, 5
    s_min_i32 s62, s62, s24
    v_readlane_b32 s24, v253, 6
    s_min_i32 s62, s62, s24
    v_readlane_b32 s24, v253, 7
    s_min_i32 s62, s62, s24
    s_cmp_ge_i32 s62, s63
    s_cbranch_scc1 chain2_kernel_r_en_ok
    s_add_u32 s61, s61, 1
    s_cmp_ge_u32 s61, s60
    s_cbranch_scc1 chain2_kernel_r_en_to
    s_sleep 2
    s_branch chain2_kernel_r_en
chain2_kernel_r_en_to:
    s_mov_b32 s60, 1
chain2_kernel_r_en_ok:
    buffer_load_dwordx4 v[48:51], v6, s[8:11], s41 offen offset:0 sc1
    buffer_load_dwordx4 v[52:55], v6, s[8:11], s41 offen offset:1024 sc1
    buffer_load_dwordx4 v[56:59], v6, s[8:11], s41 offen offset:2048 sc1
    buffer_load_dwordx4 v[60:63], v6, s[8:11], s41 offen offset:3072 sc1
    buffer_load_dwordx4 v[64:67], v7, s[8:11], s41 offen offset:0 sc1
    buffer_load_dwordx4 v[68:71], v7, s[8:11], s41 offen offset:1024 sc1
    buffer_load_dwordx4 v[72:75], v7, s[8:11], s41 offen offset:2048 sc1
    buffer_load_dwordx4 v[76:79], v7, s[8:11], s41 offen offset:3072 sc1
    s_add_u32 s41, s41, 1310720
    s_add_u32 s40, s40, 1
    s_add_u32 s42, s42, 327680
    s_add_u32 s43, s43, 81920
    s_add_u32 s47, s47, 40960
    s_add_u32 s45, s45, 4096
    s_add_u32 s46, s46, 8192
    s_cmp_lt_u32 s40, 64
    s_cbranch_scc1 chain2_kernel_r_step
    s_branch chain2_kernel_end
chain2_kernel_roleP:
    s_sub_u32 s44, s2, 104
    s_lshr_b32 s46, s44, 5
    s_and_b32 s44, s44, 31
    s_load_dwordx2 s[6:7], s[0:1], 40
    s_load_dwordx2 s[24:25], s[0:1], 48
    s_load_dwordx2 s[26:27], s[0:1], 56
    s_waitcnt lgkmcnt(0)
    s_cmp_eq_u32 s46, 1
    s_cselect_b32 s6, s24, s6
    s_cselect_b32 s7, s25, s7
    s_mov_b32 s43, 67108864
    s_cselect_b32 s43, 92274688, s43
    s_cmp_eq_u32 s46, 2
    s_cselect_b32 s6, s26, s6
    s_cselect_b32 s7, s27, s7
    s_cselect_b32 s43, 33554432, s43
    s_mov_b32 s12, s6
    s_mov_b32 s13, s7
    s_mov_b32 s14, 7864320
    s_mov_b32 s15, 0x00020000
    v_add_u32 v16, 0, v0
    s_mov_b32 s24, 683
    v_mul_lo_u32 v17, v16, s24
    v_lshrrev_b32 v17, 14, v17
    v_mul_u32_u24 v18, 24, v17
    v_sub_u32 v18, v16, v18
    s_mov_b32 s24, 12288
    v_mul_lo_u32 v4, v17, s24
    v_lshl_add_u32 v4, v18, 4, v4
    v_mul_u32_u24 v10, 400, v17
    v_lshl_add_u32 v10, v18, 4, v10
    v_add_u32 v10, 81920, v10
    v_add_u32 v16, 256, v0
    s_mov_b32 s24, 683
    v_mul_lo_u32 v17, v16, s24
    v_lshrrev_b32 v17, 14, v17
    v_mul_u32_u24 v18, 24, v17
    v_sub_u32 v18, v16, v18
    s_mov_b32 s24, 12288
    v_mul_lo_u32 v5, v17, s24
    v_lshl_add_u32 v5, v18, 4, v5
    v_mul_u32_u24 v11, 400, v17
    v_lshl_add_u32 v11, v18, 4, v11
    v_add_u32 v11, 81920, v11
    v_add_u32 v16, 512, v0
    s_mov_b32 s24, 683
    v_mul_lo_u32 v17, v16, s24
    v_lshrrev_b32 v17, 14, v17
    v_mul_u32_u24 v18, 24, v17
    v_sub_u32 v18, v16, v18
    s_mov_b32 s24, 12288
    v_mul_lo_u32 v6, v17, s24
    v_lshl_add_u32 v6, v18, 4, v6
    v_mul_u32_u24 v12, 400, v17
    v_lshl_add_u32 v12, v18, 4, v12
    v_add_u32 v12, 81920, v12
    v_add_u32 v16, 768, v0
    s_mov_b32 s24, 683
    v_mul_lo_u32 v17, v16, s24
    v_lshrrev_b32 v17, 14, v17
    v_mul_u32_u24 v18, 24, v17
    v_sub_u32 v18, v16, v18
    s_mov_b32 s24, 12288
    v_mul_lo_u32 v7, v17, s24
    v_lshl_add_u32 v7, v18, 4, v7
    v_mul_u32_u24 v13, 400, v17
    v_lshl_add_u32 v13, v18, 4, v13
    v_add_u32 v13, 81920, v13
    v_add_u32 v16, 1024, v0
    s_mov_b32 s24, 683
    v_mul_lo_u32 v17, v16, s24
    v_lshrrev_b32 v17, 14, v17
    v_mul_u32_u24 v18, 24, v17
    v_sub_u32 v18, v16, v18
    s_mov_b32 s24, 12288
    v_mul_lo_u32 v8, v17, s24
    v_lshl_add_u32 v8, v18, 4, v8
    v_mul_u32_u24 v14, 400, v17
    v_lshl_add_u32 v14, v18, 4, v14
    v_add_u32 v14, 81920, v14
    v_add_u32 v16, 1280, v0
    s_mov_b32 s24, 683
    v_mul_lo_u32 v17, v16, s24
    v_lshrrev_b32 v17, 14, v17
    v_mul_u32_u24 v18, 24, v17
    v_sub_u32 v18, v16, v18
    s_mov_b32 s24, 12288
    v_mul_lo_u32 v9, v17, s24
    v_lshl_add_u32 v9, v18, 4, v9
    v_mul_u32_u24 v15, 400, v17
    v_lshl_add_u32 v15, v18, 4, v15
    v_add_u32 v15, 81920, v15
    v_lshrrev_b32 v16, 2, v2
    v_lshl_add_u32 v16, v3, 3, v16
    v_mul_u32_u24 v0, 400, v16
    v_and_b32 v16, 3, v2
    v_lshl_add_u32 v0, v16, 3, v0
    s_mul_i32 s24, s3, 96
    s_add_u32 s24, s24, 81920
    v_add_u32 v0, s24, v0
    v_lshlrev_b32 v16, 4, v1
    s_mul_i32 s24, s3, 10240
    v_add_u32 v17, s24, v16
    v_add_u32 v18, 4096, v17
    v_add_u32 v19, 8192, v17
    s_mov_b32 s41, 59768832
    buffer_load_dwordx4 a[240:243], v17, s[8:11], s41 offen offset:0
    buffer_load_dwordx4 a[244:247], v17, s[8:11], s41 offen offset:1024
    buffer_load_dwordx4 a[248:251], v17, s[8:11], s41 offen offset:2048
    buffer_load_dwordx4 a[252:255], v17, s[8:11], s41 offen offset:3072
    buffer_load_dwordx4 v[20:23], v18, s[8:11], s41 offen offset:0
    buffer_load_dwordx4 v[24:27], v18, s[8:11], s41 offen offset:1024
    buffer_load_dwordx4 v[28:31], v18, s[8:11], s41 offen offset:2048
    buffer_load_dwordx4 v[32:35], v18, s[8:11], s41 offen offset:3072
    buffer_load_dwordx4 v[36:39], v19, s[8:11], s41 offen offset:0
    buffer_load_dwordx4 v[40:43], v19, s[8:11], s41 offen offset:1024
    s_mul_i32 s45, s44, 384
    s_add_u32 s47, s45, 0
    buffer_load_dwordx4 v[56:59], v4, s[12:15], s47 offen
    buffer_load_dwordx4 v[60:63], v5, s[12:15], s47 offen
    buffer_load_dwordx4 v[64:67], v6, s[12:15], s47 offen
    buffer_load_dwordx4 v[68:71], v7, s[12:15], s47 offen
    buffer_load_dwordx4 v[72:75], v8, s[12:15], s47 offen
    buffer_load_dwordx4 v[76:79], v9, s[12:15], s47 offen
    s_add_u32 s47, s45, 786432
    buffer_load_dwordx4 v[80:83], v4, s[12:15], s47 offen
    buffer_load_dwordx4 v[84:87], v5, s[12:15], s47 offen
    buffer_load_dwordx4 v[88:91], v6, s[12:15], s47 offen
    buffer_load_dwordx4 v[92:95], v7, s[12:15], s47 offen
    buffer_load_dwordx4 v[96:99], v8, s[12:15], s47 offen
    buffer_load_dwordx4 v[100:103], v9, s[12:15], s47 offen
    s_add_u32 s47, s45, 1572864
    buffer_load_dwordx4 v[104:107], v4, s[12:15], s47 offen
    buffer_load_dwordx4 v[108:111], v5, s[12:15], s47 offen
    buffer_load_dwordx4 v[112:115], v6, s[12:15], s47 offen
    buffer_load_dwordx4 v[116:119], v7, s[12:15], s47 offen
    buffer_load_dwordx4 v[120:123], v8, s[12:15], s47 offen
    buffer_load_dwordx4 v[124:127], v9, s[12:15], s47 offen
    s_add_u32 s47, s45, 2359296
    buffer_load_dwordx4 v[128:131], v4, s[12:15], s47 offen
    buffer_load_dwordx4 v[132:135], v5, s[12:15], s47 offen
    buffer_load_dwordx4 v[136:139], v6, s[12:15], s47 offen
    buffer_load_dwordx4 v[140:143], v7, s[12:15], s47 offen
    buffer_load_dwordx4 v[144:147], v8, s[12:15], s47 offen
    buffer_load_dwordx4 v[148:151], v9, s[12:15], s47 offen
    s_add_u32 s47, s45, 3145728
    buffer_load_dwordx4 v[152:155], v4, s[12:15], s47 offen
    buffer_load_dwordx4 v[156:159], v5, s[12:15], s47 offen
    buffer_load_dwordx4 v[160:163], v6, s[12:15], s47 offen
    buffer_load_dwordx4 v[164:167], v7, s[12:15], s47 offen
    buffer_load_dwordx4 v[168:171], v8, s[12:15], s47 offen
    buffer_load_dwordx4 v[172:175], v9, s[12:15], s47 offen
    s_add_u32 s47, s45, 3932160
    buffer_load_dwordx4 v[176:179], v4, s[12:15], s47 offen
    buffer_load_dwordx4 v[180:183], v5, s[12:15], s47 offen
    buffer_load_dwordx4 v[184:187], v6, s[12:15], s47 offen
    buffer_load_dwordx4 v[188:191], v7, s[12:15], s47 offen
    buffer_load_dwordx4 v[192:195], v8, s[12:15], s47 offen
    buffer_load_dwordx4 v[196:199], v9, s[12:15], s47 offen
    s_add_u32 s47, s45, 4718592
    buffer_load_dwordx4 v[200:203], v4, s[12:15], s47 offen
    buffer_load_dwordx4 v[204:207], v5, s[12:15], s47 offen
    buffer_load_dwordx4 v[208:211], v6, s[12:15], s47 offen
    buffer_load_dwordx4 v[212:215], v7, s[12:15], s47 offen
    buffer_load_dwordx4 v[216:219], v8, s[12:15], s47 offen
    buffer_load_dwordx4 v[220:223], v9, s[12:15], s47 offen
    s_add_u32 s47, s45, 5505024
    buffer_load_dwordx4 v[224:227], v4, s[12:15], s47 offen
    buffer_load_dwordx4 v[228:231], v5, s[12:15], s47 offen
    buffer_load_dwordx4 v[232:235], v6, s[12:15], s47 offen
    buffer_load_dwordx4 v[236:239], v7, s[12:15], s47 offen
    buffer_load_dwordx4 v[240:243], v8, s[12:15], s47 offen
    buffer_load_dwordx4 v[244:247], v9, s[12:15], s47 offen
    s_waitcnt vmcnt(42)
    ds_write_b128 v10, v[56:59] offset:0
    ds_write_b128 v11, v[60:63] offset:0
    ds_write_b128 v12, v[64:67] offset:0
    ds_write_b128 v13, v[68:71] offset:0
    ds_write_b128 v14, v[72:75] offset:0
    ds_write_b128 v15, v[76:79] offset:0
    ds_write_b128 v17, a[240:243] offset:0
    ds_write_b128 v17, a[244:247] offset:1024
    ds_write_b128 v17, a[248:251] offset:2048
    ds_write_b128 v17, a[252:255] offset:3072
    ds_write_b128 v17, v[20:23] offset:4096
    ds_write_b128 v17, v[24:27] offset:5120
    ds_write_b128 v17, v[28:31] offset:6144
    ds_write_b128 v17, v[32:35] offset:7168
    ds_write_b128 v17, v[36:39] offset:8192
    ds_write_b128 v17, v[40:43] offset:9216
    s_waitcnt lgkmcnt(0)
    s_add_u32 s47, s45, 6291456
    buffer_load_dwordx4 v[56:59], v4, s[12:15], s47 offen
    buffer_load_dwordx4 v[60:63], v5, s[12:15], s47 offen
    buffer_load_dwordx4 v[64:67], v6, s[12:15], s47 offen
    buffer_load_dwordx4 v[68:71], v7, s[12:15], s47 offen
    buffer_load_dwordx4 v[72:75], v8, s[12:15], s47 offen
    buffer_load_dwordx4 v[76:79], v9, s[12:15], s47 offen
    s_barrier
    ds_read_b64_tr_b16 a[0:1], v0 offset:0
    ds_read_b64_tr_b16 a[2:3], v0 offset:1600
    ds_read_b64_tr_b16 a[4:5], v0 offset:12800
    ds_read_b64_tr_b16 a[6:7], v0 offset:14400
    ds_read_b64_tr_b16 a[80:81], v0 offset:32
    ds_read_b64_tr_b16 a[82:83], v0 offset:1632
    ds_read_b64_tr_b16 a[84:85], v0 offset:12832
    ds_read_b64_tr_b16 a[86:87], v0 offset:14432
    ds_read_b64_tr_b16 a[160:161], v0 offset:64
    ds_read_b64_tr_b16 a[162:163], v0 offset:1664
    ds_read_b64_tr_b16 a[164:165], v0 offset:12864
    ds_read_b64_tr_b16 a[166:167], v0 offset:14464
    s_waitcnt vmcnt(42)
    ds_write_b128 v10, v[80:83] offset:25600
    ds_write_b128 v11, v[84:87] offset:25600
    ds_write_b128 v12, v[88:91] offset:25600
    ds_write_b128 v13, v[92:95] offset:25600
    ds_write_b128 v14, v[96:99] offset:25600
    ds_write_b128 v15, v[100:103] offset:25600
    s_waitcnt lgkmcnt(0)
    s_add_u32 s47, s45, 7077888
    buffer_load_dwordx4 v[80:83], v4, s[12:15], s47 offen
    buffer_load_dwordx4 v[84:87], v5, s[12:15], s47 offen
    buffer_load_dwordx4 v[88:91], v6, s[12:15], s47 offen
    buffer_load_dwordx4 v[92:95], v7, s[12:15], s47 offen
    buffer_load_dwordx4 v[96:99], v8, s[12:15], s47 offen
    buffer_load_dwordx4 v[100:103], v9, s[12:15], s47 offen
    s_barrier
    ds_read_b64_tr_b16 a[8:9], v0 offset:25600
    ds_read_b64_tr_b16 a[10:11], v0 offset:27200
    ds_read_b64_tr_b16 a[12:13], v0 offset:38400
    ds_read_b64_tr_b16 a[14:15], v0 offset:40000
    ds_read_b64_tr_b16 a[88:89], v0 offset:25632
    ds_read_b64_tr_b16 a[90:91], v0 offset:27232
    ds_read_b64_tr_b16 a[92:93], v0 offset:38432
    ds_read_b64_tr_b16 a[94:95], v0 offset:40032
    ds_read_b64_tr_b16 a[168:169], v0 offset:25664
    ds_read_b64_tr_b16 a[170:171], v0 offset:27264
    ds_read_b64_tr_b16 a[172:173], v0 offset:38464
    ds_read_b64_tr_b16 a[174:175], v0 offset:40064
    s_waitcnt vmcnt(42)
    ds_write_b128 v10, v[104:107] offset:0
    ds_write_b128 v11, v[108:111] offset:0
    ds_write_b128 v12, v[112:115] offset:0
    ds_write_b128 v13, v[116:119] offset:0
    ds_write_b128 v14, v[120:123] offset:0
    ds_write_b128 v15, v[124:127] offset:0
    s_waitcnt lgkmcnt(0)
    s_barrier
    ds_read_b64_tr_b16 a[16:17], v0 offset:0
    ds_read_b64_tr_b16 a[18:19], v0 offset:1600
    ds_read_b64_tr_b16 a[20:21], v0 offset:12800
    ds_read_b64_tr_b16 a[22:23], v0 offset:14400
    ds_read_b64_tr_b16 a[96:97], v0 offset:32
    ds_read_b64_tr_b16 a[98:99], v0 offset:1632
    ds_read_b64_tr_b16 a[100:101], v0 offset:12832
    ds_read_b64_tr_b16 a[102:103], v0 offset:14432
    ds_read_b64_tr_b16 a[176:177], v0 offset:64
    ds_read_b64_tr_b16 a[178:179], v0 offset:1664
    ds_read_b64_tr_b16 a[180:181], v0 offset:12864
    ds_read_b64_tr_b16 a[182:183], v0 offset:14464
    s_waitcnt vmcnt(36)
    ds_write_b128 v10, v[128:131] offset:25600
    ds_write_b128 v11, v[132:135] offset:25600
    ds_write_b128 v12, v[136:139] offset:25600
    ds_write_b128 v13, v[140:143] offset:25600
    ds_write_b128 v14, v[144:147] offset:25600
    ds_write_b128 v15, v[148:151] offset:25600
    s_waitcnt lgkmcnt(0)
    s_barrier
    ds_read_b64_tr_b16 a[24:25], v0 offset:25600
    ds_read_b64_tr_b16 a[26:27], v0 offset:27200
    ds_read_b64_tr_b16 a[28:29], v0 offset:38400
    ds_read_b64_tr_b16 a[30:31], v0 offset:40000
    ds_read_b64_tr_b16 a[104:105], v0 offset:25632
    ds_read_b64_tr_b16 a[106:107], v0 offset:27232
    ds_read_b64_tr_b16 a[108:109], v0 offset:38432
    ds_read_b64_tr_b16 a[110:111], v0 offset:40032
    ds_read_b64_tr_b16 a[184:185], v0 offset:25664
    ds_read_b64_tr_b16 a[186:187], v0 offset:27264
    ds_read_b64_tr_b16 a[188:189], v0 offset:38464
    ds_read_b64_tr_b16 a[190:191], v0 offset:40064
    s_waitcnt vmcnt(30)
    ds_write_b128 v10, v[152:155] offset:0
    ds_write_b128 v11, v[156:159] offset:0
    ds_write_b128 v12, v[160:163] offset:0
    ds_write_b128 v13, v[164:167] offset:0
    ds_write_b128 v14, v[168:171] offset:0
    ds_write_b128 v15, v[172:175] offset:0
    s_waitcnt lgkmcnt(0)
    s_barrier
    ds_read_b64_tr_b16 a[32:33], v0 offset:0
    ds_read_b64_tr_b16 a[34:35], v0 offset:1600
    ds_read_b64_tr_b16 a[36:37], v0 offset:12800
    ds_read_b64_tr_b16 a[38:39], v0 offset:14400
    ds_read_b64_tr_b16 a[112:113], v0 offset:32
    ds_read_b64_tr_b16 a[114:115], v0 offset:1632
    ds_read_b64_tr_b16 a[116:117], v0 offset:12832
    ds_read_b64_tr_b16 a[118:119], v0 offset:14432
    ds_read_b64_tr_b16 a[192:193], v0 offset:64
    ds_read_b64_tr_b16 a[194:195], v0 offset:1664
    ds_read_b64_tr_b16 a[196:197], v0 offset:12864
    ds_read_b64_tr_b16 a[198:199], v0 offset:14464
    s_waitcnt vmcnt(24)
    ds_write_b128 v10, v[176:179] offset:25600
    ds_write_b128 v11, v[180:183] offset:25600
    ds_write_b128 v12, v[184:187] offset:25600
    ds_write_b128 v13, v[188:191] offset:25600
    ds_write_b128 v14, v[192:195] offset:25600
    ds_write_b128 v15, v[196:199] offset:25600
    s_waitcnt lgkmcnt(0)
    s_barrier
    ds_read_b64_tr_b16 a[40:41], v0 offset:25600
    ds_read_b64_tr_b16 a[42:43], v0 offset:27200
    ds_read_b64_tr_b16 a[44:45], v0 offset:38400
    ds_read_b64_tr_b16 a[46:47], v0 offset:40000
    ds_read_b64_tr_b16 a[120:121], v0 offset:25632
    ds_read_b64_tr_b16 a[122:123], v0 offset:27232
    ds_read_b64_tr_b16 a[124:125], v0 offset:38432
    ds_read_b64_tr_b16 a[126:127], v0 offset:40032
    ds_read_b64_tr_b16 a[200:201], v0 offset:25664
    ds_read_b64_tr_b16 a[202:203], v0 offset:27264
    ds_read_b64_tr_b16 a[204:205], v0 offset:38464
    ds_read_b64_tr_b16 a[206:207], v0 offset:40064
    s_waitcnt vmcnt(18)
    ds_write_b128 v10, v[200:203] offset:0
    ds_write_b128 v11, v[204:207] offset:0
    ds_write_b128 v12, v[208:211] offset:0
    ds_write_b128 v13, v[212:215] offset:0
    ds_write_b128 v14, v[216:219] offset:0
    ds_write_b128 v15, v[220:223] offset:0
    s_waitcnt lgkmcnt(0)
    s_barrier
    ds_read_b64_tr_b16 a[48:49], v0 offset:0
    ds_read_b64_tr_b16 a[50:51], v0 offset:1600
    ds_read_b64_tr_b16 a[52:53], v0 offset:12800
    ds_read_b64_tr_b16 a[54:55], v0 offset:14400
    ds_read_b64_tr_b16 a[128:129], v0 offset:32
    ds_read_b64_tr_b16 a[130:131], v0 offset:1632
    ds_read_b64_tr_b16 a[132:133], v0 offset:12832
    ds_read_b64_tr_b16 a[134:135], v0 offset:14432
    ds_read_b64_tr_b16 a[208:209], v0 offset:64
    ds_read_b64_tr_b16 a[210:211], v0 offset:1664
    ds_read_b64_tr_b16 a[212:213], v0 offset:12864
    ds_read_b64_tr_b16 a[214:215], v0 offset:14464
    s_waitcnt vmcnt(12)
    ds_write_b128 v10, v[224:227] offset:25600
    ds_write_b128 v11, v[228:231] offset:25600
    ds_write_b128 v12, v[232:235] offset:25600
    ds_write_b128 v13, v[236:239] offset:25600
    ds_write_b128 v14, v[240:243] offset:25600
    ds_write_b128 v15, v[244:247] offset:25600
    s_waitcnt lgkmcnt(0)
    s_barrier
    ds_read_b64_tr_b16 a[56:57], v0 offset:25600
    ds_read_b64_tr_b16 a[58:59], v0 offset:27200
    ds_read_b64_tr_b16 a[60:61], v0 offset:38400
    ds_read_b64_tr_b16 a[62:63], v0 offset:40000
    ds_read_b64_tr_b16 a[136:137], v0 offset:25632
    ds_read_b64_tr_b16 a[138:139], v0 offset:27232
    ds_read_b64_tr_b16 a[140:141], v0 offset:38432
    ds_read_b64_tr_b16 a[142:143], v0 offset:40032
    ds_read_b64_tr_b16 a[216:217], v0 offset:25664
    ds_read_b64_tr_b16 a[218:219], v0 offset:27264
    ds_read_b64_tr_b16 a[220:221], v0 offset:38464
    ds_read_b64_tr_b16 a[222:223], v0 offset:40064
    s_waitcnt vmcnt(6)
    ds_write_b128 v10, v[56:59] offset:0
    ds_write_b128 v11, v[60:63] offset:0
    ds_write_b128 v12, v[64:67] offset:0
    ds_write_b128 v13, v[68:71] offset:0
    ds_write_b128 v14, v[72:75] offset:0
    ds_write_b128 v15, v[76:79] offset:0
    s_waitcnt lgkmcnt(0)
    s_barrier
    ds_read_b64_tr_b16 a[64:65], v0 offset:0
    ds_read_b64_tr_b16 a[66:67], v0 offset:1600
    ds_read_b64_tr_b16 a[68:69], v0 offset:12800
    ds_read_b64_tr_b16 a[70:71], v0 offset:14400
    ds_read_b64_tr_b16 a[144:145], v0 offset:32
    ds_read_b64_tr_b16 a[146:147], v0 offset:1632
    ds_read_b64_tr_b16 a[148:149], v0 offset:12832
    ds_read_b64_tr_b16 a[150:151], v0 offset:14432
    ds_read_b64_tr_b16 a[224:225], v0 offset:64
    ds_read_b64_tr_b16 a[226:227], v0 offset:1664
    ds_read_b64_tr_b16 a[228:229], v0 offset:12864
    ds_read_b64_tr_b16 a[230:231], v0 offset:14464
    s_waitcnt vmcnt(0)
    ds_write_b128 v10, v[80:83] offset:25600
    ds_write_b128 v11, v[84:87] offset:25600
    ds_write_b128 v12, v[88:91] offset:25600
    ds_write_b128 v13, v[92:95] offset:25600
    ds_write_b128 v14, v[96:99] offset:25600
    ds_write_b128 v15, v[100:103] offset:25600
    s_waitcnt lgkmcnt(0)
    s_barrier
    ds_read_b64_tr_b16 a[72:73], v0 offset:25600
    ds_read_b64_tr_b16 a[74:75], v0 offset:27200
    ds_read_b64_tr_b16 a[76:77], v0 offset:38400
    ds_read_b64_tr_b16 a[78:79], v0 offset:40000
    ds_read_b64_tr_b16 a[152:153], v0 offset:25632
    ds_read_b64_tr_b16 a[154:155], v0 offset:27232
    ds_read_b64_tr_b16 a[156:157], v0 offset:38432
    ds_read_b64_tr_b16 a[158:159], v0 offset:40032
    ds_read_b64_tr_b16 a[232:233], v0 offset:25664
    ds_read_b64_tr_b16 a[234:235], v0 offset:27264
    ds_read_b64_tr_b16 a[236:237], v0 offset:38464
    ds_read_b64_tr_b16 a[238:239], v0 offset:40064
    v_mov_b32 v6, v17
    v_mov_b32 v7, v18
    v_mov_b32 v8, v19
    v_lshlrev_b32 v5, 4, v1
    s_mul_i32 s24, s44, 12288
    s_mul_i32 s25, s3, 3072
    s_add_u32 s24, s24, s25
    v_add_u32 v11, s24, v5
    s_lshl_b32 s24, s46, 12
    s_lshl_b32 s25, s44, 7
    s_add_u32 s24, s24, s25
    s_add_u32 s24, s24, 151560192
    v_mov_b32 v14, s24
    v_mov_b32 v15, 2146435072
    v_cmp_eq_u32 vcc, 0, v1
    s_nop 1
    v_cndmask_b32 v14, v15, v14, vcc
    s_mov_b32 s40, 0
    s_mov_b32 s42, 0
    s_waitcnt lgkmcnt(0)
chain2_kernel_p_seg:
    v_add_u32 v9, s42, v5
    s_xor_b32 s42, s42, 40960
    v_add_u32 v10, s42, v6
    s_add_u32 s41, s41, 40960
    buffer_load_dwordx4 v[16:19], v6, s[8:11], s41 offen offset:0
    buffer_load_dwordx4 v[20:23], v6, s[8:11], s41 offen offset:1024
    buffer_load_dwordx4 v[24:27], v6, s[8:11], s41 offen offset:2048
    buffer_load_dwordx4 v[28:31], v6, s[8:11], s41 offen offset:3072
    buffer_load_dwordx4 v[32:35], v7, s[8:11], s41 offen offset:0
    buffer_load_dwordx4 v[36:39], v7, s[8:11], s41 offen offset:1024
    buffer_load_dwordx4 v[40:43], v7, s[8:11], s41 offen offset:2048
    buffer_load_dwordx4 v[44:47], v7, s[8:11], s41 offen offset:3072
    buffer_load_dwordx4 v[48:51], v8, s[8:11], s41 offen offset:0
    buffer_load_dwordx4 v[52:55], v8, s[8:11], s41 offen offset:1024
    ds_read_b128 v[56:59], v9 offset:0
    ds_read_b128 v[60:63], v9 offset:20480
    ds_read_b128 v[64:67], v9 offset:1024
    ds_read_b128 v[68:71], v9 offset:21504
    ds_read_b128 v[72:75], v9 offset:2048
    ds_read_b128 v[76:79], v9 offset:22528
    ds_read_b128 v[80:83], v9 offset:3072
    ds_read_b128 v[84:87], v9 offset:23552
    s_waitcnt lgkmcnt(6)
    v_mfma_f32_16x16x32_bf16 v[88:91], a[0:3], v[56:59], 0
    v_mfma_f32_16x16x32_bf16 v[92:95], a[80:83], v[56:59], 0
    v_mfma_f32_16x16x32_bf16 v[96:99], a[160:163], v[56:59], 0
    v_mfma_f32_16x16x32_bf16 v[100:103], a[0:3], v[60:63], 0
    v_mfma_f32_16x16x32_bf16 v[104:107], a[80:83], v[60:63], 0
    v_mfma_f32_16x16x32_bf16 v[108:111], a[160:163], v[60:63], 0
    ds_read_b128 v[56:59], v9 offset:4096
    ds_read_b128 v[60:63], v9 offset:24576
    s_waitcnt lgkmcnt(6)
    v_mfma_f32_16x16x32_bf16 v[88:91], a[4:7], v[64:67], v[88:91]
    v_mfma_f32_16x16x32_bf16 v[92:95], a[84:87], v[64:67], v[92:95]
    v_mfma_f32_16x16x32_bf16 v[96:99], a[164:167], v[64:67], v[96:99]
    v_mfma_f32_16x16x32_bf16 v[100:103], a[4:7], v[68:71], v[100:103]
    v_mfma_f32_16x16x32_bf16 v[104:107], a[84:87], v[68:71], v[104:107]
    v_mfma_f32_16x16x32_bf16 v[108:111], a[164:167], v[68:71], v[108:111]
    ds_read_b128 v[64:67], v9 offset:5120
    ds_read_b128 v[68:71], v9 offset:25600
    s_waitcnt lgkmcnt(6)
    v_mfma_f32_16x16x32_bf16 v[88:91], a[8:11], v[72:75], v[88:91]
    v_mfma_f32_16x16x32_bf16 v[92:95], a[88:91], v[72:75], v[92:95]
    v_mfma_f32_16x16x32_bf16 v[96:99], a[168:171], v[72:75], v[96:99]
    v_mfma_f32_16x16x32_bf16 v[100:103], a[8:11], v[76:79], v[100:103]
    v_mfma_f32_16x16x32_bf16 v[104:107], a[88:91], v[76:79], v[104:107]
    v_mfma_f32_16x16x32_bf16 v[108:111], a[168:171], v[76:79], v[108:111]
    ds_read_b128 v[72:75], v9 offset:6144
    ds_read_b128 v[76:79], v9 offset:26624
    s_waitcnt lgkmcnt(6)
    v_mfma_f32_16x16x32_bf16 v[88:91], a[12:15], v[80:83], v[88:91]
    v_mfma_f32_16x16x32_bf16 v[92:95], a[92:95], v[80:83], v[92:95]
    v_mfma_f32_16x16x32_bf16 v[96:99], a[172:175], v[80:83], v[96:99]
    v_mfma_f32_16x16x32_bf16 v[100:103], a[12:15], v[84:87], v[100:103]
    v_mfma_f32_16x16x32_bf16 v[104:107], a[92:95], v[84:87], v[104:107]
    v_mfma_f32_16x16x32_bf16 v[108:111], a[172:175], v[84:87], v[108:111]
    ds_read_b128 v[80:83], v9 offset:7168
    ds_read_b128 v[84:87], v9 offset:27648
    s_waitcnt lgkmcnt(6)
    v_mfma_f32_16x16x32_bf16 v[88:91], a[16:19], v[56:59], v[88:91]
    v_mfma_f32_16x16x32_bf16 v[92:95], a[96:99], v[56:59], v[92:95]
    v_mfma_f32_16x16x32_bf16 v[96:99], a[176:179], v[56:59], v[96:99]
    v_mfma_f32_16x16x32_bf16 v[100:103], a[16:19], v[60:63], v[100:103]
    v_mfma_f32_16x16x32_bf16 v[104:107], a[96:99], v[60:63], v[104:107]
    v_mfma_f32_16x16x32_bf16 v[108:111], a[176:179], v[60:63], v[108:111]
    ds_read_b128 v[56:59], v9 offset:8192
    ds_read_b128 v[60:63], v9 offset:28672
    s_waitcnt lgkmcnt(6)
    v_mfma_f32_16x16x32_bf16 v[88:91], a[20:23], v[64:67], v[88:91]
    v_mfma_f32_16x16x32_bf16 v[92:95], a[100:103], v[64:67], v[92:95]
    v_mfma_f32_16x16x32_bf16 v[96:99], a[180:183], v[64:67], v[96:99]
    v_mfma_f32_16x16x32_bf16 v[100:103], a[20:23], v[68:71], v[100:103]
    v_mfma_f32_16x16x32_bf16 v[104:107], a[100:103], v[68:71], v[104:107]
    v_mfma_f32_16x16x32_bf16 v[108:111], a[180:183], v[68:71], v[108:111]
    ds_read_b128 v[64:67], v9 offset:9216
    ds_read_b128 v[68:71], v9 offset:29696
    s_waitcnt lgkmcnt(6)
    v_mfma_f32_16x16x32_bf16 v[88:91], a[24:27], v[72:75], v[88:91]
    v_mfma_f32_16x16x32_bf16 v[92:95], a[104:107], v[72:75], v[92:95]
    v_mfma_f32_16x16x32_bf16 v[96:99], a[184:187], v[72:75], v[96:99]
    v_mfma_f32_16x16x32_bf16 v[100:103], a[24:27], v[76:79], v[100:103]
    v_mfma_f32_16x16x32_bf16 v[104:107], a[104:107], v[76:79], v[104:107]
    v_mfma_f32_16x16x32_bf16 v[108:111], a[184:187], v[76:79], v[108:111]
    ds_read_b128 v[72:75], v9 offset:10240
    ds_read_b128 v[76:79], v9 offset:30720
    s_waitcnt lgkmcnt(6)
    v_mfma_f32_16x16x32_bf16 v[88:91], a[28:31], v[80:83], v[88:91]
    v_mfma_f32_16x16x32_bf16 v[92:95], a[108:111], v[80:83], v[92:95]
    v_mfma_f32_16x16x32_bf16 v[96:99], a[188:191], v[80:83], v[96:99]
    v_mfma_f32_16x16x32_bf16 v[100:103], a[28:31], v[84:87], v[100:103]
    v_mfma_f32_16x16x32_bf16 v[104:107], a[108:111], v[84:87], v[104:107]
    v_mfma_f32_16x16x32_bf16 v[108:111], a[188:191], v[84:87], v[108:111]
    ds_read_b128 v[80:83], v9 offset:11264
    ds_read_b128 v[84:87], v9 offset:31744
    s_waitcnt lgkmcnt(6)
    v_mfma_f32_16x16x32_bf16 v[88:91], a[32:35], v[56:59], v[88:91]
    v_mfma_f32_16x16x32_bf16 v[92:95], a[112:115], v[56:59], v[92:95]
    v_mfma_f32_16x16x32_bf16 v[96:99], a[192:195], v[56:59], v[96:99]
    v_mfma_f32_16x16x32_bf16 v[100:103], a[32:35], v[60:63], v[100:103]
    v_mfma_f32_16x16x32_bf16 v[104:107], a[112:115], v[60:63], v[104:107]
    v_mfma_f32_16x16x32_bf16 v[108:111], a[192:195], v[60:63], v[108:111]
    ds_read_b128 v[56:59], v9 offset:12288
    ds_read_b128 v[60:63], v9 offset:32768
    s_waitcnt lgkmcnt(6)
    v_mfma_f32_16x16x32_bf16 v[88:91], a[36:39], v[64:67], v[88:91]
    v_mfma_f32_16x16x32_bf16 v[92:95], a[116:119], v[64:67], v[92:95]
    v_mfma_f32_16x16x32_bf16 v[96:99], a[196:199], v[64:67], v[96:99]
    v_mfma_f32_16x16x32_bf16 v[100:103], a[36:39], v[68:71], v[100:103]
    v_mfma_f32_16x16x32_bf16 v[104:107], a[116:119], v[68:71], v[104:107]
    v_mfma_f32_16x16x32_bf16 v[108:111], a[196:199], v[68:71], v[108:111]
    s_waitcnt vmcnt(10)
    s_barrier
    s_cmp_eq_u32 s3, 0
    s_cbranch_scc0 chain2_kernel_fp9
    v_mov_b32 v15, s40
    buffer_store_dword v15, v14, s[8:11], 0 offen sc1
chain2_kernel_fp9:
    ds_read_b128 v[64:67], v9 offset:13312
    ds_read_b128 v[68:71], v9 offset:33792
    s_waitcnt lgkmcnt(6)
    v_mfma_f32_16x16x32_bf16 v[88:91], a[40:43], v[72:75], v[88:91]
    v_mfma_f32_16x16x32_bf16 v[92:95], a[120:123], v[72:75], v[92:95]
    v_mfma_f32_16x16x32_bf16 v[96:99], a[200:203], v[72:75], v[96:99]
    v_mfma_f32_16x16x32_bf16 v[100:103], a[40:43], v[76:79], v[100:103]
    v_mfma_f32_16x16x32_bf16 v[104:107], a[120:123], v[76:79], v[104:107]
    v_mfma_f32_16x16x32_bf16 v[108:111], a[200:203], v[76:79], v[108:111]
    ds_read_b128 v[72:75], v9 offset:14336
    ds_read_b128 v[76:79], v9 offset:34816
    s_waitcnt lgkmcnt(6)
    v_mfma_f32_16x16x32_bf16 v[88:91], a[44:47], v[80:83], v[88:91]
    v_mfma_f32_16x16x32_bf16 v[92:95], a[124:127], v[80:83], v[92:95]
    v_mfma_f32_16x16x32_bf16 v[96:99], a[204:207], v[80:83], v[96:99]
    v_mfma_f32_16x16x32_bf16 v[100:103], a[44:47], v[84:87], v[100:103]
    v_mfma_f32_16x16x32_bf16 v[104:107], a[124:127], v[84:87], v[104:107]
    v_mfma_f32_16x16x32_bf16 v[108:111], a[204:207], v[84:87], v[108:111]
    ds_read_b128 v[80:83], v9 offset:15360
    ds_read_b128 v[84:87], v9 offset:35840
    s_waitcnt lgkmcnt(6)
    v_mfma_f32_16x16x32_bf16 v[88:91], a[48:51], v[56:59], v[88:91]
    v_mfma_f32_16x16x32_bf16 v[92:95], a[128:131], v[56:59], v[92:95]
    v_mfma_f32_16x16x32_bf16 v[96:99], a[208:211], v[56:59], v[96:99]
    v_mfma_f32_16x16x32_bf16 v[100:103], a[48:51], v[60:63], v[100:103]
    v_mfma_f32_16x16x32_bf16 v[104:107], a[128:131], v[60:63], v[104:107]
    v_mfma_f32_16x16x32_bf16 v[108:111], a[208:211], v[60:63], v[108:111]
    ds_read_b128 v[56:59], v9 offset:16384
    ds_read_b128 v[60:63], v9 offset:36864
    s_waitcnt lgkmcnt(6)
    v_mfma_f32_16x16x32_bf16 v[88:91], a[52:55], v[64:67], v[88:91]
    v_mfma_f32_16x16x32_bf16 v[92:95], a[132:135], v[64:67], v[92:95]
    v_mfma_f32_16x16x32_bf16 v[96:99], a[212:215], v[64:67], v[96:99]
    v_mfma_f32_16x16x32_bf16 v[100:103], a[52:55], v[68:71], v[100:103]
    v_mfma_f32_16x16x32_bf16 v[104:107], a[132:135], v[68:71], v[104:107]
    v_mfma_f32_16x16x32_bf16 v[108:111], a[212:215], v[68:71], v[108:111]
    ds_read_b128 v[64:67], v9 offset:17408
    ds_read_b128 v[68:71], v9 offset:37888
    s_waitcnt lgkmcnt(6)
    v_mfma_f32_16x16x32_bf16 v[88:91], a[56:59], v[72:75], v[88:91]
    v_mfma_f32_16x16x32_bf16 v[92:95], a[136:139], v[72:75], v[92:95]
    v_mfma_f32_16x16x32_bf16 v[96:99], a[216:219], v[72:75], v[96:99]
    v_mfma_f32_16x16x32_bf16 v[100:103], a[56:59], v[76:79], v[100:103]
    v_mfma_f32_16x16x32_bf16 v[104:107], a[136:139], v[76:79], v[104:107]
    v_mfma_f32_16x16x32_bf16 v[108:111], a[216:219], v[76:79], v[108:111]
    ds_read_b128 v[72:75], v9 offset:18432
    ds_read_b128 v[76:79], v9 offset:38912
    s_waitcnt lgkmcnt(6)
    v_mfma_f32_16x16x32_bf16 v[88:91], a[60:63], v[80:83], v[88:91]
    v_mfma_f32_16x16x32_bf16 v[92:95], a[140:143], v[80:83], v[92:95]
    v_mfma_f32_16x16x32_bf16 v[96:99], a[220:223], v[80:83], v[96:99]
    v_mfma_f32_16x16x32_bf16 v[100:103], a[60:63], v[84:87], v[100:103]
    v_mfma_f32_16x16x32_bf16 v[104:107], a[140:143], v[84:87], v[104:107]
    v_mfma_f32_16x16x32_bf16 v[108:111], a[220:223], v[84:87], v[108:111]
    ds_read_b128 v[80:83], v9 offset:19456
    ds_read_b128 v[84:87], v9 offset:39936
    s_waitcnt lgkmcnt(6)
    v_mfma_f32_16x16x32_bf16 v[88:91], a[64:67], v[56:59], v[88:91]
    v_mfma_f32_16x16x32_bf16 v[92:95], a[144:147], v[56:59], v[92:95]
    v_mfma_f32_16x16x32_bf16 v[96:99], a[224:227], v[56:59], v[96:99]
    v_mfma_f32_16x16x32_bf16 v[100:103], a[64:67], v[60:63], v[100:103]
    v_mfma_f32_16x16x32_bf16 v[104:107], a[144:147], v[60:63], v[104:107]
    v_mfma_f32_16x16x32_bf16 v[108:111], a[224:227], v[60:63], v[108:111]
    s_waitcnt lgkmcnt(4)
    v_mfma_f32_16x16x32_bf16 v[88:91], a[68:71], v[64:67], v[88:91]
    v_mfma_f32_16x16x32_bf16 v[92:95], a[148:151], v[64:67], v[92:95]
    v_mfma_f32_16x16x32_bf16 v[96:99], a[228:231], v[64:67], v[96:99]
    v_mfma_f32_16x16x32_bf16 v[100:103], a[68:71], v[68:71], v[100:103]
    v_mfma_f32_16x16x32_bf16 v[104:107], a[148:151], v[68:71], v[104:107]
    v_mfma_f32_16x16x32_bf16 v[108:111], a[228:231], v[68:71], v[108:111]
    s_waitcnt lgkmcnt(2)
    v_mfma_f32_16x16x32_bf16 v[88:91], a[72:75], v[72:75], v[88:91]
    v_mfma_f32_16x16x32_bf16 v[92:95], a[152:155], v[72:75], v[92:95]
    v_mfma_f32_16x16x32_bf16 v[96:99], a[232:235], v[72:75], v[96:99]
    v_mfma_f32_16x16x32_bf16 v[100:103], a[72:75], v[76:79], v[100:103]
    v_mfma_f32_16x16x32_bf16 v[104:107], a[152:155], v[76:79], v[104:107]
    v_mfma_f32_16x16x32_bf16 v[108:111], a[232:235], v[76:79], v[108:111]
    s_waitcnt lgkmcnt(0)
    v_mfma_f32_16x16x32_bf16 v[88:91], a[76:79], v[80:83], v[88:91]
    v_mfma_f32_16x16x32_bf16 v[92:95], a[156:159], v[80:83], v[92:95]
    v_mfma_f32_16x16x32_bf16 v[96:99], a[236:239], v[80:83], v[96:99]
    v_mfma_f32_16x16x32_bf16 v[100:103], a[76:79], v[84:87], v[100:103]
    v_mfma_f32_16x16x32_bf16 v[104:107], a[156:159], v[84:87], v[104:107]
    v_mfma_f32_16x16x32_bf16 v[108:111], a[236:239], v[84:87], v[108:111]
    s_nop 2
    v_cvt_pk_bf16_f32 v112, v88, v89
    v_cvt_pk_bf16_f32 v113, v90, v91
    v_cvt_pk_bf16_f32 v114, v92, v93
    v_cvt_pk_bf16_f32 v115, v94, v95
    v_cvt_pk_bf16_f32 v116, v100, v101
    v_cvt_pk_bf16_f32 v117, v102, v103
    v_cvt_pk_bf16_f32 v118, v104, v105
    v_cvt_pk_bf16_f32 v119, v106, v107
    v_cvt_pk_bf16_f32 v120, v96, v97
    v_cvt_pk_bf16_f32 v121, v98, v99
    v_cvt_pk_bf16_f32 v122, v108, v109
    v_cvt_pk_bf16_f32 v123, v110, v111
    buffer_store_dwordx4 v[112:115], v11, s[8:11], s43 offen offset:0 sc1
    buffer_store_dwordx4 v[116:119], v11, s[8:11], s43 offen offset:1024 sc1
    buffer_store_dwordx4 v[120:123], v11, s[8:11], s43 offen offset:2048 sc1
    s_waitcnt vmcnt(3)
    ds_write_b128 v10, v[16:19] offset:0
    ds_write_b128 v10, v[20:23] offset:1024
    ds_write_b128 v10, v[24:27] offset:2048
    ds_write_b128 v10, v[28:31] offset:3072
    ds_write_b128 v10, v[32:35] offset:4096
    ds_write_b128 v10, v[36:39] offset:5120
    ds_write_b128 v10, v[40:43] offset:6144
    ds_write_b128 v10, v[44:47] offset:7168
    ds_write_b128 v10, v[48:51] offset:8192
    ds_write_b128 v10, v[52:55] offset:9216
    s_add_u32 s40, s40, 1
    s_add_u32 s43, s43, 393216
    s_waitcnt lgkmcnt(0)
    s_barrier
    s_cmp_lt_u32 s40, 64
    s_cbranch_scc1 chain2_kernel_p_seg
    s_waitcnt vmcnt(0)
    s_barrier
    s_cmp_eq_u32 s3, 0
    s_cbranch_scc0 chain2_kernel_fp10
    v_mov_b32 v15, s40
    buffer_store_dword v15, v14, s[8:11], 0 offen sc1
chain2_kernel_fp10:
    s_sub_u32 s44, s2, 104
    s_cmp_ge_u32 s44, 80
    s_cbranch_scc1 chain2_kernel_end
    s_mul_i32 s40, s44, 205
    s_lshr_b32 s40, s40, 12
    s_mul_i32 s24, s40, 20
    s_sub_u32 s44, s44, s24
    v_lshlrev_b32 v5, 4, v1
    s_lshl_b32 s24, s44, 16
    s_lshl_b32 s25, s3, 13
    s_add_u32 s24, s24, s25
    v_add_u32 v6, s24, v5
    v_add_u32 v7, 4096, v6
    s_lshl_b32 s24, s44, 14
    s_lshl_b32 s25, s3, 11
    s_add_u32 s24, s24, s25
    v_add_u32 v10, s24, v5
    s_lshl_b32 s24, s3, 14
    v_add_u32 v193, s24, v5
    v_add_u32 v212, 0, v193
    v_add_u32 v213, 4096, v193
    v_add_u32 v214, 8192, v193
    v_add_u32 v215, 12288, v193
    s_lshl_b32 s24, s3, 12
    s_add_u32 s24, s24, 65536
    v_add_u32 v216, s24, v5
    s_lshl_b32 s24, s3, 12
    s_add_u32 s24, s24, 0
    v_add_u32 v217, s24, v5
    s_lshl_b32 s24, s3, 10
    s_add_u32 s24, s24, 0
    v_add_u32 v218, s24, v5
    s_and_b32 s24, s3, 1
    s_lshl_b32 s24, s24, 4
    v_add_u32 v219, s24, v2
    v_mul_u32_u24 v219, 1280, v219
    v_lshl_add_u32 v219, v3, 3, v219
    s_lshr_b32 s24, s3, 1
    s_lshl_b32 s25, s44, 1
    s_add_u32 s24, s24, s25
    s_lshl_b32 s24, s24, 5
    v_add_u32 v219, s24, v219
    s_load_dwordx2 s[26:27], s[0:1], 80
    s_waitcnt lgkmcnt(0)
    s_mov_b32 s12, s26
    s_mov_b32 s13, s27
    s_mov_b32 s14, 2621440
    s_mov_b32 s15, 0x00020000
    s_add_u32 s16, s4, 4194304
    s_addc_u32 s17, s5, 0
    s_mov_b32 s18, 2621440
    s_mov_b32 s19, 0x00020000
    s_mul_i32 s41, s40, 1310720
    s_add_u32 s41, s41, 184549376
    s_mul_i32 s42, s40, 327680
    s_add_u32 s42, s42, 117440512
    s_mul_i32 s45, s40, 81920
    s_add_u32 s45, s45, 146317312
    s_mul_i32 s46, s40, 40960
    v_and_b32 v252, 7, v1
    v_lshlrev_b32 v252, 7, v252
    s_lshl_b32 s24, s3, 10
    s_add_u32 s24, s24, 151572480
    v_add_u32 v252, s24, v252
    s_mov_b32 s62, -1
chain2_kernel_x_seg:
    s_add_u32 s63, s40, 1
    s_cmp_ge_i32 s62, s63
    s_cbranch_scc1 chain2_kernel_x_en_ok
    s_mov_b32 s61, 0
chain2_kernel_x_en:
    buffer_load_dword v253, v252, s[8:11], 0 offen sc1
    s_waitcnt vmcnt(0)
    v_readlane_b32 s62, v253, 0
    v_readlane_b32 s24, v253, 1
    s_min_i32 s62, s62, s24
    v_readlane_b32 s24, v253, 2
    s_min_i32 s62, s62, s24
    v_readlane_b32 s24, v253, 3
    s_min_i32 s62, s62, s24
    v_readlane_b32 s24, v253, 4
    s_min_i32 s62, s62, s24
    v_readlane_b32 s24, v253, 5
    s_min_i32 s62, s62, s24
    v_readlane_b32 s24, v253, 6
    s_min_i32 s62, s62, s24
    v_readlane_b32 s24, v253, 7
    s_min_i32 s62, s62, s24
    s_cmp_ge_i32 s62, s63
    s_cbranch_scc1 chain2_kernel_x_en_ok
    s_add_u32 s61, s61, 1
    s_cmp_ge_u32 s61, s60
    s_cbranch_scc1 chain2_kernel_x_en_to
    s_sleep 2
    s_branch chain2_kernel_x_en
chain2_kernel_x_en_to:
    s_mov_b32 s60, 1
chain2_kernel_x_en_ok:
    s_add_u32 s52, s41, 32768
    buffer_load_dwordx4 v[16:19], v6, s[8:11], s41 offen offset:0 sc1
    buffer_load_dwordx4 v[20:23], v6, s[8:11], s41 offen offset:1024 sc1
    buffer_load_dwordx4 v[24:27], v6, s[8:11], s41 offen offset:2048 sc1
    buffer_load_dwordx4 v[28:31], v6, s[8:11], s41 offen offset:3072 sc1
    buffer_load_dwordx4 v[32:35], v7, s[8:11], s41 offen offset:0 sc1
    buffer_load_dwordx4 v[36:39], v7, s[8:11], s41 offen offset:1024 sc1
    buffer_load_dwordx4 v[40:43], v7, s[8:11], s41 offen offset:2048 sc1
    buffer_load_dwordx4 v[44:47], v7, s[8:11], s41 offen offset:3072 sc1
    buffer_load_dwordx4 v[48:51], v6, s[8:11], s52 offen offset:0 sc1
    buffer_load_dwordx4 v[52:55], v6, s[8:11], s52 offen offset:1024 sc1
    buffer_load_dwordx4 v[56:59], v6, s[8:11], s52 offen offset:2048 sc1
    buffer_load_dwordx4 v[60:63], v6, s[8:11], s52 offen offset:3072 sc1
    buffer_load_dwordx4 v[64:67], v7, s[8:11], s52 offen offset:0 sc1
    buffer_load_dwordx4 v[68:71], v7, s[8:11], s52 offen offset:1024 sc1
    buffer_load_dwordx4 v[72:75], v7, s[8:11], s52 offen offset:2048 sc1
    buffer_load_dwordx4 v[76:79], v7, s[8:11], s52 offen offset:3072 sc1
    buffer_load_dwordx2 v[194:195], v219, s[16:19], s46 offen
    s_mov_b32 s61, 0
chain2_kernel_x_p0:
    buffer_load_dwordx4 v[140:143], v215, s[8:11], s45 offen offset:3072 sc1
    s_waitcnt vmcnt(0)
    v_max3_u32 v192, v140, v141, v142
    v_max_u32 v192, v192, v143
    v_cmp_eq_u32 vcc, -1, v192
    s_add_u32 s61, s61, 1
    s_cbranch_vccz chain2_kernel_x_p0_out
    s_cmp_ge_u32 s61, s60
    s_cbranch_scc1 chain2_kernel_x_p0_to
    s_sleep 8
    s_branch chain2_kernel_x_p0
chain2_kernel_x_p0_to:
    s_mov_b32 s60, 1
chain2_kernel_x_p0_out:
    s_mov_b32 s61, 0
chain2_kernel_x_p1:
    buffer_load_dwordx4 v[80:83], v212, s[8:11], s45 offen offset:0 sc1
    buffer_load_dwordx4 v[84:87], v212, s[8:11], s45 offen offset:1024 sc1
    buffer_load_dwordx4 v[88:91], v212, s[8:11], s45 offen offset:2048 sc1
    buffer_load_dwordx4 v[92:95], v212, s[8:11], s45 offen offset:3072 sc1
    buffer_load_dwordx4 v[96:99], v213, s[8:11], s45 offen offset:0 sc1
    buffer_load_dwordx4 v[100:103], v213, s[8:11], s45 offen offset:1024 sc1
    buffer_load_dwordx4 v[104:107], v213, s[8:11], s45 offen offset:2048 sc1
    buffer_load_dwordx4 v[108:111], v213, s[8:11], s45 offen offset:3072 sc1
    buffer_load_dwordx4 v[112:115], v214, s[8:11], s45 offen offset:0 sc1
    buffer_load_dwordx4 v[116:119], v214, s[8:11], s45 offen offset:1024 sc1
    buffer_load_dwordx4 v[120:123], v214, s[8:11], s45 offen offset:2048 sc1
    buffer_load_dwordx4 v[124:127], v214, s[8:11], s45 offen offset:3072 sc1
    buffer_load_dwordx4 v[128:131], v215, s[8:11], s45 offen offset:0 sc1
    buffer_load_dwordx4 v[132:135], v215, s[8:11], s45 offen offset:1024 sc1
    buffer_load_dwordx4 v[136:139], v215, s[8:11], s45 offen offset:2048 sc1
    buffer_load_dwordx4 v[140:143], v215, s[8:11], s45 offen offset:3072 sc1
    buffer_load_dwordx4 v[144:147], v216, s[8:11], s45 offen offset:0 sc1
    buffer_load_dwordx4 v[148:151], v216, s[8:11], s45 offen offset:1024 sc1
    buffer_load_dwordx4 v[152:155], v216, s[8:11], s45 offen offset:2048 sc1
    buffer_load_dwordx4 v[156:159], v216, s[8:11], s45 offen offset:3072 sc1
    s_waitcnt vmcnt(0)
    v_max3_u32 v192, v80, v81, v82
    v_max3_u32 v192, v192, v83, v84
    v_max3_u32 v192, v192, v85, v86
    v_max3_u32 v192, v192, v87, v88
    v_max3_u32 v192, v192, v89, v90
    v_max3_u32 v192, v192, v91, v92
    v_max3_u32 v192, v192, v93, v94
    v_max3_u32 v192, v192, v95, v96
    v_max3_u32 v192, v192, v97, v98
    v_max3_u32 v192, v192, v99, v100
    v_max3_u32 v192, v192, v101, v102
    v_max3_u32 v192, v192, v103, v104
    v_max3_u32 v192, v192, v105, v106
    v_max3_u32 v192, v192, v107, v108
    v_max3_u32 v192, v192, v109, v110
    v_max3_u32 v192, v192, v111, v112
    v_max3_u32 v192, v192, v113, v114
    v_max3_u32 v192, v192, v115, v116
    v_max3_u32 v192, v192, v117, v118
    v_max3_u32 v192, v192, v119, v120
    v_max3_u32 v192, v192, v121, v122
    v_max3_u32 v192, v192, v123, v124
    v_max3_u32 v192, v192, v125, v126
    v_max3_u32 v192, v192, v127, v128
    v_max3_u32 v192, v192, v129, v130
    v_max3_u32 v192, v192, v131, v132
    v_max3_u32 v192, v192, v133, v134
    v_max3_u32 v192, v192, v135, v136
    v_max3_u32 v192, v192, v137, v138
    v_max3_u32 v192, v192, v139, v140
    v_max3_u32 v192, v192, v141, v142
    v_max3_u32 v192, v192, v143, v144
    v_max3_u32 v192, v192, v145, v146
    v_max3_u32 v192, v192, v147, v148
    v_max3_u32 v192, v192, v149, v150
    v_max3_u32 v192, v192, v151, v152
    v_max3_u32 v192, v192, v153, v154
    v_max3_u32 v192, v192, v155, v156
    v_max3_u32 v192, v192, v157, v158
    v_max_u32 v192, v192, v159
    v_cmp_eq_u32 vcc, -1, v192
    s_add_u32 s61, s61, 1
    s_cbranch_vccz chain2_kernel_x_p1_out
    s_cmp_ge_u32 s61, s60
    s_cbranch_scc1 chain2_kernel_x_p1_to
    s_sleep 2
    s_branch chain2_kernel_x_p1
chain2_kernel_x_p1_to:
    s_mov_b32 s60, 1
chain2_kernel_x_p1_out:
    s_add_u32 s53, s42, 8192
    s_mov_b32 s61, 0
chain2_kernel_x_v:
    buffer_load_dwordx4 v[160:163], v10, s[8:11], s42 offen offset:0 sc1
    buffer_load_dwordx4 v[164:167], v10, s[8:11], s42 offen offset:1024 sc1
    buffer_load_dwordx4 v[168:171], v10, s[8:11], s53 offen offset:0 sc1
    buffer_load_dwordx4 v[172:175], v10, s[8:11], s53 offen offset:1024 sc1
    s_waitcnt vmcnt(0)
    v_max3_u32 v192, v160, v161, v162
    v_max3_u32 v192, v192, v163, v164
    v_max3_u32 v192, v192, v165, v166
    v_max3_u32 v192, v192, v167, v168
    v_max3_u32 v192, v192, v169, v170
    v_max3_u32 v192, v192, v171, v172
    v_max3_u32 v192, v192, v173, v174
    v_max_u32 v192, v192, v175
    v_cmp_eq_u32 vcc, -1, v192
    s_add_u32 s61, s61, 1
    s_cbranch_vccz chain2_kernel_x_v_out
    s_cmp_ge_u32 s61, s60
    s_cbranch_scc1 chain2_kernel_x_v_to
    s_sleep 2
    s_branch chain2_kernel_x_v
chain2_kernel_x_v_to:
    s_mov_b32 s60, 1
chain2_kernel_x_v_out:
    v_mfma_f32_16x16x32_bf16 v[176:179], v[16:19], v[80:83], 0
    v_mfma_f32_16x16x32_bf16 v[180:183], v[16:19], v[84:87], 0
    v_mfma_f32_16x16x32_bf16 v[184:187], v[48:51], v[80:83], 0
    v_mfma_f32_16x16x32_bf16 v[188:191], v[48:51], v[84:87], 0
    v_mfma_f32_16x16x32_bf16 v[176:179], v[20:23], v[88:91], v[176:179]
    v_mfma_f32_16x16x32_bf16 v[180:183], v[20:23], v[92:95], v[180:183]
    v_mfma_f32_16x16x32_bf16 v[184:187], v[52:55], v[88:91], v[184:187]
    v_mfma_f32_16x16x32_bf16 v[188:191], v[52:55], v[92:95], v[188:191]
    v_mfma_f32_16x16x32_bf16 v[176:179], v[24:27], v[96:99], v[176:179]
    v_mfma_f32_16x16x32_bf16 v[180:183], v[24:27], v[100:103], v[180:183]
    v_mfma_f32_16x16x32_bf16 v[184:187], v[56:59], v[96:99], v[184:187]
    v_mfma_f32_16x16x32_bf16 v[188:191], v[56:59], v[100:103], v[188:191]
    v_mfma_f32_16x16x32_bf16 v[176:179], v[28:31], v[104:107], v[176:179]
    v_mfma_f32_16x16x32_bf16 v[180:183], v[28:31], v[108:111], v[180:183]
    v_mfma_f32_16x16x32_bf16 v[184:187], v[60:63], v[104:107], v[184:187]
    v_mfma_f32_16x16x32_bf16 v[188:191], v[60:63], v[108:111], v[188:191]
    v_mfma_f32_16x16x32_bf16 v[176:179], v[32:35], v[112:115], v[176:179]
    v_mfma_f32_16x16x32_bf16 v[180:183], v[32:35], v[116:119], v[180:183]
    v_mfma_f32_16x16x32_bf16 v[184:187], v[64:67], v[112:115], v[184:187]
    v_mfma_f32_16x16x32_bf16 v[188:191], v[64:67], v[116:119], v[188:191]
    v_mfma_f32_16x16x32_bf16 v[176:179], v[36:39], v[120:123], v[176:179]
    v_mfma_f32_16x16x32_bf16 v[180:183], v[36:39], v[124:127], v[180:183]
    v_mfma_f32_16x16x32_bf16 v[184:187], v[68:71], v[120:123], v[184:187]
    v_mfma_f32_16x16x32_bf16 v[188:191], v[68:71], v[124:127], v[188:191]
    v_mfma_f32_16x16x32_bf16 v[176:179], v[40:43], v[128:131], v[176:179]
    v_mfma_f32_16x16x32_bf16 v[180:183], v[40:43], v[132:135], v[180:183]
    v_mfma_f32_16x16x32_bf16 v[184:187], v[72:75], v[128:131], v[184:187]
    v_mfma_f32_16x16x32_bf16 v[188:191], v[72:75], v[132:135], v[188:191]
    v_mfma_f32_16x16x32_bf16 v[176:179], v[44:47], v[136:139], v[176:179]
    v_mfma_f32_16x16x32_bf16 v[180:183], v[44:47], v[140:143], v[180:183]
    v_mfma_f32_16x16x32_bf16 v[184:187], v[76:79], v[136:139], v[184:187]
    v_mfma_f32_16x16x32_bf16 v[188:191], v[76:79], v[140:143], v[188:191]
    v_mfma_f32_16x16x32_bf16 v[176:179], v[160:163], v[144:147], v[176:179]
    v_mfma_f32_16x16x32_bf16 v[180:183], v[160:163], v[148:151], v[180:183]
    v_mfma_f32_16x16x32_bf16 v[184:187], v[168:171], v[144:147], v[184:187]
    v_mfma_f32_16x16x32_bf16 v[188:191], v[168:171], v[148:151], v[188:191]
    v_mfma_f32_16x16x32_bf16 v[176:179], v[164:167], v[152:155], v[176:179]
    v_mfma_f32_16x16x32_bf16 v[180:183], v[164:167], v[156:159], v[180:183]
    v_mfma_f32_16x16x32_bf16 v[184:187], v[172:175], v[152:155], v[184:187]
    v_mfma_f32_16x16x32_bf16 v[188:191], v[172:175], v[156:159], v[188:191]
    s_lshr_b32 s24, s40, 2
    s_and_b32 s24, s24, 1
    s_lshl_b32 s24, s24, 14
    v_add_u32 v14, s24, v217
    v_add_u32 v15, s24, v218
    ds_write_b128 v14, v[176:179] offset:0
    ds_write_b128 v14, v[180:183] offset:1024
    ds_write_b128 v14, v[184:187] offset:2048
    ds_write_b128 v14, v[188:191] offset:3072
    s_waitcnt lgkmcnt(0)
    s_barrier
    ds_read_b128 v[196:199], v15 offset:0
    ds_read_b128 v[200:203], v15 offset:4096
    ds_read_b128 v[204:207], v15 offset:8192
    ds_read_b128 v[208:211], v15 offset:12288
    s_waitcnt lgkmcnt(0)
    v_pk_add_f32 v[196:197], v[196:197], v[200:201]
    v_pk_add_f32 v[204:205], v[204:205], v[208:209]
    v_pk_add_f32 v[198:199], v[198:199], v[202:203]
    v_pk_add_f32 v[206:207], v[206:207], v[210:211]
    v_pk_add_f32 v[196:197], v[196:197], v[204:205]
    v_pk_add_f32 v[198:199], v[198:199], v[206:207]
    v_cvt_pk_bf16_f32 v200, v196, v197
    v_cvt_pk_bf16_f32 v201, v198, v199
    v_lshlrev_b32 v196, 16, v200
    v_and_b32 v197, 0xffff0000, v200
    v_lshlrev_b32 v202, 16, v194
    v_and_b32 v203, 0xffff0000, v194
    v_add_f32 v196, v196, v202
    v_add_f32 v197, v197, v203
    v_lshlrev_b32 v198, 16, v201
    v_and_b32 v199, 0xffff0000, v201
    v_lshlrev_b32 v202, 16, v195
    v_and_b32 v203, 0xffff0000, v195
    v_add_f32 v198, v198, v202
    v_add_f32 v199, v199, v203
    v_cvt_pk_bf16_f32 v200, v196, v197
    v_cvt_pk_bf16_f32 v201, v198, v199
    buffer_store_dwordx2 v[200:201], v219, s[12:15], s46 offen
    s_add_u32 s40, s40, 4
    s_add_u32 s41, s41, 5242880
    s_add_u32 s42, s42, 1310720
    s_add_u32 s45, s45, 327680
    s_add_u32 s46, s46, 163840
    s_cmp_lt_u32 s40, 64
    s_cbranch_scc1 chain2_kernel_x_seg
    s_branch chain2_kernel_end
chain2_kernel_roleO:
    s_sub_u32 s44, s2, 200
    s_load_dwordx2 s[6:7], s[0:1], 64
    s_waitcnt lgkmcnt(0)
    s_mov_b32 s12, s6
    s_mov_b32 s13, s7
    s_mov_b32 s14, 7864320
    s_mov_b32 s15, 0x00020000
    v_add_u32 v8, 0, v0
    s_mov_b32 s24, 3277
    v_mul_lo_u32 v9, v8, s24
    v_lshrrev_b32 v9, 18, v9
    v_mul_u32_u24 v10, 80, v9
    v_sub_u32 v10, v8, v10
    v_mul_u32_u24 v16, 1312, v9
    v_lshl_add_u32 v16, v10, 4, v16
    v_add_u32 v8, 256, v0
    s_mov_b32 s24, 3277
    v_mul_lo_u32 v9, v8, s24
    v_lshrrev_b32 v9, 18, v9
    v_mul_u32_u24 v10, 80, v9
    v_sub_u32 v10, v8, v10
    v_mul_u32_u24 v17, 1312, v9
    v_lshl_add_u32 v17, v10, 4, v17
    v_add_u32 v8, 512, v0
    s_mov_b32 s24, 3277
    v_mul_lo_u32 v9, v8, s24
    v_lshrrev_b32 v9, 18, v9
    v_mul_u32_u24 v10, 80, v9
    v_sub_u32 v10, v8, v10
    v_mul_u32_u24 v18, 1312, v9
    v_lshl_add_u32 v18, v10, 4, v18
    v_add_u32 v8, 768, v0
    s_mov_b32 s24, 3277
    v_mul_lo_u32 v9, v8, s24
    v_lshrrev_b32 v9, 18, v9
    v_mul_u32_u24 v10, 80, v9
    v_sub_u32 v10, v8, v10
    v_mul_u32_u24 v19, 1312, v9
    v_lshl_add_u32 v19, v10, 4, v19
    v_add_u32 v8, 1024, v0
    s_mov_b32 s24, 3277
    v_mul_lo_u32 v9, v8, s24
    v_lshrrev_b32 v9, 18, v9
    v_mul_u32_u24 v10, 80, v9
    v_sub_u32 v10, v8, v10
    v_mul_u32_u24 v20, 1312, v9
    v_lshl_add_u32 v20, v10, 4, v20
    v_add_u32 v8, 1280, v0
    s_mov_b32 s24, 3277
    v_mul_lo_u32 v9, v8, s24
    v_lshrrev_b32 v9, 18, v9
    v_mul_u32_u24 v10, 80, v9
    v_sub_u32 v10, v8, v10
    v_mul_u32_u24 v21, 1312, v9
    v_lshl_add_u32 v21, v10, 4, v21
    v_add_u32 v8, 1536, v0
    s_mov_b32 s24, 3277
    v_mul_lo_u32 v9, v8, s24
    v_lshrrev_b32 v9, 18, v9
    v_mul_u32_u24 v10, 80, v9
    v_sub_u32 v10, v8, v10
    v_mul_u32_u24 v22, 1312, v9
    v_lshl_add_u32 v22, v10, 4, v22
    v_add_u32 v8, 1792, v0
    s_mov_b32 s24, 3277
    v_mul_lo_u32 v9, v8, s24
    v_lshrrev_b32 v9, 18, v9
    v_mul_u32_u24 v10, 80, v9
    v_sub_u32 v10, v8, v10
    v_mul_u32_u24 v23, 1312, v9
    v_lshl_add_u32 v23, v10, 4, v23
    v_add_u32 v8, 2048, v0
    s_mov_b32 s24, 3277
    v_mul_lo_u32 v9, v8, s24
    v_lshrrev_b32 v9, 18, v9
    v_mul_u32_u24 v10, 80, v9
    v_sub_u32 v10, v8, v10
    v_mul_u32_u24 v24, 1312, v9
    v_lshl_add_u32 v24, v10, 4, v24
    v_add_u32 v8, 2304, v0
    s_mov_b32 s24, 3277
    v_mul_lo_u32 v9, v8, s24
    v_lshrrev_b32 v9, 18, v9
    v_mul_u32_u24 v10, 80, v9
    v_sub_u32 v10, v8, v10
    v_mul_u32_u24 v25, 1312, v9
    v_lshl_add_u32 v25, v10, 4, v25
    v_add_u32 v8, 2560, v0
    s_mov_b32 s24, 3277
    v_mul_lo_u32 v9, v8, s24
    v_lshrrev_b32 v9, 18, v9
    v_mul_u32_u24 v10, 80, v9
    v_sub_u32 v10, v8, v10
    v_mul_u32_u24 v26, 1312, v9
    v_lshl_add_u32 v26, v10, 4, v26
    v_add_u32 v8, 2816, v0
    s_mov_b32 s24, 3277
    v_mul_lo_u32 v9, v8, s24
    v_lshrrev_b32 v9, 18, v9
    v_mul_u32_u24 v10, 80, v9
    v_sub_u32 v10, v8, v10
    v_mul_u32_u24 v27, 1312, v9
    v_lshl_add_u32 v27, v10, 4, v27
    v_add_u32 v8, 3072, v0
    s_mov_b32 s24, 3277
    v_mul_lo_u32 v9, v8, s24
    v_lshrrev_b32 v9, 18, v9
    v_mul_u32_u24 v10, 80, v9
    v_sub_u32 v10, v8, v10
    v_mul_u32_u24 v28, 1312, v9
    v_lshl_add_u32 v28, v10, 4, v28
    v_add_u32 v8, 3328, v0
    s_mov_b32 s24, 3277
    v_mul_lo_u32 v9, v8, s24
    v_lshrrev_b32 v9, 18, v9
    v_mul_u32_u24 v10, 80, v9
    v_sub_u32 v10, v8, v10
    v_mul_u32_u24 v29, 1312, v9
    v_lshl_add_u32 v29, v10, 4, v29
    v_add_u32 v8, 3584, v0
    s_mov_b32 s24, 3277
    v_mul_lo_u32 v9, v8, s24
    v_lshrrev_b32 v9, 18, v9
    v_mul_u32_u24 v10, 80, v9
    v_sub_u32 v10, v8, v10
    v_mul_u32_u24 v30, 1312, v9
    v_lshl_add_u32 v30, v10, 4, v30
    v_add_u32 v8, 3840, v0
    s_mov_b32 s24, 3277
    v_mul_lo_u32 v9, v8, s24
    v_lshrrev_b32 v9, 18, v9
    v_mul_u32_u24 v10, 80, v9
    v_sub_u32 v10, v8, v10
    v_mul_u32_u24 v31, 1312, v9
    v_lshl_add_u32 v31, v10, 4, v31
    v_add_u32 v8, 4096, v0
    s_mov_b32 s24, 3277
    v_mul_lo_u32 v9, v8, s24
    v_lshrrev_b32 v9, 18, v9
    v_mul_u32_u24 v10, 80, v9
    v_sub_u32 v10, v8, v10
    v_mul_u32_u24 v32, 1312, v9
    v_lshl_add_u32 v32, v10, 4, v32
    v_add_u32 v8, 4352, v0
    s_mov_b32 s24, 3277
    v_mul_lo_u32 v9, v8, s24
    v_lshrrev_b32 v9, 18, v9
    v_mul_u32_u24 v10, 80, v9
    v_sub_u32 v10, v8, v10
    v_mul_u32_u24 v33, 1312, v9
    v_lshl_add_u32 v33, v10, 4, v33
    v_add_u32 v8, 4608, v0
    s_mov_b32 s24, 3277
    v_mul_lo_u32 v9, v8, s24
    v_lshrrev_b32 v9, 18, v9
    v_mul_u32_u24 v10, 80, v9
    v_sub_u32 v10, v8, v10
    v_mul_u32_u24 v34, 1312, v9
    v_lshl_add_u32 v34, v10, 4, v34
    v_add_u32 v8, 4864, v0
    s_mov_b32 s24, 3277
    v_mul_lo_u32 v9, v8, s24
    v_lshrrev_b32 v9, 18, v9
    v_mul_u32_u24 v10, 80, v9
    v_sub_u32 v10, v8, v10
    v_mul_u32_u24 v35, 1312, v9
    v_lshl_add_u32 v35, v10, 4, v35
    v_add_u32 v8, 5120, v0
    s_mov_b32 s24, 3277
    v_mul_lo_u32 v9, v8, s24
    v_lshrrev_b32 v9, 18, v9
    v_mul_u32_u24 v10, 80, v9
    v_sub_u32 v10, v8, v10
    v_mul_u32_u24 v36, 1312, v9
    v_lshl_add_u32 v36, v10, 4, v36
    v_add_u32 v8, 5376, v0
    s_mov_b32 s24, 3277
    v_mul_lo_u32 v9, v8, s24
    v_lshrrev_b32 v9, 18, v9
    v_mul_u32_u24 v10, 80, v9
    v_sub_u32 v10, v8, v10
    v_mul_u32_u24 v37, 1312, v9
    v_lshl_add_u32 v37, v10, 4, v37
    v_add_u32 v8, 5632, v0
    s_mov_b32 s24, 3277
    v_mul_lo_u32 v9, v8, s24
    v_lshrrev_b32 v9, 18, v9
    v_mul_u32_u24 v10, 80, v9
    v_sub_u32 v10, v8, v10
    v_mul_u32_u24 v38, 1312, v9
    v_lshl_add_u32 v38, v10, 4, v38
    v_add_u32 v8, 5888, v0
    s_mov_b32 s24, 3277
    v_mul_lo_u32 v9, v8, s24
    v_lshrrev_b32 v9, 18, v9
    v_mul_u32_u24 v10, 80, v9
    v_sub_u32 v10, v8, v10
    v_mul_u32_u24 v39, 1312, v9
    v_lshl_add_u32 v39, v10, 4, v39
    v_add_u32 v8, 6144, v0
    s_mov_b32 s24, 3277
    v_mul_lo_u32 v9, v8, s24
    v_lshrrev_b32 v9, 18, v9
    v_mul_u32_u24 v10, 80, v9
    v_sub_u32 v10, v8, v10
    v_mul_u32_u24 v40, 1312, v9
    v_lshl_add_u32 v40, v10, 4, v40
    v_add_u32 v8, 6400, v0
    s_mov_b32 s24, 3277
    v_mul_lo_u32 v9, v8, s24
    v_lshrrev_b32 v9, 18, v9
    v_mul_u32_u24 v10, 80, v9
    v_sub_u32 v10, v8, v10
    v_mul_u32_u24 v41, 1312, v9
    v_lshl_add_u32 v41, v10, 4, v41
    v_add_u32 v8, 6656, v0
    s_mov_b32 s24, 3277
    v_mul_lo_u32 v9, v8, s24
    v_lshrrev_b32 v9, 18, v9
    v_mul_u32_u24 v10, 80, v9
    v_sub_u32 v10, v8, v10
    v_mul_u32_u24 v42, 1312, v9
    v_lshl_add_u32 v42, v10, 4, v42
    v_add_u32 v8, 6912, v0
    s_mov_b32 s24, 3277
    v_mul_lo_u32 v9, v8, s24
    v_lshrrev_b32 v9, 18, v9
    v_mul_u32_u24 v10, 80, v9
    v_sub_u32 v10, v8, v10
    v_mul_u32_u24 v43, 1312, v9
    v_lshl_add_u32 v43, v10, 4, v43
    v_add_u32 v8, 7168, v0
    s_mov_b32 s24, 3277
    v_mul_lo_u32 v9, v8, s24
    v_lshrrev_b32 v9, 18, v9
    v_mul_u32_u24 v10, 80, v9
    v_sub_u32 v10, v8, v10
    v_mul_u32_u24 v44, 1312, v9
    v_lshl_add_u32 v44, v10, 4, v44
    v_add_u32 v8, 7424, v0
    s_mov_b32 s24, 3277
    v_mul_lo_u32 v9, v8, s24
    v_lshrrev_b32 v9, 18, v9
    v_mul_u32_u24 v10, 80, v9
    v_sub_u32 v10, v8, v10
    v_mul_u32_u24 v45, 1312, v9
    v_lshl_add_u32 v45, v10, 4, v45
    v_lshlrev_b32 v4, 4, v0
    s_mul_i32 s45, s44, 245760
    s_add_u32 s46, s45, 0
    buffer_load_dwordx4 v[48:51], v4, s[12:15], s46 offen
    s_add_u32 s46, s45, 4096
    buffer_load_dwordx4 v[52:55], v4, s[12:15], s46 offen
    s_add_u32 s46, s45, 8192
    buffer_load_dwordx4 v[56:59], v4, s[12:15], s46 offen
    s_add_u32 s46, s45, 12288
    buffer_load_dwordx4 v[60:63], v4, s[12:15], s46 offen
    s_add_u32 s46, s45, 16384
    buffer_load_dwordx4 v[64:67], v4, s[12:15], s46 offen
    s_add_u32 s46, s45, 20480
    buffer_load_dwordx4 v[68:71], v4, s[12:15], s46 offen
    s_add_u32 s46, s45, 24576
    buffer_load_dwordx4 v[72:75], v4, s[12:15], s46 offen
    s_add_u32 s46, s45, 28672
    buffer_load_dwordx4 v[76:79], v4, s[12:15], s46 offen
    s_add_u32 s46, s45, 32768
    buffer_load_dwordx4 v[80:83], v4, s[12:15], s46 offen
    s_add_u32 s46, s45, 36864
    buffer_load_dwordx4 v[84:87], v4, s[12:15], s46 offen
    s_add_u32 s46, s45, 40960
    buffer_load_dwordx4 v[88:91], v4, s[12:15], s46 offen
    s_add_u32 s46, s45, 45056
    buffer_load_dwordx4 v[92:95], v4, s[12:15], s46 offen
    s_add_u32 s46, s45, 49152
    buffer_load_dwordx4 v[96:99], v4, s[12:15], s46 offen
    s_add_u32 s46, s45, 53248
    buffer_load_dwordx4 v[100:103], v4, s[12:15], s46 offen
    s_add_u32 s46, s45, 57344
    buffer_load_dwordx4 v[104:107], v4, s[12:15], s46 offen
    s_add_u32 s46, s45, 61440
    buffer_load_dwordx4 v[108:111], v4, s[12:15], s46 offen
    s_add_u32 s46, s45, 65536
    buffer_load_dwordx4 v[112:115], v4, s[12:15], s46 offen
    s_add_u32 s46, s45, 69632
    buffer_load_dwordx4 v[116:119], v4, s[12:15], s46 offen
    s_add_u32 s46, s45, 73728
    buffer_load_dwordx4 v[120:123], v4, s[12:15], s46 offen
    s_add_u32 s46, s45, 77824
    buffer_load_dwordx4 v[124:127], v4, s[12:15], s46 offen
    s_add_u32 s46, s45, 81920
    buffer_load_dwordx4 v[128:131], v4, s[12:15], s46 offen
    s_add_u32 s46, s45, 86016
    buffer_load_dwordx4 v[132:135], v4, s[12:15], s46 offen
    s_add_u32 s46, s45, 90112
    buffer_load_dwordx4 v[136:139], v4, s[12:15], s46 offen
    s_add_u32 s46, s45, 94208
    buffer_load_dwordx4 v[140:143], v4, s[12:15], s46 offen
    s_add_u32 s46, s45, 98304
    buffer_load_dwordx4 v[144:147], v4, s[12:15], s46 offen
    s_add_u32 s46, s45, 102400
    buffer_load_dwordx4 v[148:151], v4, s[12:15], s46 offen
    s_add_u32 s46, s45, 106496
    buffer_load_dwordx4 v[152:155], v4, s[12:15], s46 offen
    s_add_u32 s46, s45, 110592
    buffer_load_dwordx4 v[156:159], v4, s[12:15], s46 offen
    s_add_u32 s46, s45, 114688
    buffer_load_dwordx4 v[160:163], v4, s[12:15], s46 offen
    s_add_u32 s46, s45, 118784
    buffer_load_dwordx4 v[164:167], v4, s[12:15], s46 offen
    s_add_u32 s46, s45, 122880
    buffer_load_dwordx4 v[168:171], v4, s[12:15], s46 offen
    s_add_u32 s46, s45, 126976
    buffer_load_dwordx4 v[172:175], v4, s[12:15], s46 offen
    s_add_u32 s46, s45, 131072
    buffer_load_dwordx4 v[176:179], v4, s[12:15], s46 offen
    s_add_u32 s46, s45, 135168
    buffer_load_dwordx4 v[180:183], v4, s[12:15], s46 offen
    s_add_u32 s46, s45, 139264
    buffer_load_dwordx4 v[184:187], v4, s[12:15], s46 offen
    s_add_u32 s46, s45, 143360
    buffer_load_dwordx4 v[188:191], v4, s[12:15], s46 offen
    s_add_u32 s46, s45, 147456
    buffer_load_dwordx4 v[192:195], v4, s[12:15], s46 offen
    s_add_u32 s46, s45, 151552
    buffer_load_dwordx4 v[196:199], v4, s[12:15], s46 offen
    s_add_u32 s46, s45, 155648
    buffer_load_dwordx4 v[200:203], v4, s[12:15], s46 offen
    s_add_u32 s46, s45, 159744
    buffer_load_dwordx4 v[204:207], v4, s[12:15], s46 offen
    s_add_u32 s46, s45, 163840
    buffer_load_dwordx4 v[208:211], v4, s[12:15], s46 offen
    s_add_u32 s46, s45, 167936
    buffer_load_dwordx4 v[212:215], v4, s[12:15], s46 offen
    s_add_u32 s46, s45, 172032
    buffer_load_dwordx4 v[216:219], v4, s[12:15], s46 offen
    s_add_u32 s46, s45, 176128
    buffer_load_dwordx4 v[220:223], v4, s[12:15], s46 offen
    s_add_u32 s46, s45, 180224
    buffer_load_dwordx4 v[224:227], v4, s[12:15], s46 offen
    s_add_u32 s46, s45, 184320
    buffer_load_dwordx4 v[228:231], v4, s[12:15], s46 offen
    s_add_u32 s46, s45, 188416
    buffer_load_dwordx4 v[232:235], v4, s[12:15], s46 offen
    s_add_u32 s46, s45, 192512
    buffer_load_dwordx4 v[236:239], v4, s[12:15], s46 offen
    s_add_u32 s46, s45, 196608
    buffer_load_dwordx4 v[240:243], v4, s[12:15], s46 offen
    s_add_u32 s46, s45, 200704
    buffer_load_dwordx4 v[244:247], v4, s[12:15], s46 offen
    s_add_u32 s46, s45, 204800
    buffer_load_dwordx4 v[248:251], v4, s[12:15], s46 offen
    s_add_u32 s46, s45, 208896
    buffer_load_dwordx4 v[252:255], v4, s[12:15], s46 offen
    v_lshrrev_b32 v8, 2, v2
    v_lshl_add_u32 v8, v3, 2, v8
    v_mul_u32_u24 v5, 1312, v8
    v_and_b32 v8, 3, v2
    v_lshl_add_u32 v5, v8, 3, v5
    s_mul_i32 s24, s3, 320
    v_add_u32 v5, s24, v5
    v_add_u32 v6, 62976, v5
    s_waitcnt vmcnt(22)
    ds_write_b128 v16, v[48:51]
    ds_write_b128 v17, v[52:55]
    ds_write_b128 v18, v[56:59]
    ds_write_b128 v19, v[60:63]
    ds_write_b128 v20, v[64:67]
    ds_write_b128 v21, v[68:71]
    ds_write_b128 v22, v[72:75]
    ds_write_b128 v23, v[76:79]
    ds_write_b128 v24, v[80:83]
    ds_write_b128 v25, v[84:87]
    ds_write_b128 v26, v[88:91]
    ds_write_b128 v27, v[92:95]
    ds_write_b128 v28, v[96:99]
    ds_write_b128 v29, v[100:103]
    ds_write_b128 v30, v[104:107]
    ds_write_b128 v31, v[108:111]
    ds_write_b128 v32, v[112:115]
    ds_write_b128 v33, v[116:119]
    ds_write_b128 v34, v[120:123]
    ds_write_b128 v35, v[124:127]
    ds_write_b128 v36, v[128:131]
    ds_write_b128 v37, v[132:135]
    ds_write_b128 v38, v[136:139]
    ds_write_b128 v39, v[140:143]
    ds_write_b128 v40, v[144:147]
    ds_write_b128 v41, v[148:151]
    ds_write_b128 v42, v[152:155]
    ds_write_b128 v43, v[156:159]
    ds_write_b128 v44, v[160:163]
    ds_write_b128 v45, v[164:167]
    s_waitcnt lgkmcnt(0)
    s_add_u32 s46, s45, 212992
    buffer_load_dwordx4 v[48:51], v4, s[12:15], s46 offen
    s_add_u32 s46, s45, 217088
    buffer_load_dwordx4 v[52:55], v4, s[12:15], s46 offen
    s_add_u32 s46, s45, 221184
    buffer_load_dwordx4 v[56:59], v4, s[12:15], s46 offen
    s_add_u32 s46, s45, 225280
    buffer_load_dwordx4 v[60:63], v4, s[12:15], s46 offen
    s_add_u32 s46, s45, 229376
    buffer_load_dwordx4 v[64:67], v4, s[12:15], s46 offen
    s_add_u32 s46, s45, 233472
    buffer_load_dwordx4 v[68:71], v4, s[12:15], s46 offen
    s_add_u32 s46, s45, 237568
    buffer_load_dwordx4 v[72:75], v4, s[12:15], s46 offen
    s_add_u32 s46, s45, 241664
    buffer_load_dwordx4 v[76:79], v4, s[12:15], s46 offen
    s_barrier
    ds_read_b64_tr_b16 a[0:1], v5 offset:0
    ds_read_b64_tr_b16 a[2:3], v5 offset:20992
    ds_read_b64_tr_b16 a[4:5], v6 offset:0
    ds_read_b64_tr_b16 a[6:7], v6 offset:20992
    ds_read_b64_tr_b16 a[16:17], v5 offset:41984
    ds_read_b64_tr_b16 a[18:19], v6 offset:41984
    ds_read_b64_tr_b16 a[24:25], v5 offset:32
    ds_read_b64_tr_b16 a[26:27], v5 offset:21024
    ds_read_b64_tr_b16 a[28:29], v6 offset:32
    ds_read_b64_tr_b16 a[30:31], v6 offset:21024
    ds_read_b64_tr_b16 a[40:41], v5 offset:42016
    ds_read_b64_tr_b16 a[42:43], v6 offset:42016
    ds_read_b64_tr_b16 a[48:49], v5 offset:64
    ds_read_b64_tr_b16 a[50:51], v5 offset:21056
    ds_read_b64_tr_b16 a[52:53], v6 offset:64
    ds_read_b64_tr_b16 a[54:55], v6 offset:21056
    ds_read_b64_tr_b16 a[64:65], v5 offset:42048
    ds_read_b64_tr_b16 a[66:67], v6 offset:42048
    ds_read_b64_tr_b16 a[72:73], v5 offset:96
    ds_read_b64_tr_b16 a[74:75], v5 offset:21088
    ds_read_b64_tr_b16 a[76:77], v6 offset:96
    ds_read_b64_tr_b16 a[78:79], v6 offset:21088
    ds_read_b64_tr_b16 a[88:89], v5 offset:42080
    ds_read_b64_tr_b16 a[90:91], v6 offset:42080
    ds_read_b64_tr_b16 a[96:97], v5 offset:128
    ds_read_b64_tr_b16 a[98:99], v5 offset:21120
    ds_read_b64_tr_b16 a[100:101], v6 offset:128
    ds_read_b64_tr_b16 a[102:103], v6 offset:21120
    ds_read_b64_tr_b16 a[112:113], v5 offset:42112
    ds_read_b64_tr_b16 a[114:115], v6 offset:42112
    ds_read_b64_tr_b16 a[120:121], v5 offset:160
    ds_read_b64_tr_b16 a[122:123], v5 offset:21152
    ds_read_b64_tr_b16 a[124:125], v6 offset:160
    ds_read_b64_tr_b16 a[126:127], v6 offset:21152
    ds_read_b64_tr_b16 a[136:137], v5 offset:42144
    ds_read_b64_tr_b16 a[138:139], v6 offset:42144
    ds_read_b64_tr_b16 a[144:145], v5 offset:192
    ds_read_b64_tr_b16 a[146:147], v5 offset:21184
    ds_read_b64_tr_b16 a[148:149], v6 offset:192
    ds_read_b64_tr_b16 a[150:151], v6 offset:21184
    ds_read_b64_tr_b16 a[160:161], v5 offset:42176
    ds_read_b64_tr_b16 a[162:163], v6 offset:42176
    ds_read_b64_tr_b16 a[168:169], v5 offset:224
    ds_read_b64_tr_b16 a[170:171], v5 offset:21216
    ds_read_b64_tr_b16 a[172:173], v6 offset:224
    ds_read_b64_tr_b16 a[174:175], v6 offset:21216
    ds_read_b64_tr_b16 a[184:185], v5 offset:42208
    ds_read_b64_tr_b16 a[186:187], v6 offset:42208
    ds_read_b64_tr_b16 a[192:193], v5 offset:256
    ds_read_b64_tr_b16 a[194:195], v5 offset:21248
    ds_read_b64_tr_b16 a[196:197], v6 offset:256
    ds_read_b64_tr_b16 a[198:199], v6 offset:21248
    ds_read_b64_tr_b16 a[208:209], v5 offset:42240
    ds_read_b64_tr_b16 a[210:211], v6 offset:42240
    ds_read_b64_tr_b16 a[216:217], v5 offset:288
    ds_read_b64_tr_b16 a[218:219], v5 offset:21280
    ds_read_b64_tr_b16 a[220:221], v6 offset:288
    ds_read_b64_tr_b16 a[222:223], v6 offset:21280
    ds_read_b64_tr_b16 a[232:233], v5 offset:42272
    ds_read_b64_tr_b16 a[234:235], v6 offset:42272
    s_waitcnt lgkmcnt(0)
    s_barrier
    s_waitcnt vmcnt(0)
    ds_write_b128 v16, v[168:171]
    ds_write_b128 v17, v[172:175]
    ds_write_b128 v18, v[176:179]
    ds_write_b128 v19, v[180:183]
    ds_write_b128 v20, v[184:187]
    ds_write_b128 v21, v[188:191]
    ds_write_b128 v22, v[192:195]
    ds_write_b128 v23, v[196:199]
    ds_write_b128 v24, v[200:203]
    ds_write_b128 v25, v[204:207]
    ds_write_b128 v26, v[208:211]
    ds_write_b128 v27, v[212:215]
    ds_write_b128 v28, v[216:219]
    ds_write_b128 v29, v[220:223]
    ds_write_b128 v30, v[224:227]
    ds_write_b128 v31, v[228:231]
    ds_write_b128 v32, v[232:235]
    ds_write_b128 v33, v[236:239]
    ds_write_b128 v34, v[240:243]
    ds_write_b128 v35, v[244:247]
    ds_write_b128 v36, v[248:251]
    ds_write_b128 v37, v[252:255]
    ds_write_b128 v38, v[48:51]
    ds_write_b128 v39, v[52:55]
    ds_write_b128 v40, v[56:59]
    ds_write_b128 v41, v[60:63]
    ds_write_b128 v42, v[64:67]
    ds_write_b128 v43, v[68:71]
    ds_write_b128 v44, v[72:75]
    ds_write_b128 v45, v[76:79]
    s_waitcnt lgkmcnt(0)
    s_barrier
    ds_read_b64_tr_b16 a[8:9], v5 offset:0
    ds_read_b64_tr_b16 a[10:11], v5 offset:20992
    ds_read_b64_tr_b16 a[12:13], v6 offset:0
    ds_read_b64_tr_b16 a[14:15], v6 offset:20992
    ds_read_b64_tr_b16 a[20:21], v5 offset:41984
    ds_read_b64_tr_b16 a[22:23], v6 offset:41984
    ds_read_b64_tr_b16 a[32:33], v5 offset:32
    ds_read_b64_tr_b16 a[34:35], v5 offset:21024
    ds_read_b64_tr_b16 a[36:37], v6 offset:32
    ds_read_b64_tr_b16 a[38:39], v6 offset:21024
    ds_read_b64_tr_b16 a[44:45], v5 offset:42016
    ds_read_b64_tr_b16 a[46:47], v6 offset:42016
    ds_read_b64_tr_b16 a[56:57], v5 offset:64
    ds_read_b64_tr_b16 a[58:59], v5 offset:21056
    ds_read_b64_tr_b16 a[60:61], v6 offset:64
    ds_read_b64_tr_b16 a[62:63], v6 offset:21056
    ds_read_b64_tr_b16 a[68:69], v5 offset:42048
    ds_read_b64_tr_b16 a[70:71], v6 offset:42048
    ds_read_b64_tr_b16 a[80:81], v5 offset:96
    ds_read_b64_tr_b16 a[82:83], v5 offset:21088
    ds_read_b64_tr_b16 a[84:85], v6 offset:96
    ds_read_b64_tr_b16 a[86:87], v6 offset:21088
    ds_read_b64_tr_b16 a[92:93], v5 offset:42080
    ds_read_b64_tr_b16 a[94:95], v6 offset:42080
    ds_read_b64_tr_b16 a[104:105], v5 offset:128
    ds_read_b64_tr_b16 a[106:107], v5 offset:21120
    ds_read_b64_tr_b16 a[108:109], v6 offset:128
    ds_read_b64_tr_b16 a[110:111], v6 offset:21120
    ds_read_b64_tr_b16 a[116:117], v5 offset:42112
    ds_read_b64_tr_b16 a[118:119], v6 offset:42112
    ds_read_b64_tr_b16 a[128:129], v5 offset:160
    ds_read_b64_tr_b16 a[130:131], v5 offset:21152
    ds_read_b64_tr_b16 a[132:133], v6 offset:160
    ds_read_b64_tr_b16 a[134:135], v6 offset:21152
    ds_read_b64_tr_b16 a[140:141], v5 offset:42144
    ds_read_b64_tr_b16 a[142:143], v6 offset:42144
    ds_read_b64_tr_b16 a[152:153], v5 offset:192
    ds_read_b64_tr_b16 a[154:155], v5 offset:21184
    ds_read_b64_tr_b16 a[156:157], v6 offset:192
    ds_read_b64_tr_b16 a[158:159], v6 offset:21184
    ds_read_b64_tr_b16 a[164:165], v5 offset:42176
    ds_read_b64_tr_b16 a[166:167], v6 offset:42176
    ds_read_b64_tr_b16 a[176:177], v5 offset:224
    ds_read_b64_tr_b16 a[178:179], v5 offset:21216
    ds_read_b64_tr_b16 a[180:181], v6 offset:224
    ds_read_b64_tr_b16 a[182:183], v6 offset:21216
    ds_read_b64_tr_b16 a[188:189], v5 offset:42208
    ds_read_b64_tr_b16 a[190:191], v6 offset:42208
    ds_read_b64_tr_b16 a[200:201], v5 offset:256
    ds_read_b64_tr_b16 a[202:203], v5 offset:21248
    ds_read_b64_tr_b16 a[204:205], v6 offset:256
    ds_read_b64_tr_b16 a[206:207], v6 offset:21248
    ds_read_b64_tr_b16 a[212:213], v5 offset:42240
    ds_read_b64_tr_b16 a[214:215], v6 offset:42240
    ds_read_b64_tr_b16 a[224:225], v5 offset:288
    ds_read_b64_tr_b16 a[226:227], v5 offset:21280
    ds_read_b64_tr_b16 a[228:229], v6 offset:288
    ds_read_b64_tr_b16 a[230:231], v6 offset:21280
    ds_read_b64_tr_b16 a[236:237], v5 offset:42272
    ds_read_b64_tr_b16 a[238:239], v6 offset:42272
    s_waitcnt lgkmcnt(0)
    s_barrier
    v_lshlrev_b32 v5, 4, v1
    s_mul_i32 s24, s44, 12288
    v_add_u32 v6, s24, v5
    v_add_u32 v7, 4096, v6
    v_add_u32 v8, 8192, v6
    s_mul_i32 s24, s3, 327680
    s_lshl_b32 s25, s44, 10
    s_add_u32 s24, s24, s25
    v_add_u32 v9, s24, v5
    s_mov_b32 s24, 12288
    s_lshl_b32 s25, s44, 7
    s_add_u32 s24, s24, s25
    s_add_u32 s24, s24, 151560192
    v_mov_b32 v14, s24
    v_mov_b32 v15, 2146435072
    v_cmp_eq_u32 vcc, 0, v1
    s_nop 1
    v_cndmask_b32 v14, v15, v14, vcc
    s_lshl_b32 s24, s44, 7
    s_add_u32 s24, s24, 151568384
    v_mov_b32 v10, s24
    s_mov_b32 s41, 33554432
    s_mov_b32 s43, 184549376
    s_mov_b32 s40, 0
    s_mov_b32 s62, -1
    s_mov_b32 s63, 1
    s_cmp_ge_i32 s62, s63
    s_cbranch_scc1 chain2_kernel_o_en0_ok
    s_mov_b32 s61, 0
chain2_kernel_o_en0:
    buffer_load_dword v11, v10, s[8:11], 0 offen sc1
    s_waitcnt vmcnt(0)
    v_readlane_b32 s62, v11, 0
    s_cmp_ge_i32 s62, s63
    s_cbranch_scc1 chain2_kernel_o_en0_ok
    s_add_u32 s61, s61, 1
    s_cmp_ge_u32 s61, s60
    s_cbranch_scc1 chain2_kernel_o_en0_to
    s_sleep 2
    s_branch chain2_kernel_o_en0
chain2_kernel_o_en0_to:
    s_mov_b32 s60, 1
chain2_kernel_o_en0_ok:
    buffer_load_dwordx4 v[16:19], v6, s[8:11], s41 offen offset:0 sc1
    buffer_load_dwordx4 v[20:23], v6, s[8:11], s41 offen offset:1024 sc1
    buffer_load_dwordx4 v[24:27], v6, s[8:11], s41 offen offset:2048 sc1
    buffer_load_dwordx4 v[28:31], v6, s[8:11], s41 offen offset:3072 sc1
    buffer_load_dwordx4 v[32:35], v7, s[8:11], s41 offen offset:0 sc1
    buffer_load_dwordx4 v[36:39], v7, s[8:11], s41 offen offset:1024 sc1
    buffer_load_dwordx4 v[40:43], v7, s[8:11], s41 offen offset:2048 sc1
    buffer_load_dwordx4 v[44:47], v7, s[8:11], s41 offen offset:3072 sc1
    buffer_load_dwordx4 v[48:51], v8, s[8:11], s41 offen offset:0 sc1
    buffer_load_dwordx4 v[52:55], v8, s[8:11], s41 offen offset:1024 sc1
    buffer_load_dwordx4 v[56:59], v8, s[8:11], s41 offen offset:2048 sc1
    buffer_load_dwordx4 v[60:63], v8, s[8:11], s41 offen offset:3072 sc1
    s_add_u32 s41, s41, 393216
    s_waitcnt vmcnt(0)
chain2_kernel_o_seg:
    v_swap_b32 v26, v36
    v_swap_b32 v27, v37
    v_swap_b32 v50, v60
    v_swap_b32 v51, v61
    v_mfma_f32_16x16x32_bf16 v[112:115], v[16:19], a[0:3], 0
    v_mfma_f32_16x16x32_bf16 v[116:119], v[20:23], a[0:3], 0
    v_mfma_f32_16x16x32_bf16 v[120:123], v[16:19], a[24:27], 0
    v_mfma_f32_16x16x32_bf16 v[124:127], v[20:23], a[24:27], 0
    v_mfma_f32_16x16x32_bf16 v[128:131], v[16:19], a[48:51], 0
    v_mfma_f32_16x16x32_bf16 v[132:135], v[20:23], a[48:51], 0
    v_mfma_f32_16x16x32_bf16 v[136:139], v[16:19], a[72:75], 0
    v_mfma_f32_16x16x32_bf16 v[140:143], v[20:23], a[72:75], 0
    v_mfma_f32_16x16x32_bf16 v[144:147], v[16:19], a[96:99], 0
    v_mfma_f32_16x16x32_bf16 v[148:151], v[20:23], a[96:99], 0
    v_mfma_f32_16x16x32_bf16 v[152:155], v[16:19], a[120:123], 0
    v_mfma_f32_16x16x32_bf16 v[156:159], v[20:23], a[120:123], 0
    v_mfma_f32_16x16x32_bf16 v[160:163], v[16:19], a[144:147], 0
    v_mfma_f32_16x16x32_bf16 v[164:167], v[20:23], a[144:147], 0
    v_mfma_f32_16x16x32_bf16 v[168:171], v[16:19], a[168:171], 0
    v_mfma_f32_16x16x32_bf16 v[172:175], v[20:23], a[168:171], 0
    v_mfma_f32_16x16x32_bf16 v[176:179], v[16:19], a[192:195], 0
    v_mfma_f32_16x16x32_bf16 v[180:183], v[20:23], a[192:195], 0
    v_mfma_f32_16x16x32_bf16 v[184:187], v[16:19], a[216:219], 0
    v_mfma_f32_16x16x32_bf16 v[188:191], v[20:23], a[216:219], 0
    v_mfma_f32_16x16x32_bf16 v[112:115], v[28:31], a[4:7], v[112:115]
    v_mfma_f32_16x16x32_bf16 v[116:119], v[32:35], a[4:7], v[116:119]
    v_mfma_f32_16x16x32_bf16 v[120:123], v[28:31], a[28:31], v[120:123]
    v_mfma_f32_16x16x32_bf16 v[124:127], v[32:35], a[28:31], v[124:127]
    v_mfma_f32_16x16x32_bf16 v[128:131], v[28:31], a[52:55], v[128:131]
    v_mfma_f32_16x16x32_bf16 v[132:135], v[32:35], a[52:55], v[132:135]
    v_mfma_f32_16x16x32_bf16 v[136:139], v[28:31], a[76:79], v[136:139]
    v_mfma_f32_16x16x32_bf16 v[140:143], v[32:35], a[76:79], v[140:143]
    v_mfma_f32_16x16x32_bf16 v[144:147], v[28:31], a[100:103], v[144:147]
    v_mfma_f32_16x16x32_bf16 v[148:151], v[32:35], a[100:103], v[148:151]
    v_mfma_f32_16x16x32_bf16 v[152:155], v[28:31], a[124:127], v[152:155]
    v_mfma_f32_16x16x32_bf16 v[156:159], v[32:35], a[124:127], v[156:159]
    v_mfma_f32_16x16x32_bf16 v[160:163], v[28:31], a[148:151], v[160:163]
    v_mfma_f32_16x16x32_bf16 v[164:167], v[32:35], a[148:151], v[164:167]
    v_mfma_f32_16x16x32_bf16 v[168:171], v[28:31], a[172:175], v[168:171]
    v_mfma_f32_16x16x32_bf16 v[172:175], v[32:35], a[172:175], v[172:175]
    v_mfma_f32_16x16x32_bf16 v[176:179], v[28:31], a[196:199], v[176:179]
    v_mfma_f32_16x16x32_bf16 v[180:183], v[32:35], a[196:199], v[180:183]
    v_mfma_f32_16x16x32_bf16 v[184:187], v[28:31], a[220:223], v[184:187]
    v_mfma_f32_16x16x32_bf16 v[188:191], v[32:35], a[220:223], v[188:191]
    v_mfma_f32_16x16x32_bf16 v[112:115], v[40:43], a[8:11], v[112:115]
    v_mfma_f32_16x16x32_bf16 v[116:119], v[44:47], a[8:11], v[116:119]
    v_mfma_f32_16x16x32_bf16 v[120:123], v[40:43], a[32:35], v[120:123]
    v_mfma_f32_16x16x32_bf16 v[124:127], v[44:47], a[32:35], v[124:127]
    v_mfma_f32_16x16x32_bf16 v[128:131], v[40:43], a[56:59], v[128:131]
    v_mfma_f32_16x16x32_bf16 v[132:135], v[44:47], a[56:59], v[132:135]
    v_mfma_f32_16x16x32_bf16 v[136:139], v[40:43], a[80:83], v[136:139]
    v_mfma_f32_16x16x32_bf16 v[140:143], v[44:47], a[80:83], v[140:143]
    v_mfma_f32_16x16x32_bf16 v[144:147], v[40:43], a[104:107], v[144:147]
    v_mfma_f32_16x16x32_bf16 v[148:151], v[44:47], a[104:107], v[148:151]
    v_mfma_f32_16x16x32_bf16 v[152:155], v[40:43], a[128:131], v[152:155]
    v_mfma_f32_16x16x32_bf16 v[156:159], v[44:47], a[128:131], v[156:159]
    v_mfma_f32_16x16x32_bf16 v[160:163], v[40:43], a[152:155], v[160:163]
    v_mfma_f32_16x16x32_bf16 v[164:167], v[44:47], a[152:155], v[164:167]
    v_mfma_f32_16x16x32_bf16 v[168:171], v[40:43], a[176:179], v[168:171]
    v_mfma_f32_16x16x32_bf16 v[172:175], v[44:47], a[176:179], v[172:175]
    v_mfma_f32_16x16x32_bf16 v[176:179], v[40:43], a[200:203], v[176:179]
    v_mfma_f32_16x16x32_bf16 v[180:183], v[44:47], a[200:203], v[180:183]
    v_mfma_f32_16x16x32_bf16 v[184:187], v[40:43], a[224:227], v[184:187]
    v_mfma_f32_16x16x32_bf16 v[188:191], v[44:47], a[224:227], v[188:191]
    s_waitcnt vmcnt(0)
    s_barrier
    s_cmp_eq_u32 s3, 0
    s_cbranch_scc0 chain2_kernel_fp11
    v_mov_b32 v15, s40
    buffer_store_dword v15, v14, s[8:11], 0 offen sc1
chain2_kernel_fp11:
    s_add_u32 s63, s40, 2
    s_min_u32 s63, s63, 64
    s_cmp_ge_i32 s62, s63
    s_cbranch_scc1 chain2_kernel_o_en1_ok
    s_mov_b32 s61, 0
chain2_kernel_o_en1:
    buffer_load_dword v11, v10, s[8:11], 0 offen sc1
    s_waitcnt vmcnt(0)
    v_readlane_b32 s62, v11, 0
    s_cmp_ge_i32 s62, s63
    s_cbranch_scc1 chain2_kernel_o_en1_ok
    s_add_u32 s61, s61, 1
    s_cmp_ge_u32 s61, s60
    s_cbranch_scc1 chain2_kernel_o_en1_to
    s_sleep 2
    s_branch chain2_kernel_o_en1
chain2_kernel_o_en1_to:
    s_mov_b32 s60, 1
chain2_kernel_o_en1_ok:
    buffer_load_dwordx4 v[64:67], v6, s[8:11], s41 offen offset:0 sc1
    buffer_load_dwordx4 v[68:71], v6, s[8:11], s41 offen offset:1024 sc1
    buffer_load_dwordx4 v[72:75], v6, s[8:11], s41 offen offset:2048 sc1
    buffer_load_dwordx4 v[76:79], v6, s[8:11], s41 offen offset:3072 sc1
    buffer_load_dwordx4 v[80:83], v7, s[8:11], s41 offen offset:0 sc1
    buffer_load_dwordx4 v[84:87], v7, s[8:11], s41 offen offset:1024 sc1
    buffer_load_dwordx4 v[88:91], v7, s[8:11], s41 offen offset:2048 sc1
    buffer_load_dwordx4 v[92:95], v7, s[8:11], s41 offen offset:3072 sc1
    buffer_load_dwordx4 v[96:99], v8, s[8:11], s41 offen offset:0 sc1
    buffer_load_dwordx4 v[100:103], v8, s[8:11], s41 offen offset:1024 sc1
    buffer_load_dwordx4 v[104:107], v8, s[8:11], s41 offen offset:2048 sc1
    buffer_load_dwordx4 v[108:111], v8, s[8:11], s41 offen offset:3072 sc1
    s_add_u32 s41, s41, 393216
    v_mfma_f32_16x16x32_bf16 v[112:115], v[52:55], a[12:15], v[112:115]
    v_mfma_f32_16x16x32_bf16 v[116:119], v[56:59], a[12:15], v[116:119]
    v_mfma_f32_16x16x32_bf16 v[120:123], v[52:55], a[36:39], v[120:123]
    v_mfma_f32_16x16x32_bf16 v[124:127], v[56:59], a[36:39], v[124:127]
    v_mfma_f32_16x16x32_bf16 v[128:131], v[52:55], a[60:63], v[128:131]
    v_mfma_f32_16x16x32_bf16 v[132:135], v[56:59], a[60:63], v[132:135]
    v_mfma_f32_16x16x32_bf16 v[136:139], v[52:55], a[84:87], v[136:139]
    v_mfma_f32_16x16x32_bf16 v[140:143], v[56:59], a[84:87], v[140:143]
    v_mfma_f32_16x16x32_bf16 v[144:147], v[52:55], a[108:111], v[144:147]
    v_mfma_f32_16x16x32_bf16 v[148:151], v[56:59], a[108:111], v[148:151]
    v_mfma_f32_16x16x32_bf16 v[152:155], v[52:55], a[132:135], v[152:155]
    v_mfma_f32_16x16x32_bf16 v[156:159], v[56:59], a[132:135], v[156:159]
    v_mfma_f32_16x16x32_bf16 v[160:163], v[52:55], a[156:159], v[160:163]
    v_mfma_f32_16x16x32_bf16 v[164:167], v[56:59], a[156:159], v[164:167]
    v_mfma_f32_16x16x32_bf16 v[168:171], v[52:55], a[180:183], v[168:171]
    v_mfma_f32_16x16x32_bf16 v[172:175], v[56:59], a[180:183], v[172:175]
    v_mfma_f32_16x16x32_bf16 v[176:179], v[52:55], a[204:207], v[176:179]
    v_mfma_f32_16x16x32_bf16 v[180:183], v[56:59], a[204:207], v[180:183]
    v_mfma_f32_16x16x32_bf16 v[184:187], v[52:55], a[228:231], v[184:187]
    v_mfma_f32_16x16x32_bf16 v[188:191], v[56:59], a[228:231], v[188:191]
    v_mfma_f32_16x16x32_bf16 v[112:115], v[24:27], a[16:19], v[112:115]
    v_mfma_f32_16x16x32_bf16 v[116:119], v[36:39], a[16:19], v[116:119]
    v_mfma_f32_16x16x32_bf16 v[120:123], v[24:27], a[40:43], v[120:123]
    v_mfma_f32_16x16x32_bf16 v[124:127], v[36:39], a[40:43], v[124:127]
    v_mfma_f32_16x16x32_bf16 v[128:131], v[24:27], a[64:67], v[128:131]
    v_mfma_f32_16x16x32_bf16 v[132:135], v[36:39], a[64:67], v[132:135]
    v_mfma_f32_16x16x32_bf16 v[136:139], v[24:27], a[88:91], v[136:139]
    v_mfma_f32_16x16x32_bf16 v[140:143], v[36:39], a[88:91], v[140:143]
    v_mfma_f32_16x16x32_bf16 v[144:147], v[24:27], a[112:115], v[144:147]
    v_mfma_f32_16x16x32_bf16 v[148:151], v[36:39], a[112:115], v[148:151]
    v_mfma_f32_16x16x32_bf16 v[152:155], v[24:27], a[136:139], v[152:155]
    v_mfma_f32_16x16x32_bf16 v[156:159], v[36:39], a[136:139], v[156:159]
    v_mfma_f32_16x16x32_bf16 v[160:163], v[24:27], a[160:163], v[160:163]
    v_mfma_f32_16x16x32_bf16 v[164:167], v[36:39], a[160:163], v[164:167]
    v_mfma_f32_16x16x32_bf16 v[168:171], v[24:27], a[184:187], v[168:171]
    v_mfma_f32_16x16x32_bf16 v[172:175], v[36:39], a[184:187], v[172:175]
    v_mfma_f32_16x16x32_bf16 v[176:179], v[24:27], a[208:211], v[176:179]
    v_mfma_f32_16x16x32_bf16 v[180:183], v[36:39], a[208:211], v[180:183]
    v_mfma_f32_16x16x32_bf16 v[184:187], v[24:27], a[232:235], v[184:187]
    v_mfma_f32_16x16x32_bf16 v[188:191], v[36:39], a[232:235], v[188:191]
    v_mfma_f32_16x16x32_bf16 v[112:115], v[48:51], a[20:23], v[112:115]
    v_mfma_f32_16x16x32_bf16 v[116:119], v[60:63], a[20:23], v[116:119]
    v_mfma_f32_16x16x32_bf16 v[120:123], v[48:51], a[44:47], v[120:123]
    v_mfma_f32_16x16x32_bf16 v[124:127], v[60:63], a[44:47], v[124:127]
    v_mfma_f32_16x16x32_bf16 v[128:131], v[48:51], a[68:71], v[128:131]
    v_mfma_f32_16x16x32_bf16 v[132:135], v[60:63], a[68:71], v[132:135]
    v_mfma_f32_16x16x32_bf16 v[136:139], v[48:51], a[92:95], v[136:139]
    v_mfma_f32_16x16x32_bf16 v[140:143], v[60:63], a[92:95], v[140:143]
    v_mfma_f32_16x16x32_bf16 v[144:147], v[48:51], a[116:119], v[144:147]
    v_mfma_f32_16x16x32_bf16 v[148:151], v[60:63], a[116:119], v[148:151]
    v_mfma_f32_16x16x32_bf16 v[152:155], v[48:51], a[140:143], v[152:155]
    v_mfma_f32_16x16x32_bf16 v[156:159], v[60:63], a[140:143], v[156:159]
    v_mfma_f32_16x16x32_bf16 v[160:163], v[48:51], a[164:167], v[160:163]
    v_mfma_f32_16x16x32_bf16 v[164:167], v[60:63], a[164:167], v[164:167]
    v_mfma_f32_16x16x32_bf16 v[168:171], v[48:51], a[188:191], v[168:171]
    v_mfma_f32_16x16x32_bf16 v[172:175], v[60:63], a[188:191], v[172:175]
    v_mfma_f32_16x16x32_bf16 v[176:179], v[48:51], a[212:215], v[176:179]
    v_mfma_f32_16x16x32_bf16 v[180:183], v[60:63], a[212:215], v[180:183]
    v_mfma_f32_16x16x32_bf16 v[184:187], v[48:51], a[236:239], v[184:187]
    v_mfma_f32_16x16x32_bf16 v[188:191], v[60:63], a[236:239], v[188:191]
    s_mov_b32 s46, s43
    v_cvt_pk_bf16_f32 v192, v112, v113
    v_cvt_pk_bf16_f32 v193, v114, v115
    v_cvt_pk_bf16_f32 v194, v116, v117
    v_cvt_pk_bf16_f32 v195, v118, v119
    buffer_store_dwordx4 v[192:195], v9, s[8:11], s46 offen sc1
    s_add_u32 s46, s46, 32768
    v_cvt_pk_bf16_f32 v196, v120, v121
    v_cvt_pk_bf16_f32 v197, v122, v123
    v_cvt_pk_bf16_f32 v198, v124, v125
    v_cvt_pk_bf16_f32 v199, v126, v127
    buffer_store_dwordx4 v[196:199], v9, s[8:11], s46 offen sc1
    s_add_u32 s46, s46, 32768
    v_cvt_pk_bf16_f32 v200, v128, v129
    v_cvt_pk_bf16_f32 v201, v130, v131
    v_cvt_pk_bf16_f32 v202, v132, v133
    v_cvt_pk_bf16_f32 v203, v134, v135
    buffer_store_dwordx4 v[200:203], v9, s[8:11], s46 offen sc1
    s_add_u32 s46, s46, 32768
    v_cvt_pk_bf16_f32 v204, v136, v137
    v_cvt_pk_bf16_f32 v205, v138, v139
    v_cvt_pk_bf16_f32 v206, v140, v141
    v_cvt_pk_bf16_f32 v207, v142, v143
    buffer_store_dwordx4 v[204:207], v9, s[8:11], s46 offen sc1
    s_add_u32 s46, s46, 32768
    v_cvt_pk_bf16_f32 v208, v144, v145
    v_cvt_pk_bf16_f32 v209, v146, v147
    v_cvt_pk_bf16_f32 v210, v148, v149
    v_cvt_pk_bf16_f32 v211, v150, v151
    buffer_store_dwordx4 v[208:211], v9, s[8:11], s46 offen sc1
    s_add_u32 s46, s46, 32768
    v_cvt_pk_bf16_f32 v212, v152, v153
    v_cvt_pk_bf16_f32 v213, v154, v155
    v_cvt_pk_bf16_f32 v214, v156, v157
    v_cvt_pk_bf16_f32 v215, v158, v159
    buffer_store_dwordx4 v[212:215], v9, s[8:11], s46 offen sc1
    s_add_u32 s46, s46, 32768
    v_cvt_pk_bf16_f32 v216, v160, v161
    v_cvt_pk_bf16_f32 v217, v162, v163
    v_cvt_pk_bf16_f32 v218, v164, v165
    v_cvt_pk_bf16_f32 v219, v166, v167
    buffer_store_dwordx4 v[216:219], v9, s[8:11], s46 offen sc1
    s_add_u32 s46, s46, 32768
    v_cvt_pk_bf16_f32 v220, v168, v169
    v_cvt_pk_bf16_f32 v221, v170, v171
    v_cvt_pk_bf16_f32 v222, v172, v173
    v_cvt_pk_bf16_f32 v223, v174, v175
    buffer_store_dwordx4 v[220:223], v9, s[8:11], s46 offen sc1
    s_add_u32 s46, s46, 32768
    v_cvt_pk_bf16_f32 v224, v176, v177
    v_cvt_pk_bf16_f32 v225, v178, v179
    v_cvt_pk_bf16_f32 v226, v180, v181
    v_cvt_pk_bf16_f32 v227, v182, v183
    buffer_store_dwordx4 v[224:227], v9, s[8:11], s46 offen sc1
    s_add_u32 s46, s46, 32768
    v_cvt_pk_bf16_f32 v228, v184, v185
    v_cvt_pk_bf16_f32 v229, v186, v187
    v_cvt_pk_bf16_f32 v230, v188, v189
    v_cvt_pk_bf16_f32 v231, v190, v191
    buffer_store_dwordx4 v[228:231], v9, s[8:11], s46 offen sc1
    s_waitcnt vmcnt(10)
    s_add_u32 s40, s40, 1
    s_add_u32 s43, s43, 1310720
    v_swap_b32 v74, v84
    v_swap_b32 v75, v85
    v_swap_b32 v98, v108
    v_swap_b32 v99, v109
    v_mfma_f32_16x16x32_bf16 v[112:115], v[64:67], a[0:3], 0
    v_mfma_f32_16x16x32_bf16 v[116:119], v[68:71], a[0:3], 0
    v_mfma_f32_16x16x32_bf16 v[120:123], v[64:67], a[24:27], 0
    v_mfma_f32_16x16x32_bf16 v[124:127], v[68:71], a[24:27], 0
    v_mfma_f32_16x16x32_bf16 v[128:131], v[64:67], a[48:51], 0
    v_mfma_f32_16x16x32_bf16 v[132:135], v[68:71], a[48:51], 0
    v_mfma_f32_16x16x32_bf16 v[136:139], v[64:67], a[72:75], 0
    v_mfma_f32_16x16x32_bf16 v[140:143], v[68:71], a[72:75], 0
    v_mfma_f32_16x16x32_bf16 v[144:147], v[64:67], a[96:99], 0
    v_mfma_f32_16x16x32_bf16 v[148:151], v[68:71], a[96:99], 0
    v_mfma_f32_16x16x32_bf16 v[152:155], v[64:67], a[120:123], 0
    v_mfma_f32_16x16x32_bf16 v[156:159], v[68:71], a[120:123], 0
    v_mfma_f32_16x16x32_bf16 v[160:163], v[64:67], a[144:147], 0
    v_mfma_f32_16x16x32_bf16 v[164:167], v[68:71], a[144:147], 0
    v_mfma_f32_16x16x32_bf16 v[168:171], v[64:67], a[168:171], 0
    v_mfma_f32_16x16x32_bf16 v[172:175], v[68:71], a[168:171], 0
    v_mfma_f32_16x16x32_bf16 v[176:179], v[64:67], a[192:195], 0
    v_mfma_f32_16x16x32_bf16 v[180:183], v[68:71], a[192:195], 0
    v_mfma_f32_16x16x32_bf16 v[184:187], v[64:67], a[216:219], 0
    v_mfma_f32_16x16x32_bf16 v[188:191], v[68:71], a[216:219], 0
    v_mfma_f32_16x16x32_bf16 v[112:115], v[76:79], a[4:7], v[112:115]
    v_mfma_f32_16x16x32_bf16 v[116:119], v[80:83], a[4:7], v[116:119]
    v_mfma_f32_16x16x32_bf16 v[120:123], v[76:79], a[28:31], v[120:123]
    v_mfma_f32_16x16x32_bf16 v[124:127], v[80:83], a[28:31], v[124:127]
    v_mfma_f32_16x16x32_bf16 v[128:131], v[76:79], a[52:55], v[128:131]
    v_mfma_f32_16x16x32_bf16 v[132:135], v[80:83], a[52:55], v[132:135]
    v_mfma_f32_16x16x32_bf16 v[136:139], v[76:79], a[76:79], v[136:139]
    v_mfma_f32_16x16x32_bf16 v[140:143], v[80:83], a[76:79], v[140:143]
    v_mfma_f32_16x16x32_bf16 v[144:147], v[76:79], a[100:103], v[144:147]
    v_mfma_f32_16x16x32_bf16 v[148:151], v[80:83], a[100:103], v[148:151]
    v_mfma_f32_16x16x32_bf16 v[152:155], v[76:79], a[124:127], v[152:155]
    v_mfma_f32_16x16x32_bf16 v[156:159], v[80:83], a[124:127], v[156:159]
    v_mfma_f32_16x16x32_bf16 v[160:163], v[76:79], a[148:151], v[160:163]
    v_mfma_f32_16x16x32_bf16 v[164:167], v[80:83], a[148:151], v[164:167]
    v_mfma_f32_16x16x32_bf16 v[168:171], v[76:79], a[172:175], v[168:171]
    v_mfma_f32_16x16x32_bf16 v[172:175], v[80:83], a[172:175], v[172:175]
    v_mfma_f32_16x16x32_bf16 v[176:179], v[76:79], a[196:199], v[176:179]
    v_mfma_f32_16x16x32_bf16 v[180:183], v[80:83], a[196:199], v[180:183]
    v_mfma_f32_16x16x32_bf16 v[184:187], v[76:79], a[220:223], v[184:187]
    v_mfma_f32_16x16x32_bf16 v[188:191], v[80:83], a[220:223], v[188:191]
    v_mfma_f32_16x16x32_bf16 v[112:115], v[88:91], a[8:11], v[112:115]
    v_mfma_f32_16x16x32_bf16 v[116:119], v[92:95], a[8:11], v[116:119]
    v_mfma_f32_16x16x32_bf16 v[120:123], v[88:91], a[32:35], v[120:123]
    v_mfma_f32_16x16x32_bf16 v[124:127], v[92:95], a[32:35], v[124:127]
    v_mfma_f32_16x16x32_bf16 v[128:131], v[88:91], a[56:59], v[128:131]
    v_mfma_f32_16x16x32_bf16 v[132:135], v[92:95], a[56:59], v[132:135]
    v_mfma_f32_16x16x32_bf16 v[136:139], v[88:91], a[80:83], v[136:139]
    v_mfma_f32_16x16x32_bf16 v[140:143], v[92:95], a[80:83], v[140:143]
    v_mfma_f32_16x16x32_bf16 v[144:147], v[88:91], a[104:107], v[144:147]
    v_mfma_f32_16x16x32_bf16 v[148:151], v[92:95], a[104:107], v[148:151]
    v_mfma_f32_16x16x32_bf16 v[152:155], v[88:91], a[128:131], v[152:155]
    v_mfma_f32_16x16x32_bf16 v[156:159], v[92:95], a[128:131], v[156:159]
    v_mfma_f32_16x16x32_bf16 v[160:163], v[88:91], a[152:155], v[160:163]
    v_mfma_f32_16x16x32_bf16 v[164:167], v[92:95], a[152:155], v[164:167]
    v_mfma_f32_16x16x32_bf16 v[168:171], v[88:91], a[176:179], v[168:171]
    v_mfma_f32_16x16x32_bf16 v[172:175], v[92:95], a[176:179], v[172:175]
    v_mfma_f32_16x16x32_bf16 v[176:179], v[88:91], a[200:203], v[176:179]
    v_mfma_f32_16x16x32_bf16 v[180:183], v[92:95], a[200:203], v[180:183]
    v_mfma_f32_16x16x32_bf16 v[184:187], v[88:91], a[224:227], v[184:187]
    v_mfma_f32_16x16x32_bf16 v[188:191], v[92:95], a[224:227], v[188:191]
    s_waitcnt vmcnt(0)
    s_barrier
    s_cmp_eq_u32 s3, 0
    s_cbranch_scc0 chain2_kernel_fp12
    v_mov_b32 v15, s40
    buffer_store_dword v15, v14, s[8:11], 0 offen sc1
chain2_kernel_fp12:
    s_add_u32 s63, s40, 2
    s_min_u32 s63, s63, 64
    s_cmp_ge_i32 s62, s63
    s_cbranch_scc1 chain2_kernel_o_en2_ok
    s_mov_b32 s61, 0
chain2_kernel_o_en2:
    buffer_load_dword v11, v10, s[8:11], 0 offen sc1
    s_waitcnt vmcnt(0)
    v_readlane_b32 s62, v11, 0
    s_cmp_ge_i32 s62, s63
    s_cbranch_scc1 chain2_kernel_o_en2_ok
    s_add_u32 s61, s61, 1
    s_cmp_ge_u32 s61, s60
    s_cbranch_scc1 chain2_kernel_o_en2_to
    s_sleep 2
    s_branch chain2_kernel_o_en2
chain2_kernel_o_en2_to:
    s_mov_b32 s60, 1
chain2_kernel_o_en2_ok:
    buffer_load_dwordx4 v[16:19], v6, s[8:11], s41 offen offset:0 sc1
    buffer_load_dwordx4 v[20:23], v6, s[8:11], s41 offen offset:1024 sc1
    buffer_load_dwordx4 v[24:27], v6, s[8:11], s41 offen offset:2048 sc1
    buffer_load_dwordx4 v[28:31], v6, s[8:11], s41 offen offset:3072 sc1
    buffer_load_dwordx4 v[32:35], v7, s[8:11], s41 offen offset:0 sc1
    buffer_load_dwordx4 v[36:39], v7, s[8:11], s41 offen offset:1024 sc1
    buffer_load_dwordx4 v[40:43], v7, s[8:11], s41 offen offset:2048 sc1
    buffer_load_dwordx4 v[44:47], v7, s[8:11], s41 offen offset:3072 sc1
    buffer_load_dwordx4 v[48:51], v8, s[8:11], s41 offen offset:0 sc1
    buffer_load_dwordx4 v[52:55], v8, s[8:11], s41 offen offset:1024 sc1
    buffer_load_dwordx4 v[56:59], v8, s[8:11], s41 offen offset:2048 sc1
    buffer_load_dwordx4 v[60:63], v8, s[8:11], s41 offen offset:3072 sc1
    s_add_u32 s41, s41, 393216
    v_mfma_f32_16x16x32_bf16 v[112:115], v[100:103], a[12:15], v[112:115]
    v_mfma_f32_16x16x32_bf16 v[116:119], v[104:107], a[12:15], v[116:119]
    v_mfma_f32_16x16x32_bf16 v[120:123], v[100:103], a[36:39], v[120:123]
    v_mfma_f32_16x16x32_bf16 v[124:127], v[104:107], a[36:39], v[124:127]
    v_mfma_f32_16x16x32_bf16 v[128:131], v[100:103], a[60:63], v[128:131]
    v_mfma_f32_16x16x32_bf16 v[132:135], v[104:107], a[60:63], v[132:135]
    v_mfma_f32_16x16x32_bf16 v[136:139], v[100:103], a[84:87], v[136:139]
    v_mfma_f32_16x16x32_bf16 v[140:143], v[104:107], a[84:87], v[140:143]
    v_mfma_f32_16x16x32_bf16 v[144:147], v[100:103], a[108:111], v[144:147]
    v_mfma_f32_16x16x32_bf16 v[148:151], v[104:107], a[108:111], v[148:151]
    v_mfma_f32_16x16x32_bf16 v[152:155], v[100:103], a[132:135], v[152:155]
    v_mfma_f32_16x16x32_bf16 v[156:159], v[104:107], a[132:135], v[156:159]
    v_mfma_f32_16x16x32_bf16 v[160:163], v[100:103], a[156:159], v[160:163]
    v_mfma_f32_16x16x32_bf16 v[164:167], v[104:107], a[156:159], v[164:167]
    v_mfma_f32_16x16x32_bf16 v[168:171], v[100:103], a[180:183], v[168:171]
    v_mfma_f32_16x16x32_bf16 v[172:175], v[104:107], a[180:183], v[172:175]
    v_mfma_f32_16x16x32_bf16 v[176:179], v[100:103], a[204:207], v[176:179]
    v_mfma_f32_16x16x32_bf16 v[180:183], v[104:107], a[204:207], v[180:183]
    v_mfma_f32_16x16x32_bf16 v[184:187], v[100:103], a[228:231], v[184:187]
    v_mfma_f32_16x16x32_bf16 v[188:191], v[104:107], a[228:231], v[188:191]
    v_mfma_f32_16x16x32_bf16 v[112:115], v[72:75], a[16:19], v[112:115]
    v_mfma_f32_16x16x32_bf16 v[116:119], v[84:87], a[16:19], v[116:119]
    v_mfma_f32_16x16x32_bf16 v[120:123], v[72:75], a[40:43], v[120:123]
    v_mfma_f32_16x16x32_bf16 v[124:127], v[84:87], a[40:43], v[124:127]
    v_mfma_f32_16x16x32_bf16 v[128:131], v[72:75], a[64:67], v[128:131]
    v_mfma_f32_16x16x32_bf16 v[132:135], v[84:87], a[64:67], v[132:135]
    v_mfma_f32_16x16x32_bf16 v[136:139], v[72:75], a[88:91], v[136:139]
    v_mfma_f32_16x16x32_bf16 v[140:143], v[84:87], a[88:91], v[140:143]
    v_mfma_f32_16x16x32_bf16 v[144:147], v[72:75], a[112:115], v[144:147]
    v_mfma_f32_16x16x32_bf16 v[148:151], v[84:87], a[112:115], v[148:151]
    v_mfma_f32_16x16x32_bf16 v[152:155], v[72:75], a[136:139], v[152:155]
    v_mfma_f32_16x16x32_bf16 v[156:159], v[84:87], a[136:139], v[156:159]
    v_mfma_f32_16x16x32_bf16 v[160:163], v[72:75], a[160:163], v[160:163]
    v_mfma_f32_16x16x32_bf16 v[164:167], v[84:87], a[160:163], v[164:167]
    v_mfma_f32_16x16x32_bf16 v[168:171], v[72:75], a[184:187], v[168:171]
    v_mfma_f32_16x16x32_bf16 v[172:175], v[84:87], a[184:187], v[172:175]
    v_mfma_f32_16x16x32_bf16 v[176:179], v[72:75], a[208:211], v[176:179]
    v_mfma_f32_16x16x32_bf16 v[180:183], v[84:87], a[208:211], v[180:183]
    v_mfma_f32_16x16x32_bf16 v[184:187], v[72:75], a[232:235], v[184:187]
    v_mfma_f32_16x16x32_bf16 v[188:191], v[84:87], a[232:235], v[188:191]
    v_mfma_f32_16x16x32_bf16 v[112:115], v[96:99], a[20:23], v[112:115]
    v_mfma_f32_16x16x32_bf16 v[116:119], v[108:111], a[20:23], v[116:119]
    v_mfma_f32_16x16x32_bf16 v[120:123], v[96:99], a[44:47], v[120:123]
    v_mfma_f32_16x16x32_bf16 v[124:127], v[108:111], a[44:47], v[124:127]
    v_mfma_f32_16x16x32_bf16 v[128:131], v[96:99], a[68:71], v[128:131]
    v_mfma_f32_16x16x32_bf16 v[132:135], v[108:111], a[68:71], v[132:135]
    v_mfma_f32_16x16x32_bf16 v[136:139], v[96:99], a[92:95], v[136:139]
    v_mfma_f32_16x16x32_bf16 v[140:143], v[108:111], a[92:95], v[140:143]
    v_mfma_f32_16x16x32_bf16 v[144:147], v[96:99], a[116:119], v[144:147]
    v_mfma_f32_16x16x32_bf16 v[148:151], v[108:111], a[116:119], v[148:151]
    v_mfma_f32_16x16x32_bf16 v[152:155], v[96:99], a[140:143], v[152:155]
    v_mfma_f32_16x16x32_bf16 v[156:159], v[108:111], a[140:143], v[156:159]
    v_mfma_f32_16x16x32_bf16 v[160:163], v[96:99], a[164:167], v[160:163]
    v_mfma_f32_16x16x32_bf16 v[164:167], v[108:111], a[164:167], v[164:167]
    v_mfma_f32_16x16x32_bf16 v[168:171], v[96:99], a[188:191], v[168:171]
    v_mfma_f32_16x16x32_bf16 v[172:175], v[108:111], a[188:191], v[172:175]
    v_mfma_f32_16x16x32_bf16 v[176:179], v[96:99], a[212:215], v[176:179]
    v_mfma_f32_16x16x32_bf16 v[180:183], v[108:111], a[212:215], v[180:183]
    v_mfma_f32_16x16x32_bf16 v[184:187], v[96:99], a[236:239], v[184:187]
    v_mfma_f32_16x16x32_bf16 v[188:191], v[108:111], a[236:239], v[188:191]
    s_mov_b32 s46, s43
    v_cvt_pk_bf16_f32 v192, v112, v113
    v_cvt_pk_bf16_f32 v193, v114, v115
    v_cvt_pk_bf16_f32 v194, v116, v117
    v_cvt_pk_bf16_f32 v195, v118, v119
    buffer_store_dwordx4 v[192:195], v9, s[8:11], s46 offen sc1
    s_add_u32 s46, s46, 32768
    v_cvt_pk_bf16_f32 v196, v120, v121
    v_cvt_pk_bf16_f32 v197, v122, v123
    v_cvt_pk_bf16_f32 v198, v124, v125
    v_cvt_pk_bf16_f32 v199, v126, v127
    buffer_store_dwordx4 v[196:199], v9, s[8:11], s46 offen sc1
    s_add_u32 s46, s46, 32768
    v_cvt_pk_bf16_f32 v200, v128, v129
    v_cvt_pk_bf16_f32 v201, v130, v131
    v_cvt_pk_bf16_f32 v202, v132, v133
    v_cvt_pk_bf16_f32 v203, v134, v135
    buffer_store_dwordx4 v[200:203], v9, s[8:11], s46 offen sc1
    s_add_u32 s46, s46, 32768
    v_cvt_pk_bf16_f32 v204, v136, v137
    v_cvt_pk_bf16_f32 v205, v138, v139
    v_cvt_pk_bf16_f32 v206, v140, v141
    v_cvt_pk_bf16_f32 v207, v142, v143
    buffer_store_dwordx4 v[204:207], v9, s[8:11], s46 offen sc1
    s_add_u32 s46, s46, 32768
    v_cvt_pk_bf16_f32 v208, v144, v145
    v_cvt_pk_bf16_f32 v209, v146, v147
    v_cvt_pk_bf16_f32 v210, v148, v149
    v_cvt_pk_bf16_f32 v211, v150, v151
    buffer_store_dwordx4 v[208:211], v9, s[8:11], s46 offen sc1
    s_add_u32 s46, s46, 32768
    v_cvt_pk_bf16_f32 v212, v152, v153
    v_cvt_pk_bf16_f32 v213, v154, v155
    v_cvt_pk_bf16_f32 v214, v156, v157
    v_cvt_pk_bf16_f32 v215, v158, v159
    buffer_store_dwordx4 v[212:215], v9, s[8:11], s46 offen sc1
    s_add_u32 s46, s46, 32768
    v_cvt_pk_bf16_f32 v216, v160, v161
    v_cvt_pk_bf16_f32 v217, v162, v163
    v_cvt_pk_bf16_f32 v218, v164, v165
    v_cvt_pk_bf16_f32 v219, v166, v167
    buffer_store_dwordx4 v[216:219], v9, s[8:11], s46 offen sc1
    s_add_u32 s46, s46, 32768
    v_cvt_pk_bf16_f32 v220, v168, v169
    v_cvt_pk_bf16_f32 v221, v170, v171
    v_cvt_pk_bf16_f32 v222, v172, v173
    v_cvt_pk_bf16_f32 v223, v174, v175
    buffer_store_dwordx4 v[220:223], v9, s[8:11], s46 offen sc1
    s_add_u32 s46, s46, 32768
    v_cvt_pk_bf16_f32 v224, v176, v177
    v_cvt_pk_bf16_f32 v225, v178, v179
    v_cvt_pk_bf16_f32 v226, v180, v181
    v_cvt_pk_bf16_f32 v227, v182, v183
    buffer_store_dwordx4 v[224:227], v9, s[8:11], s46 offen sc1
    s_add_u32 s46, s46, 32768
    v_cvt_pk_bf16_f32 v228, v184, v185
    v_cvt_pk_bf16_f32 v229, v186, v187
    v_cvt_pk_bf16_f32 v230, v188, v189
    v_cvt_pk_bf16_f32 v231, v190, v191
    buffer_store_dwordx4 v[228:231], v9, s[8:11], s46 offen sc1
    s_waitcnt vmcnt(10)
    s_add_u32 s40, s40, 1
    s_add_u32 s43, s43, 1310720
    s_cmp_lt_u32 s40, 64
    s_cbranch_scc1 chain2_kernel_o_seg
    s_waitcnt vmcnt(0)
    s_barrier
    s_cmp_eq_u32 s3, 0
    s_cbranch_scc0 chain2_kernel_fp13
    v_mov_b32 v15, s40
    buffer_store_dword v15, v14, s[8:11], 0 offen sc1
chain2_kernel_fp13:
    s_branch chain2_kernel_end
chain2_kernel_end:
    s_endpgm
.section .rodata,"a"
.p2align 6
.amdhsa_kernel chain2_kernel
  .amdhsa_next_free_vgpr 512
  .amdhsa_next_free_sgpr 100
  .amdhsa_accum_offset 256
  .amdhsa_group_segment_fixed_size 0
  .amdhsa_kernarg_size 104
  .amdhsa_user_sgpr_count 2
  .amdhsa_user_sgpr_kernarg_segment_ptr 1
  .amdhsa_system_sgpr_workgroup_id_x 1
.end_amdhsa_kernel
```

```asm
; @launch kernel=interleave_layers__linear_attn_block__memory_aug_recurrent_mem_tr__prompt_kernel grid=(256,1,1) block=(256,1,1) lds=135168
.amdgcn_target "amdgcn-amd-amdhsa--gfx950"
.text
.globl interleave_layers__linear_attn_block__memory_aug_recurrent_mem_tr__prompt_kernel
.p2align 8
.type interleave_layers__linear_attn_block__memory_aug_recurrent_mem_tr__prompt_kernel,@function
interleave_layers__linear_attn_block__memory_aug_recurrent_mem_tr__prompt_kernel:
    s_cmp_ge_u32 s2, 256
    s_cbranch_scc1 interleave_layers__linear_attn_block__memory_aug_recurrent_mem_tr__prompt_kernel_end
    s_load_dwordx2 s[4:5], s[0:1], 96
    s_load_dwordx2 s[6:7], s[0:1], 88
    s_load_dwordx2 s[24:25], s[0:1], 0
    v_and_b32 v1, 63, v0
    v_lshrrev_b32 v4, 6, v0
    v_and_b32 v2, 15, v1
    v_lshrrev_b32 v3, 4, v1
    v_readfirstlane_b32 s3, v4
    s_mov_b32 s60, 131072
    s_mov_b32 s59, -1
    s_mov_b32 s92, 0
    s_waitcnt lgkmcnt(0)
    s_mov_b32 s8, s4
    s_mov_b32 s9, s5
    s_mov_b32 s10, 268435456
    s_mov_b32 s11, 0x00020000
    s_mov_b32 s72, s6
    s_mov_b32 s73, s7
    s_mov_b32 s74, 256
    s_mov_b32 s75, 0x00020000
    s_mov_b32 s16, s24
    s_mov_b32 s17, s25
    s_mov_b32 s18, 2621440
    s_mov_b32 s19, 0x00020000
    s_cmp_eq_u32 s2, 255
    s_cbranch_scc0 interleave_layers__linear_attn_block__memory_aug_recurrent_mem_tr__prompt_kernel_cf1
    v_lshlrev_b32 v5, 4, v0
    v_mov_b32 v8, -1
    v_mov_b32 v9, -1
    v_mov_b32 v10, -1
    v_mov_b32 v11, -1
    s_mov_b32 s24, 23068672
    buffer_store_dwordx4 v[8:11], v5, s[8:11], s24 offen sc1
    s_add_u32 s24, s24, 4096
    buffer_store_dwordx4 v[8:11], v5, s[8:11], s24 offen sc1
    s_add_u32 s24, s24, 4096
    buffer_store_dwordx4 v[8:11], v5, s[8:11], s24 offen sc1
    s_add_u32 s24, s24, 4096
    buffer_store_dwordx4 v[8:11], v5, s[8:11], s24 offen sc1
    s_add_u32 s24, s24, 4096
    buffer_store_dwordx4 v[8:11], v5, s[8:11], s24 offen sc1
    s_add_u32 s24, s24, 4096
    buffer_store_dwordx4 v[8:11], v5, s[8:11], s24 offen sc1
    s_add_u32 s24, s24, 4096
    buffer_store_dwordx4 v[8:11], v5, s[8:11], s24 offen sc1
    s_add_u32 s24, s24, 4096
    buffer_store_dwordx4 v[8:11], v5, s[8:11], s24 offen sc1
    s_add_u32 s24, s24, 4096
    buffer_store_dwordx4 v[8:11], v5, s[8:11], s24 offen sc1
    s_add_u32 s24, s24, 4096
    buffer_store_dwordx4 v[8:11], v5, s[8:11], s24 offen sc1
    s_add_u32 s24, s24, 4096
    buffer_store_dwordx4 v[8:11], v5, s[8:11], s24 offen sc1
    s_add_u32 s24, s24, 4096
    buffer_store_dwordx4 v[8:11], v5, s[8:11], s24 offen sc1
    s_add_u32 s24, s24, 4096
    buffer_store_dwordx4 v[8:11], v5, s[8:11], s24 offen sc1
    s_add_u32 s24, s24, 4096
    buffer_store_dwordx4 v[8:11], v5, s[8:11], s24 offen sc1
    s_add_u32 s24, s24, 4096
    buffer_store_dwordx4 v[8:11], v5, s[8:11], s24 offen sc1
    s_add_u32 s24, s24, 4096
    buffer_store_dwordx4 v[8:11], v5, s[8:11], s24 offen sc1
    s_add_u32 s24, s24, 4096
interleave_layers__linear_attn_block__memory_aug_recurrent_mem_tr__prompt_kernel_cf1:
    s_mov_b32 s46, 64
    s_mov_b32 s47, 32
    s_mov_b32 s50, 0
    s_and_b32 s44, s2, 7
    s_lshr_b32 s45, s2, 3
    s_lshl_b32 s48, s45, 1
    s_mov_b32 s49, 1
    s_mov_b32 s40, 2
interleave_layers__linear_attn_block__memory_aug_recurrent_mem_tr__prompt_kernel_k1_entry:
    s_load_dwordx2 s[6:7], s[0:1], 8
    s_lshr_b32 s24, s3, 1
    s_mul_i32 s24, s24, 20480
    s_and_b32 s25, s3, 1
    s_mul_i32 s25, s25, 10
    s_mul_i32 s25, s25, s46
    s_add_u32 s24, s24, s25
    s_cmp_eq_u32 s50, 1
    s_cselect_b32 s25, 16, 1280
    s_cselect_b32 s26, 256, 8
    v_mul_u32_u24 v4, s25, v2
    v_mul_u32_u24 v5, s26, v3
    v_add3_u32 v4, v4, v5, s24
    v_add_u32 v5, s47, v4
    s_mul_i32 s43, s48, 40960
    s_mul_i32 s42, s49, 40960
    s_mov_b32 s51, 0
    s_cmp_eq_u32 s92, 0
    s_cbranch_scc0 interleave_layers__linear_attn_block__memory_aug_recurrent_mem_tr__prompt_kernel_k12
    s_mov_b32 s41, s43
    s_mov_b32 s24, s41
    buffer_load_dwordx2 v[16:17], v4, s[16:19], s24 offen sc1
    buffer_load_dwordx2 v[18:19], v5, s[16:19], s24 offen sc1
    s_add_u32 s24, s24, s46
    buffer_load_dwordx2 v[20:21], v4, s[16:19], s24 offen sc1
    buffer_load_dwordx2 v[22:23], v5, s[16:19], s24 offen sc1
    s_add_u32 s24, s24, s46
    buffer_load_dwordx2 v[24:25], v4, s[16:19], s24 offen sc1
    buffer_load_dwordx2 v[26:27], v5, s[16:19], s24 offen sc1
    s_add_u32 s24, s24, s46
    buffer_load_dwordx2 v[28:29], v4, s[16:19], s24 offen sc1
    buffer_load_dwordx2 v[30:31], v5, s[16:19], s24 offen sc1
    s_add_u32 s24, s24, s46
    buffer_load_dwordx2 v[32:33], v4, s[16:19], s24 offen sc1
    buffer_load_dwordx2 v[34:35], v5, s[16:19], s24 offen sc1
    s_add_u32 s24, s24, s46
    buffer_load_dwordx2 v[36:37], v4, s[16:19], s24 offen sc1
    buffer_load_dwordx2 v[38:39], v5, s[16:19], s24 offen sc1
    s_add_u32 s24, s24, s46
    buffer_load_dwordx2 v[40:41], v4, s[16:19], s24 offen sc1
    buffer_load_dwordx2 v[42:43], v5, s[16:19], s24 offen sc1
    s_add_u32 s24, s24, s46
    buffer_load_dwordx2 v[44:45], v4, s[16:19], s24 offen sc1
    buffer_load_dwordx2 v[46:47], v5, s[16:19], s24 offen sc1
    s_add_u32 s24, s24, s46
    buffer_load_dwordx2 v[48:49], v4, s[16:19], s24 offen sc1
    buffer_load_dwordx2 v[50:51], v5, s[16:19], s24 offen sc1
    s_add_u32 s24, s24, s46
    buffer_load_dwordx2 v[52:53], v4, s[16:19], s24 offen sc1
    buffer_load_dwordx2 v[54:55], v5, s[16:19], s24 offen sc1
    s_mov_b32 s51, 1
interleave_layers__linear_attn_block__memory_aug_recurrent_mem_tr__prompt_kernel_k12:
    v_and_b32 v7, 31, v0
    v_lshrrev_b32 v8, 5, v0
    v_mul_u32_u24 v152, 3840, v8
    v_lshlrev_b32 v9, 4, v7
    v_add_u32 v152, v152, v9
    v_cmp_le_u32 vcc, 10, v7
    s_nop 1
    v_cndmask_b32 v10, 0, 1, vcc
    v_cmp_le_u32 vcc, 20, v7
    s_nop 1
    v_cndmask_b32 v11, 0, 1, vcc
    v_add_u32 v10, v10, v11
    v_mul_u32_u24 v10, 1120, v10
    v_add_u32 v152, v152, v10
    v_mov_b32 v10, 2146435072
    v_cmp_le_u32 vcc, 30, v7
    s_nop 1
    v_cndmask_b32 v152, v152, v10, vcc
    v_mul_u32_u24 v153, 544, v8
    v_add_u32 v153, v153, v9
    v_add_u32 v153, 40960, v153
    s_waitcnt lgkmcnt(0)
    s_mov_b32 s12, s6
    s_mov_b32 s13, s7
    s_mov_b32 s14, 2457600
    s_mov_b32 s15, 0x00020000
    s_mul_i32 s52, s44, 160
    s_add_u32 s24, s52, 0
    buffer_load_dwordx4 v[56:59], v152, s[12:15], s24 offen
    s_add_u32 s24, s24, 30720
    buffer_load_dwordx4 v[60:63], v152, s[12:15], s24 offen
    s_add_u32 s24, s24, 30720
    buffer_load_dwordx4 v[64:67], v152, s[12:15], s24 offen
    s_add_u32 s24, s24, 30720
    buffer_load_dwordx4 v[68:71], v152, s[12:15], s24 offen
    s_add_u32 s24, s24, 30720
    buffer_load_dwordx4 v[72:75], v152, s[12:15], s24 offen
    s_add_u32 s24, s24, 30720
    buffer_load_dwordx4 v[76:79], v152, s[12:15], s24 offen
    s_add_u32 s24, s24, 30720
    buffer_load_dwordx4 v[80:83], v152, s[12:15], s24 offen
    s_add_u32 s24, s24, 30720
    buffer_load_dwordx4 v[84:87], v152, s[12:15], s24 offen
    s_add_u32 s24, s52, 245760
    buffer_load_dwordx4 v[88:91], v152, s[12:15], s24 offen
    s_add_u32 s24, s24, 30720
    buffer_load_dwordx4 v[92:95], v152, s[12:15], s24 offen
    s_add_u32 s24, s24, 30720
    buffer_load_dwordx4 v[96:99], v152, s[12:15], s24 offen
    s_add_u32 s24, s24, 30720
    buffer_load_dwordx4 v[100:103], v152, s[12:15], s24 offen
    s_add_u32 s24, s24, 30720
    buffer_load_dwordx4 v[104:107], v152, s[12:15], s24 offen
    s_add_u32 s24, s24, 30720
    buffer_load_dwordx4 v[108:111], v152, s[12:15], s24 offen
    s_add_u32 s24, s24, 30720
    buffer_load_dwordx4 v[112:115], v152, s[12:15], s24 offen
    s_add_u32 s24, s24, 30720
    buffer_load_dwordx4 v[116:119], v152, s[12:15], s24 offen
    s_add_u32 s24, s52, 491520
    buffer_load_dwordx4 v[120:123], v152, s[12:15], s24 offen
    s_add_u32 s24, s24, 30720
    buffer_load_dwordx4 v[124:127], v152, s[12:15], s24 offen
    s_add_u32 s24, s24, 30720
    buffer_load_dwordx4 v[128:131], v152, s[12:15], s24 offen
    s_add_u32 s24, s24, 30720
    buffer_load_dwordx4 v[132:135], v152, s[12:15], s24 offen
    s_add_u32 s24, s24, 30720
    buffer_load_dwordx4 v[136:139], v152, s[12:15], s24 offen
    s_add_u32 s24, s24, 30720
    buffer_load_dwordx4 v[140:143], v152, s[12:15], s24 offen
    s_add_u32 s24, s24, 30720
    buffer_load_dwordx4 v[144:147], v152, s[12:15], s24 offen
    s_add_u32 s24, s24, 30720
    buffer_load_dwordx4 v[148:151], v152, s[12:15], s24 offen
    v_lshrrev_b32 v6, 2, v2
    v_lshl_add_u32 v6, v3, 2, v6
    v_mul_u32_u24 v6, 544, v6
    v_and_b32 v7, 3, v2
    v_lshl_add_u32 v6, v7, 3, v6
    v_add_u32 v6, 40960, v6
    s_mov_b32 s24, 0
    s_cmp_eq_u32 s3, 1
    s_cselect_b32 s24, 64, s24
    s_cmp_eq_u32 s3, 2
    s_cselect_b32 s24, 128, s24
    s_cmp_eq_u32 s3, 3
    s_cselect_b32 s24, 224, s24
    v_add_u32 v12, s24, v6
    s_mov_b32 s24, 32
    s_cmp_eq_u32 s3, 1
    s_cselect_b32 s24, 96, s24
    s_cmp_eq_u32 s3, 2
    s_cselect_b32 s24, 160, s24
    s_cmp_eq_u32 s3, 3
    s_cselect_b32 s24, 256, s24
    v_add_u32 v13, s24, v6
    s_mov_b32 s24, 320
    s_cmp_eq_u32 s3, 1
    s_cselect_b32 s24, 384, s24
    s_cmp_eq_u32 s3, 2
    s_cselect_b32 s24, 192, s24
    s_cmp_eq_u32 s3, 3
    s_cselect_b32 s24, 288, s24
    v_add_u32 v14, s24, v6
    s_mov_b32 s24, 352
    s_cmp_eq_u32 s3, 1
    s_cselect_b32 s24, 416, s24
    s_cmp_eq_u32 s3, 2
    s_cselect_b32 s24, 448, s24
    s_cmp_eq_u32 s3, 3
    s_cselect_b32 s24, 288, s24
    v_add_u32 v15, s24, v6
    v_mov_b32 v172, 0x3f803f80
    v_mov_b32 v173, 0x3f803f80
    v_mov_b32 v174, 0x3f803f80
    v_mov_b32 v175, 0x3f803f80
    s_waitcnt vmcnt(16)
    ds_write_b128 v153, v[56:59] offset:0
    ds_write_b128 v153, v[60:63] offset:4352
    ds_write_b128 v153, v[64:67] offset:8704
    ds_write_b128 v153, v[68:71] offset:13056
    ds_write_b128 v153, v[72:75] offset:17408
    ds_write_b128 v153, v[76:79] offset:21760
    ds_write_b128 v153, v[80:83] offset:26112
    ds_write_b128 v153, v[84:87] offset:30464
    s_waitcnt lgkmcnt(0)
    s_add_u32 s24, s52, 737280
    buffer_load_dwordx4 v[56:59], v152, s[12:15], s24 offen
    s_add_u32 s24, s24, 30720
    buffer_load_dwordx4 v[60:63], v152, s[12:15], s24 offen
    s_add_u32 s24, s24, 30720
    buffer_load_dwordx4 v[64:67], v152, s[12:15], s24 offen
    s_add_u32 s24, s24, 30720
    buffer_load_dwordx4 v[68:71], v152, s[12:15], s24 offen
    s_add_u32 s24, s24, 30720
    buffer_load_dwordx4 v[72:75], v152, s[12:15], s24 offen
    s_add_u32 s24, s24, 30720
    buffer_load_dwordx4 v[76:79], v152, s[12:15], s24 offen
    s_add_u32 s24, s24, 30720
    buffer_load_dwordx4 v[80:83], v152, s[12:15], s24 offen
    s_add_u32 s24, s24, 30720
    buffer_load_dwordx4 v[84:87], v152, s[12:15], s24 offen
    s_barrier
    s_cmp_eq_u32 s2, 255
    s_cbranch_scc0 interleave_layers__linear_attn_block__memory_aug_recurrent_mem_tr__prompt_kernel_fb3
    s_cmp_eq_u32 s92, 0
    s_cbranch_scc0 interleave_layers__linear_attn_block__memory_aug_recurrent_mem_tr__prompt_kernel_fb3
    s_cmp_eq_u32 s3, 0
    s_cbranch_scc0 interleave_layers__linear_attn_block__memory_aug_recurrent_mem_tr__prompt_kernel_fb3
    v_mov_b32 v154, 2146435072
    v_cmp_eq_u32 vcc, 0, v1
    s_nop 1
    v_cndmask_b32 v154, v154, 0, vcc
    v_mov_b32 v155, 1
    buffer_store_dword v155, v154, s[72:75], 0 offen sc1
interleave_layers__linear_attn_block__memory_aug_recurrent_mem_tr__prompt_kernel_fb3:
    ds_read_b64_tr_b16 a[0:1], v12 offset:0
    ds_read_b64_tr_b16 a[2:3], v12 offset:8704
    ds_read_b64_tr_b16 a[4:5], v12 offset:17408
    ds_read_b64_tr_b16 a[6:7], v12 offset:26112
    ds_read_b64_tr_b16 a[80:81], v13 offset:0
    ds_read_b64_tr_b16 a[82:83], v13 offset:8704
    ds_read_b64_tr_b16 a[84:85], v13 offset:17408
    ds_read_b64_tr_b16 a[86:87], v13 offset:26112
    ds_read_b64_tr_b16 a[160:161], v14 offset:0
    ds_read_b64_tr_b16 a[162:163], v14 offset:8704
    ds_read_b64_tr_b16 a[164:165], v14 offset:17408
    ds_read_b64_tr_b16 a[166:167], v14 offset:26112
    ds_read_b64_tr_b16 v[176:177], v15 offset:0
    ds_read_b64_tr_b16 v[178:179], v15 offset:8704
    ds_read_b64_tr_b16 v[180:181], v15 offset:17408
    ds_read_b64_tr_b16 v[182:183], v15 offset:26112
    s_waitcnt vmcnt(16)
    ds_write_b128 v153, v[88:91] offset:34816
    ds_write_b128 v153, v[92:95] offset:39168
    ds_write_b128 v153, v[96:99] offset:43520
    ds_write_b128 v153, v[100:103] offset:47872
    ds_write_b128 v153, v[104:107] offset:52224
    ds_write_b128 v153, v[108:111] offset:56576
    ds_write_b128 v153, v[112:115] offset:60928
    ds_write_b128 v153, v[116:119] offset:65280
    s_waitcnt lgkmcnt(0)
    s_add_u32 s24, s52, 983040
    buffer_load_dwordx4 v[88:91], v152, s[12:15], s24 offen
    s_add_u32 s24, s24, 30720
    buffer_load_dwordx4 v[92:95], v152, s[12:15], s24 offen
    s_add_u32 s24, s24, 30720
    buffer_load_dwordx4 v[96:99], v152, s[12:15], s24 offen
    s_add_u32 s24, s24, 30720
    buffer_load_dwordx4 v[100:103], v152, s[12:15], s24 offen
    s_add_u32 s24, s24, 30720
    buffer_load_dwordx4 v[104:107], v152, s[12:15], s24 offen
    s_add_u32 s24, s24, 30720
    buffer_load_dwordx4 v[108:111], v152, s[12:15], s24 offen
    s_add_u32 s24, s24, 30720
    buffer_load_dwordx4 v[112:115], v152, s[12:15], s24 offen
    s_add_u32 s24, s24, 30720
    buffer_load_dwordx4 v[116:119], v152, s[12:15], s24 offen
    v_mfma_f32_16x16x32_bf16 v[156:159], a[0:3], v[172:175], 0
    v_mfma_f32_16x16x32_bf16 v[160:163], a[80:83], v[172:175], 0
    v_mfma_f32_16x16x32_bf16 v[164:167], a[160:163], v[172:175], 0
    v_mfma_f32_16x16x32_bf16 v[168:171], v[176:179], v[172:175], 0
    v_mfma_f32_16x16x32_bf16 v[156:159], a[4:7], v[172:175], v[156:159]
    v_mfma_f32_16x16x32_bf16 v[160:163], a[84:87], v[172:175], v[160:163]
    v_mfma_f32_16x16x32_bf16 v[164:167], a[164:167], v[172:175], v[164:167]
    v_mfma_f32_16x16x32_bf16 v[168:171], v[180:183], v[172:175], v[168:171]
    s_barrier
    ds_read_b64_tr_b16 a[8:9], v12 offset:34816
    ds_read_b64_tr_b16 a[10:11], v12 offset:43520
    ds_read_b64_tr_b16 a[12:13], v12 offset:52224
    ds_read_b64_tr_b16 a[14:15], v12 offset:60928
    ds_read_b64_tr_b16 a[88:89], v13 offset:34816
    ds_read_b64_tr_b16 a[90:91], v13 offset:43520
    ds_read_b64_tr_b16 a[92:93], v13 offset:52224
    ds_read_b64_tr_b16 a[94:95], v13 offset:60928
    ds_read_b64_tr_b16 a[168:169], v14 offset:34816
    ds_read_b64_tr_b16 a[170:171], v14 offset:43520
    ds_read_b64_tr_b16 a[172:173], v14 offset:52224
    ds_read_b64_tr_b16 a[174:175], v14 offset:60928
    ds_read_b64_tr_b16 v[184:185], v15 offset:34816
    ds_read_b64_tr_b16 v[186:187], v15 offset:43520
    ds_read_b64_tr_b16 v[188:189], v15 offset:52224
    ds_read_b64_tr_b16 v[190:191], v15 offset:60928
    s_waitcnt vmcnt(16)
    ds_write_b128 v153, v[120:123] offset:0
    ds_write_b128 v153, v[124:127] offset:4352
    ds_write_b128 v153, v[128:131] offset:8704
    ds_write_b128 v153, v[132:135] offset:13056
    ds_write_b128 v153, v[136:139] offset:17408
    ds_write_b128 v153, v[140:143] offset:21760
    ds_write_b128 v153, v[144:147] offset:26112
    ds_write_b128 v153, v[148:151] offset:30464
    s_waitcnt lgkmcnt(0)
    s_add_u32 s24, s52, 1228800
    buffer_load_dwordx4 v[120:123], v152, s[12:15], s24 offen
    s_add_u32 s24, s24, 30720
    buffer_load_dwordx4 v[124:127], v152, s[12:15], s24 offen
    s_add_u32 s24, s24, 30720
    buffer_load_dwordx4 v[128:131], v152, s[12:15], s24 offen
    s_add_u32 s24, s24, 30720
    buffer_load_dwordx4 v[132:135], v152, s[12:15], s24 offen
    s_add_u32 s24, s24, 30720
    buffer_load_dwordx4 v[136:139], v152, s[12:15], s24 offen
    s_add_u32 s24, s24, 30720
    buffer_load_dwordx4 v[140:143], v152, s[12:15], s24 offen
    s_add_u32 s24, s24, 30720
    buffer_load_dwordx4 v[144:147], v152, s[12:15], s24 offen
    s_add_u32 s24, s24, 30720
    buffer_load_dwordx4 v[148:151], v152, s[12:15], s24 offen
    v_mfma_f32_16x16x32_bf16 v[156:159], a[8:11], v[172:175], v[156:159]
    v_mfma_f32_16x16x32_bf16 v[160:163], a[88:91], v[172:175], v[160:163]
    v_mfma_f32_16x16x32_bf16 v[164:167], a[168:171], v[172:175], v[164:167]
    v_mfma_f32_16x16x32_bf16 v[168:171], v[184:187], v[172:175], v[168:171]
    v_mfma_f32_16x16x32_bf16 v[156:159], a[12:15], v[172:175], v[156:159]
    v_mfma_f32_16x16x32_bf16 v[160:163], a[92:95], v[172:175], v[160:163]
    v_mfma_f32_16x16x32_bf16 v[164:167], a[172:175], v[172:175], v[164:167]
    v_mfma_f32_16x16x32_bf16 v[168:171], v[188:191], v[172:175], v[168:171]
    s_barrier
    ds_read_b64_tr_b16 a[16:17], v12 offset:0
    ds_read_b64_tr_b16 a[18:19], v12 offset:8704
    ds_read_b64_tr_b16 a[20:21], v12 offset:17408
    ds_read_b64_tr_b16 a[22:23], v12 offset:26112
    ds_read_b64_tr_b16 a[96:97], v13 offset:0
    ds_read_b64_tr_b16 a[98:99], v13 offset:8704
    ds_read_b64_tr_b16 a[100:101], v13 offset:17408
    ds_read_b64_tr_b16 a[102:103], v13 offset:26112
    ds_read_b64_tr_b16 a[176:177], v14 offset:0
    ds_read_b64_tr_b16 a[178:179], v14 offset:8704
    ds_read_b64_tr_b16 a[180:181], v14 offset:17408
    ds_read_b64_tr_b16 a[182:183], v14 offset:26112
    ds_read_b64_tr_b16 v[192:193], v15 offset:0
    ds_read_b64_tr_b16 v[194:195], v15 offset:8704
    ds_read_b64_tr_b16 v[196:197], v15 offset:17408
    ds_read_b64_tr_b16 v[198:199], v15 offset:26112
    s_waitcnt vmcnt(16)
    ds_write_b128 v153, v[56:59] offset:34816
    ds_write_b128 v153, v[60:63] offset:39168
    ds_write_b128 v153, v[64:67] offset:43520
    ds_write_b128 v153, v[68:71] offset:47872
    ds_write_b128 v153, v[72:75] offset:52224
    ds_write_b128 v153, v[76:79] offset:56576
    ds_write_b128 v153, v[80:83] offset:60928
    ds_write_b128 v153, v[84:87] offset:65280
    s_waitcnt lgkmcnt(0)
    s_add_u32 s24, s52, 1474560
    buffer_load_dwordx4 v[56:59], v152, s[12:15], s24 offen
    s_add_u32 s24, s24, 30720
    buffer_load_dwordx4 v[60:63], v152, s[12:15], s24 offen
    s_add_u32 s24, s24, 30720
    buffer_load_dwordx4 v[64:67], v152, s[12:15], s24 offen
    s_add_u32 s24, s24, 30720
    buffer_load_dwordx4 v[68:71], v152, s[12:15], s24 offen
    s_add_u32 s24, s24, 30720
    buffer_load_dwordx4 v[72:75], v152, s[12:15], s24 offen
    s_add_u32 s24, s24, 30720
    buffer_load_dwordx4 v[76:79], v152, s[12:15], s24 offen
    s_add_u32 s24, s24, 30720
    buffer_load_dwordx4 v[80:83], v152, s[12:15], s24 offen
    s_add_u32 s24, s24, 30720
    buffer_load_dwordx4 v[84:87], v152, s[12:15], s24 offen
    v_mfma_f32_16x16x32_bf16 v[156:159], a[16:19], v[172:175], v[156:159]
    v_mfma_f32_16x16x32_bf16 v[160:163], a[96:99], v[172:175], v[160:163]
    v_mfma_f32_16x16x32_bf16 v[164:167], a[176:179], v[172:175], v[164:167]
    v_mfma_f32_16x16x32_bf16 v[168:171], v[192:195], v[172:175], v[168:171]
    v_mfma_f32_16x16x32_bf16 v[156:159], a[20:23], v[172:175], v[156:159]
    v_mfma_f32_16x16x32_bf16 v[160:163], a[100:103], v[172:175], v[160:163]
    v_mfma_f32_16x16x32_bf16 v[164:167], a[180:183], v[172:175], v[164:167]
    v_mfma_f32_16x16x32_bf16 v[168:171], v[196:199], v[172:175], v[168:171]
    s_barrier
    ds_read_b64_tr_b16 a[24:25], v12 offset:34816
    ds_read_b64_tr_b16 a[26:27], v12 offset:43520
    ds_read_b64_tr_b16 a[28:29], v12 offset:52224
    ds_read_b64_tr_b16 a[30:31], v12 offset:60928
    ds_read_b64_tr_b16 a[104:105], v13 offset:34816
    ds_read_b64_tr_b16 a[106:107], v13 offset:43520
    ds_read_b64_tr_b16 a[108:109], v13 offset:52224
    ds_read_b64_tr_b16 a[110:111], v13 offset:60928
    ds_read_b64_tr_b16 a[184:185], v14 offset:34816
    ds_read_b64_tr_b16 a[186:187], v14 offset:43520
    ds_read_b64_tr_b16 a[188:189], v14 offset:52224
    ds_read_b64_tr_b16 a[190:191], v14 offset:60928
    ds_read_b64_tr_b16 v[200:201], v15 offset:34816
    ds_read_b64_tr_b16 v[202:203], v15 offset:43520
    ds_read_b64_tr_b16 v[204:205], v15 offset:52224
    ds_read_b64_tr_b16 v[206:207], v15 offset:60928
    s_waitcnt vmcnt(16)
    ds_write_b128 v153, v[88:91] offset:0
    ds_write_b128 v153, v[92:95] offset:4352
    ds_write_b128 v153, v[96:99] offset:8704
    ds_write_b128 v153, v[100:103] offset:13056
    ds_write_b128 v153, v[104:107] offset:17408
    ds_write_b128 v153, v[108:111] offset:21760
    ds_write_b128 v153, v[112:115] offset:26112
    ds_write_b128 v153, v[116:119] offset:30464
    s_waitcnt lgkmcnt(0)
    s_add_u32 s24, s52, 1720320
    buffer_load_dwordx4 v[88:91], v152, s[12:15], s24 offen
    s_add_u32 s24, s24, 30720
    buffer_load_dwordx4 v[92:95], v152, s[12:15], s24 offen
    s_add_u32 s24, s24, 30720
    buffer_load_dwordx4 v[96:99], v152, s[12:15], s24 offen
    s_add_u32 s24, s24, 30720
    buffer_load_dwordx4 v[100:103], v152, s[12:15], s24 offen
    s_add_u32 s24, s24, 30720
    buffer_load_dwordx4 v[104:107], v152, s[12:15], s24 offen
    s_add_u32 s24, s24, 30720
    buffer_load_dwordx4 v[108:111], v152, s[12:15], s24 offen
    s_add_u32 s24, s24, 30720
    buffer_load_dwordx4 v[112:115], v152, s[12:15], s24 offen
    s_add_u32 s24, s24, 30720
    buffer_load_dwordx4 v[116:119], v152, s[12:15], s24 offen
    v_mfma_f32_16x16x32_bf16 v[156:159], a[24:27], v[172:175], v[156:159]
    v_mfma_f32_16x16x32_bf16 v[160:163], a[104:107], v[172:175], v[160:163]
    v_mfma_f32_16x16x32_bf16 v[164:167], a[184:187], v[172:175], v[164:167]
    v_mfma_f32_16x16x32_bf16 v[168:171], v[200:203], v[172:175], v[168:171]
    v_mfma_f32_16x16x32_bf16 v[156:159], a[28:31], v[172:175], v[156:159]
    v_mfma_f32_16x16x32_bf16 v[160:163], a[108:111], v[172:175], v[160:163]
    v_mfma_f32_16x16x32_bf16 v[164:167], a[188:191], v[172:175], v[164:167]
    v_mfma_f32_16x16x32_bf16 v[168:171], v[204:207], v[172:175], v[168:171]
    s_barrier
    ds_read_b64_tr_b16 a[32:33], v12 offset:0
    ds_read_b64_tr_b16 a[34:35], v12 offset:8704
    ds_read_b64_tr_b16 a[36:37], v12 offset:17408
    ds_read_b64_tr_b16 a[38:39], v12 offset:26112
    ds_read_b64_tr_b16 a[112:113], v13 offset:0
    ds_read_b64_tr_b16 a[114:115], v13 offset:8704
    ds_read_b64_tr_b16 a[116:117], v13 offset:17408
    ds_read_b64_tr_b16 a[118:119], v13 offset:26112
    ds_read_b64_tr_b16 a[192:193], v14 offset:0
    ds_read_b64_tr_b16 a[194:195], v14 offset:8704
    ds_read_b64_tr_b16 a[196:197], v14 offset:17408
    ds_read_b64_tr_b16 a[198:199], v14 offset:26112
    ds_read_b64_tr_b16 v[208:209], v15 offset:0
    ds_read_b64_tr_b16 v[210:211], v15 offset:8704
    ds_read_b64_tr_b16 v[212:213], v15 offset:17408
    ds_read_b64_tr_b16 v[214:215], v15 offset:26112
    s_waitcnt vmcnt(16)
    ds_write_b128 v153, v[120:123] offset:34816
    ds_write_b128 v153, v[124:127] offset:39168
    ds_write_b128 v153, v[128:131] offset:43520
    ds_write_b128 v153, v[132:135] offset:47872
    ds_write_b128 v153, v[136:139] offset:52224
    ds_write_b128 v153, v[140:143] offset:56576
    ds_write_b128 v153, v[144:147] offset:60928
    ds_write_b128 v153, v[148:151] offset:65280
    s_waitcnt lgkmcnt(0)
    s_add_u32 s24, s52, 1966080
    buffer_load_dwordx4 v[120:123], v152, s[12:15], s24 offen
    s_add_u32 s24, s24, 30720
    buffer_load_dwordx4 v[124:127], v152, s[12:15], s24 offen
    s_add_u32 s24, s24, 30720
    buffer_load_dwordx4 v[128:131], v152, s[12:15], s24 offen
    s_add_u32 s24, s24, 30720
    buffer_load_dwordx4 v[132:135], v152, s[12:15], s24 offen
    s_add_u32 s24, s24, 30720
    buffer_load_dwordx4 v[136:139], v152, s[12:15], s24 offen
    s_add_u32 s24, s24, 30720
    buffer_load_dwordx4 v[140:143], v152, s[12:15], s24 offen
    s_add_u32 s24, s24, 30720
    buffer_load_dwordx4 v[144:147], v152, s[12:15], s24 offen
    s_add_u32 s24, s24, 30720
    buffer_load_dwordx4 v[148:151], v152, s[12:15], s24 offen
    v_mfma_f32_16x16x32_bf16 v[156:159], a[32:35], v[172:175], v[156:159]
    v_mfma_f32_16x16x32_bf16 v[160:163], a[112:115], v[172:175], v[160:163]
    v_mfma_f32_16x16x32_bf16 v[164:167], a[192:195], v[172:175], v[164:167]
    v_mfma_f32_16x16x32_bf16 v[168:171], v[208:211], v[172:175], v[168:171]
    v_mfma_f32_16x16x32_bf16 v[156:159], a[36:39], v[172:175], v[156:159]
    v_mfma_f32_16x16x32_bf16 v[160:163], a[116:119], v[172:175], v[160:163]
    v_mfma_f32_16x16x32_bf16 v[164:167], a[196:199], v[172:175], v[164:167]
    v_mfma_f32_16x16x32_bf16 v[168:171], v[212:215], v[172:175], v[168:171]
    s_barrier
    ds_read_b64_tr_b16 a[40:41], v12 offset:34816
    ds_read_b64_tr_b16 a[42:43], v12 offset:43520
    ds_read_b64_tr_b16 a[44:45], v12 offset:52224
    ds_read_b64_tr_b16 a[46:47], v12 offset:60928
    ds_read_b64_tr_b16 a[120:121], v13 offset:34816
    ds_read_b64_tr_b16 a[122:123], v13 offset:43520
    ds_read_b64_tr_b16 a[124:125], v13 offset:52224
    ds_read_b64_tr_b16 a[126:127], v13 offset:60928
    ds_read_b64_tr_b16 a[200:201], v14 offset:34816
    ds_read_b64_tr_b16 a[202:203], v14 offset:43520
    ds_read_b64_tr_b16 a[204:205], v14 offset:52224
    ds_read_b64_tr_b16 a[206:207], v14 offset:60928
    ds_read_b64_tr_b16 v[216:217], v15 offset:34816
    ds_read_b64_tr_b16 v[218:219], v15 offset:43520
    ds_read_b64_tr_b16 v[220:221], v15 offset:52224
    ds_read_b64_tr_b16 v[222:223], v15 offset:60928
    s_waitcnt vmcnt(16)
    ds_write_b128 v153, v[56:59] offset:0
    ds_write_b128 v153, v[60:63] offset:4352
    ds_write_b128 v153, v[64:67] offset:8704
    ds_write_b128 v153, v[68:71] offset:13056
    ds_write_b128 v153, v[72:75] offset:17408
    ds_write_b128 v153, v[76:79] offset:21760
    ds_write_b128 v153, v[80:83] offset:26112
    ds_write_b128 v153, v[84:87] offset:30464
    s_waitcnt lgkmcnt(0)
    s_add_u32 s24, s52, 2211840
    buffer_load_dwordx4 v[56:59], v152, s[12:15], s24 offen
    s_add_u32 s24, s24, 30720
    buffer_load_dwordx4 v[60:63], v152, s[12:15], s24 offen
    s_add_u32 s24, s24, 30720
    buffer_load_dwordx4 v[64:67], v152, s[12:15], s24 offen
    s_add_u32 s24, s24, 30720
    buffer_load_dwordx4 v[68:71], v152, s[12:15], s24 offen
    s_add_u32 s24, s24, 30720
    buffer_load_dwordx4 v[72:75], v152, s[12:15], s24 offen
    s_add_u32 s24, s24, 30720
    buffer_load_dwordx4 v[76:79], v152, s[12:15], s24 offen
    s_add_u32 s24, s24, 30720
    buffer_load_dwordx4 v[80:83], v152, s[12:15], s24 offen
    s_add_u32 s24, s24, 30720
    buffer_load_dwordx4 v[84:87], v152, s[12:15], s24 offen
    v_mfma_f32_16x16x32_bf16 v[156:159], a[40:43], v[172:175], v[156:159]
    v_mfma_f32_16x16x32_bf16 v[160:163], a[120:123], v[172:175], v[160:163]
    v_mfma_f32_16x16x32_bf16 v[164:167], a[200:203], v[172:175], v[164:167]
    v_mfma_f32_16x16x32_bf16 v[168:171], v[216:219], v[172:175], v[168:171]
    v_mfma_f32_16x16x32_bf16 v[156:159], a[44:47], v[172:175], v[156:159]
    v_mfma_f32_16x16x32_bf16 v[160:163], a[124:127], v[172:175], v[160:163]
    v_mfma_f32_16x16x32_bf16 v[164:167], a[204:207], v[172:175], v[164:167]
    v_mfma_f32_16x16x32_bf16 v[168:171], v[220:223], v[172:175], v[168:171]
    s_barrier
    ds_read_b64_tr_b16 a[48:49], v12 offset:0
    ds_read_b64_tr_b16 a[50:51], v12 offset:8704
    ds_read_b64_tr_b16 a[52:53], v12 offset:17408
    ds_read_b64_tr_b16 a[54:55], v12 offset:26112
    ds_read_b64_tr_b16 a[128:129], v13 offset:0
    ds_read_b64_tr_b16 a[130:131], v13 offset:8704
    ds_read_b64_tr_b16 a[132:133], v13 offset:17408
    ds_read_b64_tr_b16 a[134:135], v13 offset:26112
    ds_read_b64_tr_b16 a[208:209], v14 offset:0
    ds_read_b64_tr_b16 a[210:211], v14 offset:8704
    ds_read_b64_tr_b16 a[212:213], v14 offset:17408
    ds_read_b64_tr_b16 a[214:215], v14 offset:26112
    ds_read_b64_tr_b16 v[224:225], v15 offset:0
    ds_read_b64_tr_b16 v[226:227], v15 offset:8704
    ds_read_b64_tr_b16 v[228:229], v15 offset:17408
    ds_read_b64_tr_b16 v[230:231], v15 offset:26112
    s_waitcnt vmcnt(16)
    ds_write_b128 v153, v[88:91] offset:34816
    ds_write_b128 v153, v[92:95] offset:39168
    ds_write_b128 v153, v[96:99] offset:43520
    ds_write_b128 v153, v[100:103] offset:47872
    ds_write_b128 v153, v[104:107] offset:52224
    ds_write_b128 v153, v[108:111] offset:56576
    ds_write_b128 v153, v[112:115] offset:60928
    ds_write_b128 v153, v[116:119] offset:65280
    s_waitcnt lgkmcnt(0)
    v_mfma_f32_16x16x32_bf16 v[156:159], a[48:51], v[172:175], v[156:159]
    v_mfma_f32_16x16x32_bf16 v[160:163], a[128:131], v[172:175], v[160:163]
    v_mfma_f32_16x16x32_bf16 v[164:167], a[208:211], v[172:175], v[164:167]
    v_mfma_f32_16x16x32_bf16 v[168:171], v[224:227], v[172:175], v[168:171]
    v_mfma_f32_16x16x32_bf16 v[156:159], a[52:55], v[172:175], v[156:159]
    v_mfma_f32_16x16x32_bf16 v[160:163], a[132:135], v[172:175], v[160:163]
    v_mfma_f32_16x16x32_bf16 v[164:167], a[212:215], v[172:175], v[164:167]
    v_mfma_f32_16x16x32_bf16 v[168:171], v[228:231], v[172:175], v[168:171]
    s_barrier
    ds_read_b64_tr_b16 a[56:57], v12 offset:34816
    ds_read_b64_tr_b16 a[58:59], v12 offset:43520
    ds_read_b64_tr_b16 a[60:61], v12 offset:52224
    ds_read_b64_tr_b16 a[62:63], v12 offset:60928
    ds_read_b64_tr_b16 a[136:137], v13 offset:34816
    ds_read_b64_tr_b16 a[138:139], v13 offset:43520
    ds_read_b64_tr_b16 a[140:141], v13 offset:52224
    ds_read_b64_tr_b16 a[142:143], v13 offset:60928
    ds_read_b64_tr_b16 a[216:217], v14 offset:34816
    ds_read_b64_tr_b16 a[218:219], v14 offset:43520
    ds_read_b64_tr_b16 a[220:221], v14 offset:52224
    ds_read_b64_tr_b16 a[222:223], v14 offset:60928
    ds_read_b64_tr_b16 v[232:233], v15 offset:34816
    ds_read_b64_tr_b16 v[234:235], v15 offset:43520
    ds_read_b64_tr_b16 v[236:237], v15 offset:52224
    ds_read_b64_tr_b16 v[238:239], v15 offset:60928
    s_waitcnt vmcnt(8)
    ds_write_b128 v153, v[120:123] offset:0
    ds_write_b128 v153, v[124:127] offset:4352
    ds_write_b128 v153, v[128:131] offset:8704
    ds_write_b128 v153, v[132:135] offset:13056
    ds_write_b128 v153, v[136:139] offset:17408
    ds_write_b128 v153, v[140:143] offset:21760
    ds_write_b128 v153, v[144:147] offset:26112
    ds_write_b128 v153, v[148:151] offset:30464
    s_waitcnt lgkmcnt(0)
    v_mfma_f32_16x16x32_bf16 v[156:159], a[56:59], v[172:175], v[156:159]
    v_mfma_f32_16x16x32_bf16 v[160:163], a[136:139], v[172:175], v[160:163]
    v_mfma_f32_16x16x32_bf16 v[164:167], a[216:219], v[172:175], v[164:167]
    v_mfma_f32_16x16x32_bf16 v[168:171], v[232:235], v[172:175], v[168:171]
    v_mfma_f32_16x16x32_bf16 v[156:159], a[60:63], v[172:175], v[156:159]
    v_mfma_f32_16x16x32_bf16 v[160:163], a[140:143], v[172:175], v[160:163]
    v_mfma_f32_16x16x32_bf16 v[164:167], a[220:223], v[172:175], v[164:167]
    v_mfma_f32_16x16x32_bf16 v[168:171], v[236:239], v[172:175], v[168:171]
    s_barrier
    ds_read_b64_tr_b16 a[64:65], v12 offset:0
    ds_read_b64_tr_b16 a[66:67], v12 offset:8704
    ds_read_b64_tr_b16 a[68:69], v12 offset:17408
    ds_read_b64_tr_b16 a[70:71], v12 offset:26112
    ds_read_b64_tr_b16 a[144:145], v13 offset:0
    ds_read_b64_tr_b16 a[146:147], v13 offset:8704
    ds_read_b64_tr_b16 a[148:149], v13 offset:17408
    ds_read_b64_tr_b16 a[150:151], v13 offset:26112
    ds_read_b64_tr_b16 a[224:225], v14 offset:0
    ds_read_b64_tr_b16 a[226:227], v14 offset:8704
    ds_read_b64_tr_b16 a[228:229], v14 offset:17408
    ds_read_b64_tr_b16 a[230:231], v14 offset:26112
    ds_read_b64_tr_b16 v[240:241], v15 offset:0
    ds_read_b64_tr_b16 v[242:243], v15 offset:8704
    ds_read_b64_tr_b16 v[244:245], v15 offset:17408
    ds_read_b64_tr_b16 v[246:247], v15 offset:26112
    s_waitcnt vmcnt(0)
    ds_write_b128 v153, v[56:59] offset:34816
    ds_write_b128 v153, v[60:63] offset:39168
    ds_write_b128 v153, v[64:67] offset:43520
    ds_write_b128 v153, v[68:71] offset:47872
    ds_write_b128 v153, v[72:75] offset:52224
    ds_write_b128 v153, v[76:79] offset:56576
    ds_write_b128 v153, v[80:83] offset:60928
    ds_write_b128 v153, v[84:87] offset:65280
    s_waitcnt lgkmcnt(0)
    v_mfma_f32_16x16x32_bf16 v[156:159], a[64:67], v[172:175], v[156:159]
    v_mfma_f32_16x16x32_bf16 v[160:163], a[144:147], v[172:175], v[160:163]
    v_mfma_f32_16x16x32_bf16 v[164:167], a[224:227], v[172:175], v[164:167]
    v_mfma_f32_16x16x32_bf16 v[168:171], v[240:243], v[172:175], v[168:171]
    v_mfma_f32_16x16x32_bf16 v[156:159], a[68:71], v[172:175], v[156:159]
    v_mfma_f32_16x16x32_bf16 v[160:163], a[148:151], v[172:175], v[160:163]
    v_mfma_f32_16x16x32_bf16 v[164:167], a[228:231], v[172:175], v[164:167]
    v_mfma_f32_16x16x32_bf16 v[168:171], v[244:247], v[172:175], v[168:171]
    s_barrier
    ds_read_b64_tr_b16 a[72:73], v12 offset:34816
    ds_read_b64_tr_b16 a[74:75], v12 offset:43520
    ds_read_b64_tr_b16 a[76:77], v12 offset:52224
    ds_read_b64_tr_b16 a[78:79], v12 offset:60928
    ds_read_b64_tr_b16 a[152:153], v13 offset:34816
    ds_read_b64_tr_b16 a[154:155], v13 offset:43520
    ds_read_b64_tr_b16 a[156:157], v13 offset:52224
    ds_read_b64_tr_b16 a[158:159], v13 offset:60928
    ds_read_b64_tr_b16 a[232:233], v14 offset:34816
    ds_read_b64_tr_b16 a[234:235], v14 offset:43520
    ds_read_b64_tr_b16 a[236:237], v14 offset:52224
    ds_read_b64_tr_b16 a[238:239], v14 offset:60928
    ds_read_b64_tr_b16 v[248:249], v15 offset:34816
    ds_read_b64_tr_b16 v[250:251], v15 offset:43520
    ds_read_b64_tr_b16 v[252:253], v15 offset:52224
    ds_read_b64_tr_b16 v[254:255], v15 offset:60928
    s_cmp_eq_u32 s92, 0
    s_cbranch_scc0 interleave_layers__linear_attn_block__memory_aug_recurrent_mem_tr__prompt_kernel_ri4
    v_mov_b32 v15, 0
    buffer_load_dword v14, v15, s[72:75], 0 offen sc1
interleave_layers__linear_attn_block__memory_aug_recurrent_mem_tr__prompt_kernel_ri4:
    v_lshlrev_b32 v7, 4, v1
    s_lshr_b32 s24, s3, 1
    s_mul_i32 s24, s24, 20
    s_and_b32 s25, s3, 1
    s_mul_i32 s25, s25, 10
    s_add_u32 s24, s24, s25
    s_lshl_b32 s24, s24, 10
    v_add_u32 v6, s24, v7
    s_lshr_b32 s24, s3, 1
    s_lshl_b32 s24, s24, 8
    s_and_b32 s25, s3, 1
    s_lshl_b32 s25, s25, 3
    s_add_u32 s24, s24, s25
    s_add_u32 s24, s24, 51712
    v_lshlrev_b32 v9, 4, v2
    v_add_u32 v8, s24, v9
    v_add_u32 v9, 51712, v9
    v_mul_u32_u24 v10, 336, v2
    v_lshl_add_u32 v10, v3, 3, v10
    v_add_u32 v10, 40960, v10
    v_lshrrev_b32 v11, 2, v2
    v_lshl_add_u32 v11, v3, 3, v11
    v_mul_u32_u24 v11, 336, v11
    v_and_b32 v15, 3, v2
    v_lshl_add_u32 v11, v15, 3, v11
    s_lshl_b32 s24, s3, 5
    s_add_u32 s24, s24, 40960
    v_add_u32 v11, s24, v11
    s_lshl_b32 s24, s3, 10
    v_add_u32 v12, s24, v7
    v_lshlrev_b32 v15, 3, v1
    v_add_u32 v15, 2048, v15
    s_cmp_eq_u32 s3, 2
    s_cselect_b64 vcc, -1, 0
    v_cndmask_b32 v12, v12, v15, vcc
    s_mul_i32 s24, s44, 2560
    s_add_u32 s24, s24, 12582912
    v_add_u32 v12, s24, v12
    s_mov_b32 s52, 0x3fb8aa3b
    s_mov_b32 s53, s52
    s_mov_b32 s54, 0x358637bd
    s_mov_b32 s55, s54
    v_mov_b32 v120, 0
    v_mov_b32 v121, 0
    v_mov_b32 v122, 0
    v_mov_b32 v123, 0
    v_mov_b32 v124, 0
    v_mov_b32 v125, 0
    v_mov_b32 v126, 0
    v_mov_b32 v127, 0
    v_mov_b32 v128, 0
    v_mov_b32 v129, 0
    v_mov_b32 v130, 0
    v_mov_b32 v131, 0
    v_mov_b32 v132, 0
    v_mov_b32 v133, 0
    v_mov_b32 v134, 0
    v_mov_b32 v135, 0
    v_mov_b32 v136, 0
    v_mov_b32 v137, 0
    v_mov_b32 v138, 0
    v_mov_b32 v139, 0
    v_mov_b32 v140, 0
    v_mov_b32 v141, 0
    v_mov_b32 v142, 0
    v_mov_b32 v143, 0
    s_waitcnt lgkmcnt(0)
    v_mfma_f32_16x16x32_bf16 v[156:159], a[72:75], v[172:175], v[156:159]
    v_mfma_f32_16x16x32_bf16 v[160:163], a[152:155], v[172:175], v[160:163]
    v_mfma_f32_16x16x32_bf16 v[164:167], a[232:235], v[172:175], v[164:167]
    v_mfma_f32_16x16x32_bf16 v[168:171], v[248:251], v[172:175], v[168:171]
    v_mfma_f32_16x16x32_bf16 v[156:159], a[76:79], v[172:175], v[156:159]
    v_mfma_f32_16x16x32_bf16 v[160:163], a[156:159], v[172:175], v[160:163]
    v_mfma_f32_16x16x32_bf16 v[164:167], a[236:239], v[172:175], v[164:167]
    v_mfma_f32_16x16x32_bf16 v[168:171], v[252:255], v[172:175], v[168:171]
    s_cmp_eq_u32 s92, 0
    s_cbranch_scc0 interleave_layers__linear_attn_block__memory_aug_recurrent_mem_tr__prompt_kernel_rc5_ok
    s_mov_b32 s61, 0
interleave_layers__linear_attn_block__memory_aug_recurrent_mem_tr__prompt_kernel_rc5:
    s_waitcnt vmcnt(0)
    v_readfirstlane_b32 s24, v14
    s_cmp_eq_u32 s24, 1
    s_cbranch_scc1 interleave_layers__linear_attn_block__memory_aug_recurrent_mem_tr__prompt_kernel_rc5_ok
    s_add_u32 s61, s61, 1
    s_cmp_ge_u32 s61, s60
    s_cbranch_scc1 interleave_layers__linear_attn_block__memory_aug_recurrent_mem_tr__prompt_kernel_rc5_to
    s_sleep 2
    v_mov_b32 v15, 0
    buffer_load_dword v14, v15, s[72:75], 0 offen sc1
    s_branch interleave_layers__linear_attn_block__memory_aug_recurrent_mem_tr__prompt_kernel_rc5
interleave_layers__linear_attn_block__memory_aug_recurrent_mem_tr__prompt_kernel_rc5_to:
    s_mov_b32 s60, 1
interleave_layers__linear_attn_block__memory_aug_recurrent_mem_tr__prompt_kernel_rc5_ok:
interleave_layers__linear_attn_block__memory_aug_recurrent_mem_tr__prompt_kernel_k1_seg:
    s_cmp_eq_u32 s51, 1
    s_cbranch_scc1 interleave_layers__linear_attn_block__memory_aug_recurrent_mem_tr__prompt_kernel_k16
    s_and_b32 s24, s48, 3
    s_lshl_b32 s24, s24, 7
    s_add_u32 s24, s24, 23107584
    v_lshlrev_b32 v15, 2, v1
    v_add_u32 v15, s24, v15
    s_lshr_b32 s95, s48, 2
    s_add_u32 s95, s95, 1
    s_mov_b32 s61, 0
interleave_layers__linear_attn_block__memory_aug_recurrent_mem_tr__prompt_kernel_k1_wx:
    buffer_load_dword v14, v15, s[8:11], 0 offen sc1
    s_waitcnt vmcnt(0)
    v_cmp_le_i32 vcc, s95, v14
    s_mov_b32 s25, 0xfffff
    s_and_b32 s24, vcc_lo, s25
    s_cmp_eq_u32 s24, s25
    s_cbranch_scc1 interleave_layers__linear_attn_block__memory_aug_recurrent_mem_tr__prompt_kernel_k1_wx_ok
    s_add_u32 s61, s61, 1
    s_cmp_ge_u32 s61, s60
    s_cbranch_scc1 interleave_layers__linear_attn_block__memory_aug_recurrent_mem_tr__prompt_kernel_k1_wx_to
    s_sleep 4
    s_branch interleave_layers__linear_attn_block__memory_aug_recurrent_mem_tr__prompt_kernel_k1_wx
interleave_layers__linear_attn_block__memory_aug_recurrent_mem_tr__prompt_kernel_k1_wx_to:
    s_mov_b32 s60, 1
interleave_layers__linear_attn_block__memory_aug_recurrent_mem_tr__prompt_kernel_k1_wx_ok:
    s_mov_b32 s41, s43
    s_mov_b32 s24, s41
    buffer_load_dwordx2 v[16:17], v4, s[16:19], s24 offen sc1
    buffer_load_dwordx2 v[18:19], v5, s[16:19], s24 offen sc1
    s_add_u32 s24, s24, s46
    buffer_load_dwordx2 v[20:21], v4, s[16:19], s24 offen sc1
    buffer_load_dwordx2 v[22:23], v5, s[16:19], s24 offen sc1
    s_add_u32 s24, s24, s46
    buffer_load_dwordx2 v[24:25], v4, s[16:19], s24 offen sc1
    buffer_load_dwordx2 v[26:27], v5, s[16:19], s24 offen sc1
    s_add_u32 s24, s24, s46
    buffer_load_dwordx2 v[28:29], v4, s[16:19], s24 offen sc1
    buffer_load_dwordx2 v[30:31], v5, s[16:19], s24 offen sc1
    s_add_u32 s24, s24, s46
    buffer_load_dwordx2 v[32:33], v4, s[16:19], s24 offen sc1
    buffer_load_dwordx2 v[34:35], v5, s[16:19], s24 offen sc1
    s_add_u32 s24, s24, s46
    buffer_load_dwordx2 v[36:37], v4, s[16:19], s24 offen sc1
    buffer_load_dwordx2 v[38:39], v5, s[16:19], s24 offen sc1
    s_add_u32 s24, s24, s46
    buffer_load_dwordx2 v[40:41], v4, s[16:19], s24 offen sc1
    buffer_load_dwordx2 v[42:43], v5, s[16:19], s24 offen sc1
    s_add_u32 s24, s24, s46
    buffer_load_dwordx2 v[44:45], v4, s[16:19], s24 offen sc1
    buffer_load_dwordx2 v[46:47], v5, s[16:19], s24 offen sc1
    s_add_u32 s24, s24, s46
    buffer_load_dwordx2 v[48:49], v4, s[16:19], s24 offen sc1
    buffer_load_dwordx2 v[50:51], v5, s[16:19], s24 offen sc1
    s_add_u32 s24, s24, s46
    buffer_load_dwordx2 v[52:53], v4, s[16:19], s24 offen sc1
    buffer_load_dwordx2 v[54:55], v5, s[16:19], s24 offen sc1
interleave_layers__linear_attn_block__memory_aug_recurrent_mem_tr__prompt_kernel_k16:
    s_waitcnt vmcnt(0)
    v_mov_b32 v148, 0
    v_mov_b32 v149, 0
    v_mov_b32 v150, 0
    v_mov_b32 v151, 0
    v_dot2c_f32_bf16 v148, v16, v172
    v_dot2c_f32_bf16 v149, v16, v16
    v_dot2c_f32_bf16 v150, v17, v172
    v_dot2c_f32_bf16 v151, v17, v17
    v_dot2c_f32_bf16 v148, v18, v172
    v_dot2c_f32_bf16 v149, v18, v18
    v_dot2c_f32_bf16 v150, v19, v172
    v_dot2c_f32_bf16 v151, v19, v19
    v_dot2c_f32_bf16 v148, v20, v172
    v_dot2c_f32_bf16 v149, v20, v20
    v_dot2c_f32_bf16 v150, v21, v172
    v_dot2c_f32_bf16 v151, v21, v21
    v_dot2c_f32_bf16 v148, v22, v172
    v_dot2c_f32_bf16 v149, v22, v22
    v_dot2c_f32_bf16 v150, v23, v172
    v_dot2c_f32_bf16 v151, v23, v23
    v_dot2c_f32_bf16 v148, v24, v172
    v_dot2c_f32_bf16 v149, v24, v24
    v_dot2c_f32_bf16 v150, v25, v172
    v_dot2c_f32_bf16 v151, v25, v25
    v_dot2c_f32_bf16 v148, v26, v172
    v_dot2c_f32_bf16 v149, v26, v26
    v_dot2c_f32_bf16 v150, v27, v172
    v_dot2c_f32_bf16 v151, v27, v27
    v_dot2c_f32_bf16 v148, v28, v172
    v_dot2c_f32_bf16 v149, v28, v28
    v_dot2c_f32_bf16 v150, v29, v172
    v_dot2c_f32_bf16 v151, v29, v29
    v_dot2c_f32_bf16 v148, v30, v172
    v_dot2c_f32_bf16 v149, v30, v30
    v_dot2c_f32_bf16 v150, v31, v172
    v_dot2c_f32_bf16 v151, v31, v31
    v_dot2c_f32_bf16 v148, v32, v172
    v_dot2c_f32_bf16 v149, v32, v32
    v_dot2c_f32_bf16 v150, v33, v172
    v_dot2c_f32_bf16 v151, v33, v33
    v_dot2c_f32_bf16 v148, v34, v172
    v_dot2c_f32_bf16 v149, v34, v34
    v_dot2c_f32_bf16 v150, v35, v172
    v_dot2c_f32_bf16 v151, v35, v35
    v_dot2c_f32_bf16 v148, v36, v172
    v_dot2c_f32_bf16 v149, v36, v36
    v_dot2c_f32_bf16 v150, v37, v172
    v_dot2c_f32_bf16 v151, v37, v37
    v_dot2c_f32_bf16 v148, v38, v172
    v_dot2c_f32_bf16 v149, v38, v38
    v_dot2c_f32_bf16 v150, v39, v172
    v_dot2c_f32_bf16 v151, v39, v39
    v_dot2c_f32_bf16 v148, v40, v172
    v_dot2c_f32_bf16 v149, v40, v40
    v_dot2c_f32_bf16 v150, v41, v172
    v_dot2c_f32_bf16 v151, v41, v41
    v_dot2c_f32_bf16 v148, v42, v172
    v_dot2c_f32_bf16 v149, v42, v42
    v_dot2c_f32_bf16 v150, v43, v172
    v_dot2c_f32_bf16 v151, v43, v43
    v_dot2c_f32_bf16 v148, v44, v172
    v_dot2c_f32_bf16 v149, v44, v44
    v_dot2c_f32_bf16 v150, v45, v172
    v_dot2c_f32_bf16 v151, v45, v45
    v_dot2c_f32_bf16 v148, v46, v172
    v_dot2c_f32_bf16 v149, v46, v46
    v_dot2c_f32_bf16 v150, v47, v172
    v_dot2c_f32_bf16 v151, v47, v47
    v_dot2c_f32_bf16 v148, v48, v172
    v_dot2c_f32_bf16 v149, v48, v48
    v_dot2c_f32_bf16 v150, v49, v172
    v_dot2c_f32_bf16 v151, v49, v49
    v_dot2c_f32_bf16 v148, v50, v172
    v_dot2c_f32_bf16 v149, v50, v50
    v_dot2c_f32_bf16 v150, v51, v172
    v_dot2c_f32_bf16 v151, v51, v51
    v_dot2c_f32_bf16 v148, v52, v172
    v_dot2c_f32_bf16 v149, v52, v52
    v_dot2c_f32_bf16 v150, v53, v172
    v_dot2c_f32_bf16 v151, v53, v53
    v_dot2c_f32_bf16 v148, v54, v172
    v_dot2c_f32_bf16 v149, v54, v54
    v_dot2c_f32_bf16 v150, v55, v172
    v_dot2c_f32_bf16 v151, v55, v55
    s_nop 1
    v_add_f32 v148, v148, v150
    v_add_f32 v149, v149, v151
    v_mov_b32 v150, v148
    v_mov_b32 v151, v149
    s_nop 0
    v_permlane16_swap_b32 v148, v150
    v_permlane16_swap_b32 v149, v151
    v_add_f32 v148, v148, v150
    v_add_f32 v149, v149, v151
    v_mov_b32 v150, v148
    v_mov_b32 v151, v149
    s_nop 0
    v_permlane32_swap_b32 v148, v150
    v_permlane32_swap_b32 v149, v151
    v_add_f32 v148, v148, v150
    v_add_f32 v149, v149, v151
    ds_write_b128 v6, v[16:19] offset:0
    ds_write_b128 v6, v[20:23] offset:1024
    ds_write_b128 v6, v[24:27] offset:2048
    ds_write_b128 v6, v[28:31] offset:3072
    ds_write_b128 v6, v[32:35] offset:4096
    ds_write_b128 v6, v[36:39] offset:5120
    ds_write_b128 v6, v[40:43] offset:6144
    ds_write_b128 v6, v[44:47] offset:7168
    ds_write_b128 v6, v[48:51] offset:8192
    ds_write_b128 v6, v[52:55] offset:9216
    ds_write_b64 v8, v[148:149]
    s_mov_b32 s51, 0
    s_waitcnt lgkmcnt(0)
    s_cmp_eq_u32 s92, 0
    s_cbranch_scc0 interleave_layers__linear_attn_block__memory_aug_recurrent_mem_tr__prompt_kernel_k17
    s_cmp_gt_u32 s40, 1
    s_cbranch_scc0 interleave_layers__linear_attn_block__memory_aug_recurrent_mem_tr__prompt_kernel_k17
    s_add_u32 s41, s43, s42
    s_mov_b32 s24, s41
    buffer_load_dwordx2 v[16:17], v4, s[16:19], s24 offen sc1
    buffer_load_dwordx2 v[18:19], v5, s[16:19], s24 offen sc1
    s_add_u32 s24, s24, s46
    buffer_load_dwordx2 v[20:21], v4, s[16:19], s24 offen sc1
    buffer_load_dwordx2 v[22:23], v5, s[16:19], s24 offen sc1
    s_add_u32 s24, s24, s46
    buffer_load_dwordx2 v[24:25], v4, s[16:19], s24 offen sc1
    buffer_load_dwordx2 v[26:27], v5, s[16:19], s24 offen sc1
    s_add_u32 s24, s24, s46
    buffer_load_dwordx2 v[28:29], v4, s[16:19], s24 offen sc1
    buffer_load_dwordx2 v[30:31], v5, s[16:19], s24 offen sc1
    s_add_u32 s24, s24, s46
    buffer_load_dwordx2 v[32:33], v4, s[16:19], s24 offen sc1
    buffer_load_dwordx2 v[34:35], v5, s[16:19], s24 offen sc1
    s_add_u32 s24, s24, s46
    buffer_load_dwordx2 v[36:37], v4, s[16:19], s24 offen sc1
    buffer_load_dwordx2 v[38:39], v5, s[16:19], s24 offen sc1
    s_add_u32 s24, s24, s46
    buffer_load_dwordx2 v[40:41], v4, s[16:19], s24 offen sc1
    buffer_load_dwordx2 v[42:43], v5, s[16:19], s24 offen sc1
    s_add_u32 s24, s24, s46
    buffer_load_dwordx2 v[44:45], v4, s[16:19], s24 offen sc1
    buffer_load_dwordx2 v[46:47], v5, s[16:19], s24 offen sc1
    s_add_u32 s24, s24, s46
    buffer_load_dwordx2 v[48:49], v4, s[16:19], s24 offen sc1
    buffer_load_dwordx2 v[50:51], v5, s[16:19], s24 offen sc1
    s_add_u32 s24, s24, s46
    buffer_load_dwordx2 v[52:53], v4, s[16:19], s24 offen sc1
    buffer_load_dwordx2 v[54:55], v5, s[16:19], s24 offen sc1
    s_mov_b32 s51, 1
interleave_layers__linear_attn_block__memory_aug_recurrent_mem_tr__prompt_kernel_k17:
    s_barrier
    ds_read_b128 v[148:151], v9
    ds_read_b128 v[152:155], v9 offset:256
    ds_read_b128 v[56:59], v7 offset:0
    ds_read_b128 v[60:63], v7 offset:20480
    ds_read_b128 v[64:67], v7 offset:1024
    ds_read_b128 v[68:71], v7 offset:21504
    ds_read_b128 v[72:75], v7 offset:2048
    ds_read_b128 v[76:79], v7 offset:22528
    s_waitcnt lgkmcnt(6)
    v_add_f32 v148, v148, v150
    v_add_f32 v149, v149, v151
    v_mul_f32 v148, 0x3acccccd, v148
    v_mul_f32 v150, v148, v148
    v_mov_b32 v151, 0x3acccccd
    v_fma_f32 v149, v149, v151, -v150
    v_max_f32 v149, 0, v149
    v_add_f32 v149, 0x3727c5ac, v149
    v_rsq_f32 v144, v149
    s_nop 0
    v_mul_f32 v145, v148, v144
    v_sub_f32 v145, 0, v145
    v_add_f32 v152, v152, v154
    v_add_f32 v153, v153, v155
    v_mul_f32 v152, 0x3acccccd, v152
    v_mul_f32 v154, v152, v152
    v_mov_b32 v155, 0x3acccccd
    v_fma_f32 v153, v153, v155, -v154
    v_max_f32 v153, 0, v153
    v_add_f32 v153, 0x3727c5ac, v153
    v_rsq_f32 v146, v153
    s_nop 0
    v_mul_f32 v147, v152, v146
    v_sub_f32 v147, 0, v147
    ds_read_b128 v[80:83], v7 offset:3072
    ds_read_b128 v[84:87], v7 offset:23552
    s_waitcnt lgkmcnt(6)
    v_mfma_f32_16x16x32_bf16 v[88:91], a[0:3], v[56:59], 0
    v_mfma_f32_16x16x32_bf16 v[96:99], a[80:83], v[56:59], 0
    v_mfma_f32_16x16x32_bf16 v[104:107], a[160:163], v[56:59], 0
    v_mfma_f32_16x16x32_bf16 v[112:115], v[176:179], v[56:59], 0
    v_mfma_f32_16x16x32_bf16 v[92:95], a[0:3], v[60:63], 0
    v_mfma_f32_16x16x32_bf16 v[100:103], a[80:83], v[60:63], 0
    v_mfma_f32_16x16x32_bf16 v[108:111], a[160:163], v[60:63], 0
    v_mfma_f32_16x16x32_bf16 v[116:119], v[176:179], v[60:63], 0
    ds_read_b128 v[56:59], v7 offset:4096
    ds_read_b128 v[60:63], v7 offset:24576
    s_waitcnt lgkmcnt(6)
    v_mfma_f32_16x16x32_bf16 v[88:91], a[4:7], v[64:67], v[88:91]
    v_mfma_f32_16x16x32_bf16 v[96:99], a[84:87], v[64:67], v[96:99]
    v_mfma_f32_16x16x32_bf16 v[104:107], a[164:167], v[64:67], v[104:107]
    v_mfma_f32_16x16x32_bf16 v[112:115], v[180:183], v[64:67], v[112:115]
    v_mfma_f32_16x16x32_bf16 v[92:95], a[4:7], v[68:71], v[92:95]
    v_mfma_f32_16x16x32_bf16 v[100:103], a[84:87], v[68:71], v[100:103]
    v_mfma_f32_16x16x32_bf16 v[108:111], a[164:167], v[68:71], v[108:111]
    v_mfma_f32_16x16x32_bf16 v[116:119], v[180:183], v[68:71], v[116:119]
    ds_read_b128 v[64:67], v7 offset:5120
    ds_read_b128 v[68:71], v7 offset:25600
    s_waitcnt lgkmcnt(6)
    v_mfma_f32_16x16x32_bf16 v[88:91], a[8:11], v[72:75], v[88:91]
    v_mfma_f32_16x16x32_bf16 v[96:99], a[88:91], v[72:75], v[96:99]
    v_mfma_f32_16x16x32_bf16 v[104:107], a[168:171], v[72:75], v[104:107]
    v_mfma_f32_16x16x32_bf16 v[112:115], v[184:187], v[72:75], v[112:115]
    v_mfma_f32_16x16x32_bf16 v[92:95], a[8:11], v[76:79], v[92:95]
    v_mfma_f32_16x16x32_bf16 v[100:103], a[88:91], v[76:79], v[100:103]
    v_mfma_f32_16x16x32_bf16 v[108:111], a[168:171], v[76:79], v[108:111]
    v_mfma_f32_16x16x32_bf16 v[116:119], v[184:187], v[76:79], v[116:119]
    ds_read_b128 v[72:75], v7 offset:6144
    ds_read_b128 v[76:79], v7 offset:26624
    s_waitcnt lgkmcnt(6)
    v_mfma_f32_16x16x32_bf16 v[88:91], a[12:15], v[80:83], v[88:91]
    v_mfma_f32_16x16x32_bf16 v[96:99], a[92:95], v[80:83], v[96:99]
    v_mfma_f32_16x16x32_bf16 v[104:107], a[172:175], v[80:83], v[104:107]
    v_mfma_f32_16x16x32_bf16 v[112:115], v[188:191], v[80:83], v[112:115]
    v_mfma_f32_16x16x32_bf16 v[92:95], a[12:15], v[84:87], v[92:95]
    v_mfma_f32_16x16x32_bf16 v[100:103], a[92:95], v[84:87], v[100:103]
    v_mfma_f32_16x16x32_bf16 v[108:111], a[172:175], v[84:87], v[108:111]
    v_mfma_f32_16x16x32_bf16 v[116:119], v[188:191], v[84:87], v[116:119]
    ds_read_b128 v[80:83], v7 offset:7168
    ds_read_b128 v[84:87], v7 offset:27648
    s_waitcnt lgkmcnt(6)
    v_mfma_f32_16x16x32_bf16 v[88:91], a[16:19], v[56:59], v[88:91]
    v_mfma_f32_16x16x32_bf16 v[96:99], a[96:99], v[56:59], v[96:99]
    v_mfma_f32_16x16x32_bf16 v[104:107], a[176:179], v[56:59], v[104:107]
    v_mfma_f32_16x16x32_bf16 v[112:115], v[192:195], v[56:59], v[112:115]
    v_mfma_f32_16x16x32_bf16 v[92:95], a[16:19], v[60:63], v[92:95]
    v_mfma_f32_16x16x32_bf16 v[100:103], a[96:99], v[60:63], v[100:103]
    v_mfma_f32_16x16x32_bf16 v[108:111], a[176:179], v[60:63], v[108:111]
    v_mfma_f32_16x16x32_bf16 v[116:119], v[192:195], v[60:63], v[116:119]
    ds_read_b128 v[56:59], v7 offset:8192
    ds_read_b128 v[60:63], v7 offset:28672
    s_waitcnt lgkmcnt(6)
    v_mfma_f32_16x16x32_bf16 v[88:91], a[20:23], v[64:67], v[88:91]
    v_mfma_f32_16x16x32_bf16 v[96:99], a[100:103], v[64:67], v[96:99]
    v_mfma_f32_16x16x32_bf16 v[104:107], a[180:183], v[64:67], v[104:107]
    v_mfma_f32_16x16x32_bf16 v[112:115], v[196:199], v[64:67], v[112:115]
    v_mfma_f32_16x16x32_bf16 v[92:95], a[20:23], v[68:71], v[92:95]
    v_mfma_f32_16x16x32_bf16 v[100:103], a[100:103], v[68:71], v[100:103]
    v_mfma_f32_16x16x32_bf16 v[108:111], a[180:183], v[68:71], v[108:111]
    v_mfma_f32_16x16x32_bf16 v[116:119], v[196:199], v[68:71], v[116:119]
    ds_read_b128 v[64:67], v7 offset:9216
    ds_read_b128 v[68:71], v7 offset:29696
    s_waitcnt lgkmcnt(6)
    v_mfma_f32_16x16x32_bf16 v[88:91], a[24:27], v[72:75], v[88:91]
    v_mfma_f32_16x16x32_bf16 v[96:99], a[104:107], v[72:75], v[96:99]
    v_mfma_f32_16x16x32_bf16 v[104:107], a[184:187], v[72:75], v[104:107]
    v_mfma_f32_16x16x32_bf16 v[112:115], v[200:203], v[72:75], v[112:115]
    v_mfma_f32_16x16x32_bf16 v[92:95], a[24:27], v[76:79], v[92:95]
    v_mfma_f32_16x16x32_bf16 v[100:103], a[104:107], v[76:79], v[100:103]
    v_mfma_f32_16x16x32_bf16 v[108:111], a[184:187], v[76:79], v[108:111]
    v_mfma_f32_16x16x32_bf16 v[116:119], v[200:203], v[76:79], v[116:119]
    ds_read_b128 v[72:75], v7 offset:10240
    ds_read_b128 v[76:79], v7 offset:30720
    s_waitcnt lgkmcnt(6)
    v_mfma_f32_16x16x32_bf16 v[88:91], a[28:31], v[80:83], v[88:91]
    v_mfma_f32_16x16x32_bf16 v[96:99], a[108:111], v[80:83], v[96:99]
    v_mfma_f32_16x16x32_bf16 v[104:107], a[188:191], v[80:83], v[104:107]
    v_mfma_f32_16x16x32_bf16 v[112:115], v[204:207], v[80:83], v[112:115]
    v_mfma_f32_16x16x32_bf16 v[92:95], a[28:31], v[84:87], v[92:95]
    v_mfma_f32_16x16x32_bf16 v[100:103], a[108:111], v[84:87], v[100:103]
    v_mfma_f32_16x16x32_bf16 v[108:111], a[188:191], v[84:87], v[108:111]
    v_mfma_f32_16x16x32_bf16 v[116:119], v[204:207], v[84:87], v[116:119]
    ds_read_b128 v[80:83], v7 offset:11264
    ds_read_b128 v[84:87], v7 offset:31744
    s_waitcnt lgkmcnt(6)
    v_mfma_f32_16x16x32_bf16 v[88:91], a[32:35], v[56:59], v[88:91]
    v_mfma_f32_16x16x32_bf16 v[96:99], a[112:115], v[56:59], v[96:99]
    v_mfma_f32_16x16x32_bf16 v[104:107], a[192:195], v[56:59], v[104:107]
    v_mfma_f32_16x16x32_bf16 v[112:115], v[208:211], v[56:59], v[112:115]
    v_mfma_f32_16x16x32_bf16 v[92:95], a[32:35], v[60:63], v[92:95]
    v_mfma_f32_16x16x32_bf16 v[100:103], a[112:115], v[60:63], v[100:103]
    v_mfma_f32_16x16x32_bf16 v[108:111], a[192:195], v[60:63], v[108:111]
    v_mfma_f32_16x16x32_bf16 v[116:119], v[208:211], v[60:63], v[116:119]
    ds_read_b128 v[56:59], v7 offset:12288
    ds_read_b128 v[60:63], v7 offset:32768
    s_waitcnt lgkmcnt(6)
    v_mfma_f32_16x16x32_bf16 v[88:91], a[36:39], v[64:67], v[88:91]
    v_mfma_f32_16x16x32_bf16 v[96:99], a[116:119], v[64:67], v[96:99]
    v_mfma_f32_16x16x32_bf16 v[104:107], a[196:199], v[64:67], v[104:107]
    v_mfma_f32_16x16x32_bf16 v[112:115], v[212:215], v[64:67], v[112:115]
    v_mfma_f32_16x16x32_bf16 v[92:95], a[36:39], v[68:71], v[92:95]
    v_mfma_f32_16x16x32_bf16 v[100:103], a[116:119], v[68:71], v[100:103]
    v_mfma_f32_16x16x32_bf16 v[108:111], a[196:199], v[68:71], v[108:111]
    v_mfma_f32_16x16x32_bf16 v[116:119], v[212:215], v[68:71], v[116:119]
    ds_read_b128 v[64:67], v7 offset:13312
    ds_read_b128 v[68:71], v7 offset:33792
    s_waitcnt lgkmcnt(6)
    v_mfma_f32_16x16x32_bf16 v[88:91], a[40:43], v[72:75], v[88:91]
    v_mfma_f32_16x16x32_bf16 v[96:99], a[120:123], v[72:75], v[96:99]
    v_mfma_f32_16x16x32_bf16 v[104:107], a[200:203], v[72:75], v[104:107]
    v_mfma_f32_16x16x32_bf16 v[112:115], v[216:219], v[72:75], v[112:115]
    v_mfma_f32_16x16x32_bf16 v[92:95], a[40:43], v[76:79], v[92:95]
    v_mfma_f32_16x16x32_bf16 v[100:103], a[120:123], v[76:79], v[100:103]
    v_mfma_f32_16x16x32_bf16 v[108:111], a[200:203], v[76:79], v[108:111]
    v_mfma_f32_16x16x32_bf16 v[116:119], v[216:219], v[76:79], v[116:119]
    ds_read_b128 v[72:75], v7 offset:14336
    ds_read_b128 v[76:79], v7 offset:34816
    s_waitcnt lgkmcnt(6)
    v_mfma_f32_16x16x32_bf16 v[88:91], a[44:47], v[80:83], v[88:91]
    v_mfma_f32_16x16x32_bf16 v[96:99], a[124:127], v[80:83], v[96:99]
    v_mfma_f32_16x16x32_bf16 v[104:107], a[204:207], v[80:83], v[104:107]
    v_mfma_f32_16x16x32_bf16 v[112:115], v[220:223], v[80:83], v[112:115]
    v_mfma_f32_16x16x32_bf16 v[92:95], a[44:47], v[84:87], v[92:95]
    v_mfma_f32_16x16x32_bf16 v[100:103], a[124:127], v[84:87], v[100:103]
    v_mfma_f32_16x16x32_bf16 v[108:111], a[204:207], v[84:87], v[108:111]
    v_mfma_f32_16x16x32_bf16 v[116:119], v[220:223], v[84:87], v[116:119]
    ds_read_b128 v[80:83], v7 offset:15360
    ds_read_b128 v[84:87], v7 offset:35840
    s_waitcnt lgkmcnt(6)
    v_mfma_f32_16x16x32_bf16 v[88:91], a[48:51], v[56:59], v[88:91]
    v_mfma_f32_16x16x32_bf16 v[96:99], a[128:131], v[56:59], v[96:99]
    v_mfma_f32_16x16x32_bf16 v[104:107], a[208:211], v[56:59], v[104:107]
    v_mfma_f32_16x16x32_bf16 v[112:115], v[224:227], v[56:59], v[112:115]
    v_mfma_f32_16x16x32_bf16 v[92:95], a[48:51], v[60:63], v[92:95]
    v_mfma_f32_16x16x32_bf16 v[100:103], a[128:131], v[60:63], v[100:103]
    v_mfma_f32_16x16x32_bf16 v[108:111], a[208:211], v[60:63], v[108:111]
    v_mfma_f32_16x16x32_bf16 v[116:119], v[224:227], v[60:63], v[116:119]
    ds_read_b128 v[56:59], v7 offset:16384
    ds_read_b128 v[60:63], v7 offset:36864
    s_waitcnt lgkmcnt(6)
    v_mfma_f32_16x16x32_bf16 v[88:91], a[52:55], v[64:67], v[88:91]
    v_mfma_f32_16x16x32_bf16 v[96:99], a[132:135], v[64:67], v[96:99]
    v_mfma_f32_16x16x32_bf16 v[104:107], a[212:215], v[64:67], v[104:107]
    v_mfma_f32_16x16x32_bf16 v[112:115], v[228:231], v[64:67], v[112:115]
    v_mfma_f32_16x16x32_bf16 v[92:95], a[52:55], v[68:71], v[92:95]
    v_mfma_f32_16x16x32_bf16 v[100:103], a[132:135], v[68:71], v[100:103]
    v_mfma_f32_16x16x32_bf16 v[108:111], a[212:215], v[68:71], v[108:111]
    v_mfma_f32_16x16x32_bf16 v[116:119], v[228:231], v[68:71], v[116:119]
    ds_read_b128 v[64:67], v7 offset:17408
    ds_read_b128 v[68:71], v7 offset:37888
    s_waitcnt lgkmcnt(6)
    v_mfma_f32_16x16x32_bf16 v[88:91], a[56:59], v[72:75], v[88:91]
    v_mfma_f32_16x16x32_bf16 v[96:99], a[136:139], v[72:75], v[96:99]
    v_mfma_f32_16x16x32_bf16 v[104:107], a[216:219], v[72:75], v[104:107]
    v_mfma_f32_16x16x32_bf16 v[112:115], v[232:235], v[72:75], v[112:115]
    v_mfma_f32_16x16x32_bf16 v[92:95], a[56:59], v[76:79], v[92:95]
    v_mfma_f32_16x16x32_bf16 v[100:103], a[136:139], v[76:79], v[100:103]
    v_mfma_f32_16x16x32_bf16 v[108:111], a[216:219], v[76:79], v[108:111]
    v_mfma_f32_16x16x32_bf16 v[116:119], v[232:235], v[76:79], v[116:119]
    ds_read_b128 v[72:75], v7 offset:18432
    ds_read_b128 v[76:79], v7 offset:38912
    s_waitcnt lgkmcnt(6)
    v_mfma_f32_16x16x32_bf16 v[88:91], a[60:63], v[80:83], v[88:91]
    v_mfma_f32_16x16x32_bf16 v[96:99], a[140:143], v[80:83], v[96:99]
    v_mfma_f32_16x16x32_bf16 v[104:107], a[220:223], v[80:83], v[104:107]
    v_mfma_f32_16x16x32_bf16 v[112:115], v[236:239], v[80:83], v[112:115]
    v_mfma_f32_16x16x32_bf16 v[92:95], a[60:63], v[84:87], v[92:95]
    v_mfma_f32_16x16x32_bf16 v[100:103], a[140:143], v[84:87], v[100:103]
    v_mfma_f32_16x16x32_bf16 v[108:111], a[220:223], v[84:87], v[108:111]
    v_mfma_f32_16x16x32_bf16 v[116:119], v[236:239], v[84:87], v[116:119]
    ds_read_b128 v[80:83], v7 offset:19456
    ds_read_b128 v[84:87], v7 offset:39936
    s_waitcnt lgkmcnt(6)
    v_mfma_f32_16x16x32_bf16 v[88:91], a[64:67], v[56:59], v[88:91]
    v_mfma_f32_16x16x32_bf16 v[96:99], a[144:147], v[56:59], v[96:99]
    v_mfma_f32_16x16x32_bf16 v[104:107], a[224:227], v[56:59], v[104:107]
    v_mfma_f32_16x16x32_bf16 v[112:115], v[240:243], v[56:59], v[112:115]
    v_mfma_f32_16x16x32_bf16 v[92:95], a[64:67], v[60:63], v[92:95]
    v_mfma_f32_16x16x32_bf16 v[100:103], a[144:147], v[60:63], v[100:103]
    v_mfma_f32_16x16x32_bf16 v[108:111], a[224:227], v[60:63], v[108:111]
    v_mfma_f32_16x16x32_bf16 v[116:119], v[240:243], v[60:63], v[116:119]
    s_waitcnt lgkmcnt(4)
    v_mfma_f32_16x16x32_bf16 v[88:91], a[68:71], v[64:67], v[88:91]
    v_mfma_f32_16x16x32_bf16 v[96:99], a[148:151], v[64:67], v[96:99]
    v_mfma_f32_16x16x32_bf16 v[104:107], a[228:231], v[64:67], v[104:107]
    v_mfma_f32_16x16x32_bf16 v[112:115], v[244:247], v[64:67], v[112:115]
    v_mfma_f32_16x16x32_bf16 v[92:95], a[68:71], v[68:71], v[92:95]
    v_mfma_f32_16x16x32_bf16 v[100:103], a[148:151], v[68:71], v[100:103]
    v_mfma_f32_16x16x32_bf16 v[108:111], a[228:231], v[68:71], v[108:111]
    v_mfma_f32_16x16x32_bf16 v[116:119], v[244:247], v[68:71], v[116:119]
    s_waitcnt lgkmcnt(2)
    v_mfma_f32_16x16x32_bf16 v[88:91], a[72:75], v[72:75], v[88:91]
    v_mfma_f32_16x16x32_bf16 v[96:99], a[152:155], v[72:75], v[96:99]
    v_mfma_f32_16x16x32_bf16 v[104:107], a[232:235], v[72:75], v[104:107]
    v_mfma_f32_16x16x32_bf16 v[112:115], v[248:251], v[72:75], v[112:115]
    v_mfma_f32_16x16x32_bf16 v[92:95], a[72:75], v[76:79], v[92:95]
    v_mfma_f32_16x16x32_bf16 v[100:103], a[152:155], v[76:79], v[100:103]
    v_mfma_f32_16x16x32_bf16 v[108:111], a[232:235], v[76:79], v[108:111]
    v_mfma_f32_16x16x32_bf16 v[116:119], v[248:251], v[76:79], v[116:119]
    s_waitcnt lgkmcnt(0)
    v_mfma_f32_16x16x32_bf16 v[88:91], a[76:79], v[80:83], v[88:91]
    v_mfma_f32_16x16x32_bf16 v[96:99], a[156:159], v[80:83], v[96:99]
    v_mfma_f32_16x16x32_bf16 v[104:107], a[236:239], v[80:83], v[104:107]
    v_mfma_f32_16x16x32_bf16 v[112:115], v[252:255], v[80:83], v[112:115]
    v_mfma_f32_16x16x32_bf16 v[92:95], a[76:79], v[84:87], v[92:95]
    v_mfma_f32_16x16x32_bf16 v[100:103], a[156:159], v[84:87], v[100:103]
    v_mfma_f32_16x16x32_bf16 v[108:111], a[236:239], v[84:87], v[108:111]
    v_mfma_f32_16x16x32_bf16 v[116:119], v[252:255], v[84:87], v[116:119]
    v_pk_mul_f32 v[148:149], v[156:157], v[144:145] op_sel:[0,1] op_sel_hi:[1,1]
    v_pk_mul_f32 v[150:151], v[158:159], v[144:145] op_sel:[0,1] op_sel_hi:[1,1]
    v_pk_fma_f32 v[88:89], v[88:89], v[144:145], v[148:149] op_sel:[0,0,0] op_sel_hi:[1,0,1]
    v_pk_fma_f32 v[90:91], v[90:91], v[144:145], v[150:151] op_sel:[0,0,0] op_sel_hi:[1,0,1]
    v_pk_mul_f32 v[148:149], v[156:157], v[146:147] op_sel:[0,1] op_sel_hi:[1,1]
    v_pk_mul_f32 v[150:151], v[158:159], v[146:147] op_sel:[0,1] op_sel_hi:[1,1]
    v_pk_fma_f32 v[92:93], v[92:93], v[146:147], v[148:149] op_sel:[0,0,0] op_sel_hi:[1,0,1]
    v_pk_fma_f32 v[94:95], v[94:95], v[146:147], v[150:151] op_sel:[0,0,0] op_sel_hi:[1,0,1]
    v_pk_mul_f32 v[148:149], v[160:161], v[144:145] op_sel:[0,1] op_sel_hi:[1,1]
    v_pk_mul_f32 v[150:151], v[162:163], v[144:145] op_sel:[0,1] op_sel_hi:[1,1]
    v_pk_fma_f32 v[96:97], v[96:97], v[144:145], v[148:149] op_sel:[0,0,0] op_sel_hi:[1,0,1]
    v_pk_fma_f32 v[98:99], v[98:99], v[144:145], v[150:151] op_sel:[0,0,0] op_sel_hi:[1,0,1]
    v_pk_mul_f32 v[148:149], v[160:161], v[146:147] op_sel:[0,1] op_sel_hi:[1,1]
    v_pk_mul_f32 v[150:151], v[162:163], v[146:147] op_sel:[0,1] op_sel_hi:[1,1]
    v_pk_fma_f32 v[100:101], v[100:101], v[146:147], v[148:149] op_sel:[0,0,0] op_sel_hi:[1,0,1]
    v_pk_fma_f32 v[102:103], v[102:103], v[146:147], v[150:151] op_sel:[0,0,0] op_sel_hi:[1,0,1]
    v_pk_mul_f32 v[148:149], v[164:165], v[144:145] op_sel:[0,1] op_sel_hi:[1,1]
    v_pk_mul_f32 v[150:151], v[166:167], v[144:145] op_sel:[0,1] op_sel_hi:[1,1]
    v_pk_fma_f32 v[104:105], v[104:105], v[144:145], v[148:149] op_sel:[0,0,0] op_sel_hi:[1,0,1]
    v_pk_fma_f32 v[106:107], v[106:107], v[144:145], v[150:151] op_sel:[0,0,0] op_sel_hi:[1,0,1]
    v_pk_mul_f32 v[148:149], v[164:165], v[146:147] op_sel:[0,1] op_sel_hi:[1,1]
    v_pk_mul_f32 v[150:151], v[166:167], v[146:147] op_sel:[0,1] op_sel_hi:[1,1]
    v_pk_fma_f32 v[108:109], v[108:109], v[146:147], v[148:149] op_sel:[0,0,0] op_sel_hi:[1,0,1]
    v_pk_fma_f32 v[110:111], v[110:111], v[146:147], v[150:151] op_sel:[0,0,0] op_sel_hi:[1,0,1]
    v_pk_mul_f32 v[148:149], v[168:169], v[144:145] op_sel:[0,1] op_sel_hi:[1,1]
    v_pk_mul_f32 v[150:151], v[170:171], v[144:145] op_sel:[0,1] op_sel_hi:[1,1]
    v_pk_fma_f32 v[112:113], v[112:113], v[144:145], v[148:149] op_sel:[0,0,0] op_sel_hi:[1,0,1]
    v_pk_fma_f32 v[114:115], v[114:115], v[144:145], v[150:151] op_sel:[0,0,0] op_sel_hi:[1,0,1]
    v_pk_mul_f32 v[148:149], v[168:169], v[146:147] op_sel:[0,1] op_sel_hi:[1,1]
    v_pk_mul_f32 v[150:151], v[170:171], v[146:147] op_sel:[0,1] op_sel_hi:[1,1]
    v_pk_fma_f32 v[116:117], v[116:117], v[146:147], v[148:149] op_sel:[0,0,0] op_sel_hi:[1,0,1]
    v_pk_fma_f32 v[118:119], v[118:119], v[146:147], v[150:151] op_sel:[0,0,0] op_sel_hi:[1,0,1]
    s_add_u32 s25, s43, 20480
    s_cmp_ge_u32 s3, 2
    s_cbranch_scc1 interleave_layers__linear_attn_block__memory_aug_recurrent_mem_tr__prompt_kernel_k1_e2
    s_lshl_b32 s24, s3, 6
    v_add_u32 v15, s24, v10
    v_cvt_pk_bf16_f32 v64, v104, v105
    v_cvt_pk_bf16_f32 v65, v106, v107
    ds_write_b64 v15, v[64:65] offset:160
    v_cvt_pk_bf16_f32 v66, v108, v109
    v_cvt_pk_bf16_f32 v67, v110, v111
    ds_write_b64 v15, v[66:67] offset:5536
    v_cvt_pk_bf16_f32 v68, v112, v113
    v_cvt_pk_bf16_f32 v69, v114, v115
    ds_write_b64 v15, v[68:69] offset:192
    v_cvt_pk_bf16_f32 v70, v116, v117
    v_cvt_pk_bf16_f32 v71, v118, v119
    ds_write_b64 v15, v[70:71] offset:5568
    v_min_f32 v148, 0, v88
    v_min_f32 v149, 0, v89
    v_pk_mul_f32 v[148:149], v[148:149], s[52:53]
    v_min_f32 v150, 0, v90
    v_min_f32 v151, 0, v91
    v_pk_mul_f32 v[150:151], v[150:151], s[52:53]
    v_exp_f32 v148, v148
    v_exp_f32 v149, v149
    v_exp_f32 v150, v150
    v_exp_f32 v151, v151
    v_max_f32 v88, 0, v88
    v_max_f32 v89, 0, v89
    v_max_f32 v90, 0, v90
    v_max_f32 v91, 0, v91
    v_pk_add_f32 v[88:89], v[88:89], v[148:149]
    v_pk_add_f32 v[90:91], v[90:91], v[150:151]
    v_pk_add_f32 v[88:89], v[88:89], s[54:55]
    v_pk_add_f32 v[90:91], v[90:91], s[54:55]
    v_min_f32 v148, 0, v96
    v_min_f32 v149, 0, v97
    v_pk_mul_f32 v[148:149], v[148:149], s[52:53]
    v_min_f32 v150, 0, v98
    v_min_f32 v151, 0, v99
    v_pk_mul_f32 v[150:151], v[150:151], s[52:53]
    v_exp_f32 v148, v148
    v_exp_f32 v149, v149
    v_exp_f32 v150, v150
    v_exp_f32 v151, v151
    v_max_f32 v96, 0, v96
    v_max_f32 v97, 0, v97
    v_max_f32 v98, 0, v98
    v_max_f32 v99, 0, v99
    v_pk_add_f32 v[96:97], v[96:97], v[148:149]
    v_pk_add_f32 v[98:99], v[98:99], v[150:151]
    v_pk_add_f32 v[96:97], v[96:97], s[54:55]
    v_pk_add_f32 v[98:99], v[98:99], s[54:55]
    v_cvt_pk_bf16_f32 v56, v88, v89
    v_cvt_pk_bf16_f32 v57, v90, v91
    v_cvt_pk_bf16_f32 v58, v96, v97
    v_cvt_pk_bf16_f32 v59, v98, v99
    buffer_store_dwordx4 v[56:59], v12, s[8:11], s43 offen sc1
    v_min_f32 v148, 0, v92
    v_min_f32 v149, 0, v93
    v_pk_mul_f32 v[148:149], v[148:149], s[52:53]
    v_min_f32 v150, 0, v94
    v_min_f32 v151, 0, v95
    v_pk_mul_f32 v[150:151], v[150:151], s[52:53]
    v_exp_f32 v148, v148
    v_exp_f32 v149, v149
    v_exp_f32 v150, v150
    v_exp_f32 v151, v151
    v_max_f32 v92, 0, v92
    v_max_f32 v93, 0, v93
    v_max_f32 v94, 0, v94
    v_max_f32 v95, 0, v95
    v_pk_add_f32 v[92:93], v[92:93], v[148:149]
    v_pk_add_f32 v[94:95], v[94:95], v[150:151]
    v_pk_add_f32 v[92:93], v[92:93], s[54:55]
    v_pk_add_f32 v[94:95], v[94:95], s[54:55]
    v_min_f32 v148, 0, v100
    v_min_f32 v149, 0, v101
    v_pk_mul_f32 v[148:149], v[148:149], s[52:53]
    v_min_f32 v150, 0, v102
    v_min_f32 v151, 0, v103
    v_pk_mul_f32 v[150:151], v[150:151], s[52:53]
    v_exp_f32 v148, v148
    v_exp_f32 v149, v149
    v_exp_f32 v150, v150
    v_exp_f32 v151, v151
    v_max_f32 v100, 0, v100
    v_max_f32 v101, 0, v101
    v_max_f32 v102, 0, v102
    v_max_f32 v103, 0, v103
    v_pk_add_f32 v[100:101], v[100:101], v[148:149]
    v_pk_add_f32 v[102:103], v[102:103], v[150:151]
    v_pk_add_f32 v[100:101], v[100:101], s[54:55]
    v_pk_add_f32 v[102:103], v[102:103], s[54:55]
    v_cvt_pk_bf16_f32 v60, v92, v93
    v_cvt_pk_bf16_f32 v61, v94, v95
    v_cvt_pk_bf16_f32 v62, v100, v101
    v_cvt_pk_bf16_f32 v63, v102, v103
    buffer_store_dwordx4 v[60:63], v12, s[8:11], s25 offen sc1
    s_branch interleave_layers__linear_attn_block__memory_aug_recurrent_mem_tr__prompt_kernel_k1_ej
interleave_layers__linear_attn_block__memory_aug_recurrent_mem_tr__prompt_kernel_k1_e2:
    s_cmp_eq_u32 s3, 3
    s_cbranch_scc1 interleave_layers__linear_attn_block__memory_aug_recurrent_mem_tr__prompt_kernel_k1_e3
    v_cvt_pk_bf16_f32 v68, v112, v113
    v_cvt_pk_bf16_f32 v69, v114, v115
    ds_write_b64 v10, v[68:69] offset:288
    v_cvt_pk_bf16_f32 v70, v116, v117
    v_cvt_pk_bf16_f32 v71, v118, v119
    ds_write_b64 v10, v[70:71] offset:5664
    v_min_f32 v148, 0, v96
    v_min_f32 v149, 0, v97
    v_pk_mul_f32 v[148:149], v[148:149], s[52:53]
    v_min_f32 v150, 0, v98
    v_min_f32 v151, 0, v99
    v_pk_mul_f32 v[150:151], v[150:151], s[52:53]
    v_exp_f32 v148, v148
    v_exp_f32 v149, v149
    v_exp_f32 v150, v150
    v_exp_f32 v151, v151
    v_max_f32 v96, 0, v96
    v_max_f32 v97, 0, v97
    v_max_f32 v98, 0, v98
    v_max_f32 v99, 0, v99
    v_pk_add_f32 v[96:97], v[96:97], v[148:149]
    v_pk_add_f32 v[98:99], v[98:99], v[150:151]
    v_pk_add_f32 v[96:97], v[96:97], s[54:55]
    v_pk_add_f32 v[98:99], v[98:99], s[54:55]
    v_min_f32 v148, 0, v104
    v_min_f32 v149, 0, v105
    v_pk_mul_f32 v[148:149], v[148:149], s[52:53]
    v_min_f32 v150, 0, v106
    v_min_f32 v151, 0, v107
    v_pk_mul_f32 v[150:151], v[150:151], s[52:53]
    v_exp_f32 v148, v148
    v_exp_f32 v149, v149
    v_exp_f32 v150, v150
    v_exp_f32 v151, v151
    v_max_f32 v104, 0, v104
    v_max_f32 v105, 0, v105
    v_max_f32 v106, 0, v106
    v_max_f32 v107, 0, v107
    v_pk_add_f32 v[104:105], v[104:105], v[148:149]
    v_pk_add_f32 v[106:107], v[106:107], v[150:151]
    v_pk_add_f32 v[104:105], v[104:105], s[54:55]
    v_pk_add_f32 v[106:107], v[106:107], s[54:55]
    v_min_f32 v148, 0, v100
    v_min_f32 v149, 0, v101
    v_pk_mul_f32 v[148:149], v[148:149], s[52:53]
    v_min_f32 v150, 0, v102
    v_min_f32 v151, 0, v103
    v_pk_mul_f32 v[150:151], v[150:151], s[52:53]
    v_exp_f32 v148, v148
    v_exp_f32 v149, v149
    v_exp_f32 v150, v150
    v_exp_f32 v151, v151
    v_max_f32 v100, 0, v100
    v_max_f32 v101, 0, v101
    v_max_f32 v102, 0, v102
    v_max_f32 v103, 0, v103
    v_pk_add_f32 v[100:101], v[100:101], v[148:149]
    v_pk_add_f32 v[102:103], v[102:103], v[150:151]
    v_pk_add_f32 v[100:101], v[100:101], s[54:55]
    v_pk_add_f32 v[102:103], v[102:103], s[54:55]
    v_min_f32 v148, 0, v108
    v_min_f32 v149, 0, v109
    v_pk_mul_f32 v[148:149], v[148:149], s[52:53]
    v_min_f32 v150, 0, v110
    v_min_f32 v151, 0, v111
    v_pk_mul_f32 v[150:151], v[150:151], s[52:53]
    v_exp_f32 v148, v148
    v_exp_f32 v149, v149
    v_exp_f32 v150, v150
    v_exp_f32 v151, v151
    v_max_f32 v108, 0, v108
    v_max_f32 v109, 0, v109
    v_max_f32 v110, 0, v110
    v_max_f32 v111, 0, v111
    v_pk_add_f32 v[108:109], v[108:109], v[148:149]
    v_pk_add_f32 v[110:111], v[110:111], v[150:151]
    v_pk_add_f32 v[108:109], v[108:109], s[54:55]
    v_pk_add_f32 v[110:111], v[110:111], s[54:55]
    v_cvt_pk_bf16_f32 v60, v96, v97
    v_cvt_pk_bf16_f32 v61, v98, v99
    ds_write_b64 v10, v[60:61] offset:0
    v_cvt_pk_bf16_f32 v62, v100, v101
    v_cvt_pk_bf16_f32 v63, v102, v103
    ds_write_b64 v10, v[62:63] offset:5376
    v_cvt_pk_bf16_f32 v64, v104, v105
    v_cvt_pk_bf16_f32 v65, v106, v107
    ds_write_b64 v10, v[64:65] offset:32
    v_cvt_pk_bf16_f32 v66, v108, v109
    v_cvt_pk_bf16_f32 v67, v110, v111
    ds_write_b64 v10, v[66:67] offset:5408
    v_min_f32 v148, 0, v88
    v_min_f32 v149, 0, v89
    v_pk_mul_f32 v[148:149], v[148:149], s[52:53]
    v_min_f32 v150, 0, v90
    v_min_f32 v151, 0, v91
    v_pk_mul_f32 v[150:151], v[150:151], s[52:53]
    v_exp_f32 v148, v148
    v_exp_f32 v149, v149
    v_exp_f32 v150, v150
    v_exp_f32 v151, v151
    v_max_f32 v88, 0, v88
    v_max_f32 v89, 0, v89
    v_max_f32 v90, 0, v90
    v_max_f32 v91, 0, v91
    v_pk_add_f32 v[88:89], v[88:89], v[148:149]
    v_pk_add_f32 v[90:91], v[90:91], v[150:151]
    v_pk_add_f32 v[88:89], v[88:89], s[54:55]
    v_pk_add_f32 v[90:91], v[90:91], s[54:55]
    v_cvt_pk_bf16_f32 v56, v88, v89
    v_cvt_pk_bf16_f32 v57, v90, v91
    buffer_store_dwordx2 v[56:57], v12, s[8:11], s43 offen sc1
    v_min_f32 v148, 0, v92
    v_min_f32 v149, 0, v93
    v_pk_mul_f32 v[148:149], v[148:149], s[52:53]
    v_min_f32 v150, 0, v94
    v_min_f32 v151, 0, v95
    v_pk_mul_f32 v[150:151], v[150:151], s[52:53]
    v_exp_f32 v148, v148
    v_exp_f32 v149, v149
    v_exp_f32 v150, v150
    v_exp_f32 v151, v151
    v_max_f32 v92, 0, v92
    v_max_f32 v93, 0, v93
    v_max_f32 v94, 0, v94
    v_max_f32 v95, 0, v95
    v_pk_add_f32 v[92:93], v[92:93], v[148:149]
    v_pk_add_f32 v[94:95], v[94:95], v[150:151]
    v_pk_add_f32 v[92:93], v[92:93], s[54:55]
    v_pk_add_f32 v[94:95], v[94:95], s[54:55]
    v_cvt_pk_bf16_f32 v58, v92, v93
    v_cvt_pk_bf16_f32 v59, v94, v95
    buffer_store_dwordx2 v[58:59], v12, s[8:11], s25 offen sc1
    s_branch interleave_layers__linear_attn_block__memory_aug_recurrent_mem_tr__prompt_kernel_k1_ej
interleave_layers__linear_attn_block__memory_aug_recurrent_mem_tr__prompt_kernel_k1_e3:
    v_min_f32 v148, 0, v88
    v_min_f32 v149, 0, v89
    v_pk_mul_f32 v[148:149], v[148:149], s[52:53]
    v_min_f32 v150, 0, v90
    v_min_f32 v151, 0, v91
    v_pk_mul_f32 v[150:151], v[150:151], s[52:53]
    v_exp_f32 v148, v148
    v_exp_f32 v149, v149
    v_exp_f32 v150, v150
    v_exp_f32 v151, v151
    v_max_f32 v88, 0, v88
    v_max_f32 v89, 0, v89
    v_max_f32 v90, 0, v90
    v_max_f32 v91, 0, v91
    v_pk_add_f32 v[88:89], v[88:89], v[148:149]
    v_pk_add_f32 v[90:91], v[90:91], v[150:151]
    v_pk_add_f32 v[88:89], v[88:89], s[54:55]
    v_pk_add_f32 v[90:91], v[90:91], s[54:55]
    v_min_f32 v148, 0, v92
    v_min_f32 v149, 0, v93
    v_pk_mul_f32 v[148:149], v[148:149], s[52:53]
    v_min_f32 v150, 0, v94
    v_min_f32 v151, 0, v95
    v_pk_mul_f32 v[150:151], v[150:151], s[52:53]
    v_exp_f32 v148, v148
    v_exp_f32 v149, v149
    v_exp_f32 v150, v150
    v_exp_f32 v151, v151
    v_max_f32 v92, 0, v92
    v_max_f32 v93, 0, v93
    v_max_f32 v94, 0, v94
    v_max_f32 v95, 0, v95
    v_pk_add_f32 v[92:93], v[92:93], v[148:149]
    v_pk_add_f32 v[94:95], v[94:95], v[150:151]
    v_pk_add_f32 v[92:93], v[92:93], s[54:55]
    v_pk_add_f32 v[94:95], v[94:95], s[54:55]
    v_cvt_pk_bf16_f32 v56, v88, v89
    v_cvt_pk_bf16_f32 v57, v90, v91
    ds_write_b64 v10, v[56:57] offset:64
    v_cvt_pk_bf16_f32 v58, v92, v93
    v_cvt_pk_bf16_f32 v59, v94, v95
    ds_write_b64 v10, v[58:59] offset:5440
    v_min_f32 v148, 0, v96
    v_min_f32 v149, 0, v97
    v_pk_mul_f32 v[148:149], v[148:149], s[52:53]
    v_min_f32 v150, 0, v98
    v_min_f32 v151, 0, v99
    v_pk_mul_f32 v[150:151], v[150:151], s[52:53]
    v_exp_f32 v148, v148
    v_exp_f32 v149, v149
    v_exp_f32 v150, v150
    v_exp_f32 v151, v151
    v_max_f32 v96, 0, v96
    v_max_f32 v97, 0, v97
    v_max_f32 v98, 0, v98
    v_max_f32 v99, 0, v99
    v_pk_add_f32 v[96:97], v[96:97], v[148:149]
    v_pk_add_f32 v[98:99], v[98:99], v[150:151]
    v_pk_add_f32 v[96:97], v[96:97], s[54:55]
    v_pk_add_f32 v[98:99], v[98:99], s[54:55]
    v_min_f32 v148, 0, v100
    v_min_f32 v149, 0, v101
    v_pk_mul_f32 v[148:149], v[148:149], s[52:53]
    v_min_f32 v150, 0, v102
    v_min_f32 v151, 0, v103
    v_pk_mul_f32 v[150:151], v[150:151], s[52:53]
    v_exp_f32 v148, v148
    v_exp_f32 v149, v149
    v_exp_f32 v150, v150
    v_exp_f32 v151, v151
    v_max_f32 v100, 0, v100
    v_max_f32 v101, 0, v101
    v_max_f32 v102, 0, v102
    v_max_f32 v103, 0, v103
    v_pk_add_f32 v[100:101], v[100:101], v[148:149]
    v_pk_add_f32 v[102:103], v[102:103], v[150:151]
    v_pk_add_f32 v[100:101], v[100:101], s[54:55]
    v_pk_add_f32 v[102:103], v[102:103], s[54:55]
    v_cvt_pk_bf16_f32 v60, v96, v97
    v_cvt_pk_bf16_f32 v61, v98, v99
    ds_write_b64 v10, v[60:61] offset:96
    v_cvt_pk_bf16_f32 v62, v100, v101
    v_cvt_pk_bf16_f32 v63, v102, v103
    ds_write_b64 v10, v[62:63] offset:5472
    v_min_f32 v148, 0, v104
    v_min_f32 v149, 0, v105
    v_pk_mul_f32 v[148:149], v[148:149], s[52:53]
    v_min_f32 v150, 0, v106
    v_min_f32 v151, 0, v107
    v_pk_mul_f32 v[150:151], v[150:151], s[52:53]
    v_exp_f32 v148, v148
    v_exp_f32 v149, v149
    v_exp_f32 v150, v150
    v_exp_f32 v151, v151
    v_max_f32 v104, 0, v104
    v_max_f32 v105, 0, v105
    v_max_f32 v106, 0, v106
    v_max_f32 v107, 0, v107
    v_pk_add_f32 v[104:105], v[104:105], v[148:149]
    v_pk_add_f32 v[106:107], v[106:107], v[150:151]
    v_pk_add_f32 v[104:105], v[104:105], s[54:55]
    v_pk_add_f32 v[106:107], v[106:107], s[54:55]
    v_min_f32 v148, 0, v108
    v_min_f32 v149, 0, v109
    v_pk_mul_f32 v[148:149], v[148:149], s[52:53]
    v_min_f32 v150, 0, v110
    v_min_f32 v151, 0, v111
    v_pk_mul_f32 v[150:151], v[150:151], s[52:53]
    v_exp_f32 v148, v148
    v_exp_f32 v149, v149
    v_exp_f32 v150, v150
    v_exp_f32 v151, v151
    v_max_f32 v108, 0, v108
    v_max_f32 v109, 0, v109
    v_max_f32 v110, 0, v110
    v_max_f32 v111, 0, v111
    v_pk_add_f32 v[108:109], v[108:109], v[148:149]
    v_pk_add_f32 v[110:111], v[110:111], v[150:151]
    v_pk_add_f32 v[108:109], v[108:109], s[54:55]
    v_pk_add_f32 v[110:111], v[110:111], s[54:55]
    v_cvt_pk_bf16_f32 v64, v104, v105
    v_cvt_pk_bf16_f32 v65, v106, v107
    ds_write_b64 v10, v[64:65] offset:128
    v_cvt_pk_bf16_f32 v66, v108, v109
    v_cvt_pk_bf16_f32 v67, v110, v111
    ds_write_b64 v10, v[66:67] offset:5504
interleave_layers__linear_attn_block__memory_aug_recurrent_mem_tr__prompt_kernel_k1_ej:
    s_waitcnt lgkmcnt(0)
    s_barrier
    ds_read_b64_tr_b16 v[72:73], v11 offset:0
    ds_read_b64_tr_b16 v[74:75], v11 offset:1344
    ds_read_b64_tr_b16 v[76:77], v11 offset:32
    ds_read_b64_tr_b16 v[78:79], v11 offset:1376
    ds_read_b64_tr_b16 v[80:81], v11 offset:160
    ds_read_b64_tr_b16 v[82:83], v11 offset:1504
    ds_read_b64_tr_b16 v[84:85], v11 offset:192
    ds_read_b64_tr_b16 v[86:87], v11 offset:1536
    s_waitcnt lgkmcnt(0)
    v_mfma_f32_16x16x32_bf16 v[120:123], v[72:75], v[84:87], v[120:123]
    v_mfma_f32_16x16x32_bf16 v[124:127], v[76:79], v[80:83], v[124:127]
    v_mfma_f32_16x16x32_bf16 v[128:131], v[76:79], v[84:87], v[128:131]
    v_mfma_f32_16x16x32_bf16 v[132:135], v[76:79], v[172:175], v[132:135]
    v_mfma_f32_16x16x32_bf16 v[136:139], v[72:75], v[80:83], v[136:139]
    v_mfma_f32_16x16x32_bf16 v[140:143], v[72:75], v[172:175], v[140:143]
    s_add_u32 s43, s43, s42
    s_add_u32 s48, s48, s49
    s_sub_u32 s40, s40, 1
    s_cmp_gt_u32 s40, 0
    s_cbranch_scc1 interleave_layers__linear_attn_block__memory_aug_recurrent_mem_tr__prompt_kernel_k1_seg
    s_mul_i32 s24, s45, 147456
    s_mul_i32 s25, s44, 18432
    s_add_u32 s24, s24, s25
    s_add_u32 s24, s24, 16777216
    s_mul_i32 s25, s3, 3072
    s_add_u32 s25, s25, s24
    s_lshl_b32 s26, s3, 10
    s_add_u32 s26, s26, s24
    s_add_u32 s26, s26, 13312
    s_cmp_eq_u32 s3, 0
    s_cselect_b32 s27, 0, 2146435072
    s_add_u32 s27, s27, s24
    s_add_u32 s28, s27, 17408
    s_add_u32 s27, s27, 12288
    buffer_store_dwordx4 v[120:123], v7, s[8:11], s25 offen offset:0 sc1
    buffer_store_dwordx4 v[124:127], v7, s[8:11], s25 offen offset:1024 sc1
    buffer_store_dwordx4 v[128:131], v7, s[8:11], s25 offen offset:2048 sc1
    buffer_store_dwordx4 v[132:135], v7, s[8:11], s26 offen sc1
    buffer_store_dwordx4 v[136:139], v7, s[8:11], s27 offen sc1
    buffer_store_dwordx4 v[140:143], v7, s[8:11], s28 offen sc1
    s_waitcnt vmcnt(0)
    s_barrier
    s_lshl_b32 s24, s92, 3
    s_add_u32 s24, s24, s44
    s_lshl_b32 s24, s24, 7
    s_lshl_b32 s25, s45, 2
    s_add_u32 s24, s24, s25
    s_add_u32 s24, s24, 23101440
    s_cmp_eq_u32 s3, 0
    s_cbranch_scc0 interleave_layers__linear_attn_block__memory_aug_recurrent_mem_tr__prompt_kernel_pb8
    v_lshlrev_b32 v14, 7, v1
    v_add_u32 v14, s24, v14
    v_mov_b32 v15, 2146435072
    v_cmp_le_u32 vcc, 1, v1
    s_nop 1
    v_cndmask_b32 v14, v14, v15, vcc
    v_mov_b32 v15, 1
    buffer_store_dword v15, v14, s[8:11], 0 offen sc1
interleave_layers__linear_attn_block__memory_aug_recurrent_mem_tr__prompt_kernel_pb8:
    s_cmp_eq_u32 s92, 0
    s_cbranch_scc0 interleave_layers__linear_attn_block__memory_aug_recurrent_mem_tr__prompt_kernel_helper_k2
    s_cmp_ge_u32 s2, 232
    s_cbranch_scc1 interleave_layers__linear_attn_block__memory_aug_recurrent_mem_tr__prompt_kernel_helper_k2
    s_cmp_ge_u32 s2, 200
    s_cbranch_scc1 interleave_layers__linear_attn_block__memory_aug_recurrent_mem_tr__prompt_kernel_toO
    s_cmp_ge_u32 s2, 104
    s_cbranch_scc1 interleave_layers__linear_attn_block__memory_aug_recurrent_mem_tr__prompt_kernel_toP
    s_cmp_ge_u32 s2, 64
    s_cbranch_scc1 interleave_layers__linear_attn_block__memory_aug_recurrent_mem_tr__prompt_kernel_toR
    s_cmp_ge_u32 s2, 32
    s_cbranch_scc1 interleave_layers__linear_attn_block__memory_aug_recurrent_mem_tr__prompt_kernel_toV
    s_branch interleave_layers__linear_attn_block__memory_aug_recurrent_mem_tr__prompt_kernel_roleS
interleave_layers__linear_attn_block__memory_aug_recurrent_mem_tr__prompt_kernel_toV:
    s_branch interleave_layers__linear_attn_block__memory_aug_recurrent_mem_tr__prompt_kernel_roleV
interleave_layers__linear_attn_block__memory_aug_recurrent_mem_tr__prompt_kernel_toR:
    s_branch interleave_layers__linear_attn_block__memory_aug_recurrent_mem_tr__prompt_kernel_roleR
interleave_layers__linear_attn_block__memory_aug_recurrent_mem_tr__prompt_kernel_toP:
    s_branch interleave_layers__linear_attn_block__memory_aug_recurrent_mem_tr__prompt_kernel_roleP
interleave_layers__linear_attn_block__memory_aug_recurrent_mem_tr__prompt_kernel_toO:
    s_branch interleave_layers__linear_attn_block__memory_aug_recurrent_mem_tr__prompt_kernel_roleO
interleave_layers__linear_attn_block__memory_aug_recurrent_mem_tr__prompt_kernel_helper_top:
    s_sub_u32 s24, s2, 232
    s_cmp_ge_u32 s24, 16
    s_cbranch_scc1 interleave_layers__linear_attn_block__memory_aug_recurrent_mem_tr__prompt_kernel_helper_k2
    s_add_u32 s16, s4, 4194304
    s_addc_u32 s17, s5, 0
    s_mov_b32 s18, 2621440
    s_mov_b32 s19, 0x00020000
    s_mov_b32 s46, 1024
    s_mov_b32 s47, 8
    s_mov_b32 s50, 1
    s_and_b32 s44, s24, 7
    s_lshr_b32 s45, s24, 3
    s_mov_b32 s48, s45
    s_mov_b32 s49, 2
    s_mov_b32 s40, 32
    s_branch interleave_layers__linear_attn_block__memory_aug_recurrent_mem_tr__prompt_kernel_k1_entry
interleave_layers__linear_attn_block__memory_aug_recurrent_mem_tr__prompt_kernel_helper_k2:
    s_sub_u32 s24, s2, 232
    s_and_b32 s44, s24, 7
    s_lshr_b32 s45, s24, 3
    s_cmp_eq_u32 s92, 0
    s_cselect_b32 s46, 32, 2
    s_mul_i32 s57, s24, 52
    s_lshr_b32 s57, s57, 8
    s_mul_i32 s56, s57, 5
    s_sub_u32 s56, s24, s56
    v_lshlrev_b32 v5, 4, v1
    s_mov_b32 s64, 12288
    s_cmp_eq_u32 s45, 1
    s_cselect_b32 s64, 5120, s64
    s_cmp_eq_u32 s45, 2
    s_cselect_b32 s64, 17408, s64
    s_mov_b32 s65, 1024
    s_cmp_eq_u32 s45, 1
    s_cselect_b32 s65, 7168, s65
    s_cmp_eq_u32 s45, 2
    s_cselect_b32 s65, 13312, s65
    s_mov_b32 s66, 0
    s_cmp_eq_u32 s45, 1
    s_cselect_b32 s66, 6144, s66
    s_cmp_eq_u32 s45, 2
    s_cselect_b32 s66, 14336, s66
    s_mov_b32 s67, 2048
    s_cmp_eq_u32 s45, 1
    s_cselect_b32 s67, 8192, s67
    s_cmp_eq_u32 s45, 2
    s_cselect_b32 s67, 15360, s67
    s_mov_b32 s68, 4096
    s_cmp_eq_u32 s45, 1
    s_cselect_b32 s68, 10240, s68
    s_cmp_eq_u32 s45, 2
    s_cselect_b32 s68, 16384, s68
    s_mov_b32 s69, 3072
    s_cmp_eq_u32 s45, 1
    s_cselect_b32 s69, 9216, s69
    s_cmp_eq_u32 s45, 2
    s_cselect_b32 s69, 16384, s69
    s_mov_b32 s70, 3072
    s_cmp_eq_u32 s45, 1
    s_cselect_b32 s70, 11264, s70
    s_cmp_eq_u32 s45, 2
    s_cselect_b32 s70, 16384, s70
    v_mov_b32 v16, 0
    v_mov_b32 v17, 0
    v_mov_b32 v18, 0
    v_mov_b32 v19, 0
    v_mov_b32 v20, 0
    v_mov_b32 v21, 0
    v_mov_b32 v22, 0
    v_mov_b32 v23, 0
    v_mov_b32 v24, 0
    v_mov_b32 v25, 0
    v_mov_b32 v26, 0
    v_mov_b32 v27, 0
    v_mov_b32 v28, 0
    v_mov_b32 v29, 0
    v_mov_b32 v30, 0
    v_mov_b32 v31, 0
    v_mov_b32 v32, 0
    v_mov_b32 v33, 0
    v_mov_b32 v34, 0
    v_mov_b32 v35, 0
    v_mov_b32 v36, 0
    v_mov_b32 v37, 0
    v_mov_b32 v38, 0
    v_mov_b32 v39, 0
    v_mov_b32 v40, 0
    v_mov_b32 v41, 0
    v_mov_b32 v42, 0
    v_mov_b32 v43, 0
    s_lshl_b32 s24, s92, 3
    s_add_u32 s24, s24, s44
    s_lshl_b32 s24, s24, 7
    s_add_u32 s24, s24, 23101440
    v_lshlrev_b32 v15, 2, v1
    v_add_u32 v15, s24, v15
    s_cmp_eq_u32 s92, 0
    s_cselect_b32 s26, -1, 3
    s_mov_b32 s61, 0
interleave_layers__linear_attn_block__memory_aug_recurrent_mem_tr__prompt_kernel_k2_w:
    buffer_load_dword v14, v15, s[8:11], 0 offen sc1
    s_waitcnt vmcnt(0)
    v_cmp_le_i32 vcc, 1, v14
    s_and_b32 s24, vcc_lo, s26
    s_cmp_eq_u32 s24, s26
    s_cbranch_scc1 interleave_layers__linear_attn_block__memory_aug_recurrent_mem_tr__prompt_kernel_k2_w_ok
    s_add_u32 s61, s61, 1
    s_cmp_ge_u32 s61, s60
    s_cbranch_scc1 interleave_layers__linear_attn_block__memory_aug_recurrent_mem_tr__prompt_kernel_k2_w_to
    s_sleep 2
    s_branch interleave_layers__linear_attn_block__memory_aug_recurrent_mem_tr__prompt_kernel_k2_w
interleave_layers__linear_attn_block__memory_aug_recurrent_mem_tr__prompt_kernel_k2_w_to:
    s_mov_b32 s60, 1
interleave_layers__linear_attn_block__memory_aug_recurrent_mem_tr__prompt_kernel_k2_w_ok:
    s_mov_b32 s40, s3
interleave_layers__linear_attn_block__memory_aug_recurrent_mem_tr__prompt_kernel_k2_rd:
    s_add_u32 s25, s40, 0
    s_mul_i32 s24, s25, 147456
    s_mul_i32 s26, s44, 18432
    s_add_u32 s24, s24, s26
    s_add_u32 s24, s24, 16777216
    s_cmp_lt_u32 s25, s46
    s_cselect_b32 s24, s24, 2146435072
    s_add_u32 s26, s24, s64
    buffer_load_dwordx4 v[48:51], v5, s[8:11], s26 offen sc1
    s_add_u32 s26, s24, s65
    buffer_load_dwordx4 v[52:55], v5, s[8:11], s26 offen sc1
    s_add_u32 s26, s24, s66
    buffer_load_dwordx4 v[56:59], v5, s[8:11], s26 offen sc1
    s_add_u32 s26, s24, s67
    buffer_load_dwordx4 v[60:63], v5, s[8:11], s26 offen sc1
    s_add_u32 s26, s24, s68
    buffer_load_dwordx4 v[64:67], v5, s[8:11], s26 offen sc1
    s_add_u32 s26, s24, s69
    buffer_load_dwordx4 v[68:71], v5, s[8:11], s26 offen sc1
    s_add_u32 s26, s24, s70
    buffer_load_dwordx4 v[72:75], v5, s[8:11], s26 offen sc1
    s_add_u32 s25, s40, 4
    s_mul_i32 s24, s25, 147456
    s_mul_i32 s26, s44, 18432
    s_add_u32 s24, s24, s26
    s_add_u32 s24, s24, 16777216
    s_cmp_lt_u32 s25, s46
    s_cselect_b32 s24, s24, 2146435072
    s_add_u32 s26, s24, s64
    buffer_load_dwordx4 v[76:79], v5, s[8:11], s26 offen sc1
    s_add_u32 s26, s24, s65
    buffer_load_dwordx4 v[80:83], v5, s[8:11], s26 offen sc1
    s_add_u32 s26, s24, s66
    buffer_load_dwordx4 v[84:87], v5, s[8:11], s26 offen sc1
    s_add_u32 s26, s24, s67
    buffer_load_dwordx4 v[88:91], v5, s[8:11], s26 offen sc1
    s_add_u32 s26, s24, s68
    buffer_load_dwordx4 v[92:95], v5, s[8:11], s26 offen sc1
    s_add_u32 s26, s24, s69
    buffer_load_dwordx4 v[96:99], v5, s[8:11], s26 offen sc1
    s_add_u32 s26, s24, s70
    buffer_load_dwordx4 v[100:103], v5, s[8:11], s26 offen sc1
    s_add_u32 s25, s40, 8
    s_mul_i32 s24, s25, 147456
    s_mul_i32 s26, s44, 18432
    s_add_u32 s24, s24, s26
    s_add_u32 s24, s24, 16777216
    s_cmp_lt_u32 s25, s46
    s_cselect_b32 s24, s24, 2146435072
    s_add_u32 s26, s24, s64
    buffer_load_dwordx4 v[104:107], v5, s[8:11], s26 offen sc1
    s_add_u32 s26, s24, s65
    buffer_load_dwordx4 v[108:111], v5, s[8:11], s26 offen sc1
    s_add_u32 s26, s24, s66
    buffer_load_dwordx4 v[112:115], v5, s[8:11], s26 offen sc1
    s_add_u32 s26, s24, s67
    buffer_load_dwordx4 v[116:119], v5, s[8:11], s26 offen sc1
    s_add_u32 s26, s24, s68
    buffer_load_dwordx4 v[120:123], v5, s[8:11], s26 offen sc1
    s_add_u32 s26, s24, s69
    buffer_load_dwordx4 v[124:127], v5, s[8:11], s26 offen sc1
    s_add_u32 s26, s24, s70
    buffer_load_dwordx4 v[128:131], v5, s[8:11], s26 offen sc1
    s_add_u32 s25, s40, 12
    s_mul_i32 s24, s25, 147456
    s_mul_i32 s26, s44, 18432
    s_add_u32 s24, s24, s26
    s_add_u32 s24, s24, 16777216
    s_cmp_lt_u32 s25, s46
    s_cselect_b32 s24, s24, 2146435072
    s_add_u32 s26, s24, s64
    buffer_load_dwordx4 v[132:135], v5, s[8:11], s26 offen sc1
    s_add_u32 s26, s24, s65
    buffer_load_dwordx4 v[136:139], v5, s[8:11], s26 offen sc1
    s_add_u32 s26, s24, s66
    buffer_load_dwordx4 v[140:143], v5, s[8:11], s26 offen sc1
    s_add_u32 s26, s24, s67
    buffer_load_dwordx4 v[144:147], v5, s[8:11], s26 offen sc1
    s_add_u32 s26, s24, s68
    buffer_load_dwordx4 v[148:151], v5, s[8:11], s26 offen sc1
    s_add_u32 s26, s24, s69
    buffer_load_dwordx4 v[152:155], v5, s[8:11], s26 offen sc1
    s_add_u32 s26, s24, s70
    buffer_load_dwordx4 v[156:159], v5, s[8:11], s26 offen sc1
    s_add_u32 s40, s40, 16
    s_cmp_lt_u32 s40, s46
    s_cbranch_scc0 interleave_layers__linear_attn_block__memory_aug_recurrent_mem_tr__prompt_kernel_k2m9
    s_waitcnt vmcnt(21)
    v_pk_add_f32 v[16:17], v[16:17], v[48:49]
    v_pk_add_f32 v[18:19], v[18:19], v[50:51]
    v_pk_add_f32 v[20:21], v[20:21], v[52:53]
    v_pk_add_f32 v[22:23], v[22:23], v[54:55]
    v_pk_add_f32 v[24:25], v[24:25], v[56:57]
    v_pk_add_f32 v[26:27], v[26:27], v[58:59]
    v_pk_add_f32 v[28:29], v[28:29], v[60:61]
    v_pk_add_f32 v[30:31], v[30:31], v[62:63]
    v_pk_add_f32 v[32:33], v[32:33], v[64:65]
    v_pk_add_f32 v[34:35], v[34:35], v[66:67]
    v_pk_add_f32 v[36:37], v[36:37], v[68:69]
    v_pk_add_f32 v[38:39], v[38:39], v[70:71]
    v_pk_add_f32 v[40:41], v[40:41], v[72:73]
    v_pk_add_f32 v[42:43], v[42:43], v[74:75]
    s_waitcnt vmcnt(14)
    v_pk_add_f32 v[16:17], v[16:17], v[76:77]
    v_pk_add_f32 v[18:19], v[18:19], v[78:79]
    v_pk_add_f32 v[20:21], v[20:21], v[80:81]
    v_pk_add_f32 v[22:23], v[22:23], v[82:83]
    v_pk_add_f32 v[24:25], v[24:25], v[84:85]
    v_pk_add_f32 v[26:27], v[26:27], v[86:87]
    v_pk_add_f32 v[28:29], v[28:29], v[88:89]
    v_pk_add_f32 v[30:31], v[30:31], v[90:91]
    v_pk_add_f32 v[32:33], v[32:33], v[92:93]
    v_pk_add_f32 v[34:35], v[34:35], v[94:95]
    v_pk_add_f32 v[36:37], v[36:37], v[96:97]
    v_pk_add_f32 v[38:39], v[38:39], v[98:99]
    v_pk_add_f32 v[40:41], v[40:41], v[100:101]
    v_pk_add_f32 v[42:43], v[42:43], v[102:103]
    s_waitcnt vmcnt(7)
    v_pk_add_f32 v[16:17], v[16:17], v[104:105]
    v_pk_add_f32 v[18:19], v[18:19], v[106:107]
    v_pk_add_f32 v[20:21], v[20:21], v[108:109]
    v_pk_add_f32 v[22:23], v[22:23], v[110:111]
    v_pk_add_f32 v[24:25], v[24:25], v[112:113]
    v_pk_add_f32 v[26:27], v[26:27], v[114:115]
    v_pk_add_f32 v[28:29], v[28:29], v[116:117]
    v_pk_add_f32 v[30:31], v[30:31], v[118:119]
    v_pk_add_f32 v[32:33], v[32:33], v[120:121]
    v_pk_add_f32 v[34:35], v[34:35], v[122:123]
    v_pk_add_f32 v[36:37], v[36:37], v[124:125]
    v_pk_add_f32 v[38:39], v[38:39], v[126:127]
    v_pk_add_f32 v[40:41], v[40:41], v[128:129]
    v_pk_add_f32 v[42:43], v[42:43], v[130:131]
    s_waitcnt vmcnt(0)
    v_pk_add_f32 v[16:17], v[16:17], v[132:133]
    v_pk_add_f32 v[18:19], v[18:19], v[134:135]
    v_pk_add_f32 v[20:21], v[20:21], v[136:137]
    v_pk_add_f32 v[22:23], v[22:23], v[138:139]
    v_pk_add_f32 v[24:25], v[24:25], v[140:141]
    v_pk_add_f32 v[26:27], v[26:27], v[142:143]
    v_pk_add_f32 v[28:29], v[28:29], v[144:145]
    v_pk_add_f32 v[30:31], v[30:31], v[146:147]
    v_pk_add_f32 v[32:33], v[32:33], v[148:149]
    v_pk_add_f32 v[34:35], v[34:35], v[150:151]
    v_pk_add_f32 v[36:37], v[36:37], v[152:153]
    v_pk_add_f32 v[38:39], v[38:39], v[154:155]
    v_pk_add_f32 v[40:41], v[40:41], v[156:157]
    v_pk_add_f32 v[42:43], v[42:43], v[158:159]
    s_branch interleave_layers__linear_attn_block__memory_aug_recurrent_mem_tr__prompt_kernel_k2_rd
interleave_layers__linear_attn_block__memory_aug_recurrent_mem_tr__prompt_kernel_k2m9:
    s_load_dwordx2 s[6:7], s[0:1], 16
    v_lshrrev_b32 v12, 4, v0
    v_mul_u32_u24 v12, 1280, v12
    v_and_b32 v13, 15, v0
    v_lshl_add_u32 v12, v13, 4, v12
    s_waitcnt lgkmcnt(0)
    s_mov_b32 s12, s6
    s_mov_b32 s13, s7
    s_mov_b32 s14, 819200
    s_mov_b32 s15, 0x00020000
    s_lshl_b32 s52, s56, 8
    s_add_u32 s24, s52, 0
    buffer_load_dwordx4 a[0:3], v12, s[12:15], s24 offen
    s_add_u32 s24, s52, 20480
    buffer_load_dwordx4 a[4:7], v12, s[12:15], s24 offen
    s_add_u32 s24, s52, 40960
    buffer_load_dwordx4 a[8:11], v12, s[12:15], s24 offen
    s_add_u32 s24, s52, 61440
    buffer_load_dwordx4 a[12:15], v12, s[12:15], s24 offen
    s_add_u32 s24, s52, 81920
    buffer_load_dwordx4 a[16:19], v12, s[12:15], s24 offen
    s_add_u32 s24, s52, 102400
    buffer_load_dwordx4 a[20:23], v12, s[12:15], s24 offen
    s_add_u32 s24, s52, 122880
    buffer_load_dwordx4 a[24:27], v12, s[12:15], s24 offen
    s_add_u32 s24, s52, 143360
    buffer_load_dwordx4 a[28:31], v12, s[12:15], s24 offen
    s_add_u32 s24, s52, 163840
    buffer_load_dwordx4 a[32:35], v12, s[12:15], s24 offen
    s_add_u32 s24, s52, 184320
    buffer_load_dwordx4 a[36:39], v12, s[12:15], s24 offen
    s_add_u32 s24, s52, 204800
    buffer_load_dwordx4 a[40:43], v12, s[12:15], s24 offen
    s_add_u32 s24, s52, 225280
    buffer_load_dwordx4 a[44:47], v12, s[12:15], s24 offen
    s_add_u32 s24, s52, 245760
    buffer_load_dwordx4 a[48:51], v12, s[12:15], s24 offen
    s_add_u32 s24, s52, 266240
    buffer_load_dwordx4 a[52:55], v12, s[12:15], s24 offen
    s_add_u32 s24, s52, 286720
    buffer_load_dwordx4 a[56:59], v12, s[12:15], s24 offen
    s_add_u32 s24, s52, 307200
    buffer_load_dwordx4 a[60:63], v12, s[12:15], s24 offen
    s_add_u32 s24, s52, 327680
    buffer_load_dwordx4 a[64:67], v12, s[12:15], s24 offen
    s_add_u32 s24, s52, 348160
    buffer_load_dwordx4 a[68:71], v12, s[12:15], s24 offen
    s_add_u32 s24, s52, 368640
    buffer_load_dwordx4 a[72:75], v12, s[12:15], s24 offen
    s_add_u32 s24, s52, 389120
    buffer_load_dwordx4 a[76:79], v12, s[12:15], s24 offen
    s_add_u32 s24, s52, 409600
    buffer_load_dwordx4 a[80:83], v12, s[12:15], s24 offen
    s_add_u32 s24, s52, 430080
    buffer_load_dwordx4 a[84:87], v12, s[12:15], s24 offen
    s_add_u32 s24, s52, 450560
    buffer_load_dwordx4 a[88:91], v12, s[12:15], s24 offen
    s_add_u32 s24, s52, 471040
    buffer_load_dwordx4 a[92:95], v12, s[12:15], s24 offen
    s_add_u32 s24, s52, 491520
    buffer_load_dwordx4 a[96:99], v12, s[12:15], s24 offen
    s_add_u32 s24, s52, 512000
    buffer_load_dwordx4 a[100:103], v12, s[12:15], s24 offen
    s_add_u32 s24, s52, 532480
    buffer_load_dwordx4 a[104:107], v12, s[12:15], s24 offen
    s_add_u32 s24, s52, 552960
    buffer_load_dwordx4 a[108:111], v12, s[12:15], s24 offen
    s_add_u32 s24, s52, 573440
    buffer_load_dwordx4 a[112:115], v12, s[12:15], s24 offen
    s_add_u32 s24, s52, 593920
    buffer_load_dwordx4 a[116:119], v12, s[12:15], s24 offen
    s_add_u32 s24, s52, 614400
    buffer_load_dwordx4 a[120:123], v12, s[12:15], s24 offen
    s_add_u32 s24, s52, 634880
    buffer_load_dwordx4 a[124:127], v12, s[12:15], s24 offen
    s_add_u32 s24, s52, 655360
    buffer_load_dwordx4 a[128:131], v12, s[12:15], s24 offen
    s_add_u32 s24, s52, 675840
    buffer_load_dwordx4 a[132:135], v12, s[12:15], s24 offen
    s_add_u32 s24, s52, 696320
    buffer_load_dwordx4 a[136:139], v12, s[12:15], s24 offen
    s_add_u32 s24, s52, 716800
    buffer_load_dwordx4 a[140:143], v12, s[12:15], s24 offen
    s_add_u32 s24, s52, 737280
    buffer_load_dwordx4 a[144:147], v12, s[12:15], s24 offen
    s_add_u32 s24, s52, 757760
    buffer_load_dwordx4 a[148:151], v12, s[12:15], s24 offen
    s_add_u32 s24, s52, 778240
    buffer_load_dwordx4 a[152:155], v12, s[12:15], s24 offen
    s_add_u32 s24, s52, 798720
    buffer_load_dwordx4 a[156:159], v12, s[12:15], s24 offen
    s_waitcnt vmcnt(61)
    v_pk_add_f32 v[16:17], v[16:17], v[48:49]
    v_pk_add_f32 v[18:19], v[18:19], v[50:51]
    v_pk_add_f32 v[20:21], v[20:21], v[52:53]
    v_pk_add_f32 v[22:23], v[22:23], v[54:55]
    v_pk_add_f32 v[24:25], v[24:25], v[56:57]
    v_pk_add_f32 v[26:27], v[26:27], v[58:59]
    v_pk_add_f32 v[28:29], v[28:29], v[60:61]
    v_pk_add_f32 v[30:31], v[30:31], v[62:63]
    v_pk_add_f32 v[32:33], v[32:33], v[64:65]
    v_pk_add_f32 v[34:35], v[34:35], v[66:67]
    v_pk_add_f32 v[36:37], v[36:37], v[68:69]
    v_pk_add_f32 v[38:39], v[38:39], v[70:71]
    v_pk_add_f32 v[40:41], v[40:41], v[72:73]
    v_pk_add_f32 v[42:43], v[42:43], v[74:75]
    s_waitcnt vmcnt(54)
    v_pk_add_f32 v[16:17], v[16:17], v[76:77]
    v_pk_add_f32 v[18:19], v[18:19], v[78:79]
    v_pk_add_f32 v[20:21], v[20:21], v[80:81]
    v_pk_add_f32 v[22:23], v[22:23], v[82:83]
    v_pk_add_f32 v[24:25], v[24:25], v[84:85]
    v_pk_add_f32 v[26:27], v[26:27], v[86:87]
    v_pk_add_f32 v[28:29], v[28:29], v[88:89]
    v_pk_add_f32 v[30:31], v[30:31], v[90:91]
    v_pk_add_f32 v[32:33], v[32:33], v[92:93]
    v_pk_add_f32 v[34:35], v[34:35], v[94:95]
    v_pk_add_f32 v[36:37], v[36:37], v[96:97]
    v_pk_add_f32 v[38:39], v[38:39], v[98:99]
    v_pk_add_f32 v[40:41], v[40:41], v[100:101]
    v_pk_add_f32 v[42:43], v[42:43], v[102:103]
    s_waitcnt vmcnt(47)
    v_pk_add_f32 v[16:17], v[16:17], v[104:105]
    v_pk_add_f32 v[18:19], v[18:19], v[106:107]
    v_pk_add_f32 v[20:21], v[20:21], v[108:109]
    v_pk_add_f32 v[22:23], v[22:23], v[110:111]
    v_pk_add_f32 v[24:25], v[24:25], v[112:113]
    v_pk_add_f32 v[26:27], v[26:27], v[114:115]
    v_pk_add_f32 v[28:29], v[28:29], v[116:117]
    v_pk_add_f32 v[30:31], v[30:31], v[118:119]
    v_pk_add_f32 v[32:33], v[32:33], v[120:121]
    v_pk_add_f32 v[34:35], v[34:35], v[122:123]
    v_pk_add_f32 v[36:37], v[36:37], v[124:125]
    v_pk_add_f32 v[38:39], v[38:39], v[126:127]
    v_pk_add_f32 v[40:41], v[40:41], v[128:129]
    v_pk_add_f32 v[42:43], v[42:43], v[130:131]
    s_waitcnt vmcnt(40)
    v_pk_add_f32 v[16:17], v[16:17], v[132:133]
    v_pk_add_f32 v[18:19], v[18:19], v[134:135]
    v_pk_add_f32 v[20:21], v[20:21], v[136:137]
    v_pk_add_f32 v[22:23], v[22:23], v[138:139]
    v_pk_add_f32 v[24:25], v[24:25], v[140:141]
    v_pk_add_f32 v[26:27], v[26:27], v[142:143]
    v_pk_add_f32 v[28:29], v[28:29], v[144:145]
    v_pk_add_f32 v[30:31], v[30:31], v[146:147]
    v_pk_add_f32 v[32:33], v[32:33], v[148:149]
    v_pk_add_f32 v[34:35], v[34:35], v[150:151]
    v_pk_add_f32 v[36:37], v[36:37], v[152:153]
    v_pk_add_f32 v[38:39], v[38:39], v[154:155]
    v_pk_add_f32 v[40:41], v[40:41], v[156:157]
    v_pk_add_f32 v[42:43], v[42:43], v[158:159]
    s_mul_i32 s24, s3, 7168
    v_add_u32 v6, s24, v5
    ds_write_b128 v6, v[16:19] offset:0
    ds_write_b128 v6, v[20:23] offset:1024
    ds_write_b128 v6, v[24:27] offset:2048
    ds_write_b128 v6, v[28:31] offset:3072
    ds_write_b128 v6, v[32:35] offset:4096
    ds_write_b128 v6, v[36:39] offset:5120
    ds_write_b128 v6, v[40:43] offset:6144
    s_waitcnt lgkmcnt(0)
    s_barrier
    s_mov_b32 s41, 0
    s_cmp_eq_u32 s45, 1
    s_cselect_b32 s41, 4, s41
    s_cmp_eq_u32 s45, 2
    s_cselect_b32 s41, 9, s41
    s_mov_b32 s42, 4
    s_cmp_eq_u32 s45, 1
    s_cselect_b32 s42, 5, s42
    s_cmp_eq_u32 s45, 2
    s_cselect_b32 s42, 5, s42
    s_mul_i32 s43, s92, 131072
    s_mul_i32 s24, s44, 14336
    s_add_u32 s43, s43, s24
    s_add_u32 s43, s43, 22020096
    v_and_b32 v7, 3, v2
    v_lshrrev_b32 v8, 2, v2
    s_add_u32 s40, s3, 0
    s_cmp_lt_u32 s40, s42
    s_cbranch_scc0 interleave_layers__linear_attn_block__memory_aug_recurrent_mem_tr__prompt_kernel_k2f10
    s_add_u32 s40, s40, s41
    s_mov_b32 s47, 67633672
    s_cmp_eq_u32 s40, 1
    s_cselect_b32 s47, 67699226, s47
    s_cmp_eq_u32 s40, 2
    s_cselect_b32 s47, 67702404, s47
    s_cmp_eq_u32 s40, 3
    s_cselect_b32 s47, 67765224, s47
    s_cmp_eq_u32 s40, 4
    s_cselect_b32 s47, 67765896, s47
    s_cmp_eq_u32 s40, 5
    s_cselect_b32 s47, 67831450, s47
    s_cmp_eq_u32 s40, 6
    s_cselect_b32 s47, 67833604, s47
    s_cmp_eq_u32 s40, 7
    s_cselect_b32 s47, 67897320, s47
    s_cmp_eq_u32 s40, 8
    s_cselect_b32 s47, 67899142, s47
    s_cmp_eq_u32 s40, 9
    s_cselect_b32 s47, 75497992, s47
    s_cmp_eq_u32 s40, 10
    s_cselect_b32 s47, 75499162, s47
    s_cmp_eq_u32 s40, 11
    s_cselect_b32 s47, 75501316, s47
    s_cmp_eq_u32 s40, 12
    s_cselect_b32 s47, 247768, s47
    s_cmp_eq_u32 s40, 13
    s_cselect_b32 s47, 249604, s47
    s_bfe_u32 s24, s47, 0x7000c
    s_bfe_u32 s25, s47, 0x50013
    s_bfe_u32 s26, s47, 0x30018
    v_mul_u32_u24 v9, s25, v7
    v_mul_u32_u24 v10, s26, v8
    v_add3_u32 v9, v9, v10, s24
    v_mul_u32_u24 v9, 205, v9
    v_lshrrev_b32 v9, 12, v9
    s_bfe_u32 s24, s47, 196608
    s_lshl_b32 s24, s24, 10
    v_add_u32 v10, s24, v5
    ds_read_b128 v[160:163], v10 offset:0
    ds_read_b128 v[164:167], v10 offset:7168
    ds_read_b128 v[168:171], v10 offset:14336
    ds_read_b128 v[172:175], v10 offset:21504
    s_bfe_u32 s25, s47, 196614
    s_lshl_b32 s25, s25, 4
    v_lshl_add_u32 v11, v3, 2, s25
    v_mul_u32_u24 v11, 205, v11
    v_lshrrev_b32 v11, 12, v11
    v_cmp_eq_u32 vcc, v9, v11
    s_waitcnt lgkmcnt(0)
    v_pk_add_f32 v[160:161], v[160:161], v[164:165]
    v_pk_add_f32 v[168:169], v[168:169], v[172:173]
    v_pk_add_f32 v[162:163], v[162:163], v[166:167]
    v_pk_add_f32 v[170:171], v[170:171], v[174:175]
    v_pk_add_f32 v[160:161], v[160:161], v[168:169]
    v_pk_add_f32 v[162:163], v[162:163], v[170:171]
    v_cvt_pk_bf16_f32 v176, v160, v161
    v_cvt_pk_bf16_f32 v177, v162, v163
    v_cndmask_b32 v176, 0, v176, vcc
    v_cndmask_b32 v177, 0, v177, vcc
    s_bfe_u32 s24, s47, 196611
    s_lshl_b32 s24, s24, 10
    v_add_u32 v10, s24, v5
    ds_read_b128 v[160:163], v10 offset:0
    ds_read_b128 v[164:167], v10 offset:7168
    ds_read_b128 v[168:171], v10 offset:14336
    ds_read_b128 v[172:175], v10 offset:21504
    s_bfe_u32 s25, s47, 196617
    s_lshl_b32 s25, s25, 4
    v_lshl_add_u32 v11, v3, 2, s25
    v_mul_u32_u24 v11, 205, v11
    v_lshrrev_b32 v11, 12, v11
    v_cmp_eq_u32 vcc, v9, v11
    s_waitcnt lgkmcnt(0)
    v_pk_add_f32 v[160:161], v[160:161], v[164:165]
    v_pk_add_f32 v[168:169], v[168:169], v[172:173]
    v_pk_add_f32 v[162:163], v[162:163], v[166:167]
    v_pk_add_f32 v[170:171], v[170:171], v[174:175]
    v_pk_add_f32 v[160:161], v[160:161], v[168:169]
    v_pk_add_f32 v[162:163], v[162:163], v[170:171]
    v_cvt_pk_bf16_f32 v178, v160, v161
    v_cvt_pk_bf16_f32 v179, v162, v163
    v_cndmask_b32 v178, 0, v178, vcc
    v_cndmask_b32 v179, 0, v179, vcc
    s_lshl_b32 s24, s40, 10
    s_add_u32 s24, s24, s43
    buffer_store_dwordx4 v[176:179], v5, s[8:11], s24 offen sc1
interleave_layers__linear_attn_block__memory_aug_recurrent_mem_tr__prompt_kernel_k2f10:
    s_add_u32 s40, s3, 4
    s_cmp_lt_u32 s40, s42
    s_cbranch_scc0 interleave_layers__linear_attn_block__memory_aug_recurrent_mem_tr__prompt_kernel_k2f11
    s_add_u32 s40, s40, s41
    s_mov_b32 s47, 67633672
    s_cmp_eq_u32 s40, 1
    s_cselect_b32 s47, 67699226, s47
    s_cmp_eq_u32 s40, 2
    s_cselect_b32 s47, 67702404, s47
    s_cmp_eq_u32 s40, 3
    s_cselect_b32 s47, 67765224, s47
    s_cmp_eq_u32 s40, 4
    s_cselect_b32 s47, 67765896, s47
    s_cmp_eq_u32 s40, 5
    s_cselect_b32 s47, 67831450, s47
    s_cmp_eq_u32 s40, 6
    s_cselect_b32 s47, 67833604, s47
    s_cmp_eq_u32 s40, 7
    s_cselect_b32 s47, 67897320, s47
    s_cmp_eq_u32 s40, 8
    s_cselect_b32 s47, 67899142, s47
    s_cmp_eq_u32 s40, 9
    s_cselect_b32 s47, 75497992, s47
    s_cmp_eq_u32 s40, 10
    s_cselect_b32 s47, 75499162, s47
    s_cmp_eq_u32 s40, 11
    s_cselect_b32 s47, 75501316, s47
    s_cmp_eq_u32 s40, 12
    s_cselect_b32 s47, 247768, s47
    s_cmp_eq_u32 s40, 13
    s_cselect_b32 s47, 249604, s47
    s_bfe_u32 s24, s47, 0x7000c
    s_bfe_u32 s25, s47, 0x50013
    s_bfe_u32 s26, s47, 0x30018
    v_mul_u32_u24 v9, s25, v7
    v_mul_u32_u24 v10, s26, v8
    v_add3_u32 v9, v9, v10, s24
    v_mul_u32_u24 v9, 205, v9
    v_lshrrev_b32 v9, 12, v9
    s_bfe_u32 s24, s47, 196608
    s_lshl_b32 s24, s24, 10
    v_add_u32 v10, s24, v5
    ds_read_b128 v[160:163], v10 offset:0
    ds_read_b128 v[164:167], v10 offset:7168
    ds_read_b128 v[168:171], v10 offset:14336
    ds_read_b128 v[172:175], v10 offset:21504
    s_bfe_u32 s25, s47, 196614
    s_lshl_b32 s25, s25, 4
    v_lshl_add_u32 v11, v3, 2, s25
    v_mul_u32_u24 v11, 205, v11
    v_lshrrev_b32 v11, 12, v11
    v_cmp_eq_u32 vcc, v9, v11
    s_waitcnt lgkmcnt(0)
    v_pk_add_f32 v[160:161], v[160:161], v[164:165]
    v_pk_add_f32 v[168:169], v[168:169], v[172:173]
    v_pk_add_f32 v[162:163], v[162:163], v[166:167]
    v_pk_add_f32 v[170:171], v[170:171], v[174:175]
    v_pk_add_f32 v[160:161], v[160:161], v[168:169]
    v_pk_add_f32 v[162:163], v[162:163], v[170:171]
    v_cvt_pk_bf16_f32 v176, v160, v161
    v_cvt_pk_bf16_f32 v177, v162, v163
    v_cndmask_b32 v176, 0, v176, vcc
    v_cndmask_b32 v177, 0, v177, vcc
    s_bfe_u32 s24, s47, 196611
    s_lshl_b32 s24, s24, 10
    v_add_u32 v10, s24, v5
    ds_read_b128 v[160:163], v10 offset:0
    ds_read_b128 v[164:167], v10 offset:7168
    ds_read_b128 v[168:171], v10 offset:14336
    ds_read_b128 v[172:175], v10 offset:21504
    s_bfe_u32 s25, s47, 196617
    s_lshl_b32 s25, s25, 4
    v_lshl_add_u32 v11, v3, 2, s25
    v_mul_u32_u24 v11, 205, v11
    v_lshrrev_b32 v11, 12, v11
    v_cmp_eq_u32 vcc, v9, v11
    s_waitcnt lgkmcnt(0)
    v_pk_add_f32 v[160:161], v[160:161], v[164:165]
    v_pk_add_f32 v[168:169], v[168:169], v[172:173]
    v_pk_add_f32 v[162:163], v[162:163], v[166:167]
    v_pk_add_f32 v[170:171], v[170:171], v[174:175]
    v_pk_add_f32 v[160:161], v[160:161], v[168:169]
    v_pk_add_f32 v[162:163], v[162:163], v[170:171]
    v_cvt_pk_bf16_f32 v178, v160, v161
    v_cvt_pk_bf16_f32 v179, v162, v163
    v_cndmask_b32 v178, 0, v178, vcc
    v_cndmask_b32 v179, 0, v179, vcc
    s_lshl_b32 s24, s40, 10
    s_add_u32 s24, s24, s43
    buffer_store_dwordx4 v[176:179], v5, s[8:11], s24 offen sc1
interleave_layers__linear_attn_block__memory_aug_recurrent_mem_tr__prompt_kernel_k2f11:
    s_waitcnt vmcnt(0)
    s_barrier
    s_lshl_b32 s24, s92, 7
    s_sub_u32 s25, s2, 232
    s_lshl_b32 s25, s25, 2
    s_add_u32 s24, s24, s25
    s_add_u32 s24, s24, 23103488
    s_cmp_eq_u32 s3, 0
    s_cbranch_scc0 interleave_layers__linear_attn_block__memory_aug_recurrent_mem_tr__prompt_kernel_pb12
    v_lshlrev_b32 v14, 7, v1
    v_add_u32 v14, s24, v14
    v_mov_b32 v15, 2146435072
    v_cmp_le_u32 vcc, 1, v1
    s_nop 1
    v_cndmask_b32 v14, v14, v15, vcc
    v_mov_b32 v15, 1
    buffer_store_dword v15, v14, s[8:11], 0 offen sc1
interleave_layers__linear_attn_block__memory_aug_recurrent_mem_tr__prompt_kernel_pb12:
    s_cmp_ge_u32 s2, 252
    s_cbranch_scc1 interleave_layers__linear_attn_block__memory_aug_recurrent_mem_tr__prompt_kernel_helper_clr
    s_cmp_eq_u32 s92, 0
    s_cbranch_scc0 interleave_layers__linear_attn_block__memory_aug_recurrent_mem_tr__prompt_kernel_h313
    s_load_dwordx2 s[6:7], s[0:1], 0
    s_waitcnt lgkmcnt(0)
    s_mov_b32 s16, s6
    s_mov_b32 s17, s7
    s_mov_b32 s18, 2621440
    s_mov_b32 s19, 0x00020000
    s_mov_b32 s46, 64
    s_mov_b32 s47, 32
    s_mov_b32 s50, 0
    s_mov_b32 s58, 0
    s_branch interleave_layers__linear_attn_block__memory_aug_recurrent_mem_tr__prompt_kernel_h314
interleave_layers__linear_attn_block__memory_aug_recurrent_mem_tr__prompt_kernel_h313:
    s_add_u32 s16, s4, 4194304
    s_addc_u32 s17, s5, 0
    s_mov_b32 s18, 2621440
    s_mov_b32 s19, 0x00020000
    s_mov_b32 s46, 1024
    s_mov_b32 s47, 8
    s_mov_b32 s50, 1
    s_mov_b32 s58, 8388608
interleave_layers__linear_attn_block__memory_aug_recurrent_mem_tr__prompt_kernel_h314:
    v_lshrrev_b32 v6, 4, v0
    v_mul_u32_u24 v6, 288, v6
    v_and_b32 v7, 15, v0
    v_lshl_add_u32 v6, v7, 4, v6
    v_add_u32 v6, 81920, v6
    v_lshrrev_b32 v7, 2, v2
    v_lshl_add_u32 v7, v3, 2, v7
    v_mul_u32_u24 v7, 288, v7
    v_and_b32 v8, 3, v2
    v_lshl_add_u32 v7, v8, 3, v7
    s_lshl_b32 s24, s3, 6
    s_add_u32 s24, s24, 81920
    v_add_u32 v7, s24, v7
    s_waitcnt vmcnt(0)
    ds_write_b128 v6, a[0:3] offset:0
    ds_write_b128 v6, a[4:7] offset:4608
    ds_write_b128 v6, a[8:11] offset:9216
    ds_write_b128 v6, a[12:15] offset:13824
    s_waitcnt lgkmcnt(0)
    s_barrier
    ds_read_b64_tr_b16 a[0:1], v7 offset:0
    ds_read_b64_tr_b16 a[2:3], v7 offset:4608
    ds_read_b64_tr_b16 a[4:5], v7 offset:32
    ds_read_b64_tr_b16 a[6:7], v7 offset:4640
    ds_read_b64_tr_b16 a[8:9], v7 offset:9216
    ds_read_b64_tr_b16 a[10:11], v7 offset:13824
    ds_read_b64_tr_b16 a[12:13], v7 offset:9248
    ds_read_b64_tr_b16 a[14:15], v7 offset:13856
    ds_write_b128 v6, a[16:19] offset:18432
    ds_write_b128 v6, a[20:23] offset:23040
    ds_write_b128 v6, a[24:27] offset:27648
    ds_write_b128 v6, a[28:31] offset:32256
    s_waitcnt lgkmcnt(0)
    s_barrier
    ds_read_b64_tr_b16 a[16:17], v7 offset:18432
    ds_read_b64_tr_b16 a[18:19], v7 offset:23040
    ds_read_b64_tr_b16 a[20:21], v7 offset:18464
    ds_read_b64_tr_b16 a[22:23], v7 offset:23072
    ds_read_b64_tr_b16 a[24:25], v7 offset:27648
    ds_read_b64_tr_b16 a[26:27], v7 offset:32256
    ds_read_b64_tr_b16 a[28:29], v7 offset:27680
    ds_read_b64_tr_b16 a[30:31], v7 offset:32288
    ds_write_b128 v6, a[32:35] offset:0
    ds_write_b128 v6, a[36:39] offset:4608
    ds_write_b128 v6, a[40:43] offset:9216
    ds_write_b128 v6, a[44:47] offset:13824
    s_waitcnt lgkmcnt(0)
    s_barrier
    ds_read_b64_tr_b16 a[32:33], v7 offset:0
    ds_read_b64_tr_b16 a[34:35], v7 offset:4608
    ds_read_b64_tr_b16 a[36:37], v7 offset:32
    ds_read_b64_tr_b16 a[38:39], v7 offset:4640
    ds_read_b64_tr_b16 a[40:41], v7 offset:9216
    ds_read_b64_tr_b16 a[42:43], v7 offset:13824
    ds_read_b64_tr_b16 a[44:45], v7 offset:9248
    ds_read_b64_tr_b16 a[46:47], v7 offset:13856
    ds_write_b128 v6, a[48:51] offset:18432
    ds_write_b128 v6, a[52:55] offset:23040
    ds_write_b128 v6, a[56:59] offset:27648
    ds_write_b128 v6, a[60:63] offset:32256
    s_waitcnt lgkmcnt(0)
    s_barrier
    ds_read_b64_tr_b16 a[48:49], v7 offset:18432
    ds_read_b64_tr_b16 a[50:51], v7 offset:23040
    ds_read_b64_tr_b16 a[52:53], v7 offset:18464
    ds_read_b64_tr_b16 a[54:55], v7 offset:23072
    ds_read_b64_tr_b16 a[56:57], v7 offset:27648
    ds_read_b64_tr_b16 a[58:59], v7 offset:32256
    ds_read_b64_tr_b16 a[60:61], v7 offset:27680
    ds_read_b64_tr_b16 a[62:63], v7 offset:32288
    ds_write_b128 v6, a[64:67] offset:0
    ds_write_b128 v6, a[68:71] offset:4608
    ds_write_b128 v6, a[72:75] offset:9216
    ds_write_b128 v6, a[76:79] offset:13824
    s_waitcnt lgkmcnt(0)
    s_barrier
    ds_read_b64_tr_b16 a[64:65], v7 offset:0
    ds_read_b64_tr_b16 a[66:67], v7 offset:4608
    ds_read_b64_tr_b16 a[68:69], v7 offset:32
    ds_read_b64_tr_b16 a[70:71], v7 offset:4640
    ds_read_b64_tr_b16 a[72:73], v7 offset:9216
    ds_read_b64_tr_b16 a[74:75], v7 offset:13824
    ds_read_b64_tr_b16 a[76:77], v7 offset:9248
    ds_read_b64_tr_b16 a[78:79], v7 offset:13856
    ds_write_b128 v6, a[80:83] offset:18432
    ds_write_b128 v6, a[84:87] offset:23040
    ds_write_b128 v6, a[88:91] offset:27648
    ds_write_b128 v6, a[92:95] offset:32256
    s_waitcnt lgkmcnt(0)
    s_barrier
    ds_read_b64_tr_b16 a[80:81], v7 offset:18432
    ds_read_b64_tr_b16 a[82:83], v7 offset:23040
    ds_read_b64_tr_b16 a[84:85], v7 offset:18464
    ds_read_b64_tr_b16 a[86:87], v7 offset:23072
    ds_read_b64_tr_b16 a[88:89], v7 offset:27648
    ds_read_b64_tr_b16 a[90:91], v7 offset:32256
    ds_read_b64_tr_b16 a[92:93], v7 offset:27680
    ds_read_b64_tr_b16 a[94:95], v7 offset:32288
    ds_write_b128 v6, a[96:99] offset:0
    ds_write_b128 v6, a[100:103] offset:4608
    ds_write_b128 v6, a[104:107] offset:9216
    ds_write_b128 v6, a[108:111] offset:13824
    s_waitcnt lgkmcnt(0)
    s_barrier
    ds_read_b64_tr_b16 a[96:97], v7 offset:0
    ds_read_b64_tr_b16 a[98:99], v7 offset:4608
    ds_read_b64_tr_b16 a[100:101], v7 offset:32
    ds_read_b64_tr_b16 a[102:103], v7 offset:4640
    ds_read_b64_tr_b16 a[104:105], v7 offset:9216
    ds_read_b64_tr_b16 a[106:107], v7 offset:13824
    ds_read_b64_tr_b16 a[108:109], v7 offset:9248
    ds_read_b64_tr_b16 a[110:111], v7 offset:13856
    ds_write_b128 v6, a[112:115] offset:18432
    ds_write_b128 v6, a[116:119] offset:23040
    ds_write_b128 v6, a[120:123] offset:27648
    ds_write_b128 v6, a[124:127] offset:32256
    s_waitcnt lgkmcnt(0)
    s_barrier
    ds_read_b64_tr_b16 a[112:113], v7 offset:18432
    ds_read_b64_tr_b16 a[114:115], v7 offset:23040
    ds_read_b64_tr_b16 a[116:117], v7 offset:18464
    ds_read_b64_tr_b16 a[118:119], v7 offset:23072
    ds_read_b64_tr_b16 a[120:121], v7 offset:27648
    ds_read_b64_tr_b16 a[122:123], v7 offset:32256
    ds_read_b64_tr_b16 a[124:125], v7 offset:27680
    ds_read_b64_tr_b16 a[126:127], v7 offset:32288
    ds_write_b128 v6, a[128:131] offset:0
    ds_write_b128 v6, a[132:135] offset:4608
    ds_write_b128 v6, a[136:139] offset:9216
    ds_write_b128 v6, a[140:143] offset:13824
    s_waitcnt lgkmcnt(0)
    s_barrier
    ds_read_b64_tr_b16 a[128:129], v7 offset:0
    ds_read_b64_tr_b16 a[130:131], v7 offset:4608
    ds_read_b64_tr_b16 a[132:133], v7 offset:32
    ds_read_b64_tr_b16 a[134:135], v7 offset:4640
    ds_read_b64_tr_b16 a[136:137], v7 offset:9216
    ds_read_b64_tr_b16 a[138:139], v7 offset:13824
    ds_read_b64_tr_b16 a[140:141], v7 offset:9248
    ds_read_b64_tr_b16 a[142:143], v7 offset:13856
    ds_write_b128 v6, a[144:147] offset:18432
    ds_write_b128 v6, a[148:151] offset:23040
    ds_write_b128 v6, a[152:155] offset:27648
    ds_write_b128 v6, a[156:159] offset:32256
    s_waitcnt lgkmcnt(0)
    s_barrier
    ds_read_b64_tr_b16 a[144:145], v7 offset:18432
    ds_read_b64_tr_b16 a[146:147], v7 offset:23040
    ds_read_b64_tr_b16 a[148:149], v7 offset:18464
    ds_read_b64_tr_b16 a[150:151], v7 offset:23072
    ds_read_b64_tr_b16 a[152:153], v7 offset:27648
    ds_read_b64_tr_b16 a[154:155], v7 offset:32256
    ds_read_b64_tr_b16 a[156:157], v7 offset:27680
    ds_read_b64_tr_b16 a[158:159], v7 offset:32288
    v_lshlrev_b32 v5, 4, v1
    s_mul_i32 s24, s3, 5120
    s_add_u32 s24, s24, 12582912
    v_add_u32 v8, s24, v5
    v_lshlrev_b32 v9, 3, v1
    s_add_u32 s24, s24, 2048
    v_add_u32 v9, s24, v9
    s_cmp_eq_u32 s50, 1
    s_cselect_b32 s25, 16, 1280
    s_cselect_b32 s26, 256, 8
    v_mul_u32_u24 v10, s25, v2
    v_mul_u32_u24 v11, s26, v3
    s_lshl_b32 s24, s56, 2
    s_add_u32 s24, s24, s3
    s_mul_i32 s25, s24, s46
    v_add3_u32 v10, v10, v11, s25
    v_add_u32 v11, s47, v10
    s_lshl_b32 s24, s24, 10
    s_add_u32 s24, s24, s58
    v_add_u32 v12, s24, v5
    s_mul_i32 s24, s3, 5120
    s_add_u32 s24, s24, 0
    v_add_u32 v13, s24, v5
    s_mov_b32 s54, 0x358637bd
    s_mul_i32 s43, s57, 40960
    s_mov_b32 s40, 0
    s_mov_b32 s42, 0
    s_lshl_b32 s24, s92, 7
    s_add_u32 s24, s24, 23103488
    v_lshlrev_b32 v15, 2, v1
    v_add_u32 v15, s24, v15
    s_mov_b32 s61, 0
interleave_layers__linear_attn_block__memory_aug_recurrent_mem_tr__prompt_kernel_k3_w:
    buffer_load_dword v14, v15, s[8:11], 0 offen sc1
    s_waitcnt vmcnt(0)
    v_cmp_le_i32 vcc, 1, v14
    s_mov_b32 s25, 0xffffff
    s_and_b32 s24, vcc_lo, s25
    s_cmp_eq_u32 s24, s25
    s_cbranch_scc1 interleave_layers__linear_attn_block__memory_aug_recurrent_mem_tr__prompt_kernel_k3_w_ok
    s_add_u32 s61, s61, 1
    s_cmp_ge_u32 s61, s60
    s_cbranch_scc1 interleave_layers__linear_attn_block__memory_aug_recurrent_mem_tr__prompt_kernel_k3_w_to
    s_sleep 2
    s_branch interleave_layers__linear_attn_block__memory_aug_recurrent_mem_tr__prompt_kernel_k3_w
interleave_layers__linear_attn_block__memory_aug_recurrent_mem_tr__prompt_kernel_k3_w_to:
    s_mov_b32 s60, 1
interleave_layers__linear_attn_block__memory_aug_recurrent_mem_tr__prompt_kernel_k3_w_ok:
    s_mul_i32 s24, s92, 131072
    s_mul_i32 s25, s3, 28672
    s_add_u32 s24, s24, s25
    s_add_u32 s24, s24, 22020096
    s_add_u32 s25, s24, 0
    buffer_load_dwordx4 a[160:163], v5, s[8:11], s25 offen sc1
    s_add_u32 s25, s24, 1024
    buffer_load_dwordx4 a[164:167], v5, s[8:11], s25 offen sc1
    s_add_u32 s25, s24, 2048
    buffer_load_dwordx4 a[168:171], v5, s[8:11], s25 offen sc1
    s_add_u32 s25, s24, 3072
    buffer_load_dwordx4 a[172:175], v5, s[8:11], s25 offen sc1
    s_add_u32 s25, s24, 4096
    buffer_load_dwordx4 a[176:179], v5, s[8:11], s25 offen sc1
    s_add_u32 s25, s24, 5120
    buffer_load_dwordx4 a[180:183], v5, s[8:11], s25 offen sc1
    s_add_u32 s25, s24, 6144
    buffer_load_dwordx2 a[184:185], v5, s[8:11], s25 offen sc1
    s_add_u32 s25, s24, 7168
    buffer_load_dwordx4 a[186:189], v5, s[8:11], s25 offen sc1
    s_add_u32 s25, s24, 8192
    buffer_load_dwordx2 a[190:191], v5, s[8:11], s25 offen sc1
    s_add_u32 s25, s24, 9216
    buffer_load_dwordx4 a[192:195], v5, s[8:11], s25 offen sc1
    s_add_u32 s25, s24, 10240
    buffer_load_dwordx4 a[196:199], v5, s[8:11], s25 offen sc1
    s_add_u32 s25, s24, 11264
    buffer_load_dwordx2 a[200:201], v5, s[8:11], s25 offen sc1
    s_add_u32 s25, s24, 12288
    buffer_load_dwordx4 a[202:205], v5, s[8:11], s25 offen sc1
    s_add_u32 s25, s24, 13312
    buffer_load_dwordx2 a[206:207], v5, s[8:11], s25 offen sc1
    s_add_u32 s25, s24, 14336
    buffer_load_dwordx4 a[208:211], v5, s[8:11], s25 offen sc1
    s_add_u32 s25, s24, 15360
    buffer_load_dwordx4 a[212:215], v5, s[8:11], s25 offen sc1
    s_add_u32 s25, s24, 16384
    buffer_load_dwordx4 a[216:219], v5, s[8:11], s25 offen sc1
    s_add_u32 s25, s24, 17408
    buffer_load_dwordx4 a[220:223], v5, s[8:11], s25 offen sc1
    s_add_u32 s25, s24, 18432
    buffer_load_dwordx4 a[224:227], v5, s[8:11], s25 offen sc1
    s_add_u32 s25, s24, 19456
    buffer_load_dwordx4 a[228:231], v5, s[8:11], s25 offen sc1
    s_add_u32 s25, s24, 20480
    buffer_load_dwordx2 a[232:233], v5, s[8:11], s25 offen sc1
    s_add_u32 s25, s24, 21504
    buffer_load_dwordx4 a[234:237], v5, s[8:11], s25 offen sc1
    s_add_u32 s25, s24, 22528
    buffer_load_dwordx2 a[238:239], v5, s[8:11], s25 offen sc1
    s_add_u32 s25, s24, 23552
    buffer_load_dwordx4 a[240:243], v5, s[8:11], s25 offen sc1
    s_add_u32 s25, s24, 24576
    buffer_load_dwordx4 a[244:247], v5, s[8:11], s25 offen sc1
    s_add_u32 s25, s24, 25600
    buffer_load_dwordx2 a[248:249], v5, s[8:11], s25 offen sc1
    s_add_u32 s25, s24, 26624
    buffer_load_dwordx4 a[250:253], v5, s[8:11], s25 offen sc1
    s_add_u32 s25, s24, 27648
    buffer_load_dwordx2 a[254:255], v5, s[8:11], s25 offen sc1
    s_mov_b32 s41, s43
    s_add_u32 s25, s41, 20480
    buffer_load_dwordx4 v[16:19], v8, s[8:11], s41 offen offset:0 sc1
    buffer_load_dwordx4 v[20:23], v8, s[8:11], s41 offen offset:1024 sc1
    buffer_load_dwordx2 v[24:25], v9, s[8:11], s41 offen offset:0 sc1
    buffer_load_dwordx4 v[26:29], v8, s[8:11], s41 offen offset:2560 sc1
    buffer_load_dwordx4 v[30:33], v8, s[8:11], s41 offen offset:3584 sc1
    buffer_load_dwordx2 v[34:35], v9, s[8:11], s41 offen offset:2560 sc1
    buffer_load_dwordx4 v[36:39], v8, s[8:11], s25 offen offset:0 sc1
    buffer_load_dwordx4 v[40:43], v8, s[8:11], s25 offen offset:1024 sc1
    buffer_load_dwordx2 v[44:45], v9, s[8:11], s25 offen offset:0 sc1
    buffer_load_dwordx4 v[46:49], v8, s[8:11], s25 offen offset:2560 sc1
    buffer_load_dwordx4 v[50:53], v8, s[8:11], s25 offen offset:3584 sc1
    buffer_load_dwordx2 v[54:55], v9, s[8:11], s25 offen offset:2560 sc1
    buffer_load_dwordx2 v[96:97], v10, s[16:19], s41 offen sc1
    buffer_load_dwordx2 v[98:99], v11, s[16:19], s41 offen sc1
    buffer_load_dwordx2 v[100:101], v10, s[16:19], s25 offen sc1
    buffer_load_dwordx2 v[102:103], v11, s[16:19], s25 offen sc1
    s_waitcnt vmcnt(0)
    s_add_u32 s41, s43, 163840
    s_add_u32 s25, s41, 20480
    buffer_load_dwordx4 v[56:59], v8, s[8:11], s41 offen offset:0 sc1
    buffer_load_dwordx4 v[60:63], v8, s[8:11], s41 offen offset:1024 sc1
    buffer_load_dwordx2 v[64:65], v9, s[8:11], s41 offen offset:0 sc1
    buffer_load_dwordx4 v[66:69], v8, s[8:11], s41 offen offset:2560 sc1
    buffer_load_dwordx4 v[70:73], v8, s[8:11], s41 offen offset:3584 sc1
    buffer_load_dwordx2 v[74:75], v9, s[8:11], s41 offen offset:2560 sc1
    buffer_load_dwordx4 v[76:79], v8, s[8:11], s25 offen offset:0 sc1
    buffer_load_dwordx4 v[80:83], v8, s[8:11], s25 offen offset:1024 sc1
    buffer_load_dwordx2 v[84:85], v9, s[8:11], s25 offen offset:0 sc1
    buffer_load_dwordx4 v[86:89], v8, s[8:11], s25 offen offset:2560 sc1
    buffer_load_dwordx4 v[90:93], v8, s[8:11], s25 offen offset:3584 sc1
    buffer_load_dwordx2 v[94:95], v9, s[8:11], s25 offen offset:2560 sc1
    buffer_load_dwordx2 v[104:105], v10, s[16:19], s41 offen sc1
    buffer_load_dwordx2 v[106:107], v11, s[16:19], s41 offen sc1
    buffer_load_dwordx2 v[108:109], v10, s[16:19], s25 offen sc1
    buffer_load_dwordx2 v[110:111], v11, s[16:19], s25 offen sc1
    v_mfma_f32_16x16x32_bf16 v[132:135], a[192:195], v[16:19], 0
    v_mfma_f32_16x16x32_bf16 v[136:139], a[202:205], v[20:23], 0
    v_mfma_f32_16x16x32_bf16 v[112:115], a[160:163], v[16:19], 0
    v_mfma_f32_16x16x32_bf16 v[116:119], a[164:167], v[16:19], 0
    v_mfma_f32_16x16x32_bf16 v[120:123], a[172:175], v[16:19], 0
    v_mfma_f32_16x16x32_bf16 v[124:127], a[180:183], v[20:23], 0
    v_mfma_f32_16x16x32_bf16 v[128:131], a[186:189], v[20:23], 0
    v_mfma_f32_16x16x32_bf16 v[132:135], a[196:199], v[20:23], v[132:135]
    v_mfma_f32_16x16x32_bf16 v[116:119], a[168:171], v[20:23], v[116:119]
    v_mfma_f32_16x16x32_bf16 v[120:123], a[176:179], v[20:23], v[120:123]
    v_mfma_f32_16x16x16_bf16 v[136:139], a[206:207], v[24:25], v[136:139]
    s_nop 0
    v_mfma_f32_16x16x16_bf16 v[124:127], a[184:185], v[24:25], v[124:127]
    v_mfma_f32_16x16x16_bf16 v[128:131], a[190:191], v[24:25], v[128:131]
    v_mfma_f32_16x16x16_bf16 v[132:135], a[200:201], v[24:25], v[132:135]
    v_mfma_f32_16x16x32_bf16 v[160:163], a[240:243], v[26:29], 0
    v_mfma_f32_16x16x32_bf16 v[164:167], a[250:253], v[30:33], 0
    v_mfma_f32_16x16x32_bf16 v[140:143], a[208:211], v[26:29], 0
    v_mfma_f32_16x16x32_bf16 v[144:147], a[212:215], v[26:29], 0
    v_mfma_f32_16x16x32_bf16 v[148:151], a[220:223], v[26:29], 0
    v_mfma_f32_16x16x32_bf16 v[152:155], a[228:231], v[30:33], 0
    v_mfma_f32_16x16x32_bf16 v[156:159], a[234:237], v[30:33], 0
    v_mfma_f32_16x16x32_bf16 v[160:163], a[244:247], v[30:33], v[160:163]
    v_mfma_f32_16x16x32_bf16 v[144:147], a[216:219], v[30:33], v[144:147]
    v_mfma_f32_16x16x32_bf16 v[148:151], a[224:227], v[30:33], v[148:151]
    v_mfma_f32_16x16x16_bf16 v[164:167], a[254:255], v[34:35], v[164:167]
    s_nop 0
    v_mfma_f32_16x16x16_bf16 v[152:155], a[232:233], v[34:35], v[152:155]
    v_mfma_f32_16x16x16_bf16 v[156:159], a[238:239], v[34:35], v[156:159]
    v_mfma_f32_16x16x16_bf16 v[160:163], a[248:249], v[34:35], v[160:163]
    v_add_f32 v132, s54, v132
    v_add_f32 v133, s54, v133
    v_add_f32 v134, s54, v134
    v_add_f32 v135, s54, v135
    v_add_f32 v136, s54, v136
    v_rcp_f32 v132, v132
    v_rcp_f32 v133, v133
    v_rcp_f32 v134, v134
    v_rcp_f32 v135, v135
    v_rcp_f32 v136, v136
    v_mul_f32 v112, v112, v132
    v_mul_f32 v113, v113, v132
    v_mul_f32 v114, v114, v132
    v_mul_f32 v115, v115, v132
    v_cvt_pk_bf16_f32 v168, v112, v113
    v_cvt_pk_bf16_f32 v169, v114, v115
    v_mul_f32 v116, v116, v133
    v_mul_f32 v117, v117, v133
    v_mul_f32 v118, v118, v133
    v_mul_f32 v119, v119, v133
    v_cvt_pk_bf16_f32 v170, v116, v117
    v_cvt_pk_bf16_f32 v171, v118, v119
    v_mul_f32 v120, v120, v134
    v_mul_f32 v121, v121, v134
    v_mul_f32 v122, v122, v134
    v_mul_f32 v123, v123, v134
    v_cvt_pk_bf16_f32 v172, v120, v121
    v_cvt_pk_bf16_f32 v173, v122, v123
    v_mul_f32 v124, v124, v135
    v_mul_f32 v125, v125, v135
    v_mul_f32 v126, v126, v135
    v_mul_f32 v127, v127, v135
    v_cvt_pk_bf16_f32 v174, v124, v125
    v_cvt_pk_bf16_f32 v175, v126, v127
    v_mul_f32 v128, v128, v136
    v_mul_f32 v129, v129, v136
    v_mul_f32 v130, v130, v136
    v_mul_f32 v131, v131, v136
    v_cvt_pk_bf16_f32 v176, v128, v129
    v_cvt_pk_bf16_f32 v177, v130, v131
    v_add_f32 v160, s54, v160
    v_add_f32 v161, s54, v161
    v_add_f32 v162, s54, v162
    v_add_f32 v163, s54, v163
    v_add_f32 v164, s54, v164
    v_rcp_f32 v160, v160
    v_rcp_f32 v161, v161
    v_rcp_f32 v162, v162
    v_rcp_f32 v163, v163
    v_rcp_f32 v164, v164
    v_mul_f32 v140, v140, v160
    v_mul_f32 v141, v141, v160
    v_mul_f32 v142, v142, v160
    v_mul_f32 v143, v143, v160
    v_cvt_pk_bf16_f32 v178, v140, v141
    v_cvt_pk_bf16_f32 v179, v142, v143
    v_mul_f32 v144, v144, v161
    v_mul_f32 v145, v145, v161
    v_mul_f32 v146, v146, v161
    v_mul_f32 v147, v147, v161
    v_cvt_pk_bf16_f32 v180, v144, v145
    v_cvt_pk_bf16_f32 v181, v146, v147
    v_mul_f32 v148, v148, v162
    v_mul_f32 v149, v149, v162
    v_mul_f32 v150, v150, v162
    v_mul_f32 v151, v151, v162
    v_cvt_pk_bf16_f32 v182, v148, v149
    v_cvt_pk_bf16_f32 v183, v150, v151
    v_mul_f32 v152, v152, v163
    v_mul_f32 v153, v153, v163
    v_mul_f32 v154, v154, v163
    v_mul_f32 v155, v155, v163
    v_cvt_pk_bf16_f32 v184, v152, v153
    v_cvt_pk_bf16_f32 v185, v154, v155
    v_mul_f32 v156, v156, v164
    v_mul_f32 v157, v157, v164
    v_mul_f32 v158, v158, v164
    v_mul_f32 v159, v159, v164
    v_cvt_pk_bf16_f32 v186, v156, v157
    v_cvt_pk_bf16_f32 v187, v158, v159
    v_mfma_f32_16x16x32_bf16 v[132:135], a[192:195], v[36:39], 0
    v_mfma_f32_16x16x32_bf16 v[136:139], a[202:205], v[40:43], 0
    v_mfma_f32_16x16x32_bf16 v[112:115], a[160:163], v[36:39], 0
    v_mfma_f32_16x16x32_bf16 v[116:119], a[164:167], v[36:39], 0
    v_mfma_f32_16x16x32_bf16 v[120:123], a[172:175], v[36:39], 0
    v_mfma_f32_16x16x32_bf16 v[124:127], a[180:183], v[40:43], 0
    v_mfma_f32_16x16x32_bf16 v[128:131], a[186:189], v[40:43], 0
    v_mfma_f32_16x16x32_bf16 v[132:135], a[196:199], v[40:43], v[132:135]
    v_mfma_f32_16x16x32_bf16 v[116:119], a[168:171], v[40:43], v[116:119]
    v_mfma_f32_16x16x32_bf16 v[120:123], a[176:179], v[40:43], v[120:123]
    v_mfma_f32_16x16x16_bf16 v[136:139], a[206:207], v[44:45], v[136:139]
    s_nop 0
    v_mfma_f32_16x16x16_bf16 v[124:127], a[184:185], v[44:45], v[124:127]
    v_mfma_f32_16x16x16_bf16 v[128:131], a[190:191], v[44:45], v[128:131]
    v_mfma_f32_16x16x16_bf16 v[132:135], a[200:201], v[44:45], v[132:135]
    v_mfma_f32_16x16x32_bf16 v[160:163], a[240:243], v[46:49], 0
    v_mfma_f32_16x16x32_bf16 v[164:167], a[250:253], v[50:53], 0
    v_mfma_f32_16x16x32_bf16 v[140:143], a[208:211], v[46:49], 0
    v_mfma_f32_16x16x32_bf16 v[144:147], a[212:215], v[46:49], 0
    v_mfma_f32_16x16x32_bf16 v[148:151], a[220:223], v[46:49], 0
    v_mfma_f32_16x16x32_bf16 v[152:155], a[228:231], v[50:53], 0
    v_mfma_f32_16x16x32_bf16 v[156:159], a[234:237], v[50:53], 0
    v_mfma_f32_16x16x32_bf16 v[160:163], a[244:247], v[50:53], v[160:163]
    v_mfma_f32_16x16x32_bf16 v[144:147], a[216:219], v[50:53], v[144:147]
    v_mfma_f32_16x16x32_bf16 v[148:151], a[224:227], v[50:53], v[148:151]
    v_mfma_f32_16x16x16_bf16 v[164:167], a[254:255], v[54:55], v[164:167]
    s_nop 0
    v_mfma_f32_16x16x16_bf16 v[152:155], a[232:233], v[54:55], v[152:155]
    v_mfma_f32_16x16x16_bf16 v[156:159], a[238:239], v[54:55], v[156:159]
    v_mfma_f32_16x16x16_bf16 v[160:163], a[248:249], v[54:55], v[160:163]
    v_add_f32 v132, s54, v132
    v_add_f32 v133, s54, v133
    v_add_f32 v134, s54, v134
    v_add_f32 v135, s54, v135
    v_add_f32 v136, s54, v136
    v_rcp_f32 v132, v132
    v_rcp_f32 v133, v133
    v_rcp_f32 v134, v134
    v_rcp_f32 v135, v135
    v_rcp_f32 v136, v136
    v_mul_f32 v112, v112, v132
    v_mul_f32 v113, v113, v132
    v_mul_f32 v114, v114, v132
    v_mul_f32 v115, v115, v132
    v_cvt_pk_bf16_f32 v188, v112, v113
    v_cvt_pk_bf16_f32 v189, v114, v115
    v_mul_f32 v116, v116, v133
    v_mul_f32 v117, v117, v133
    v_mul_f32 v118, v118, v133
    v_mul_f32 v119, v119, v133
    v_cvt_pk_bf16_f32 v190, v116, v117
    v_cvt_pk_bf16_f32 v191, v118, v119
    v_mul_f32 v120, v120, v134
    v_mul_f32 v121, v121, v134
    v_mul_f32 v122, v122, v134
    v_mul_f32 v123, v123, v134
    v_cvt_pk_bf16_f32 v192, v120, v121
    v_cvt_pk_bf16_f32 v193, v122, v123
    v_mul_f32 v124, v124, v135
    v_mul_f32 v125, v125, v135
    v_mul_f32 v126, v126, v135
    v_mul_f32 v127, v127, v135
    v_cvt_pk_bf16_f32 v194, v124, v125
    v_cvt_pk_bf16_f32 v195, v126, v127
    v_mul_f32 v128, v128, v136
    v_mul_f32 v129, v129, v136
    v_mul_f32 v130, v130, v136
    v_mul_f32 v131, v131, v136
    v_cvt_pk_bf16_f32 v196, v128, v129
    v_cvt_pk_bf16_f32 v197, v130, v131
    v_add_f32 v160, s54, v160
    v_add_f32 v161, s54, v161
    v_add_f32 v162, s54, v162
    v_add_f32 v163, s54, v163
    v_add_f32 v164, s54, v164
    v_rcp_f32 v160, v160
    v_rcp_f32 v161, v161
    v_rcp_f32 v162, v162
    v_rcp_f32 v163, v163
    v_rcp_f32 v164, v164
    v_mul_f32 v140, v140, v160
    v_mul_f32 v141, v141, v160
    v_mul_f32 v142, v142, v160
    v_mul_f32 v143, v143, v160
    v_cvt_pk_bf16_f32 v198, v140, v141
    v_cvt_pk_bf16_f32 v199, v142, v143
    v_mul_f32 v144, v144, v161
    v_mul_f32 v145, v145, v161
    v_mul_f32 v146, v146, v161
    v_mul_f32 v147, v147, v161
    v_cvt_pk_bf16_f32 v200, v144, v145
    v_cvt_pk_bf16_f32 v201, v146, v147
    v_mul_f32 v148, v148, v162
    v_mul_f32 v149, v149, v162
    v_mul_f32 v150, v150, v162
    v_mul_f32 v151, v151, v162
    v_cvt_pk_bf16_f32 v202, v148, v149
    v_cvt_pk_bf16_f32 v203, v150, v151
    v_mul_f32 v152, v152, v163
    v_mul_f32 v153, v153, v163
    v_mul_f32 v154, v154, v163
    v_mul_f32 v155, v155, v163
    v_cvt_pk_bf16_f32 v204, v152, v153
    v_cvt_pk_bf16_f32 v205, v154, v155
    v_mul_f32 v156, v156, v164
    v_mul_f32 v157, v157, v164
    v_mul_f32 v158, v158, v164
    v_mul_f32 v159, v159, v164
    v_cvt_pk_bf16_f32 v206, v156, v157
    v_cvt_pk_bf16_f32 v207, v158, v159
    v_add_u32 v14, s42, v13
    ds_write_b128 v14, v[168:171] offset:0
    ds_write_b128 v14, v[172:175] offset:1024
    ds_write_b128 v14, v[176:179] offset:2048
    ds_write_b128 v14, v[180:183] offset:3072
    ds_write_b128 v14, v[184:187] offset:4096
    ds_write_b128 v14, v[188:191] offset:20480
    ds_write_b128 v14, v[192:195] offset:21504
    ds_write_b128 v14, v[196:199] offset:22528
    ds_write_b128 v14, v[200:203] offset:23552
    ds_write_b128 v14, v[204:207] offset:24576
    s_waitcnt lgkmcnt(0)
    s_barrier
interleave_layers__linear_attn_block__memory_aug_recurrent_mem_tr__prompt_kernel_k3_seg:
    v_add_u32 v15, s42, v5
    ds_read_b128 v[208:211], v15 offset:0
    ds_read_b128 v[212:215], v15 offset:20480
    ds_read_b128 v[216:219], v15 offset:1024
    ds_read_b128 v[220:223], v15 offset:21504
    ds_read_b128 v[224:227], v15 offset:2048
    ds_read_b128 v[228:231], v15 offset:22528
    ds_read_b128 v[232:235], v15 offset:3072
    ds_read_b128 v[236:239], v15 offset:23552
    s_waitcnt lgkmcnt(6)
    v_mfma_f32_16x16x32_bf16 v[240:243], a[0:3], v[208:211], 0
    v_mfma_f32_16x16x32_bf16 v[244:247], a[4:7], v[208:211], 0
    v_mfma_f32_16x16x32_bf16 v[248:251], a[0:3], v[212:215], 0
    v_mfma_f32_16x16x32_bf16 v[252:255], a[4:7], v[212:215], 0
    ds_read_b128 v[208:211], v15 offset:4096
    ds_read_b128 v[212:215], v15 offset:24576
    s_waitcnt lgkmcnt(6)
    v_mfma_f32_16x16x32_bf16 v[240:243], a[8:11], v[216:219], v[240:243]
    v_mfma_f32_16x16x32_bf16 v[244:247], a[12:15], v[216:219], v[244:247]
    v_mfma_f32_16x16x32_bf16 v[248:251], a[8:11], v[220:223], v[248:251]
    v_mfma_f32_16x16x32_bf16 v[252:255], a[12:15], v[220:223], v[252:255]
    ds_read_b128 v[216:219], v15 offset:5120
    ds_read_b128 v[220:223], v15 offset:25600
    s_waitcnt lgkmcnt(6)
    v_mfma_f32_16x16x32_bf16 v[240:243], a[16:19], v[224:227], v[240:243]
    v_mfma_f32_16x16x32_bf16 v[244:247], a[20:23], v[224:227], v[244:247]
    v_mfma_f32_16x16x32_bf16 v[248:251], a[16:19], v[228:231], v[248:251]
    v_mfma_f32_16x16x32_bf16 v[252:255], a[20:23], v[228:231], v[252:255]
    ds_read_b128 v[224:227], v15 offset:6144
    ds_read_b128 v[228:231], v15 offset:26624
    s_waitcnt lgkmcnt(6)
    v_mfma_f32_16x16x32_bf16 v[240:243], a[24:27], v[232:235], v[240:243]
    v_mfma_f32_16x16x32_bf16 v[244:247], a[28:31], v[232:235], v[244:247]
    v_mfma_f32_16x16x32_bf16 v[248:251], a[24:27], v[236:239], v[248:251]
    v_mfma_f32_16x16x32_bf16 v[252:255], a[28:31], v[236:239], v[252:255]
    ds_read_b128 v[232:235], v15 offset:7168
    ds_read_b128 v[236:239], v15 offset:27648
    s_waitcnt lgkmcnt(6)
    v_mfma_f32_16x16x32_bf16 v[240:243], a[32:35], v[208:211], v[240:243]
    v_mfma_f32_16x16x32_bf16 v[244:247], a[36:39], v[208:211], v[244:247]
    v_mfma_f32_16x16x32_bf16 v[248:251], a[32:35], v[212:215], v[248:251]
    v_mfma_f32_16x16x32_bf16 v[252:255], a[36:39], v[212:215], v[252:255]
    ds_read_b128 v[208:211], v15 offset:8192
    ds_read_b128 v[212:215], v15 offset:28672
    s_waitcnt lgkmcnt(6)
    v_mfma_f32_16x16x32_bf16 v[240:243], a[40:43], v[216:219], v[240:243]
    v_mfma_f32_16x16x32_bf16 v[244:247], a[44:47], v[216:219], v[244:247]
    v_mfma_f32_16x16x32_bf16 v[248:251], a[40:43], v[220:223], v[248:251]
    v_mfma_f32_16x16x32_bf16 v[252:255], a[44:47], v[220:223], v[252:255]
    ds_read_b128 v[216:219], v15 offset:9216
    ds_read_b128 v[220:223], v15 offset:29696
    s_waitcnt lgkmcnt(6)
    v_mfma_f32_16x16x32_bf16 v[240:243], a[48:51], v[224:227], v[240:243]
    v_mfma_f32_16x16x32_bf16 v[244:247], a[52:55], v[224:227], v[244:247]
    v_mfma_f32_16x16x32_bf16 v[248:251], a[48:51], v[228:231], v[248:251]
    v_mfma_f32_16x16x32_bf16 v[252:255], a[52:55], v[228:231], v[252:255]
    ds_read_b128 v[224:227], v15 offset:10240
    ds_read_b128 v[228:231], v15 offset:30720
    s_waitcnt lgkmcnt(6)
    v_mfma_f32_16x16x32_bf16 v[240:243], a[56:59], v[232:235], v[240:243]
    v_mfma_f32_16x16x32_bf16 v[244:247], a[60:63], v[232:235], v[244:247]
    v_mfma_f32_16x16x32_bf16 v[248:251], a[56:59], v[236:239], v[248:251]
    v_mfma_f32_16x16x32_bf16 v[252:255], a[60:63], v[236:239], v[252:255]
    ds_read_b128 v[232:235], v15 offset:11264
    ds_read_b128 v[236:239], v15 offset:31744
    s_waitcnt lgkmcnt(6)
    v_mfma_f32_16x16x32_bf16 v[240:243], a[64:67], v[208:211], v[240:243]
    v_mfma_f32_16x16x32_bf16 v[244:247], a[68:71], v[208:211], v[244:247]
    v_mfma_f32_16x16x32_bf16 v[248:251], a[64:67], v[212:215], v[248:251]
    v_mfma_f32_16x16x32_bf16 v[252:255], a[68:71], v[212:215], v[252:255]
    ds_read_b128 v[208:211], v15 offset:12288
    ds_read_b128 v[212:215], v15 offset:32768
    s_waitcnt lgkmcnt(6)
    v_mfma_f32_16x16x32_bf16 v[240:243], a[72:75], v[216:219], v[240:243]
    v_mfma_f32_16x16x32_bf16 v[244:247], a[76:79], v[216:219], v[244:247]
    v_mfma_f32_16x16x32_bf16 v[248:251], a[72:75], v[220:223], v[248:251]
    v_mfma_f32_16x16x32_bf16 v[252:255], a[76:79], v[220:223], v[252:255]
    ds_read_b128 v[216:219], v15 offset:13312
    ds_read_b128 v[220:223], v15 offset:33792
    s_waitcnt lgkmcnt(6)
    v_mfma_f32_16x16x32_bf16 v[240:243], a[80:83], v[224:227], v[240:243]
    v_mfma_f32_16x16x32_bf16 v[244:247], a[84:87], v[224:227], v[244:247]
    v_mfma_f32_16x16x32_bf16 v[248:251], a[80:83], v[228:231], v[248:251]
    v_mfma_f32_16x16x32_bf16 v[252:255], a[84:87], v[228:231], v[252:255]
    ds_read_b128 v[224:227], v15 offset:14336
    ds_read_b128 v[228:231], v15 offset:34816
    s_waitcnt lgkmcnt(6)
    v_mfma_f32_16x16x32_bf16 v[240:243], a[88:91], v[232:235], v[240:243]
    v_mfma_f32_16x16x32_bf16 v[244:247], a[92:95], v[232:235], v[244:247]
    v_mfma_f32_16x16x32_bf16 v[248:251], a[88:91], v[236:239], v[248:251]
    v_mfma_f32_16x16x32_bf16 v[252:255], a[92:95], v[236:239], v[252:255]
    ds_read_b128 v[232:235], v15 offset:15360
    ds_read_b128 v[236:239], v15 offset:35840
    s_waitcnt lgkmcnt(6)
    v_mfma_f32_16x16x32_bf16 v[240:243], a[96:99], v[208:211], v[240:243]
    v_mfma_f32_16x16x32_bf16 v[244:247], a[100:103], v[208:211], v[244:247]
    v_mfma_f32_16x16x32_bf16 v[248:251], a[96:99], v[212:215], v[248:251]
    v_mfma_f32_16x16x32_bf16 v[252:255], a[100:103], v[212:215], v[252:255]
    ds_read_b128 v[208:211], v15 offset:16384
    ds_read_b128 v[212:215], v15 offset:36864
    s_waitcnt lgkmcnt(6)
    v_mfma_f32_16x16x32_bf16 v[240:243], a[104:107], v[216:219], v[240:243]
    v_mfma_f32_16x16x32_bf16 v[244:247], a[108:111], v[216:219], v[244:247]
    v_mfma_f32_16x16x32_bf16 v[248:251], a[104:107], v[220:223], v[248:251]
    v_mfma_f32_16x16x32_bf16 v[252:255], a[108:111], v[220:223], v[252:255]
    ds_read_b128 v[216:219], v15 offset:17408
    ds_read_b128 v[220:223], v15 offset:37888
    s_waitcnt lgkmcnt(6)
    v_mfma_f32_16x16x32_bf16 v[240:243], a[112:115], v[224:227], v[240:243]
    v_mfma_f32_16x16x32_bf16 v[244:247], a[116:119], v[224:227], v[244:247]
    v_mfma_f32_16x16x32_bf16 v[248:251], a[112:115], v[228:231], v[248:251]
    v_mfma_f32_16x16x32_bf16 v[252:255], a[116:119], v[228:231], v[252:255]
    ds_read_b128 v[224:227], v15 offset:18432
    ds_read_b128 v[228:231], v15 offset:38912
    s_waitcnt lgkmcnt(6)
    v_mfma_f32_16x16x32_bf16 v[240:243], a[120:123], v[232:235], v[240:243]
    v_mfma_f32_16x16x32_bf16 v[244:247], a[124:127], v[232:235], v[244:247]
    v_mfma_f32_16x16x32_bf16 v[248:251], a[120:123], v[236:239], v[248:251]
    v_mfma_f32_16x16x32_bf16 v[252:255], a[124:127], v[236:239], v[252:255]
    ds_read_b128 v[232:235], v15 offset:19456
    ds_read_b128 v[236:239], v15 offset:39936
    s_waitcnt lgkmcnt(6)
    v_mfma_f32_16x16x32_bf16 v[240:243], a[128:131], v[208:211], v[240:243]
    v_mfma_f32_16x16x32_bf16 v[244:247], a[132:135], v[208:211], v[244:247]
    v_mfma_f32_16x16x32_bf16 v[248:251], a[128:131], v[212:215], v[248:251]
    v_mfma_f32_16x16x32_bf16 v[252:255], a[132:135], v[212:215], v[252:255]
    s_waitcnt lgkmcnt(4)
    v_mfma_f32_16x16x32_bf16 v[240:243], a[136:139], v[216:219], v[240:243]
    v_mfma_f32_16x16x32_bf16 v[244:247], a[140:143], v[216:219], v[244:247]
    v_mfma_f32_16x16x32_bf16 v[248:251], a[136:139], v[220:223], v[248:251]
    v_mfma_f32_16x16x32_bf16 v[252:255], a[140:143], v[220:223], v[252:255]
    s_waitcnt lgkmcnt(2)
    v_mfma_f32_16x16x32_bf16 v[240:243], a[144:147], v[224:227], v[240:243]
    v_mfma_f32_16x16x32_bf16 v[244:247], a[148:151], v[224:227], v[244:247]
    v_mfma_f32_16x16x32_bf16 v[248:251], a[144:147], v[228:231], v[248:251]
    v_mfma_f32_16x16x32_bf16 v[252:255], a[148:151], v[228:231], v[252:255]
    s_waitcnt lgkmcnt(0)
    v_mfma_f32_16x16x32_bf16 v[240:243], a[152:155], v[232:235], v[240:243]
    v_mfma_f32_16x16x32_bf16 v[244:247], a[156:159], v[232:235], v[244:247]
    v_mfma_f32_16x16x32_bf16 v[248:251], a[152:155], v[236:239], v[248:251]
    v_mfma_f32_16x16x32_bf16 v[252:255], a[156:159], v[236:239], v[252:255]
    s_nop 4
    v_cvt_pk_bf16_f32 v208, v240, v241
    v_cvt_pk_bf16_f32 v209, v242, v243
    v_lshlrev_b32 v210, 16, v208
    v_and_b32 v211, 0xffff0000, v208
    v_lshlrev_b32 v212, 16, v96
    v_and_b32 v213, 0xffff0000, v96
    v_pk_add_f32 v[210:211], v[210:211], v[212:213]
    v_cvt_pk_bf16_f32 v216, v210, v211
    v_lshlrev_b32 v210, 16, v209
    v_and_b32 v211, 0xffff0000, v209
    v_lshlrev_b32 v212, 16, v97
    v_and_b32 v213, 0xffff0000, v97
    v_pk_add_f32 v[210:211], v[210:211], v[212:213]
    v_cvt_pk_bf16_f32 v217, v210, v211
    v_cvt_pk_bf16_f32 v208, v244, v245
    v_cvt_pk_bf16_f32 v209, v246, v247
    v_lshlrev_b32 v210, 16, v208
    v_and_b32 v211, 0xffff0000, v208
    v_lshlrev_b32 v212, 16, v98
    v_and_b32 v213, 0xffff0000, v98
    v_pk_add_f32 v[210:211], v[210:211], v[212:213]
    v_cvt_pk_bf16_f32 v218, v210, v211
    v_lshlrev_b32 v210, 16, v209
    v_and_b32 v211, 0xffff0000, v209
    v_lshlrev_b32 v212, 16, v99
    v_and_b32 v213, 0xffff0000, v99
    v_pk_add_f32 v[210:211], v[210:211], v[212:213]
    v_cvt_pk_bf16_f32 v219, v210, v211
    v_cvt_pk_bf16_f32 v208, v248, v249
    v_cvt_pk_bf16_f32 v209, v250, v251
    v_lshlrev_b32 v210, 16, v208
    v_and_b32 v211, 0xffff0000, v208
    v_lshlrev_b32 v212, 16, v100
    v_and_b32 v213, 0xffff0000, v100
    v_pk_add_f32 v[210:211], v[210:211], v[212:213]
    v_cvt_pk_bf16_f32 v220, v210, v211
    v_lshlrev_b32 v210, 16, v209
    v_and_b32 v211, 0xffff0000, v209
    v_lshlrev_b32 v212, 16, v101
    v_and_b32 v213, 0xffff0000, v101
    v_pk_add_f32 v[210:211], v[210:211], v[212:213]
    v_cvt_pk_bf16_f32 v221, v210, v211
    v_cvt_pk_bf16_f32 v208, v252, v253
    v_cvt_pk_bf16_f32 v209, v254, v255
    v_lshlrev_b32 v210, 16, v208
    v_and_b32 v211, 0xffff0000, v208
    v_lshlrev_b32 v212, 16, v102
    v_and_b32 v213, 0xffff0000, v102
    v_pk_add_f32 v[210:211], v[210:211], v[212:213]
    v_cvt_pk_bf16_f32 v222, v210, v211
    v_lshlrev_b32 v210, 16, v209
    v_and_b32 v211, 0xffff0000, v209
    v_lshlrev_b32 v212, 16, v103
    v_and_b32 v213, 0xffff0000, v103
    v_pk_add_f32 v[210:211], v[210:211], v[212:213]
    v_cvt_pk_bf16_f32 v223, v210, v211
    s_add_u32 s25, s43, 20480
    buffer_store_dwordx4 v[216:219], v12, s[8:11], s43 offen sc1
    buffer_store_dwordx4 v[220:223], v12, s[8:11], s25 offen sc1
    s_add_u32 s40, s40, 1
    s_add_u32 s43, s43, 163840
    s_cmp_ge_u32 s40, 16
    s_cbranch_scc1 interleave_layers__linear_attn_block__memory_aug_recurrent_mem_tr__prompt_kernel_k3_done
    s_xor_b32 s42, s42, 40960
    s_waitcnt vmcnt(2)
    v_mfma_f32_16x16x32_bf16 v[132:135], a[192:195], v[56:59], 0
    v_mfma_f32_16x16x32_bf16 v[136:139], a[202:205], v[60:63], 0
    v_mfma_f32_16x16x32_bf16 v[112:115], a[160:163], v[56:59], 0
    v_mfma_f32_16x16x32_bf16 v[116:119], a[164:167], v[56:59], 0
    v_mfma_f32_16x16x32_bf16 v[120:123], a[172:175], v[56:59], 0
    v_mfma_f32_16x16x32_bf16 v[124:127], a[180:183], v[60:63], 0
    v_mfma_f32_16x16x32_bf16 v[128:131], a[186:189], v[60:63], 0
    v_mfma_f32_16x16x32_bf16 v[132:135], a[196:199], v[60:63], v[132:135]
    v_mfma_f32_16x16x32_bf16 v[116:119], a[168:171], v[60:63], v[116:119]
    v_mfma_f32_16x16x32_bf16 v[120:123], a[176:179], v[60:63], v[120:123]
    v_mfma_f32_16x16x16_bf16 v[136:139], a[206:207], v[64:65], v[136:139]
    s_nop 0
    v_mfma_f32_16x16x16_bf16 v[124:127], a[184:185], v[64:65], v[124:127]
    v_mfma_f32_16x16x16_bf16 v[128:131], a[190:191], v[64:65], v[128:131]
    v_mfma_f32_16x16x16_bf16 v[132:135], a[200:201], v[64:65], v[132:135]
    v_mfma_f32_16x16x32_bf16 v[160:163], a[240:243], v[66:69], 0
    v_mfma_f32_16x16x32_bf16 v[164:167], a[250:253], v[70:73], 0
    v_mfma_f32_16x16x32_bf16 v[140:143], a[208:211], v[66:69], 0
    v_mfma_f32_16x16x32_bf16 v[144:147], a[212:215], v[66:69], 0
    v_mfma_f32_16x16x32_bf16 v[148:151], a[220:223], v[66:69], 0
    v_mfma_f32_16x16x32_bf16 v[152:155], a[228:231], v[70:73], 0
    v_mfma_f32_16x16x32_bf16 v[156:159], a[234:237], v[70:73], 0
    v_mfma_f32_16x16x32_bf16 v[160:163], a[244:247], v[70:73], v[160:163]
    v_mfma_f32_16x16x32_bf16 v[144:147], a[216:219], v[70:73], v[144:147]
    v_mfma_f32_16x16x32_bf16 v[148:151], a[224:227], v[70:73], v[148:151]
    v_mfma_f32_16x16x16_bf16 v[164:167], a[254:255], v[74:75], v[164:167]
    s_nop 0
    v_mfma_f32_16x16x16_bf16 v[152:155], a[232:233], v[74:75], v[152:155]
    v_mfma_f32_16x16x16_bf16 v[156:159], a[238:239], v[74:75], v[156:159]
    v_mfma_f32_16x16x16_bf16 v[160:163], a[248:249], v[74:75], v[160:163]
    v_add_f32 v132, s54, v132
    v_add_f32 v133, s54, v133
    v_add_f32 v134, s54, v134
    v_add_f32 v135, s54, v135
    v_add_f32 v136, s54, v136
    v_rcp_f32 v132, v132
    v_rcp_f32 v133, v133
    v_rcp_f32 v134, v134
    v_rcp_f32 v135, v135
    v_rcp_f32 v136, v136
    v_mul_f32 v112, v112, v132
    v_mul_f32 v113, v113, v132
    v_mul_f32 v114, v114, v132
    v_mul_f32 v115, v115, v132
    v_cvt_pk_bf16_f32 v168, v112, v113
    v_cvt_pk_bf16_f32 v169, v114, v115
    v_mul_f32 v116, v116, v133
    v_mul_f32 v117, v117, v133
    v_mul_f32 v118, v118, v133
    v_mul_f32 v119, v119, v133
    v_cvt_pk_bf16_f32 v170, v116, v117
    v_cvt_pk_bf16_f32 v171, v118, v119
    v_mul_f32 v120, v120, v134
    v_mul_f32 v121, v121, v134
    v_mul_f32 v122, v122, v134
    v_mul_f32 v123, v123, v134
    v_cvt_pk_bf16_f32 v172, v120, v121
    v_cvt_pk_bf16_f32 v173, v122, v123
    v_mul_f32 v124, v124, v135
    v_mul_f32 v125, v125, v135
    v_mul_f32 v126, v126, v135
    v_mul_f32 v127, v127, v135
    v_cvt_pk_bf16_f32 v174, v124, v125
    v_cvt_pk_bf16_f32 v175, v126, v127
    v_mul_f32 v128, v128, v136
    v_mul_f32 v129, v129, v136
    v_mul_f32 v130, v130, v136
    v_mul_f32 v131, v131, v136
    v_cvt_pk_bf16_f32 v176, v128, v129
    v_cvt_pk_bf16_f32 v177, v130, v131
    v_add_f32 v160, s54, v160
    v_add_f32 v161, s54, v161
    v_add_f32 v162, s54, v162
    v_add_f32 v163, s54, v163
    v_add_f32 v164, s54, v164
    v_rcp_f32 v160, v160
    v_rcp_f32 v161, v161
    v_rcp_f32 v162, v162
    v_rcp_f32 v163, v163
    v_rcp_f32 v164, v164
    v_mul_f32 v140, v140, v160
    v_mul_f32 v141, v141, v160
    v_mul_f32 v142, v142, v160
    v_mul_f32 v143, v143, v160
    v_cvt_pk_bf16_f32 v178, v140, v141
    v_cvt_pk_bf16_f32 v179, v142, v143
    v_mul_f32 v144, v144, v161
    v_mul_f32 v145, v145, v161
    v_mul_f32 v146, v146, v161
    v_mul_f32 v147, v147, v161
    v_cvt_pk_bf16_f32 v180, v144, v145
    v_cvt_pk_bf16_f32 v181, v146, v147
    v_mul_f32 v148, v148, v162
    v_mul_f32 v149, v149, v162
    v_mul_f32 v150, v150, v162
    v_mul_f32 v151, v151, v162
    v_cvt_pk_bf16_f32 v182, v148, v149
    v_cvt_pk_bf16_f32 v183, v150, v151
    v_mul_f32 v152, v152, v163
    v_mul_f32 v153, v153, v163
    v_mul_f32 v154, v154, v163
    v_mul_f32 v155, v155, v163
    v_cvt_pk_bf16_f32 v184, v152, v153
    v_cvt_pk_bf16_f32 v185, v154, v155
    v_mul_f32 v156, v156, v164
    v_mul_f32 v157, v157, v164
    v_mul_f32 v158, v158, v164
    v_mul_f32 v159, v159, v164
    v_cvt_pk_bf16_f32 v186, v156, v157
    v_cvt_pk_bf16_f32 v187, v158, v159
    v_mfma_f32_16x16x32_bf16 v[132:135], a[192:195], v[76:79], 0
    v_mfma_f32_16x16x32_bf16 v[136:139], a[202:205], v[80:83], 0
    v_mfma_f32_16x16x32_bf16 v[112:115], a[160:163], v[76:79], 0
    v_mfma_f32_16x16x32_bf16 v[116:119], a[164:167], v[76:79], 0
    v_mfma_f32_16x16x32_bf16 v[120:123], a[172:175], v[76:79], 0
    v_mfma_f32_16x16x32_bf16 v[124:127], a[180:183], v[80:83], 0
    v_mfma_f32_16x16x32_bf16 v[128:131], a[186:189], v[80:83], 0
    v_mfma_f32_16x16x32_bf16 v[132:135], a[196:199], v[80:83], v[132:135]
    v_mfma_f32_16x16x32_bf16 v[116:119], a[168:171], v[80:83], v[116:119]
    v_mfma_f32_16x16x32_bf16 v[120:123], a[176:179], v[80:83], v[120:123]
    v_mfma_f32_16x16x16_bf16 v[136:139], a[206:207], v[84:85], v[136:139]
    s_nop 0
    v_mfma_f32_16x16x16_bf16 v[124:127], a[184:185], v[84:85], v[124:127]
    v_mfma_f32_16x16x16_bf16 v[128:131], a[190:191], v[84:85], v[128:131]
    v_mfma_f32_16x16x16_bf16 v[132:135], a[200:201], v[84:85], v[132:135]
    v_mfma_f32_16x16x32_bf16 v[160:163], a[240:243], v[86:89], 0
    v_mfma_f32_16x16x32_bf16 v[164:167], a[250:253], v[90:93], 0
    v_mfma_f32_16x16x32_bf16 v[140:143], a[208:211], v[86:89], 0
    v_mfma_f32_16x16x32_bf16 v[144:147], a[212:215], v[86:89], 0
    v_mfma_f32_16x16x32_bf16 v[148:151], a[220:223], v[86:89], 0
    v_mfma_f32_16x16x32_bf16 v[152:155], a[228:231], v[90:93], 0
    v_mfma_f32_16x16x32_bf16 v[156:159], a[234:237], v[90:93], 0
    v_mfma_f32_16x16x32_bf16 v[160:163], a[244:247], v[90:93], v[160:163]
    v_mfma_f32_16x16x32_bf16 v[144:147], a[216:219], v[90:93], v[144:147]
    v_mfma_f32_16x16x32_bf16 v[148:151], a[224:227], v[90:93], v[148:151]
    v_mfma_f32_16x16x16_bf16 v[164:167], a[254:255], v[94:95], v[164:167]
    s_nop 0
    v_mfma_f32_16x16x16_bf16 v[152:155], a[232:233], v[94:95], v[152:155]
    v_mfma_f32_16x16x16_bf16 v[156:159], a[238:239], v[94:95], v[156:159]
    v_mfma_f32_16x16x16_bf16 v[160:163], a[248:249], v[94:95], v[160:163]
    v_add_f32 v132, s54, v132
    v_add_f32 v133, s54, v133
    v_add_f32 v134, s54, v134
    v_add_f32 v135, s54, v135
    v_add_f32 v136, s54, v136
    v_rcp_f32 v132, v132
    v_rcp_f32 v133, v133
    v_rcp_f32 v134, v134
    v_rcp_f32 v135, v135
    v_rcp_f32 v136, v136
    v_mul_f32 v112, v112, v132
    v_mul_f32 v113, v113, v132
    v_mul_f32 v114, v114, v132
    v_mul_f32 v115, v115, v132
    v_cvt_pk_bf16_f32 v188, v112, v113
    v_cvt_pk_bf16_f32 v189, v114, v115
    v_mul_f32 v116, v116, v133
    v_mul_f32 v117, v117, v133
    v_mul_f32 v118, v118, v133
    v_mul_f32 v119, v119, v133
    v_cvt_pk_bf16_f32 v190, v116, v117
    v_cvt_pk_bf16_f32 v191, v118, v119
    v_mul_f32 v120, v120, v134
    v_mul_f32 v121, v121, v134
    v_mul_f32 v122, v122, v134
    v_mul_f32 v123, v123, v134
    v_cvt_pk_bf16_f32 v192, v120, v121
    v_cvt_pk_bf16_f32 v193, v122, v123
    v_mul_f32 v124, v124, v135
    v_mul_f32 v125, v125, v135
    v_mul_f32 v126, v126, v135
    v_mul_f32 v127, v127, v135
    v_cvt_pk_bf16_f32 v194, v124, v125
    v_cvt_pk_bf16_f32 v195, v126, v127
    v_mul_f32 v128, v128, v136
    v_mul_f32 v129, v129, v136
    v_mul_f32 v130, v130, v136
    v_mul_f32 v131, v131, v136
    v_cvt_pk_bf16_f32 v196, v128, v129
    v_cvt_pk_bf16_f32 v197, v130, v131
    v_add_f32 v160, s54, v160
    v_add_f32 v161, s54, v161
    v_add_f32 v162, s54, v162
    v_add_f32 v163, s54, v163
    v_add_f32 v164, s54, v164
    v_rcp_f32 v160, v160
    v_rcp_f32 v161, v161
    v_rcp_f32 v162, v162
    v_rcp_f32 v163, v163
    v_rcp_f32 v164, v164
    v_mul_f32 v140, v140, v160
    v_mul_f32 v141, v141, v160
    v_mul_f32 v142, v142, v160
    v_mul_f32 v143, v143, v160
    v_cvt_pk_bf16_f32 v198, v140, v141
    v_cvt_pk_bf16_f32 v199, v142, v143
    v_mul_f32 v144, v144, v161
    v_mul_f32 v145, v145, v161
    v_mul_f32 v146, v146, v161
    v_mul_f32 v147, v147, v161
    v_cvt_pk_bf16_f32 v200, v144, v145
    v_cvt_pk_bf16_f32 v201, v146, v147
    v_mul_f32 v148, v148, v162
    v_mul_f32 v149, v149, v162
    v_mul_f32 v150, v150, v162
    v_mul_f32 v151, v151, v162
    v_cvt_pk_bf16_f32 v202, v148, v149
    v_cvt_pk_bf16_f32 v203, v150, v151
    v_mul_f32 v152, v152, v163
    v_mul_f32 v153, v153, v163
    v_mul_f32 v154, v154, v163
    v_mul_f32 v155, v155, v163
    v_cvt_pk_bf16_f32 v204, v152, v153
    v_cvt_pk_bf16_f32 v205, v154, v155
    v_mul_f32 v156, v156, v164
    v_mul_f32 v157, v157, v164
    v_mul_f32 v158, v158, v164
    v_mul_f32 v159, v159, v164
    v_cvt_pk_bf16_f32 v206, v156, v157
    v_cvt_pk_bf16_f32 v207, v158, v159
    v_add_u32 v14, s42, v13
    ds_write_b128 v14, v[168:171] offset:0
    ds_write_b128 v14, v[172:175] offset:1024
    ds_write_b128 v14, v[176:179] offset:2048
    ds_write_b128 v14, v[180:183] offset:3072
    ds_write_b128 v14, v[184:187] offset:4096
    ds_write_b128 v14, v[188:191] offset:20480
    ds_write_b128 v14, v[192:195] offset:21504
    ds_write_b128 v14, v[196:199] offset:22528
    ds_write_b128 v14, v[200:203] offset:23552
    ds_write_b128 v14, v[204:207] offset:24576
    s_add_u32 s41, s43, 163840
    s_cmp_lt_u32 s40, 15
    s_cselect_b32 s41, s41, 2146435072
    s_waitcnt vmcnt(0)
    s_add_u32 s25, s41, 20480
    buffer_load_dwordx4 v[16:19], v8, s[8:11], s41 offen offset:0 sc1
    buffer_load_dwordx4 v[20:23], v8, s[8:11], s41 offen offset:1024 sc1
    buffer_load_dwordx2 v[24:25], v9, s[8:11], s41 offen offset:0 sc1
    buffer_load_dwordx4 v[26:29], v8, s[8:11], s41 offen offset:2560 sc1
    buffer_load_dwordx4 v[30:33], v8, s[8:11], s41 offen offset:3584 sc1
    buffer_load_dwordx2 v[34:35], v9, s[8:11], s41 offen offset:2560 sc1
    buffer_load_dwordx4 v[36:39], v8, s[8:11], s25 offen offset:0 sc1
    buffer_load_dwordx4 v[40:43], v8, s[8:11], s25 offen offset:1024 sc1
    buffer_load_dwordx2 v[44:45], v9, s[8:11], s25 offen offset:0 sc1
    buffer_load_dwordx4 v[46:49], v8, s[8:11], s25 offen offset:2560 sc1
    buffer_load_dwordx4 v[50:53], v8, s[8:11], s25 offen offset:3584 sc1
    buffer_load_dwordx2 v[54:55], v9, s[8:11], s25 offen offset:2560 sc1
    buffer_load_dwordx2 v[96:97], v10, s[16:19], s41 offen sc1
    buffer_load_dwordx2 v[98:99], v11, s[16:19], s41 offen sc1
    buffer_load_dwordx2 v[100:101], v10, s[16:19], s25 offen sc1
    buffer_load_dwordx2 v[102:103], v11, s[16:19], s25 offen sc1
    s_waitcnt lgkmcnt(0)
    s_barrier
    s_lshl_b32 s24, s92, 10
    s_sub_u32 s25, s2, 232
    s_lshl_b32 s25, s25, 2
    s_add_u32 s24, s24, s25
    s_add_u32 s24, s24, 23105536
    s_cmp_eq_u32 s3, 0
    s_cbranch_scc0 interleave_layers__linear_attn_block__memory_aug_recurrent_mem_tr__prompt_kernel_pb15
    v_lshlrev_b32 v14, 7, v1
    v_add_u32 v14, s24, v14
    v_mov_b32 v15, 2146435072
    v_cmp_le_u32 vcc, 8, v1
    s_nop 1
    v_cndmask_b32 v14, v14, v15, vcc
    v_mov_b32 v15, s40
    buffer_store_dword v15, v14, s[8:11], 0 offen sc1
interleave_layers__linear_attn_block__memory_aug_recurrent_mem_tr__prompt_kernel_pb15:
    v_add_u32 v15, s42, v5
    ds_read_b128 v[208:211], v15 offset:0
    ds_read_b128 v[212:215], v15 offset:20480
    ds_read_b128 v[216:219], v15 offset:1024
    ds_read_b128 v[220:223], v15 offset:21504
    ds_read_b128 v[224:227], v15 offset:2048
    ds_read_b128 v[228:231], v15 offset:22528
    ds_read_b128 v[232:235], v15 offset:3072
    ds_read_b128 v[236:239], v15 offset:23552
    s_waitcnt lgkmcnt(6)
    v_mfma_f32_16x16x32_bf16 v[240:243], a[0:3], v[208:211], 0
    v_mfma_f32_16x16x32_bf16 v[244:247], a[4:7], v[208:211], 0
    v_mfma_f32_16x16x32_bf16 v[248:251], a[0:3], v[212:215], 0
    v_mfma_f32_16x16x32_bf16 v[252:255], a[4:7], v[212:215], 0
    ds_read_b128 v[208:211], v15 offset:4096
    ds_read_b128 v[212:215], v15 offset:24576
    s_waitcnt lgkmcnt(6)
    v_mfma_f32_16x16x32_bf16 v[240:243], a[8:11], v[216:219], v[240:243]
    v_mfma_f32_16x16x32_bf16 v[244:247], a[12:15], v[216:219], v[244:247]
    v_mfma_f32_16x16x32_bf16 v[248:251], a[8:11], v[220:223], v[248:251]
    v_mfma_f32_16x16x32_bf16 v[252:255], a[12:15], v[220:223], v[252:255]
    ds_read_b128 v[216:219], v15 offset:5120
    ds_read_b128 v[220:223], v15 offset:25600
    s_waitcnt lgkmcnt(6)
    v_mfma_f32_16x16x32_bf16 v[240:243], a[16:19], v[224:227], v[240:243]
    v_mfma_f32_16x16x32_bf16 v[244:247], a[20:23], v[224:227], v[244:247]
    v_mfma_f32_16x16x32_bf16 v[248:251], a[16:19], v[228:231], v[248:251]
    v_mfma_f32_16x16x32_bf16 v[252:255], a[20:23], v[228:231], v[252:255]
    ds_read_b128 v[224:227], v15 offset:6144
    ds_read_b128 v[228:231], v15 offset:26624
    s_waitcnt lgkmcnt(6)
    v_mfma_f32_16x16x32_bf16 v[240:243], a[24:27], v[232:235], v[240:243]
    v_mfma_f32_16x16x32_bf16 v[244:247], a[28:31], v[232:235], v[244:247]
    v_mfma_f32_16x16x32_bf16 v[248:251], a[24:27], v[236:239], v[248:251]
    v_mfma_f32_16x16x32_bf16 v[252:255], a[28:31], v[236:239], v[252:255]
    ds_read_b128 v[232:235], v15 offset:7168
    ds_read_b128 v[236:239], v15 offset:27648
    s_waitcnt lgkmcnt(6)
    v_mfma_f32_16x16x32_bf16 v[240:243], a[32:35], v[208:211], v[240:243]
    v_mfma_f32_16x16x32_bf16 v[244:247], a[36:39], v[208:211], v[244:247]
    v_mfma_f32_16x16x32_bf16 v[248:251], a[32:35], v[212:215], v[248:251]
    v_mfma_f32_16x16x32_bf16 v[252:255], a[36:39], v[212:215], v[252:255]
    ds_read_b128 v[208:211], v15 offset:8192
    ds_read_b128 v[212:215], v15 offset:28672
    s_waitcnt lgkmcnt(6)
    v_mfma_f32_16x16x32_bf16 v[240:243], a[40:43], v[216:219], v[240:243]
    v_mfma_f32_16x16x32_bf16 v[244:247], a[44:47], v[216:219], v[244:247]
    v_mfma_f32_16x16x32_bf16 v[248:251], a[40:43], v[220:223], v[248:251]
    v_mfma_f32_16x16x32_bf16 v[252:255], a[44:47], v[220:223], v[252:255]
    ds_read_b128 v[216:219], v15 offset:9216
    ds_read_b128 v[220:223], v15 offset:29696
    s_waitcnt lgkmcnt(6)
    v_mfma_f32_16x16x32_bf16 v[240:243], a[48:51], v[224:227], v[240:243]
    v_mfma_f32_16x16x32_bf16 v[244:247], a[52:55], v[224:227], v[244:247]
    v_mfma_f32_16x16x32_bf16 v[248:251], a[48:51], v[228:231], v[248:251]
    v_mfma_f32_16x16x32_bf16 v[252:255], a[52:55], v[228:231], v[252:255]
    ds_read_b128 v[224:227], v15 offset:10240
    ds_read_b128 v[228:231], v15 offset:30720
    s_waitcnt lgkmcnt(6)
    v_mfma_f32_16x16x32_bf16 v[240:243], a[56:59], v[232:235], v[240:243]
    v_mfma_f32_16x16x32_bf16 v[244:247], a[60:63], v[232:235], v[244:247]
    v_mfma_f32_16x16x32_bf16 v[248:251], a[56:59], v[236:239], v[248:251]
    v_mfma_f32_16x16x32_bf16 v[252:255], a[60:63], v[236:239], v[252:255]
    ds_read_b128 v[232:235], v15 offset:11264
    ds_read_b128 v[236:239], v15 offset:31744
    s_waitcnt lgkmcnt(6)
    v_mfma_f32_16x16x32_bf16 v[240:243], a[64:67], v[208:211], v[240:243]
    v_mfma_f32_16x16x32_bf16 v[244:247], a[68:71], v[208:211], v[244:247]
    v_mfma_f32_16x16x32_bf16 v[248:251], a[64:67], v[212:215], v[248:251]
    v_mfma_f32_16x16x32_bf16 v[252:255], a[68:71], v[212:215], v[252:255]
    ds_read_b128 v[208:211], v15 offset:12288
    ds_read_b128 v[212:215], v15 offset:32768
    s_waitcnt lgkmcnt(6)
    v_mfma_f32_16x16x32_bf16 v[240:243], a[72:75], v[216:219], v[240:243]
    v_mfma_f32_16x16x32_bf16 v[244:247], a[76:79], v[216:219], v[244:247]
    v_mfma_f32_16x16x32_bf16 v[248:251], a[72:75], v[220:223], v[248:251]
    v_mfma_f32_16x16x32_bf16 v[252:255], a[76:79], v[220:223], v[252:255]
    ds_read_b128 v[216:219], v15 offset:13312
    ds_read_b128 v[220:223], v15 offset:33792
    s_waitcnt lgkmcnt(6)
    v_mfma_f32_16x16x32_bf16 v[240:243], a[80:83], v[224:227], v[240:243]
    v_mfma_f32_16x16x32_bf16 v[244:247], a[84:87], v[224:227], v[244:247]
    v_mfma_f32_16x16x32_bf16 v[248:251], a[80:83], v[228:231], v[248:251]
    v_mfma_f32_16x16x32_bf16 v[252:255], a[84:87], v[228:231], v[252:255]
    ds_read_b128 v[224:227], v15 offset:14336
    ds_read_b128 v[228:231], v15 offset:34816
    s_waitcnt lgkmcnt(6)
    v_mfma_f32_16x16x32_bf16 v[240:243], a[88:91], v[232:235], v[240:243]
    v_mfma_f32_16x16x32_bf16 v[244:247], a[92:95], v[232:235], v[244:247]
    v_mfma_f32_16x16x32_bf16 v[248:251], a[88:91], v[236:239], v[248:251]
    v_mfma_f32_16x16x32_bf16 v[252:255], a[92:95], v[236:239], v[252:255]
    ds_read_b128 v[232:235], v15 offset:15360
    ds_read_b128 v[236:239], v15 offset:35840
    s_waitcnt lgkmcnt(6)
    v_mfma_f32_16x16x32_bf16 v[240:243], a[96:99], v[208:211], v[240:243]
    v_mfma_f32_16x16x32_bf16 v[244:247], a[100:103], v[208:211], v[244:247]
    v_mfma_f32_16x16x32_bf16 v[248:251], a[96:99], v[212:215], v[248:251]
    v_mfma_f32_16x16x32_bf16 v[252:255], a[100:103], v[212:215], v[252:255]
    ds_read_b128 v[208:211], v15 offset:16384
    ds_read_b128 v[212:215], v15 offset:36864
    s_waitcnt lgkmcnt(6)
    v_mfma_f32_16x16x32_bf16 v[240:243], a[104:107], v[216:219], v[240:243]
    v_mfma_f32_16x16x32_bf16 v[244:247], a[108:111], v[216:219], v[244:247]
    v_mfma_f32_16x16x32_bf16 v[248:251], a[104:107], v[220:223], v[248:251]
    v_mfma_f32_16x16x32_bf16 v[252:255], a[108:111], v[220:223], v[252:255]
    ds_read_b128 v[216:219], v15 offset:17408
    ds_read_b128 v[220:223], v15 offset:37888
    s_waitcnt lgkmcnt(6)
    v_mfma_f32_16x16x32_bf16 v[240:243], a[112:115], v[224:227], v[240:243]
    v_mfma_f32_16x16x32_bf16 v[244:247], a[116:119], v[224:227], v[244:247]
    v_mfma_f32_16x16x32_bf16 v[248:251], a[112:115], v[228:231], v[248:251]
    v_mfma_f32_16x16x32_bf16 v[252:255], a[116:119], v[228:231], v[252:255]
    ds_read_b128 v[224:227], v15 offset:18432
    ds_read_b128 v[228:231], v15 offset:38912
    s_waitcnt lgkmcnt(6)
    v_mfma_f32_16x16x32_bf16 v[240:243], a[120:123], v[232:235], v[240:243]
    v_mfma_f32_16x16x32_bf16 v[244:247], a[124:127], v[232:235], v[244:247]
    v_mfma_f32_16x16x32_bf16 v[248:251], a[120:123], v[236:239], v[248:251]
    v_mfma_f32_16x16x32_bf16 v[252:255], a[124:127], v[236:239], v[252:255]
    ds_read_b128 v[232:235], v15 offset:19456
    ds_read_b128 v[236:239], v15 offset:39936
    s_waitcnt lgkmcnt(6)
    v_mfma_f32_16x16x32_bf16 v[240:243], a[128:131], v[208:211], v[240:243]
    v_mfma_f32_16x16x32_bf16 v[244:247], a[132:135], v[208:211], v[244:247]
    v_mfma_f32_16x16x32_bf16 v[248:251], a[128:131], v[212:215], v[248:251]
    v_mfma_f32_16x16x32_bf16 v[252:255], a[132:135], v[212:215], v[252:255]
    s_waitcnt lgkmcnt(4)
    v_mfma_f32_16x16x32_bf16 v[240:243], a[136:139], v[216:219], v[240:243]
    v_mfma_f32_16x16x32_bf16 v[244:247], a[140:143], v[216:219], v[244:247]
    v_mfma_f32_16x16x32_bf16 v[248:251], a[136:139], v[220:223], v[248:251]
    v_mfma_f32_16x16x32_bf16 v[252:255], a[140:143], v[220:223], v[252:255]
    s_waitcnt lgkmcnt(2)
    v_mfma_f32_16x16x32_bf16 v[240:243], a[144:147], v[224:227], v[240:243]
    v_mfma_f32_16x16x32_bf16 v[244:247], a[148:151], v[224:227], v[244:247]
    v_mfma_f32_16x16x32_bf16 v[248:251], a[144:147], v[228:231], v[248:251]
    v_mfma_f32_16x16x32_bf16 v[252:255], a[148:151], v[228:231], v[252:255]
    s_waitcnt lgkmcnt(0)
    v_mfma_f32_16x16x32_bf16 v[240:243], a[152:155], v[232:235], v[240:243]
    v_mfma_f32_16x16x32_bf16 v[244:247], a[156:159], v[232:235], v[244:247]
    v_mfma_f32_16x16x32_bf16 v[248:251], a[152:155], v[236:239], v[248:251]
    v_mfma_f32_16x16x32_bf16 v[252:255], a[156:159], v[236:239], v[252:255]
    s_nop 4
    v_cvt_pk_bf16_f32 v208, v240, v241
    v_cvt_pk_bf16_f32 v209, v242, v243
    v_lshlrev_b32 v210, 16, v208
    v_and_b32 v211, 0xffff0000, v208
    v_lshlrev_b32 v212, 16, v104
    v_and_b32 v213, 0xffff0000, v104
    v_pk_add_f32 v[210:211], v[210:211], v[212:213]
    v_cvt_pk_bf16_f32 v216, v210, v211
    v_lshlrev_b32 v210, 16, v209
    v_and_b32 v211, 0xffff0000, v209
    v_lshlrev_b32 v212, 16, v105
    v_and_b32 v213, 0xffff0000, v105
    v_pk_add_f32 v[210:211], v[210:211], v[212:213]
    v_cvt_pk_bf16_f32 v217, v210, v211
    v_cvt_pk_bf16_f32 v208, v244, v245
    v_cvt_pk_bf16_f32 v209, v246, v247
    v_lshlrev_b32 v210, 16, v208
    v_and_b32 v211, 0xffff0000, v208
    v_lshlrev_b32 v212, 16, v106
    v_and_b32 v213, 0xffff0000, v106
    v_pk_add_f32 v[210:211], v[210:211], v[212:213]
    v_cvt_pk_bf16_f32 v218, v210, v211
    v_lshlrev_b32 v210, 16, v209
    v_and_b32 v211, 0xffff0000, v209
    v_lshlrev_b32 v212, 16, v107
    v_and_b32 v213, 0xffff0000, v107
    v_pk_add_f32 v[210:211], v[210:211], v[212:213]
    v_cvt_pk_bf16_f32 v219, v210, v211
    v_cvt_pk_bf16_f32 v208, v248, v249
    v_cvt_pk_bf16_f32 v209, v250, v251
    v_lshlrev_b32 v210, 16, v208
    v_and_b32 v211, 0xffff0000, v208
    v_lshlrev_b32 v212, 16, v108
    v_and_b32 v213, 0xffff0000, v108
    v_pk_add_f32 v[210:211], v[210:211], v[212:213]
    v_cvt_pk_bf16_f32 v220, v210, v211
    v_lshlrev_b32 v210, 16, v209
    v_and_b32 v211, 0xffff0000, v209
    v_lshlrev_b32 v212, 16, v109
    v_and_b32 v213, 0xffff0000, v109
    v_pk_add_f32 v[210:211], v[210:211], v[212:213]
    v_cvt_pk_bf16_f32 v221, v210, v211
    v_cvt_pk_bf16_f32 v208, v252, v253
    v_cvt_pk_bf16_f32 v209, v254, v255
    v_lshlrev_b32 v210, 16, v208
    v_and_b32 v211, 0xffff0000, v208
    v_lshlrev_b32 v212, 16, v110
    v_and_b32 v213, 0xffff0000, v110
    v_pk_add_f32 v[210:211], v[210:211], v[212:213]
    v_cvt_pk_bf16_f32 v222, v210, v211
    v_lshlrev_b32 v210, 16, v209
    v_and_b32 v211, 0xffff0000, v209
    v_lshlrev_b32 v212, 16, v111
    v_and_b32 v213, 0xffff0000, v111
    v_pk_add_f32 v[210:211], v[210:211], v[212:213]
    v_cvt_pk_bf16_f32 v223, v210, v211
    s_add_u32 s25, s43, 20480
    buffer_store_dwordx4 v[216:219], v12, s[8:11], s43 offen sc1
    buffer_store_dwordx4 v[220:223], v12, s[8:11], s25 offen sc1
    s_add_u32 s40, s40, 1
    s_add_u32 s43, s43, 163840
    s_cmp_ge_u32 s40, 16
    s_cbranch_scc1 interleave_layers__linear_attn_block__memory_aug_recurrent_mem_tr__prompt_kernel_k3_done
    s_xor_b32 s42, s42, 40960
    s_waitcnt vmcnt(2)
    v_mfma_f32_16x16x32_bf16 v[132:135], a[192:195], v[16:19], 0
    v_mfma_f32_16x16x32_bf16 v[136:139], a[202:205], v[20:23], 0
    v_mfma_f32_16x16x32_bf16 v[112:115], a[160:163], v[16:19], 0
    v_mfma_f32_16x16x32_bf16 v[116:119], a[164:167], v[16:19], 0
    v_mfma_f32_16x16x32_bf16 v[120:123], a[172:175], v[16:19], 0
    v_mfma_f32_16x16x32_bf16 v[124:127], a[180:183], v[20:23], 0
    v_mfma_f32_16x16x32_bf16 v[128:131], a[186:189], v[20:23], 0
    v_mfma_f32_16x16x32_bf16 v[132:135], a[196:199], v[20:23], v[132:135]
    v_mfma_f32_16x16x32_bf16 v[116:119], a[168:171], v[20:23], v[116:119]
    v_mfma_f32_16x16x32_bf16 v[120:123], a[176:179], v[20:23], v[120:123]
    v_mfma_f32_16x16x16_bf16 v[136:139], a[206:207], v[24:25], v[136:139]
    s_nop 0
    v_mfma_f32_16x16x16_bf16 v[124:127], a[184:185], v[24:25], v[124:127]
    v_mfma_f32_16x16x16_bf16 v[128:131], a[190:191], v[24:25], v[128:131]
    v_mfma_f32_16x16x16_bf16 v[132:135], a[200:201], v[24:25], v[132:135]
    v_mfma_f32_16x16x32_bf16 v[160:163], a[240:243], v[26:29], 0
    v_mfma_f32_16x16x32_bf16 v[164:167], a[250:253], v[30:33], 0
    v_mfma_f32_16x16x32_bf16 v[140:143], a[208:211], v[26:29], 0
    v_mfma_f32_16x16x32_bf16 v[144:147], a[212:215], v[26:29], 0
    v_mfma_f32_16x16x32_bf16 v[148:151], a[220:223], v[26:29], 0
    v_mfma_f32_16x16x32_bf16 v[152:155], a[228:231], v[30:33], 0
    v_mfma_f32_16x16x32_bf16 v[156:159], a[234:237], v[30:33], 0
    v_mfma_f32_16x16x32_bf16 v[160:163], a[244:247], v[30:33], v[160:163]
    v_mfma_f32_16x16x32_bf16 v[144:147], a[216:219], v[30:33], v[144:147]
    v_mfma_f32_16x16x32_bf16 v[148:151], a[224:227], v[30:33], v[148:151]
    v_mfma_f32_16x16x16_bf16 v[164:167], a[254:255], v[34:35], v[164:167]
    s_nop 0
    v_mfma_f32_16x16x16_bf16 v[152:155], a[232:233], v[34:35], v[152:155]
    v_mfma_f32_16x16x16_bf16 v[156:159], a[238:239], v[34:35], v[156:159]
    v_mfma_f32_16x16x16_bf16 v[160:163], a[248:249], v[34:35], v[160:163]
    v_add_f32 v132, s54, v132
    v_add_f32 v133, s54, v133
    v_add_f32 v134, s54, v134
    v_add_f32 v135, s54, v135
    v_add_f32 v136, s54, v136
    v_rcp_f32 v132, v132
    v_rcp_f32 v133, v133
    v_rcp_f32 v134, v134
    v_rcp_f32 v135, v135
    v_rcp_f32 v136, v136
    v_mul_f32 v112, v112, v132
    v_mul_f32 v113, v113, v132
    v_mul_f32 v114, v114, v132
    v_mul_f32 v115, v115, v132
    v_cvt_pk_bf16_f32 v168, v112, v113
    v_cvt_pk_bf16_f32 v169, v114, v115
    v_mul_f32 v116, v116, v133
    v_mul_f32 v117, v117, v133
    v_mul_f32 v118, v118, v133
    v_mul_f32 v119, v119, v133
    v_cvt_pk_bf16_f32 v170, v116, v117
    v_cvt_pk_bf16_f32 v171, v118, v119
    v_mul_f32 v120, v120, v134
    v_mul_f32 v121, v121, v134
    v_mul_f32 v122, v122, v134
    v_mul_f32 v123, v123, v134
    v_cvt_pk_bf16_f32 v172, v120, v121
    v_cvt_pk_bf16_f32 v173, v122, v123
    v_mul_f32 v124, v124, v135
    v_mul_f32 v125, v125, v135
    v_mul_f32 v126, v126, v135
    v_mul_f32 v127, v127, v135
    v_cvt_pk_bf16_f32 v174, v124, v125
    v_cvt_pk_bf16_f32 v175, v126, v127
    v_mul_f32 v128, v128, v136
    v_mul_f32 v129, v129, v136
    v_mul_f32 v130, v130, v136
    v_mul_f32 v131, v131, v136
    v_cvt_pk_bf16_f32 v176, v128, v129
    v_cvt_pk_bf16_f32 v177, v130, v131
    v_add_f32 v160, s54, v160
    v_add_f32 v161, s54, v161
    v_add_f32 v162, s54, v162
    v_add_f32 v163, s54, v163
    v_add_f32 v164, s54, v164
    v_rcp_f32 v160, v160
    v_rcp_f32 v161, v161
    v_rcp_f32 v162, v162
    v_rcp_f32 v163, v163
    v_rcp_f32 v164, v164
    v_mul_f32 v140, v140, v160
    v_mul_f32 v141, v141, v160
    v_mul_f32 v142, v142, v160
    v_mul_f32 v143, v143, v160
    v_cvt_pk_bf16_f32 v178, v140, v141
    v_cvt_pk_bf16_f32 v179, v142, v143
    v_mul_f32 v144, v144, v161
    v_mul_f32 v145, v145, v161
    v_mul_f32 v146, v146, v161
    v_mul_f32 v147, v147, v161
    v_cvt_pk_bf16_f32 v180, v144, v145
    v_cvt_pk_bf16_f32 v181, v146, v147
    v_mul_f32 v148, v148, v162
    v_mul_f32 v149, v149, v162
    v_mul_f32 v150, v150, v162
    v_mul_f32 v151, v151, v162
    v_cvt_pk_bf16_f32 v182, v148, v149
    v_cvt_pk_bf16_f32 v183, v150, v151
    v_mul_f32 v152, v152, v163
    v_mul_f32 v153, v153, v163
    v_mul_f32 v154, v154, v163
    v_mul_f32 v155, v155, v163
    v_cvt_pk_bf16_f32 v184, v152, v153
    v_cvt_pk_bf16_f32 v185, v154, v155
    v_mul_f32 v156, v156, v164
    v_mul_f32 v157, v157, v164
    v_mul_f32 v158, v158, v164
    v_mul_f32 v159, v159, v164
    v_cvt_pk_bf16_f32 v186, v156, v157
    v_cvt_pk_bf16_f32 v187, v158, v159
    v_mfma_f32_16x16x32_bf16 v[132:135], a[192:195], v[36:39], 0
    v_mfma_f32_16x16x32_bf16 v[136:139], a[202:205], v[40:43], 0
    v_mfma_f32_16x16x32_bf16 v[112:115], a[160:163], v[36:39], 0
    v_mfma_f32_16x16x32_bf16 v[116:119], a[164:167], v[36:39], 0
    v_mfma_f32_16x16x32_bf16 v[120:123], a[172:175], v[36:39], 0
    v_mfma_f32_16x16x32_bf16 v[124:127], a[180:183], v[40:43], 0
    v_mfma_f32_16x16x32_bf16 v[128:131], a[186:189], v[40:43], 0
    v_mfma_f32_16x16x32_bf16 v[132:135], a[196:199], v[40:43], v[132:135]
    v_mfma_f32_16x16x32_bf16 v[116:119], a[168:171], v[40:43], v[116:119]
    v_mfma_f32_16x16x32_bf16 v[120:123], a[176:179], v[40:43], v[120:123]
    v_mfma_f32_16x16x16_bf16 v[136:139], a[206:207], v[44:45], v[136:139]
    s_nop 0
    v_mfma_f32_16x16x16_bf16 v[124:127], a[184:185], v[44:45], v[124:127]
    v_mfma_f32_16x16x16_bf16 v[128:131], a[190:191], v[44:45], v[128:131]
    v_mfma_f32_16x16x16_bf16 v[132:135], a[200:201], v[44:45], v[132:135]
    v_mfma_f32_16x16x32_bf16 v[160:163], a[240:243], v[46:49], 0
    v_mfma_f32_16x16x32_bf16 v[164:167], a[250:253], v[50:53], 0
    v_mfma_f32_16x16x32_bf16 v[140:143], a[208:211], v[46:49], 0
    v_mfma_f32_16x16x32_bf16 v[144:147], a[212:215], v[46:49], 0
    v_mfma_f32_16x16x32_bf16 v[148:151], a[220:223], v[46:49], 0
    v_mfma_f32_16x16x32_bf16 v[152:155], a[228:231], v[50:53], 0
    v_mfma_f32_16x16x32_bf16 v[156:159], a[234:237], v[50:53], 0
    v_mfma_f32_16x16x32_bf16 v[160:163], a[244:247], v[50:53], v[160:163]
    v_mfma_f32_16x16x32_bf16 v[144:147], a[216:219], v[50:53], v[144:147]
    v_mfma_f32_16x16x32_bf16 v[148:151], a[224:227], v[50:53], v[148:151]
    v_mfma_f32_16x16x16_bf16 v[164:167], a[254:255], v[54:55], v[164:167]
    s_nop 0
    v_mfma_f32_16x16x16_bf16 v[152:155], a[232:233], v[54:55], v[152:155]
    v_mfma_f32_16x16x16_bf16 v[156:159], a[238:239], v[54:55], v[156:159]
    v_mfma_f32_16x16x16_bf16 v[160:163], a[248:249], v[54:55], v[160:163]
    v_add_f32 v132, s54, v132
    v_add_f32 v133, s54, v133
    v_add_f32 v134, s54, v134
    v_add_f32 v135, s54, v135
    v_add_f32 v136, s54, v136
    v_rcp_f32 v132, v132
    v_rcp_f32 v133, v133
    v_rcp_f32 v134, v134
    v_rcp_f32 v135, v135
    v_rcp_f32 v136, v136
    v_mul_f32 v112, v112, v132
    v_mul_f32 v113, v113, v132
    v_mul_f32 v114, v114, v132
    v_mul_f32 v115, v115, v132
    v_cvt_pk_bf16_f32 v188, v112, v113
    v_cvt_pk_bf16_f32 v189, v114, v115
    v_mul_f32 v116, v116, v133
    v_mul_f32 v117, v117, v133
    v_mul_f32 v118, v118, v133
    v_mul_f32 v119, v119, v133
    v_cvt_pk_bf16_f32 v190, v116, v117
    v_cvt_pk_bf16_f32 v191, v118, v119
    v_mul_f32 v120, v120, v134
    v_mul_f32 v121, v121, v134
    v_mul_f32 v122, v122, v134
    v_mul_f32 v123, v123, v134
    v_cvt_pk_bf16_f32 v192, v120, v121
    v_cvt_pk_bf16_f32 v193, v122, v123
    v_mul_f32 v124, v124, v135
    v_mul_f32 v125, v125, v135
    v_mul_f32 v126, v126, v135
    v_mul_f32 v127, v127, v135
    v_cvt_pk_bf16_f32 v194, v124, v125
    v_cvt_pk_bf16_f32 v195, v126, v127
    v_mul_f32 v128, v128, v136
    v_mul_f32 v129, v129, v136
    v_mul_f32 v130, v130, v136
    v_mul_f32 v131, v131, v136
    v_cvt_pk_bf16_f32 v196, v128, v129
    v_cvt_pk_bf16_f32 v197, v130, v131
    v_add_f32 v160, s54, v160
    v_add_f32 v161, s54, v161
    v_add_f32 v162, s54, v162
    v_add_f32 v163, s54, v163
    v_add_f32 v164, s54, v164
    v_rcp_f32 v160, v160
    v_rcp_f32 v161, v161
    v_rcp_f32 v162, v162
    v_rcp_f32 v163, v163
    v_rcp_f32 v164, v164
    v_mul_f32 v140, v140, v160
    v_mul_f32 v141, v141, v160
    v_mul_f32 v142, v142, v160
    v_mul_f32 v143, v143, v160
    v_cvt_pk_bf16_f32 v198, v140, v141
    v_cvt_pk_bf16_f32 v199, v142, v143
    v_mul_f32 v144, v144, v161
    v_mul_f32 v145, v145, v161
    v_mul_f32 v146, v146, v161
    v_mul_f32 v147, v147, v161
    v_cvt_pk_bf16_f32 v200, v144, v145
    v_cvt_pk_bf16_f32 v201, v146, v147
    v_mul_f32 v148, v148, v162
    v_mul_f32 v149, v149, v162
    v_mul_f32 v150, v150, v162
    v_mul_f32 v151, v151, v162
    v_cvt_pk_bf16_f32 v202, v148, v149
    v_cvt_pk_bf16_f32 v203, v150, v151
    v_mul_f32 v152, v152, v163
    v_mul_f32 v153, v153, v163
    v_mul_f32 v154, v154, v163
    v_mul_f32 v155, v155, v163
    v_cvt_pk_bf16_f32 v204, v152, v153
    v_cvt_pk_bf16_f32 v205, v154, v155
    v_mul_f32 v156, v156, v164
    v_mul_f32 v157, v157, v164
    v_mul_f32 v158, v158, v164
    v_mul_f32 v159, v159, v164
    v_cvt_pk_bf16_f32 v206, v156, v157
    v_cvt_pk_bf16_f32 v207, v158, v159
    v_add_u32 v14, s42, v13
    ds_write_b128 v14, v[168:171] offset:0
    ds_write_b128 v14, v[172:175] offset:1024
    ds_write_b128 v14, v[176:179] offset:2048
    ds_write_b128 v14, v[180:183] offset:3072
    ds_write_b128 v14, v[184:187] offset:4096
    ds_write_b128 v14, v[188:191] offset:20480
    ds_write_b128 v14, v[192:195] offset:21504
    ds_write_b128 v14, v[196:199] offset:22528
    ds_write_b128 v14, v[200:203] offset:23552
    ds_write_b128 v14, v[204:207] offset:24576
    s_add_u32 s41, s43, 163840
    s_cmp_lt_u32 s40, 15
    s_cselect_b32 s41, s41, 2146435072
    s_waitcnt vmcnt(0)
    s_add_u32 s25, s41, 20480
    buffer_load_dwordx4 v[56:59], v8, s[8:11], s41 offen offset:0 sc1
    buffer_load_dwordx4 v[60:63], v8, s[8:11], s41 offen offset:1024 sc1
    buffer_load_dwordx2 v[64:65], v9, s[8:11], s41 offen offset:0 sc1
    buffer_load_dwordx4 v[66:69], v8, s[8:11], s41 offen offset:2560 sc1
    buffer_load_dwordx4 v[70:73], v8, s[8:11], s41 offen offset:3584 sc1
    buffer_load_dwordx2 v[74:75], v9, s[8:11], s41 offen offset:2560 sc1
    buffer_load_dwordx4 v[76:79], v8, s[8:11], s25 offen offset:0 sc1
    buffer_load_dwordx4 v[80:83], v8, s[8:11], s25 offen offset:1024 sc1
    buffer_load_dwordx2 v[84:85], v9, s[8:11], s25 offen offset:0 sc1
    buffer_load_dwordx4 v[86:89], v8, s[8:11], s25 offen offset:2560 sc1
    buffer_load_dwordx4 v[90:93], v8, s[8:11], s25 offen offset:3584 sc1
    buffer_load_dwordx2 v[94:95], v9, s[8:11], s25 offen offset:2560 sc1
    buffer_load_dwordx2 v[104:105], v10, s[16:19], s41 offen sc1
    buffer_load_dwordx2 v[106:107], v11, s[16:19], s41 offen sc1
    buffer_load_dwordx2 v[108:109], v10, s[16:19], s25 offen sc1
    buffer_load_dwordx2 v[110:111], v11, s[16:19], s25 offen sc1
    s_waitcnt lgkmcnt(0)
    s_barrier
    s_lshl_b32 s24, s92, 10
    s_sub_u32 s25, s2, 232
    s_lshl_b32 s25, s25, 2
    s_add_u32 s24, s24, s25
    s_add_u32 s24, s24, 23105536
    s_cmp_eq_u32 s3, 0
    s_cbranch_scc0 interleave_layers__linear_attn_block__memory_aug_recurrent_mem_tr__prompt_kernel_pb16
    v_lshlrev_b32 v14, 7, v1
    v_add_u32 v14, s24, v14
    v_mov_b32 v15, 2146435072
    v_cmp_le_u32 vcc, 8, v1
    s_nop 1
    v_cndmask_b32 v14, v14, v15, vcc
    v_mov_b32 v15, s40
    buffer_store_dword v15, v14, s[8:11], 0 offen sc1
interleave_layers__linear_attn_block__memory_aug_recurrent_mem_tr__prompt_kernel_pb16:
    s_branch interleave_layers__linear_attn_block__memory_aug_recurrent_mem_tr__prompt_kernel_k3_seg
interleave_layers__linear_attn_block__memory_aug_recurrent_mem_tr__prompt_kernel_k3_done:
    s_waitcnt vmcnt(0)
    s_barrier
    s_lshl_b32 s24, s92, 10
    s_sub_u32 s25, s2, 232
    s_lshl_b32 s25, s25, 2
    s_add_u32 s24, s24, s25
    s_add_u32 s24, s24, 23105536
    s_cmp_eq_u32 s3, 0
    s_cbranch_scc0 interleave_layers__linear_attn_block__memory_aug_recurrent_mem_tr__prompt_kernel_pb17
    v_lshlrev_b32 v14, 7, v1
    v_add_u32 v14, s24, v14
    v_mov_b32 v15, 2146435072
    v_cmp_le_u32 vcc, 8, v1
    s_nop 1
    v_cndmask_b32 v14, v14, v15, vcc
    v_mov_b32 v15, s40
    buffer_store_dword v15, v14, s[8:11], 0 offen sc1
interleave_layers__linear_attn_block__memory_aug_recurrent_mem_tr__prompt_kernel_pb17:
    s_cmp_eq_u32 s92, 0
    s_cbranch_scc0 interleave_layers__linear_attn_block__memory_aug_recurrent_mem_tr__prompt_kernel_end
    s_mov_b32 s92, 1
    s_branch interleave_layers__linear_attn_block__memory_aug_recurrent_mem_tr__prompt_kernel_helper_top
interleave_layers__linear_attn_block__memory_aug_recurrent_mem_tr__prompt_kernel_helper_clr:
    s_cmp_eq_u32 s92, 0
    s_cbranch_scc0 interleave_layers__linear_attn_block__memory_aug_recurrent_mem_tr__prompt_kernel_end
    s_sub_u32 s44, s2, 252
    s_lshl_b32 s24, s44, 2
    s_add_u32 s24, s24, s3
    s_mul_i32 s24, s24, 28672
    s_add_u32 s41, s24, 117440512
    v_lshlrev_b32 v5, 4, v1
    v_add_u32 v6, 4096, v5
    v_mov_b32 v8, -1
    v_mov_b32 v9, -1
    v_mov_b32 v10, -1
    v_mov_b32 v11, -1
    s_lshl_b32 s24, s44, 2
    s_add_u32 s42, s24, 23109632
    s_mov_b32 s40, 0
interleave_layers__linear_attn_block__memory_aug_recurrent_mem_tr__prompt_kernel_clr_blk:
    s_mov_b32 s43, s41
    buffer_store_dwordx4 v[8:11], v5, s[8:11], s43 offen offset:0 sc0 sc1
    buffer_store_dwordx4 v[8:11], v5, s[8:11], s43 offen offset:1024 sc0 sc1
    buffer_store_dwordx4 v[8:11], v5, s[8:11], s43 offen offset:2048 sc0 sc1
    buffer_store_dwordx4 v[8:11], v5, s[8:11], s43 offen offset:3072 sc0 sc1
    s_add_u32 s43, s43, 4096
    buffer_store_dwordx4 v[8:11], v5, s[8:11], s43 offen offset:0 sc0 sc1
    buffer_store_dwordx4 v[8:11], v5, s[8:11], s43 offen offset:1024 sc0 sc1
    buffer_store_dwordx4 v[8:11], v5, s[8:11], s43 offen offset:2048 sc0 sc1
    buffer_store_dwordx4 v[8:11], v5, s[8:11], s43 offen offset:3072 sc0 sc1
    s_add_u32 s43, s43, 4096
    buffer_store_dwordx4 v[8:11], v5, s[8:11], s43 offen offset:0 sc0 sc1
    buffer_store_dwordx4 v[8:11], v5, s[8:11], s43 offen offset:1024 sc0 sc1
    buffer_store_dwordx4 v[8:11], v5, s[8:11], s43 offen offset:2048 sc0 sc1
    buffer_store_dwordx4 v[8:11], v5, s[8:11], s43 offen offset:3072 sc0 sc1
    s_add_u32 s43, s43, 4096
    buffer_store_dwordx4 v[8:11], v5, s[8:11], s43 offen offset:0 sc0 sc1
    buffer_store_dwordx4 v[8:11], v5, s[8:11], s43 offen offset:1024 sc0 sc1
    buffer_store_dwordx4 v[8:11], v5, s[8:11], s43 offen offset:2048 sc0 sc1
    buffer_store_dwordx4 v[8:11], v5, s[8:11], s43 offen offset:3072 sc0 sc1
    s_add_u32 s43, s43, 4096
    buffer_store_dwordx4 v[8:11], v5, s[8:11], s43 offen offset:0 sc0 sc1
    buffer_store_dwordx4 v[8:11], v5, s[8:11], s43 offen offset:1024 sc0 sc1
    buffer_store_dwordx4 v[8:11], v5, s[8:11], s43 offen offset:2048 sc0 sc1
    buffer_store_dwordx4 v[8:11], v5, s[8:11], s43 offen offset:3072 sc0 sc1
    s_add_u32 s43, s43, 4096
    buffer_store_dwordx4 v[8:11], v5, s[8:11], s43 offen offset:0 sc0 sc1
    buffer_store_dwordx4 v[8:11], v5, s[8:11], s43 offen offset:1024 sc0 sc1
    buffer_store_dwordx4 v[8:11], v5, s[8:11], s43 offen offset:2048 sc0 sc1
    buffer_store_dwordx4 v[8:11], v5, s[8:11], s43 offen offset:3072 sc0 sc1
    s_add_u32 s43, s43, 4096
    buffer_store_dwordx4 v[8:11], v5, s[8:11], s43 offen offset:0 sc0 sc1
    buffer_store_dwordx4 v[8:11], v5, s[8:11], s43 offen offset:1024 sc0 sc1
    buffer_store_dwordx4 v[8:11], v5, s[8:11], s43 offen offset:2048 sc0 sc1
    buffer_store_dwordx4 v[8:11], v5, s[8:11], s43 offen offset:3072 sc0 sc1
    s_waitcnt vmcnt(28)
    s_barrier
    s_cmp_eq_u32 s3, 0
    s_cbranch_scc0 interleave_layers__linear_attn_block__memory_aug_recurrent_mem_tr__prompt_kernel_pb18
    v_lshlrev_b32 v14, 7, v1
    v_add_u32 v14, s42, v14
    v_mov_b32 v15, 2146435072
    v_cmp_le_u32 vcc, 8, v1
    s_nop 1
    v_cndmask_b32 v14, v14, v15, vcc
    v_mov_b32 v15, s40
    buffer_store_dword v15, v14, s[8:11], 0 offen sc1
interleave_layers__linear_attn_block__memory_aug_recurrent_mem_tr__prompt_kernel_pb18:
    s_add_u32 s40, s40, 1
    s_add_u32 s41, s41, 458752
    s_cmp_lt_u32 s40, 128
    s_cbranch_scc1 interleave_layers__linear_attn_block__memory_aug_recurrent_mem_tr__prompt_kernel_clr_blk
    s_waitcnt vmcnt(0)
    s_barrier
    s_cmp_eq_u32 s3, 0
    s_cbranch_scc0 interleave_layers__linear_attn_block__memory_aug_recurrent_mem_tr__prompt_kernel_pb19
    v_lshlrev_b32 v14, 7, v1
    v_add_u32 v14, s42, v14
    v_mov_b32 v15, 2146435072
    v_cmp_le_u32 vcc, 8, v1
    s_nop 1
    v_cndmask_b32 v14, v14, v15, vcc
    v_mov_b32 v15, s40
    buffer_store_dword v15, v14, s[8:11], 0 offen sc1
interleave_layers__linear_attn_block__memory_aug_recurrent_mem_tr__prompt_kernel_pb19:
    s_mov_b32 s92, 1
    s_branch interleave_layers__linear_attn_block__memory_aug_recurrent_mem_tr__prompt_kernel_helper_top
interleave_layers__linear_attn_block__memory_aug_recurrent_mem_tr__prompt_kernel_roleS:
    s_mov_b32 s44, s2
    s_load_dwordx2 s[6:7], s[0:1], 40
    s_load_dwordx2 s[24:25], s[0:1], 48
    s_load_dwordx2 s[26:27], s[0:1], 32
    s_waitcnt lgkmcnt(0)
    s_mov_b32 s12, s6
    s_mov_b32 s13, s7
    s_mov_b32 s14, 7864320
    s_mov_b32 s15, 0x00020000
    s_mov_b32 s16, s24
    s_mov_b32 s17, s25
    s_mov_b32 s18, 7864320
    s_mov_b32 s19, 0x00020000
    s_mov_b32 s20, s26
    s_mov_b32 s21, s27
    s_mov_b32 s22, 10240
    s_mov_b32 s23, 0x00020000
    v_add_u32 v16, 0, v0
    s_mov_b32 s24, 683
    v_mul_lo_u32 v17, v16, s24
    v_lshrrev_b32 v17, 14, v17
    v_mul_u32_u24 v18, 24, v17
    v_sub_u32 v18, v16, v18
    s_mov_b32 s24, 12288
    v_mul_lo_u32 v4, v17, s24
    v_lshl_add_u32 v4, v18, 4, v4
    v_mul_u32_u24 v10, 400, v17
    v_lshl_add_u32 v10, v18, 4, v10
    v_add_u32 v10, 106496, v10
    v_add_u32 v16, 256, v0
    s_mov_b32 s24, 683
    v_mul_lo_u32 v17, v16, s24
    v_lshrrev_b32 v17, 14, v17
    v_mul_u32_u24 v18, 24, v17
    v_sub_u32 v18, v16, v18
    s_mov_b32 s24, 12288
    v_mul_lo_u32 v5, v17, s24
    v_lshl_add_u32 v5, v18, 4, v5
    v_mul_u32_u24 v11, 400, v17
    v_lshl_add_u32 v11, v18, 4, v11
    v_add_u32 v11, 106496, v11
    v_add_u32 v16, 512, v0
    s_mov_b32 s24, 683
    v_mul_lo_u32 v17, v16, s24
    v_lshrrev_b32 v17, 14, v17
    v_mul_u32_u24 v18, 24, v17
    v_sub_u32 v18, v16, v18
    s_mov_b32 s24, 12288
    v_mul_lo_u32 v6, v17, s24
    v_lshl_add_u32 v6, v18, 4, v6
    v_mul_u32_u24 v12, 400, v17
    v_lshl_add_u32 v12, v18, 4, v12
    v_add_u32 v12, 106496, v12
    v_add_u32 v16, 768, v0
    s_mov_b32 s24, 683
    v_mul_lo_u32 v17, v16, s24
    v_lshrrev_b32 v17, 14, v17
    v_mul_u32_u24 v18, 24, v17
    v_sub_u32 v18, v16, v18
    s_mov_b32 s24, 12288
    v_mul_lo_u32 v7, v17, s24
    v_lshl_add_u32 v7, v18, 4, v7
    v_mul_u32_u24 v13, 400, v17
    v_lshl_add_u32 v13, v18, 4, v13
    v_add_u32 v13, 106496, v13
    v_add_u32 v16, 1024, v0
    s_mov_b32 s24, 683
    v_mul_lo_u32 v17, v16, s24
    v_lshrrev_b32 v17, 14, v17
    v_mul_u32_u24 v18, 24, v17
    v_sub_u32 v18, v16, v18
    s_mov_b32 s24, 12288
    v_mul_lo_u32 v8, v17, s24
    v_lshl_add_u32 v8, v18, 4, v8
    v_mul_u32_u24 v14, 400, v17
    v_lshl_add_u32 v14, v18, 4, v14
    v_add_u32 v14, 106496, v14
    v_add_u32 v16, 1280, v0
    s_mov_b32 s24, 683
    v_mul_lo_u32 v17, v16, s24
    v_lshrrev_b32 v17, 14, v17
    v_mul_u32_u24 v18, 24, v17
    v_sub_u32 v18, v16, v18
    s_mov_b32 s24, 12288
    v_mul_lo_u32 v9, v17, s24
    v_lshl_add_u32 v9, v18, 4, v9
    v_mul_u32_u24 v15, 400, v17
    v_lshl_add_u32 v15, v18, 4, v15
    v_add_u32 v15, 106496, v15
    v_lshrrev_b32 v17, 1, v3
    v_lshlrev_b32 v17, 4, v17
    v_and_b32 v18, 1, v3
    v_lshl_add_u32 v17, v18, 2, v17
    v_lshrrev_b32 v18, 2, v2
    v_and_b32 v19, 1, v18
    v_add_u32 v17, v17, v19
    v_lshrrev_b32 v18, 1, v18
    v_lshl_add_u32 v17, v18, 3, v17
    v_mul_u32_u24 v16, 400, v17
    v_and_b32 v18, 3, v2
    v_lshl_add_u32 v16, v18, 3, v16
    v_add_u32 v16, 106496, v16
    s_mul_i32 s24, s3, 96
    v_add_u32 v16, s24, v16
    v_lshlrev_b32 v17, 4, v1
    s_mul_i32 s24, s3, 20480
    s_add_u32 s24, s24, 24576
    v_add_u32 v17, s24, v17
    s_mul_i32 s45, s44, 384
    s_add_u32 s46, s45, 0
    buffer_load_dwordx4 v[24:27], v4, s[12:15], s46 offen
    buffer_load_dwordx4 v[28:31], v5, s[12:15], s46 offen
    buffer_load_dwordx4 v[32:35], v6, s[12:15], s46 offen
    buffer_load_dwordx4 v[36:39], v7, s[12:15], s46 offen
    buffer_load_dwordx4 v[40:43], v8, s[12:15], s46 offen
    buffer_load_dwordx4 v[44:47], v9, s[12:15], s46 offen
    s_add_u32 s46, s45, 0
    buffer_load_dwordx4 v[48:51], v4, s[16:19], s46 offen
    buffer_load_dwordx4 v[52:55], v5, s[16:19], s46 offen
    buffer_load_dwordx4 v[56:59], v6, s[16:19], s46 offen
    buffer_load_dwordx4 v[60:63], v7, s[16:19], s46 offen
    buffer_load_dwordx4 v[64:67], v8, s[16:19], s46 offen
    buffer_load_dwordx4 v[68:71], v9, s[16:19], s46 offen
    s_waitcnt vmcnt(6)
    ds_write_b128 v10, v[24:27]
    ds_write_b128 v11, v[28:31]
    ds_write_b128 v12, v[32:35]
    ds_write_b128 v13, v[36:39]
    ds_write_b128 v14, v[40:43]
    ds_write_b128 v15, v[44:47]
    s_add_u32 s46, s45, 786432
    buffer_load_dwordx4 v[72:75], v4, s[12:15], s46 offen
    buffer_load_dwordx4 v[76:79], v5, s[12:15], s46 offen
    buffer_load_dwordx4 v[80:83], v6, s[12:15], s46 offen
    buffer_load_dwordx4 v[84:87], v7, s[12:15], s46 offen
    buffer_load_dwordx4 v[88:91], v8, s[12:15], s46 offen
    buffer_load_dwordx4 v[92:95], v9, s[12:15], s46 offen
    s_waitcnt lgkmcnt(0)
    s_barrier
    ds_read_b64_tr_b16 a[0:1], v16 offset:0
    ds_read_b64_tr_b16 a[2:3], v16 offset:800
    ds_read_b64_tr_b16 a[4:5], v16 offset:12800
    ds_read_b64_tr_b16 a[6:7], v16 offset:13600
    ds_read_b64_tr_b16 a[80:81], v16 offset:32
    ds_read_b64_tr_b16 a[82:83], v16 offset:832
    ds_read_b64_tr_b16 a[84:85], v16 offset:12832
    ds_read_b64_tr_b16 a[86:87], v16 offset:13632
    ds_read_b64_tr_b16 a[160:161], v16 offset:64
    ds_read_b64_tr_b16 a[162:163], v16 offset:864
    ds_read_b64_tr_b16 a[164:165], v16 offset:12864
    ds_read_b64_tr_b16 a[166:167], v16 offset:13664
    s_waitcnt lgkmcnt(0)
    s_barrier
    s_waitcnt vmcnt(6)
    ds_write_b128 v10, v[48:51]
    ds_write_b128 v11, v[52:55]
    ds_write_b128 v12, v[56:59]
    ds_write_b128 v13, v[60:63]
    ds_write_b128 v14, v[64:67]
    ds_write_b128 v15, v[68:71]
    s_add_u32 s46, s45, 786432
    buffer_load_dwordx4 v[24:27], v4, s[16:19], s46 offen
    buffer_load_dwordx4 v[28:31], v5, s[16:19], s46 offen
    buffer_load_dwordx4 v[32:35], v6, s[16:19], s46 offen
    buffer_load_dwordx4 v[36:39], v7, s[16:19], s46 offen
    buffer_load_dwordx4 v[40:43], v8, s[16:19], s46 offen
    buffer_load_dwordx4 v[44:47], v9, s[16:19], s46 offen
    s_waitcnt lgkmcnt(0)
    s_barrier
    ds_read_b64_tr_b16 v[96:97], v16 offset:0
    ds_read_b64_tr_b16 v[98:99], v16 offset:800
    ds_read_b64_tr_b16 v[100:101], v16 offset:12800
    ds_read_b64_tr_b16 v[102:103], v16 offset:13600
    ds_read_b64_tr_b16 v[176:177], v16 offset:32
    ds_read_b64_tr_b16 v[178:179], v16 offset:832
    ds_read_b64_tr_b16 v[180:181], v16 offset:12832
    ds_read_b64_tr_b16 v[182:183], v16 offset:13632
    ds_read_b64_tr_b16 v[48:49], v16 offset:64
    ds_read_b64_tr_b16 v[50:51], v16 offset:864
    ds_read_b64_tr_b16 v[52:53], v16 offset:12864
    ds_read_b64_tr_b16 v[54:55], v16 offset:13664
    s_waitcnt lgkmcnt(0)
    ds_write_b128 v17, v[48:51] offset:0
    ds_write_b128 v17, v[52:55] offset:1024
    s_waitcnt lgkmcnt(0)
    s_barrier
    s_waitcnt vmcnt(6)
    ds_write_b128 v10, v[72:75]
    ds_write_b128 v11, v[76:79]
    ds_write_b128 v12, v[80:83]
    ds_write_b128 v13, v[84:87]
    ds_write_b128 v14, v[88:91]
    ds_write_b128 v15, v[92:95]
    s_add_u32 s46, s45, 1572864
    buffer_load_dwordx4 v[48:51], v4, s[12:15], s46 offen
    buffer_load_dwordx4 v[52:55], v5, s[12:15], s46 offen
    buffer_load_dwordx4 v[56:59], v6, s[12:15], s46 offen
    buffer_load_dwordx4 v[60:63], v7, s[12:15], s46 offen
    buffer_load_dwordx4 v[64:67], v8, s[12:15], s46 offen
    buffer_load_dwordx4 v[68:71], v9, s[12:15], s46 offen
    s_waitcnt lgkmcnt(0)
    s_barrier
    ds_read_b64_tr_b16 a[8:9], v16 offset:0
    ds_read_b64_tr_b16 a[10:11], v16 offset:800
    ds_read_b64_tr_b16 a[12:13], v16 offset:12800
    ds_read_b64_tr_b16 a[14:15], v16 offset:13600
    ds_read_b64_tr_b16 a[88:89], v16 offset:32
    ds_read_b64_tr_b16 a[90:91], v16 offset:832
    ds_read_b64_tr_b16 a[92:93], v16 offset:12832
    ds_read_b64_tr_b16 a[94:95], v16 offset:13632
    ds_read_b64_tr_b16 a[168:169], v16 offset:64
    ds_read_b64_tr_b16 a[170:171], v16 offset:864
    ds_read_b64_tr_b16 a[172:173], v16 offset:12864
    ds_read_b64_tr_b16 a[174:175], v16 offset:13664
    s_waitcnt lgkmcnt(0)
    s_barrier
    s_waitcnt vmcnt(6)
    ds_write_b128 v10, v[24:27]
    ds_write_b128 v11, v[28:31]
    ds_write_b128 v12, v[32:35]
    ds_write_b128 v13, v[36:39]
    ds_write_b128 v14, v[40:43]
    ds_write_b128 v15, v[44:47]
    s_add_u32 s46, s45, 1572864
    buffer_load_dwordx4 v[72:75], v4, s[16:19], s46 offen
    buffer_load_dwordx4 v[76:79], v5, s[16:19], s46 offen
    buffer_load_dwordx4 v[80:83], v6, s[16:19], s46 offen
    buffer_load_dwordx4 v[84:87], v7, s[16:19], s46 offen
    buffer_load_dwordx4 v[88:91], v8, s[16:19], s46 offen
    buffer_load_dwordx4 v[92:95], v9, s[16:19], s46 offen
    s_waitcnt lgkmcnt(0)
    s_barrier
    ds_read_b64_tr_b16 v[104:105], v16 offset:0
    ds_read_b64_tr_b16 v[106:107], v16 offset:800
    ds_read_b64_tr_b16 v[108:109], v16 offset:12800
    ds_read_b64_tr_b16 v[110:111], v16 offset:13600
    ds_read_b64_tr_b16 v[184:185], v16 offset:32
    ds_read_b64_tr_b16 v[186:187], v16 offset:832
    ds_read_b64_tr_b16 v[188:189], v16 offset:12832
    ds_read_b64_tr_b16 v[190:191], v16 offset:13632
    ds_read_b64_tr_b16 v[24:25], v16 offset:64
    ds_read_b64_tr_b16 v[26:27], v16 offset:864
    ds_read_b64_tr_b16 v[28:29], v16 offset:12864
    ds_read_b64_tr_b16 v[30:31], v16 offset:13664
    s_waitcnt lgkmcnt(0)
    ds_write_b128 v17, v[24:27] offset:2048
    ds_write_b128 v17, v[28:31] offset:3072
    s_waitcnt lgkmcnt(0)
    s_barrier
    s_waitcnt vmcnt(6)
    ds_write_b128 v10, v[48:51]
    ds_write_b128 v11, v[52:55]
    ds_write_b128 v12, v[56:59]
    ds_write_b128 v13, v[60:63]
    ds_write_b128 v14, v[64:67]
    ds_write_b128 v15, v[68:71]
    s_add_u32 s46, s45, 2359296
    buffer_load_dwordx4 v[24:27], v4, s[12:15], s46 offen
    buffer_load_dwordx4 v[28:31], v5, s[12:15], s46 offen
    buffer_load_dwordx4 v[32:35], v6, s[12:15], s46 offen
    buffer_load_dwordx4 v[36:39], v7, s[12:15], s46 offen
    buffer_load_dwordx4 v[40:43], v8, s[12:15], s46 offen
    buffer_load_dwordx4 v[44:47], v9, s[12:15], s46 offen
    s_waitcnt lgkmcnt(0)
    s_barrier
    ds_read_b64_tr_b16 a[16:17], v16 offset:0
    ds_read_b64_tr_b16 a[18:19], v16 offset:800
    ds_read_b64_tr_b16 a[20:21], v16 offset:12800
    ds_read_b64_tr_b16 a[22:23], v16 offset:13600
    ds_read_b64_tr_b16 a[96:97], v16 offset:32
    ds_read_b64_tr_b16 a[98:99], v16 offset:832
    ds_read_b64_tr_b16 a[100:101], v16 offset:12832
    ds_read_b64_tr_b16 a[102:103], v16 offset:13632
    ds_read_b64_tr_b16 a[176:177], v16 offset:64
    ds_read_b64_tr_b16 a[178:179], v16 offset:864
    ds_read_b64_tr_b16 a[180:181], v16 offset:12864
    ds_read_b64_tr_b16 a[182:183], v16 offset:13664
    s_waitcnt lgkmcnt(0)
    s_barrier
    s_waitcnt vmcnt(6)
    ds_write_b128 v10, v[72:75]
    ds_write_b128 v11, v[76:79]
    ds_write_b128 v12, v[80:83]
    ds_write_b128 v13, v[84:87]
    ds_write_b128 v14, v[88:91]
    ds_write_b128 v15, v[92:95]
    s_add_u32 s46, s45, 2359296
    buffer_load_dwordx4 v[48:51], v4, s[16:19], s46 offen
    buffer_load_dwordx4 v[52:55], v5, s[16:19], s46 offen
    buffer_load_dwordx4 v[56:59], v6, s[16:19], s46 offen
    buffer_load_dwordx4 v[60:63], v7, s[16:19], s46 offen
    buffer_load_dwordx4 v[64:67], v8, s[16:19], s46 offen
    buffer_load_dwordx4 v[68:71], v9, s[16:19], s46 offen
    s_waitcnt lgkmcnt(0)
    s_barrier
    ds_read_b64_tr_b16 v[112:113], v16 offset:0
    ds_read_b64_tr_b16 v[114:115], v16 offset:800
    ds_read_b64_tr_b16 v[116:117], v16 offset:12800
    ds_read_b64_tr_b16 v[118:119], v16 offset:13600
    ds_read_b64_tr_b16 v[192:193], v16 offset:32
    ds_read_b64_tr_b16 v[194:195], v16 offset:832
    ds_read_b64_tr_b16 v[196:197], v16 offset:12832
    ds_read_b64_tr_b16 v[198:199], v16 offset:13632
    ds_read_b64_tr_b16 v[72:73], v16 offset:64
    ds_read_b64_tr_b16 v[74:75], v16 offset:864
    ds_read_b64_tr_b16 v[76:77], v16 offset:12864
    ds_read_b64_tr_b16 v[78:79], v16 offset:13664
    s_waitcnt lgkmcnt(0)
    ds_write_b128 v17, v[72:75] offset:4096
    ds_write_b128 v17, v[76:79] offset:5120
    s_waitcnt lgkmcnt(0)
    s_barrier
    s_waitcnt vmcnt(6)
    ds_write_b128 v10, v[24:27]
    ds_write_b128 v11, v[28:31]
    ds_write_b128 v12, v[32:35]
    ds_write_b128 v13, v[36:39]
    ds_write_b128 v14, v[40:43]
    ds_write_b128 v15, v[44:47]
    s_add_u32 s46, s45, 3145728
    buffer_load_dwordx4 v[72:75], v4, s[12:15], s46 offen
    buffer_load_dwordx4 v[76:79], v5, s[12:15], s46 offen
    buffer_load_dwordx4 v[80:83], v6, s[12:15], s46 offen
    buffer_load_dwordx4 v[84:87], v7, s[12:15], s46 offen
    buffer_load_dwordx4 v[88:91], v8, s[12:15], s46 offen
    buffer_load_dwordx4 v[92:95], v9, s[12:15], s46 offen
    s_waitcnt lgkmcnt(0)
    s_barrier
    ds_read_b64_tr_b16 a[24:25], v16 offset:0
    ds_read_b64_tr_b16 a[26:27], v16 offset:800
    ds_read_b64_tr_b16 a[28:29], v16 offset:12800
    ds_read_b64_tr_b16 a[30:31], v16 offset:13600
    ds_read_b64_tr_b16 a[104:105], v16 offset:32
    ds_read_b64_tr_b16 a[106:107], v16 offset:832
    ds_read_b64_tr_b16 a[108:109], v16 offset:12832
    ds_read_b64_tr_b16 a[110:111], v16 offset:13632
    ds_read_b64_tr_b16 a[184:185], v16 offset:64
    ds_read_b64_tr_b16 a[186:187], v16 offset:864
    ds_read_b64_tr_b16 a[188:189], v16 offset:12864
    ds_read_b64_tr_b16 a[190:191], v16 offset:13664
    s_waitcnt lgkmcnt(0)
    s_barrier
    s_waitcnt vmcnt(6)
    ds_write_b128 v10, v[48:51]
    ds_write_b128 v11, v[52:55]
    ds_write_b128 v12, v[56:59]
    ds_write_b128 v13, v[60:63]
    ds_write_b128 v14, v[64:67]
    ds_write_b128 v15, v[68:71]
    s_add_u32 s46, s45, 3145728
    buffer_load_dwordx4 v[24:27], v4, s[16:19], s46 offen
    buffer_load_dwordx4 v[28:31], v5, s[16:19], s46 offen
    buffer_load_dwordx4 v[32:35], v6, s[16:19], s46 offen
    buffer_load_dwordx4 v[36:39], v7, s[16:19], s46 offen
    buffer_load_dwordx4 v[40:43], v8, s[16:19], s46 offen
    buffer_load_dwordx4 v[44:47], v9, s[16:19], s46 offen
    s_waitcnt lgkmcnt(0)
    s_barrier
    ds_read_b64_tr_b16 v[120:121], v16 offset:0
    ds_read_b64_tr_b16 v[122:123], v16 offset:800
    ds_read_b64_tr_b16 v[124:125], v16 offset:12800
    ds_read_b64_tr_b16 v[126:127], v16 offset:13600
    ds_read_b64_tr_b16 v[200:201], v16 offset:32
    ds_read_b64_tr_b16 v[202:203], v16 offset:832
    ds_read_b64_tr_b16 v[204:205], v16 offset:12832
    ds_read_b64_tr_b16 v[206:207], v16 offset:13632
    ds_read_b64_tr_b16 v[48:49], v16 offset:64
    ds_read_b64_tr_b16 v[50:51], v16 offset:864
    ds_read_b64_tr_b16 v[52:53], v16 offset:12864
    ds_read_b64_tr_b16 v[54:55], v16 offset:13664
    s_waitcnt lgkmcnt(0)
    ds_write_b128 v17, v[48:51] offset:6144
    ds_write_b128 v17, v[52:55] offset:7168
    s_waitcnt lgkmcnt(0)
    s_barrier
    s_waitcnt vmcnt(6)
    ds_write_b128 v10, v[72:75]
    ds_write_b128 v11, v[76:79]
    ds_write_b128 v12, v[80:83]
    ds_write_b128 v13, v[84:87]
    ds_write_b128 v14, v[88:91]
    ds_write_b128 v15, v[92:95]
    s_add_u32 s46, s45, 3932160
    buffer_load_dwordx4 v[48:51], v4, s[12:15], s46 offen
    buffer_load_dwordx4 v[52:55], v5, s[12:15], s46 offen
    buffer_load_dwordx4 v[56:59], v6, s[12:15], s46 offen
    buffer_load_dwordx4 v[60:63], v7, s[12:15], s46 offen
    buffer_load_dwordx4 v[64:67], v8, s[12:15], s46 offen
    buffer_load_dwordx4 v[68:71], v9, s[12:15], s46 offen
    s_waitcnt lgkmcnt(0)
    s_barrier
    ds_read_b64_tr_b16 a[32:33], v16 offset:0
    ds_read_b64_tr_b16 a[34:35], v16 offset:800
    ds_read_b64_tr_b16 a[36:37], v16 offset:12800
    ds_read_b64_tr_b16 a[38:39], v16 offset:13600
    ds_read_b64_tr_b16 a[112:113], v16 offset:32
    ds_read_b64_tr_b16 a[114:115], v16 offset:832
    ds_read_b64_tr_b16 a[116:117], v16 offset:12832
    ds_read_b64_tr_b16 a[118:119], v16 offset:13632
    ds_read_b64_tr_b16 a[192:193], v16 offset:64
    ds_read_b64_tr_b16 a[194:195], v16 offset:864
    ds_read_b64_tr_b16 a[196:197], v16 offset:12864
    ds_read_b64_tr_b16 a[198:199], v16 offset:13664
    s_waitcnt lgkmcnt(0)
    s_barrier
    s_waitcnt vmcnt(6)
    ds_write_b128 v10, v[24:27]
    ds_write_b128 v11, v[28:31]
    ds_write_b128 v12, v[32:35]
    ds_write_b128 v13, v[36:39]
    ds_write_b128 v14, v[40:43]
    ds_write_b128 v15, v[44:47]
    s_add_u32 s46, s45, 3932160
    buffer_load_dwordx4 v[72:75], v4, s[16:19], s46 offen
    buffer_load_dwordx4 v[76:79], v5, s[16:19], s46 offen
    buffer_load_dwordx4 v[80:83], v6, s[16:19], s46 offen
    buffer_load_dwordx4 v[84:87], v7, s[16:19], s46 offen
    buffer_load_dwordx4 v[88:91], v8, s[16:19], s46 offen
    buffer_load_dwordx4 v[92:95], v9, s[16:19], s46 offen
    s_waitcnt lgkmcnt(0)
    s_barrier
    ds_read_b64_tr_b16 v[128:129], v16 offset:0
    ds_read_b64_tr_b16 v[130:131], v16 offset:800
    ds_read_b64_tr_b16 v[132:133], v16 offset:12800
    ds_read_b64_tr_b16 v[134:135], v16 offset:13600
    ds_read_b64_tr_b16 v[208:209], v16 offset:32
    ds_read_b64_tr_b16 v[210:211], v16 offset:832
    ds_read_b64_tr_b16 v[212:213], v16 offset:12832
    ds_read_b64_tr_b16 v[214:215], v16 offset:13632
    ds_read_b64_tr_b16 v[24:25], v16 offset:64
    ds_read_b64_tr_b16 v[26:27], v16 offset:864
    ds_read_b64_tr_b16 v[28:29], v16 offset:12864
    ds_read_b64_tr_b16 v[30:31], v16 offset:13664
    s_waitcnt lgkmcnt(0)
    ds_write_b128 v17, v[24:27] offset:8192
    ds_write_b128 v17, v[28:31] offset:9216
    s_waitcnt lgkmcnt(0)
    s_barrier
    s_waitcnt vmcnt(6)
    ds_write_b128 v10, v[48:51]
    ds_write_b128 v11, v[52:55]
    ds_write_b128 v12, v[56:59]
    ds_write_b128 v13, v[60:63]
    ds_write_b128 v14, v[64:67]
    ds_write_b128 v15, v[68:71]
    s_add_u32 s46, s45, 4718592
    buffer_load_dwordx4 v[24:27], v4, s[12:15], s46 offen
    buffer_load_dwordx4 v[28:31], v5, s[12:15], s46 offen
    buffer_load_dwordx4 v[32:35], v6, s[12:15], s46 offen
    buffer_load_dwordx4 v[36:39], v7, s[12:15], s46 offen
    buffer_load_dwordx4 v[40:43], v8, s[12:15], s46 offen
    buffer_load_dwordx4 v[44:47], v9, s[12:15], s46 offen
    s_waitcnt lgkmcnt(0)
    s_barrier
    ds_read_b64_tr_b16 a[40:41], v16 offset:0
    ds_read_b64_tr_b16 a[42:43], v16 offset:800
    ds_read_b64_tr_b16 a[44:45], v16 offset:12800
    ds_read_b64_tr_b16 a[46:47], v16 offset:13600
    ds_read_b64_tr_b16 a[120:121], v16 offset:32
    ds_read_b64_tr_b16 a[122:123], v16 offset:832
    ds_read_b64_tr_b16 a[124:125], v16 offset:12832
    ds_read_b64_tr_b16 a[126:127], v16 offset:13632
    ds_read_b64_tr_b16 a[200:201], v16 offset:64
    ds_read_b64_tr_b16 a[202:203], v16 offset:864
    ds_read_b64_tr_b16 a[204:205], v16 offset:12864
    ds_read_b64_tr_b16 a[206:207], v16 offset:13664
    s_waitcnt lgkmcnt(0)
    s_barrier
    s_waitcnt vmcnt(6)
    ds_write_b128 v10, v[72:75]
    ds_write_b128 v11, v[76:79]
    ds_write_b128 v12, v[80:83]
    ds_write_b128 v13, v[84:87]
    ds_write_b128 v14, v[88:91]
    ds_write_b128 v15, v[92:95]
    s_add_u32 s46, s45, 4718592
    buffer_load_dwordx4 v[48:51], v4, s[16:19], s46 offen
    buffer_load_dwordx4 v[52:55], v5, s[16:19], s46 offen
    buffer_load_dwordx4 v[56:59], v6, s[16:19], s46 offen
    buffer_load_dwordx4 v[60:63], v7, s[16:19], s46 offen
    buffer_load_dwordx4 v[64:67], v8, s[16:19], s46 offen
    buffer_load_dwordx4 v[68:71], v9, s[16:19], s46 offen
    s_waitcnt lgkmcnt(0)
    s_barrier
    ds_read_b64_tr_b16 v[136:137], v16 offset:0
    ds_read_b64_tr_b16 v[138:139], v16 offset:800
    ds_read_b64_tr_b16 v[140:141], v16 offset:12800
    ds_read_b64_tr_b16 v[142:143], v16 offset:13600
    ds_read_b64_tr_b16 v[216:217], v16 offset:32
    ds_read_b64_tr_b16 v[218:219], v16 offset:832
    ds_read_b64_tr_b16 v[220:221], v16 offset:12832
    ds_read_b64_tr_b16 v[222:223], v16 offset:13632
    ds_read_b64_tr_b16 v[72:73], v16 offset:64
    ds_read_b64_tr_b16 v[74:75], v16 offset:864
    ds_read_b64_tr_b16 v[76:77], v16 offset:12864
    ds_read_b64_tr_b16 v[78:79], v16 offset:13664
    s_waitcnt lgkmcnt(0)
    ds_write_b128 v17, v[72:75] offset:10240
    ds_write_b128 v17, v[76:79] offset:11264
    s_waitcnt lgkmcnt(0)
    s_barrier
    s_waitcnt vmcnt(6)
    ds_write_b128 v10, v[24:27]
    ds_write_b128 v11, v[28:31]
    ds_write_b128 v12, v[32:35]
    ds_write_b128 v13, v[36:39]
    ds_write_b128 v14, v[40:43]
    ds_write_b128 v15, v[44:47]
    s_add_u32 s46, s45, 5505024
    buffer_load_dwordx4 v[72:75], v4, s[12:15], s46 offen
    buffer_load_dwordx4 v[76:79], v5, s[12:15], s46 offen
    buffer_load_dwordx4 v[80:83], v6, s[12:15], s46 offen
    buffer_load_dwordx4 v[84:87], v7, s[12:15], s46 offen
    buffer_load_dwordx4 v[88:91], v8, s[12:15], s46 offen
    buffer_load_dwordx4 v[92:95], v9, s[12:15], s46 offen
    s_waitcnt lgkmcnt(0)
    s_barrier
    ds_read_b64_tr_b16 a[48:49], v16 offset:0
    ds_read_b64_tr_b16 a[50:51], v16 offset:800
    ds_read_b64_tr_b16 a[52:53], v16 offset:12800
    ds_read_b64_tr_b16 a[54:55], v16 offset:13600
    ds_read_b64_tr_b16 a[128:129], v16 offset:32
    ds_read_b64_tr_b16 a[130:131], v16 offset:832
    ds_read_b64_tr_b16 a[132:133], v16 offset:12832
    ds_read_b64_tr_b16 a[134:135], v16 offset:13632
    ds_read_b64_tr_b16 a[208:209], v16 offset:64
    ds_read_b64_tr_b16 a[210:211], v16 offset:864
    ds_read_b64_tr_b16 a[212:213], v16 offset:12864
    ds_read_b64_tr_b16 a[214:215], v16 offset:13664
    s_waitcnt lgkmcnt(0)
    s_barrier
    s_waitcnt vmcnt(6)
    ds_write_b128 v10, v[48:51]
    ds_write_b128 v11, v[52:55]
    ds_write_b128 v12, v[56:59]
    ds_write_b128 v13, v[60:63]
    ds_write_b128 v14, v[64:67]
    ds_write_b128 v15, v[68:71]
    s_add_u32 s46, s45, 5505024
    buffer_load_dwordx4 v[24:27], v4, s[16:19], s46 offen
    buffer_load_dwordx4 v[28:31], v5, s[16:19], s46 offen
    buffer_load_dwordx4 v[32:35], v6, s[16:19], s46 offen
    buffer_load_dwordx4 v[36:39], v7, s[16:19], s46 offen
    buffer_load_dwordx4 v[40:43], v8, s[16:19], s46 offen
    buffer_load_dwordx4 v[44:47], v9, s[16:19], s46 offen
    s_waitcnt lgkmcnt(0)
    s_barrier
    ds_read_b64_tr_b16 v[144:145], v16 offset:0
    ds_read_b64_tr_b16 v[146:147], v16 offset:800
    ds_read_b64_tr_b16 v[148:149], v16 offset:12800
    ds_read_b64_tr_b16 v[150:151], v16 offset:13600
    ds_read_b64_tr_b16 v[224:225], v16 offset:32
    ds_read_b64_tr_b16 v[226:227], v16 offset:832
    ds_read_b64_tr_b16 v[228:229], v16 offset:12832
    ds_read_b64_tr_b16 v[230:231], v16 offset:13632
    ds_read_b64_tr_b16 v[48:49], v16 offset:64
    ds_read_b64_tr_b16 v[50:51], v16 offset:864
    ds_read_b64_tr_b16 v[52:53], v16 offset:12864
    ds_read_b64_tr_b16 v[54:55], v16 offset:13664
    s_waitcnt lgkmcnt(0)
    ds_write_b128 v17, v[48:51] offset:12288
    ds_write_b128 v17, v[52:55] offset:13312
    s_waitcnt lgkmcnt(0)
    s_barrier
    s_waitcnt vmcnt(6)
    ds_write_b128 v10, v[72:75]
    ds_write_b128 v11, v[76:79]
    ds_write_b128 v12, v[80:83]
    ds_write_b128 v13, v[84:87]
    ds_write_b128 v14, v[88:91]
    ds_write_b128 v15, v[92:95]
    s_add_u32 s46, s45, 6291456
    buffer_load_dwordx4 v[48:51], v4, s[12:15], s46 offen
    buffer_load_dwordx4 v[52:55], v5, s[12:15], s46 offen
    buffer_load_dwordx4 v[56:59], v6, s[12:15], s46 offen
    buffer_load_dwordx4 v[60:63], v7, s[12:15], s46 offen
    buffer_load_dwordx4 v[64:67], v8, s[12:15], s46 offen
    buffer_load_dwordx4 v[68:71], v9, s[12:15], s46 offen
    s_waitcnt lgkmcnt(0)
    s_barrier
    ds_read_b64_tr_b16 a[56:57], v16 offset:0
    ds_read_b64_tr_b16 a[58:59], v16 offset:800
    ds_read_b64_tr_b16 a[60:61], v16 offset:12800
    ds_read_b64_tr_b16 a[62:63], v16 offset:13600
    ds_read_b64_tr_b16 a[136:137], v16 offset:32
    ds_read_b64_tr_b16 a[138:139], v16 offset:832
    ds_read_b64_tr_b16 a[140:141], v16 offset:12832
    ds_read_b64_tr_b16 a[142:143], v16 offset:13632
    ds_read_b64_tr_b16 a[216:217], v16 offset:64
    ds_read_b64_tr_b16 a[218:219], v16 offset:864
    ds_read_b64_tr_b16 a[220:221], v16 offset:12864
    ds_read_b64_tr_b16 a[222:223], v16 offset:13664
    s_waitcnt lgkmcnt(0)
    s_barrier
    s_waitcnt vmcnt(6)
    ds_write_b128 v10, v[24:27]
    ds_write_b128 v11, v[28:31]
    ds_write_b128 v12, v[32:35]
    ds_write_b128 v13, v[36:39]
    ds_write_b128 v14, v[40:43]
    ds_write_b128 v15, v[44:47]
    s_add_u32 s46, s45, 6291456
    buffer_load_dwordx4 v[72:75], v4, s[16:19], s46 offen
    buffer_load_dwordx4 v[76:79], v5, s[16:19], s46 offen
    buffer_load_dwordx4 v[80:83], v6, s[16:19], s46 offen
    buffer_load_dwordx4 v[84:87], v7, s[16:19], s46 offen
    buffer_load_dwordx4 v[88:91], v8, s[16:19], s46 offen
    buffer_load_dwordx4 v[92:95], v9, s[16:19], s46 offen
    s_waitcnt lgkmcnt(0)
    s_barrier
    ds_read_b64_tr_b16 v[152:153], v16 offset:0
    ds_read_b64_tr_b16 v[154:155], v16 offset:800
    ds_read_b64_tr_b16 v[156:157], v16 offset:12800
    ds_read_b64_tr_b16 v[158:159], v16 offset:13600
    ds_read_b64_tr_b16 v[232:233], v16 offset:32
    ds_read_b64_tr_b16 v[234:235], v16 offset:832
    ds_read_b64_tr_b16 v[236:237], v16 offset:12832
    ds_read_b64_tr_b16 v[238:239], v16 offset:13632
    ds_read_b64_tr_b16 v[24:25], v16 offset:64
    ds_read_b64_tr_b16 v[26:27], v16 offset:864
    ds_read_b64_tr_b16 v[28:29], v16 offset:12864
    ds_read_b64_tr_b16 v[30:31], v16 offset:13664
    s_waitcnt lgkmcnt(0)
    ds_write_b128 v17, v[24:27] offset:14336
    ds_write_b128 v17, v[28:31] offset:15360
    s_waitcnt lgkmcnt(0)
    s_barrier
    s_waitcnt vmcnt(6)
    ds_write_b128 v10, v[48:51]
    ds_write_b128 v11, v[52:55]
    ds_write_b128 v12, v[56:59]
    ds_write_b128 v13, v[60:63]
    ds_write_b128 v14, v[64:67]
    ds_write_b128 v15, v[68:71]
    s_add_u32 s46, s45, 7077888
    buffer_load_dwordx4 v[24:27], v4, s[12:15], s46 offen
    buffer_load_dwordx4 v[28:31], v5, s[12:15], s46 offen
    buffer_load_dwordx4 v[32:35], v6, s[12:15], s46 offen
    buffer_load_dwordx4 v[36:39], v7, s[12:15], s46 offen
    buffer_load_dwordx4 v[40:43], v8, s[12:15], s46 offen
    buffer_load_dwordx4 v[44:47], v9, s[12:15], s46 offen
    s_waitcnt lgkmcnt(0)
    s_barrier
    ds_read_b64_tr_b16 a[64:65], v16 offset:0
    ds_read_b64_tr_b16 a[66:67], v16 offset:800
    ds_read_b64_tr_b16 a[68:69], v16 offset:12800
    ds_read_b64_tr_b16 a[70:71], v16 offset:13600
    ds_read_b64_tr_b16 a[144:145], v16 offset:32
    ds_read_b64_tr_b16 a[146:147], v16 offset:832
    ds_read_b64_tr_b16 a[148:149], v16 offset:12832
    ds_read_b64_tr_b16 a[150:151], v16 offset:13632
    ds_read_b64_tr_b16 a[224:225], v16 offset:64
    ds_read_b64_tr_b16 a[226:227], v16 offset:864
    ds_read_b64_tr_b16 a[228:229], v16 offset:12864
    ds_read_b64_tr_b16 a[230:231], v16 offset:13664
    s_waitcnt lgkmcnt(0)
    s_barrier
    s_waitcnt vmcnt(6)
    ds_write_b128 v10, v[72:75]
    ds_write_b128 v11, v[76:79]
    ds_write_b128 v12, v[80:83]
    ds_write_b128 v13, v[84:87]
    ds_write_b128 v14, v[88:91]
    ds_write_b128 v15, v[92:95]
    s_add_u32 s46, s45, 7077888
    buffer_load_dwordx4 v[48:51], v4, s[16:19], s46 offen
    buffer_load_dwordx4 v[52:55], v5, s[16:19], s46 offen
    buffer_load_dwordx4 v[56:59], v6, s[16:19], s46 offen
    buffer_load_dwordx4 v[60:63], v7, s[16:19], s46 offen
    buffer_load_dwordx4 v[64:67], v8, s[16:19], s46 offen
    buffer_load_dwordx4 v[68:71], v9, s[16:19], s46 offen
    s_waitcnt lgkmcnt(0)
    s_barrier
    ds_read_b64_tr_b16 v[160:161], v16 offset:0
    ds_read_b64_tr_b16 v[162:163], v16 offset:800
    ds_read_b64_tr_b16 v[164:165], v16 offset:12800
    ds_read_b64_tr_b16 v[166:167], v16 offset:13600
    ds_read_b64_tr_b16 v[240:241], v16 offset:32
    ds_read_b64_tr_b16 v[242:243], v16 offset:832
    ds_read_b64_tr_b16 v[244:245], v16 offset:12832
    ds_read_b64_tr_b16 v[246:247], v16 offset:13632
    ds_read_b64_tr_b16 v[72:73], v16 offset:64
    ds_read_b64_tr_b16 v[74:75], v16 offset:864
    ds_read_b64_tr_b16 v[76:77], v16 offset:12864
    ds_read_b64_tr_b16 v[78:79], v16 offset:13664
    s_waitcnt lgkmcnt(0)
    ds_write_b128 v17, v[72:75] offset:16384
    ds_write_b128 v17, v[76:79] offset:17408
    s_waitcnt lgkmcnt(0)
    s_barrier
    s_waitcnt vmcnt(6)
    ds_write_b128 v10, v[24:27]
    ds_write_b128 v11, v[28:31]
    ds_write_b128 v12, v[32:35]
    ds_write_b128 v13, v[36:39]
    ds_write_b128 v14, v[40:43]
    ds_write_b128 v15, v[44:47]
    s_waitcnt lgkmcnt(0)
    s_barrier
    ds_read_b64_tr_b16 a[72:73], v16 offset:0
    ds_read_b64_tr_b16 a[74:75], v16 offset:800
    ds_read_b64_tr_b16 a[76:77], v16 offset:12800
    ds_read_b64_tr_b16 a[78:79], v16 offset:13600
    ds_read_b64_tr_b16 a[152:153], v16 offset:32
    ds_read_b64_tr_b16 a[154:155], v16 offset:832
    ds_read_b64_tr_b16 a[156:157], v16 offset:12832
    ds_read_b64_tr_b16 a[158:159], v16 offset:13632
    ds_read_b64_tr_b16 a[232:233], v16 offset:64
    ds_read_b64_tr_b16 a[234:235], v16 offset:864
    ds_read_b64_tr_b16 a[236:237], v16 offset:12864
    ds_read_b64_tr_b16 a[238:239], v16 offset:13664
    s_waitcnt lgkmcnt(0)
    s_barrier
    s_waitcnt vmcnt(0)
    ds_write_b128 v10, v[48:51]
    ds_write_b128 v11, v[52:55]
    ds_write_b128 v12, v[56:59]
    ds_write_b128 v13, v[60:63]
    ds_write_b128 v14, v[64:67]
    ds_write_b128 v15, v[68:71]
    s_waitcnt lgkmcnt(0)
    s_barrier
    ds_read_b64_tr_b16 v[168:169], v16 offset:0
    ds_read_b64_tr_b16 v[170:171], v16 offset:800
    ds_read_b64_tr_b16 v[172:173], v16 offset:12800
    ds_read_b64_tr_b16 v[174:175], v16 offset:13600
    ds_read_b64_tr_b16 v[248:249], v16 offset:32
    ds_read_b64_tr_b16 v[250:251], v16 offset:832
    ds_read_b64_tr_b16 v[252:253], v16 offset:12832
    ds_read_b64_tr_b16 v[254:255], v16 offset:13632
    ds_read_b64_tr_b16 v[48:49], v16 offset:64
    ds_read_b64_tr_b16 v[50:51], v16 offset:864
    ds_read_b64_tr_b16 v[52:53], v16 offset:12864
    ds_read_b64_tr_b16 v[54:55], v16 offset:13664
    s_waitcnt lgkmcnt(0)
    ds_write_b128 v17, v[48:51] offset:18432
    ds_write_b128 v17, v[52:55] offset:19456
    s_waitcnt lgkmcnt(0)
    s_barrier
    v_mov_b32 v6, v17
    v_mov_b32 v30, 0xeeee
    v_mov_b32 v4, 0x4444
    v_cmp_gt_u32 vcc, 8, v2
    s_nop 1
    v_cndmask_b32 v4, v30, v4, vcc
    v_lshlrev_b32 v5, 4, v1
    s_lshl_b32 s24, s3, 10
    v_add_u32 v7, s24, v5
    s_lshl_b32 s24, s3, 9
    s_add_u32 s24, s24, 8192
    v_lshlrev_b32 v8, 3, v1
    v_add_u32 v8, s24, v8
    s_mul_i32 s24, s3, 1536
    s_add_u32 s24, s24, 10240
    v_lshlrev_b32 v9, 5, v2
    v_lshl_add_u32 v9, v3, 3, v9
    v_add_u32 v9, s24, v9
    v_lshrrev_b32 v30, 2, v2
    v_and_b32 v31, 3, v2
    v_lshl_add_u32 v11, v3, 2, v30
    v_lshlrev_b32 v11, 5, v11
    v_lshl_add_u32 v11, v31, 3, v11
    v_add_u32 v11, s24, v11
    v_add_u32 v33, 22528, v5
    s_mul_i32 s24, s3, 1408
    s_add_u32 s24, s24, 16384
    v_mul_u32_u24 v30, 176, v2
    v_add_u32 v30, s24, v30
    v_lshl_add_u32 v12, v3, 5, v30
    v_cmp_gt_u32 vcc, 8, v2
    s_nop 1
    v_cndmask_b32 v12, v33, v12, vcc
    v_lshl_add_u32 v13, v3, 4, v30
    v_add_u32 v13, 96, v13
    v_cmp_le_u32 s[24:25], 2, v3
    s_and_b64 vcc, vcc, s[24:25]
    v_cndmask_b32 v13, v33, v13, vcc
    s_mul_i32 s24, s3, 5632
    s_add_u32 s24, s24, 106496
    v_mul_u32_u24 v30, 176, v2
    v_add_u32 v30, s24, v30
    v_lshl_add_u32 v16, v3, 5, v30
    v_lshl_add_u32 v17, v3, 4, v30
    v_add_u32 v17, 96, v17
    v_add_u32 v18, 2816, v17
    v_cmp_le_u32 vcc, 2, v3
    s_nop 1
    v_cndmask_b32 v17, v33, v17, vcc
    v_cndmask_b32 v18, v33, v18, vcc
    v_lshrrev_b32 v30, 3, v1
    v_and_b32 v31, 7, v1
    v_min_u32 v32, 4, v31
    v_mul_u32_u24 v14, 176, v30
    v_lshl_add_u32 v14, v32, 5, v14
    s_mul_i32 s24, s3, 1408
    s_add_u32 s24, s24, 106496
    v_add_u32 v21, s24, v14
    v_add_u32 v14, 16384, v14
    v_cmp_gt_u32 s[50:51], 5, v31
    s_lshl_b32 s24, s3, 3
    v_add_u32 v32, s24, v30
    v_lshlrev_b32 v33, 2, v31
    v_sub_u32 v32, v32, v33
    v_mov_b32 v33, 100
    v_cmp_gt_u32 vcc, 4, v31
    s_nop 1
    v_cndmask_b32 v32, v33, v32, vcc
    v_cmp_le_i32 s[64:65], 0, v32
    v_cmp_le_i32 s[66:67], 1, v32
    v_cmp_le_i32 s[68:69], 2, v32
    v_cmp_le_i32 s[70:71], 3, v32
    v_cmp_le_i32 s[72:73], 16, v32
    v_cmp_le_i32 s[74:75], 17, v32
    v_cmp_le_i32 s[76:77], 18, v32
    v_cmp_le_i32 s[78:79], 19, v32
    s_lshr_b32 s24, s44, 1
    s_lshl_b32 s24, s24, 10
    s_and_b32 s25, s44, 1
    s_lshl_b32 s25, s25, 7
    s_add_u32 s24, s24, s25
    v_lshlrev_b32 v15, 8, v31
    v_lshl_add_u32 v15, v30, 4, v15
    v_add_u32 v15, s24, v15
    s_lshr_b32 s24, s44, 3
    s_lshl_b32 s24, s24, 10
    s_and_b32 s25, s44, 3
    s_lshl_b32 s25, s25, 8
    s_add_u32 s24, s24, s25
    s_lshr_b32 s25, s44, 2
    s_and_b32 s25, s25, 1
    s_lshl_b32 s25, s25, 7
    s_add_u32 s24, s24, s25
    s_add_u32 s24, s24, 16384
    v_lshlrev_b32 v32, 4, v30
    v_add_u32 v32, s24, v32
    v_cmp_eq_u32 vcc, 4, v31
    s_nop 1
    v_cndmask_b32 v15, v15, v32, vcc
    v_mov_b32 v32, 2146435072
    v_cndmask_b32 v15, v32, v15, s[50:51]
    s_cmp_lt_u32 s3, 1
    s_cselect_b32 s24, 0, 2146435072
    v_or_b32 v15, s24, v15
    s_and_b32 s24, s3, 1
    s_lshl_b32 s24, s24, 7
    s_lshr_b32 s25, s3, 1
    s_lshl_b32 s25, s25, 10
    s_add_u32 s24, s24, s25
    s_lshl_b32 s25, s44, 11
    s_add_u32 s25, s25, s24
    v_lshlrev_b32 v22, 8, v31
    v_lshl_add_u32 v22, v30, 4, v22
    v_add_u32 v22, s25, v22
    s_lshr_b32 s25, s44, 2
    s_lshl_b32 s25, s25, 11
    s_add_u32 s25, s25, s24
    s_and_b32 s26, s44, 3
    s_lshl_b32 s26, s26, 8
    s_add_u32 s25, s25, s26
    s_add_u32 s25, s25, 65536
    v_lshlrev_b32 v32, 4, v30
    v_add_u32 v32, s25, v32
    v_cmp_eq_u32 vcc, 4, v31
    s_nop 1
    v_cndmask_b32 v22, v22, v32, vcc
    v_mov_b32 v32, 2146435072
    v_cndmask_b32 v22, v32, v22, s[50:51]
    s_mul_i32 s24, s44, 12288
    s_mul_i32 s25, s3, 3072
    s_add_u32 s24, s24, s25
    v_add_u32 v19, s24, v5
    s_and_b32 s24, s2, 15
    s_mul_i32 s25, s3, 16
    s_add_u32 s24, s24, s25
    s_lshl_b32 s24, s24, 7
    v_mov_b32 v23, s24
    s_lshr_b32 s25, s44, 3
    s_mul_i32 s24, s25, 8
    v_add_u32 v20, s24, v1
    v_lshlrev_b32 v20, 7, v20
    v_mov_b32 v30, 2146435072
    v_cmp_le_u32 vcc, 8, v1
    s_nop 1
    v_cndmask_b32 v20, v20, v30, vcc
    s_cmp_eq_u32 s3, 0
    s_cselect_b32 s24, 0, 2146435072
    v_or_b32 v20, s24, v20
    v_mov_b32 v0, 1
interleave_layers__linear_attn_block__memory_aug_recurrent_mem_tr__prompt_kernel_s_layer:
    s_mul_i32 s93, s92, 29360128
    s_add_u32 s93, s93, 117440512
    s_mul_i32 s94, s92, 16384
    s_add_u32 s94, s94, 23068672
    v_and_b32 v10, 1, v1
    v_lshlrev_b32 v10, 12, v10
    s_lshl_b32 s24, s44, 7
    s_add_u32 s24, s24, s94
    v_add_u32 v10, s24, v10
    s_lshl_b32 s24, s3, 6
    s_add_u32 s24, s24, 0
    v_add_u32 v48, s24, v1
    v_and_b32 v49, 7, v48
    v_mul_u32_u24 v49, 1280, v49
    v_lshrrev_b32 v50, 3, v48
    v_lshl_add_u32 v49, v50, 4, v49
    v_cmp_gt_u32 vcc, 640, v48
    v_mov_b32 v51, 2146435072
    s_nop 0
    v_cndmask_b32 v49, v51, v49, vcc
    buffer_load_dwordx4 v[52:55], v49, s[20:23], 0 offen
    v_lshlrev_b32 v48, 4, v48
    s_waitcnt vmcnt(0)
    s_and_saveexec_b64 s[30:31], vcc
    ds_write_b128 v48, v[52:55]
    s_mov_b64 exec, s[30:31]
    s_lshl_b32 s24, s3, 6
    s_add_u32 s24, s24, 256
    v_add_u32 v48, s24, v1
    v_and_b32 v49, 7, v48
    v_mul_u32_u24 v49, 1280, v49
    v_lshrrev_b32 v50, 3, v48
    v_lshl_add_u32 v49, v50, 4, v49
    v_cmp_gt_u32 vcc, 640, v48
    v_mov_b32 v51, 2146435072
    s_nop 0
    v_cndmask_b32 v49, v51, v49, vcc
    buffer_load_dwordx4 v[52:55], v49, s[20:23], 0 offen
    v_lshlrev_b32 v48, 4, v48
    s_waitcnt vmcnt(0)
    s_and_saveexec_b64 s[30:31], vcc
    ds_write_b128 v48, v[52:55]
    s_mov_b64 exec, s[30:31]
    s_lshl_b32 s24, s3, 6
    s_add_u32 s24, s24, 512
    v_add_u32 v48, s24, v1
    v_and_b32 v49, 7, v48
    v_mul_u32_u24 v49, 1280, v49
    v_lshrrev_b32 v50, 3, v48
    v_lshl_add_u32 v49, v50, 4, v49
    v_cmp_gt_u32 vcc, 640, v48
    v_mov_b32 v51, 2146435072
    s_nop 0
    v_cndmask_b32 v49, v51, v49, vcc
    buffer_load_dwordx4 v[52:55], v49, s[20:23], 0 offen
    v_lshlrev_b32 v48, 4, v48
    s_waitcnt vmcnt(0)
    s_and_saveexec_b64 s[30:31], vcc
    ds_write_b128 v48, v[52:55]
    s_mov_b64 exec, s[30:31]
    s_mov_b32 s40, 0
    s_mov_b32 s41, 92274688
    s_add_u32 s42, s93, 327680
    s_add_u32 s43, s93, 409600
    s_mov_b32 s45, 67108864
    s_add_u32 s47, s93, -28672
    s_add_u32 s48, s93, -18432
    s_add_u32 s49, s93, 448512
    s_lshl_b32 s95, s92, 6
    s_add_u32 s95, s95, s40
    s_add_u32 s95, s95, 1
    s_cmp_ge_i32 s59, s95
    s_cbranch_scc1 interleave_layers__linear_attn_block__memory_aug_recurrent_mem_tr__prompt_kernel_s_ec0_ok
    s_and_b32 s24, s2, 7
    s_lshl_b32 s24, s24, 7
    s_add_u32 s24, s24, 23109632
    v_and_b32 v49, 3, v1
    v_lshl_add_u32 v49, v49, 2, s24
    s_mov_b32 s61, 0
interleave_layers__linear_attn_block__memory_aug_recurrent_mem_tr__prompt_kernel_s_ec0:
    buffer_load_dword v48, v49, s[8:11], 0 offen sc1
    s_waitcnt vmcnt(0)
    v_readlane_b32 s59, v48, 0
    v_readlane_b32 s24, v48, 1
    s_min_i32 s59, s59, s24
    v_readlane_b32 s24, v48, 2
    s_min_i32 s59, s59, s24
    v_readlane_b32 s24, v48, 3
    s_min_i32 s59, s59, s24
    s_cmp_ge_i32 s59, s95
    s_cbranch_scc1 interleave_layers__linear_attn_block__memory_aug_recurrent_mem_tr__prompt_kernel_s_ec0_ok
    s_add_u32 s61, s61, 1
    s_cmp_ge_u32 s61, s60
    s_cbranch_scc1 interleave_layers__linear_attn_block__memory_aug_recurrent_mem_tr__prompt_kernel_s_ec0_to
    s_sleep 2
    s_branch interleave_layers__linear_attn_block__memory_aug_recurrent_mem_tr__prompt_kernel_s_ec0
interleave_layers__linear_attn_block__memory_aug_recurrent_mem_tr__prompt_kernel_s_ec0_to:
    s_mov_b32 s60, 1
interleave_layers__linear_attn_block__memory_aug_recurrent_mem_tr__prompt_kernel_s_ec0_ok:
    s_mov_b32 s62, -1
    s_mov_b32 s63, 1
    s_cmp_ge_i32 s62, s63
    s_cbranch_scc1 interleave_layers__linear_attn_block__memory_aug_recurrent_mem_tr__prompt_kernel_s_en0_ok
    s_mov_b32 s61, 0
interleave_layers__linear_attn_block__memory_aug_recurrent_mem_tr__prompt_kernel_s_en0:
    buffer_load_dword v48, v10, s[8:11], 0 offen sc1
    s_waitcnt vmcnt(0)
    v_readlane_b32 s62, v48, 0
    v_readlane_b32 s24, v48, 1
    s_min_i32 s62, s62, s24
    s_cmp_ge_i32 s62, s63
    s_cbranch_scc1 interleave_layers__linear_attn_block__memory_aug_recurrent_mem_tr__prompt_kernel_s_en0_ok
    s_add_u32 s61, s61, 1
    s_cmp_ge_u32 s61, s60
    s_cbranch_scc1 interleave_layers__linear_attn_block__memory_aug_recurrent_mem_tr__prompt_kernel_s_en0_to
    s_sleep 2
    s_branch interleave_layers__linear_attn_block__memory_aug_recurrent_mem_tr__prompt_kernel_s_en0
interleave_layers__linear_attn_block__memory_aug_recurrent_mem_tr__prompt_kernel_s_en0_to:
    s_mov_b32 s60, 1
interleave_layers__linear_attn_block__memory_aug_recurrent_mem_tr__prompt_kernel_s_en0_ok:
    buffer_load_dwordx4 a[240:243], v19, s[8:11], s41 offen offset:0 sc1
    buffer_load_dwordx4 a[244:247], v19, s[8:11], s41 offen offset:1024 sc1
    buffer_load_dwordx4 a[248:251], v19, s[8:11], s41 offen offset:2048 sc1
    s_waitcnt lgkmcnt(0)
    s_branch interleave_layers__linear_attn_block__memory_aug_recurrent_mem_tr__prompt_kernel_s_go
interleave_layers__linear_attn_block__memory_aug_recurrent_mem_tr__prompt_kernel_s_step:
    v_mov_b32 v24, 0
    v_mov_b32 v25, 0
    v_mov_b32 v26, 0
    v_mov_b32 v27, 0
    v_mov_b32 v28, 0
    v_mov_b32 v29, 0
    v_mov_b32 v30, 0
    v_mov_b32 v31, 0
    v_mov_b32 v32, 0
    v_mov_b32 v33, 0
    v_mov_b32 v34, 0
    v_mov_b32 v35, 0
    v_mov_b32 v36, 0
    v_mov_b32 v37, 0
    v_mov_b32 v38, 0
    v_mov_b32 v39, 0
    v_mov_b32 v40, 0
    v_mov_b32 v41, 0
    v_mov_b32 v42, 0
    v_mov_b32 v43, 0
    v_mov_b32 v44, 0
    v_mov_b32 v45, 0
    v_mov_b32 v46, 0
    v_mov_b32 v47, 0
    s_add_u32 s46, s47, 4096
    s_lshl_b32 s95, s92, 6
    s_add_u32 s95, s95, s40
    s_add_u32 s95, s95, 1
    s_cmp_ge_i32 s59, s95
    s_cbranch_scc1 interleave_layers__linear_attn_block__memory_aug_recurrent_mem_tr__prompt_kernel_s_ec_ok
    s_and_b32 s24, s2, 7
    s_lshl_b32 s24, s24, 7
    s_add_u32 s24, s24, 23109632
    v_and_b32 v49, 3, v1
    v_lshl_add_u32 v49, v49, 2, s24
    s_mov_b32 s61, 0
interleave_layers__linear_attn_block__memory_aug_recurrent_mem_tr__prompt_kernel_s_ec:
    buffer_load_dword v48, v49, s[8:11], 0 offen sc1
    s_waitcnt vmcnt(0)
    v_readlane_b32 s59, v48, 0
    v_readlane_b32 s24, v48, 1
    s_min_i32 s59, s59, s24
    v_readlane_b32 s24, v48, 2
    s_min_i32 s59, s59, s24
    v_readlane_b32 s24, v48, 3
    s_min_i32 s59, s59, s24
    s_cmp_ge_i32 s59, s95
    s_cbranch_scc1 interleave_layers__linear_attn_block__memory_aug_recurrent_mem_tr__prompt_kernel_s_ec_ok
    s_add_u32 s61, s61, 1
    s_cmp_ge_u32 s61, s60
    s_cbranch_scc1 interleave_layers__linear_attn_block__memory_aug_recurrent_mem_tr__prompt_kernel_s_ec_to
    s_sleep 2
    s_branch interleave_layers__linear_attn_block__memory_aug_recurrent_mem_tr__prompt_kernel_s_ec
interleave_layers__linear_attn_block__memory_aug_recurrent_mem_tr__prompt_kernel_s_ec_to:
    s_mov_b32 s60, 1
interleave_layers__linear_attn_block__memory_aug_recurrent_mem_tr__prompt_kernel_s_ec_ok:
    s_add_u32 s63, s40, 1
    s_cmp_ge_i32 s62, s63
    s_cbranch_scc1 interleave_layers__linear_attn_block__memory_aug_recurrent_mem_tr__prompt_kernel_s_en_ok
    s_mov_b32 s61, 0
interleave_layers__linear_attn_block__memory_aug_recurrent_mem_tr__prompt_kernel_s_en:
    buffer_load_dword v48, v10, s[8:11], 0 offen sc1
    s_waitcnt vmcnt(0)
    v_readlane_b32 s62, v48, 0
    v_readlane_b32 s24, v48, 1
    s_min_i32 s62, s62, s24
    s_cmp_ge_i32 s62, s63
    s_cbranch_scc1 interleave_layers__linear_attn_block__memory_aug_recurrent_mem_tr__prompt_kernel_s_en_ok
    s_add_u32 s61, s61, 1
    s_cmp_ge_u32 s61, s60
    s_cbranch_scc1 interleave_layers__linear_attn_block__memory_aug_recurrent_mem_tr__prompt_kernel_s_en_to
    s_sleep 2
    s_branch interleave_layers__linear_attn_block__memory_aug_recurrent_mem_tr__prompt_kernel_s_en
interleave_layers__linear_attn_block__memory_aug_recurrent_mem_tr__prompt_kernel_s_en_to:
    s_mov_b32 s60, 1
interleave_layers__linear_attn_block__memory_aug_recurrent_mem_tr__prompt_kernel_s_en_ok:
    s_sleep 5
    s_mov_b64 exec, 1
    s_mov_b32 s61, 0
    v_mov_b32 v83, 0
    buffer_atomic_add v83, v23, s[8:11], s48 offen sc0
    s_sleep 2
    v_mov_b32 v94, 0
    buffer_atomic_add v94, v23, s[8:11], s48 offen sc0
    s_sleep 2
    v_mov_b32 v95, 0
    buffer_atomic_add v95, v23, s[8:11], s48 offen sc0
    s_sleep 2
interleave_layers__linear_attn_block__memory_aug_recurrent_mem_tr__prompt_kernel_s_pr:
    v_mov_b32 v82, 0
    buffer_atomic_add v82, v23, s[8:11], s48 offen sc0
    s_waitcnt vmcnt(3)
    v_cmp_le_i32 vcc, 9, v83
    s_add_u32 s61, s61, 1
    s_cbranch_vccnz interleave_layers__linear_attn_block__memory_aug_recurrent_mem_tr__prompt_kernel_s_pr_out
    s_sleep 2
    v_mov_b32 v83, 0
    buffer_atomic_add v83, v23, s[8:11], s48 offen sc0
    s_waitcnt vmcnt(3)
    v_cmp_le_i32 vcc, 9, v94
    s_add_u32 s61, s61, 1
    s_cbranch_vccnz interleave_layers__linear_attn_block__memory_aug_recurrent_mem_tr__prompt_kernel_s_pr_out
    s_sleep 2
    v_mov_b32 v94, 0
    buffer_atomic_add v94, v23, s[8:11], s48 offen sc0
    s_waitcnt vmcnt(3)
    v_cmp_le_i32 vcc, 9, v95
    s_add_u32 s61, s61, 1
    s_cbranch_vccnz interleave_layers__linear_attn_block__memory_aug_recurrent_mem_tr__prompt_kernel_s_pr_out
    s_sleep 2
    v_mov_b32 v95, 0
    buffer_atomic_add v95, v23, s[8:11], s48 offen sc0
    s_waitcnt vmcnt(3)
    v_cmp_le_i32 vcc, 9, v82
    s_add_u32 s61, s61, 1
    s_cbranch_vccnz interleave_layers__linear_attn_block__memory_aug_recurrent_mem_tr__prompt_kernel_s_pr_out
    s_sleep 2
    s_cmp_ge_u32 s61, s60
    s_cbranch_scc0 interleave_layers__linear_attn_block__memory_aug_recurrent_mem_tr__prompt_kernel_s_pr
    s_mov_b32 s60, 1
interleave_layers__linear_attn_block__memory_aug_recurrent_mem_tr__prompt_kernel_s_pr_out:
    s_mov_b64 exec, -1
    buffer_load_dwordx4 v[84:87], v7, s[8:11], s47 offen sc1
    buffer_load_dwordx4 v[88:91], v7, s[8:11], s46 offen sc1
    buffer_load_dwordx2 v[92:93], v8, s[8:11], s47 offen sc1
    buffer_load_dwordx4 a[240:243], v19, s[8:11], s41 offen offset:0 sc1
    buffer_load_dwordx4 a[244:247], v19, s[8:11], s41 offen offset:1024 sc1
    buffer_load_dwordx4 a[248:251], v19, s[8:11], s41 offen offset:2048 sc1
    ds_read_b128 v[48:51], v21 offset:0
    ds_read_b128 v[52:55], v21 offset:16
    ds_read_b128 v[56:59], v21 offset:5632
    ds_read_b128 v[60:63], v21 offset:5648
    ds_read_b128 v[64:67], v21 offset:11264
    ds_read_b128 v[68:71], v21 offset:11280
    ds_read_b128 v[72:75], v21 offset:16896
    ds_read_b128 v[76:79], v21 offset:16912
    s_waitcnt lgkmcnt(4)
    v_pk_add_f32 v[48:49], v[48:49], v[56:57]
    v_pk_add_f32 v[50:51], v[50:51], v[58:59]
    v_pk_add_f32 v[52:53], v[52:53], v[60:61]
    v_pk_add_f32 v[54:55], v[54:55], v[62:63]
    s_waitcnt lgkmcnt(0)
    v_pk_add_f32 v[64:65], v[64:65], v[72:73]
    v_pk_add_f32 v[66:67], v[66:67], v[74:75]
    v_pk_add_f32 v[68:69], v[68:69], v[76:77]
    v_pk_add_f32 v[70:71], v[70:71], v[78:79]
    v_pk_add_f32 v[48:49], v[48:49], v[64:65]
    v_pk_add_f32 v[50:51], v[50:51], v[66:67]
    v_pk_add_f32 v[52:53], v[52:53], v[68:69]
    v_pk_add_f32 v[54:55], v[54:55], v[70:71]
    v_mov_b32 v81, 0xff800000
    v_cndmask_b32 v48, v81, v48, s[64:65]
    v_cndmask_b32 v49, v81, v49, s[66:67]
    v_cndmask_b32 v50, v81, v50, s[68:69]
    v_cndmask_b32 v51, v81, v51, s[70:71]
    v_cndmask_b32 v52, v81, v52, s[72:73]
    v_cndmask_b32 v53, v81, v53, s[74:75]
    v_cndmask_b32 v54, v81, v54, s[76:77]
    v_cndmask_b32 v55, v81, v55, s[78:79]
    v_max3_f32 v80, v48, v49, v50
    v_max3_f32 v80, v80, v51, v52
    v_max3_f32 v80, v80, v53, v54
    v_max_f32 v80, v80, v55
    v_mov_b32 v81, 0xff800000
    v_cndmask_b32 v80, v81, v80, s[50:51]
    s_nop 1
    v_max_f32 v80, v80, v80 quad_perm:[1,0,3,2] row_mask:0xf bank_mask:0xf
    s_nop 1
    v_max_f32 v80, v80, v80 quad_perm:[2,3,0,1] row_mask:0xf bank_mask:0xf
    s_nop 1
    v_max_f32 v80, v80, v80 row_half_mirror row_mask:0xf bank_mask:0xf
    s_mov_b32 s24, 0x3dd53b95
    v_mul_f32 v80, s24, v80
    v_fma_f32 v48, v48, s24, -v80
    v_fma_f32 v49, v49, s24, -v80
    v_fma_f32 v50, v50, s24, -v80
    v_fma_f32 v51, v51, s24, -v80
    v_fma_f32 v52, v52, s24, -v80
    v_fma_f32 v53, v53, s24, -v80
    v_fma_f32 v54, v54, s24, -v80
    v_fma_f32 v55, v55, s24, -v80
    v_exp_f32 v48, v48
    v_exp_f32 v49, v49
    v_exp_f32 v50, v50
    v_exp_f32 v51, v51
    v_exp_f32 v52, v52
    v_exp_f32 v53, v53
    v_exp_f32 v54, v54
    v_exp_f32 v55, v55
    v_add_f32 v80, v48, v49
    v_add_f32 v81, v50, v51
    v_add_f32 v80, v80, v52
    v_add_f32 v81, v81, v53
    v_add_f32 v80, v80, v54
    v_add_f32 v81, v81, v55
    v_add_f32 v80, v80, v81
    v_cndmask_b32 v80, 0, v80, s[50:51]
    s_nop 1
    v_add_f32 v80, v80, v80 quad_perm:[1,0,3,2] row_mask:0xf bank_mask:0xf
    s_nop 1
    v_add_f32 v80, v80, v80 quad_perm:[2,3,0,1] row_mask:0xf bank_mask:0xf
    s_nop 1
    v_add_f32 v80, v80, v80 row_half_mirror row_mask:0xf bank_mask:0xf
    v_rcp_f32 v80, v80
    s_nop 0
    v_mul_f32 v48, v48, v80
    v_mul_f32 v49, v49, v80
    v_mul_f32 v50, v50, v80
    v_mul_f32 v51, v51, v80
    v_mul_f32 v52, v52, v80
    v_mul_f32 v53, v53, v80
    v_mul_f32 v54, v54, v80
    v_mul_f32 v55, v55, v80
    v_cvt_pk_bf16_f32 v56, v48, v49
    v_cvt_pk_bf16_f32 v57, v50, v51
    v_cvt_pk_bf16_f32 v58, v52, v53
    v_cvt_pk_bf16_f32 v59, v54, v55
    v_min_u32 v56, -2, v56
    v_min_u32 v57, -2, v57
    v_min_u32 v58, -2, v58
    v_min_u32 v59, -2, v59
    buffer_store_dwordx4 v[56:59], v22, s[8:11], s42 offen sc1
    s_add_u32 s42, s42, 458752
    s_waitcnt vmcnt(4)
    v_max3_u32 v58, v84, v85, v86
    v_max3_u32 v58, v58, v87, v88
    v_max3_u32 v58, v58, v89, v90
    v_max3_u32 v58, v58, v91, v92
    v_max_u32 v58, v58, v93
    v_cmp_eq_u32 vcc, -1, v58
    s_cbranch_vccz interleave_layers__linear_attn_block__memory_aug_recurrent_mem_tr__prompt_kernel_s_pm_out
    s_mov_b32 s61, 0
interleave_layers__linear_attn_block__memory_aug_recurrent_mem_tr__prompt_kernel_s_pm:
    buffer_load_dwordx4 v[84:87], v7, s[8:11], s47 offen sc1
    buffer_load_dwordx4 v[88:91], v7, s[8:11], s46 offen sc1
    buffer_load_dwordx2 v[92:93], v8, s[8:11], s47 offen sc1
    s_waitcnt vmcnt(0)
    v_max3_u32 v58, v84, v85, v86
    v_max3_u32 v58, v58, v87, v88
    v_max3_u32 v58, v58, v89, v90
    v_max3_u32 v58, v58, v91, v92
    v_max_u32 v58, v58, v93
    v_cmp_eq_u32 vcc, -1, v58
    s_add_u32 s61, s61, 1
    s_cbranch_vccz interleave_layers__linear_attn_block__memory_aug_recurrent_mem_tr__prompt_kernel_s_pm_out
    s_cmp_ge_u32 s61, s60
    s_cbranch_scc1 interleave_layers__linear_attn_block__memory_aug_recurrent_mem_tr__prompt_kernel_s_pm_to
    s_sleep 1
    s_branch interleave_layers__linear_attn_block__memory_aug_recurrent_mem_tr__prompt_kernel_s_pm
interleave_layers__linear_attn_block__memory_aug_recurrent_mem_tr__prompt_kernel_s_pm_to:
    s_mov_b32 s60, 1
interleave_layers__linear_attn_block__memory_aug_recurrent_mem_tr__prompt_kernel_s_pm_out:
    ds_write_b128 v7, v[84:87]
    ds_write_b128 v7, v[88:91] offset:4096
    ds_write_b64 v8, v[92:93]
    s_waitcnt lgkmcnt(0)
interleave_layers__linear_attn_block__memory_aug_recurrent_mem_tr__prompt_kernel_s_go2:
    s_barrier
    ds_read_b128 v[48:51], v5 offset:0
    ds_read_b128 v[68:71], v6 offset:0
    ds_read_b128 v[72:75], v6 offset:1024
    ds_read_b128 v[52:55], v5 offset:1024
    ds_read_b128 v[76:79], v6 offset:2048
    ds_read_b128 v[80:83], v6 offset:3072
    ds_read_b128 v[56:59], v5 offset:2048
    ds_read_b128 v[60:63], v5 offset:3072
    ds_read_b128 v[64:67], v5 offset:4096
    s_waitcnt lgkmcnt(8)
    v_smfmac_f32_16x16x64_bf16 v[24:27], v[48:51], a[0:7], v4
    v_smfmac_f32_16x16x64_bf16 v[28:31], v[48:51], a[80:87], v4
    v_smfmac_f32_16x16x64_bf16 v[32:35], v[48:51], a[160:167], v4
    v_smfmac_f32_16x16x64_bf16 v[36:39], v[48:51], v[96:103], v4
    v_smfmac_f32_16x16x64_bf16 v[40:43], v[48:51], v[176:183], v4
    s_waitcnt lgkmcnt(6)
    v_smfmac_f32_16x16x64_bf16 v[44:47], v[48:51], v[68:75], v4
    ds_read_b128 v[68:71], v6 offset:4096
    ds_read_b128 v[72:75], v6 offset:5120
    ds_read_b128 v[48:51], v5 offset:5120
    s_waitcnt lgkmcnt(8)
    v_smfmac_f32_16x16x64_bf16 v[24:27], v[52:55], a[8:15], v4
    v_smfmac_f32_16x16x64_bf16 v[28:31], v[52:55], a[88:95], v4
    v_smfmac_f32_16x16x64_bf16 v[32:35], v[52:55], a[168:175], v4
    v_smfmac_f32_16x16x64_bf16 v[36:39], v[52:55], v[104:111], v4
    v_smfmac_f32_16x16x64_bf16 v[40:43], v[52:55], v[184:191], v4
    s_waitcnt lgkmcnt(6)
    v_smfmac_f32_16x16x64_bf16 v[44:47], v[52:55], v[76:83], v4
    ds_read_b128 v[76:79], v6 offset:6144
    ds_read_b128 v[80:83], v6 offset:7168
    ds_read_b128 v[52:55], v5 offset:6144
    s_waitcnt lgkmcnt(8)
    v_smfmac_f32_16x16x64_bf16 v[24:27], v[56:59], a[16:23], v4
    v_smfmac_f32_16x16x64_bf16 v[28:31], v[56:59], a[96:103], v4
    v_smfmac_f32_16x16x64_bf16 v[32:35], v[56:59], a[176:183], v4
    v_smfmac_f32_16x16x64_bf16 v[36:39], v[56:59], v[112:119], v4
    v_smfmac_f32_16x16x64_bf16 v[40:43], v[56:59], v[192:199], v4
    s_waitcnt lgkmcnt(4)
    v_smfmac_f32_16x16x64_bf16 v[44:47], v[56:59], v[68:75], v4
    ds_read_b128 v[68:71], v6 offset:8192
    ds_read_b128 v[72:75], v6 offset:9216
    ds_read_b128 v[56:59], v5 offset:7168
    v_smfmac_f32_16x16x64_bf16 v[24:27], v[60:63], a[24:31], v4
    v_smfmac_f32_16x16x64_bf16 v[28:31], v[60:63], a[104:111], v4
    v_smfmac_f32_16x16x64_bf16 v[32:35], v[60:63], a[184:191], v4
    v_smfmac_f32_16x16x64_bf16 v[36:39], v[60:63], v[120:127], v4
    v_smfmac_f32_16x16x64_bf16 v[40:43], v[60:63], v[200:207], v4
    s_waitcnt lgkmcnt(4)
    v_smfmac_f32_16x16x64_bf16 v[44:47], v[60:63], v[76:83], v4
    ds_read_b128 v[76:79], v6 offset:10240
    ds_read_b128 v[80:83], v6 offset:11264
    ds_read_b128 v[60:63], v5 offset:8192
    v_smfmac_f32_16x16x64_bf16 v[24:27], v[64:67], a[32:39], v4
    v_smfmac_f32_16x16x64_bf16 v[28:31], v[64:67], a[112:119], v4
    v_smfmac_f32_16x16x64_bf16 v[32:35], v[64:67], a[192:199], v4
    v_smfmac_f32_16x16x64_bf16 v[36:39], v[64:67], v[128:135], v4
    v_smfmac_f32_16x16x64_bf16 v[40:43], v[64:67], v[208:215], v4
    s_waitcnt lgkmcnt(4)
    v_smfmac_f32_16x16x64_bf16 v[44:47], v[64:67], v[68:75], v4
    ds_read_b128 v[68:71], v6 offset:12288
    ds_read_b128 v[72:75], v6 offset:13312
    ds_read_b128 v[64:67], v5 offset:9216
    v_smfmac_f32_16x16x64_bf16 v[24:27], v[48:51], a[40:47], v4
    v_smfmac_f32_16x16x64_bf16 v[28:31], v[48:51], a[120:127], v4
    v_smfmac_f32_16x16x64_bf16 v[32:35], v[48:51], a[200:207], v4
    v_smfmac_f32_16x16x64_bf16 v[36:39], v[48:51], v[136:143], v4
    v_smfmac_f32_16x16x64_bf16 v[40:43], v[48:51], v[216:223], v4
    s_waitcnt lgkmcnt(4)
    v_smfmac_f32_16x16x64_bf16 v[44:47], v[48:51], v[76:83], v4
    ds_read_b128 v[76:79], v6 offset:14336
    ds_read_b128 v[80:83], v6 offset:15360
    v_smfmac_f32_16x16x64_bf16 v[24:27], v[52:55], a[48:55], v4
    v_smfmac_f32_16x16x64_bf16 v[28:31], v[52:55], a[128:135], v4
    v_smfmac_f32_16x16x64_bf16 v[32:35], v[52:55], a[208:215], v4
    v_smfmac_f32_16x16x64_bf16 v[36:39], v[52:55], v[144:151], v4
    v_smfmac_f32_16x16x64_bf16 v[40:43], v[52:55], v[224:231], v4
    s_waitcnt lgkmcnt(3)
    v_smfmac_f32_16x16x64_bf16 v[44:47], v[52:55], v[68:75], v4
    ds_read_b128 v[68:71], v6 offset:16384
    ds_read_b128 v[72:75], v6 offset:17408
    v_smfmac_f32_16x16x64_bf16 v[24:27], v[56:59], a[56:63], v4
    v_smfmac_f32_16x16x64_bf16 v[28:31], v[56:59], a[136:143], v4
    v_smfmac_f32_16x16x64_bf16 v[32:35], v[56:59], a[216:223], v4
    v_smfmac_f32_16x16x64_bf16 v[36:39], v[56:59], v[152:159], v4
    v_smfmac_f32_16x16x64_bf16 v[40:43], v[56:59], v[232:239], v4
    s_waitcnt lgkmcnt(2)
    v_smfmac_f32_16x16x64_bf16 v[44:47], v[56:59], v[76:83], v4
    ds_read_b128 v[76:79], v6 offset:18432
    ds_read_b128 v[80:83], v6 offset:19456
    v_smfmac_f32_16x16x64_bf16 v[24:27], v[60:63], a[64:71], v4
    v_smfmac_f32_16x16x64_bf16 v[28:31], v[60:63], a[144:151], v4
    v_smfmac_f32_16x16x64_bf16 v[32:35], v[60:63], a[224:231], v4
    v_smfmac_f32_16x16x64_bf16 v[36:39], v[60:63], v[160:167], v4
    v_smfmac_f32_16x16x64_bf16 v[40:43], v[60:63], v[240:247], v4
    s_waitcnt lgkmcnt(2)
    v_smfmac_f32_16x16x64_bf16 v[44:47], v[60:63], v[68:75], v4
    v_smfmac_f32_16x16x64_bf16 v[24:27], v[64:67], a[72:79], v4
    v_smfmac_f32_16x16x64_bf16 v[28:31], v[64:67], a[152:159], v4
    v_smfmac_f32_16x16x64_bf16 v[32:35], v[64:67], a[232:239], v4
    v_smfmac_f32_16x16x64_bf16 v[36:39], v[64:67], v[168:175], v4
    v_smfmac_f32_16x16x64_bf16 v[40:43], v[64:67], v[248:255], v4
    s_waitcnt lgkmcnt(0)
    v_smfmac_f32_16x16x64_bf16 v[44:47], v[64:67], v[76:83], v4
    buffer_load_dwordx4 v[80:83], v19, s[8:11], s45 offen offset:0 sc1
    buffer_load_dwordx4 v[84:87], v19, s[8:11], s45 offen offset:1024 sc1
    buffer_load_dwordx4 v[88:91], v19, s[8:11], s45 offen offset:2048 sc1
    s_waitcnt vmcnt(3)
    s_nop 4
    v_permlane32_swap_b32 v24, v36
    v_permlane32_swap_b32 v25, v37
    v_permlane32_swap_b32 v26, v38
    v_permlane32_swap_b32 v27, v39
    v_add_f32 v24, v24, v36
    v_add_f32 v25, v25, v37
    v_add_f32 v26, v26, v38
    v_add_f32 v27, v27, v39
    v_cvt_pk_bf16_f32 v48, v24, v25
    v_cvt_pk_bf16_f32 v49, v26, v27
    ds_write_b64 v9, v[48:49] offset:0
    v_permlane32_swap_b32 v28, v40
    v_permlane32_swap_b32 v29, v41
    v_permlane32_swap_b32 v30, v42
    v_permlane32_swap_b32 v31, v43
    v_add_f32 v28, v28, v40
    v_add_f32 v29, v29, v41
    v_add_f32 v30, v30, v42
    v_add_f32 v31, v31, v43
    v_cvt_pk_bf16_f32 v50, v28, v29
    v_cvt_pk_bf16_f32 v51, v30, v31
    ds_write_b64 v9, v[50:51] offset:512
    v_permlane32_swap_b32 v32, v44
    v_permlane32_swap_b32 v33, v45
    v_permlane32_swap_b32 v34, v46
    v_permlane32_swap_b32 v35, v47
    v_add_f32 v32, v32, v44
    v_add_f32 v33, v33, v45
    v_add_f32 v34, v34, v46
    v_add_f32 v35, v35, v47
    v_cvt_pk_bf16_f32 v52, v32, v33
    v_cvt_pk_bf16_f32 v53, v34, v35
    ds_write_b64 v9, v[52:53] offset:1024
    s_waitcnt lgkmcnt(0)
    ds_read_b64_tr_b16 v[24:25], v11
    ds_read_b64_tr_b16 v[26:27], v11 offset:512
    ds_read_b64_tr_b16 v[28:29], v11 offset:1024
    s_waitcnt lgkmcnt(0)
    v_mfma_f32_16x16x32_bf16 v[64:67], a[240:243], v[24:27], 0
    v_mfma_f32_16x16x32_bf16 v[68:71], a[244:247], v[24:27], 0
    v_mfma_f32_16x16x32_bf16 v[72:75], v[24:27], v[24:27], 0
    s_nop 3
    v_mfma_f32_16x16x16_bf16 v[64:67], a[248:249], v[28:29], v[64:67]
    v_mfma_f32_16x16x16_bf16 v[68:71], a[250:251], v[28:29], v[68:71]
    v_mfma_f32_16x16x16_bf16 v[72:75], v[28:29], v[28:29], v[72:75]
    s_nop 5
    ds_write_b128 v12, v[64:67]
    ds_write_b128 v12, v[68:71] offset:16
    ds_write_b128 v13, v[72:75]
    s_waitcnt lgkmcnt(0)
    s_barrier
    buffer_atomic_add v0, v20, s[8:11], s49 offen
    ds_read_b128 v[48:51], v14 offset:0
    ds_read_b128 v[52:55], v14 offset:16
    ds_read_b128 v[56:59], v14 offset:1408
    ds_read_b128 v[60:63], v14 offset:1424
    ds_read_b128 v[64:67], v14 offset:2816
    ds_read_b128 v[68:71], v14 offset:2832
    ds_read_b128 v[72:75], v14 offset:4224
    ds_read_b128 v[76:79], v14 offset:4240
    s_waitcnt lgkmcnt(4)
    v_pk_add_f32 v[48:49], v[48:49], v[56:57]
    v_pk_add_f32 v[50:51], v[50:51], v[58:59]
    v_pk_add_f32 v[52:53], v[52:53], v[60:61]
    v_pk_add_f32 v[54:55], v[54:55], v[62:63]
    s_waitcnt lgkmcnt(0)
    v_pk_add_f32 v[64:65], v[64:65], v[72:73]
    v_pk_add_f32 v[66:67], v[66:67], v[74:75]
    v_pk_add_f32 v[68:69], v[68:69], v[76:77]
    v_pk_add_f32 v[70:71], v[70:71], v[78:79]
    v_pk_add_f32 v[48:49], v[48:49], v[64:65]
    v_pk_add_f32 v[50:51], v[50:51], v[66:67]
    v_pk_add_f32 v[52:53], v[52:53], v[68:69]
    v_pk_add_f32 v[54:55], v[54:55], v[70:71]
    v_max3_f32 v92, v48, v49, v50
    v_max3_f32 v92, v92, v51, v52
    v_max3_f32 v92, v92, v53, v54
    v_max_f32 v92, v92, v55
    v_mov_b32 v93, 0xff800000
    v_cndmask_b32 v92, v93, v92, s[50:51]
    s_nop 1
    v_max_f32 v92, v92, v92 quad_perm:[1,0,3,2] row_mask:0xf bank_mask:0xf
    s_nop 1
    v_max_f32 v92, v92, v92 quad_perm:[2,3,0,1] row_mask:0xf bank_mask:0xf
    s_nop 1
    v_max_f32 v92, v92, v92 row_half_mirror row_mask:0xf bank_mask:0xf
    s_mov_b32 s24, 0x3dd53b95
    v_mul_f32 v92, s24, v92
    v_fma_f32 v48, v48, s24, -v92
    v_fma_f32 v49, v49, s24, -v92
    v_fma_f32 v50, v50, s24, -v92
    v_fma_f32 v51, v51, s24, -v92
    v_fma_f32 v52, v52, s24, -v92
    v_fma_f32 v53, v53, s24, -v92
    v_fma_f32 v54, v54, s24, -v92
    v_fma_f32 v55, v55, s24, -v92
    v_exp_f32 v48, v48
    v_exp_f32 v49, v49
    v_exp_f32 v50, v50
    v_exp_f32 v51, v51
    v_exp_f32 v52, v52
    v_exp_f32 v53, v53
    v_exp_f32 v54, v54
    v_exp_f32 v55, v55
    v_add_f32 v92, v48, v49
    v_add_f32 v93, v50, v51
    v_add_f32 v92, v92, v52
    v_add_f32 v93, v93, v53
    v_add_f32 v92, v92, v54
    v_add_f32 v93, v93, v55
    v_add_f32 v92, v92, v93
    v_cndmask_b32 v92, 0, v92, s[50:51]
    s_nop 1
    v_add_f32 v92, v92, v92 quad_perm:[1,0,3,2] row_mask:0xf bank_mask:0xf
    s_nop 1
    v_add_f32 v92, v92, v92 quad_perm:[2,3,0,1] row_mask:0xf bank_mask:0xf
    s_nop 1
    v_add_f32 v92, v92, v92 row_half_mirror row_mask:0xf bank_mask:0xf
    v_rcp_f32 v92, v92
    s_nop 0
    v_mul_f32 v48, v48, v92
    v_mul_f32 v49, v49, v92
    v_mul_f32 v50, v50, v92
    v_mul_f32 v51, v51, v92
    v_mul_f32 v52, v52, v92
    v_mul_f32 v53, v53, v92
    v_mul_f32 v54, v54, v92
    v_mul_f32 v55, v55, v92
    v_cvt_pk_bf16_f32 v56, v48, v49
    v_cvt_pk_bf16_f32 v57, v50, v51
    v_cvt_pk_bf16_f32 v58, v52, v53
    v_cvt_pk_bf16_f32 v59, v54, v55
    v_min_u32 v56, -2, v56
    v_min_u32 v57, -2, v57
    v_min_u32 v58, -2, v58
    v_min_u32 v59, -2, v59
    buffer_store_dwordx4 v[56:59], v15, s[8:11], s43 offen sc1
    s_waitcnt vmcnt(2)
    v_mfma_f32_16x16x32_bf16 v[32:35], a[240:243], v[80:83], 0
    v_mfma_f32_16x16x32_bf16 v[40:43], a[244:247], v[80:83], 0
    v_mfma_f32_16x16x32_bf16 v[64:67], v[24:27], v[80:83], 0
    v_mfma_f32_16x16x32_bf16 v[36:39], a[240:243], v[84:87], 0
    v_mfma_f32_16x16x32_bf16 v[44:47], a[244:247], v[84:87], 0
    v_mfma_f32_16x16x32_bf16 v[68:71], v[24:27], v[84:87], 0
    s_nop 0
    v_mfma_f32_16x16x16_bf16 v[32:35], a[248:249], v[88:89], v[32:35]
    v_mfma_f32_16x16x16_bf16 v[40:43], a[250:251], v[88:89], v[40:43]
    v_mfma_f32_16x16x16_bf16 v[64:67], v[28:29], v[88:89], v[64:67]
    v_mfma_f32_16x16x16_bf16 v[36:39], a[248:249], v[90:91], v[36:39]
    v_mfma_f32_16x16x16_bf16 v[44:47], a[250:251], v[90:91], v[44:47]
    v_mfma_f32_16x16x16_bf16 v[68:71], v[28:29], v[90:91], v[68:71]
    s_nop 2
    ds_write_b128 v16, v[32:35] offset:0
    ds_write_b128 v16, v[40:43] offset:16
    ds_write_b128 v17, v[64:67]
    ds_write_b128 v16, v[36:39] offset:2816
    ds_write_b128 v16, v[44:47] offset:2832
    ds_write_b128 v18, v[68:71]
    s_add_u32 s40, s40, 1
    s_add_u32 s41, s41, 393216
    s_add_u32 s45, s45, 393216
    s_add_u32 s43, s43, 458752
    s_add_u32 s47, s47, 458752
    s_add_u32 s48, s48, 458752
    s_add_u32 s49, s49, 458752
    s_waitcnt lgkmcnt(0)
    s_barrier
    s_cmp_lt_u32 s40, 64
    s_cbranch_scc1 interleave_layers__linear_attn_block__memory_aug_recurrent_mem_tr__prompt_kernel_s_step
    ds_read_b128 v[48:51], v21 offset:0
    ds_read_b128 v[52:55], v21 offset:16
    ds_read_b128 v[56:59], v21 offset:5632
    ds_read_b128 v[60:63], v21 offset:5648
    ds_read_b128 v[64:67], v21 offset:11264
    ds_read_b128 v[68:71], v21 offset:11280
    ds_read_b128 v[72:75], v21 offset:16896
    ds_read_b128 v[76:79], v21 offset:16912
    s_waitcnt lgkmcnt(4)
    v_pk_add_f32 v[48:49], v[48:49], v[56:57]
    v_pk_add_f32 v[50:51], v[50:51], v[58:59]
    v_pk_add_f32 v[52:53], v[52:53], v[60:61]
    v_pk_add_f32 v[54:55], v[54:55], v[62:63]
    s_waitcnt lgkmcnt(0)
    v_pk_add_f32 v[64:65], v[64:65], v[72:73]
    v_pk_add_f32 v[66:67], v[66:67], v[74:75]
    v_pk_add_f32 v[68:69], v[68:69], v[76:77]
    v_pk_add_f32 v[70:71], v[70:71], v[78:79]
    v_pk_add_f32 v[48:49], v[48:49], v[64:65]
    v_pk_add_f32 v[50:51], v[50:51], v[66:67]
    v_pk_add_f32 v[52:53], v[52:53], v[68:69]
    v_pk_add_f32 v[54:55], v[54:55], v[70:71]
    v_mov_b32 v81, 0xff800000
    v_cndmask_b32 v48, v81, v48, s[64:65]
    v_cndmask_b32 v49, v81, v49, s[66:67]
    v_cndmask_b32 v50, v81, v50, s[68:69]
    v_cndmask_b32 v51, v81, v51, s[70:71]
    v_cndmask_b32 v52, v81, v52, s[72:73]
    v_cndmask_b32 v53, v81, v53, s[74:75]
    v_cndmask_b32 v54, v81, v54, s[76:77]
    v_cndmask_b32 v55, v81, v55, s[78:79]
    v_max3_f32 v80, v48, v49, v50
    v_max3_f32 v80, v80, v51, v52
    v_max3_f32 v80, v80, v53, v54
    v_max_f32 v80, v80, v55
    v_mov_b32 v81, 0xff800000
    v_cndmask_b32 v80, v81, v80, s[50:51]
    s_nop 1
    v_max_f32 v80, v80, v80 quad_perm:[1,0,3,2] row_mask:0xf bank_mask:0xf
    s_nop 1
    v_max_f32 v80, v80, v80 quad_perm:[2,3,0,1] row_mask:0xf bank_mask:0xf
    s_nop 1
    v_max_f32 v80, v80, v80 row_half_mirror row_mask:0xf bank_mask:0xf
    s_mov_b32 s24, 0x3dd53b95
    v_mul_f32 v80, s24, v80
    v_fma_f32 v48, v48, s24, -v80
    v_fma_f32 v49, v49, s24, -v80
    v_fma_f32 v50, v50, s24, -v80
    v_fma_f32 v51, v51, s24, -v80
    v_fma_f32 v52, v52, s24, -v80
    v_fma_f32 v53, v53, s24, -v80
    v_fma_f32 v54, v54, s24, -v80
    v_fma_f32 v55, v55, s24, -v80
    v_exp_f32 v48, v48
    v_exp_f32 v49, v49
    v_exp_f32 v50, v50
    v_exp_f32 v51, v51
    v_exp_f32 v52, v52
    v_exp_f32 v53, v53
    v_exp_f32 v54, v54
    v_exp_f32 v55, v55
    v_add_f32 v80, v48, v49
    v_add_f32 v81, v50, v51
    v_add_f32 v80, v80, v52
    v_add_f32 v81, v81, v53
    v_add_f32 v80, v80, v54
    v_add_f32 v81, v81, v55
    v_add_f32 v80, v80, v81
    v_cndmask_b32 v80, 0, v80, s[50:51]
    s_nop 1
    v_add_f32 v80, v80, v80 quad_perm:[1,0,3,2] row_mask:0xf bank_mask:0xf
    s_nop 1
    v_add_f32 v80, v80, v80 quad_perm:[2,3,0,1] row_mask:0xf bank_mask:0xf
    s_nop 1
    v_add_f32 v80, v80, v80 row_half_mirror row_mask:0xf bank_mask:0xf
    v_rcp_f32 v80, v80
    s_nop 0
    v_mul_f32 v48, v48, v80
    v_mul_f32 v49, v49, v80
    v_mul_f32 v50, v50, v80
    v_mul_f32 v51, v51, v80
    v_mul_f32 v52, v52, v80
    v_mul_f32 v53, v53, v80
    v_mul_f32 v54, v54, v80
    v_mul_f32 v55, v55, v80
    v_cvt_pk_bf16_f32 v56, v48, v49
    v_cvt_pk_bf16_f32 v57, v50, v51
    v_cvt_pk_bf16_f32 v58, v52, v53
    v_cvt_pk_bf16_f32 v59, v54, v55
    v_min_u32 v56, -2, v56
    v_min_u32 v57, -2, v57
    v_min_u32 v58, -2, v58
    v_min_u32 v59, -2, v59
    buffer_store_dwordx4 v[56:59], v22, s[8:11], s42 offen sc1
    s_add_u32 s42, s42, 458752
    s_cmp_eq_u32 s92, 0
    s_cbranch_scc0 interleave_layers__linear_attn_block__memory_aug_recurrent_mem_tr__prompt_kernel_end
    s_mov_b32 s92, 1
    s_branch interleave_layers__linear_attn_block__memory_aug_recurrent_mem_tr__prompt_kernel_s_layer
interleave_layers__linear_attn_block__memory_aug_recurrent_mem_tr__prompt_kernel_s_go:
    v_mov_b32 v24, 0
    v_mov_b32 v25, 0
    v_mov_b32 v26, 0
    v_mov_b32 v27, 0
    v_mov_b32 v28, 0
    v_mov_b32 v29, 0
    v_mov_b32 v30, 0
    v_mov_b32 v31, 0
    v_mov_b32 v32, 0
    v_mov_b32 v33, 0
    v_mov_b32 v34, 0
    v_mov_b32 v35, 0
    v_mov_b32 v36, 0
    v_mov_b32 v37, 0
    v_mov_b32 v38, 0
    v_mov_b32 v39, 0
    v_mov_b32 v40, 0
    v_mov_b32 v41, 0
    v_mov_b32 v42, 0
    v_mov_b32 v43, 0
    v_mov_b32 v44, 0
    v_mov_b32 v45, 0
    v_mov_b32 v46, 0
    v_mov_b32 v47, 0
    s_waitcnt vmcnt(0)
    s_branch interleave_layers__linear_attn_block__memory_aug_recurrent_mem_tr__prompt_kernel_s_go2
interleave_layers__linear_attn_block__memory_aug_recurrent_mem_tr__prompt_kernel_roleV:
    s_sub_u32 s44, s2, 32
    s_load_dwordx2 s[6:7], s[0:1], 56
    s_load_dwordx2 s[24:25], s[0:1], 64
    s_load_dwordx2 s[26:27], s[0:1], 32
    s_waitcnt lgkmcnt(0)
    s_mov_b32 s12, s6
    s_mov_b32 s13, s7
    s_mov_b32 s14, 7864320
    s_mov_b32 s15, 0x00020000
    s_mov_b32 s16, s24
    s_mov_b32 s17, s25
    s_mov_b32 s18, 7864320
    s_mov_b32 s19, 0x00020000
    s_mov_b32 s20, s26
    s_mov_b32 s21, s27
    s_mov_b32 s22, 10240
    s_mov_b32 s23, 0x00020000
    v_add_u32 v16, 0, v0
    s_mov_b32 s24, 683
    v_mul_lo_u32 v17, v16, s24
    v_lshrrev_b32 v17, 14, v17
    v_mul_u32_u24 v18, 24, v17
    v_sub_u32 v18, v16, v18
    s_mov_b32 s24, 12288
    v_mul_lo_u32 v4, v17, s24
    v_lshl_add_u32 v4, v18, 4, v4
    v_mul_u32_u24 v10, 400, v17
    v_lshl_add_u32 v10, v18, 4, v10
    v_add_u32 v10, 90112, v10
    v_add_u32 v16, 256, v0
    s_mov_b32 s24, 683
    v_mul_lo_u32 v17, v16, s24
    v_lshrrev_b32 v17, 14, v17
    v_mul_u32_u24 v18, 24, v17
    v_sub_u32 v18, v16, v18
    s_mov_b32 s24, 12288
    v_mul_lo_u32 v5, v17, s24
    v_lshl_add_u32 v5, v18, 4, v5
    v_mul_u32_u24 v11, 400, v17
    v_lshl_add_u32 v11, v18, 4, v11
    v_add_u32 v11, 90112, v11
    v_add_u32 v16, 512, v0
    s_mov_b32 s24, 683
    v_mul_lo_u32 v17, v16, s24
    v_lshrrev_b32 v17, 14, v17
    v_mul_u32_u24 v18, 24, v17
    v_sub_u32 v18, v16, v18
    s_mov_b32 s24, 12288
    v_mul_lo_u32 v6, v17, s24
    v_lshl_add_u32 v6, v18, 4, v6
    v_mul_u32_u24 v12, 400, v17
    v_lshl_add_u32 v12, v18, 4, v12
    v_add_u32 v12, 90112, v12
    v_add_u32 v16, 768, v0
    s_mov_b32 s24, 683
    v_mul_lo_u32 v17, v16, s24
    v_lshrrev_b32 v17, 14, v17
    v_mul_u32_u24 v18, 24, v17
    v_sub_u32 v18, v16, v18
    s_mov_b32 s24, 12288
    v_mul_lo_u32 v7, v17, s24
    v_lshl_add_u32 v7, v18, 4, v7
    v_mul_u32_u24 v13, 400, v17
    v_lshl_add_u32 v13, v18, 4, v13
    v_add_u32 v13, 90112, v13
    v_add_u32 v16, 1024, v0
    s_mov_b32 s24, 683
    v_mul_lo_u32 v17, v16, s24
    v_lshrrev_b32 v17, 14, v17
    v_mul_u32_u24 v18, 24, v17
    v_sub_u32 v18, v16, v18
    s_mov_b32 s24, 12288
    v_mul_lo_u32 v8, v17, s24
    v_lshl_add_u32 v8, v18, 4, v8
    v_mul_u32_u24 v14, 400, v17
    v_lshl_add_u32 v14, v18, 4, v14
    v_add_u32 v14, 90112, v14
    v_add_u32 v16, 1280, v0
    s_mov_b32 s24, 683
    v_mul_lo_u32 v17, v16, s24
    v_lshrrev_b32 v17, 14, v17
    v_mul_u32_u24 v18, 24, v17
    v_sub_u32 v18, v16, v18
    s_mov_b32 s24, 12288
    v_mul_lo_u32 v9, v17, s24
    v_lshl_add_u32 v9, v18, 4, v9
    v_mul_u32_u24 v15, 400, v17
    v_lshl_add_u32 v15, v18, 4, v15
    v_add_u32 v15, 90112, v15
    v_lshrrev_b32 v17, 1, v3
    v_lshlrev_b32 v17, 4, v17
    v_and_b32 v18, 1, v3
    v_lshl_add_u32 v17, v18, 2, v17
    v_lshrrev_b32 v18, 2, v2
    v_and_b32 v19, 1, v18
    v_add_u32 v17, v17, v19
    v_lshrrev_b32 v18, 1, v18
    v_lshl_add_u32 v17, v18, 3, v17
    v_mul_u32_u24 v16, 400, v17
    v_and_b32 v18, 3, v2
    v_lshl_add_u32 v16, v18, 3, v16
    v_add_u32 v16, 90112, v16
    s_mul_i32 s24, s3, 96
    v_add_u32 v16, s24, v16
    s_mul_i32 s45, s44, 384
    s_add_u32 s46, s45, 0
    buffer_load_dwordx4 v[24:27], v4, s[12:15], s46 offen
    buffer_load_dwordx4 v[28:31], v5, s[12:15], s46 offen
    buffer_load_dwordx4 v[32:35], v6, s[12:15], s46 offen
    buffer_load_dwordx4 v[36:39], v7, s[12:15], s46 offen
    buffer_load_dwordx4 v[40:43], v8, s[12:15], s46 offen
    buffer_load_dwordx4 v[44:47], v9, s[12:15], s46 offen
    s_add_u32 s46, s45, 786432
    buffer_load_dwordx4 v[48:51], v4, s[12:15], s46 offen
    buffer_load_dwordx4 v[52:55], v5, s[12:15], s46 offen
    buffer_load_dwordx4 v[56:59], v6, s[12:15], s46 offen
    buffer_load_dwordx4 v[60:63], v7, s[12:15], s46 offen
    buffer_load_dwordx4 v[64:67], v8, s[12:15], s46 offen
    buffer_load_dwordx4 v[68:71], v9, s[12:15], s46 offen
    s_waitcnt vmcnt(6)
    ds_write_b128 v10, v[24:27]
    ds_write_b128 v11, v[28:31]
    ds_write_b128 v12, v[32:35]
    ds_write_b128 v13, v[36:39]
    ds_write_b128 v14, v[40:43]
    ds_write_b128 v15, v[44:47]
    s_add_u32 s46, s45, 1572864
    buffer_load_dwordx4 v[72:75], v4, s[12:15], s46 offen
    buffer_load_dwordx4 v[76:79], v5, s[12:15], s46 offen
    buffer_load_dwordx4 v[80:83], v6, s[12:15], s46 offen
    buffer_load_dwordx4 v[84:87], v7, s[12:15], s46 offen
    buffer_load_dwordx4 v[88:91], v8, s[12:15], s46 offen
    buffer_load_dwordx4 v[92:95], v9, s[12:15], s46 offen
    s_waitcnt lgkmcnt(0)
    s_barrier
    ds_read_b64_tr_b16 a[0:1], v16 offset:0
    ds_read_b64_tr_b16 a[2:3], v16 offset:800
    ds_read_b64_tr_b16 a[4:5], v16 offset:12800
    ds_read_b64_tr_b16 a[6:7], v16 offset:13600
    ds_read_b64_tr_b16 a[80:81], v16 offset:32
    ds_read_b64_tr_b16 a[82:83], v16 offset:832
    ds_read_b64_tr_b16 a[84:85], v16 offset:12832
    ds_read_b64_tr_b16 a[86:87], v16 offset:13632
    ds_read_b64_tr_b16 a[160:161], v16 offset:64
    ds_read_b64_tr_b16 a[162:163], v16 offset:864
    ds_read_b64_tr_b16 a[164:165], v16 offset:12864
    ds_read_b64_tr_b16 a[166:167], v16 offset:13664
    s_waitcnt lgkmcnt(0)
    s_barrier
    s_waitcnt vmcnt(6)
    ds_write_b128 v10, v[48:51]
    ds_write_b128 v11, v[52:55]
    ds_write_b128 v12, v[56:59]
    ds_write_b128 v13, v[60:63]
    ds_write_b128 v14, v[64:67]
    ds_write_b128 v15, v[68:71]
    s_add_u32 s46, s45, 2359296
    buffer_load_dwordx4 v[24:27], v4, s[12:15], s46 offen
    buffer_load_dwordx4 v[28:31], v5, s[12:15], s46 offen
    buffer_load_dwordx4 v[32:35], v6, s[12:15], s46 offen
    buffer_load_dwordx4 v[36:39], v7, s[12:15], s46 offen
    buffer_load_dwordx4 v[40:43], v8, s[12:15], s46 offen
    buffer_load_dwordx4 v[44:47], v9, s[12:15], s46 offen
    s_waitcnt lgkmcnt(0)
    s_barrier
    ds_read_b64_tr_b16 a[8:9], v16 offset:0
    ds_read_b64_tr_b16 a[10:11], v16 offset:800
    ds_read_b64_tr_b16 a[12:13], v16 offset:12800
    ds_read_b64_tr_b16 a[14:15], v16 offset:13600
    ds_read_b64_tr_b16 a[88:89], v16 offset:32
    ds_read_b64_tr_b16 a[90:91], v16 offset:832
    ds_read_b64_tr_b16 a[92:93], v16 offset:12832
    ds_read_b64_tr_b16 a[94:95], v16 offset:13632
    ds_read_b64_tr_b16 a[168:169], v16 offset:64
    ds_read_b64_tr_b16 a[170:171], v16 offset:864
    ds_read_b64_tr_b16 a[172:173], v16 offset:12864
    ds_read_b64_tr_b16 a[174:175], v16 offset:13664
    s_waitcnt lgkmcnt(0)
    s_barrier
    s_waitcnt vmcnt(6)
    ds_write_b128 v10, v[72:75]
    ds_write_b128 v11, v[76:79]
    ds_write_b128 v12, v[80:83]
    ds_write_b128 v13, v[84:87]
    ds_write_b128 v14, v[88:91]
    ds_write_b128 v15, v[92:95]
    s_add_u32 s46, s45, 3145728
    buffer_load_dwordx4 v[48:51], v4, s[12:15], s46 offen
    buffer_load_dwordx4 v[52:55], v5, s[12:15], s46 offen
    buffer_load_dwordx4 v[56:59], v6, s[12:15], s46 offen
    buffer_load_dwordx4 v[60:63], v7, s[12:15], s46 offen
    buffer_load_dwordx4 v[64:67], v8, s[12:15], s46 offen
    buffer_load_dwordx4 v[68:71], v9, s[12:15], s46 offen
    s_waitcnt lgkmcnt(0)
    s_barrier
    ds_read_b64_tr_b16 a[16:17], v16 offset:0
    ds_read_b64_tr_b16 a[18:19], v16 offset:800
    ds_read_b64_tr_b16 a[20:21], v16 offset:12800
    ds_read_b64_tr_b16 a[22:23], v16 offset:13600
    ds_read_b64_tr_b16 a[96:97], v16 offset:32
    ds_read_b64_tr_b16 a[98:99], v16 offset:832
    ds_read_b64_tr_b16 a[100:101], v16 offset:12832
    ds_read_b64_tr_b16 a[102:103], v16 offset:13632
    ds_read_b64_tr_b16 a[176:177], v16 offset:64
    ds_read_b64_tr_b16 a[178:179], v16 offset:864
    ds_read_b64_tr_b16 a[180:181], v16 offset:12864
    ds_read_b64_tr_b16 a[182:183], v16 offset:13664
    s_waitcnt lgkmcnt(0)
    s_barrier
    s_waitcnt vmcnt(6)
    ds_write_b128 v10, v[24:27]
    ds_write_b128 v11, v[28:31]
    ds_write_b128 v12, v[32:35]
    ds_write_b128 v13, v[36:39]
    ds_write_b128 v14, v[40:43]
    ds_write_b128 v15, v[44:47]
    s_add_u32 s46, s45, 3932160
    buffer_load_dwordx4 v[72:75], v4, s[12:15], s46 offen
    buffer_load_dwordx4 v[76:79], v5, s[12:15], s46 offen
    buffer_load_dwordx4 v[80:83], v6, s[12:15], s46 offen
    buffer_load_dwordx4 v[84:87], v7, s[12:15], s46 offen
    buffer_load_dwordx4 v[88:91], v8, s[12:15], s46 offen
    buffer_load_dwordx4 v[92:95], v9, s[12:15], s46 offen
    s_waitcnt lgkmcnt(0)
    s_barrier
    ds_read_b64_tr_b16 a[24:25], v16 offset:0
    ds_read_b64_tr_b16 a[26:27], v16 offset:800
    ds_read_b64_tr_b16 a[28:29], v16 offset:12800
    ds_read_b64_tr_b16 a[30:31], v16 offset:13600
    ds_read_b64_tr_b16 a[104:105], v16 offset:32
    ds_read_b64_tr_b16 a[106:107], v16 offset:832
    ds_read_b64_tr_b16 a[108:109], v16 offset:12832
    ds_read_b64_tr_b16 a[110:111], v16 offset:13632
    ds_read_b64_tr_b16 a[184:185], v16 offset:64
    ds_read_b64_tr_b16 a[186:187], v16 offset:864
    ds_read_b64_tr_b16 a[188:189], v16 offset:12864
    ds_read_b64_tr_b16 a[190:191], v16 offset:13664
    s_waitcnt lgkmcnt(0)
    s_barrier
    s_waitcnt vmcnt(6)
    ds_write_b128 v10, v[48:51]
    ds_write_b128 v11, v[52:55]
    ds_write_b128 v12, v[56:59]
    ds_write_b128 v13, v[60:63]
    ds_write_b128 v14, v[64:67]
    ds_write_b128 v15, v[68:71]
    s_add_u32 s46, s45, 4718592
    buffer_load_dwordx4 v[24:27], v4, s[12:15], s46 offen
    buffer_load_dwordx4 v[28:31], v5, s[12:15], s46 offen
    buffer_load_dwordx4 v[32:35], v6, s[12:15], s46 offen
    buffer_load_dwordx4 v[36:39], v7, s[12:15], s46 offen
    buffer_load_dwordx4 v[40:43], v8, s[12:15], s46 offen
    buffer_load_dwordx4 v[44:47], v9, s[12:15], s46 offen
    s_waitcnt lgkmcnt(0)
    s_barrier
    ds_read_b64_tr_b16 a[32:33], v16 offset:0
    ds_read_b64_tr_b16 a[34:35], v16 offset:800
    ds_read_b64_tr_b16 a[36:37], v16 offset:12800
    ds_read_b64_tr_b16 a[38:39], v16 offset:13600
    ds_read_b64_tr_b16 a[112:113], v16 offset:32
    ds_read_b64_tr_b16 a[114:115], v16 offset:832
    ds_read_b64_tr_b16 a[116:117], v16 offset:12832
    ds_read_b64_tr_b16 a[118:119], v16 offset:13632
    ds_read_b64_tr_b16 a[192:193], v16 offset:64
    ds_read_b64_tr_b16 a[194:195], v16 offset:864
    ds_read_b64_tr_b16 a[196:197], v16 offset:12864
    ds_read_b64_tr_b16 a[198:199], v16 offset:13664
    s_waitcnt lgkmcnt(0)
    s_barrier
    s_waitcnt vmcnt(6)
    ds_write_b128 v10, v[72:75]
    ds_write_b128 v11, v[76:79]
    ds_write_b128 v12, v[80:83]
    ds_write_b128 v13, v[84:87]
    ds_write_b128 v14, v[88:91]
    ds_write_b128 v15, v[92:95]
    s_add_u32 s46, s45, 5505024
    buffer_load_dwordx4 v[48:51], v4, s[12:15], s46 offen
    buffer_load_dwordx4 v[52:55], v5, s[12:15], s46 offen
    buffer_load_dwordx4 v[56:59], v6, s[12:15], s46 offen
    buffer_load_dwordx4 v[60:63], v7, s[12:15], s46 offen
    buffer_load_dwordx4 v[64:67], v8, s[12:15], s46 offen
    buffer_load_dwordx4 v[68:71], v9, s[12:15], s46 offen
    s_waitcnt lgkmcnt(0)
    s_barrier
    ds_read_b64_tr_b16 a[40:41], v16 offset:0
    ds_read_b64_tr_b16 a[42:43], v16 offset:800
    ds_read_b64_tr_b16 a[44:45], v16 offset:12800
    ds_read_b64_tr_b16 a[46:47], v16 offset:13600
    ds_read_b64_tr_b16 a[120:121], v16 offset:32
    ds_read_b64_tr_b16 a[122:123], v16 offset:832
    ds_read_b64_tr_b16 a[124:125], v16 offset:12832
    ds_read_b64_tr_b16 a[126:127], v16 offset:13632
    ds_read_b64_tr_b16 a[200:201], v16 offset:64
    ds_read_b64_tr_b16 a[202:203], v16 offset:864
    ds_read_b64_tr_b16 a[204:205], v16 offset:12864
    ds_read_b64_tr_b16 a[206:207], v16 offset:13664
    s_waitcnt lgkmcnt(0)
    s_barrier
    s_waitcnt vmcnt(6)
    ds_write_b128 v10, v[24:27]
    ds_write_b128 v11, v[28:31]
    ds_write_b128 v12, v[32:35]
    ds_write_b128 v13, v[36:39]
    ds_write_b128 v14, v[40:43]
    ds_write_b128 v15, v[44:47]
    s_add_u32 s46, s45, 6291456
    buffer_load_dwordx4 v[72:75], v4, s[12:15], s46 offen
    buffer_load_dwordx4 v[76:79], v5, s[12:15], s46 offen
    buffer_load_dwordx4 v[80:83], v6, s[12:15], s46 offen
    buffer_load_dwordx4 v[84:87], v7, s[12:15], s46 offen
    buffer_load_dwordx4 v[88:91], v8, s[12:15], s46 offen
    buffer_load_dwordx4 v[92:95], v9, s[12:15], s46 offen
    s_waitcnt lgkmcnt(0)
    s_barrier
    ds_read_b64_tr_b16 a[48:49], v16 offset:0
    ds_read_b64_tr_b16 a[50:51], v16 offset:800
    ds_read_b64_tr_b16 a[52:53], v16 offset:12800
    ds_read_b64_tr_b16 a[54:55], v16 offset:13600
    ds_read_b64_tr_b16 a[128:129], v16 offset:32
    ds_read_b64_tr_b16 a[130:131], v16 offset:832
    ds_read_b64_tr_b16 a[132:133], v16 offset:12832
    ds_read_b64_tr_b16 a[134:135], v16 offset:13632
    ds_read_b64_tr_b16 a[208:209], v16 offset:64
    ds_read_b64_tr_b16 a[210:211], v16 offset:864
    ds_read_b64_tr_b16 a[212:213], v16 offset:12864
    ds_read_b64_tr_b16 a[214:215], v16 offset:13664
    s_waitcnt lgkmcnt(0)
    s_barrier
    s_waitcnt vmcnt(6)
    ds_write_b128 v10, v[48:51]
    ds_write_b128 v11, v[52:55]
    ds_write_b128 v12, v[56:59]
    ds_write_b128 v13, v[60:63]
    ds_write_b128 v14, v[64:67]
    ds_write_b128 v15, v[68:71]
    s_add_u32 s46, s45, 7077888
    buffer_load_dwordx4 v[24:27], v4, s[12:15], s46 offen
    buffer_load_dwordx4 v[28:31], v5, s[12:15], s46 offen
    buffer_load_dwordx4 v[32:35], v6, s[12:15], s46 offen
    buffer_load_dwordx4 v[36:39], v7, s[12:15], s46 offen
    buffer_load_dwordx4 v[40:43], v8, s[12:15], s46 offen
    buffer_load_dwordx4 v[44:47], v9, s[12:15], s46 offen
    s_waitcnt lgkmcnt(0)
    s_barrier
    ds_read_b64_tr_b16 a[56:57], v16 offset:0
    ds_read_b64_tr_b16 a[58:59], v16 offset:800
    ds_read_b64_tr_b16 a[60:61], v16 offset:12800
    ds_read_b64_tr_b16 a[62:63], v16 offset:13600
    ds_read_b64_tr_b16 a[136:137], v16 offset:32
    ds_read_b64_tr_b16 a[138:139], v16 offset:832
    ds_read_b64_tr_b16 a[140:141], v16 offset:12832
    ds_read_b64_tr_b16 a[142:143], v16 offset:13632
    ds_read_b64_tr_b16 a[216:217], v16 offset:64
    ds_read_b64_tr_b16 a[218:219], v16 offset:864
    ds_read_b64_tr_b16 a[220:221], v16 offset:12864
    ds_read_b64_tr_b16 a[222:223], v16 offset:13664
    s_waitcnt lgkmcnt(0)
    s_barrier
    s_waitcnt vmcnt(6)
    ds_write_b128 v10, v[72:75]
    ds_write_b128 v11, v[76:79]
    ds_write_b128 v12, v[80:83]
    ds_write_b128 v13, v[84:87]
    ds_write_b128 v14, v[88:91]
    ds_write_b128 v15, v[92:95]
    s_waitcnt lgkmcnt(0)
    s_barrier
    ds_read_b64_tr_b16 a[64:65], v16 offset:0
    ds_read_b64_tr_b16 a[66:67], v16 offset:800
    ds_read_b64_tr_b16 a[68:69], v16 offset:12800
    ds_read_b64_tr_b16 a[70:71], v16 offset:13600
    ds_read_b64_tr_b16 a[144:145], v16 offset:32
    ds_read_b64_tr_b16 a[146:147], v16 offset:832
    ds_read_b64_tr_b16 a[148:149], v16 offset:12832
    ds_read_b64_tr_b16 a[150:151], v16 offset:13632
    ds_read_b64_tr_b16 a[224:225], v16 offset:64
    ds_read_b64_tr_b16 a[226:227], v16 offset:864
    ds_read_b64_tr_b16 a[228:229], v16 offset:12864
    ds_read_b64_tr_b16 a[230:231], v16 offset:13664
    s_waitcnt lgkmcnt(0)
    s_barrier
    s_waitcnt vmcnt(0)
    ds_write_b128 v10, v[24:27]
    ds_write_b128 v11, v[28:31]
    ds_write_b128 v12, v[32:35]
    ds_write_b128 v13, v[36:39]
    ds_write_b128 v14, v[40:43]
    ds_write_b128 v15, v[44:47]
    s_waitcnt lgkmcnt(0)
    s_barrier
    ds_read_b64_tr_b16 a[72:73], v16 offset:0
    ds_read_b64_tr_b16 a[74:75], v16 offset:800
    ds_read_b64_tr_b16 a[76:77], v16 offset:12800
    ds_read_b64_tr_b16 a[78:79], v16 offset:13600
    ds_read_b64_tr_b16 a[152:153], v16 offset:32
    ds_read_b64_tr_b16 a[154:155], v16 offset:832
    ds_read_b64_tr_b16 a[156:157], v16 offset:12832
    ds_read_b64_tr_b16 a[158:159], v16 offset:13632
    ds_read_b64_tr_b16 a[232:233], v16 offset:64
    ds_read_b64_tr_b16 a[234:235], v16 offset:864
    ds_read_b64_tr_b16 a[236:237], v16 offset:12864
    ds_read_b64_tr_b16 a[238:239], v16 offset:13664
    s_waitcnt lgkmcnt(0)
    s_barrier
    v_add_u32 v64, 0, v0
    s_mov_b32 s24, 1639
    v_mul_lo_u32 v65, v64, s24
    v_lshrrev_b32 v65, 16, v65
    v_mul_u32_u24 v66, 40, v65
    v_sub_u32 v66, v64, v66
    s_mov_b32 s24, 1280
    v_mul_lo_u32 v4, v65, s24
    v_lshl_add_u32 v4, v66, 4, v4
    v_mul_u32_u24 v14, 656, v65
    v_lshl_add_u32 v14, v66, 4, v14
    v_add_u32 v14, 90112, v14
    v_add_u32 v64, 256, v0
    s_mov_b32 s24, 1639
    v_mul_lo_u32 v65, v64, s24
    v_lshrrev_b32 v65, 16, v65
    v_mul_u32_u24 v66, 40, v65
    v_sub_u32 v66, v64, v66
    s_mov_b32 s24, 1280
    v_mul_lo_u32 v5, v65, s24
    v_lshl_add_u32 v5, v66, 4, v5
    v_mul_u32_u24 v15, 656, v65
    v_lshl_add_u32 v15, v66, 4, v15
    v_add_u32 v15, 90112, v15
    v_add_u32 v64, 512, v0
    s_mov_b32 s24, 1639
    v_mul_lo_u32 v65, v64, s24
    v_lshrrev_b32 v65, 16, v65
    v_mul_u32_u24 v66, 40, v65
    v_sub_u32 v66, v64, v66
    s_mov_b32 s24, 1280
    v_mul_lo_u32 v6, v65, s24
    v_lshl_add_u32 v6, v66, 4, v6
    v_mul_u32_u24 v16, 656, v65
    v_lshl_add_u32 v16, v66, 4, v16
    v_add_u32 v16, 90112, v16
    v_add_u32 v64, 768, v0
    s_mov_b32 s24, 1639
    v_mul_lo_u32 v65, v64, s24
    v_lshrrev_b32 v65, 16, v65
    v_mul_u32_u24 v66, 40, v65
    v_sub_u32 v66, v64, v66
    s_mov_b32 s24, 1280
    v_mul_lo_u32 v7, v65, s24
    v_lshl_add_u32 v7, v66, 4, v7
    v_mul_u32_u24 v17, 656, v65
    v_lshl_add_u32 v17, v66, 4, v17
    v_add_u32 v17, 90112, v17
    v_add_u32 v64, 1024, v0
    s_mov_b32 s24, 1639
    v_mul_lo_u32 v65, v64, s24
    v_lshrrev_b32 v65, 16, v65
    v_mul_u32_u24 v66, 40, v65
    v_sub_u32 v66, v64, v66
    s_mov_b32 s24, 1280
    v_mul_lo_u32 v8, v65, s24
    v_lshl_add_u32 v8, v66, 4, v8
    v_mul_u32_u24 v18, 656, v65
    v_lshl_add_u32 v18, v66, 4, v18
    v_add_u32 v18, 90112, v18
    v_add_u32 v64, 1280, v0
    s_mov_b32 s24, 1639
    v_mul_lo_u32 v65, v64, s24
    v_lshrrev_b32 v65, 16, v65
    v_mul_u32_u24 v66, 40, v65
    v_sub_u32 v66, v64, v66
    s_mov_b32 s24, 1280
    v_mul_lo_u32 v9, v65, s24
    v_lshl_add_u32 v9, v66, 4, v9
    v_mul_u32_u24 v19, 656, v65
    v_lshl_add_u32 v19, v66, 4, v19
    v_add_u32 v19, 90112, v19
    v_add_u32 v64, 1536, v0
    s_mov_b32 s24, 1639
    v_mul_lo_u32 v65, v64, s24
    v_lshrrev_b32 v65, 16, v65
    v_mul_u32_u24 v66, 40, v65
    v_sub_u32 v66, v64, v66
    s_mov_b32 s24, 1280
    v_mul_lo_u32 v10, v65, s24
    v_lshl_add_u32 v10, v66, 4, v10
    v_mul_u32_u24 v20, 656, v65
    v_lshl_add_u32 v20, v66, 4, v20
    v_add_u32 v20, 90112, v20
    v_add_u32 v64, 1792, v0
    s_mov_b32 s24, 1639
    v_mul_lo_u32 v65, v64, s24
    v_lshrrev_b32 v65, 16, v65
    v_mul_u32_u24 v66, 40, v65
    v_sub_u32 v66, v64, v66
    s_mov_b32 s24, 1280
    v_mul_lo_u32 v11, v65, s24
    v_lshl_add_u32 v11, v66, 4, v11
    v_mul_u32_u24 v21, 656, v65
    v_lshl_add_u32 v21, v66, 4, v21
    v_add_u32 v21, 90112, v21
    v_add_u32 v64, 2048, v0
    s_mov_b32 s24, 1639
    v_mul_lo_u32 v65, v64, s24
    v_lshrrev_b32 v65, 16, v65
    v_mul_u32_u24 v66, 40, v65
    v_sub_u32 v66, v64, v66
    s_mov_b32 s24, 1280
    v_mul_lo_u32 v12, v65, s24
    v_lshl_add_u32 v12, v66, 4, v12
    v_mul_u32_u24 v22, 656, v65
    v_lshl_add_u32 v22, v66, 4, v22
    v_add_u32 v22, 90112, v22
    v_add_u32 v64, 2304, v0
    s_mov_b32 s24, 1639
    v_mul_lo_u32 v65, v64, s24
    v_lshrrev_b32 v65, 16, v65
    v_mul_u32_u24 v66, 40, v65
    v_sub_u32 v66, v64, v66
    s_mov_b32 s24, 1280
    v_mul_lo_u32 v13, v65, s24
    v_lshl_add_u32 v13, v66, 4, v13
    v_mul_u32_u24 v23, 656, v65
    v_lshl_add_u32 v23, v66, 4, v23
    v_add_u32 v23, 90112, v23
    v_lshrrev_b32 v64, 1, v3
    v_lshlrev_b32 v64, 4, v64
    v_and_b32 v65, 1, v3
    v_lshl_add_u32 v64, v65, 2, v64
    v_lshrrev_b32 v65, 2, v2
    v_and_b32 v66, 1, v65
    v_add_u32 v64, v64, v66
    v_lshrrev_b32 v65, 1, v65
    v_lshl_add_u32 v64, v65, 3, v64
    v_mul_u32_u24 v72, 656, v64
    v_and_b32 v65, 3, v2
    v_lshl_add_u32 v72, v65, 3, v72
    v_add_u32 v72, 90112, v72
    s_and_b32 s24, s3, 1
    s_mul_i32 s24, s24, 320
    v_add_u32 v72, s24, v72
    v_lshlrev_b32 v73, 4, v1
    s_mul_i32 s24, s3, 18432
    s_add_u32 s24, s24, 16384
    v_add_u32 v73, s24, v73
    s_mul_i32 s45, s44, 245760
    s_add_u32 s46, s45, 0
    buffer_load_dwordx4 v[24:27], v4, s[16:19], s46 offen
    buffer_load_dwordx4 v[28:31], v5, s[16:19], s46 offen
    buffer_load_dwordx4 v[32:35], v6, s[16:19], s46 offen
    buffer_load_dwordx4 v[36:39], v7, s[16:19], s46 offen
    buffer_load_dwordx4 v[40:43], v8, s[16:19], s46 offen
    buffer_load_dwordx4 v[44:47], v9, s[16:19], s46 offen
    buffer_load_dwordx4 v[48:51], v10, s[16:19], s46 offen
    buffer_load_dwordx4 v[52:55], v11, s[16:19], s46 offen
    buffer_load_dwordx4 v[56:59], v12, s[16:19], s46 offen
    buffer_load_dwordx4 v[60:63], v13, s[16:19], s46 offen
    s_waitcnt vmcnt(0)
    ds_write_b128 v14, v[24:27]
    ds_write_b128 v15, v[28:31]
    ds_write_b128 v16, v[32:35]
    ds_write_b128 v17, v[36:39]
    ds_write_b128 v18, v[40:43]
    ds_write_b128 v19, v[44:47]
    ds_write_b128 v20, v[48:51]
    ds_write_b128 v21, v[52:55]
    ds_write_b128 v22, v[56:59]
    ds_write_b128 v23, v[60:63]
    s_waitcnt lgkmcnt(0)
    s_barrier
    s_lshr_b32 s24, s3, 1
    s_cmp_eq_u32 s24, 0
    s_cbranch_scc0 interleave_layers__linear_attn_block__memory_aug_recurrent_mem_tr__prompt_kernel_wo20
    ds_read_b64_tr_b16 a[240:241], v72 offset:0
    ds_read_b64_tr_b16 a[242:243], v72 offset:1312
    ds_read_b64_tr_b16 a[244:245], v72 offset:20992
    ds_read_b64_tr_b16 a[246:247], v72 offset:22304
    ds_read_b64_tr_b16 v[112:113], v72 offset:32
    ds_read_b64_tr_b16 v[114:115], v72 offset:1344
    ds_read_b64_tr_b16 v[116:117], v72 offset:21024
    ds_read_b64_tr_b16 v[118:119], v72 offset:22336
    ds_read_b64_tr_b16 v[136:137], v72 offset:64
    ds_read_b64_tr_b16 v[138:139], v72 offset:1376
    ds_read_b64_tr_b16 v[140:141], v72 offset:21056
    ds_read_b64_tr_b16 v[142:143], v72 offset:22368
    ds_read_b64_tr_b16 v[160:161], v72 offset:96
    ds_read_b64_tr_b16 v[162:163], v72 offset:1408
    ds_read_b64_tr_b16 v[164:165], v72 offset:21088
    ds_read_b64_tr_b16 v[166:167], v72 offset:22400
    ds_read_b64_tr_b16 v[184:185], v72 offset:128
    ds_read_b64_tr_b16 v[186:187], v72 offset:1440
    ds_read_b64_tr_b16 v[188:189], v72 offset:21120
    ds_read_b64_tr_b16 v[190:191], v72 offset:22432
    ds_read_b64_tr_b16 v[208:209], v72 offset:160
    ds_read_b64_tr_b16 v[210:211], v72 offset:1472
    ds_read_b64_tr_b16 v[212:213], v72 offset:21152
    ds_read_b64_tr_b16 v[214:215], v72 offset:22464
    ds_read_b64_tr_b16 v[232:233], v72 offset:192
    ds_read_b64_tr_b16 v[234:235], v72 offset:1504
    ds_read_b64_tr_b16 v[236:237], v72 offset:21184
    ds_read_b64_tr_b16 v[238:239], v72 offset:22496
    ds_read_b64_tr_b16 v[64:65], v72 offset:224
    ds_read_b64_tr_b16 v[66:67], v72 offset:1536
    ds_read_b64_tr_b16 v[68:69], v72 offset:21216
    ds_read_b64_tr_b16 v[70:71], v72 offset:22528
    s_waitcnt lgkmcnt(0)
    ds_write_b128 v73, v[64:67] offset:0
    ds_write_b128 v73, v[68:71] offset:1024
    s_waitcnt lgkmcnt(0)
    ds_read_b64_tr_b16 v[64:65], v72 offset:256
    ds_read_b64_tr_b16 v[66:67], v72 offset:1568
    ds_read_b64_tr_b16 v[68:69], v72 offset:21248
    ds_read_b64_tr_b16 v[70:71], v72 offset:22560
    s_waitcnt lgkmcnt(0)
    ds_write_b128 v73, v[64:67] offset:6144
    ds_write_b128 v73, v[68:71] offset:7168
    s_waitcnt lgkmcnt(0)
    ds_read_b64_tr_b16 v[64:65], v72 offset:288
    ds_read_b64_tr_b16 v[66:67], v72 offset:1600
    ds_read_b64_tr_b16 v[68:69], v72 offset:21280
    ds_read_b64_tr_b16 v[70:71], v72 offset:22592
    s_waitcnt lgkmcnt(0)
    ds_write_b128 v73, v[64:67] offset:12288
    ds_write_b128 v73, v[68:71] offset:13312
    s_waitcnt lgkmcnt(0)
    s_waitcnt lgkmcnt(0)
interleave_layers__linear_attn_block__memory_aug_recurrent_mem_tr__prompt_kernel_wo20:
    s_barrier
    s_add_u32 s46, s45, 640
    buffer_load_dwordx4 v[24:27], v4, s[16:19], s46 offen
    buffer_load_dwordx4 v[28:31], v5, s[16:19], s46 offen
    buffer_load_dwordx4 v[32:35], v6, s[16:19], s46 offen
    buffer_load_dwordx4 v[36:39], v7, s[16:19], s46 offen
    buffer_load_dwordx4 v[40:43], v8, s[16:19], s46 offen
    buffer_load_dwordx4 v[44:47], v9, s[16:19], s46 offen
    buffer_load_dwordx4 v[48:51], v10, s[16:19], s46 offen
    buffer_load_dwordx4 v[52:55], v11, s[16:19], s46 offen
    buffer_load_dwordx4 v[56:59], v12, s[16:19], s46 offen
    buffer_load_dwordx4 v[60:63], v13, s[16:19], s46 offen
    s_waitcnt vmcnt(0)
    ds_write_b128 v14, v[24:27]
    ds_write_b128 v15, v[28:31]
    ds_write_b128 v16, v[32:35]
    ds_write_b128 v17, v[36:39]
    ds_write_b128 v18, v[40:43]
    ds_write_b128 v19, v[44:47]
    ds_write_b128 v20, v[48:51]
    ds_write_b128 v21, v[52:55]
    ds_write_b128 v22, v[56:59]
    ds_write_b128 v23, v[60:63]
    s_waitcnt lgkmcnt(0)
    s_barrier
    s_lshr_b32 s24, s3, 1
    s_cmp_eq_u32 s24, 1
    s_cbranch_scc0 interleave_layers__linear_attn_block__memory_aug_recurrent_mem_tr__prompt_kernel_wo21
    ds_read_b64_tr_b16 a[240:241], v72 offset:0
    ds_read_b64_tr_b16 a[242:243], v72 offset:1312
    ds_read_b64_tr_b16 a[244:245], v72 offset:20992
    ds_read_b64_tr_b16 a[246:247], v72 offset:22304
    ds_read_b64_tr_b16 v[112:113], v72 offset:32
    ds_read_b64_tr_b16 v[114:115], v72 offset:1344
    ds_read_b64_tr_b16 v[116:117], v72 offset:21024
    ds_read_b64_tr_b16 v[118:119], v72 offset:22336
    ds_read_b64_tr_b16 v[136:137], v72 offset:64
    ds_read_b64_tr_b16 v[138:139], v72 offset:1376
    ds_read_b64_tr_b16 v[140:141], v72 offset:21056
    ds_read_b64_tr_b16 v[142:143], v72 offset:22368
    ds_read_b64_tr_b16 v[160:161], v72 offset:96
    ds_read_b64_tr_b16 v[162:163], v72 offset:1408
    ds_read_b64_tr_b16 v[164:165], v72 offset:21088
    ds_read_b64_tr_b16 v[166:167], v72 offset:22400
    ds_read_b64_tr_b16 v[184:185], v72 offset:128
    ds_read_b64_tr_b16 v[186:187], v72 offset:1440
    ds_read_b64_tr_b16 v[188:189], v72 offset:21120
    ds_read_b64_tr_b16 v[190:191], v72 offset:22432
    ds_read_b64_tr_b16 v[208:209], v72 offset:160
    ds_read_b64_tr_b16 v[210:211], v72 offset:1472
    ds_read_b64_tr_b16 v[212:213], v72 offset:21152
    ds_read_b64_tr_b16 v[214:215], v72 offset:22464
    ds_read_b64_tr_b16 v[232:233], v72 offset:192
    ds_read_b64_tr_b16 v[234:235], v72 offset:1504
    ds_read_b64_tr_b16 v[236:237], v72 offset:21184
    ds_read_b64_tr_b16 v[238:239], v72 offset:22496
    ds_read_b64_tr_b16 v[64:65], v72 offset:224
    ds_read_b64_tr_b16 v[66:67], v72 offset:1536
    ds_read_b64_tr_b16 v[68:69], v72 offset:21216
    ds_read_b64_tr_b16 v[70:71], v72 offset:22528
    s_waitcnt lgkmcnt(0)
    ds_write_b128 v73, v[64:67] offset:0
    ds_write_b128 v73, v[68:71] offset:1024
    s_waitcnt lgkmcnt(0)
    ds_read_b64_tr_b16 v[64:65], v72 offset:256
    ds_read_b64_tr_b16 v[66:67], v72 offset:1568
    ds_read_b64_tr_b16 v[68:69], v72 offset:21248
    ds_read_b64_tr_b16 v[70:71], v72 offset:22560
    s_waitcnt lgkmcnt(0)
    ds_write_b128 v73, v[64:67] offset:6144
    ds_write_b128 v73, v[68:71] offset:7168
    s_waitcnt lgkmcnt(0)
    ds_read_b64_tr_b16 v[64:65], v72 offset:288
    ds_read_b64_tr_b16 v[66:67], v72 offset:1600
    ds_read_b64_tr_b16 v[68:69], v72 offset:21280
    ds_read_b64_tr_b16 v[70:71], v72 offset:22592
    s_waitcnt lgkmcnt(0)
    ds_write_b128 v73, v[64:67] offset:12288
    ds_write_b128 v73, v[68:71] offset:13312
    s_waitcnt lgkmcnt(0)
    s_waitcnt lgkmcnt(0)
interleave_layers__linear_attn_block__memory_aug_recurrent_mem_tr__prompt_kernel_wo21:
    s_barrier
    s_add_u32 s46, s45, 81920
    buffer_load_dwordx4 v[24:27], v4, s[16:19], s46 offen
    buffer_load_dwordx4 v[28:31], v5, s[16:19], s46 offen
    buffer_load_dwordx4 v[32:35], v6, s[16:19], s46 offen
    buffer_load_dwordx4 v[36:39], v7, s[16:19], s46 offen
    buffer_load_dwordx4 v[40:43], v8, s[16:19], s46 offen
    buffer_load_dwordx4 v[44:47], v9, s[16:19], s46 offen
    buffer_load_dwordx4 v[48:51], v10, s[16:19], s46 offen
    buffer_load_dwordx4 v[52:55], v11, s[16:19], s46 offen
    buffer_load_dwordx4 v[56:59], v12, s[16:19], s46 offen
    buffer_load_dwordx4 v[60:63], v13, s[16:19], s46 offen
    s_waitcnt vmcnt(0)
    ds_write_b128 v14, v[24:27]
    ds_write_b128 v15, v[28:31]
    ds_write_b128 v16, v[32:35]
    ds_write_b128 v17, v[36:39]
    ds_write_b128 v18, v[40:43]
    ds_write_b128 v19, v[44:47]
    ds_write_b128 v20, v[48:51]
    ds_write_b128 v21, v[52:55]
    ds_write_b128 v22, v[56:59]
    ds_write_b128 v23, v[60:63]
    s_waitcnt lgkmcnt(0)
    s_barrier
    s_lshr_b32 s24, s3, 1
    s_cmp_eq_u32 s24, 0
    s_cbranch_scc0 interleave_layers__linear_attn_block__memory_aug_recurrent_mem_tr__prompt_kernel_wo22
    ds_read_b64_tr_b16 a[248:249], v72 offset:0
    ds_read_b64_tr_b16 a[250:251], v72 offset:1312
    ds_read_b64_tr_b16 a[252:253], v72 offset:20992
    ds_read_b64_tr_b16 a[254:255], v72 offset:22304
    ds_read_b64_tr_b16 v[120:121], v72 offset:32
    ds_read_b64_tr_b16 v[122:123], v72 offset:1344
    ds_read_b64_tr_b16 v[124:125], v72 offset:21024
    ds_read_b64_tr_b16 v[126:127], v72 offset:22336
    ds_read_b64_tr_b16 v[144:145], v72 offset:64
    ds_read_b64_tr_b16 v[146:147], v72 offset:1376
    ds_read_b64_tr_b16 v[148:149], v72 offset:21056
    ds_read_b64_tr_b16 v[150:151], v72 offset:22368
    ds_read_b64_tr_b16 v[168:169], v72 offset:96
    ds_read_b64_tr_b16 v[170:171], v72 offset:1408
    ds_read_b64_tr_b16 v[172:173], v72 offset:21088
    ds_read_b64_tr_b16 v[174:175], v72 offset:22400
    ds_read_b64_tr_b16 v[192:193], v72 offset:128
    ds_read_b64_tr_b16 v[194:195], v72 offset:1440
    ds_read_b64_tr_b16 v[196:197], v72 offset:21120
    ds_read_b64_tr_b16 v[198:199], v72 offset:22432
    ds_read_b64_tr_b16 v[216:217], v72 offset:160
    ds_read_b64_tr_b16 v[218:219], v72 offset:1472
    ds_read_b64_tr_b16 v[220:221], v72 offset:21152
    ds_read_b64_tr_b16 v[222:223], v72 offset:22464
    ds_read_b64_tr_b16 v[240:241], v72 offset:192
    ds_read_b64_tr_b16 v[242:243], v72 offset:1504
    ds_read_b64_tr_b16 v[244:245], v72 offset:21184
    ds_read_b64_tr_b16 v[246:247], v72 offset:22496
    ds_read_b64_tr_b16 v[64:65], v72 offset:224
    ds_read_b64_tr_b16 v[66:67], v72 offset:1536
    ds_read_b64_tr_b16 v[68:69], v72 offset:21216
    ds_read_b64_tr_b16 v[70:71], v72 offset:22528
    s_waitcnt lgkmcnt(0)
    ds_write_b128 v73, v[64:67] offset:2048
    ds_write_b128 v73, v[68:71] offset:3072
    s_waitcnt lgkmcnt(0)
    ds_read_b64_tr_b16 v[64:65], v72 offset:256
    ds_read_b64_tr_b16 v[66:67], v72 offset:1568
    ds_read_b64_tr_b16 v[68:69], v72 offset:21248
    ds_read_b64_tr_b16 v[70:71], v72 offset:22560
    s_waitcnt lgkmcnt(0)
    ds_write_b128 v73, v[64:67] offset:8192
    ds_write_b128 v73, v[68:71] offset:9216
    s_waitcnt lgkmcnt(0)
    ds_read_b64_tr_b16 v[64:65], v72 offset:288
    ds_read_b64_tr_b16 v[66:67], v72 offset:1600
    ds_read_b64_tr_b16 v[68:69], v72 offset:21280
    ds_read_b64_tr_b16 v[70:71], v72 offset:22592
    s_waitcnt lgkmcnt(0)
    ds_write_b128 v73, v[64:67] offset:14336
    ds_write_b128 v73, v[68:71] offset:15360
    s_waitcnt lgkmcnt(0)
    s_waitcnt lgkmcnt(0)
interleave_layers__linear_attn_block__memory_aug_recurrent_mem_tr__prompt_kernel_wo22:
    s_barrier
    s_add_u32 s46, s45, 82560
    buffer_load_dwordx4 v[24:27], v4, s[16:19], s46 offen
    buffer_load_dwordx4 v[28:31], v5, s[16:19], s46 offen
    buffer_load_dwordx4 v[32:35], v6, s[16:19], s46 offen
    buffer_load_dwordx4 v[36:39], v7, s[16:19], s46 offen
    buffer_load_dwordx4 v[40:43], v8, s[16:19], s46 offen
    buffer_load_dwordx4 v[44:47], v9, s[16:19], s46 offen
    buffer_load_dwordx4 v[48:51], v10, s[16:19], s46 offen
    buffer_load_dwordx4 v[52:55], v11, s[16:19], s46 offen
    buffer_load_dwordx4 v[56:59], v12, s[16:19], s46 offen
    buffer_load_dwordx4 v[60:63], v13, s[16:19], s46 offen
    s_waitcnt vmcnt(0)
    ds_write_b128 v14, v[24:27]
    ds_write_b128 v15, v[28:31]
    ds_write_b128 v16, v[32:35]
    ds_write_b128 v17, v[36:39]
    ds_write_b128 v18, v[40:43]
    ds_write_b128 v19, v[44:47]
    ds_write_b128 v20, v[48:51]
    ds_write_b128 v21, v[52:55]
    ds_write_b128 v22, v[56:59]
    ds_write_b128 v23, v[60:63]
    s_waitcnt lgkmcnt(0)
    s_barrier
    s_lshr_b32 s24, s3, 1
    s_cmp_eq_u32 s24, 1
    s_cbranch_scc0 interleave_layers__linear_attn_block__memory_aug_recurrent_mem_tr__prompt_kernel_wo23
    ds_read_b64_tr_b16 a[248:249], v72 offset:0
    ds_read_b64_tr_b16 a[250:251], v72 offset:1312
    ds_read_b64_tr_b16 a[252:253], v72 offset:20992
    ds_read_b64_tr_b16 a[254:255], v72 offset:22304
    ds_read_b64_tr_b16 v[120:121], v72 offset:32
    ds_read_b64_tr_b16 v[122:123], v72 offset:1344
    ds_read_b64_tr_b16 v[124:125], v72 offset:21024
    ds_read_b64_tr_b16 v[126:127], v72 offset:22336
    ds_read_b64_tr_b16 v[144:145], v72 offset:64
    ds_read_b64_tr_b16 v[146:147], v72 offset:1376
    ds_read_b64_tr_b16 v[148:149], v72 offset:21056
    ds_read_b64_tr_b16 v[150:151], v72 offset:22368
    ds_read_b64_tr_b16 v[168:169], v72 offset:96
    ds_read_b64_tr_b16 v[170:171], v72 offset:1408
    ds_read_b64_tr_b16 v[172:173], v72 offset:21088
    ds_read_b64_tr_b16 v[174:175], v72 offset:22400
    ds_read_b64_tr_b16 v[192:193], v72 offset:128
    ds_read_b64_tr_b16 v[194:195], v72 offset:1440
    ds_read_b64_tr_b16 v[196:197], v72 offset:21120
    ds_read_b64_tr_b16 v[198:199], v72 offset:22432
    ds_read_b64_tr_b16 v[216:217], v72 offset:160
    ds_read_b64_tr_b16 v[218:219], v72 offset:1472
    ds_read_b64_tr_b16 v[220:221], v72 offset:21152
    ds_read_b64_tr_b16 v[222:223], v72 offset:22464
    ds_read_b64_tr_b16 v[240:241], v72 offset:192
    ds_read_b64_tr_b16 v[242:243], v72 offset:1504
    ds_read_b64_tr_b16 v[244:245], v72 offset:21184
    ds_read_b64_tr_b16 v[246:247], v72 offset:22496
    ds_read_b64_tr_b16 v[64:65], v72 offset:224
    ds_read_b64_tr_b16 v[66:67], v72 offset:1536
    ds_read_b64_tr_b16 v[68:69], v72 offset:21216
    ds_read_b64_tr_b16 v[70:71], v72 offset:22528
    s_waitcnt lgkmcnt(0)
    ds_write_b128 v73, v[64:67] offset:2048
    ds_write_b128 v73, v[68:71] offset:3072
    s_waitcnt lgkmcnt(0)
    ds_read_b64_tr_b16 v[64:65], v72 offset:256
    ds_read_b64_tr_b16 v[66:67], v72 offset:1568
    ds_read_b64_tr_b16 v[68:69], v72 offset:21248
    ds_read_b64_tr_b16 v[70:71], v72 offset:22560
    s_waitcnt lgkmcnt(0)
    ds_write_b128 v73, v[64:67] offset:8192
    ds_write_b128 v73, v[68:71] offset:9216
    s_waitcnt lgkmcnt(0)
    ds_read_b64_tr_b16 v[64:65], v72 offset:288
    ds_read_b64_tr_b16 v[66:67], v72 offset:1600
    ds_read_b64_tr_b16 v[68:69], v72 offset:21280
    ds_read_b64_tr_b16 v[70:71], v72 offset:22592
    s_waitcnt lgkmcnt(0)
    ds_write_b128 v73, v[64:67] offset:14336
    ds_write_b128 v73, v[68:71] offset:15360
    s_waitcnt lgkmcnt(0)
    s_waitcnt lgkmcnt(0)
interleave_layers__linear_attn_block__memory_aug_recurrent_mem_tr__prompt_kernel_wo23:
    s_barrier
    s_add_u32 s46, s45, 163840
    buffer_load_dwordx4 v[24:27], v4, s[16:19], s46 offen
    buffer_load_dwordx4 v[28:31], v5, s[16:19], s46 offen
    buffer_load_dwordx4 v[32:35], v6, s[16:19], s46 offen
    buffer_load_dwordx4 v[36:39], v7, s[16:19], s46 offen
    buffer_load_dwordx4 v[40:43], v8, s[16:19], s46 offen
    buffer_load_dwordx4 v[44:47], v9, s[16:19], s46 offen
    buffer_load_dwordx4 v[48:51], v10, s[16:19], s46 offen
    buffer_load_dwordx4 v[52:55], v11, s[16:19], s46 offen
    buffer_load_dwordx4 v[56:59], v12, s[16:19], s46 offen
    buffer_load_dwordx4 v[60:63], v13, s[16:19], s46 offen
    s_waitcnt vmcnt(0)
    ds_write_b128 v14, v[24:27]
    ds_write_b128 v15, v[28:31]
    ds_write_b128 v16, v[32:35]
    ds_write_b128 v17, v[36:39]
    ds_write_b128 v18, v[40:43]
    ds_write_b128 v19, v[44:47]
    ds_write_b128 v20, v[48:51]
    ds_write_b128 v21, v[52:55]
    ds_write_b128 v22, v[56:59]
    ds_write_b128 v23, v[60:63]
    s_waitcnt lgkmcnt(0)
    s_barrier
    s_lshr_b32 s24, s3, 1
    s_cmp_eq_u32 s24, 0
    s_cbranch_scc0 interleave_layers__linear_attn_block__memory_aug_recurrent_mem_tr__prompt_kernel_wo24
    ds_read_b64_tr_b16 v[104:105], v72 offset:0
    ds_read_b64_tr_b16 v[106:107], v72 offset:1312
    ds_read_b64_tr_b16 v[108:109], v72 offset:20992
    ds_read_b64_tr_b16 v[110:111], v72 offset:22304
    ds_read_b64_tr_b16 v[128:129], v72 offset:32
    ds_read_b64_tr_b16 v[130:131], v72 offset:1344
    ds_read_b64_tr_b16 v[132:133], v72 offset:21024
    ds_read_b64_tr_b16 v[134:135], v72 offset:22336
    ds_read_b64_tr_b16 v[152:153], v72 offset:64
    ds_read_b64_tr_b16 v[154:155], v72 offset:1376
    ds_read_b64_tr_b16 v[156:157], v72 offset:21056
    ds_read_b64_tr_b16 v[158:159], v72 offset:22368
    ds_read_b64_tr_b16 v[176:177], v72 offset:96
    ds_read_b64_tr_b16 v[178:179], v72 offset:1408
    ds_read_b64_tr_b16 v[180:181], v72 offset:21088
    ds_read_b64_tr_b16 v[182:183], v72 offset:22400
    ds_read_b64_tr_b16 v[200:201], v72 offset:128
    ds_read_b64_tr_b16 v[202:203], v72 offset:1440
    ds_read_b64_tr_b16 v[204:205], v72 offset:21120
    ds_read_b64_tr_b16 v[206:207], v72 offset:22432
    ds_read_b64_tr_b16 v[224:225], v72 offset:160
    ds_read_b64_tr_b16 v[226:227], v72 offset:1472
    ds_read_b64_tr_b16 v[228:229], v72 offset:21152
    ds_read_b64_tr_b16 v[230:231], v72 offset:22464
    ds_read_b64_tr_b16 v[248:249], v72 offset:192
    ds_read_b64_tr_b16 v[250:251], v72 offset:1504
    ds_read_b64_tr_b16 v[252:253], v72 offset:21184
    ds_read_b64_tr_b16 v[254:255], v72 offset:22496
    ds_read_b64_tr_b16 v[64:65], v72 offset:224
    ds_read_b64_tr_b16 v[66:67], v72 offset:1536
    ds_read_b64_tr_b16 v[68:69], v72 offset:21216
    ds_read_b64_tr_b16 v[70:71], v72 offset:22528
    s_waitcnt lgkmcnt(0)
    ds_write_b128 v73, v[64:67] offset:4096
    ds_write_b128 v73, v[68:71] offset:5120
    s_waitcnt lgkmcnt(0)
    ds_read_b64_tr_b16 v[64:65], v72 offset:256
    ds_read_b64_tr_b16 v[66:67], v72 offset:1568
    ds_read_b64_tr_b16 v[68:69], v72 offset:21248
    ds_read_b64_tr_b16 v[70:71], v72 offset:22560
    s_waitcnt lgkmcnt(0)
    ds_write_b128 v73, v[64:67] offset:10240
    ds_write_b128 v73, v[68:71] offset:11264
    s_waitcnt lgkmcnt(0)
    ds_read_b64_tr_b16 v[64:65], v72 offset:288
    ds_read_b64_tr_b16 v[66:67], v72 offset:1600
    ds_read_b64_tr_b16 v[68:69], v72 offset:21280
    ds_read_b64_tr_b16 v[70:71], v72 offset:22592
    s_waitcnt lgkmcnt(0)
    ds_write_b128 v73, v[64:67] offset:16384
    ds_write_b128 v73, v[68:71] offset:17408
    s_waitcnt lgkmcnt(0)
    s_waitcnt lgkmcnt(0)
interleave_layers__linear_attn_block__memory_aug_recurrent_mem_tr__prompt_kernel_wo24:
    s_barrier
    s_add_u32 s46, s45, 164480
    buffer_load_dwordx4 v[24:27], v4, s[16:19], s46 offen
    buffer_load_dwordx4 v[28:31], v5, s[16:19], s46 offen
    buffer_load_dwordx4 v[32:35], v6, s[16:19], s46 offen
    buffer_load_dwordx4 v[36:39], v7, s[16:19], s46 offen
    buffer_load_dwordx4 v[40:43], v8, s[16:19], s46 offen
    buffer_load_dwordx4 v[44:47], v9, s[16:19], s46 offen
    buffer_load_dwordx4 v[48:51], v10, s[16:19], s46 offen
    buffer_load_dwordx4 v[52:55], v11, s[16:19], s46 offen
    buffer_load_dwordx4 v[56:59], v12, s[16:19], s46 offen
    buffer_load_dwordx4 v[60:63], v13, s[16:19], s46 offen
    s_waitcnt vmcnt(0)
    ds_write_b128 v14, v[24:27]
    ds_write_b128 v15, v[28:31]
    ds_write_b128 v16, v[32:35]
    ds_write_b128 v17, v[36:39]
    ds_write_b128 v18, v[40:43]
    ds_write_b128 v19, v[44:47]
    ds_write_b128 v20, v[48:51]
    ds_write_b128 v21, v[52:55]
    ds_write_b128 v22, v[56:59]
    ds_write_b128 v23, v[60:63]
    s_waitcnt lgkmcnt(0)
    s_barrier
    s_lshr_b32 s24, s3, 1
    s_cmp_eq_u32 s24, 1
    s_cbranch_scc0 interleave_layers__linear_attn_block__memory_aug_recurrent_mem_tr__prompt_kernel_wo25
    ds_read_b64_tr_b16 v[104:105], v72 offset:0
    ds_read_b64_tr_b16 v[106:107], v72 offset:1312
    ds_read_b64_tr_b16 v[108:109], v72 offset:20992
    ds_read_b64_tr_b16 v[110:111], v72 offset:22304
    ds_read_b64_tr_b16 v[128:129], v72 offset:32
    ds_read_b64_tr_b16 v[130:131], v72 offset:1344
    ds_read_b64_tr_b16 v[132:133], v72 offset:21024
    ds_read_b64_tr_b16 v[134:135], v72 offset:22336
    ds_read_b64_tr_b16 v[152:153], v72 offset:64
    ds_read_b64_tr_b16 v[154:155], v72 offset:1376
    ds_read_b64_tr_b16 v[156:157], v72 offset:21056
    ds_read_b64_tr_b16 v[158:159], v72 offset:22368
    ds_read_b64_tr_b16 v[176:177], v72 offset:96
    ds_read_b64_tr_b16 v[178:179], v72 offset:1408
    ds_read_b64_tr_b16 v[180:181], v72 offset:21088
    ds_read_b64_tr_b16 v[182:183], v72 offset:22400
    ds_read_b64_tr_b16 v[200:201], v72 offset:128
    ds_read_b64_tr_b16 v[202:203], v72 offset:1440
    ds_read_b64_tr_b16 v[204:205], v72 offset:21120
    ds_read_b64_tr_b16 v[206:207], v72 offset:22432
    ds_read_b64_tr_b16 v[224:225], v72 offset:160
    ds_read_b64_tr_b16 v[226:227], v72 offset:1472
    ds_read_b64_tr_b16 v[228:229], v72 offset:21152
    ds_read_b64_tr_b16 v[230:231], v72 offset:22464
    ds_read_b64_tr_b16 v[248:249], v72 offset:192
    ds_read_b64_tr_b16 v[250:251], v72 offset:1504
    ds_read_b64_tr_b16 v[252:253], v72 offset:21184
    ds_read_b64_tr_b16 v[254:255], v72 offset:22496
    ds_read_b64_tr_b16 v[64:65], v72 offset:224
    ds_read_b64_tr_b16 v[66:67], v72 offset:1536
    ds_read_b64_tr_b16 v[68:69], v72 offset:21216
    ds_read_b64_tr_b16 v[70:71], v72 offset:22528
    s_waitcnt lgkmcnt(0)
    ds_write_b128 v73, v[64:67] offset:4096
    ds_write_b128 v73, v[68:71] offset:5120
    s_waitcnt lgkmcnt(0)
    ds_read_b64_tr_b16 v[64:65], v72 offset:256
    ds_read_b64_tr_b16 v[66:67], v72 offset:1568
    ds_read_b64_tr_b16 v[68:69], v72 offset:21248
    ds_read_b64_tr_b16 v[70:71], v72 offset:22560
    s_waitcnt lgkmcnt(0)
    ds_write_b128 v73, v[64:67] offset:10240
    ds_write_b128 v73, v[68:71] offset:11264
    s_waitcnt lgkmcnt(0)
    ds_read_b64_tr_b16 v[64:65], v72 offset:288
    ds_read_b64_tr_b16 v[66:67], v72 offset:1600
    ds_read_b64_tr_b16 v[68:69], v72 offset:21280
    ds_read_b64_tr_b16 v[70:71], v72 offset:22592
    s_waitcnt lgkmcnt(0)
    ds_write_b128 v73, v[64:67] offset:16384
    ds_write_b128 v73, v[68:71] offset:17408
    s_waitcnt lgkmcnt(0)
    s_waitcnt lgkmcnt(0)
interleave_layers__linear_attn_block__memory_aug_recurrent_mem_tr__prompt_kernel_wo25:
    s_barrier
    v_mov_b32 v6, v73
    v_mov_b32 v4, 0x4444
    v_mov_b32 v5, 0xeeee
    v_cmp_gt_u32 vcc, 8, v2
    s_nop 1
    v_cndmask_b32 v4, v5, v4, vcc
    v_lshlrev_b32 v5, 4, v1
    s_lshl_b32 s24, s3, 10
    v_add_u32 v7, s24, v5
    s_lshl_b32 s24, s3, 9
    s_add_u32 s24, s24, 8192
    v_lshlrev_b32 v8, 3, v1
    v_add_u32 v8, s24, v8
    v_and_b32 v64, 7, v2
    v_lshlrev_b32 v9, 5, v64
    v_lshrrev_b32 v64, 3, v2
    v_lshl_add_u32 v9, v64, 4, v9
    v_and_b32 v64, 1, v3
    v_lshl_add_u32 v9, v64, 3, v9
    s_mul_i32 s24, s3, 768
    s_add_u32 s24, s24, 10240
    v_add_u32 v9, s24, v9
    v_lshrrev_b32 v65, 1, v3
    v_lshl_add_u32 v10, v65, 8, v9
    v_lshrrev_b32 v64, 2, v2
    v_lshlrev_b32 v11, 5, v64
    v_and_b32 v64, 3, v2
    v_lshl_add_u32 v11, v64, 3, v11
    v_lshl_add_u32 v11, v3, 8, v11
    v_add_u32 v11, 10240, v11
    s_mul_i32 s24, s3, 10
    s_lshl_b32 s24, s24, 13
    s_lshl_b32 s25, s44, 8
    s_add_u32 s24, s24, s25
    v_lshlrev_b32 v14, 13, v3
    v_lshl_add_u32 v14, v2, 4, v14
    v_add_u32 v14, s24, v14
    v_lshrrev_b32 v64, 1, v3
    v_lshlrev_b32 v15, 13, v64
    v_lshl_add_u32 v15, v2, 4, v15
    v_add_u32 v15, s24, v15
    v_add_u32 v15, 65536, v15
    v_and_b32 v64, 1, v3
    v_cmp_eq_u32 vcc, 0, v64
    v_mov_b32 v64, 2146435072
    s_nop 0
    v_cndmask_b32 v15, v64, v15, vcc
    s_and_b32 s24, s2, 15
    s_mul_i32 s25, s3, 16
    s_add_u32 s24, s24, s25
    s_lshl_b32 s24, s24, 7
    v_mov_b32 v12, s24
    v_mov_b32 v0, 1
interleave_layers__linear_attn_block__memory_aug_recurrent_mem_tr__prompt_kernel_v_layer:
    s_mul_i32 s93, s92, 29360128
    s_add_u32 s93, s93, 117440512
    s_mul_i32 s94, s92, 16384
    s_add_u32 s94, s94, 23068672
    s_lshl_b32 s24, s3, 6
    s_add_u32 s24, s24, 0
    v_add_u32 v64, s24, v1
    v_and_b32 v65, 7, v64
    v_mul_u32_u24 v65, 1280, v65
    v_lshrrev_b32 v66, 3, v64
    v_lshl_add_u32 v65, v66, 4, v65
    v_cmp_gt_u32 vcc, 640, v64
    v_mov_b32 v67, 2146435072
    s_nop 0
    v_cndmask_b32 v65, v67, v65, vcc
    buffer_load_dwordx4 v[68:71], v65, s[20:23], 0 offen
    v_lshlrev_b32 v64, 4, v64
    s_waitcnt vmcnt(0)
    s_and_saveexec_b64 s[30:31], vcc
    ds_write_b128 v64, v[68:71]
    s_mov_b64 exec, s[30:31]
    s_lshl_b32 s24, s3, 6
    s_add_u32 s24, s24, 256
    v_add_u32 v64, s24, v1
    v_and_b32 v65, 7, v64
    v_mul_u32_u24 v65, 1280, v65
    v_lshrrev_b32 v66, 3, v64
    v_lshl_add_u32 v65, v66, 4, v65
    v_cmp_gt_u32 vcc, 640, v64
    v_mov_b32 v67, 2146435072
    s_nop 0
    v_cndmask_b32 v65, v67, v65, vcc
    buffer_load_dwordx4 v[68:71], v65, s[20:23], 0 offen
    v_lshlrev_b32 v64, 4, v64
    s_waitcnt vmcnt(0)
    s_and_saveexec_b64 s[30:31], vcc
    ds_write_b128 v64, v[68:71]
    s_mov_b64 exec, s[30:31]
    s_lshl_b32 s24, s3, 6
    s_add_u32 s24, s24, 512
    v_add_u32 v64, s24, v1
    v_and_b32 v65, 7, v64
    v_mul_u32_u24 v65, 1280, v65
    v_lshrrev_b32 v66, 3, v64
    v_lshl_add_u32 v65, v66, 4, v65
    v_cmp_gt_u32 vcc, 640, v64
    v_mov_b32 v67, 2146435072
    s_nop 0
    v_cndmask_b32 v65, v67, v65, vcc
    buffer_load_dwordx4 v[68:71], v65, s[20:23], 0 offen
    v_lshlrev_b32 v64, 4, v64
    s_waitcnt vmcnt(0)
    s_and_saveexec_b64 s[30:31], vcc
    ds_write_b128 v64, v[68:71]
    s_mov_b64 exec, s[30:31]
    s_mov_b32 s40, 0
    s_add_u32 s43, s93, 0
    s_add_u32 s47, s93, -28672
    s_add_u32 s45, s93, -18432
    s_lshl_b32 s95, s92, 6
    s_add_u32 s95, s95, s40
    s_add_u32 s95, s95, 1
    s_cmp_ge_i32 s59, s95
    s_cbranch_scc1 interleave_layers__linear_attn_block__memory_aug_recurrent_mem_tr__prompt_kernel_v_ec0_ok
    s_and_b32 s24, s2, 7
    s_lshl_b32 s24, s24, 7
    s_add_u32 s24, s24, 23109632
    v_and_b32 v65, 3, v1
    v_lshl_add_u32 v65, v65, 2, s24
    s_mov_b32 s61, 0
interleave_layers__linear_attn_block__memory_aug_recurrent_mem_tr__prompt_kernel_v_ec0:
    buffer_load_dword v64, v65, s[8:11], 0 offen sc1
    s_waitcnt vmcnt(0)
    v_readlane_b32 s59, v64, 0
    v_readlane_b32 s24, v64, 1
    s_min_i32 s59, s59, s24
    v_readlane_b32 s24, v64, 2
    s_min_i32 s59, s59, s24
    v_readlane_b32 s24, v64, 3
    s_min_i32 s59, s59, s24
    s_cmp_ge_i32 s59, s95
    s_cbranch_scc1 interleave_layers__linear_attn_block__memory_aug_recurrent_mem_tr__prompt_kernel_v_ec0_ok
    s_add_u32 s61, s61, 1
    s_cmp_ge_u32 s61, s60
    s_cbranch_scc1 interleave_layers__linear_attn_block__memory_aug_recurrent_mem_tr__prompt_kernel_v_ec0_to
    s_sleep 2
    s_branch interleave_layers__linear_attn_block__memory_aug_recurrent_mem_tr__prompt_kernel_v_ec0
interleave_layers__linear_attn_block__memory_aug_recurrent_mem_tr__prompt_kernel_v_ec0_to:
    s_mov_b32 s60, 1
interleave_layers__linear_attn_block__memory_aug_recurrent_mem_tr__prompt_kernel_v_ec0_ok:
    s_waitcnt lgkmcnt(0)
    s_branch interleave_layers__linear_attn_block__memory_aug_recurrent_mem_tr__prompt_kernel_v_go2
interleave_layers__linear_attn_block__memory_aug_recurrent_mem_tr__prompt_kernel_v_step:
    s_add_u32 s48, s47, 4096
    s_lshl_b32 s95, s92, 6
    s_add_u32 s95, s95, s40
    s_add_u32 s95, s95, 1
    s_cmp_ge_i32 s59, s95
    s_cbranch_scc1 interleave_layers__linear_attn_block__memory_aug_recurrent_mem_tr__prompt_kernel_v_ec_ok
    s_and_b32 s24, s2, 7
    s_lshl_b32 s24, s24, 7
    s_add_u32 s24, s24, 23109632
    v_and_b32 v65, 3, v1
    v_lshl_add_u32 v65, v65, 2, s24
    s_mov_b32 s61, 0
interleave_layers__linear_attn_block__memory_aug_recurrent_mem_tr__prompt_kernel_v_ec:
    buffer_load_dword v64, v65, s[8:11], 0 offen sc1
    s_waitcnt vmcnt(0)
    v_readlane_b32 s59, v64, 0
    v_readlane_b32 s24, v64, 1
    s_min_i32 s59, s59, s24
    v_readlane_b32 s24, v64, 2
    s_min_i32 s59, s59, s24
    v_readlane_b32 s24, v64, 3
    s_min_i32 s59, s59, s24
    s_cmp_ge_i32 s59, s95
    s_cbranch_scc1 interleave_layers__linear_attn_block__memory_aug_recurrent_mem_tr__prompt_kernel_v_ec_ok
    s_add_u32 s61, s61, 1
    s_cmp_ge_u32 s61, s60
    s_cbranch_scc1 interleave_layers__linear_attn_block__memory_aug_recurrent_mem_tr__prompt_kernel_v_ec_to
    s_sleep 2
    s_branch interleave_layers__linear_attn_block__memory_aug_recurrent_mem_tr__prompt_kernel_v_ec
interleave_layers__linear_attn_block__memory_aug_recurrent_mem_tr__prompt_kernel_v_ec_to:
    s_mov_b32 s60, 1
interleave_layers__linear_attn_block__memory_aug_recurrent_mem_tr__prompt_kernel_v_ec_ok:
    s_sleep 20
    s_mov_b64 exec, 1
    s_mov_b32 s61, 0
    v_mov_b32 v81, 0
    buffer_atomic_add v81, v12, s[8:11], s45 offen sc0
    s_sleep 2
    v_mov_b32 v82, 0
    buffer_atomic_add v82, v12, s[8:11], s45 offen sc0
    s_sleep 2
    v_mov_b32 v83, 0
    buffer_atomic_add v83, v12, s[8:11], s45 offen sc0
    s_sleep 2
interleave_layers__linear_attn_block__memory_aug_recurrent_mem_tr__prompt_kernel_v_pr:
    v_mov_b32 v80, 0
    buffer_atomic_add v80, v12, s[8:11], s45 offen sc0
    s_waitcnt vmcnt(3)
    v_cmp_le_i32 vcc, 9, v81
    s_add_u32 s61, s61, 1
    s_cbranch_vccnz interleave_layers__linear_attn_block__memory_aug_recurrent_mem_tr__prompt_kernel_v_pr_out
    s_sleep 2
    v_mov_b32 v81, 0
    buffer_atomic_add v81, v12, s[8:11], s45 offen sc0
    s_waitcnt vmcnt(3)
    v_cmp_le_i32 vcc, 9, v82
    s_add_u32 s61, s61, 1
    s_cbranch_vccnz interleave_layers__linear_attn_block__memory_aug_recurrent_mem_tr__prompt_kernel_v_pr_out
    s_sleep 2
    v_mov_b32 v82, 0
    buffer_atomic_add v82, v12, s[8:11], s45 offen sc0
    s_waitcnt vmcnt(3)
    v_cmp_le_i32 vcc, 9, v83
    s_add_u32 s61, s61, 1
    s_cbranch_vccnz interleave_layers__linear_attn_block__memory_aug_recurrent_mem_tr__prompt_kernel_v_pr_out
    s_sleep 2
    v_mov_b32 v83, 0
    buffer_atomic_add v83, v12, s[8:11], s45 offen sc0
    s_waitcnt vmcnt(3)
    v_cmp_le_i32 vcc, 9, v80
    s_add_u32 s61, s61, 1
    s_cbranch_vccnz interleave_layers__linear_attn_block__memory_aug_recurrent_mem_tr__prompt_kernel_v_pr_out
    s_sleep 2
    s_cmp_ge_u32 s61, s60
    s_cbranch_scc0 interleave_layers__linear_attn_block__memory_aug_recurrent_mem_tr__prompt_kernel_v_pr
    s_mov_b32 s60, 1
interleave_layers__linear_attn_block__memory_aug_recurrent_mem_tr__prompt_kernel_v_pr_out:
    s_mov_b64 exec, -1
    buffer_load_dwordx4 v[68:71], v7, s[8:11], s47 offen sc1
    buffer_load_dwordx4 v[72:75], v7, s[8:11], s48 offen sc1
    buffer_load_dwordx2 v[76:77], v8, s[8:11], s47 offen sc1
    s_waitcnt vmcnt(0)
    v_max3_u32 v26, v68, v69, v70
    v_max3_u32 v26, v26, v71, v72
    v_max3_u32 v26, v26, v73, v74
    v_max3_u32 v26, v26, v75, v76
    v_max_u32 v26, v26, v77
    v_cmp_eq_u32 vcc, -1, v26
    s_cbranch_vccz interleave_layers__linear_attn_block__memory_aug_recurrent_mem_tr__prompt_kernel_v_pm_out
    s_mov_b32 s61, 0
interleave_layers__linear_attn_block__memory_aug_recurrent_mem_tr__prompt_kernel_v_pm:
    buffer_load_dwordx4 v[68:71], v7, s[8:11], s47 offen sc1
    buffer_load_dwordx4 v[72:75], v7, s[8:11], s48 offen sc1
    buffer_load_dwordx2 v[76:77], v8, s[8:11], s47 offen sc1
    s_waitcnt vmcnt(0)
    v_max3_u32 v26, v68, v69, v70
    v_max3_u32 v26, v26, v71, v72
    v_max3_u32 v26, v26, v73, v74
    v_max3_u32 v26, v26, v75, v76
    v_max_u32 v26, v26, v77
    v_cmp_eq_u32 vcc, -1, v26
    s_add_u32 s61, s61, 1
    s_cbranch_vccz interleave_layers__linear_attn_block__memory_aug_recurrent_mem_tr__prompt_kernel_v_pm_out
    s_cmp_ge_u32 s61, s60
    s_cbranch_scc1 interleave_layers__linear_attn_block__memory_aug_recurrent_mem_tr__prompt_kernel_v_pm_to
    s_sleep 1
    s_branch interleave_layers__linear_attn_block__memory_aug_recurrent_mem_tr__prompt_kernel_v_pm
interleave_layers__linear_attn_block__memory_aug_recurrent_mem_tr__prompt_kernel_v_pm_to:
    s_mov_b32 s60, 1
interleave_layers__linear_attn_block__memory_aug_recurrent_mem_tr__prompt_kernel_v_pm_out:
    ds_write_b128 v7, v[68:71]
    ds_write_b128 v7, v[72:75] offset:4096
    ds_write_b64 v8, v[76:77]
    s_waitcnt lgkmcnt(0)
interleave_layers__linear_attn_block__memory_aug_recurrent_mem_tr__prompt_kernel_v_go2:
    s_barrier
    ds_read_b128 v[16:19], v5 offset:0
    ds_read_b128 v[20:23], v5 offset:1024
    ds_read_b128 v[24:27], v5 offset:2048
    ds_read_b128 v[28:31], v5 offset:3072
    ds_read_b128 v[32:35], v5 offset:4096
    ds_read_b128 v[36:39], v5 offset:5120
    ds_read_b128 v[40:43], v5 offset:6144
    ds_read_b128 v[44:47], v5 offset:7168
    ds_read_b128 v[48:51], v5 offset:8192
    ds_read_b128 v[52:55], v5 offset:9216
    v_mov_b32 v56, 0
    v_mov_b32 v57, 0
    v_mov_b32 v58, 0
    v_mov_b32 v59, 0
    v_mov_b32 v60, 0
    v_mov_b32 v61, 0
    v_mov_b32 v62, 0
    v_mov_b32 v63, 0
    v_mov_b32 v64, 0
    v_mov_b32 v65, 0
    v_mov_b32 v66, 0
    v_mov_b32 v67, 0
    s_waitcnt lgkmcnt(9)
    v_smfmac_f32_16x16x64_bf16 v[56:59], v[16:19], a[0:7], v4
    v_smfmac_f32_16x16x64_bf16 v[60:63], v[16:19], a[80:87], v4
    v_smfmac_f32_16x16x64_bf16 v[64:67], v[16:19], a[160:167], v4
    s_waitcnt lgkmcnt(8)
    v_smfmac_f32_16x16x64_bf16 v[56:59], v[20:23], a[8:15], v4
    v_smfmac_f32_16x16x64_bf16 v[60:63], v[20:23], a[88:95], v4
    v_smfmac_f32_16x16x64_bf16 v[64:67], v[20:23], a[168:175], v4
    s_waitcnt lgkmcnt(7)
    v_smfmac_f32_16x16x64_bf16 v[56:59], v[24:27], a[16:23], v4
    v_smfmac_f32_16x16x64_bf16 v[60:63], v[24:27], a[96:103], v4
    v_smfmac_f32_16x16x64_bf16 v[64:67], v[24:27], a[176:183], v4
    s_waitcnt lgkmcnt(6)
    v_smfmac_f32_16x16x64_bf16 v[56:59], v[28:31], a[24:31], v4
    v_smfmac_f32_16x16x64_bf16 v[60:63], v[28:31], a[104:111], v4
    v_smfmac_f32_16x16x64_bf16 v[64:67], v[28:31], a[184:191], v4
    s_waitcnt lgkmcnt(5)
    v_smfmac_f32_16x16x64_bf16 v[56:59], v[32:35], a[32:39], v4
    v_smfmac_f32_16x16x64_bf16 v[60:63], v[32:35], a[112:119], v4
    v_smfmac_f32_16x16x64_bf16 v[64:67], v[32:35], a[192:199], v4
    s_waitcnt lgkmcnt(4)
    v_smfmac_f32_16x16x64_bf16 v[56:59], v[36:39], a[40:47], v4
    v_smfmac_f32_16x16x64_bf16 v[60:63], v[36:39], a[120:127], v4
    v_smfmac_f32_16x16x64_bf16 v[64:67], v[36:39], a[200:207], v4
    s_waitcnt lgkmcnt(3)
    v_smfmac_f32_16x16x64_bf16 v[56:59], v[40:43], a[48:55], v4
    v_smfmac_f32_16x16x64_bf16 v[60:63], v[40:43], a[128:135], v4
    v_smfmac_f32_16x16x64_bf16 v[64:67], v[40:43], a[208:215], v4
    s_waitcnt lgkmcnt(2)
    v_smfmac_f32_16x16x64_bf16 v[56:59], v[44:47], a[56:63], v4
    v_smfmac_f32_16x16x64_bf16 v[60:63], v[44:47], a[136:143], v4
    v_smfmac_f32_16x16x64_bf16 v[64:67], v[44:47], a[216:223], v4
    s_waitcnt lgkmcnt(1)
    v_smfmac_f32_16x16x64_bf16 v[56:59], v[48:51], a[64:71], v4
    v_smfmac_f32_16x16x64_bf16 v[60:63], v[48:51], a[144:151], v4
    v_smfmac_f32_16x16x64_bf16 v[64:67], v[48:51], a[224:231], v4
    s_waitcnt lgkmcnt(0)
    v_smfmac_f32_16x16x64_bf16 v[56:59], v[52:55], a[72:79], v4
    v_smfmac_f32_16x16x64_bf16 v[60:63], v[52:55], a[152:159], v4
    v_smfmac_f32_16x16x64_bf16 v[64:67], v[52:55], a[232:239], v4
    ds_read_b128 v[80:83], v6 offset:0
    ds_read_b128 v[84:87], v6 offset:1024
    ds_read_b128 v[88:91], v6 offset:2048
    ds_read_b128 v[92:95], v6 offset:3072
    ds_read_b128 v[96:99], v6 offset:4096
    ds_read_b128 v[100:103], v6 offset:5120
    s_waitcnt vmcnt(0)
    v_mov_b32 v16, 0
    v_mov_b32 v17, 0
    v_mov_b32 v18, 0
    v_mov_b32 v19, 0
    v_mov_b32 v20, 0
    v_mov_b32 v21, 0
    v_mov_b32 v22, 0
    v_mov_b32 v23, 0
    v_mov_b32 v24, 0
    v_mov_b32 v25, 0
    v_mov_b32 v26, 0
    v_mov_b32 v27, 0
    v_mov_b32 v28, 0
    v_mov_b32 v29, 0
    v_mov_b32 v30, 0
    v_mov_b32 v31, 0
    v_mov_b32 v32, 0
    v_mov_b32 v33, 0
    v_mov_b32 v34, 0
    v_mov_b32 v35, 0
    v_mov_b32 v36, 0
    v_mov_b32 v37, 0
    v_mov_b32 v38, 0
    v_mov_b32 v39, 0
    v_mov_b32 v40, 0
    v_mov_b32 v41, 0
    v_mov_b32 v42, 0
    v_mov_b32 v43, 0
    v_mov_b32 v44, 0
    v_mov_b32 v45, 0
    v_mov_b32 v46, 0
    v_mov_b32 v47, 0
    v_mov_b32 v48, 0
    v_mov_b32 v49, 0
    v_mov_b32 v50, 0
    v_mov_b32 v51, 0
    v_mov_b32 v52, 0
    v_mov_b32 v53, 0
    v_mov_b32 v54, 0
    v_mov_b32 v55, 0
    v_permlane32_swap_b32 v56, v60
    v_permlane32_swap_b32 v57, v61
    v_permlane32_swap_b32 v58, v62
    v_permlane32_swap_b32 v59, v63
    v_add_f32 v56, v56, v60
    v_add_f32 v57, v57, v61
    v_add_f32 v58, v58, v62
    v_add_f32 v59, v59, v63
    v_cvt_pk_bf16_f32 v68, v56, v57
    v_cvt_pk_bf16_f32 v69, v58, v59
    v_mov_b32 v60, v64
    v_mov_b32 v61, v65
    v_mov_b32 v62, v66
    v_mov_b32 v63, v67
    v_permlane32_swap_b32 v64, v60
    v_permlane32_swap_b32 v65, v61
    v_permlane32_swap_b32 v66, v62
    v_permlane32_swap_b32 v67, v63
    v_add_f32 v64, v64, v60
    v_add_f32 v65, v65, v61
    v_add_f32 v66, v66, v62
    v_add_f32 v67, v67, v63
    v_cvt_pk_bf16_f32 v70, v64, v65
    v_cvt_pk_bf16_f32 v71, v66, v67
    ds_write_b64 v10, v[68:69]
    ds_write_b64 v9, v[70:71] offset:512
    s_waitcnt lgkmcnt(0)
    s_barrier
    ds_read_b64_tr_b16 v[68:69], v11 offset:0
    ds_read_b64_tr_b16 v[70:71], v11 offset:128
    ds_read_b64_tr_b16 v[72:73], v11 offset:1024
    ds_read_b64_tr_b16 v[74:75], v11 offset:1152
    ds_read_b64_tr_b16 v[76:77], v11 offset:2048
    ds_read_b64_tr_b16 v[78:79], v11 offset:2176
    s_waitcnt lgkmcnt(4)
    v_smfmac_f32_16x16x64_bf16 v[16:19], v[68:71], a[240:247], v4
    v_smfmac_f32_16x16x64_bf16 v[20:23], v[68:71], v[112:119], v4
    v_smfmac_f32_16x16x64_bf16 v[24:27], v[68:71], v[136:143], v4
    v_smfmac_f32_16x16x64_bf16 v[28:31], v[68:71], v[160:167], v4
    s_waitcnt lgkmcnt(2)
    v_smfmac_f32_16x16x64_bf16 v[16:19], v[72:75], a[248:255], v4
    v_smfmac_f32_16x16x64_bf16 v[20:23], v[72:75], v[120:127], v4
    v_smfmac_f32_16x16x64_bf16 v[24:27], v[72:75], v[144:151], v4
    v_smfmac_f32_16x16x64_bf16 v[28:31], v[72:75], v[168:175], v4
    s_waitcnt lgkmcnt(0)
    v_smfmac_f32_16x16x64_bf16 v[16:19], v[76:79], v[104:111], v4
    v_smfmac_f32_16x16x64_bf16 v[20:23], v[76:79], v[128:135], v4
    v_smfmac_f32_16x16x64_bf16 v[24:27], v[76:79], v[152:159], v4
    v_smfmac_f32_16x16x64_bf16 v[28:31], v[76:79], v[176:183], v4
    v_smfmac_f32_16x16x64_bf16 v[32:35], v[68:71], v[184:191], v4
    v_smfmac_f32_16x16x64_bf16 v[36:39], v[68:71], v[208:215], v4
    v_smfmac_f32_16x16x64_bf16 v[40:43], v[68:71], v[232:239], v4
    v_smfmac_f32_16x16x64_bf16 v[44:47], v[68:71], v[80:87], v4
    ds_read_b128 v[80:83], v6 offset:6144
    ds_read_b128 v[84:87], v6 offset:7168
    v_smfmac_f32_16x16x64_bf16 v[32:35], v[72:75], v[192:199], v4
    v_smfmac_f32_16x16x64_bf16 v[36:39], v[72:75], v[216:223], v4
    v_smfmac_f32_16x16x64_bf16 v[40:43], v[72:75], v[240:247], v4
    v_smfmac_f32_16x16x64_bf16 v[44:47], v[72:75], v[88:95], v4
    ds_read_b128 v[88:91], v6 offset:8192
    ds_read_b128 v[92:95], v6 offset:9216
    v_smfmac_f32_16x16x64_bf16 v[32:35], v[76:79], v[200:207], v4
    v_smfmac_f32_16x16x64_bf16 v[36:39], v[76:79], v[224:231], v4
    v_smfmac_f32_16x16x64_bf16 v[40:43], v[76:79], v[248:255], v4
    v_smfmac_f32_16x16x64_bf16 v[44:47], v[76:79], v[96:103], v4
    ds_read_b128 v[96:99], v6 offset:10240
    ds_read_b128 v[100:103], v6 offset:11264
    v_permlane32_swap_b32 v16, v24
    v_permlane32_swap_b32 v17, v25
    v_permlane32_swap_b32 v18, v26
    v_permlane32_swap_b32 v19, v27
    v_add_f32 v16, v16, v24
    v_add_f32 v17, v17, v25
    v_add_f32 v18, v18, v26
    v_add_f32 v19, v19, v27
    v_permlane32_swap_b32 v20, v28
    v_permlane32_swap_b32 v21, v29
    v_permlane32_swap_b32 v22, v30
    v_permlane32_swap_b32 v23, v31
    v_add_f32 v20, v20, v28
    v_add_f32 v21, v21, v29
    v_add_f32 v22, v22, v30
    v_add_f32 v23, v23, v31
    v_cvt_pk_bf16_f32 v56, v16, v17
    v_cvt_pk_bf16_f32 v57, v18, v19
    v_cvt_pk_bf16_f32 v58, v20, v21
    v_cvt_pk_bf16_f32 v59, v22, v23
    s_nop 0
    v_permlane16_swap_b32 v56, v58
    v_permlane16_swap_b32 v57, v59
    v_min_u32 v56, -2, v56
    v_min_u32 v57, -2, v57
    v_min_u32 v58, -2, v58
    v_min_u32 v59, -2, v59
    buffer_store_dwordx4 v[56:59], v14, s[8:11], s43 offen sc1
    s_waitcnt lgkmcnt(4)
    v_smfmac_f32_16x16x64_bf16 v[48:51], v[68:71], v[80:87], v4
    ds_read_b128 v[80:83], v6 offset:12288
    ds_read_b128 v[84:87], v6 offset:13312
    s_waitcnt lgkmcnt(4)
    v_smfmac_f32_16x16x64_bf16 v[48:51], v[72:75], v[88:95], v4
    ds_read_b128 v[88:91], v6 offset:14336
    ds_read_b128 v[92:95], v6 offset:15360
    s_waitcnt lgkmcnt(4)
    v_smfmac_f32_16x16x64_bf16 v[48:51], v[76:79], v[96:103], v4
    ds_read_b128 v[96:99], v6 offset:16384
    ds_read_b128 v[100:103], v6 offset:17408
    v_permlane32_swap_b32 v32, v40
    v_permlane32_swap_b32 v33, v41
    v_permlane32_swap_b32 v34, v42
    v_permlane32_swap_b32 v35, v43
    v_add_f32 v32, v32, v40
    v_add_f32 v33, v33, v41
    v_add_f32 v34, v34, v42
    v_add_f32 v35, v35, v43
    v_permlane32_swap_b32 v36, v44
    v_permlane32_swap_b32 v37, v45
    v_permlane32_swap_b32 v38, v46
    v_permlane32_swap_b32 v39, v47
    v_add_f32 v36, v36, v44
    v_add_f32 v37, v37, v45
    v_add_f32 v38, v38, v46
    v_add_f32 v39, v39, v47
    v_cvt_pk_bf16_f32 v60, v32, v33
    v_cvt_pk_bf16_f32 v61, v34, v35
    v_cvt_pk_bf16_f32 v62, v36, v37
    v_cvt_pk_bf16_f32 v63, v38, v39
    s_nop 0
    v_permlane16_swap_b32 v60, v62
    v_permlane16_swap_b32 v61, v63
    v_min_u32 v60, -2, v60
    v_min_u32 v61, -2, v61
    v_min_u32 v62, -2, v62
    v_min_u32 v63, -2, v63
    s_add_u32 s49, s43, 32768
    buffer_store_dwordx4 v[60:63], v14, s[8:11], s49 offen sc1
    s_waitcnt lgkmcnt(4)
    v_smfmac_f32_16x16x64_bf16 v[52:55], v[68:71], v[80:87], v4
    s_waitcnt lgkmcnt(2)
    v_smfmac_f32_16x16x64_bf16 v[52:55], v[72:75], v[88:95], v4
    s_waitcnt lgkmcnt(0)
    v_smfmac_f32_16x16x64_bf16 v[52:55], v[76:79], v[96:103], v4
    s_nop 11
    v_permlane32_swap_b32 v48, v52
    v_permlane32_swap_b32 v49, v53
    v_permlane32_swap_b32 v50, v54
    v_permlane32_swap_b32 v51, v55
    v_add_f32 v48, v48, v52
    v_add_f32 v49, v49, v53
    v_add_f32 v50, v50, v54
    v_add_f32 v51, v51, v55
    v_cvt_pk_bf16_f32 v64, v48, v49
    v_cvt_pk_bf16_f32 v65, v50, v51
    v_mov_b32 v66, v64
    v_mov_b32 v67, v65
    s_nop 0
    v_permlane16_swap_b32 v64, v66
    v_permlane16_swap_b32 v65, v67
    v_min_u32 v64, -2, v64
    v_min_u32 v65, -2, v65
    v_min_u32 v66, -2, v66
    v_min_u32 v67, -2, v67
    buffer_store_dwordx4 v[64:67], v15, s[8:11], s43 offen sc1
    s_add_u32 s40, s40, 1
    s_add_u32 s43, s43, 458752
    s_add_u32 s47, s47, 458752
    s_add_u32 s45, s45, 458752
    s_cmp_lt_u32 s40, 64
    s_cbranch_scc1 interleave_layers__linear_attn_block__memory_aug_recurrent_mem_tr__prompt_kernel_v_step
    s_cmp_eq_u32 s92, 0
    s_cbranch_scc0 interleave_layers__linear_attn_block__memory_aug_recurrent_mem_tr__prompt_kernel_end
    s_mov_b32 s92, 1
    s_branch interleave_layers__linear_attn_block__memory_aug_recurrent_mem_tr__prompt_kernel_v_layer
interleave_layers__linear_attn_block__memory_aug_recurrent_mem_tr__prompt_kernel_roleR:
    s_sub_u32 s44, s2, 64
    v_lshlrev_b32 v5, 4, v1
    s_lshl_b32 s24, s44, 15
    s_lshl_b32 s25, s3, 13
    s_add_u32 s24, s24, s25
    v_add_u32 v6, s24, v5
    v_add_u32 v7, 4096, v6
    s_lshl_b32 s24, s3, 12
    v_add_u32 v8, s24, v5
    s_lshl_b32 s24, s3, 10
    s_add_u32 s24, s24, 16384
    v_add_u32 v9, s24, v5
    s_lshl_b32 s24, s44, 13
    s_lshl_b32 s25, s3, 11
    s_add_u32 s24, s24, s25
    v_add_u32 v10, s24, v5
    v_and_b32 v204, 7, v2
    v_mul_u32_u24 v11, 80, v204
    v_lshl_add_u32 v11, v3, 4, v11
    s_mul_i32 s24, s3, 640
    v_add_u32 v11, s24, v11
    v_add_u32 v204, 8192, v5
    v_cmp_gt_u32 vcc, 8, v2
    s_nop 1
    v_cndmask_b32 v11, v204, v11, vcc
    v_and_b32 v204, 7, v2
    v_mul_u32_u24 v12, 80, v204
    v_lshrrev_b32 v204, 3, v2
    v_lshl_add_u32 v12, v204, 5, v12
    v_lshlrev_b32 v13, 4, v2
    s_lshl_b32 s24, s44, 8
    v_add_u32 v13, s24, v13
    v_mov_b32 v204, 2146435072
    v_cmp_gt_u32 vcc, 1, v3
    s_nop 1
    v_cndmask_b32 v13, v204, v13, vcc
    v_cmp_le_u32 s[50:51], 8, v2
    s_and_b32 s25, s44, 15
    s_lshr_b32 s25, s25, 2
    s_sub_u32 s26, s44, 32
    s_lshr_b32 s26, s26, 1
    s_cmp_ge_u32 s44, 32
    s_cselect_b32 s25, s26, s25
    s_mul_i32 s24, s25, 16
    v_add_u32 v120, s24, v1
    v_lshlrev_b32 v120, 7, v120
    v_mov_b32 v204, 2146435072
    v_cmp_le_u32 vcc, 16, v1
    s_nop 1
    v_cndmask_b32 v120, v120, v204, vcc
    s_and_b32 s24, s44, 7
    s_mul_i32 s25, s3, 8
    s_add_u32 s24, s24, s25
    s_lshl_b32 s24, s24, 7
    v_mov_b32 v125, s24
    v_mov_b32 v122, 12288
    v_mov_b32 v123, 0
    s_barrier
    ds_write_b32 v122, v123
    v_mov_b32 v123, 1
    s_waitcnt lgkmcnt(0)
    s_barrier
interleave_layers__linear_attn_block__memory_aug_recurrent_mem_tr__prompt_kernel_r_layer:
    s_mul_i32 s93, s92, 29360128
    s_add_u32 s93, s93, 117440512
    s_mul_i32 s94, s92, 16384
    s_add_u32 s94, s94, 23068672
    s_mov_b32 s40, 0
    s_mov_b32 s41, 184549376
    s_add_u32 s45, s93, 448512
    s_add_u32 s46, s93, 440320
    s_add_u32 s43, s93, 409600
    s_add_u32 s42, s93, 0
    s_add_u32 s47, s93, 430080
    v_and_b32 v252, 7, v1
    v_lshlrev_b32 v252, 7, v252
    s_lshl_b32 s24, s3, 10
    s_add_u32 s24, s24, 12288
    s_add_u32 s24, s24, s94
    v_add_u32 v252, s24, v252
    s_mov_b32 s62, -1
    s_mov_b32 s63, 1
    s_cmp_ge_i32 s62, s63
    s_cbranch_scc1 interleave_layers__linear_attn_block__memory_aug_recurrent_mem_tr__prompt_kernel_r_en0_ok
    s_mov_b32 s61, 0
interleave_layers__linear_attn_block__memory_aug_recurrent_mem_tr__prompt_kernel_r_en0:
    buffer_load_dword v253, v252, s[8:11], 0 offen sc1
    s_waitcnt vmcnt(0)
    v_readlane_b32 s62, v253, 0
    v_readlane_b32 s24, v253, 1
    s_min_i32 s62, s62, s24
    v_readlane_b32 s24, v253, 2
    s_min_i32 s62, s62, s24
    v_readlane_b32 s24, v253, 3
    s_min_i32 s62, s62, s24
    v_readlane_b32 s24, v253, 4
    s_min_i32 s62, s62, s24
    v_readlane_b32 s24, v253, 5
    s_min_i32 s62, s62, s24
    v_readlane_b32 s24, v253, 6
    s_min_i32 s62, s62, s24
    v_readlane_b32 s24, v253, 7
    s_min_i32 s62, s62, s24
    s_cmp_ge_i32 s62, s63
    s_cbranch_scc1 interleave_layers__linear_attn_block__memory_aug_recurrent_mem_tr__prompt_kernel_r_en0_ok
    s_add_u32 s61, s61, 1
    s_cmp_ge_u32 s61, s60
    s_cbranch_scc1 interleave_layers__linear_attn_block__memory_aug_recurrent_mem_tr__prompt_kernel_r_en0_to
    s_sleep 2
    s_branch interleave_layers__linear_attn_block__memory_aug_recurrent_mem_tr__prompt_kernel_r_en0
interleave_layers__linear_attn_block__memory_aug_recurrent_mem_tr__prompt_kernel_r_en0_to:
    s_mov_b32 s60, 1
interleave_layers__linear_attn_block__memory_aug_recurrent_mem_tr__prompt_kernel_r_en0_ok:
    buffer_load_dwordx4 v[48:51], v6, s[8:11], s41 offen offset:0 sc1
    buffer_load_dwordx4 v[52:55], v6, s[8:11], s41 offen offset:1024 sc1
    buffer_load_dwordx4 v[56:59], v6, s[8:11], s41 offen offset:2048 sc1
    buffer_load_dwordx4 v[60:63], v6, s[8:11], s41 offen offset:3072 sc1
    buffer_load_dwordx4 v[64:67], v7, s[8:11], s41 offen offset:0 sc1
    buffer_load_dwordx4 v[68:71], v7, s[8:11], s41 offen offset:1024 sc1
    buffer_load_dwordx4 v[72:75], v7, s[8:11], s41 offen offset:2048 sc1
    buffer_load_dwordx4 v[76:79], v7, s[8:11], s41 offen offset:3072 sc1
    s_add_u32 s41, s41, 1310720
interleave_layers__linear_attn_block__memory_aug_recurrent_mem_tr__prompt_kernel_r_step:
    s_waitcnt vmcnt(0)
    v_mov_b32 v16, v48
    v_mov_b32 v17, v49
    v_mov_b32 v18, v50
    v_mov_b32 v19, v51
    v_mov_b32 v20, v52
    v_mov_b32 v21, v53
    v_mov_b32 v22, v54
    v_mov_b32 v23, v55
    v_mov_b32 v24, v56
    v_mov_b32 v25, v57
    v_mov_b32 v26, v58
    v_mov_b32 v27, v59
    v_mov_b32 v28, v60
    v_mov_b32 v29, v61
    v_mov_b32 v30, v62
    v_mov_b32 v31, v63
    v_mov_b32 v32, v64
    v_mov_b32 v33, v65
    v_mov_b32 v34, v66
    v_mov_b32 v35, v67
    v_mov_b32 v36, v68
    v_mov_b32 v37, v69
    v_mov_b32 v38, v70
    v_mov_b32 v39, v71
    v_mov_b32 v40, v72
    v_mov_b32 v41, v73
    v_mov_b32 v42, v74
    v_mov_b32 v43, v75
    v_mov_b32 v44, v76
    v_mov_b32 v45, v77
    v_mov_b32 v46, v78
    v_mov_b32 v47, v79
    s_lshl_b32 s95, s92, 6
    s_add_u32 s95, s95, s40
    s_add_u32 s95, s95, 1
    s_cmp_ge_i32 s59, s95
    s_cbranch_scc1 interleave_layers__linear_attn_block__memory_aug_recurrent_mem_tr__prompt_kernel_r_ec_ok
    s_and_b32 s24, s2, 7
    s_lshl_b32 s24, s24, 7
    s_add_u32 s24, s24, 23109632
    v_and_b32 v254, 3, v1
    v_lshl_add_u32 v254, v254, 2, s24
    s_mov_b32 s61, 0
interleave_layers__linear_attn_block__memory_aug_recurrent_mem_tr__prompt_kernel_r_ec:
    buffer_load_dword v253, v254, s[8:11], 0 offen sc1
    s_waitcnt vmcnt(0)
    v_readlane_b32 s59, v253, 0
    v_readlane_b32 s24, v253, 1
    s_min_i32 s59, s59, s24
    v_readlane_b32 s24, v253, 2
    s_min_i32 s59, s59, s24
    v_readlane_b32 s24, v253, 3
    s_min_i32 s59, s59, s24
    s_cmp_ge_i32 s59, s95
    s_cbranch_scc1 interleave_layers__linear_attn_block__memory_aug_recurrent_mem_tr__prompt_kernel_r_ec_ok
    s_add_u32 s61, s61, 1
    s_cmp_ge_u32 s61, s60
    s_cbranch_scc1 interleave_layers__linear_attn_block__memory_aug_recurrent_mem_tr__prompt_kernel_r_ec_to
    s_sleep 2
    s_branch interleave_layers__linear_attn_block__memory_aug_recurrent_mem_tr__prompt_kernel_r_ec
interleave_layers__linear_attn_block__memory_aug_recurrent_mem_tr__prompt_kernel_r_ec_to:
    s_mov_b32 s60, 1
interleave_layers__linear_attn_block__memory_aug_recurrent_mem_tr__prompt_kernel_r_ec_ok:
    s_sleep 10
    s_mov_b64 exec, 1
    s_mov_b32 s61, 0
    v_mov_b32 v117, 0
    buffer_atomic_add v117, v125, s[8:11], s45 offen sc0
    s_sleep 2
    v_mov_b32 v118, 0
    buffer_atomic_add v118, v125, s[8:11], s45 offen sc0
    s_sleep 2
    v_mov_b32 v119, 0
    buffer_atomic_add v119, v125, s[8:11], s45 offen sc0
    s_sleep 2
interleave_layers__linear_attn_block__memory_aug_recurrent_mem_tr__prompt_kernel_r_pr:
    v_mov_b32 v116, 0
    buffer_atomic_add v116, v125, s[8:11], s45 offen sc0
    s_waitcnt vmcnt(3)
    v_cmp_le_i32 vcc, 7, v117
    s_add_u32 s61, s61, 1
    s_cbranch_vccnz interleave_layers__linear_attn_block__memory_aug_recurrent_mem_tr__prompt_kernel_r_pr_out
    s_sleep 2
    v_mov_b32 v117, 0
    buffer_atomic_add v117, v125, s[8:11], s45 offen sc0
    s_waitcnt vmcnt(3)
    v_cmp_le_i32 vcc, 7, v118
    s_add_u32 s61, s61, 1
    s_cbranch_vccnz interleave_layers__linear_attn_block__memory_aug_recurrent_mem_tr__prompt_kernel_r_pr_out
    s_sleep 2
    v_mov_b32 v118, 0
    buffer_atomic_add v118, v125, s[8:11], s45 offen sc0
    s_waitcnt vmcnt(3)
    v_cmp_le_i32 vcc, 7, v119
    s_add_u32 s61, s61, 1
    s_cbranch_vccnz interleave_layers__linear_attn_block__memory_aug_recurrent_mem_tr__prompt_kernel_r_pr_out
    s_sleep 2
    v_mov_b32 v119, 0
    buffer_atomic_add v119, v125, s[8:11], s45 offen sc0
    s_waitcnt vmcnt(3)
    v_cmp_le_i32 vcc, 7, v116
    s_add_u32 s61, s61, 1
    s_cbranch_vccnz interleave_layers__linear_attn_block__memory_aug_recurrent_mem_tr__prompt_kernel_r_pr_out
    s_sleep 2
    s_cmp_ge_u32 s61, s60
    s_cbranch_scc0 interleave_layers__linear_attn_block__memory_aug_recurrent_mem_tr__prompt_kernel_r_pr
    s_mov_b32 s60, 1
interleave_layers__linear_attn_block__memory_aug_recurrent_mem_tr__prompt_kernel_r_pr_out:
    s_mov_b64 exec, -1
    buffer_load_dwordx4 v[100:103], v10, s[8:11], s42 offen offset:0 sc1
    buffer_load_dwordx4 v[104:107], v10, s[8:11], s42 offen offset:1024 sc1
    buffer_load_dwordx4 v[80:83], v8, s[8:11], s43 offen offset:0 sc1
    buffer_load_dwordx4 v[84:87], v8, s[8:11], s43 offen offset:1024 sc1
    buffer_load_dwordx4 v[88:91], v8, s[8:11], s43 offen offset:2048 sc1
    buffer_load_dwordx4 v[92:95], v8, s[8:11], s43 offen offset:3072 sc1
    buffer_load_dwordx4 v[96:99], v9, s[8:11], s43 offen sc1
    s_waitcnt vmcnt(0)
    v_max3_u32 v204, v80, v81, v82
    v_max3_u32 v204, v204, v83, v84
    v_max3_u32 v204, v204, v85, v86
    v_max3_u32 v204, v204, v87, v88
    v_max3_u32 v204, v204, v89, v90
    v_max3_u32 v204, v204, v91, v92
    v_max3_u32 v204, v204, v93, v94
    v_max3_u32 v204, v204, v95, v96
    v_max3_u32 v204, v204, v97, v98
    v_max3_u32 v204, v204, v99, v100
    v_max3_u32 v204, v204, v101, v102
    v_max3_u32 v204, v204, v103, v104
    v_max3_u32 v204, v204, v105, v106
    v_max_u32 v204, v204, v107
    v_cmp_eq_u32 vcc, -1, v204
    s_cbranch_vccz interleave_layers__linear_attn_block__memory_aug_recurrent_mem_tr__prompt_kernel_r_p_out
    s_mov_b32 s61, 0
interleave_layers__linear_attn_block__memory_aug_recurrent_mem_tr__prompt_kernel_r_p:
    buffer_load_dwordx4 v[100:103], v10, s[8:11], s42 offen offset:0 sc1
    buffer_load_dwordx4 v[104:107], v10, s[8:11], s42 offen offset:1024 sc1
    buffer_load_dwordx4 v[80:83], v8, s[8:11], s43 offen offset:0 sc1
    buffer_load_dwordx4 v[84:87], v8, s[8:11], s43 offen offset:1024 sc1
    buffer_load_dwordx4 v[88:91], v8, s[8:11], s43 offen offset:2048 sc1
    buffer_load_dwordx4 v[92:95], v8, s[8:11], s43 offen offset:3072 sc1
    buffer_load_dwordx4 v[96:99], v9, s[8:11], s43 offen sc1
    s_waitcnt vmcnt(0)
    v_max3_u32 v204, v80, v81, v82
    v_max3_u32 v204, v204, v83, v84
    v_max3_u32 v204, v204, v85, v86
    v_max3_u32 v204, v204, v87, v88
    v_max3_u32 v204, v204, v89, v90
    v_max3_u32 v204, v204, v91, v92
    v_max3_u32 v204, v204, v93, v94
    v_max3_u32 v204, v204, v95, v96
    v_max3_u32 v204, v204, v97, v98
    v_max3_u32 v204, v204, v99, v100
    v_max3_u32 v204, v204, v101, v102
    v_max3_u32 v204, v204, v103, v104
    v_max3_u32 v204, v204, v105, v106
    v_max_u32 v204, v204, v107
    v_cmp_eq_u32 vcc, -1, v204
    s_add_u32 s61, s61, 1
    s_cbranch_vccz interleave_layers__linear_attn_block__memory_aug_recurrent_mem_tr__prompt_kernel_r_p_out
    s_cmp_ge_u32 s61, s60
    s_cbranch_scc1 interleave_layers__linear_attn_block__memory_aug_recurrent_mem_tr__prompt_kernel_r_p_to
    s_sleep 1
    s_branch interleave_layers__linear_attn_block__memory_aug_recurrent_mem_tr__prompt_kernel_r_p
interleave_layers__linear_attn_block__memory_aug_recurrent_mem_tr__prompt_kernel_r_p_to:
    s_mov_b32 s60, 1
interleave_layers__linear_attn_block__memory_aug_recurrent_mem_tr__prompt_kernel_r_p_out:
    s_mov_b64 exec, 1
    ds_add_rtn_u32 v124, v122, v123
    s_mov_b64 exec, -1
    v_mfma_f32_16x16x32_bf16 v[108:111], v[100:103], v[96:99], 0
    v_mfma_f32_16x16x32_bf16 v[112:115], v[104:107], v[96:99], 0
    v_mfma_f32_16x16x32_bf16 v[108:111], v[16:19], v[80:83], v[108:111]
    v_mfma_f32_16x16x32_bf16 v[112:115], v[20:23], v[80:83], v[112:115]
    s_waitcnt lgkmcnt(0)
    v_readfirstlane_b32 s24, v124
    s_and_b32 s24, s24, 3
    s_cmp_eq_u32 s24, 3
    s_cbranch_scc0 interleave_layers__linear_attn_block__memory_aug_recurrent_mem_tr__prompt_kernel_nh26
    buffer_atomic_add v123, v120, s[8:11], s46 offen
interleave_layers__linear_attn_block__memory_aug_recurrent_mem_tr__prompt_kernel_nh26:
    v_mfma_f32_16x16x32_bf16 v[108:111], v[24:27], v[84:87], v[108:111]
    v_mfma_f32_16x16x32_bf16 v[112:115], v[28:31], v[84:87], v[112:115]
    v_mfma_f32_16x16x32_bf16 v[108:111], v[32:35], v[88:91], v[108:111]
    v_mfma_f32_16x16x32_bf16 v[112:115], v[36:39], v[88:91], v[112:115]
    v_mfma_f32_16x16x32_bf16 v[108:111], v[40:43], v[92:95], v[108:111]
    v_mfma_f32_16x16x32_bf16 v[112:115], v[44:47], v[92:95], v[112:115]
    s_and_b32 s24, s40, 1
    s_mul_i32 s24, s24, 2560
    v_add_u32 v14, s24, v11
    v_add_u32 v15, s24, v12
    s_nop 3
    v_cndmask_b32 v108, v108, v112, s[50:51]
    v_cndmask_b32 v109, v109, v113, s[50:51]
    v_cndmask_b32 v110, v110, v114, s[50:51]
    v_cndmask_b32 v111, v111, v115, s[50:51]
    v_add_f32 v108, v108, v108 row_ror:8 row_mask:0xf bank_mask:0xf
    v_add_f32 v109, v109, v109 row_ror:8 row_mask:0xf bank_mask:0xf
    v_add_f32 v110, v110, v110 row_ror:8 row_mask:0xf bank_mask:0xf
    v_add_f32 v111, v111, v111 row_ror:8 row_mask:0xf bank_mask:0xf
    ds_write_b128 v14, v[108:111]
    s_waitcnt lgkmcnt(0)
    s_barrier
    s_cmp_eq_u32 s3, 0
    s_cbranch_scc0 interleave_layers__linear_attn_block__memory_aug_recurrent_mem_tr__prompt_kernel_np27
    ds_read_b128 v[220:223], v15 offset:0
    ds_read_b128 v[224:227], v15 offset:16
    ds_read_b128 v[228:231], v15 offset:640
    ds_read_b128 v[232:235], v15 offset:656
    ds_read_b128 v[236:239], v15 offset:1280
    ds_read_b128 v[240:243], v15 offset:1296
    ds_read_b128 v[244:247], v15 offset:1920
    ds_read_b128 v[248:251], v15 offset:1936
    s_waitcnt lgkmcnt(4)
    v_pk_add_f32 v[220:221], v[220:221], v[228:229]
    v_pk_add_f32 v[222:223], v[222:223], v[230:231]
    v_pk_add_f32 v[224:225], v[224:225], v[232:233]
    v_pk_add_f32 v[226:227], v[226:227], v[234:235]
    s_waitcnt lgkmcnt(0)
    v_pk_add_f32 v[236:237], v[236:237], v[244:245]
    v_pk_add_f32 v[238:239], v[238:239], v[246:247]
    v_pk_add_f32 v[240:241], v[240:241], v[248:249]
    v_pk_add_f32 v[242:243], v[242:243], v[250:251]
    v_pk_add_f32 v[220:221], v[220:221], v[236:237]
    v_pk_add_f32 v[222:223], v[222:223], v[238:239]
    v_pk_add_f32 v[224:225], v[224:225], v[240:241]
    v_pk_add_f32 v[226:227], v[226:227], v[242:243]
    v_cvt_pk_bf16_f32 v228, v220, v221
    v_cvt_pk_bf16_f32 v229, v222, v223
    v_cvt_pk_bf16_f32 v230, v224, v225
    v_cvt_pk_bf16_f32 v231, v226, v227
    v_min_u32 v228, -2, v228
    v_min_u32 v229, -2, v229
    v_min_u32 v230, -2, v230
    v_min_u32 v231, -2, v231
    buffer_store_dwordx4 v[228:231], v13, s[8:11], s47 offen sc1
interleave_layers__linear_attn_block__memory_aug_recurrent_mem_tr__prompt_kernel_np27:
    s_add_u32 s63, s40, 2
    s_min_u32 s63, s63, 64
    s_sleep 20
    s_cmp_ge_i32 s62, s63
    s_cbranch_scc1 interleave_layers__linear_attn_block__memory_aug_recurrent_mem_tr__prompt_kernel_r_en_ok
    s_mov_b32 s61, 0
interleave_layers__linear_attn_block__memory_aug_recurrent_mem_tr__prompt_kernel_r_en:
    buffer_load_dword v253, v252, s[8:11], 0 offen sc1
    s_waitcnt vmcnt(0)
    v_readlane_b32 s62, v253, 0
    v_readlane_b32 s24, v253, 1
    s_min_i32 s62, s62, s24
    v_readlane_b32 s24, v253, 2
    s_min_i32 s62, s62, s24
    v_readlane_b32 s24, v253, 3
    s_min_i32 s62, s62, s24
    v_readlane_b32 s24, v253, 4
    s_min_i32 s62, s62, s24
    v_readlane_b32 s24, v253, 5
    s_min_i32 s62, s62, s24
    v_readlane_b32 s24, v253, 6
    s_min_i32 s62, s62, s24
    v_readlane_b32 s24, v253, 7
    s_min_i32 s62, s62, s24
    s_cmp_ge_i32 s62, s63
    s_cbranch_scc1 interleave_layers__linear_attn_block__memory_aug_recurrent_mem_tr__prompt_kernel_r_en_ok
    s_add_u32 s61, s61, 1
    s_cmp_ge_u32 s61, s60
    s_cbranch_scc1 interleave_layers__linear_attn_block__memory_aug_recurrent_mem_tr__prompt_kernel_r_en_to
    s_sleep 2
    s_branch interleave_layers__linear_attn_block__memory_aug_recurrent_mem_tr__prompt_kernel_r_en
interleave_layers__linear_attn_block__memory_aug_recurrent_mem_tr__prompt_kernel_r_en_to:
    s_mov_b32 s60, 1
interleave_layers__linear_attn_block__memory_aug_recurrent_mem_tr__prompt_kernel_r_en_ok:
    buffer_load_dwordx4 v[48:51], v6, s[8:11], s41 offen offset:0 sc1
    buffer_load_dwordx4 v[52:55], v6, s[8:11], s41 offen offset:1024 sc1
    buffer_load_dwordx4 v[56:59], v6, s[8:11], s41 offen offset:2048 sc1
    buffer_load_dwordx4 v[60:63], v6, s[8:11], s41 offen offset:3072 sc1
    buffer_load_dwordx4 v[64:67], v7, s[8:11], s41 offen offset:0 sc1
    buffer_load_dwordx4 v[68:71], v7, s[8:11], s41 offen offset:1024 sc1
    buffer_load_dwordx4 v[72:75], v7, s[8:11], s41 offen offset:2048 sc1
    buffer_load_dwordx4 v[76:79], v7, s[8:11], s41 offen offset:3072 sc1
    s_add_u32 s41, s41, 1310720
    s_add_u32 s40, s40, 1
    s_add_u32 s42, s42, 458752
    s_add_u32 s43, s43, 458752
    s_add_u32 s47, s47, 458752
    s_add_u32 s45, s45, 458752
    s_add_u32 s46, s46, 458752
    s_cmp_lt_u32 s40, 64
    s_cbranch_scc1 interleave_layers__linear_attn_block__memory_aug_recurrent_mem_tr__prompt_kernel_r_step
    s_waitcnt vmcnt(0)
    s_cmp_eq_u32 s92, 0
    s_cbranch_scc0 interleave_layers__linear_attn_block__memory_aug_recurrent_mem_tr__prompt_kernel_end
    s_mov_b32 s92, 1
    s_branch interleave_layers__linear_attn_block__memory_aug_recurrent_mem_tr__prompt_kernel_r_layer
interleave_layers__linear_attn_block__memory_aug_recurrent_mem_tr__prompt_kernel_roleP:
    s_sub_u32 s44, s2, 104
    s_lshr_b32 s46, s44, 5
    s_and_b32 s44, s44, 31
    s_load_dwordx2 s[6:7], s[0:1], 40
    s_load_dwordx2 s[24:25], s[0:1], 48
    s_load_dwordx2 s[26:27], s[0:1], 56
    s_waitcnt lgkmcnt(0)
    s_cmp_eq_u32 s46, 1
    s_cselect_b32 s6, s24, s6
    s_cselect_b32 s7, s25, s7
    s_cmp_eq_u32 s46, 2
    s_cselect_b32 s6, s26, s6
    s_cselect_b32 s7, s27, s7
    s_mov_b32 s12, s6
    s_mov_b32 s13, s7
    s_mov_b32 s14, 7864320
    s_mov_b32 s15, 0x00020000
    v_add_u32 v16, 0, v0
    s_mov_b32 s24, 683
    v_mul_lo_u32 v17, v16, s24
    v_lshrrev_b32 v17, 14, v17
    v_mul_u32_u24 v18, 24, v17
    v_sub_u32 v18, v16, v18
    s_mov_b32 s24, 12288
    v_mul_lo_u32 v4, v17, s24
    v_lshl_add_u32 v4, v18, 4, v4
    v_mul_u32_u24 v10, 400, v17
    v_lshl_add_u32 v10, v18, 4, v10
    v_add_u32 v10, 81920, v10
    v_add_u32 v16, 256, v0
    s_mov_b32 s24, 683
    v_mul_lo_u32 v17, v16, s24
    v_lshrrev_b32 v17, 14, v17
    v_mul_u32_u24 v18, 24, v17
    v_sub_u32 v18, v16, v18
    s_mov_b32 s24, 12288
    v_mul_lo_u32 v5, v17, s24
    v_lshl_add_u32 v5, v18, 4, v5
    v_mul_u32_u24 v11, 400, v17
    v_lshl_add_u32 v11, v18, 4, v11
    v_add_u32 v11, 81920, v11
    v_add_u32 v16, 512, v0
    s_mov_b32 s24, 683
    v_mul_lo_u32 v17, v16, s24
    v_lshrrev_b32 v17, 14, v17
    v_mul_u32_u24 v18, 24, v17
    v_sub_u32 v18, v16, v18
    s_mov_b32 s24, 12288
    v_mul_lo_u32 v6, v17, s24
    v_lshl_add_u32 v6, v18, 4, v6
    v_mul_u32_u24 v12, 400, v17
    v_lshl_add_u32 v12, v18, 4, v12
    v_add_u32 v12, 81920, v12
    v_add_u32 v16, 768, v0
    s_mov_b32 s24, 683
    v_mul_lo_u32 v17, v16, s24
    v_lshrrev_b32 v17, 14, v17
    v_mul_u32_u24 v18, 24, v17
    v_sub_u32 v18, v16, v18
    s_mov_b32 s24, 12288
    v_mul_lo_u32 v7, v17, s24
    v_lshl_add_u32 v7, v18, 4, v7
    v_mul_u32_u24 v13, 400, v17
    v_lshl_add_u32 v13, v18, 4, v13
    v_add_u32 v13, 81920, v13
    v_add_u32 v16, 1024, v0
    s_mov_b32 s24, 683
    v_mul_lo_u32 v17, v16, s24
    v_lshrrev_b32 v17, 14, v17
    v_mul_u32_u24 v18, 24, v17
    v_sub_u32 v18, v16, v18
    s_mov_b32 s24, 12288
    v_mul_lo_u32 v8, v17, s24
    v_lshl_add_u32 v8, v18, 4, v8
    v_mul_u32_u24 v14, 400, v17
    v_lshl_add_u32 v14, v18, 4, v14
    v_add_u32 v14, 81920, v14
    v_add_u32 v16, 1280, v0
    s_mov_b32 s24, 683
    v_mul_lo_u32 v17, v16, s24
    v_lshrrev_b32 v17, 14, v17
    v_mul_u32_u24 v18, 24, v17
    v_sub_u32 v18, v16, v18
    s_mov_b32 s24, 12288
    v_mul_lo_u32 v9, v17, s24
    v_lshl_add_u32 v9, v18, 4, v9
    v_mul_u32_u24 v15, 400, v17
    v_lshl_add_u32 v15, v18, 4, v15
    v_add_u32 v15, 81920, v15
    v_lshrrev_b32 v16, 2, v2
    v_lshl_add_u32 v16, v3, 2, v16
    v_mul_u32_u24 v32, 400, v16
    v_and_b32 v16, 3, v2
    v_lshl_add_u32 v32, v16, 3, v32
    s_mul_i32 s24, s3, 96
    s_add_u32 s24, s24, 81920
    v_add_u32 v32, s24, v32
    s_mul_i32 s45, s44, 384
    s_add_u32 s47, s45, 0
    buffer_load_dwordx4 v[56:59], v4, s[12:15], s47 offen
    buffer_load_dwordx4 v[60:63], v5, s[12:15], s47 offen
    buffer_load_dwordx4 v[64:67], v6, s[12:15], s47 offen
    buffer_load_dwordx4 v[68:71], v7, s[12:15], s47 offen
    buffer_load_dwordx4 v[72:75], v8, s[12:15], s47 offen
    buffer_load_dwordx4 v[76:79], v9, s[12:15], s47 offen
    s_add_u32 s47, s45, 786432
    buffer_load_dwordx4 v[80:83], v4, s[12:15], s47 offen
    buffer_load_dwordx4 v[84:87], v5, s[12:15], s47 offen
    buffer_load_dwordx4 v[88:91], v6, s[12:15], s47 offen
    buffer_load_dwordx4 v[92:95], v7, s[12:15], s47 offen
    buffer_load_dwordx4 v[96:99], v8, s[12:15], s47 offen
    buffer_load_dwordx4 v[100:103], v9, s[12:15], s47 offen
    s_add_u32 s47, s45, 1572864
    buffer_load_dwordx4 v[104:107], v4, s[12:15], s47 offen
    buffer_load_dwordx4 v[108:111], v5, s[12:15], s47 offen
    buffer_load_dwordx4 v[112:115], v6, s[12:15], s47 offen
    buffer_load_dwordx4 v[116:119], v7, s[12:15], s47 offen
    buffer_load_dwordx4 v[120:123], v8, s[12:15], s47 offen
    buffer_load_dwordx4 v[124:127], v9, s[12:15], s47 offen
    s_add_u32 s47, s45, 2359296
    buffer_load_dwordx4 v[128:131], v4, s[12:15], s47 offen
    buffer_load_dwordx4 v[132:135], v5, s[12:15], s47 offen
    buffer_load_dwordx4 v[136:139], v6, s[12:15], s47 offen
    buffer_load_dwordx4 v[140:143], v7, s[12:15], s47 offen
    buffer_load_dwordx4 v[144:147], v8, s[12:15], s47 offen
    buffer_load_dwordx4 v[148:151], v9, s[12:15], s47 offen
    s_add_u32 s47, s45, 3145728
    buffer_load_dwordx4 v[152:155], v4, s[12:15], s47 offen
    buffer_load_dwordx4 v[156:159], v5, s[12:15], s47 offen
    buffer_load_dwordx4 v[160:163], v6, s[12:15], s47 offen
    buffer_load_dwordx4 v[164:167], v7, s[12:15], s47 offen
    buffer_load_dwordx4 v[168:171], v8, s[12:15], s47 offen
    buffer_load_dwordx4 v[172:175], v9, s[12:15], s47 offen
    s_add_u32 s47, s45, 3932160
    buffer_load_dwordx4 v[176:179], v4, s[12:15], s47 offen
    buffer_load_dwordx4 v[180:183], v5, s[12:15], s47 offen
    buffer_load_dwordx4 v[184:187], v6, s[12:15], s47 offen
    buffer_load_dwordx4 v[188:191], v7, s[12:15], s47 offen
    buffer_load_dwordx4 v[192:195], v8, s[12:15], s47 offen
    buffer_load_dwordx4 v[196:199], v9, s[12:15], s47 offen
    s_add_u32 s47, s45, 4718592
    buffer_load_dwordx4 v[200:203], v4, s[12:15], s47 offen
    buffer_load_dwordx4 v[204:207], v5, s[12:15], s47 offen
    buffer_load_dwordx4 v[208:211], v6, s[12:15], s47 offen
    buffer_load_dwordx4 v[212:215], v7, s[12:15], s47 offen
    buffer_load_dwordx4 v[216:219], v8, s[12:15], s47 offen
    buffer_load_dwordx4 v[220:223], v9, s[12:15], s47 offen
    s_add_u32 s47, s45, 5505024
    buffer_load_dwordx4 v[224:227], v4, s[12:15], s47 offen
    buffer_load_dwordx4 v[228:231], v5, s[12:15], s47 offen
    buffer_load_dwordx4 v[232:235], v6, s[12:15], s47 offen
    buffer_load_dwordx4 v[236:239], v7, s[12:15], s47 offen
    buffer_load_dwordx4 v[240:243], v8, s[12:15], s47 offen
    buffer_load_dwordx4 v[244:247], v9, s[12:15], s47 offen
    v_mov_b32 v28, 0x3f803f80
    v_mov_b32 v29, 0x3f803f80
    v_mov_b32 v30, 0x3f803f80
    v_mov_b32 v31, 0x3f803f80
    s_waitcnt vmcnt(42)
    ds_write_b128 v10, v[56:59] offset:0
    ds_write_b128 v11, v[60:63] offset:0
    ds_write_b128 v12, v[64:67] offset:0
    ds_write_b128 v13, v[68:71] offset:0
    ds_write_b128 v14, v[72:75] offset:0
    ds_write_b128 v15, v[76:79] offset:0
    s_waitcnt lgkmcnt(0)
    s_add_u32 s47, s45, 6291456
    buffer_load_dwordx4 v[56:59], v4, s[12:15], s47 offen
    buffer_load_dwordx4 v[60:63], v5, s[12:15], s47 offen
    buffer_load_dwordx4 v[64:67], v6, s[12:15], s47 offen
    buffer_load_dwordx4 v[68:71], v7, s[12:15], s47 offen
    buffer_load_dwordx4 v[72:75], v8, s[12:15], s47 offen
    buffer_load_dwordx4 v[76:79], v9, s[12:15], s47 offen
    s_barrier
    ds_read_b64_tr_b16 a[0:1], v32 offset:0
    ds_read_b64_tr_b16 a[2:3], v32 offset:6400
    ds_read_b64_tr_b16 a[4:5], v32 offset:12800
    ds_read_b64_tr_b16 a[6:7], v32 offset:19200
    ds_read_b64_tr_b16 a[80:81], v32 offset:32
    ds_read_b64_tr_b16 a[82:83], v32 offset:6432
    ds_read_b64_tr_b16 a[84:85], v32 offset:12832
    ds_read_b64_tr_b16 a[86:87], v32 offset:19232
    ds_read_b64_tr_b16 a[160:161], v32 offset:64
    ds_read_b64_tr_b16 a[162:163], v32 offset:6464
    ds_read_b64_tr_b16 a[164:165], v32 offset:12864
    ds_read_b64_tr_b16 a[166:167], v32 offset:19264
    s_waitcnt vmcnt(42)
    ds_write_b128 v10, v[80:83] offset:25600
    ds_write_b128 v11, v[84:87] offset:25600
    ds_write_b128 v12, v[88:91] offset:25600
    ds_write_b128 v13, v[92:95] offset:25600
    ds_write_b128 v14, v[96:99] offset:25600
    ds_write_b128 v15, v[100:103] offset:25600
    s_waitcnt lgkmcnt(0)
    s_add_u32 s47, s45, 7077888
    buffer_load_dwordx4 v[80:83], v4, s[12:15], s47 offen
    buffer_load_dwordx4 v[84:87], v5, s[12:15], s47 offen
    buffer_load_dwordx4 v[88:91], v6, s[12:15], s47 offen
    buffer_load_dwordx4 v[92:95], v7, s[12:15], s47 offen
    buffer_load_dwordx4 v[96:99], v8, s[12:15], s47 offen
    buffer_load_dwordx4 v[100:103], v9, s[12:15], s47 offen
    v_mfma_f32_16x16x32_bf16 v[16:19], a[0:3], v[28:31], 0
    v_mfma_f32_16x16x32_bf16 v[20:23], a[80:83], v[28:31], 0
    v_mfma_f32_16x16x32_bf16 v[24:27], a[160:163], v[28:31], 0
    v_mfma_f32_16x16x32_bf16 v[16:19], a[4:7], v[28:31], v[16:19]
    v_mfma_f32_16x16x32_bf16 v[20:23], a[84:87], v[28:31], v[20:23]
    v_mfma_f32_16x16x32_bf16 v[24:27], a[164:167], v[28:31], v[24:27]
    s_barrier
    ds_read_b64_tr_b16 a[8:9], v32 offset:25600
    ds_read_b64_tr_b16 a[10:11], v32 offset:32000
    ds_read_b64_tr_b16 a[12:13], v32 offset:38400
    ds_read_b64_tr_b16 a[14:15], v32 offset:44800
    ds_read_b64_tr_b16 a[88:89], v32 offset:25632
    ds_read_b64_tr_b16 a[90:91], v32 offset:32032
    ds_read_b64_tr_b16 a[92:93], v32 offset:38432
    ds_read_b64_tr_b16 a[94:95], v32 offset:44832
    ds_read_b64_tr_b16 a[168:169], v32 offset:25664
    ds_read_b64_tr_b16 a[170:171], v32 offset:32064
    ds_read_b64_tr_b16 a[172:173], v32 offset:38464
    ds_read_b64_tr_b16 a[174:175], v32 offset:44864
    s_waitcnt vmcnt(42)
    ds_write_b128 v10, v[104:107] offset:0
    ds_write_b128 v11, v[108:111] offset:0
    ds_write_b128 v12, v[112:115] offset:0
    ds_write_b128 v13, v[116:119] offset:0
    ds_write_b128 v14, v[120:123] offset:0
    ds_write_b128 v15, v[124:127] offset:0
    s_waitcnt lgkmcnt(0)
    v_mfma_f32_16x16x32_bf16 v[16:19], a[8:11], v[28:31], v[16:19]
    v_mfma_f32_16x16x32_bf16 v[20:23], a[88:91], v[28:31], v[20:23]
    v_mfma_f32_16x16x32_bf16 v[24:27], a[168:171], v[28:31], v[24:27]
    v_mfma_f32_16x16x32_bf16 v[16:19], a[12:15], v[28:31], v[16:19]
    v_mfma_f32_16x16x32_bf16 v[20:23], a[92:95], v[28:31], v[20:23]
    v_mfma_f32_16x16x32_bf16 v[24:27], a[172:175], v[28:31], v[24:27]
    s_barrier
    ds_read_b64_tr_b16 a[16:17], v32 offset:0
    ds_read_b64_tr_b16 a[18:19], v32 offset:6400
    ds_read_b64_tr_b16 a[20:21], v32 offset:12800
    ds_read_b64_tr_b16 a[22:23], v32 offset:19200
    ds_read_b64_tr_b16 a[96:97], v32 offset:32
    ds_read_b64_tr_b16 a[98:99], v32 offset:6432
    ds_read_b64_tr_b16 a[100:101], v32 offset:12832
    ds_read_b64_tr_b16 a[102:103], v32 offset:19232
    ds_read_b64_tr_b16 a[176:177], v32 offset:64
    ds_read_b64_tr_b16 a[178:179], v32 offset:6464
    ds_read_b64_tr_b16 a[180:181], v32 offset:12864
    ds_read_b64_tr_b16 a[182:183], v32 offset:19264
    s_waitcnt vmcnt(36)
    ds_write_b128 v10, v[128:131] offset:25600
    ds_write_b128 v11, v[132:135] offset:25600
    ds_write_b128 v12, v[136:139] offset:25600
    ds_write_b128 v13, v[140:143] offset:25600
    ds_write_b128 v14, v[144:147] offset:25600
    ds_write_b128 v15, v[148:151] offset:25600
    s_waitcnt lgkmcnt(0)
    v_mfma_f32_16x16x32_bf16 v[16:19], a[16:19], v[28:31], v[16:19]
    v_mfma_f32_16x16x32_bf16 v[20:23], a[96:99], v[28:31], v[20:23]
    v_mfma_f32_16x16x32_bf16 v[24:27], a[176:179], v[28:31], v[24:27]
    v_mfma_f32_16x16x32_bf16 v[16:19], a[20:23], v[28:31], v[16:19]
    v_mfma_f32_16x16x32_bf16 v[20:23], a[100:103], v[28:31], v[20:23]
    v_mfma_f32_16x16x32_bf16 v[24:27], a[180:183], v[28:31], v[24:27]
    s_barrier
    ds_read_b64_tr_b16 a[24:25], v32 offset:25600
    ds_read_b64_tr_b16 a[26:27], v32 offset:32000
    ds_read_b64_tr_b16 a[28:29], v32 offset:38400
    ds_read_b64_tr_b16 a[30:31], v32 offset:44800
    ds_read_b64_tr_b16 a[104:105], v32 offset:25632
    ds_read_b64_tr_b16 a[106:107], v32 offset:32032
    ds_read_b64_tr_b16 a[108:109], v32 offset:38432
    ds_read_b64_tr_b16 a[110:111], v32 offset:44832
    ds_read_b64_tr_b16 a[184:185], v32 offset:25664
    ds_read_b64_tr_b16 a[186:187], v32 offset:32064
    ds_read_b64_tr_b16 a[188:189], v32 offset:38464
    ds_read_b64_tr_b16 a[190:191], v32 offset:44864
    s_waitcnt vmcnt(30)
    ds_write_b128 v10, v[152:155] offset:0
    ds_write_b128 v11, v[156:159] offset:0
    ds_write_b128 v12, v[160:163] offset:0
    ds_write_b128 v13, v[164:167] offset:0
    ds_write_b128 v14, v[168:171] offset:0
    ds_write_b128 v15, v[172:175] offset:0
    s_waitcnt lgkmcnt(0)
    v_mfma_f32_16x16x32_bf16 v[16:19], a[24:27], v[28:31], v[16:19]
    v_mfma_f32_16x16x32_bf16 v[20:23], a[104:107], v[28:31], v[20:23]
    v_mfma_f32_16x16x32_bf16 v[24:27], a[184:187], v[28:31], v[24:27]
    v_mfma_f32_16x16x32_bf16 v[16:19], a[28:31], v[28:31], v[16:19]
    v_mfma_f32_16x16x32_bf16 v[20:23], a[108:111], v[28:31], v[20:23]
    v_mfma_f32_16x16x32_bf16 v[24:27], a[188:191], v[28:31], v[24:27]
    s_barrier
    ds_read_b64_tr_b16 a[32:33], v32 offset:0
    ds_read_b64_tr_b16 a[34:35], v32 offset:6400
    ds_read_b64_tr_b16 a[36:37], v32 offset:12800
    ds_read_b64_tr_b16 a[38:39], v32 offset:19200
    ds_read_b64_tr_b16 a[112:113], v32 offset:32
    ds_read_b64_tr_b16 a[114:115], v32 offset:6432
    ds_read_b64_tr_b16 a[116:117], v32 offset:12832
    ds_read_b64_tr_b16 a[118:119], v32 offset:19232
    ds_read_b64_tr_b16 a[192:193], v32 offset:64
    ds_read_b64_tr_b16 a[194:195], v32 offset:6464
    ds_read_b64_tr_b16 a[196:197], v32 offset:12864
    ds_read_b64_tr_b16 a[198:199], v32 offset:19264
    s_waitcnt vmcnt(24)
    ds_write_b128 v10, v[176:179] offset:25600
    ds_write_b128 v11, v[180:183] offset:25600
    ds_write_b128 v12, v[184:187] offset:25600
    ds_write_b128 v13, v[188:191] offset:25600
    ds_write_b128 v14, v[192:195] offset:25600
    ds_write_b128 v15, v[196:199] offset:25600
    s_waitcnt lgkmcnt(0)
    v_mfma_f32_16x16x32_bf16 v[16:19], a[32:35], v[28:31], v[16:19]
    v_mfma_f32_16x16x32_bf16 v[20:23], a[112:115], v[28:31], v[20:23]
    v_mfma_f32_16x16x32_bf16 v[24:27], a[192:195], v[28:31], v[24:27]
    v_mfma_f32_16x16x32_bf16 v[16:19], a[36:39], v[28:31], v[16:19]
    v_mfma_f32_16x16x32_bf16 v[20:23], a[116:119], v[28:31], v[20:23]
    v_mfma_f32_16x16x32_bf16 v[24:27], a[196:199], v[28:31], v[24:27]
    s_barrier
    ds_read_b64_tr_b16 a[40:41], v32 offset:25600
    ds_read_b64_tr_b16 a[42:43], v32 offset:32000
    ds_read_b64_tr_b16 a[44:45], v32 offset:38400
    ds_read_b64_tr_b16 a[46:47], v32 offset:44800
    ds_read_b64_tr_b16 a[120:121], v32 offset:25632
    ds_read_b64_tr_b16 a[122:123], v32 offset:32032
    ds_read_b64_tr_b16 a[124:125], v32 offset:38432
    ds_read_b64_tr_b16 a[126:127], v32 offset:44832
    ds_read_b64_tr_b16 a[200:201], v32 offset:25664
    ds_read_b64_tr_b16 a[202:203], v32 offset:32064
    ds_read_b64_tr_b16 a[204:205], v32 offset:38464
    ds_read_b64_tr_b16 a[206:207], v32 offset:44864
    s_waitcnt vmcnt(18)
    ds_write_b128 v10, v[200:203] offset:0
    ds_write_b128 v11, v[204:207] offset:0
    ds_write_b128 v12, v[208:211] offset:0
    ds_write_b128 v13, v[212:215] offset:0
    ds_write_b128 v14, v[216:219] offset:0
    ds_write_b128 v15, v[220:223] offset:0
    s_waitcnt lgkmcnt(0)
    v_mfma_f32_16x16x32_bf16 v[16:19], a[40:43], v[28:31], v[16:19]
    v_mfma_f32_16x16x32_bf16 v[20:23], a[120:123], v[28:31], v[20:23]
    v_mfma_f32_16x16x32_bf16 v[24:27], a[200:203], v[28:31], v[24:27]
    v_mfma_f32_16x16x32_bf16 v[16:19], a[44:47], v[28:31], v[16:19]
    v_mfma_f32_16x16x32_bf16 v[20:23], a[124:127], v[28:31], v[20:23]
    v_mfma_f32_16x16x32_bf16 v[24:27], a[204:207], v[28:31], v[24:27]
    s_barrier
    ds_read_b64_tr_b16 a[48:49], v32 offset:0
    ds_read_b64_tr_b16 a[50:51], v32 offset:6400
    ds_read_b64_tr_b16 a[52:53], v32 offset:12800
    ds_read_b64_tr_b16 a[54:55], v32 offset:19200
    ds_read_b64_tr_b16 a[128:129], v32 offset:32
    ds_read_b64_tr_b16 a[130:131], v32 offset:6432
    ds_read_b64_tr_b16 a[132:133], v32 offset:12832
    ds_read_b64_tr_b16 a[134:135], v32 offset:19232
    ds_read_b64_tr_b16 a[208:209], v32 offset:64
    ds_read_b64_tr_b16 a[210:211], v32 offset:6464
    ds_read_b64_tr_b16 a[212:213], v32 offset:12864
    ds_read_b64_tr_b16 a[214:215], v32 offset:19264
    s_waitcnt vmcnt(12)
    ds_write_b128 v10, v[224:227] offset:25600
    ds_write_b128 v11, v[228:231] offset:25600
    ds_write_b128 v12, v[232:235] offset:25600
    ds_write_b128 v13, v[236:239] offset:25600
    ds_write_b128 v14, v[240:243] offset:25600
    ds_write_b128 v15, v[244:247] offset:25600
    s_waitcnt lgkmcnt(0)
    v_mfma_f32_16x16x32_bf16 v[16:19], a[48:51], v[28:31], v[16:19]
    v_mfma_f32_16x16x32_bf16 v[20:23], a[128:131], v[28:31], v[20:23]
    v_mfma_f32_16x16x32_bf16 v[24:27], a[208:211], v[28:31], v[24:27]
    v_mfma_f32_16x16x32_bf16 v[16:19], a[52:55], v[28:31], v[16:19]
    v_mfma_f32_16x16x32_bf16 v[20:23], a[132:135], v[28:31], v[20:23]
    v_mfma_f32_16x16x32_bf16 v[24:27], a[212:215], v[28:31], v[24:27]
    s_barrier
    ds_read_b64_tr_b16 a[56:57], v32 offset:25600
    ds_read_b64_tr_b16 a[58:59], v32 offset:32000
    ds_read_b64_tr_b16 a[60:61], v32 offset:38400
    ds_read_b64_tr_b16 a[62:63], v32 offset:44800
    ds_read_b64_tr_b16 a[136:137], v32 offset:25632
    ds_read_b64_tr_b16 a[138:139], v32 offset:32032
    ds_read_b64_tr_b16 a[140:141], v32 offset:38432
    ds_read_b64_tr_b16 a[142:143], v32 offset:44832
    ds_read_b64_tr_b16 a[216:217], v32 offset:25664
    ds_read_b64_tr_b16 a[218:219], v32 offset:32064
    ds_read_b64_tr_b16 a[220:221], v32 offset:38464
    ds_read_b64_tr_b16 a[222:223], v32 offset:44864
    s_waitcnt vmcnt(6)
    ds_write_b128 v10, v[56:59] offset:0
    ds_write_b128 v11, v[60:63] offset:0
    ds_write_b128 v12, v[64:67] offset:0
    ds_write_b128 v13, v[68:71] offset:0
    ds_write_b128 v14, v[72:75] offset:0
    ds_write_b128 v15, v[76:79] offset:0
    s_waitcnt lgkmcnt(0)
    v_mfma_f32_16x16x32_bf16 v[16:19], a[56:59], v[28:31], v[16:19]
    v_mfma_f32_16x16x32_bf16 v[20:23], a[136:139], v[28:31], v[20:23]
    v_mfma_f32_16x16x32_bf16 v[24:27], a[216:219], v[28:31], v[24:27]
    v_mfma_f32_16x16x32_bf16 v[16:19], a[60:63], v[28:31], v[16:19]
    v_mfma_f32_16x16x32_bf16 v[20:23], a[140:143], v[28:31], v[20:23]
    v_mfma_f32_16x16x32_bf16 v[24:27], a[220:223], v[28:31], v[24:27]
    s_barrier
    ds_read_b64_tr_b16 a[64:65], v32 offset:0
    ds_read_b64_tr_b16 a[66:67], v32 offset:6400
    ds_read_b64_tr_b16 a[68:69], v32 offset:12800
    ds_read_b64_tr_b16 a[70:71], v32 offset:19200
    ds_read_b64_tr_b16 a[144:145], v32 offset:32
    ds_read_b64_tr_b16 a[146:147], v32 offset:6432
    ds_read_b64_tr_b16 a[148:149], v32 offset:12832
    ds_read_b64_tr_b16 a[150:151], v32 offset:19232
    ds_read_b64_tr_b16 a[224:225], v32 offset:64
    ds_read_b64_tr_b16 a[226:227], v32 offset:6464
    ds_read_b64_tr_b16 a[228:229], v32 offset:12864
    ds_read_b64_tr_b16 a[230:231], v32 offset:19264
    s_waitcnt vmcnt(0)
    ds_write_b128 v10, v[80:83] offset:25600
    ds_write_b128 v11, v[84:87] offset:25600
    ds_write_b128 v12, v[88:91] offset:25600
    ds_write_b128 v13, v[92:95] offset:25600
    ds_write_b128 v14, v[96:99] offset:25600
    ds_write_b128 v15, v[100:103] offset:25600
    s_waitcnt lgkmcnt(0)
    v_mfma_f32_16x16x32_bf16 v[16:19], a[64:67], v[28:31], v[16:19]
    v_mfma_f32_16x16x32_bf16 v[20:23], a[144:147], v[28:31], v[20:23]
    v_mfma_f32_16x16x32_bf16 v[24:27], a[224:227], v[28:31], v[24:27]
    v_mfma_f32_16x16x32_bf16 v[16:19], a[68:71], v[28:31], v[16:19]
    v_mfma_f32_16x16x32_bf16 v[20:23], a[148:151], v[28:31], v[20:23]
    v_mfma_f32_16x16x32_bf16 v[24:27], a[228:231], v[28:31], v[24:27]
    s_barrier
    ds_read_b64_tr_b16 a[72:73], v32 offset:25600
    ds_read_b64_tr_b16 a[74:75], v32 offset:32000
    ds_read_b64_tr_b16 a[76:77], v32 offset:38400
    ds_read_b64_tr_b16 a[78:79], v32 offset:44800
    ds_read_b64_tr_b16 a[152:153], v32 offset:25632
    ds_read_b64_tr_b16 a[154:155], v32 offset:32032
    ds_read_b64_tr_b16 a[156:157], v32 offset:38432
    ds_read_b64_tr_b16 a[158:159], v32 offset:44832
    ds_read_b64_tr_b16 a[232:233], v32 offset:25664
    ds_read_b64_tr_b16 a[234:235], v32 offset:32064
    ds_read_b64_tr_b16 a[236:237], v32 offset:38464
    ds_read_b64_tr_b16 a[238:239], v32 offset:44864
    s_waitcnt lgkmcnt(0)
    v_mfma_f32_16x16x32_bf16 v[16:19], a[72:75], v[28:31], v[16:19]
    v_mfma_f32_16x16x32_bf16 v[20:23], a[152:155], v[28:31], v[20:23]
    v_mfma_f32_16x16x32_bf16 v[24:27], a[232:235], v[28:31], v[24:27]
    v_mfma_f32_16x16x32_bf16 v[16:19], a[76:79], v[28:31], v[16:19]
    v_mfma_f32_16x16x32_bf16 v[20:23], a[156:159], v[28:31], v[20:23]
    v_mfma_f32_16x16x32_bf16 v[24:27], a[236:239], v[28:31], v[24:27]
    s_nop 5
    v_mov_b32 v224, v16
    v_mov_b32 v225, v17
    v_mov_b32 v226, v18
    v_mov_b32 v227, v19
    v_mov_b32 v228, v20
    v_mov_b32 v229, v21
    v_mov_b32 v230, v22
    v_mov_b32 v231, v23
    v_mov_b32 v232, v24
    v_mov_b32 v233, v25
    v_mov_b32 v234, v26
    v_mov_b32 v235, v27
    v_mov_b32 v236, v28
    v_mov_b32 v237, v29
    v_mov_b32 v238, v30
    v_mov_b32 v239, v31
    s_barrier
interleave_layers__linear_attn_block__memory_aug_recurrent_mem_tr__prompt_kernel_p_layer:
    s_mul_i32 s93, s92, 29360128
    s_add_u32 s93, s93, 117440512
    s_mul_i32 s94, s92, 16384
    s_add_u32 s94, s94, 23068672
    s_sub_u32 s44, s2, 104
    s_lshr_b32 s46, s44, 5
    s_and_b32 s44, s44, 31
    s_mov_b32 s43, 67108864
    s_cmp_eq_u32 s46, 1
    s_cselect_b32 s43, 92274688, s43
    s_cmp_eq_u32 s46, 2
    s_cselect_b32 s43, 33554432, s43
    s_cmp_eq_u32 s92, 0
    s_cselect_b32 s73, 0, 8388608
    v_lshlrev_b32 v5, 4, v1
    s_mul_i32 s24, s3, 10240
    v_add_u32 v6, s24, v5
    v_add_u32 v7, 4096, v6
    v_add_u32 v8, 8192, v6
    s_mul_i32 s24, s44, 12288
    s_mul_i32 s25, s3, 3072
    s_add_u32 s24, s24, s25
    v_add_u32 v11, s24, v5
    s_lshr_b32 s24, s3, 1
    s_lshl_b32 s24, s24, 8
    s_and_b32 s25, s3, 1
    s_lshl_b32 s25, s25, 3
    s_add_u32 s24, s24, s25
    s_add_u32 s24, s24, 81920
    v_lshlrev_b32 v13, 4, v2
    v_add_u32 v12, s24, v13
    v_add_u32 v13, 81920, v13
    s_and_b32 s24, s2, 7
    s_lshl_b32 s24, s24, 7
    s_lshl_b32 s25, s92, 10
    s_add_u32 s24, s24, s25
    s_add_u32 s24, s24, 23105536
    v_lshlrev_b32 v4, 2, v1
    v_add_u32 v4, s24, v4
    s_lshl_b32 s24, s46, 12
    s_lshl_b32 s25, s44, 7
    s_add_u32 s24, s24, s25
    s_add_u32 s24, s24, s94
    v_mov_b32 v14, s24
    v_mov_b32 v15, 2146435072
    v_cmp_eq_u32 vcc, 0, v1
    s_nop 1
    v_cndmask_b32 v14, v15, v14, vcc
    s_sub_u32 s70, s2, 104
    s_mul_i32 s71, s70, 205
    s_lshr_b32 s71, s71, 12
    s_mul_i32 s24, s71, 20
    s_sub_u32 s70, s70, s24
    s_cmp_lt_u32 s71, 4
    s_cselect_b32 s64, s71, 64
    s_lshl_b32 s24, s70, 16
    s_lshl_b32 s25, s3, 13
    s_add_u32 s24, s24, s25
    v_add_u32 v240, s24, v5
    v_add_u32 v241, 4096, v240
    s_lshl_b32 s24, s70, 14
    s_lshl_b32 s25, s3, 11
    s_add_u32 s24, s24, s25
    v_add_u32 v242, s24, v5
    s_lshl_b32 s24, s3, 14
    v_add_u32 v193, s24, v5
    v_add_u32 v212, 0, v193
    v_add_u32 v213, 4096, v193
    v_add_u32 v214, 8192, v193
    v_add_u32 v215, 12288, v193
    s_lshl_b32 s24, s3, 12
    s_add_u32 s24, s24, 65536
    v_add_u32 v216, s24, v5
    s_lshl_b32 s24, s3, 12
    s_add_u32 s24, s24, 83968
    v_add_u32 v217, s24, v5
    s_and_b32 s24, s3, 1
    s_lshl_b32 s24, s24, 10
    s_add_u32 s24, s24, 83968
    v_add_u32 v218, s24, v5
    s_and_b32 s24, s3, 1
    s_mul_i32 s24, s24, 20480
    s_lshl_b32 s25, s70, 10
    s_add_u32 s24, s24, s25
    v_add_u32 v219, s24, v5
    s_and_b32 s24, s3, 1
    s_lshl_b32 s24, s24, 4
    v_add_u32 v243, s24, v2
    v_mul_u32_u24 v243, 1280, v243
    v_lshl_add_u32 v243, v3, 3, v243
    s_lshl_b32 s24, s70, 6
    v_add_u32 v243, s24, v243
    s_load_dwordx2 s[26:27], s[0:1], 80
    s_waitcnt lgkmcnt(0)
    s_mov_b32 s12, s26
    s_mov_b32 s13, s27
    s_mov_b32 s14, 2621440
    s_mov_b32 s15, 0x00020000
    s_mul_i32 s65, s71, 1310720
    s_add_u32 s65, s65, 184549376
    s_mul_i32 s24, s71, 458752
    s_add_u32 s24, s24, s93
    s_add_u32 s66, s24, 0
    s_add_u32 s67, s24, 327680
    s_mul_i32 s68, s71, 40960
    v_and_b32 v252, 7, v1
    v_lshlrev_b32 v252, 7, v252
    s_lshl_b32 s24, s3, 10
    s_add_u32 s24, s24, 12288
    s_add_u32 s24, s24, s94
    v_add_u32 v252, s24, v252
    s_mov_b32 s69, -1
    s_mov_b32 s62, -1
    s_mov_b32 s63, 1
    s_cmp_ge_i32 s62, s63
    s_cbranch_scc1 interleave_layers__linear_attn_block__memory_aug_recurrent_mem_tr__prompt_kernel_p_en0_ok
    s_mov_b32 s61, 0
interleave_layers__linear_attn_block__memory_aug_recurrent_mem_tr__prompt_kernel_p_en0:
    buffer_load_dword v16, v4, s[8:11], 0 offen sc1
    s_waitcnt vmcnt(0)
    v_readlane_b32 s62, v16, 0
    v_readlane_b32 s24, v16, 1
    s_min_i32 s62, s62, s24
    v_readlane_b32 s24, v16, 2
    s_min_i32 s62, s62, s24
    v_readlane_b32 s24, v16, 3
    s_min_i32 s62, s62, s24
    v_readlane_b32 s24, v16, 4
    s_min_i32 s62, s62, s24
    v_readlane_b32 s24, v16, 5
    s_min_i32 s62, s62, s24
    v_readlane_b32 s24, v16, 6
    s_min_i32 s62, s62, s24
    v_readlane_b32 s24, v16, 7
    s_min_i32 s62, s62, s24
    v_readlane_b32 s24, v16, 8
    s_min_i32 s62, s62, s24
    v_readlane_b32 s24, v16, 9
    s_min_i32 s62, s62, s24
    v_readlane_b32 s24, v16, 10
    s_min_i32 s62, s62, s24
    v_readlane_b32 s24, v16, 11
    s_min_i32 s62, s62, s24
    v_readlane_b32 s24, v16, 12
    s_min_i32 s62, s62, s24
    v_readlane_b32 s24, v16, 13
    s_min_i32 s62, s62, s24
    v_readlane_b32 s24, v16, 14
    s_min_i32 s62, s62, s24
    v_readlane_b32 s24, v16, 15
    s_min_i32 s62, s62, s24
    v_readlane_b32 s24, v16, 16
    s_min_i32 s62, s62, s24
    v_readlane_b32 s24, v16, 17
    s_min_i32 s62, s62, s24
    v_readlane_b32 s24, v16, 18
    s_min_i32 s62, s62, s24
    v_readlane_b32 s24, v16, 19
    s_min_i32 s62, s62, s24
    s_cmp_ge_i32 s62, s63
    s_cbranch_scc1 interleave_layers__linear_attn_block__memory_aug_recurrent_mem_tr__prompt_kernel_p_en0_ok
    s_add_u32 s61, s61, 1
    s_cmp_ge_u32 s61, s60
    s_cbranch_scc1 interleave_layers__linear_attn_block__memory_aug_recurrent_mem_tr__prompt_kernel_p_en0_to
    s_sleep 2
    s_branch interleave_layers__linear_attn_block__memory_aug_recurrent_mem_tr__prompt_kernel_p_en0
interleave_layers__linear_attn_block__memory_aug_recurrent_mem_tr__prompt_kernel_p_en0_to:
    s_mov_b32 s60, 1
interleave_layers__linear_attn_block__memory_aug_recurrent_mem_tr__prompt_kernel_p_en0_ok:
    s_mov_b32 s41, s73
    buffer_load_dwordx4 v[16:19], v6, s[8:11], s41 offen offset:0 sc1
    buffer_load_dwordx4 v[20:23], v6, s[8:11], s41 offen offset:1024 sc1
    buffer_load_dwordx4 v[24:27], v6, s[8:11], s41 offen offset:2048 sc1
    buffer_load_dwordx4 v[28:31], v6, s[8:11], s41 offen offset:3072 sc1
    buffer_load_dwordx4 v[32:35], v7, s[8:11], s41 offen offset:0 sc1
    buffer_load_dwordx4 v[36:39], v7, s[8:11], s41 offen offset:1024 sc1
    buffer_load_dwordx4 v[40:43], v7, s[8:11], s41 offen offset:2048 sc1
    buffer_load_dwordx4 v[44:47], v7, s[8:11], s41 offen offset:3072 sc1
    buffer_load_dwordx4 v[48:51], v8, s[8:11], s41 offen offset:0 sc1
    buffer_load_dwordx4 v[52:55], v8, s[8:11], s41 offen offset:1024 sc1
    s_mov_b32 s40, 0
    s_mov_b32 s42, 0
    s_waitcnt vmcnt(0)
    v_mov_b32 v124, 0
    v_mov_b32 v125, 0
    v_mov_b32 v126, 0
    v_mov_b32 v127, 0
    v_dot2c_f32_bf16 v124, v16, v236
    v_dot2c_f32_bf16 v125, v16, v16
    v_dot2c_f32_bf16 v126, v17, v236
    v_dot2c_f32_bf16 v127, v17, v17
    v_dot2c_f32_bf16 v124, v18, v236
    v_dot2c_f32_bf16 v125, v18, v18
    v_dot2c_f32_bf16 v126, v19, v236
    v_dot2c_f32_bf16 v127, v19, v19
    v_dot2c_f32_bf16 v124, v20, v236
    v_dot2c_f32_bf16 v125, v20, v20
    v_dot2c_f32_bf16 v126, v21, v236
    v_dot2c_f32_bf16 v127, v21, v21
    v_dot2c_f32_bf16 v124, v22, v236
    v_dot2c_f32_bf16 v125, v22, v22
    v_dot2c_f32_bf16 v126, v23, v236
    v_dot2c_f32_bf16 v127, v23, v23
    v_dot2c_f32_bf16 v124, v24, v236
    v_dot2c_f32_bf16 v125, v24, v24
    v_dot2c_f32_bf16 v126, v25, v236
    v_dot2c_f32_bf16 v127, v25, v25
    v_dot2c_f32_bf16 v124, v26, v236
    v_dot2c_f32_bf16 v125, v26, v26
    v_dot2c_f32_bf16 v126, v27, v236
    v_dot2c_f32_bf16 v127, v27, v27
    v_dot2c_f32_bf16 v124, v28, v236
    v_dot2c_f32_bf16 v125, v28, v28
    v_dot2c_f32_bf16 v126, v29, v236
    v_dot2c_f32_bf16 v127, v29, v29
    v_dot2c_f32_bf16 v124, v30, v236
    v_dot2c_f32_bf16 v125, v30, v30
    v_dot2c_f32_bf16 v126, v31, v236
    v_dot2c_f32_bf16 v127, v31, v31
    v_dot2c_f32_bf16 v124, v32, v236
    v_dot2c_f32_bf16 v125, v32, v32
    v_dot2c_f32_bf16 v126, v33, v236
    v_dot2c_f32_bf16 v127, v33, v33
    v_dot2c_f32_bf16 v124, v34, v236
    v_dot2c_f32_bf16 v125, v34, v34
    v_dot2c_f32_bf16 v126, v35, v236
    v_dot2c_f32_bf16 v127, v35, v35
    v_dot2c_f32_bf16 v124, v36, v236
    v_dot2c_f32_bf16 v125, v36, v36
    v_dot2c_f32_bf16 v126, v37, v236
    v_dot2c_f32_bf16 v127, v37, v37
    v_dot2c_f32_bf16 v124, v38, v236
    v_dot2c_f32_bf16 v125, v38, v38
    v_dot2c_f32_bf16 v126, v39, v236
    v_dot2c_f32_bf16 v127, v39, v39
    v_dot2c_f32_bf16 v124, v40, v236
    v_dot2c_f32_bf16 v125, v40, v40
    v_dot2c_f32_bf16 v126, v41, v236
    v_dot2c_f32_bf16 v127, v41, v41
    v_dot2c_f32_bf16 v124, v42, v236
    v_dot2c_f32_bf16 v125, v42, v42
    v_dot2c_f32_bf16 v126, v43, v236
    v_dot2c_f32_bf16 v127, v43, v43
    v_dot2c_f32_bf16 v124, v44, v236
    v_dot2c_f32_bf16 v125, v44, v44
    v_dot2c_f32_bf16 v126, v45, v236
    v_dot2c_f32_bf16 v127, v45, v45
    v_dot2c_f32_bf16 v124, v46, v236
    v_dot2c_f32_bf16 v125, v46, v46
    v_dot2c_f32_bf16 v126, v47, v236
    v_dot2c_f32_bf16 v127, v47, v47
    v_dot2c_f32_bf16 v124, v48, v236
    v_dot2c_f32_bf16 v125, v48, v48
    v_dot2c_f32_bf16 v126, v49, v236
    v_dot2c_f32_bf16 v127, v49, v49
    v_dot2c_f32_bf16 v124, v50, v236
    v_dot2c_f32_bf16 v125, v50, v50
    v_dot2c_f32_bf16 v126, v51, v236
    v_dot2c_f32_bf16 v127, v51, v51
    v_dot2c_f32_bf16 v124, v52, v236
    v_dot2c_f32_bf16 v125, v52, v52
    v_dot2c_f32_bf16 v126, v53, v236
    v_dot2c_f32_bf16 v127, v53, v53
    v_dot2c_f32_bf16 v124, v54, v236
    v_dot2c_f32_bf16 v125, v54, v54
    v_dot2c_f32_bf16 v126, v55, v236
    v_dot2c_f32_bf16 v127, v55, v55
    s_nop 1
    v_add_f32 v124, v124, v126
    v_add_f32 v125, v125, v127
    v_mov_b32 v126, v124
    v_mov_b32 v127, v125
    s_nop 0
    v_permlane16_swap_b32 v124, v126
    v_permlane16_swap_b32 v125, v127
    v_add_f32 v124, v124, v126
    v_add_f32 v125, v125, v127
    v_mov_b32 v126, v124
    v_mov_b32 v127, v125
    s_nop 0
    v_permlane32_swap_b32 v124, v126
    v_permlane32_swap_b32 v125, v127
    v_add_f32 v124, v124, v126
    v_add_f32 v125, v125, v127
    ds_write_b128 v6, v[16:19] offset:0
    ds_write_b128 v6, v[20:23] offset:1024
    ds_write_b128 v6, v[24:27] offset:2048
    ds_write_b128 v6, v[28:31] offset:3072
    ds_write_b128 v6, v[32:35] offset:4096
    ds_write_b128 v6, v[36:39] offset:5120
    ds_write_b128 v6, v[40:43] offset:6144
    ds_write_b128 v6, v[44:47] offset:7168
    ds_write_b128 v6, v[48:51] offset:8192
    ds_write_b128 v6, v[52:55] offset:9216
    ds_write_b64 v12, v[124:125]
    s_waitcnt lgkmcnt(0)
    s_barrier
interleave_layers__linear_attn_block__memory_aug_recurrent_mem_tr__prompt_kernel_p_seg:
    v_add_u32 v9, s42, v5
    s_xor_b32 s42, s42, 40960
    v_add_u32 v10, s42, v6
    s_add_u32 s63, s40, 1
    s_lshr_b32 s63, s63, 2
    s_add_u32 s63, s63, 1
    s_min_u32 s63, s63, 16
    s_cmp_ge_i32 s62, s63
    s_cbranch_scc1 interleave_layers__linear_attn_block__memory_aug_recurrent_mem_tr__prompt_kernel_p_en_ok
    s_mov_b32 s61, 0
interleave_layers__linear_attn_block__memory_aug_recurrent_mem_tr__prompt_kernel_p_en:
    buffer_load_dword v16, v4, s[8:11], 0 offen sc1
    s_waitcnt vmcnt(0)
    v_readlane_b32 s62, v16, 0
    v_readlane_b32 s24, v16, 1
    s_min_i32 s62, s62, s24
    v_readlane_b32 s24, v16, 2
    s_min_i32 s62, s62, s24
    v_readlane_b32 s24, v16, 3
    s_min_i32 s62, s62, s24
    v_readlane_b32 s24, v16, 4
    s_min_i32 s62, s62, s24
    v_readlane_b32 s24, v16, 5
    s_min_i32 s62, s62, s24
    v_readlane_b32 s24, v16, 6
    s_min_i32 s62, s62, s24
    v_readlane_b32 s24, v16, 7
    s_min_i32 s62, s62, s24
    v_readlane_b32 s24, v16, 8
    s_min_i32 s62, s62, s24
    v_readlane_b32 s24, v16, 9
    s_min_i32 s62, s62, s24
    v_readlane_b32 s24, v16, 10
    s_min_i32 s62, s62, s24
    v_readlane_b32 s24, v16, 11
    s_min_i32 s62, s62, s24
    v_readlane_b32 s24, v16, 12
    s_min_i32 s62, s62, s24
    v_readlane_b32 s24, v16, 13
    s_min_i32 s62, s62, s24
    v_readlane_b32 s24, v16, 14
    s_min_i32 s62, s62, s24
    v_readlane_b32 s24, v16, 15
    s_min_i32 s62, s62, s24
    v_readlane_b32 s24, v16, 16
    s_min_i32 s62, s62, s24
    v_readlane_b32 s24, v16, 17
    s_min_i32 s62, s62, s24
    v_readlane_b32 s24, v16, 18
    s_min_i32 s62, s62, s24
    v_readlane_b32 s24, v16, 19
    s_min_i32 s62, s62, s24
    s_cmp_ge_i32 s62, s63
    s_cbranch_scc1 interleave_layers__linear_attn_block__memory_aug_recurrent_mem_tr__prompt_kernel_p_en_ok
    s_add_u32 s61, s61, 1
    s_cmp_ge_u32 s61, s60
    s_cbranch_scc1 interleave_layers__linear_attn_block__memory_aug_recurrent_mem_tr__prompt_kernel_p_en_to
    s_sleep 2
    s_branch interleave_layers__linear_attn_block__memory_aug_recurrent_mem_tr__prompt_kernel_p_en
interleave_layers__linear_attn_block__memory_aug_recurrent_mem_tr__prompt_kernel_p_en_to:
    s_mov_b32 s60, 1
interleave_layers__linear_attn_block__memory_aug_recurrent_mem_tr__prompt_kernel_p_en_ok:
    s_add_u32 s41, s41, 40960
    buffer_load_dwordx4 v[16:19], v6, s[8:11], s41 offen offset:0 sc1
    buffer_load_dwordx4 v[20:23], v6, s[8:11], s41 offen offset:1024 sc1
    buffer_load_dwordx4 v[24:27], v6, s[8:11], s41 offen offset:2048 sc1
    buffer_load_dwordx4 v[28:31], v6, s[8:11], s41 offen offset:3072 sc1
    buffer_load_dwordx4 v[32:35], v7, s[8:11], s41 offen offset:0 sc1
    buffer_load_dwordx4 v[36:39], v7, s[8:11], s41 offen offset:1024 sc1
    buffer_load_dwordx4 v[40:43], v7, s[8:11], s41 offen offset:2048 sc1
    buffer_load_dwordx4 v[44:47], v7, s[8:11], s41 offen offset:3072 sc1
    buffer_load_dwordx4 v[48:51], v8, s[8:11], s41 offen offset:0 sc1
    buffer_load_dwordx4 v[52:55], v8, s[8:11], s41 offen offset:1024 sc1
    s_and_b32 s24, s40, 1
    s_lshl_b32 s24, s24, 9
    v_add_u32 v124, s24, v13
    ds_read_b128 v[112:115], v124
    ds_read_b128 v[116:119], v124 offset:256
    ds_read_b128 v[56:59], v9 offset:0
    ds_read_b128 v[60:63], v9 offset:20480
    ds_read_b128 v[64:67], v9 offset:1024
    ds_read_b128 v[68:71], v9 offset:21504
    ds_read_b128 v[72:75], v9 offset:2048
    ds_read_b128 v[76:79], v9 offset:22528
    s_waitcnt lgkmcnt(6)
    v_add_f32 v112, v112, v114
    v_add_f32 v113, v113, v115
    v_mul_f32 v112, 0x3acccccd, v112
    v_mul_f32 v114, v112, v112
    v_mov_b32 v115, 0x3acccccd
    v_fma_f32 v113, v113, v115, -v114
    v_max_f32 v113, 0, v113
    v_add_f32 v113, 0x3727c5ac, v113
    v_rsq_f32 v132, v113
    s_nop 0
    v_mul_f32 v133, v112, v132
    v_sub_f32 v133, 0, v133
    v_add_f32 v116, v116, v118
    v_add_f32 v117, v117, v119
    v_mul_f32 v116, 0x3acccccd, v116
    v_mul_f32 v118, v116, v116
    v_mov_b32 v119, 0x3acccccd
    v_fma_f32 v117, v117, v119, -v118
    v_max_f32 v117, 0, v117
    v_add_f32 v117, 0x3727c5ac, v117
    v_rsq_f32 v134, v117
    s_nop 0
    v_mul_f32 v135, v116, v134
    v_sub_f32 v135, 0, v135
    ds_read_b128 v[80:83], v9 offset:3072
    ds_read_b128 v[84:87], v9 offset:23552
    s_waitcnt lgkmcnt(6)
    v_mfma_f32_16x16x32_bf16 v[88:91], a[0:3], v[56:59], 0
    v_mfma_f32_16x16x32_bf16 v[92:95], a[80:83], v[56:59], 0
    v_mfma_f32_16x16x32_bf16 v[96:99], a[160:163], v[56:59], 0
    v_mfma_f32_16x16x32_bf16 v[100:103], a[0:3], v[60:63], 0
    v_mfma_f32_16x16x32_bf16 v[104:107], a[80:83], v[60:63], 0
    v_mfma_f32_16x16x32_bf16 v[108:111], a[160:163], v[60:63], 0
    ds_read_b128 v[56:59], v9 offset:4096
    ds_read_b128 v[60:63], v9 offset:24576
    s_waitcnt lgkmcnt(6)
    v_mfma_f32_16x16x32_bf16 v[88:91], a[4:7], v[64:67], v[88:91]
    v_mfma_f32_16x16x32_bf16 v[92:95], a[84:87], v[64:67], v[92:95]
    v_mfma_f32_16x16x32_bf16 v[96:99], a[164:167], v[64:67], v[96:99]
    v_mfma_f32_16x16x32_bf16 v[100:103], a[4:7], v[68:71], v[100:103]
    v_mfma_f32_16x16x32_bf16 v[104:107], a[84:87], v[68:71], v[104:107]
    v_mfma_f32_16x16x32_bf16 v[108:111], a[164:167], v[68:71], v[108:111]
    ds_read_b128 v[64:67], v9 offset:5120
    ds_read_b128 v[68:71], v9 offset:25600
    s_waitcnt lgkmcnt(6)
    v_mfma_f32_16x16x32_bf16 v[88:91], a[8:11], v[72:75], v[88:91]
    v_mfma_f32_16x16x32_bf16 v[92:95], a[88:91], v[72:75], v[92:95]
    v_mfma_f32_16x16x32_bf16 v[96:99], a[168:171], v[72:75], v[96:99]
    v_mfma_f32_16x16x32_bf16 v[100:103], a[8:11], v[76:79], v[100:103]
    v_mfma_f32_16x16x32_bf16 v[104:107], a[88:91], v[76:79], v[104:107]
    v_mfma_f32_16x16x32_bf16 v[108:111], a[168:171], v[76:79], v[108:111]
    ds_read_b128 v[72:75], v9 offset:6144
    ds_read_b128 v[76:79], v9 offset:26624
    s_waitcnt lgkmcnt(6)
    v_mfma_f32_16x16x32_bf16 v[88:91], a[12:15], v[80:83], v[88:91]
    v_mfma_f32_16x16x32_bf16 v[92:95], a[92:95], v[80:83], v[92:95]
    v_mfma_f32_16x16x32_bf16 v[96:99], a[172:175], v[80:83], v[96:99]
    v_mfma_f32_16x16x32_bf16 v[100:103], a[12:15], v[84:87], v[100:103]
    v_mfma_f32_16x16x32_bf16 v[104:107], a[92:95], v[84:87], v[104:107]
    v_mfma_f32_16x16x32_bf16 v[108:111], a[172:175], v[84:87], v[108:111]
    ds_read_b128 v[80:83], v9 offset:7168
    ds_read_b128 v[84:87], v9 offset:27648
    s_waitcnt lgkmcnt(6)
    v_mfma_f32_16x16x32_bf16 v[88:91], a[16:19], v[56:59], v[88:91]
    v_mfma_f32_16x16x32_bf16 v[92:95], a[96:99], v[56:59], v[92:95]
    v_mfma_f32_16x16x32_bf16 v[96:99], a[176:179], v[56:59], v[96:99]
    v_mfma_f32_16x16x32_bf16 v[100:103], a[16:19], v[60:63], v[100:103]
    v_mfma_f32_16x16x32_bf16 v[104:107], a[96:99], v[60:63], v[104:107]
    v_mfma_f32_16x16x32_bf16 v[108:111], a[176:179], v[60:63], v[108:111]
    ds_read_b128 v[56:59], v9 offset:8192
    ds_read_b128 v[60:63], v9 offset:28672
    s_waitcnt lgkmcnt(6)
    v_mfma_f32_16x16x32_bf16 v[88:91], a[20:23], v[64:67], v[88:91]
    v_mfma_f32_16x16x32_bf16 v[92:95], a[100:103], v[64:67], v[92:95]
    v_mfma_f32_16x16x32_bf16 v[96:99], a[180:183], v[64:67], v[96:99]
    v_mfma_f32_16x16x32_bf16 v[100:103], a[20:23], v[68:71], v[100:103]
    v_mfma_f32_16x16x32_bf16 v[104:107], a[100:103], v[68:71], v[104:107]
    v_mfma_f32_16x16x32_bf16 v[108:111], a[180:183], v[68:71], v[108:111]
    ds_read_b128 v[64:67], v9 offset:9216
    ds_read_b128 v[68:71], v9 offset:29696
    s_waitcnt lgkmcnt(6)
    v_mfma_f32_16x16x32_bf16 v[88:91], a[24:27], v[72:75], v[88:91]
    v_mfma_f32_16x16x32_bf16 v[92:95], a[104:107], v[72:75], v[92:95]
    v_mfma_f32_16x16x32_bf16 v[96:99], a[184:187], v[72:75], v[96:99]
    v_mfma_f32_16x16x32_bf16 v[100:103], a[24:27], v[76:79], v[100:103]
    v_mfma_f32_16x16x32_bf16 v[104:107], a[104:107], v[76:79], v[104:107]
    v_mfma_f32_16x16x32_bf16 v[108:111], a[184:187], v[76:79], v[108:111]
    ds_read_b128 v[72:75], v9 offset:10240
    ds_read_b128 v[76:79], v9 offset:30720
    s_waitcnt lgkmcnt(6)
    v_mfma_f32_16x16x32_bf16 v[88:91], a[28:31], v[80:83], v[88:91]
    v_mfma_f32_16x16x32_bf16 v[92:95], a[108:111], v[80:83], v[92:95]
    v_mfma_f32_16x16x32_bf16 v[96:99], a[188:191], v[80:83], v[96:99]
    v_mfma_f32_16x16x32_bf16 v[100:103], a[28:31], v[84:87], v[100:103]
    v_mfma_f32_16x16x32_bf16 v[104:107], a[108:111], v[84:87], v[104:107]
    v_mfma_f32_16x16x32_bf16 v[108:111], a[188:191], v[84:87], v[108:111]
    ds_read_b128 v[80:83], v9 offset:11264
    ds_read_b128 v[84:87], v9 offset:31744
    s_waitcnt lgkmcnt(6)
    v_mfma_f32_16x16x32_bf16 v[88:91], a[32:35], v[56:59], v[88:91]
    v_mfma_f32_16x16x32_bf16 v[92:95], a[112:115], v[56:59], v[92:95]
    v_mfma_f32_16x16x32_bf16 v[96:99], a[192:195], v[56:59], v[96:99]
    v_mfma_f32_16x16x32_bf16 v[100:103], a[32:35], v[60:63], v[100:103]
    v_mfma_f32_16x16x32_bf16 v[104:107], a[112:115], v[60:63], v[104:107]
    v_mfma_f32_16x16x32_bf16 v[108:111], a[192:195], v[60:63], v[108:111]
    ds_read_b128 v[56:59], v9 offset:12288
    ds_read_b128 v[60:63], v9 offset:32768
    s_waitcnt lgkmcnt(6)
    v_mfma_f32_16x16x32_bf16 v[88:91], a[36:39], v[64:67], v[88:91]
    v_mfma_f32_16x16x32_bf16 v[92:95], a[116:119], v[64:67], v[92:95]
    v_mfma_f32_16x16x32_bf16 v[96:99], a[196:199], v[64:67], v[96:99]
    v_mfma_f32_16x16x32_bf16 v[100:103], a[36:39], v[68:71], v[100:103]
    v_mfma_f32_16x16x32_bf16 v[104:107], a[116:119], v[68:71], v[104:107]
    v_mfma_f32_16x16x32_bf16 v[108:111], a[196:199], v[68:71], v[108:111]
    s_waitcnt vmcnt(10)
    s_barrier
    s_cmp_eq_u32 s3, 0
    s_cbranch_scc0 interleave_layers__linear_attn_block__memory_aug_recurrent_mem_tr__prompt_kernel_fp28
    v_mov_b32 v15, s40
    buffer_store_dword v15, v14, s[8:11], 0 offen sc1
interleave_layers__linear_attn_block__memory_aug_recurrent_mem_tr__prompt_kernel_fp28:
    ds_read_b128 v[64:67], v9 offset:13312
    ds_read_b128 v[68:71], v9 offset:33792
    s_waitcnt lgkmcnt(6)
    v_mfma_f32_16x16x32_bf16 v[88:91], a[40:43], v[72:75], v[88:91]
    v_mfma_f32_16x16x32_bf16 v[92:95], a[120:123], v[72:75], v[92:95]
    v_mfma_f32_16x16x32_bf16 v[96:99], a[200:203], v[72:75], v[96:99]
    v_mfma_f32_16x16x32_bf16 v[100:103], a[40:43], v[76:79], v[100:103]
    v_mfma_f32_16x16x32_bf16 v[104:107], a[120:123], v[76:79], v[104:107]
    v_mfma_f32_16x16x32_bf16 v[108:111], a[200:203], v[76:79], v[108:111]
    ds_read_b128 v[72:75], v9 offset:14336
    ds_read_b128 v[76:79], v9 offset:34816
    s_waitcnt lgkmcnt(6)
    v_mfma_f32_16x16x32_bf16 v[88:91], a[44:47], v[80:83], v[88:91]
    v_mfma_f32_16x16x32_bf16 v[92:95], a[124:127], v[80:83], v[92:95]
    v_mfma_f32_16x16x32_bf16 v[96:99], a[204:207], v[80:83], v[96:99]
    v_mfma_f32_16x16x32_bf16 v[100:103], a[44:47], v[84:87], v[100:103]
    v_mfma_f32_16x16x32_bf16 v[104:107], a[124:127], v[84:87], v[104:107]
    v_mfma_f32_16x16x32_bf16 v[108:111], a[204:207], v[84:87], v[108:111]
    ds_read_b128 v[80:83], v9 offset:15360
    ds_read_b128 v[84:87], v9 offset:35840
    s_waitcnt lgkmcnt(6)
    v_mfma_f32_16x16x32_bf16 v[88:91], a[48:51], v[56:59], v[88:91]
    v_mfma_f32_16x16x32_bf16 v[92:95], a[128:131], v[56:59], v[92:95]
    v_mfma_f32_16x16x32_bf16 v[96:99], a[208:211], v[56:59], v[96:99]
    v_mfma_f32_16x16x32_bf16 v[100:103], a[48:51], v[60:63], v[100:103]
    v_mfma_f32_16x16x32_bf16 v[104:107], a[128:131], v[60:63], v[104:107]
    v_mfma_f32_16x16x32_bf16 v[108:111], a[208:211], v[60:63], v[108:111]
    ds_read_b128 v[56:59], v9 offset:16384
    ds_read_b128 v[60:63], v9 offset:36864
    s_waitcnt lgkmcnt(6)
    v_mfma_f32_16x16x32_bf16 v[88:91], a[52:55], v[64:67], v[88:91]
    v_mfma_f32_16x16x32_bf16 v[92:95], a[132:135], v[64:67], v[92:95]
    v_mfma_f32_16x16x32_bf16 v[96:99], a[212:215], v[64:67], v[96:99]
    v_mfma_f32_16x16x32_bf16 v[100:103], a[52:55], v[68:71], v[100:103]
    v_mfma_f32_16x16x32_bf16 v[104:107], a[132:135], v[68:71], v[104:107]
    v_mfma_f32_16x16x32_bf16 v[108:111], a[212:215], v[68:71], v[108:111]
    ds_read_b128 v[64:67], v9 offset:17408
    ds_read_b128 v[68:71], v9 offset:37888
    s_waitcnt lgkmcnt(6)
    v_mfma_f32_16x16x32_bf16 v[88:91], a[56:59], v[72:75], v[88:91]
    v_mfma_f32_16x16x32_bf16 v[92:95], a[136:139], v[72:75], v[92:95]
    v_mfma_f32_16x16x32_bf16 v[96:99], a[216:219], v[72:75], v[96:99]
    v_mfma_f32_16x16x32_bf16 v[100:103], a[56:59], v[76:79], v[100:103]
    v_mfma_f32_16x16x32_bf16 v[104:107], a[136:139], v[76:79], v[104:107]
    v_mfma_f32_16x16x32_bf16 v[108:111], a[216:219], v[76:79], v[108:111]
    ds_read_b128 v[72:75], v9 offset:18432
    ds_read_b128 v[76:79], v9 offset:38912
    s_waitcnt lgkmcnt(6)
    v_mfma_f32_16x16x32_bf16 v[88:91], a[60:63], v[80:83], v[88:91]
    v_mfma_f32_16x16x32_bf16 v[92:95], a[140:143], v[80:83], v[92:95]
    v_mfma_f32_16x16x32_bf16 v[96:99], a[220:223], v[80:83], v[96:99]
    v_mfma_f32_16x16x32_bf16 v[100:103], a[60:63], v[84:87], v[100:103]
    v_mfma_f32_16x16x32_bf16 v[104:107], a[140:143], v[84:87], v[104:107]
    v_mfma_f32_16x16x32_bf16 v[108:111], a[220:223], v[84:87], v[108:111]
    ds_read_b128 v[80:83], v9 offset:19456
    ds_read_b128 v[84:87], v9 offset:39936
    s_waitcnt lgkmcnt(6)
    v_mfma_f32_16x16x32_bf16 v[88:91], a[64:67], v[56:59], v[88:91]
    v_mfma_f32_16x16x32_bf16 v[92:95], a[144:147], v[56:59], v[92:95]
    v_mfma_f32_16x16x32_bf16 v[96:99], a[224:227], v[56:59], v[96:99]
    v_mfma_f32_16x16x32_bf16 v[100:103], a[64:67], v[60:63], v[100:103]
    v_mfma_f32_16x16x32_bf16 v[104:107], a[144:147], v[60:63], v[104:107]
    v_mfma_f32_16x16x32_bf16 v[108:111], a[224:227], v[60:63], v[108:111]
    s_waitcnt lgkmcnt(4)
    v_mfma_f32_16x16x32_bf16 v[88:91], a[68:71], v[64:67], v[88:91]
    v_mfma_f32_16x16x32_bf16 v[92:95], a[148:151], v[64:67], v[92:95]
    v_mfma_f32_16x16x32_bf16 v[96:99], a[228:231], v[64:67], v[96:99]
    v_mfma_f32_16x16x32_bf16 v[100:103], a[68:71], v[68:71], v[100:103]
    v_mfma_f32_16x16x32_bf16 v[104:107], a[148:151], v[68:71], v[104:107]
    v_mfma_f32_16x16x32_bf16 v[108:111], a[228:231], v[68:71], v[108:111]
    s_waitcnt lgkmcnt(2)
    v_mfma_f32_16x16x32_bf16 v[88:91], a[72:75], v[72:75], v[88:91]
    v_mfma_f32_16x16x32_bf16 v[92:95], a[152:155], v[72:75], v[92:95]
    v_mfma_f32_16x16x32_bf16 v[96:99], a[232:235], v[72:75], v[96:99]
    v_mfma_f32_16x16x32_bf16 v[100:103], a[72:75], v[76:79], v[100:103]
    v_mfma_f32_16x16x32_bf16 v[104:107], a[152:155], v[76:79], v[104:107]
    v_mfma_f32_16x16x32_bf16 v[108:111], a[232:235], v[76:79], v[108:111]
    s_waitcnt lgkmcnt(0)
    v_mfma_f32_16x16x32_bf16 v[88:91], a[76:79], v[80:83], v[88:91]
    v_mfma_f32_16x16x32_bf16 v[92:95], a[156:159], v[80:83], v[92:95]
    v_mfma_f32_16x16x32_bf16 v[96:99], a[236:239], v[80:83], v[96:99]
    v_mfma_f32_16x16x32_bf16 v[100:103], a[76:79], v[84:87], v[100:103]
    v_mfma_f32_16x16x32_bf16 v[104:107], a[156:159], v[84:87], v[104:107]
    v_mfma_f32_16x16x32_bf16 v[108:111], a[236:239], v[84:87], v[108:111]
    v_pk_mul_f32 v[124:125], v[224:225], v[132:133] op_sel:[0,1] op_sel_hi:[1,1]
    v_pk_mul_f32 v[126:127], v[226:227], v[132:133] op_sel:[0,1] op_sel_hi:[1,1]
    s_nop 0
    v_pk_fma_f32 v[88:89], v[88:89], v[132:133], v[124:125] op_sel:[0,0,0] op_sel_hi:[1,0,1]
    v_pk_fma_f32 v[90:91], v[90:91], v[132:133], v[126:127] op_sel:[0,0,0] op_sel_hi:[1,0,1]
    v_pk_mul_f32 v[124:125], v[228:229], v[132:133] op_sel:[0,1] op_sel_hi:[1,1]
    v_pk_mul_f32 v[126:127], v[230:231], v[132:133] op_sel:[0,1] op_sel_hi:[1,1]
    v_pk_fma_f32 v[92:93], v[92:93], v[132:133], v[124:125] op_sel:[0,0,0] op_sel_hi:[1,0,1]
    v_pk_fma_f32 v[94:95], v[94:95], v[132:133], v[126:127] op_sel:[0,0,0] op_sel_hi:[1,0,1]
    v_pk_mul_f32 v[124:125], v[232:233], v[132:133] op_sel:[0,1] op_sel_hi:[1,1]
    v_pk_mul_f32 v[126:127], v[234:235], v[132:133] op_sel:[0,1] op_sel_hi:[1,1]
    v_pk_fma_f32 v[96:97], v[96:97], v[132:133], v[124:125] op_sel:[0,0,0] op_sel_hi:[1,0,1]
    v_pk_fma_f32 v[98:99], v[98:99], v[132:133], v[126:127] op_sel:[0,0,0] op_sel_hi:[1,0,1]
    v_pk_mul_f32 v[124:125], v[224:225], v[134:135] op_sel:[0,1] op_sel_hi:[1,1]
    v_pk_mul_f32 v[126:127], v[226:227], v[134:135] op_sel:[0,1] op_sel_hi:[1,1]
    v_pk_fma_f32 v[100:101], v[100:101], v[134:135], v[124:125] op_sel:[0,0,0] op_sel_hi:[1,0,1]
    v_pk_fma_f32 v[102:103], v[102:103], v[134:135], v[126:127] op_sel:[0,0,0] op_sel_hi:[1,0,1]
    v_pk_mul_f32 v[124:125], v[228:229], v[134:135] op_sel:[0,1] op_sel_hi:[1,1]
    v_pk_mul_f32 v[126:127], v[230:231], v[134:135] op_sel:[0,1] op_sel_hi:[1,1]
    v_pk_fma_f32 v[104:105], v[104:105], v[134:135], v[124:125] op_sel:[0,0,0] op_sel_hi:[1,0,1]
    v_pk_fma_f32 v[106:107], v[106:107], v[134:135], v[126:127] op_sel:[0,0,0] op_sel_hi:[1,0,1]
    v_pk_mul_f32 v[124:125], v[232:233], v[134:135] op_sel:[0,1] op_sel_hi:[1,1]
    v_pk_mul_f32 v[126:127], v[234:235], v[134:135] op_sel:[0,1] op_sel_hi:[1,1]
    v_pk_fma_f32 v[108:109], v[108:109], v[134:135], v[124:125] op_sel:[0,0,0] op_sel_hi:[1,0,1]
    v_pk_fma_f32 v[110:111], v[110:111], v[134:135], v[126:127] op_sel:[0,0,0] op_sel_hi:[1,0,1]
    v_cvt_pk_bf16_f32 v112, v88, v89
    v_cvt_pk_bf16_f32 v113, v90, v91
    v_cvt_pk_bf16_f32 v114, v92, v93
    v_cvt_pk_bf16_f32 v115, v94, v95
    v_cvt_pk_bf16_f32 v116, v100, v101
    v_cvt_pk_bf16_f32 v117, v102, v103
    v_cvt_pk_bf16_f32 v118, v104, v105
    v_cvt_pk_bf16_f32 v119, v106, v107
    v_cvt_pk_bf16_f32 v120, v96, v97
    v_cvt_pk_bf16_f32 v121, v98, v99
    v_cvt_pk_bf16_f32 v122, v108, v109
    v_cvt_pk_bf16_f32 v123, v110, v111
    buffer_store_dwordx4 v[112:115], v11, s[8:11], s43 offen offset:0 sc1
    buffer_store_dwordx4 v[116:119], v11, s[8:11], s43 offen offset:1024 sc1
    buffer_store_dwordx4 v[120:123], v11, s[8:11], s43 offen offset:2048 sc1
    s_add_u32 s40, s40, 1
    s_and_b32 s24, s40, 1
    s_lshl_b32 s24, s24, 9
    v_add_u32 v9, s24, v12
    s_waitcnt vmcnt(3)
    v_mov_b32 v124, 0
    v_mov_b32 v125, 0
    v_mov_b32 v126, 0
    v_mov_b32 v127, 0
    v_dot2c_f32_bf16 v124, v16, v236
    v_dot2c_f32_bf16 v125, v16, v16
    v_dot2c_f32_bf16 v126, v17, v236
    v_dot2c_f32_bf16 v127, v17, v17
    v_dot2c_f32_bf16 v124, v18, v236
    v_dot2c_f32_bf16 v125, v18, v18
    v_dot2c_f32_bf16 v126, v19, v236
    v_dot2c_f32_bf16 v127, v19, v19
    v_dot2c_f32_bf16 v124, v20, v236
    v_dot2c_f32_bf16 v125, v20, v20
    v_dot2c_f32_bf16 v126, v21, v236
    v_dot2c_f32_bf16 v127, v21, v21
    v_dot2c_f32_bf16 v124, v22, v236
    v_dot2c_f32_bf16 v125, v22, v22
    v_dot2c_f32_bf16 v126, v23, v236
    v_dot2c_f32_bf16 v127, v23, v23
    v_dot2c_f32_bf16 v124, v24, v236
    v_dot2c_f32_bf16 v125, v24, v24
    v_dot2c_f32_bf16 v126, v25, v236
    v_dot2c_f32_bf16 v127, v25, v25
    v_dot2c_f32_bf16 v124, v26, v236
    v_dot2c_f32_bf16 v125, v26, v26
    v_dot2c_f32_bf16 v126, v27, v236
    v_dot2c_f32_bf16 v127, v27, v27
    v_dot2c_f32_bf16 v124, v28, v236
    v_dot2c_f32_bf16 v125, v28, v28
    v_dot2c_f32_bf16 v126, v29, v236
    v_dot2c_f32_bf16 v127, v29, v29
    v_dot2c_f32_bf16 v124, v30, v236
    v_dot2c_f32_bf16 v125, v30, v30
    v_dot2c_f32_bf16 v126, v31, v236
    v_dot2c_f32_bf16 v127, v31, v31
    v_dot2c_f32_bf16 v124, v32, v236
    v_dot2c_f32_bf16 v125, v32, v32
    v_dot2c_f32_bf16 v126, v33, v236
    v_dot2c_f32_bf16 v127, v33, v33
    v_dot2c_f32_bf16 v124, v34, v236
    v_dot2c_f32_bf16 v125, v34, v34
    v_dot2c_f32_bf16 v126, v35, v236
    v_dot2c_f32_bf16 v127, v35, v35
    v_dot2c_f32_bf16 v124, v36, v236
    v_dot2c_f32_bf16 v125, v36, v36
    v_dot2c_f32_bf16 v126, v37, v236
    v_dot2c_f32_bf16 v127, v37, v37
    v_dot2c_f32_bf16 v124, v38, v236
    v_dot2c_f32_bf16 v125, v38, v38
    v_dot2c_f32_bf16 v126, v39, v236
    v_dot2c_f32_bf16 v127, v39, v39
    v_dot2c_f32_bf16 v124, v40, v236
    v_dot2c_f32_bf16 v125, v40, v40
    v_dot2c_f32_bf16 v126, v41, v236
    v_dot2c_f32_bf16 v127, v41, v41
    v_dot2c_f32_bf16 v124, v42, v236
    v_dot2c_f32_bf16 v125, v42, v42
    v_dot2c_f32_bf16 v126, v43, v236
    v_dot2c_f32_bf16 v127, v43, v43
    v_dot2c_f32_bf16 v124, v44, v236
    v_dot2c_f32_bf16 v125, v44, v44
    v_dot2c_f32_bf16 v126, v45, v236
    v_dot2c_f32_bf16 v127, v45, v45
    v_dot2c_f32_bf16 v124, v46, v236
    v_dot2c_f32_bf16 v125, v46, v46
    v_dot2c_f32_bf16 v126, v47, v236
    v_dot2c_f32_bf16 v127, v47, v47
    v_dot2c_f32_bf16 v124, v48, v236
    v_dot2c_f32_bf16 v125, v48, v48
    v_dot2c_f32_bf16 v126, v49, v236
    v_dot2c_f32_bf16 v127, v49, v49
    v_dot2c_f32_bf16 v124, v50, v236
    v_dot2c_f32_bf16 v125, v50, v50
    v_dot2c_f32_bf16 v126, v51, v236
    v_dot2c_f32_bf16 v127, v51, v51
    v_dot2c_f32_bf16 v124, v52, v236
    v_dot2c_f32_bf16 v125, v52, v52
    v_dot2c_f32_bf16 v126, v53, v236
    v_dot2c_f32_bf16 v127, v53, v53
    v_dot2c_f32_bf16 v124, v54, v236
    v_dot2c_f32_bf16 v125, v54, v54
    v_dot2c_f32_bf16 v126, v55, v236
    v_dot2c_f32_bf16 v127, v55, v55
    s_nop 1
    v_add_f32 v124, v124, v126
    v_add_f32 v125, v125, v127
    v_mov_b32 v126, v124
    v_mov_b32 v127, v125
    s_nop 0
    v_permlane16_swap_b32 v124, v126
    v_permlane16_swap_b32 v125, v127
    v_add_f32 v124, v124, v126
    v_add_f32 v125, v125, v127
    v_mov_b32 v126, v124
    v_mov_b32 v127, v125
    s_nop 0
    v_permlane32_swap_b32 v124, v126
    v_permlane32_swap_b32 v125, v127
    v_add_f32 v124, v124, v126
    v_add_f32 v125, v125, v127
    ds_write_b128 v10, v[16:19] offset:0
    ds_write_b128 v10, v[20:23] offset:1024
    ds_write_b128 v10, v[24:27] offset:2048
    ds_write_b128 v10, v[28:31] offset:3072
    ds_write_b128 v10, v[32:35] offset:4096
    ds_write_b128 v10, v[36:39] offset:5120
    ds_write_b128 v10, v[40:43] offset:6144
    ds_write_b128 v10, v[44:47] offset:7168
    ds_write_b128 v10, v[48:51] offset:8192
    ds_write_b128 v10, v[52:55] offset:9216
    ds_write_b64 v9, v[124:125]
    s_add_u32 s43, s43, 393216
    s_waitcnt lgkmcnt(0)
    s_barrier
interleave_layers__linear_attn_block__memory_aug_recurrent_mem_tr__prompt_kernel_p_next:
    s_cmp_lt_u32 s40, 2
    s_cbranch_scc1 interleave_layers__linear_attn_block__memory_aug_recurrent_mem_tr__prompt_kernel_p_pub
    s_add_u32 s24, s64, 24
    s_cmp_le_u32 s24, s40
    s_cbranch_scc1 interleave_layers__linear_attn_block__memory_aug_recurrent_mem_tr__prompt_kernel_p_pub
    s_cmp_lt_u32 s40, 64
    s_cbranch_scc1 interleave_layers__linear_attn_block__memory_aug_recurrent_mem_tr__prompt_kernel_p_seg
interleave_layers__linear_attn_block__memory_aug_recurrent_mem_tr__prompt_kernel_p_pub:
    s_waitcnt vmcnt(0)
    s_barrier
    s_cmp_eq_u32 s3, 0
    s_cbranch_scc0 interleave_layers__linear_attn_block__memory_aug_recurrent_mem_tr__prompt_kernel_fp29
    v_mov_b32 v15, s40
    buffer_store_dword v15, v14, s[8:11], 0 offen sc1
interleave_layers__linear_attn_block__memory_aug_recurrent_mem_tr__prompt_kernel_fp29:
    s_add_u32 s24, s64, 24
    s_cmp_le_u32 s24, s40
    s_cbranch_scc1 interleave_layers__linear_attn_block__memory_aug_recurrent_mem_tr__prompt_kernel_p_x
    s_cmp_lt_u32 s40, 64
    s_cbranch_scc1 interleave_layers__linear_attn_block__memory_aug_recurrent_mem_tr__prompt_kernel_p_seg
    s_cmp_ge_u32 s64, 64
    s_cbranch_scc1 interleave_layers__linear_attn_block__memory_aug_recurrent_mem_tr__prompt_kernel_p_done
interleave_layers__linear_attn_block__memory_aug_recurrent_mem_tr__prompt_kernel_p_x:
    s_add_u32 s63, s64, 1
    s_cmp_ge_i32 s69, s63
    s_cbranch_scc1 interleave_layers__linear_attn_block__memory_aug_recurrent_mem_tr__prompt_kernel_x_en_ok
    s_mov_b32 s61, 0
interleave_layers__linear_attn_block__memory_aug_recurrent_mem_tr__prompt_kernel_x_en:
    buffer_load_dword v253, v252, s[8:11], 0 offen sc1
    s_waitcnt vmcnt(0)
    v_readlane_b32 s69, v253, 0
    v_readlane_b32 s24, v253, 1
    s_min_i32 s69, s69, s24
    v_readlane_b32 s24, v253, 2
    s_min_i32 s69, s69, s24
    v_readlane_b32 s24, v253, 3
    s_min_i32 s69, s69, s24
    v_readlane_b32 s24, v253, 4
    s_min_i32 s69, s69, s24
    v_readlane_b32 s24, v253, 5
    s_min_i32 s69, s69, s24
    v_readlane_b32 s24, v253, 6
    s_min_i32 s69, s69, s24
    v_readlane_b32 s24, v253, 7
    s_min_i32 s69, s69, s24
    s_cmp_ge_i32 s69, s63
    s_cbranch_scc1 interleave_layers__linear_attn_block__memory_aug_recurrent_mem_tr__prompt_kernel_x_en_ok
    s_add_u32 s61, s61, 1
    s_cmp_ge_u32 s61, s60
    s_cbranch_scc1 interleave_layers__linear_attn_block__memory_aug_recurrent_mem_tr__prompt_kernel_x_en_to
    s_sleep 2
    s_branch interleave_layers__linear_attn_block__memory_aug_recurrent_mem_tr__prompt_kernel_x_en
interleave_layers__linear_attn_block__memory_aug_recurrent_mem_tr__prompt_kernel_x_en_to:
    s_mov_b32 s60, 1
interleave_layers__linear_attn_block__memory_aug_recurrent_mem_tr__prompt_kernel_x_en_ok:
    s_lshl_b32 s95, s92, 6
    s_add_u32 s95, s95, s64
    s_add_u32 s95, s95, 1
    s_cmp_ge_i32 s59, s95
    s_cbranch_scc1 interleave_layers__linear_attn_block__memory_aug_recurrent_mem_tr__prompt_kernel_x_ec_ok
    s_and_b32 s24, s2, 7
    s_lshl_b32 s24, s24, 7
    s_add_u32 s24, s24, 23109632
    v_and_b32 v254, 3, v1
    v_lshl_add_u32 v254, v254, 2, s24
    s_mov_b32 s61, 0
interleave_layers__linear_attn_block__memory_aug_recurrent_mem_tr__prompt_kernel_x_ec:
    buffer_load_dword v253, v254, s[8:11], 0 offen sc1
    s_waitcnt vmcnt(0)
    v_readlane_b32 s59, v253, 0
    v_readlane_b32 s24, v253, 1
    s_min_i32 s59, s59, s24
    v_readlane_b32 s24, v253, 2
    s_min_i32 s59, s59, s24
    v_readlane_b32 s24, v253, 3
    s_min_i32 s59, s59, s24
    s_cmp_ge_i32 s59, s95
    s_cbranch_scc1 interleave_layers__linear_attn_block__memory_aug_recurrent_mem_tr__prompt_kernel_x_ec_ok
    s_add_u32 s61, s61, 1
    s_cmp_ge_u32 s61, s60
    s_cbranch_scc1 interleave_layers__linear_attn_block__memory_aug_recurrent_mem_tr__prompt_kernel_x_ec_to
    s_sleep 2
    s_branch interleave_layers__linear_attn_block__memory_aug_recurrent_mem_tr__prompt_kernel_x_ec
interleave_layers__linear_attn_block__memory_aug_recurrent_mem_tr__prompt_kernel_x_ec_to:
    s_mov_b32 s60, 1
interleave_layers__linear_attn_block__memory_aug_recurrent_mem_tr__prompt_kernel_x_ec_ok:
    s_add_u32 s52, s65, 32768
    buffer_load_dwordx4 v[16:19], v240, s[8:11], s65 offen offset:0 sc1
    buffer_load_dwordx4 v[20:23], v240, s[8:11], s65 offen offset:1024 sc1
    buffer_load_dwordx4 v[24:27], v240, s[8:11], s65 offen offset:2048 sc1
    buffer_load_dwordx4 v[28:31], v240, s[8:11], s65 offen offset:3072 sc1
    buffer_load_dwordx4 v[32:35], v241, s[8:11], s65 offen offset:0 sc1
    buffer_load_dwordx4 v[36:39], v241, s[8:11], s65 offen offset:1024 sc1
    buffer_load_dwordx4 v[40:43], v241, s[8:11], s65 offen offset:2048 sc1
    buffer_load_dwordx4 v[44:47], v241, s[8:11], s65 offen offset:3072 sc1
    buffer_load_dwordx4 v[48:51], v240, s[8:11], s52 offen offset:0 sc1
    buffer_load_dwordx4 v[52:55], v240, s[8:11], s52 offen offset:1024 sc1
    buffer_load_dwordx4 v[56:59], v240, s[8:11], s52 offen offset:2048 sc1
    buffer_load_dwordx4 v[60:63], v240, s[8:11], s52 offen offset:3072 sc1
    buffer_load_dwordx4 v[64:67], v241, s[8:11], s52 offen offset:0 sc1
    buffer_load_dwordx4 v[68:71], v241, s[8:11], s52 offen offset:1024 sc1
    buffer_load_dwordx4 v[72:75], v241, s[8:11], s52 offen offset:2048 sc1
    buffer_load_dwordx4 v[76:79], v241, s[8:11], s52 offen offset:3072 sc1
    s_add_u32 s24, s68, s73
    buffer_load_dwordx4 v[196:199], v219, s[8:11], s24 offen sc1
    s_mov_b32 s61, 0
interleave_layers__linear_attn_block__memory_aug_recurrent_mem_tr__prompt_kernel_x_p0:
    buffer_load_dwordx4 v[140:143], v215, s[8:11], s67 offen offset:3072 sc1
    s_waitcnt vmcnt(0)
    v_max3_u32 v192, v140, v141, v142
    v_max_u32 v192, v192, v143
    v_cmp_eq_u32 vcc, -1, v192
    s_add_u32 s61, s61, 1
    s_cbranch_vccz interleave_layers__linear_attn_block__memory_aug_recurrent_mem_tr__prompt_kernel_x_p0_out
    s_cmp_ge_u32 s61, s60
    s_cbranch_scc1 interleave_layers__linear_attn_block__memory_aug_recurrent_mem_tr__prompt_kernel_x_p0_to
    s_sleep 8
    s_branch interleave_layers__linear_attn_block__memory_aug_recurrent_mem_tr__prompt_kernel_x_p0
interleave_layers__linear_attn_block__memory_aug_recurrent_mem_tr__prompt_kernel_x_p0_to:
    s_mov_b32 s60, 1
interleave_layers__linear_attn_block__memory_aug_recurrent_mem_tr__prompt_kernel_x_p0_out:
    s_mov_b32 s61, 0
interleave_layers__linear_attn_block__memory_aug_recurrent_mem_tr__prompt_kernel_x_p1:
    buffer_load_dwordx4 v[80:83], v212, s[8:11], s67 offen offset:0 sc1
    buffer_load_dwordx4 v[84:87], v212, s[8:11], s67 offen offset:1024 sc1
    buffer_load_dwordx4 v[88:91], v212, s[8:11], s67 offen offset:2048 sc1
    buffer_load_dwordx4 v[92:95], v212, s[8:11], s67 offen offset:3072 sc1
    buffer_load_dwordx4 v[96:99], v213, s[8:11], s67 offen offset:0 sc1
    buffer_load_dwordx4 v[100:103], v213, s[8:11], s67 offen offset:1024 sc1
    buffer_load_dwordx4 v[104:107], v213, s[8:11], s67 offen offset:2048 sc1
    buffer_load_dwordx4 v[108:111], v213, s[8:11], s67 offen offset:3072 sc1
    buffer_load_dwordx4 v[112:115], v214, s[8:11], s67 offen offset:0 sc1
    buffer_load_dwordx4 v[116:119], v214, s[8:11], s67 offen offset:1024 sc1
    buffer_load_dwordx4 v[120:123], v214, s[8:11], s67 offen offset:2048 sc1
    buffer_load_dwordx4 v[124:127], v214, s[8:11], s67 offen offset:3072 sc1
    buffer_load_dwordx4 v[128:131], v215, s[8:11], s67 offen offset:0 sc1
    buffer_load_dwordx4 v[132:135], v215, s[8:11], s67 offen offset:1024 sc1
    buffer_load_dwordx4 v[136:139], v215, s[8:11], s67 offen offset:2048 sc1
    buffer_load_dwordx4 v[140:143], v215, s[8:11], s67 offen offset:3072 sc1
    buffer_load_dwordx4 v[144:147], v216, s[8:11], s67 offen offset:0 sc1
    buffer_load_dwordx4 v[148:151], v216, s[8:11], s67 offen offset:1024 sc1
    buffer_load_dwordx4 v[152:155], v216, s[8:11], s67 offen offset:2048 sc1
    buffer_load_dwordx4 v[156:159], v216, s[8:11], s67 offen offset:3072 sc1
    s_waitcnt vmcnt(0)
    v_max3_u32 v192, v80, v81, v82
    v_max3_u32 v192, v192, v83, v84
    v_max3_u32 v192, v192, v85, v86
    v_max3_u32 v192, v192, v87, v88
    v_max3_u32 v192, v192, v89, v90
    v_max3_u32 v192, v192, v91, v92
    v_max3_u32 v192, v192, v93, v94
    v_max3_u32 v192, v192, v95, v96
    v_max3_u32 v192, v192, v97, v98
    v_max3_u32 v192, v192, v99, v100
    v_max3_u32 v192, v192, v101, v102
    v_max3_u32 v192, v192, v103, v104
    v_max3_u32 v192, v192, v105, v106
    v_max3_u32 v192, v192, v107, v108
    v_max3_u32 v192, v192, v109, v110
    v_max3_u32 v192, v192, v111, v112
    v_max3_u32 v192, v192, v113, v114
    v_max3_u32 v192, v192, v115, v116
    v_max3_u32 v192, v192, v117, v118
    v_max3_u32 v192, v192, v119, v120
    v_max3_u32 v192, v192, v121, v122
    v_max3_u32 v192, v192, v123, v124
    v_max3_u32 v192, v192, v125, v126
    v_max3_u32 v192, v192, v127, v128
    v_max3_u32 v192, v192, v129, v130
    v_max3_u32 v192, v192, v131, v132
    v_max3_u32 v192, v192, v133, v134
    v_max3_u32 v192, v192, v135, v136
    v_max3_u32 v192, v192, v137, v138
    v_max3_u32 v192, v192, v139, v140
    v_max3_u32 v192, v192, v141, v142
    v_max3_u32 v192, v192, v143, v144
    v_max3_u32 v192, v192, v145, v146
    v_max3_u32 v192, v192, v147, v148
    v_max3_u32 v192, v192, v149, v150
    v_max3_u32 v192, v192, v151, v152
    v_max3_u32 v192, v192, v153, v154
    v_max3_u32 v192, v192, v155, v156
    v_max3_u32 v192, v192, v157, v158
    v_max_u32 v192, v192, v159
    v_cmp_eq_u32 vcc, -1, v192
    s_add_u32 s61, s61, 1
    s_cbranch_vccz interleave_layers__linear_attn_block__memory_aug_recurrent_mem_tr__prompt_kernel_x_p1_out
    s_cmp_ge_u32 s61, s60
    s_cbranch_scc1 interleave_layers__linear_attn_block__memory_aug_recurrent_mem_tr__prompt_kernel_x_p1_to
    s_sleep 2
    s_branch interleave_layers__linear_attn_block__memory_aug_recurrent_mem_tr__prompt_kernel_x_p1
interleave_layers__linear_attn_block__memory_aug_recurrent_mem_tr__prompt_kernel_x_p1_to:
    s_mov_b32 s60, 1
interleave_layers__linear_attn_block__memory_aug_recurrent_mem_tr__prompt_kernel_x_p1_out:
    s_add_u32 s53, s66, 8192
    s_mov_b32 s61, 0
interleave_layers__linear_attn_block__memory_aug_recurrent_mem_tr__prompt_kernel_x_v:
    buffer_load_dwordx4 v[160:163], v242, s[8:11], s66 offen offset:0 sc1
    buffer_load_dwordx4 v[164:167], v242, s[8:11], s66 offen offset:1024 sc1
    buffer_load_dwordx4 v[168:171], v242, s[8:11], s53 offen offset:0 sc1
    buffer_load_dwordx4 v[172:175], v242, s[8:11], s53 offen offset:1024 sc1
    s_waitcnt vmcnt(0)
    v_max3_u32 v192, v160, v161, v162
    v_max3_u32 v192, v192, v163, v164
    v_max3_u32 v192, v192, v165, v166
    v_max3_u32 v192, v192, v167, v168
    v_max3_u32 v192, v192, v169, v170
    v_max3_u32 v192, v192, v171, v172
    v_max3_u32 v192, v192, v173, v174
    v_max_u32 v192, v192, v175
    v_cmp_eq_u32 vcc, -1, v192
    s_add_u32 s61, s61, 1
    s_cbranch_vccz interleave_layers__linear_attn_block__memory_aug_recurrent_mem_tr__prompt_kernel_x_v_out
    s_cmp_ge_u32 s61, s60
    s_cbranch_scc1 interleave_layers__linear_attn_block__memory_aug_recurrent_mem_tr__prompt_kernel_x_v_to
    s_sleep 2
    s_branch interleave_layers__linear_attn_block__memory_aug_recurrent_mem_tr__prompt_kernel_x_v
interleave_layers__linear_attn_block__memory_aug_recurrent_mem_tr__prompt_kernel_x_v_to:
    s_mov_b32 s60, 1
interleave_layers__linear_attn_block__memory_aug_recurrent_mem_tr__prompt_kernel_x_v_out:
    v_mfma_f32_16x16x32_bf16 v[176:179], v[16:19], v[80:83], 0
    v_mfma_f32_16x16x32_bf16 v[180:183], v[16:19], v[84:87], 0
    v_mfma_f32_16x16x32_bf16 v[184:187], v[48:51], v[80:83], 0
    v_mfma_f32_16x16x32_bf16 v[188:191], v[48:51], v[84:87], 0
    v_mfma_f32_16x16x32_bf16 v[176:179], v[20:23], v[88:91], v[176:179]
    v_mfma_f32_16x16x32_bf16 v[180:183], v[20:23], v[92:95], v[180:183]
    v_mfma_f32_16x16x32_bf16 v[184:187], v[52:55], v[88:91], v[184:187]
    v_mfma_f32_16x16x32_bf16 v[188:191], v[52:55], v[92:95], v[188:191]
    v_mfma_f32_16x16x32_bf16 v[176:179], v[24:27], v[96:99], v[176:179]
    v_mfma_f32_16x16x32_bf16 v[180:183], v[24:27], v[100:103], v[180:183]
    v_mfma_f32_16x16x32_bf16 v[184:187], v[56:59], v[96:99], v[184:187]
    v_mfma_f32_16x16x32_bf16 v[188:191], v[56:59], v[100:103], v[188:191]
    v_mfma_f32_16x16x32_bf16 v[176:179], v[28:31], v[104:107], v[176:179]
    v_mfma_f32_16x16x32_bf16 v[180:183], v[28:31], v[108:111], v[180:183]
    v_mfma_f32_16x16x32_bf16 v[184:187], v[60:63], v[104:107], v[184:187]
    v_mfma_f32_16x16x32_bf16 v[188:191], v[60:63], v[108:111], v[188:191]
    v_mfma_f32_16x16x32_bf16 v[176:179], v[32:35], v[112:115], v[176:179]
    v_mfma_f32_16x16x32_bf16 v[180:183], v[32:35], v[116:119], v[180:183]
    v_mfma_f32_16x16x32_bf16 v[184:187], v[64:67], v[112:115], v[184:187]
    v_mfma_f32_16x16x32_bf16 v[188:191], v[64:67], v[116:119], v[188:191]
    v_mfma_f32_16x16x32_bf16 v[176:179], v[36:39], v[120:123], v[176:179]
    v_mfma_f32_16x16x32_bf16 v[180:183], v[36:39], v[124:127], v[180:183]
    v_mfma_f32_16x16x32_bf16 v[184:187], v[68:71], v[120:123], v[184:187]
    v_mfma_f32_16x16x32_bf16 v[188:191], v[68:71], v[124:127], v[188:191]
    v_mfma_f32_16x16x32_bf16 v[176:179], v[40:43], v[128:131], v[176:179]
    v_mfma_f32_16x16x32_bf16 v[180:183], v[40:43], v[132:135], v[180:183]
    v_mfma_f32_16x16x32_bf16 v[184:187], v[72:75], v[128:131], v[184:187]
    v_mfma_f32_16x16x32_bf16 v[188:191], v[72:75], v[132:135], v[188:191]
    v_mfma_f32_16x16x32_bf16 v[176:179], v[44:47], v[136:139], v[176:179]
    v_mfma_f32_16x16x32_bf16 v[180:183], v[44:47], v[140:143], v[180:183]
    v_mfma_f32_16x16x32_bf16 v[184:187], v[76:79], v[136:139], v[184:187]
    v_mfma_f32_16x16x32_bf16 v[188:191], v[76:79], v[140:143], v[188:191]
    v_mfma_f32_16x16x32_bf16 v[176:179], v[160:163], v[144:147], v[176:179]
    v_mfma_f32_16x16x32_bf16 v[180:183], v[160:163], v[148:151], v[180:183]
    v_mfma_f32_16x16x32_bf16 v[184:187], v[168:171], v[144:147], v[184:187]
    v_mfma_f32_16x16x32_bf16 v[188:191], v[168:171], v[148:151], v[188:191]
    v_mfma_f32_16x16x32_bf16 v[176:179], v[164:167], v[152:155], v[176:179]
    v_mfma_f32_16x16x32_bf16 v[180:183], v[164:167], v[156:159], v[180:183]
    v_mfma_f32_16x16x32_bf16 v[184:187], v[172:175], v[152:155], v[184:187]
    v_mfma_f32_16x16x32_bf16 v[188:191], v[172:175], v[156:159], v[188:191]
    s_nop 4
    ds_write_b128 v217, v[176:179] offset:0
    ds_write_b128 v217, v[180:183] offset:1024
    ds_write_b128 v217, v[184:187] offset:2048
    ds_write_b128 v217, v[188:191] offset:3072
    s_waitcnt lgkmcnt(0)
    s_barrier
    s_cmp_ge_u32 s3, 2
    s_cbranch_scc1 interleave_layers__linear_attn_block__memory_aug_recurrent_mem_tr__prompt_kernel_xs30
    ds_read_b128 v[16:19], v218 offset:0
    ds_read_b128 v[20:23], v218 offset:4096
    ds_read_b128 v[24:27], v218 offset:8192
    ds_read_b128 v[28:31], v218 offset:12288
    ds_read_b128 v[32:35], v218 offset:2048
    ds_read_b128 v[36:39], v218 offset:6144
    ds_read_b128 v[40:43], v218 offset:10240
    ds_read_b128 v[44:47], v218 offset:14336
    s_waitcnt lgkmcnt(4)
    v_pk_add_f32 v[16:17], v[16:17], v[20:21]
    v_pk_add_f32 v[24:25], v[24:25], v[28:29]
    v_pk_add_f32 v[18:19], v[18:19], v[22:23]
    v_pk_add_f32 v[26:27], v[26:27], v[30:31]
    v_pk_add_f32 v[16:17], v[16:17], v[24:25]
    v_pk_add_f32 v[18:19], v[18:19], v[26:27]
    v_cvt_pk_bf16_f32 v20, v16, v17
    v_cvt_pk_bf16_f32 v21, v18, v19
    v_lshlrev_b32 v16, 16, v20
    v_and_b32 v17, 0xffff0000, v20
    v_lshlrev_b32 v22, 16, v196
    v_and_b32 v23, 0xffff0000, v196
    v_pk_add_f32 v[16:17], v[16:17], v[22:23]
    v_cvt_pk_bf16_f32 v48, v16, v17
    v_lshlrev_b32 v16, 16, v21
    v_and_b32 v17, 0xffff0000, v21
    v_lshlrev_b32 v22, 16, v197
    v_and_b32 v23, 0xffff0000, v197
    v_pk_add_f32 v[16:17], v[16:17], v[22:23]
    v_cvt_pk_bf16_f32 v49, v16, v17
    s_waitcnt lgkmcnt(0)
    v_pk_add_f32 v[32:33], v[32:33], v[36:37]
    v_pk_add_f32 v[40:41], v[40:41], v[44:45]
    v_pk_add_f32 v[34:35], v[34:35], v[38:39]
    v_pk_add_f32 v[42:43], v[42:43], v[46:47]
    v_pk_add_f32 v[32:33], v[32:33], v[40:41]
    v_pk_add_f32 v[34:35], v[34:35], v[42:43]
    v_cvt_pk_bf16_f32 v36, v32, v33
    v_cvt_pk_bf16_f32 v37, v34, v35
    v_lshlrev_b32 v32, 16, v36
    v_and_b32 v33, 0xffff0000, v36
    v_lshlrev_b32 v38, 16, v198
    v_and_b32 v39, 0xffff0000, v198
    v_pk_add_f32 v[32:33], v[32:33], v[38:39]
    v_cvt_pk_bf16_f32 v50, v32, v33
    v_lshlrev_b32 v32, 16, v37
    v_and_b32 v33, 0xffff0000, v37
    v_lshlrev_b32 v38, 16, v199
    v_and_b32 v39, 0xffff0000, v199
    v_pk_add_f32 v[32:33], v[32:33], v[38:39]
    v_cvt_pk_bf16_f32 v51, v32, v33
    s_cmp_eq_u32 s92, 0
    s_cbranch_scc0 interleave_layers__linear_attn_block__memory_aug_recurrent_mem_tr__prompt_kernel_xo31
    s_add_u32 s24, s68, 4194304
    buffer_store_dwordx4 v[48:51], v219, s[8:11], s24 offen sc1
    s_branch interleave_layers__linear_attn_block__memory_aug_recurrent_mem_tr__prompt_kernel_xs30
interleave_layers__linear_attn_block__memory_aug_recurrent_mem_tr__prompt_kernel_xo31:
    buffer_store_dwordx2 v[48:49], v243, s[12:15], s68 offen
    buffer_store_dwordx2 v[50:51], v243, s[12:15], s68 offen offset:32
interleave_layers__linear_attn_block__memory_aug_recurrent_mem_tr__prompt_kernel_xs30:
    s_waitcnt vmcnt(0)
    s_barrier
    s_cmp_eq_u32 s92, 0
    s_cbranch_scc0 interleave_layers__linear_attn_block__memory_aug_recurrent_mem_tr__prompt_kernel_xp32
    s_lshl_b32 s24, s71, 7
    s_lshl_b32 s25, s70, 2
    s_add_u32 s24, s24, s25
    s_add_u32 s24, s24, 23107584
    s_lshr_b32 s25, s64, 2
    s_add_u32 s25, s25, 1
    s_cmp_eq_u32 s3, 0
    s_cbranch_scc0 interleave_layers__linear_attn_block__memory_aug_recurrent_mem_tr__prompt_kernel_pb33
    v_lshlrev_b32 v244, 7, v1
    v_add_u32 v244, s24, v244
    v_mov_b32 v245, 2146435072
    v_cmp_le_u32 vcc, 1, v1
    s_nop 1
    v_cndmask_b32 v244, v244, v245, vcc
    v_mov_b32 v245, s25
    buffer_store_dword v245, v244, s[8:11], 0 offen sc1
interleave_layers__linear_attn_block__memory_aug_recurrent_mem_tr__prompt_kernel_pb33:
interleave_layers__linear_attn_block__memory_aug_recurrent_mem_tr__prompt_kernel_xp32:
    s_add_u32 s64, s64, 4
    s_add_u32 s65, s65, 5242880
    s_add_u32 s66, s66, 1835008
    s_add_u32 s67, s67, 1835008
    s_add_u32 s68, s68, 163840
    s_branch interleave_layers__linear_attn_block__memory_aug_recurrent_mem_tr__prompt_kernel_p_next
interleave_layers__linear_attn_block__memory_aug_recurrent_mem_tr__prompt_kernel_p_done:
    s_cmp_eq_u32 s92, 0
    s_cbranch_scc0 interleave_layers__linear_attn_block__memory_aug_recurrent_mem_tr__prompt_kernel_end
    s_mov_b32 s92, 1
    s_branch interleave_layers__linear_attn_block__memory_aug_recurrent_mem_tr__prompt_kernel_p_layer
interleave_layers__linear_attn_block__memory_aug_recurrent_mem_tr__prompt_kernel_roleO:
    s_sub_u32 s44, s2, 200
    s_load_dwordx2 s[6:7], s[0:1], 64
    s_waitcnt lgkmcnt(0)
    s_mov_b32 s12, s6
    s_mov_b32 s13, s7
    s_mov_b32 s14, 7864320
    s_mov_b32 s15, 0x00020000
    v_add_u32 v8, 0, v0
    s_mov_b32 s24, 3277
    v_mul_lo_u32 v9, v8, s24
    v_lshrrev_b32 v9, 18, v9
    v_mul_u32_u24 v10, 80, v9
    v_sub_u32 v10, v8, v10
    v_mul_u32_u24 v16, 1312, v9
    v_lshl_add_u32 v16, v10, 4, v16
    v_add_u32 v8, 256, v0
    s_mov_b32 s24, 3277
    v_mul_lo_u32 v9, v8, s24
    v_lshrrev_b32 v9, 18, v9
    v_mul_u32_u24 v10, 80, v9
    v_sub_u32 v10, v8, v10
    v_mul_u32_u24 v17, 1312, v9
    v_lshl_add_u32 v17, v10, 4, v17
    v_add_u32 v8, 512, v0
    s_mov_b32 s24, 3277
    v_mul_lo_u32 v9, v8, s24
    v_lshrrev_b32 v9, 18, v9
    v_mul_u32_u24 v10, 80, v9
    v_sub_u32 v10, v8, v10
    v_mul_u32_u24 v18, 1312, v9
    v_lshl_add_u32 v18, v10, 4, v18
    v_add_u32 v8, 768, v0
    s_mov_b32 s24, 3277
    v_mul_lo_u32 v9, v8, s24
    v_lshrrev_b32 v9, 18, v9
    v_mul_u32_u24 v10, 80, v9
    v_sub_u32 v10, v8, v10
    v_mul_u32_u24 v19, 1312, v9
    v_lshl_add_u32 v19, v10, 4, v19
    v_add_u32 v8, 1024, v0
    s_mov_b32 s24, 3277
    v_mul_lo_u32 v9, v8, s24
    v_lshrrev_b32 v9, 18, v9
    v_mul_u32_u24 v10, 80, v9
    v_sub_u32 v10, v8, v10
    v_mul_u32_u24 v20, 1312, v9
    v_lshl_add_u32 v20, v10, 4, v20
    v_add_u32 v8, 1280, v0
    s_mov_b32 s24, 3277
    v_mul_lo_u32 v9, v8, s24
    v_lshrrev_b32 v9, 18, v9
    v_mul_u32_u24 v10, 80, v9
    v_sub_u32 v10, v8, v10
    v_mul_u32_u24 v21, 1312, v9
    v_lshl_add_u32 v21, v10, 4, v21
    v_add_u32 v8, 1536, v0
    s_mov_b32 s24, 3277
    v_mul_lo_u32 v9, v8, s24
    v_lshrrev_b32 v9, 18, v9
    v_mul_u32_u24 v10, 80, v9
    v_sub_u32 v10, v8, v10
    v_mul_u32_u24 v22, 1312, v9
    v_lshl_add_u32 v22, v10, 4, v22
    v_add_u32 v8, 1792, v0
    s_mov_b32 s24, 3277
    v_mul_lo_u32 v9, v8, s24
    v_lshrrev_b32 v9, 18, v9
    v_mul_u32_u24 v10, 80, v9
    v_sub_u32 v10, v8, v10
    v_mul_u32_u24 v23, 1312, v9
    v_lshl_add_u32 v23, v10, 4, v23
    v_add_u32 v8, 2048, v0
    s_mov_b32 s24, 3277
    v_mul_lo_u32 v9, v8, s24
    v_lshrrev_b32 v9, 18, v9
    v_mul_u32_u24 v10, 80, v9
    v_sub_u32 v10, v8, v10
    v_mul_u32_u24 v24, 1312, v9
    v_lshl_add_u32 v24, v10, 4, v24
    v_add_u32 v8, 2304, v0
    s_mov_b32 s24, 3277
    v_mul_lo_u32 v9, v8, s24
    v_lshrrev_b32 v9, 18, v9
    v_mul_u32_u24 v10, 80, v9
    v_sub_u32 v10, v8, v10
    v_mul_u32_u24 v25, 1312, v9
    v_lshl_add_u32 v25, v10, 4, v25
    v_add_u32 v8, 2560, v0
    s_mov_b32 s24, 3277
    v_mul_lo_u32 v9, v8, s24
    v_lshrrev_b32 v9, 18, v9
    v_mul_u32_u24 v10, 80, v9
    v_sub_u32 v10, v8, v10
    v_mul_u32_u24 v26, 1312, v9
    v_lshl_add_u32 v26, v10, 4, v26
    v_add_u32 v8, 2816, v0
    s_mov_b32 s24, 3277
    v_mul_lo_u32 v9, v8, s24
    v_lshrrev_b32 v9, 18, v9
    v_mul_u32_u24 v10, 80, v9
    v_sub_u32 v10, v8, v10
    v_mul_u32_u24 v27, 1312, v9
    v_lshl_add_u32 v27, v10, 4, v27
    v_add_u32 v8, 3072, v0
    s_mov_b32 s24, 3277
    v_mul_lo_u32 v9, v8, s24
    v_lshrrev_b32 v9, 18, v9
    v_mul_u32_u24 v10, 80, v9
    v_sub_u32 v10, v8, v10
    v_mul_u32_u24 v28, 1312, v9
    v_lshl_add_u32 v28, v10, 4, v28
    v_add_u32 v8, 3328, v0
    s_mov_b32 s24, 3277
    v_mul_lo_u32 v9, v8, s24
    v_lshrrev_b32 v9, 18, v9
    v_mul_u32_u24 v10, 80, v9
    v_sub_u32 v10, v8, v10
    v_mul_u32_u24 v29, 1312, v9
    v_lshl_add_u32 v29, v10, 4, v29
    v_add_u32 v8, 3584, v0
    s_mov_b32 s24, 3277
    v_mul_lo_u32 v9, v8, s24
    v_lshrrev_b32 v9, 18, v9
    v_mul_u32_u24 v10, 80, v9
    v_sub_u32 v10, v8, v10
    v_mul_u32_u24 v30, 1312, v9
    v_lshl_add_u32 v30, v10, 4, v30
    v_add_u32 v8, 3840, v0
    s_mov_b32 s24, 3277
    v_mul_lo_u32 v9, v8, s24
    v_lshrrev_b32 v9, 18, v9
    v_mul_u32_u24 v10, 80, v9
    v_sub_u32 v10, v8, v10
    v_mul_u32_u24 v31, 1312, v9
    v_lshl_add_u32 v31, v10, 4, v31
    v_add_u32 v8, 4096, v0
    s_mov_b32 s24, 3277
    v_mul_lo_u32 v9, v8, s24
    v_lshrrev_b32 v9, 18, v9
    v_mul_u32_u24 v10, 80, v9
    v_sub_u32 v10, v8, v10
    v_mul_u32_u24 v32, 1312, v9
    v_lshl_add_u32 v32, v10, 4, v32
    v_add_u32 v8, 4352, v0
    s_mov_b32 s24, 3277
    v_mul_lo_u32 v9, v8, s24
    v_lshrrev_b32 v9, 18, v9
    v_mul_u32_u24 v10, 80, v9
    v_sub_u32 v10, v8, v10
    v_mul_u32_u24 v33, 1312, v9
    v_lshl_add_u32 v33, v10, 4, v33
    v_add_u32 v8, 4608, v0
    s_mov_b32 s24, 3277
    v_mul_lo_u32 v9, v8, s24
    v_lshrrev_b32 v9, 18, v9
    v_mul_u32_u24 v10, 80, v9
    v_sub_u32 v10, v8, v10
    v_mul_u32_u24 v34, 1312, v9
    v_lshl_add_u32 v34, v10, 4, v34
    v_add_u32 v8, 4864, v0
    s_mov_b32 s24, 3277
    v_mul_lo_u32 v9, v8, s24
    v_lshrrev_b32 v9, 18, v9
    v_mul_u32_u24 v10, 80, v9
    v_sub_u32 v10, v8, v10
    v_mul_u32_u24 v35, 1312, v9
    v_lshl_add_u32 v35, v10, 4, v35
    v_add_u32 v8, 5120, v0
    s_mov_b32 s24, 3277
    v_mul_lo_u32 v9, v8, s24
    v_lshrrev_b32 v9, 18, v9
    v_mul_u32_u24 v10, 80, v9
    v_sub_u32 v10, v8, v10
    v_mul_u32_u24 v36, 1312, v9
    v_lshl_add_u32 v36, v10, 4, v36
    v_add_u32 v8, 5376, v0
    s_mov_b32 s24, 3277
    v_mul_lo_u32 v9, v8, s24
    v_lshrrev_b32 v9, 18, v9
    v_mul_u32_u24 v10, 80, v9
    v_sub_u32 v10, v8, v10
    v_mul_u32_u24 v37, 1312, v9
    v_lshl_add_u32 v37, v10, 4, v37
    v_add_u32 v8, 5632, v0
    s_mov_b32 s24, 3277
    v_mul_lo_u32 v9, v8, s24
    v_lshrrev_b32 v9, 18, v9
    v_mul_u32_u24 v10, 80, v9
    v_sub_u32 v10, v8, v10
    v_mul_u32_u24 v38, 1312, v9
    v_lshl_add_u32 v38, v10, 4, v38
    v_add_u32 v8, 5888, v0
    s_mov_b32 s24, 3277
    v_mul_lo_u32 v9, v8, s24
    v_lshrrev_b32 v9, 18, v9
    v_mul_u32_u24 v10, 80, v9
    v_sub_u32 v10, v8, v10
    v_mul_u32_u24 v39, 1312, v9
    v_lshl_add_u32 v39, v10, 4, v39
    v_add_u32 v8, 6144, v0
    s_mov_b32 s24, 3277
    v_mul_lo_u32 v9, v8, s24
    v_lshrrev_b32 v9, 18, v9
    v_mul_u32_u24 v10, 80, v9
    v_sub_u32 v10, v8, v10
    v_mul_u32_u24 v40, 1312, v9
    v_lshl_add_u32 v40, v10, 4, v40
    v_add_u32 v8, 6400, v0
    s_mov_b32 s24, 3277
    v_mul_lo_u32 v9, v8, s24
    v_lshrrev_b32 v9, 18, v9
    v_mul_u32_u24 v10, 80, v9
    v_sub_u32 v10, v8, v10
    v_mul_u32_u24 v41, 1312, v9
    v_lshl_add_u32 v41, v10, 4, v41
    v_add_u32 v8, 6656, v0
    s_mov_b32 s24, 3277
    v_mul_lo_u32 v9, v8, s24
    v_lshrrev_b32 v9, 18, v9
    v_mul_u32_u24 v10, 80, v9
    v_sub_u32 v10, v8, v10
    v_mul_u32_u24 v42, 1312, v9
    v_lshl_add_u32 v42, v10, 4, v42
    v_add_u32 v8, 6912, v0
    s_mov_b32 s24, 3277
    v_mul_lo_u32 v9, v8, s24
    v_lshrrev_b32 v9, 18, v9
    v_mul_u32_u24 v10, 80, v9
    v_sub_u32 v10, v8, v10
    v_mul_u32_u24 v43, 1312, v9
    v_lshl_add_u32 v43, v10, 4, v43
    v_add_u32 v8, 7168, v0
    s_mov_b32 s24, 3277
    v_mul_lo_u32 v9, v8, s24
    v_lshrrev_b32 v9, 18, v9
    v_mul_u32_u24 v10, 80, v9
    v_sub_u32 v10, v8, v10
    v_mul_u32_u24 v44, 1312, v9
    v_lshl_add_u32 v44, v10, 4, v44
    v_add_u32 v8, 7424, v0
    s_mov_b32 s24, 3277
    v_mul_lo_u32 v9, v8, s24
    v_lshrrev_b32 v9, 18, v9
    v_mul_u32_u24 v10, 80, v9
    v_sub_u32 v10, v8, v10
    v_mul_u32_u24 v45, 1312, v9
    v_lshl_add_u32 v45, v10, 4, v45
    v_lshlrev_b32 v4, 4, v0
    s_mul_i32 s45, s44, 245760
    s_add_u32 s46, s45, 0
    buffer_load_dwordx4 v[48:51], v4, s[12:15], s46 offen
    s_add_u32 s46, s45, 4096
    buffer_load_dwordx4 v[52:55], v4, s[12:15], s46 offen
    s_add_u32 s46, s45, 8192
    buffer_load_dwordx4 v[56:59], v4, s[12:15], s46 offen
    s_add_u32 s46, s45, 12288
    buffer_load_dwordx4 v[60:63], v4, s[12:15], s46 offen
    s_add_u32 s46, s45, 16384
    buffer_load_dwordx4 v[64:67], v4, s[12:15], s46 offen
    s_add_u32 s46, s45, 20480
    buffer_load_dwordx4 v[68:71], v4, s[12:15], s46 offen
    s_add_u32 s46, s45, 24576
    buffer_load_dwordx4 v[72:75], v4, s[12:15], s46 offen
    s_add_u32 s46, s45, 28672
    buffer_load_dwordx4 v[76:79], v4, s[12:15], s46 offen
    s_add_u32 s46, s45, 32768
    buffer_load_dwordx4 v[80:83], v4, s[12:15], s46 offen
    s_add_u32 s46, s45, 36864
    buffer_load_dwordx4 v[84:87], v4, s[12:15], s46 offen
    s_add_u32 s46, s45, 40960
    buffer_load_dwordx4 v[88:91], v4, s[12:15], s46 offen
    s_add_u32 s46, s45, 45056
    buffer_load_dwordx4 v[92:95], v4, s[12:15], s46 offen
    s_add_u32 s46, s45, 49152
    buffer_load_dwordx4 v[96:99], v4, s[12:15], s46 offen
    s_add_u32 s46, s45, 53248
    buffer_load_dwordx4 v[100:103], v4, s[12:15], s46 offen
    s_add_u32 s46, s45, 57344
    buffer_load_dwordx4 v[104:107], v4, s[12:15], s46 offen
    s_add_u32 s46, s45, 61440
    buffer_load_dwordx4 v[108:111], v4, s[12:15], s46 offen
    s_add_u32 s46, s45, 65536
    buffer_load_dwordx4 v[112:115], v4, s[12:15], s46 offen
    s_add_u32 s46, s45, 69632
    buffer_load_dwordx4 v[116:119], v4, s[12:15], s46 offen
    s_add_u32 s46, s45, 73728
    buffer_load_dwordx4 v[120:123], v4, s[12:15], s46 offen
    s_add_u32 s46, s45, 77824
    buffer_load_dwordx4 v[124:127], v4, s[12:15], s46 offen
    s_add_u32 s46, s45, 81920
    buffer_load_dwordx4 v[128:131], v4, s[12:15], s46 offen
    s_add_u32 s46, s45, 86016
    buffer_load_dwordx4 v[132:135], v4, s[12:15], s46 offen
    s_add_u32 s46, s45, 90112
    buffer_load_dwordx4 v[136:139], v4, s[12:15], s46 offen
    s_add_u32 s46, s45, 94208
    buffer_load_dwordx4 v[140:143], v4, s[12:15], s46 offen
    s_add_u32 s46, s45, 98304
    buffer_load_dwordx4 v[144:147], v4, s[12:15], s46 offen
    s_add_u32 s46, s45, 102400
    buffer_load_dwordx4 v[148:151], v4, s[12:15], s46 offen
    s_add_u32 s46, s45, 106496
    buffer_load_dwordx4 v[152:155], v4, s[12:15], s46 offen
    s_add_u32 s46, s45, 110592
    buffer_load_dwordx4 v[156:159], v4, s[12:15], s46 offen
    s_add_u32 s46, s45, 114688
    buffer_load_dwordx4 v[160:163], v4, s[12:15], s46 offen
    s_add_u32 s46, s45, 118784
    buffer_load_dwordx4 v[164:167], v4, s[12:15], s46 offen
    s_add_u32 s46, s45, 122880
    buffer_load_dwordx4 v[168:171], v4, s[12:15], s46 offen
    s_add_u32 s46, s45, 126976
    buffer_load_dwordx4 v[172:175], v4, s[12:15], s46 offen
    s_add_u32 s46, s45, 131072
    buffer_load_dwordx4 v[176:179], v4, s[12:15], s46 offen
    s_add_u32 s46, s45, 135168
    buffer_load_dwordx4 v[180:183], v4, s[12:15], s46 offen
    s_add_u32 s46, s45, 139264
    buffer_load_dwordx4 v[184:187], v4, s[12:15], s46 offen
    s_add_u32 s46, s45, 143360
    buffer_load_dwordx4 v[188:191], v4, s[12:15], s46 offen
    s_add_u32 s46, s45, 147456
    buffer_load_dwordx4 v[192:195], v4, s[12:15], s46 offen
    s_add_u32 s46, s45, 151552
    buffer_load_dwordx4 v[196:199], v4, s[12:15], s46 offen
    s_add_u32 s46, s45, 155648
    buffer_load_dwordx4 v[200:203], v4, s[12:15], s46 offen
    s_add_u32 s46, s45, 159744
    buffer_load_dwordx4 v[204:207], v4, s[12:15], s46 offen
    s_add_u32 s46, s45, 163840
    buffer_load_dwordx4 v[208:211], v4, s[12:15], s46 offen
    s_add_u32 s46, s45, 167936
    buffer_load_dwordx4 v[212:215], v4, s[12:15], s46 offen
    s_add_u32 s46, s45, 172032
    buffer_load_dwordx4 v[216:219], v4, s[12:15], s46 offen
    s_add_u32 s46, s45, 176128
    buffer_load_dwordx4 v[220:223], v4, s[12:15], s46 offen
    s_add_u32 s46, s45, 180224
    buffer_load_dwordx4 v[224:227], v4, s[12:15], s46 offen
    s_add_u32 s46, s45, 184320
    buffer_load_dwordx4 v[228:231], v4, s[12:15], s46 offen
    s_add_u32 s46, s45, 188416
    buffer_load_dwordx4 v[232:235], v4, s[12:15], s46 offen
    s_add_u32 s46, s45, 192512
    buffer_load_dwordx4 v[236:239], v4, s[12:15], s46 offen
    s_add_u32 s46, s45, 196608
    buffer_load_dwordx4 v[240:243], v4, s[12:15], s46 offen
    s_add_u32 s46, s45, 200704
    buffer_load_dwordx4 v[244:247], v4, s[12:15], s46 offen
    s_add_u32 s46, s45, 204800
    buffer_load_dwordx4 v[248:251], v4, s[12:15], s46 offen
    s_add_u32 s46, s45, 208896
    buffer_load_dwordx4 v[252:255], v4, s[12:15], s46 offen
    v_lshrrev_b32 v8, 2, v2
    v_lshl_add_u32 v8, v3, 2, v8
    v_mul_u32_u24 v5, 1312, v8
    v_and_b32 v8, 3, v2
    v_lshl_add_u32 v5, v8, 3, v5
    s_mul_i32 s24, s3, 320
    v_add_u32 v5, s24, v5
    v_add_u32 v6, 62976, v5
    s_waitcnt vmcnt(22)
    ds_write_b128 v16, v[48:51]
    ds_write_b128 v17, v[52:55]
    ds_write_b128 v18, v[56:59]
    ds_write_b128 v19, v[60:63]
    ds_write_b128 v20, v[64:67]
    ds_write_b128 v21, v[68:71]
    ds_write_b128 v22, v[72:75]
    ds_write_b128 v23, v[76:79]
    ds_write_b128 v24, v[80:83]
    ds_write_b128 v25, v[84:87]
    ds_write_b128 v26, v[88:91]
    ds_write_b128 v27, v[92:95]
    ds_write_b128 v28, v[96:99]
    ds_write_b128 v29, v[100:103]
    ds_write_b128 v30, v[104:107]
    ds_write_b128 v31, v[108:111]
    ds_write_b128 v32, v[112:115]
    ds_write_b128 v33, v[116:119]
    ds_write_b128 v34, v[120:123]
    ds_write_b128 v35, v[124:127]
    ds_write_b128 v36, v[128:131]
    ds_write_b128 v37, v[132:135]
    ds_write_b128 v38, v[136:139]
    ds_write_b128 v39, v[140:143]
    ds_write_b128 v40, v[144:147]
    ds_write_b128 v41, v[148:151]
    ds_write_b128 v42, v[152:155]
    ds_write_b128 v43, v[156:159]
    ds_write_b128 v44, v[160:163]
    ds_write_b128 v45, v[164:167]
    s_waitcnt lgkmcnt(0)
    s_add_u32 s46, s45, 212992
    buffer_load_dwordx4 v[48:51], v4, s[12:15], s46 offen
    s_add_u32 s46, s45, 217088
    buffer_load_dwordx4 v[52:55], v4, s[12:15], s46 offen
    s_add_u32 s46, s45, 221184
    buffer_load_dwordx4 v[56:59], v4, s[12:15], s46 offen
    s_add_u32 s46, s45, 225280
    buffer_load_dwordx4 v[60:63], v4, s[12:15], s46 offen
    s_add_u32 s46, s45, 229376
    buffer_load_dwordx4 v[64:67], v4, s[12:15], s46 offen
    s_add_u32 s46, s45, 233472
    buffer_load_dwordx4 v[68:71], v4, s[12:15], s46 offen
    s_add_u32 s46, s45, 237568
    buffer_load_dwordx4 v[72:75], v4, s[12:15], s46 offen
    s_add_u32 s46, s45, 241664
    buffer_load_dwordx4 v[76:79], v4, s[12:15], s46 offen
    s_barrier
    ds_read_b64_tr_b16 a[0:1], v5 offset:0
    ds_read_b64_tr_b16 a[2:3], v5 offset:20992
    ds_read_b64_tr_b16 a[4:5], v6 offset:0
    ds_read_b64_tr_b16 a[6:7], v6 offset:20992
    ds_read_b64_tr_b16 a[16:17], v5 offset:41984
    ds_read_b64_tr_b16 a[18:19], v6 offset:41984
    ds_read_b64_tr_b16 a[24:25], v5 offset:32
    ds_read_b64_tr_b16 a[26:27], v5 offset:21024
    ds_read_b64_tr_b16 a[28:29], v6 offset:32
    ds_read_b64_tr_b16 a[30:31], v6 offset:21024
    ds_read_b64_tr_b16 a[40:41], v5 offset:42016
    ds_read_b64_tr_b16 a[42:43], v6 offset:42016
    ds_read_b64_tr_b16 a[48:49], v5 offset:64
    ds_read_b64_tr_b16 a[50:51], v5 offset:21056
    ds_read_b64_tr_b16 a[52:53], v6 offset:64
    ds_read_b64_tr_b16 a[54:55], v6 offset:21056
    ds_read_b64_tr_b16 a[64:65], v5 offset:42048
    ds_read_b64_tr_b16 a[66:67], v6 offset:42048
    ds_read_b64_tr_b16 a[72:73], v5 offset:96
    ds_read_b64_tr_b16 a[74:75], v5 offset:21088
    ds_read_b64_tr_b16 a[76:77], v6 offset:96
    ds_read_b64_tr_b16 a[78:79], v6 offset:21088
    ds_read_b64_tr_b16 a[88:89], v5 offset:42080
    ds_read_b64_tr_b16 a[90:91], v6 offset:42080
    ds_read_b64_tr_b16 a[96:97], v5 offset:128
    ds_read_b64_tr_b16 a[98:99], v5 offset:21120
    ds_read_b64_tr_b16 a[100:101], v6 offset:128
    ds_read_b64_tr_b16 a[102:103], v6 offset:21120
    ds_read_b64_tr_b16 a[112:113], v5 offset:42112
    ds_read_b64_tr_b16 a[114:115], v6 offset:42112
    ds_read_b64_tr_b16 a[120:121], v5 offset:160
    ds_read_b64_tr_b16 a[122:123], v5 offset:21152
    ds_read_b64_tr_b16 a[124:125], v6 offset:160
    ds_read_b64_tr_b16 a[126:127], v6 offset:21152
    ds_read_b64_tr_b16 a[136:137], v5 offset:42144
    ds_read_b64_tr_b16 a[138:139], v6 offset:42144
    ds_read_b64_tr_b16 a[144:145], v5 offset:192
    ds_read_b64_tr_b16 a[146:147], v5 offset:21184
    ds_read_b64_tr_b16 a[148:149], v6 offset:192
    ds_read_b64_tr_b16 a[150:151], v6 offset:21184
    ds_read_b64_tr_b16 a[160:161], v5 offset:42176
    ds_read_b64_tr_b16 a[162:163], v6 offset:42176
    ds_read_b64_tr_b16 a[168:169], v5 offset:224
    ds_read_b64_tr_b16 a[170:171], v5 offset:21216
    ds_read_b64_tr_b16 a[172:173], v6 offset:224
    ds_read_b64_tr_b16 a[174:175], v6 offset:21216
    ds_read_b64_tr_b16 a[184:185], v5 offset:42208
    ds_read_b64_tr_b16 a[186:187], v6 offset:42208
    ds_read_b64_tr_b16 a[192:193], v5 offset:256
    ds_read_b64_tr_b16 a[194:195], v5 offset:21248
    ds_read_b64_tr_b16 a[196:197], v6 offset:256
    ds_read_b64_tr_b16 a[198:199], v6 offset:21248
    ds_read_b64_tr_b16 a[208:209], v5 offset:42240
    ds_read_b64_tr_b16 a[210:211], v6 offset:42240
    ds_read_b64_tr_b16 a[216:217], v5 offset:288
    ds_read_b64_tr_b16 a[218:219], v5 offset:21280
    ds_read_b64_tr_b16 a[220:221], v6 offset:288
    ds_read_b64_tr_b16 a[222:223], v6 offset:21280
    ds_read_b64_tr_b16 a[232:233], v5 offset:42272
    ds_read_b64_tr_b16 a[234:235], v6 offset:42272
    s_waitcnt lgkmcnt(0)
    s_barrier
    s_waitcnt vmcnt(0)
    ds_write_b128 v16, v[168:171]
    ds_write_b128 v17, v[172:175]
    ds_write_b128 v18, v[176:179]
    ds_write_b128 v19, v[180:183]
    ds_write_b128 v20, v[184:187]
    ds_write_b128 v21, v[188:191]
    ds_write_b128 v22, v[192:195]
    ds_write_b128 v23, v[196:199]
    ds_write_b128 v24, v[200:203]
    ds_write_b128 v25, v[204:207]
    ds_write_b128 v26, v[208:211]
    ds_write_b128 v27, v[212:215]
    ds_write_b128 v28, v[216:219]
    ds_write_b128 v29, v[220:223]
    ds_write_b128 v30, v[224:227]
    ds_write_b128 v31, v[228:231]
    ds_write_b128 v32, v[232:235]
    ds_write_b128 v33, v[236:239]
    ds_write_b128 v34, v[240:243]
    ds_write_b128 v35, v[244:247]
    ds_write_b128 v36, v[248:251]
    ds_write_b128 v37, v[252:255]
    ds_write_b128 v38, v[48:51]
    ds_write_b128 v39, v[52:55]
    ds_write_b128 v40, v[56:59]
    ds_write_b128 v41, v[60:63]
    ds_write_b128 v42, v[64:67]
    ds_write_b128 v43, v[68:71]
    ds_write_b128 v44, v[72:75]
    ds_write_b128 v45, v[76:79]
    s_waitcnt lgkmcnt(0)
    s_barrier
    ds_read_b64_tr_b16 a[8:9], v5 offset:0
    ds_read_b64_tr_b16 a[10:11], v5 offset:20992
    ds_read_b64_tr_b16 a[12:13], v6 offset:0
    ds_read_b64_tr_b16 a[14:15], v6 offset:20992
    ds_read_b64_tr_b16 a[20:21], v5 offset:41984
    ds_read_b64_tr_b16 a[22:23], v6 offset:41984
    ds_read_b64_tr_b16 a[32:33], v5 offset:32
    ds_read_b64_tr_b16 a[34:35], v5 offset:21024
    ds_read_b64_tr_b16 a[36:37], v6 offset:32
    ds_read_b64_tr_b16 a[38:39], v6 offset:21024
    ds_read_b64_tr_b16 a[44:45], v5 offset:42016
    ds_read_b64_tr_b16 a[46:47], v6 offset:42016
    ds_read_b64_tr_b16 a[56:57], v5 offset:64
    ds_read_b64_tr_b16 a[58:59], v5 offset:21056
    ds_read_b64_tr_b16 a[60:61], v6 offset:64
    ds_read_b64_tr_b16 a[62:63], v6 offset:21056
    ds_read_b64_tr_b16 a[68:69], v5 offset:42048
    ds_read_b64_tr_b16 a[70:71], v6 offset:42048
    ds_read_b64_tr_b16 a[80:81], v5 offset:96
    ds_read_b64_tr_b16 a[82:83], v5 offset:21088
    ds_read_b64_tr_b16 a[84:85], v6 offset:96
    ds_read_b64_tr_b16 a[86:87], v6 offset:21088
    ds_read_b64_tr_b16 a[92:93], v5 offset:42080
    ds_read_b64_tr_b16 a[94:95], v6 offset:42080
    ds_read_b64_tr_b16 a[104:105], v5 offset:128
    ds_read_b64_tr_b16 a[106:107], v5 offset:21120
    ds_read_b64_tr_b16 a[108:109], v6 offset:128
    ds_read_b64_tr_b16 a[110:111], v6 offset:21120
    ds_read_b64_tr_b16 a[116:117], v5 offset:42112
    ds_read_b64_tr_b16 a[118:119], v6 offset:42112
    ds_read_b64_tr_b16 a[128:129], v5 offset:160
    ds_read_b64_tr_b16 a[130:131], v5 offset:21152
    ds_read_b64_tr_b16 a[132:133], v6 offset:160
    ds_read_b64_tr_b16 a[134:135], v6 offset:21152
    ds_read_b64_tr_b16 a[140:141], v5 offset:42144
    ds_read_b64_tr_b16 a[142:143], v6 offset:42144
    ds_read_b64_tr_b16 a[152:153], v5 offset:192
    ds_read_b64_tr_b16 a[154:155], v5 offset:21184
    ds_read_b64_tr_b16 a[156:157], v6 offset:192
    ds_read_b64_tr_b16 a[158:159], v6 offset:21184
    ds_read_b64_tr_b16 a[164:165], v5 offset:42176
    ds_read_b64_tr_b16 a[166:167], v6 offset:42176
    ds_read_b64_tr_b16 a[176:177], v5 offset:224
    ds_read_b64_tr_b16 a[178:179], v5 offset:21216
    ds_read_b64_tr_b16 a[180:181], v6 offset:224
    ds_read_b64_tr_b16 a[182:183], v6 offset:21216
    ds_read_b64_tr_b16 a[188:189], v5 offset:42208
    ds_read_b64_tr_b16 a[190:191], v6 offset:42208
    ds_read_b64_tr_b16 a[200:201], v5 offset:256
    ds_read_b64_tr_b16 a[202:203], v5 offset:21248
    ds_read_b64_tr_b16 a[204:205], v6 offset:256
    ds_read_b64_tr_b16 a[206:207], v6 offset:21248
    ds_read_b64_tr_b16 a[212:213], v5 offset:42240
    ds_read_b64_tr_b16 a[214:215], v6 offset:42240
    ds_read_b64_tr_b16 a[224:225], v5 offset:288
    ds_read_b64_tr_b16 a[226:227], v5 offset:21280
    ds_read_b64_tr_b16 a[228:229], v6 offset:288
    ds_read_b64_tr_b16 a[230:231], v6 offset:21280
    ds_read_b64_tr_b16 a[236:237], v5 offset:42272
    ds_read_b64_tr_b16 a[238:239], v6 offset:42272
    s_waitcnt lgkmcnt(0)
    s_barrier
    v_lshlrev_b32 v5, 4, v1
    s_mul_i32 s24, s44, 12288
    v_add_u32 v6, s24, v5
    v_add_u32 v7, 4096, v6
    v_add_u32 v8, 8192, v6
    s_mul_i32 s24, s3, 327680
    s_lshl_b32 s25, s44, 10
    s_add_u32 s24, s24, s25
    v_add_u32 v9, s24, v5
interleave_layers__linear_attn_block__memory_aug_recurrent_mem_tr__prompt_kernel_o_layer:
    s_mul_i32 s93, s92, 29360128
    s_add_u32 s93, s93, 117440512
    s_mul_i32 s94, s92, 16384
    s_add_u32 s94, s94, 23068672
    s_mov_b32 s24, 12288
    s_lshl_b32 s25, s44, 7
    s_add_u32 s24, s24, s25
    s_add_u32 s24, s24, s94
    v_mov_b32 v14, s24
    v_mov_b32 v15, 2146435072
    v_cmp_eq_u32 vcc, 0, v1
    s_nop 1
    v_cndmask_b32 v14, v15, v14, vcc
    s_lshl_b32 s24, s44, 7
    s_add_u32 s24, s24, 8192
    s_add_u32 s24, s24, s94
    v_mov_b32 v10, s24
    s_mov_b32 s41, 33554432
    s_mov_b32 s43, 184549376
    s_mov_b32 s40, 0
    s_mov_b32 s62, -1
    s_mov_b32 s63, 1
    s_cmp_ge_i32 s62, s63
    s_cbranch_scc1 interleave_layers__linear_attn_block__memory_aug_recurrent_mem_tr__prompt_kernel_o_en0_ok
    s_mov_b32 s61, 0
interleave_layers__linear_attn_block__memory_aug_recurrent_mem_tr__prompt_kernel_o_en0:
    buffer_load_dword v11, v10, s[8:11], 0 offen sc1
    s_waitcnt vmcnt(0)
    v_readlane_b32 s62, v11, 0
    s_cmp_ge_i32 s62, s63
    s_cbranch_scc1 interleave_layers__linear_attn_block__memory_aug_recurrent_mem_tr__prompt_kernel_o_en0_ok
    s_add_u32 s61, s61, 1
    s_cmp_ge_u32 s61, s60
    s_cbranch_scc1 interleave_layers__linear_attn_block__memory_aug_recurrent_mem_tr__prompt_kernel_o_en0_to
    s_sleep 2
    s_branch interleave_layers__linear_attn_block__memory_aug_recurrent_mem_tr__prompt_kernel_o_en0
interleave_layers__linear_attn_block__memory_aug_recurrent_mem_tr__prompt_kernel_o_en0_to:
    s_mov_b32 s60, 1
interleave_layers__linear_attn_block__memory_aug_recurrent_mem_tr__prompt_kernel_o_en0_ok:
    buffer_load_dwordx4 v[16:19], v6, s[8:11], s41 offen offset:0 sc1
    buffer_load_dwordx4 v[20:23], v6, s[8:11], s41 offen offset:1024 sc1
    buffer_load_dwordx4 v[24:27], v6, s[8:11], s41 offen offset:2048 sc1
    buffer_load_dwordx4 v[28:31], v6, s[8:11], s41 offen offset:3072 sc1
    buffer_load_dwordx4 v[32:35], v7, s[8:11], s41 offen offset:0 sc1
    buffer_load_dwordx4 v[36:39], v7, s[8:11], s41 offen offset:1024 sc1
    buffer_load_dwordx4 v[40:43], v7, s[8:11], s41 offen offset:2048 sc1
    buffer_load_dwordx4 v[44:47], v7, s[8:11], s41 offen offset:3072 sc1
    buffer_load_dwordx4 v[48:51], v8, s[8:11], s41 offen offset:0 sc1
    buffer_load_dwordx4 v[52:55], v8, s[8:11], s41 offen offset:1024 sc1
    buffer_load_dwordx4 v[56:59], v8, s[8:11], s41 offen offset:2048 sc1
    buffer_load_dwordx4 v[60:63], v8, s[8:11], s41 offen offset:3072 sc1
    s_add_u32 s41, s41, 393216
    s_waitcnt vmcnt(0)
interleave_layers__linear_attn_block__memory_aug_recurrent_mem_tr__prompt_kernel_o_seg:
    v_swap_b32 v26, v36
    v_swap_b32 v27, v37
    v_swap_b32 v50, v60
    v_swap_b32 v51, v61
    v_mfma_f32_16x16x32_bf16 v[112:115], v[16:19], a[0:3], 0
    v_mfma_f32_16x16x32_bf16 v[116:119], v[20:23], a[0:3], 0
    v_mfma_f32_16x16x32_bf16 v[120:123], v[16:19], a[24:27], 0
    v_mfma_f32_16x16x32_bf16 v[124:127], v[20:23], a[24:27], 0
    v_mfma_f32_16x16x32_bf16 v[128:131], v[16:19], a[48:51], 0
    v_mfma_f32_16x16x32_bf16 v[132:135], v[20:23], a[48:51], 0
    v_mfma_f32_16x16x32_bf16 v[136:139], v[16:19], a[72:75], 0
    v_mfma_f32_16x16x32_bf16 v[140:143], v[20:23], a[72:75], 0
    v_mfma_f32_16x16x32_bf16 v[144:147], v[16:19], a[96:99], 0
    v_mfma_f32_16x16x32_bf16 v[148:151], v[20:23], a[96:99], 0
    v_mfma_f32_16x16x32_bf16 v[152:155], v[16:19], a[120:123], 0
    v_mfma_f32_16x16x32_bf16 v[156:159], v[20:23], a[120:123], 0
    v_mfma_f32_16x16x32_bf16 v[160:163], v[16:19], a[144:147], 0
    v_mfma_f32_16x16x32_bf16 v[164:167], v[20:23], a[144:147], 0
    v_mfma_f32_16x16x32_bf16 v[168:171], v[16:19], a[168:171], 0
    v_mfma_f32_16x16x32_bf16 v[172:175], v[20:23], a[168:171], 0
    v_mfma_f32_16x16x32_bf16 v[176:179], v[16:19], a[192:195], 0
    v_mfma_f32_16x16x32_bf16 v[180:183], v[20:23], a[192:195], 0
    v_mfma_f32_16x16x32_bf16 v[184:187], v[16:19], a[216:219], 0
    v_mfma_f32_16x16x32_bf16 v[188:191], v[20:23], a[216:219], 0
    v_mfma_f32_16x16x32_bf16 v[112:115], v[28:31], a[4:7], v[112:115]
    v_mfma_f32_16x16x32_bf16 v[116:119], v[32:35], a[4:7], v[116:119]
    v_mfma_f32_16x16x32_bf16 v[120:123], v[28:31], a[28:31], v[120:123]
    v_mfma_f32_16x16x32_bf16 v[124:127], v[32:35], a[28:31], v[124:127]
    v_mfma_f32_16x16x32_bf16 v[128:131], v[28:31], a[52:55], v[128:131]
    v_mfma_f32_16x16x32_bf16 v[132:135], v[32:35], a[52:55], v[132:135]
    v_mfma_f32_16x16x32_bf16 v[136:139], v[28:31], a[76:79], v[136:139]
    v_mfma_f32_16x16x32_bf16 v[140:143], v[32:35], a[76:79], v[140:143]
    v_mfma_f32_16x16x32_bf16 v[144:147], v[28:31], a[100:103], v[144:147]
    v_mfma_f32_16x16x32_bf16 v[148:151], v[32:35], a[100:103], v[148:151]
    v_mfma_f32_16x16x32_bf16 v[152:155], v[28:31], a[124:127], v[152:155]
    v_mfma_f32_16x16x32_bf16 v[156:159], v[32:35], a[124:127], v[156:159]
    v_mfma_f32_16x16x32_bf16 v[160:163], v[28:31], a[148:151], v[160:163]
    v_mfma_f32_16x16x32_bf16 v[164:167], v[32:35], a[148:151], v[164:167]
    v_mfma_f32_16x16x32_bf16 v[168:171], v[28:31], a[172:175], v[168:171]
    v_mfma_f32_16x16x32_bf16 v[172:175], v[32:35], a[172:175], v[172:175]
    v_mfma_f32_16x16x32_bf16 v[176:179], v[28:31], a[196:199], v[176:179]
    v_mfma_f32_16x16x32_bf16 v[180:183], v[32:35], a[196:199], v[180:183]
    v_mfma_f32_16x16x32_bf16 v[184:187], v[28:31], a[220:223], v[184:187]
    v_mfma_f32_16x16x32_bf16 v[188:191], v[32:35], a[220:223], v[188:191]
    v_mfma_f32_16x16x32_bf16 v[112:115], v[40:43], a[8:11], v[112:115]
    v_mfma_f32_16x16x32_bf16 v[116:119], v[44:47], a[8:11], v[116:119]
    v_mfma_f32_16x16x32_bf16 v[120:123], v[40:43], a[32:35], v[120:123]
    v_mfma_f32_16x16x32_bf16 v[124:127], v[44:47], a[32:35], v[124:127]
    v_mfma_f32_16x16x32_bf16 v[128:131], v[40:43], a[56:59], v[128:131]
    v_mfma_f32_16x16x32_bf16 v[132:135], v[44:47], a[56:59], v[132:135]
    v_mfma_f32_16x16x32_bf16 v[136:139], v[40:43], a[80:83], v[136:139]
    v_mfma_f32_16x16x32_bf16 v[140:143], v[44:47], a[80:83], v[140:143]
    v_mfma_f32_16x16x32_bf16 v[144:147], v[40:43], a[104:107], v[144:147]
    v_mfma_f32_16x16x32_bf16 v[148:151], v[44:47], a[104:107], v[148:151]
    v_mfma_f32_16x16x32_bf16 v[152:155], v[40:43], a[128:131], v[152:155]
    v_mfma_f32_16x16x32_bf16 v[156:159], v[44:47], a[128:131], v[156:159]
    v_mfma_f32_16x16x32_bf16 v[160:163], v[40:43], a[152:155], v[160:163]
    v_mfma_f32_16x16x32_bf16 v[164:167], v[44:47], a[152:155], v[164:167]
    v_mfma_f32_16x16x32_bf16 v[168:171], v[40:43], a[176:179], v[168:171]
    v_mfma_f32_16x16x32_bf16 v[172:175], v[44:47], a[176:179], v[172:175]
    v_mfma_f32_16x16x32_bf16 v[176:179], v[40:43], a[200:203], v[176:179]
    v_mfma_f32_16x16x32_bf16 v[180:183], v[44:47], a[200:203], v[180:183]
    v_mfma_f32_16x16x32_bf16 v[184:187], v[40:43], a[224:227], v[184:187]
    v_mfma_f32_16x16x32_bf16 v[188:191], v[44:47], a[224:227], v[188:191]
    s_cmp_eq_u32 s40, 0
    s_cbranch_scc1 interleave_layers__linear_attn_block__memory_aug_recurrent_mem_tr__prompt_kernel_of34
    s_waitcnt vmcnt(0)
    s_barrier
    s_cmp_eq_u32 s3, 0
    s_cbranch_scc0 interleave_layers__linear_attn_block__memory_aug_recurrent_mem_tr__prompt_kernel_fp35
    v_mov_b32 v15, s40
    buffer_store_dword v15, v14, s[8:11], 0 offen sc1
interleave_layers__linear_attn_block__memory_aug_recurrent_mem_tr__prompt_kernel_fp35:
    s_add_u32 s63, s40, 2
    s_min_u32 s63, s63, 64
    s_cmp_ge_i32 s62, s63
    s_cbranch_scc1 interleave_layers__linear_attn_block__memory_aug_recurrent_mem_tr__prompt_kernel_o_en1_ok
    s_mov_b32 s61, 0
interleave_layers__linear_attn_block__memory_aug_recurrent_mem_tr__prompt_kernel_o_en1:
    buffer_load_dword v11, v10, s[8:11], 0 offen sc1
    s_waitcnt vmcnt(0)
    v_readlane_b32 s62, v11, 0
    s_cmp_ge_i32 s62, s63
    s_cbranch_scc1 interleave_layers__linear_attn_block__memory_aug_recurrent_mem_tr__prompt_kernel_o_en1_ok
    s_add_u32 s61, s61, 1
    s_cmp_ge_u32 s61, s60
    s_cbranch_scc1 interleave_layers__linear_attn_block__memory_aug_recurrent_mem_tr__prompt_kernel_o_en1_to
    s_sleep 2
    s_branch interleave_layers__linear_attn_block__memory_aug_recurrent_mem_tr__prompt_kernel_o_en1
interleave_layers__linear_attn_block__memory_aug_recurrent_mem_tr__prompt_kernel_o_en1_to:
    s_mov_b32 s60, 1
interleave_layers__linear_attn_block__memory_aug_recurrent_mem_tr__prompt_kernel_o_en1_ok:
    buffer_load_dwordx4 v[64:67], v6, s[8:11], s41 offen offset:0 sc1
    buffer_load_dwordx4 v[68:71], v6, s[8:11], s41 offen offset:1024 sc1
    buffer_load_dwordx4 v[72:75], v6, s[8:11], s41 offen offset:2048 sc1
    buffer_load_dwordx4 v[76:79], v6, s[8:11], s41 offen offset:3072 sc1
    buffer_load_dwordx4 v[80:83], v7, s[8:11], s41 offen offset:0 sc1
    buffer_load_dwordx4 v[84:87], v7, s[8:11], s41 offen offset:1024 sc1
    buffer_load_dwordx4 v[88:91], v7, s[8:11], s41 offen offset:2048 sc1
    buffer_load_dwordx4 v[92:95], v7, s[8:11], s41 offen offset:3072 sc1
    buffer_load_dwordx4 v[96:99], v8, s[8:11], s41 offen offset:0 sc1
    buffer_load_dwordx4 v[100:103], v8, s[8:11], s41 offen offset:1024 sc1
    buffer_load_dwordx4 v[104:107], v8, s[8:11], s41 offen offset:2048 sc1
    buffer_load_dwordx4 v[108:111], v8, s[8:11], s41 offen offset:3072 sc1
    s_add_u32 s41, s41, 393216
interleave_layers__linear_attn_block__memory_aug_recurrent_mem_tr__prompt_kernel_of34:
    v_mfma_f32_16x16x32_bf16 v[112:115], v[52:55], a[12:15], v[112:115]
    v_mfma_f32_16x16x32_bf16 v[116:119], v[56:59], a[12:15], v[116:119]
    v_mfma_f32_16x16x32_bf16 v[120:123], v[52:55], a[36:39], v[120:123]
    v_mfma_f32_16x16x32_bf16 v[124:127], v[56:59], a[36:39], v[124:127]
    v_mfma_f32_16x16x32_bf16 v[128:131], v[52:55], a[60:63], v[128:131]
    v_mfma_f32_16x16x32_bf16 v[132:135], v[56:59], a[60:63], v[132:135]
    v_mfma_f32_16x16x32_bf16 v[136:139], v[52:55], a[84:87], v[136:139]
    v_mfma_f32_16x16x32_bf16 v[140:143], v[56:59], a[84:87], v[140:143]
    v_mfma_f32_16x16x32_bf16 v[144:147], v[52:55], a[108:111], v[144:147]
    v_mfma_f32_16x16x32_bf16 v[148:151], v[56:59], a[108:111], v[148:151]
    v_mfma_f32_16x16x32_bf16 v[152:155], v[52:55], a[132:135], v[152:155]
    v_mfma_f32_16x16x32_bf16 v[156:159], v[56:59], a[132:135], v[156:159]
    v_mfma_f32_16x16x32_bf16 v[160:163], v[52:55], a[156:159], v[160:163]
    v_mfma_f32_16x16x32_bf16 v[164:167], v[56:59], a[156:159], v[164:167]
    v_mfma_f32_16x16x32_bf16 v[168:171], v[52:55], a[180:183], v[168:171]
    v_mfma_f32_16x16x32_bf16 v[172:175], v[56:59], a[180:183], v[172:175]
    v_mfma_f32_16x16x32_bf16 v[176:179], v[52:55], a[204:207], v[176:179]
    v_mfma_f32_16x16x32_bf16 v[180:183], v[56:59], a[204:207], v[180:183]
    v_mfma_f32_16x16x32_bf16 v[184:187], v[52:55], a[228:231], v[184:187]
    v_mfma_f32_16x16x32_bf16 v[188:191], v[56:59], a[228:231], v[188:191]
    v_mfma_f32_16x16x32_bf16 v[112:115], v[24:27], a[16:19], v[112:115]
    v_mfma_f32_16x16x32_bf16 v[116:119], v[36:39], a[16:19], v[116:119]
    v_mfma_f32_16x16x32_bf16 v[120:123], v[24:27], a[40:43], v[120:123]
    v_mfma_f32_16x16x32_bf16 v[124:127], v[36:39], a[40:43], v[124:127]
    v_mfma_f32_16x16x32_bf16 v[128:131], v[24:27], a[64:67], v[128:131]
    v_mfma_f32_16x16x32_bf16 v[132:135], v[36:39], a[64:67], v[132:135]
    v_mfma_f32_16x16x32_bf16 v[136:139], v[24:27], a[88:91], v[136:139]
    v_mfma_f32_16x16x32_bf16 v[140:143], v[36:39], a[88:91], v[140:143]
    v_mfma_f32_16x16x32_bf16 v[144:147], v[24:27], a[112:115], v[144:147]
    v_mfma_f32_16x16x32_bf16 v[148:151], v[36:39], a[112:115], v[148:151]
    v_mfma_f32_16x16x32_bf16 v[152:155], v[24:27], a[136:139], v[152:155]
    v_mfma_f32_16x16x32_bf16 v[156:159], v[36:39], a[136:139], v[156:159]
    v_mfma_f32_16x16x32_bf16 v[160:163], v[24:27], a[160:163], v[160:163]
    v_mfma_f32_16x16x32_bf16 v[164:167], v[36:39], a[160:163], v[164:167]
    v_mfma_f32_16x16x32_bf16 v[168:171], v[24:27], a[184:187], v[168:171]
    v_mfma_f32_16x16x32_bf16 v[172:175], v[36:39], a[184:187], v[172:175]
    v_mfma_f32_16x16x32_bf16 v[176:179], v[24:27], a[208:211], v[176:179]
    v_mfma_f32_16x16x32_bf16 v[180:183], v[36:39], a[208:211], v[180:183]
    v_mfma_f32_16x16x32_bf16 v[184:187], v[24:27], a[232:235], v[184:187]
    v_mfma_f32_16x16x32_bf16 v[188:191], v[36:39], a[232:235], v[188:191]
    v_mfma_f32_16x16x32_bf16 v[112:115], v[48:51], a[20:23], v[112:115]
    v_mfma_f32_16x16x32_bf16 v[116:119], v[60:63], a[20:23], v[116:119]
    v_mfma_f32_16x16x32_bf16 v[120:123], v[48:51], a[44:47], v[120:123]
    v_mfma_f32_16x16x32_bf16 v[124:127], v[60:63], a[44:47], v[124:127]
    v_mfma_f32_16x16x32_bf16 v[128:131], v[48:51], a[68:71], v[128:131]
    v_mfma_f32_16x16x32_bf16 v[132:135], v[60:63], a[68:71], v[132:135]
    v_mfma_f32_16x16x32_bf16 v[136:139], v[48:51], a[92:95], v[136:139]
    v_mfma_f32_16x16x32_bf16 v[140:143], v[60:63], a[92:95], v[140:143]
    v_mfma_f32_16x16x32_bf16 v[144:147], v[48:51], a[116:119], v[144:147]
    v_mfma_f32_16x16x32_bf16 v[148:151], v[60:63], a[116:119], v[148:151]
    v_mfma_f32_16x16x32_bf16 v[152:155], v[48:51], a[140:143], v[152:155]
    v_mfma_f32_16x16x32_bf16 v[156:159], v[60:63], a[140:143], v[156:159]
    v_mfma_f32_16x16x32_bf16 v[160:163], v[48:51], a[164:167], v[160:163]
    v_mfma_f32_16x16x32_bf16 v[164:167], v[60:63], a[164:167], v[164:167]
    v_mfma_f32_16x16x32_bf16 v[168:171], v[48:51], a[188:191], v[168:171]
    v_mfma_f32_16x16x32_bf16 v[172:175], v[60:63], a[188:191], v[172:175]
    v_mfma_f32_16x16x32_bf16 v[176:179], v[48:51], a[212:215], v[176:179]
    v_mfma_f32_16x16x32_bf16 v[180:183], v[60:63], a[212:215], v[180:183]
    v_mfma_f32_16x16x32_bf16 v[184:187], v[48:51], a[236:239], v[184:187]
    v_mfma_f32_16x16x32_bf16 v[188:191], v[60:63], a[236:239], v[188:191]
    s_mov_b32 s46, s43
    v_cvt_pk_bf16_f32 v192, v112, v113
    v_cvt_pk_bf16_f32 v193, v114, v115
    v_cvt_pk_bf16_f32 v194, v116, v117
    v_cvt_pk_bf16_f32 v195, v118, v119
    buffer_store_dwordx4 v[192:195], v9, s[8:11], s46 offen sc1
    s_add_u32 s46, s46, 32768
    v_cvt_pk_bf16_f32 v196, v120, v121
    v_cvt_pk_bf16_f32 v197, v122, v123
    v_cvt_pk_bf16_f32 v198, v124, v125
    v_cvt_pk_bf16_f32 v199, v126, v127
    buffer_store_dwordx4 v[196:199], v9, s[8:11], s46 offen sc1
    s_add_u32 s46, s46, 32768
    v_cvt_pk_bf16_f32 v200, v128, v129
    v_cvt_pk_bf16_f32 v201, v130, v131
    v_cvt_pk_bf16_f32 v202, v132, v133
    v_cvt_pk_bf16_f32 v203, v134, v135
    buffer_store_dwordx4 v[200:203], v9, s[8:11], s46 offen sc1
    s_add_u32 s46, s46, 32768
    v_cvt_pk_bf16_f32 v204, v136, v137
    v_cvt_pk_bf16_f32 v205, v138, v139
    v_cvt_pk_bf16_f32 v206, v140, v141
    v_cvt_pk_bf16_f32 v207, v142, v143
    buffer_store_dwordx4 v[204:207], v9, s[8:11], s46 offen sc1
    s_add_u32 s46, s46, 32768
    v_cvt_pk_bf16_f32 v208, v144, v145
    v_cvt_pk_bf16_f32 v209, v146, v147
    v_cvt_pk_bf16_f32 v210, v148, v149
    v_cvt_pk_bf16_f32 v211, v150, v151
    buffer_store_dwordx4 v[208:211], v9, s[8:11], s46 offen sc1
    s_add_u32 s46, s46, 32768
    v_cvt_pk_bf16_f32 v212, v152, v153
    v_cvt_pk_bf16_f32 v213, v154, v155
    v_cvt_pk_bf16_f32 v214, v156, v157
    v_cvt_pk_bf16_f32 v215, v158, v159
    buffer_store_dwordx4 v[212:215], v9, s[8:11], s46 offen sc1
    s_add_u32 s46, s46, 32768
    v_cvt_pk_bf16_f32 v216, v160, v161
    v_cvt_pk_bf16_f32 v217, v162, v163
    v_cvt_pk_bf16_f32 v218, v164, v165
    v_cvt_pk_bf16_f32 v219, v166, v167
    buffer_store_dwordx4 v[216:219], v9, s[8:11], s46 offen sc1
    s_add_u32 s46, s46, 32768
    v_cvt_pk_bf16_f32 v220, v168, v169
    v_cvt_pk_bf16_f32 v221, v170, v171
    v_cvt_pk_bf16_f32 v222, v172, v173
    v_cvt_pk_bf16_f32 v223, v174, v175
    buffer_store_dwordx4 v[220:223], v9, s[8:11], s46 offen sc1
    s_add_u32 s46, s46, 32768
    v_cvt_pk_bf16_f32 v224, v176, v177
    v_cvt_pk_bf16_f32 v225, v178, v179
    v_cvt_pk_bf16_f32 v226, v180, v181
    v_cvt_pk_bf16_f32 v227, v182, v183
    buffer_store_dwordx4 v[224:227], v9, s[8:11], s46 offen sc1
    s_add_u32 s46, s46, 32768
    v_cvt_pk_bf16_f32 v228, v184, v185
    v_cvt_pk_bf16_f32 v229, v186, v187
    v_cvt_pk_bf16_f32 v230, v188, v189
    v_cvt_pk_bf16_f32 v231, v190, v191
    buffer_store_dwordx4 v[228:231], v9, s[8:11], s46 offen sc1
    s_cmp_eq_u32 s40, 0
    s_cbranch_scc0 interleave_layers__linear_attn_block__memory_aug_recurrent_mem_tr__prompt_kernel_of36
    s_waitcnt vmcnt(0)
    s_barrier
    s_cmp_eq_u32 s3, 0
    s_cbranch_scc0 interleave_layers__linear_attn_block__memory_aug_recurrent_mem_tr__prompt_kernel_fp37
    v_mov_b32 v15, 1
    buffer_store_dword v15, v14, s[8:11], 0 offen sc1
interleave_layers__linear_attn_block__memory_aug_recurrent_mem_tr__prompt_kernel_fp37:
    s_add_u32 s63, s40, 2
    s_min_u32 s63, s63, 64
    s_cmp_ge_i32 s62, s63
    s_cbranch_scc1 interleave_layers__linear_attn_block__memory_aug_recurrent_mem_tr__prompt_kernel_o_en3_ok
    s_mov_b32 s61, 0
interleave_layers__linear_attn_block__memory_aug_recurrent_mem_tr__prompt_kernel_o_en3:
    buffer_load_dword v11, v10, s[8:11], 0 offen sc1
    s_waitcnt vmcnt(0)
    v_readlane_b32 s62, v11, 0
    s_cmp_ge_i32 s62, s63
    s_cbranch_scc1 interleave_layers__linear_attn_block__memory_aug_recurrent_mem_tr__prompt_kernel_o_en3_ok
    s_add_u32 s61, s61, 1
    s_cmp_ge_u32 s61, s60
    s_cbranch_scc1 interleave_layers__linear_attn_block__memory_aug_recurrent_mem_tr__prompt_kernel_o_en3_to
    s_sleep 2
    s_branch interleave_layers__linear_attn_block__memory_aug_recurrent_mem_tr__prompt_kernel_o_en3
interleave_layers__linear_attn_block__memory_aug_recurrent_mem_tr__prompt_kernel_o_en3_to:
    s_mov_b32 s60, 1
interleave_layers__linear_attn_block__memory_aug_recurrent_mem_tr__prompt_kernel_o_en3_ok:
    buffer_load_dwordx4 v[64:67], v6, s[8:11], s41 offen offset:0 sc1
    buffer_load_dwordx4 v[68:71], v6, s[8:11], s41 offen offset:1024 sc1
    buffer_load_dwordx4 v[72:75], v6, s[8:11], s41 offen offset:2048 sc1
    buffer_load_dwordx4 v[76:79], v6, s[8:11], s41 offen offset:3072 sc1
    buffer_load_dwordx4 v[80:83], v7, s[8:11], s41 offen offset:0 sc1
    buffer_load_dwordx4 v[84:87], v7, s[8:11], s41 offen offset:1024 sc1
    buffer_load_dwordx4 v[88:91], v7, s[8:11], s41 offen offset:2048 sc1
    buffer_load_dwordx4 v[92:95], v7, s[8:11], s41 offen offset:3072 sc1
    buffer_load_dwordx4 v[96:99], v8, s[8:11], s41 offen offset:0 sc1
    buffer_load_dwordx4 v[100:103], v8, s[8:11], s41 offen offset:1024 sc1
    buffer_load_dwordx4 v[104:107], v8, s[8:11], s41 offen offset:2048 sc1
    buffer_load_dwordx4 v[108:111], v8, s[8:11], s41 offen offset:3072 sc1
    s_add_u32 s41, s41, 393216
    s_waitcnt vmcnt(0)
interleave_layers__linear_attn_block__memory_aug_recurrent_mem_tr__prompt_kernel_of36:
    s_waitcnt vmcnt(10)
    s_add_u32 s40, s40, 1
    s_add_u32 s43, s43, 1310720
    v_swap_b32 v74, v84
    v_swap_b32 v75, v85
    v_swap_b32 v98, v108
    v_swap_b32 v99, v109
    v_mfma_f32_16x16x32_bf16 v[112:115], v[64:67], a[0:3], 0
    v_mfma_f32_16x16x32_bf16 v[116:119], v[68:71], a[0:3], 0
    v_mfma_f32_16x16x32_bf16 v[120:123], v[64:67], a[24:27], 0
    v_mfma_f32_16x16x32_bf16 v[124:127], v[68:71], a[24:27], 0
    v_mfma_f32_16x16x32_bf16 v[128:131], v[64:67], a[48:51], 0
    v_mfma_f32_16x16x32_bf16 v[132:135], v[68:71], a[48:51], 0
    v_mfma_f32_16x16x32_bf16 v[136:139], v[64:67], a[72:75], 0
    v_mfma_f32_16x16x32_bf16 v[140:143], v[68:71], a[72:75], 0
    v_mfma_f32_16x16x32_bf16 v[144:147], v[64:67], a[96:99], 0
    v_mfma_f32_16x16x32_bf16 v[148:151], v[68:71], a[96:99], 0
    v_mfma_f32_16x16x32_bf16 v[152:155], v[64:67], a[120:123], 0
    v_mfma_f32_16x16x32_bf16 v[156:159], v[68:71], a[120:123], 0
    v_mfma_f32_16x16x32_bf16 v[160:163], v[64:67], a[144:147], 0
    v_mfma_f32_16x16x32_bf16 v[164:167], v[68:71], a[144:147], 0
    v_mfma_f32_16x16x32_bf16 v[168:171], v[64:67], a[168:171], 0
    v_mfma_f32_16x16x32_bf16 v[172:175], v[68:71], a[168:171], 0
    v_mfma_f32_16x16x32_bf16 v[176:179], v[64:67], a[192:195], 0
    v_mfma_f32_16x16x32_bf16 v[180:183], v[68:71], a[192:195], 0
    v_mfma_f32_16x16x32_bf16 v[184:187], v[64:67], a[216:219], 0
    v_mfma_f32_16x16x32_bf16 v[188:191], v[68:71], a[216:219], 0
    v_mfma_f32_16x16x32_bf16 v[112:115], v[76:79], a[4:7], v[112:115]
    v_mfma_f32_16x16x32_bf16 v[116:119], v[80:83], a[4:7], v[116:119]
    v_mfma_f32_16x16x32_bf16 v[120:123], v[76:79], a[28:31], v[120:123]
    v_mfma_f32_16x16x32_bf16 v[124:127], v[80:83], a[28:31], v[124:127]
    v_mfma_f32_16x16x32_bf16 v[128:131], v[76:79], a[52:55], v[128:131]
    v_mfma_f32_16x16x32_bf16 v[132:135], v[80:83], a[52:55], v[132:135]
    v_mfma_f32_16x16x32_bf16 v[136:139], v[76:79], a[76:79], v[136:139]
    v_mfma_f32_16x16x32_bf16 v[140:143], v[80:83], a[76:79], v[140:143]
    v_mfma_f32_16x16x32_bf16 v[144:147], v[76:79], a[100:103], v[144:147]
    v_mfma_f32_16x16x32_bf16 v[148:151], v[80:83], a[100:103], v[148:151]
    v_mfma_f32_16x16x32_bf16 v[152:155], v[76:79], a[124:127], v[152:155]
    v_mfma_f32_16x16x32_bf16 v[156:159], v[80:83], a[124:127], v[156:159]
    v_mfma_f32_16x16x32_bf16 v[160:163], v[76:79], a[148:151], v[160:163]
    v_mfma_f32_16x16x32_bf16 v[164:167], v[80:83], a[148:151], v[164:167]
    v_mfma_f32_16x16x32_bf16 v[168:171], v[76:79], a[172:175], v[168:171]
    v_mfma_f32_16x16x32_bf16 v[172:175], v[80:83], a[172:175], v[172:175]
    v_mfma_f32_16x16x32_bf16 v[176:179], v[76:79], a[196:199], v[176:179]
    v_mfma_f32_16x16x32_bf16 v[180:183], v[80:83], a[196:199], v[180:183]
    v_mfma_f32_16x16x32_bf16 v[184:187], v[76:79], a[220:223], v[184:187]
    v_mfma_f32_16x16x32_bf16 v[188:191], v[80:83], a[220:223], v[188:191]
    v_mfma_f32_16x16x32_bf16 v[112:115], v[88:91], a[8:11], v[112:115]
    v_mfma_f32_16x16x32_bf16 v[116:119], v[92:95], a[8:11], v[116:119]
    v_mfma_f32_16x16x32_bf16 v[120:123], v[88:91], a[32:35], v[120:123]
    v_mfma_f32_16x16x32_bf16 v[124:127], v[92:95], a[32:35], v[124:127]
    v_mfma_f32_16x16x32_bf16 v[128:131], v[88:91], a[56:59], v[128:131]
    v_mfma_f32_16x16x32_bf16 v[132:135], v[92:95], a[56:59], v[132:135]
    v_mfma_f32_16x16x32_bf16 v[136:139], v[88:91], a[80:83], v[136:139]
    v_mfma_f32_16x16x32_bf16 v[140:143], v[92:95], a[80:83], v[140:143]
    v_mfma_f32_16x16x32_bf16 v[144:147], v[88:91], a[104:107], v[144:147]
    v_mfma_f32_16x16x32_bf16 v[148:151], v[92:95], a[104:107], v[148:151]
    v_mfma_f32_16x16x32_bf16 v[152:155], v[88:91], a[128:131], v[152:155]
    v_mfma_f32_16x16x32_bf16 v[156:159], v[92:95], a[128:131], v[156:159]
    v_mfma_f32_16x16x32_bf16 v[160:163], v[88:91], a[152:155], v[160:163]
    v_mfma_f32_16x16x32_bf16 v[164:167], v[92:95], a[152:155], v[164:167]
    v_mfma_f32_16x16x32_bf16 v[168:171], v[88:91], a[176:179], v[168:171]
    v_mfma_f32_16x16x32_bf16 v[172:175], v[92:95], a[176:179], v[172:175]
    v_mfma_f32_16x16x32_bf16 v[176:179], v[88:91], a[200:203], v[176:179]
    v_mfma_f32_16x16x32_bf16 v[180:183], v[92:95], a[200:203], v[180:183]
    v_mfma_f32_16x16x32_bf16 v[184:187], v[88:91], a[224:227], v[184:187]
    v_mfma_f32_16x16x32_bf16 v[188:191], v[92:95], a[224:227], v[188:191]
    s_waitcnt vmcnt(0)
    s_barrier
    s_cmp_eq_u32 s3, 0
    s_cbranch_scc0 interleave_layers__linear_attn_block__memory_aug_recurrent_mem_tr__prompt_kernel_fp39
    v_mov_b32 v15, s40
    buffer_store_dword v15, v14, s[8:11], 0 offen sc1
interleave_layers__linear_attn_block__memory_aug_recurrent_mem_tr__prompt_kernel_fp39:
    s_add_u32 s63, s40, 2
    s_min_u32 s63, s63, 64
    s_cmp_ge_i32 s62, s63
    s_cbranch_scc1 interleave_layers__linear_attn_block__memory_aug_recurrent_mem_tr__prompt_kernel_o_en2_ok
    s_mov_b32 s61, 0
interleave_layers__linear_attn_block__memory_aug_recurrent_mem_tr__prompt_kernel_o_en2:
    buffer_load_dword v11, v10, s[8:11], 0 offen sc1
    s_waitcnt vmcnt(0)
    v_readlane_b32 s62, v11, 0
    s_cmp_ge_i32 s62, s63
    s_cbranch_scc1 interleave_layers__linear_attn_block__memory_aug_recurrent_mem_tr__prompt_kernel_o_en2_ok
    s_add_u32 s61, s61, 1
    s_cmp_ge_u32 s61, s60
    s_cbranch_scc1 interleave_layers__linear_attn_block__memory_aug_recurrent_mem_tr__prompt_kernel_o_en2_to
    s_sleep 2
    s_branch interleave_layers__linear_attn_block__memory_aug_recurrent_mem_tr__prompt_kernel_o_en2
interleave_layers__linear_attn_block__memory_aug_recurrent_mem_tr__prompt_kernel_o_en2_to:
    s_mov_b32 s60, 1
interleave_layers__linear_attn_block__memory_aug_recurrent_mem_tr__prompt_kernel_o_en2_ok:
    buffer_load_dwordx4 v[16:19], v6, s[8:11], s41 offen offset:0 sc1
    buffer_load_dwordx4 v[20:23], v6, s[8:11], s41 offen offset:1024 sc1
    buffer_load_dwordx4 v[24:27], v6, s[8:11], s41 offen offset:2048 sc1
    buffer_load_dwordx4 v[28:31], v6, s[8:11], s41 offen offset:3072 sc1
    buffer_load_dwordx4 v[32:35], v7, s[8:11], s41 offen offset:0 sc1
    buffer_load_dwordx4 v[36:39], v7, s[8:11], s41 offen offset:1024 sc1
    buffer_load_dwordx4 v[40:43], v7, s[8:11], s41 offen offset:2048 sc1
    buffer_load_dwordx4 v[44:47], v7, s[8:11], s41 offen offset:3072 sc1
    buffer_load_dwordx4 v[48:51], v8, s[8:11], s41 offen offset:0 sc1
    buffer_load_dwordx4 v[52:55], v8, s[8:11], s41 offen offset:1024 sc1
    buffer_load_dwordx4 v[56:59], v8, s[8:11], s41 offen offset:2048 sc1
    buffer_load_dwordx4 v[60:63], v8, s[8:11], s41 offen offset:3072 sc1
    s_add_u32 s41, s41, 393216
interleave_layers__linear_attn_block__memory_aug_recurrent_mem_tr__prompt_kernel_of38:
    v_mfma_f32_16x16x32_bf16 v[112:115], v[100:103], a[12:15], v[112:115]
    v_mfma_f32_16x16x32_bf16 v[116:119], v[104:107], a[12:15], v[116:119]
    v_mfma_f32_16x16x32_bf16 v[120:123], v[100:103], a[36:39], v[120:123]
    v_mfma_f32_16x16x32_bf16 v[124:127], v[104:107], a[36:39], v[124:127]
    v_mfma_f32_16x16x32_bf16 v[128:131], v[100:103], a[60:63], v[128:131]
    v_mfma_f32_16x16x32_bf16 v[132:135], v[104:107], a[60:63], v[132:135]
    v_mfma_f32_16x16x32_bf16 v[136:139], v[100:103], a[84:87], v[136:139]
    v_mfma_f32_16x16x32_bf16 v[140:143], v[104:107], a[84:87], v[140:143]
    v_mfma_f32_16x16x32_bf16 v[144:147], v[100:103], a[108:111], v[144:147]
    v_mfma_f32_16x16x32_bf16 v[148:151], v[104:107], a[108:111], v[148:151]
    v_mfma_f32_16x16x32_bf16 v[152:155], v[100:103], a[132:135], v[152:155]
    v_mfma_f32_16x16x32_bf16 v[156:159], v[104:107], a[132:135], v[156:159]
    v_mfma_f32_16x16x32_bf16 v[160:163], v[100:103], a[156:159], v[160:163]
    v_mfma_f32_16x16x32_bf16 v[164:167], v[104:107], a[156:159], v[164:167]
    v_mfma_f32_16x16x32_bf16 v[168:171], v[100:103], a[180:183], v[168:171]
    v_mfma_f32_16x16x32_bf16 v[172:175], v[104:107], a[180:183], v[172:175]
    v_mfma_f32_16x16x32_bf16 v[176:179], v[100:103], a[204:207], v[176:179]
    v_mfma_f32_16x16x32_bf16 v[180:183], v[104:107], a[204:207], v[180:183]
    v_mfma_f32_16x16x32_bf16 v[184:187], v[100:103], a[228:231], v[184:187]
    v_mfma_f32_16x16x32_bf16 v[188:191], v[104:107], a[228:231], v[188:191]
    v_mfma_f32_16x16x32_bf16 v[112:115], v[72:75], a[16:19], v[112:115]
    v_mfma_f32_16x16x32_bf16 v[116:119], v[84:87], a[16:19], v[116:119]
    v_mfma_f32_16x16x32_bf16 v[120:123], v[72:75], a[40:43], v[120:123]
    v_mfma_f32_16x16x32_bf16 v[124:127], v[84:87], a[40:43], v[124:127]
    v_mfma_f32_16x16x32_bf16 v[128:131], v[72:75], a[64:67], v[128:131]
    v_mfma_f32_16x16x32_bf16 v[132:135], v[84:87], a[64:67], v[132:135]
    v_mfma_f32_16x16x32_bf16 v[136:139], v[72:75], a[88:91], v[136:139]
    v_mfma_f32_16x16x32_bf16 v[140:143], v[84:87], a[88:91], v[140:143]
    v_mfma_f32_16x16x32_bf16 v[144:147], v[72:75], a[112:115], v[144:147]
    v_mfma_f32_16x16x32_bf16 v[148:151], v[84:87], a[112:115], v[148:151]
    v_mfma_f32_16x16x32_bf16 v[152:155], v[72:75], a[136:139], v[152:155]
    v_mfma_f32_16x16x32_bf16 v[156:159], v[84:87], a[136:139], v[156:159]
    v_mfma_f32_16x16x32_bf16 v[160:163], v[72:75], a[160:163], v[160:163]
    v_mfma_f32_16x16x32_bf16 v[164:167], v[84:87], a[160:163], v[164:167]
    v_mfma_f32_16x16x32_bf16 v[168:171], v[72:75], a[184:187], v[168:171]
    v_mfma_f32_16x16x32_bf16 v[172:175], v[84:87], a[184:187], v[172:175]
    v_mfma_f32_16x16x32_bf16 v[176:179], v[72:75], a[208:211], v[176:179]
    v_mfma_f32_16x16x32_bf16 v[180:183], v[84:87], a[208:211], v[180:183]
    v_mfma_f32_16x16x32_bf16 v[184:187], v[72:75], a[232:235], v[184:187]
    v_mfma_f32_16x16x32_bf16 v[188:191], v[84:87], a[232:235], v[188:191]
    v_mfma_f32_16x16x32_bf16 v[112:115], v[96:99], a[20:23], v[112:115]
    v_mfma_f32_16x16x32_bf16 v[116:119], v[108:111], a[20:23], v[116:119]
    v_mfma_f32_16x16x32_bf16 v[120:123], v[96:99], a[44:47], v[120:123]
    v_mfma_f32_16x16x32_bf16 v[124:127], v[108:111], a[44:47], v[124:127]
    v_mfma_f32_16x16x32_bf16 v[128:131], v[96:99], a[68:71], v[128:131]
    v_mfma_f32_16x16x32_bf16 v[132:135], v[108:111], a[68:71], v[132:135]
    v_mfma_f32_16x16x32_bf16 v[136:139], v[96:99], a[92:95], v[136:139]
    v_mfma_f32_16x16x32_bf16 v[140:143], v[108:111], a[92:95], v[140:143]
    v_mfma_f32_16x16x32_bf16 v[144:147], v[96:99], a[116:119], v[144:147]
    v_mfma_f32_16x16x32_bf16 v[148:151], v[108:111], a[116:119], v[148:151]
    v_mfma_f32_16x16x32_bf16 v[152:155], v[96:99], a[140:143], v[152:155]
    v_mfma_f32_16x16x32_bf16 v[156:159], v[108:111], a[140:143], v[156:159]
    v_mfma_f32_16x16x32_bf16 v[160:163], v[96:99], a[164:167], v[160:163]
    v_mfma_f32_16x16x32_bf16 v[164:167], v[108:111], a[164:167], v[164:167]
    v_mfma_f32_16x16x32_bf16 v[168:171], v[96:99], a[188:191], v[168:171]
    v_mfma_f32_16x16x32_bf16 v[172:175], v[108:111], a[188:191], v[172:175]
    v_mfma_f32_16x16x32_bf16 v[176:179], v[96:99], a[212:215], v[176:179]
    v_mfma_f32_16x16x32_bf16 v[180:183], v[108:111], a[212:215], v[180:183]
    v_mfma_f32_16x16x32_bf16 v[184:187], v[96:99], a[236:239], v[184:187]
    v_mfma_f32_16x16x32_bf16 v[188:191], v[108:111], a[236:239], v[188:191]
    s_mov_b32 s46, s43
    v_cvt_pk_bf16_f32 v192, v112, v113
    v_cvt_pk_bf16_f32 v193, v114, v115
    v_cvt_pk_bf16_f32 v194, v116, v117
    v_cvt_pk_bf16_f32 v195, v118, v119
    buffer_store_dwordx4 v[192:195], v9, s[8:11], s46 offen sc1
    s_add_u32 s46, s46, 32768
    v_cvt_pk_bf16_f32 v196, v120, v121
    v_cvt_pk_bf16_f32 v197, v122, v123
    v_cvt_pk_bf16_f32 v198, v124, v125
    v_cvt_pk_bf16_f32 v199, v126, v127
    buffer_store_dwordx4 v[196:199], v9, s[8:11], s46 offen sc1
    s_add_u32 s46, s46, 32768
    v_cvt_pk_bf16_f32 v200, v128, v129
    v_cvt_pk_bf16_f32 v201, v130, v131
    v_cvt_pk_bf16_f32 v202, v132, v133
    v_cvt_pk_bf16_f32 v203, v134, v135
    buffer_store_dwordx4 v[200:203], v9, s[8:11], s46 offen sc1
    s_add_u32 s46, s46, 32768
    v_cvt_pk_bf16_f32 v204, v136, v137
    v_cvt_pk_bf16_f32 v205, v138, v139
    v_cvt_pk_bf16_f32 v206, v140, v141
    v_cvt_pk_bf16_f32 v207, v142, v143
    buffer_store_dwordx4 v[204:207], v9, s[8:11], s46 offen sc1
    s_add_u32 s46, s46, 32768
    v_cvt_pk_bf16_f32 v208, v144, v145
    v_cvt_pk_bf16_f32 v209, v146, v147
    v_cvt_pk_bf16_f32 v210, v148, v149
    v_cvt_pk_bf16_f32 v211, v150, v151
    buffer_store_dwordx4 v[208:211], v9, s[8:11], s46 offen sc1
    s_add_u32 s46, s46, 32768
    v_cvt_pk_bf16_f32 v212, v152, v153
    v_cvt_pk_bf16_f32 v213, v154, v155
    v_cvt_pk_bf16_f32 v214, v156, v157
    v_cvt_pk_bf16_f32 v215, v158, v159
    buffer_store_dwordx4 v[212:215], v9, s[8:11], s46 offen sc1
    s_add_u32 s46, s46, 32768
    v_cvt_pk_bf16_f32 v216, v160, v161
    v_cvt_pk_bf16_f32 v217, v162, v163
    v_cvt_pk_bf16_f32 v218, v164, v165
    v_cvt_pk_bf16_f32 v219, v166, v167
    buffer_store_dwordx4 v[216:219], v9, s[8:11], s46 offen sc1
    s_add_u32 s46, s46, 32768
    v_cvt_pk_bf16_f32 v220, v168, v169
    v_cvt_pk_bf16_f32 v221, v170, v171
    v_cvt_pk_bf16_f32 v222, v172, v173
    v_cvt_pk_bf16_f32 v223, v174, v175
    buffer_store_dwordx4 v[220:223], v9, s[8:11], s46 offen sc1
    s_add_u32 s46, s46, 32768
    v_cvt_pk_bf16_f32 v224, v176, v177
    v_cvt_pk_bf16_f32 v225, v178, v179
    v_cvt_pk_bf16_f32 v226, v180, v181
    v_cvt_pk_bf16_f32 v227, v182, v183
    buffer_store_dwordx4 v[224:227], v9, s[8:11], s46 offen sc1
    s_add_u32 s46, s46, 32768
    v_cvt_pk_bf16_f32 v228, v184, v185
    v_cvt_pk_bf16_f32 v229, v186, v187
    v_cvt_pk_bf16_f32 v230, v188, v189
    v_cvt_pk_bf16_f32 v231, v190, v191
    buffer_store_dwordx4 v[228:231], v9, s[8:11], s46 offen sc1
    s_waitcnt vmcnt(10)
    s_add_u32 s40, s40, 1
    s_add_u32 s43, s43, 1310720
    s_cmp_lt_u32 s40, 64
    s_cbranch_scc1 interleave_layers__linear_attn_block__memory_aug_recurrent_mem_tr__prompt_kernel_o_seg
    s_waitcnt vmcnt(0)
    s_barrier
    s_cmp_eq_u32 s3, 0
    s_cbranch_scc0 interleave_layers__linear_attn_block__memory_aug_recurrent_mem_tr__prompt_kernel_fp40
    v_mov_b32 v15, s40
    buffer_store_dword v15, v14, s[8:11], 0 offen sc1
interleave_layers__linear_attn_block__memory_aug_recurrent_mem_tr__prompt_kernel_fp40:
    s_cmp_eq_u32 s92, 0
    s_cbranch_scc0 interleave_layers__linear_attn_block__memory_aug_recurrent_mem_tr__prompt_kernel_end
    s_mov_b32 s92, 1
    s_branch interleave_layers__linear_attn_block__memory_aug_recurrent_mem_tr__prompt_kernel_o_layer
interleave_layers__linear_attn_block__memory_aug_recurrent_mem_tr__prompt_kernel_end:
    s_endpgm
.section .rodata,"a"
.p2align 6
.amdhsa_kernel interleave_layers__linear_attn_block__memory_aug_recurrent_mem_tr__prompt_kernel
  .amdhsa_next_free_vgpr 512
  .amdhsa_next_free_sgpr 100
  .amdhsa_accum_offset 256
  .amdhsa_group_segment_fixed_size 0
  .amdhsa_kernarg_size 104
  .amdhsa_user_sgpr_count 2
  .amdhsa_user_sgpr_kernarg_segment_ptr 1
  .amdhsa_system_sgpr_workgroup_id_x 1
.end_amdhsa_kernel
```

```asm
; @launch kernel=interleave_layers__linear_attn_block__memory_aug_recurrent_mem_tr__prompt_kernel grid=(256,1,1) block=(256,1,1) lds=135168
.amdgcn_target "amdgcn-amd-amdhsa--gfx950"
.text
.globl interleave_layers__linear_attn_block__memory_aug_recurrent_mem_tr__prompt_kernel
.p2align 8
.type interleave_layers__linear_attn_block__memory_aug_recurrent_mem_tr__prompt_kernel,@function
interleave_layers__linear_attn_block__memory_aug_recurrent_mem_tr__prompt_kernel:
    s_cmp_ge_u32 s2, 256
    s_cbranch_scc1 interleave_layers__linear_attn_block__memory_aug_recurrent_mem_tr__prompt_kernel_end
    s_load_dwordx2 s[4:5], s[0:1], 96
    s_load_dwordx2 s[6:7], s[0:1], 88
    s_load_dwordx2 s[24:25], s[0:1], 0
    v_and_b32 v1, 63, v0
    v_lshrrev_b32 v4, 6, v0
    v_and_b32 v2, 15, v1
    v_lshrrev_b32 v3, 4, v1
    v_readfirstlane_b32 s3, v4
    s_mov_b32 s60, 131072
    s_mov_b32 s59, -1
    s_mov_b32 s92, 0
    s_waitcnt lgkmcnt(0)
    s_mov_b32 s8, s4
    s_mov_b32 s9, s5
    s_mov_b32 s10, 268435456
    s_mov_b32 s11, 0x00020000
    s_mov_b32 s72, s6
    s_mov_b32 s73, s7
    s_mov_b32 s74, 256
    s_mov_b32 s75, 0x00020000
    s_mov_b32 s16, s24
    s_mov_b32 s17, s25
    s_mov_b32 s18, 2621440
    s_mov_b32 s19, 0x00020000
    s_cmp_eq_u32 s2, 255
    s_cbranch_scc0 interleave_layers__linear_attn_block__memory_aug_recurrent_mem_tr__prompt_kernel_cf1
    v_lshlrev_b32 v5, 4, v0
    v_mov_b32 v8, -1
    v_mov_b32 v9, -1
    v_mov_b32 v10, -1
    v_mov_b32 v11, -1
    s_mov_b32 s24, 23068672
    buffer_store_dwordx4 v[8:11], v5, s[8:11], s24 offen sc1
    s_add_u32 s24, s24, 4096
    buffer_store_dwordx4 v[8:11], v5, s[8:11], s24 offen sc1
    s_add_u32 s24, s24, 4096
    buffer_store_dwordx4 v[8:11], v5, s[8:11], s24 offen sc1
    s_add_u32 s24, s24, 4096
    buffer_store_dwordx4 v[8:11], v5, s[8:11], s24 offen sc1
    s_add_u32 s24, s24, 4096
    buffer_store_dwordx4 v[8:11], v5, s[8:11], s24 offen sc1
    s_add_u32 s24, s24, 4096
    buffer_store_dwordx4 v[8:11], v5, s[8:11], s24 offen sc1
    s_add_u32 s24, s24, 4096
    buffer_store_dwordx4 v[8:11], v5, s[8:11], s24 offen sc1
    s_add_u32 s24, s24, 4096
    buffer_store_dwordx4 v[8:11], v5, s[8:11], s24 offen sc1
    s_add_u32 s24, s24, 4096
    buffer_store_dwordx4 v[8:11], v5, s[8:11], s24 offen sc1
    s_add_u32 s24, s24, 4096
    buffer_store_dwordx4 v[8:11], v5, s[8:11], s24 offen sc1
    s_add_u32 s24, s24, 4096
    buffer_store_dwordx4 v[8:11], v5, s[8:11], s24 offen sc1
    s_add_u32 s24, s24, 4096
    buffer_store_dwordx4 v[8:11], v5, s[8:11], s24 offen sc1
    s_add_u32 s24, s24, 4096
    buffer_store_dwordx4 v[8:11], v5, s[8:11], s24 offen sc1
    s_add_u32 s24, s24, 4096
    buffer_store_dwordx4 v[8:11], v5, s[8:11], s24 offen sc1
    s_add_u32 s24, s24, 4096
    buffer_store_dwordx4 v[8:11], v5, s[8:11], s24 offen sc1
    s_add_u32 s24, s24, 4096
    buffer_store_dwordx4 v[8:11], v5, s[8:11], s24 offen sc1
    s_add_u32 s24, s24, 4096
interleave_layers__linear_attn_block__memory_aug_recurrent_mem_tr__prompt_kernel_cf1:
    s_mov_b32 s46, 64
    s_mov_b32 s47, 32
    s_mov_b32 s50, 0
    s_and_b32 s44, s2, 7
    s_lshr_b32 s45, s2, 3
    s_lshl_b32 s48, s45, 1
    s_mov_b32 s49, 1
    s_mov_b32 s40, 2
interleave_layers__linear_attn_block__memory_aug_recurrent_mem_tr__prompt_kernel_k1_entry:
    s_load_dwordx2 s[6:7], s[0:1], 8
    s_lshr_b32 s24, s3, 1
    s_mul_i32 s24, s24, 20480
    s_and_b32 s25, s3, 1
    s_mul_i32 s25, s25, 10
    s_mul_i32 s25, s25, s46
    s_add_u32 s24, s24, s25
    s_cmp_eq_u32 s50, 1
    s_cselect_b32 s25, 16, 1280
    s_cselect_b32 s26, 256, 8
    v_mul_u32_u24 v4, s25, v2
    v_mul_u32_u24 v5, s26, v3
    v_add3_u32 v4, v4, v5, s24
    v_add_u32 v5, s47, v4
    s_mul_i32 s43, s48, 40960
    s_mul_i32 s42, s49, 40960
    s_mov_b32 s51, 0
    s_cmp_eq_u32 s92, 0
    s_cbranch_scc0 interleave_layers__linear_attn_block__memory_aug_recurrent_mem_tr__prompt_kernel_k12
    s_mov_b32 s41, s43
    s_mov_b32 s24, s41
    buffer_load_dwordx2 v[16:17], v4, s[16:19], s24 offen sc1
    buffer_load_dwordx2 v[18:19], v5, s[16:19], s24 offen sc1
    s_add_u32 s24, s24, s46
    buffer_load_dwordx2 v[20:21], v4, s[16:19], s24 offen sc1
    buffer_load_dwordx2 v[22:23], v5, s[16:19], s24 offen sc1
    s_add_u32 s24, s24, s46
    buffer_load_dwordx2 v[24:25], v4, s[16:19], s24 offen sc1
    buffer_load_dwordx2 v[26:27], v5, s[16:19], s24 offen sc1
    s_add_u32 s24, s24, s46
    buffer_load_dwordx2 v[28:29], v4, s[16:19], s24 offen sc1
    buffer_load_dwordx2 v[30:31], v5, s[16:19], s24 offen sc1
    s_add_u32 s24, s24, s46
    buffer_load_dwordx2 v[32:33], v4, s[16:19], s24 offen sc1
    buffer_load_dwordx2 v[34:35], v5, s[16:19], s24 offen sc1
    s_add_u32 s24, s24, s46
    buffer_load_dwordx2 v[36:37], v4, s[16:19], s24 offen sc1
    buffer_load_dwordx2 v[38:39], v5, s[16:19], s24 offen sc1
    s_add_u32 s24, s24, s46
    buffer_load_dwordx2 v[40:41], v4, s[16:19], s24 offen sc1
    buffer_load_dwordx2 v[42:43], v5, s[16:19], s24 offen sc1
    s_add_u32 s24, s24, s46
    buffer_load_dwordx2 v[44:45], v4, s[16:19], s24 offen sc1
    buffer_load_dwordx2 v[46:47], v5, s[16:19], s24 offen sc1
    s_add_u32 s24, s24, s46
    buffer_load_dwordx2 v[48:49], v4, s[16:19], s24 offen sc1
    buffer_load_dwordx2 v[50:51], v5, s[16:19], s24 offen sc1
    s_add_u32 s24, s24, s46
    buffer_load_dwordx2 v[52:53], v4, s[16:19], s24 offen sc1
    buffer_load_dwordx2 v[54:55], v5, s[16:19], s24 offen sc1
    s_mov_b32 s51, 1
interleave_layers__linear_attn_block__memory_aug_recurrent_mem_tr__prompt_kernel_k12:
    v_and_b32 v7, 31, v0
    v_lshrrev_b32 v8, 5, v0
    v_mul_u32_u24 v152, 3840, v8
    v_lshlrev_b32 v9, 4, v7
    v_add_u32 v152, v152, v9
    v_cmp_le_u32 vcc, 10, v7
    s_nop 1
    v_cndmask_b32 v10, 0, 1, vcc
    v_cmp_le_u32 vcc, 20, v7
    s_nop 1
    v_cndmask_b32 v11, 0, 1, vcc
    v_add_u32 v10, v10, v11
    v_mul_u32_u24 v10, 1120, v10
    v_add_u32 v152, v152, v10
    v_mov_b32 v10, 2146435072
    v_cmp_le_u32 vcc, 30, v7
    s_nop 1
    v_cndmask_b32 v152, v152, v10, vcc
    v_mul_u32_u24 v153, 544, v8
    v_add_u32 v153, v153, v9
    v_add_u32 v153, 40960, v153
    s_waitcnt lgkmcnt(0)
    s_mov_b32 s12, s6
    s_mov_b32 s13, s7
    s_mov_b32 s14, 2457600
    s_mov_b32 s15, 0x00020000
    s_mul_i32 s52, s44, 160
    s_add_u32 s24, s52, 0
    buffer_load_dwordx4 v[56:59], v152, s[12:15], s24 offen
    s_add_u32 s24, s24, 30720
    buffer_load_dwordx4 v[60:63], v152, s[12:15], s24 offen
    s_add_u32 s24, s24, 30720
    buffer_load_dwordx4 v[64:67], v152, s[12:15], s24 offen
    s_add_u32 s24, s24, 30720
    buffer_load_dwordx4 v[68:71], v152, s[12:15], s24 offen
    s_add_u32 s24, s24, 30720
    buffer_load_dwordx4 v[72:75], v152, s[12:15], s24 offen
    s_add_u32 s24, s24, 30720
    buffer_load_dwordx4 v[76:79], v152, s[12:15], s24 offen
    s_add_u32 s24, s24, 30720
    buffer_load_dwordx4 v[80:83], v152, s[12:15], s24 offen
    s_add_u32 s24, s24, 30720
    buffer_load_dwordx4 v[84:87], v152, s[12:15], s24 offen
    s_add_u32 s24, s52, 245760
    buffer_load_dwordx4 v[88:91], v152, s[12:15], s24 offen
    s_add_u32 s24, s24, 30720
    buffer_load_dwordx4 v[92:95], v152, s[12:15], s24 offen
    s_add_u32 s24, s24, 30720
    buffer_load_dwordx4 v[96:99], v152, s[12:15], s24 offen
    s_add_u32 s24, s24, 30720
    buffer_load_dwordx4 v[100:103], v152, s[12:15], s24 offen
    s_add_u32 s24, s24, 30720
    buffer_load_dwordx4 v[104:107], v152, s[12:15], s24 offen
    s_add_u32 s24, s24, 30720
    buffer_load_dwordx4 v[108:111], v152, s[12:15], s24 offen
    s_add_u32 s24, s24, 30720
    buffer_load_dwordx4 v[112:115], v152, s[12:15], s24 offen
    s_add_u32 s24, s24, 30720
    buffer_load_dwordx4 v[116:119], v152, s[12:15], s24 offen
    s_add_u32 s24, s52, 491520
    buffer_load_dwordx4 v[120:123], v152, s[12:15], s24 offen
    s_add_u32 s24, s24, 30720
    buffer_load_dwordx4 v[124:127], v152, s[12:15], s24 offen
    s_add_u32 s24, s24, 30720
    buffer_load_dwordx4 v[128:131], v152, s[12:15], s24 offen
    s_add_u32 s24, s24, 30720
    buffer_load_dwordx4 v[132:135], v152, s[12:15], s24 offen
    s_add_u32 s24, s24, 30720
    buffer_load_dwordx4 v[136:139], v152, s[12:15], s24 offen
    s_add_u32 s24, s24, 30720
    buffer_load_dwordx4 v[140:143], v152, s[12:15], s24 offen
    s_add_u32 s24, s24, 30720
    buffer_load_dwordx4 v[144:147], v152, s[12:15], s24 offen
    s_add_u32 s24, s24, 30720
    buffer_load_dwordx4 v[148:151], v152, s[12:15], s24 offen
    v_lshrrev_b32 v6, 2, v2
    v_lshl_add_u32 v6, v3, 2, v6
    v_mul_u32_u24 v6, 544, v6
    v_and_b32 v7, 3, v2
    v_lshl_add_u32 v6, v7, 3, v6
    v_add_u32 v6, 40960, v6
    s_mov_b32 s24, 0
    s_cmp_eq_u32 s3, 1
    s_cselect_b32 s24, 64, s24
    s_cmp_eq_u32 s3, 2
    s_cselect_b32 s24, 128, s24
    s_cmp_eq_u32 s3, 3
    s_cselect_b32 s24, 224, s24
    v_add_u32 v12, s24, v6
    s_mov_b32 s24, 32
    s_cmp_eq_u32 s3, 1
    s_cselect_b32 s24, 96, s24
    s_cmp_eq_u32 s3, 2
    s_cselect_b32 s24, 160, s24
    s_cmp_eq_u32 s3, 3
    s_cselect_b32 s24, 256, s24
    v_add_u32 v13, s24, v6
    s_mov_b32 s24, 320
    s_cmp_eq_u32 s3, 1
    s_cselect_b32 s24, 384, s24
    s_cmp_eq_u32 s3, 2
    s_cselect_b32 s24, 192, s24
    s_cmp_eq_u32 s3, 3
    s_cselect_b32 s24, 288, s24
    v_add_u32 v14, s24, v6
    s_mov_b32 s24, 352
    s_cmp_eq_u32 s3, 1
    s_cselect_b32 s24, 416, s24
    s_cmp_eq_u32 s3, 2
    s_cselect_b32 s24, 448, s24
    s_cmp_eq_u32 s3, 3
    s_cselect_b32 s24, 288, s24
    v_add_u32 v15, s24, v6
    v_mov_b32 v172, 0x3f803f80
    v_mov_b32 v173, 0x3f803f80
    v_mov_b32 v174, 0x3f803f80
    v_mov_b32 v175, 0x3f803f80
    s_waitcnt vmcnt(16)
    ds_write_b128 v153, v[56:59] offset:0
    ds_write_b128 v153, v[60:63] offset:4352
    ds_write_b128 v153, v[64:67] offset:8704
    ds_write_b128 v153, v[68:71] offset:13056
    ds_write_b128 v153, v[72:75] offset:17408
    ds_write_b128 v153, v[76:79] offset:21760
    ds_write_b128 v153, v[80:83] offset:26112
    ds_write_b128 v153, v[84:87] offset:30464
    s_waitcnt lgkmcnt(0)
    s_add_u32 s24, s52, 737280
    buffer_load_dwordx4 v[56:59], v152, s[12:15], s24 offen
    s_add_u32 s24, s24, 30720
    buffer_load_dwordx4 v[60:63], v152, s[12:15], s24 offen
    s_add_u32 s24, s24, 30720
    buffer_load_dwordx4 v[64:67], v152, s[12:15], s24 offen
    s_add_u32 s24, s24, 30720
    buffer_load_dwordx4 v[68:71], v152, s[12:15], s24 offen
    s_add_u32 s24, s24, 30720
    buffer_load_dwordx4 v[72:75], v152, s[12:15], s24 offen
    s_add_u32 s24, s24, 30720
    buffer_load_dwordx4 v[76:79], v152, s[12:15], s24 offen
    s_add_u32 s24, s24, 30720
    buffer_load_dwordx4 v[80:83], v152, s[12:15], s24 offen
    s_add_u32 s24, s24, 30720
    buffer_load_dwordx4 v[84:87], v152, s[12:15], s24 offen
    s_barrier
    s_cmp_eq_u32 s2, 255
    s_cbranch_scc0 interleave_layers__linear_attn_block__memory_aug_recurrent_mem_tr__prompt_kernel_fb3
    s_cmp_eq_u32 s92, 0
    s_cbranch_scc0 interleave_layers__linear_attn_block__memory_aug_recurrent_mem_tr__prompt_kernel_fb3
    s_cmp_eq_u32 s3, 0
    s_cbranch_scc0 interleave_layers__linear_attn_block__memory_aug_recurrent_mem_tr__prompt_kernel_fb3
    v_mov_b32 v154, 2146435072
    v_cmp_eq_u32 vcc, 0, v1
    s_nop 1
    v_cndmask_b32 v154, v154, 0, vcc
    v_mov_b32 v155, 1
    buffer_store_dword v155, v154, s[72:75], 0 offen sc1
interleave_layers__linear_attn_block__memory_aug_recurrent_mem_tr__prompt_kernel_fb3:
    ds_read_b64_tr_b16 a[0:1], v12 offset:0
    ds_read_b64_tr_b16 a[2:3], v12 offset:8704
    ds_read_b64_tr_b16 a[4:5], v12 offset:17408
    ds_read_b64_tr_b16 a[6:7], v12 offset:26112
    ds_read_b64_tr_b16 a[80:81], v13 offset:0
    ds_read_b64_tr_b16 a[82:83], v13 offset:8704
    ds_read_b64_tr_b16 a[84:85], v13 offset:17408
    ds_read_b64_tr_b16 a[86:87], v13 offset:26112
    ds_read_b64_tr_b16 a[160:161], v14 offset:0
    ds_read_b64_tr_b16 a[162:163], v14 offset:8704
    ds_read_b64_tr_b16 a[164:165], v14 offset:17408
    ds_read_b64_tr_b16 a[166:167], v14 offset:26112
    ds_read_b64_tr_b16 v[176:177], v15 offset:0
    ds_read_b64_tr_b16 v[178:179], v15 offset:8704
    ds_read_b64_tr_b16 v[180:181], v15 offset:17408
    ds_read_b64_tr_b16 v[182:183], v15 offset:26112
    s_waitcnt vmcnt(16)
    ds_write_b128 v153, v[88:91] offset:34816
    ds_write_b128 v153, v[92:95] offset:39168
    ds_write_b128 v153, v[96:99] offset:43520
    ds_write_b128 v153, v[100:103] offset:47872
    ds_write_b128 v153, v[104:107] offset:52224
    ds_write_b128 v153, v[108:111] offset:56576
    ds_write_b128 v153, v[112:115] offset:60928
    ds_write_b128 v153, v[116:119] offset:65280
    s_waitcnt lgkmcnt(0)
    s_add_u32 s24, s52, 983040
    buffer_load_dwordx4 v[88:91], v152, s[12:15], s24 offen
    s_add_u32 s24, s24, 30720
    buffer_load_dwordx4 v[92:95], v152, s[12:15], s24 offen
    s_add_u32 s24, s24, 30720
    buffer_load_dwordx4 v[96:99], v152, s[12:15], s24 offen
    s_add_u32 s24, s24, 30720
    buffer_load_dwordx4 v[100:103], v152, s[12:15], s24 offen
    s_add_u32 s24, s24, 30720
    buffer_load_dwordx4 v[104:107], v152, s[12:15], s24 offen
    s_add_u32 s24, s24, 30720
    buffer_load_dwordx4 v[108:111], v152, s[12:15], s24 offen
    s_add_u32 s24, s24, 30720
    buffer_load_dwordx4 v[112:115], v152, s[12:15], s24 offen
    s_add_u32 s24, s24, 30720
    buffer_load_dwordx4 v[116:119], v152, s[12:15], s24 offen
    v_mfma_f32_16x16x32_bf16 v[156:159], a[0:3], v[172:175], 0
    v_mfma_f32_16x16x32_bf16 v[160:163], a[80:83], v[172:175], 0
    v_mfma_f32_16x16x32_bf16 v[164:167], a[160:163], v[172:175], 0
    v_mfma_f32_16x16x32_bf16 v[168:171], v[176:179], v[172:175], 0
    v_mfma_f32_16x16x32_bf16 v[156:159], a[4:7], v[172:175], v[156:159]
    v_mfma_f32_16x16x32_bf16 v[160:163], a[84:87], v[172:175], v[160:163]
    v_mfma_f32_16x16x32_bf16 v[164:167], a[164:167], v[172:175], v[164:167]
    v_mfma_f32_16x16x32_bf16 v[168:171], v[180:183], v[172:175], v[168:171]
    s_barrier
    ds_read_b64_tr_b16 a[8:9], v12 offset:34816
    ds_read_b64_tr_b16 a[10:11], v12 offset:43520
    ds_read_b64_tr_b16 a[12:13], v12 offset:52224
    ds_read_b64_tr_b16 a[14:15], v12 offset:60928
    ds_read_b64_tr_b16 a[88:89], v13 offset:34816
    ds_read_b64_tr_b16 a[90:91], v13 offset:43520
    ds_read_b64_tr_b16 a[92:93], v13 offset:52224
    ds_read_b64_tr_b16 a[94:95], v13 offset:60928
    ds_read_b64_tr_b16 a[168:169], v14 offset:34816
    ds_read_b64_tr_b16 a[170:171], v14 offset:43520
    ds_read_b64_tr_b16 a[172:173], v14 offset:52224
    ds_read_b64_tr_b16 a[174:175], v14 offset:60928
    ds_read_b64_tr_b16 v[184:185], v15 offset:34816
    ds_read_b64_tr_b16 v[186:187], v15 offset:43520
    ds_read_b64_tr_b16 v[188:189], v15 offset:52224
    ds_read_b64_tr_b16 v[190:191], v15 offset:60928
    s_waitcnt vmcnt(16)
    ds_write_b128 v153, v[120:123] offset:0
    ds_write_b128 v153, v[124:127] offset:4352
    ds_write_b128 v153, v[128:131] offset:8704
    ds_write_b128 v153, v[132:135] offset:13056
    ds_write_b128 v153, v[136:139] offset:17408
    ds_write_b128 v153, v[140:143] offset:21760
    ds_write_b128 v153, v[144:147] offset:26112
    ds_write_b128 v153, v[148:151] offset:30464
    s_waitcnt lgkmcnt(0)
    s_add_u32 s24, s52, 1228800
    buffer_load_dwordx4 v[120:123], v152, s[12:15], s24 offen
    s_add_u32 s24, s24, 30720
    buffer_load_dwordx4 v[124:127], v152, s[12:15], s24 offen
    s_add_u32 s24, s24, 30720
    buffer_load_dwordx4 v[128:131], v152, s[12:15], s24 offen
    s_add_u32 s24, s24, 30720
    buffer_load_dwordx4 v[132:135], v152, s[12:15], s24 offen
    s_add_u32 s24, s24, 30720
    buffer_load_dwordx4 v[136:139], v152, s[12:15], s24 offen
    s_add_u32 s24, s24, 30720
    buffer_load_dwordx4 v[140:143], v152, s[12:15], s24 offen
    s_add_u32 s24, s24, 30720
    buffer_load_dwordx4 v[144:147], v152, s[12:15], s24 offen
    s_add_u32 s24, s24, 30720
    buffer_load_dwordx4 v[148:151], v152, s[12:15], s24 offen
    v_mfma_f32_16x16x32_bf16 v[156:159], a[8:11], v[172:175], v[156:159]
    v_mfma_f32_16x16x32_bf16 v[160:163], a[88:91], v[172:175], v[160:163]
    v_mfma_f32_16x16x32_bf16 v[164:167], a[168:171], v[172:175], v[164:167]
    v_mfma_f32_16x16x32_bf16 v[168:171], v[184:187], v[172:175], v[168:171]
    v_mfma_f32_16x16x32_bf16 v[156:159], a[12:15], v[172:175], v[156:159]
    v_mfma_f32_16x16x32_bf16 v[160:163], a[92:95], v[172:175], v[160:163]
    v_mfma_f32_16x16x32_bf16 v[164:167], a[172:175], v[172:175], v[164:167]
    v_mfma_f32_16x16x32_bf16 v[168:171], v[188:191], v[172:175], v[168:171]
    s_barrier
    ds_read_b64_tr_b16 a[16:17], v12 offset:0
    ds_read_b64_tr_b16 a[18:19], v12 offset:8704
    ds_read_b64_tr_b16 a[20:21], v12 offset:17408
    ds_read_b64_tr_b16 a[22:23], v12 offset:26112
    ds_read_b64_tr_b16 a[96:97], v13 offset:0
    ds_read_b64_tr_b16 a[98:99], v13 offset:8704
    ds_read_b64_tr_b16 a[100:101], v13 offset:17408
    ds_read_b64_tr_b16 a[102:103], v13 offset:26112
    ds_read_b64_tr_b16 a[176:177], v14 offset:0
    ds_read_b64_tr_b16 a[178:179], v14 offset:8704
    ds_read_b64_tr_b16 a[180:181], v14 offset:17408
    ds_read_b64_tr_b16 a[182:183], v14 offset:26112
    ds_read_b64_tr_b16 v[192:193], v15 offset:0
    ds_read_b64_tr_b16 v[194:195], v15 offset:8704
    ds_read_b64_tr_b16 v[196:197], v15 offset:17408
    ds_read_b64_tr_b16 v[198:199], v15 offset:26112
    s_waitcnt vmcnt(16)
    ds_write_b128 v153, v[56:59] offset:34816
    ds_write_b128 v153, v[60:63] offset:39168
    ds_write_b128 v153, v[64:67] offset:43520
    ds_write_b128 v153, v[68:71] offset:47872
    ds_write_b128 v153, v[72:75] offset:52224
    ds_write_b128 v153, v[76:79] offset:56576
    ds_write_b128 v153, v[80:83] offset:60928
    ds_write_b128 v153, v[84:87] offset:65280
    s_waitcnt lgkmcnt(0)
    s_add_u32 s24, s52, 1474560
    buffer_load_dwordx4 v[56:59], v152, s[12:15], s24 offen
    s_add_u32 s24, s24, 30720
    buffer_load_dwordx4 v[60:63], v152, s[12:15], s24 offen
    s_add_u32 s24, s24, 30720
    buffer_load_dwordx4 v[64:67], v152, s[12:15], s24 offen
    s_add_u32 s24, s24, 30720
    buffer_load_dwordx4 v[68:71], v152, s[12:15], s24 offen
    s_add_u32 s24, s24, 30720
    buffer_load_dwordx4 v[72:75], v152, s[12:15], s24 offen
    s_add_u32 s24, s24, 30720
    buffer_load_dwordx4 v[76:79], v152, s[12:15], s24 offen
    s_add_u32 s24, s24, 30720
    buffer_load_dwordx4 v[80:83], v152, s[12:15], s24 offen
    s_add_u32 s24, s24, 30720
    buffer_load_dwordx4 v[84:87], v152, s[12:15], s24 offen
    v_mfma_f32_16x16x32_bf16 v[156:159], a[16:19], v[172:175], v[156:159]
    v_mfma_f32_16x16x32_bf16 v[160:163], a[96:99], v[172:175], v[160:163]
    v_mfma_f32_16x16x32_bf16 v[164:167], a[176:179], v[172:175], v[164:167]
    v_mfma_f32_16x16x32_bf16 v[168:171], v[192:195], v[172:175], v[168:171]
    v_mfma_f32_16x16x32_bf16 v[156:159], a[20:23], v[172:175], v[156:159]
    v_mfma_f32_16x16x32_bf16 v[160:163], a[100:103], v[172:175], v[160:163]
    v_mfma_f32_16x16x32_bf16 v[164:167], a[180:183], v[172:175], v[164:167]
    v_mfma_f32_16x16x32_bf16 v[168:171], v[196:199], v[172:175], v[168:171]
    s_barrier
    ds_read_b64_tr_b16 a[24:25], v12 offset:34816
    ds_read_b64_tr_b16 a[26:27], v12 offset:43520
    ds_read_b64_tr_b16 a[28:29], v12 offset:52224
    ds_read_b64_tr_b16 a[30:31], v12 offset:60928
    ds_read_b64_tr_b16 a[104:105], v13 offset:34816
    ds_read_b64_tr_b16 a[106:107], v13 offset:43520
    ds_read_b64_tr_b16 a[108:109], v13 offset:52224
    ds_read_b64_tr_b16 a[110:111], v13 offset:60928
    ds_read_b64_tr_b16 a[184:185], v14 offset:34816
    ds_read_b64_tr_b16 a[186:187], v14 offset:43520
    ds_read_b64_tr_b16 a[188:189], v14 offset:52224
    ds_read_b64_tr_b16 a[190:191], v14 offset:60928
    ds_read_b64_tr_b16 v[200:201], v15 offset:34816
    ds_read_b64_tr_b16 v[202:203], v15 offset:43520
    ds_read_b64_tr_b16 v[204:205], v15 offset:52224
    ds_read_b64_tr_b16 v[206:207], v15 offset:60928
    s_waitcnt vmcnt(16)
    ds_write_b128 v153, v[88:91] offset:0
    ds_write_b128 v153, v[92:95] offset:4352
    ds_write_b128 v153, v[96:99] offset:8704
    ds_write_b128 v153, v[100:103] offset:13056
    ds_write_b128 v153, v[104:107] offset:17408
    ds_write_b128 v153, v[108:111] offset:21760
    ds_write_b128 v153, v[112:115] offset:26112
    ds_write_b128 v153, v[116:119] offset:30464
    s_waitcnt lgkmcnt(0)
    s_add_u32 s24, s52, 1720320
    buffer_load_dwordx4 v[88:91], v152, s[12:15], s24 offen
    s_add_u32 s24, s24, 30720
    buffer_load_dwordx4 v[92:95], v152, s[12:15], s24 offen
    s_add_u32 s24, s24, 30720
    buffer_load_dwordx4 v[96:99], v152, s[12:15], s24 offen
    s_add_u32 s24, s24, 30720
    buffer_load_dwordx4 v[100:103], v152, s[12:15], s24 offen
    s_add_u32 s24, s24, 30720
    buffer_load_dwordx4 v[104:107], v152, s[12:15], s24 offen
    s_add_u32 s24, s24, 30720
    buffer_load_dwordx4 v[108:111], v152, s[12:15], s24 offen
    s_add_u32 s24, s24, 30720
    buffer_load_dwordx4 v[112:115], v152, s[12:15], s24 offen
    s_add_u32 s24, s24, 30720
    buffer_load_dwordx4 v[116:119], v152, s[12:15], s24 offen
    v_mfma_f32_16x16x32_bf16 v[156:159], a[24:27], v[172:175], v[156:159]
    v_mfma_f32_16x16x32_bf16 v[160:163], a[104:107], v[172:175], v[160:163]
    v_mfma_f32_16x16x32_bf16 v[164:167], a[184:187], v[172:175], v[164:167]
    v_mfma_f32_16x16x32_bf16 v[168:171], v[200:203], v[172:175], v[168:171]
    v_mfma_f32_16x16x32_bf16 v[156:159], a[28:31], v[172:175], v[156:159]
    v_mfma_f32_16x16x32_bf16 v[160:163], a[108:111], v[172:175], v[160:163]
    v_mfma_f32_16x16x32_bf16 v[164:167], a[188:191], v[172:175], v[164:167]
    v_mfma_f32_16x16x32_bf16 v[168:171], v[204:207], v[172:175], v[168:171]
    s_barrier
    ds_read_b64_tr_b16 a[32:33], v12 offset:0
    ds_read_b64_tr_b16 a[34:35], v12 offset:8704
    ds_read_b64_tr_b16 a[36:37], v12 offset:17408
    ds_read_b64_tr_b16 a[38:39], v12 offset:26112
    ds_read_b64_tr_b16 a[112:113], v13 offset:0
    ds_read_b64_tr_b16 a[114:115], v13 offset:8704
    ds_read_b64_tr_b16 a[116:117], v13 offset:17408
    ds_read_b64_tr_b16 a[118:119], v13 offset:26112
    ds_read_b64_tr_b16 a[192:193], v14 offset:0
    ds_read_b64_tr_b16 a[194:195], v14 offset:8704
    ds_read_b64_tr_b16 a[196:197], v14 offset:17408
    ds_read_b64_tr_b16 a[198:199], v14 offset:26112
    ds_read_b64_tr_b16 v[208:209], v15 offset:0
    ds_read_b64_tr_b16 v[210:211], v15 offset:8704
    ds_read_b64_tr_b16 v[212:213], v15 offset:17408
    ds_read_b64_tr_b16 v[214:215], v15 offset:26112
    s_waitcnt vmcnt(16)
    ds_write_b128 v153, v[120:123] offset:34816
    ds_write_b128 v153, v[124:127] offset:39168
    ds_write_b128 v153, v[128:131] offset:43520
    ds_write_b128 v153, v[132:135] offset:47872
    ds_write_b128 v153, v[136:139] offset:52224
    ds_write_b128 v153, v[140:143] offset:56576
    ds_write_b128 v153, v[144:147] offset:60928
    ds_write_b128 v153, v[148:151] offset:65280
    s_waitcnt lgkmcnt(0)
    s_add_u32 s24, s52, 1966080
    buffer_load_dwordx4 v[120:123], v152, s[12:15], s24 offen
    s_add_u32 s24, s24, 30720
    buffer_load_dwordx4 v[124:127], v152, s[12:15], s24 offen
    s_add_u32 s24, s24, 30720
    buffer_load_dwordx4 v[128:131], v152, s[12:15], s24 offen
    s_add_u32 s24, s24, 30720
    buffer_load_dwordx4 v[132:135], v152, s[12:15], s24 offen
    s_add_u32 s24, s24, 30720
    buffer_load_dwordx4 v[136:139], v152, s[12:15], s24 offen
    s_add_u32 s24, s24, 30720
    buffer_load_dwordx4 v[140:143], v152, s[12:15], s24 offen
    s_add_u32 s24, s24, 30720
    buffer_load_dwordx4 v[144:147], v152, s[12:15], s24 offen
    s_add_u32 s24, s24, 30720
    buffer_load_dwordx4 v[148:151], v152, s[12:15], s24 offen
    v_mfma_f32_16x16x32_bf16 v[156:159], a[32:35], v[172:175], v[156:159]
    v_mfma_f32_16x16x32_bf16 v[160:163], a[112:115], v[172:175], v[160:163]
    v_mfma_f32_16x16x32_bf16 v[164:167], a[192:195], v[172:175], v[164:167]
    v_mfma_f32_16x16x32_bf16 v[168:171], v[208:211], v[172:175], v[168:171]
    v_mfma_f32_16x16x32_bf16 v[156:159], a[36:39], v[172:175], v[156:159]
    v_mfma_f32_16x16x32_bf16 v[160:163], a[116:119], v[172:175], v[160:163]
    v_mfma_f32_16x16x32_bf16 v[164:167], a[196:199], v[172:175], v[164:167]
    v_mfma_f32_16x16x32_bf16 v[168:171], v[212:215], v[172:175], v[168:171]
    s_barrier
    ds_read_b64_tr_b16 a[40:41], v12 offset:34816
    ds_read_b64_tr_b16 a[42:43], v12 offset:43520
    ds_read_b64_tr_b16 a[44:45], v12 offset:52224
    ds_read_b64_tr_b16 a[46:47], v12 offset:60928
    ds_read_b64_tr_b16 a[120:121], v13 offset:34816
    ds_read_b64_tr_b16 a[122:123], v13 offset:43520
    ds_read_b64_tr_b16 a[124:125], v13 offset:52224
    ds_read_b64_tr_b16 a[126:127], v13 offset:60928
    ds_read_b64_tr_b16 a[200:201], v14 offset:34816
    ds_read_b64_tr_b16 a[202:203], v14 offset:43520
    ds_read_b64_tr_b16 a[204:205], v14 offset:52224
    ds_read_b64_tr_b16 a[206:207], v14 offset:60928
    ds_read_b64_tr_b16 v[216:217], v15 offset:34816
    ds_read_b64_tr_b16 v[218:219], v15 offset:43520
    ds_read_b64_tr_b16 v[220:221], v15 offset:52224
    ds_read_b64_tr_b16 v[222:223], v15 offset:60928
    s_waitcnt vmcnt(16)
    ds_write_b128 v153, v[56:59] offset:0
    ds_write_b128 v153, v[60:63] offset:4352
    ds_write_b128 v153, v[64:67] offset:8704
    ds_write_b128 v153, v[68:71] offset:13056
    ds_write_b128 v153, v[72:75] offset:17408
    ds_write_b128 v153, v[76:79] offset:21760
    ds_write_b128 v153, v[80:83] offset:26112
    ds_write_b128 v153, v[84:87] offset:30464
    s_waitcnt lgkmcnt(0)
    s_add_u32 s24, s52, 2211840
    buffer_load_dwordx4 v[56:59], v152, s[12:15], s24 offen
    s_add_u32 s24, s24, 30720
    buffer_load_dwordx4 v[60:63], v152, s[12:15], s24 offen
    s_add_u32 s24, s24, 30720
    buffer_load_dwordx4 v[64:67], v152, s[12:15], s24 offen
    s_add_u32 s24, s24, 30720
    buffer_load_dwordx4 v[68:71], v152, s[12:15], s24 offen
    s_add_u32 s24, s24, 30720
    buffer_load_dwordx4 v[72:75], v152, s[12:15], s24 offen
    s_add_u32 s24, s24, 30720
    buffer_load_dwordx4 v[76:79], v152, s[12:15], s24 offen
    s_add_u32 s24, s24, 30720
    buffer_load_dwordx4 v[80:83], v152, s[12:15], s24 offen
    s_add_u32 s24, s24, 30720
    buffer_load_dwordx4 v[84:87], v152, s[12:15], s24 offen
    v_mfma_f32_16x16x32_bf16 v[156:159], a[40:43], v[172:175], v[156:159]
    v_mfma_f32_16x16x32_bf16 v[160:163], a[120:123], v[172:175], v[160:163]
    v_mfma_f32_16x16x32_bf16 v[164:167], a[200:203], v[172:175], v[164:167]
    v_mfma_f32_16x16x32_bf16 v[168:171], v[216:219], v[172:175], v[168:171]
    v_mfma_f32_16x16x32_bf16 v[156:159], a[44:47], v[172:175], v[156:159]
    v_mfma_f32_16x16x32_bf16 v[160:163], a[124:127], v[172:175], v[160:163]
    v_mfma_f32_16x16x32_bf16 v[164:167], a[204:207], v[172:175], v[164:167]
    v_mfma_f32_16x16x32_bf16 v[168:171], v[220:223], v[172:175], v[168:171]
    s_barrier
    ds_read_b64_tr_b16 a[48:49], v12 offset:0
    ds_read_b64_tr_b16 a[50:51], v12 offset:8704
    ds_read_b64_tr_b16 a[52:53], v12 offset:17408
    ds_read_b64_tr_b16 a[54:55], v12 offset:26112
    ds_read_b64_tr_b16 a[128:129], v13 offset:0
    ds_read_b64_tr_b16 a[130:131], v13 offset:8704
    ds_read_b64_tr_b16 a[132:133], v13 offset:17408
    ds_read_b64_tr_b16 a[134:135], v13 offset:26112
    ds_read_b64_tr_b16 a[208:209], v14 offset:0
    ds_read_b64_tr_b16 a[210:211], v14 offset:8704
    ds_read_b64_tr_b16 a[212:213], v14 offset:17408
    ds_read_b64_tr_b16 a[214:215], v14 offset:26112
    ds_read_b64_tr_b16 v[224:225], v15 offset:0
    ds_read_b64_tr_b16 v[226:227], v15 offset:8704
    ds_read_b64_tr_b16 v[228:229], v15 offset:17408
    ds_read_b64_tr_b16 v[230:231], v15 offset:26112
    s_waitcnt vmcnt(16)
    ds_write_b128 v153, v[88:91] offset:34816
    ds_write_b128 v153, v[92:95] offset:39168
    ds_write_b128 v153, v[96:99] offset:43520
    ds_write_b128 v153, v[100:103] offset:47872
    ds_write_b128 v153, v[104:107] offset:52224
    ds_write_b128 v153, v[108:111] offset:56576
    ds_write_b128 v153, v[112:115] offset:60928
    ds_write_b128 v153, v[116:119] offset:65280
    s_waitcnt lgkmcnt(0)
    v_mfma_f32_16x16x32_bf16 v[156:159], a[48:51], v[172:175], v[156:159]
    v_mfma_f32_16x16x32_bf16 v[160:163], a[128:131], v[172:175], v[160:163]
    v_mfma_f32_16x16x32_bf16 v[164:167], a[208:211], v[172:175], v[164:167]
    v_mfma_f32_16x16x32_bf16 v[168:171], v[224:227], v[172:175], v[168:171]
    v_mfma_f32_16x16x32_bf16 v[156:159], a[52:55], v[172:175], v[156:159]
    v_mfma_f32_16x16x32_bf16 v[160:163], a[132:135], v[172:175], v[160:163]
    v_mfma_f32_16x16x32_bf16 v[164:167], a[212:215], v[172:175], v[164:167]
    v_mfma_f32_16x16x32_bf16 v[168:171], v[228:231], v[172:175], v[168:171]
    s_barrier
    ds_read_b64_tr_b16 a[56:57], v12 offset:34816
    ds_read_b64_tr_b16 a[58:59], v12 offset:43520
    ds_read_b64_tr_b16 a[60:61], v12 offset:52224
    ds_read_b64_tr_b16 a[62:63], v12 offset:60928
    ds_read_b64_tr_b16 a[136:137], v13 offset:34816
    ds_read_b64_tr_b16 a[138:139], v13 offset:43520
    ds_read_b64_tr_b16 a[140:141], v13 offset:52224
    ds_read_b64_tr_b16 a[142:143], v13 offset:60928
    ds_read_b64_tr_b16 a[216:217], v14 offset:34816
    ds_read_b64_tr_b16 a[218:219], v14 offset:43520
    ds_read_b64_tr_b16 a[220:221], v14 offset:52224
    ds_read_b64_tr_b16 a[222:223], v14 offset:60928
    ds_read_b64_tr_b16 v[232:233], v15 offset:34816
    ds_read_b64_tr_b16 v[234:235], v15 offset:43520
    ds_read_b64_tr_b16 v[236:237], v15 offset:52224
    ds_read_b64_tr_b16 v[238:239], v15 offset:60928
    s_waitcnt vmcnt(8)
    ds_write_b128 v153, v[120:123] offset:0
    ds_write_b128 v153, v[124:127] offset:4352
    ds_write_b128 v153, v[128:131] offset:8704
    ds_write_b128 v153, v[132:135] offset:13056
    ds_write_b128 v153, v[136:139] offset:17408
    ds_write_b128 v153, v[140:143] offset:21760
    ds_write_b128 v153, v[144:147] offset:26112
    ds_write_b128 v153, v[148:151] offset:30464
    s_waitcnt lgkmcnt(0)
    v_mfma_f32_16x16x32_bf16 v[156:159], a[56:59], v[172:175], v[156:159]
    v_mfma_f32_16x16x32_bf16 v[160:163], a[136:139], v[172:175], v[160:163]
    v_mfma_f32_16x16x32_bf16 v[164:167], a[216:219], v[172:175], v[164:167]
    v_mfma_f32_16x16x32_bf16 v[168:171], v[232:235], v[172:175], v[168:171]
    v_mfma_f32_16x16x32_bf16 v[156:159], a[60:63], v[172:175], v[156:159]
    v_mfma_f32_16x16x32_bf16 v[160:163], a[140:143], v[172:175], v[160:163]
    v_mfma_f32_16x16x32_bf16 v[164:167], a[220:223], v[172:175], v[164:167]
    v_mfma_f32_16x16x32_bf16 v[168:171], v[236:239], v[172:175], v[168:171]
    s_barrier
    ds_read_b64_tr_b16 a[64:65], v12 offset:0
    ds_read_b64_tr_b16 a[66:67], v12 offset:8704
    ds_read_b64_tr_b16 a[68:69], v12 offset:17408
    ds_read_b64_tr_b16 a[70:71], v12 offset:26112
    ds_read_b64_tr_b16 a[144:145], v13 offset:0
    ds_read_b64_tr_b16 a[146:147], v13 offset:8704
    ds_read_b64_tr_b16 a[148:149], v13 offset:17408
    ds_read_b64_tr_b16 a[150:151], v13 offset:26112
    ds_read_b64_tr_b16 a[224:225], v14 offset:0
    ds_read_b64_tr_b16 a[226:227], v14 offset:8704
    ds_read_b64_tr_b16 a[228:229], v14 offset:17408
    ds_read_b64_tr_b16 a[230:231], v14 offset:26112
    ds_read_b64_tr_b16 v[240:241], v15 offset:0
    ds_read_b64_tr_b16 v[242:243], v15 offset:8704
    ds_read_b64_tr_b16 v[244:245], v15 offset:17408
    ds_read_b64_tr_b16 v[246:247], v15 offset:26112
    s_waitcnt vmcnt(0)
    ds_write_b128 v153, v[56:59] offset:34816
    ds_write_b128 v153, v[60:63] offset:39168
    ds_write_b128 v153, v[64:67] offset:43520
    ds_write_b128 v153, v[68:71] offset:47872
    ds_write_b128 v153, v[72:75] offset:52224
    ds_write_b128 v153, v[76:79] offset:56576
    ds_write_b128 v153, v[80:83] offset:60928
    ds_write_b128 v153, v[84:87] offset:65280
    s_waitcnt lgkmcnt(0)
    v_mfma_f32_16x16x32_bf16 v[156:159], a[64:67], v[172:175], v[156:159]
    v_mfma_f32_16x16x32_bf16 v[160:163], a[144:147], v[172:175], v[160:163]
    v_mfma_f32_16x16x32_bf16 v[164:167], a[224:227], v[172:175], v[164:167]
    v_mfma_f32_16x16x32_bf16 v[168:171], v[240:243], v[172:175], v[168:171]
    v_mfma_f32_16x16x32_bf16 v[156:159], a[68:71], v[172:175], v[156:159]
    v_mfma_f32_16x16x32_bf16 v[160:163], a[148:151], v[172:175], v[160:163]
    v_mfma_f32_16x16x32_bf16 v[164:167], a[228:231], v[172:175], v[164:167]
    v_mfma_f32_16x16x32_bf16 v[168:171], v[244:247], v[172:175], v[168:171]
    s_barrier
    ds_read_b64_tr_b16 a[72:73], v12 offset:34816
    ds_read_b64_tr_b16 a[74:75], v12 offset:43520
    ds_read_b64_tr_b16 a[76:77], v12 offset:52224
    ds_read_b64_tr_b16 a[78:79], v12 offset:60928
    ds_read_b64_tr_b16 a[152:153], v13 offset:34816
    ds_read_b64_tr_b16 a[154:155], v13 offset:43520
    ds_read_b64_tr_b16 a[156:157], v13 offset:52224
    ds_read_b64_tr_b16 a[158:159], v13 offset:60928
    ds_read_b64_tr_b16 a[232:233], v14 offset:34816
    ds_read_b64_tr_b16 a[234:235], v14 offset:43520
    ds_read_b64_tr_b16 a[236:237], v14 offset:52224
    ds_read_b64_tr_b16 a[238:239], v14 offset:60928
    ds_read_b64_tr_b16 v[248:249], v15 offset:34816
    ds_read_b64_tr_b16 v[250:251], v15 offset:43520
    ds_read_b64_tr_b16 v[252:253], v15 offset:52224
    ds_read_b64_tr_b16 v[254:255], v15 offset:60928
    s_cmp_eq_u32 s92, 0
    s_cbranch_scc0 interleave_layers__linear_attn_block__memory_aug_recurrent_mem_tr__prompt_kernel_ri4
    v_mov_b32 v15, 0
    buffer_load_dword v14, v15, s[72:75], 0 offen sc1
interleave_layers__linear_attn_block__memory_aug_recurrent_mem_tr__prompt_kernel_ri4:
    v_lshlrev_b32 v7, 4, v1
    s_lshr_b32 s24, s3, 1
    s_mul_i32 s24, s24, 20
    s_and_b32 s25, s3, 1
    s_mul_i32 s25, s25, 10
    s_add_u32 s24, s24, s25
    s_lshl_b32 s24, s24, 10
    v_add_u32 v6, s24, v7
    s_lshr_b32 s24, s3, 1
    s_lshl_b32 s24, s24, 8
    s_and_b32 s25, s3, 1
    s_lshl_b32 s25, s25, 3
    s_add_u32 s24, s24, s25
    s_add_u32 s24, s24, 51712
    v_lshlrev_b32 v9, 4, v2
    v_add_u32 v8, s24, v9
    v_add_u32 v9, 51712, v9
    v_mul_u32_u24 v10, 336, v2
    v_lshl_add_u32 v10, v3, 3, v10
    v_add_u32 v10, 40960, v10
    v_lshrrev_b32 v11, 2, v2
    v_lshl_add_u32 v11, v3, 3, v11
    v_mul_u32_u24 v11, 336, v11
    v_and_b32 v15, 3, v2
    v_lshl_add_u32 v11, v15, 3, v11
    s_lshl_b32 s24, s3, 5
    s_add_u32 s24, s24, 40960
    v_add_u32 v11, s24, v11
    s_lshl_b32 s24, s3, 10
    v_add_u32 v12, s24, v7
    v_lshlrev_b32 v15, 3, v1
    v_add_u32 v15, 2048, v15
    s_cmp_eq_u32 s3, 2
    s_cselect_b64 vcc, -1, 0
    v_cndmask_b32 v12, v12, v15, vcc
    s_mul_i32 s24, s44, 2560
    s_add_u32 s24, s24, 12582912
    v_add_u32 v12, s24, v12
    s_mov_b32 s52, 0x3fb8aa3b
    s_mov_b32 s53, s52
    s_mov_b32 s54, 0x358637bd
    s_mov_b32 s55, s54
    v_mov_b32 v120, 0
    v_mov_b32 v121, 0
    v_mov_b32 v122, 0
    v_mov_b32 v123, 0
    v_mov_b32 v124, 0
    v_mov_b32 v125, 0
    v_mov_b32 v126, 0
    v_mov_b32 v127, 0
    v_mov_b32 v128, 0
    v_mov_b32 v129, 0
    v_mov_b32 v130, 0
    v_mov_b32 v131, 0
    v_mov_b32 v132, 0
    v_mov_b32 v133, 0
    v_mov_b32 v134, 0
    v_mov_b32 v135, 0
    v_mov_b32 v136, 0
    v_mov_b32 v137, 0
    v_mov_b32 v138, 0
    v_mov_b32 v139, 0
    v_mov_b32 v140, 0
    v_mov_b32 v141, 0
    v_mov_b32 v142, 0
    v_mov_b32 v143, 0
    s_waitcnt lgkmcnt(0)
    v_mfma_f32_16x16x32_bf16 v[156:159], a[72:75], v[172:175], v[156:159]
    v_mfma_f32_16x16x32_bf16 v[160:163], a[152:155], v[172:175], v[160:163]
    v_mfma_f32_16x16x32_bf16 v[164:167], a[232:235], v[172:175], v[164:167]
    v_mfma_f32_16x16x32_bf16 v[168:171], v[248:251], v[172:175], v[168:171]
    v_mfma_f32_16x16x32_bf16 v[156:159], a[76:79], v[172:175], v[156:159]
    v_mfma_f32_16x16x32_bf16 v[160:163], a[156:159], v[172:175], v[160:163]
    v_mfma_f32_16x16x32_bf16 v[164:167], a[236:239], v[172:175], v[164:167]
    v_mfma_f32_16x16x32_bf16 v[168:171], v[252:255], v[172:175], v[168:171]
    s_cmp_eq_u32 s92, 0
    s_cbranch_scc0 interleave_layers__linear_attn_block__memory_aug_recurrent_mem_tr__prompt_kernel_rc5_ok
    s_mov_b32 s61, 0
interleave_layers__linear_attn_block__memory_aug_recurrent_mem_tr__prompt_kernel_rc5:
    s_waitcnt vmcnt(0)
    v_readfirstlane_b32 s24, v14
    s_cmp_eq_u32 s24, 1
    s_cbranch_scc1 interleave_layers__linear_attn_block__memory_aug_recurrent_mem_tr__prompt_kernel_rc5_ok
    s_add_u32 s61, s61, 1
    s_cmp_ge_u32 s61, s60
    s_cbranch_scc1 interleave_layers__linear_attn_block__memory_aug_recurrent_mem_tr__prompt_kernel_rc5_to
    s_sleep 2
    v_mov_b32 v15, 0
    buffer_load_dword v14, v15, s[72:75], 0 offen sc1
    s_branch interleave_layers__linear_attn_block__memory_aug_recurrent_mem_tr__prompt_kernel_rc5
interleave_layers__linear_attn_block__memory_aug_recurrent_mem_tr__prompt_kernel_rc5_to:
    s_mov_b32 s60, 1
interleave_layers__linear_attn_block__memory_aug_recurrent_mem_tr__prompt_kernel_rc5_ok:
interleave_layers__linear_attn_block__memory_aug_recurrent_mem_tr__prompt_kernel_k1_seg:
    s_cmp_eq_u32 s51, 1
    s_cbranch_scc1 interleave_layers__linear_attn_block__memory_aug_recurrent_mem_tr__prompt_kernel_k16
    s_and_b32 s24, s48, 3
    s_lshl_b32 s24, s24, 7
    s_add_u32 s24, s24, 23107584
    v_lshlrev_b32 v15, 2, v1
    v_add_u32 v15, s24, v15
    s_lshr_b32 s95, s48, 2
    s_add_u32 s95, s95, 1
    s_mov_b32 s61, 0
interleave_layers__linear_attn_block__memory_aug_recurrent_mem_tr__prompt_kernel_k1_wx:
    buffer_load_dword v14, v15, s[8:11], 0 offen sc1
    s_waitcnt vmcnt(0)
    v_cmp_le_i32 vcc, s95, v14
    s_mov_b32 s25, 0xfffff
    s_and_b32 s24, vcc_lo, s25
    s_cmp_eq_u32 s24, s25
    s_cbranch_scc1 interleave_layers__linear_attn_block__memory_aug_recurrent_mem_tr__prompt_kernel_k1_wx_ok
    s_add_u32 s61, s61, 1
    s_cmp_ge_u32 s61, s60
    s_cbranch_scc1 interleave_layers__linear_attn_block__memory_aug_recurrent_mem_tr__prompt_kernel_k1_wx_to
    s_sleep 4
    s_branch interleave_layers__linear_attn_block__memory_aug_recurrent_mem_tr__prompt_kernel_k1_wx
interleave_layers__linear_attn_block__memory_aug_recurrent_mem_tr__prompt_kernel_k1_wx_to:
    s_mov_b32 s60, 1
interleave_layers__linear_attn_block__memory_aug_recurrent_mem_tr__prompt_kernel_k1_wx_ok:
    s_mov_b32 s41, s43
    s_mov_b32 s24, s41
    buffer_load_dwordx2 v[16:17], v4, s[16:19], s24 offen sc1
    buffer_load_dwordx2 v[18:19], v5, s[16:19], s24 offen sc1
    s_add_u32 s24, s24, s46
    buffer_load_dwordx2 v[20:21], v4, s[16:19], s24 offen sc1
    buffer_load_dwordx2 v[22:23], v5, s[16:19], s24 offen sc1
    s_add_u32 s24, s24, s46
    buffer_load_dwordx2 v[24:25], v4, s[16:19], s24 offen sc1
    buffer_load_dwordx2 v[26:27], v5, s[16:19], s24 offen sc1
    s_add_u32 s24, s24, s46
    buffer_load_dwordx2 v[28:29], v4, s[16:19], s24 offen sc1
    buffer_load_dwordx2 v[30:31], v5, s[16:19], s24 offen sc1
    s_add_u32 s24, s24, s46
    buffer_load_dwordx2 v[32:33], v4, s[16:19], s24 offen sc1
    buffer_load_dwordx2 v[34:35], v5, s[16:19], s24 offen sc1
    s_add_u32 s24, s24, s46
    buffer_load_dwordx2 v[36:37], v4, s[16:19], s24 offen sc1
    buffer_load_dwordx2 v[38:39], v5, s[16:19], s24 offen sc1
    s_add_u32 s24, s24, s46
    buffer_load_dwordx2 v[40:41], v4, s[16:19], s24 offen sc1
    buffer_load_dwordx2 v[42:43], v5, s[16:19], s24 offen sc1
    s_add_u32 s24, s24, s46
    buffer_load_dwordx2 v[44:45], v4, s[16:19], s24 offen sc1
    buffer_load_dwordx2 v[46:47], v5, s[16:19], s24 offen sc1
    s_add_u32 s24, s24, s46
    buffer_load_dwordx2 v[48:49], v4, s[16:19], s24 offen sc1
    buffer_load_dwordx2 v[50:51], v5, s[16:19], s24 offen sc1
    s_add_u32 s24, s24, s46
    buffer_load_dwordx2 v[52:53], v4, s[16:19], s24 offen sc1
    buffer_load_dwordx2 v[54:55], v5, s[16:19], s24 offen sc1
interleave_layers__linear_attn_block__memory_aug_recurrent_mem_tr__prompt_kernel_k16:
    s_waitcnt vmcnt(0)
    v_mov_b32 v148, 0
    v_mov_b32 v149, 0
    v_mov_b32 v150, 0
    v_mov_b32 v151, 0
    v_dot2c_f32_bf16 v148, v16, v172
    v_dot2c_f32_bf16 v149, v16, v16
    v_dot2c_f32_bf16 v150, v17, v172
    v_dot2c_f32_bf16 v151, v17, v17
    v_dot2c_f32_bf16 v148, v18, v172
    v_dot2c_f32_bf16 v149, v18, v18
    v_dot2c_f32_bf16 v150, v19, v172
    v_dot2c_f32_bf16 v151, v19, v19
    v_dot2c_f32_bf16 v148, v20, v172
    v_dot2c_f32_bf16 v149, v20, v20
    v_dot2c_f32_bf16 v150, v21, v172
    v_dot2c_f32_bf16 v151, v21, v21
    v_dot2c_f32_bf16 v148, v22, v172
    v_dot2c_f32_bf16 v149, v22, v22
    v_dot2c_f32_bf16 v150, v23, v172
    v_dot2c_f32_bf16 v151, v23, v23
    v_dot2c_f32_bf16 v148, v24, v172
    v_dot2c_f32_bf16 v149, v24, v24
    v_dot2c_f32_bf16 v150, v25, v172
    v_dot2c_f32_bf16 v151, v25, v25
    v_dot2c_f32_bf16 v148, v26, v172
    v_dot2c_f32_bf16 v149, v26, v26
    v_dot2c_f32_bf16 v150, v27, v172
    v_dot2c_f32_bf16 v151, v27, v27
    v_dot2c_f32_bf16 v148, v28, v172
    v_dot2c_f32_bf16 v149, v28, v28
    v_dot2c_f32_bf16 v150, v29, v172
    v_dot2c_f32_bf16 v151, v29, v29
    v_dot2c_f32_bf16 v148, v30, v172
    v_dot2c_f32_bf16 v149, v30, v30
    v_dot2c_f32_bf16 v150, v31, v172
    v_dot2c_f32_bf16 v151, v31, v31
    v_dot2c_f32_bf16 v148, v32, v172
    v_dot2c_f32_bf16 v149, v32, v32
    v_dot2c_f32_bf16 v150, v33, v172
    v_dot2c_f32_bf16 v151, v33, v33
    v_dot2c_f32_bf16 v148, v34, v172
    v_dot2c_f32_bf16 v149, v34, v34
    v_dot2c_f32_bf16 v150, v35, v172
    v_dot2c_f32_bf16 v151, v35, v35
    v_dot2c_f32_bf16 v148, v36, v172
    v_dot2c_f32_bf16 v149, v36, v36
    v_dot2c_f32_bf16 v150, v37, v172
    v_dot2c_f32_bf16 v151, v37, v37
    v_dot2c_f32_bf16 v148, v38, v172
    v_dot2c_f32_bf16 v149, v38, v38
    v_dot2c_f32_bf16 v150, v39, v172
    v_dot2c_f32_bf16 v151, v39, v39
    v_dot2c_f32_bf16 v148, v40, v172
    v_dot2c_f32_bf16 v149, v40, v40
    v_dot2c_f32_bf16 v150, v41, v172
    v_dot2c_f32_bf16 v151, v41, v41
    v_dot2c_f32_bf16 v148, v42, v172
    v_dot2c_f32_bf16 v149, v42, v42
    v_dot2c_f32_bf16 v150, v43, v172
    v_dot2c_f32_bf16 v151, v43, v43
    v_dot2c_f32_bf16 v148, v44, v172
    v_dot2c_f32_bf16 v149, v44, v44
    v_dot2c_f32_bf16 v150, v45, v172
    v_dot2c_f32_bf16 v151, v45, v45
    v_dot2c_f32_bf16 v148, v46, v172
    v_dot2c_f32_bf16 v149, v46, v46
    v_dot2c_f32_bf16 v150, v47, v172
    v_dot2c_f32_bf16 v151, v47, v47
    v_dot2c_f32_bf16 v148, v48, v172
    v_dot2c_f32_bf16 v149, v48, v48
    v_dot2c_f32_bf16 v150, v49, v172
    v_dot2c_f32_bf16 v151, v49, v49
    v_dot2c_f32_bf16 v148, v50, v172
    v_dot2c_f32_bf16 v149, v50, v50
    v_dot2c_f32_bf16 v150, v51, v172
    v_dot2c_f32_bf16 v151, v51, v51
    v_dot2c_f32_bf16 v148, v52, v172
    v_dot2c_f32_bf16 v149, v52, v52
    v_dot2c_f32_bf16 v150, v53, v172
    v_dot2c_f32_bf16 v151, v53, v53
    v_dot2c_f32_bf16 v148, v54, v172
    v_dot2c_f32_bf16 v149, v54, v54
    v_dot2c_f32_bf16 v150, v55, v172
    v_dot2c_f32_bf16 v151, v55, v55
    s_nop 1
    v_add_f32 v148, v148, v150
    v_add_f32 v149, v149, v151
    v_mov_b32 v150, v148
    v_mov_b32 v151, v149
    s_nop 0
    v_permlane16_swap_b32 v148, v150
    v_permlane16_swap_b32 v149, v151
    v_add_f32 v148, v148, v150
    v_add_f32 v149, v149, v151
    v_mov_b32 v150, v148
    v_mov_b32 v151, v149
    s_nop 0
    v_permlane32_swap_b32 v148, v150
    v_permlane32_swap_b32 v149, v151
    v_add_f32 v148, v148, v150
    v_add_f32 v149, v149, v151
    ds_write_b128 v6, v[16:19] offset:0
    ds_write_b128 v6, v[20:23] offset:1024
    ds_write_b128 v6, v[24:27] offset:2048
    ds_write_b128 v6, v[28:31] offset:3072
    ds_write_b128 v6, v[32:35] offset:4096
    ds_write_b128 v6, v[36:39] offset:5120
    ds_write_b128 v6, v[40:43] offset:6144
    ds_write_b128 v6, v[44:47] offset:7168
    ds_write_b128 v6, v[48:51] offset:8192
    ds_write_b128 v6, v[52:55] offset:9216
    ds_write_b64 v8, v[148:149]
    s_mov_b32 s51, 0
    s_waitcnt lgkmcnt(0)
    s_cmp_eq_u32 s92, 0
    s_cbranch_scc0 interleave_layers__linear_attn_block__memory_aug_recurrent_mem_tr__prompt_kernel_k17
    s_cmp_gt_u32 s40, 1
    s_cbranch_scc0 interleave_layers__linear_attn_block__memory_aug_recurrent_mem_tr__prompt_kernel_k17
    s_add_u32 s41, s43, s42
    s_mov_b32 s24, s41
    buffer_load_dwordx2 v[16:17], v4, s[16:19], s24 offen sc1
    buffer_load_dwordx2 v[18:19], v5, s[16:19], s24 offen sc1
    s_add_u32 s24, s24, s46
    buffer_load_dwordx2 v[20:21], v4, s[16:19], s24 offen sc1
    buffer_load_dwordx2 v[22:23], v5, s[16:19], s24 offen sc1
    s_add_u32 s24, s24, s46
    buffer_load_dwordx2 v[24:25], v4, s[16:19], s24 offen sc1
    buffer_load_dwordx2 v[26:27], v5, s[16:19], s24 offen sc1
    s_add_u32 s24, s24, s46
    buffer_load_dwordx2 v[28:29], v4, s[16:19], s24 offen sc1
    buffer_load_dwordx2 v[30:31], v5, s[16:19], s24 offen sc1
    s_add_u32 s24, s24, s46
    buffer_load_dwordx2 v[32:33], v4, s[16:19], s24 offen sc1
    buffer_load_dwordx2 v[34:35], v5, s[16:19], s24 offen sc1
    s_add_u32 s24, s24, s46
    buffer_load_dwordx2 v[36:37], v4, s[16:19], s24 offen sc1
    buffer_load_dwordx2 v[38:39], v5, s[16:19], s24 offen sc1
    s_add_u32 s24, s24, s46
    buffer_load_dwordx2 v[40:41], v4, s[16:19], s24 offen sc1
    buffer_load_dwordx2 v[42:43], v5, s[16:19], s24 offen sc1
    s_add_u32 s24, s24, s46
    buffer_load_dwordx2 v[44:45], v4, s[16:19], s24 offen sc1
    buffer_load_dwordx2 v[46:47], v5, s[16:19], s24 offen sc1
    s_add_u32 s24, s24, s46
    buffer_load_dwordx2 v[48:49], v4, s[16:19], s24 offen sc1
    buffer_load_dwordx2 v[50:51], v5, s[16:19], s24 offen sc1
    s_add_u32 s24, s24, s46
    buffer_load_dwordx2 v[52:53], v4, s[16:19], s24 offen sc1
    buffer_load_dwordx2 v[54:55], v5, s[16:19], s24 offen sc1
    s_mov_b32 s51, 1
interleave_layers__linear_attn_block__memory_aug_recurrent_mem_tr__prompt_kernel_k17:
    s_barrier
    ds_read_b128 v[148:151], v9
    ds_read_b128 v[152:155], v9 offset:256
    ds_read_b128 v[56:59], v7 offset:0
    ds_read_b128 v[60:63], v7 offset:20480
    ds_read_b128 v[64:67], v7 offset:1024
    ds_read_b128 v[68:71], v7 offset:21504
    ds_read_b128 v[72:75], v7 offset:2048
    ds_read_b128 v[76:79], v7 offset:22528
    s_waitcnt lgkmcnt(6)
    v_add_f32 v148, v148, v150
    v_add_f32 v149, v149, v151
    v_mul_f32 v148, 0x3acccccd, v148
    v_mul_f32 v150, v148, v148
    v_mov_b32 v151, 0x3acccccd
    v_fma_f32 v149, v149, v151, -v150
    v_max_f32 v149, 0, v149
    v_add_f32 v149, 0x3727c5ac, v149
    v_rsq_f32 v144, v149
    s_nop 0
    v_mul_f32 v145, v148, v144
    v_sub_f32 v145, 0, v145
    v_add_f32 v152, v152, v154
    v_add_f32 v153, v153, v155
    v_mul_f32 v152, 0x3acccccd, v152
    v_mul_f32 v154, v152, v152
    v_mov_b32 v155, 0x3acccccd
    v_fma_f32 v153, v153, v155, -v154
    v_max_f32 v153, 0, v153
    v_add_f32 v153, 0x3727c5ac, v153
    v_rsq_f32 v146, v153
    s_nop 0
    v_mul_f32 v147, v152, v146
    v_sub_f32 v147, 0, v147
    ds_read_b128 v[80:83], v7 offset:3072
    ds_read_b128 v[84:87], v7 offset:23552
    s_waitcnt lgkmcnt(6)
    v_mfma_f32_16x16x32_bf16 v[88:91], a[0:3], v[56:59], 0
    v_mfma_f32_16x16x32_bf16 v[96:99], a[80:83], v[56:59], 0
    v_mfma_f32_16x16x32_bf16 v[104:107], a[160:163], v[56:59], 0
    v_mfma_f32_16x16x32_bf16 v[112:115], v[176:179], v[56:59], 0
    v_mfma_f32_16x16x32_bf16 v[92:95], a[0:3], v[60:63], 0
    v_mfma_f32_16x16x32_bf16 v[100:103], a[80:83], v[60:63], 0
    v_mfma_f32_16x16x32_bf16 v[108:111], a[160:163], v[60:63], 0
    v_mfma_f32_16x16x32_bf16 v[116:119], v[176:179], v[60:63], 0
    ds_read_b128 v[56:59], v7 offset:4096
    ds_read_b128 v[60:63], v7 offset:24576
    s_waitcnt lgkmcnt(6)
    v_mfma_f32_16x16x32_bf16 v[88:91], a[4:7], v[64:67], v[88:91]
    v_mfma_f32_16x16x32_bf16 v[96:99], a[84:87], v[64:67], v[96:99]
    v_mfma_f32_16x16x32_bf16 v[104:107], a[164:167], v[64:67], v[104:107]
    v_mfma_f32_16x16x32_bf16 v[112:115], v[180:183], v[64:67], v[112:115]
    v_mfma_f32_16x16x32_bf16 v[92:95], a[4:7], v[68:71], v[92:95]
    v_mfma_f32_16x16x32_bf16 v[100:103], a[84:87], v[68:71], v[100:103]
    v_mfma_f32_16x16x32_bf16 v[108:111], a[164:167], v[68:71], v[108:111]
    v_mfma_f32_16x16x32_bf16 v[116:119], v[180:183], v[68:71], v[116:119]
    ds_read_b128 v[64:67], v7 offset:5120
    ds_read_b128 v[68:71], v7 offset:25600
    s_waitcnt lgkmcnt(6)
    v_mfma_f32_16x16x32_bf16 v[88:91], a[8:11], v[72:75], v[88:91]
    v_mfma_f32_16x16x32_bf16 v[96:99], a[88:91], v[72:75], v[96:99]
    v_mfma_f32_16x16x32_bf16 v[104:107], a[168:171], v[72:75], v[104:107]
    v_mfma_f32_16x16x32_bf16 v[112:115], v[184:187], v[72:75], v[112:115]
    v_mfma_f32_16x16x32_bf16 v[92:95], a[8:11], v[76:79], v[92:95]
    v_mfma_f32_16x16x32_bf16 v[100:103], a[88:91], v[76:79], v[100:103]
    v_mfma_f32_16x16x32_bf16 v[108:111], a[168:171], v[76:79], v[108:111]
    v_mfma_f32_16x16x32_bf16 v[116:119], v[184:187], v[76:79], v[116:119]
    ds_read_b128 v[72:75], v7 offset:6144
    ds_read_b128 v[76:79], v7 offset:26624
    s_waitcnt lgkmcnt(6)
    v_mfma_f32_16x16x32_bf16 v[88:91], a[12:15], v[80:83], v[88:91]
    v_mfma_f32_16x16x32_bf16 v[96:99], a[92:95], v[80:83], v[96:99]
    v_mfma_f32_16x16x32_bf16 v[104:107], a[172:175], v[80:83], v[104:107]
    v_mfma_f32_16x16x32_bf16 v[112:115], v[188:191], v[80:83], v[112:115]
    v_mfma_f32_16x16x32_bf16 v[92:95], a[12:15], v[84:87], v[92:95]
    v_mfma_f32_16x16x32_bf16 v[100:103], a[92:95], v[84:87], v[100:103]
    v_mfma_f32_16x16x32_bf16 v[108:111], a[172:175], v[84:87], v[108:111]
    v_mfma_f32_16x16x32_bf16 v[116:119], v[188:191], v[84:87], v[116:119]
    ds_read_b128 v[80:83], v7 offset:7168
    ds_read_b128 v[84:87], v7 offset:27648
    s_waitcnt lgkmcnt(6)
    v_mfma_f32_16x16x32_bf16 v[88:91], a[16:19], v[56:59], v[88:91]
    v_mfma_f32_16x16x32_bf16 v[96:99], a[96:99], v[56:59], v[96:99]
    v_mfma_f32_16x16x32_bf16 v[104:107], a[176:179], v[56:59], v[104:107]
    v_mfma_f32_16x16x32_bf16 v[112:115], v[192:195], v[56:59], v[112:115]
    v_mfma_f32_16x16x32_bf16 v[92:95], a[16:19], v[60:63], v[92:95]
    v_mfma_f32_16x16x32_bf16 v[100:103], a[96:99], v[60:63], v[100:103]
    v_mfma_f32_16x16x32_bf16 v[108:111], a[176:179], v[60:63], v[108:111]
    v_mfma_f32_16x16x32_bf16 v[116:119], v[192:195], v[60:63], v[116:119]
    ds_read_b128 v[56:59], v7 offset:8192
    ds_read_b128 v[60:63], v7 offset:28672
    s_waitcnt lgkmcnt(6)
    v_mfma_f32_16x16x32_bf16 v[88:91], a[20:23], v[64:67], v[88:91]
    v_mfma_f32_16x16x32_bf16 v[96:99], a[100:103], v[64:67], v[96:99]
    v_mfma_f32_16x16x32_bf16 v[104:107], a[180:183], v[64:67], v[104:107]
    v_mfma_f32_16x16x32_bf16 v[112:115], v[196:199], v[64:67], v[112:115]
    v_mfma_f32_16x16x32_bf16 v[92:95], a[20:23], v[68:71], v[92:95]
    v_mfma_f32_16x16x32_bf16 v[100:103], a[100:103], v[68:71], v[100:103]
    v_mfma_f32_16x16x32_bf16 v[108:111], a[180:183], v[68:71], v[108:111]
    v_mfma_f32_16x16x32_bf16 v[116:119], v[196:199], v[68:71], v[116:119]
    ds_read_b128 v[64:67], v7 offset:9216
    ds_read_b128 v[68:71], v7 offset:29696
    s_waitcnt lgkmcnt(6)
    v_mfma_f32_16x16x32_bf16 v[88:91], a[24:27], v[72:75], v[88:91]
    v_mfma_f32_16x16x32_bf16 v[96:99], a[104:107], v[72:75], v[96:99]
    v_mfma_f32_16x16x32_bf16 v[104:107], a[184:187], v[72:75], v[104:107]
    v_mfma_f32_16x16x32_bf16 v[112:115], v[200:203], v[72:75], v[112:115]
    v_mfma_f32_16x16x32_bf16 v[92:95], a[24:27], v[76:79], v[92:95]
    v_mfma_f32_16x16x32_bf16 v[100:103], a[104:107], v[76:79], v[100:103]
    v_mfma_f32_16x16x32_bf16 v[108:111], a[184:187], v[76:79], v[108:111]
    v_mfma_f32_16x16x32_bf16 v[116:119], v[200:203], v[76:79], v[116:119]
    ds_read_b128 v[72:75], v7 offset:10240
    ds_read_b128 v[76:79], v7 offset:30720
    s_waitcnt lgkmcnt(6)
    v_mfma_f32_16x16x32_bf16 v[88:91], a[28:31], v[80:83], v[88:91]
    v_mfma_f32_16x16x32_bf16 v[96:99], a[108:111], v[80:83], v[96:99]
    v_mfma_f32_16x16x32_bf16 v[104:107], a[188:191], v[80:83], v[104:107]
    v_mfma_f32_16x16x32_bf16 v[112:115], v[204:207], v[80:83], v[112:115]
    v_mfma_f32_16x16x32_bf16 v[92:95], a[28:31], v[84:87], v[92:95]
    v_mfma_f32_16x16x32_bf16 v[100:103], a[108:111], v[84:87], v[100:103]
    v_mfma_f32_16x16x32_bf16 v[108:111], a[188:191], v[84:87], v[108:111]
    v_mfma_f32_16x16x32_bf16 v[116:119], v[204:207], v[84:87], v[116:119]
    ds_read_b128 v[80:83], v7 offset:11264
    ds_read_b128 v[84:87], v7 offset:31744
    s_waitcnt lgkmcnt(6)
    v_mfma_f32_16x16x32_bf16 v[88:91], a[32:35], v[56:59], v[88:91]
    v_mfma_f32_16x16x32_bf16 v[96:99], a[112:115], v[56:59], v[96:99]
    v_mfma_f32_16x16x32_bf16 v[104:107], a[192:195], v[56:59], v[104:107]
    v_mfma_f32_16x16x32_bf16 v[112:115], v[208:211], v[56:59], v[112:115]
    v_mfma_f32_16x16x32_bf16 v[92:95], a[32:35], v[60:63], v[92:95]
    v_mfma_f32_16x16x32_bf16 v[100:103], a[112:115], v[60:63], v[100:103]
    v_mfma_f32_16x16x32_bf16 v[108:111], a[192:195], v[60:63], v[108:111]
    v_mfma_f32_16x16x32_bf16 v[116:119], v[208:211], v[60:63], v[116:119]
    ds_read_b128 v[56:59], v7 offset:12288
    ds_read_b128 v[60:63], v7 offset:32768
    s_waitcnt lgkmcnt(6)
    v_mfma_f32_16x16x32_bf16 v[88:91], a[36:39], v[64:67], v[88:91]
    v_mfma_f32_16x16x32_bf16 v[96:99], a[116:119], v[64:67], v[96:99]
    v_mfma_f32_16x16x32_bf16 v[104:107], a[196:199], v[64:67], v[104:107]
    v_mfma_f32_16x16x32_bf16 v[112:115], v[212:215], v[64:67], v[112:115]
    v_mfma_f32_16x16x32_bf16 v[92:95], a[36:39], v[68:71], v[92:95]
    v_mfma_f32_16x16x32_bf16 v[100:103], a[116:119], v[68:71], v[100:103]
    v_mfma_f32_16x16x32_bf16 v[108:111], a[196:199], v[68:71], v[108:111]
    v_mfma_f32_16x16x32_bf16 v[116:119], v[212:215], v[68:71], v[116:119]
    ds_read_b128 v[64:67], v7 offset:13312
    ds_read_b128 v[68:71], v7 offset:33792
    s_waitcnt lgkmcnt(6)
    v_mfma_f32_16x16x32_bf16 v[88:91], a[40:43], v[72:75], v[88:91]
    v_mfma_f32_16x16x32_bf16 v[96:99], a[120:123], v[72:75], v[96:99]
    v_mfma_f32_16x16x32_bf16 v[104:107], a[200:203], v[72:75], v[104:107]
    v_mfma_f32_16x16x32_bf16 v[112:115], v[216:219], v[72:75], v[112:115]
    v_mfma_f32_16x16x32_bf16 v[92:95], a[40:43], v[76:79], v[92:95]
    v_mfma_f32_16x16x32_bf16 v[100:103], a[120:123], v[76:79], v[100:103]
    v_mfma_f32_16x16x32_bf16 v[108:111], a[200:203], v[76:79], v[108:111]
    v_mfma_f32_16x16x32_bf16 v[116:119], v[216:219], v[76:79], v[116:119]
    ds_read_b128 v[72:75], v7 offset:14336
    ds_read_b128 v[76:79], v7 offset:34816
    s_waitcnt lgkmcnt(6)
    v_mfma_f32_16x16x32_bf16 v[88:91], a[44:47], v[80:83], v[88:91]
    v_mfma_f32_16x16x32_bf16 v[96:99], a[124:127], v[80:83], v[96:99]
    v_mfma_f32_16x16x32_bf16 v[104:107], a[204:207], v[80:83], v[104:107]
    v_mfma_f32_16x16x32_bf16 v[112:115], v[220:223], v[80:83], v[112:115]
    v_mfma_f32_16x16x32_bf16 v[92:95], a[44:47], v[84:87], v[92:95]
    v_mfma_f32_16x16x32_bf16 v[100:103], a[124:127], v[84:87], v[100:103]
    v_mfma_f32_16x16x32_bf16 v[108:111], a[204:207], v[84:87], v[108:111]
    v_mfma_f32_16x16x32_bf16 v[116:119], v[220:223], v[84:87], v[116:119]
    ds_read_b128 v[80:83], v7 offset:15360
    ds_read_b128 v[84:87], v7 offset:35840
    s_waitcnt lgkmcnt(6)
    v_mfma_f32_16x16x32_bf16 v[88:91], a[48:51], v[56:59], v[88:91]
    v_mfma_f32_16x16x32_bf16 v[96:99], a[128:131], v[56:59], v[96:99]
    v_mfma_f32_16x16x32_bf16 v[104:107], a[208:211], v[56:59], v[104:107]
    v_mfma_f32_16x16x32_bf16 v[112:115], v[224:227], v[56:59], v[112:115]
    v_mfma_f32_16x16x32_bf16 v[92:95], a[48:51], v[60:63], v[92:95]
    v_mfma_f32_16x16x32_bf16 v[100:103], a[128:131], v[60:63], v[100:103]
    v_mfma_f32_16x16x32_bf16 v[108:111], a[208:211], v[60:63], v[108:111]
    v_mfma_f32_16x16x32_bf16 v[116:119], v[224:227], v[60:63], v[116:119]
    ds_read_b128 v[56:59], v7 offset:16384
    ds_read_b128 v[60:63], v7 offset:36864
    s_waitcnt lgkmcnt(6)
    v_mfma_f32_16x16x32_bf16 v[88:91], a[52:55], v[64:67], v[88:91]
    v_mfma_f32_16x16x32_bf16 v[96:99], a[132:135], v[64:67], v[96:99]
    v_mfma_f32_16x16x32_bf16 v[104:107], a[212:215], v[64:67], v[104:107]
    v_mfma_f32_16x16x32_bf16 v[112:115], v[228:231], v[64:67], v[112:115]
    v_mfma_f32_16x16x32_bf16 v[92:95], a[52:55], v[68:71], v[92:95]
    v_mfma_f32_16x16x32_bf16 v[100:103], a[132:135], v[68:71], v[100:103]
    v_mfma_f32_16x16x32_bf16 v[108:111], a[212:215], v[68:71], v[108:111]
    v_mfma_f32_16x16x32_bf16 v[116:119], v[228:231], v[68:71], v[116:119]
    ds_read_b128 v[64:67], v7 offset:17408
    ds_read_b128 v[68:71], v7 offset:37888
    s_waitcnt lgkmcnt(6)
    v_mfma_f32_16x16x32_bf16 v[88:91], a[56:59], v[72:75], v[88:91]
    v_mfma_f32_16x16x32_bf16 v[96:99], a[136:139], v[72:75], v[96:99]
    v_mfma_f32_16x16x32_bf16 v[104:107], a[216:219], v[72:75], v[104:107]
    v_mfma_f32_16x16x32_bf16 v[112:115], v[232:235], v[72:75], v[112:115]
    v_mfma_f32_16x16x32_bf16 v[92:95], a[56:59], v[76:79], v[92:95]
    v_mfma_f32_16x16x32_bf16 v[100:103], a[136:139], v[76:79], v[100:103]
    v_mfma_f32_16x16x32_bf16 v[108:111], a[216:219], v[76:79], v[108:111]
    v_mfma_f32_16x16x32_bf16 v[116:119], v[232:235], v[76:79], v[116:119]
    ds_read_b128 v[72:75], v7 offset:18432
    ds_read_b128 v[76:79], v7 offset:38912
    s_waitcnt lgkmcnt(6)
    v_mfma_f32_16x16x32_bf16 v[88:91], a[60:63], v[80:83], v[88:91]
    v_mfma_f32_16x16x32_bf16 v[96:99], a[140:143], v[80:83], v[96:99]
    v_mfma_f32_16x16x32_bf16 v[104:107], a[220:223], v[80:83], v[104:107]
    v_mfma_f32_16x16x32_bf16 v[112:115], v[236:239], v[80:83], v[112:115]
    v_mfma_f32_16x16x32_bf16 v[92:95], a[60:63], v[84:87], v[92:95]
    v_mfma_f32_16x16x32_bf16 v[100:103], a[140:143], v[84:87], v[100:103]
    v_mfma_f32_16x16x32_bf16 v[108:111], a[220:223], v[84:87], v[108:111]
    v_mfma_f32_16x16x32_bf16 v[116:119], v[236:239], v[84:87], v[116:119]
    ds_read_b128 v[80:83], v7 offset:19456
    ds_read_b128 v[84:87], v7 offset:39936
    s_waitcnt lgkmcnt(6)
    v_mfma_f32_16x16x32_bf16 v[88:91], a[64:67], v[56:59], v[88:91]
    v_mfma_f32_16x16x32_bf16 v[96:99], a[144:147], v[56:59], v[96:99]
    v_mfma_f32_16x16x32_bf16 v[104:107], a[224:227], v[56:59], v[104:107]
    v_mfma_f32_16x16x32_bf16 v[112:115], v[240:243], v[56:59], v[112:115]
    v_mfma_f32_16x16x32_bf16 v[92:95], a[64:67], v[60:63], v[92:95]
    v_mfma_f32_16x16x32_bf16 v[100:103], a[144:147], v[60:63], v[100:103]
    v_mfma_f32_16x16x32_bf16 v[108:111], a[224:227], v[60:63], v[108:111]
    v_mfma_f32_16x16x32_bf16 v[116:119], v[240:243], v[60:63], v[116:119]
    s_waitcnt lgkmcnt(4)
    v_mfma_f32_16x16x32_bf16 v[88:91], a[68:71], v[64:67], v[88:91]
    v_mfma_f32_16x16x32_bf16 v[96:99], a[148:151], v[64:67], v[96:99]
    v_mfma_f32_16x16x32_bf16 v[104:107], a[228:231], v[64:67], v[104:107]
    v_mfma_f32_16x16x32_bf16 v[112:115], v[244:247], v[64:67], v[112:115]
    v_mfma_f32_16x16x32_bf16 v[92:95], a[68:71], v[68:71], v[92:95]
    v_mfma_f32_16x16x32_bf16 v[100:103], a[148:151], v[68:71], v[100:103]
    v_mfma_f32_16x16x32_bf16 v[108:111], a[228:231], v[68:71], v[108:111]
    v_mfma_f32_16x16x32_bf16 v[116:119], v[244:247], v[68:71], v[116:119]
    s_waitcnt lgkmcnt(2)
    v_mfma_f32_16x16x32_bf16 v[88:91], a[72:75], v[72:75], v[88:91]
    v_mfma_f32_16x16x32_bf16 v[96:99], a[152:155], v[72:75], v[96:99]
    v_mfma_f32_16x16x32_bf16 v[104:107], a[232:235], v[72:75], v[104:107]
    v_mfma_f32_16x16x32_bf16 v[112:115], v[248:251], v[72:75], v[112:115]
    v_mfma_f32_16x16x32_bf16 v[92:95], a[72:75], v[76:79], v[92:95]
    v_mfma_f32_16x16x32_bf16 v[100:103], a[152:155], v[76:79], v[100:103]
    v_mfma_f32_16x16x32_bf16 v[108:111], a[232:235], v[76:79], v[108:111]
    v_mfma_f32_16x16x32_bf16 v[116:119], v[248:251], v[76:79], v[116:119]
    s_waitcnt lgkmcnt(0)
    v_mfma_f32_16x16x32_bf16 v[88:91], a[76:79], v[80:83], v[88:91]
    v_mfma_f32_16x16x32_bf16 v[96:99], a[156:159], v[80:83], v[96:99]
    v_mfma_f32_16x16x32_bf16 v[104:107], a[236:239], v[80:83], v[104:107]
    v_mfma_f32_16x16x32_bf16 v[112:115], v[252:255], v[80:83], v[112:115]
    v_mfma_f32_16x16x32_bf16 v[92:95], a[76:79], v[84:87], v[92:95]
    v_mfma_f32_16x16x32_bf16 v[100:103], a[156:159], v[84:87], v[100:103]
    v_mfma_f32_16x16x32_bf16 v[108:111], a[236:239], v[84:87], v[108:111]
    v_mfma_f32_16x16x32_bf16 v[116:119], v[252:255], v[84:87], v[116:119]
    v_pk_mul_f32 v[148:149], v[156:157], v[144:145] op_sel:[0,1] op_sel_hi:[1,1]
    v_pk_mul_f32 v[150:151], v[158:159], v[144:145] op_sel:[0,1] op_sel_hi:[1,1]
    v_pk_fma_f32 v[88:89], v[88:89], v[144:145], v[148:149] op_sel:[0,0,0] op_sel_hi:[1,0,1]
    v_pk_fma_f32 v[90:91], v[90:91], v[144:145], v[150:151] op_sel:[0,0,0] op_sel_hi:[1,0,1]
    v_pk_mul_f32 v[148:149], v[156:157], v[146:147] op_sel:[0,1] op_sel_hi:[1,1]
    v_pk_mul_f32 v[150:151], v[158:159], v[146:147] op_sel:[0,1] op_sel_hi:[1,1]
    v_pk_fma_f32 v[92:93], v[92:93], v[146:147], v[148:149] op_sel:[0,0,0] op_sel_hi:[1,0,1]
    v_pk_fma_f32 v[94:95], v[94:95], v[146:147], v[150:151] op_sel:[0,0,0] op_sel_hi:[1,0,1]
    v_pk_mul_f32 v[148:149], v[160:161], v[144:145] op_sel:[0,1] op_sel_hi:[1,1]
    v_pk_mul_f32 v[150:151], v[162:163], v[144:145] op_sel:[0,1] op_sel_hi:[1,1]
    v_pk_fma_f32 v[96:97], v[96:97], v[144:145], v[148:149] op_sel:[0,0,0] op_sel_hi:[1,0,1]
    v_pk_fma_f32 v[98:99], v[98:99], v[144:145], v[150:151] op_sel:[0,0,0] op_sel_hi:[1,0,1]
    v_pk_mul_f32 v[148:149], v[160:161], v[146:147] op_sel:[0,1] op_sel_hi:[1,1]
    v_pk_mul_f32 v[150:151], v[162:163], v[146:147] op_sel:[0,1] op_sel_hi:[1,1]
    v_pk_fma_f32 v[100:101], v[100:101], v[146:147], v[148:149] op_sel:[0,0,0] op_sel_hi:[1,0,1]
    v_pk_fma_f32 v[102:103], v[102:103], v[146:147], v[150:151] op_sel:[0,0,0] op_sel_hi:[1,0,1]
    v_pk_mul_f32 v[148:149], v[164:165], v[144:145] op_sel:[0,1] op_sel_hi:[1,1]
    v_pk_mul_f32 v[150:151], v[166:167], v[144:145] op_sel:[0,1] op_sel_hi:[1,1]
    v_pk_fma_f32 v[104:105], v[104:105], v[144:145], v[148:149] op_sel:[0,0,0] op_sel_hi:[1,0,1]
    v_pk_fma_f32 v[106:107], v[106:107], v[144:145], v[150:151] op_sel:[0,0,0] op_sel_hi:[1,0,1]
    v_pk_mul_f32 v[148:149], v[164:165], v[146:147] op_sel:[0,1] op_sel_hi:[1,1]
    v_pk_mul_f32 v[150:151], v[166:167], v[146:147] op_sel:[0,1] op_sel_hi:[1,1]
    v_pk_fma_f32 v[108:109], v[108:109], v[146:147], v[148:149] op_sel:[0,0,0] op_sel_hi:[1,0,1]
    v_pk_fma_f32 v[110:111], v[110:111], v[146:147], v[150:151] op_sel:[0,0,0] op_sel_hi:[1,0,1]
    v_pk_mul_f32 v[148:149], v[168:169], v[144:145] op_sel:[0,1] op_sel_hi:[1,1]
    v_pk_mul_f32 v[150:151], v[170:171], v[144:145] op_sel:[0,1] op_sel_hi:[1,1]
    v_pk_fma_f32 v[112:113], v[112:113], v[144:145], v[148:149] op_sel:[0,0,0] op_sel_hi:[1,0,1]
    v_pk_fma_f32 v[114:115], v[114:115], v[144:145], v[150:151] op_sel:[0,0,0] op_sel_hi:[1,0,1]
    v_pk_mul_f32 v[148:149], v[168:169], v[146:147] op_sel:[0,1] op_sel_hi:[1,1]
    v_pk_mul_f32 v[150:151], v[170:171], v[146:147] op_sel:[0,1] op_sel_hi:[1,1]
    v_pk_fma_f32 v[116:117], v[116:117], v[146:147], v[148:149] op_sel:[0,0,0] op_sel_hi:[1,0,1]
    v_pk_fma_f32 v[118:119], v[118:119], v[146:147], v[150:151] op_sel:[0,0,0] op_sel_hi:[1,0,1]
    s_add_u32 s25, s43, 20480
    s_cmp_ge_u32 s3, 2
    s_cbranch_scc1 interleave_layers__linear_attn_block__memory_aug_recurrent_mem_tr__prompt_kernel_k1_e2
    s_lshl_b32 s24, s3, 6
    v_add_u32 v15, s24, v10
    v_cvt_pk_bf16_f32 v64, v104, v105
    v_cvt_pk_bf16_f32 v65, v106, v107
    ds_write_b64 v15, v[64:65] offset:160
    v_cvt_pk_bf16_f32 v66, v108, v109
    v_cvt_pk_bf16_f32 v67, v110, v111
    ds_write_b64 v15, v[66:67] offset:5536
    v_cvt_pk_bf16_f32 v68, v112, v113
    v_cvt_pk_bf16_f32 v69, v114, v115
    ds_write_b64 v15, v[68:69] offset:192
    v_cvt_pk_bf16_f32 v70, v116, v117
    v_cvt_pk_bf16_f32 v71, v118, v119
    ds_write_b64 v15, v[70:71] offset:5568
    v_min_f32 v148, 0, v88
    v_min_f32 v149, 0, v89
    v_pk_mul_f32 v[148:149], v[148:149], s[52:53]
    v_min_f32 v150, 0, v90
    v_min_f32 v151, 0, v91
    v_pk_mul_f32 v[150:151], v[150:151], s[52:53]
    v_exp_f32 v148, v148
    v_exp_f32 v149, v149
    v_exp_f32 v150, v150
    v_exp_f32 v151, v151
    v_max_f32 v88, 0, v88
    v_max_f32 v89, 0, v89
    v_max_f32 v90, 0, v90
    v_max_f32 v91, 0, v91
    v_pk_add_f32 v[88:89], v[88:89], v[148:149]
    v_pk_add_f32 v[90:91], v[90:91], v[150:151]
    v_pk_add_f32 v[88:89], v[88:89], s[54:55]
    v_pk_add_f32 v[90:91], v[90:91], s[54:55]
    v_min_f32 v148, 0, v96
    v_min_f32 v149, 0, v97
    v_pk_mul_f32 v[148:149], v[148:149], s[52:53]
    v_min_f32 v150, 0, v98
    v_min_f32 v151, 0, v99
    v_pk_mul_f32 v[150:151], v[150:151], s[52:53]
    v_exp_f32 v148, v148
    v_exp_f32 v149, v149
    v_exp_f32 v150, v150
    v_exp_f32 v151, v151
    v_max_f32 v96, 0, v96
    v_max_f32 v97, 0, v97
    v_max_f32 v98, 0, v98
    v_max_f32 v99, 0, v99
    v_pk_add_f32 v[96:97], v[96:97], v[148:149]
    v_pk_add_f32 v[98:99], v[98:99], v[150:151]
    v_pk_add_f32 v[96:97], v[96:97], s[54:55]
    v_pk_add_f32 v[98:99], v[98:99], s[54:55]
    v_cvt_pk_bf16_f32 v56, v88, v89
    v_cvt_pk_bf16_f32 v57, v90, v91
    v_cvt_pk_bf16_f32 v58, v96, v97
    v_cvt_pk_bf16_f32 v59, v98, v99
    buffer_store_dwordx4 v[56:59], v12, s[8:11], s43 offen sc1
    v_min_f32 v148, 0, v92
    v_min_f32 v149, 0, v93
    v_pk_mul_f32 v[148:149], v[148:149], s[52:53]
    v_min_f32 v150, 0, v94
    v_min_f32 v151, 0, v95
    v_pk_mul_f32 v[150:151], v[150:151], s[52:53]
    v_exp_f32 v148, v148
    v_exp_f32 v149, v149
    v_exp_f32 v150, v150
    v_exp_f32 v151, v151
    v_max_f32 v92, 0, v92
    v_max_f32 v93, 0, v93
    v_max_f32 v94, 0, v94
    v_max_f32 v95, 0, v95
    v_pk_add_f32 v[92:93], v[92:93], v[148:149]
    v_pk_add_f32 v[94:95], v[94:95], v[150:151]
    v_pk_add_f32 v[92:93], v[92:93], s[54:55]
    v_pk_add_f32 v[94:95], v[94:95], s[54:55]
    v_min_f32 v148, 0, v100
    v_min_f32 v149, 0, v101
    v_pk_mul_f32 v[148:149], v[148:149], s[52:53]
    v_min_f32 v150, 0, v102
    v_min_f32 v151, 0, v103
    v_pk_mul_f32 v[150:151], v[150:151], s[52:53]
    v_exp_f32 v148, v148
    v_exp_f32 v149, v149
    v_exp_f32 v150, v150
    v_exp_f32 v151, v151
    v_max_f32 v100, 0, v100
    v_max_f32 v101, 0, v101
    v_max_f32 v102, 0, v102
    v_max_f32 v103, 0, v103
    v_pk_add_f32 v[100:101], v[100:101], v[148:149]
    v_pk_add_f32 v[102:103], v[102:103], v[150:151]
    v_pk_add_f32 v[100:101], v[100:101], s[54:55]
    v_pk_add_f32 v[102:103], v[102:103], s[54:55]
    v_cvt_pk_bf16_f32 v60, v92, v93
    v_cvt_pk_bf16_f32 v61, v94, v95
    v_cvt_pk_bf16_f32 v62, v100, v101
    v_cvt_pk_bf16_f32 v63, v102, v103
    buffer_store_dwordx4 v[60:63], v12, s[8:11], s25 offen sc1
    s_branch interleave_layers__linear_attn_block__memory_aug_recurrent_mem_tr__prompt_kernel_k1_ej
interleave_layers__linear_attn_block__memory_aug_recurrent_mem_tr__prompt_kernel_k1_e2:
    s_cmp_eq_u32 s3, 3
    s_cbranch_scc1 interleave_layers__linear_attn_block__memory_aug_recurrent_mem_tr__prompt_kernel_k1_e3
    v_cvt_pk_bf16_f32 v68, v112, v113
    v_cvt_pk_bf16_f32 v69, v114, v115
    ds_write_b64 v10, v[68:69] offset:288
    v_cvt_pk_bf16_f32 v70, v116, v117
    v_cvt_pk_bf16_f32 v71, v118, v119
    ds_write_b64 v10, v[70:71] offset:5664
    v_min_f32 v148, 0, v96
    v_min_f32 v149, 0, v97
    v_pk_mul_f32 v[148:149], v[148:149], s[52:53]
    v_min_f32 v150, 0, v98
    v_min_f32 v151, 0, v99
    v_pk_mul_f32 v[150:151], v[150:151], s[52:53]
    v_exp_f32 v148, v148
    v_exp_f32 v149, v149
    v_exp_f32 v150, v150
    v_exp_f32 v151, v151
    v_max_f32 v96, 0, v96
    v_max_f32 v97, 0, v97
    v_max_f32 v98, 0, v98
    v_max_f32 v99, 0, v99
    v_pk_add_f32 v[96:97], v[96:97], v[148:149]
    v_pk_add_f32 v[98:99], v[98:99], v[150:151]
    v_pk_add_f32 v[96:97], v[96:97], s[54:55]
    v_pk_add_f32 v[98:99], v[98:99], s[54:55]
    v_min_f32 v148, 0, v104
    v_min_f32 v149, 0, v105
    v_pk_mul_f32 v[148:149], v[148:149], s[52:53]
    v_min_f32 v150, 0, v106
    v_min_f32 v151, 0, v107
    v_pk_mul_f32 v[150:151], v[150:151], s[52:53]
    v_exp_f32 v148, v148
    v_exp_f32 v149, v149
    v_exp_f32 v150, v150
    v_exp_f32 v151, v151
    v_max_f32 v104, 0, v104
    v_max_f32 v105, 0, v105
    v_max_f32 v106, 0, v106
    v_max_f32 v107, 0, v107
    v_pk_add_f32 v[104:105], v[104:105], v[148:149]
    v_pk_add_f32 v[106:107], v[106:107], v[150:151]
    v_pk_add_f32 v[104:105], v[104:105], s[54:55]
    v_pk_add_f32 v[106:107], v[106:107], s[54:55]
    v_min_f32 v148, 0, v100
    v_min_f32 v149, 0, v101
    v_pk_mul_f32 v[148:149], v[148:149], s[52:53]
    v_min_f32 v150, 0, v102
    v_min_f32 v151, 0, v103
    v_pk_mul_f32 v[150:151], v[150:151], s[52:53]
    v_exp_f32 v148, v148
    v_exp_f32 v149, v149
    v_exp_f32 v150, v150
    v_exp_f32 v151, v151
    v_max_f32 v100, 0, v100
    v_max_f32 v101, 0, v101
    v_max_f32 v102, 0, v102
    v_max_f32 v103, 0, v103
    v_pk_add_f32 v[100:101], v[100:101], v[148:149]
    v_pk_add_f32 v[102:103], v[102:103], v[150:151]
    v_pk_add_f32 v[100:101], v[100:101], s[54:55]
    v_pk_add_f32 v[102:103], v[102:103], s[54:55]
    v_min_f32 v148, 0, v108
    v_min_f32 v149, 0, v109
    v_pk_mul_f32 v[148:149], v[148:149], s[52:53]
    v_min_f32 v150, 0, v110
    v_min_f32 v151, 0, v111
    v_pk_mul_f32 v[150:151], v[150:151], s[52:53]
    v_exp_f32 v148, v148
    v_exp_f32 v149, v149
    v_exp_f32 v150, v150
    v_exp_f32 v151, v151
    v_max_f32 v108, 0, v108
    v_max_f32 v109, 0, v109
    v_max_f32 v110, 0, v110
    v_max_f32 v111, 0, v111
    v_pk_add_f32 v[108:109], v[108:109], v[148:149]
    v_pk_add_f32 v[110:111], v[110:111], v[150:151]
    v_pk_add_f32 v[108:109], v[108:109], s[54:55]
    v_pk_add_f32 v[110:111], v[110:111], s[54:55]
    v_cvt_pk_bf16_f32 v60, v96, v97
    v_cvt_pk_bf16_f32 v61, v98, v99
    ds_write_b64 v10, v[60:61] offset:0
    v_cvt_pk_bf16_f32 v62, v100, v101
    v_cvt_pk_bf16_f32 v63, v102, v103
    ds_write_b64 v10, v[62:63] offset:5376
    v_cvt_pk_bf16_f32 v64, v104, v105
    v_cvt_pk_bf16_f32 v65, v106, v107
    ds_write_b64 v10, v[64:65] offset:32
    v_cvt_pk_bf16_f32 v66, v108, v109
    v_cvt_pk_bf16_f32 v67, v110, v111
    ds_write_b64 v10, v[66:67] offset:5408
    v_min_f32 v148, 0, v88
    v_min_f32 v149, 0, v89
    v_pk_mul_f32 v[148:149], v[148:149], s[52:53]
    v_min_f32 v150, 0, v90
    v_min_f32 v151, 0, v91
    v_pk_mul_f32 v[150:151], v[150:151], s[52:53]
    v_exp_f32 v148, v148
    v_exp_f32 v149, v149
    v_exp_f32 v150, v150
    v_exp_f32 v151, v151
    v_max_f32 v88, 0, v88
    v_max_f32 v89, 0, v89
    v_max_f32 v90, 0, v90
    v_max_f32 v91, 0, v91
    v_pk_add_f32 v[88:89], v[88:89], v[148:149]
    v_pk_add_f32 v[90:91], v[90:91], v[150:151]
    v_pk_add_f32 v[88:89], v[88:89], s[54:55]
    v_pk_add_f32 v[90:91], v[90:91], s[54:55]
    v_cvt_pk_bf16_f32 v56, v88, v89
    v_cvt_pk_bf16_f32 v57, v90, v91
    buffer_store_dwordx2 v[56:57], v12, s[8:11], s43 offen sc1
    v_min_f32 v148, 0, v92
    v_min_f32 v149, 0, v93
    v_pk_mul_f32 v[148:149], v[148:149], s[52:53]
    v_min_f32 v150, 0, v94
    v_min_f32 v151, 0, v95
    v_pk_mul_f32 v[150:151], v[150:151], s[52:53]
    v_exp_f32 v148, v148
    v_exp_f32 v149, v149
    v_exp_f32 v150, v150
    v_exp_f32 v151, v151
    v_max_f32 v92, 0, v92
    v_max_f32 v93, 0, v93
    v_max_f32 v94, 0, v94
    v_max_f32 v95, 0, v95
    v_pk_add_f32 v[92:93], v[92:93], v[148:149]
    v_pk_add_f32 v[94:95], v[94:95], v[150:151]
    v_pk_add_f32 v[92:93], v[92:93], s[54:55]
    v_pk_add_f32 v[94:95], v[94:95], s[54:55]
    v_cvt_pk_bf16_f32 v58, v92, v93
    v_cvt_pk_bf16_f32 v59, v94, v95
    buffer_store_dwordx2 v[58:59], v12, s[8:11], s25 offen sc1
    s_branch interleave_layers__linear_attn_block__memory_aug_recurrent_mem_tr__prompt_kernel_k1_ej
interleave_layers__linear_attn_block__memory_aug_recurrent_mem_tr__prompt_kernel_k1_e3:
    v_min_f32 v148, 0, v88
    v_min_f32 v149, 0, v89
    v_pk_mul_f32 v[148:149], v[148:149], s[52:53]
    v_min_f32 v150, 0, v90
    v_min_f32 v151, 0, v91
    v_pk_mul_f32 v[150:151], v[150:151], s[52:53]
    v_exp_f32 v148, v148
    v_exp_f32 v149, v149
    v_exp_f32 v150, v150
    v_exp_f32 v151, v151
    v_max_f32 v88, 0, v88
    v_max_f32 v89, 0, v89
    v_max_f32 v90, 0, v90
    v_max_f32 v91, 0, v91
    v_pk_add_f32 v[88:89], v[88:89], v[148:149]
    v_pk_add_f32 v[90:91], v[90:91], v[150:151]
    v_pk_add_f32 v[88:89], v[88:89], s[54:55]
    v_pk_add_f32 v[90:91], v[90:91], s[54:55]
    v_min_f32 v148, 0, v92
    v_min_f32 v149, 0, v93
    v_pk_mul_f32 v[148:149], v[148:149], s[52:53]
    v_min_f32 v150, 0, v94
    v_min_f32 v151, 0, v95
    v_pk_mul_f32 v[150:151], v[150:151], s[52:53]
    v_exp_f32 v148, v148
    v_exp_f32 v149, v149
    v_exp_f32 v150, v150
    v_exp_f32 v151, v151
    v_max_f32 v92, 0, v92
    v_max_f32 v93, 0, v93
    v_max_f32 v94, 0, v94
    v_max_f32 v95, 0, v95
    v_pk_add_f32 v[92:93], v[92:93], v[148:149]
    v_pk_add_f32 v[94:95], v[94:95], v[150:151]
    v_pk_add_f32 v[92:93], v[92:93], s[54:55]
    v_pk_add_f32 v[94:95], v[94:95], s[54:55]
    v_cvt_pk_bf16_f32 v56, v88, v89
    v_cvt_pk_bf16_f32 v57, v90, v91
    ds_write_b64 v10, v[56:57] offset:64
    v_cvt_pk_bf16_f32 v58, v92, v93
    v_cvt_pk_bf16_f32 v59, v94, v95
    ds_write_b64 v10, v[58:59] offset:5440
    v_min_f32 v148, 0, v96
    v_min_f32 v149, 0, v97
    v_pk_mul_f32 v[148:149], v[148:149], s[52:53]
    v_min_f32 v150, 0, v98
    v_min_f32 v151, 0, v99
    v_pk_mul_f32 v[150:151], v[150:151], s[52:53]
    v_exp_f32 v148, v148
    v_exp_f32 v149, v149
    v_exp_f32 v150, v150
    v_exp_f32 v151, v151
    v_max_f32 v96, 0, v96
    v_max_f32 v97, 0, v97
    v_max_f32 v98, 0, v98
    v_max_f32 v99, 0, v99
    v_pk_add_f32 v[96:97], v[96:97], v[148:149]
    v_pk_add_f32 v[98:99], v[98:99], v[150:151]
    v_pk_add_f32 v[96:97], v[96:97], s[54:55]
    v_pk_add_f32 v[98:99], v[98:99], s[54:55]
    v_min_f32 v148, 0, v100
    v_min_f32 v149, 0, v101
    v_pk_mul_f32 v[148:149], v[148:149], s[52:53]
    v_min_f32 v150, 0, v102
    v_min_f32 v151, 0, v103
    v_pk_mul_f32 v[150:151], v[150:151], s[52:53]
    v_exp_f32 v148, v148
    v_exp_f32 v149, v149
    v_exp_f32 v150, v150
    v_exp_f32 v151, v151
    v_max_f32 v100, 0, v100
    v_max_f32 v101, 0, v101
    v_max_f32 v102, 0, v102
    v_max_f32 v103, 0, v103
    v_pk_add_f32 v[100:101], v[100:101], v[148:149]
    v_pk_add_f32 v[102:103], v[102:103], v[150:151]
    v_pk_add_f32 v[100:101], v[100:101], s[54:55]
    v_pk_add_f32 v[102:103], v[102:103], s[54:55]
    v_cvt_pk_bf16_f32 v60, v96, v97
    v_cvt_pk_bf16_f32 v61, v98, v99
    ds_write_b64 v10, v[60:61] offset:96
    v_cvt_pk_bf16_f32 v62, v100, v101
    v_cvt_pk_bf16_f32 v63, v102, v103
    ds_write_b64 v10, v[62:63] offset:5472
    v_min_f32 v148, 0, v104
    v_min_f32 v149, 0, v105
    v_pk_mul_f32 v[148:149], v[148:149], s[52:53]
    v_min_f32 v150, 0, v106
    v_min_f32 v151, 0, v107
    v_pk_mul_f32 v[150:151], v[150:151], s[52:53]
    v_exp_f32 v148, v148
    v_exp_f32 v149, v149
    v_exp_f32 v150, v150
    v_exp_f32 v151, v151
    v_max_f32 v104, 0, v104
    v_max_f32 v105, 0, v105
    v_max_f32 v106, 0, v106
    v_max_f32 v107, 0, v107
    v_pk_add_f32 v[104:105], v[104:105], v[148:149]
    v_pk_add_f32 v[106:107], v[106:107], v[150:151]
    v_pk_add_f32 v[104:105], v[104:105], s[54:55]
    v_pk_add_f32 v[106:107], v[106:107], s[54:55]
    v_min_f32 v148, 0, v108
    v_min_f32 v149, 0, v109
    v_pk_mul_f32 v[148:149], v[148:149], s[52:53]
    v_min_f32 v150, 0, v110
    v_min_f32 v151, 0, v111
    v_pk_mul_f32 v[150:151], v[150:151], s[52:53]
    v_exp_f32 v148, v148
    v_exp_f32 v149, v149
    v_exp_f32 v150, v150
    v_exp_f32 v151, v151
    v_max_f32 v108, 0, v108
    v_max_f32 v109, 0, v109
    v_max_f32 v110, 0, v110
    v_max_f32 v111, 0, v111
    v_pk_add_f32 v[108:109], v[108:109], v[148:149]
    v_pk_add_f32 v[110:111], v[110:111], v[150:151]
    v_pk_add_f32 v[108:109], v[108:109], s[54:55]
    v_pk_add_f32 v[110:111], v[110:111], s[54:55]
    v_cvt_pk_bf16_f32 v64, v104, v105
    v_cvt_pk_bf16_f32 v65, v106, v107
    ds_write_b64 v10, v[64:65] offset:128
    v_cvt_pk_bf16_f32 v66, v108, v109
    v_cvt_pk_bf16_f32 v67, v110, v111
    ds_write_b64 v10, v[66:67] offset:5504
interleave_layers__linear_attn_block__memory_aug_recurrent_mem_tr__prompt_kernel_k1_ej:
    s_waitcnt lgkmcnt(0)
    s_barrier
    ds_read_b64_tr_b16 v[72:73], v11 offset:0
    ds_read_b64_tr_b16 v[74:75], v11 offset:1344
    ds_read_b64_tr_b16 v[76:77], v11 offset:32
    ds_read_b64_tr_b16 v[78:79], v11 offset:1376
    ds_read_b64_tr_b16 v[80:81], v11 offset:160
    ds_read_b64_tr_b16 v[82:83], v11 offset:1504
    ds_read_b64_tr_b16 v[84:85], v11 offset:192
    ds_read_b64_tr_b16 v[86:87], v11 offset:1536
    s_waitcnt lgkmcnt(0)
    v_mfma_f32_16x16x32_bf16 v[120:123], v[72:75], v[84:87], v[120:123]
    v_mfma_f32_16x16x32_bf16 v[124:127], v[76:79], v[80:83], v[124:127]
    v_mfma_f32_16x16x32_bf16 v[128:131], v[76:79], v[84:87], v[128:131]
    v_mfma_f32_16x16x32_bf16 v[132:135], v[76:79], v[172:175], v[132:135]
    v_mfma_f32_16x16x32_bf16 v[136:139], v[72:75], v[80:83], v[136:139]
    v_mfma_f32_16x16x32_bf16 v[140:143], v[72:75], v[172:175], v[140:143]
    s_add_u32 s43, s43, s42
    s_add_u32 s48, s48, s49
    s_sub_u32 s40, s40, 1
    s_cmp_gt_u32 s40, 0
    s_cbranch_scc1 interleave_layers__linear_attn_block__memory_aug_recurrent_mem_tr__prompt_kernel_k1_seg
    s_mul_i32 s24, s45, 147456
    s_mul_i32 s25, s44, 18432
    s_add_u32 s24, s24, s25
    s_add_u32 s24, s24, 16777216
    s_mul_i32 s25, s3, 3072
    s_add_u32 s25, s25, s24
    s_lshl_b32 s26, s3, 10
    s_add_u32 s26, s26, s24
    s_add_u32 s26, s26, 13312
    s_cmp_eq_u32 s3, 0
    s_cselect_b32 s27, 0, 2146435072
    s_add_u32 s27, s27, s24
    s_add_u32 s28, s27, 17408
    s_add_u32 s27, s27, 12288
    buffer_store_dwordx4 v[120:123], v7, s[8:11], s25 offen offset:0 sc1
    buffer_store_dwordx4 v[124:127], v7, s[8:11], s25 offen offset:1024 sc1
    buffer_store_dwordx4 v[128:131], v7, s[8:11], s25 offen offset:2048 sc1
    buffer_store_dwordx4 v[132:135], v7, s[8:11], s26 offen sc1
    buffer_store_dwordx4 v[136:139], v7, s[8:11], s27 offen sc1
    buffer_store_dwordx4 v[140:143], v7, s[8:11], s28 offen sc1
    s_waitcnt vmcnt(0)
    s_barrier
    s_lshl_b32 s24, s92, 3
    s_add_u32 s24, s24, s44
    s_lshl_b32 s24, s24, 7
    s_lshl_b32 s25, s45, 2
    s_add_u32 s24, s24, s25
    s_add_u32 s24, s24, 23101440
    s_cmp_eq_u32 s3, 0
    s_cbranch_scc0 interleave_layers__linear_attn_block__memory_aug_recurrent_mem_tr__prompt_kernel_pb8
    v_lshlrev_b32 v14, 7, v1
    v_add_u32 v14, s24, v14
    v_mov_b32 v15, 2146435072
    v_cmp_le_u32 vcc, 1, v1
    s_nop 1
    v_cndmask_b32 v14, v14, v15, vcc
    v_mov_b32 v15, 1
    buffer_store_dword v15, v14, s[8:11], 0 offen sc1
interleave_layers__linear_attn_block__memory_aug_recurrent_mem_tr__prompt_kernel_pb8:
    s_cmp_eq_u32 s92, 0
    s_cbranch_scc0 interleave_layers__linear_attn_block__memory_aug_recurrent_mem_tr__prompt_kernel_end
    s_cmp_ge_u32 s2, 232
    s_cbranch_scc1 interleave_layers__linear_attn_block__memory_aug_recurrent_mem_tr__prompt_kernel_helper
    s_cmp_ge_u32 s2, 200
    s_cbranch_scc1 interleave_layers__linear_attn_block__memory_aug_recurrent_mem_tr__prompt_kernel_toO
    s_cmp_ge_u32 s2, 104
    s_cbranch_scc1 interleave_layers__linear_attn_block__memory_aug_recurrent_mem_tr__prompt_kernel_toP
    s_cmp_ge_u32 s2, 64
    s_cbranch_scc1 interleave_layers__linear_attn_block__memory_aug_recurrent_mem_tr__prompt_kernel_toR
    s_cmp_ge_u32 s2, 32
    s_cbranch_scc1 interleave_layers__linear_attn_block__memory_aug_recurrent_mem_tr__prompt_kernel_toV
    s_branch interleave_layers__linear_attn_block__memory_aug_recurrent_mem_tr__prompt_kernel_roleS
interleave_layers__linear_attn_block__memory_aug_recurrent_mem_tr__prompt_kernel_toV:
    s_branch interleave_layers__linear_attn_block__memory_aug_recurrent_mem_tr__prompt_kernel_roleV
interleave_layers__linear_attn_block__memory_aug_recurrent_mem_tr__prompt_kernel_toR:
    s_branch interleave_layers__linear_attn_block__memory_aug_recurrent_mem_tr__prompt_kernel_roleR
interleave_layers__linear_attn_block__memory_aug_recurrent_mem_tr__prompt_kernel_toP:
    s_branch interleave_layers__linear_attn_block__memory_aug_recurrent_mem_tr__prompt_kernel_roleP
interleave_layers__linear_attn_block__memory_aug_recurrent_mem_tr__prompt_kernel_toO:
    s_branch interleave_layers__linear_attn_block__memory_aug_recurrent_mem_tr__prompt_kernel_roleO
interleave_layers__linear_attn_block__memory_aug_recurrent_mem_tr__prompt_kernel_helper:
    s_sub_u32 s24, s2, 232
    s_cmp_ge_u32 s24, 21
    s_cbranch_scc1 interleave_layers__linear_attn_block__memory_aug_recurrent_mem_tr__prompt_kernel_helper_clr
    s_cmp_eq_u32 s24, 15
    s_cbranch_scc1 interleave_layers__linear_attn_block__memory_aug_recurrent_mem_tr__prompt_kernel_helper_k1
    s_mul_i32 s57, s24, 52
    s_lshr_b32 s57, s57, 8
    s_mul_i32 s56, s57, 5
    s_sub_u32 s56, s24, s56
    s_add_u32 s57, s57, 1
    s_sub_u32 s25, s24, 16
    s_cmp_ge_u32 s24, 16
    s_cselect_b32 s56, s25, s56
    s_cselect_b32 s57, 0, s57
    s_mul_i32 s78, s57, 5
    s_add_u32 s78, s78, s56
    s_load_dwordx2 s[6:7], s[0:1], 16
    v_lshrrev_b32 v12, 4, v0
    v_mul_u32_u24 v12, 1280, v12
    v_and_b32 v13, 15, v0
    v_lshl_add_u32 v12, v13, 4, v12
    s_waitcnt lgkmcnt(0)
    s_mov_b32 s12, s6
    s_mov_b32 s13, s7
    s_mov_b32 s14, 819200
    s_mov_b32 s15, 0x00020000
    s_lshl_b32 s52, s56, 8
    s_add_u32 s24, s52, 0
    buffer_load_dwordx4 a[0:3], v12, s[12:15], s24 offen
    s_add_u32 s24, s52, 20480
    buffer_load_dwordx4 a[4:7], v12, s[12:15], s24 offen
    s_add_u32 s24, s52, 40960
    buffer_load_dwordx4 a[8:11], v12, s[12:15], s24 offen
    s_add_u32 s24, s52, 61440
    buffer_load_dwordx4 a[12:15], v12, s[12:15], s24 offen
    s_add_u32 s24, s52, 81920
    buffer_load_dwordx4 a[16:19], v12, s[12:15], s24 offen
    s_add_u32 s24, s52, 102400
    buffer_load_dwordx4 a[20:23], v12, s[12:15], s24 offen
    s_add_u32 s24, s52, 122880
    buffer_load_dwordx4 a[24:27], v12, s[12:15], s24 offen
    s_add_u32 s24, s52, 143360
    buffer_load_dwordx4 a[28:31], v12, s[12:15], s24 offen
    s_add_u32 s24, s52, 163840
    buffer_load_dwordx4 a[32:35], v12, s[12:15], s24 offen
    s_add_u32 s24, s52, 184320
    buffer_load_dwordx4 a[36:39], v12, s[12:15], s24 offen
    s_add_u32 s24, s52, 204800
    buffer_load_dwordx4 a[40:43], v12, s[12:15], s24 offen
    s_add_u32 s24, s52, 225280
    buffer_load_dwordx4 a[44:47], v12, s[12:15], s24 offen
    s_add_u32 s24, s52, 245760
    buffer_load_dwordx4 a[48:51], v12, s[12:15], s24 offen
    s_add_u32 s24, s52, 266240
    buffer_load_dwordx4 a[52:55], v12, s[12:15], s24 offen
    s_add_u32 s24, s52, 286720
    buffer_load_dwordx4 a[56:59], v12, s[12:15], s24 offen
    s_add_u32 s24, s52, 307200
    buffer_load_dwordx4 a[60:63], v12, s[12:15], s24 offen
    s_add_u32 s24, s52, 327680
    buffer_load_dwordx4 a[64:67], v12, s[12:15], s24 offen
    s_add_u32 s24, s52, 348160
    buffer_load_dwordx4 a[68:71], v12, s[12:15], s24 offen
    s_add_u32 s24, s52, 368640
    buffer_load_dwordx4 a[72:75], v12, s[12:15], s24 offen
    s_add_u32 s24, s52, 389120
    buffer_load_dwordx4 a[76:79], v12, s[12:15], s24 offen
    s_add_u32 s24, s52, 409600
    buffer_load_dwordx4 a[80:83], v12, s[12:15], s24 offen
    s_add_u32 s24, s52, 430080
    buffer_load_dwordx4 a[84:87], v12, s[12:15], s24 offen
    s_add_u32 s24, s52, 450560
    buffer_load_dwordx4 a[88:91], v12, s[12:15], s24 offen
    s_add_u32 s24, s52, 471040
    buffer_load_dwordx4 a[92:95], v12, s[12:15], s24 offen
    s_add_u32 s24, s52, 491520
    buffer_load_dwordx4 a[96:99], v12, s[12:15], s24 offen
    s_add_u32 s24, s52, 512000
    buffer_load_dwordx4 a[100:103], v12, s[12:15], s24 offen
    s_add_u32 s24, s52, 532480
    buffer_load_dwordx4 a[104:107], v12, s[12:15], s24 offen
    s_add_u32 s24, s52, 552960
    buffer_load_dwordx4 a[108:111], v12, s[12:15], s24 offen
    s_add_u32 s24, s52, 573440
    buffer_load_dwordx4 a[112:115], v12, s[12:15], s24 offen
    s_add_u32 s24, s52, 593920
    buffer_load_dwordx4 a[116:119], v12, s[12:15], s24 offen
    s_add_u32 s24, s52, 614400
    buffer_load_dwordx4 a[120:123], v12, s[12:15], s24 offen
    s_add_u32 s24, s52, 634880
    buffer_load_dwordx4 a[124:127], v12, s[12:15], s24 offen
    s_add_u32 s24, s52, 655360
    buffer_load_dwordx4 a[128:131], v12, s[12:15], s24 offen
    s_add_u32 s24, s52, 675840
    buffer_load_dwordx4 a[132:135], v12, s[12:15], s24 offen
    s_add_u32 s24, s52, 696320
    buffer_load_dwordx4 a[136:139], v12, s[12:15], s24 offen
    s_add_u32 s24, s52, 716800
    buffer_load_dwordx4 a[140:143], v12, s[12:15], s24 offen
    s_add_u32 s24, s52, 737280
    buffer_load_dwordx4 a[144:147], v12, s[12:15], s24 offen
    s_add_u32 s24, s52, 757760
    buffer_load_dwordx4 a[148:151], v12, s[12:15], s24 offen
    s_add_u32 s24, s52, 778240
    buffer_load_dwordx4 a[152:155], v12, s[12:15], s24 offen
    s_add_u32 s24, s52, 798720
    buffer_load_dwordx4 a[156:159], v12, s[12:15], s24 offen
    v_lshrrev_b32 v6, 4, v0
    v_mul_u32_u24 v6, 288, v6
    v_and_b32 v7, 15, v0
    v_lshl_add_u32 v6, v7, 4, v6
    v_add_u32 v6, 81920, v6
    v_lshrrev_b32 v7, 2, v2
    v_lshl_add_u32 v7, v3, 2, v7
    v_mul_u32_u24 v7, 288, v7
    v_and_b32 v8, 3, v2
    v_lshl_add_u32 v7, v8, 3, v7
    s_lshl_b32 s24, s3, 6
    s_add_u32 s24, s24, 81920
    v_add_u32 v7, s24, v7
    s_waitcnt vmcnt(36)
    ds_write_b128 v6, a[0:3] offset:0
    ds_write_b128 v6, a[4:7] offset:4608
    ds_write_b128 v6, a[8:11] offset:9216
    ds_write_b128 v6, a[12:15] offset:13824
    s_waitcnt lgkmcnt(0)
    s_barrier
    ds_read_b64_tr_b16 a[0:1], v7 offset:0
    ds_read_b64_tr_b16 a[2:3], v7 offset:4608
    ds_read_b64_tr_b16 a[4:5], v7 offset:32
    ds_read_b64_tr_b16 a[6:7], v7 offset:4640
    ds_read_b64_tr_b16 a[8:9], v7 offset:9216
    ds_read_b64_tr_b16 a[10:11], v7 offset:13824
    ds_read_b64_tr_b16 a[12:13], v7 offset:9248
    ds_read_b64_tr_b16 a[14:15], v7 offset:13856
    s_waitcnt vmcnt(32)
    ds_write_b128 v6, a[16:19] offset:18432
    ds_write_b128 v6, a[20:23] offset:23040
    ds_write_b128 v6, a[24:27] offset:27648
    ds_write_b128 v6, a[28:31] offset:32256
    s_waitcnt lgkmcnt(0)
    s_barrier
    ds_read_b64_tr_b16 a[16:17], v7 offset:18432
    ds_read_b64_tr_b16 a[18:19], v7 offset:23040
    ds_read_b64_tr_b16 a[20:21], v7 offset:18464
    ds_read_b64_tr_b16 a[22:23], v7 offset:23072
    ds_read_b64_tr_b16 a[24:25], v7 offset:27648
    ds_read_b64_tr_b16 a[26:27], v7 offset:32256
    ds_read_b64_tr_b16 a[28:29], v7 offset:27680
    ds_read_b64_tr_b16 a[30:31], v7 offset:32288
    s_waitcnt vmcnt(28)
    ds_write_b128 v6, a[32:35] offset:0
    ds_write_b128 v6, a[36:39] offset:4608
    ds_write_b128 v6, a[40:43] offset:9216
    ds_write_b128 v6, a[44:47] offset:13824
    s_waitcnt lgkmcnt(0)
    s_barrier
    ds_read_b64_tr_b16 a[32:33], v7 offset:0
    ds_read_b64_tr_b16 a[34:35], v7 offset:4608
    ds_read_b64_tr_b16 a[36:37], v7 offset:32
    ds_read_b64_tr_b16 a[38:39], v7 offset:4640
    ds_read_b64_tr_b16 a[40:41], v7 offset:9216
    ds_read_b64_tr_b16 a[42:43], v7 offset:13824
    ds_read_b64_tr_b16 a[44:45], v7 offset:9248
    ds_read_b64_tr_b16 a[46:47], v7 offset:13856
    s_waitcnt vmcnt(24)
    ds_write_b128 v6, a[48:51] offset:18432
    ds_write_b128 v6, a[52:55] offset:23040
    ds_write_b128 v6, a[56:59] offset:27648
    ds_write_b128 v6, a[60:63] offset:32256
    s_waitcnt lgkmcnt(0)
    s_barrier
    ds_read_b64_tr_b16 a[48:49], v7 offset:18432
    ds_read_b64_tr_b16 a[50:51], v7 offset:23040
    ds_read_b64_tr_b16 a[52:53], v7 offset:18464
    ds_read_b64_tr_b16 a[54:55], v7 offset:23072
    ds_read_b64_tr_b16 a[56:57], v7 offset:27648
    ds_read_b64_tr_b16 a[58:59], v7 offset:32256
    ds_read_b64_tr_b16 a[60:61], v7 offset:27680
    ds_read_b64_tr_b16 a[62:63], v7 offset:32288
    s_waitcnt vmcnt(20)
    ds_write_b128 v6, a[64:67] offset:0
    ds_write_b128 v6, a[68:71] offset:4608
    ds_write_b128 v6, a[72:75] offset:9216
    ds_write_b128 v6, a[76:79] offset:13824
    s_waitcnt lgkmcnt(0)
    s_barrier
    ds_read_b64_tr_b16 a[64:65], v7 offset:0
    ds_read_b64_tr_b16 a[66:67], v7 offset:4608
    ds_read_b64_tr_b16 a[68:69], v7 offset:32
    ds_read_b64_tr_b16 a[70:71], v7 offset:4640
    ds_read_b64_tr_b16 a[72:73], v7 offset:9216
    ds_read_b64_tr_b16 a[74:75], v7 offset:13824
    ds_read_b64_tr_b16 a[76:77], v7 offset:9248
    ds_read_b64_tr_b16 a[78:79], v7 offset:13856
    s_waitcnt vmcnt(16)
    ds_write_b128 v6, a[80:83] offset:18432
    ds_write_b128 v6, a[84:87] offset:23040
    ds_write_b128 v6, a[88:91] offset:27648
    ds_write_b128 v6, a[92:95] offset:32256
    s_waitcnt lgkmcnt(0)
    s_barrier
    ds_read_b64_tr_b16 a[80:81], v7 offset:18432
    ds_read_b64_tr_b16 a[82:83], v7 offset:23040
    ds_read_b64_tr_b16 a[84:85], v7 offset:18464
    ds_read_b64_tr_b16 a[86:87], v7 offset:23072
    ds_read_b64_tr_b16 a[88:89], v7 offset:27648
    ds_read_b64_tr_b16 a[90:91], v7 offset:32256
    ds_read_b64_tr_b16 a[92:93], v7 offset:27680
    ds_read_b64_tr_b16 a[94:95], v7 offset:32288
    s_waitcnt vmcnt(12)
    ds_write_b128 v6, a[96:99] offset:0
    ds_write_b128 v6, a[100:103] offset:4608
    ds_write_b128 v6, a[104:107] offset:9216
    ds_write_b128 v6, a[108:111] offset:13824
    s_waitcnt lgkmcnt(0)
    s_barrier
    ds_read_b64_tr_b16 a[96:97], v7 offset:0
    ds_read_b64_tr_b16 a[98:99], v7 offset:4608
    ds_read_b64_tr_b16 a[100:101], v7 offset:32
    ds_read_b64_tr_b16 a[102:103], v7 offset:4640
    ds_read_b64_tr_b16 a[104:105], v7 offset:9216
    ds_read_b64_tr_b16 a[106:107], v7 offset:13824
    ds_read_b64_tr_b16 a[108:109], v7 offset:9248
    ds_read_b64_tr_b16 a[110:111], v7 offset:13856
    s_waitcnt vmcnt(8)
    ds_write_b128 v6, a[112:115] offset:18432
    ds_write_b128 v6, a[116:119] offset:23040
    ds_write_b128 v6, a[120:123] offset:27648
    ds_write_b128 v6, a[124:127] offset:32256
    s_waitcnt lgkmcnt(0)
    s_barrier
    ds_read_b64_tr_b16 a[112:113], v7 offset:18432
    ds_read_b64_tr_b16 a[114:115], v7 offset:23040
    ds_read_b64_tr_b16 a[116:117], v7 offset:18464
    ds_read_b64_tr_b16 a[118:119], v7 offset:23072
    ds_read_b64_tr_b16 a[120:121], v7 offset:27648
    ds_read_b64_tr_b16 a[122:123], v7 offset:32256
    ds_read_b64_tr_b16 a[124:125], v7 offset:27680
    ds_read_b64_tr_b16 a[126:127], v7 offset:32288
    s_waitcnt vmcnt(4)
    ds_write_b128 v6, a[128:131] offset:0
    ds_write_b128 v6, a[132:135] offset:4608
    ds_write_b128 v6, a[136:139] offset:9216
    ds_write_b128 v6, a[140:143] offset:13824
    s_waitcnt lgkmcnt(0)
    s_barrier
    ds_read_b64_tr_b16 a[128:129], v7 offset:0
    ds_read_b64_tr_b16 a[130:131], v7 offset:4608
    ds_read_b64_tr_b16 a[132:133], v7 offset:32
    ds_read_b64_tr_b16 a[134:135], v7 offset:4640
    ds_read_b64_tr_b16 a[136:137], v7 offset:9216
    ds_read_b64_tr_b16 a[138:139], v7 offset:13824
    ds_read_b64_tr_b16 a[140:141], v7 offset:9248
    ds_read_b64_tr_b16 a[142:143], v7 offset:13856
    s_waitcnt vmcnt(0)
    ds_write_b128 v6, a[144:147] offset:18432
    ds_write_b128 v6, a[148:151] offset:23040
    ds_write_b128 v6, a[152:155] offset:27648
    ds_write_b128 v6, a[156:159] offset:32256
    s_waitcnt lgkmcnt(0)
    s_barrier
    ds_read_b64_tr_b16 a[144:145], v7 offset:18432
    ds_read_b64_tr_b16 a[146:147], v7 offset:23040
    ds_read_b64_tr_b16 a[148:149], v7 offset:18464
    ds_read_b64_tr_b16 a[150:151], v7 offset:23072
    ds_read_b64_tr_b16 a[152:153], v7 offset:27648
    ds_read_b64_tr_b16 a[154:155], v7 offset:32256
    ds_read_b64_tr_b16 a[156:157], v7 offset:27680
    ds_read_b64_tr_b16 a[158:159], v7 offset:32288
    s_waitcnt lgkmcnt(0)
    s_load_dwordx2 s[6:7], s[0:1], 0
    s_waitcnt lgkmcnt(0)
    s_mov_b32 s16, s6
    s_mov_b32 s17, s7
    s_mov_b32 s18, 2621440
    s_mov_b32 s19, 0x00020000
    s_mov_b32 s46, 64
    s_mov_b32 s47, 32
    s_mov_b32 s50, 0
    s_mov_b32 s58, 0
    s_mov_b32 s76, 16
    s_mov_b32 s77, 163840
interleave_layers__linear_attn_block__memory_aug_recurrent_mem_tr__prompt_kernel_k3_entry:
    v_lshlrev_b32 v5, 4, v1
    s_mul_i32 s24, s3, 5120
    s_add_u32 s24, s24, 12582912
    v_add_u32 v8, s24, v5
    v_lshlrev_b32 v9, 3, v1
    s_add_u32 s24, s24, 2048
    v_add_u32 v9, s24, v9
    s_cmp_eq_u32 s50, 1
    s_cselect_b32 s25, 16, 1280
    s_cselect_b32 s26, 256, 8
    v_mul_u32_u24 v10, s25, v2
    v_mul_u32_u24 v11, s26, v3
    s_lshl_b32 s24, s56, 2
    s_add_u32 s24, s24, s3
    s_mul_i32 s25, s24, s46
    v_add3_u32 v10, v10, v11, s25
    v_add_u32 v11, s47, v10
    s_lshl_b32 s24, s24, 10
    s_add_u32 s24, s24, s58
    v_add_u32 v12, s24, v5
    s_mul_i32 s24, s3, 5120
    s_add_u32 s24, s24, 0
    v_add_u32 v13, s24, v5
    s_mov_b32 s54, 0x358637bd
    s_mul_i32 s43, s57, 40960
    s_mov_b32 s40, 0
    s_mov_b32 s42, 0
    s_cmp_eq_u32 s92, 0
    s_cselect_b32 s26, 32, 0
    s_cselect_b32 s27, 7, 1
    s_lshl_b32 s24, s92, 10
    s_add_u32 s24, s24, 23101440
    v_and_b32 v15, 7, v1
    v_lshlrev_b32 v15, 7, v15
    v_lshrrev_b32 v14, 3, v1
    v_and_b32 v14, s27, v14
    v_lshl_add_u32 v15, v14, 2, v15
    v_add_u32 v15, s24, v15
    s_lshl_b32 s27, s26, 1
    s_add_u32 s28, s27, s26
    s_mov_b32 s61, 0
interleave_layers__linear_attn_block__memory_aug_recurrent_mem_tr__prompt_kernel_k3_w0:
    buffer_load_dword v16, v15, s[8:11], 0 offen sc1
    buffer_load_dword v17, v15, s[8:11], s26 offen sc1
    buffer_load_dword v18, v15, s[8:11], s27 offen sc1
    buffer_load_dword v19, v15, s[8:11], s28 offen sc1
    s_waitcnt vmcnt(0)
    v_min_i32 v16, v16, v17
    v_min3_i32 v16, v16, v18, v19
    v_cmp_le_i32 vcc, 1, v16
    s_cmp_eq_u64 vcc, -1
    s_cbranch_scc1 interleave_layers__linear_attn_block__memory_aug_recurrent_mem_tr__prompt_kernel_k3_w0_ok
    s_add_u32 s61, s61, 1
    s_cmp_ge_u32 s61, s60
    s_cbranch_scc1 interleave_layers__linear_attn_block__memory_aug_recurrent_mem_tr__prompt_kernel_k3_w0_to
    s_sleep 4
    s_branch interleave_layers__linear_attn_block__memory_aug_recurrent_mem_tr__prompt_kernel_k3_w0
interleave_layers__linear_attn_block__memory_aug_recurrent_mem_tr__prompt_kernel_k3_w0_to:
    s_mov_b32 s60, 1
interleave_layers__linear_attn_block__memory_aug_recurrent_mem_tr__prompt_kernel_k3_w0_ok:
    s_mov_b32 s41, s43
    s_add_u32 s25, s41, 20480
    buffer_load_dwordx4 v[16:19], v8, s[8:11], s41 offen offset:0 sc1
    buffer_load_dwordx4 v[20:23], v8, s[8:11], s41 offen offset:1024 sc1
    buffer_load_dwordx2 v[24:25], v9, s[8:11], s41 offen offset:0 sc1
    buffer_load_dwordx4 v[26:29], v8, s[8:11], s41 offen offset:2560 sc1
    buffer_load_dwordx4 v[30:33], v8, s[8:11], s41 offen offset:3584 sc1
    buffer_load_dwordx2 v[34:35], v9, s[8:11], s41 offen offset:2560 sc1
    buffer_load_dwordx4 v[36:39], v8, s[8:11], s25 offen offset:0 sc1
    buffer_load_dwordx4 v[40:43], v8, s[8:11], s25 offen offset:1024 sc1
    buffer_load_dwordx2 v[44:45], v9, s[8:11], s25 offen offset:0 sc1
    buffer_load_dwordx4 v[46:49], v8, s[8:11], s25 offen offset:2560 sc1
    buffer_load_dwordx4 v[50:53], v8, s[8:11], s25 offen offset:3584 sc1
    buffer_load_dwordx2 v[54:55], v9, s[8:11], s25 offen offset:2560 sc1
    buffer_load_dwordx2 v[96:97], v10, s[16:19], s41 offen sc1
    buffer_load_dwordx2 v[98:99], v11, s[16:19], s41 offen sc1
    buffer_load_dwordx2 v[100:101], v10, s[16:19], s25 offen sc1
    buffer_load_dwordx2 v[102:103], v11, s[16:19], s25 offen sc1
    s_add_u32 s41, s43, s77
    s_add_u32 s25, s41, 20480
    buffer_load_dwordx4 v[56:59], v8, s[8:11], s41 offen offset:0 sc1
    buffer_load_dwordx4 v[60:63], v8, s[8:11], s41 offen offset:1024 sc1
    buffer_load_dwordx2 v[64:65], v9, s[8:11], s41 offen offset:0 sc1
    buffer_load_dwordx4 v[66:69], v8, s[8:11], s41 offen offset:2560 sc1
    buffer_load_dwordx4 v[70:73], v8, s[8:11], s41 offen offset:3584 sc1
    buffer_load_dwordx2 v[74:75], v9, s[8:11], s41 offen offset:2560 sc1
    buffer_load_dwordx4 v[76:79], v8, s[8:11], s25 offen offset:0 sc1
    buffer_load_dwordx4 v[80:83], v8, s[8:11], s25 offen offset:1024 sc1
    buffer_load_dwordx2 v[84:85], v9, s[8:11], s25 offen offset:0 sc1
    buffer_load_dwordx4 v[86:89], v8, s[8:11], s25 offen offset:2560 sc1
    buffer_load_dwordx4 v[90:93], v8, s[8:11], s25 offen offset:3584 sc1
    buffer_load_dwordx2 v[94:95], v9, s[8:11], s25 offen offset:2560 sc1
    buffer_load_dwordx2 v[104:105], v10, s[16:19], s41 offen sc1
    buffer_load_dwordx2 v[106:107], v11, s[16:19], s41 offen sc1
    buffer_load_dwordx2 v[108:109], v10, s[16:19], s25 offen sc1
    buffer_load_dwordx2 v[110:111], v11, s[16:19], s25 offen sc1
    s_lshl_b32 s24, s92, 7
    s_add_u32 s24, s24, 23103488
    v_lshlrev_b32 v15, 2, v1
    v_add_u32 v15, s24, v15
    s_mov_b32 s61, 0
interleave_layers__linear_attn_block__memory_aug_recurrent_mem_tr__prompt_kernel_k3_w:
    buffer_load_dword v14, v15, s[8:11], 0 offen sc1
    s_waitcnt vmcnt(0)
    v_cmp_le_i32 vcc, 1, v14
    s_mov_b32 s25, 0xffffff
    s_and_b32 s24, vcc_lo, s25
    s_cmp_eq_u32 s24, s25
    s_cbranch_scc1 interleave_layers__linear_attn_block__memory_aug_recurrent_mem_tr__prompt_kernel_k3_w_ok
    s_add_u32 s61, s61, 1
    s_cmp_ge_u32 s61, s60
    s_cbranch_scc1 interleave_layers__linear_attn_block__memory_aug_recurrent_mem_tr__prompt_kernel_k3_w_to
    s_sleep 2
    s_branch interleave_layers__linear_attn_block__memory_aug_recurrent_mem_tr__prompt_kernel_k3_w
interleave_layers__linear_attn_block__memory_aug_recurrent_mem_tr__prompt_kernel_k3_w_to:
    s_mov_b32 s60, 1
interleave_layers__linear_attn_block__memory_aug_recurrent_mem_tr__prompt_kernel_k3_w_ok:
    s_mul_i32 s24, s92, 131072
    s_mul_i32 s25, s3, 28672
    s_add_u32 s24, s24, s25
    s_add_u32 s24, s24, 22020096
    s_add_u32 s25, s24, 0
    buffer_load_dwordx4 a[160:163], v5, s[8:11], s25 offen sc1
    s_add_u32 s25, s24, 1024
    buffer_load_dwordx4 a[164:167], v5, s[8:11], s25 offen sc1
    s_add_u32 s25, s24, 2048
    buffer_load_dwordx4 a[168:171], v5, s[8:11], s25 offen sc1
    s_add_u32 s25, s24, 3072
    buffer_load_dwordx4 a[172:175], v5, s[8:11], s25 offen sc1
    s_add_u32 s25, s24, 4096
    buffer_load_dwordx4 a[176:179], v5, s[8:11], s25 offen sc1
    s_add_u32 s25, s24, 5120
    buffer_load_dwordx4 a[180:183], v5, s[8:11], s25 offen sc1
    s_add_u32 s25, s24, 6144
    buffer_load_dwordx2 a[184:185], v5, s[8:11], s25 offen sc1
    s_add_u32 s25, s24, 7168
    buffer_load_dwordx4 a[186:189], v5, s[8:11], s25 offen sc1
    s_add_u32 s25, s24, 8192
    buffer_load_dwordx2 a[190:191], v5, s[8:11], s25 offen sc1
    s_add_u32 s25, s24, 9216
    buffer_load_dwordx4 a[192:195], v5, s[8:11], s25 offen sc1
    s_add_u32 s25, s24, 10240
    buffer_load_dwordx4 a[196:199], v5, s[8:11], s25 offen sc1
    s_add_u32 s25, s24, 11264
    buffer_load_dwordx2 a[200:201], v5, s[8:11], s25 offen sc1
    s_add_u32 s25, s24, 12288
    buffer_load_dwordx4 a[202:205], v5, s[8:11], s25 offen sc1
    s_add_u32 s25, s24, 13312
    buffer_load_dwordx2 a[206:207], v5, s[8:11], s25 offen sc1
    s_add_u32 s25, s24, 14336
    buffer_load_dwordx4 a[208:211], v5, s[8:11], s25 offen sc1
    s_add_u32 s25, s24, 15360
    buffer_load_dwordx4 a[212:215], v5, s[8:11], s25 offen sc1
    s_add_u32 s25, s24, 16384
    buffer_load_dwordx4 a[216:219], v5, s[8:11], s25 offen sc1
    s_add_u32 s25, s24, 17408
    buffer_load_dwordx4 a[220:223], v5, s[8:11], s25 offen sc1
    s_add_u32 s25, s24, 18432
    buffer_load_dwordx4 a[224:227], v5, s[8:11], s25 offen sc1
    s_add_u32 s25, s24, 19456
    buffer_load_dwordx4 a[228:231], v5, s[8:11], s25 offen sc1
    s_add_u32 s25, s24, 20480
    buffer_load_dwordx2 a[232:233], v5, s[8:11], s25 offen sc1
    s_add_u32 s25, s24, 21504
    buffer_load_dwordx4 a[234:237], v5, s[8:11], s25 offen sc1
    s_add_u32 s25, s24, 22528
    buffer_load_dwordx2 a[238:239], v5, s[8:11], s25 offen sc1
    s_add_u32 s25, s24, 23552
    buffer_load_dwordx4 a[240:243], v5, s[8:11], s25 offen sc1
    s_add_u32 s25, s24, 24576
    buffer_load_dwordx4 a[244:247], v5, s[8:11], s25 offen sc1
    s_add_u32 s25, s24, 25600
    buffer_load_dwordx2 a[248:249], v5, s[8:11], s25 offen sc1
    s_add_u32 s25, s24, 26624
    buffer_load_dwordx4 a[250:253], v5, s[8:11], s25 offen sc1
    s_add_u32 s25, s24, 27648
    buffer_load_dwordx2 a[254:255], v5, s[8:11], s25 offen sc1
    s_waitcnt vmcnt(0)
    v_mfma_f32_16x16x32_bf16 v[132:135], a[192:195], v[16:19], 0
    v_mfma_f32_16x16x32_bf16 v[136:139], a[202:205], v[20:23], 0
    v_mfma_f32_16x16x32_bf16 v[112:115], a[160:163], v[16:19], 0
    v_mfma_f32_16x16x32_bf16 v[116:119], a[164:167], v[16:19], 0
    v_mfma_f32_16x16x32_bf16 v[120:123], a[172:175], v[16:19], 0
    v_mfma_f32_16x16x32_bf16 v[124:127], a[180:183], v[20:23], 0
    v_mfma_f32_16x16x32_bf16 v[128:131], a[186:189], v[20:23], 0
    v_mfma_f32_16x16x32_bf16 v[132:135], a[196:199], v[20:23], v[132:135]
    v_mfma_f32_16x16x32_bf16 v[116:119], a[168:171], v[20:23], v[116:119]
    v_mfma_f32_16x16x32_bf16 v[120:123], a[176:179], v[20:23], v[120:123]
    v_mfma_f32_16x16x16_bf16 v[136:139], a[206:207], v[24:25], v[136:139]
    s_nop 0
    v_mfma_f32_16x16x16_bf16 v[124:127], a[184:185], v[24:25], v[124:127]
    v_mfma_f32_16x16x16_bf16 v[128:131], a[190:191], v[24:25], v[128:131]
    v_mfma_f32_16x16x16_bf16 v[132:135], a[200:201], v[24:25], v[132:135]
    v_mfma_f32_16x16x32_bf16 v[160:163], a[240:243], v[26:29], 0
    v_mfma_f32_16x16x32_bf16 v[164:167], a[250:253], v[30:33], 0
    v_mfma_f32_16x16x32_bf16 v[140:143], a[208:211], v[26:29], 0
    v_mfma_f32_16x16x32_bf16 v[144:147], a[212:215], v[26:29], 0
    v_mfma_f32_16x16x32_bf16 v[148:151], a[220:223], v[26:29], 0
    v_mfma_f32_16x16x32_bf16 v[152:155], a[228:231], v[30:33], 0
    v_mfma_f32_16x16x32_bf16 v[156:159], a[234:237], v[30:33], 0
    v_mfma_f32_16x16x32_bf16 v[160:163], a[244:247], v[30:33], v[160:163]
    v_mfma_f32_16x16x32_bf16 v[144:147], a[216:219], v[30:33], v[144:147]
    v_mfma_f32_16x16x32_bf16 v[148:151], a[224:227], v[30:33], v[148:151]
    v_mfma_f32_16x16x16_bf16 v[164:167], a[254:255], v[34:35], v[164:167]
    s_nop 0
    v_mfma_f32_16x16x16_bf16 v[152:155], a[232:233], v[34:35], v[152:155]
    v_mfma_f32_16x16x16_bf16 v[156:159], a[238:239], v[34:35], v[156:159]
    v_mfma_f32_16x16x16_bf16 v[160:163], a[248:249], v[34:35], v[160:163]
    v_add_f32 v132, s54, v132
    v_add_f32 v133, s54, v133
    v_add_f32 v134, s54, v134
    v_add_f32 v135, s54, v135
    v_add_f32 v136, s54, v136
    v_rcp_f32 v132, v132
    v_rcp_f32 v133, v133
    v_rcp_f32 v134, v134
    v_rcp_f32 v135, v135
    v_rcp_f32 v136, v136
    v_mul_f32 v112, v112, v132
    v_mul_f32 v113, v113, v132
    v_mul_f32 v114, v114, v132
    v_mul_f32 v115, v115, v132
    v_cvt_pk_bf16_f32 v168, v112, v113
    v_cvt_pk_bf16_f32 v169, v114, v115
    v_mul_f32 v116, v116, v133
    v_mul_f32 v117, v117, v133
    v_mul_f32 v118, v118, v133
    v_mul_f32 v119, v119, v133
    v_cvt_pk_bf16_f32 v170, v116, v117
    v_cvt_pk_bf16_f32 v171, v118, v119
    v_mul_f32 v120, v120, v134
    v_mul_f32 v121, v121, v134
    v_mul_f32 v122, v122, v134
    v_mul_f32 v123, v123, v134
    v_cvt_pk_bf16_f32 v172, v120, v121
    v_cvt_pk_bf16_f32 v173, v122, v123
    v_mul_f32 v124, v124, v135
    v_mul_f32 v125, v125, v135
    v_mul_f32 v126, v126, v135
    v_mul_f32 v127, v127, v135
    v_cvt_pk_bf16_f32 v174, v124, v125
    v_cvt_pk_bf16_f32 v175, v126, v127
    v_mul_f32 v128, v128, v136
    v_mul_f32 v129, v129, v136
    v_mul_f32 v130, v130, v136
    v_mul_f32 v131, v131, v136
    v_cvt_pk_bf16_f32 v176, v128, v129
    v_cvt_pk_bf16_f32 v177, v130, v131
    v_add_f32 v160, s54, v160
    v_add_f32 v161, s54, v161
    v_add_f32 v162, s54, v162
    v_add_f32 v163, s54, v163
    v_add_f32 v164, s54, v164
    v_rcp_f32 v160, v160
    v_rcp_f32 v161, v161
    v_rcp_f32 v162, v162
    v_rcp_f32 v163, v163
    v_rcp_f32 v164, v164
    v_mul_f32 v140, v140, v160
    v_mul_f32 v141, v141, v160
    v_mul_f32 v142, v142, v160
    v_mul_f32 v143, v143, v160
    v_cvt_pk_bf16_f32 v178, v140, v141
    v_cvt_pk_bf16_f32 v179, v142, v143
    v_mul_f32 v144, v144, v161
    v_mul_f32 v145, v145, v161
    v_mul_f32 v146, v146, v161
    v_mul_f32 v147, v147, v161
    v_cvt_pk_bf16_f32 v180, v144, v145
    v_cvt_pk_bf16_f32 v181, v146, v147
    v_mul_f32 v148, v148, v162
    v_mul_f32 v149, v149, v162
    v_mul_f32 v150, v150, v162
    v_mul_f32 v151, v151, v162
    v_cvt_pk_bf16_f32 v182, v148, v149
    v_cvt_pk_bf16_f32 v183, v150, v151
    v_mul_f32 v152, v152, v163
    v_mul_f32 v153, v153, v163
    v_mul_f32 v154, v154, v163
    v_mul_f32 v155, v155, v163
    v_cvt_pk_bf16_f32 v184, v152, v153
    v_cvt_pk_bf16_f32 v185, v154, v155
    v_mul_f32 v156, v156, v164
    v_mul_f32 v157, v157, v164
    v_mul_f32 v158, v158, v164
    v_mul_f32 v159, v159, v164
    v_cvt_pk_bf16_f32 v186, v156, v157
    v_cvt_pk_bf16_f32 v187, v158, v159
    v_mfma_f32_16x16x32_bf16 v[132:135], a[192:195], v[36:39], 0
    v_mfma_f32_16x16x32_bf16 v[136:139], a[202:205], v[40:43], 0
    v_mfma_f32_16x16x32_bf16 v[112:115], a[160:163], v[36:39], 0
    v_mfma_f32_16x16x32_bf16 v[116:119], a[164:167], v[36:39], 0
    v_mfma_f32_16x16x32_bf16 v[120:123], a[172:175], v[36:39], 0
    v_mfma_f32_16x16x32_bf16 v[124:127], a[180:183], v[40:43], 0
    v_mfma_f32_16x16x32_bf16 v[128:131], a[186:189], v[40:43], 0
    v_mfma_f32_16x16x32_bf16 v[132:135], a[196:199], v[40:43], v[132:135]
    v_mfma_f32_16x16x32_bf16 v[116:119], a[168:171], v[40:43], v[116:119]
    v_mfma_f32_16x16x32_bf16 v[120:123], a[176:179], v[40:43], v[120:123]
    v_mfma_f32_16x16x16_bf16 v[136:139], a[206:207], v[44:45], v[136:139]
    s_nop 0
    v_mfma_f32_16x16x16_bf16 v[124:127], a[184:185], v[44:45], v[124:127]
    v_mfma_f32_16x16x16_bf16 v[128:131], a[190:191], v[44:45], v[128:131]
    v_mfma_f32_16x16x16_bf16 v[132:135], a[200:201], v[44:45], v[132:135]
    v_mfma_f32_16x16x32_bf16 v[160:163], a[240:243], v[46:49], 0
    v_mfma_f32_16x16x32_bf16 v[164:167], a[250:253], v[50:53], 0
    v_mfma_f32_16x16x32_bf16 v[140:143], a[208:211], v[46:49], 0
    v_mfma_f32_16x16x32_bf16 v[144:147], a[212:215], v[46:49], 0
    v_mfma_f32_16x16x32_bf16 v[148:151], a[220:223], v[46:49], 0
    v_mfma_f32_16x16x32_bf16 v[152:155], a[228:231], v[50:53], 0
    v_mfma_f32_16x16x32_bf16 v[156:159], a[234:237], v[50:53], 0
    v_mfma_f32_16x16x32_bf16 v[160:163], a[244:247], v[50:53], v[160:163]
    v_mfma_f32_16x16x32_bf16 v[144:147], a[216:219], v[50:53], v[144:147]
    v_mfma_f32_16x16x32_bf16 v[148:151], a[224:227], v[50:53], v[148:151]
    v_mfma_f32_16x16x16_bf16 v[164:167], a[254:255], v[54:55], v[164:167]
    s_nop 0
    v_mfma_f32_16x16x16_bf16 v[152:155], a[232:233], v[54:55], v[152:155]
    v_mfma_f32_16x16x16_bf16 v[156:159], a[238:239], v[54:55], v[156:159]
    v_mfma_f32_16x16x16_bf16 v[160:163], a[248:249], v[54:55], v[160:163]
    v_add_f32 v132, s54, v132
    v_add_f32 v133, s54, v133
    v_add_f32 v134, s54, v134
    v_add_f32 v135, s54, v135
    v_add_f32 v136, s54, v136
    v_rcp_f32 v132, v132
    v_rcp_f32 v133, v133
    v_rcp_f32 v134, v134
    v_rcp_f32 v135, v135
    v_rcp_f32 v136, v136
    v_mul_f32 v112, v112, v132
    v_mul_f32 v113, v113, v132
    v_mul_f32 v114, v114, v132
    v_mul_f32 v115, v115, v132
    v_cvt_pk_bf16_f32 v188, v112, v113
    v_cvt_pk_bf16_f32 v189, v114, v115
    v_mul_f32 v116, v116, v133
    v_mul_f32 v117, v117, v133
    v_mul_f32 v118, v118, v133
    v_mul_f32 v119, v119, v133
    v_cvt_pk_bf16_f32 v190, v116, v117
    v_cvt_pk_bf16_f32 v191, v118, v119
    v_mul_f32 v120, v120, v134
    v_mul_f32 v121, v121, v134
    v_mul_f32 v122, v122, v134
    v_mul_f32 v123, v123, v134
    v_cvt_pk_bf16_f32 v192, v120, v121
    v_cvt_pk_bf16_f32 v193, v122, v123
    v_mul_f32 v124, v124, v135
    v_mul_f32 v125, v125, v135
    v_mul_f32 v126, v126, v135
    v_mul_f32 v127, v127, v135
    v_cvt_pk_bf16_f32 v194, v124, v125
    v_cvt_pk_bf16_f32 v195, v126, v127
    v_mul_f32 v128, v128, v136
    v_mul_f32 v129, v129, v136
    v_mul_f32 v130, v130, v136
    v_mul_f32 v131, v131, v136
    v_cvt_pk_bf16_f32 v196, v128, v129
    v_cvt_pk_bf16_f32 v197, v130, v131
    v_add_f32 v160, s54, v160
    v_add_f32 v161, s54, v161
    v_add_f32 v162, s54, v162
    v_add_f32 v163, s54, v163
    v_add_f32 v164, s54, v164
    v_rcp_f32 v160, v160
    v_rcp_f32 v161, v161
    v_rcp_f32 v162, v162
    v_rcp_f32 v163, v163
    v_rcp_f32 v164, v164
    v_mul_f32 v140, v140, v160
    v_mul_f32 v141, v141, v160
    v_mul_f32 v142, v142, v160
    v_mul_f32 v143, v143, v160
    v_cvt_pk_bf16_f32 v198, v140, v141
    v_cvt_pk_bf16_f32 v199, v142, v143
    v_mul_f32 v144, v144, v161
    v_mul_f32 v145, v145, v161
    v_mul_f32 v146, v146, v161
    v_mul_f32 v147, v147, v161
    v_cvt_pk_bf16_f32 v200, v144, v145
    v_cvt_pk_bf16_f32 v201, v146, v147
    v_mul_f32 v148, v148, v162
    v_mul_f32 v149, v149, v162
    v_mul_f32 v150, v150, v162
    v_mul_f32 v151, v151, v162
    v_cvt_pk_bf16_f32 v202, v148, v149
    v_cvt_pk_bf16_f32 v203, v150, v151
    v_mul_f32 v152, v152, v163
    v_mul_f32 v153, v153, v163
    v_mul_f32 v154, v154, v163
    v_mul_f32 v155, v155, v163
    v_cvt_pk_bf16_f32 v204, v152, v153
    v_cvt_pk_bf16_f32 v205, v154, v155
    v_mul_f32 v156, v156, v164
    v_mul_f32 v157, v157, v164
    v_mul_f32 v158, v158, v164
    v_mul_f32 v159, v159, v164
    v_cvt_pk_bf16_f32 v206, v156, v157
    v_cvt_pk_bf16_f32 v207, v158, v159
    v_add_u32 v14, s42, v13
    ds_write_b128 v14, v[168:171] offset:0
    ds_write_b128 v14, v[172:175] offset:1024
    ds_write_b128 v14, v[176:179] offset:2048
    ds_write_b128 v14, v[180:183] offset:3072
    ds_write_b128 v14, v[184:187] offset:4096
    ds_write_b128 v14, v[188:191] offset:20480
    ds_write_b128 v14, v[192:195] offset:21504
    ds_write_b128 v14, v[196:199] offset:22528
    ds_write_b128 v14, v[200:203] offset:23552
    ds_write_b128 v14, v[204:207] offset:24576
    s_waitcnt lgkmcnt(0)
    s_barrier
interleave_layers__linear_attn_block__memory_aug_recurrent_mem_tr__prompt_kernel_k3_seg:
    v_add_u32 v15, s42, v5
    ds_read_b128 v[208:211], v15 offset:0
    ds_read_b128 v[212:215], v15 offset:20480
    ds_read_b128 v[216:219], v15 offset:1024
    ds_read_b128 v[220:223], v15 offset:21504
    ds_read_b128 v[224:227], v15 offset:2048
    ds_read_b128 v[228:231], v15 offset:22528
    ds_read_b128 v[232:235], v15 offset:3072
    ds_read_b128 v[236:239], v15 offset:23552
    s_waitcnt lgkmcnt(6)
    v_mfma_f32_16x16x32_bf16 v[240:243], a[0:3], v[208:211], 0
    v_mfma_f32_16x16x32_bf16 v[244:247], a[4:7], v[208:211], 0
    v_mfma_f32_16x16x32_bf16 v[248:251], a[0:3], v[212:215], 0
    v_mfma_f32_16x16x32_bf16 v[252:255], a[4:7], v[212:215], 0
    ds_read_b128 v[208:211], v15 offset:4096
    ds_read_b128 v[212:215], v15 offset:24576
    s_waitcnt lgkmcnt(6)
    v_mfma_f32_16x16x32_bf16 v[240:243], a[8:11], v[216:219], v[240:243]
    v_mfma_f32_16x16x32_bf16 v[244:247], a[12:15], v[216:219], v[244:247]
    v_mfma_f32_16x16x32_bf16 v[248:251], a[8:11], v[220:223], v[248:251]
    v_mfma_f32_16x16x32_bf16 v[252:255], a[12:15], v[220:223], v[252:255]
    ds_read_b128 v[216:219], v15 offset:5120
    ds_read_b128 v[220:223], v15 offset:25600
    s_waitcnt lgkmcnt(6)
    v_mfma_f32_16x16x32_bf16 v[240:243], a[16:19], v[224:227], v[240:243]
    v_mfma_f32_16x16x32_bf16 v[244:247], a[20:23], v[224:227], v[244:247]
    v_mfma_f32_16x16x32_bf16 v[248:251], a[16:19], v[228:231], v[248:251]
    v_mfma_f32_16x16x32_bf16 v[252:255], a[20:23], v[228:231], v[252:255]
    ds_read_b128 v[224:227], v15 offset:6144
    ds_read_b128 v[228:231], v15 offset:26624
    s_waitcnt lgkmcnt(6)
    v_mfma_f32_16x16x32_bf16 v[240:243], a[24:27], v[232:235], v[240:243]
    v_mfma_f32_16x16x32_bf16 v[244:247], a[28:31], v[232:235], v[244:247]
    v_mfma_f32_16x16x32_bf16 v[248:251], a[24:27], v[236:239], v[248:251]
    v_mfma_f32_16x16x32_bf16 v[252:255], a[28:31], v[236:239], v[252:255]
    ds_read_b128 v[232:235], v15 offset:7168
    ds_read_b128 v[236:239], v15 offset:27648
    s_waitcnt lgkmcnt(6)
    v_mfma_f32_16x16x32_bf16 v[240:243], a[32:35], v[208:211], v[240:243]
    v_mfma_f32_16x16x32_bf16 v[244:247], a[36:39], v[208:211], v[244:247]
    v_mfma_f32_16x16x32_bf16 v[248:251], a[32:35], v[212:215], v[248:251]
    v_mfma_f32_16x16x32_bf16 v[252:255], a[36:39], v[212:215], v[252:255]
    ds_read_b128 v[208:211], v15 offset:8192
    ds_read_b128 v[212:215], v15 offset:28672
    s_waitcnt lgkmcnt(6)
    v_mfma_f32_16x16x32_bf16 v[240:243], a[40:43], v[216:219], v[240:243]
    v_mfma_f32_16x16x32_bf16 v[244:247], a[44:47], v[216:219], v[244:247]
    v_mfma_f32_16x16x32_bf16 v[248:251], a[40:43], v[220:223], v[248:251]
    v_mfma_f32_16x16x32_bf16 v[252:255], a[44:47], v[220:223], v[252:255]
    ds_read_b128 v[216:219], v15 offset:9216
    ds_read_b128 v[220:223], v15 offset:29696
    s_waitcnt lgkmcnt(6)
    v_mfma_f32_16x16x32_bf16 v[240:243], a[48:51], v[224:227], v[240:243]
    v_mfma_f32_16x16x32_bf16 v[244:247], a[52:55], v[224:227], v[244:247]
    v_mfma_f32_16x16x32_bf16 v[248:251], a[48:51], v[228:231], v[248:251]
    v_mfma_f32_16x16x32_bf16 v[252:255], a[52:55], v[228:231], v[252:255]
    ds_read_b128 v[224:227], v15 offset:10240
    ds_read_b128 v[228:231], v15 offset:30720
    s_waitcnt lgkmcnt(6)
    v_mfma_f32_16x16x32_bf16 v[240:243], a[56:59], v[232:235], v[240:243]
    v_mfma_f32_16x16x32_bf16 v[244:247], a[60:63], v[232:235], v[244:247]
    v_mfma_f32_16x16x32_bf16 v[248:251], a[56:59], v[236:239], v[248:251]
    v_mfma_f32_16x16x32_bf16 v[252:255], a[60:63], v[236:239], v[252:255]
    ds_read_b128 v[232:235], v15 offset:11264
    ds_read_b128 v[236:239], v15 offset:31744
    s_waitcnt lgkmcnt(6)
    v_mfma_f32_16x16x32_bf16 v[240:243], a[64:67], v[208:211], v[240:243]
    v_mfma_f32_16x16x32_bf16 v[244:247], a[68:71], v[208:211], v[244:247]
    v_mfma_f32_16x16x32_bf16 v[248:251], a[64:67], v[212:215], v[248:251]
    v_mfma_f32_16x16x32_bf16 v[252:255], a[68:71], v[212:215], v[252:255]
    ds_read_b128 v[208:211], v15 offset:12288
    ds_read_b128 v[212:215], v15 offset:32768
    s_waitcnt lgkmcnt(6)
    v_mfma_f32_16x16x32_bf16 v[240:243], a[72:75], v[216:219], v[240:243]
    v_mfma_f32_16x16x32_bf16 v[244:247], a[76:79], v[216:219], v[244:247]
    v_mfma_f32_16x16x32_bf16 v[248:251], a[72:75], v[220:223], v[248:251]
    v_mfma_f32_16x16x32_bf16 v[252:255], a[76:79], v[220:223], v[252:255]
    ds_read_b128 v[216:219], v15 offset:13312
    ds_read_b128 v[220:223], v15 offset:33792
    s_waitcnt lgkmcnt(6)
    v_mfma_f32_16x16x32_bf16 v[240:243], a[80:83], v[224:227], v[240:243]
    v_mfma_f32_16x16x32_bf16 v[244:247], a[84:87], v[224:227], v[244:247]
    v_mfma_f32_16x16x32_bf16 v[248:251], a[80:83], v[228:231], v[248:251]
    v_mfma_f32_16x16x32_bf16 v[252:255], a[84:87], v[228:231], v[252:255]
    ds_read_b128 v[224:227], v15 offset:14336
    ds_read_b128 v[228:231], v15 offset:34816
    s_waitcnt lgkmcnt(6)
    v_mfma_f32_16x16x32_bf16 v[240:243], a[88:91], v[232:235], v[240:243]
    v_mfma_f32_16x16x32_bf16 v[244:247], a[92:95], v[232:235], v[244:247]
    v_mfma_f32_16x16x32_bf16 v[248:251], a[88:91], v[236:239], v[248:251]
    v_mfma_f32_16x16x32_bf16 v[252:255], a[92:95], v[236:239], v[252:255]
    ds_read_b128 v[232:235], v15 offset:15360
    ds_read_b128 v[236:239], v15 offset:35840
    s_waitcnt lgkmcnt(6)
    v_mfma_f32_16x16x32_bf16 v[240:243], a[96:99], v[208:211], v[240:243]
    v_mfma_f32_16x16x32_bf16 v[244:247], a[100:103], v[208:211], v[244:247]
    v_mfma_f32_16x16x32_bf16 v[248:251], a[96:99], v[212:215], v[248:251]
    v_mfma_f32_16x16x32_bf16 v[252:255], a[100:103], v[212:215], v[252:255]
    ds_read_b128 v[208:211], v15 offset:16384
    ds_read_b128 v[212:215], v15 offset:36864
    s_waitcnt lgkmcnt(6)
    v_mfma_f32_16x16x32_bf16 v[240:243], a[104:107], v[216:219], v[240:243]
    v_mfma_f32_16x16x32_bf16 v[244:247], a[108:111], v[216:219], v[244:247]
    v_mfma_f32_16x16x32_bf16 v[248:251], a[104:107], v[220:223], v[248:251]
    v_mfma_f32_16x16x32_bf16 v[252:255], a[108:111], v[220:223], v[252:255]
    ds_read_b128 v[216:219], v15 offset:17408
    ds_read_b128 v[220:223], v15 offset:37888
    s_waitcnt lgkmcnt(6)
    v_mfma_f32_16x16x32_bf16 v[240:243], a[112:115], v[224:227], v[240:243]
    v_mfma_f32_16x16x32_bf16 v[244:247], a[116:119], v[224:227], v[244:247]
    v_mfma_f32_16x16x32_bf16 v[248:251], a[112:115], v[228:231], v[248:251]
    v_mfma_f32_16x16x32_bf16 v[252:255], a[116:119], v[228:231], v[252:255]
    ds_read_b128 v[224:227], v15 offset:18432
    ds_read_b128 v[228:231], v15 offset:38912
    s_waitcnt lgkmcnt(6)
    v_mfma_f32_16x16x32_bf16 v[240:243], a[120:123], v[232:235], v[240:243]
    v_mfma_f32_16x16x32_bf16 v[244:247], a[124:127], v[232:235], v[244:247]
    v_mfma_f32_16x16x32_bf16 v[248:251], a[120:123], v[236:239], v[248:251]
    v_mfma_f32_16x16x32_bf16 v[252:255], a[124:127], v[236:239], v[252:255]
    ds_read_b128 v[232:235], v15 offset:19456
    ds_read_b128 v[236:239], v15 offset:39936
    s_waitcnt lgkmcnt(6)
    v_mfma_f32_16x16x32_bf16 v[240:243], a[128:131], v[208:211], v[240:243]
    v_mfma_f32_16x16x32_bf16 v[244:247], a[132:135], v[208:211], v[244:247]
    v_mfma_f32_16x16x32_bf16 v[248:251], a[128:131], v[212:215], v[248:251]
    v_mfma_f32_16x16x32_bf16 v[252:255], a[132:135], v[212:215], v[252:255]
    s_waitcnt lgkmcnt(4)
    v_mfma_f32_16x16x32_bf16 v[240:243], a[136:139], v[216:219], v[240:243]
    v_mfma_f32_16x16x32_bf16 v[244:247], a[140:143], v[216:219], v[244:247]
    v_mfma_f32_16x16x32_bf16 v[248:251], a[136:139], v[220:223], v[248:251]
    v_mfma_f32_16x16x32_bf16 v[252:255], a[140:143], v[220:223], v[252:255]
    s_waitcnt lgkmcnt(2)
    v_mfma_f32_16x16x32_bf16 v[240:243], a[144:147], v[224:227], v[240:243]
    v_mfma_f32_16x16x32_bf16 v[244:247], a[148:151], v[224:227], v[244:247]
    v_mfma_f32_16x16x32_bf16 v[248:251], a[144:147], v[228:231], v[248:251]
    v_mfma_f32_16x16x32_bf16 v[252:255], a[148:151], v[228:231], v[252:255]
    s_waitcnt lgkmcnt(0)
    v_mfma_f32_16x16x32_bf16 v[240:243], a[152:155], v[232:235], v[240:243]
    v_mfma_f32_16x16x32_bf16 v[244:247], a[156:159], v[232:235], v[244:247]
    v_mfma_f32_16x16x32_bf16 v[248:251], a[152:155], v[236:239], v[248:251]
    v_mfma_f32_16x16x32_bf16 v[252:255], a[156:159], v[236:239], v[252:255]
    s_nop 4
    v_cvt_pk_bf16_f32 v208, v240, v241
    v_cvt_pk_bf16_f32 v209, v242, v243
    v_lshlrev_b32 v210, 16, v208
    v_and_b32 v211, 0xffff0000, v208
    v_lshlrev_b32 v212, 16, v96
    v_and_b32 v213, 0xffff0000, v96
    v_pk_add_f32 v[210:211], v[210:211], v[212:213]
    v_cvt_pk_bf16_f32 v216, v210, v211
    v_lshlrev_b32 v210, 16, v209
    v_and_b32 v211, 0xffff0000, v209
    v_lshlrev_b32 v212, 16, v97
    v_and_b32 v213, 0xffff0000, v97
    v_pk_add_f32 v[210:211], v[210:211], v[212:213]
    v_cvt_pk_bf16_f32 v217, v210, v211
    v_cvt_pk_bf16_f32 v208, v244, v245
    v_cvt_pk_bf16_f32 v209, v246, v247
    v_lshlrev_b32 v210, 16, v208
    v_and_b32 v211, 0xffff0000, v208
    v_lshlrev_b32 v212, 16, v98
    v_and_b32 v213, 0xffff0000, v98
    v_pk_add_f32 v[210:211], v[210:211], v[212:213]
    v_cvt_pk_bf16_f32 v218, v210, v211
    v_lshlrev_b32 v210, 16, v209
    v_and_b32 v211, 0xffff0000, v209
    v_lshlrev_b32 v212, 16, v99
    v_and_b32 v213, 0xffff0000, v99
    v_pk_add_f32 v[210:211], v[210:211], v[212:213]
    v_cvt_pk_bf16_f32 v219, v210, v211
    v_cvt_pk_bf16_f32 v208, v248, v249
    v_cvt_pk_bf16_f32 v209, v250, v251
    v_lshlrev_b32 v210, 16, v208
    v_and_b32 v211, 0xffff0000, v208
    v_lshlrev_b32 v212, 16, v100
    v_and_b32 v213, 0xffff0000, v100
    v_pk_add_f32 v[210:211], v[210:211], v[212:213]
    v_cvt_pk_bf16_f32 v220, v210, v211
    v_lshlrev_b32 v210, 16, v209
    v_and_b32 v211, 0xffff0000, v209
    v_lshlrev_b32 v212, 16, v101
    v_and_b32 v213, 0xffff0000, v101
    v_pk_add_f32 v[210:211], v[210:211], v[212:213]
    v_cvt_pk_bf16_f32 v221, v210, v211
    v_cvt_pk_bf16_f32 v208, v252, v253
    v_cvt_pk_bf16_f32 v209, v254, v255
    v_lshlrev_b32 v210, 16, v208
    v_and_b32 v211, 0xffff0000, v208
    v_lshlrev_b32 v212, 16, v102
    v_and_b32 v213, 0xffff0000, v102
    v_pk_add_f32 v[210:211], v[210:211], v[212:213]
    v_cvt_pk_bf16_f32 v222, v210, v211
    v_lshlrev_b32 v210, 16, v209
    v_and_b32 v211, 0xffff0000, v209
    v_lshlrev_b32 v212, 16, v103
    v_and_b32 v213, 0xffff0000, v103
    v_pk_add_f32 v[210:211], v[210:211], v[212:213]
    v_cvt_pk_bf16_f32 v223, v210, v211
    s_add_u32 s25, s43, 20480
    buffer_store_dwordx4 v[216:219], v12, s[8:11], s43 offen sc1
    buffer_store_dwordx4 v[220:223], v12, s[8:11], s25 offen sc1
    s_add_u32 s40, s40, 1
    s_add_u32 s43, s43, s77
    s_cmp_ge_u32 s40, s76
    s_cbranch_scc1 interleave_layers__linear_attn_block__memory_aug_recurrent_mem_tr__prompt_kernel_k3_done
    s_cmp_eq_u32 s40, 1
    s_cbranch_scc0 interleave_layers__linear_attn_block__memory_aug_recurrent_mem_tr__prompt_kernel_k3q9
    s_waitcnt vmcnt(0)
    s_barrier
    s_lshl_b32 s24, s92, 10
    s_lshl_b32 s25, s78, 2
    s_add_u32 s24, s24, s25
    s_add_u32 s24, s24, 23105536
    s_cmp_eq_u32 s3, 0
    s_cbranch_scc0 interleave_layers__linear_attn_block__memory_aug_recurrent_mem_tr__prompt_kernel_pb10
    v_lshlrev_b32 v14, 7, v1
    v_add_u32 v14, s24, v14
    v_mov_b32 v15, 2146435072
    v_cmp_le_u32 vcc, 8, v1
    s_nop 1
    v_cndmask_b32 v14, v14, v15, vcc
    v_mov_b32 v15, s40
    buffer_store_dword v15, v14, s[8:11], 0 offen sc1
interleave_layers__linear_attn_block__memory_aug_recurrent_mem_tr__prompt_kernel_pb10:
interleave_layers__linear_attn_block__memory_aug_recurrent_mem_tr__prompt_kernel_k3q9:
    s_xor_b32 s42, s42, 40960
    s_waitcnt vmcnt(2)
    v_mfma_f32_16x16x32_bf16 v[132:135], a[192:195], v[56:59], 0
    v_mfma_f32_16x16x32_bf16 v[136:139], a[202:205], v[60:63], 0
    v_mfma_f32_16x16x32_bf16 v[112:115], a[160:163], v[56:59], 0
    v_mfma_f32_16x16x32_bf16 v[116:119], a[164:167], v[56:59], 0
    v_mfma_f32_16x16x32_bf16 v[120:123], a[172:175], v[56:59], 0
    v_mfma_f32_16x16x32_bf16 v[124:127], a[180:183], v[60:63], 0
    v_mfma_f32_16x16x32_bf16 v[128:131], a[186:189], v[60:63], 0
    v_mfma_f32_16x16x32_bf16 v[132:135], a[196:199], v[60:63], v[132:135]
    v_mfma_f32_16x16x32_bf16 v[116:119], a[168:171], v[60:63], v[116:119]
    v_mfma_f32_16x16x32_bf16 v[120:123], a[176:179], v[60:63], v[120:123]
    v_mfma_f32_16x16x16_bf16 v[136:139], a[206:207], v[64:65], v[136:139]
    s_nop 0
    v_mfma_f32_16x16x16_bf16 v[124:127], a[184:185], v[64:65], v[124:127]
    v_mfma_f32_16x16x16_bf16 v[128:131], a[190:191], v[64:65], v[128:131]
    v_mfma_f32_16x16x16_bf16 v[132:135], a[200:201], v[64:65], v[132:135]
    v_mfma_f32_16x16x32_bf16 v[160:163], a[240:243], v[66:69], 0
    v_mfma_f32_16x16x32_bf16 v[164:167], a[250:253], v[70:73], 0
    v_mfma_f32_16x16x32_bf16 v[140:143], a[208:211], v[66:69], 0
    v_mfma_f32_16x16x32_bf16 v[144:147], a[212:215], v[66:69], 0
    v_mfma_f32_16x16x32_bf16 v[148:151], a[220:223], v[66:69], 0
    v_mfma_f32_16x16x32_bf16 v[152:155], a[228:231], v[70:73], 0
    v_mfma_f32_16x16x32_bf16 v[156:159], a[234:237], v[70:73], 0
    v_mfma_f32_16x16x32_bf16 v[160:163], a[244:247], v[70:73], v[160:163]
    v_mfma_f32_16x16x32_bf16 v[144:147], a[216:219], v[70:73], v[144:147]
    v_mfma_f32_16x16x32_bf16 v[148:151], a[224:227], v[70:73], v[148:151]
    v_mfma_f32_16x16x16_bf16 v[164:167], a[254:255], v[74:75], v[164:167]
    s_nop 0
    v_mfma_f32_16x16x16_bf16 v[152:155], a[232:233], v[74:75], v[152:155]
    v_mfma_f32_16x16x16_bf16 v[156:159], a[238:239], v[74:75], v[156:159]
    v_mfma_f32_16x16x16_bf16 v[160:163], a[248:249], v[74:75], v[160:163]
    v_add_f32 v132, s54, v132
    v_add_f32 v133, s54, v133
    v_add_f32 v134, s54, v134
    v_add_f32 v135, s54, v135
    v_add_f32 v136, s54, v136
    v_rcp_f32 v132, v132
    v_rcp_f32 v133, v133
    v_rcp_f32 v134, v134
    v_rcp_f32 v135, v135
    v_rcp_f32 v136, v136
    v_mul_f32 v112, v112, v132
    v_mul_f32 v113, v113, v132
    v_mul_f32 v114, v114, v132
    v_mul_f32 v115, v115, v132
    v_cvt_pk_bf16_f32 v168, v112, v113
    v_cvt_pk_bf16_f32 v169, v114, v115
    v_mul_f32 v116, v116, v133
    v_mul_f32 v117, v117, v133
    v_mul_f32 v118, v118, v133
    v_mul_f32 v119, v119, v133
    v_cvt_pk_bf16_f32 v170, v116, v117
    v_cvt_pk_bf16_f32 v171, v118, v119
    v_mul_f32 v120, v120, v134
    v_mul_f32 v121, v121, v134
    v_mul_f32 v122, v122, v134
    v_mul_f32 v123, v123, v134
    v_cvt_pk_bf16_f32 v172, v120, v121
    v_cvt_pk_bf16_f32 v173, v122, v123
    v_mul_f32 v124, v124, v135
    v_mul_f32 v125, v125, v135
    v_mul_f32 v126, v126, v135
    v_mul_f32 v127, v127, v135
    v_cvt_pk_bf16_f32 v174, v124, v125
    v_cvt_pk_bf16_f32 v175, v126, v127
    v_mul_f32 v128, v128, v136
    v_mul_f32 v129, v129, v136
    v_mul_f32 v130, v130, v136
    v_mul_f32 v131, v131, v136
    v_cvt_pk_bf16_f32 v176, v128, v129
    v_cvt_pk_bf16_f32 v177, v130, v131
    v_add_f32 v160, s54, v160
    v_add_f32 v161, s54, v161
    v_add_f32 v162, s54, v162
    v_add_f32 v163, s54, v163
    v_add_f32 v164, s54, v164
    v_rcp_f32 v160, v160
    v_rcp_f32 v161, v161
    v_rcp_f32 v162, v162
    v_rcp_f32 v163, v163
    v_rcp_f32 v164, v164
    v_mul_f32 v140, v140, v160
    v_mul_f32 v141, v141, v160
    v_mul_f32 v142, v142, v160
    v_mul_f32 v143, v143, v160
    v_cvt_pk_bf16_f32 v178, v140, v141
    v_cvt_pk_bf16_f32 v179, v142, v143
    v_mul_f32 v144, v144, v161
    v_mul_f32 v145, v145, v161
    v_mul_f32 v146, v146, v161
    v_mul_f32 v147, v147, v161
    v_cvt_pk_bf16_f32 v180, v144, v145
    v_cvt_pk_bf16_f32 v181, v146, v147
    v_mul_f32 v148, v148, v162
    v_mul_f32 v149, v149, v162
    v_mul_f32 v150, v150, v162
    v_mul_f32 v151, v151, v162
    v_cvt_pk_bf16_f32 v182, v148, v149
    v_cvt_pk_bf16_f32 v183, v150, v151
    v_mul_f32 v152, v152, v163
    v_mul_f32 v153, v153, v163
    v_mul_f32 v154, v154, v163
    v_mul_f32 v155, v155, v163
    v_cvt_pk_bf16_f32 v184, v152, v153
    v_cvt_pk_bf16_f32 v185, v154, v155
    v_mul_f32 v156, v156, v164
    v_mul_f32 v157, v157, v164
    v_mul_f32 v158, v158, v164
    v_mul_f32 v159, v159, v164
    v_cvt_pk_bf16_f32 v186, v156, v157
    v_cvt_pk_bf16_f32 v187, v158, v159
    v_mfma_f32_16x16x32_bf16 v[132:135], a[192:195], v[76:79], 0
    v_mfma_f32_16x16x32_bf16 v[136:139], a[202:205], v[80:83], 0
    v_mfma_f32_16x16x32_bf16 v[112:115], a[160:163], v[76:79], 0
    v_mfma_f32_16x16x32_bf16 v[116:119], a[164:167], v[76:79], 0
    v_mfma_f32_16x16x32_bf16 v[120:123], a[172:175], v[76:79], 0
    v_mfma_f32_16x16x32_bf16 v[124:127], a[180:183], v[80:83], 0
    v_mfma_f32_16x16x32_bf16 v[128:131], a[186:189], v[80:83], 0
    v_mfma_f32_16x16x32_bf16 v[132:135], a[196:199], v[80:83], v[132:135]
    v_mfma_f32_16x16x32_bf16 v[116:119], a[168:171], v[80:83], v[116:119]
    v_mfma_f32_16x16x32_bf16 v[120:123], a[176:179], v[80:83], v[120:123]
    v_mfma_f32_16x16x16_bf16 v[136:139], a[206:207], v[84:85], v[136:139]
    s_nop 0
    v_mfma_f32_16x16x16_bf16 v[124:127], a[184:185], v[84:85], v[124:127]
    v_mfma_f32_16x16x16_bf16 v[128:131], a[190:191], v[84:85], v[128:131]
    v_mfma_f32_16x16x16_bf16 v[132:135], a[200:201], v[84:85], v[132:135]
    v_mfma_f32_16x16x32_bf16 v[160:163], a[240:243], v[86:89], 0
    v_mfma_f32_16x16x32_bf16 v[164:167], a[250:253], v[90:93], 0
    v_mfma_f32_16x16x32_bf16 v[140:143], a[208:211], v[86:89], 0
    v_mfma_f32_16x16x32_bf16 v[144:147], a[212:215], v[86:89], 0
    v_mfma_f32_16x16x32_bf16 v[148:151], a[220:223], v[86:89], 0
    v_mfma_f32_16x16x32_bf16 v[152:155], a[228:231], v[90:93], 0
    v_mfma_f32_16x16x32_bf16 v[156:159], a[234:237], v[90:93], 0
    v_mfma_f32_16x16x32_bf16 v[160:163], a[244:247], v[90:93], v[160:163]
    v_mfma_f32_16x16x32_bf16 v[144:147], a[216:219], v[90:93], v[144:147]
    v_mfma_f32_16x16x32_bf16 v[148:151], a[224:227], v[90:93], v[148:151]
    v_mfma_f32_16x16x16_bf16 v[164:167], a[254:255], v[94:95], v[164:167]
    s_nop 0
    v_mfma_f32_16x16x16_bf16 v[152:155], a[232:233], v[94:95], v[152:155]
    v_mfma_f32_16x16x16_bf16 v[156:159], a[238:239], v[94:95], v[156:159]
    v_mfma_f32_16x16x16_bf16 v[160:163], a[248:249], v[94:95], v[160:163]
    v_add_f32 v132, s54, v132
    v_add_f32 v133, s54, v133
    v_add_f32 v134, s54, v134
    v_add_f32 v135, s54, v135
    v_add_f32 v136, s54, v136
    v_rcp_f32 v132, v132
    v_rcp_f32 v133, v133
    v_rcp_f32 v134, v134
    v_rcp_f32 v135, v135
    v_rcp_f32 v136, v136
    v_mul_f32 v112, v112, v132
    v_mul_f32 v113, v113, v132
    v_mul_f32 v114, v114, v132
    v_mul_f32 v115, v115, v132
    v_cvt_pk_bf16_f32 v188, v112, v113
    v_cvt_pk_bf16_f32 v189, v114, v115
    v_mul_f32 v116, v116, v133
    v_mul_f32 v117, v117, v133
    v_mul_f32 v118, v118, v133
    v_mul_f32 v119, v119, v133
    v_cvt_pk_bf16_f32 v190, v116, v117
    v_cvt_pk_bf16_f32 v191, v118, v119
    v_mul_f32 v120, v120, v134
    v_mul_f32 v121, v121, v134
    v_mul_f32 v122, v122, v134
    v_mul_f32 v123, v123, v134
    v_cvt_pk_bf16_f32 v192, v120, v121
    v_cvt_pk_bf16_f32 v193, v122, v123
    v_mul_f32 v124, v124, v135
    v_mul_f32 v125, v125, v135
    v_mul_f32 v126, v126, v135
    v_mul_f32 v127, v127, v135
    v_cvt_pk_bf16_f32 v194, v124, v125
    v_cvt_pk_bf16_f32 v195, v126, v127
    v_mul_f32 v128, v128, v136
    v_mul_f32 v129, v129, v136
    v_mul_f32 v130, v130, v136
    v_mul_f32 v131, v131, v136
    v_cvt_pk_bf16_f32 v196, v128, v129
    v_cvt_pk_bf16_f32 v197, v130, v131
    v_add_f32 v160, s54, v160
    v_add_f32 v161, s54, v161
    v_add_f32 v162, s54, v162
    v_add_f32 v163, s54, v163
    v_add_f32 v164, s54, v164
    v_rcp_f32 v160, v160
    v_rcp_f32 v161, v161
    v_rcp_f32 v162, v162
    v_rcp_f32 v163, v163
    v_rcp_f32 v164, v164
    v_mul_f32 v140, v140, v160
    v_mul_f32 v141, v141, v160
    v_mul_f32 v142, v142, v160
    v_mul_f32 v143, v143, v160
    v_cvt_pk_bf16_f32 v198, v140, v141
    v_cvt_pk_bf16_f32 v199, v142, v143
    v_mul_f32 v144, v144, v161
    v_mul_f32 v145, v145, v161
    v_mul_f32 v146, v146, v161
    v_mul_f32 v147, v147, v161
    v_cvt_pk_bf16_f32 v200, v144, v145
    v_cvt_pk_bf16_f32 v201, v146, v147
    v_mul_f32 v148, v148, v162
    v_mul_f32 v149, v149, v162
    v_mul_f32 v150, v150, v162
    v_mul_f32 v151, v151, v162
    v_cvt_pk_bf16_f32 v202, v148, v149
    v_cvt_pk_bf16_f32 v203, v150, v151
    v_mul_f32 v152, v152, v163
    v_mul_f32 v153, v153, v163
    v_mul_f32 v154, v154, v163
    v_mul_f32 v155, v155, v163
    v_cvt_pk_bf16_f32 v204, v152, v153
    v_cvt_pk_bf16_f32 v205, v154, v155
    v_mul_f32 v156, v156, v164
    v_mul_f32 v157, v157, v164
    v_mul_f32 v158, v158, v164
    v_mul_f32 v159, v159, v164
    v_cvt_pk_bf16_f32 v206, v156, v157
    v_cvt_pk_bf16_f32 v207, v158, v159
    v_add_u32 v14, s42, v13
    ds_write_b128 v14, v[168:171] offset:0
    ds_write_b128 v14, v[172:175] offset:1024
    ds_write_b128 v14, v[176:179] offset:2048
    ds_write_b128 v14, v[180:183] offset:3072
    ds_write_b128 v14, v[184:187] offset:4096
    ds_write_b128 v14, v[188:191] offset:20480
    ds_write_b128 v14, v[192:195] offset:21504
    ds_write_b128 v14, v[196:199] offset:22528
    ds_write_b128 v14, v[200:203] offset:23552
    ds_write_b128 v14, v[204:207] offset:24576
    s_add_u32 s41, s43, s77
    s_add_u32 s24, s40, 1
    s_cmp_lt_u32 s24, s76
    s_cselect_b32 s41, s41, 2146435072
    s_waitcnt vmcnt(0)
    s_add_u32 s25, s41, 20480
    buffer_load_dwordx4 v[16:19], v8, s[8:11], s41 offen offset:0 sc1
    buffer_load_dwordx4 v[20:23], v8, s[8:11], s41 offen offset:1024 sc1
    buffer_load_dwordx2 v[24:25], v9, s[8:11], s41 offen offset:0 sc1
    buffer_load_dwordx4 v[26:29], v8, s[8:11], s41 offen offset:2560 sc1
    buffer_load_dwordx4 v[30:33], v8, s[8:11], s41 offen offset:3584 sc1
    buffer_load_dwordx2 v[34:35], v9, s[8:11], s41 offen offset:2560 sc1
    buffer_load_dwordx4 v[36:39], v8, s[8:11], s25 offen offset:0 sc1
    buffer_load_dwordx4 v[40:43], v8, s[8:11], s25 offen offset:1024 sc1
    buffer_load_dwordx2 v[44:45], v9, s[8:11], s25 offen offset:0 sc1
    buffer_load_dwordx4 v[46:49], v8, s[8:11], s25 offen offset:2560 sc1
    buffer_load_dwordx4 v[50:53], v8, s[8:11], s25 offen offset:3584 sc1
    buffer_load_dwordx2 v[54:55], v9, s[8:11], s25 offen offset:2560 sc1
    buffer_load_dwordx2 v[96:97], v10, s[16:19], s41 offen sc1
    buffer_load_dwordx2 v[98:99], v11, s[16:19], s41 offen sc1
    buffer_load_dwordx2 v[100:101], v10, s[16:19], s25 offen sc1
    buffer_load_dwordx2 v[102:103], v11, s[16:19], s25 offen sc1
    s_waitcnt lgkmcnt(0)
    s_barrier
    s_lshl_b32 s24, s92, 10
    s_lshl_b32 s25, s78, 2
    s_add_u32 s24, s24, s25
    s_add_u32 s24, s24, 23105536
    s_cmp_eq_u32 s3, 0
    s_cbranch_scc0 interleave_layers__linear_attn_block__memory_aug_recurrent_mem_tr__prompt_kernel_pb11
    v_lshlrev_b32 v14, 7, v1
    v_add_u32 v14, s24, v14
    v_mov_b32 v15, 2146435072
    v_cmp_le_u32 vcc, 8, v1
    s_nop 1
    v_cndmask_b32 v14, v14, v15, vcc
    v_mov_b32 v15, s40
    buffer_store_dword v15, v14, s[8:11], 0 offen sc1
interleave_layers__linear_attn_block__memory_aug_recurrent_mem_tr__prompt_kernel_pb11:
    v_add_u32 v15, s42, v5
    ds_read_b128 v[208:211], v15 offset:0
    ds_read_b128 v[212:215], v15 offset:20480
    ds_read_b128 v[216:219], v15 offset:1024
    ds_read_b128 v[220:223], v15 offset:21504
    ds_read_b128 v[224:227], v15 offset:2048
    ds_read_b128 v[228:231], v15 offset:22528
    ds_read_b128 v[232:235], v15 offset:3072
    ds_read_b128 v[236:239], v15 offset:23552
    s_waitcnt lgkmcnt(6)
    v_mfma_f32_16x16x32_bf16 v[240:243], a[0:3], v[208:211], 0
    v_mfma_f32_16x16x32_bf16 v[244:247], a[4:7], v[208:211], 0
    v_mfma_f32_16x16x32_bf16 v[248:251], a[0:3], v[212:215], 0
    v_mfma_f32_16x16x32_bf16 v[252:255], a[4:7], v[212:215], 0
    ds_read_b128 v[208:211], v15 offset:4096
    ds_read_b128 v[212:215], v15 offset:24576
    s_waitcnt lgkmcnt(6)
    v_mfma_f32_16x16x32_bf16 v[240:243], a[8:11], v[216:219], v[240:243]
    v_mfma_f32_16x16x32_bf16 v[244:247], a[12:15], v[216:219], v[244:247]
    v_mfma_f32_16x16x32_bf16 v[248:251], a[8:11], v[220:223], v[248:251]
    v_mfma_f32_16x16x32_bf16 v[252:255], a[12:15], v[220:223], v[252:255]
    ds_read_b128 v[216:219], v15 offset:5120
    ds_read_b128 v[220:223], v15 offset:25600
    s_waitcnt lgkmcnt(6)
    v_mfma_f32_16x16x32_bf16 v[240:243], a[16:19], v[224:227], v[240:243]
    v_mfma_f32_16x16x32_bf16 v[244:247], a[20:23], v[224:227], v[244:247]
    v_mfma_f32_16x16x32_bf16 v[248:251], a[16:19], v[228:231], v[248:251]
    v_mfma_f32_16x16x32_bf16 v[252:255], a[20:23], v[228:231], v[252:255]
    ds_read_b128 v[224:227], v15 offset:6144
    ds_read_b128 v[228:231], v15 offset:26624
    s_waitcnt lgkmcnt(6)
    v_mfma_f32_16x16x32_bf16 v[240:243], a[24:27], v[232:235], v[240:243]
    v_mfma_f32_16x16x32_bf16 v[244:247], a[28:31], v[232:235], v[244:247]
    v_mfma_f32_16x16x32_bf16 v[248:251], a[24:27], v[236:239], v[248:251]
    v_mfma_f32_16x16x32_bf16 v[252:255], a[28:31], v[236:239], v[252:255]
    ds_read_b128 v[232:235], v15 offset:7168
    ds_read_b128 v[236:239], v15 offset:27648
    s_waitcnt lgkmcnt(6)
    v_mfma_f32_16x16x32_bf16 v[240:243], a[32:35], v[208:211], v[240:243]
    v_mfma_f32_16x16x32_bf16 v[244:247], a[36:39], v[208:211], v[244:247]
    v_mfma_f32_16x16x32_bf16 v[248:251], a[32:35], v[212:215], v[248:251]
    v_mfma_f32_16x16x32_bf16 v[252:255], a[36:39], v[212:215], v[252:255]
    ds_read_b128 v[208:211], v15 offset:8192
    ds_read_b128 v[212:215], v15 offset:28672
    s_waitcnt lgkmcnt(6)
    v_mfma_f32_16x16x32_bf16 v[240:243], a[40:43], v[216:219], v[240:243]
    v_mfma_f32_16x16x32_bf16 v[244:247], a[44:47], v[216:219], v[244:247]
    v_mfma_f32_16x16x32_bf16 v[248:251], a[40:43], v[220:223], v[248:251]
    v_mfma_f32_16x16x32_bf16 v[252:255], a[44:47], v[220:223], v[252:255]
    ds_read_b128 v[216:219], v15 offset:9216
    ds_read_b128 v[220:223], v15 offset:29696
    s_waitcnt lgkmcnt(6)
    v_mfma_f32_16x16x32_bf16 v[240:243], a[48:51], v[224:227], v[240:243]
    v_mfma_f32_16x16x32_bf16 v[244:247], a[52:55], v[224:227], v[244:247]
    v_mfma_f32_16x16x32_bf16 v[248:251], a[48:51], v[228:231], v[248:251]
    v_mfma_f32_16x16x32_bf16 v[252:255], a[52:55], v[228:231], v[252:255]
    ds_read_b128 v[224:227], v15 offset:10240
    ds_read_b128 v[228:231], v15 offset:30720
    s_waitcnt lgkmcnt(6)
    v_mfma_f32_16x16x32_bf16 v[240:243], a[56:59], v[232:235], v[240:243]
    v_mfma_f32_16x16x32_bf16 v[244:247], a[60:63], v[232:235], v[244:247]
    v_mfma_f32_16x16x32_bf16 v[248:251], a[56:59], v[236:239], v[248:251]
    v_mfma_f32_16x16x32_bf16 v[252:255], a[60:63], v[236:239], v[252:255]
    ds_read_b128 v[232:235], v15 offset:11264
    ds_read_b128 v[236:239], v15 offset:31744
    s_waitcnt lgkmcnt(6)
    v_mfma_f32_16x16x32_bf16 v[240:243], a[64:67], v[208:211], v[240:243]
    v_mfma_f32_16x16x32_bf16 v[244:247], a[68:71], v[208:211], v[244:247]
    v_mfma_f32_16x16x32_bf16 v[248:251], a[64:67], v[212:215], v[248:251]
    v_mfma_f32_16x16x32_bf16 v[252:255], a[68:71], v[212:215], v[252:255]
    ds_read_b128 v[208:211], v15 offset:12288
    ds_read_b128 v[212:215], v15 offset:32768
    s_waitcnt lgkmcnt(6)
    v_mfma_f32_16x16x32_bf16 v[240:243], a[72:75], v[216:219], v[240:243]
    v_mfma_f32_16x16x32_bf16 v[244:247], a[76:79], v[216:219], v[244:247]
    v_mfma_f32_16x16x32_bf16 v[248:251], a[72:75], v[220:223], v[248:251]
    v_mfma_f32_16x16x32_bf16 v[252:255], a[76:79], v[220:223], v[252:255]
    ds_read_b128 v[216:219], v15 offset:13312
    ds_read_b128 v[220:223], v15 offset:33792
    s_waitcnt lgkmcnt(6)
    v_mfma_f32_16x16x32_bf16 v[240:243], a[80:83], v[224:227], v[240:243]
    v_mfma_f32_16x16x32_bf16 v[244:247], a[84:87], v[224:227], v[244:247]
    v_mfma_f32_16x16x32_bf16 v[248:251], a[80:83], v[228:231], v[248:251]
    v_mfma_f32_16x16x32_bf16 v[252:255], a[84:87], v[228:231], v[252:255]
    ds_read_b128 v[224:227], v15 offset:14336
    ds_read_b128 v[228:231], v15 offset:34816
    s_waitcnt lgkmcnt(6)
    v_mfma_f32_16x16x32_bf16 v[240:243], a[88:91], v[232:235], v[240:243]
    v_mfma_f32_16x16x32_bf16 v[244:247], a[92:95], v[232:235], v[244:247]
    v_mfma_f32_16x16x32_bf16 v[248:251], a[88:91], v[236:239], v[248:251]
    v_mfma_f32_16x16x32_bf16 v[252:255], a[92:95], v[236:239], v[252:255]
    ds_read_b128 v[232:235], v15 offset:15360
    ds_read_b128 v[236:239], v15 offset:35840
    s_waitcnt lgkmcnt(6)
    v_mfma_f32_16x16x32_bf16 v[240:243], a[96:99], v[208:211], v[240:243]
    v_mfma_f32_16x16x32_bf16 v[244:247], a[100:103], v[208:211], v[244:247]
    v_mfma_f32_16x16x32_bf16 v[248:251], a[96:99], v[212:215], v[248:251]
    v_mfma_f32_16x16x32_bf16 v[252:255], a[100:103], v[212:215], v[252:255]
    ds_read_b128 v[208:211], v15 offset:16384
    ds_read_b128 v[212:215], v15 offset:36864
    s_waitcnt lgkmcnt(6)
    v_mfma_f32_16x16x32_bf16 v[240:243], a[104:107], v[216:219], v[240:243]
    v_mfma_f32_16x16x32_bf16 v[244:247], a[108:111], v[216:219], v[244:247]
    v_mfma_f32_16x16x32_bf16 v[248:251], a[104:107], v[220:223], v[248:251]
    v_mfma_f32_16x16x32_bf16 v[252:255], a[108:111], v[220:223], v[252:255]
    ds_read_b128 v[216:219], v15 offset:17408
    ds_read_b128 v[220:223], v15 offset:37888
    s_waitcnt lgkmcnt(6)
    v_mfma_f32_16x16x32_bf16 v[240:243], a[112:115], v[224:227], v[240:243]
    v_mfma_f32_16x16x32_bf16 v[244:247], a[116:119], v[224:227], v[244:247]
    v_mfma_f32_16x16x32_bf16 v[248:251], a[112:115], v[228:231], v[248:251]
    v_mfma_f32_16x16x32_bf16 v[252:255], a[116:119], v[228:231], v[252:255]
    ds_read_b128 v[224:227], v15 offset:18432
    ds_read_b128 v[228:231], v15 offset:38912
    s_waitcnt lgkmcnt(6)
    v_mfma_f32_16x16x32_bf16 v[240:243], a[120:123], v[232:235], v[240:243]
    v_mfma_f32_16x16x32_bf16 v[244:247], a[124:127], v[232:235], v[244:247]
    v_mfma_f32_16x16x32_bf16 v[248:251], a[120:123], v[236:239], v[248:251]
    v_mfma_f32_16x16x32_bf16 v[252:255], a[124:127], v[236:239], v[252:255]
    ds_read_b128 v[232:235], v15 offset:19456
    ds_read_b128 v[236:239], v15 offset:39936
    s_waitcnt lgkmcnt(6)
    v_mfma_f32_16x16x32_bf16 v[240:243], a[128:131], v[208:211], v[240:243]
    v_mfma_f32_16x16x32_bf16 v[244:247], a[132:135], v[208:211], v[244:247]
    v_mfma_f32_16x16x32_bf16 v[248:251], a[128:131], v[212:215], v[248:251]
    v_mfma_f32_16x16x32_bf16 v[252:255], a[132:135], v[212:215], v[252:255]
    s_waitcnt lgkmcnt(4)
    v_mfma_f32_16x16x32_bf16 v[240:243], a[136:139], v[216:219], v[240:243]
    v_mfma_f32_16x16x32_bf16 v[244:247], a[140:143], v[216:219], v[244:247]
    v_mfma_f32_16x16x32_bf16 v[248:251], a[136:139], v[220:223], v[248:251]
    v_mfma_f32_16x16x32_bf16 v[252:255], a[140:143], v[220:223], v[252:255]
    s_waitcnt lgkmcnt(2)
    v_mfma_f32_16x16x32_bf16 v[240:243], a[144:147], v[224:227], v[240:243]
    v_mfma_f32_16x16x32_bf16 v[244:247], a[148:151], v[224:227], v[244:247]
    v_mfma_f32_16x16x32_bf16 v[248:251], a[144:147], v[228:231], v[248:251]
    v_mfma_f32_16x16x32_bf16 v[252:255], a[148:151], v[228:231], v[252:255]
    s_waitcnt lgkmcnt(0)
    v_mfma_f32_16x16x32_bf16 v[240:243], a[152:155], v[232:235], v[240:243]
    v_mfma_f32_16x16x32_bf16 v[244:247], a[156:159], v[232:235], v[244:247]
    v_mfma_f32_16x16x32_bf16 v[248:251], a[152:155], v[236:239], v[248:251]
    v_mfma_f32_16x16x32_bf16 v[252:255], a[156:159], v[236:239], v[252:255]
    s_nop 4
    v_cvt_pk_bf16_f32 v208, v240, v241
    v_cvt_pk_bf16_f32 v209, v242, v243
    v_lshlrev_b32 v210, 16, v208
    v_and_b32 v211, 0xffff0000, v208
    v_lshlrev_b32 v212, 16, v104
    v_and_b32 v213, 0xffff0000, v104
    v_pk_add_f32 v[210:211], v[210:211], v[212:213]
    v_cvt_pk_bf16_f32 v216, v210, v211
    v_lshlrev_b32 v210, 16, v209
    v_and_b32 v211, 0xffff0000, v209
    v_lshlrev_b32 v212, 16, v105
    v_and_b32 v213, 0xffff0000, v105
    v_pk_add_f32 v[210:211], v[210:211], v[212:213]
    v_cvt_pk_bf16_f32 v217, v210, v211
    v_cvt_pk_bf16_f32 v208, v244, v245
    v_cvt_pk_bf16_f32 v209, v246, v247
    v_lshlrev_b32 v210, 16, v208
    v_and_b32 v211, 0xffff0000, v208
    v_lshlrev_b32 v212, 16, v106
    v_and_b32 v213, 0xffff0000, v106
    v_pk_add_f32 v[210:211], v[210:211], v[212:213]
    v_cvt_pk_bf16_f32 v218, v210, v211
    v_lshlrev_b32 v210, 16, v209
    v_and_b32 v211, 0xffff0000, v209
    v_lshlrev_b32 v212, 16, v107
    v_and_b32 v213, 0xffff0000, v107
    v_pk_add_f32 v[210:211], v[210:211], v[212:213]
    v_cvt_pk_bf16_f32 v219, v210, v211
    v_cvt_pk_bf16_f32 v208, v248, v249
    v_cvt_pk_bf16_f32 v209, v250, v251
    v_lshlrev_b32 v210, 16, v208
    v_and_b32 v211, 0xffff0000, v208
    v_lshlrev_b32 v212, 16, v108
    v_and_b32 v213, 0xffff0000, v108
    v_pk_add_f32 v[210:211], v[210:211], v[212:213]
    v_cvt_pk_bf16_f32 v220, v210, v211
    v_lshlrev_b32 v210, 16, v209
    v_and_b32 v211, 0xffff0000, v209
    v_lshlrev_b32 v212, 16, v109
    v_and_b32 v213, 0xffff0000, v109
    v_pk_add_f32 v[210:211], v[210:211], v[212:213]
    v_cvt_pk_bf16_f32 v221, v210, v211
    v_cvt_pk_bf16_f32 v208, v252, v253
    v_cvt_pk_bf16_f32 v209, v254, v255
    v_lshlrev_b32 v210, 16, v208
    v_and_b32 v211, 0xffff0000, v208
    v_lshlrev_b32 v212, 16, v110
    v_and_b32 v213, 0xffff0000, v110
    v_pk_add_f32 v[210:211], v[210:211], v[212:213]
    v_cvt_pk_bf16_f32 v222, v210, v211
    v_lshlrev_b32 v210, 16, v209
    v_and_b32 v211, 0xffff0000, v209
    v_lshlrev_b32 v212, 16, v111
    v_and_b32 v213, 0xffff0000, v111
    v_pk_add_f32 v[210:211], v[210:211], v[212:213]
    v_cvt_pk_bf16_f32 v223, v210, v211
    s_add_u32 s25, s43, 20480
    buffer_store_dwordx4 v[216:219], v12, s[8:11], s43 offen sc1
    buffer_store_dwordx4 v[220:223], v12, s[8:11], s25 offen sc1
    s_add_u32 s40, s40, 1
    s_add_u32 s43, s43, s77
    s_cmp_ge_u32 s40, s76
    s_cbranch_scc1 interleave_layers__linear_attn_block__memory_aug_recurrent_mem_tr__prompt_kernel_k3_done
    s_xor_b32 s42, s42, 40960
    s_waitcnt vmcnt(2)
    v_mfma_f32_16x16x32_bf16 v[132:135], a[192:195], v[16:19], 0
    v_mfma_f32_16x16x32_bf16 v[136:139], a[202:205], v[20:23], 0
    v_mfma_f32_16x16x32_bf16 v[112:115], a[160:163], v[16:19], 0
    v_mfma_f32_16x16x32_bf16 v[116:119], a[164:167], v[16:19], 0
    v_mfma_f32_16x16x32_bf16 v[120:123], a[172:175], v[16:19], 0
    v_mfma_f32_16x16x32_bf16 v[124:127], a[180:183], v[20:23], 0
    v_mfma_f32_16x16x32_bf16 v[128:131], a[186:189], v[20:23], 0
    v_mfma_f32_16x16x32_bf16 v[132:135], a[196:199], v[20:23], v[132:135]
    v_mfma_f32_16x16x32_bf16 v[116:119], a[168:171], v[20:23], v[116:119]
    v_mfma_f32_16x16x32_bf16 v[120:123], a[176:179], v[20:23], v[120:123]
    v_mfma_f32_16x16x16_bf16 v[136:139], a[206:207], v[24:25], v[136:139]
    s_nop 0
    v_mfma_f32_16x16x16_bf16 v[124:127], a[184:185], v[24:25], v[124:127]
    v_mfma_f32_16x16x16_bf16 v[128:131], a[190:191], v[24:25], v[128:131]
    v_mfma_f32_16x16x16_bf16 v[132:135], a[200:201], v[24:25], v[132:135]
    v_mfma_f32_16x16x32_bf16 v[160:163], a[240:243], v[26:29], 0
    v_mfma_f32_16x16x32_bf16 v[164:167], a[250:253], v[30:33], 0
    v_mfma_f32_16x16x32_bf16 v[140:143], a[208:211], v[26:29], 0
    v_mfma_f32_16x16x32_bf16 v[144:147], a[212:215], v[26:29], 0
    v_mfma_f32_16x16x32_bf16 v[148:151], a[220:223], v[26:29], 0
    v_mfma_f32_16x16x32_bf16 v[152:155], a[228:231], v[30:33], 0
    v_mfma_f32_16x16x32_bf16 v[156:159], a[234:237], v[30:33], 0
    v_mfma_f32_16x16x32_bf16 v[160:163], a[244:247], v[30:33], v[160:163]
    v_mfma_f32_16x16x32_bf16 v[144:147], a[216:219], v[30:33], v[144:147]
    v_mfma_f32_16x16x32_bf16 v[148:151], a[224:227], v[30:33], v[148:151]
    v_mfma_f32_16x16x16_bf16 v[164:167], a[254:255], v[34:35], v[164:167]
    s_nop 0
    v_mfma_f32_16x16x16_bf16 v[152:155], a[232:233], v[34:35], v[152:155]
    v_mfma_f32_16x16x16_bf16 v[156:159], a[238:239], v[34:35], v[156:159]
    v_mfma_f32_16x16x16_bf16 v[160:163], a[248:249], v[34:35], v[160:163]
    v_add_f32 v132, s54, v132
    v_add_f32 v133, s54, v133
    v_add_f32 v134, s54, v134
    v_add_f32 v135, s54, v135
    v_add_f32 v136, s54, v136
    v_rcp_f32 v132, v132
    v_rcp_f32 v133, v133
    v_rcp_f32 v134, v134
    v_rcp_f32 v135, v135
    v_rcp_f32 v136, v136
    v_mul_f32 v112, v112, v132
    v_mul_f32 v113, v113, v132
    v_mul_f32 v114, v114, v132
    v_mul_f32 v115, v115, v132
    v_cvt_pk_bf16_f32 v168, v112, v113
    v_cvt_pk_bf16_f32 v169, v114, v115
    v_mul_f32 v116, v116, v133
    v_mul_f32 v117, v117, v133
    v_mul_f32 v118, v118, v133
    v_mul_f32 v119, v119, v133
    v_cvt_pk_bf16_f32 v170, v116, v117
    v_cvt_pk_bf16_f32 v171, v118, v119
    v_mul_f32 v120, v120, v134
    v_mul_f32 v121, v121, v134
    v_mul_f32 v122, v122, v134
    v_mul_f32 v123, v123, v134
    v_cvt_pk_bf16_f32 v172, v120, v121
    v_cvt_pk_bf16_f32 v173, v122, v123
    v_mul_f32 v124, v124, v135
    v_mul_f32 v125, v125, v135
    v_mul_f32 v126, v126, v135
    v_mul_f32 v127, v127, v135
    v_cvt_pk_bf16_f32 v174, v124, v125
    v_cvt_pk_bf16_f32 v175, v126, v127
    v_mul_f32 v128, v128, v136
    v_mul_f32 v129, v129, v136
    v_mul_f32 v130, v130, v136
    v_mul_f32 v131, v131, v136
    v_cvt_pk_bf16_f32 v176, v128, v129
    v_cvt_pk_bf16_f32 v177, v130, v131
    v_add_f32 v160, s54, v160
    v_add_f32 v161, s54, v161
    v_add_f32 v162, s54, v162
    v_add_f32 v163, s54, v163
    v_add_f32 v164, s54, v164
    v_rcp_f32 v160, v160
    v_rcp_f32 v161, v161
    v_rcp_f32 v162, v162
    v_rcp_f32 v163, v163
    v_rcp_f32 v164, v164
    v_mul_f32 v140, v140, v160
    v_mul_f32 v141, v141, v160
    v_mul_f32 v142, v142, v160
    v_mul_f32 v143, v143, v160
    v_cvt_pk_bf16_f32 v178, v140, v141
    v_cvt_pk_bf16_f32 v179, v142, v143
    v_mul_f32 v144, v144, v161
    v_mul_f32 v145, v145, v161
    v_mul_f32 v146, v146, v161
    v_mul_f32 v147, v147, v161
    v_cvt_pk_bf16_f32 v180, v144, v145
    v_cvt_pk_bf16_f32 v181, v146, v147
    v_mul_f32 v148, v148, v162
    v_mul_f32 v149, v149, v162
    v_mul_f32 v150, v150, v162
    v_mul_f32 v151, v151, v162
    v_cvt_pk_bf16_f32 v182, v148, v149
    v_cvt_pk_bf16_f32 v183, v150, v151
    v_mul_f32 v152, v152, v163
    v_mul_f32 v153, v153, v163
    v_mul_f32 v154, v154, v163
    v_mul_f32 v155, v155, v163
    v_cvt_pk_bf16_f32 v184, v152, v153
    v_cvt_pk_bf16_f32 v185, v154, v155
    v_mul_f32 v156, v156, v164
    v_mul_f32 v157, v157, v164
    v_mul_f32 v158, v158, v164
    v_mul_f32 v159, v159, v164
    v_cvt_pk_bf16_f32 v186, v156, v157
    v_cvt_pk_bf16_f32 v187, v158, v159
    v_mfma_f32_16x16x32_bf16 v[132:135], a[192:195], v[36:39], 0
    v_mfma_f32_16x16x32_bf16 v[136:139], a[202:205], v[40:43], 0
    v_mfma_f32_16x16x32_bf16 v[112:115], a[160:163], v[36:39], 0
    v_mfma_f32_16x16x32_bf16 v[116:119], a[164:167], v[36:39], 0
    v_mfma_f32_16x16x32_bf16 v[120:123], a[172:175], v[36:39], 0
    v_mfma_f32_16x16x32_bf16 v[124:127], a[180:183], v[40:43], 0
    v_mfma_f32_16x16x32_bf16 v[128:131], a[186:189], v[40:43], 0
    v_mfma_f32_16x16x32_bf16 v[132:135], a[196:199], v[40:43], v[132:135]
    v_mfma_f32_16x16x32_bf16 v[116:119], a[168:171], v[40:43], v[116:119]
    v_mfma_f32_16x16x32_bf16 v[120:123], a[176:179], v[40:43], v[120:123]
    v_mfma_f32_16x16x16_bf16 v[136:139], a[206:207], v[44:45], v[136:139]
    s_nop 0
    v_mfma_f32_16x16x16_bf16 v[124:127], a[184:185], v[44:45], v[124:127]
    v_mfma_f32_16x16x16_bf16 v[128:131], a[190:191], v[44:45], v[128:131]
    v_mfma_f32_16x16x16_bf16 v[132:135], a[200:201], v[44:45], v[132:135]
    v_mfma_f32_16x16x32_bf16 v[160:163], a[240:243], v[46:49], 0
    v_mfma_f32_16x16x32_bf16 v[164:167], a[250:253], v[50:53], 0
    v_mfma_f32_16x16x32_bf16 v[140:143], a[208:211], v[46:49], 0
    v_mfma_f32_16x16x32_bf16 v[144:147], a[212:215], v[46:49], 0
    v_mfma_f32_16x16x32_bf16 v[148:151], a[220:223], v[46:49], 0
    v_mfma_f32_16x16x32_bf16 v[152:155], a[228:231], v[50:53], 0
    v_mfma_f32_16x16x32_bf16 v[156:159], a[234:237], v[50:53], 0
    v_mfma_f32_16x16x32_bf16 v[160:163], a[244:247], v[50:53], v[160:163]
    v_mfma_f32_16x16x32_bf16 v[144:147], a[216:219], v[50:53], v[144:147]
    v_mfma_f32_16x16x32_bf16 v[148:151], a[224:227], v[50:53], v[148:151]
    v_mfma_f32_16x16x16_bf16 v[164:167], a[254:255], v[54:55], v[164:167]
    s_nop 0
    v_mfma_f32_16x16x16_bf16 v[152:155], a[232:233], v[54:55], v[152:155]
    v_mfma_f32_16x16x16_bf16 v[156:159], a[238:239], v[54:55], v[156:159]
    v_mfma_f32_16x16x16_bf16 v[160:163], a[248:249], v[54:55], v[160:163]
    v_add_f32 v132, s54, v132
    v_add_f32 v133, s54, v133
    v_add_f32 v134, s54, v134
    v_add_f32 v135, s54, v135
    v_add_f32 v136, s54, v136
    v_rcp_f32 v132, v132
    v_rcp_f32 v133, v133
    v_rcp_f32 v134, v134
    v_rcp_f32 v135, v135
    v_rcp_f32 v136, v136
    v_mul_f32 v112, v112, v132
    v_mul_f32 v113, v113, v132
    v_mul_f32 v114, v114, v132
    v_mul_f32 v115, v115, v132
    v_cvt_pk_bf16_f32 v188, v112, v113
    v_cvt_pk_bf16_f32 v189, v114, v115
    v_mul_f32 v116, v116, v133
    v_mul_f32 v117, v117, v133
    v_mul_f32 v118, v118, v133
    v_mul_f32 v119, v119, v133
    v_cvt_pk_bf16_f32 v190, v116, v117
    v_cvt_pk_bf16_f32 v191, v118, v119
    v_mul_f32 v120, v120, v134
    v_mul_f32 v121, v121, v134
    v_mul_f32 v122, v122, v134
    v_mul_f32 v123, v123, v134
    v_cvt_pk_bf16_f32 v192, v120, v121
    v_cvt_pk_bf16_f32 v193, v122, v123
    v_mul_f32 v124, v124, v135
    v_mul_f32 v125, v125, v135
    v_mul_f32 v126, v126, v135
    v_mul_f32 v127, v127, v135
    v_cvt_pk_bf16_f32 v194, v124, v125
    v_cvt_pk_bf16_f32 v195, v126, v127
    v_mul_f32 v128, v128, v136
    v_mul_f32 v129, v129, v136
    v_mul_f32 v130, v130, v136
    v_mul_f32 v131, v131, v136
    v_cvt_pk_bf16_f32 v196, v128, v129
    v_cvt_pk_bf16_f32 v197, v130, v131
    v_add_f32 v160, s54, v160
    v_add_f32 v161, s54, v161
    v_add_f32 v162, s54, v162
    v_add_f32 v163, s54, v163
    v_add_f32 v164, s54, v164
    v_rcp_f32 v160, v160
    v_rcp_f32 v161, v161
    v_rcp_f32 v162, v162
    v_rcp_f32 v163, v163
    v_rcp_f32 v164, v164
    v_mul_f32 v140, v140, v160
    v_mul_f32 v141, v141, v160
    v_mul_f32 v142, v142, v160
    v_mul_f32 v143, v143, v160
    v_cvt_pk_bf16_f32 v198, v140, v141
    v_cvt_pk_bf16_f32 v199, v142, v143
    v_mul_f32 v144, v144, v161
    v_mul_f32 v145, v145, v161
    v_mul_f32 v146, v146, v161
    v_mul_f32 v147, v147, v161
    v_cvt_pk_bf16_f32 v200, v144, v145
    v_cvt_pk_bf16_f32 v201, v146, v147
    v_mul_f32 v148, v148, v162
    v_mul_f32 v149, v149, v162
    v_mul_f32 v150, v150, v162
    v_mul_f32 v151, v151, v162
    v_cvt_pk_bf16_f32 v202, v148, v149
    v_cvt_pk_bf16_f32 v203, v150, v151
    v_mul_f32 v152, v152, v163
    v_mul_f32 v153, v153, v163
    v_mul_f32 v154, v154, v163
    v_mul_f32 v155, v155, v163
    v_cvt_pk_bf16_f32 v204, v152, v153
    v_cvt_pk_bf16_f32 v205, v154, v155
    v_mul_f32 v156, v156, v164
    v_mul_f32 v157, v157, v164
    v_mul_f32 v158, v158, v164
    v_mul_f32 v159, v159, v164
    v_cvt_pk_bf16_f32 v206, v156, v157
    v_cvt_pk_bf16_f32 v207, v158, v159
    v_add_u32 v14, s42, v13
    ds_write_b128 v14, v[168:171] offset:0
    ds_write_b128 v14, v[172:175] offset:1024
    ds_write_b128 v14, v[176:179] offset:2048
    ds_write_b128 v14, v[180:183] offset:3072
    ds_write_b128 v14, v[184:187] offset:4096
    ds_write_b128 v14, v[188:191] offset:20480
    ds_write_b128 v14, v[192:195] offset:21504
    ds_write_b128 v14, v[196:199] offset:22528
    ds_write_b128 v14, v[200:203] offset:23552
    ds_write_b128 v14, v[204:207] offset:24576
    s_add_u32 s41, s43, s77
    s_add_u32 s24, s40, 1
    s_cmp_lt_u32 s24, s76
    s_cselect_b32 s41, s41, 2146435072
    s_waitcnt vmcnt(0)
    s_add_u32 s25, s41, 20480
    buffer_load_dwordx4 v[56:59], v8, s[8:11], s41 offen offset:0 sc1
    buffer_load_dwordx4 v[60:63], v8, s[8:11], s41 offen offset:1024 sc1
    buffer_load_dwordx2 v[64:65], v9, s[8:11], s41 offen offset:0 sc1
    buffer_load_dwordx4 v[66:69], v8, s[8:11], s41 offen offset:2560 sc1
    buffer_load_dwordx4 v[70:73], v8, s[8:11], s41 offen offset:3584 sc1
    buffer_load_dwordx2 v[74:75], v9, s[8:11], s41 offen offset:2560 sc1
    buffer_load_dwordx4 v[76:79], v8, s[8:11], s25 offen offset:0 sc1
    buffer_load_dwordx4 v[80:83], v8, s[8:11], s25 offen offset:1024 sc1
    buffer_load_dwordx2 v[84:85], v9, s[8:11], s25 offen offset:0 sc1
    buffer_load_dwordx4 v[86:89], v8, s[8:11], s25 offen offset:2560 sc1
    buffer_load_dwordx4 v[90:93], v8, s[8:11], s25 offen offset:3584 sc1
    buffer_load_dwordx2 v[94:95], v9, s[8:11], s25 offen offset:2560 sc1
    buffer_load_dwordx2 v[104:105], v10, s[16:19], s41 offen sc1
    buffer_load_dwordx2 v[106:107], v11, s[16:19], s41 offen sc1
    buffer_load_dwordx2 v[108:109], v10, s[16:19], s25 offen sc1
    buffer_load_dwordx2 v[110:111], v11, s[16:19], s25 offen sc1
    s_waitcnt lgkmcnt(0)
    s_barrier
    s_lshl_b32 s24, s92, 10
    s_lshl_b32 s25, s78, 2
    s_add_u32 s24, s24, s25
    s_add_u32 s24, s24, 23105536
    s_cmp_eq_u32 s3, 0
    s_cbranch_scc0 interleave_layers__linear_attn_block__memory_aug_recurrent_mem_tr__prompt_kernel_pb12
    v_lshlrev_b32 v14, 7, v1
    v_add_u32 v14, s24, v14
    v_mov_b32 v15, 2146435072
    v_cmp_le_u32 vcc, 8, v1
    s_nop 1
    v_cndmask_b32 v14, v14, v15, vcc
    v_mov_b32 v15, s40
    buffer_store_dword v15, v14, s[8:11], 0 offen sc1
interleave_layers__linear_attn_block__memory_aug_recurrent_mem_tr__prompt_kernel_pb12:
    s_branch interleave_layers__linear_attn_block__memory_aug_recurrent_mem_tr__prompt_kernel_k3_seg
interleave_layers__linear_attn_block__memory_aug_recurrent_mem_tr__prompt_kernel_k3_done:
    s_waitcnt vmcnt(0)
    s_barrier
    s_lshl_b32 s24, s92, 10
    s_lshl_b32 s25, s78, 2
    s_add_u32 s24, s24, s25
    s_add_u32 s24, s24, 23105536
    s_cmp_eq_u32 s3, 0
    s_cbranch_scc0 interleave_layers__linear_attn_block__memory_aug_recurrent_mem_tr__prompt_kernel_pb13
    v_lshlrev_b32 v14, 7, v1
    v_add_u32 v14, s24, v14
    v_mov_b32 v15, 2146435072
    v_cmp_le_u32 vcc, 8, v1
    s_nop 1
    v_cndmask_b32 v14, v14, v15, vcc
    v_mov_b32 v15, s40
    buffer_store_dword v15, v14, s[8:11], 0 offen sc1
interleave_layers__linear_attn_block__memory_aug_recurrent_mem_tr__prompt_kernel_pb13:
    s_cmp_eq_u32 s92, 0
    s_cbranch_scc0 interleave_layers__linear_attn_block__memory_aug_recurrent_mem_tr__prompt_kernel_end
    s_mov_b32 s92, 1
    s_cmp_lt_u32 s2, 248
    s_cbranch_scc1 interleave_layers__linear_attn_block__memory_aug_recurrent_mem_tr__prompt_kernel_helper_k1
    s_add_u32 s16, s4, 4194304
    s_addc_u32 s17, s5, 0
    s_mov_b32 s18, 2621440
    s_mov_b32 s19, 0x00020000
    s_mov_b32 s46, 1024
    s_mov_b32 s47, 8
    s_mov_b32 s50, 1
    s_mov_b32 s58, 8388608
    s_mov_b32 s76, 64
    s_mov_b32 s77, 40960
    s_branch interleave_layers__linear_attn_block__memory_aug_recurrent_mem_tr__prompt_kernel_k3_entry
interleave_layers__linear_attn_block__memory_aug_recurrent_mem_tr__prompt_kernel_helper_k1:
    s_mov_b32 s92, 1
    s_sub_u32 s24, s2, 232
    s_add_u32 s16, s4, 4194304
    s_addc_u32 s17, s5, 0
    s_mov_b32 s18, 2621440
    s_mov_b32 s19, 0x00020000
    s_mov_b32 s46, 1024
    s_mov_b32 s47, 8
    s_mov_b32 s50, 1
    s_and_b32 s44, s24, 7
    s_lshr_b32 s45, s24, 3
    s_mov_b32 s48, s45
    s_mov_b32 s49, 2
    s_mov_b32 s40, 32
    s_branch interleave_layers__linear_attn_block__memory_aug_recurrent_mem_tr__prompt_kernel_k1_entry
interleave_layers__linear_attn_block__memory_aug_recurrent_mem_tr__prompt_kernel_helper_clr:
    s_sub_u32 s44, s2, 253
    s_lshl_b32 s24, s44, 2
    s_add_u32 s24, s24, s3
    s_mul_i32 s24, s24, 38912
    s_add_u32 s41, s24, 117440512
    v_lshlrev_b32 v5, 4, v1
    v_mov_b32 v8, -1
    v_mov_b32 v9, -1
    v_mov_b32 v10, -1
    v_mov_b32 v11, -1
    s_lshl_b32 s24, s44, 2
    s_add_u32 s42, s24, 23109632
    s_mov_b32 s40, 0
interleave_layers__linear_attn_block__memory_aug_recurrent_mem_tr__prompt_kernel_clr_blk:
    s_mov_b32 s43, s41
    buffer_store_dwordx4 v[8:11], v5, s[8:11], s43 offen offset:0 sc1
    buffer_store_dwordx4 v[8:11], v5, s[8:11], s43 offen offset:1024 sc1
    buffer_store_dwordx4 v[8:11], v5, s[8:11], s43 offen offset:2048 sc1
    buffer_store_dwordx4 v[8:11], v5, s[8:11], s43 offen offset:3072 sc1
    s_add_u32 s43, s43, 4096
    buffer_store_dwordx4 v[8:11], v5, s[8:11], s43 offen offset:0 sc1
    buffer_store_dwordx4 v[8:11], v5, s[8:11], s43 offen offset:1024 sc1
    buffer_store_dwordx4 v[8:11], v5, s[8:11], s43 offen offset:2048 sc1
    buffer_store_dwordx4 v[8:11], v5, s[8:11], s43 offen offset:3072 sc1
    s_add_u32 s43, s43, 4096
    buffer_store_dwordx4 v[8:11], v5, s[8:11], s43 offen offset:0 sc1
    buffer_store_dwordx4 v[8:11], v5, s[8:11], s43 offen offset:1024 sc1
    buffer_store_dwordx4 v[8:11], v5, s[8:11], s43 offen offset:2048 sc1
    buffer_store_dwordx4 v[8:11], v5, s[8:11], s43 offen offset:3072 sc1
    s_add_u32 s43, s43, 4096
    buffer_store_dwordx4 v[8:11], v5, s[8:11], s43 offen offset:0 sc1
    buffer_store_dwordx4 v[8:11], v5, s[8:11], s43 offen offset:1024 sc1
    buffer_store_dwordx4 v[8:11], v5, s[8:11], s43 offen offset:2048 sc1
    buffer_store_dwordx4 v[8:11], v5, s[8:11], s43 offen offset:3072 sc1
    s_add_u32 s43, s43, 4096
    buffer_store_dwordx4 v[8:11], v5, s[8:11], s43 offen offset:0 sc1
    buffer_store_dwordx4 v[8:11], v5, s[8:11], s43 offen offset:1024 sc1
    buffer_store_dwordx4 v[8:11], v5, s[8:11], s43 offen offset:2048 sc1
    buffer_store_dwordx4 v[8:11], v5, s[8:11], s43 offen offset:3072 sc1
    s_add_u32 s43, s43, 4096
    buffer_store_dwordx4 v[8:11], v5, s[8:11], s43 offen offset:0 sc1
    buffer_store_dwordx4 v[8:11], v5, s[8:11], s43 offen offset:1024 sc1
    buffer_store_dwordx4 v[8:11], v5, s[8:11], s43 offen offset:2048 sc1
    buffer_store_dwordx4 v[8:11], v5, s[8:11], s43 offen offset:3072 sc1
    s_add_u32 s43, s43, 4096
    buffer_store_dwordx4 v[8:11], v5, s[8:11], s43 offen offset:0 sc1
    buffer_store_dwordx4 v[8:11], v5, s[8:11], s43 offen offset:1024 sc1
    buffer_store_dwordx4 v[8:11], v5, s[8:11], s43 offen offset:2048 sc1
    buffer_store_dwordx4 v[8:11], v5, s[8:11], s43 offen offset:3072 sc1
    s_add_u32 s43, s43, 4096
    buffer_store_dwordx4 v[8:11], v5, s[8:11], s43 offen offset:0 sc1
    buffer_store_dwordx4 v[8:11], v5, s[8:11], s43 offen offset:1024 sc1
    buffer_store_dwordx4 v[8:11], v5, s[8:11], s43 offen offset:2048 sc1
    buffer_store_dwordx4 v[8:11], v5, s[8:11], s43 offen offset:3072 sc1
    s_add_u32 s43, s43, 4096
    buffer_store_dwordx4 v[8:11], v5, s[8:11], s43 offen offset:0 sc1
    buffer_store_dwordx4 v[8:11], v5, s[8:11], s43 offen offset:1024 sc1
    buffer_store_dwordx4 v[8:11], v5, s[8:11], s43 offen offset:2048 sc1
    buffer_store_dwordx4 v[8:11], v5, s[8:11], s43 offen offset:3072 sc1
    s_add_u32 s43, s43, 4096
    buffer_store_dwordx4 v[8:11], v5, s[8:11], s43 offen offset:0 sc1
    buffer_store_dwordx4 v[8:11], v5, s[8:11], s43 offen offset:1024 sc1
    s_waitcnt vmcnt(38)
    s_barrier
    s_cmp_eq_u32 s3, 0
    s_cbranch_scc0 interleave_layers__linear_attn_block__memory_aug_recurrent_mem_tr__prompt_kernel_pb14
    v_lshlrev_b32 v14, 7, v1
    v_add_u32 v14, s42, v14
    v_mov_b32 v15, 2146435072
    v_cmp_le_u32 vcc, 8, v1
    s_nop 1
    v_cndmask_b32 v14, v14, v15, vcc
    v_mov_b32 v15, s40
    buffer_store_dword v15, v14, s[8:11], 0 offen sc1
interleave_layers__linear_attn_block__memory_aug_recurrent_mem_tr__prompt_kernel_pb14:
    s_add_u32 s40, s40, 1
    s_add_u32 s41, s41, 458752
    s_cmp_lt_u32 s40, 128
    s_cbranch_scc1 interleave_layers__linear_attn_block__memory_aug_recurrent_mem_tr__prompt_kernel_clr_blk
    s_waitcnt vmcnt(0)
    s_barrier
    s_cmp_eq_u32 s3, 0
    s_cbranch_scc0 interleave_layers__linear_attn_block__memory_aug_recurrent_mem_tr__prompt_kernel_pb15
    v_lshlrev_b32 v14, 7, v1
    v_add_u32 v14, s42, v14
    v_mov_b32 v15, 2146435072
    v_cmp_le_u32 vcc, 8, v1
    s_nop 1
    v_cndmask_b32 v14, v14, v15, vcc
    v_mov_b32 v15, s40
    buffer_store_dword v15, v14, s[8:11], 0 offen sc1
interleave_layers__linear_attn_block__memory_aug_recurrent_mem_tr__prompt_kernel_pb15:
    s_branch interleave_layers__linear_attn_block__memory_aug_recurrent_mem_tr__prompt_kernel_end
interleave_layers__linear_attn_block__memory_aug_recurrent_mem_tr__prompt_kernel_roleS:
    s_mov_b32 s44, s2
    s_load_dwordx2 s[6:7], s[0:1], 40
    s_load_dwordx2 s[24:25], s[0:1], 48
    s_load_dwordx2 s[26:27], s[0:1], 32
    s_waitcnt lgkmcnt(0)
    s_mov_b32 s12, s6
    s_mov_b32 s13, s7
    s_mov_b32 s14, 7864320
    s_mov_b32 s15, 0x00020000
    s_mov_b32 s16, s24
    s_mov_b32 s17, s25
    s_mov_b32 s18, 7864320
    s_mov_b32 s19, 0x00020000
    s_mov_b32 s20, s26
    s_mov_b32 s21, s27
    s_mov_b32 s22, 10240
    s_mov_b32 s23, 0x00020000
    v_add_u32 v16, 0, v0
    s_mov_b32 s24, 683
    v_mul_lo_u32 v17, v16, s24
    v_lshrrev_b32 v17, 14, v17
    v_mul_u32_u24 v18, 24, v17
    v_sub_u32 v18, v16, v18
    s_mov_b32 s24, 12288
    v_mul_lo_u32 v4, v17, s24
    v_lshl_add_u32 v4, v18, 4, v4
    v_mul_u32_u24 v10, 400, v17
    v_lshl_add_u32 v10, v18, 4, v10
    v_add_u32 v10, 106496, v10
    v_add_u32 v16, 256, v0
    s_mov_b32 s24, 683
    v_mul_lo_u32 v17, v16, s24
    v_lshrrev_b32 v17, 14, v17
    v_mul_u32_u24 v18, 24, v17
    v_sub_u32 v18, v16, v18
    s_mov_b32 s24, 12288
    v_mul_lo_u32 v5, v17, s24
    v_lshl_add_u32 v5, v18, 4, v5
    v_mul_u32_u24 v11, 400, v17
    v_lshl_add_u32 v11, v18, 4, v11
    v_add_u32 v11, 106496, v11
    v_add_u32 v16, 512, v0
    s_mov_b32 s24, 683
    v_mul_lo_u32 v17, v16, s24
    v_lshrrev_b32 v17, 14, v17
    v_mul_u32_u24 v18, 24, v17
    v_sub_u32 v18, v16, v18
    s_mov_b32 s24, 12288
    v_mul_lo_u32 v6, v17, s24
    v_lshl_add_u32 v6, v18, 4, v6
    v_mul_u32_u24 v12, 400, v17
    v_lshl_add_u32 v12, v18, 4, v12
    v_add_u32 v12, 106496, v12
    v_add_u32 v16, 768, v0
    s_mov_b32 s24, 683
    v_mul_lo_u32 v17, v16, s24
    v_lshrrev_b32 v17, 14, v17
    v_mul_u32_u24 v18, 24, v17
    v_sub_u32 v18, v16, v18
    s_mov_b32 s24, 12288
    v_mul_lo_u32 v7, v17, s24
    v_lshl_add_u32 v7, v18, 4, v7
    v_mul_u32_u24 v13, 400, v17
    v_lshl_add_u32 v13, v18, 4, v13
    v_add_u32 v13, 106496, v13
    v_add_u32 v16, 1024, v0
    s_mov_b32 s24, 683
    v_mul_lo_u32 v17, v16, s24
    v_lshrrev_b32 v17, 14, v17
    v_mul_u32_u24 v18, 24, v17
    v_sub_u32 v18, v16, v18
    s_mov_b32 s24, 12288
    v_mul_lo_u32 v8, v17, s24
    v_lshl_add_u32 v8, v18, 4, v8
    v_mul_u32_u24 v14, 400, v17
    v_lshl_add_u32 v14, v18, 4, v14
    v_add_u32 v14, 106496, v14
    v_add_u32 v16, 1280, v0
    s_mov_b32 s24, 683
    v_mul_lo_u32 v17, v16, s24
    v_lshrrev_b32 v17, 14, v17
    v_mul_u32_u24 v18, 24, v17
    v_sub_u32 v18, v16, v18
    s_mov_b32 s24, 12288
    v_mul_lo_u32 v9, v17, s24
    v_lshl_add_u32 v9, v18, 4, v9
    v_mul_u32_u24 v15, 400, v17
    v_lshl_add_u32 v15, v18, 4, v15
    v_add_u32 v15, 106496, v15
    v_lshrrev_b32 v17, 1, v3
    v_lshlrev_b32 v17, 4, v17
    v_and_b32 v18, 1, v3
    v_lshl_add_u32 v17, v18, 2, v17
    v_lshrrev_b32 v18, 2, v2
    v_and_b32 v19, 1, v18
    v_add_u32 v17, v17, v19
    v_lshrrev_b32 v18, 1, v18
    v_lshl_add_u32 v17, v18, 3, v17
    v_mul_u32_u24 v16, 400, v17
    v_and_b32 v18, 3, v2
    v_lshl_add_u32 v16, v18, 3, v16
    v_add_u32 v16, 106496, v16
    s_mul_i32 s24, s3, 96
    v_add_u32 v16, s24, v16
    v_lshlrev_b32 v17, 4, v1
    s_mul_i32 s24, s3, 20480
    s_add_u32 s24, s24, 24576
    v_add_u32 v17, s24, v17
    s_mul_i32 s45, s44, 384
    s_add_u32 s46, s45, 0
    buffer_load_dwordx4 v[24:27], v4, s[12:15], s46 offen
    buffer_load_dwordx4 v[28:31], v5, s[12:15], s46 offen
    buffer_load_dwordx4 v[32:35], v6, s[12:15], s46 offen
    buffer_load_dwordx4 v[36:39], v7, s[12:15], s46 offen
    buffer_load_dwordx4 v[40:43], v8, s[12:15], s46 offen
    buffer_load_dwordx4 v[44:47], v9, s[12:15], s46 offen
    s_add_u32 s46, s45, 0
    buffer_load_dwordx4 v[48:51], v4, s[16:19], s46 offen
    buffer_load_dwordx4 v[52:55], v5, s[16:19], s46 offen
    buffer_load_dwordx4 v[56:59], v6, s[16:19], s46 offen
    buffer_load_dwordx4 v[60:63], v7, s[16:19], s46 offen
    buffer_load_dwordx4 v[64:67], v8, s[16:19], s46 offen
    buffer_load_dwordx4 v[68:71], v9, s[16:19], s46 offen
    s_waitcnt vmcnt(6)
    ds_write_b128 v10, v[24:27]
    ds_write_b128 v11, v[28:31]
    ds_write_b128 v12, v[32:35]
    ds_write_b128 v13, v[36:39]
    ds_write_b128 v14, v[40:43]
    ds_write_b128 v15, v[44:47]
    s_add_u32 s46, s45, 786432
    buffer_load_dwordx4 v[72:75], v4, s[12:15], s46 offen
    buffer_load_dwordx4 v[76:79], v5, s[12:15], s46 offen
    buffer_load_dwordx4 v[80:83], v6, s[12:15], s46 offen
    buffer_load_dwordx4 v[84:87], v7, s[12:15], s46 offen
    buffer_load_dwordx4 v[88:91], v8, s[12:15], s46 offen
    buffer_load_dwordx4 v[92:95], v9, s[12:15], s46 offen
    s_waitcnt lgkmcnt(0)
    s_barrier
    ds_read_b64_tr_b16 a[0:1], v16 offset:0
    ds_read_b64_tr_b16 a[2:3], v16 offset:800
    ds_read_b64_tr_b16 a[4:5], v16 offset:12800
    ds_read_b64_tr_b16 a[6:7], v16 offset:13600
    ds_read_b64_tr_b16 a[80:81], v16 offset:32
    ds_read_b64_tr_b16 a[82:83], v16 offset:832
    ds_read_b64_tr_b16 a[84:85], v16 offset:12832
    ds_read_b64_tr_b16 a[86:87], v16 offset:13632
    ds_read_b64_tr_b16 a[160:161], v16 offset:64
    ds_read_b64_tr_b16 a[162:163], v16 offset:864
    ds_read_b64_tr_b16 a[164:165], v16 offset:12864
    ds_read_b64_tr_b16 a[166:167], v16 offset:13664
    s_waitcnt lgkmcnt(0)
    s_barrier
    s_waitcnt vmcnt(6)
    ds_write_b128 v10, v[48:51]
    ds_write_b128 v11, v[52:55]
    ds_write_b128 v12, v[56:59]
    ds_write_b128 v13, v[60:63]
    ds_write_b128 v14, v[64:67]
    ds_write_b128 v15, v[68:71]
    s_add_u32 s46, s45, 786432
    buffer_load_dwordx4 v[24:27], v4, s[16:19], s46 offen
    buffer_load_dwordx4 v[28:31], v5, s[16:19], s46 offen
    buffer_load_dwordx4 v[32:35], v6, s[16:19], s46 offen
    buffer_load_dwordx4 v[36:39], v7, s[16:19], s46 offen
    buffer_load_dwordx4 v[40:43], v8, s[16:19], s46 offen
    buffer_load_dwordx4 v[44:47], v9, s[16:19], s46 offen
    s_waitcnt lgkmcnt(0)
    s_barrier
    ds_read_b64_tr_b16 v[96:97], v16 offset:32
    ds_read_b64_tr_b16 v[98:99], v16 offset:832
    ds_read_b64_tr_b16 v[100:101], v16 offset:12832
    ds_read_b64_tr_b16 v[102:103], v16 offset:13632
    ds_read_b64_tr_b16 v[176:177], v16 offset:64
    ds_read_b64_tr_b16 v[178:179], v16 offset:864
    ds_read_b64_tr_b16 v[180:181], v16 offset:12864
    ds_read_b64_tr_b16 v[182:183], v16 offset:13664
    ds_read_b64_tr_b16 v[48:49], v16 offset:0
    ds_read_b64_tr_b16 v[50:51], v16 offset:800
    ds_read_b64_tr_b16 v[52:53], v16 offset:12800
    ds_read_b64_tr_b16 v[54:55], v16 offset:13600
    s_waitcnt lgkmcnt(0)
    ds_write_b128 v17, v[48:51] offset:0
    ds_write_b128 v17, v[52:55] offset:1024
    s_waitcnt lgkmcnt(0)
    s_barrier
    s_waitcnt vmcnt(6)
    ds_write_b128 v10, v[72:75]
    ds_write_b128 v11, v[76:79]
    ds_write_b128 v12, v[80:83]
    ds_write_b128 v13, v[84:87]
    ds_write_b128 v14, v[88:91]
    ds_write_b128 v15, v[92:95]
    s_add_u32 s46, s45, 1572864
    buffer_load_dwordx4 v[48:51], v4, s[12:15], s46 offen
    buffer_load_dwordx4 v[52:55], v5, s[12:15], s46 offen
    buffer_load_dwordx4 v[56:59], v6, s[12:15], s46 offen
    buffer_load_dwordx4 v[60:63], v7, s[12:15], s46 offen
    buffer_load_dwordx4 v[64:67], v8, s[12:15], s46 offen
    buffer_load_dwordx4 v[68:71], v9, s[12:15], s46 offen
    s_waitcnt lgkmcnt(0)
    s_barrier
    ds_read_b64_tr_b16 a[8:9], v16 offset:0
    ds_read_b64_tr_b16 a[10:11], v16 offset:800
    ds_read_b64_tr_b16 a[12:13], v16 offset:12800
    ds_read_b64_tr_b16 a[14:15], v16 offset:13600
    ds_read_b64_tr_b16 a[88:89], v16 offset:32
    ds_read_b64_tr_b16 a[90:91], v16 offset:832
    ds_read_b64_tr_b16 a[92:93], v16 offset:12832
    ds_read_b64_tr_b16 a[94:95], v16 offset:13632
    ds_read_b64_tr_b16 a[168:169], v16 offset:64
    ds_read_b64_tr_b16 a[170:171], v16 offset:864
    ds_read_b64_tr_b16 a[172:173], v16 offset:12864
    ds_read_b64_tr_b16 a[174:175], v16 offset:13664
    s_waitcnt lgkmcnt(0)
    s_barrier
    s_waitcnt vmcnt(6)
    ds_write_b128 v10, v[24:27]
    ds_write_b128 v11, v[28:31]
    ds_write_b128 v12, v[32:35]
    ds_write_b128 v13, v[36:39]
    ds_write_b128 v14, v[40:43]
    ds_write_b128 v15, v[44:47]
    s_add_u32 s46, s45, 1572864
    buffer_load_dwordx4 v[72:75], v4, s[16:19], s46 offen
    buffer_load_dwordx4 v[76:79], v5, s[16:19], s46 offen
    buffer_load_dwordx4 v[80:83], v6, s[16:19], s46 offen
    buffer_load_dwordx4 v[84:87], v7, s[16:19], s46 offen
    buffer_load_dwordx4 v[88:91], v8, s[16:19], s46 offen
    buffer_load_dwordx4 v[92:95], v9, s[16:19], s46 offen
    s_waitcnt lgkmcnt(0)
    s_barrier
    ds_read_b64_tr_b16 v[104:105], v16 offset:32
    ds_read_b64_tr_b16 v[106:107], v16 offset:832
    ds_read_b64_tr_b16 v[108:109], v16 offset:12832
    ds_read_b64_tr_b16 v[110:111], v16 offset:13632
    ds_read_b64_tr_b16 v[184:185], v16 offset:64
    ds_read_b64_tr_b16 v[186:187], v16 offset:864
    ds_read_b64_tr_b16 v[188:189], v16 offset:12864
    ds_read_b64_tr_b16 v[190:191], v16 offset:13664
    ds_read_b64_tr_b16 v[24:25], v16 offset:0
    ds_read_b64_tr_b16 v[26:27], v16 offset:800
    ds_read_b64_tr_b16 v[28:29], v16 offset:12800
    ds_read_b64_tr_b16 v[30:31], v16 offset:13600
    s_waitcnt lgkmcnt(0)
    ds_write_b128 v17, v[24:27] offset:2048
    ds_write_b128 v17, v[28:31] offset:3072
    s_waitcnt lgkmcnt(0)
    s_barrier
    s_waitcnt vmcnt(6)
    ds_write_b128 v10, v[48:51]
    ds_write_b128 v11, v[52:55]
    ds_write_b128 v12, v[56:59]
    ds_write_b128 v13, v[60:63]
    ds_write_b128 v14, v[64:67]
    ds_write_b128 v15, v[68:71]
    s_add_u32 s46, s45, 2359296
    buffer_load_dwordx4 v[24:27], v4, s[12:15], s46 offen
    buffer_load_dwordx4 v[28:31], v5, s[12:15], s46 offen
    buffer_load_dwordx4 v[32:35], v6, s[12:15], s46 offen
    buffer_load_dwordx4 v[36:39], v7, s[12:15], s46 offen
    buffer_load_dwordx4 v[40:43], v8, s[12:15], s46 offen
    buffer_load_dwordx4 v[44:47], v9, s[12:15], s46 offen
    s_waitcnt lgkmcnt(0)
    s_barrier
    ds_read_b64_tr_b16 a[16:17], v16 offset:0
    ds_read_b64_tr_b16 a[18:19], v16 offset:800
    ds_read_b64_tr_b16 a[20:21], v16 offset:12800
    ds_read_b64_tr_b16 a[22:23], v16 offset:13600
    ds_read_b64_tr_b16 a[96:97], v16 offset:32
    ds_read_b64_tr_b16 a[98:99], v16 offset:832
    ds_read_b64_tr_b16 a[100:101], v16 offset:12832
    ds_read_b64_tr_b16 a[102:103], v16 offset:13632
    ds_read_b64_tr_b16 a[176:177], v16 offset:64
    ds_read_b64_tr_b16 a[178:179], v16 offset:864
    ds_read_b64_tr_b16 a[180:181], v16 offset:12864
    ds_read_b64_tr_b16 a[182:183], v16 offset:13664
    s_waitcnt lgkmcnt(0)
    s_barrier
    s_waitcnt vmcnt(6)
    ds_write_b128 v10, v[72:75]
    ds_write_b128 v11, v[76:79]
    ds_write_b128 v12, v[80:83]
    ds_write_b128 v13, v[84:87]
    ds_write_b128 v14, v[88:91]
    ds_write_b128 v15, v[92:95]
    s_add_u32 s46, s45, 2359296
    buffer_load_dwordx4 v[48:51], v4, s[16:19], s46 offen
    buffer_load_dwordx4 v[52:55], v5, s[16:19], s46 offen
    buffer_load_dwordx4 v[56:59], v6, s[16:19], s46 offen
    buffer_load_dwordx4 v[60:63], v7, s[16:19], s46 offen
    buffer_load_dwordx4 v[64:67], v8, s[16:19], s46 offen
    buffer_load_dwordx4 v[68:71], v9, s[16:19], s46 offen
    s_waitcnt lgkmcnt(0)
    s_barrier
    ds_read_b64_tr_b16 v[112:113], v16 offset:32
    ds_read_b64_tr_b16 v[114:115], v16 offset:832
    ds_read_b64_tr_b16 v[116:117], v16 offset:12832
    ds_read_b64_tr_b16 v[118:119], v16 offset:13632
    ds_read_b64_tr_b16 v[192:193], v16 offset:64
    ds_read_b64_tr_b16 v[194:195], v16 offset:864
    ds_read_b64_tr_b16 v[196:197], v16 offset:12864
    ds_read_b64_tr_b16 v[198:199], v16 offset:13664
    ds_read_b64_tr_b16 v[72:73], v16 offset:0
    ds_read_b64_tr_b16 v[74:75], v16 offset:800
    ds_read_b64_tr_b16 v[76:77], v16 offset:12800
    ds_read_b64_tr_b16 v[78:79], v16 offset:13600
    s_waitcnt lgkmcnt(0)
    ds_write_b128 v17, v[72:75] offset:4096
    ds_write_b128 v17, v[76:79] offset:5120
    s_waitcnt lgkmcnt(0)
    s_barrier
    s_waitcnt vmcnt(6)
    ds_write_b128 v10, v[24:27]
    ds_write_b128 v11, v[28:31]
    ds_write_b128 v12, v[32:35]
    ds_write_b128 v13, v[36:39]
    ds_write_b128 v14, v[40:43]
    ds_write_b128 v15, v[44:47]
    s_add_u32 s46, s45, 3145728
    buffer_load_dwordx4 v[72:75], v4, s[12:15], s46 offen
    buffer_load_dwordx4 v[76:79], v5, s[12:15], s46 offen
    buffer_load_dwordx4 v[80:83], v6, s[12:15], s46 offen
    buffer_load_dwordx4 v[84:87], v7, s[12:15], s46 offen
    buffer_load_dwordx4 v[88:91], v8, s[12:15], s46 offen
    buffer_load_dwordx4 v[92:95], v9, s[12:15], s46 offen
    s_waitcnt lgkmcnt(0)
    s_barrier
    ds_read_b64_tr_b16 a[24:25], v16 offset:0
    ds_read_b64_tr_b16 a[26:27], v16 offset:800
    ds_read_b64_tr_b16 a[28:29], v16 offset:12800
    ds_read_b64_tr_b16 a[30:31], v16 offset:13600
    ds_read_b64_tr_b16 a[104:105], v16 offset:32
    ds_read_b64_tr_b16 a[106:107], v16 offset:832
    ds_read_b64_tr_b16 a[108:109], v16 offset:12832
    ds_read_b64_tr_b16 a[110:111], v16 offset:13632
    ds_read_b64_tr_b16 a[184:185], v16 offset:64
    ds_read_b64_tr_b16 a[186:187], v16 offset:864
    ds_read_b64_tr_b16 a[188:189], v16 offset:12864
    ds_read_b64_tr_b16 a[190:191], v16 offset:13664
    s_waitcnt lgkmcnt(0)
    s_barrier
    s_waitcnt vmcnt(6)
    ds_write_b128 v10, v[48:51]
    ds_write_b128 v11, v[52:55]
    ds_write_b128 v12, v[56:59]
    ds_write_b128 v13, v[60:63]
    ds_write_b128 v14, v[64:67]
    ds_write_b128 v15, v[68:71]
    s_add_u32 s46, s45, 3145728
    buffer_load_dwordx4 v[24:27], v4, s[16:19], s46 offen
    buffer_load_dwordx4 v[28:31], v5, s[16:19], s46 offen
    buffer_load_dwordx4 v[32:35], v6, s[16:19], s46 offen
    buffer_load_dwordx4 v[36:39], v7, s[16:19], s46 offen
    buffer_load_dwordx4 v[40:43], v8, s[16:19], s46 offen
    buffer_load_dwordx4 v[44:47], v9, s[16:19], s46 offen
    s_waitcnt lgkmcnt(0)
    s_barrier
    ds_read_b64_tr_b16 v[120:121], v16 offset:32
    ds_read_b64_tr_b16 v[122:123], v16 offset:832
    ds_read_b64_tr_b16 v[124:125], v16 offset:12832
    ds_read_b64_tr_b16 v[126:127], v16 offset:13632
    ds_read_b64_tr_b16 v[200:201], v16 offset:64
    ds_read_b64_tr_b16 v[202:203], v16 offset:864
    ds_read_b64_tr_b16 v[204:205], v16 offset:12864
    ds_read_b64_tr_b16 v[206:207], v16 offset:13664
    ds_read_b64_tr_b16 v[48:49], v16 offset:0
    ds_read_b64_tr_b16 v[50:51], v16 offset:800
    ds_read_b64_tr_b16 v[52:53], v16 offset:12800
    ds_read_b64_tr_b16 v[54:55], v16 offset:13600
    s_waitcnt lgkmcnt(0)
    ds_write_b128 v17, v[48:51] offset:6144
    ds_write_b128 v17, v[52:55] offset:7168
    s_waitcnt lgkmcnt(0)
    s_barrier
    s_waitcnt vmcnt(6)
    ds_write_b128 v10, v[72:75]
    ds_write_b128 v11, v[76:79]
    ds_write_b128 v12, v[80:83]
    ds_write_b128 v13, v[84:87]
    ds_write_b128 v14, v[88:91]
    ds_write_b128 v15, v[92:95]
    s_add_u32 s46, s45, 3932160
    buffer_load_dwordx4 v[48:51], v4, s[12:15], s46 offen
    buffer_load_dwordx4 v[52:55], v5, s[12:15], s46 offen
    buffer_load_dwordx4 v[56:59], v6, s[12:15], s46 offen
    buffer_load_dwordx4 v[60:63], v7, s[12:15], s46 offen
    buffer_load_dwordx4 v[64:67], v8, s[12:15], s46 offen
    buffer_load_dwordx4 v[68:71], v9, s[12:15], s46 offen
    s_waitcnt lgkmcnt(0)
    s_barrier
    ds_read_b64_tr_b16 a[32:33], v16 offset:0
    ds_read_b64_tr_b16 a[34:35], v16 offset:800
    ds_read_b64_tr_b16 a[36:37], v16 offset:12800
    ds_read_b64_tr_b16 a[38:39], v16 offset:13600
    ds_read_b64_tr_b16 a[112:113], v16 offset:32
    ds_read_b64_tr_b16 a[114:115], v16 offset:832
    ds_read_b64_tr_b16 a[116:117], v16 offset:12832
    ds_read_b64_tr_b16 a[118:119], v16 offset:13632
    ds_read_b64_tr_b16 a[192:193], v16 offset:64
    ds_read_b64_tr_b16 a[194:195], v16 offset:864
    ds_read_b64_tr_b16 a[196:197], v16 offset:12864
    ds_read_b64_tr_b16 a[198:199], v16 offset:13664
    s_waitcnt lgkmcnt(0)
    s_barrier
    s_waitcnt vmcnt(6)
    ds_write_b128 v10, v[24:27]
    ds_write_b128 v11, v[28:31]
    ds_write_b128 v12, v[32:35]
    ds_write_b128 v13, v[36:39]
    ds_write_b128 v14, v[40:43]
    ds_write_b128 v15, v[44:47]
    s_add_u32 s46, s45, 3932160
    buffer_load_dwordx4 v[72:75], v4, s[16:19], s46 offen
    buffer_load_dwordx4 v[76:79], v5, s[16:19], s46 offen
    buffer_load_dwordx4 v[80:83], v6, s[16:19], s46 offen
    buffer_load_dwordx4 v[84:87], v7, s[16:19], s46 offen
    buffer_load_dwordx4 v[88:91], v8, s[16:19], s46 offen
    buffer_load_dwordx4 v[92:95], v9, s[16:19], s46 offen
    s_waitcnt lgkmcnt(0)
    s_barrier
    ds_read_b64_tr_b16 v[128:129], v16 offset:32
    ds_read_b64_tr_b16 v[130:131], v16 offset:832
    ds_read_b64_tr_b16 v[132:133], v16 offset:12832
    ds_read_b64_tr_b16 v[134:135], v16 offset:13632
    ds_read_b64_tr_b16 v[208:209], v16 offset:64
    ds_read_b64_tr_b16 v[210:211], v16 offset:864
    ds_read_b64_tr_b16 v[212:213], v16 offset:12864
    ds_read_b64_tr_b16 v[214:215], v16 offset:13664
    ds_read_b64_tr_b16 v[24:25], v16 offset:0
    ds_read_b64_tr_b16 v[26:27], v16 offset:800
    ds_read_b64_tr_b16 v[28:29], v16 offset:12800
    ds_read_b64_tr_b16 v[30:31], v16 offset:13600
    s_waitcnt lgkmcnt(0)
    ds_write_b128 v17, v[24:27] offset:8192
    ds_write_b128 v17, v[28:31] offset:9216
    s_waitcnt lgkmcnt(0)
    s_barrier
    s_waitcnt vmcnt(6)
    ds_write_b128 v10, v[48:51]
    ds_write_b128 v11, v[52:55]
    ds_write_b128 v12, v[56:59]
    ds_write_b128 v13, v[60:63]
    ds_write_b128 v14, v[64:67]
    ds_write_b128 v15, v[68:71]
    s_add_u32 s46, s45, 4718592
    buffer_load_dwordx4 v[24:27], v4, s[12:15], s46 offen
    buffer_load_dwordx4 v[28:31], v5, s[12:15], s46 offen
    buffer_load_dwordx4 v[32:35], v6, s[12:15], s46 offen
    buffer_load_dwordx4 v[36:39], v7, s[12:15], s46 offen
    buffer_load_dwordx4 v[40:43], v8, s[12:15], s46 offen
    buffer_load_dwordx4 v[44:47], v9, s[12:15], s46 offen
    s_waitcnt lgkmcnt(0)
    s_barrier
    ds_read_b64_tr_b16 a[40:41], v16 offset:0
    ds_read_b64_tr_b16 a[42:43], v16 offset:800
    ds_read_b64_tr_b16 a[44:45], v16 offset:12800
    ds_read_b64_tr_b16 a[46:47], v16 offset:13600
    ds_read_b64_tr_b16 a[120:121], v16 offset:32
    ds_read_b64_tr_b16 a[122:123], v16 offset:832
    ds_read_b64_tr_b16 a[124:125], v16 offset:12832
    ds_read_b64_tr_b16 a[126:127], v16 offset:13632
    ds_read_b64_tr_b16 a[200:201], v16 offset:64
    ds_read_b64_tr_b16 a[202:203], v16 offset:864
    ds_read_b64_tr_b16 a[204:205], v16 offset:12864
    ds_read_b64_tr_b16 a[206:207], v16 offset:13664
    s_waitcnt lgkmcnt(0)
    s_barrier
    s_waitcnt vmcnt(6)
    ds_write_b128 v10, v[72:75]
    ds_write_b128 v11, v[76:79]
    ds_write_b128 v12, v[80:83]
    ds_write_b128 v13, v[84:87]
    ds_write_b128 v14, v[88:91]
    ds_write_b128 v15, v[92:95]
    s_add_u32 s46, s45, 4718592
    buffer_load_dwordx4 v[48:51], v4, s[16:19], s46 offen
    buffer_load_dwordx4 v[52:55], v5, s[16:19], s46 offen
    buffer_load_dwordx4 v[56:59], v6, s[16:19], s46 offen
    buffer_load_dwordx4 v[60:63], v7, s[16:19], s46 offen
    buffer_load_dwordx4 v[64:67], v8, s[16:19], s46 offen
    buffer_load_dwordx4 v[68:71], v9, s[16:19], s46 offen
    s_waitcnt lgkmcnt(0)
    s_barrier
    ds_read_b64_tr_b16 v[136:137], v16 offset:32
    ds_read_b64_tr_b16 v[138:139], v16 offset:832
    ds_read_b64_tr_b16 v[140:141], v16 offset:12832
    ds_read_b64_tr_b16 v[142:143], v16 offset:13632
    ds_read_b64_tr_b16 v[216:217], v16 offset:64
    ds_read_b64_tr_b16 v[218:219], v16 offset:864
    ds_read_b64_tr_b16 v[220:221], v16 offset:12864
    ds_read_b64_tr_b16 v[222:223], v16 offset:13664
    ds_read_b64_tr_b16 v[72:73], v16 offset:0
    ds_read_b64_tr_b16 v[74:75], v16 offset:800
    ds_read_b64_tr_b16 v[76:77], v16 offset:12800
    ds_read_b64_tr_b16 v[78:79], v16 offset:13600
    s_waitcnt lgkmcnt(0)
    ds_write_b128 v17, v[72:75] offset:10240
    ds_write_b128 v17, v[76:79] offset:11264
    s_waitcnt lgkmcnt(0)
    s_barrier
    s_waitcnt vmcnt(6)
    ds_write_b128 v10, v[24:27]
    ds_write_b128 v11, v[28:31]
    ds_write_b128 v12, v[32:35]
    ds_write_b128 v13, v[36:39]
    ds_write_b128 v14, v[40:43]
    ds_write_b128 v15, v[44:47]
    s_add_u32 s46, s45, 5505024
    buffer_load_dwordx4 v[72:75], v4, s[12:15], s46 offen
    buffer_load_dwordx4 v[76:79], v5, s[12:15], s46 offen
    buffer_load_dwordx4 v[80:83], v6, s[12:15], s46 offen
    buffer_load_dwordx4 v[84:87], v7, s[12:15], s46 offen
    buffer_load_dwordx4 v[88:91], v8, s[12:15], s46 offen
    buffer_load_dwordx4 v[92:95], v9, s[12:15], s46 offen
    s_waitcnt lgkmcnt(0)
    s_barrier
    ds_read_b64_tr_b16 a[48:49], v16 offset:0
    ds_read_b64_tr_b16 a[50:51], v16 offset:800
    ds_read_b64_tr_b16 a[52:53], v16 offset:12800
    ds_read_b64_tr_b16 a[54:55], v16 offset:13600
    ds_read_b64_tr_b16 a[128:129], v16 offset:32
    ds_read_b64_tr_b16 a[130:131], v16 offset:832
    ds_read_b64_tr_b16 a[132:133], v16 offset:12832
    ds_read_b64_tr_b16 a[134:135], v16 offset:13632
    ds_read_b64_tr_b16 a[208:209], v16 offset:64
    ds_read_b64_tr_b16 a[210:211], v16 offset:864
    ds_read_b64_tr_b16 a[212:213], v16 offset:12864
    ds_read_b64_tr_b16 a[214:215], v16 offset:13664
    s_waitcnt lgkmcnt(0)
    s_barrier
    s_waitcnt vmcnt(6)
    ds_write_b128 v10, v[48:51]
    ds_write_b128 v11, v[52:55]
    ds_write_b128 v12, v[56:59]
    ds_write_b128 v13, v[60:63]
    ds_write_b128 v14, v[64:67]
    ds_write_b128 v15, v[68:71]
    s_add_u32 s46, s45, 5505024
    buffer_load_dwordx4 v[24:27], v4, s[16:19], s46 offen
    buffer_load_dwordx4 v[28:31], v5, s[16:19], s46 offen
    buffer_load_dwordx4 v[32:35], v6, s[16:19], s46 offen
    buffer_load_dwordx4 v[36:39], v7, s[16:19], s46 offen
    buffer_load_dwordx4 v[40:43], v8, s[16:19], s46 offen
    buffer_load_dwordx4 v[44:47], v9, s[16:19], s46 offen
    s_waitcnt lgkmcnt(0)
    s_barrier
    ds_read_b64_tr_b16 v[144:145], v16 offset:32
    ds_read_b64_tr_b16 v[146:147], v16 offset:832
    ds_read_b64_tr_b16 v[148:149], v16 offset:12832
    ds_read_b64_tr_b16 v[150:151], v16 offset:13632
    ds_read_b64_tr_b16 v[224:225], v16 offset:64
    ds_read_b64_tr_b16 v[226:227], v16 offset:864
    ds_read_b64_tr_b16 v[228:229], v16 offset:12864
    ds_read_b64_tr_b16 v[230:231], v16 offset:13664
    ds_read_b64_tr_b16 v[48:49], v16 offset:0
    ds_read_b64_tr_b16 v[50:51], v16 offset:800
    ds_read_b64_tr_b16 v[52:53], v16 offset:12800
    ds_read_b64_tr_b16 v[54:55], v16 offset:13600
    s_waitcnt lgkmcnt(0)
    ds_write_b128 v17, v[48:51] offset:12288
    ds_write_b128 v17, v[52:55] offset:13312
    s_waitcnt lgkmcnt(0)
    s_barrier
    s_waitcnt vmcnt(6)
    ds_write_b128 v10, v[72:75]
    ds_write_b128 v11, v[76:79]
    ds_write_b128 v12, v[80:83]
    ds_write_b128 v13, v[84:87]
    ds_write_b128 v14, v[88:91]
    ds_write_b128 v15, v[92:95]
    s_add_u32 s46, s45, 6291456
    buffer_load_dwordx4 v[48:51], v4, s[12:15], s46 offen
    buffer_load_dwordx4 v[52:55], v5, s[12:15], s46 offen
    buffer_load_dwordx4 v[56:59], v6, s[12:15], s46 offen
    buffer_load_dwordx4 v[60:63], v7, s[12:15], s46 offen
    buffer_load_dwordx4 v[64:67], v8, s[12:15], s46 offen
    buffer_load_dwordx4 v[68:71], v9, s[12:15], s46 offen
    s_waitcnt lgkmcnt(0)
    s_barrier
    ds_read_b64_tr_b16 a[56:57], v16 offset:0
    ds_read_b64_tr_b16 a[58:59], v16 offset:800
    ds_read_b64_tr_b16 a[60:61], v16 offset:12800
    ds_read_b64_tr_b16 a[62:63], v16 offset:13600
    ds_read_b64_tr_b16 a[136:137], v16 offset:32
    ds_read_b64_tr_b16 a[138:139], v16 offset:832
    ds_read_b64_tr_b16 a[140:141], v16 offset:12832
    ds_read_b64_tr_b16 a[142:143], v16 offset:13632
    ds_read_b64_tr_b16 a[216:217], v16 offset:64
    ds_read_b64_tr_b16 a[218:219], v16 offset:864
    ds_read_b64_tr_b16 a[220:221], v16 offset:12864
    ds_read_b64_tr_b16 a[222:223], v16 offset:13664
    s_waitcnt lgkmcnt(0)
    s_barrier
    s_waitcnt vmcnt(6)
    ds_write_b128 v10, v[24:27]
    ds_write_b128 v11, v[28:31]
    ds_write_b128 v12, v[32:35]
    ds_write_b128 v13, v[36:39]
    ds_write_b128 v14, v[40:43]
    ds_write_b128 v15, v[44:47]
    s_add_u32 s46, s45, 6291456
    buffer_load_dwordx4 v[72:75], v4, s[16:19], s46 offen
    buffer_load_dwordx4 v[76:79], v5, s[16:19], s46 offen
    buffer_load_dwordx4 v[80:83], v6, s[16:19], s46 offen
    buffer_load_dwordx4 v[84:87], v7, s[16:19], s46 offen
    buffer_load_dwordx4 v[88:91], v8, s[16:19], s46 offen
    buffer_load_dwordx4 v[92:95], v9, s[16:19], s46 offen
    s_waitcnt lgkmcnt(0)
    s_barrier
    ds_read_b64_tr_b16 v[152:153], v16 offset:32
    ds_read_b64_tr_b16 v[154:155], v16 offset:832
    ds_read_b64_tr_b16 v[156:157], v16 offset:12832
    ds_read_b64_tr_b16 v[158:159], v16 offset:13632
    ds_read_b64_tr_b16 v[232:233], v16 offset:64
    ds_read_b64_tr_b16 v[234:235], v16 offset:864
    ds_read_b64_tr_b16 v[236:237], v16 offset:12864
    ds_read_b64_tr_b16 v[238:239], v16 offset:13664
    ds_read_b64_tr_b16 v[24:25], v16 offset:0
    ds_read_b64_tr_b16 v[26:27], v16 offset:800
    ds_read_b64_tr_b16 v[28:29], v16 offset:12800
    ds_read_b64_tr_b16 v[30:31], v16 offset:13600
    s_waitcnt lgkmcnt(0)
    ds_write_b128 v17, v[24:27] offset:14336
    ds_write_b128 v17, v[28:31] offset:15360
    s_waitcnt lgkmcnt(0)
    s_barrier
    s_waitcnt vmcnt(6)
    ds_write_b128 v10, v[48:51]
    ds_write_b128 v11, v[52:55]
    ds_write_b128 v12, v[56:59]
    ds_write_b128 v13, v[60:63]
    ds_write_b128 v14, v[64:67]
    ds_write_b128 v15, v[68:71]
    s_add_u32 s46, s45, 7077888
    buffer_load_dwordx4 v[24:27], v4, s[12:15], s46 offen
    buffer_load_dwordx4 v[28:31], v5, s[12:15], s46 offen
    buffer_load_dwordx4 v[32:35], v6, s[12:15], s46 offen
    buffer_load_dwordx4 v[36:39], v7, s[12:15], s46 offen
    buffer_load_dwordx4 v[40:43], v8, s[12:15], s46 offen
    buffer_load_dwordx4 v[44:47], v9, s[12:15], s46 offen
    s_waitcnt lgkmcnt(0)
    s_barrier
    ds_read_b64_tr_b16 a[64:65], v16 offset:0
    ds_read_b64_tr_b16 a[66:67], v16 offset:800
    ds_read_b64_tr_b16 a[68:69], v16 offset:12800
    ds_read_b64_tr_b16 a[70:71], v16 offset:13600
    ds_read_b64_tr_b16 a[144:145], v16 offset:32
    ds_read_b64_tr_b16 a[146:147], v16 offset:832
    ds_read_b64_tr_b16 a[148:149], v16 offset:12832
    ds_read_b64_tr_b16 a[150:151], v16 offset:13632
    ds_read_b64_tr_b16 a[224:225], v16 offset:64
    ds_read_b64_tr_b16 a[226:227], v16 offset:864
    ds_read_b64_tr_b16 a[228:229], v16 offset:12864
    ds_read_b64_tr_b16 a[230:231], v16 offset:13664
    s_waitcnt lgkmcnt(0)
    s_barrier
    s_waitcnt vmcnt(6)
    ds_write_b128 v10, v[72:75]
    ds_write_b128 v11, v[76:79]
    ds_write_b128 v12, v[80:83]
    ds_write_b128 v13, v[84:87]
    ds_write_b128 v14, v[88:91]
    ds_write_b128 v15, v[92:95]
    s_add_u32 s46, s45, 7077888
    buffer_load_dwordx4 v[48:51], v4, s[16:19], s46 offen
    buffer_load_dwordx4 v[52:55], v5, s[16:19], s46 offen
    buffer_load_dwordx4 v[56:59], v6, s[16:19], s46 offen
    buffer_load_dwordx4 v[60:63], v7, s[16:19], s46 offen
    buffer_load_dwordx4 v[64:67], v8, s[16:19], s46 offen
    buffer_load_dwordx4 v[68:71], v9, s[16:19], s46 offen
    s_waitcnt lgkmcnt(0)
    s_barrier
    ds_read_b64_tr_b16 v[160:161], v16 offset:32
    ds_read_b64_tr_b16 v[162:163], v16 offset:832
    ds_read_b64_tr_b16 v[164:165], v16 offset:12832
    ds_read_b64_tr_b16 v[166:167], v16 offset:13632
    ds_read_b64_tr_b16 v[240:241], v16 offset:64
    ds_read_b64_tr_b16 v[242:243], v16 offset:864
    ds_read_b64_tr_b16 v[244:245], v16 offset:12864
    ds_read_b64_tr_b16 v[246:247], v16 offset:13664
    ds_read_b64_tr_b16 v[72:73], v16 offset:0
    ds_read_b64_tr_b16 v[74:75], v16 offset:800
    ds_read_b64_tr_b16 v[76:77], v16 offset:12800
    ds_read_b64_tr_b16 v[78:79], v16 offset:13600
    s_waitcnt lgkmcnt(0)
    ds_write_b128 v17, v[72:75] offset:16384
    ds_write_b128 v17, v[76:79] offset:17408
    s_waitcnt lgkmcnt(0)
    s_barrier
    s_waitcnt vmcnt(6)
    ds_write_b128 v10, v[24:27]
    ds_write_b128 v11, v[28:31]
    ds_write_b128 v12, v[32:35]
    ds_write_b128 v13, v[36:39]
    ds_write_b128 v14, v[40:43]
    ds_write_b128 v15, v[44:47]
    s_waitcnt lgkmcnt(0)
    s_barrier
    ds_read_b64_tr_b16 a[72:73], v16 offset:0
    ds_read_b64_tr_b16 a[74:75], v16 offset:800
    ds_read_b64_tr_b16 a[76:77], v16 offset:12800
    ds_read_b64_tr_b16 a[78:79], v16 offset:13600
    ds_read_b64_tr_b16 a[152:153], v16 offset:32
    ds_read_b64_tr_b16 a[154:155], v16 offset:832
    ds_read_b64_tr_b16 a[156:157], v16 offset:12832
    ds_read_b64_tr_b16 a[158:159], v16 offset:13632
    ds_read_b64_tr_b16 a[232:233], v16 offset:64
    ds_read_b64_tr_b16 a[234:235], v16 offset:864
    ds_read_b64_tr_b16 a[236:237], v16 offset:12864
    ds_read_b64_tr_b16 a[238:239], v16 offset:13664
    s_waitcnt lgkmcnt(0)
    s_barrier
    s_waitcnt vmcnt(0)
    ds_write_b128 v10, v[48:51]
    ds_write_b128 v11, v[52:55]
    ds_write_b128 v12, v[56:59]
    ds_write_b128 v13, v[60:63]
    ds_write_b128 v14, v[64:67]
    ds_write_b128 v15, v[68:71]
    s_waitcnt lgkmcnt(0)
    s_barrier
    ds_read_b64_tr_b16 v[168:169], v16 offset:32
    ds_read_b64_tr_b16 v[170:171], v16 offset:832
    ds_read_b64_tr_b16 v[172:173], v16 offset:12832
    ds_read_b64_tr_b16 v[174:175], v16 offset:13632
    ds_read_b64_tr_b16 v[248:249], v16 offset:64
    ds_read_b64_tr_b16 v[250:251], v16 offset:864
    ds_read_b64_tr_b16 v[252:253], v16 offset:12864
    ds_read_b64_tr_b16 v[254:255], v16 offset:13664
    ds_read_b64_tr_b16 v[48:49], v16 offset:0
    ds_read_b64_tr_b16 v[50:51], v16 offset:800
    ds_read_b64_tr_b16 v[52:53], v16 offset:12800
    ds_read_b64_tr_b16 v[54:55], v16 offset:13600
    s_waitcnt lgkmcnt(0)
    ds_write_b128 v17, v[48:51] offset:18432
    ds_write_b128 v17, v[52:55] offset:19456
    s_waitcnt lgkmcnt(0)
    s_barrier
    v_mov_b32 v6, v17
    v_mov_b32 v30, 0xeeee
    v_mov_b32 v4, 0x4444
    v_cmp_gt_u32 vcc, 8, v2
    s_nop 1
    v_cndmask_b32 v4, v30, v4, vcc
    v_lshlrev_b32 v5, 4, v1
    s_lshl_b32 s24, s3, 10
    v_add_u32 v7, s24, v5
    s_lshl_b32 s24, s3, 9
    s_add_u32 s24, s24, 8192
    v_lshlrev_b32 v8, 3, v1
    v_add_u32 v8, s24, v8
    v_and_b32 v30, 1, v2
    v_lshlrev_b32 v30, 4, v30
    v_mov_b32 v31, 0x3f80
    v_lshlrev_b32 v31, v30, v31
    v_lshrrev_b32 v30, 2, v2
    v_cmp_eq_u32 vcc, v30, v3
    s_nop 1
    v_cndmask_b32 v31, 0, v31, vcc
    v_and_b32 v30, 2, v2
    v_cmp_eq_u32 vcc, 0, v30
    s_nop 1
    v_cndmask_b32 v10, 0, v31, vcc
    v_cndmask_b32 v11, v31, 0, vcc
    v_add_u32 v33, 22528, v5
    s_mul_i32 s24, s3, 1408
    s_add_u32 s24, s24, 16384
    v_mul_u32_u24 v30, 176, v2
    v_add_u32 v30, s24, v30
    v_lshl_add_u32 v12, v3, 5, v30
    v_cmp_gt_u32 vcc, 8, v2
    s_nop 1
    v_cndmask_b32 v12, v33, v12, vcc
    v_lshl_add_u32 v13, v3, 4, v30
    v_add_u32 v13, 96, v13
    v_cmp_le_u32 s[24:25], 2, v3
    s_and_b64 vcc, vcc, s[24:25]
    v_cndmask_b32 v13, v33, v13, vcc
    s_mul_i32 s24, s3, 5632
    s_add_u32 s24, s24, 106496
    v_mul_u32_u24 v30, 176, v2
    v_add_u32 v30, s24, v30
    v_lshl_add_u32 v16, v3, 5, v30
    v_lshl_add_u32 v17, v3, 4, v30
    v_add_u32 v17, 96, v17
    v_add_u32 v18, 2816, v17
    v_cmp_le_u32 vcc, 2, v3
    s_nop 1
    v_cndmask_b32 v17, v33, v17, vcc
    v_cndmask_b32 v18, v33, v18, vcc
    v_lshrrev_b32 v30, 3, v1
    v_and_b32 v31, 7, v1
    v_min_u32 v32, 4, v31
    v_mul_u32_u24 v14, 176, v30
    v_lshl_add_u32 v14, v32, 5, v14
    s_mul_i32 s24, s3, 1408
    s_add_u32 s24, s24, 106496
    v_add_u32 v21, s24, v14
    v_add_u32 v14, 16384, v14
    v_cmp_gt_u32 s[50:51], 5, v31
    s_lshl_b32 s24, s3, 3
    v_add_u32 v32, s24, v30
    v_lshlrev_b32 v33, 2, v31
    v_sub_u32 v32, v32, v33
    v_mov_b32 v33, 100
    v_cmp_gt_u32 vcc, 4, v31
    s_nop 1
    v_cndmask_b32 v32, v33, v32, vcc
    v_cmp_le_i32 s[64:65], 0, v32
    v_cmp_le_i32 s[66:67], 1, v32
    v_cmp_le_i32 s[68:69], 2, v32
    v_cmp_le_i32 s[70:71], 3, v32
    v_cmp_le_i32 s[72:73], 16, v32
    v_cmp_le_i32 s[74:75], 17, v32
    v_cmp_le_i32 s[76:77], 18, v32
    v_cmp_le_i32 s[78:79], 19, v32
    s_lshr_b32 s24, s44, 1
    s_lshl_b32 s24, s24, 10
    s_and_b32 s25, s44, 1
    s_lshl_b32 s25, s25, 7
    s_add_u32 s24, s24, s25
    v_lshlrev_b32 v15, 8, v31
    v_lshl_add_u32 v15, v30, 4, v15
    v_add_u32 v15, s24, v15
    s_lshr_b32 s24, s44, 3
    s_lshl_b32 s24, s24, 10
    s_and_b32 s25, s44, 3
    s_lshl_b32 s25, s25, 8
    s_add_u32 s24, s24, s25
    s_lshr_b32 s25, s44, 2
    s_and_b32 s25, s25, 1
    s_lshl_b32 s25, s25, 7
    s_add_u32 s24, s24, s25
    s_add_u32 s24, s24, 16384
    v_lshlrev_b32 v32, 4, v30
    v_add_u32 v32, s24, v32
    v_cmp_eq_u32 vcc, 4, v31
    s_nop 1
    v_cndmask_b32 v15, v15, v32, vcc
    v_mov_b32 v32, 2146435072
    v_cndmask_b32 v15, v32, v15, s[50:51]
    s_cmp_lt_u32 s3, 1
    s_cselect_b32 s24, 0, 2146435072
    v_or_b32 v15, s24, v15
    s_and_b32 s24, s3, 1
    s_lshl_b32 s24, s24, 7
    s_lshr_b32 s25, s3, 1
    s_lshl_b32 s25, s25, 10
    s_add_u32 s24, s24, s25
    s_lshl_b32 s25, s44, 11
    s_add_u32 s25, s25, s24
    v_lshlrev_b32 v22, 8, v31
    v_lshl_add_u32 v22, v30, 4, v22
    v_add_u32 v22, s25, v22
    s_lshr_b32 s25, s44, 2
    s_lshl_b32 s25, s25, 11
    s_add_u32 s25, s25, s24
    s_and_b32 s26, s44, 3
    s_lshl_b32 s26, s26, 8
    s_add_u32 s25, s25, s26
    s_add_u32 s25, s25, 65536
    v_lshlrev_b32 v32, 4, v30
    v_add_u32 v32, s25, v32
    v_cmp_eq_u32 vcc, 4, v31
    s_nop 1
    v_cndmask_b32 v22, v22, v32, vcc
    v_mov_b32 v32, 2146435072
    v_cndmask_b32 v22, v32, v22, s[50:51]
    s_mul_i32 s24, s44, 12288
    s_mul_i32 s25, s3, 3072
    s_add_u32 s24, s24, s25
    v_add_u32 v19, s24, v5
    s_and_b32 s24, s2, 15
    s_mul_i32 s25, s3, 16
    s_add_u32 s24, s24, s25
    s_lshl_b32 s24, s24, 7
    v_mov_b32 v23, s24
    s_lshr_b32 s25, s44, 3
    s_mul_i32 s24, s25, 8
    v_add_u32 v20, s24, v1
    v_lshlrev_b32 v20, 7, v20
    v_mov_b32 v30, 2146435072
    v_cmp_le_u32 vcc, 8, v1
    s_nop 1
    v_cndmask_b32 v20, v20, v30, vcc
    s_cmp_eq_u32 s3, 0
    s_cselect_b32 s24, 0, 2146435072
    v_or_b32 v20, s24, v20
    v_mov_b32 v0, 1
interleave_layers__linear_attn_block__memory_aug_recurrent_mem_tr__prompt_kernel_s_layer:
    s_mul_i32 s93, s92, 29360128
    s_add_u32 s93, s93, 117440512
    s_mul_i32 s94, s92, 16384
    s_add_u32 s94, s94, 23068672
    v_and_b32 v9, 1, v1
    v_lshlrev_b32 v9, 12, v9
    s_lshl_b32 s24, s44, 7
    s_add_u32 s24, s24, s94
    v_add_u32 v9, s24, v9
    s_lshl_b32 s24, s3, 6
    s_add_u32 s24, s24, 0
    v_add_u32 v48, s24, v1
    v_and_b32 v49, 7, v48
    v_mul_u32_u24 v49, 1280, v49
    v_lshrrev_b32 v50, 3, v48
    v_lshl_add_u32 v49, v50, 4, v49
    v_cmp_gt_u32 vcc, 640, v48
    v_mov_b32 v51, 2146435072
    s_nop 0
    v_cndmask_b32 v49, v51, v49, vcc
    buffer_load_dwordx4 v[52:55], v49, s[20:23], 0 offen
    v_lshlrev_b32 v48, 4, v48
    s_waitcnt vmcnt(0)
    s_and_saveexec_b64 s[30:31], vcc
    ds_write_b128 v48, v[52:55]
    s_mov_b64 exec, s[30:31]
    s_lshl_b32 s24, s3, 6
    s_add_u32 s24, s24, 256
    v_add_u32 v48, s24, v1
    v_and_b32 v49, 7, v48
    v_mul_u32_u24 v49, 1280, v49
    v_lshrrev_b32 v50, 3, v48
    v_lshl_add_u32 v49, v50, 4, v49
    v_cmp_gt_u32 vcc, 640, v48
    v_mov_b32 v51, 2146435072
    s_nop 0
    v_cndmask_b32 v49, v51, v49, vcc
    buffer_load_dwordx4 v[52:55], v49, s[20:23], 0 offen
    v_lshlrev_b32 v48, 4, v48
    s_waitcnt vmcnt(0)
    s_and_saveexec_b64 s[30:31], vcc
    ds_write_b128 v48, v[52:55]
    s_mov_b64 exec, s[30:31]
    s_lshl_b32 s24, s3, 6
    s_add_u32 s24, s24, 512
    v_add_u32 v48, s24, v1
    v_and_b32 v49, 7, v48
    v_mul_u32_u24 v49, 1280, v49
    v_lshrrev_b32 v50, 3, v48
    v_lshl_add_u32 v49, v50, 4, v49
    v_cmp_gt_u32 vcc, 640, v48
    v_mov_b32 v51, 2146435072
    s_nop 0
    v_cndmask_b32 v49, v51, v49, vcc
    buffer_load_dwordx4 v[52:55], v49, s[20:23], 0 offen
    v_lshlrev_b32 v48, 4, v48
    s_waitcnt vmcnt(0)
    s_and_saveexec_b64 s[30:31], vcc
    ds_write_b128 v48, v[52:55]
    s_mov_b64 exec, s[30:31]
    s_mov_b32 s40, 0
    s_mov_b32 s41, 92274688
    s_add_u32 s42, s93, 327680
    s_add_u32 s43, s93, 409600
    s_mov_b32 s45, 67108864
    s_add_u32 s47, s93, -28672
    s_add_u32 s48, s93, -18432
    s_add_u32 s49, s93, 448512
    s_lshl_b32 s95, s92, 6
    s_add_u32 s95, s95, s40
    s_add_u32 s95, s95, 1
    s_cmp_ge_i32 s59, s95
    s_cbranch_scc1 interleave_layers__linear_attn_block__memory_aug_recurrent_mem_tr__prompt_kernel_s_ec0_ok
    s_and_b32 s24, s2, 7
    s_lshl_b32 s24, s24, 7
    s_add_u32 s24, s24, 23109632
    v_and_b32 v49, 3, v1
    v_lshl_add_u32 v49, v49, 2, s24
    s_mov_b32 s61, 0
interleave_layers__linear_attn_block__memory_aug_recurrent_mem_tr__prompt_kernel_s_ec0:
    buffer_load_dword v48, v49, s[8:11], 0 offen sc1
    s_waitcnt vmcnt(0)
    v_readlane_b32 s59, v48, 0
    v_readlane_b32 s24, v48, 1
    s_min_i32 s59, s59, s24
    v_readlane_b32 s24, v48, 2
    s_min_i32 s59, s59, s24
    s_cmp_ge_i32 s59, s95
    s_cbranch_scc1 interleave_layers__linear_attn_block__memory_aug_recurrent_mem_tr__prompt_kernel_s_ec0_ok
    s_add_u32 s61, s61, 1
    s_cmp_ge_u32 s61, s60
    s_cbranch_scc1 interleave_layers__linear_attn_block__memory_aug_recurrent_mem_tr__prompt_kernel_s_ec0_to
    s_sleep 2
    s_branch interleave_layers__linear_attn_block__memory_aug_recurrent_mem_tr__prompt_kernel_s_ec0
interleave_layers__linear_attn_block__memory_aug_recurrent_mem_tr__prompt_kernel_s_ec0_to:
    s_mov_b32 s60, 1
interleave_layers__linear_attn_block__memory_aug_recurrent_mem_tr__prompt_kernel_s_ec0_ok:
    s_mov_b32 s62, -1
    s_mov_b32 s63, 1
    s_cmp_ge_i32 s62, s63
    s_cbranch_scc1 interleave_layers__linear_attn_block__memory_aug_recurrent_mem_tr__prompt_kernel_s_en0_ok
    s_mov_b32 s61, 0
interleave_layers__linear_attn_block__memory_aug_recurrent_mem_tr__prompt_kernel_s_en0:
    buffer_load_dword v48, v9, s[8:11], 0 offen sc1
    s_waitcnt vmcnt(0)
    v_readlane_b32 s62, v48, 0
    v_readlane_b32 s24, v48, 1
    s_min_i32 s62, s62, s24
    s_cmp_ge_i32 s62, s63
    s_cbranch_scc1 interleave_layers__linear_attn_block__memory_aug_recurrent_mem_tr__prompt_kernel_s_en0_ok
    s_add_u32 s61, s61, 1
    s_cmp_ge_u32 s61, s60
    s_cbranch_scc1 interleave_layers__linear_attn_block__memory_aug_recurrent_mem_tr__prompt_kernel_s_en0_to
    s_sleep 2
    s_branch interleave_layers__linear_attn_block__memory_aug_recurrent_mem_tr__prompt_kernel_s_en0
interleave_layers__linear_attn_block__memory_aug_recurrent_mem_tr__prompt_kernel_s_en0_to:
    s_mov_b32 s60, 1
interleave_layers__linear_attn_block__memory_aug_recurrent_mem_tr__prompt_kernel_s_en0_ok:
    buffer_load_dwordx4 a[240:243], v19, s[8:11], s41 offen offset:0 sc1
    buffer_load_dwordx4 a[244:247], v19, s[8:11], s41 offen offset:1024 sc1
    buffer_load_dwordx4 a[248:251], v19, s[8:11], s41 offen offset:2048 sc1
    s_waitcnt lgkmcnt(0)
    v_mov_b32 v24, 0
    v_mov_b32 v25, 0
    v_mov_b32 v26, 0
    v_mov_b32 v27, 0
    v_mov_b32 v28, 0
    v_mov_b32 v29, 0
    v_mov_b32 v30, 0
    v_mov_b32 v31, 0
    v_mov_b32 v32, 0
    v_mov_b32 v33, 0
    v_mov_b32 v34, 0
    v_mov_b32 v35, 0
    v_mov_b32 v36, 0
    v_mov_b32 v37, 0
    v_mov_b32 v38, 0
    v_mov_b32 v39, 0
    v_mov_b32 v40, 0
    v_mov_b32 v41, 0
    v_mov_b32 v42, 0
    v_mov_b32 v43, 0
    v_mov_b32 v44, 0
    v_mov_b32 v45, 0
    v_mov_b32 v46, 0
    v_mov_b32 v47, 0
    s_barrier
    ds_read_b128 v[84:87], v7
    ds_read_b128 v[88:91], v7 offset:4096
    s_waitcnt vmcnt(0) lgkmcnt(0)
    s_cmp_eq_u32 s3, 0
    s_cbranch_scc1 interleave_layers__linear_attn_block__memory_aug_recurrent_mem_tr__prompt_kernel_s_gow0
    s_cmp_eq_u32 s3, 1
    s_cbranch_scc1 interleave_layers__linear_attn_block__memory_aug_recurrent_mem_tr__prompt_kernel_s_gow1
    s_cmp_eq_u32 s3, 2
    s_cbranch_scc1 interleave_layers__linear_attn_block__memory_aug_recurrent_mem_tr__prompt_kernel_s_gow2
    s_branch interleave_layers__linear_attn_block__memory_aug_recurrent_mem_tr__prompt_kernel_s_gow3
interleave_layers__linear_attn_block__memory_aug_recurrent_mem_tr__prompt_kernel_s_stepw0:
    v_mov_b32 v24, 0
    v_mov_b32 v25, 0
    v_mov_b32 v26, 0
    v_mov_b32 v27, 0
    v_mov_b32 v28, 0
    v_mov_b32 v29, 0
    v_mov_b32 v30, 0
    v_mov_b32 v31, 0
    v_mov_b32 v32, 0
    v_mov_b32 v33, 0
    v_mov_b32 v34, 0
    v_mov_b32 v35, 0
    v_mov_b32 v36, 0
    v_mov_b32 v37, 0
    v_mov_b32 v38, 0
    v_mov_b32 v39, 0
    v_mov_b32 v40, 0
    v_mov_b32 v41, 0
    v_mov_b32 v42, 0
    v_mov_b32 v43, 0
    v_mov_b32 v44, 0
    v_mov_b32 v45, 0
    v_mov_b32 v46, 0
    v_mov_b32 v47, 0
    s_add_u32 s46, s47, 4096
    s_lshl_b32 s95, s92, 6
    s_add_u32 s95, s95, s40
    s_add_u32 s95, s95, 1
    s_cmp_ge_i32 s59, s95
    s_cbranch_scc1 interleave_layers__linear_attn_block__memory_aug_recurrent_mem_tr__prompt_kernel_s_ecw0_ok
    s_and_b32 s24, s2, 7
    s_lshl_b32 s24, s24, 7
    s_add_u32 s24, s24, 23109632
    v_and_b32 v49, 3, v1
    v_lshl_add_u32 v49, v49, 2, s24
    s_mov_b32 s61, 0
interleave_layers__linear_attn_block__memory_aug_recurrent_mem_tr__prompt_kernel_s_ecw0:
    buffer_load_dword v48, v49, s[8:11], 0 offen sc1
    s_waitcnt vmcnt(0)
    v_readlane_b32 s59, v48, 0
    v_readlane_b32 s24, v48, 1
    s_min_i32 s59, s59, s24
    v_readlane_b32 s24, v48, 2
    s_min_i32 s59, s59, s24
    s_cmp_ge_i32 s59, s95
    s_cbranch_scc1 interleave_layers__linear_attn_block__memory_aug_recurrent_mem_tr__prompt_kernel_s_ecw0_ok
    s_add_u32 s61, s61, 1
    s_cmp_ge_u32 s61, s60
    s_cbranch_scc1 interleave_layers__linear_attn_block__memory_aug_recurrent_mem_tr__prompt_kernel_s_ecw0_to
    s_sleep 2
    s_branch interleave_layers__linear_attn_block__memory_aug_recurrent_mem_tr__prompt_kernel_s_ecw0
interleave_layers__linear_attn_block__memory_aug_recurrent_mem_tr__prompt_kernel_s_ecw0_to:
    s_mov_b32 s60, 1
interleave_layers__linear_attn_block__memory_aug_recurrent_mem_tr__prompt_kernel_s_ecw0_ok:
    s_add_u32 s63, s40, 1
    s_cmp_ge_i32 s62, s63
    s_cbranch_scc1 interleave_layers__linear_attn_block__memory_aug_recurrent_mem_tr__prompt_kernel_s_enw0_ok
    s_mov_b32 s61, 0
interleave_layers__linear_attn_block__memory_aug_recurrent_mem_tr__prompt_kernel_s_enw0:
    buffer_load_dword v48, v9, s[8:11], 0 offen sc1
    s_waitcnt vmcnt(0)
    v_readlane_b32 s62, v48, 0
    v_readlane_b32 s24, v48, 1
    s_min_i32 s62, s62, s24
    s_cmp_ge_i32 s62, s63
    s_cbranch_scc1 interleave_layers__linear_attn_block__memory_aug_recurrent_mem_tr__prompt_kernel_s_enw0_ok
    s_add_u32 s61, s61, 1
    s_cmp_ge_u32 s61, s60
    s_cbranch_scc1 interleave_layers__linear_attn_block__memory_aug_recurrent_mem_tr__prompt_kernel_s_enw0_to
    s_sleep 2
    s_branch interleave_layers__linear_attn_block__memory_aug_recurrent_mem_tr__prompt_kernel_s_enw0
interleave_layers__linear_attn_block__memory_aug_recurrent_mem_tr__prompt_kernel_s_enw0_to:
    s_mov_b32 s60, 1
interleave_layers__linear_attn_block__memory_aug_recurrent_mem_tr__prompt_kernel_s_enw0_ok:
    s_sleep 5
    s_mov_b64 exec, 1
    s_mov_b32 s61, 0
    v_mov_b32 v83, 0
    buffer_atomic_add v83, v23, s[8:11], s48 offen sc0
    s_sleep 3
    v_mov_b32 v94, 0
    buffer_atomic_add v94, v23, s[8:11], s48 offen sc0
    s_sleep 3
    v_mov_b32 v95, 0
    buffer_atomic_add v95, v23, s[8:11], s48 offen sc0
    s_sleep 3
interleave_layers__linear_attn_block__memory_aug_recurrent_mem_tr__prompt_kernel_s_prw0:
    v_mov_b32 v82, 0
    buffer_atomic_add v82, v23, s[8:11], s48 offen sc0
    s_waitcnt vmcnt(3)
    v_cmp_le_i32 vcc, 8, v83
    s_add_u32 s61, s61, 1
    s_cbranch_vccnz interleave_layers__linear_attn_block__memory_aug_recurrent_mem_tr__prompt_kernel_s_prw0_out
    s_sleep 3
    v_mov_b32 v83, 0
    buffer_atomic_add v83, v23, s[8:11], s48 offen sc0
    s_waitcnt vmcnt(3)
    v_cmp_le_i32 vcc, 8, v94
    s_add_u32 s61, s61, 1
    s_cbranch_vccnz interleave_layers__linear_attn_block__memory_aug_recurrent_mem_tr__prompt_kernel_s_prw0_out
    s_sleep 3
    v_mov_b32 v94, 0
    buffer_atomic_add v94, v23, s[8:11], s48 offen sc0
    s_waitcnt vmcnt(3)
    v_cmp_le_i32 vcc, 8, v95
    s_add_u32 s61, s61, 1
    s_cbranch_vccnz interleave_layers__linear_attn_block__memory_aug_recurrent_mem_tr__prompt_kernel_s_prw0_out
    s_sleep 3
    v_mov_b32 v95, 0
    buffer_atomic_add v95, v23, s[8:11], s48 offen sc0
    s_waitcnt vmcnt(3)
    v_cmp_le_i32 vcc, 8, v82
    s_add_u32 s61, s61, 1
    s_cbranch_vccnz interleave_layers__linear_attn_block__memory_aug_recurrent_mem_tr__prompt_kernel_s_prw0_out
    s_sleep 3
    s_cmp_ge_u32 s61, s60
    s_cbranch_scc0 interleave_layers__linear_attn_block__memory_aug_recurrent_mem_tr__prompt_kernel_s_prw0
    s_mov_b32 s60, 1
interleave_layers__linear_attn_block__memory_aug_recurrent_mem_tr__prompt_kernel_s_prw0_out:
    s_mov_b64 exec, -1
    buffer_load_dwordx4 v[84:87], v7, s[8:11], s47 offen sc1
    buffer_load_dwordx4 v[88:91], v7, s[8:11], s46 offen sc1
    buffer_load_dwordx2 v[92:93], v8, s[8:11], s47 offen sc1
    buffer_load_dwordx4 a[240:243], v19, s[8:11], s41 offen offset:0 sc1
    buffer_load_dwordx4 a[244:247], v19, s[8:11], s41 offen offset:1024 sc1
    buffer_load_dwordx4 a[248:251], v19, s[8:11], s41 offen offset:2048 sc1
    ds_read_b128 v[48:51], v21 offset:0
    ds_read_b128 v[52:55], v21 offset:16
    ds_read_b128 v[56:59], v21 offset:5632
    ds_read_b128 v[60:63], v21 offset:5648
    ds_read_b128 v[64:67], v21 offset:11264
    ds_read_b128 v[68:71], v21 offset:11280
    ds_read_b128 v[72:75], v21 offset:16896
    ds_read_b128 v[76:79], v21 offset:16912
    s_waitcnt lgkmcnt(4)
    v_pk_add_f32 v[48:49], v[48:49], v[56:57]
    v_pk_add_f32 v[50:51], v[50:51], v[58:59]
    v_pk_add_f32 v[52:53], v[52:53], v[60:61]
    v_pk_add_f32 v[54:55], v[54:55], v[62:63]
    s_waitcnt lgkmcnt(0)
    v_pk_add_f32 v[64:65], v[64:65], v[72:73]
    v_pk_add_f32 v[66:67], v[66:67], v[74:75]
    v_pk_add_f32 v[68:69], v[68:69], v[76:77]
    v_pk_add_f32 v[70:71], v[70:71], v[78:79]
    v_pk_add_f32 v[48:49], v[48:49], v[64:65]
    v_pk_add_f32 v[50:51], v[50:51], v[66:67]
    v_pk_add_f32 v[52:53], v[52:53], v[68:69]
    v_pk_add_f32 v[54:55], v[54:55], v[70:71]
    v_mov_b32 v81, 0xff800000
    v_cndmask_b32 v48, v81, v48, s[64:65]
    v_cndmask_b32 v49, v81, v49, s[66:67]
    v_cndmask_b32 v50, v81, v50, s[68:69]
    v_cndmask_b32 v51, v81, v51, s[70:71]
    v_cndmask_b32 v52, v81, v52, s[72:73]
    v_cndmask_b32 v53, v81, v53, s[74:75]
    v_cndmask_b32 v54, v81, v54, s[76:77]
    v_cndmask_b32 v55, v81, v55, s[78:79]
    v_max3_f32 v80, v48, v49, v50
    v_max3_f32 v80, v80, v51, v52
    v_max3_f32 v80, v80, v53, v54
    v_max_f32 v80, v80, v55
    v_mov_b32 v81, 0xff800000
    v_cndmask_b32 v80, v81, v80, s[50:51]
    s_nop 1
    v_max_f32 v80, v80, v80 quad_perm:[1,0,3,2] row_mask:0xf bank_mask:0xf
    s_nop 1
    v_max_f32 v80, v80, v80 quad_perm:[2,3,0,1] row_mask:0xf bank_mask:0xf
    s_nop 1
    v_max_f32 v80, v80, v80 row_half_mirror row_mask:0xf bank_mask:0xf
    s_mov_b32 s24, 0x3dd53b95
    v_mul_f32 v80, s24, v80
    v_fma_f32 v48, v48, s24, -v80
    v_fma_f32 v49, v49, s24, -v80
    v_fma_f32 v50, v50, s24, -v80
    v_fma_f32 v51, v51, s24, -v80
    v_fma_f32 v52, v52, s24, -v80
    v_fma_f32 v53, v53, s24, -v80
    v_fma_f32 v54, v54, s24, -v80
    v_fma_f32 v55, v55, s24, -v80
    v_exp_f32 v48, v48
    v_exp_f32 v49, v49
    v_exp_f32 v50, v50
    v_exp_f32 v51, v51
    v_exp_f32 v52, v52
    v_exp_f32 v53, v53
    v_exp_f32 v54, v54
    v_exp_f32 v55, v55
    v_add_f32 v80, v48, v49
    v_add_f32 v81, v50, v51
    v_add_f32 v80, v80, v52
    v_add_f32 v81, v81, v53
    v_add_f32 v80, v80, v54
    v_add_f32 v81, v81, v55
    v_add_f32 v80, v80, v81
    v_cndmask_b32 v80, 0, v80, s[50:51]
    s_nop 1
    v_add_f32 v80, v80, v80 quad_perm:[1,0,3,2] row_mask:0xf bank_mask:0xf
    s_nop 1
    v_add_f32 v80, v80, v80 quad_perm:[2,3,0,1] row_mask:0xf bank_mask:0xf
    s_nop 1
    v_add_f32 v80, v80, v80 row_half_mirror row_mask:0xf bank_mask:0xf
    v_rcp_f32 v80, v80
    s_nop 0
    v_mul_f32 v48, v48, v80
    v_mul_f32 v49, v49, v80
    v_mul_f32 v50, v50, v80
    v_mul_f32 v51, v51, v80
    v_mul_f32 v52, v52, v80
    v_mul_f32 v53, v53, v80
    v_mul_f32 v54, v54, v80
    v_mul_f32 v55, v55, v80
    v_cvt_pk_bf16_f32 v56, v48, v49
    v_cvt_pk_bf16_f32 v57, v50, v51
    v_cvt_pk_bf16_f32 v58, v52, v53
    v_cvt_pk_bf16_f32 v59, v54, v55
    v_min_u32 v56, -2, v56
    v_min_u32 v57, -2, v57
    v_min_u32 v58, -2, v58
    v_min_u32 v59, -2, v59
    buffer_store_dwordx4 v[56:59], v22, s[8:11], s42 offen sc1
    s_add_u32 s42, s42, 458752
    s_waitcnt vmcnt(4)
    v_max3_u32 v58, v84, v85, v86
    v_max3_u32 v58, v58, v87, v88
    v_max3_u32 v58, v58, v89, v90
    v_max3_u32 v58, v58, v91, v92
    v_max_u32 v58, v58, v93
    v_cmp_eq_u32 vcc, -1, v58
    s_cbranch_vccz interleave_layers__linear_attn_block__memory_aug_recurrent_mem_tr__prompt_kernel_s_pmw0_out
    s_mov_b32 s61, 0
interleave_layers__linear_attn_block__memory_aug_recurrent_mem_tr__prompt_kernel_s_pmw0:
    buffer_load_dwordx4 v[84:87], v7, s[8:11], s47 offen sc1
    buffer_load_dwordx4 v[88:91], v7, s[8:11], s46 offen sc1
    buffer_load_dwordx2 v[92:93], v8, s[8:11], s47 offen sc1
    s_waitcnt vmcnt(0)
    v_max3_u32 v58, v84, v85, v86
    v_max3_u32 v58, v58, v87, v88
    v_max3_u32 v58, v58, v89, v90
    v_max3_u32 v58, v58, v91, v92
    v_max_u32 v58, v58, v93
    v_cmp_eq_u32 vcc, -1, v58
    s_add_u32 s61, s61, 1
    s_cbranch_vccz interleave_layers__linear_attn_block__memory_aug_recurrent_mem_tr__prompt_kernel_s_pmw0_out
    s_cmp_ge_u32 s61, s60
    s_cbranch_scc1 interleave_layers__linear_attn_block__memory_aug_recurrent_mem_tr__prompt_kernel_s_pmw0_to
    s_sleep 1
    s_branch interleave_layers__linear_attn_block__memory_aug_recurrent_mem_tr__prompt_kernel_s_pmw0
interleave_layers__linear_attn_block__memory_aug_recurrent_mem_tr__prompt_kernel_s_pmw0_to:
    s_mov_b32 s60, 1
interleave_layers__linear_attn_block__memory_aug_recurrent_mem_tr__prompt_kernel_s_pmw0_out:
    ds_write_b128 v7, v[84:87]
    ds_write_b128 v7, v[88:91] offset:4096
    ds_write_b64 v8, v[92:93]
interleave_layers__linear_attn_block__memory_aug_recurrent_mem_tr__prompt_kernel_s_gow0:
    ds_read_b128 v[68:71], v6 offset:0
    ds_read_b128 v[72:75], v6 offset:1024
    ds_read_b128 v[76:79], v6 offset:8192
    ds_read_b128 v[80:83], v6 offset:9216
    v_smfmac_f32_16x16x64_bf16 v[24:27], v[84:87], a[0:7], v4
    v_smfmac_f32_16x16x64_bf16 v[28:31], v[84:87], a[80:87], v4
    v_smfmac_f32_16x16x64_bf16 v[32:35], v[84:87], a[160:167], v4
    v_smfmac_f32_16x16x64_bf16 v[40:43], v[84:87], v[96:103], v4
    v_smfmac_f32_16x16x64_bf16 v[44:47], v[84:87], v[176:183], v4
    s_waitcnt lgkmcnt(2)
    v_smfmac_f32_16x16x64_bf16 v[36:39], v[84:87], v[68:75], v4
    ds_read_b128 v[68:71], v6 offset:2048
    ds_read_b128 v[72:75], v6 offset:3072
    s_barrier
    ds_read_b128 v[48:51], v5 offset:1024
    ds_read_b128 v[52:55], v5 offset:2048
    ds_read_b128 v[56:59], v5 offset:3072
    ds_read_b128 v[60:63], v5 offset:5120
    ds_read_b128 v[64:67], v5 offset:6144
    v_smfmac_f32_16x16x64_bf16 v[24:27], v[88:91], a[32:39], v4
    v_smfmac_f32_16x16x64_bf16 v[28:31], v[88:91], a[112:119], v4
    v_smfmac_f32_16x16x64_bf16 v[32:35], v[88:91], a[192:199], v4
    v_smfmac_f32_16x16x64_bf16 v[40:43], v[88:91], v[128:135], v4
    v_smfmac_f32_16x16x64_bf16 v[44:47], v[88:91], v[208:215], v4
    s_waitcnt lgkmcnt(7)
    v_smfmac_f32_16x16x64_bf16 v[36:39], v[88:91], v[76:83], v4
    ds_read_b128 v[76:79], v6 offset:4096
    ds_read_b128 v[80:83], v6 offset:5120
    s_waitcnt lgkmcnt(6)
    v_smfmac_f32_16x16x64_bf16 v[24:27], v[48:51], a[8:15], v4
    v_smfmac_f32_16x16x64_bf16 v[28:31], v[48:51], a[88:95], v4
    v_smfmac_f32_16x16x64_bf16 v[40:43], v[48:51], v[104:111], v4
    v_smfmac_f32_16x16x64_bf16 v[36:39], v[48:51], v[68:75], v4
    ds_read_b128 v[68:71], v6 offset:6144
    ds_read_b128 v[72:75], v6 offset:7168
    ds_read_b128 v[48:51], v5 offset:7168
    s_waitcnt lgkmcnt(8)
    v_smfmac_f32_16x16x64_bf16 v[24:27], v[52:55], a[16:23], v4
    v_smfmac_f32_16x16x64_bf16 v[28:31], v[52:55], a[96:103], v4
    v_smfmac_f32_16x16x64_bf16 v[40:43], v[52:55], v[112:119], v4
    s_waitcnt lgkmcnt(3)
    v_smfmac_f32_16x16x64_bf16 v[36:39], v[52:55], v[76:83], v4
    ds_read_b128 v[76:79], v6 offset:10240
    ds_read_b128 v[80:83], v6 offset:11264
    ds_read_b128 v[52:55], v5 offset:8192
    v_smfmac_f32_16x16x64_bf16 v[24:27], v[56:59], a[24:31], v4
    v_smfmac_f32_16x16x64_bf16 v[28:31], v[56:59], a[104:111], v4
    v_smfmac_f32_16x16x64_bf16 v[40:43], v[56:59], v[120:127], v4
    s_waitcnt lgkmcnt(4)
    v_smfmac_f32_16x16x64_bf16 v[36:39], v[56:59], v[68:75], v4
    ds_read_b128 v[68:71], v6 offset:12288
    ds_read_b128 v[72:75], v6 offset:13312
    ds_read_b128 v[56:59], v5 offset:9216
    v_smfmac_f32_16x16x64_bf16 v[24:27], v[60:63], a[40:47], v4
    v_smfmac_f32_16x16x64_bf16 v[28:31], v[60:63], a[120:127], v4
    v_smfmac_f32_16x16x64_bf16 v[40:43], v[60:63], v[136:143], v4
    s_waitcnt lgkmcnt(4)
    v_smfmac_f32_16x16x64_bf16 v[36:39], v[60:63], v[76:83], v4
    ds_read_b128 v[76:79], v6 offset:14336
    ds_read_b128 v[80:83], v6 offset:15360
    ds_read_b128 v[60:63], v5 offset:1024
    v_smfmac_f32_16x16x64_bf16 v[24:27], v[64:67], a[48:55], v4
    v_smfmac_f32_16x16x64_bf16 v[28:31], v[64:67], a[128:135], v4
    v_smfmac_f32_16x16x64_bf16 v[40:43], v[64:67], v[144:151], v4
    s_waitcnt lgkmcnt(4)
    v_smfmac_f32_16x16x64_bf16 v[36:39], v[64:67], v[68:75], v4
    ds_read_b128 v[68:71], v6 offset:16384
    ds_read_b128 v[72:75], v6 offset:17408
    ds_read_b128 v[64:67], v5 offset:2048
    v_smfmac_f32_16x16x64_bf16 v[24:27], v[48:51], a[56:63], v4
    v_smfmac_f32_16x16x64_bf16 v[28:31], v[48:51], a[136:143], v4
    v_smfmac_f32_16x16x64_bf16 v[40:43], v[48:51], v[152:159], v4
    s_waitcnt lgkmcnt(4)
    v_smfmac_f32_16x16x64_bf16 v[36:39], v[48:51], v[76:83], v4
    ds_read_b128 v[76:79], v6 offset:18432
    ds_read_b128 v[80:83], v6 offset:19456
    ds_read_b128 v[48:51], v5 offset:3072
    v_smfmac_f32_16x16x64_bf16 v[24:27], v[52:55], a[64:71], v4
    v_smfmac_f32_16x16x64_bf16 v[28:31], v[52:55], a[144:151], v4
    v_smfmac_f32_16x16x64_bf16 v[40:43], v[52:55], v[160:167], v4
    s_waitcnt lgkmcnt(4)
    v_smfmac_f32_16x16x64_bf16 v[36:39], v[52:55], v[68:75], v4
    ds_read_b128 v[52:55], v5 offset:5120
    v_smfmac_f32_16x16x64_bf16 v[24:27], v[56:59], a[72:79], v4
    v_smfmac_f32_16x16x64_bf16 v[28:31], v[56:59], a[152:159], v4
    v_smfmac_f32_16x16x64_bf16 v[40:43], v[56:59], v[168:175], v4
    s_waitcnt lgkmcnt(2)
    v_smfmac_f32_16x16x64_bf16 v[36:39], v[56:59], v[76:83], v4
    ds_read_b128 v[56:59], v5 offset:6144
    buffer_load_dwordx4 v[80:83], v19, s[8:11], s45 offen offset:0 sc1
    buffer_load_dwordx4 v[84:87], v19, s[8:11], s45 offen offset:1024 sc1
    buffer_load_dwordx4 v[88:91], v19, s[8:11], s45 offen offset:2048 sc1
    v_smfmac_f32_16x16x64_bf16 v[32:35], v[60:63], a[168:175], v4
    v_smfmac_f32_16x16x64_bf16 v[44:47], v[60:63], v[184:191], v4
    v_permlane32_swap_b32 v28, v40
    v_permlane32_swap_b32 v29, v41
    ds_read_b128 v[60:63], v5 offset:7168
    v_smfmac_f32_16x16x64_bf16 v[32:35], v[64:67], a[176:183], v4
    v_permlane32_swap_b32 v30, v42
    v_permlane32_swap_b32 v31, v43
    v_smfmac_f32_16x16x64_bf16 v[44:47], v[64:67], v[192:199], v4
    v_add_f32 v28, v28, v40
    v_add_f32 v29, v29, v41
    ds_read_b128 v[64:67], v5 offset:8192
    s_waitcnt lgkmcnt(4)
    v_smfmac_f32_16x16x64_bf16 v[32:35], v[48:51], a[184:191], v4
    v_add_f32 v30, v30, v42
    v_add_f32 v31, v31, v43
    v_smfmac_f32_16x16x64_bf16 v[44:47], v[48:51], v[200:207], v4
    v_cvt_pk_bf16_f32 v40, v28, v29
    v_cvt_pk_bf16_f32 v41, v30, v31
    ds_read_b128 v[48:51], v5 offset:9216
    s_waitcnt lgkmcnt(4)
    v_smfmac_f32_16x16x64_bf16 v[32:35], v[52:55], a[200:207], v4
    v_mfma_f32_16x16x16_bf16 v[28:31], v[40:41], v[10:11], 0
    v_permlane32_swap_b32 v24, v36
    v_smfmac_f32_16x16x64_bf16 v[44:47], v[52:55], v[216:223], v4
    v_permlane32_swap_b32 v25, v37
    v_permlane32_swap_b32 v26, v38
    s_waitcnt lgkmcnt(3)
    v_smfmac_f32_16x16x64_bf16 v[32:35], v[56:59], a[208:215], v4
    v_permlane32_swap_b32 v27, v39
    v_add_f32 v24, v24, v36
    v_smfmac_f32_16x16x64_bf16 v[44:47], v[56:59], v[224:231], v4
    v_add_f32 v25, v25, v37
    v_add_f32 v26, v26, v38
    s_waitcnt lgkmcnt(2)
    v_smfmac_f32_16x16x64_bf16 v[32:35], v[60:63], a[216:223], v4
    v_add_f32 v27, v27, v39
    v_cvt_pk_bf16_f32 v36, v24, v25
    v_smfmac_f32_16x16x64_bf16 v[44:47], v[60:63], v[232:239], v4
    v_cvt_pk_bf16_f32 v37, v26, v27
    s_nop 1
    v_mfma_f32_16x16x16_bf16 v[24:27], v[36:37], v[10:11], 0
    s_waitcnt lgkmcnt(1)
    v_smfmac_f32_16x16x64_bf16 v[32:35], v[64:67], a[224:231], v4
    s_nop 5
    v_cvt_pk_bf16_f32 v24, v24, v25
    v_smfmac_f32_16x16x64_bf16 v[44:47], v[64:67], v[240:247], v4
    v_cvt_pk_bf16_f32 v25, v26, v27
    v_cvt_pk_bf16_f32 v26, v28, v29
    s_waitcnt lgkmcnt(0)
    v_smfmac_f32_16x16x64_bf16 v[32:35], v[48:51], a[232:239], v4
    v_cvt_pk_bf16_f32 v27, v30, v31
    s_waitcnt vmcnt(4)
    v_smfmac_f32_16x16x64_bf16 v[44:47], v[48:51], v[248:255], v4
    v_mfma_f32_16x16x32_bf16 v[28:31], a[240:243], v[24:27], 0
    v_mfma_f32_16x16x32_bf16 v[36:39], a[244:247], v[24:27], 0
    v_mfma_f32_16x16x32_bf16 v[40:43], v[24:27], v[24:27], 0
    s_nop 4
    v_permlane32_swap_b32 v32, v44
    v_permlane32_swap_b32 v33, v45
    v_permlane32_swap_b32 v34, v46
    v_permlane32_swap_b32 v35, v47
    v_add_f32 v32, v32, v44
    v_add_f32 v33, v33, v45
    v_add_f32 v34, v34, v46
    v_add_f32 v35, v35, v47
    v_cvt_pk_bf16_f32 v44, v32, v33
    v_cvt_pk_bf16_f32 v45, v34, v35
    s_nop 1
    v_mfma_f32_16x16x16_bf16 v[32:35], v[44:45], v[10:11], 0
    s_nop 7
    v_cvt_pk_bf16_f32 v32, v32, v33
    v_cvt_pk_bf16_f32 v33, v34, v35
    s_nop 1
    v_mfma_f32_16x16x16_bf16 v[28:31], a[248:249], v[32:33], v[28:31]
    v_mfma_f32_16x16x16_bf16 v[36:39], a[250:251], v[32:33], v[36:39]
    v_mfma_f32_16x16x16_bf16 v[40:43], v[32:33], v[32:33], v[40:43]
    buffer_atomic_add v0, v20, s[8:11], s49 offen
    s_nop 4
    ds_write_b128 v12, v[28:31]
    ds_write_b128 v12, v[36:39] offset:16
    ds_write_b128 v13, v[40:43]
    s_waitcnt lgkmcnt(0)
    s_barrier
    ds_read_b128 v[48:51], v14 offset:0
    ds_read_b128 v[52:55], v14 offset:16
    ds_read_b128 v[56:59], v14 offset:1408
    ds_read_b128 v[60:63], v14 offset:1424
    ds_read_b128 v[64:67], v14 offset:2816
    ds_read_b128 v[68:71], v14 offset:2832
    ds_read_b128 v[72:75], v14 offset:4224
    ds_read_b128 v[76:79], v14 offset:4240
    s_waitcnt lgkmcnt(4)
    v_pk_add_f32 v[48:49], v[48:49], v[56:57]
    v_pk_add_f32 v[50:51], v[50:51], v[58:59]
    v_pk_add_f32 v[52:53], v[52:53], v[60:61]
    v_pk_add_f32 v[54:55], v[54:55], v[62:63]
    s_waitcnt lgkmcnt(0)
    v_pk_add_f32 v[64:65], v[64:65], v[72:73]
    v_pk_add_f32 v[66:67], v[66:67], v[74:75]
    v_pk_add_f32 v[68:69], v[68:69], v[76:77]
    v_pk_add_f32 v[70:71], v[70:71], v[78:79]
    v_pk_add_f32 v[48:49], v[48:49], v[64:65]
    v_pk_add_f32 v[50:51], v[50:51], v[66:67]
    v_pk_add_f32 v[52:53], v[52:53], v[68:69]
    v_pk_add_f32 v[54:55], v[54:55], v[70:71]
    v_max3_f32 v92, v48, v49, v50
    v_max3_f32 v92, v92, v51, v52
    v_max3_f32 v92, v92, v53, v54
    v_max_f32 v92, v92, v55
    v_mov_b32 v93, 0xff800000
    v_cndmask_b32 v92, v93, v92, s[50:51]
    s_nop 1
    v_max_f32 v92, v92, v92 quad_perm:[1,0,3,2] row_mask:0xf bank_mask:0xf
    s_nop 1
    v_max_f32 v92, v92, v92 quad_perm:[2,3,0,1] row_mask:0xf bank_mask:0xf
    s_nop 1
    v_max_f32 v92, v92, v92 row_half_mirror row_mask:0xf bank_mask:0xf
    s_mov_b32 s24, 0x3dd53b95
    v_mul_f32 v92, s24, v92
    v_fma_f32 v48, v48, s24, -v92
    v_fma_f32 v49, v49, s24, -v92
    v_fma_f32 v50, v50, s24, -v92
    v_fma_f32 v51, v51, s24, -v92
    v_fma_f32 v52, v52, s24, -v92
    v_fma_f32 v53, v53, s24, -v92
    v_fma_f32 v54, v54, s24, -v92
    v_fma_f32 v55, v55, s24, -v92
    v_exp_f32 v48, v48
    v_exp_f32 v49, v49
    v_exp_f32 v50, v50
    v_exp_f32 v51, v51
    v_exp_f32 v52, v52
    v_exp_f32 v53, v53
    v_exp_f32 v54, v54
    v_exp_f32 v55, v55
    v_add_f32 v92, v48, v49
    v_add_f32 v93, v50, v51
    v_add_f32 v92, v92, v52
    v_add_f32 v93, v93, v53
    v_add_f32 v92, v92, v54
    v_add_f32 v93, v93, v55
    v_add_f32 v92, v92, v93
    v_cndmask_b32 v92, 0, v92, s[50:51]
    s_nop 1
    v_add_f32 v92, v92, v92 quad_perm:[1,0,3,2] row_mask:0xf bank_mask:0xf
    s_nop 1
    v_add_f32 v92, v92, v92 quad_perm:[2,3,0,1] row_mask:0xf bank_mask:0xf
    s_nop 1
    v_add_f32 v92, v92, v92 row_half_mirror row_mask:0xf bank_mask:0xf
    v_rcp_f32 v92, v92
    s_nop 0
    v_mul_f32 v48, v48, v92
    v_mul_f32 v49, v49, v92
    v_mul_f32 v50, v50, v92
    v_mul_f32 v51, v51, v92
    v_mul_f32 v52, v52, v92
    v_mul_f32 v53, v53, v92
    v_mul_f32 v54, v54, v92
    v_mul_f32 v55, v55, v92
    v_cvt_pk_bf16_f32 v56, v48, v49
    v_cvt_pk_bf16_f32 v57, v50, v51
    v_cvt_pk_bf16_f32 v58, v52, v53
    v_cvt_pk_bf16_f32 v59, v54, v55
    v_min_u32 v56, -2, v56
    v_min_u32 v57, -2, v57
    v_min_u32 v58, -2, v58
    v_min_u32 v59, -2, v59
    buffer_store_dwordx4 v[56:59], v15, s[8:11], s43 offen sc1
    s_waitcnt vmcnt(2)
    v_mfma_f32_16x16x32_bf16 v[36:39], a[240:243], v[80:83], 0
    v_mfma_f32_16x16x32_bf16 v[44:47], a[244:247], v[80:83], 0
    v_mfma_f32_16x16x32_bf16 v[68:71], v[24:27], v[80:83], 0
    v_mfma_f32_16x16x32_bf16 v[40:43], a[240:243], v[84:87], 0
    v_mfma_f32_16x16x32_bf16 v[64:67], a[244:247], v[84:87], 0
    v_mfma_f32_16x16x32_bf16 v[72:75], v[24:27], v[84:87], 0
    s_nop 0
    v_mfma_f32_16x16x16_bf16 v[36:39], a[248:249], v[88:89], v[36:39]
    v_mfma_f32_16x16x16_bf16 v[44:47], a[250:251], v[88:89], v[44:47]
    v_mfma_f32_16x16x16_bf16 v[68:71], v[32:33], v[88:89], v[68:71]
    v_mfma_f32_16x16x16_bf16 v[40:43], a[248:249], v[90:91], v[40:43]
    v_mfma_f32_16x16x16_bf16 v[64:67], a[250:251], v[90:91], v[64:67]
    v_mfma_f32_16x16x16_bf16 v[72:75], v[32:33], v[90:91], v[72:75]
    s_nop 2
    ds_write_b128 v16, v[36:39] offset:0
    ds_write_b128 v16, v[44:47] offset:16
    ds_write_b128 v17, v[68:71]
    ds_write_b128 v16, v[40:43] offset:2816
    ds_write_b128 v16, v[64:67] offset:2832
    ds_write_b128 v18, v[72:75]
    s_add_u32 s40, s40, 1
    s_add_u32 s41, s41, 393216
    s_add_u32 s45, s45, 393216
    s_add_u32 s43, s43, 458752
    s_add_u32 s47, s47, 458752
    s_add_u32 s48, s48, 458752
    s_add_u32 s49, s49, 458752
    s_waitcnt lgkmcnt(0)
    s_barrier
    s_cmp_lt_u32 s40, 64
    s_cbranch_scc1 interleave_layers__linear_attn_block__memory_aug_recurrent_mem_tr__prompt_kernel_s_stepw0
    s_branch interleave_layers__linear_attn_block__memory_aug_recurrent_mem_tr__prompt_kernel_s_end
interleave_layers__linear_attn_block__memory_aug_recurrent_mem_tr__prompt_kernel_s_stepw1:
    v_mov_b32 v24, 0
    v_mov_b32 v25, 0
    v_mov_b32 v26, 0
    v_mov_b32 v27, 0
    v_mov_b32 v28, 0
    v_mov_b32 v29, 0
    v_mov_b32 v30, 0
    v_mov_b32 v31, 0
    v_mov_b32 v32, 0
    v_mov_b32 v33, 0
    v_mov_b32 v34, 0
    v_mov_b32 v35, 0
    v_mov_b32 v36, 0
    v_mov_b32 v37, 0
    v_mov_b32 v38, 0
    v_mov_b32 v39, 0
    v_mov_b32 v40, 0
    v_mov_b32 v41, 0
    v_mov_b32 v42, 0
    v_mov_b32 v43, 0
    v_mov_b32 v44, 0
    v_mov_b32 v45, 0
    v_mov_b32 v46, 0
    v_mov_b32 v47, 0
    s_add_u32 s46, s47, 4096
    s_lshl_b32 s95, s92, 6
    s_add_u32 s95, s95, s40
    s_add_u32 s95, s95, 1
    s_cmp_ge_i32 s59, s95
    s_cbranch_scc1 interleave_layers__linear_attn_block__memory_aug_recurrent_mem_tr__prompt_kernel_s_ecw1_ok
    s_and_b32 s24, s2, 7
    s_lshl_b32 s24, s24, 7
    s_add_u32 s24, s24, 23109632
    v_and_b32 v49, 3, v1
    v_lshl_add_u32 v49, v49, 2, s24
    s_mov_b32 s61, 0
interleave_layers__linear_attn_block__memory_aug_recurrent_mem_tr__prompt_kernel_s_ecw1:
    buffer_load_dword v48, v49, s[8:11], 0 offen sc1
    s_waitcnt vmcnt(0)
    v_readlane_b32 s59, v48, 0
    v_readlane_b32 s24, v48, 1
    s_min_i32 s59, s59, s24
    v_readlane_b32 s24, v48, 2
    s_min_i32 s59, s59, s24
    s_cmp_ge_i32 s59, s95
    s_cbranch_scc1 interleave_layers__linear_attn_block__memory_aug_recurrent_mem_tr__prompt_kernel_s_ecw1_ok
    s_add_u32 s61, s61, 1
    s_cmp_ge_u32 s61, s60
    s_cbranch_scc1 interleave_layers__linear_attn_block__memory_aug_recurrent_mem_tr__prompt_kernel_s_ecw1_to
    s_sleep 2
    s_branch interleave_layers__linear_attn_block__memory_aug_recurrent_mem_tr__prompt_kernel_s_ecw1
interleave_layers__linear_attn_block__memory_aug_recurrent_mem_tr__prompt_kernel_s_ecw1_to:
    s_mov_b32 s60, 1
interleave_layers__linear_attn_block__memory_aug_recurrent_mem_tr__prompt_kernel_s_ecw1_ok:
    s_add_u32 s63, s40, 1
    s_cmp_ge_i32 s62, s63
    s_cbranch_scc1 interleave_layers__linear_attn_block__memory_aug_recurrent_mem_tr__prompt_kernel_s_enw1_ok
    s_mov_b32 s61, 0
interleave_layers__linear_attn_block__memory_aug_recurrent_mem_tr__prompt_kernel_s_enw1:
    buffer_load_dword v48, v9, s[8:11], 0 offen sc1
    s_waitcnt vmcnt(0)
    v_readlane_b32 s62, v48, 0
    v_readlane_b32 s24, v48, 1
    s_min_i32 s62, s62, s24
    s_cmp_ge_i32 s62, s63
    s_cbranch_scc1 interleave_layers__linear_attn_block__memory_aug_recurrent_mem_tr__prompt_kernel_s_enw1_ok
    s_add_u32 s61, s61, 1
    s_cmp_ge_u32 s61, s60
    s_cbranch_scc1 interleave_layers__linear_attn_block__memory_aug_recurrent_mem_tr__prompt_kernel_s_enw1_to
    s_sleep 2
    s_branch interleave_layers__linear_attn_block__memory_aug_recurrent_mem_tr__prompt_kernel_s_enw1
interleave_layers__linear_attn_block__memory_aug_recurrent_mem_tr__prompt_kernel_s_enw1_to:
    s_mov_b32 s60, 1
interleave_layers__linear_attn_block__memory_aug_recurrent_mem_tr__prompt_kernel_s_enw1_ok:
    s_sleep 5
    s_mov_b64 exec, 1
    s_mov_b32 s61, 0
    v_mov_b32 v83, 0
    buffer_atomic_add v83, v23, s[8:11], s48 offen sc0
    s_sleep 3
    v_mov_b32 v94, 0
    buffer_atomic_add v94, v23, s[8:11], s48 offen sc0
    s_sleep 3
    v_mov_b32 v95, 0
    buffer_atomic_add v95, v23, s[8:11], s48 offen sc0
    s_sleep 3
interleave_layers__linear_attn_block__memory_aug_recurrent_mem_tr__prompt_kernel_s_prw1:
    v_mov_b32 v82, 0
    buffer_atomic_add v82, v23, s[8:11], s48 offen sc0
    s_waitcnt vmcnt(3)
    v_cmp_le_i32 vcc, 8, v83
    s_add_u32 s61, s61, 1
    s_cbranch_vccnz interleave_layers__linear_attn_block__memory_aug_recurrent_mem_tr__prompt_kernel_s_prw1_out
    s_sleep 3
    v_mov_b32 v83, 0
    buffer_atomic_add v83, v23, s[8:11], s48 offen sc0
    s_waitcnt vmcnt(3)
    v_cmp_le_i32 vcc, 8, v94
    s_add_u32 s61, s61, 1
    s_cbranch_vccnz interleave_layers__linear_attn_block__memory_aug_recurrent_mem_tr__prompt_kernel_s_prw1_out
    s_sleep 3
    v_mov_b32 v94, 0
    buffer_atomic_add v94, v23, s[8:11], s48 offen sc0
    s_waitcnt vmcnt(3)
    v_cmp_le_i32 vcc, 8, v95
    s_add_u32 s61, s61, 1
    s_cbranch_vccnz interleave_layers__linear_attn_block__memory_aug_recurrent_mem_tr__prompt_kernel_s_prw1_out
    s_sleep 3
    v_mov_b32 v95, 0
    buffer_atomic_add v95, v23, s[8:11], s48 offen sc0
    s_waitcnt vmcnt(3)
    v_cmp_le_i32 vcc, 8, v82
    s_add_u32 s61, s61, 1
    s_cbranch_vccnz interleave_layers__linear_attn_block__memory_aug_recurrent_mem_tr__prompt_kernel_s_prw1_out
    s_sleep 3
    s_cmp_ge_u32 s61, s60
    s_cbranch_scc0 interleave_layers__linear_attn_block__memory_aug_recurrent_mem_tr__prompt_kernel_s_prw1
    s_mov_b32 s60, 1
interleave_layers__linear_attn_block__memory_aug_recurrent_mem_tr__prompt_kernel_s_prw1_out:
    s_mov_b64 exec, -1
    buffer_load_dwordx4 v[84:87], v7, s[8:11], s47 offen sc1
    buffer_load_dwordx4 v[88:91], v7, s[8:11], s46 offen sc1
    buffer_load_dwordx2 v[92:93], v8, s[8:11], s47 offen sc1
    buffer_load_dwordx4 a[240:243], v19, s[8:11], s41 offen offset:0 sc1
    buffer_load_dwordx4 a[244:247], v19, s[8:11], s41 offen offset:1024 sc1
    buffer_load_dwordx4 a[248:251], v19, s[8:11], s41 offen offset:2048 sc1
    ds_read_b128 v[48:51], v21 offset:0
    ds_read_b128 v[52:55], v21 offset:16
    ds_read_b128 v[56:59], v21 offset:5632
    ds_read_b128 v[60:63], v21 offset:5648
    ds_read_b128 v[64:67], v21 offset:11264
    ds_read_b128 v[68:71], v21 offset:11280
    ds_read_b128 v[72:75], v21 offset:16896
    ds_read_b128 v[76:79], v21 offset:16912
    s_waitcnt lgkmcnt(4)
    v_pk_add_f32 v[48:49], v[48:49], v[56:57]
    v_pk_add_f32 v[50:51], v[50:51], v[58:59]
    v_pk_add_f32 v[52:53], v[52:53], v[60:61]
    v_pk_add_f32 v[54:55], v[54:55], v[62:63]
    s_waitcnt lgkmcnt(0)
    v_pk_add_f32 v[64:65], v[64:65], v[72:73]
    v_pk_add_f32 v[66:67], v[66:67], v[74:75]
    v_pk_add_f32 v[68:69], v[68:69], v[76:77]
    v_pk_add_f32 v[70:71], v[70:71], v[78:79]
    v_pk_add_f32 v[48:49], v[48:49], v[64:65]
    v_pk_add_f32 v[50:51], v[50:51], v[66:67]
    v_pk_add_f32 v[52:53], v[52:53], v[68:69]
    v_pk_add_f32 v[54:55], v[54:55], v[70:71]
    v_mov_b32 v81, 0xff800000
    v_cndmask_b32 v48, v81, v48, s[64:65]
    v_cndmask_b32 v49, v81, v49, s[66:67]
    v_cndmask_b32 v50, v81, v50, s[68:69]
    v_cndmask_b32 v51, v81, v51, s[70:71]
    v_cndmask_b32 v52, v81, v52, s[72:73]
    v_cndmask_b32 v53, v81, v53, s[74:75]
    v_cndmask_b32 v54, v81, v54, s[76:77]
    v_cndmask_b32 v55, v81, v55, s[78:79]
    v_max3_f32 v80, v48, v49, v50
    v_max3_f32 v80, v80, v51, v52
    v_max3_f32 v80, v80, v53, v54
    v_max_f32 v80, v80, v55
    v_mov_b32 v81, 0xff800000
    v_cndmask_b32 v80, v81, v80, s[50:51]
    s_nop 1
    v_max_f32 v80, v80, v80 quad_perm:[1,0,3,2] row_mask:0xf bank_mask:0xf
    s_nop 1
    v_max_f32 v80, v80, v80 quad_perm:[2,3,0,1] row_mask:0xf bank_mask:0xf
    s_nop 1
    v_max_f32 v80, v80, v80 row_half_mirror row_mask:0xf bank_mask:0xf
    s_mov_b32 s24, 0x3dd53b95
    v_mul_f32 v80, s24, v80
    v_fma_f32 v48, v48, s24, -v80
    v_fma_f32 v49, v49, s24, -v80
    v_fma_f32 v50, v50, s24, -v80
    v_fma_f32 v51, v51, s24, -v80
    v_fma_f32 v52, v52, s24, -v80
    v_fma_f32 v53, v53, s24, -v80
    v_fma_f32 v54, v54, s24, -v80
    v_fma_f32 v55, v55, s24, -v80
    v_exp_f32 v48, v48
    v_exp_f32 v49, v49
    v_exp_f32 v50, v50
    v_exp_f32 v51, v51
    v_exp_f32 v52, v52
    v_exp_f32 v53, v53
    v_exp_f32 v54, v54
    v_exp_f32 v55, v55
    v_add_f32 v80, v48, v49
    v_add_f32 v81, v50, v51
    v_add_f32 v80, v80, v52
    v_add_f32 v81, v81, v53
    v_add_f32 v80, v80, v54
    v_add_f32 v81, v81, v55
    v_add_f32 v80, v80, v81
    v_cndmask_b32 v80, 0, v80, s[50:51]
    s_nop 1
    v_add_f32 v80, v80, v80 quad_perm:[1,0,3,2] row_mask:0xf bank_mask:0xf
    s_nop 1
    v_add_f32 v80, v80, v80 quad_perm:[2,3,0,1] row_mask:0xf bank_mask:0xf
    s_nop 1
    v_add_f32 v80, v80, v80 row_half_mirror row_mask:0xf bank_mask:0xf
    v_rcp_f32 v80, v80
    s_nop 0
    v_mul_f32 v48, v48, v80
    v_mul_f32 v49, v49, v80
    v_mul_f32 v50, v50, v80
    v_mul_f32 v51, v51, v80
    v_mul_f32 v52, v52, v80
    v_mul_f32 v53, v53, v80
    v_mul_f32 v54, v54, v80
    v_mul_f32 v55, v55, v80
    v_cvt_pk_bf16_f32 v56, v48, v49
    v_cvt_pk_bf16_f32 v57, v50, v51
    v_cvt_pk_bf16_f32 v58, v52, v53
    v_cvt_pk_bf16_f32 v59, v54, v55
    v_min_u32 v56, -2, v56
    v_min_u32 v57, -2, v57
    v_min_u32 v58, -2, v58
    v_min_u32 v59, -2, v59
    buffer_store_dwordx4 v[56:59], v22, s[8:11], s42 offen sc1
    s_add_u32 s42, s42, 458752
    s_waitcnt vmcnt(4)
    v_max3_u32 v58, v84, v85, v86
    v_max3_u32 v58, v58, v87, v88
    v_max3_u32 v58, v58, v89, v90
    v_max3_u32 v58, v58, v91, v92
    v_max_u32 v58, v58, v93
    v_cmp_eq_u32 vcc, -1, v58
    s_cbranch_vccz interleave_layers__linear_attn_block__memory_aug_recurrent_mem_tr__prompt_kernel_s_pmw1_out
    s_mov_b32 s61, 0
interleave_layers__linear_attn_block__memory_aug_recurrent_mem_tr__prompt_kernel_s_pmw1:
    buffer_load_dwordx4 v[84:87], v7, s[8:11], s47 offen sc1
    buffer_load_dwordx4 v[88:91], v7, s[8:11], s46 offen sc1
    buffer_load_dwordx2 v[92:93], v8, s[8:11], s47 offen sc1
    s_waitcnt vmcnt(0)
    v_max3_u32 v58, v84, v85, v86
    v_max3_u32 v58, v58, v87, v88
    v_max3_u32 v58, v58, v89, v90
    v_max3_u32 v58, v58, v91, v92
    v_max_u32 v58, v58, v93
    v_cmp_eq_u32 vcc, -1, v58
    s_add_u32 s61, s61, 1
    s_cbranch_vccz interleave_layers__linear_attn_block__memory_aug_recurrent_mem_tr__prompt_kernel_s_pmw1_out
    s_cmp_ge_u32 s61, s60
    s_cbranch_scc1 interleave_layers__linear_attn_block__memory_aug_recurrent_mem_tr__prompt_kernel_s_pmw1_to
    s_sleep 1
    s_branch interleave_layers__linear_attn_block__memory_aug_recurrent_mem_tr__prompt_kernel_s_pmw1
interleave_layers__linear_attn_block__memory_aug_recurrent_mem_tr__prompt_kernel_s_pmw1_to:
    s_mov_b32 s60, 1
interleave_layers__linear_attn_block__memory_aug_recurrent_mem_tr__prompt_kernel_s_pmw1_out:
    ds_write_b128 v7, v[84:87]
    ds_write_b128 v7, v[88:91] offset:4096
    ds_write_b64 v8, v[92:93]
interleave_layers__linear_attn_block__memory_aug_recurrent_mem_tr__prompt_kernel_s_gow1:
    ds_read_b128 v[68:71], v6 offset:2048
    ds_read_b128 v[72:75], v6 offset:3072
    ds_read_b128 v[76:79], v6 offset:10240
    ds_read_b128 v[80:83], v6 offset:11264
    v_smfmac_f32_16x16x64_bf16 v[24:27], v[84:87], a[8:15], v4
    v_smfmac_f32_16x16x64_bf16 v[28:31], v[84:87], a[88:95], v4
    v_smfmac_f32_16x16x64_bf16 v[32:35], v[84:87], a[168:175], v4
    v_smfmac_f32_16x16x64_bf16 v[40:43], v[84:87], v[104:111], v4
    v_smfmac_f32_16x16x64_bf16 v[44:47], v[84:87], v[184:191], v4
    s_waitcnt lgkmcnt(2)
    v_smfmac_f32_16x16x64_bf16 v[36:39], v[84:87], v[68:75], v4
    ds_read_b128 v[68:71], v6 offset:0
    ds_read_b128 v[72:75], v6 offset:1024
    s_barrier
    ds_read_b128 v[48:51], v5 offset:0
    ds_read_b128 v[52:55], v5 offset:2048
    ds_read_b128 v[56:59], v5 offset:3072
    ds_read_b128 v[60:63], v5 offset:4096
    ds_read_b128 v[64:67], v5 offset:6144
    v_smfmac_f32_16x16x64_bf16 v[24:27], v[88:91], a[40:47], v4
    v_smfmac_f32_16x16x64_bf16 v[28:31], v[88:91], a[120:127], v4
    v_smfmac_f32_16x16x64_bf16 v[32:35], v[88:91], a[200:207], v4
    v_smfmac_f32_16x16x64_bf16 v[40:43], v[88:91], v[136:143], v4
    v_smfmac_f32_16x16x64_bf16 v[44:47], v[88:91], v[216:223], v4
    s_waitcnt lgkmcnt(7)
    v_smfmac_f32_16x16x64_bf16 v[36:39], v[88:91], v[76:83], v4
    ds_read_b128 v[76:79], v6 offset:4096
    ds_read_b128 v[80:83], v6 offset:5120
    s_waitcnt lgkmcnt(6)
    v_smfmac_f32_16x16x64_bf16 v[24:27], v[48:51], a[0:7], v4
    v_smfmac_f32_16x16x64_bf16 v[28:31], v[48:51], a[80:87], v4
    v_smfmac_f32_16x16x64_bf16 v[40:43], v[48:51], v[96:103], v4
    v_smfmac_f32_16x16x64_bf16 v[36:39], v[48:51], v[68:75], v4
    ds_read_b128 v[68:71], v6 offset:6144
    ds_read_b128 v[72:75], v6 offset:7168
    ds_read_b128 v[48:51], v5 offset:7168
    s_waitcnt lgkmcnt(8)
    v_smfmac_f32_16x16x64_bf16 v[24:27], v[52:55], a[16:23], v4
    v_smfmac_f32_16x16x64_bf16 v[28:31], v[52:55], a[96:103], v4
    v_smfmac_f32_16x16x64_bf16 v[40:43], v[52:55], v[112:119], v4
    s_waitcnt lgkmcnt(3)
    v_smfmac_f32_16x16x64_bf16 v[36:39], v[52:55], v[76:83], v4
    ds_read_b128 v[76:79], v6 offset:8192
    ds_read_b128 v[80:83], v6 offset:9216
    ds_read_b128 v[52:55], v5 offset:8192
    v_smfmac_f32_16x16x64_bf16 v[24:27], v[56:59], a[24:31], v4
    v_smfmac_f32_16x16x64_bf16 v[28:31], v[56:59], a[104:111], v4
    v_smfmac_f32_16x16x64_bf16 v[40:43], v[56:59], v[120:127], v4
    s_waitcnt lgkmcnt(4)
    v_smfmac_f32_16x16x64_bf16 v[36:39], v[56:59], v[68:75], v4
    ds_read_b128 v[68:71], v6 offset:12288
    ds_read_b128 v[72:75], v6 offset:13312
    ds_read_b128 v[56:59], v5 offset:9216
    v_smfmac_f32_16x16x64_bf16 v[24:27], v[60:63], a[32:39], v4
    v_smfmac_f32_16x16x64_bf16 v[28:31], v[60:63], a[112:119], v4
    v_smfmac_f32_16x16x64_bf16 v[40:43], v[60:63], v[128:135], v4
    s_waitcnt lgkmcnt(4)
    v_smfmac_f32_16x16x64_bf16 v[36:39], v[60:63], v[76:83], v4
    ds_read_b128 v[76:79], v6 offset:14336
    ds_read_b128 v[80:83], v6 offset:15360
    ds_read_b128 v[60:63], v5 offset:0
    v_smfmac_f32_16x16x64_bf16 v[24:27], v[64:67], a[48:55], v4
    v_smfmac_f32_16x16x64_bf16 v[28:31], v[64:67], a[128:135], v4
    v_smfmac_f32_16x16x64_bf16 v[40:43], v[64:67], v[144:151], v4
    s_waitcnt lgkmcnt(4)
    v_smfmac_f32_16x16x64_bf16 v[36:39], v[64:67], v[68:75], v4
    ds_read_b128 v[68:71], v6 offset:16384
    ds_read_b128 v[72:75], v6 offset:17408
    ds_read_b128 v[64:67], v5 offset:2048
    v_smfmac_f32_16x16x64_bf16 v[24:27], v[48:51], a[56:63], v4
    v_smfmac_f32_16x16x64_bf16 v[28:31], v[48:51], a[136:143], v4
    v_smfmac_f32_16x16x64_bf16 v[40:43], v[48:51], v[152:159], v4
    s_waitcnt lgkmcnt(4)
    v_smfmac_f32_16x16x64_bf16 v[36:39], v[48:51], v[76:83], v4
    ds_read_b128 v[76:79], v6 offset:18432
    ds_read_b128 v[80:83], v6 offset:19456
    ds_read_b128 v[48:51], v5 offset:3072
    v_smfmac_f32_16x16x64_bf16 v[24:27], v[52:55], a[64:71], v4
    v_smfmac_f32_16x16x64_bf16 v[28:31], v[52:55], a[144:151], v4
    v_smfmac_f32_16x16x64_bf16 v[40:43], v[52:55], v[160:167], v4
    s_waitcnt lgkmcnt(4)
    v_smfmac_f32_16x16x64_bf16 v[36:39], v[52:55], v[68:75], v4
    ds_read_b128 v[52:55], v5 offset:4096
    v_smfmac_f32_16x16x64_bf16 v[24:27], v[56:59], a[72:79], v4
    v_smfmac_f32_16x16x64_bf16 v[28:31], v[56:59], a[152:159], v4
    v_smfmac_f32_16x16x64_bf16 v[40:43], v[56:59], v[168:175], v4
    s_waitcnt lgkmcnt(2)
    v_smfmac_f32_16x16x64_bf16 v[36:39], v[56:59], v[76:83], v4
    ds_read_b128 v[56:59], v5 offset:6144
    buffer_load_dwordx4 v[80:83], v19, s[8:11], s45 offen offset:0 sc1
    buffer_load_dwordx4 v[84:87], v19, s[8:11], s45 offen offset:1024 sc1
    buffer_load_dwordx4 v[88:91], v19, s[8:11], s45 offen offset:2048 sc1
    v_smfmac_f32_16x16x64_bf16 v[32:35], v[60:63], a[160:167], v4
    v_smfmac_f32_16x16x64_bf16 v[44:47], v[60:63], v[176:183], v4
    v_permlane32_swap_b32 v28, v40
    v_permlane32_swap_b32 v29, v41
    ds_read_b128 v[60:63], v5 offset:7168
    v_smfmac_f32_16x16x64_bf16 v[32:35], v[64:67], a[176:183], v4
    v_permlane32_swap_b32 v30, v42
    v_permlane32_swap_b32 v31, v43
    v_smfmac_f32_16x16x64_bf16 v[44:47], v[64:67], v[192:199], v4
    v_add_f32 v28, v28, v40
    v_add_f32 v29, v29, v41
    ds_read_b128 v[64:67], v5 offset:8192
    s_waitcnt lgkmcnt(4)
    v_smfmac_f32_16x16x64_bf16 v[32:35], v[48:51], a[184:191], v4
    v_add_f32 v30, v30, v42
    v_add_f32 v31, v31, v43
    v_smfmac_f32_16x16x64_bf16 v[44:47], v[48:51], v[200:207], v4
    v_cvt_pk_bf16_f32 v40, v28, v29
    v_cvt_pk_bf16_f32 v41, v30, v31
    ds_read_b128 v[48:51], v5 offset:9216
    s_waitcnt lgkmcnt(4)
    v_smfmac_f32_16x16x64_bf16 v[32:35], v[52:55], a[192:199], v4
    v_mfma_f32_16x16x16_bf16 v[28:31], v[40:41], v[10:11], 0
    v_permlane32_swap_b32 v24, v36
    v_smfmac_f32_16x16x64_bf16 v[44:47], v[52:55], v[208:215], v4
    v_permlane32_swap_b32 v25, v37
    v_permlane32_swap_b32 v26, v38
    s_waitcnt lgkmcnt(3)
    v_smfmac_f32_16x16x64_bf16 v[32:35], v[56:59], a[208:215], v4
    v_permlane32_swap_b32 v27, v39
    v_add_f32 v24, v24, v36
    v_smfmac_f32_16x16x64_bf16 v[44:47], v[56:59], v[224:231], v4
    v_add_f32 v25, v25, v37
    v_add_f32 v26, v26, v38
    s_waitcnt lgkmcnt(2)
    v_smfmac_f32_16x16x64_bf16 v[32:35], v[60:63], a[216:223], v4
    v_add_f32 v27, v27, v39
    v_cvt_pk_bf16_f32 v36, v24, v25
    v_smfmac_f32_16x16x64_bf16 v[44:47], v[60:63], v[232:239], v4
    v_cvt_pk_bf16_f32 v37, v26, v27
    s_nop 1
    v_mfma_f32_16x16x16_bf16 v[24:27], v[36:37], v[10:11], 0
    s_waitcnt lgkmcnt(1)
    v_smfmac_f32_16x16x64_bf16 v[32:35], v[64:67], a[224:231], v4
    s_nop 5
    v_cvt_pk_bf16_f32 v24, v24, v25
    v_smfmac_f32_16x16x64_bf16 v[44:47], v[64:67], v[240:247], v4
    v_cvt_pk_bf16_f32 v25, v26, v27
    v_cvt_pk_bf16_f32 v26, v28, v29
    s_waitcnt lgkmcnt(0)
    v_smfmac_f32_16x16x64_bf16 v[32:35], v[48:51], a[232:239], v4
    v_cvt_pk_bf16_f32 v27, v30, v31
    s_waitcnt vmcnt(4)
    v_smfmac_f32_16x16x64_bf16 v[44:47], v[48:51], v[248:255], v4
    v_mfma_f32_16x16x32_bf16 v[28:31], a[240:243], v[24:27], 0
    v_mfma_f32_16x16x32_bf16 v[36:39], a[244:247], v[24:27], 0
    v_mfma_f32_16x16x32_bf16 v[40:43], v[24:27], v[24:27], 0
    s_nop 4
    v_permlane32_swap_b32 v32, v44
    v_permlane32_swap_b32 v33, v45
    v_permlane32_swap_b32 v34, v46
    v_permlane32_swap_b32 v35, v47
    v_add_f32 v32, v32, v44
    v_add_f32 v33, v33, v45
    v_add_f32 v34, v34, v46
    v_add_f32 v35, v35, v47
    v_cvt_pk_bf16_f32 v44, v32, v33
    v_cvt_pk_bf16_f32 v45, v34, v35
    s_nop 1
    v_mfma_f32_16x16x16_bf16 v[32:35], v[44:45], v[10:11], 0
    s_nop 7
    v_cvt_pk_bf16_f32 v32, v32, v33
    v_cvt_pk_bf16_f32 v33, v34, v35
    s_nop 1
    v_mfma_f32_16x16x16_bf16 v[28:31], a[248:249], v[32:33], v[28:31]
    v_mfma_f32_16x16x16_bf16 v[36:39], a[250:251], v[32:33], v[36:39]
    v_mfma_f32_16x16x16_bf16 v[40:43], v[32:33], v[32:33], v[40:43]
    s_nop 5
    ds_write_b128 v12, v[28:31]
    ds_write_b128 v12, v[36:39] offset:16
    ds_write_b128 v13, v[40:43]
    s_waitcnt lgkmcnt(0)
    s_barrier
    s_waitcnt vmcnt(0)
    v_mfma_f32_16x16x32_bf16 v[36:39], a[240:243], v[80:83], 0
    v_mfma_f32_16x16x32_bf16 v[44:47], a[244:247], v[80:83], 0
    v_mfma_f32_16x16x32_bf16 v[68:71], v[24:27], v[80:83], 0
    v_mfma_f32_16x16x32_bf16 v[40:43], a[240:243], v[84:87], 0
    v_mfma_f32_16x16x32_bf16 v[64:67], a[244:247], v[84:87], 0
    v_mfma_f32_16x16x32_bf16 v[72:75], v[24:27], v[84:87], 0
    s_nop 0
    v_mfma_f32_16x16x16_bf16 v[36:39], a[248:249], v[88:89], v[36:39]
    v_mfma_f32_16x16x16_bf16 v[44:47], a[250:251], v[88:89], v[44:47]
    v_mfma_f32_16x16x16_bf16 v[68:71], v[32:33], v[88:89], v[68:71]
    v_mfma_f32_16x16x16_bf16 v[40:43], a[248:249], v[90:91], v[40:43]
    v_mfma_f32_16x16x16_bf16 v[64:67], a[250:251], v[90:91], v[64:67]
    v_mfma_f32_16x16x16_bf16 v[72:75], v[32:33], v[90:91], v[72:75]
    s_nop 2
    ds_write_b128 v16, v[36:39] offset:0
    ds_write_b128 v16, v[44:47] offset:16
    ds_write_b128 v17, v[68:71]
    ds_write_b128 v16, v[40:43] offset:2816
    ds_write_b128 v16, v[64:67] offset:2832
    ds_write_b128 v18, v[72:75]
    s_add_u32 s40, s40, 1
    s_add_u32 s41, s41, 393216
    s_add_u32 s45, s45, 393216
    s_add_u32 s43, s43, 458752
    s_add_u32 s47, s47, 458752
    s_add_u32 s48, s48, 458752
    s_add_u32 s49, s49, 458752
    s_waitcnt lgkmcnt(0)
    s_barrier
    s_cmp_lt_u32 s40, 64
    s_cbranch_scc1 interleave_layers__linear_attn_block__memory_aug_recurrent_mem_tr__prompt_kernel_s_stepw1
    s_branch interleave_layers__linear_attn_block__memory_aug_recurrent_mem_tr__prompt_kernel_s_end
interleave_layers__linear_attn_block__memory_aug_recurrent_mem_tr__prompt_kernel_s_stepw2:
    v_mov_b32 v24, 0
    v_mov_b32 v25, 0
    v_mov_b32 v26, 0
    v_mov_b32 v27, 0
    v_mov_b32 v28, 0
    v_mov_b32 v29, 0
    v_mov_b32 v30, 0
    v_mov_b32 v31, 0
    v_mov_b32 v32, 0
    v_mov_b32 v33, 0
    v_mov_b32 v34, 0
    v_mov_b32 v35, 0
    v_mov_b32 v36, 0
    v_mov_b32 v37, 0
    v_mov_b32 v38, 0
    v_mov_b32 v39, 0
    v_mov_b32 v40, 0
    v_mov_b32 v41, 0
    v_mov_b32 v42, 0
    v_mov_b32 v43, 0
    v_mov_b32 v44, 0
    v_mov_b32 v45, 0
    v_mov_b32 v46, 0
    v_mov_b32 v47, 0
    s_add_u32 s46, s47, 4096
    s_lshl_b32 s95, s92, 6
    s_add_u32 s95, s95, s40
    s_add_u32 s95, s95, 1
    s_cmp_ge_i32 s59, s95
    s_cbranch_scc1 interleave_layers__linear_attn_block__memory_aug_recurrent_mem_tr__prompt_kernel_s_ecw2_ok
    s_and_b32 s24, s2, 7
    s_lshl_b32 s24, s24, 7
    s_add_u32 s24, s24, 23109632
    v_and_b32 v49, 3, v1
    v_lshl_add_u32 v49, v49, 2, s24
    s_mov_b32 s61, 0
interleave_layers__linear_attn_block__memory_aug_recurrent_mem_tr__prompt_kernel_s_ecw2:
    buffer_load_dword v48, v49, s[8:11], 0 offen sc1
    s_waitcnt vmcnt(0)
    v_readlane_b32 s59, v48, 0
    v_readlane_b32 s24, v48, 1
    s_min_i32 s59, s59, s24
    v_readlane_b32 s24, v48, 2
    s_min_i32 s59, s59, s24
    s_cmp_ge_i32 s59, s95
    s_cbranch_scc1 interleave_layers__linear_attn_block__memory_aug_recurrent_mem_tr__prompt_kernel_s_ecw2_ok
    s_add_u32 s61, s61, 1
    s_cmp_ge_u32 s61, s60
    s_cbranch_scc1 interleave_layers__linear_attn_block__memory_aug_recurrent_mem_tr__prompt_kernel_s_ecw2_to
    s_sleep 2
    s_branch interleave_layers__linear_attn_block__memory_aug_recurrent_mem_tr__prompt_kernel_s_ecw2
interleave_layers__linear_attn_block__memory_aug_recurrent_mem_tr__prompt_kernel_s_ecw2_to:
    s_mov_b32 s60, 1
interleave_layers__linear_attn_block__memory_aug_recurrent_mem_tr__prompt_kernel_s_ecw2_ok:
    s_add_u32 s63, s40, 1
    s_cmp_ge_i32 s62, s63
    s_cbranch_scc1 interleave_layers__linear_attn_block__memory_aug_recurrent_mem_tr__prompt_kernel_s_enw2_ok
    s_mov_b32 s61, 0
interleave_layers__linear_attn_block__memory_aug_recurrent_mem_tr__prompt_kernel_s_enw2:
    buffer_load_dword v48, v9, s[8:11], 0 offen sc1
    s_waitcnt vmcnt(0)
    v_readlane_b32 s62, v48, 0
    v_readlane_b32 s24, v48, 1
    s_min_i32 s62, s62, s24
    s_cmp_ge_i32 s62, s63
    s_cbranch_scc1 interleave_layers__linear_attn_block__memory_aug_recurrent_mem_tr__prompt_kernel_s_enw2_ok
    s_add_u32 s61, s61, 1
    s_cmp_ge_u32 s61, s60
    s_cbranch_scc1 interleave_layers__linear_attn_block__memory_aug_recurrent_mem_tr__prompt_kernel_s_enw2_to
    s_sleep 2
    s_branch interleave_layers__linear_attn_block__memory_aug_recurrent_mem_tr__prompt_kernel_s_enw2
interleave_layers__linear_attn_block__memory_aug_recurrent_mem_tr__prompt_kernel_s_enw2_to:
    s_mov_b32 s60, 1
interleave_layers__linear_attn_block__memory_aug_recurrent_mem_tr__prompt_kernel_s_enw2_ok:
    s_sleep 5
    s_mov_b64 exec, 1
    s_mov_b32 s61, 0
    v_mov_b32 v83, 0
    buffer_atomic_add v83, v23, s[8:11], s48 offen sc0
    s_sleep 3
    v_mov_b32 v94, 0
    buffer_atomic_add v94, v23, s[8:11], s48 offen sc0
    s_sleep 3
    v_mov_b32 v95, 0
    buffer_atomic_add v95, v23, s[8:11], s48 offen sc0
    s_sleep 3
interleave_layers__linear_attn_block__memory_aug_recurrent_mem_tr__prompt_kernel_s_prw2:
    v_mov_b32 v82, 0
    buffer_atomic_add v82, v23, s[8:11], s48 offen sc0
    s_waitcnt vmcnt(3)
    v_cmp_le_i32 vcc, 8, v83
    s_add_u32 s61, s61, 1
    s_cbranch_vccnz interleave_layers__linear_attn_block__memory_aug_recurrent_mem_tr__prompt_kernel_s_prw2_out
    s_sleep 3
    v_mov_b32 v83, 0
    buffer_atomic_add v83, v23, s[8:11], s48 offen sc0
    s_waitcnt vmcnt(3)
    v_cmp_le_i32 vcc, 8, v94
    s_add_u32 s61, s61, 1
    s_cbranch_vccnz interleave_layers__linear_attn_block__memory_aug_recurrent_mem_tr__prompt_kernel_s_prw2_out
    s_sleep 3
    v_mov_b32 v94, 0
    buffer_atomic_add v94, v23, s[8:11], s48 offen sc0
    s_waitcnt vmcnt(3)
    v_cmp_le_i32 vcc, 8, v95
    s_add_u32 s61, s61, 1
    s_cbranch_vccnz interleave_layers__linear_attn_block__memory_aug_recurrent_mem_tr__prompt_kernel_s_prw2_out
    s_sleep 3
    v_mov_b32 v95, 0
    buffer_atomic_add v95, v23, s[8:11], s48 offen sc0
    s_waitcnt vmcnt(3)
    v_cmp_le_i32 vcc, 8, v82
    s_add_u32 s61, s61, 1
    s_cbranch_vccnz interleave_layers__linear_attn_block__memory_aug_recurrent_mem_tr__prompt_kernel_s_prw2_out
    s_sleep 3
    s_cmp_ge_u32 s61, s60
    s_cbranch_scc0 interleave_layers__linear_attn_block__memory_aug_recurrent_mem_tr__prompt_kernel_s_prw2
    s_mov_b32 s60, 1
interleave_layers__linear_attn_block__memory_aug_recurrent_mem_tr__prompt_kernel_s_prw2_out:
    s_mov_b64 exec, -1
    buffer_load_dwordx4 v[84:87], v7, s[8:11], s47 offen sc1
    buffer_load_dwordx4 v[88:91], v7, s[8:11], s46 offen sc1
    buffer_load_dwordx2 v[92:93], v8, s[8:11], s47 offen sc1
    buffer_load_dwordx4 a[240:243], v19, s[8:11], s41 offen offset:0 sc1
    buffer_load_dwordx4 a[244:247], v19, s[8:11], s41 offen offset:1024 sc1
    buffer_load_dwordx4 a[248:251], v19, s[8:11], s41 offen offset:2048 sc1
    ds_read_b128 v[48:51], v21 offset:0
    ds_read_b128 v[52:55], v21 offset:16
    ds_read_b128 v[56:59], v21 offset:5632
    ds_read_b128 v[60:63], v21 offset:5648
    ds_read_b128 v[64:67], v21 offset:11264
    ds_read_b128 v[68:71], v21 offset:11280
    ds_read_b128 v[72:75], v21 offset:16896
    ds_read_b128 v[76:79], v21 offset:16912
    s_waitcnt lgkmcnt(4)
    v_pk_add_f32 v[48:49], v[48:49], v[56:57]
    v_pk_add_f32 v[50:51], v[50:51], v[58:59]
    v_pk_add_f32 v[52:53], v[52:53], v[60:61]
    v_pk_add_f32 v[54:55], v[54:55], v[62:63]
    s_waitcnt lgkmcnt(0)
    v_pk_add_f32 v[64:65], v[64:65], v[72:73]
    v_pk_add_f32 v[66:67], v[66:67], v[74:75]
    v_pk_add_f32 v[68:69], v[68:69], v[76:77]
    v_pk_add_f32 v[70:71], v[70:71], v[78:79]
    v_pk_add_f32 v[48:49], v[48:49], v[64:65]
    v_pk_add_f32 v[50:51], v[50:51], v[66:67]
    v_pk_add_f32 v[52:53], v[52:53], v[68:69]
    v_pk_add_f32 v[54:55], v[54:55], v[70:71]
    v_mov_b32 v81, 0xff800000
    v_cndmask_b32 v48, v81, v48, s[64:65]
    v_cndmask_b32 v49, v81, v49, s[66:67]
    v_cndmask_b32 v50, v81, v50, s[68:69]
    v_cndmask_b32 v51, v81, v51, s[70:71]
    v_cndmask_b32 v52, v81, v52, s[72:73]
    v_cndmask_b32 v53, v81, v53, s[74:75]
    v_cndmask_b32 v54, v81, v54, s[76:77]
    v_cndmask_b32 v55, v81, v55, s[78:79]
    v_max3_f32 v80, v48, v49, v50
    v_max3_f32 v80, v80, v51, v52
    v_max3_f32 v80, v80, v53, v54
    v_max_f32 v80, v80, v55
    v_mov_b32 v81, 0xff800000
    v_cndmask_b32 v80, v81, v80, s[50:51]
    s_nop 1
    v_max_f32 v80, v80, v80 quad_perm:[1,0,3,2] row_mask:0xf bank_mask:0xf
    s_nop 1
    v_max_f32 v80, v80, v80 quad_perm:[2,3,0,1] row_mask:0xf bank_mask:0xf
    s_nop 1
    v_max_f32 v80, v80, v80 row_half_mirror row_mask:0xf bank_mask:0xf
    s_mov_b32 s24, 0x3dd53b95
    v_mul_f32 v80, s24, v80
    v_fma_f32 v48, v48, s24, -v80
    v_fma_f32 v49, v49, s24, -v80
    v_fma_f32 v50, v50, s24, -v80
    v_fma_f32 v51, v51, s24, -v80
    v_fma_f32 v52, v52, s24, -v80
    v_fma_f32 v53, v53, s24, -v80
    v_fma_f32 v54, v54, s24, -v80
    v_fma_f32 v55, v55, s24, -v80
    v_exp_f32 v48, v48
    v_exp_f32 v49, v49
    v_exp_f32 v50, v50
    v_exp_f32 v51, v51
    v_exp_f32 v52, v52
    v_exp_f32 v53, v53
    v_exp_f32 v54, v54
    v_exp_f32 v55, v55
    v_add_f32 v80, v48, v49
    v_add_f32 v81, v50, v51
    v_add_f32 v80, v80, v52
    v_add_f32 v81, v81, v53
    v_add_f32 v80, v80, v54
    v_add_f32 v81, v81, v55
    v_add_f32 v80, v80, v81
    v_cndmask_b32 v80, 0, v80, s[50:51]
    s_nop 1
    v_add_f32 v80, v80, v80 quad_perm:[1,0,3,2] row_mask:0xf bank_mask:0xf
    s_nop 1
    v_add_f32 v80, v80, v80 quad_perm:[2,3,0,1] row_mask:0xf bank_mask:0xf
    s_nop 1
    v_add_f32 v80, v80, v80 row_half_mirror row_mask:0xf bank_mask:0xf
    v_rcp_f32 v80, v80
    s_nop 0
    v_mul_f32 v48, v48, v80
    v_mul_f32 v49, v49, v80
    v_mul_f32 v50, v50, v80
    v_mul_f32 v51, v51, v80
    v_mul_f32 v52, v52, v80
    v_mul_f32 v53, v53, v80
    v_mul_f32 v54, v54, v80
    v_mul_f32 v55, v55, v80
    v_cvt_pk_bf16_f32 v56, v48, v49
    v_cvt_pk_bf16_f32 v57, v50, v51
    v_cvt_pk_bf16_f32 v58, v52, v53
    v_cvt_pk_bf16_f32 v59, v54, v55
    v_min_u32 v56, -2, v56
    v_min_u32 v57, -2, v57
    v_min_u32 v58, -2, v58
    v_min_u32 v59, -2, v59
    buffer_store_dwordx4 v[56:59], v22, s[8:11], s42 offen sc1
    s_add_u32 s42, s42, 458752
    s_waitcnt vmcnt(4)
    v_max3_u32 v58, v84, v85, v86
    v_max3_u32 v58, v58, v87, v88
    v_max3_u32 v58, v58, v89, v90
    v_max3_u32 v58, v58, v91, v92
    v_max_u32 v58, v58, v93
    v_cmp_eq_u32 vcc, -1, v58
    s_cbranch_vccz interleave_layers__linear_attn_block__memory_aug_recurrent_mem_tr__prompt_kernel_s_pmw2_out
    s_mov_b32 s61, 0
interleave_layers__linear_attn_block__memory_aug_recurrent_mem_tr__prompt_kernel_s_pmw2:
    buffer_load_dwordx4 v[84:87], v7, s[8:11], s47 offen sc1
    buffer_load_dwordx4 v[88:91], v7, s[8:11], s46 offen sc1
    buffer_load_dwordx2 v[92:93], v8, s[8:11], s47 offen sc1
    s_waitcnt vmcnt(0)
    v_max3_u32 v58, v84, v85, v86
    v_max3_u32 v58, v58, v87, v88
    v_max3_u32 v58, v58, v89, v90
    v_max3_u32 v58, v58, v91, v92
    v_max_u32 v58, v58, v93
    v_cmp_eq_u32 vcc, -1, v58
    s_add_u32 s61, s61, 1
    s_cbranch_vccz interleave_layers__linear_attn_block__memory_aug_recurrent_mem_tr__prompt_kernel_s_pmw2_out
    s_cmp_ge_u32 s61, s60
    s_cbranch_scc1 interleave_layers__linear_attn_block__memory_aug_recurrent_mem_tr__prompt_kernel_s_pmw2_to
    s_sleep 1
    s_branch interleave_layers__linear_attn_block__memory_aug_recurrent_mem_tr__prompt_kernel_s_pmw2
interleave_layers__linear_attn_block__memory_aug_recurrent_mem_tr__prompt_kernel_s_pmw2_to:
    s_mov_b32 s60, 1
interleave_layers__linear_attn_block__memory_aug_recurrent_mem_tr__prompt_kernel_s_pmw2_out:
    ds_write_b128 v7, v[84:87]
    ds_write_b128 v7, v[88:91] offset:4096
    ds_write_b64 v8, v[92:93]
interleave_layers__linear_attn_block__memory_aug_recurrent_mem_tr__prompt_kernel_s_gow2:
    ds_read_b128 v[68:71], v6 offset:4096
    ds_read_b128 v[72:75], v6 offset:5120
    ds_read_b128 v[76:79], v6 offset:12288
    ds_read_b128 v[80:83], v6 offset:13312
    v_smfmac_f32_16x16x64_bf16 v[24:27], v[84:87], a[16:23], v4
    v_smfmac_f32_16x16x64_bf16 v[28:31], v[84:87], a[96:103], v4
    v_smfmac_f32_16x16x64_bf16 v[32:35], v[84:87], a[176:183], v4
    v_smfmac_f32_16x16x64_bf16 v[40:43], v[84:87], v[112:119], v4
    v_smfmac_f32_16x16x64_bf16 v[44:47], v[84:87], v[192:199], v4
    s_waitcnt lgkmcnt(2)
    v_smfmac_f32_16x16x64_bf16 v[36:39], v[84:87], v[68:75], v4
    ds_read_b128 v[68:71], v6 offset:0
    ds_read_b128 v[72:75], v6 offset:1024
    s_barrier
    ds_read_b128 v[48:51], v5 offset:0
    ds_read_b128 v[52:55], v5 offset:1024
    ds_read_b128 v[56:59], v5 offset:3072
    ds_read_b128 v[60:63], v5 offset:4096
    ds_read_b128 v[64:67], v5 offset:5120
    v_smfmac_f32_16x16x64_bf16 v[24:27], v[88:91], a[48:55], v4
    v_smfmac_f32_16x16x64_bf16 v[28:31], v[88:91], a[128:135], v4
    v_smfmac_f32_16x16x64_bf16 v[32:35], v[88:91], a[208:215], v4
    v_smfmac_f32_16x16x64_bf16 v[40:43], v[88:91], v[144:151], v4
    v_smfmac_f32_16x16x64_bf16 v[44:47], v[88:91], v[224:231], v4
    s_waitcnt lgkmcnt(7)
    v_smfmac_f32_16x16x64_bf16 v[36:39], v[88:91], v[76:83], v4
    ds_read_b128 v[76:79], v6 offset:2048
    ds_read_b128 v[80:83], v6 offset:3072
    s_waitcnt lgkmcnt(6)
    v_smfmac_f32_16x16x64_bf16 v[24:27], v[48:51], a[0:7], v4
    v_smfmac_f32_16x16x64_bf16 v[28:31], v[48:51], a[80:87], v4
    v_smfmac_f32_16x16x64_bf16 v[40:43], v[48:51], v[96:103], v4
    v_smfmac_f32_16x16x64_bf16 v[36:39], v[48:51], v[68:75], v4
    ds_read_b128 v[68:71], v6 offset:6144
    ds_read_b128 v[72:75], v6 offset:7168
    ds_read_b128 v[48:51], v5 offset:7168
    s_waitcnt lgkmcnt(8)
    v_smfmac_f32_16x16x64_bf16 v[24:27], v[52:55], a[8:15], v4
    v_smfmac_f32_16x16x64_bf16 v[28:31], v[52:55], a[88:95], v4
    v_smfmac_f32_16x16x64_bf16 v[40:43], v[52:55], v[104:111], v4
    s_waitcnt lgkmcnt(3)
    v_smfmac_f32_16x16x64_bf16 v[36:39], v[52:55], v[76:83], v4
    ds_read_b128 v[76:79], v6 offset:8192
    ds_read_b128 v[80:83], v6 offset:9216
    ds_read_b128 v[52:55], v5 offset:8192
    v_smfmac_f32_16x16x64_bf16 v[24:27], v[56:59], a[24:31], v4
    v_smfmac_f32_16x16x64_bf16 v[28:31], v[56:59], a[104:111], v4
    v_smfmac_f32_16x16x64_bf16 v[40:43], v[56:59], v[120:127], v4
    s_waitcnt lgkmcnt(4)
    v_smfmac_f32_16x16x64_bf16 v[36:39], v[56:59], v[68:75], v4
    ds_read_b128 v[68:71], v6 offset:10240
    ds_read_b128 v[72:75], v6 offset:11264
    ds_read_b128 v[56:59], v5 offset:9216
    v_smfmac_f32_16x16x64_bf16 v[24:27], v[60:63], a[32:39], v4
    v_smfmac_f32_16x16x64_bf16 v[28:31], v[60:63], a[112:119], v4
    v_smfmac_f32_16x16x64_bf16 v[40:43], v[60:63], v[128:135], v4
    s_waitcnt lgkmcnt(4)
    v_smfmac_f32_16x16x64_bf16 v[36:39], v[60:63], v[76:83], v4
    ds_read_b128 v[76:79], v6 offset:14336
    ds_read_b128 v[80:83], v6 offset:15360
    ds_read_b128 v[60:63], v5 offset:0
    v_smfmac_f32_16x16x64_bf16 v[24:27], v[64:67], a[40:47], v4
    v_smfmac_f32_16x16x64_bf16 v[28:31], v[64:67], a[120:127], v4
    v_smfmac_f32_16x16x64_bf16 v[40:43], v[64:67], v[136:143], v4
    s_waitcnt lgkmcnt(4)
    v_smfmac_f32_16x16x64_bf16 v[36:39], v[64:67], v[68:75], v4
    ds_read_b128 v[68:71], v6 offset:16384
    ds_read_b128 v[72:75], v6 offset:17408
    ds_read_b128 v[64:67], v5 offset:1024
    v_smfmac_f32_16x16x64_bf16 v[24:27], v[48:51], a[56:63], v4
    v_smfmac_f32_16x16x64_bf16 v[28:31], v[48:51], a[136:143], v4
    v_smfmac_f32_16x16x64_bf16 v[40:43], v[48:51], v[152:159], v4
    s_waitcnt lgkmcnt(4)
    v_smfmac_f32_16x16x64_bf16 v[36:39], v[48:51], v[76:83], v4
    ds_read_b128 v[76:79], v6 offset:18432
    ds_read_b128 v[80:83], v6 offset:19456
    ds_read_b128 v[48:51], v5 offset:3072
    v_smfmac_f32_16x16x64_bf16 v[24:27], v[52:55], a[64:71], v4
    v_smfmac_f32_16x16x64_bf16 v[28:31], v[52:55], a[144:151], v4
    v_smfmac_f32_16x16x64_bf16 v[40:43], v[52:55], v[160:167], v4
    s_waitcnt lgkmcnt(4)
    v_smfmac_f32_16x16x64_bf16 v[36:39], v[52:55], v[68:75], v4
    ds_read_b128 v[52:55], v5 offset:4096
    v_smfmac_f32_16x16x64_bf16 v[24:27], v[56:59], a[72:79], v4
    v_smfmac_f32_16x16x64_bf16 v[28:31], v[56:59], a[152:159], v4
    v_smfmac_f32_16x16x64_bf16 v[40:43], v[56:59], v[168:175], v4
    s_waitcnt lgkmcnt(2)
    v_smfmac_f32_16x16x64_bf16 v[36:39], v[56:59], v[76:83], v4
    ds_read_b128 v[56:59], v5 offset:5120
    buffer_load_dwordx4 v[80:83], v19, s[8:11], s45 offen offset:0 sc1
    buffer_load_dwordx4 v[84:87], v19, s[8:11], s45 offen offset:1024 sc1
    buffer_load_dwordx4 v[88:91], v19, s[8:11], s45 offen offset:2048 sc1
    v_smfmac_f32_16x16x64_bf16 v[32:35], v[60:63], a[160:167], v4
    v_smfmac_f32_16x16x64_bf16 v[44:47], v[60:63], v[176:183], v4
    v_permlane32_swap_b32 v28, v40
    v_permlane32_swap_b32 v29, v41
    ds_read_b128 v[60:63], v5 offset:7168
    v_smfmac_f32_16x16x64_bf16 v[32:35], v[64:67], a[168:175], v4
    v_permlane32_swap_b32 v30, v42
    v_permlane32_swap_b32 v31, v43
    v_smfmac_f32_16x16x64_bf16 v[44:47], v[64:67], v[184:191], v4
    v_add_f32 v28, v28, v40
    v_add_f32 v29, v29, v41
    ds_read_b128 v[64:67], v5 offset:8192
    s_waitcnt lgkmcnt(4)
    v_smfmac_f32_16x16x64_bf16 v[32:35], v[48:51], a[184:191], v4
    v_add_f32 v30, v30, v42
    v_add_f32 v31, v31, v43
    v_smfmac_f32_16x16x64_bf16 v[44:47], v[48:51], v[200:207], v4
    v_cvt_pk_bf16_f32 v40, v28, v29
    v_cvt_pk_bf16_f32 v41, v30, v31
    ds_read_b128 v[48:51], v5 offset:9216
    s_waitcnt lgkmcnt(4)
    v_smfmac_f32_16x16x64_bf16 v[32:35], v[52:55], a[192:199], v4
    v_mfma_f32_16x16x16_bf16 v[28:31], v[40:41], v[10:11], 0
    v_permlane32_swap_b32 v24, v36
    v_smfmac_f32_16x16x64_bf16 v[44:47], v[52:55], v[208:215], v4
    v_permlane32_swap_b32 v25, v37
    v_permlane32_swap_b32 v26, v38
    s_waitcnt lgkmcnt(3)
    v_smfmac_f32_16x16x64_bf16 v[32:35], v[56:59], a[200:207], v4
    v_permlane32_swap_b32 v27, v39
    v_add_f32 v24, v24, v36
    v_smfmac_f32_16x16x64_bf16 v[44:47], v[56:59], v[216:223], v4
    v_add_f32 v25, v25, v37
    v_add_f32 v26, v26, v38
    s_waitcnt lgkmcnt(2)
    v_smfmac_f32_16x16x64_bf16 v[32:35], v[60:63], a[216:223], v4
    v_add_f32 v27, v27, v39
    v_cvt_pk_bf16_f32 v36, v24, v25
    v_smfmac_f32_16x16x64_bf16 v[44:47], v[60:63], v[232:239], v4
    v_cvt_pk_bf16_f32 v37, v26, v27
    s_nop 1
    v_mfma_f32_16x16x16_bf16 v[24:27], v[36:37], v[10:11], 0
    s_waitcnt lgkmcnt(1)
    v_smfmac_f32_16x16x64_bf16 v[32:35], v[64:67], a[224:231], v4
    s_nop 5
    v_cvt_pk_bf16_f32 v24, v24, v25
    v_smfmac_f32_16x16x64_bf16 v[44:47], v[64:67], v[240:247], v4
    v_cvt_pk_bf16_f32 v25, v26, v27
    v_cvt_pk_bf16_f32 v26, v28, v29
    s_waitcnt lgkmcnt(0)
    v_smfmac_f32_16x16x64_bf16 v[32:35], v[48:51], a[232:239], v4
    v_cvt_pk_bf16_f32 v27, v30, v31
    s_waitcnt vmcnt(4)
    v_smfmac_f32_16x16x64_bf16 v[44:47], v[48:51], v[248:255], v4
    v_mfma_f32_16x16x32_bf16 v[28:31], a[240:243], v[24:27], 0
    v_mfma_f32_16x16x32_bf16 v[36:39], a[244:247], v[24:27], 0
    v_mfma_f32_16x16x32_bf16 v[40:43], v[24:27], v[24:27], 0
    s_nop 4
    v_permlane32_swap_b32 v32, v44
    v_permlane32_swap_b32 v33, v45
    v_permlane32_swap_b32 v34, v46
    v_permlane32_swap_b32 v35, v47
    v_add_f32 v32, v32, v44
    v_add_f32 v33, v33, v45
    v_add_f32 v34, v34, v46
    v_add_f32 v35, v35, v47
    v_cvt_pk_bf16_f32 v44, v32, v33
    v_cvt_pk_bf16_f32 v45, v34, v35
    s_nop 1
    v_mfma_f32_16x16x16_bf16 v[32:35], v[44:45], v[10:11], 0
    s_nop 7
    v_cvt_pk_bf16_f32 v32, v32, v33
    v_cvt_pk_bf16_f32 v33, v34, v35
    s_nop 1
    v_mfma_f32_16x16x16_bf16 v[28:31], a[248:249], v[32:33], v[28:31]
    v_mfma_f32_16x16x16_bf16 v[36:39], a[250:251], v[32:33], v[36:39]
    v_mfma_f32_16x16x16_bf16 v[40:43], v[32:33], v[32:33], v[40:43]
    s_nop 5
    ds_write_b128 v12, v[28:31]
    ds_write_b128 v12, v[36:39] offset:16
    ds_write_b128 v13, v[40:43]
    s_waitcnt lgkmcnt(0)
    s_barrier
    s_waitcnt vmcnt(0)
    v_mfma_f32_16x16x32_bf16 v[36:39], a[240:243], v[80:83], 0
    v_mfma_f32_16x16x32_bf16 v[44:47], a[244:247], v[80:83], 0
    v_mfma_f32_16x16x32_bf16 v[68:71], v[24:27], v[80:83], 0
    v_mfma_f32_16x16x32_bf16 v[40:43], a[240:243], v[84:87], 0
    v_mfma_f32_16x16x32_bf16 v[64:67], a[244:247], v[84:87], 0
    v_mfma_f32_16x16x32_bf16 v[72:75], v[24:27], v[84:87], 0
    s_nop 0
    v_mfma_f32_16x16x16_bf16 v[36:39], a[248:249], v[88:89], v[36:39]
    v_mfma_f32_16x16x16_bf16 v[44:47], a[250:251], v[88:89], v[44:47]
    v_mfma_f32_16x16x16_bf16 v[68:71], v[32:33], v[88:89], v[68:71]
    v_mfma_f32_16x16x16_bf16 v[40:43], a[248:249], v[90:91], v[40:43]
    v_mfma_f32_16x16x16_bf16 v[64:67], a[250:251], v[90:91], v[64:67]
    v_mfma_f32_16x16x16_bf16 v[72:75], v[32:33], v[90:91], v[72:75]
    s_nop 2
    ds_write_b128 v16, v[36:39] offset:0
    ds_write_b128 v16, v[44:47] offset:16
    ds_write_b128 v17, v[68:71]
    ds_write_b128 v16, v[40:43] offset:2816
    ds_write_b128 v16, v[64:67] offset:2832
    ds_write_b128 v18, v[72:75]
    s_add_u32 s40, s40, 1
    s_add_u32 s41, s41, 393216
    s_add_u32 s45, s45, 393216
    s_add_u32 s43, s43, 458752
    s_add_u32 s47, s47, 458752
    s_add_u32 s48, s48, 458752
    s_add_u32 s49, s49, 458752
    s_waitcnt lgkmcnt(0)
    s_barrier
    s_cmp_lt_u32 s40, 64
    s_cbranch_scc1 interleave_layers__linear_attn_block__memory_aug_recurrent_mem_tr__prompt_kernel_s_stepw2
    s_branch interleave_layers__linear_attn_block__memory_aug_recurrent_mem_tr__prompt_kernel_s_end
interleave_layers__linear_attn_block__memory_aug_recurrent_mem_tr__prompt_kernel_s_stepw3:
    v_mov_b32 v24, 0
    v_mov_b32 v25, 0
    v_mov_b32 v26, 0
    v_mov_b32 v27, 0
    v_mov_b32 v28, 0
    v_mov_b32 v29, 0
    v_mov_b32 v30, 0
    v_mov_b32 v31, 0
    v_mov_b32 v32, 0
    v_mov_b32 v33, 0
    v_mov_b32 v34, 0
    v_mov_b32 v35, 0
    v_mov_b32 v36, 0
    v_mov_b32 v37, 0
    v_mov_b32 v38, 0
    v_mov_b32 v39, 0
    v_mov_b32 v40, 0
    v_mov_b32 v41, 0
    v_mov_b32 v42, 0
    v_mov_b32 v43, 0
    v_mov_b32 v44, 0
    v_mov_b32 v45, 0
    v_mov_b32 v46, 0
    v_mov_b32 v47, 0
    s_add_u32 s46, s47, 4096
    s_lshl_b32 s95, s92, 6
    s_add_u32 s95, s95, s40
    s_add_u32 s95, s95, 1
    s_cmp_ge_i32 s59, s95
    s_cbranch_scc1 interleave_layers__linear_attn_block__memory_aug_recurrent_mem_tr__prompt_kernel_s_ecw3_ok
    s_and_b32 s24, s2, 7
    s_lshl_b32 s24, s24, 7
    s_add_u32 s24, s24, 23109632
    v_and_b32 v49, 3, v1
    v_lshl_add_u32 v49, v49, 2, s24
    s_mov_b32 s61, 0
interleave_layers__linear_attn_block__memory_aug_recurrent_mem_tr__prompt_kernel_s_ecw3:
    buffer_load_dword v48, v49, s[8:11], 0 offen sc1
    s_waitcnt vmcnt(0)
    v_readlane_b32 s59, v48, 0
    v_readlane_b32 s24, v48, 1
    s_min_i32 s59, s59, s24
    v_readlane_b32 s24, v48, 2
    s_min_i32 s59, s59, s24
    s_cmp_ge_i32 s59, s95
    s_cbranch_scc1 interleave_layers__linear_attn_block__memory_aug_recurrent_mem_tr__prompt_kernel_s_ecw3_ok
    s_add_u32 s61, s61, 1
    s_cmp_ge_u32 s61, s60
    s_cbranch_scc1 interleave_layers__linear_attn_block__memory_aug_recurrent_mem_tr__prompt_kernel_s_ecw3_to
    s_sleep 2
    s_branch interleave_layers__linear_attn_block__memory_aug_recurrent_mem_tr__prompt_kernel_s_ecw3
interleave_layers__linear_attn_block__memory_aug_recurrent_mem_tr__prompt_kernel_s_ecw3_to:
    s_mov_b32 s60, 1
interleave_layers__linear_attn_block__memory_aug_recurrent_mem_tr__prompt_kernel_s_ecw3_ok:
    s_add_u32 s63, s40, 1
    s_cmp_ge_i32 s62, s63
    s_cbranch_scc1 interleave_layers__linear_attn_block__memory_aug_recurrent_mem_tr__prompt_kernel_s_enw3_ok
    s_mov_b32 s61, 0
interleave_layers__linear_attn_block__memory_aug_recurrent_mem_tr__prompt_kernel_s_enw3:
    buffer_load_dword v48, v9, s[8:11], 0 offen sc1
    s_waitcnt vmcnt(0)
    v_readlane_b32 s62, v48, 0
    v_readlane_b32 s24, v48, 1
    s_min_i32 s62, s62, s24
    s_cmp_ge_i32 s62, s63
    s_cbranch_scc1 interleave_layers__linear_attn_block__memory_aug_recurrent_mem_tr__prompt_kernel_s_enw3_ok
    s_add_u32 s61, s61, 1
    s_cmp_ge_u32 s61, s60
    s_cbranch_scc1 interleave_layers__linear_attn_block__memory_aug_recurrent_mem_tr__prompt_kernel_s_enw3_to
    s_sleep 2
    s_branch interleave_layers__linear_attn_block__memory_aug_recurrent_mem_tr__prompt_kernel_s_enw3
interleave_layers__linear_attn_block__memory_aug_recurrent_mem_tr__prompt_kernel_s_enw3_to:
    s_mov_b32 s60, 1
interleave_layers__linear_attn_block__memory_aug_recurrent_mem_tr__prompt_kernel_s_enw3_ok:
    s_sleep 5
    s_mov_b64 exec, 1
    s_mov_b32 s61, 0
    v_mov_b32 v83, 0
    buffer_atomic_add v83, v23, s[8:11], s48 offen sc0
    s_sleep 3
    v_mov_b32 v94, 0
    buffer_atomic_add v94, v23, s[8:11], s48 offen sc0
    s_sleep 3
    v_mov_b32 v95, 0
    buffer_atomic_add v95, v23, s[8:11], s48 offen sc0
    s_sleep 3
interleave_layers__linear_attn_block__memory_aug_recurrent_mem_tr__prompt_kernel_s_prw3:
    v_mov_b32 v82, 0
    buffer_atomic_add v82, v23, s[8:11], s48 offen sc0
    s_waitcnt vmcnt(3)
    v_cmp_le_i32 vcc, 8, v83
    s_add_u32 s61, s61, 1
    s_cbranch_vccnz interleave_layers__linear_attn_block__memory_aug_recurrent_mem_tr__prompt_kernel_s_prw3_out
    s_sleep 3
    v_mov_b32 v83, 0
    buffer_atomic_add v83, v23, s[8:11], s48 offen sc0
    s_waitcnt vmcnt(3)
    v_cmp_le_i32 vcc, 8, v94
    s_add_u32 s61, s61, 1
    s_cbranch_vccnz interleave_layers__linear_attn_block__memory_aug_recurrent_mem_tr__prompt_kernel_s_prw3_out
    s_sleep 3
    v_mov_b32 v94, 0
    buffer_atomic_add v94, v23, s[8:11], s48 offen sc0
    s_waitcnt vmcnt(3)
    v_cmp_le_i32 vcc, 8, v95
    s_add_u32 s61, s61, 1
    s_cbranch_vccnz interleave_layers__linear_attn_block__memory_aug_recurrent_mem_tr__prompt_kernel_s_prw3_out
    s_sleep 3
    v_mov_b32 v95, 0
    buffer_atomic_add v95, v23, s[8:11], s48 offen sc0
    s_waitcnt vmcnt(3)
    v_cmp_le_i32 vcc, 8, v82
    s_add_u32 s61, s61, 1
    s_cbranch_vccnz interleave_layers__linear_attn_block__memory_aug_recurrent_mem_tr__prompt_kernel_s_prw3_out
    s_sleep 3
    s_cmp_ge_u32 s61, s60
    s_cbranch_scc0 interleave_layers__linear_attn_block__memory_aug_recurrent_mem_tr__prompt_kernel_s_prw3
    s_mov_b32 s60, 1
interleave_layers__linear_attn_block__memory_aug_recurrent_mem_tr__prompt_kernel_s_prw3_out:
    s_mov_b64 exec, -1
    buffer_load_dwordx4 v[84:87], v7, s[8:11], s47 offen sc1
    buffer_load_dwordx4 v[88:91], v7, s[8:11], s46 offen sc1
    buffer_load_dwordx2 v[92:93], v8, s[8:11], s47 offen sc1
    buffer_load_dwordx4 a[240:243], v19, s[8:11], s41 offen offset:0 sc1
    buffer_load_dwordx4 a[244:247], v19, s[8:11], s41 offen offset:1024 sc1
    buffer_load_dwordx4 a[248:251], v19, s[8:11], s41 offen offset:2048 sc1
    ds_read_b128 v[48:51], v21 offset:0
    ds_read_b128 v[52:55], v21 offset:16
    ds_read_b128 v[56:59], v21 offset:5632
    ds_read_b128 v[60:63], v21 offset:5648
    ds_read_b128 v[64:67], v21 offset:11264
    ds_read_b128 v[68:71], v21 offset:11280
    ds_read_b128 v[72:75], v21 offset:16896
    ds_read_b128 v[76:79], v21 offset:16912
    s_waitcnt lgkmcnt(4)
    v_pk_add_f32 v[48:49], v[48:49], v[56:57]
    v_pk_add_f32 v[50:51], v[50:51], v[58:59]
    v_pk_add_f32 v[52:53], v[52:53], v[60:61]
    v_pk_add_f32 v[54:55], v[54:55], v[62:63]
    s_waitcnt lgkmcnt(0)
    v_pk_add_f32 v[64:65], v[64:65], v[72:73]
    v_pk_add_f32 v[66:67], v[66:67], v[74:75]
    v_pk_add_f32 v[68:69], v[68:69], v[76:77]
    v_pk_add_f32 v[70:71], v[70:71], v[78:79]
    v_pk_add_f32 v[48:49], v[48:49], v[64:65]
    v_pk_add_f32 v[50:51], v[50:51], v[66:67]
    v_pk_add_f32 v[52:53], v[52:53], v[68:69]
    v_pk_add_f32 v[54:55], v[54:55], v[70:71]
    v_mov_b32 v81, 0xff800000
    v_cndmask_b32 v48, v81, v48, s[64:65]
    v_cndmask_b32 v49, v81, v49, s[66:67]
    v_cndmask_b32 v50, v81, v50, s[68:69]
    v_cndmask_b32 v51, v81, v51, s[70:71]
    v_cndmask_b32 v52, v81, v52, s[72:73]
    v_cndmask_b32 v53, v81, v53, s[74:75]
    v_cndmask_b32 v54, v81, v54, s[76:77]
    v_cndmask_b32 v55, v81, v55, s[78:79]
    v_max3_f32 v80, v48, v49, v50
    v_max3_f32 v80, v80, v51, v52
    v_max3_f32 v80, v80, v53, v54
    v_max_f32 v80, v80, v55
    v_mov_b32 v81, 0xff800000
    v_cndmask_b32 v80, v81, v80, s[50:51]
    s_nop 1
    v_max_f32 v80, v80, v80 quad_perm:[1,0,3,2] row_mask:0xf bank_mask:0xf
    s_nop 1
    v_max_f32 v80, v80, v80 quad_perm:[2,3,0,1] row_mask:0xf bank_mask:0xf
    s_nop 1
    v_max_f32 v80, v80, v80 row_half_mirror row_mask:0xf bank_mask:0xf
    s_mov_b32 s24, 0x3dd53b95
    v_mul_f32 v80, s24, v80
    v_fma_f32 v48, v48, s24, -v80
    v_fma_f32 v49, v49, s24, -v80
    v_fma_f32 v50, v50, s24, -v80
    v_fma_f32 v51, v51, s24, -v80
    v_fma_f32 v52, v52, s24, -v80
    v_fma_f32 v53, v53, s24, -v80
    v_fma_f32 v54, v54, s24, -v80
    v_fma_f32 v55, v55, s24, -v80
    v_exp_f32 v48, v48
    v_exp_f32 v49, v49
    v_exp_f32 v50, v50
    v_exp_f32 v51, v51
    v_exp_f32 v52, v52
    v_exp_f32 v53, v53
    v_exp_f32 v54, v54
    v_exp_f32 v55, v55
    v_add_f32 v80, v48, v49
    v_add_f32 v81, v50, v51
    v_add_f32 v80, v80, v52
    v_add_f32 v81, v81, v53
    v_add_f32 v80, v80, v54
    v_add_f32 v81, v81, v55
    v_add_f32 v80, v80, v81
    v_cndmask_b32 v80, 0, v80, s[50:51]
    s_nop 1
    v_add_f32 v80, v80, v80 quad_perm:[1,0,3,2] row_mask:0xf bank_mask:0xf
    s_nop 1
    v_add_f32 v80, v80, v80 quad_perm:[2,3,0,1] row_mask:0xf bank_mask:0xf
    s_nop 1
    v_add_f32 v80, v80, v80 row_half_mirror row_mask:0xf bank_mask:0xf
    v_rcp_f32 v80, v80
    s_nop 0
    v_mul_f32 v48, v48, v80
    v_mul_f32 v49, v49, v80
    v_mul_f32 v50, v50, v80
    v_mul_f32 v51, v51, v80
    v_mul_f32 v52, v52, v80
    v_mul_f32 v53, v53, v80
    v_mul_f32 v54, v54, v80
    v_mul_f32 v55, v55, v80
    v_cvt_pk_bf16_f32 v56, v48, v49
    v_cvt_pk_bf16_f32 v57, v50, v51
    v_cvt_pk_bf16_f32 v58, v52, v53
    v_cvt_pk_bf16_f32 v59, v54, v55
    v_min_u32 v56, -2, v56
    v_min_u32 v57, -2, v57
    v_min_u32 v58, -2, v58
    v_min_u32 v59, -2, v59
    buffer_store_dwordx4 v[56:59], v22, s[8:11], s42 offen sc1
    s_add_u32 s42, s42, 458752
    s_waitcnt vmcnt(4)
    v_max3_u32 v58, v84, v85, v86
    v_max3_u32 v58, v58, v87, v88
    v_max3_u32 v58, v58, v89, v90
    v_max3_u32 v58, v58, v91, v92
    v_max_u32 v58, v58, v93
    v_cmp_eq_u32 vcc, -1, v58
    s_cbranch_vccz interleave_layers__linear_attn_block__memory_aug_recurrent_mem_tr__prompt_kernel_s_pmw3_out
    s_mov_b32 s61, 0
interleave_layers__linear_attn_block__memory_aug_recurrent_mem_tr__prompt_kernel_s_pmw3:
    buffer_load_dwordx4 v[84:87], v7, s[8:11], s47 offen sc1
    buffer_load_dwordx4 v[88:91], v7, s[8:11], s46 offen sc1
    buffer_load_dwordx2 v[92:93], v8, s[8:11], s47 offen sc1
    s_waitcnt vmcnt(0)
    v_max3_u32 v58, v84, v85, v86
    v_max3_u32 v58, v58, v87, v88
    v_max3_u32 v58, v58, v89, v90
    v_max3_u32 v58, v58, v91, v92
    v_max_u32 v58, v58, v93
    v_cmp_eq_u32 vcc, -1, v58
    s_add_u32 s61, s61, 1
    s_cbranch_vccz interleave_layers__linear_attn_block__memory_aug_recurrent_mem_tr__prompt_kernel_s_pmw3_out
    s_cmp_ge_u32 s61, s60
    s_cbranch_scc1 interleave_layers__linear_attn_block__memory_aug_recurrent_mem_tr__prompt_kernel_s_pmw3_to
    s_sleep 1
    s_branch interleave_layers__linear_attn_block__memory_aug_recurrent_mem_tr__prompt_kernel_s_pmw3
interleave_layers__linear_attn_block__memory_aug_recurrent_mem_tr__prompt_kernel_s_pmw3_to:
    s_mov_b32 s60, 1
interleave_layers__linear_attn_block__memory_aug_recurrent_mem_tr__prompt_kernel_s_pmw3_out:
    ds_write_b128 v7, v[84:87]
    ds_write_b128 v7, v[88:91] offset:4096
    ds_write_b64 v8, v[92:93]
interleave_layers__linear_attn_block__memory_aug_recurrent_mem_tr__prompt_kernel_s_gow3:
    ds_read_b128 v[68:71], v6 offset:6144
    ds_read_b128 v[72:75], v6 offset:7168
    ds_read_b128 v[76:79], v6 offset:14336
    ds_read_b128 v[80:83], v6 offset:15360
    v_smfmac_f32_16x16x64_bf16 v[24:27], v[84:87], a[24:31], v4
    v_smfmac_f32_16x16x64_bf16 v[28:31], v[84:87], a[104:111], v4
    v_smfmac_f32_16x16x64_bf16 v[32:35], v[84:87], a[184:191], v4
    v_smfmac_f32_16x16x64_bf16 v[40:43], v[84:87], v[120:127], v4
    v_smfmac_f32_16x16x64_bf16 v[44:47], v[84:87], v[200:207], v4
    s_waitcnt lgkmcnt(2)
    v_smfmac_f32_16x16x64_bf16 v[36:39], v[84:87], v[68:75], v4
    ds_read_b128 v[68:71], v6 offset:0
    ds_read_b128 v[72:75], v6 offset:1024
    s_barrier
    ds_read_b128 v[48:51], v5 offset:0
    ds_read_b128 v[52:55], v5 offset:1024
    ds_read_b128 v[56:59], v5 offset:2048
    ds_read_b128 v[60:63], v5 offset:4096
    ds_read_b128 v[64:67], v5 offset:5120
    v_smfmac_f32_16x16x64_bf16 v[24:27], v[88:91], a[56:63], v4
    v_smfmac_f32_16x16x64_bf16 v[28:31], v[88:91], a[136:143], v4
    v_smfmac_f32_16x16x64_bf16 v[32:35], v[88:91], a[216:223], v4
    v_smfmac_f32_16x16x64_bf16 v[40:43], v[88:91], v[152:159], v4
    v_smfmac_f32_16x16x64_bf16 v[44:47], v[88:91], v[232:239], v4
    s_waitcnt lgkmcnt(7)
    v_smfmac_f32_16x16x64_bf16 v[36:39], v[88:91], v[76:83], v4
    ds_read_b128 v[76:79], v6 offset:2048
    ds_read_b128 v[80:83], v6 offset:3072
    s_waitcnt lgkmcnt(6)
    v_smfmac_f32_16x16x64_bf16 v[24:27], v[48:51], a[0:7], v4
    v_smfmac_f32_16x16x64_bf16 v[28:31], v[48:51], a[80:87], v4
    v_smfmac_f32_16x16x64_bf16 v[40:43], v[48:51], v[96:103], v4
    v_smfmac_f32_16x16x64_bf16 v[36:39], v[48:51], v[68:75], v4
    ds_read_b128 v[68:71], v6 offset:4096
    ds_read_b128 v[72:75], v6 offset:5120
    ds_read_b128 v[48:51], v5 offset:6144
    s_waitcnt lgkmcnt(8)
    v_smfmac_f32_16x16x64_bf16 v[24:27], v[52:55], a[8:15], v4
    v_smfmac_f32_16x16x64_bf16 v[28:31], v[52:55], a[88:95], v4
    v_smfmac_f32_16x16x64_bf16 v[40:43], v[52:55], v[104:111], v4
    s_waitcnt lgkmcnt(3)
    v_smfmac_f32_16x16x64_bf16 v[36:39], v[52:55], v[76:83], v4
    ds_read_b128 v[76:79], v6 offset:8192
    ds_read_b128 v[80:83], v6 offset:9216
    ds_read_b128 v[52:55], v5 offset:8192
    v_smfmac_f32_16x16x64_bf16 v[24:27], v[56:59], a[16:23], v4
    v_smfmac_f32_16x16x64_bf16 v[28:31], v[56:59], a[96:103], v4
    v_smfmac_f32_16x16x64_bf16 v[40:43], v[56:59], v[112:119], v4
    s_waitcnt lgkmcnt(4)
    v_smfmac_f32_16x16x64_bf16 v[36:39], v[56:59], v[68:75], v4
    ds_read_b128 v[68:71], v6 offset:10240
    ds_read_b128 v[72:75], v6 offset:11264
    ds_read_b128 v[56:59], v5 offset:9216
    v_smfmac_f32_16x16x64_bf16 v[24:27], v[60:63], a[32:39], v4
    v_smfmac_f32_16x16x64_bf16 v[28:31], v[60:63], a[112:119], v4
    v_smfmac_f32_16x16x64_bf16 v[40:43], v[60:63], v[128:135], v4
    s_waitcnt lgkmcnt(4)
    v_smfmac_f32_16x16x64_bf16 v[36:39], v[60:63], v[76:83], v4
    ds_read_b128 v[76:79], v6 offset:12288
    ds_read_b128 v[80:83], v6 offset:13312
    ds_read_b128 v[60:63], v5 offset:0
    v_smfmac_f32_16x16x64_bf16 v[24:27], v[64:67], a[40:47], v4
    v_smfmac_f32_16x16x64_bf16 v[28:31], v[64:67], a[120:127], v4
    v_smfmac_f32_16x16x64_bf16 v[40:43], v[64:67], v[136:143], v4
    s_waitcnt lgkmcnt(4)
    v_smfmac_f32_16x16x64_bf16 v[36:39], v[64:67], v[68:75], v4
    ds_read_b128 v[68:71], v6 offset:16384
    ds_read_b128 v[72:75], v6 offset:17408
    ds_read_b128 v[64:67], v5 offset:1024
    v_smfmac_f32_16x16x64_bf16 v[24:27], v[48:51], a[48:55], v4
    v_smfmac_f32_16x16x64_bf16 v[28:31], v[48:51], a[128:135], v4
    v_smfmac_f32_16x16x64_bf16 v[40:43], v[48:51], v[144:151], v4
    s_waitcnt lgkmcnt(4)
    v_smfmac_f32_16x16x64_bf16 v[36:39], v[48:51], v[76:83], v4
    ds_read_b128 v[76:79], v6 offset:18432
    ds_read_b128 v[80:83], v6 offset:19456
    ds_read_b128 v[48:51], v5 offset:2048
    v_smfmac_f32_16x16x64_bf16 v[24:27], v[52:55], a[64:71], v4
    v_smfmac_f32_16x16x64_bf16 v[28:31], v[52:55], a[144:151], v4
    v_smfmac_f32_16x16x64_bf16 v[40:43], v[52:55], v[160:167], v4
    s_waitcnt lgkmcnt(4)
    v_smfmac_f32_16x16x64_bf16 v[36:39], v[52:55], v[68:75], v4
    ds_read_b128 v[52:55], v5 offset:4096
    v_smfmac_f32_16x16x64_bf16 v[24:27], v[56:59], a[72:79], v4
    v_smfmac_f32_16x16x64_bf16 v[28:31], v[56:59], a[152:159], v4
    v_smfmac_f32_16x16x64_bf16 v[40:43], v[56:59], v[168:175], v4
    s_waitcnt lgkmcnt(2)
    v_smfmac_f32_16x16x64_bf16 v[36:39], v[56:59], v[76:83], v4
    ds_read_b128 v[56:59], v5 offset:5120
    buffer_load_dwordx4 v[80:83], v19, s[8:11], s45 offen offset:0 sc1
    buffer_load_dwordx4 v[84:87], v19, s[8:11], s45 offen offset:1024 sc1
    buffer_load_dwordx4 v[88:91], v19, s[8:11], s45 offen offset:2048 sc1
    v_smfmac_f32_16x16x64_bf16 v[32:35], v[60:63], a[160:167], v4
    v_smfmac_f32_16x16x64_bf16 v[44:47], v[60:63], v[176:183], v4
    v_permlane32_swap_b32 v28, v40
    v_permlane32_swap_b32 v29, v41
    ds_read_b128 v[60:63], v5 offset:6144
    v_smfmac_f32_16x16x64_bf16 v[32:35], v[64:67], a[168:175], v4
    v_permlane32_swap_b32 v30, v42
    v_permlane32_swap_b32 v31, v43
    v_smfmac_f32_16x16x64_bf16 v[44:47], v[64:67], v[184:191], v4
    v_add_f32 v28, v28, v40
    v_add_f32 v29, v29, v41
    ds_read_b128 v[64:67], v5 offset:8192
    s_waitcnt lgkmcnt(4)
    v_smfmac_f32_16x16x64_bf16 v[32:35], v[48:51], a[176:183], v4
    v_add_f32 v30, v30, v42
    v_add_f32 v31, v31, v43
    v_smfmac_f32_16x16x64_bf16 v[44:47], v[48:51], v[192:199], v4
    v_cvt_pk_bf16_f32 v40, v28, v29
    v_cvt_pk_bf16_f32 v41, v30, v31
    ds_read_b128 v[48:51], v5 offset:9216
    s_waitcnt lgkmcnt(4)
    v_smfmac_f32_16x16x64_bf16 v[32:35], v[52:55], a[192:199], v4
    v_mfma_f32_16x16x16_bf16 v[28:31], v[40:41], v[10:11], 0
    v_permlane32_swap_b32 v24, v36
    v_smfmac_f32_16x16x64_bf16 v[44:47], v[52:55], v[208:215], v4
    v_permlane32_swap_b32 v25, v37
    v_permlane32_swap_b32 v26, v38
    s_waitcnt lgkmcnt(3)
    v_smfmac_f32_16x16x64_bf16 v[32:35], v[56:59], a[200:207], v4
    v_permlane32_swap_b32 v27, v39
    v_add_f32 v24, v24, v36
    v_smfmac_f32_16x16x64_bf16 v[44:47], v[56:59], v[216:223], v4
    v_add_f32 v25, v25, v37
    v_add_f32 v26, v26, v38
    s_waitcnt lgkmcnt(2)
    v_smfmac_f32_16x16x64_bf16 v[32:35], v[60:63], a[208:215], v4
    v_add_f32 v27, v27, v39
    v_cvt_pk_bf16_f32 v36, v24, v25
    v_smfmac_f32_16x16x64_bf16 v[44:47], v[60:63], v[224:231], v4
    v_cvt_pk_bf16_f32 v37, v26, v27
    s_nop 1
    v_mfma_f32_16x16x16_bf16 v[24:27], v[36:37], v[10:11], 0
    s_waitcnt lgkmcnt(1)
    v_smfmac_f32_16x16x64_bf16 v[32:35], v[64:67], a[224:231], v4
    s_nop 5
    v_cvt_pk_bf16_f32 v24, v24, v25
    v_smfmac_f32_16x16x64_bf16 v[44:47], v[64:67], v[240:247], v4
    v_cvt_pk_bf16_f32 v25, v26, v27
    v_cvt_pk_bf16_f32 v26, v28, v29
    s_waitcnt lgkmcnt(0)
    v_smfmac_f32_16x16x64_bf16 v[32:35], v[48:51], a[232:239], v4
    v_cvt_pk_bf16_f32 v27, v30, v31
    s_waitcnt vmcnt(4)
    v_smfmac_f32_16x16x64_bf16 v[44:47], v[48:51], v[248:255], v4
    v_mfma_f32_16x16x32_bf16 v[28:31], a[240:243], v[24:27], 0
    v_mfma_f32_16x16x32_bf16 v[36:39], a[244:247], v[24:27], 0
    v_mfma_f32_16x16x32_bf16 v[40:43], v[24:27], v[24:27], 0
    s_nop 4
    v_permlane32_swap_b32 v32, v44
    v_permlane32_swap_b32 v33, v45
    v_permlane32_swap_b32 v34, v46
    v_permlane32_swap_b32 v35, v47
    v_add_f32 v32, v32, v44
    v_add_f32 v33, v33, v45
    v_add_f32 v34, v34, v46
    v_add_f32 v35, v35, v47
    v_cvt_pk_bf16_f32 v44, v32, v33
    v_cvt_pk_bf16_f32 v45, v34, v35
    s_nop 1
    v_mfma_f32_16x16x16_bf16 v[32:35], v[44:45], v[10:11], 0
    s_nop 7
    v_cvt_pk_bf16_f32 v32, v32, v33
    v_cvt_pk_bf16_f32 v33, v34, v35
    s_nop 1
    v_mfma_f32_16x16x16_bf16 v[28:31], a[248:249], v[32:33], v[28:31]
    v_mfma_f32_16x16x16_bf16 v[36:39], a[250:251], v[32:33], v[36:39]
    v_mfma_f32_16x16x16_bf16 v[40:43], v[32:33], v[32:33], v[40:43]
    s_nop 5
    ds_write_b128 v12, v[28:31]
    ds_write_b128 v12, v[36:39] offset:16
    ds_write_b128 v13, v[40:43]
    s_waitcnt lgkmcnt(0)
    s_barrier
    s_waitcnt vmcnt(0)
    v_mfma_f32_16x16x32_bf16 v[36:39], a[240:243], v[80:83], 0
    v_mfma_f32_16x16x32_bf16 v[44:47], a[244:247], v[80:83], 0
    v_mfma_f32_16x16x32_bf16 v[68:71], v[24:27], v[80:83], 0
    v_mfma_f32_16x16x32_bf16 v[40:43], a[240:243], v[84:87], 0
    v_mfma_f32_16x16x32_bf16 v[64:67], a[244:247], v[84:87], 0
    v_mfma_f32_16x16x32_bf16 v[72:75], v[24:27], v[84:87], 0
    s_nop 0
    v_mfma_f32_16x16x16_bf16 v[36:39], a[248:249], v[88:89], v[36:39]
    v_mfma_f32_16x16x16_bf16 v[44:47], a[250:251], v[88:89], v[44:47]
    v_mfma_f32_16x16x16_bf16 v[68:71], v[32:33], v[88:89], v[68:71]
    v_mfma_f32_16x16x16_bf16 v[40:43], a[248:249], v[90:91], v[40:43]
    v_mfma_f32_16x16x16_bf16 v[64:67], a[250:251], v[90:91], v[64:67]
    v_mfma_f32_16x16x16_bf16 v[72:75], v[32:33], v[90:91], v[72:75]
    s_nop 2
    ds_write_b128 v16, v[36:39] offset:0
    ds_write_b128 v16, v[44:47] offset:16
    ds_write_b128 v17, v[68:71]
    ds_write_b128 v16, v[40:43] offset:2816
    ds_write_b128 v16, v[64:67] offset:2832
    ds_write_b128 v18, v[72:75]
    s_add_u32 s40, s40, 1
    s_add_u32 s41, s41, 393216
    s_add_u32 s45, s45, 393216
    s_add_u32 s43, s43, 458752
    s_add_u32 s47, s47, 458752
    s_add_u32 s48, s48, 458752
    s_add_u32 s49, s49, 458752
    s_waitcnt lgkmcnt(0)
    s_barrier
    s_cmp_lt_u32 s40, 64
    s_cbranch_scc1 interleave_layers__linear_attn_block__memory_aug_recurrent_mem_tr__prompt_kernel_s_stepw3
interleave_layers__linear_attn_block__memory_aug_recurrent_mem_tr__prompt_kernel_s_end:
    ds_read_b128 v[48:51], v21 offset:0
    ds_read_b128 v[52:55], v21 offset:16
    ds_read_b128 v[56:59], v21 offset:5632
    ds_read_b128 v[60:63], v21 offset:5648
    ds_read_b128 v[64:67], v21 offset:11264
    ds_read_b128 v[68:71], v21 offset:11280
    ds_read_b128 v[72:75], v21 offset:16896
    ds_read_b128 v[76:79], v21 offset:16912
    s_waitcnt lgkmcnt(4)
    v_pk_add_f32 v[48:49], v[48:49], v[56:57]
    v_pk_add_f32 v[50:51], v[50:51], v[58:59]
    v_pk_add_f32 v[52:53], v[52:53], v[60:61]
    v_pk_add_f32 v[54:55], v[54:55], v[62:63]
    s_waitcnt lgkmcnt(0)
    v_pk_add_f32 v[64:65], v[64:65], v[72:73]
    v_pk_add_f32 v[66:67], v[66:67], v[74:75]
    v_pk_add_f32 v[68:69], v[68:69], v[76:77]
    v_pk_add_f32 v[70:71], v[70:71], v[78:79]
    v_pk_add_f32 v[48:49], v[48:49], v[64:65]
    v_pk_add_f32 v[50:51], v[50:51], v[66:67]
    v_pk_add_f32 v[52:53], v[52:53], v[68:69]
    v_pk_add_f32 v[54:55], v[54:55], v[70:71]
    v_mov_b32 v81, 0xff800000
    v_cndmask_b32 v48, v81, v48, s[64:65]
    v_cndmask_b32 v49, v81, v49, s[66:67]
    v_cndmask_b32 v50, v81, v50, s[68:69]
    v_cndmask_b32 v51, v81, v51, s[70:71]
    v_cndmask_b32 v52, v81, v52, s[72:73]
    v_cndmask_b32 v53, v81, v53, s[74:75]
    v_cndmask_b32 v54, v81, v54, s[76:77]
    v_cndmask_b32 v55, v81, v55, s[78:79]
    v_max3_f32 v80, v48, v49, v50
    v_max3_f32 v80, v80, v51, v52
    v_max3_f32 v80, v80, v53, v54
    v_max_f32 v80, v80, v55
    v_mov_b32 v81, 0xff800000
    v_cndmask_b32 v80, v81, v80, s[50:51]
    s_nop 1
    v_max_f32 v80, v80, v80 quad_perm:[1,0,3,2] row_mask:0xf bank_mask:0xf
    s_nop 1
    v_max_f32 v80, v80, v80 quad_perm:[2,3,0,1] row_mask:0xf bank_mask:0xf
    s_nop 1
    v_max_f32 v80, v80, v80 row_half_mirror row_mask:0xf bank_mask:0xf
    s_mov_b32 s24, 0x3dd53b95
    v_mul_f32 v80, s24, v80
    v_fma_f32 v48, v48, s24, -v80
    v_fma_f32 v49, v49, s24, -v80
    v_fma_f32 v50, v50, s24, -v80
    v_fma_f32 v51, v51, s24, -v80
    v_fma_f32 v52, v52, s24, -v80
    v_fma_f32 v53, v53, s24, -v80
    v_fma_f32 v54, v54, s24, -v80
    v_fma_f32 v55, v55, s24, -v80
    v_exp_f32 v48, v48
    v_exp_f32 v49, v49
    v_exp_f32 v50, v50
    v_exp_f32 v51, v51
    v_exp_f32 v52, v52
    v_exp_f32 v53, v53
    v_exp_f32 v54, v54
    v_exp_f32 v55, v55
    v_add_f32 v80, v48, v49
    v_add_f32 v81, v50, v51
    v_add_f32 v80, v80, v52
    v_add_f32 v81, v81, v53
    v_add_f32 v80, v80, v54
    v_add_f32 v81, v81, v55
    v_add_f32 v80, v80, v81
    v_cndmask_b32 v80, 0, v80, s[50:51]
    s_nop 1
    v_add_f32 v80, v80, v80 quad_perm:[1,0,3,2] row_mask:0xf bank_mask:0xf
    s_nop 1
    v_add_f32 v80, v80, v80 quad_perm:[2,3,0,1] row_mask:0xf bank_mask:0xf
    s_nop 1
    v_add_f32 v80, v80, v80 row_half_mirror row_mask:0xf bank_mask:0xf
    v_rcp_f32 v80, v80
    s_nop 0
    v_mul_f32 v48, v48, v80
    v_mul_f32 v49, v49, v80
    v_mul_f32 v50, v50, v80
    v_mul_f32 v51, v51, v80
    v_mul_f32 v52, v52, v80
    v_mul_f32 v53, v53, v80
    v_mul_f32 v54, v54, v80
    v_mul_f32 v55, v55, v80
    v_cvt_pk_bf16_f32 v56, v48, v49
    v_cvt_pk_bf16_f32 v57, v50, v51
    v_cvt_pk_bf16_f32 v58, v52, v53
    v_cvt_pk_bf16_f32 v59, v54, v55
    v_min_u32 v56, -2, v56
    v_min_u32 v57, -2, v57
    v_min_u32 v58, -2, v58
    v_min_u32 v59, -2, v59
    buffer_store_dwordx4 v[56:59], v22, s[8:11], s42 offen sc1
    s_add_u32 s42, s42, 458752
    s_cmp_eq_u32 s92, 0
    s_cbranch_scc0 interleave_layers__linear_attn_block__memory_aug_recurrent_mem_tr__prompt_kernel_end
    s_mov_b32 s92, 1
    s_branch interleave_layers__linear_attn_block__memory_aug_recurrent_mem_tr__prompt_kernel_s_layer
interleave_layers__linear_attn_block__memory_aug_recurrent_mem_tr__prompt_kernel_roleV:
    s_sub_u32 s44, s2, 32
    s_load_dwordx2 s[6:7], s[0:1], 56
    s_load_dwordx2 s[24:25], s[0:1], 64
    s_load_dwordx2 s[26:27], s[0:1], 32
    s_waitcnt lgkmcnt(0)
    s_mov_b32 s12, s6
    s_mov_b32 s13, s7
    s_mov_b32 s14, 7864320
    s_mov_b32 s15, 0x00020000
    s_mov_b32 s16, s24
    s_mov_b32 s17, s25
    s_mov_b32 s18, 7864320
    s_mov_b32 s19, 0x00020000
    s_mov_b32 s20, s26
    s_mov_b32 s21, s27
    s_mov_b32 s22, 10240
    s_mov_b32 s23, 0x00020000
    v_add_u32 v16, 0, v0
    s_mov_b32 s24, 683
    v_mul_lo_u32 v17, v16, s24
    v_lshrrev_b32 v17, 14, v17
    v_mul_u32_u24 v18, 24, v17
    v_sub_u32 v18, v16, v18
    s_mov_b32 s24, 12288
    v_mul_lo_u32 v4, v17, s24
    v_lshl_add_u32 v4, v18, 4, v4
    v_mul_u32_u24 v10, 400, v17
    v_lshl_add_u32 v10, v18, 4, v10
    v_add_u32 v10, 90112, v10
    v_add_u32 v16, 256, v0
    s_mov_b32 s24, 683
    v_mul_lo_u32 v17, v16, s24
    v_lshrrev_b32 v17, 14, v17
    v_mul_u32_u24 v18, 24, v17
    v_sub_u32 v18, v16, v18
    s_mov_b32 s24, 12288
    v_mul_lo_u32 v5, v17, s24
    v_lshl_add_u32 v5, v18, 4, v5
    v_mul_u32_u24 v11, 400, v17
    v_lshl_add_u32 v11, v18, 4, v11
    v_add_u32 v11, 90112, v11
    v_add_u32 v16, 512, v0
    s_mov_b32 s24, 683
    v_mul_lo_u32 v17, v16, s24
    v_lshrrev_b32 v17, 14, v17
    v_mul_u32_u24 v18, 24, v17
    v_sub_u32 v18, v16, v18
    s_mov_b32 s24, 12288
    v_mul_lo_u32 v6, v17, s24
    v_lshl_add_u32 v6, v18, 4, v6
    v_mul_u32_u24 v12, 400, v17
    v_lshl_add_u32 v12, v18, 4, v12
    v_add_u32 v12, 90112, v12
    v_add_u32 v16, 768, v0
    s_mov_b32 s24, 683
    v_mul_lo_u32 v17, v16, s24
    v_lshrrev_b32 v17, 14, v17
    v_mul_u32_u24 v18, 24, v17
    v_sub_u32 v18, v16, v18
    s_mov_b32 s24, 12288
    v_mul_lo_u32 v7, v17, s24
    v_lshl_add_u32 v7, v18, 4, v7
    v_mul_u32_u24 v13, 400, v17
    v_lshl_add_u32 v13, v18, 4, v13
    v_add_u32 v13, 90112, v13
    v_add_u32 v16, 1024, v0
    s_mov_b32 s24, 683
    v_mul_lo_u32 v17, v16, s24
    v_lshrrev_b32 v17, 14, v17
    v_mul_u32_u24 v18, 24, v17
    v_sub_u32 v18, v16, v18
    s_mov_b32 s24, 12288
    v_mul_lo_u32 v8, v17, s24
    v_lshl_add_u32 v8, v18, 4, v8
    v_mul_u32_u24 v14, 400, v17
    v_lshl_add_u32 v14, v18, 4, v14
    v_add_u32 v14, 90112, v14
    v_add_u32 v16, 1280, v0
    s_mov_b32 s24, 683
    v_mul_lo_u32 v17, v16, s24
    v_lshrrev_b32 v17, 14, v17
    v_mul_u32_u24 v18, 24, v17
    v_sub_u32 v18, v16, v18
    s_mov_b32 s24, 12288
    v_mul_lo_u32 v9, v17, s24
    v_lshl_add_u32 v9, v18, 4, v9
    v_mul_u32_u24 v15, 400, v17
    v_lshl_add_u32 v15, v18, 4, v15
    v_add_u32 v15, 90112, v15
    v_lshrrev_b32 v17, 1, v3
    v_lshlrev_b32 v17, 4, v17
    v_and_b32 v18, 1, v3
    v_lshl_add_u32 v17, v18, 2, v17
    v_lshrrev_b32 v18, 2, v2
    v_and_b32 v19, 1, v18
    v_add_u32 v17, v17, v19
    v_lshrrev_b32 v18, 1, v18
    v_lshl_add_u32 v17, v18, 3, v17
    v_mul_u32_u24 v16, 400, v17
    v_and_b32 v18, 3, v2
    v_lshl_add_u32 v16, v18, 3, v16
    v_add_u32 v16, 90112, v16
    s_mul_i32 s24, s3, 96
    v_add_u32 v16, s24, v16
    s_mul_i32 s45, s44, 384
    s_add_u32 s46, s45, 0
    buffer_load_dwordx4 v[24:27], v4, s[12:15], s46 offen
    buffer_load_dwordx4 v[28:31], v5, s[12:15], s46 offen
    buffer_load_dwordx4 v[32:35], v6, s[12:15], s46 offen
    buffer_load_dwordx4 v[36:39], v7, s[12:15], s46 offen
    buffer_load_dwordx4 v[40:43], v8, s[12:15], s46 offen
    buffer_load_dwordx4 v[44:47], v9, s[12:15], s46 offen
    s_add_u32 s46, s45, 786432
    buffer_load_dwordx4 v[48:51], v4, s[12:15], s46 offen
    buffer_load_dwordx4 v[52:55], v5, s[12:15], s46 offen
    buffer_load_dwordx4 v[56:59], v6, s[12:15], s46 offen
    buffer_load_dwordx4 v[60:63], v7, s[12:15], s46 offen
    buffer_load_dwordx4 v[64:67], v8, s[12:15], s46 offen
    buffer_load_dwordx4 v[68:71], v9, s[12:15], s46 offen
    s_waitcnt vmcnt(6)
    ds_write_b128 v10, v[24:27]
    ds_write_b128 v11, v[28:31]
    ds_write_b128 v12, v[32:35]
    ds_write_b128 v13, v[36:39]
    ds_write_b128 v14, v[40:43]
    ds_write_b128 v15, v[44:47]
    s_add_u32 s46, s45, 1572864
    buffer_load_dwordx4 v[72:75], v4, s[12:15], s46 offen
    buffer_load_dwordx4 v[76:79], v5, s[12:15], s46 offen
    buffer_load_dwordx4 v[80:83], v6, s[12:15], s46 offen
    buffer_load_dwordx4 v[84:87], v7, s[12:15], s46 offen
    buffer_load_dwordx4 v[88:91], v8, s[12:15], s46 offen
    buffer_load_dwordx4 v[92:95], v9, s[12:15], s46 offen
    s_waitcnt lgkmcnt(0)
    s_barrier
    ds_read_b64_tr_b16 a[0:1], v16 offset:0
    ds_read_b64_tr_b16 a[2:3], v16 offset:800
    ds_read_b64_tr_b16 a[4:5], v16 offset:12800
    ds_read_b64_tr_b16 a[6:7], v16 offset:13600
    ds_read_b64_tr_b16 a[80:81], v16 offset:32
    ds_read_b64_tr_b16 a[82:83], v16 offset:832
    ds_read_b64_tr_b16 a[84:85], v16 offset:12832
    ds_read_b64_tr_b16 a[86:87], v16 offset:13632
    ds_read_b64_tr_b16 a[160:161], v16 offset:64
    ds_read_b64_tr_b16 a[162:163], v16 offset:864
    ds_read_b64_tr_b16 a[164:165], v16 offset:12864
    ds_read_b64_tr_b16 a[166:167], v16 offset:13664
    s_waitcnt lgkmcnt(0)
    s_barrier
    s_waitcnt vmcnt(6)
    ds_write_b128 v10, v[48:51]
    ds_write_b128 v11, v[52:55]
    ds_write_b128 v12, v[56:59]
    ds_write_b128 v13, v[60:63]
    ds_write_b128 v14, v[64:67]
    ds_write_b128 v15, v[68:71]
    s_add_u32 s46, s45, 2359296
    buffer_load_dwordx4 v[24:27], v4, s[12:15], s46 offen
    buffer_load_dwordx4 v[28:31], v5, s[12:15], s46 offen
    buffer_load_dwordx4 v[32:35], v6, s[12:15], s46 offen
    buffer_load_dwordx4 v[36:39], v7, s[12:15], s46 offen
    buffer_load_dwordx4 v[40:43], v8, s[12:15], s46 offen
    buffer_load_dwordx4 v[44:47], v9, s[12:15], s46 offen
    s_waitcnt lgkmcnt(0)
    s_barrier
    ds_read_b64_tr_b16 a[8:9], v16 offset:0
    ds_read_b64_tr_b16 a[10:11], v16 offset:800
    ds_read_b64_tr_b16 a[12:13], v16 offset:12800
    ds_read_b64_tr_b16 a[14:15], v16 offset:13600
    ds_read_b64_tr_b16 a[88:89], v16 offset:32
    ds_read_b64_tr_b16 a[90:91], v16 offset:832
    ds_read_b64_tr_b16 a[92:93], v16 offset:12832
    ds_read_b64_tr_b16 a[94:95], v16 offset:13632
    ds_read_b64_tr_b16 a[168:169], v16 offset:64
    ds_read_b64_tr_b16 a[170:171], v16 offset:864
    ds_read_b64_tr_b16 a[172:173], v16 offset:12864
    ds_read_b64_tr_b16 a[174:175], v16 offset:13664
    s_waitcnt lgkmcnt(0)
    s_barrier
    s_waitcnt vmcnt(6)
    ds_write_b128 v10, v[72:75]
    ds_write_b128 v11, v[76:79]
    ds_write_b128 v12, v[80:83]
    ds_write_b128 v13, v[84:87]
    ds_write_b128 v14, v[88:91]
    ds_write_b128 v15, v[92:95]
    s_add_u32 s46, s45, 3145728
    buffer_load_dwordx4 v[48:51], v4, s[12:15], s46 offen
    buffer_load_dwordx4 v[52:55], v5, s[12:15], s46 offen
    buffer_load_dwordx4 v[56:59], v6, s[12:15], s46 offen
    buffer_load_dwordx4 v[60:63], v7, s[12:15], s46 offen
    buffer_load_dwordx4 v[64:67], v8, s[12:15], s46 offen
    buffer_load_dwordx4 v[68:71], v9, s[12:15], s46 offen
    s_waitcnt lgkmcnt(0)
    s_barrier
    ds_read_b64_tr_b16 a[16:17], v16 offset:0
    ds_read_b64_tr_b16 a[18:19], v16 offset:800
    ds_read_b64_tr_b16 a[20:21], v16 offset:12800
    ds_read_b64_tr_b16 a[22:23], v16 offset:13600
    ds_read_b64_tr_b16 a[96:97], v16 offset:32
    ds_read_b64_tr_b16 a[98:99], v16 offset:832
    ds_read_b64_tr_b16 a[100:101], v16 offset:12832
    ds_read_b64_tr_b16 a[102:103], v16 offset:13632
    ds_read_b64_tr_b16 a[176:177], v16 offset:64
    ds_read_b64_tr_b16 a[178:179], v16 offset:864
    ds_read_b64_tr_b16 a[180:181], v16 offset:12864
    ds_read_b64_tr_b16 a[182:183], v16 offset:13664
    s_waitcnt lgkmcnt(0)
    s_barrier
    s_waitcnt vmcnt(6)
    ds_write_b128 v10, v[24:27]
    ds_write_b128 v11, v[28:31]
    ds_write_b128 v12, v[32:35]
    ds_write_b128 v13, v[36:39]
    ds_write_b128 v14, v[40:43]
    ds_write_b128 v15, v[44:47]
    s_add_u32 s46, s45, 3932160
    buffer_load_dwordx4 v[72:75], v4, s[12:15], s46 offen
    buffer_load_dwordx4 v[76:79], v5, s[12:15], s46 offen
    buffer_load_dwordx4 v[80:83], v6, s[12:15], s46 offen
    buffer_load_dwordx4 v[84:87], v7, s[12:15], s46 offen
    buffer_load_dwordx4 v[88:91], v8, s[12:15], s46 offen
    buffer_load_dwordx4 v[92:95], v9, s[12:15], s46 offen
    s_waitcnt lgkmcnt(0)
    s_barrier
    ds_read_b64_tr_b16 a[24:25], v16 offset:0
    ds_read_b64_tr_b16 a[26:27], v16 offset:800
    ds_read_b64_tr_b16 a[28:29], v16 offset:12800
    ds_read_b64_tr_b16 a[30:31], v16 offset:13600
    ds_read_b64_tr_b16 a[104:105], v16 offset:32
    ds_read_b64_tr_b16 a[106:107], v16 offset:832
    ds_read_b64_tr_b16 a[108:109], v16 offset:12832
    ds_read_b64_tr_b16 a[110:111], v16 offset:13632
    ds_read_b64_tr_b16 a[184:185], v16 offset:64
    ds_read_b64_tr_b16 a[186:187], v16 offset:864
    ds_read_b64_tr_b16 a[188:189], v16 offset:12864
    ds_read_b64_tr_b16 a[190:191], v16 offset:13664
    s_waitcnt lgkmcnt(0)
    s_barrier
    s_waitcnt vmcnt(6)
    ds_write_b128 v10, v[48:51]
    ds_write_b128 v11, v[52:55]
    ds_write_b128 v12, v[56:59]
    ds_write_b128 v13, v[60:63]
    ds_write_b128 v14, v[64:67]
    ds_write_b128 v15, v[68:71]
    s_add_u32 s46, s45, 4718592
    buffer_load_dwordx4 v[24:27], v4, s[12:15], s46 offen
    buffer_load_dwordx4 v[28:31], v5, s[12:15], s46 offen
    buffer_load_dwordx4 v[32:35], v6, s[12:15], s46 offen
    buffer_load_dwordx4 v[36:39], v7, s[12:15], s46 offen
    buffer_load_dwordx4 v[40:43], v8, s[12:15], s46 offen
    buffer_load_dwordx4 v[44:47], v9, s[12:15], s46 offen
    s_waitcnt lgkmcnt(0)
    s_barrier
    ds_read_b64_tr_b16 a[32:33], v16 offset:0
    ds_read_b64_tr_b16 a[34:35], v16 offset:800
    ds_read_b64_tr_b16 a[36:37], v16 offset:12800
    ds_read_b64_tr_b16 a[38:39], v16 offset:13600
    ds_read_b64_tr_b16 a[112:113], v16 offset:32
    ds_read_b64_tr_b16 a[114:115], v16 offset:832
    ds_read_b64_tr_b16 a[116:117], v16 offset:12832
    ds_read_b64_tr_b16 a[118:119], v16 offset:13632
    ds_read_b64_tr_b16 a[192:193], v16 offset:64
    ds_read_b64_tr_b16 a[194:195], v16 offset:864
    ds_read_b64_tr_b16 a[196:197], v16 offset:12864
    ds_read_b64_tr_b16 a[198:199], v16 offset:13664
    s_waitcnt lgkmcnt(0)
    s_barrier
    s_waitcnt vmcnt(6)
    ds_write_b128 v10, v[72:75]
    ds_write_b128 v11, v[76:79]
    ds_write_b128 v12, v[80:83]
    ds_write_b128 v13, v[84:87]
    ds_write_b128 v14, v[88:91]
    ds_write_b128 v15, v[92:95]
    s_add_u32 s46, s45, 5505024
    buffer_load_dwordx4 v[48:51], v4, s[12:15], s46 offen
    buffer_load_dwordx4 v[52:55], v5, s[12:15], s46 offen
    buffer_load_dwordx4 v[56:59], v6, s[12:15], s46 offen
    buffer_load_dwordx4 v[60:63], v7, s[12:15], s46 offen
    buffer_load_dwordx4 v[64:67], v8, s[12:15], s46 offen
    buffer_load_dwordx4 v[68:71], v9, s[12:15], s46 offen
    s_waitcnt lgkmcnt(0)
    s_barrier
    ds_read_b64_tr_b16 a[40:41], v16 offset:0
    ds_read_b64_tr_b16 a[42:43], v16 offset:800
    ds_read_b64_tr_b16 a[44:45], v16 offset:12800
    ds_read_b64_tr_b16 a[46:47], v16 offset:13600
    ds_read_b64_tr_b16 a[120:121], v16 offset:32
    ds_read_b64_tr_b16 a[122:123], v16 offset:832
    ds_read_b64_tr_b16 a[124:125], v16 offset:12832
    ds_read_b64_tr_b16 a[126:127], v16 offset:13632
    ds_read_b64_tr_b16 a[200:201], v16 offset:64
    ds_read_b64_tr_b16 a[202:203], v16 offset:864
    ds_read_b64_tr_b16 a[204:205], v16 offset:12864
    ds_read_b64_tr_b16 a[206:207], v16 offset:13664
    s_waitcnt lgkmcnt(0)
    s_barrier
    s_waitcnt vmcnt(6)
    ds_write_b128 v10, v[24:27]
    ds_write_b128 v11, v[28:31]
    ds_write_b128 v12, v[32:35]
    ds_write_b128 v13, v[36:39]
    ds_write_b128 v14, v[40:43]
    ds_write_b128 v15, v[44:47]
    s_add_u32 s46, s45, 6291456
    buffer_load_dwordx4 v[72:75], v4, s[12:15], s46 offen
    buffer_load_dwordx4 v[76:79], v5, s[12:15], s46 offen
    buffer_load_dwordx4 v[80:83], v6, s[12:15], s46 offen
    buffer_load_dwordx4 v[84:87], v7, s[12:15], s46 offen
    buffer_load_dwordx4 v[88:91], v8, s[12:15], s46 offen
    buffer_load_dwordx4 v[92:95], v9, s[12:15], s46 offen
    s_waitcnt lgkmcnt(0)
    s_barrier
    ds_read_b64_tr_b16 a[48:49], v16 offset:0
    ds_read_b64_tr_b16 a[50:51], v16 offset:800
    ds_read_b64_tr_b16 a[52:53], v16 offset:12800
    ds_read_b64_tr_b16 a[54:55], v16 offset:13600
    ds_read_b64_tr_b16 a[128:129], v16 offset:32
    ds_read_b64_tr_b16 a[130:131], v16 offset:832
    ds_read_b64_tr_b16 a[132:133], v16 offset:12832
    ds_read_b64_tr_b16 a[134:135], v16 offset:13632
    ds_read_b64_tr_b16 a[208:209], v16 offset:64
    ds_read_b64_tr_b16 a[210:211], v16 offset:864
    ds_read_b64_tr_b16 a[212:213], v16 offset:12864
    ds_read_b64_tr_b16 a[214:215], v16 offset:13664
    s_waitcnt lgkmcnt(0)
    s_barrier
    s_waitcnt vmcnt(6)
    ds_write_b128 v10, v[48:51]
    ds_write_b128 v11, v[52:55]
    ds_write_b128 v12, v[56:59]
    ds_write_b128 v13, v[60:63]
    ds_write_b128 v14, v[64:67]
    ds_write_b128 v15, v[68:71]
    s_add_u32 s46, s45, 7077888
    buffer_load_dwordx4 v[24:27], v4, s[12:15], s46 offen
    buffer_load_dwordx4 v[28:31], v5, s[12:15], s46 offen
    buffer_load_dwordx4 v[32:35], v6, s[12:15], s46 offen
    buffer_load_dwordx4 v[36:39], v7, s[12:15], s46 offen
    buffer_load_dwordx4 v[40:43], v8, s[12:15], s46 offen
    buffer_load_dwordx4 v[44:47], v9, s[12:15], s46 offen
    s_waitcnt lgkmcnt(0)
    s_barrier
    ds_read_b64_tr_b16 a[56:57], v16 offset:0
    ds_read_b64_tr_b16 a[58:59], v16 offset:800
    ds_read_b64_tr_b16 a[60:61], v16 offset:12800
    ds_read_b64_tr_b16 a[62:63], v16 offset:13600
    ds_read_b64_tr_b16 a[136:137], v16 offset:32
    ds_read_b64_tr_b16 a[138:139], v16 offset:832
    ds_read_b64_tr_b16 a[140:141], v16 offset:12832
    ds_read_b64_tr_b16 a[142:143], v16 offset:13632
    ds_read_b64_tr_b16 a[216:217], v16 offset:64
    ds_read_b64_tr_b16 a[218:219], v16 offset:864
    ds_read_b64_tr_b16 a[220:221], v16 offset:12864
    ds_read_b64_tr_b16 a[222:223], v16 offset:13664
    s_waitcnt lgkmcnt(0)
    s_barrier
    s_waitcnt vmcnt(6)
    ds_write_b128 v10, v[72:75]
    ds_write_b128 v11, v[76:79]
    ds_write_b128 v12, v[80:83]
    ds_write_b128 v13, v[84:87]
    ds_write_b128 v14, v[88:91]
    ds_write_b128 v15, v[92:95]
    s_waitcnt lgkmcnt(0)
    s_barrier
    ds_read_b64_tr_b16 a[64:65], v16 offset:0
    ds_read_b64_tr_b16 a[66:67], v16 offset:800
    ds_read_b64_tr_b16 a[68:69], v16 offset:12800
    ds_read_b64_tr_b16 a[70:71], v16 offset:13600
    ds_read_b64_tr_b16 a[144:145], v16 offset:32
    ds_read_b64_tr_b16 a[146:147], v16 offset:832
    ds_read_b64_tr_b16 a[148:149], v16 offset:12832
    ds_read_b64_tr_b16 a[150:151], v16 offset:13632
    ds_read_b64_tr_b16 a[224:225], v16 offset:64
    ds_read_b64_tr_b16 a[226:227], v16 offset:864
    ds_read_b64_tr_b16 a[228:229], v16 offset:12864
    ds_read_b64_tr_b16 a[230:231], v16 offset:13664
    s_waitcnt lgkmcnt(0)
    s_barrier
    s_waitcnt vmcnt(0)
    ds_write_b128 v10, v[24:27]
    ds_write_b128 v11, v[28:31]
    ds_write_b128 v12, v[32:35]
    ds_write_b128 v13, v[36:39]
    ds_write_b128 v14, v[40:43]
    ds_write_b128 v15, v[44:47]
    s_waitcnt lgkmcnt(0)
    s_barrier
    ds_read_b64_tr_b16 a[72:73], v16 offset:0
    ds_read_b64_tr_b16 a[74:75], v16 offset:800
    ds_read_b64_tr_b16 a[76:77], v16 offset:12800
    ds_read_b64_tr_b16 a[78:79], v16 offset:13600
    ds_read_b64_tr_b16 a[152:153], v16 offset:32
    ds_read_b64_tr_b16 a[154:155], v16 offset:832
    ds_read_b64_tr_b16 a[156:157], v16 offset:12832
    ds_read_b64_tr_b16 a[158:159], v16 offset:13632
    ds_read_b64_tr_b16 a[232:233], v16 offset:64
    ds_read_b64_tr_b16 a[234:235], v16 offset:864
    ds_read_b64_tr_b16 a[236:237], v16 offset:12864
    ds_read_b64_tr_b16 a[238:239], v16 offset:13664
    s_waitcnt lgkmcnt(0)
    s_barrier
    v_add_u32 v64, 0, v0
    s_mov_b32 s24, 1639
    v_mul_lo_u32 v65, v64, s24
    v_lshrrev_b32 v65, 16, v65
    v_mul_u32_u24 v66, 40, v65
    v_sub_u32 v66, v64, v66
    s_mov_b32 s24, 1280
    v_mul_lo_u32 v4, v65, s24
    v_lshl_add_u32 v4, v66, 4, v4
    v_mul_u32_u24 v14, 656, v65
    v_lshl_add_u32 v14, v66, 4, v14
    v_add_u32 v14, 90112, v14
    v_add_u32 v64, 256, v0
    s_mov_b32 s24, 1639
    v_mul_lo_u32 v65, v64, s24
    v_lshrrev_b32 v65, 16, v65
    v_mul_u32_u24 v66, 40, v65
    v_sub_u32 v66, v64, v66
    s_mov_b32 s24, 1280
    v_mul_lo_u32 v5, v65, s24
    v_lshl_add_u32 v5, v66, 4, v5
    v_mul_u32_u24 v15, 656, v65
    v_lshl_add_u32 v15, v66, 4, v15
    v_add_u32 v15, 90112, v15
    v_add_u32 v64, 512, v0
    s_mov_b32 s24, 1639
    v_mul_lo_u32 v65, v64, s24
    v_lshrrev_b32 v65, 16, v65
    v_mul_u32_u24 v66, 40, v65
    v_sub_u32 v66, v64, v66
    s_mov_b32 s24, 1280
    v_mul_lo_u32 v6, v65, s24
    v_lshl_add_u32 v6, v66, 4, v6
    v_mul_u32_u24 v16, 656, v65
    v_lshl_add_u32 v16, v66, 4, v16
    v_add_u32 v16, 90112, v16
    v_add_u32 v64, 768, v0
    s_mov_b32 s24, 1639
    v_mul_lo_u32 v65, v64, s24
    v_lshrrev_b32 v65, 16, v65
    v_mul_u32_u24 v66, 40, v65
    v_sub_u32 v66, v64, v66
    s_mov_b32 s24, 1280
    v_mul_lo_u32 v7, v65, s24
    v_lshl_add_u32 v7, v66, 4, v7
    v_mul_u32_u24 v17, 656, v65
    v_lshl_add_u32 v17, v66, 4, v17
    v_add_u32 v17, 90112, v17
    v_add_u32 v64, 1024, v0
    s_mov_b32 s24, 1639
    v_mul_lo_u32 v65, v64, s24
    v_lshrrev_b32 v65, 16, v65
    v_mul_u32_u24 v66, 40, v65
    v_sub_u32 v66, v64, v66
    s_mov_b32 s24, 1280
    v_mul_lo_u32 v8, v65, s24
    v_lshl_add_u32 v8, v66, 4, v8
    v_mul_u32_u24 v18, 656, v65
    v_lshl_add_u32 v18, v66, 4, v18
    v_add_u32 v18, 90112, v18
    v_add_u32 v64, 1280, v0
    s_mov_b32 s24, 1639
    v_mul_lo_u32 v65, v64, s24
    v_lshrrev_b32 v65, 16, v65
    v_mul_u32_u24 v66, 40, v65
    v_sub_u32 v66, v64, v66
    s_mov_b32 s24, 1280
    v_mul_lo_u32 v9, v65, s24
    v_lshl_add_u32 v9, v66, 4, v9
    v_mul_u32_u24 v19, 656, v65
    v_lshl_add_u32 v19, v66, 4, v19
    v_add_u32 v19, 90112, v19
    v_add_u32 v64, 1536, v0
    s_mov_b32 s24, 1639
    v_mul_lo_u32 v65, v64, s24
    v_lshrrev_b32 v65, 16, v65
    v_mul_u32_u24 v66, 40, v65
    v_sub_u32 v66, v64, v66
    s_mov_b32 s24, 1280
    v_mul_lo_u32 v10, v65, s24
    v_lshl_add_u32 v10, v66, 4, v10
    v_mul_u32_u24 v20, 656, v65
    v_lshl_add_u32 v20, v66, 4, v20
    v_add_u32 v20, 90112, v20
    v_add_u32 v64, 1792, v0
    s_mov_b32 s24, 1639
    v_mul_lo_u32 v65, v64, s24
    v_lshrrev_b32 v65, 16, v65
    v_mul_u32_u24 v66, 40, v65
    v_sub_u32 v66, v64, v66
    s_mov_b32 s24, 1280
    v_mul_lo_u32 v11, v65, s24
    v_lshl_add_u32 v11, v66, 4, v11
    v_mul_u32_u24 v21, 656, v65
    v_lshl_add_u32 v21, v66, 4, v21
    v_add_u32 v21, 90112, v21
    v_add_u32 v64, 2048, v0
    s_mov_b32 s24, 1639
    v_mul_lo_u32 v65, v64, s24
    v_lshrrev_b32 v65, 16, v65
    v_mul_u32_u24 v66, 40, v65
    v_sub_u32 v66, v64, v66
    s_mov_b32 s24, 1280
    v_mul_lo_u32 v12, v65, s24
    v_lshl_add_u32 v12, v66, 4, v12
    v_mul_u32_u24 v22, 656, v65
    v_lshl_add_u32 v22, v66, 4, v22
    v_add_u32 v22, 90112, v22
    v_add_u32 v64, 2304, v0
    s_mov_b32 s24, 1639
    v_mul_lo_u32 v65, v64, s24
    v_lshrrev_b32 v65, 16, v65
    v_mul_u32_u24 v66, 40, v65
    v_sub_u32 v66, v64, v66
    s_mov_b32 s24, 1280
    v_mul_lo_u32 v13, v65, s24
    v_lshl_add_u32 v13, v66, 4, v13
    v_mul_u32_u24 v23, 656, v65
    v_lshl_add_u32 v23, v66, 4, v23
    v_add_u32 v23, 90112, v23
    v_lshrrev_b32 v64, 1, v3
    v_lshlrev_b32 v64, 4, v64
    v_and_b32 v65, 1, v3
    v_lshl_add_u32 v64, v65, 2, v64
    v_lshrrev_b32 v65, 2, v2
    v_and_b32 v66, 1, v65
    v_add_u32 v64, v64, v66
    v_lshrrev_b32 v65, 1, v65
    v_lshl_add_u32 v64, v65, 3, v64
    v_mul_u32_u24 v72, 656, v64
    v_and_b32 v65, 3, v2
    v_lshl_add_u32 v72, v65, 3, v72
    v_add_u32 v72, 90112, v72
    s_and_b32 s24, s3, 1
    s_mul_i32 s24, s24, 320
    v_add_u32 v72, s24, v72
    v_lshlrev_b32 v73, 4, v1
    s_mul_i32 s24, s3, 18432
    s_add_u32 s24, s24, 16384
    v_add_u32 v73, s24, v73
    s_mul_i32 s45, s44, 245760
    s_add_u32 s46, s45, 0
    buffer_load_dwordx4 v[24:27], v4, s[16:19], s46 offen
    buffer_load_dwordx4 v[28:31], v5, s[16:19], s46 offen
    buffer_load_dwordx4 v[32:35], v6, s[16:19], s46 offen
    buffer_load_dwordx4 v[36:39], v7, s[16:19], s46 offen
    buffer_load_dwordx4 v[40:43], v8, s[16:19], s46 offen
    buffer_load_dwordx4 v[44:47], v9, s[16:19], s46 offen
    buffer_load_dwordx4 v[48:51], v10, s[16:19], s46 offen
    buffer_load_dwordx4 v[52:55], v11, s[16:19], s46 offen
    buffer_load_dwordx4 v[56:59], v12, s[16:19], s46 offen
    buffer_load_dwordx4 v[60:63], v13, s[16:19], s46 offen
    s_waitcnt vmcnt(0)
    ds_write_b128 v14, v[24:27]
    ds_write_b128 v15, v[28:31]
    ds_write_b128 v16, v[32:35]
    ds_write_b128 v17, v[36:39]
    ds_write_b128 v18, v[40:43]
    ds_write_b128 v19, v[44:47]
    ds_write_b128 v20, v[48:51]
    ds_write_b128 v21, v[52:55]
    ds_write_b128 v22, v[56:59]
    ds_write_b128 v23, v[60:63]
    s_waitcnt lgkmcnt(0)
    s_barrier
    s_lshr_b32 s24, s3, 1
    s_cmp_eq_u32 s24, 0
    s_cbranch_scc0 interleave_layers__linear_attn_block__memory_aug_recurrent_mem_tr__prompt_kernel_wo16
    ds_read_b64_tr_b16 a[240:241], v72 offset:0
    ds_read_b64_tr_b16 a[242:243], v72 offset:1312
    ds_read_b64_tr_b16 a[244:245], v72 offset:20992
    ds_read_b64_tr_b16 a[246:247], v72 offset:22304
    ds_read_b64_tr_b16 v[112:113], v72 offset:32
    ds_read_b64_tr_b16 v[114:115], v72 offset:1344
    ds_read_b64_tr_b16 v[116:117], v72 offset:21024
    ds_read_b64_tr_b16 v[118:119], v72 offset:22336
    ds_read_b64_tr_b16 v[136:137], v72 offset:64
    ds_read_b64_tr_b16 v[138:139], v72 offset:1376
    ds_read_b64_tr_b16 v[140:141], v72 offset:21056
    ds_read_b64_tr_b16 v[142:143], v72 offset:22368
    ds_read_b64_tr_b16 v[160:161], v72 offset:96
    ds_read_b64_tr_b16 v[162:163], v72 offset:1408
    ds_read_b64_tr_b16 v[164:165], v72 offset:21088
    ds_read_b64_tr_b16 v[166:167], v72 offset:22400
    ds_read_b64_tr_b16 v[184:185], v72 offset:128
    ds_read_b64_tr_b16 v[186:187], v72 offset:1440
    ds_read_b64_tr_b16 v[188:189], v72 offset:21120
    ds_read_b64_tr_b16 v[190:191], v72 offset:22432
    ds_read_b64_tr_b16 v[208:209], v72 offset:160
    ds_read_b64_tr_b16 v[210:211], v72 offset:1472
    ds_read_b64_tr_b16 v[212:213], v72 offset:21152
    ds_read_b64_tr_b16 v[214:215], v72 offset:22464
    ds_read_b64_tr_b16 v[232:233], v72 offset:192
    ds_read_b64_tr_b16 v[234:235], v72 offset:1504
    ds_read_b64_tr_b16 v[236:237], v72 offset:21184
    ds_read_b64_tr_b16 v[238:239], v72 offset:22496
    ds_read_b64_tr_b16 v[64:65], v72 offset:224
    ds_read_b64_tr_b16 v[66:67], v72 offset:1536
    ds_read_b64_tr_b16 v[68:69], v72 offset:21216
    ds_read_b64_tr_b16 v[70:71], v72 offset:22528
    s_waitcnt lgkmcnt(0)
    ds_write_b128 v73, v[64:67] offset:0
    ds_write_b128 v73, v[68:71] offset:1024
    s_waitcnt lgkmcnt(0)
    ds_read_b64_tr_b16 v[64:65], v72 offset:256
    ds_read_b64_tr_b16 v[66:67], v72 offset:1568
    ds_read_b64_tr_b16 v[68:69], v72 offset:21248
    ds_read_b64_tr_b16 v[70:71], v72 offset:22560
    s_waitcnt lgkmcnt(0)
    ds_write_b128 v73, v[64:67] offset:6144
    ds_write_b128 v73, v[68:71] offset:7168
    s_waitcnt lgkmcnt(0)
    ds_read_b64_tr_b16 v[64:65], v72 offset:288
    ds_read_b64_tr_b16 v[66:67], v72 offset:1600
    ds_read_b64_tr_b16 v[68:69], v72 offset:21280
    ds_read_b64_tr_b16 v[70:71], v72 offset:22592
    s_waitcnt lgkmcnt(0)
    ds_write_b128 v73, v[64:67] offset:12288
    ds_write_b128 v73, v[68:71] offset:13312
    s_waitcnt lgkmcnt(0)
    s_waitcnt lgkmcnt(0)
interleave_layers__linear_attn_block__memory_aug_recurrent_mem_tr__prompt_kernel_wo16:
    s_barrier
    s_add_u32 s46, s45, 640
    buffer_load_dwordx4 v[24:27], v4, s[16:19], s46 offen
    buffer_load_dwordx4 v[28:31], v5, s[16:19], s46 offen
    buffer_load_dwordx4 v[32:35], v6, s[16:19], s46 offen
    buffer_load_dwordx4 v[36:39], v7, s[16:19], s46 offen
    buffer_load_dwordx4 v[40:43], v8, s[16:19], s46 offen
    buffer_load_dwordx4 v[44:47], v9, s[16:19], s46 offen
    buffer_load_dwordx4 v[48:51], v10, s[16:19], s46 offen
    buffer_load_dwordx4 v[52:55], v11, s[16:19], s46 offen
    buffer_load_dwordx4 v[56:59], v12, s[16:19], s46 offen
    buffer_load_dwordx4 v[60:63], v13, s[16:19], s46 offen
    s_waitcnt vmcnt(0)
    ds_write_b128 v14, v[24:27]
    ds_write_b128 v15, v[28:31]
    ds_write_b128 v16, v[32:35]
    ds_write_b128 v17, v[36:39]
    ds_write_b128 v18, v[40:43]
    ds_write_b128 v19, v[44:47]
    ds_write_b128 v20, v[48:51]
    ds_write_b128 v21, v[52:55]
    ds_write_b128 v22, v[56:59]
    ds_write_b128 v23, v[60:63]
    s_waitcnt lgkmcnt(0)
    s_barrier
    s_lshr_b32 s24, s3, 1
    s_cmp_eq_u32 s24, 1
    s_cbranch_scc0 interleave_layers__linear_attn_block__memory_aug_recurrent_mem_tr__prompt_kernel_wo17
    ds_read_b64_tr_b16 a[240:241], v72 offset:0
    ds_read_b64_tr_b16 a[242:243], v72 offset:1312
    ds_read_b64_tr_b16 a[244:245], v72 offset:20992
    ds_read_b64_tr_b16 a[246:247], v72 offset:22304
    ds_read_b64_tr_b16 v[112:113], v72 offset:32
    ds_read_b64_tr_b16 v[114:115], v72 offset:1344
    ds_read_b64_tr_b16 v[116:117], v72 offset:21024
    ds_read_b64_tr_b16 v[118:119], v72 offset:22336
    ds_read_b64_tr_b16 v[136:137], v72 offset:64
    ds_read_b64_tr_b16 v[138:139], v72 offset:1376
    ds_read_b64_tr_b16 v[140:141], v72 offset:21056
    ds_read_b64_tr_b16 v[142:143], v72 offset:22368
    ds_read_b64_tr_b16 v[160:161], v72 offset:96
    ds_read_b64_tr_b16 v[162:163], v72 offset:1408
    ds_read_b64_tr_b16 v[164:165], v72 offset:21088
    ds_read_b64_tr_b16 v[166:167], v72 offset:22400
    ds_read_b64_tr_b16 v[184:185], v72 offset:128
    ds_read_b64_tr_b16 v[186:187], v72 offset:1440
    ds_read_b64_tr_b16 v[188:189], v72 offset:21120
    ds_read_b64_tr_b16 v[190:191], v72 offset:22432
    ds_read_b64_tr_b16 v[208:209], v72 offset:160
    ds_read_b64_tr_b16 v[210:211], v72 offset:1472
    ds_read_b64_tr_b16 v[212:213], v72 offset:21152
    ds_read_b64_tr_b16 v[214:215], v72 offset:22464
    ds_read_b64_tr_b16 v[232:233], v72 offset:192
    ds_read_b64_tr_b16 v[234:235], v72 offset:1504
    ds_read_b64_tr_b16 v[236:237], v72 offset:21184
    ds_read_b64_tr_b16 v[238:239], v72 offset:22496
    ds_read_b64_tr_b16 v[64:65], v72 offset:224
    ds_read_b64_tr_b16 v[66:67], v72 offset:1536
    ds_read_b64_tr_b16 v[68:69], v72 offset:21216
    ds_read_b64_tr_b16 v[70:71], v72 offset:22528
    s_waitcnt lgkmcnt(0)
    ds_write_b128 v73, v[64:67] offset:0
    ds_write_b128 v73, v[68:71] offset:1024
    s_waitcnt lgkmcnt(0)
    ds_read_b64_tr_b16 v[64:65], v72 offset:256
    ds_read_b64_tr_b16 v[66:67], v72 offset:1568
    ds_read_b64_tr_b16 v[68:69], v72 offset:21248
    ds_read_b64_tr_b16 v[70:71], v72 offset:22560
    s_waitcnt lgkmcnt(0)
    ds_write_b128 v73, v[64:67] offset:6144
    ds_write_b128 v73, v[68:71] offset:7168
    s_waitcnt lgkmcnt(0)
    ds_read_b64_tr_b16 v[64:65], v72 offset:288
    ds_read_b64_tr_b16 v[66:67], v72 offset:1600
    ds_read_b64_tr_b16 v[68:69], v72 offset:21280
    ds_read_b64_tr_b16 v[70:71], v72 offset:22592
    s_waitcnt lgkmcnt(0)
    ds_write_b128 v73, v[64:67] offset:12288
    ds_write_b128 v73, v[68:71] offset:13312
    s_waitcnt lgkmcnt(0)
    s_waitcnt lgkmcnt(0)
interleave_layers__linear_attn_block__memory_aug_recurrent_mem_tr__prompt_kernel_wo17:
    s_barrier
    s_add_u32 s46, s45, 81920
    buffer_load_dwordx4 v[24:27], v4, s[16:19], s46 offen
    buffer_load_dwordx4 v[28:31], v5, s[16:19], s46 offen
    buffer_load_dwordx4 v[32:35], v6, s[16:19], s46 offen
    buffer_load_dwordx4 v[36:39], v7, s[16:19], s46 offen
    buffer_load_dwordx4 v[40:43], v8, s[16:19], s46 offen
    buffer_load_dwordx4 v[44:47], v9, s[16:19], s46 offen
    buffer_load_dwordx4 v[48:51], v10, s[16:19], s46 offen
    buffer_load_dwordx4 v[52:55], v11, s[16:19], s46 offen
    buffer_load_dwordx4 v[56:59], v12, s[16:19], s46 offen
    buffer_load_dwordx4 v[60:63], v13, s[16:19], s46 offen
    s_waitcnt vmcnt(0)
    ds_write_b128 v14, v[24:27]
    ds_write_b128 v15, v[28:31]
    ds_write_b128 v16, v[32:35]
    ds_write_b128 v17, v[36:39]
    ds_write_b128 v18, v[40:43]
    ds_write_b128 v19, v[44:47]
    ds_write_b128 v20, v[48:51]
    ds_write_b128 v21, v[52:55]
    ds_write_b128 v22, v[56:59]
    ds_write_b128 v23, v[60:63]
    s_waitcnt lgkmcnt(0)
    s_barrier
    s_lshr_b32 s24, s3, 1
    s_cmp_eq_u32 s24, 0
    s_cbranch_scc0 interleave_layers__linear_attn_block__memory_aug_recurrent_mem_tr__prompt_kernel_wo18
    ds_read_b64_tr_b16 a[248:249], v72 offset:0
    ds_read_b64_tr_b16 a[250:251], v72 offset:1312
    ds_read_b64_tr_b16 a[252:253], v72 offset:20992
    ds_read_b64_tr_b16 a[254:255], v72 offset:22304
    ds_read_b64_tr_b16 v[120:121], v72 offset:32
    ds_read_b64_tr_b16 v[122:123], v72 offset:1344
    ds_read_b64_tr_b16 v[124:125], v72 offset:21024
    ds_read_b64_tr_b16 v[126:127], v72 offset:22336
    ds_read_b64_tr_b16 v[144:145], v72 offset:64
    ds_read_b64_tr_b16 v[146:147], v72 offset:1376
    ds_read_b64_tr_b16 v[148:149], v72 offset:21056
    ds_read_b64_tr_b16 v[150:151], v72 offset:22368
    ds_read_b64_tr_b16 v[168:169], v72 offset:96
    ds_read_b64_tr_b16 v[170:171], v72 offset:1408
    ds_read_b64_tr_b16 v[172:173], v72 offset:21088
    ds_read_b64_tr_b16 v[174:175], v72 offset:22400
    ds_read_b64_tr_b16 v[192:193], v72 offset:128
    ds_read_b64_tr_b16 v[194:195], v72 offset:1440
    ds_read_b64_tr_b16 v[196:197], v72 offset:21120
    ds_read_b64_tr_b16 v[198:199], v72 offset:22432
    ds_read_b64_tr_b16 v[216:217], v72 offset:160
    ds_read_b64_tr_b16 v[218:219], v72 offset:1472
    ds_read_b64_tr_b16 v[220:221], v72 offset:21152
    ds_read_b64_tr_b16 v[222:223], v72 offset:22464
    ds_read_b64_tr_b16 v[240:241], v72 offset:192
    ds_read_b64_tr_b16 v[242:243], v72 offset:1504
    ds_read_b64_tr_b16 v[244:245], v72 offset:21184
    ds_read_b64_tr_b16 v[246:247], v72 offset:22496
    ds_read_b64_tr_b16 v[64:65], v72 offset:224
    ds_read_b64_tr_b16 v[66:67], v72 offset:1536
    ds_read_b64_tr_b16 v[68:69], v72 offset:21216
    ds_read_b64_tr_b16 v[70:71], v72 offset:22528
    s_waitcnt lgkmcnt(0)
    ds_write_b128 v73, v[64:67] offset:2048
    ds_write_b128 v73, v[68:71] offset:3072
    s_waitcnt lgkmcnt(0)
    ds_read_b64_tr_b16 v[64:65], v72 offset:256
    ds_read_b64_tr_b16 v[66:67], v72 offset:1568
    ds_read_b64_tr_b16 v[68:69], v72 offset:21248
    ds_read_b64_tr_b16 v[70:71], v72 offset:22560
    s_waitcnt lgkmcnt(0)
    ds_write_b128 v73, v[64:67] offset:8192
    ds_write_b128 v73, v[68:71] offset:9216
    s_waitcnt lgkmcnt(0)
    ds_read_b64_tr_b16 v[64:65], v72 offset:288
    ds_read_b64_tr_b16 v[66:67], v72 offset:1600
    ds_read_b64_tr_b16 v[68:69], v72 offset:21280
    ds_read_b64_tr_b16 v[70:71], v72 offset:22592
    s_waitcnt lgkmcnt(0)
    ds_write_b128 v73, v[64:67] offset:14336
    ds_write_b128 v73, v[68:71] offset:15360
    s_waitcnt lgkmcnt(0)
    s_waitcnt lgkmcnt(0)
interleave_layers__linear_attn_block__memory_aug_recurrent_mem_tr__prompt_kernel_wo18:
    s_barrier
    s_add_u32 s46, s45, 82560
    buffer_load_dwordx4 v[24:27], v4, s[16:19], s46 offen
    buffer_load_dwordx4 v[28:31], v5, s[16:19], s46 offen
    buffer_load_dwordx4 v[32:35], v6, s[16:19], s46 offen
    buffer_load_dwordx4 v[36:39], v7, s[16:19], s46 offen
    buffer_load_dwordx4 v[40:43], v8, s[16:19], s46 offen
    buffer_load_dwordx4 v[44:47], v9, s[16:19], s46 offen
    buffer_load_dwordx4 v[48:51], v10, s[16:19], s46 offen
    buffer_load_dwordx4 v[52:55], v11, s[16:19], s46 offen
    buffer_load_dwordx4 v[56:59], v12, s[16:19], s46 offen
    buffer_load_dwordx4 v[60:63], v13, s[16:19], s46 offen
    s_waitcnt vmcnt(0)
    ds_write_b128 v14, v[24:27]
    ds_write_b128 v15, v[28:31]
    ds_write_b128 v16, v[32:35]
    ds_write_b128 v17, v[36:39]
    ds_write_b128 v18, v[40:43]
    ds_write_b128 v19, v[44:47]
    ds_write_b128 v20, v[48:51]
    ds_write_b128 v21, v[52:55]
    ds_write_b128 v22, v[56:59]
    ds_write_b128 v23, v[60:63]
    s_waitcnt lgkmcnt(0)
    s_barrier
    s_lshr_b32 s24, s3, 1
    s_cmp_eq_u32 s24, 1
    s_cbranch_scc0 interleave_layers__linear_attn_block__memory_aug_recurrent_mem_tr__prompt_kernel_wo19
    ds_read_b64_tr_b16 a[248:249], v72 offset:0
    ds_read_b64_tr_b16 a[250:251], v72 offset:1312
    ds_read_b64_tr_b16 a[252:253], v72 offset:20992
    ds_read_b64_tr_b16 a[254:255], v72 offset:22304
    ds_read_b64_tr_b16 v[120:121], v72 offset:32
    ds_read_b64_tr_b16 v[122:123], v72 offset:1344
    ds_read_b64_tr_b16 v[124:125], v72 offset:21024
    ds_read_b64_tr_b16 v[126:127], v72 offset:22336
    ds_read_b64_tr_b16 v[144:145], v72 offset:64
    ds_read_b64_tr_b16 v[146:147], v72 offset:1376
    ds_read_b64_tr_b16 v[148:149], v72 offset:21056
    ds_read_b64_tr_b16 v[150:151], v72 offset:22368
    ds_read_b64_tr_b16 v[168:169], v72 offset:96
    ds_read_b64_tr_b16 v[170:171], v72 offset:1408
    ds_read_b64_tr_b16 v[172:173], v72 offset:21088
    ds_read_b64_tr_b16 v[174:175], v72 offset:22400
    ds_read_b64_tr_b16 v[192:193], v72 offset:128
    ds_read_b64_tr_b16 v[194:195], v72 offset:1440
    ds_read_b64_tr_b16 v[196:197], v72 offset:21120
    ds_read_b64_tr_b16 v[198:199], v72 offset:22432
    ds_read_b64_tr_b16 v[216:217], v72 offset:160
    ds_read_b64_tr_b16 v[218:219], v72 offset:1472
    ds_read_b64_tr_b16 v[220:221], v72 offset:21152
    ds_read_b64_tr_b16 v[222:223], v72 offset:22464
    ds_read_b64_tr_b16 v[240:241], v72 offset:192
    ds_read_b64_tr_b16 v[242:243], v72 offset:1504
    ds_read_b64_tr_b16 v[244:245], v72 offset:21184
    ds_read_b64_tr_b16 v[246:247], v72 offset:22496
    ds_read_b64_tr_b16 v[64:65], v72 offset:224
    ds_read_b64_tr_b16 v[66:67], v72 offset:1536
    ds_read_b64_tr_b16 v[68:69], v72 offset:21216
    ds_read_b64_tr_b16 v[70:71], v72 offset:22528
    s_waitcnt lgkmcnt(0)
    ds_write_b128 v73, v[64:67] offset:2048
    ds_write_b128 v73, v[68:71] offset:3072
    s_waitcnt lgkmcnt(0)
    ds_read_b64_tr_b16 v[64:65], v72 offset:256
    ds_read_b64_tr_b16 v[66:67], v72 offset:1568
    ds_read_b64_tr_b16 v[68:69], v72 offset:21248
    ds_read_b64_tr_b16 v[70:71], v72 offset:22560
    s_waitcnt lgkmcnt(0)
    ds_write_b128 v73, v[64:67] offset:8192
    ds_write_b128 v73, v[68:71] offset:9216
    s_waitcnt lgkmcnt(0)
    ds_read_b64_tr_b16 v[64:65], v72 offset:288
    ds_read_b64_tr_b16 v[66:67], v72 offset:1600
    ds_read_b64_tr_b16 v[68:69], v72 offset:21280
    ds_read_b64_tr_b16 v[70:71], v72 offset:22592
    s_waitcnt lgkmcnt(0)
    ds_write_b128 v73, v[64:67] offset:14336
    ds_write_b128 v73, v[68:71] offset:15360
    s_waitcnt lgkmcnt(0)
    s_waitcnt lgkmcnt(0)
interleave_layers__linear_attn_block__memory_aug_recurrent_mem_tr__prompt_kernel_wo19:
    s_barrier
    s_add_u32 s46, s45, 163840
    buffer_load_dwordx4 v[24:27], v4, s[16:19], s46 offen
    buffer_load_dwordx4 v[28:31], v5, s[16:19], s46 offen
    buffer_load_dwordx4 v[32:35], v6, s[16:19], s46 offen
    buffer_load_dwordx4 v[36:39], v7, s[16:19], s46 offen
    buffer_load_dwordx4 v[40:43], v8, s[16:19], s46 offen
    buffer_load_dwordx4 v[44:47], v9, s[16:19], s46 offen
    buffer_load_dwordx4 v[48:51], v10, s[16:19], s46 offen
    buffer_load_dwordx4 v[52:55], v11, s[16:19], s46 offen
    buffer_load_dwordx4 v[56:59], v12, s[16:19], s46 offen
    buffer_load_dwordx4 v[60:63], v13, s[16:19], s46 offen
    s_waitcnt vmcnt(0)
    ds_write_b128 v14, v[24:27]
    ds_write_b128 v15, v[28:31]
    ds_write_b128 v16, v[32:35]
    ds_write_b128 v17, v[36:39]
    ds_write_b128 v18, v[40:43]
    ds_write_b128 v19, v[44:47]
    ds_write_b128 v20, v[48:51]
    ds_write_b128 v21, v[52:55]
    ds_write_b128 v22, v[56:59]
    ds_write_b128 v23, v[60:63]
    s_waitcnt lgkmcnt(0)
    s_barrier
    s_lshr_b32 s24, s3, 1
    s_cmp_eq_u32 s24, 0
    s_cbranch_scc0 interleave_layers__linear_attn_block__memory_aug_recurrent_mem_tr__prompt_kernel_wo20
    ds_read_b64_tr_b16 v[104:105], v72 offset:0
    ds_read_b64_tr_b16 v[106:107], v72 offset:1312
    ds_read_b64_tr_b16 v[108:109], v72 offset:20992
    ds_read_b64_tr_b16 v[110:111], v72 offset:22304
    ds_read_b64_tr_b16 v[128:129], v72 offset:32
    ds_read_b64_tr_b16 v[130:131], v72 offset:1344
    ds_read_b64_tr_b16 v[132:133], v72 offset:21024
    ds_read_b64_tr_b16 v[134:135], v72 offset:22336
    ds_read_b64_tr_b16 v[152:153], v72 offset:64
    ds_read_b64_tr_b16 v[154:155], v72 offset:1376
    ds_read_b64_tr_b16 v[156:157], v72 offset:21056
    ds_read_b64_tr_b16 v[158:159], v72 offset:22368
    ds_read_b64_tr_b16 v[176:177], v72 offset:96
    ds_read_b64_tr_b16 v[178:179], v72 offset:1408
    ds_read_b64_tr_b16 v[180:181], v72 offset:21088
    ds_read_b64_tr_b16 v[182:183], v72 offset:22400
    ds_read_b64_tr_b16 v[200:201], v72 offset:128
    ds_read_b64_tr_b16 v[202:203], v72 offset:1440
    ds_read_b64_tr_b16 v[204:205], v72 offset:21120
    ds_read_b64_tr_b16 v[206:207], v72 offset:22432
    ds_read_b64_tr_b16 v[224:225], v72 offset:160
    ds_read_b64_tr_b16 v[226:227], v72 offset:1472
    ds_read_b64_tr_b16 v[228:229], v72 offset:21152
    ds_read_b64_tr_b16 v[230:231], v72 offset:22464
    ds_read_b64_tr_b16 v[248:249], v72 offset:192
    ds_read_b64_tr_b16 v[250:251], v72 offset:1504
    ds_read_b64_tr_b16 v[252:253], v72 offset:21184
    ds_read_b64_tr_b16 v[254:255], v72 offset:22496
    ds_read_b64_tr_b16 v[64:65], v72 offset:224
    ds_read_b64_tr_b16 v[66:67], v72 offset:1536
    ds_read_b64_tr_b16 v[68:69], v72 offset:21216
    ds_read_b64_tr_b16 v[70:71], v72 offset:22528
    s_waitcnt lgkmcnt(0)
    ds_write_b128 v73, v[64:67] offset:4096
    ds_write_b128 v73, v[68:71] offset:5120
    s_waitcnt lgkmcnt(0)
    ds_read_b64_tr_b16 v[64:65], v72 offset:256
    ds_read_b64_tr_b16 v[66:67], v72 offset:1568
    ds_read_b64_tr_b16 v[68:69], v72 offset:21248
    ds_read_b64_tr_b16 v[70:71], v72 offset:22560
    s_waitcnt lgkmcnt(0)
    ds_write_b128 v73, v[64:67] offset:10240
    ds_write_b128 v73, v[68:71] offset:11264
    s_waitcnt lgkmcnt(0)
    ds_read_b64_tr_b16 v[64:65], v72 offset:288
    ds_read_b64_tr_b16 v[66:67], v72 offset:1600
    ds_read_b64_tr_b16 v[68:69], v72 offset:21280
    ds_read_b64_tr_b16 v[70:71], v72 offset:22592
    s_waitcnt lgkmcnt(0)
    ds_write_b128 v73, v[64:67] offset:16384
    ds_write_b128 v73, v[68:71] offset:17408
    s_waitcnt lgkmcnt(0)
    s_waitcnt lgkmcnt(0)
interleave_layers__linear_attn_block__memory_aug_recurrent_mem_tr__prompt_kernel_wo20:
    s_barrier
    s_add_u32 s46, s45, 164480
    buffer_load_dwordx4 v[24:27], v4, s[16:19], s46 offen
    buffer_load_dwordx4 v[28:31], v5, s[16:19], s46 offen
    buffer_load_dwordx4 v[32:35], v6, s[16:19], s46 offen
    buffer_load_dwordx4 v[36:39], v7, s[16:19], s46 offen
    buffer_load_dwordx4 v[40:43], v8, s[16:19], s46 offen
    buffer_load_dwordx4 v[44:47], v9, s[16:19], s46 offen
    buffer_load_dwordx4 v[48:51], v10, s[16:19], s46 offen
    buffer_load_dwordx4 v[52:55], v11, s[16:19], s46 offen
    buffer_load_dwordx4 v[56:59], v12, s[16:19], s46 offen
    buffer_load_dwordx4 v[60:63], v13, s[16:19], s46 offen
    s_waitcnt vmcnt(0)
    ds_write_b128 v14, v[24:27]
    ds_write_b128 v15, v[28:31]
    ds_write_b128 v16, v[32:35]
    ds_write_b128 v17, v[36:39]
    ds_write_b128 v18, v[40:43]
    ds_write_b128 v19, v[44:47]
    ds_write_b128 v20, v[48:51]
    ds_write_b128 v21, v[52:55]
    ds_write_b128 v22, v[56:59]
    ds_write_b128 v23, v[60:63]
    s_waitcnt lgkmcnt(0)
    s_barrier
    s_lshr_b32 s24, s3, 1
    s_cmp_eq_u32 s24, 1
    s_cbranch_scc0 interleave_layers__linear_attn_block__memory_aug_recurrent_mem_tr__prompt_kernel_wo21
    ds_read_b64_tr_b16 v[104:105], v72 offset:0
    ds_read_b64_tr_b16 v[106:107], v72 offset:1312
    ds_read_b64_tr_b16 v[108:109], v72 offset:20992
    ds_read_b64_tr_b16 v[110:111], v72 offset:22304
    ds_read_b64_tr_b16 v[128:129], v72 offset:32
    ds_read_b64_tr_b16 v[130:131], v72 offset:1344
    ds_read_b64_tr_b16 v[132:133], v72 offset:21024
    ds_read_b64_tr_b16 v[134:135], v72 offset:22336
    ds_read_b64_tr_b16 v[152:153], v72 offset:64
    ds_read_b64_tr_b16 v[154:155], v72 offset:1376
    ds_read_b64_tr_b16 v[156:157], v72 offset:21056
    ds_read_b64_tr_b16 v[158:159], v72 offset:22368
    ds_read_b64_tr_b16 v[176:177], v72 offset:96
    ds_read_b64_tr_b16 v[178:179], v72 offset:1408
    ds_read_b64_tr_b16 v[180:181], v72 offset:21088
    ds_read_b64_tr_b16 v[182:183], v72 offset:22400
    ds_read_b64_tr_b16 v[200:201], v72 offset:128
    ds_read_b64_tr_b16 v[202:203], v72 offset:1440
    ds_read_b64_tr_b16 v[204:205], v72 offset:21120
    ds_read_b64_tr_b16 v[206:207], v72 offset:22432
    ds_read_b64_tr_b16 v[224:225], v72 offset:160
    ds_read_b64_tr_b16 v[226:227], v72 offset:1472
    ds_read_b64_tr_b16 v[228:229], v72 offset:21152
    ds_read_b64_tr_b16 v[230:231], v72 offset:22464
    ds_read_b64_tr_b16 v[248:249], v72 offset:192
    ds_read_b64_tr_b16 v[250:251], v72 offset:1504
    ds_read_b64_tr_b16 v[252:253], v72 offset:21184
    ds_read_b64_tr_b16 v[254:255], v72 offset:22496
    ds_read_b64_tr_b16 v[64:65], v72 offset:224
    ds_read_b64_tr_b16 v[66:67], v72 offset:1536
    ds_read_b64_tr_b16 v[68:69], v72 offset:21216
    ds_read_b64_tr_b16 v[70:71], v72 offset:22528
    s_waitcnt lgkmcnt(0)
    ds_write_b128 v73, v[64:67] offset:4096
    ds_write_b128 v73, v[68:71] offset:5120
    s_waitcnt lgkmcnt(0)
    ds_read_b64_tr_b16 v[64:65], v72 offset:256
    ds_read_b64_tr_b16 v[66:67], v72 offset:1568
    ds_read_b64_tr_b16 v[68:69], v72 offset:21248
    ds_read_b64_tr_b16 v[70:71], v72 offset:22560
    s_waitcnt lgkmcnt(0)
    ds_write_b128 v73, v[64:67] offset:10240
    ds_write_b128 v73, v[68:71] offset:11264
    s_waitcnt lgkmcnt(0)
    ds_read_b64_tr_b16 v[64:65], v72 offset:288
    ds_read_b64_tr_b16 v[66:67], v72 offset:1600
    ds_read_b64_tr_b16 v[68:69], v72 offset:21280
    ds_read_b64_tr_b16 v[70:71], v72 offset:22592
    s_waitcnt lgkmcnt(0)
    ds_write_b128 v73, v[64:67] offset:16384
    ds_write_b128 v73, v[68:71] offset:17408
    s_waitcnt lgkmcnt(0)
    s_waitcnt lgkmcnt(0)
interleave_layers__linear_attn_block__memory_aug_recurrent_mem_tr__prompt_kernel_wo21:
    s_barrier
    v_mov_b32 v6, v73
    v_mov_b32 v4, 0x4444
    v_mov_b32 v5, 0xeeee
    v_cmp_gt_u32 vcc, 8, v2
    s_nop 1
    v_cndmask_b32 v4, v5, v4, vcc
    v_lshlrev_b32 v5, 4, v1
    s_lshl_b32 s24, s3, 10
    v_add_u32 v7, s24, v5
    s_lshl_b32 s24, s3, 9
    s_add_u32 s24, s24, 8192
    v_lshlrev_b32 v8, 3, v1
    v_add_u32 v8, s24, v8
    v_and_b32 v64, 7, v2
    v_lshlrev_b32 v9, 5, v64
    v_lshrrev_b32 v64, 3, v2
    v_lshl_add_u32 v9, v64, 4, v9
    v_and_b32 v64, 1, v3
    v_lshl_add_u32 v9, v64, 3, v9
    s_mul_i32 s24, s3, 768
    s_add_u32 s24, s24, 10240
    v_add_u32 v9, s24, v9
    v_lshrrev_b32 v65, 1, v3
    v_lshl_add_u32 v10, v65, 8, v9
    v_lshrrev_b32 v64, 2, v2
    v_lshlrev_b32 v11, 5, v64
    v_and_b32 v64, 3, v2
    v_lshl_add_u32 v11, v64, 3, v11
    v_lshl_add_u32 v11, v3, 8, v11
    v_add_u32 v11, 10240, v11
    s_mul_i32 s24, s3, 10
    s_lshl_b32 s24, s24, 13
    s_lshl_b32 s25, s44, 8
    s_add_u32 s24, s24, s25
    v_lshlrev_b32 v14, 13, v3
    v_lshl_add_u32 v14, v2, 4, v14
    v_add_u32 v14, s24, v14
    v_lshrrev_b32 v64, 1, v3
    v_lshlrev_b32 v15, 13, v64
    v_lshl_add_u32 v15, v2, 4, v15
    v_add_u32 v15, s24, v15
    v_add_u32 v15, 65536, v15
    v_and_b32 v64, 1, v3
    v_cmp_eq_u32 vcc, 0, v64
    v_mov_b32 v64, 2146435072
    s_nop 0
    v_cndmask_b32 v15, v64, v15, vcc
    s_and_b32 s24, s2, 15
    s_mul_i32 s25, s3, 16
    s_add_u32 s24, s24, s25
    s_lshl_b32 s24, s24, 7
    v_mov_b32 v12, s24
    v_mov_b32 v0, 1
interleave_layers__linear_attn_block__memory_aug_recurrent_mem_tr__prompt_kernel_v_layer:
    s_mul_i32 s93, s92, 29360128
    s_add_u32 s93, s93, 117440512
    s_mul_i32 s94, s92, 16384
    s_add_u32 s94, s94, 23068672
    s_lshl_b32 s24, s3, 6
    s_add_u32 s24, s24, 0
    v_add_u32 v64, s24, v1
    v_and_b32 v65, 7, v64
    v_mul_u32_u24 v65, 1280, v65
    v_lshrrev_b32 v66, 3, v64
    v_lshl_add_u32 v65, v66, 4, v65
    v_cmp_gt_u32 vcc, 640, v64
    v_mov_b32 v67, 2146435072
    s_nop 0
    v_cndmask_b32 v65, v67, v65, vcc
    buffer_load_dwordx4 v[68:71], v65, s[20:23], 0 offen
    v_lshlrev_b32 v64, 4, v64
    s_waitcnt vmcnt(0)
    s_and_saveexec_b64 s[30:31], vcc
    ds_write_b128 v64, v[68:71]
    s_mov_b64 exec, s[30:31]
    s_lshl_b32 s24, s3, 6
    s_add_u32 s24, s24, 256
    v_add_u32 v64, s24, v1
    v_and_b32 v65, 7, v64
    v_mul_u32_u24 v65, 1280, v65
    v_lshrrev_b32 v66, 3, v64
    v_lshl_add_u32 v65, v66, 4, v65
    v_cmp_gt_u32 vcc, 640, v64
    v_mov_b32 v67, 2146435072
    s_nop 0
    v_cndmask_b32 v65, v67, v65, vcc
    buffer_load_dwordx4 v[68:71], v65, s[20:23], 0 offen
    v_lshlrev_b32 v64, 4, v64
    s_waitcnt vmcnt(0)
    s_and_saveexec_b64 s[30:31], vcc
    ds_write_b128 v64, v[68:71]
    s_mov_b64 exec, s[30:31]
    s_lshl_b32 s24, s3, 6
    s_add_u32 s24, s24, 512
    v_add_u32 v64, s24, v1
    v_and_b32 v65, 7, v64
    v_mul_u32_u24 v65, 1280, v65
    v_lshrrev_b32 v66, 3, v64
    v_lshl_add_u32 v65, v66, 4, v65
    v_cmp_gt_u32 vcc, 640, v64
    v_mov_b32 v67, 2146435072
    s_nop 0
    v_cndmask_b32 v65, v67, v65, vcc
    buffer_load_dwordx4 v[68:71], v65, s[20:23], 0 offen
    v_lshlrev_b32 v64, 4, v64
    s_waitcnt vmcnt(0)
    s_and_saveexec_b64 s[30:31], vcc
    ds_write_b128 v64, v[68:71]
    s_mov_b64 exec, s[30:31]
    s_mov_b32 s40, 0
    s_add_u32 s43, s93, 0
    s_add_u32 s47, s93, -28672
    s_add_u32 s45, s93, -18432
    s_lshl_b32 s95, s92, 6
    s_add_u32 s95, s95, s40
    s_add_u32 s95, s95, 1
    s_cmp_ge_i32 s59, s95
    s_cbranch_scc1 interleave_layers__linear_attn_block__memory_aug_recurrent_mem_tr__prompt_kernel_v_ec0_ok
    s_and_b32 s24, s2, 7
    s_lshl_b32 s24, s24, 7
    s_add_u32 s24, s24, 23109632
    v_and_b32 v65, 3, v1
    v_lshl_add_u32 v65, v65, 2, s24
    s_mov_b32 s61, 0
interleave_layers__linear_attn_block__memory_aug_recurrent_mem_tr__prompt_kernel_v_ec0:
    buffer_load_dword v64, v65, s[8:11], 0 offen sc1
    s_waitcnt vmcnt(0)
    v_readlane_b32 s59, v64, 0
    v_readlane_b32 s24, v64, 1
    s_min_i32 s59, s59, s24
    v_readlane_b32 s24, v64, 2
    s_min_i32 s59, s59, s24
    s_cmp_ge_i32 s59, s95
    s_cbranch_scc1 interleave_layers__linear_attn_block__memory_aug_recurrent_mem_tr__prompt_kernel_v_ec0_ok
    s_add_u32 s61, s61, 1
    s_cmp_ge_u32 s61, s60
    s_cbranch_scc1 interleave_layers__linear_attn_block__memory_aug_recurrent_mem_tr__prompt_kernel_v_ec0_to
    s_sleep 2
    s_branch interleave_layers__linear_attn_block__memory_aug_recurrent_mem_tr__prompt_kernel_v_ec0
interleave_layers__linear_attn_block__memory_aug_recurrent_mem_tr__prompt_kernel_v_ec0_to:
    s_mov_b32 s60, 1
interleave_layers__linear_attn_block__memory_aug_recurrent_mem_tr__prompt_kernel_v_ec0_ok:
    v_mov_b32 v16, 0
    v_mov_b32 v17, 0
    v_mov_b32 v18, 0
    v_mov_b32 v19, 0
    v_mov_b32 v20, 0
    v_mov_b32 v21, 0
    v_mov_b32 v22, 0
    v_mov_b32 v23, 0
    v_mov_b32 v24, 0
    v_mov_b32 v25, 0
    v_mov_b32 v26, 0
    v_mov_b32 v27, 0
    v_mov_b32 v28, 0
    v_mov_b32 v29, 0
    v_mov_b32 v30, 0
    v_mov_b32 v31, 0
    v_mov_b32 v32, 0
    v_mov_b32 v33, 0
    v_mov_b32 v34, 0
    v_mov_b32 v35, 0
    v_mov_b32 v36, 0
    v_mov_b32 v37, 0
    v_mov_b32 v38, 0
    v_mov_b32 v39, 0
    v_mov_b32 v40, 0
    v_mov_b32 v41, 0
    v_mov_b32 v42, 0
    v_mov_b32 v43, 0
    v_mov_b32 v44, 0
    v_mov_b32 v45, 0
    v_mov_b32 v46, 0
    v_mov_b32 v47, 0
    v_mov_b32 v48, 0
    v_mov_b32 v49, 0
    v_mov_b32 v50, 0
    v_mov_b32 v51, 0
    v_mov_b32 v52, 0
    v_mov_b32 v53, 0
    v_mov_b32 v54, 0
    v_mov_b32 v55, 0
    v_mov_b32 v56, 0
    v_mov_b32 v57, 0
    v_mov_b32 v58, 0
    v_mov_b32 v59, 0
    v_mov_b32 v60, 0
    v_mov_b32 v61, 0
    v_mov_b32 v62, 0
    v_mov_b32 v63, 0
    v_mov_b32 v64, 0
    v_mov_b32 v65, 0
    v_mov_b32 v66, 0
    v_mov_b32 v67, 0
    s_waitcnt lgkmcnt(0)
    s_barrier
    ds_read_b128 v[68:71], v7
    ds_read_b128 v[72:75], v7 offset:4096
    s_waitcnt lgkmcnt(0)
    s_cmp_eq_u32 s3, 0
    s_cbranch_scc1 interleave_layers__linear_attn_block__memory_aug_recurrent_mem_tr__prompt_kernel_v_gow0
    s_cmp_eq_u32 s3, 1
    s_cbranch_scc1 interleave_layers__linear_attn_block__memory_aug_recurrent_mem_tr__prompt_kernel_v_gow1
    s_cmp_eq_u32 s3, 2
    s_cbranch_scc1 interleave_layers__linear_attn_block__memory_aug_recurrent_mem_tr__prompt_kernel_v_gow2
    s_branch interleave_layers__linear_attn_block__memory_aug_recurrent_mem_tr__prompt_kernel_v_gow3
interleave_layers__linear_attn_block__memory_aug_recurrent_mem_tr__prompt_kernel_v_stepw0:
    v_mov_b32 v16, 0
    v_mov_b32 v17, 0
    v_mov_b32 v18, 0
    v_mov_b32 v19, 0
    v_mov_b32 v20, 0
    v_mov_b32 v21, 0
    v_mov_b32 v22, 0
    v_mov_b32 v23, 0
    v_mov_b32 v24, 0
    v_mov_b32 v25, 0
    v_mov_b32 v26, 0
    v_mov_b32 v27, 0
    v_mov_b32 v28, 0
    v_mov_b32 v29, 0
    v_mov_b32 v30, 0
    v_mov_b32 v31, 0
    v_mov_b32 v32, 0
    v_mov_b32 v33, 0
    v_mov_b32 v34, 0
    v_mov_b32 v35, 0
    v_mov_b32 v36, 0
    v_mov_b32 v37, 0
    v_mov_b32 v38, 0
    v_mov_b32 v39, 0
    v_mov_b32 v40, 0
    v_mov_b32 v41, 0
    v_mov_b32 v42, 0
    v_mov_b32 v43, 0
    v_mov_b32 v44, 0
    v_mov_b32 v45, 0
    v_mov_b32 v46, 0
    v_mov_b32 v47, 0
    v_mov_b32 v48, 0
    v_mov_b32 v49, 0
    v_mov_b32 v50, 0
    v_mov_b32 v51, 0
    v_mov_b32 v52, 0
    v_mov_b32 v53, 0
    v_mov_b32 v54, 0
    v_mov_b32 v55, 0
    v_mov_b32 v56, 0
    v_mov_b32 v57, 0
    v_mov_b32 v58, 0
    v_mov_b32 v59, 0
    v_mov_b32 v60, 0
    v_mov_b32 v61, 0
    v_mov_b32 v62, 0
    v_mov_b32 v63, 0
    v_mov_b32 v64, 0
    v_mov_b32 v65, 0
    v_mov_b32 v66, 0
    v_mov_b32 v67, 0
    s_add_u32 s48, s47, 4096
    s_lshl_b32 s95, s92, 6
    s_add_u32 s95, s95, s40
    s_add_u32 s95, s95, 1
    s_cmp_ge_i32 s59, s95
    s_cbranch_scc1 interleave_layers__linear_attn_block__memory_aug_recurrent_mem_tr__prompt_kernel_v_ecw0_ok
    s_and_b32 s24, s2, 7
    s_lshl_b32 s24, s24, 7
    s_add_u32 s24, s24, 23109632
    v_and_b32 v79, 3, v1
    v_lshl_add_u32 v79, v79, 2, s24
    s_mov_b32 s61, 0
interleave_layers__linear_attn_block__memory_aug_recurrent_mem_tr__prompt_kernel_v_ecw0:
    buffer_load_dword v78, v79, s[8:11], 0 offen sc1
    s_waitcnt vmcnt(0)
    v_readlane_b32 s59, v78, 0
    v_readlane_b32 s24, v78, 1
    s_min_i32 s59, s59, s24
    v_readlane_b32 s24, v78, 2
    s_min_i32 s59, s59, s24
    s_cmp_ge_i32 s59, s95
    s_cbranch_scc1 interleave_layers__linear_attn_block__memory_aug_recurrent_mem_tr__prompt_kernel_v_ecw0_ok
    s_add_u32 s61, s61, 1
    s_cmp_ge_u32 s61, s60
    s_cbranch_scc1 interleave_layers__linear_attn_block__memory_aug_recurrent_mem_tr__prompt_kernel_v_ecw0_to
    s_sleep 2
    s_branch interleave_layers__linear_attn_block__memory_aug_recurrent_mem_tr__prompt_kernel_v_ecw0
interleave_layers__linear_attn_block__memory_aug_recurrent_mem_tr__prompt_kernel_v_ecw0_to:
    s_mov_b32 s60, 1
interleave_layers__linear_attn_block__memory_aug_recurrent_mem_tr__prompt_kernel_v_ecw0_ok:
    s_sleep 20
    s_mov_b64 exec, 1
    s_mov_b32 s61, 0
    v_mov_b32 v81, 0
    buffer_atomic_add v81, v12, s[8:11], s45 offen sc0
    s_sleep 3
    v_mov_b32 v82, 0
    buffer_atomic_add v82, v12, s[8:11], s45 offen sc0
    s_sleep 3
    v_mov_b32 v83, 0
    buffer_atomic_add v83, v12, s[8:11], s45 offen sc0
    s_sleep 3
interleave_layers__linear_attn_block__memory_aug_recurrent_mem_tr__prompt_kernel_v_prw0:
    v_mov_b32 v80, 0
    buffer_atomic_add v80, v12, s[8:11], s45 offen sc0
    s_waitcnt vmcnt(3)
    v_cmp_le_i32 vcc, 8, v81
    s_add_u32 s61, s61, 1
    s_cbranch_vccnz interleave_layers__linear_attn_block__memory_aug_recurrent_mem_tr__prompt_kernel_v_prw0_out
    s_sleep 3
    v_mov_b32 v81, 0
    buffer_atomic_add v81, v12, s[8:11], s45 offen sc0
    s_waitcnt vmcnt(3)
    v_cmp_le_i32 vcc, 8, v82
    s_add_u32 s61, s61, 1
    s_cbranch_vccnz interleave_layers__linear_attn_block__memory_aug_recurrent_mem_tr__prompt_kernel_v_prw0_out
    s_sleep 3
    v_mov_b32 v82, 0
    buffer_atomic_add v82, v12, s[8:11], s45 offen sc0
    s_waitcnt vmcnt(3)
    v_cmp_le_i32 vcc, 8, v83
    s_add_u32 s61, s61, 1
    s_cbranch_vccnz interleave_layers__linear_attn_block__memory_aug_recurrent_mem_tr__prompt_kernel_v_prw0_out
    s_sleep 3
    v_mov_b32 v83, 0
    buffer_atomic_add v83, v12, s[8:11], s45 offen sc0
    s_waitcnt vmcnt(3)
    v_cmp_le_i32 vcc, 8, v80
    s_add_u32 s61, s61, 1
    s_cbranch_vccnz interleave_layers__linear_attn_block__memory_aug_recurrent_mem_tr__prompt_kernel_v_prw0_out
    s_sleep 3
    s_cmp_ge_u32 s61, s60
    s_cbranch_scc0 interleave_layers__linear_attn_block__memory_aug_recurrent_mem_tr__prompt_kernel_v_prw0
    s_mov_b32 s60, 1
interleave_layers__linear_attn_block__memory_aug_recurrent_mem_tr__prompt_kernel_v_prw0_out:
    s_mov_b64 exec, -1
    buffer_load_dwordx4 v[68:71], v7, s[8:11], s47 offen sc1
    buffer_load_dwordx4 v[72:75], v7, s[8:11], s48 offen sc1
    buffer_load_dwordx2 v[76:77], v8, s[8:11], s47 offen sc1
    s_waitcnt vmcnt(0)
    v_max3_u32 v103, v68, v69, v70
    v_max3_u32 v103, v103, v71, v72
    v_max3_u32 v103, v103, v73, v74
    v_max3_u32 v103, v103, v75, v76
    v_max_u32 v103, v103, v77
    v_cmp_eq_u32 vcc, -1, v103
    s_cbranch_vccz interleave_layers__linear_attn_block__memory_aug_recurrent_mem_tr__prompt_kernel_v_pmw0_out
    s_mov_b32 s61, 0
interleave_layers__linear_attn_block__memory_aug_recurrent_mem_tr__prompt_kernel_v_pmw0:
    buffer_load_dwordx4 v[68:71], v7, s[8:11], s47 offen sc1
    buffer_load_dwordx4 v[72:75], v7, s[8:11], s48 offen sc1
    buffer_load_dwordx2 v[76:77], v8, s[8:11], s47 offen sc1
    s_waitcnt vmcnt(0)
    v_max3_u32 v103, v68, v69, v70
    v_max3_u32 v103, v103, v71, v72
    v_max3_u32 v103, v103, v73, v74
    v_max3_u32 v103, v103, v75, v76
    v_max_u32 v103, v103, v77
    v_cmp_eq_u32 vcc, -1, v103
    s_add_u32 s61, s61, 1
    s_cbranch_vccz interleave_layers__linear_attn_block__memory_aug_recurrent_mem_tr__prompt_kernel_v_pmw0_out
    s_cmp_ge_u32 s61, s60
    s_cbranch_scc1 interleave_layers__linear_attn_block__memory_aug_recurrent_mem_tr__prompt_kernel_v_pmw0_to
    s_sleep 1
    s_branch interleave_layers__linear_attn_block__memory_aug_recurrent_mem_tr__prompt_kernel_v_pmw0
interleave_layers__linear_attn_block__memory_aug_recurrent_mem_tr__prompt_kernel_v_pmw0_to:
    s_mov_b32 s60, 1
interleave_layers__linear_attn_block__memory_aug_recurrent_mem_tr__prompt_kernel_v_pmw0_out:
    ds_write_b128 v7, v[68:71]
    ds_write_b128 v7, v[72:75] offset:4096
    ds_write_b64 v8, v[76:77]
interleave_layers__linear_attn_block__memory_aug_recurrent_mem_tr__prompt_kernel_v_gow0:
    v_smfmac_f32_16x16x64_bf16 v[56:59], v[68:71], a[0:7], v4
    v_smfmac_f32_16x16x64_bf16 v[60:63], v[68:71], a[80:87], v4
    v_smfmac_f32_16x16x64_bf16 v[64:67], v[68:71], a[160:167], v4
    s_waitcnt lgkmcnt(0)
    s_barrier
    ds_read_b128 v[80:83], v5 offset:1024
    ds_read_b128 v[84:87], v5 offset:2048
    ds_read_b128 v[88:91], v5 offset:3072
    ds_read_b128 v[92:95], v5 offset:5120
    ds_read_b128 v[96:99], v5 offset:6144
    ds_read_b128 v[100:103], v5 offset:7168
    ds_read_b128 v[76:79], v5 offset:8192
    ds_read_b128 v[68:71], v5 offset:9216
    v_smfmac_f32_16x16x64_bf16 v[64:67], v[72:75], a[192:199], v4
    v_smfmac_f32_16x16x64_bf16 v[56:59], v[72:75], a[32:39], v4
    v_smfmac_f32_16x16x64_bf16 v[60:63], v[72:75], a[112:119], v4
    s_waitcnt lgkmcnt(7)
    v_smfmac_f32_16x16x64_bf16 v[64:67], v[80:83], a[168:175], v4
    s_waitcnt lgkmcnt(6)
    v_smfmac_f32_16x16x64_bf16 v[64:67], v[84:87], a[176:183], v4
    s_waitcnt lgkmcnt(5)
    v_smfmac_f32_16x16x64_bf16 v[64:67], v[88:91], a[184:191], v4
    s_waitcnt lgkmcnt(4)
    v_smfmac_f32_16x16x64_bf16 v[64:67], v[92:95], a[200:207], v4
    s_waitcnt lgkmcnt(3)
    v_smfmac_f32_16x16x64_bf16 v[64:67], v[96:99], a[208:215], v4
    s_waitcnt lgkmcnt(2)
    v_smfmac_f32_16x16x64_bf16 v[64:67], v[100:103], a[216:223], v4
    s_waitcnt lgkmcnt(1)
    v_smfmac_f32_16x16x64_bf16 v[64:67], v[76:79], a[224:231], v4
    s_waitcnt lgkmcnt(0)
    v_smfmac_f32_16x16x64_bf16 v[64:67], v[68:71], a[232:239], v4
    v_smfmac_f32_16x16x64_bf16 v[56:59], v[80:83], a[8:15], v4
    v_smfmac_f32_16x16x64_bf16 v[60:63], v[80:83], a[88:95], v4
    v_smfmac_f32_16x16x64_bf16 v[56:59], v[84:87], a[16:23], v4
    s_nop 4
    v_mov_b32 v72, v64
    v_smfmac_f32_16x16x64_bf16 v[60:63], v[84:87], a[96:103], v4
    v_mov_b32 v73, v65
    v_mov_b32 v74, v66
    v_smfmac_f32_16x16x64_bf16 v[56:59], v[88:91], a[24:31], v4
    v_mov_b32 v75, v67
    v_smfmac_f32_16x16x64_bf16 v[60:63], v[88:91], a[104:111], v4
    v_permlane32_swap_b32 v64, v72
    v_permlane32_swap_b32 v65, v73
    v_smfmac_f32_16x16x64_bf16 v[56:59], v[92:95], a[40:47], v4
    v_permlane32_swap_b32 v66, v74
    v_permlane32_swap_b32 v67, v75
    v_smfmac_f32_16x16x64_bf16 v[60:63], v[92:95], a[120:127], v4
    v_add_f32 v64, v64, v72
    v_add_f32 v65, v65, v73
    v_smfmac_f32_16x16x64_bf16 v[56:59], v[96:99], a[48:55], v4
    v_add_f32 v66, v66, v74
    v_add_f32 v67, v67, v75
    v_smfmac_f32_16x16x64_bf16 v[60:63], v[96:99], a[128:135], v4
    v_cvt_pk_bf16_f32 v72, v64, v65
    v_cvt_pk_bf16_f32 v73, v66, v67
    v_smfmac_f32_16x16x64_bf16 v[56:59], v[100:103], a[56:63], v4
    ds_write_b64 v9, v[72:73] offset:512
    v_smfmac_f32_16x16x64_bf16 v[60:63], v[100:103], a[136:143], v4
    v_smfmac_f32_16x16x64_bf16 v[56:59], v[76:79], a[64:71], v4
    v_smfmac_f32_16x16x64_bf16 v[60:63], v[76:79], a[144:151], v4
    v_smfmac_f32_16x16x64_bf16 v[56:59], v[68:71], a[72:79], v4
    v_smfmac_f32_16x16x64_bf16 v[60:63], v[68:71], a[152:159], v4
    s_nop 7
    v_permlane32_swap_b32 v56, v60
    v_permlane32_swap_b32 v57, v61
    v_permlane32_swap_b32 v58, v62
    v_permlane32_swap_b32 v59, v63
    v_add_f32 v56, v56, v60
    v_add_f32 v57, v57, v61
    v_add_f32 v58, v58, v62
    v_add_f32 v59, v59, v63
    v_cvt_pk_bf16_f32 v68, v56, v57
    v_cvt_pk_bf16_f32 v69, v58, v59
    ds_write_b64 v10, v[68:69]
    s_waitcnt lgkmcnt(0)
    s_barrier
    ds_read_b64_tr_b16 v[68:69], v11 offset:0
    ds_read_b64_tr_b16 v[70:71], v11 offset:128
    ds_read_b64_tr_b16 v[72:73], v11 offset:1024
    ds_read_b64_tr_b16 v[74:75], v11 offset:1152
    ds_read_b64_tr_b16 v[76:77], v11 offset:2048
    ds_read_b64_tr_b16 v[78:79], v11 offset:2176
    ds_read_b128 v[80:83], v6 offset:0
    ds_read_b128 v[84:87], v6 offset:1024
    ds_read_b128 v[88:91], v6 offset:2048
    ds_read_b128 v[92:95], v6 offset:3072
    ds_read_b128 v[96:99], v6 offset:4096
    ds_read_b128 v[100:103], v6 offset:5120
    s_waitcnt lgkmcnt(10)
    v_smfmac_f32_16x16x64_bf16 v[16:19], v[68:71], a[240:247], v4
    v_smfmac_f32_16x16x64_bf16 v[20:23], v[68:71], v[112:119], v4
    v_smfmac_f32_16x16x64_bf16 v[24:27], v[68:71], v[136:143], v4
    v_smfmac_f32_16x16x64_bf16 v[28:31], v[68:71], v[160:167], v4
    s_waitcnt lgkmcnt(8)
    v_smfmac_f32_16x16x64_bf16 v[16:19], v[72:75], a[248:255], v4
    v_smfmac_f32_16x16x64_bf16 v[20:23], v[72:75], v[120:127], v4
    v_smfmac_f32_16x16x64_bf16 v[24:27], v[72:75], v[144:151], v4
    v_smfmac_f32_16x16x64_bf16 v[28:31], v[72:75], v[168:175], v4
    s_waitcnt lgkmcnt(6)
    v_smfmac_f32_16x16x64_bf16 v[16:19], v[76:79], v[104:111], v4
    v_smfmac_f32_16x16x64_bf16 v[20:23], v[76:79], v[128:135], v4
    v_smfmac_f32_16x16x64_bf16 v[24:27], v[76:79], v[152:159], v4
    v_smfmac_f32_16x16x64_bf16 v[28:31], v[76:79], v[176:183], v4
    v_smfmac_f32_16x16x64_bf16 v[32:35], v[68:71], v[184:191], v4
    v_smfmac_f32_16x16x64_bf16 v[36:39], v[68:71], v[208:215], v4
    s_nop 4
    v_permlane32_swap_b32 v16, v24
    v_permlane32_swap_b32 v17, v25
    v_smfmac_f32_16x16x64_bf16 v[40:43], v[68:71], v[232:239], v4
    v_permlane32_swap_b32 v18, v26
    v_permlane32_swap_b32 v19, v27
    s_waitcnt lgkmcnt(4)
    v_smfmac_f32_16x16x64_bf16 v[44:47], v[68:71], v[80:87], v4
    v_add_f32 v16, v16, v24
    v_add_f32 v17, v17, v25
    ds_read_b128 v[80:83], v6 offset:6144
    ds_read_b128 v[84:87], v6 offset:7168
    v_smfmac_f32_16x16x64_bf16 v[32:35], v[72:75], v[192:199], v4
    v_add_f32 v18, v18, v26
    v_add_f32 v19, v19, v27
    v_smfmac_f32_16x16x64_bf16 v[36:39], v[72:75], v[216:223], v4
    v_permlane32_swap_b32 v20, v28
    v_permlane32_swap_b32 v21, v29
    v_smfmac_f32_16x16x64_bf16 v[40:43], v[72:75], v[240:247], v4
    v_permlane32_swap_b32 v22, v30
    v_permlane32_swap_b32 v23, v31
    s_waitcnt lgkmcnt(4)
    v_smfmac_f32_16x16x64_bf16 v[44:47], v[72:75], v[88:95], v4
    v_add_f32 v20, v20, v28
    v_add_f32 v21, v21, v29
    ds_read_b128 v[88:91], v6 offset:8192
    ds_read_b128 v[92:95], v6 offset:9216
    v_smfmac_f32_16x16x64_bf16 v[32:35], v[76:79], v[200:207], v4
    v_add_f32 v22, v22, v30
    v_add_f32 v23, v23, v31
    v_smfmac_f32_16x16x64_bf16 v[36:39], v[76:79], v[224:231], v4
    v_cvt_pk_bf16_f32 v56, v16, v17
    v_cvt_pk_bf16_f32 v57, v18, v19
    v_smfmac_f32_16x16x64_bf16 v[40:43], v[76:79], v[248:255], v4
    v_cvt_pk_bf16_f32 v58, v20, v21
    v_cvt_pk_bf16_f32 v59, v22, v23
    s_waitcnt lgkmcnt(4)
    v_smfmac_f32_16x16x64_bf16 v[44:47], v[76:79], v[96:103], v4
    v_permlane16_swap_b32 v56, v58
    ds_read_b128 v[96:99], v6 offset:10240
    ds_read_b128 v[100:103], v6 offset:11264
    v_permlane16_swap_b32 v57, v59
    v_min_u32 v56, -2, v56
    v_min_u32 v57, -2, v57
    v_min_u32 v58, -2, v58
    v_min_u32 v59, -2, v59
    buffer_store_dwordx4 v[56:59], v14, s[8:11], s43 offen sc1
    s_add_u32 s49, s43, 32768
    s_waitcnt lgkmcnt(4)
    v_smfmac_f32_16x16x64_bf16 v[48:51], v[68:71], v[80:87], v4
    v_permlane32_swap_b32 v32, v40
    v_permlane32_swap_b32 v33, v41
    v_permlane32_swap_b32 v34, v42
    ds_read_b128 v[80:83], v6 offset:12288
    ds_read_b128 v[84:87], v6 offset:13312
    s_waitcnt lgkmcnt(4)
    v_smfmac_f32_16x16x64_bf16 v[48:51], v[72:75], v[88:95], v4
    v_permlane32_swap_b32 v35, v43
    v_add_f32 v32, v32, v40
    v_add_f32 v33, v33, v41
    v_add_f32 v34, v34, v42
    ds_read_b128 v[88:91], v6 offset:14336
    ds_read_b128 v[92:95], v6 offset:15360
    s_waitcnt lgkmcnt(4)
    v_smfmac_f32_16x16x64_bf16 v[48:51], v[76:79], v[96:103], v4
    v_add_f32 v35, v35, v43
    v_permlane32_swap_b32 v36, v44
    v_permlane32_swap_b32 v37, v45
    v_permlane32_swap_b32 v38, v46
    ds_read_b128 v[96:99], v6 offset:16384
    ds_read_b128 v[100:103], v6 offset:17408
    v_permlane32_swap_b32 v39, v47
    v_add_f32 v36, v36, v44
    v_add_f32 v37, v37, v45
    v_add_f32 v38, v38, v46
    s_waitcnt lgkmcnt(4)
    v_smfmac_f32_16x16x64_bf16 v[52:55], v[68:71], v[80:87], v4
    v_add_f32 v39, v39, v47
    v_cvt_pk_bf16_f32 v60, v32, v33
    v_cvt_pk_bf16_f32 v61, v34, v35
    s_waitcnt lgkmcnt(2)
    v_smfmac_f32_16x16x64_bf16 v[52:55], v[72:75], v[88:95], v4
    v_cvt_pk_bf16_f32 v62, v36, v37
    v_cvt_pk_bf16_f32 v63, v38, v39
    s_waitcnt lgkmcnt(0)
    v_smfmac_f32_16x16x64_bf16 v[52:55], v[76:79], v[96:103], v4
    v_permlane16_swap_b32 v60, v62
    v_permlane16_swap_b32 v61, v63
    v_min_u32 v60, -2, v60
    v_min_u32 v61, -2, v61
    v_min_u32 v62, -2, v62
    v_min_u32 v63, -2, v63
    buffer_store_dwordx4 v[60:63], v14, s[8:11], s49 offen sc1
    s_nop 0
    v_permlane32_swap_b32 v48, v52
    v_permlane32_swap_b32 v49, v53
    v_permlane32_swap_b32 v50, v54
    v_permlane32_swap_b32 v51, v55
    v_add_f32 v48, v48, v52
    v_add_f32 v49, v49, v53
    v_add_f32 v50, v50, v54
    v_add_f32 v51, v51, v55
    v_cvt_pk_bf16_f32 v64, v48, v49
    v_cvt_pk_bf16_f32 v65, v50, v51
    v_mov_b32 v66, v64
    v_mov_b32 v67, v65
    s_nop 0
    v_permlane16_swap_b32 v64, v66
    v_permlane16_swap_b32 v65, v67
    v_min_u32 v64, -2, v64
    v_min_u32 v65, -2, v65
    v_min_u32 v66, -2, v66
    v_min_u32 v67, -2, v67
    buffer_store_dwordx4 v[64:67], v15, s[8:11], s43 offen sc1
    s_add_u32 s40, s40, 1
    s_add_u32 s43, s43, 458752
    s_add_u32 s47, s47, 458752
    s_add_u32 s45, s45, 458752
    s_cmp_lt_u32 s40, 64
    s_cbranch_scc1 interleave_layers__linear_attn_block__memory_aug_recurrent_mem_tr__prompt_kernel_v_stepw0
    s_branch interleave_layers__linear_attn_block__memory_aug_recurrent_mem_tr__prompt_kernel_v_end
interleave_layers__linear_attn_block__memory_aug_recurrent_mem_tr__prompt_kernel_v_stepw1:
    v_mov_b32 v16, 0
    v_mov_b32 v17, 0
    v_mov_b32 v18, 0
    v_mov_b32 v19, 0
    v_mov_b32 v20, 0
    v_mov_b32 v21, 0
    v_mov_b32 v22, 0
    v_mov_b32 v23, 0
    v_mov_b32 v24, 0
    v_mov_b32 v25, 0
    v_mov_b32 v26, 0
    v_mov_b32 v27, 0
    v_mov_b32 v28, 0
    v_mov_b32 v29, 0
    v_mov_b32 v30, 0
    v_mov_b32 v31, 0
    v_mov_b32 v32, 0
    v_mov_b32 v33, 0
    v_mov_b32 v34, 0
    v_mov_b32 v35, 0
    v_mov_b32 v36, 0
    v_mov_b32 v37, 0
    v_mov_b32 v38, 0
    v_mov_b32 v39, 0
    v_mov_b32 v40, 0
    v_mov_b32 v41, 0
    v_mov_b32 v42, 0
    v_mov_b32 v43, 0
    v_mov_b32 v44, 0
    v_mov_b32 v45, 0
    v_mov_b32 v46, 0
    v_mov_b32 v47, 0
    v_mov_b32 v48, 0
    v_mov_b32 v49, 0
    v_mov_b32 v50, 0
    v_mov_b32 v51, 0
    v_mov_b32 v52, 0
    v_mov_b32 v53, 0
    v_mov_b32 v54, 0
    v_mov_b32 v55, 0
    v_mov_b32 v56, 0
    v_mov_b32 v57, 0
    v_mov_b32 v58, 0
    v_mov_b32 v59, 0
    v_mov_b32 v60, 0
    v_mov_b32 v61, 0
    v_mov_b32 v62, 0
    v_mov_b32 v63, 0
    v_mov_b32 v64, 0
    v_mov_b32 v65, 0
    v_mov_b32 v66, 0
    v_mov_b32 v67, 0
    s_add_u32 s48, s47, 4096
    s_lshl_b32 s95, s92, 6
    s_add_u32 s95, s95, s40
    s_add_u32 s95, s95, 1
    s_cmp_ge_i32 s59, s95
    s_cbranch_scc1 interleave_layers__linear_attn_block__memory_aug_recurrent_mem_tr__prompt_kernel_v_ecw1_ok
    s_and_b32 s24, s2, 7
    s_lshl_b32 s24, s24, 7
    s_add_u32 s24, s24, 23109632
    v_and_b32 v79, 3, v1
    v_lshl_add_u32 v79, v79, 2, s24
    s_mov_b32 s61, 0
interleave_layers__linear_attn_block__memory_aug_recurrent_mem_tr__prompt_kernel_v_ecw1:
    buffer_load_dword v78, v79, s[8:11], 0 offen sc1
    s_waitcnt vmcnt(0)
    v_readlane_b32 s59, v78, 0
    v_readlane_b32 s24, v78, 1
    s_min_i32 s59, s59, s24
    v_readlane_b32 s24, v78, 2
    s_min_i32 s59, s59, s24
    s_cmp_ge_i32 s59, s95
    s_cbranch_scc1 interleave_layers__linear_attn_block__memory_aug_recurrent_mem_tr__prompt_kernel_v_ecw1_ok
    s_add_u32 s61, s61, 1
    s_cmp_ge_u32 s61, s60
    s_cbranch_scc1 interleave_layers__linear_attn_block__memory_aug_recurrent_mem_tr__prompt_kernel_v_ecw1_to
    s_sleep 2
    s_branch interleave_layers__linear_attn_block__memory_aug_recurrent_mem_tr__prompt_kernel_v_ecw1
interleave_layers__linear_attn_block__memory_aug_recurrent_mem_tr__prompt_kernel_v_ecw1_to:
    s_mov_b32 s60, 1
interleave_layers__linear_attn_block__memory_aug_recurrent_mem_tr__prompt_kernel_v_ecw1_ok:
    s_sleep 20
    s_mov_b64 exec, 1
    s_mov_b32 s61, 0
    v_mov_b32 v81, 0
    buffer_atomic_add v81, v12, s[8:11], s45 offen sc0
    s_sleep 3
    v_mov_b32 v82, 0
    buffer_atomic_add v82, v12, s[8:11], s45 offen sc0
    s_sleep 3
    v_mov_b32 v83, 0
    buffer_atomic_add v83, v12, s[8:11], s45 offen sc0
    s_sleep 3
interleave_layers__linear_attn_block__memory_aug_recurrent_mem_tr__prompt_kernel_v_prw1:
    v_mov_b32 v80, 0
    buffer_atomic_add v80, v12, s[8:11], s45 offen sc0
    s_waitcnt vmcnt(3)
    v_cmp_le_i32 vcc, 8, v81
    s_add_u32 s61, s61, 1
    s_cbranch_vccnz interleave_layers__linear_attn_block__memory_aug_recurrent_mem_tr__prompt_kernel_v_prw1_out
    s_sleep 3
    v_mov_b32 v81, 0
    buffer_atomic_add v81, v12, s[8:11], s45 offen sc0
    s_waitcnt vmcnt(3)
    v_cmp_le_i32 vcc, 8, v82
    s_add_u32 s61, s61, 1
    s_cbranch_vccnz interleave_layers__linear_attn_block__memory_aug_recurrent_mem_tr__prompt_kernel_v_prw1_out
    s_sleep 3
    v_mov_b32 v82, 0
    buffer_atomic_add v82, v12, s[8:11], s45 offen sc0
    s_waitcnt vmcnt(3)
    v_cmp_le_i32 vcc, 8, v83
    s_add_u32 s61, s61, 1
    s_cbranch_vccnz interleave_layers__linear_attn_block__memory_aug_recurrent_mem_tr__prompt_kernel_v_prw1_out
    s_sleep 3
    v_mov_b32 v83, 0
    buffer_atomic_add v83, v12, s[8:11], s45 offen sc0
    s_waitcnt vmcnt(3)
    v_cmp_le_i32 vcc, 8, v80
    s_add_u32 s61, s61, 1
    s_cbranch_vccnz interleave_layers__linear_attn_block__memory_aug_recurrent_mem_tr__prompt_kernel_v_prw1_out
    s_sleep 3
    s_cmp_ge_u32 s61, s60
    s_cbranch_scc0 interleave_layers__linear_attn_block__memory_aug_recurrent_mem_tr__prompt_kernel_v_prw1
    s_mov_b32 s60, 1
interleave_layers__linear_attn_block__memory_aug_recurrent_mem_tr__prompt_kernel_v_prw1_out:
    s_mov_b64 exec, -1
    buffer_load_dwordx4 v[68:71], v7, s[8:11], s47 offen sc1
    buffer_load_dwordx4 v[72:75], v7, s[8:11], s48 offen sc1
    buffer_load_dwordx2 v[76:77], v8, s[8:11], s47 offen sc1
    s_waitcnt vmcnt(0)
    v_max3_u32 v103, v68, v69, v70
    v_max3_u32 v103, v103, v71, v72
    v_max3_u32 v103, v103, v73, v74
    v_max3_u32 v103, v103, v75, v76
    v_max_u32 v103, v103, v77
    v_cmp_eq_u32 vcc, -1, v103
    s_cbranch_vccz interleave_layers__linear_attn_block__memory_aug_recurrent_mem_tr__prompt_kernel_v_pmw1_out
    s_mov_b32 s61, 0
interleave_layers__linear_attn_block__memory_aug_recurrent_mem_tr__prompt_kernel_v_pmw1:
    buffer_load_dwordx4 v[68:71], v7, s[8:11], s47 offen sc1
    buffer_load_dwordx4 v[72:75], v7, s[8:11], s48 offen sc1
    buffer_load_dwordx2 v[76:77], v8, s[8:11], s47 offen sc1
    s_waitcnt vmcnt(0)
    v_max3_u32 v103, v68, v69, v70
    v_max3_u32 v103, v103, v71, v72
    v_max3_u32 v103, v103, v73, v74
    v_max3_u32 v103, v103, v75, v76
    v_max_u32 v103, v103, v77
    v_cmp_eq_u32 vcc, -1, v103
    s_add_u32 s61, s61, 1
    s_cbranch_vccz interleave_layers__linear_attn_block__memory_aug_recurrent_mem_tr__prompt_kernel_v_pmw1_out
    s_cmp_ge_u32 s61, s60
    s_cbranch_scc1 interleave_layers__linear_attn_block__memory_aug_recurrent_mem_tr__prompt_kernel_v_pmw1_to
    s_sleep 1
    s_branch interleave_layers__linear_attn_block__memory_aug_recurrent_mem_tr__prompt_kernel_v_pmw1
interleave_layers__linear_attn_block__memory_aug_recurrent_mem_tr__prompt_kernel_v_pmw1_to:
    s_mov_b32 s60, 1
interleave_layers__linear_attn_block__memory_aug_recurrent_mem_tr__prompt_kernel_v_pmw1_out:
    ds_write_b128 v7, v[68:71]
    ds_write_b128 v7, v[72:75] offset:4096
    ds_write_b64 v8, v[76:77]
interleave_layers__linear_attn_block__memory_aug_recurrent_mem_tr__prompt_kernel_v_gow1:
    v_smfmac_f32_16x16x64_bf16 v[56:59], v[68:71], a[8:15], v4
    v_smfmac_f32_16x16x64_bf16 v[60:63], v[68:71], a[88:95], v4
    v_smfmac_f32_16x16x64_bf16 v[64:67], v[68:71], a[168:175], v4
    s_waitcnt lgkmcnt(0)
    s_barrier
    ds_read_b128 v[80:83], v5 offset:0
    ds_read_b128 v[84:87], v5 offset:2048
    ds_read_b128 v[88:91], v5 offset:3072
    ds_read_b128 v[92:95], v5 offset:4096
    ds_read_b128 v[96:99], v5 offset:6144
    ds_read_b128 v[100:103], v5 offset:7168
    ds_read_b128 v[76:79], v5 offset:8192
    ds_read_b128 v[68:71], v5 offset:9216
    v_smfmac_f32_16x16x64_bf16 v[64:67], v[72:75], a[200:207], v4
    v_smfmac_f32_16x16x64_bf16 v[56:59], v[72:75], a[40:47], v4
    v_smfmac_f32_16x16x64_bf16 v[60:63], v[72:75], a[120:127], v4
    s_waitcnt lgkmcnt(7)
    v_smfmac_f32_16x16x64_bf16 v[64:67], v[80:83], a[160:167], v4
    s_waitcnt lgkmcnt(6)
    v_smfmac_f32_16x16x64_bf16 v[64:67], v[84:87], a[176:183], v4
    s_waitcnt lgkmcnt(5)
    v_smfmac_f32_16x16x64_bf16 v[64:67], v[88:91], a[184:191], v4
    s_waitcnt lgkmcnt(4)
    v_smfmac_f32_16x16x64_bf16 v[64:67], v[92:95], a[192:199], v4
    s_waitcnt lgkmcnt(3)
    v_smfmac_f32_16x16x64_bf16 v[64:67], v[96:99], a[208:215], v4
    s_waitcnt lgkmcnt(2)
    v_smfmac_f32_16x16x64_bf16 v[64:67], v[100:103], a[216:223], v4
    s_waitcnt lgkmcnt(1)
    v_smfmac_f32_16x16x64_bf16 v[64:67], v[76:79], a[224:231], v4
    s_waitcnt lgkmcnt(0)
    v_smfmac_f32_16x16x64_bf16 v[64:67], v[68:71], a[232:239], v4
    v_smfmac_f32_16x16x64_bf16 v[56:59], v[80:83], a[0:7], v4
    v_smfmac_f32_16x16x64_bf16 v[60:63], v[80:83], a[80:87], v4
    v_smfmac_f32_16x16x64_bf16 v[56:59], v[84:87], a[16:23], v4
    s_nop 4
    v_mov_b32 v72, v64
    v_smfmac_f32_16x16x64_bf16 v[60:63], v[84:87], a[96:103], v4
    v_mov_b32 v73, v65
    v_mov_b32 v74, v66
    v_smfmac_f32_16x16x64_bf16 v[56:59], v[88:91], a[24:31], v4
    v_mov_b32 v75, v67
    v_smfmac_f32_16x16x64_bf16 v[60:63], v[88:91], a[104:111], v4
    v_permlane32_swap_b32 v64, v72
    v_permlane32_swap_b32 v65, v73
    v_smfmac_f32_16x16x64_bf16 v[56:59], v[92:95], a[32:39], v4
    v_permlane32_swap_b32 v66, v74
    v_permlane32_swap_b32 v67, v75
    v_smfmac_f32_16x16x64_bf16 v[60:63], v[92:95], a[112:119], v4
    v_add_f32 v64, v64, v72
    v_add_f32 v65, v65, v73
    v_smfmac_f32_16x16x64_bf16 v[56:59], v[96:99], a[48:55], v4
    v_add_f32 v66, v66, v74
    v_add_f32 v67, v67, v75
    v_smfmac_f32_16x16x64_bf16 v[60:63], v[96:99], a[128:135], v4
    v_cvt_pk_bf16_f32 v72, v64, v65
    v_cvt_pk_bf16_f32 v73, v66, v67
    v_smfmac_f32_16x16x64_bf16 v[56:59], v[100:103], a[56:63], v4
    ds_write_b64 v9, v[72:73] offset:512
    v_smfmac_f32_16x16x64_bf16 v[60:63], v[100:103], a[136:143], v4
    v_smfmac_f32_16x16x64_bf16 v[56:59], v[76:79], a[64:71], v4
    v_smfmac_f32_16x16x64_bf16 v[60:63], v[76:79], a[144:151], v4
    v_smfmac_f32_16x16x64_bf16 v[56:59], v[68:71], a[72:79], v4
    v_smfmac_f32_16x16x64_bf16 v[60:63], v[68:71], a[152:159], v4
    s_nop 7
    v_permlane32_swap_b32 v56, v60
    v_permlane32_swap_b32 v57, v61
    v_permlane32_swap_b32 v58, v62
    v_permlane32_swap_b32 v59, v63
    v_add_f32 v56, v56, v60
    v_add_f32 v57, v57, v61
    v_add_f32 v58, v58, v62
    v_add_f32 v59, v59, v63
    v_cvt_pk_bf16_f32 v68, v56, v57
    v_cvt_pk_bf16_f32 v69, v58, v59
    ds_write_b64 v10, v[68:69]
    s_waitcnt lgkmcnt(0)
    s_barrier
    ds_read_b64_tr_b16 v[68:69], v11 offset:0
    ds_read_b64_tr_b16 v[70:71], v11 offset:128
    ds_read_b64_tr_b16 v[72:73], v11 offset:1024
    ds_read_b64_tr_b16 v[74:75], v11 offset:1152
    ds_read_b64_tr_b16 v[76:77], v11 offset:2048
    ds_read_b64_tr_b16 v[78:79], v11 offset:2176
    ds_read_b128 v[80:83], v6 offset:0
    ds_read_b128 v[84:87], v6 offset:1024
    ds_read_b128 v[88:91], v6 offset:2048
    ds_read_b128 v[92:95], v6 offset:3072
    ds_read_b128 v[96:99], v6 offset:4096
    ds_read_b128 v[100:103], v6 offset:5120
    s_waitcnt lgkmcnt(10)
    v_smfmac_f32_16x16x64_bf16 v[16:19], v[68:71], a[240:247], v4
    v_smfmac_f32_16x16x64_bf16 v[20:23], v[68:71], v[112:119], v4
    v_smfmac_f32_16x16x64_bf16 v[24:27], v[68:71], v[136:143], v4
    v_smfmac_f32_16x16x64_bf16 v[28:31], v[68:71], v[160:167], v4
    s_waitcnt lgkmcnt(8)
    v_smfmac_f32_16x16x64_bf16 v[16:19], v[72:75], a[248:255], v4
    v_smfmac_f32_16x16x64_bf16 v[20:23], v[72:75], v[120:127], v4
    v_smfmac_f32_16x16x64_bf16 v[24:27], v[72:75], v[144:151], v4
    v_smfmac_f32_16x16x64_bf16 v[28:31], v[72:75], v[168:175], v4
    s_waitcnt lgkmcnt(6)
    v_smfmac_f32_16x16x64_bf16 v[16:19], v[76:79], v[104:111], v4
    v_smfmac_f32_16x16x64_bf16 v[20:23], v[76:79], v[128:135], v4
    v_smfmac_f32_16x16x64_bf16 v[24:27], v[76:79], v[152:159], v4
    v_smfmac_f32_16x16x64_bf16 v[28:31], v[76:79], v[176:183], v4
    v_smfmac_f32_16x16x64_bf16 v[32:35], v[68:71], v[184:191], v4
    v_smfmac_f32_16x16x64_bf16 v[36:39], v[68:71], v[208:215], v4
    s_nop 4
    v_permlane32_swap_b32 v16, v24
    v_permlane32_swap_b32 v17, v25
    v_smfmac_f32_16x16x64_bf16 v[40:43], v[68:71], v[232:239], v4
    v_permlane32_swap_b32 v18, v26
    v_permlane32_swap_b32 v19, v27
    s_waitcnt lgkmcnt(4)
    v_smfmac_f32_16x16x64_bf16 v[44:47], v[68:71], v[80:87], v4
    v_add_f32 v16, v16, v24
    v_add_f32 v17, v17, v25
    ds_read_b128 v[80:83], v6 offset:6144
    ds_read_b128 v[84:87], v6 offset:7168
    v_smfmac_f32_16x16x64_bf16 v[32:35], v[72:75], v[192:199], v4
    v_add_f32 v18, v18, v26
    v_add_f32 v19, v19, v27
    v_smfmac_f32_16x16x64_bf16 v[36:39], v[72:75], v[216:223], v4
    v_permlane32_swap_b32 v20, v28
    v_permlane32_swap_b32 v21, v29
    v_smfmac_f32_16x16x64_bf16 v[40:43], v[72:75], v[240:247], v4
    v_permlane32_swap_b32 v22, v30
    v_permlane32_swap_b32 v23, v31
    s_waitcnt lgkmcnt(4)
    v_smfmac_f32_16x16x64_bf16 v[44:47], v[72:75], v[88:95], v4
    v_add_f32 v20, v20, v28
    v_add_f32 v21, v21, v29
    ds_read_b128 v[88:91], v6 offset:8192
    ds_read_b128 v[92:95], v6 offset:9216
    v_smfmac_f32_16x16x64_bf16 v[32:35], v[76:79], v[200:207], v4
    v_add_f32 v22, v22, v30
    v_add_f32 v23, v23, v31
    v_smfmac_f32_16x16x64_bf16 v[36:39], v[76:79], v[224:231], v4
    v_cvt_pk_bf16_f32 v56, v16, v17
    v_cvt_pk_bf16_f32 v57, v18, v19
    v_smfmac_f32_16x16x64_bf16 v[40:43], v[76:79], v[248:255], v4
    v_cvt_pk_bf16_f32 v58, v20, v21
    v_cvt_pk_bf16_f32 v59, v22, v23
    s_waitcnt lgkmcnt(4)
    v_smfmac_f32_16x16x64_bf16 v[44:47], v[76:79], v[96:103], v4
    v_permlane16_swap_b32 v56, v58
    ds_read_b128 v[96:99], v6 offset:10240
    ds_read_b128 v[100:103], v6 offset:11264
    v_permlane16_swap_b32 v57, v59
    v_min_u32 v56, -2, v56
    v_min_u32 v57, -2, v57
    v_min_u32 v58, -2, v58
    v_min_u32 v59, -2, v59
    buffer_store_dwordx4 v[56:59], v14, s[8:11], s43 offen sc1
    s_add_u32 s49, s43, 32768
    s_waitcnt lgkmcnt(4)
    v_smfmac_f32_16x16x64_bf16 v[48:51], v[68:71], v[80:87], v4
    v_permlane32_swap_b32 v32, v40
    v_permlane32_swap_b32 v33, v41
    v_permlane32_swap_b32 v34, v42
    ds_read_b128 v[80:83], v6 offset:12288
    ds_read_b128 v[84:87], v6 offset:13312
    s_waitcnt lgkmcnt(4)
    v_smfmac_f32_16x16x64_bf16 v[48:51], v[72:75], v[88:95], v4
    v_permlane32_swap_b32 v35, v43
    v_add_f32 v32, v32, v40
    v_add_f32 v33, v33, v41
    v_add_f32 v34, v34, v42
    ds_read_b128 v[88:91], v6 offset:14336
    ds_read_b128 v[92:95], v6 offset:15360
    s_waitcnt lgkmcnt(4)
    v_smfmac_f32_16x16x64_bf16 v[48:51], v[76:79], v[96:103], v4
    v_add_f32 v35, v35, v43
    v_permlane32_swap_b32 v36, v44
    v_permlane32_swap_b32 v37, v45
    v_permlane32_swap_b32 v38, v46
    ds_read_b128 v[96:99], v6 offset:16384
    ds_read_b128 v[100:103], v6 offset:17408
    v_permlane32_swap_b32 v39, v47
    v_add_f32 v36, v36, v44
    v_add_f32 v37, v37, v45
    v_add_f32 v38, v38, v46
    s_waitcnt lgkmcnt(4)
    v_smfmac_f32_16x16x64_bf16 v[52:55], v[68:71], v[80:87], v4
    v_add_f32 v39, v39, v47
    v_cvt_pk_bf16_f32 v60, v32, v33
    v_cvt_pk_bf16_f32 v61, v34, v35
    s_waitcnt lgkmcnt(2)
    v_smfmac_f32_16x16x64_bf16 v[52:55], v[72:75], v[88:95], v4
    v_cvt_pk_bf16_f32 v62, v36, v37
    v_cvt_pk_bf16_f32 v63, v38, v39
    s_waitcnt lgkmcnt(0)
    v_smfmac_f32_16x16x64_bf16 v[52:55], v[76:79], v[96:103], v4
    v_permlane16_swap_b32 v60, v62
    v_permlane16_swap_b32 v61, v63
    v_min_u32 v60, -2, v60
    v_min_u32 v61, -2, v61
    v_min_u32 v62, -2, v62
    v_min_u32 v63, -2, v63
    buffer_store_dwordx4 v[60:63], v14, s[8:11], s49 offen sc1
    s_nop 0
    v_permlane32_swap_b32 v48, v52
    v_permlane32_swap_b32 v49, v53
    v_permlane32_swap_b32 v50, v54
    v_permlane32_swap_b32 v51, v55
    v_add_f32 v48, v48, v52
    v_add_f32 v49, v49, v53
    v_add_f32 v50, v50, v54
    v_add_f32 v51, v51, v55
    v_cvt_pk_bf16_f32 v64, v48, v49
    v_cvt_pk_bf16_f32 v65, v50, v51
    v_mov_b32 v66, v64
    v_mov_b32 v67, v65
    s_nop 0
    v_permlane16_swap_b32 v64, v66
    v_permlane16_swap_b32 v65, v67
    v_min_u32 v64, -2, v64
    v_min_u32 v65, -2, v65
    v_min_u32 v66, -2, v66
    v_min_u32 v67, -2, v67
    buffer_store_dwordx4 v[64:67], v15, s[8:11], s43 offen sc1
    s_add_u32 s40, s40, 1
    s_add_u32 s43, s43, 458752
    s_add_u32 s47, s47, 458752
    s_add_u32 s45, s45, 458752
    s_cmp_lt_u32 s40, 64
    s_cbranch_scc1 interleave_layers__linear_attn_block__memory_aug_recurrent_mem_tr__prompt_kernel_v_stepw1
    s_branch interleave_layers__linear_attn_block__memory_aug_recurrent_mem_tr__prompt_kernel_v_end
interleave_layers__linear_attn_block__memory_aug_recurrent_mem_tr__prompt_kernel_v_stepw2:
    v_mov_b32 v16, 0
    v_mov_b32 v17, 0
    v_mov_b32 v18, 0
    v_mov_b32 v19, 0
    v_mov_b32 v20, 0
    v_mov_b32 v21, 0
    v_mov_b32 v22, 0
    v_mov_b32 v23, 0
    v_mov_b32 v24, 0
    v_mov_b32 v25, 0
    v_mov_b32 v26, 0
    v_mov_b32 v27, 0
    v_mov_b32 v28, 0
    v_mov_b32 v29, 0
    v_mov_b32 v30, 0
    v_mov_b32 v31, 0
    v_mov_b32 v32, 0
    v_mov_b32 v33, 0
    v_mov_b32 v34, 0
    v_mov_b32 v35, 0
    v_mov_b32 v36, 0
    v_mov_b32 v37, 0
    v_mov_b32 v38, 0
    v_mov_b32 v39, 0
    v_mov_b32 v40, 0
    v_mov_b32 v41, 0
    v_mov_b32 v42, 0
    v_mov_b32 v43, 0
    v_mov_b32 v44, 0
    v_mov_b32 v45, 0
    v_mov_b32 v46, 0
    v_mov_b32 v47, 0
    v_mov_b32 v48, 0
    v_mov_b32 v49, 0
    v_mov_b32 v50, 0
    v_mov_b32 v51, 0
    v_mov_b32 v52, 0
    v_mov_b32 v53, 0
    v_mov_b32 v54, 0
    v_mov_b32 v55, 0
    v_mov_b32 v56, 0
    v_mov_b32 v57, 0
    v_mov_b32 v58, 0
    v_mov_b32 v59, 0
    v_mov_b32 v60, 0
    v_mov_b32 v61, 0
    v_mov_b32 v62, 0
    v_mov_b32 v63, 0
    v_mov_b32 v64, 0
    v_mov_b32 v65, 0
    v_mov_b32 v66, 0
    v_mov_b32 v67, 0
    s_add_u32 s48, s47, 4096
    s_lshl_b32 s95, s92, 6
    s_add_u32 s95, s95, s40
    s_add_u32 s95, s95, 1
    s_cmp_ge_i32 s59, s95
    s_cbranch_scc1 interleave_layers__linear_attn_block__memory_aug_recurrent_mem_tr__prompt_kernel_v_ecw2_ok
    s_and_b32 s24, s2, 7
    s_lshl_b32 s24, s24, 7
    s_add_u32 s24, s24, 23109632
    v_and_b32 v79, 3, v1
    v_lshl_add_u32 v79, v79, 2, s24
    s_mov_b32 s61, 0
interleave_layers__linear_attn_block__memory_aug_recurrent_mem_tr__prompt_kernel_v_ecw2:
    buffer_load_dword v78, v79, s[8:11], 0 offen sc1
    s_waitcnt vmcnt(0)
    v_readlane_b32 s59, v78, 0
    v_readlane_b32 s24, v78, 1
    s_min_i32 s59, s59, s24
    v_readlane_b32 s24, v78, 2
    s_min_i32 s59, s59, s24
    s_cmp_ge_i32 s59, s95
    s_cbranch_scc1 interleave_layers__linear_attn_block__memory_aug_recurrent_mem_tr__prompt_kernel_v_ecw2_ok
    s_add_u32 s61, s61, 1
    s_cmp_ge_u32 s61, s60
    s_cbranch_scc1 interleave_layers__linear_attn_block__memory_aug_recurrent_mem_tr__prompt_kernel_v_ecw2_to
    s_sleep 2
    s_branch interleave_layers__linear_attn_block__memory_aug_recurrent_mem_tr__prompt_kernel_v_ecw2
interleave_layers__linear_attn_block__memory_aug_recurrent_mem_tr__prompt_kernel_v_ecw2_to:
    s_mov_b32 s60, 1
interleave_layers__linear_attn_block__memory_aug_recurrent_mem_tr__prompt_kernel_v_ecw2_ok:
    s_sleep 20
    s_mov_b64 exec, 1
    s_mov_b32 s61, 0
    v_mov_b32 v81, 0
    buffer_atomic_add v81, v12, s[8:11], s45 offen sc0
    s_sleep 3
    v_mov_b32 v82, 0
    buffer_atomic_add v82, v12, s[8:11], s45 offen sc0
    s_sleep 3
    v_mov_b32 v83, 0
    buffer_atomic_add v83, v12, s[8:11], s45 offen sc0
    s_sleep 3
interleave_layers__linear_attn_block__memory_aug_recurrent_mem_tr__prompt_kernel_v_prw2:
    v_mov_b32 v80, 0
    buffer_atomic_add v80, v12, s[8:11], s45 offen sc0
    s_waitcnt vmcnt(3)
    v_cmp_le_i32 vcc, 8, v81
    s_add_u32 s61, s61, 1
    s_cbranch_vccnz interleave_layers__linear_attn_block__memory_aug_recurrent_mem_tr__prompt_kernel_v_prw2_out
    s_sleep 3
    v_mov_b32 v81, 0
    buffer_atomic_add v81, v12, s[8:11], s45 offen sc0
    s_waitcnt vmcnt(3)
    v_cmp_le_i32 vcc, 8, v82
    s_add_u32 s61, s61, 1
    s_cbranch_vccnz interleave_layers__linear_attn_block__memory_aug_recurrent_mem_tr__prompt_kernel_v_prw2_out
    s_sleep 3
    v_mov_b32 v82, 0
    buffer_atomic_add v82, v12, s[8:11], s45 offen sc0
    s_waitcnt vmcnt(3)
    v_cmp_le_i32 vcc, 8, v83
    s_add_u32 s61, s61, 1
    s_cbranch_vccnz interleave_layers__linear_attn_block__memory_aug_recurrent_mem_tr__prompt_kernel_v_prw2_out
    s_sleep 3
    v_mov_b32 v83, 0
    buffer_atomic_add v83, v12, s[8:11], s45 offen sc0
    s_waitcnt vmcnt(3)
    v_cmp_le_i32 vcc, 8, v80
    s_add_u32 s61, s61, 1
    s_cbranch_vccnz interleave_layers__linear_attn_block__memory_aug_recurrent_mem_tr__prompt_kernel_v_prw2_out
    s_sleep 3
    s_cmp_ge_u32 s61, s60
    s_cbranch_scc0 interleave_layers__linear_attn_block__memory_aug_recurrent_mem_tr__prompt_kernel_v_prw2
    s_mov_b32 s60, 1
interleave_layers__linear_attn_block__memory_aug_recurrent_mem_tr__prompt_kernel_v_prw2_out:
    s_mov_b64 exec, -1
    buffer_load_dwordx4 v[68:71], v7, s[8:11], s47 offen sc1
    buffer_load_dwordx4 v[72:75], v7, s[8:11], s48 offen sc1
    buffer_load_dwordx2 v[76:77], v8, s[8:11], s47 offen sc1
    s_waitcnt vmcnt(0)
    v_max3_u32 v103, v68, v69, v70
    v_max3_u32 v103, v103, v71, v72
    v_max3_u32 v103, v103, v73, v74
    v_max3_u32 v103, v103, v75, v76
    v_max_u32 v103, v103, v77
    v_cmp_eq_u32 vcc, -1, v103
    s_cbranch_vccz interleave_layers__linear_attn_block__memory_aug_recurrent_mem_tr__prompt_kernel_v_pmw2_out
    s_mov_b32 s61, 0
interleave_layers__linear_attn_block__memory_aug_recurrent_mem_tr__prompt_kernel_v_pmw2:
    buffer_load_dwordx4 v[68:71], v7, s[8:11], s47 offen sc1
    buffer_load_dwordx4 v[72:75], v7, s[8:11], s48 offen sc1
    buffer_load_dwordx2 v[76:77], v8, s[8:11], s47 offen sc1
    s_waitcnt vmcnt(0)
    v_max3_u32 v103, v68, v69, v70
    v_max3_u32 v103, v103, v71, v72
    v_max3_u32 v103, v103, v73, v74
    v_max3_u32 v103, v103, v75, v76
    v_max_u32 v103, v103, v77
    v_cmp_eq_u32 vcc, -1, v103
    s_add_u32 s61, s61, 1
    s_cbranch_vccz interleave_layers__linear_attn_block__memory_aug_recurrent_mem_tr__prompt_kernel_v_pmw2_out
    s_cmp_ge_u32 s61, s60
    s_cbranch_scc1 interleave_layers__linear_attn_block__memory_aug_recurrent_mem_tr__prompt_kernel_v_pmw2_to
    s_sleep 1
    s_branch interleave_layers__linear_attn_block__memory_aug_recurrent_mem_tr__prompt_kernel_v_pmw2
interleave_layers__linear_attn_block__memory_aug_recurrent_mem_tr__prompt_kernel_v_pmw2_to:
    s_mov_b32 s60, 1
interleave_layers__linear_attn_block__memory_aug_recurrent_mem_tr__prompt_kernel_v_pmw2_out:
    ds_write_b128 v7, v[68:71]
    ds_write_b128 v7, v[72:75] offset:4096
    ds_write_b64 v8, v[76:77]
interleave_layers__linear_attn_block__memory_aug_recurrent_mem_tr__prompt_kernel_v_gow2:
    v_smfmac_f32_16x16x64_bf16 v[56:59], v[68:71], a[16:23], v4
    v_smfmac_f32_16x16x64_bf16 v[60:63], v[68:71], a[96:103], v4
    v_smfmac_f32_16x16x64_bf16 v[64:67], v[68:71], a[176:183], v4
    s_waitcnt lgkmcnt(0)
    s_barrier
    ds_read_b128 v[80:83], v5 offset:0
    ds_read_b128 v[84:87], v5 offset:1024
    ds_read_b128 v[88:91], v5 offset:3072
    ds_read_b128 v[92:95], v5 offset:4096
    ds_read_b128 v[96:99], v5 offset:5120
    ds_read_b128 v[100:103], v5 offset:7168
    ds_read_b128 v[76:79], v5 offset:8192
    ds_read_b128 v[68:71], v5 offset:9216
    v_smfmac_f32_16x16x64_bf16 v[64:67], v[72:75], a[208:215], v4
    v_smfmac_f32_16x16x64_bf16 v[56:59], v[72:75], a[48:55], v4
    v_smfmac_f32_16x16x64_bf16 v[60:63], v[72:75], a[128:135], v4
    s_waitcnt lgkmcnt(7)
    v_smfmac_f32_16x16x64_bf16 v[64:67], v[80:83], a[160:167], v4
    s_waitcnt lgkmcnt(6)
    v_smfmac_f32_16x16x64_bf16 v[64:67], v[84:87], a[168:175], v4
    s_waitcnt lgkmcnt(5)
    v_smfmac_f32_16x16x64_bf16 v[64:67], v[88:91], a[184:191], v4
    s_waitcnt lgkmcnt(4)
    v_smfmac_f32_16x16x64_bf16 v[64:67], v[92:95], a[192:199], v4
    s_waitcnt lgkmcnt(3)
    v_smfmac_f32_16x16x64_bf16 v[64:67], v[96:99], a[200:207], v4
    s_waitcnt lgkmcnt(2)
    v_smfmac_f32_16x16x64_bf16 v[64:67], v[100:103], a[216:223], v4
    s_waitcnt lgkmcnt(1)
    v_smfmac_f32_16x16x64_bf16 v[64:67], v[76:79], a[224:231], v4
    s_waitcnt lgkmcnt(0)
    v_smfmac_f32_16x16x64_bf16 v[64:67], v[68:71], a[232:239], v4
    v_smfmac_f32_16x16x64_bf16 v[56:59], v[80:83], a[0:7], v4
    v_smfmac_f32_16x16x64_bf16 v[60:63], v[80:83], a[80:87], v4
    v_smfmac_f32_16x16x64_bf16 v[56:59], v[84:87], a[8:15], v4
    s_nop 4
    v_mov_b32 v72, v64
    v_smfmac_f32_16x16x64_bf16 v[60:63], v[84:87], a[88:95], v4
    v_mov_b32 v73, v65
    v_mov_b32 v74, v66
    v_smfmac_f32_16x16x64_bf16 v[56:59], v[88:91], a[24:31], v4
    v_mov_b32 v75, v67
    v_smfmac_f32_16x16x64_bf16 v[60:63], v[88:91], a[104:111], v4
    v_permlane32_swap_b32 v64, v72
    v_permlane32_swap_b32 v65, v73
    v_smfmac_f32_16x16x64_bf16 v[56:59], v[92:95], a[32:39], v4
    v_permlane32_swap_b32 v66, v74
    v_permlane32_swap_b32 v67, v75
    v_smfmac_f32_16x16x64_bf16 v[60:63], v[92:95], a[112:119], v4
    v_add_f32 v64, v64, v72
    v_add_f32 v65, v65, v73
    v_smfmac_f32_16x16x64_bf16 v[56:59], v[96:99], a[40:47], v4
    v_add_f32 v66, v66, v74
    v_add_f32 v67, v67, v75
    v_smfmac_f32_16x16x64_bf16 v[60:63], v[96:99], a[120:127], v4
    v_cvt_pk_bf16_f32 v72, v64, v65
    v_cvt_pk_bf16_f32 v73, v66, v67
    v_smfmac_f32_16x16x64_bf16 v[56:59], v[100:103], a[56:63], v4
    ds_write_b64 v9, v[72:73] offset:512
    v_smfmac_f32_16x16x64_bf16 v[60:63], v[100:103], a[136:143], v4
    v_smfmac_f32_16x16x64_bf16 v[56:59], v[76:79], a[64:71], v4
    v_smfmac_f32_16x16x64_bf16 v[60:63], v[76:79], a[144:151], v4
    v_smfmac_f32_16x16x64_bf16 v[56:59], v[68:71], a[72:79], v4
    v_smfmac_f32_16x16x64_bf16 v[60:63], v[68:71], a[152:159], v4
    s_nop 7
    v_permlane32_swap_b32 v56, v60
    v_permlane32_swap_b32 v57, v61
    v_permlane32_swap_b32 v58, v62
    v_permlane32_swap_b32 v59, v63
    v_add_f32 v56, v56, v60
    v_add_f32 v57, v57, v61
    v_add_f32 v58, v58, v62
    v_add_f32 v59, v59, v63
    v_cvt_pk_bf16_f32 v68, v56, v57
    v_cvt_pk_bf16_f32 v69, v58, v59
    ds_write_b64 v10, v[68:69]
    s_waitcnt lgkmcnt(0)
    s_barrier
    ds_read_b64_tr_b16 v[68:69], v11 offset:0
    ds_read_b64_tr_b16 v[70:71], v11 offset:128
    ds_read_b64_tr_b16 v[72:73], v11 offset:1024
    ds_read_b64_tr_b16 v[74:75], v11 offset:1152
    ds_read_b64_tr_b16 v[76:77], v11 offset:2048
    ds_read_b64_tr_b16 v[78:79], v11 offset:2176
    ds_read_b128 v[80:83], v6 offset:0
    ds_read_b128 v[84:87], v6 offset:1024
    ds_read_b128 v[88:91], v6 offset:2048
    ds_read_b128 v[92:95], v6 offset:3072
    ds_read_b128 v[96:99], v6 offset:4096
    ds_read_b128 v[100:103], v6 offset:5120
    s_waitcnt lgkmcnt(10)
    v_smfmac_f32_16x16x64_bf16 v[16:19], v[68:71], a[240:247], v4
    v_smfmac_f32_16x16x64_bf16 v[20:23], v[68:71], v[112:119], v4
    v_smfmac_f32_16x16x64_bf16 v[24:27], v[68:71], v[136:143], v4
    v_smfmac_f32_16x16x64_bf16 v[28:31], v[68:71], v[160:167], v4
    s_waitcnt lgkmcnt(8)
    v_smfmac_f32_16x16x64_bf16 v[16:19], v[72:75], a[248:255], v4
    v_smfmac_f32_16x16x64_bf16 v[20:23], v[72:75], v[120:127], v4
    v_smfmac_f32_16x16x64_bf16 v[24:27], v[72:75], v[144:151], v4
    v_smfmac_f32_16x16x64_bf16 v[28:31], v[72:75], v[168:175], v4
    s_waitcnt lgkmcnt(6)
    v_smfmac_f32_16x16x64_bf16 v[16:19], v[76:79], v[104:111], v4
    v_smfmac_f32_16x16x64_bf16 v[20:23], v[76:79], v[128:135], v4
    v_smfmac_f32_16x16x64_bf16 v[24:27], v[76:79], v[152:159], v4
    v_smfmac_f32_16x16x64_bf16 v[28:31], v[76:79], v[176:183], v4
    v_smfmac_f32_16x16x64_bf16 v[32:35], v[68:71], v[184:191], v4
    v_smfmac_f32_16x16x64_bf16 v[36:39], v[68:71], v[208:215], v4
    s_nop 4
    v_permlane32_swap_b32 v16, v24
    v_permlane32_swap_b32 v17, v25
    v_smfmac_f32_16x16x64_bf16 v[40:43], v[68:71], v[232:239], v4
    v_permlane32_swap_b32 v18, v26
    v_permlane32_swap_b32 v19, v27
    s_waitcnt lgkmcnt(4)
    v_smfmac_f32_16x16x64_bf16 v[44:47], v[68:71], v[80:87], v4
    v_add_f32 v16, v16, v24
    v_add_f32 v17, v17, v25
    ds_read_b128 v[80:83], v6 offset:6144
    ds_read_b128 v[84:87], v6 offset:7168
    v_smfmac_f32_16x16x64_bf16 v[32:35], v[72:75], v[192:199], v4
    v_add_f32 v18, v18, v26
    v_add_f32 v19, v19, v27
    v_smfmac_f32_16x16x64_bf16 v[36:39], v[72:75], v[216:223], v4
    v_permlane32_swap_b32 v20, v28
    v_permlane32_swap_b32 v21, v29
    v_smfmac_f32_16x16x64_bf16 v[40:43], v[72:75], v[240:247], v4
    v_permlane32_swap_b32 v22, v30
    v_permlane32_swap_b32 v23, v31
    s_waitcnt lgkmcnt(4)
    v_smfmac_f32_16x16x64_bf16 v[44:47], v[72:75], v[88:95], v4
    v_add_f32 v20, v20, v28
    v_add_f32 v21, v21, v29
    ds_read_b128 v[88:91], v6 offset:8192
    ds_read_b128 v[92:95], v6 offset:9216
    v_smfmac_f32_16x16x64_bf16 v[32:35], v[76:79], v[200:207], v4
    v_add_f32 v22, v22, v30
    v_add_f32 v23, v23, v31
    v_smfmac_f32_16x16x64_bf16 v[36:39], v[76:79], v[224:231], v4
    v_cvt_pk_bf16_f32 v56, v16, v17
    v_cvt_pk_bf16_f32 v57, v18, v19
    v_smfmac_f32_16x16x64_bf16 v[40:43], v[76:79], v[248:255], v4
    v_cvt_pk_bf16_f32 v58, v20, v21
    v_cvt_pk_bf16_f32 v59, v22, v23
    s_waitcnt lgkmcnt(4)
    v_smfmac_f32_16x16x64_bf16 v[44:47], v[76:79], v[96:103], v4
    v_permlane16_swap_b32 v56, v58
    ds_read_b128 v[96:99], v6 offset:10240
    ds_read_b128 v[100:103], v6 offset:11264
    v_permlane16_swap_b32 v57, v59
    v_min_u32 v56, -2, v56
    v_min_u32 v57, -2, v57
    v_min_u32 v58, -2, v58
    v_min_u32 v59, -2, v59
    buffer_store_dwordx4 v[56:59], v14, s[8:11], s43 offen sc1
    s_add_u32 s49, s43, 32768
    s_waitcnt lgkmcnt(4)
    v_smfmac_f32_16x16x64_bf16 v[48:51], v[68:71], v[80:87], v4
    v_permlane32_swap_b32 v32, v40
    v_permlane32_swap_b32 v33, v41
    v_permlane32_swap_b32 v34, v42
    ds_read_b128 v[80:83], v6 offset:12288
    ds_read_b128 v[84:87], v6 offset:13312
    s_waitcnt lgkmcnt(4)
    v_smfmac_f32_16x16x64_bf16 v[48:51], v[72:75], v[88:95], v4
    v_permlane32_swap_b32 v35, v43
    v_add_f32 v32, v32, v40
    v_add_f32 v33, v33, v41
    v_add_f32 v34, v34, v42
    ds_read_b128 v[88:91], v6 offset:14336
    ds_read_b128 v[92:95], v6 offset:15360
    s_waitcnt lgkmcnt(4)
    v_smfmac_f32_16x16x64_bf16 v[48:51], v[76:79], v[96:103], v4
    v_add_f32 v35, v35, v43
    v_permlane32_swap_b32 v36, v44
    v_permlane32_swap_b32 v37, v45
    v_permlane32_swap_b32 v38, v46
    ds_read_b128 v[96:99], v6 offset:16384
    ds_read_b128 v[100:103], v6 offset:17408
    v_permlane32_swap_b32 v39, v47
    v_add_f32 v36, v36, v44
    v_add_f32 v37, v37, v45
    v_add_f32 v38, v38, v46
    s_waitcnt lgkmcnt(4)
    v_smfmac_f32_16x16x64_bf16 v[52:55], v[68:71], v[80:87], v4
    v_add_f32 v39, v39, v47
    v_cvt_pk_bf16_f32 v60, v32, v33
    v_cvt_pk_bf16_f32 v61, v34, v35
    s_waitcnt lgkmcnt(2)
    v_smfmac_f32_16x16x64_bf16 v[52:55], v[72:75], v[88:95], v4
    v_cvt_pk_bf16_f32 v62, v36, v37
    v_cvt_pk_bf16_f32 v63, v38, v39
    s_waitcnt lgkmcnt(0)
    v_smfmac_f32_16x16x64_bf16 v[52:55], v[76:79], v[96:103], v4
    v_permlane16_swap_b32 v60, v62
    v_permlane16_swap_b32 v61, v63
    v_min_u32 v60, -2, v60
    v_min_u32 v61, -2, v61
    v_min_u32 v62, -2, v62
    v_min_u32 v63, -2, v63
    buffer_store_dwordx4 v[60:63], v14, s[8:11], s49 offen sc1
    s_nop 0
    v_permlane32_swap_b32 v48, v52
    v_permlane32_swap_b32 v49, v53
    v_permlane32_swap_b32 v50, v54
    v_permlane32_swap_b32 v51, v55
    v_add_f32 v48, v48, v52
    v_add_f32 v49, v49, v53
    v_add_f32 v50, v50, v54
    v_add_f32 v51, v51, v55
    v_cvt_pk_bf16_f32 v64, v48, v49
    v_cvt_pk_bf16_f32 v65, v50, v51
    v_mov_b32 v66, v64
    v_mov_b32 v67, v65
    s_nop 0
    v_permlane16_swap_b32 v64, v66
    v_permlane16_swap_b32 v65, v67
    v_min_u32 v64, -2, v64
    v_min_u32 v65, -2, v65
    v_min_u32 v66, -2, v66
    v_min_u32 v67, -2, v67
    buffer_store_dwordx4 v[64:67], v15, s[8:11], s43 offen sc1
    s_add_u32 s40, s40, 1
    s_add_u32 s43, s43, 458752
    s_add_u32 s47, s47, 458752
    s_add_u32 s45, s45, 458752
    s_cmp_lt_u32 s40, 64
    s_cbranch_scc1 interleave_layers__linear_attn_block__memory_aug_recurrent_mem_tr__prompt_kernel_v_stepw2
    s_branch interleave_layers__linear_attn_block__memory_aug_recurrent_mem_tr__prompt_kernel_v_end
interleave_layers__linear_attn_block__memory_aug_recurrent_mem_tr__prompt_kernel_v_stepw3:
    v_mov_b32 v16, 0
    v_mov_b32 v17, 0
    v_mov_b32 v18, 0
    v_mov_b32 v19, 0
    v_mov_b32 v20, 0
    v_mov_b32 v21, 0
    v_mov_b32 v22, 0
    v_mov_b32 v23, 0
    v_mov_b32 v24, 0
    v_mov_b32 v25, 0
    v_mov_b32 v26, 0
    v_mov_b32 v27, 0
    v_mov_b32 v28, 0
    v_mov_b32 v29, 0
    v_mov_b32 v30, 0
    v_mov_b32 v31, 0
    v_mov_b32 v32, 0
    v_mov_b32 v33, 0
    v_mov_b32 v34, 0
    v_mov_b32 v35, 0
    v_mov_b32 v36, 0
    v_mov_b32 v37, 0
    v_mov_b32 v38, 0
    v_mov_b32 v39, 0
    v_mov_b32 v40, 0
    v_mov_b32 v41, 0
    v_mov_b32 v42, 0
    v_mov_b32 v43, 0
    v_mov_b32 v44, 0
    v_mov_b32 v45, 0
    v_mov_b32 v46, 0
    v_mov_b32 v47, 0
    v_mov_b32 v48, 0
    v_mov_b32 v49, 0
    v_mov_b32 v50, 0
    v_mov_b32 v51, 0
    v_mov_b32 v52, 0
    v_mov_b32 v53, 0
    v_mov_b32 v54, 0
    v_mov_b32 v55, 0
    v_mov_b32 v56, 0
    v_mov_b32 v57, 0
    v_mov_b32 v58, 0
    v_mov_b32 v59, 0
    v_mov_b32 v60, 0
    v_mov_b32 v61, 0
    v_mov_b32 v62, 0
    v_mov_b32 v63, 0
    v_mov_b32 v64, 0
    v_mov_b32 v65, 0
    v_mov_b32 v66, 0
    v_mov_b32 v67, 0
    s_add_u32 s48, s47, 4096
    s_lshl_b32 s95, s92, 6
    s_add_u32 s95, s95, s40
    s_add_u32 s95, s95, 1
    s_cmp_ge_i32 s59, s95
    s_cbranch_scc1 interleave_layers__linear_attn_block__memory_aug_recurrent_mem_tr__prompt_kernel_v_ecw3_ok
    s_and_b32 s24, s2, 7
    s_lshl_b32 s24, s24, 7
    s_add_u32 s24, s24, 23109632
    v_and_b32 v79, 3, v1
    v_lshl_add_u32 v79, v79, 2, s24
    s_mov_b32 s61, 0
interleave_layers__linear_attn_block__memory_aug_recurrent_mem_tr__prompt_kernel_v_ecw3:
    buffer_load_dword v78, v79, s[8:11], 0 offen sc1
    s_waitcnt vmcnt(0)
    v_readlane_b32 s59, v78, 0
    v_readlane_b32 s24, v78, 1
    s_min_i32 s59, s59, s24
    v_readlane_b32 s24, v78, 2
    s_min_i32 s59, s59, s24
    s_cmp_ge_i32 s59, s95
    s_cbranch_scc1 interleave_layers__linear_attn_block__memory_aug_recurrent_mem_tr__prompt_kernel_v_ecw3_ok
    s_add_u32 s61, s61, 1
    s_cmp_ge_u32 s61, s60
    s_cbranch_scc1 interleave_layers__linear_attn_block__memory_aug_recurrent_mem_tr__prompt_kernel_v_ecw3_to
    s_sleep 2
    s_branch interleave_layers__linear_attn_block__memory_aug_recurrent_mem_tr__prompt_kernel_v_ecw3
interleave_layers__linear_attn_block__memory_aug_recurrent_mem_tr__prompt_kernel_v_ecw3_to:
    s_mov_b32 s60, 1
interleave_layers__linear_attn_block__memory_aug_recurrent_mem_tr__prompt_kernel_v_ecw3_ok:
    s_sleep 20
    s_mov_b64 exec, 1
    s_mov_b32 s61, 0
    v_mov_b32 v81, 0
    buffer_atomic_add v81, v12, s[8:11], s45 offen sc0
    s_sleep 3
    v_mov_b32 v82, 0
    buffer_atomic_add v82, v12, s[8:11], s45 offen sc0
    s_sleep 3
    v_mov_b32 v83, 0
    buffer_atomic_add v83, v12, s[8:11], s45 offen sc0
    s_sleep 3
interleave_layers__linear_attn_block__memory_aug_recurrent_mem_tr__prompt_kernel_v_prw3:
    v_mov_b32 v80, 0
    buffer_atomic_add v80, v12, s[8:11], s45 offen sc0
    s_waitcnt vmcnt(3)
    v_cmp_le_i32 vcc, 8, v81
    s_add_u32 s61, s61, 1
    s_cbranch_vccnz interleave_layers__linear_attn_block__memory_aug_recurrent_mem_tr__prompt_kernel_v_prw3_out
    s_sleep 3
    v_mov_b32 v81, 0
    buffer_atomic_add v81, v12, s[8:11], s45 offen sc0
    s_waitcnt vmcnt(3)
    v_cmp_le_i32 vcc, 8, v82
    s_add_u32 s61, s61, 1
    s_cbranch_vccnz interleave_layers__linear_attn_block__memory_aug_recurrent_mem_tr__prompt_kernel_v_prw3_out
    s_sleep 3
    v_mov_b32 v82, 0
    buffer_atomic_add v82, v12, s[8:11], s45 offen sc0
    s_waitcnt vmcnt(3)
    v_cmp_le_i32 vcc, 8, v83
    s_add_u32 s61, s61, 1
    s_cbranch_vccnz interleave_layers__linear_attn_block__memory_aug_recurrent_mem_tr__prompt_kernel_v_prw3_out
    s_sleep 3
    v_mov_b32 v83, 0
    buffer_atomic_add v83, v12, s[8:11], s45 offen sc0
    s_waitcnt vmcnt(3)
    v_cmp_le_i32 vcc, 8, v80
    s_add_u32 s61, s61, 1
    s_cbranch_vccnz interleave_layers__linear_attn_block__memory_aug_recurrent_mem_tr__prompt_kernel_v_prw3_out
    s_sleep 3
    s_cmp_ge_u32 s61, s60
    s_cbranch_scc0 interleave_layers__linear_attn_block__memory_aug_recurrent_mem_tr__prompt_kernel_v_prw3
    s_mov_b32 s60, 1
interleave_layers__linear_attn_block__memory_aug_recurrent_mem_tr__prompt_kernel_v_prw3_out:
    s_mov_b64 exec, -1
    buffer_load_dwordx4 v[68:71], v7, s[8:11], s47 offen sc1
    buffer_load_dwordx4 v[72:75], v7, s[8:11], s48 offen sc1
    buffer_load_dwordx2 v[76:77], v8, s[8:11], s47 offen sc1
    s_waitcnt vmcnt(0)
    v_max3_u32 v103, v68, v69, v70
    v_max3_u32 v103, v103, v71, v72
    v_max3_u32 v103, v103, v73, v74
    v_max3_u32 v103, v103, v75, v76
    v_max_u32 v103, v103, v77
    v_cmp_eq_u32 vcc, -1, v103
    s_cbranch_vccz interleave_layers__linear_attn_block__memory_aug_recurrent_mem_tr__prompt_kernel_v_pmw3_out
    s_mov_b32 s61, 0
interleave_layers__linear_attn_block__memory_aug_recurrent_mem_tr__prompt_kernel_v_pmw3:
    buffer_load_dwordx4 v[68:71], v7, s[8:11], s47 offen sc1
    buffer_load_dwordx4 v[72:75], v7, s[8:11], s48 offen sc1
    buffer_load_dwordx2 v[76:77], v8, s[8:11], s47 offen sc1
    s_waitcnt vmcnt(0)
    v_max3_u32 v103, v68, v69, v70
    v_max3_u32 v103, v103, v71, v72
    v_max3_u32 v103, v103, v73, v74
    v_max3_u32 v103, v103, v75, v76
    v_max_u32 v103, v103, v77
    v_cmp_eq_u32 vcc, -1, v103
    s_add_u32 s61, s61, 1
    s_cbranch_vccz interleave_layers__linear_attn_block__memory_aug_recurrent_mem_tr__prompt_kernel_v_pmw3_out
    s_cmp_ge_u32 s61, s60
    s_cbranch_scc1 interleave_layers__linear_attn_block__memory_aug_recurrent_mem_tr__prompt_kernel_v_pmw3_to
    s_sleep 1
    s_branch interleave_layers__linear_attn_block__memory_aug_recurrent_mem_tr__prompt_kernel_v_pmw3
interleave_layers__linear_attn_block__memory_aug_recurrent_mem_tr__prompt_kernel_v_pmw3_to:
    s_mov_b32 s60, 1
interleave_layers__linear_attn_block__memory_aug_recurrent_mem_tr__prompt_kernel_v_pmw3_out:
    ds_write_b128 v7, v[68:71]
    ds_write_b128 v7, v[72:75] offset:4096
    ds_write_b64 v8, v[76:77]
interleave_layers__linear_attn_block__memory_aug_recurrent_mem_tr__prompt_kernel_v_gow3:
    v_smfmac_f32_16x16x64_bf16 v[56:59], v[68:71], a[24:31], v4
    v_smfmac_f32_16x16x64_bf16 v[60:63], v[68:71], a[104:111], v4
    v_smfmac_f32_16x16x64_bf16 v[64:67], v[68:71], a[184:191], v4
    s_waitcnt lgkmcnt(0)
    s_barrier
    ds_read_b128 v[80:83], v5 offset:0
    ds_read_b128 v[84:87], v5 offset:1024
    ds_read_b128 v[88:91], v5 offset:2048
    ds_read_b128 v[92:95], v5 offset:4096
    ds_read_b128 v[96:99], v5 offset:5120
    ds_read_b128 v[100:103], v5 offset:6144
    ds_read_b128 v[76:79], v5 offset:8192
    ds_read_b128 v[68:71], v5 offset:9216
    v_smfmac_f32_16x16x64_bf16 v[64:67], v[72:75], a[216:223], v4
    v_smfmac_f32_16x16x64_bf16 v[56:59], v[72:75], a[56:63], v4
    v_smfmac_f32_16x16x64_bf16 v[60:63], v[72:75], a[136:143], v4
    s_waitcnt lgkmcnt(7)
    v_smfmac_f32_16x16x64_bf16 v[64:67], v[80:83], a[160:167], v4
    s_waitcnt lgkmcnt(6)
    v_smfmac_f32_16x16x64_bf16 v[64:67], v[84:87], a[168:175], v4
    s_waitcnt lgkmcnt(5)
    v_smfmac_f32_16x16x64_bf16 v[64:67], v[88:91], a[176:183], v4
    s_waitcnt lgkmcnt(4)
    v_smfmac_f32_16x16x64_bf16 v[64:67], v[92:95], a[192:199], v4
    s_waitcnt lgkmcnt(3)
    v_smfmac_f32_16x16x64_bf16 v[64:67], v[96:99], a[200:207], v4
    s_waitcnt lgkmcnt(2)
    v_smfmac_f32_16x16x64_bf16 v[64:67], v[100:103], a[208:215], v4
    s_waitcnt lgkmcnt(1)
    v_smfmac_f32_16x16x64_bf16 v[64:67], v[76:79], a[224:231], v4
    s_waitcnt lgkmcnt(0)
    v_smfmac_f32_16x16x64_bf16 v[64:67], v[68:71], a[232:239], v4
    v_smfmac_f32_16x16x64_bf16 v[56:59], v[80:83], a[0:7], v4
    v_smfmac_f32_16x16x64_bf16 v[60:63], v[80:83], a[80:87], v4
    v_smfmac_f32_16x16x64_bf16 v[56:59], v[84:87], a[8:15], v4
    s_nop 4
    v_mov_b32 v72, v64
    v_smfmac_f32_16x16x64_bf16 v[60:63], v[84:87], a[88:95], v4
    v_mov_b32 v73, v65
    v_mov_b32 v74, v66
    v_smfmac_f32_16x16x64_bf16 v[56:59], v[88:91], a[16:23], v4
    v_mov_b32 v75, v67
    v_smfmac_f32_16x16x64_bf16 v[60:63], v[88:91], a[96:103], v4
    v_permlane32_swap_b32 v64, v72
    v_permlane32_swap_b32 v65, v73
    v_smfmac_f32_16x16x64_bf16 v[56:59], v[92:95], a[32:39], v4
    v_permlane32_swap_b32 v66, v74
    v_permlane32_swap_b32 v67, v75
    v_smfmac_f32_16x16x64_bf16 v[60:63], v[92:95], a[112:119], v4
    v_add_f32 v64, v64, v72
    v_add_f32 v65, v65, v73
    v_smfmac_f32_16x16x64_bf16 v[56:59], v[96:99], a[40:47], v4
    v_add_f32 v66, v66, v74
    v_add_f32 v67, v67, v75
    v_smfmac_f32_16x16x64_bf16 v[60:63], v[96:99], a[120:127], v4
    v_cvt_pk_bf16_f32 v72, v64, v65
    v_cvt_pk_bf16_f32 v73, v66, v67
    v_smfmac_f32_16x16x64_bf16 v[56:59], v[100:103], a[48:55], v4
    ds_write_b64 v9, v[72:73] offset:512
    v_smfmac_f32_16x16x64_bf16 v[60:63], v[100:103], a[128:135], v4
    v_smfmac_f32_16x16x64_bf16 v[56:59], v[76:79], a[64:71], v4
    v_smfmac_f32_16x16x64_bf16 v[60:63], v[76:79], a[144:151], v4
    v_smfmac_f32_16x16x64_bf16 v[56:59], v[68:71], a[72:79], v4
    v_smfmac_f32_16x16x64_bf16 v[60:63], v[68:71], a[152:159], v4
    s_nop 7
    v_permlane32_swap_b32 v56, v60
    v_permlane32_swap_b32 v57, v61
    v_permlane32_swap_b32 v58, v62
    v_permlane32_swap_b32 v59, v63
    v_add_f32 v56, v56, v60
    v_add_f32 v57, v57, v61
    v_add_f32 v58, v58, v62
    v_add_f32 v59, v59, v63
    v_cvt_pk_bf16_f32 v68, v56, v57
    v_cvt_pk_bf16_f32 v69, v58, v59
    ds_write_b64 v10, v[68:69]
    s_waitcnt lgkmcnt(0)
    s_barrier
    ds_read_b64_tr_b16 v[68:69], v11 offset:0
    ds_read_b64_tr_b16 v[70:71], v11 offset:128
    ds_read_b64_tr_b16 v[72:73], v11 offset:1024
    ds_read_b64_tr_b16 v[74:75], v11 offset:1152
    ds_read_b64_tr_b16 v[76:77], v11 offset:2048
    ds_read_b64_tr_b16 v[78:79], v11 offset:2176
    ds_read_b128 v[80:83], v6 offset:0
    ds_read_b128 v[84:87], v6 offset:1024
    ds_read_b128 v[88:91], v6 offset:2048
    ds_read_b128 v[92:95], v6 offset:3072
    ds_read_b128 v[96:99], v6 offset:4096
    ds_read_b128 v[100:103], v6 offset:5120
    s_waitcnt lgkmcnt(10)
    v_smfmac_f32_16x16x64_bf16 v[16:19], v[68:71], a[240:247], v4
    v_smfmac_f32_16x16x64_bf16 v[20:23], v[68:71], v[112:119], v4
    v_smfmac_f32_16x16x64_bf16 v[24:27], v[68:71], v[136:143], v4
    v_smfmac_f32_16x16x64_bf16 v[28:31], v[68:71], v[160:167], v4
    s_waitcnt lgkmcnt(8)
    v_smfmac_f32_16x16x64_bf16 v[16:19], v[72:75], a[248:255], v4
    v_smfmac_f32_16x16x64_bf16 v[20:23], v[72:75], v[120:127], v4
    v_smfmac_f32_16x16x64_bf16 v[24:27], v[72:75], v[144:151], v4
    v_smfmac_f32_16x16x64_bf16 v[28:31], v[72:75], v[168:175], v4
    s_waitcnt lgkmcnt(6)
    v_smfmac_f32_16x16x64_bf16 v[16:19], v[76:79], v[104:111], v4
    v_smfmac_f32_16x16x64_bf16 v[20:23], v[76:79], v[128:135], v4
    v_smfmac_f32_16x16x64_bf16 v[24:27], v[76:79], v[152:159], v4
    v_smfmac_f32_16x16x64_bf16 v[28:31], v[76:79], v[176:183], v4
    v_smfmac_f32_16x16x64_bf16 v[32:35], v[68:71], v[184:191], v4
    v_smfmac_f32_16x16x64_bf16 v[36:39], v[68:71], v[208:215], v4
    s_nop 4
    v_permlane32_swap_b32 v16, v24
    v_permlane32_swap_b32 v17, v25
    v_smfmac_f32_16x16x64_bf16 v[40:43], v[68:71], v[232:239], v4
    v_permlane32_swap_b32 v18, v26
    v_permlane32_swap_b32 v19, v27
    s_waitcnt lgkmcnt(4)
    v_smfmac_f32_16x16x64_bf16 v[44:47], v[68:71], v[80:87], v4
    v_add_f32 v16, v16, v24
    v_add_f32 v17, v17, v25
    ds_read_b128 v[80:83], v6 offset:6144
    ds_read_b128 v[84:87], v6 offset:7168
    v_smfmac_f32_16x16x64_bf16 v[32:35], v[72:75], v[192:199], v4
    v_add_f32 v18, v18, v26
    v_add_f32 v19, v19, v27
    v_smfmac_f32_16x16x64_bf16 v[36:39], v[72:75], v[216:223], v4
    v_permlane32_swap_b32 v20, v28
    v_permlane32_swap_b32 v21, v29
    v_smfmac_f32_16x16x64_bf16 v[40:43], v[72:75], v[240:247], v4
    v_permlane32_swap_b32 v22, v30
    v_permlane32_swap_b32 v23, v31
    s_waitcnt lgkmcnt(4)
    v_smfmac_f32_16x16x64_bf16 v[44:47], v[72:75], v[88:95], v4
    v_add_f32 v20, v20, v28
    v_add_f32 v21, v21, v29
    ds_read_b128 v[88:91], v6 offset:8192
    ds_read_b128 v[92:95], v6 offset:9216
    v_smfmac_f32_16x16x64_bf16 v[32:35], v[76:79], v[200:207], v4
    v_add_f32 v22, v22, v30
    v_add_f32 v23, v23, v31
    v_smfmac_f32_16x16x64_bf16 v[36:39], v[76:79], v[224:231], v4
    v_cvt_pk_bf16_f32 v56, v16, v17
    v_cvt_pk_bf16_f32 v57, v18, v19
    v_smfmac_f32_16x16x64_bf16 v[40:43], v[76:79], v[248:255], v4
    v_cvt_pk_bf16_f32 v58, v20, v21
    v_cvt_pk_bf16_f32 v59, v22, v23
    s_waitcnt lgkmcnt(4)
    v_smfmac_f32_16x16x64_bf16 v[44:47], v[76:79], v[96:103], v4
    v_permlane16_swap_b32 v56, v58
    ds_read_b128 v[96:99], v6 offset:10240
    ds_read_b128 v[100:103], v6 offset:11264
    v_permlane16_swap_b32 v57, v59
    v_min_u32 v56, -2, v56
    v_min_u32 v57, -2, v57
    v_min_u32 v58, -2, v58
    v_min_u32 v59, -2, v59
    buffer_store_dwordx4 v[56:59], v14, s[8:11], s43 offen sc1
    s_add_u32 s49, s43, 32768
    s_waitcnt lgkmcnt(4)
    v_smfmac_f32_16x16x64_bf16 v[48:51], v[68:71], v[80:87], v4
    v_permlane32_swap_b32 v32, v40
    v_permlane32_swap_b32 v33, v41
    v_permlane32_swap_b32 v34, v42
    ds_read_b128 v[80:83], v6 offset:12288
    ds_read_b128 v[84:87], v6 offset:13312
    s_waitcnt lgkmcnt(4)
    v_smfmac_f32_16x16x64_bf16 v[48:51], v[72:75], v[88:95], v4
    v_permlane32_swap_b32 v35, v43
    v_add_f32 v32, v32, v40
    v_add_f32 v33, v33, v41
    v_add_f32 v34, v34, v42
    ds_read_b128 v[88:91], v6 offset:14336
    ds_read_b128 v[92:95], v6 offset:15360
    s_waitcnt lgkmcnt(4)
    v_smfmac_f32_16x16x64_bf16 v[48:51], v[76:79], v[96:103], v4
    v_add_f32 v35, v35, v43
    v_permlane32_swap_b32 v36, v44
    v_permlane32_swap_b32 v37, v45
    v_permlane32_swap_b32 v38, v46
    ds_read_b128 v[96:99], v6 offset:16384
    ds_read_b128 v[100:103], v6 offset:17408
    v_permlane32_swap_b32 v39, v47
    v_add_f32 v36, v36, v44
    v_add_f32 v37, v37, v45
    v_add_f32 v38, v38, v46
    s_waitcnt lgkmcnt(4)
    v_smfmac_f32_16x16x64_bf16 v[52:55], v[68:71], v[80:87], v4
    v_add_f32 v39, v39, v47
    v_cvt_pk_bf16_f32 v60, v32, v33
    v_cvt_pk_bf16_f32 v61, v34, v35
    s_waitcnt lgkmcnt(2)
    v_smfmac_f32_16x16x64_bf16 v[52:55], v[72:75], v[88:95], v4
    v_cvt_pk_bf16_f32 v62, v36, v37
    v_cvt_pk_bf16_f32 v63, v38, v39
    s_waitcnt lgkmcnt(0)
    v_smfmac_f32_16x16x64_bf16 v[52:55], v[76:79], v[96:103], v4
    v_permlane16_swap_b32 v60, v62
    v_permlane16_swap_b32 v61, v63
    v_min_u32 v60, -2, v60
    v_min_u32 v61, -2, v61
    v_min_u32 v62, -2, v62
    v_min_u32 v63, -2, v63
    buffer_store_dwordx4 v[60:63], v14, s[8:11], s49 offen sc1
    s_nop 0
    v_permlane32_swap_b32 v48, v52
    v_permlane32_swap_b32 v49, v53
    v_permlane32_swap_b32 v50, v54
    v_permlane32_swap_b32 v51, v55
    v_add_f32 v48, v48, v52
    v_add_f32 v49, v49, v53
    v_add_f32 v50, v50, v54
    v_add_f32 v51, v51, v55
    v_cvt_pk_bf16_f32 v64, v48, v49
    v_cvt_pk_bf16_f32 v65, v50, v51
    v_mov_b32 v66, v64
    v_mov_b32 v67, v65
    s_nop 0
    v_permlane16_swap_b32 v64, v66
    v_permlane16_swap_b32 v65, v67
    v_min_u32 v64, -2, v64
    v_min_u32 v65, -2, v65
    v_min_u32 v66, -2, v66
    v_min_u32 v67, -2, v67
    buffer_store_dwordx4 v[64:67], v15, s[8:11], s43 offen sc1
    s_add_u32 s40, s40, 1
    s_add_u32 s43, s43, 458752
    s_add_u32 s47, s47, 458752
    s_add_u32 s45, s45, 458752
    s_cmp_lt_u32 s40, 64
    s_cbranch_scc1 interleave_layers__linear_attn_block__memory_aug_recurrent_mem_tr__prompt_kernel_v_stepw3
interleave_layers__linear_attn_block__memory_aug_recurrent_mem_tr__prompt_kernel_v_end:
    s_cmp_eq_u32 s92, 0
    s_cbranch_scc0 interleave_layers__linear_attn_block__memory_aug_recurrent_mem_tr__prompt_kernel_end
    s_mov_b32 s92, 1
    s_branch interleave_layers__linear_attn_block__memory_aug_recurrent_mem_tr__prompt_kernel_v_layer
interleave_layers__linear_attn_block__memory_aug_recurrent_mem_tr__prompt_kernel_roleR:
interleave_layers__linear_attn_block__memory_aug_recurrent_mem_tr__prompt_kernel_r_top:
    s_barrier
    s_sub_u32 s24, s2, 64
    s_cmp_ge_u32 s24, 24
    s_cbranch_scc1 interleave_layers__linear_attn_block__memory_aug_recurrent_mem_tr__prompt_kernel_rk22
    s_and_b32 s44, s24, 7
    s_lshr_b32 s45, s24, 3
    s_cmp_eq_u32 s92, 0
    s_cselect_b32 s46, 32, 2
    v_lshlrev_b32 v5, 4, v1
    s_mov_b32 s64, 12288
    s_cmp_eq_u32 s45, 1
    s_cselect_b32 s64, 5120, s64
    s_cmp_eq_u32 s45, 2
    s_cselect_b32 s64, 17408, s64
    s_mov_b32 s65, 1024
    s_cmp_eq_u32 s45, 1
    s_cselect_b32 s65, 7168, s65
    s_cmp_eq_u32 s45, 2
    s_cselect_b32 s65, 13312, s65
    s_mov_b32 s66, 0
    s_cmp_eq_u32 s45, 1
    s_cselect_b32 s66, 6144, s66
    s_cmp_eq_u32 s45, 2
    s_cselect_b32 s66, 14336, s66
    s_mov_b32 s67, 2048
    s_cmp_eq_u32 s45, 1
    s_cselect_b32 s67, 8192, s67
    s_cmp_eq_u32 s45, 2
    s_cselect_b32 s67, 15360, s67
    s_mov_b32 s68, 4096
    s_cmp_eq_u32 s45, 1
    s_cselect_b32 s68, 10240, s68
    s_cmp_eq_u32 s45, 2
    s_cselect_b32 s68, 16384, s68
    s_mov_b32 s69, 3072
    s_cmp_eq_u32 s45, 1
    s_cselect_b32 s69, 9216, s69
    s_cmp_eq_u32 s45, 2
    s_cselect_b32 s69, 16384, s69
    s_mov_b32 s70, 3072
    s_cmp_eq_u32 s45, 1
    s_cselect_b32 s70, 11264, s70
    s_cmp_eq_u32 s45, 2
    s_cselect_b32 s70, 16384, s70
    v_mov_b32 v16, 0
    v_mov_b32 v17, 0
    v_mov_b32 v18, 0
    v_mov_b32 v19, 0
    v_mov_b32 v20, 0
    v_mov_b32 v21, 0
    v_mov_b32 v22, 0
    v_mov_b32 v23, 0
    v_mov_b32 v24, 0
    v_mov_b32 v25, 0
    v_mov_b32 v26, 0
    v_mov_b32 v27, 0
    v_mov_b32 v28, 0
    v_mov_b32 v29, 0
    v_mov_b32 v30, 0
    v_mov_b32 v31, 0
    v_mov_b32 v32, 0
    v_mov_b32 v33, 0
    v_mov_b32 v34, 0
    v_mov_b32 v35, 0
    v_mov_b32 v36, 0
    v_mov_b32 v37, 0
    v_mov_b32 v38, 0
    v_mov_b32 v39, 0
    v_mov_b32 v40, 0
    v_mov_b32 v41, 0
    v_mov_b32 v42, 0
    v_mov_b32 v43, 0
    s_lshl_b32 s24, s92, 3
    s_add_u32 s24, s24, s44
    s_lshl_b32 s24, s24, 7
    s_add_u32 s24, s24, 23101440
    v_lshlrev_b32 v15, 2, v1
    v_add_u32 v15, s24, v15
    s_cmp_eq_u32 s92, 0
    s_cselect_b32 s26, -1, 3
    s_mov_b32 s61, 0
interleave_layers__linear_attn_block__memory_aug_recurrent_mem_tr__prompt_kernel_k2_w:
    buffer_load_dword v14, v15, s[8:11], 0 offen sc1
    s_waitcnt vmcnt(0)
    v_cmp_le_i32 vcc, 1, v14
    s_and_b32 s24, vcc_lo, s26
    s_cmp_eq_u32 s24, s26
    s_cbranch_scc1 interleave_layers__linear_attn_block__memory_aug_recurrent_mem_tr__prompt_kernel_k2_w_ok
    s_add_u32 s61, s61, 1
    s_cmp_ge_u32 s61, s60
    s_cbranch_scc1 interleave_layers__linear_attn_block__memory_aug_recurrent_mem_tr__prompt_kernel_k2_w_to
    s_sleep 2
    s_branch interleave_layers__linear_attn_block__memory_aug_recurrent_mem_tr__prompt_kernel_k2_w
interleave_layers__linear_attn_block__memory_aug_recurrent_mem_tr__prompt_kernel_k2_w_to:
    s_mov_b32 s60, 1
interleave_layers__linear_attn_block__memory_aug_recurrent_mem_tr__prompt_kernel_k2_w_ok:
    s_mov_b32 s40, s3
interleave_layers__linear_attn_block__memory_aug_recurrent_mem_tr__prompt_kernel_k2_rd:
    s_add_u32 s25, s40, 0
    s_mul_i32 s24, s25, 147456
    s_mul_i32 s26, s44, 18432
    s_add_u32 s24, s24, s26
    s_add_u32 s24, s24, 16777216
    s_cmp_lt_u32 s25, s46
    s_cselect_b32 s24, s24, 2146435072
    s_add_u32 s26, s24, s64
    buffer_load_dwordx4 v[48:51], v5, s[8:11], s26 offen sc1
    s_add_u32 s26, s24, s65
    buffer_load_dwordx4 v[52:55], v5, s[8:11], s26 offen sc1
    s_add_u32 s26, s24, s66
    buffer_load_dwordx4 v[56:59], v5, s[8:11], s26 offen sc1
    s_add_u32 s26, s24, s67
    buffer_load_dwordx4 v[60:63], v5, s[8:11], s26 offen sc1
    s_add_u32 s26, s24, s68
    buffer_load_dwordx4 v[64:67], v5, s[8:11], s26 offen sc1
    s_add_u32 s26, s24, s69
    buffer_load_dwordx4 v[68:71], v5, s[8:11], s26 offen sc1
    s_add_u32 s26, s24, s70
    buffer_load_dwordx4 v[72:75], v5, s[8:11], s26 offen sc1
    s_add_u32 s25, s40, 4
    s_mul_i32 s24, s25, 147456
    s_mul_i32 s26, s44, 18432
    s_add_u32 s24, s24, s26
    s_add_u32 s24, s24, 16777216
    s_cmp_lt_u32 s25, s46
    s_cselect_b32 s24, s24, 2146435072
    s_add_u32 s26, s24, s64
    buffer_load_dwordx4 v[76:79], v5, s[8:11], s26 offen sc1
    s_add_u32 s26, s24, s65
    buffer_load_dwordx4 v[80:83], v5, s[8:11], s26 offen sc1
    s_add_u32 s26, s24, s66
    buffer_load_dwordx4 v[84:87], v5, s[8:11], s26 offen sc1
    s_add_u32 s26, s24, s67
    buffer_load_dwordx4 v[88:91], v5, s[8:11], s26 offen sc1
    s_add_u32 s26, s24, s68
    buffer_load_dwordx4 v[92:95], v5, s[8:11], s26 offen sc1
    s_add_u32 s26, s24, s69
    buffer_load_dwordx4 v[96:99], v5, s[8:11], s26 offen sc1
    s_add_u32 s26, s24, s70
    buffer_load_dwordx4 v[100:103], v5, s[8:11], s26 offen sc1
    s_add_u32 s25, s40, 8
    s_mul_i32 s24, s25, 147456
    s_mul_i32 s26, s44, 18432
    s_add_u32 s24, s24, s26
    s_add_u32 s24, s24, 16777216
    s_cmp_lt_u32 s25, s46
    s_cselect_b32 s24, s24, 2146435072
    s_add_u32 s26, s24, s64
    buffer_load_dwordx4 v[104:107], v5, s[8:11], s26 offen sc1
    s_add_u32 s26, s24, s65
    buffer_load_dwordx4 v[108:111], v5, s[8:11], s26 offen sc1
    s_add_u32 s26, s24, s66
    buffer_load_dwordx4 v[112:115], v5, s[8:11], s26 offen sc1
    s_add_u32 s26, s24, s67
    buffer_load_dwordx4 v[116:119], v5, s[8:11], s26 offen sc1
    s_add_u32 s26, s24, s68
    buffer_load_dwordx4 v[120:123], v5, s[8:11], s26 offen sc1
    s_add_u32 s26, s24, s69
    buffer_load_dwordx4 v[124:127], v5, s[8:11], s26 offen sc1
    s_add_u32 s26, s24, s70
    buffer_load_dwordx4 v[128:131], v5, s[8:11], s26 offen sc1
    s_add_u32 s25, s40, 12
    s_mul_i32 s24, s25, 147456
    s_mul_i32 s26, s44, 18432
    s_add_u32 s24, s24, s26
    s_add_u32 s24, s24, 16777216
    s_cmp_lt_u32 s25, s46
    s_cselect_b32 s24, s24, 2146435072
    s_add_u32 s26, s24, s64
    buffer_load_dwordx4 v[132:135], v5, s[8:11], s26 offen sc1
    s_add_u32 s26, s24, s65
    buffer_load_dwordx4 v[136:139], v5, s[8:11], s26 offen sc1
    s_add_u32 s26, s24, s66
    buffer_load_dwordx4 v[140:143], v5, s[8:11], s26 offen sc1
    s_add_u32 s26, s24, s67
    buffer_load_dwordx4 v[144:147], v5, s[8:11], s26 offen sc1
    s_add_u32 s26, s24, s68
    buffer_load_dwordx4 v[148:151], v5, s[8:11], s26 offen sc1
    s_add_u32 s26, s24, s69
    buffer_load_dwordx4 v[152:155], v5, s[8:11], s26 offen sc1
    s_add_u32 s26, s24, s70
    buffer_load_dwordx4 v[156:159], v5, s[8:11], s26 offen sc1
    s_add_u32 s40, s40, 16
    s_cmp_lt_u32 s40, s46
    s_cbranch_scc0 interleave_layers__linear_attn_block__memory_aug_recurrent_mem_tr__prompt_kernel_k2m23
    s_waitcnt vmcnt(21)
    v_pk_add_f32 v[16:17], v[16:17], v[48:49]
    v_pk_add_f32 v[18:19], v[18:19], v[50:51]
    v_pk_add_f32 v[20:21], v[20:21], v[52:53]
    v_pk_add_f32 v[22:23], v[22:23], v[54:55]
    v_pk_add_f32 v[24:25], v[24:25], v[56:57]
    v_pk_add_f32 v[26:27], v[26:27], v[58:59]
    v_pk_add_f32 v[28:29], v[28:29], v[60:61]
    v_pk_add_f32 v[30:31], v[30:31], v[62:63]
    v_pk_add_f32 v[32:33], v[32:33], v[64:65]
    v_pk_add_f32 v[34:35], v[34:35], v[66:67]
    v_pk_add_f32 v[36:37], v[36:37], v[68:69]
    v_pk_add_f32 v[38:39], v[38:39], v[70:71]
    v_pk_add_f32 v[40:41], v[40:41], v[72:73]
    v_pk_add_f32 v[42:43], v[42:43], v[74:75]
    s_waitcnt vmcnt(14)
    v_pk_add_f32 v[16:17], v[16:17], v[76:77]
    v_pk_add_f32 v[18:19], v[18:19], v[78:79]
    v_pk_add_f32 v[20:21], v[20:21], v[80:81]
    v_pk_add_f32 v[22:23], v[22:23], v[82:83]
    v_pk_add_f32 v[24:25], v[24:25], v[84:85]
    v_pk_add_f32 v[26:27], v[26:27], v[86:87]
    v_pk_add_f32 v[28:29], v[28:29], v[88:89]
    v_pk_add_f32 v[30:31], v[30:31], v[90:91]
    v_pk_add_f32 v[32:33], v[32:33], v[92:93]
    v_pk_add_f32 v[34:35], v[34:35], v[94:95]
    v_pk_add_f32 v[36:37], v[36:37], v[96:97]
    v_pk_add_f32 v[38:39], v[38:39], v[98:99]
    v_pk_add_f32 v[40:41], v[40:41], v[100:101]
    v_pk_add_f32 v[42:43], v[42:43], v[102:103]
    s_waitcnt vmcnt(7)
    v_pk_add_f32 v[16:17], v[16:17], v[104:105]
    v_pk_add_f32 v[18:19], v[18:19], v[106:107]
    v_pk_add_f32 v[20:21], v[20:21], v[108:109]
    v_pk_add_f32 v[22:23], v[22:23], v[110:111]
    v_pk_add_f32 v[24:25], v[24:25], v[112:113]
    v_pk_add_f32 v[26:27], v[26:27], v[114:115]
    v_pk_add_f32 v[28:29], v[28:29], v[116:117]
    v_pk_add_f32 v[30:31], v[30:31], v[118:119]
    v_pk_add_f32 v[32:33], v[32:33], v[120:121]
    v_pk_add_f32 v[34:35], v[34:35], v[122:123]
    v_pk_add_f32 v[36:37], v[36:37], v[124:125]
    v_pk_add_f32 v[38:39], v[38:39], v[126:127]
    v_pk_add_f32 v[40:41], v[40:41], v[128:129]
    v_pk_add_f32 v[42:43], v[42:43], v[130:131]
    s_waitcnt vmcnt(0)
    v_pk_add_f32 v[16:17], v[16:17], v[132:133]
    v_pk_add_f32 v[18:19], v[18:19], v[134:135]
    v_pk_add_f32 v[20:21], v[20:21], v[136:137]
    v_pk_add_f32 v[22:23], v[22:23], v[138:139]
    v_pk_add_f32 v[24:25], v[24:25], v[140:141]
    v_pk_add_f32 v[26:27], v[26:27], v[142:143]
    v_pk_add_f32 v[28:29], v[28:29], v[144:145]
    v_pk_add_f32 v[30:31], v[30:31], v[146:147]
    v_pk_add_f32 v[32:33], v[32:33], v[148:149]
    v_pk_add_f32 v[34:35], v[34:35], v[150:151]
    v_pk_add_f32 v[36:37], v[36:37], v[152:153]
    v_pk_add_f32 v[38:39], v[38:39], v[154:155]
    v_pk_add_f32 v[40:41], v[40:41], v[156:157]
    v_pk_add_f32 v[42:43], v[42:43], v[158:159]
    s_branch interleave_layers__linear_attn_block__memory_aug_recurrent_mem_tr__prompt_kernel_k2_rd
interleave_layers__linear_attn_block__memory_aug_recurrent_mem_tr__prompt_kernel_k2m23:
    s_waitcnt vmcnt(21)
    v_pk_add_f32 v[16:17], v[16:17], v[48:49]
    v_pk_add_f32 v[18:19], v[18:19], v[50:51]
    v_pk_add_f32 v[20:21], v[20:21], v[52:53]
    v_pk_add_f32 v[22:23], v[22:23], v[54:55]
    v_pk_add_f32 v[24:25], v[24:25], v[56:57]
    v_pk_add_f32 v[26:27], v[26:27], v[58:59]
    v_pk_add_f32 v[28:29], v[28:29], v[60:61]
    v_pk_add_f32 v[30:31], v[30:31], v[62:63]
    v_pk_add_f32 v[32:33], v[32:33], v[64:65]
    v_pk_add_f32 v[34:35], v[34:35], v[66:67]
    v_pk_add_f32 v[36:37], v[36:37], v[68:69]
    v_pk_add_f32 v[38:39], v[38:39], v[70:71]
    v_pk_add_f32 v[40:41], v[40:41], v[72:73]
    v_pk_add_f32 v[42:43], v[42:43], v[74:75]
    s_waitcnt vmcnt(14)
    v_pk_add_f32 v[16:17], v[16:17], v[76:77]
    v_pk_add_f32 v[18:19], v[18:19], v[78:79]
    v_pk_add_f32 v[20:21], v[20:21], v[80:81]
    v_pk_add_f32 v[22:23], v[22:23], v[82:83]
    v_pk_add_f32 v[24:25], v[24:25], v[84:85]
    v_pk_add_f32 v[26:27], v[26:27], v[86:87]
    v_pk_add_f32 v[28:29], v[28:29], v[88:89]
    v_pk_add_f32 v[30:31], v[30:31], v[90:91]
    v_pk_add_f32 v[32:33], v[32:33], v[92:93]
    v_pk_add_f32 v[34:35], v[34:35], v[94:95]
    v_pk_add_f32 v[36:37], v[36:37], v[96:97]
    v_pk_add_f32 v[38:39], v[38:39], v[98:99]
    v_pk_add_f32 v[40:41], v[40:41], v[100:101]
    v_pk_add_f32 v[42:43], v[42:43], v[102:103]
    s_waitcnt vmcnt(7)
    v_pk_add_f32 v[16:17], v[16:17], v[104:105]
    v_pk_add_f32 v[18:19], v[18:19], v[106:107]
    v_pk_add_f32 v[20:21], v[20:21], v[108:109]
    v_pk_add_f32 v[22:23], v[22:23], v[110:111]
    v_pk_add_f32 v[24:25], v[24:25], v[112:113]
    v_pk_add_f32 v[26:27], v[26:27], v[114:115]
    v_pk_add_f32 v[28:29], v[28:29], v[116:117]
    v_pk_add_f32 v[30:31], v[30:31], v[118:119]
    v_pk_add_f32 v[32:33], v[32:33], v[120:121]
    v_pk_add_f32 v[34:35], v[34:35], v[122:123]
    v_pk_add_f32 v[36:37], v[36:37], v[124:125]
    v_pk_add_f32 v[38:39], v[38:39], v[126:127]
    v_pk_add_f32 v[40:41], v[40:41], v[128:129]
    v_pk_add_f32 v[42:43], v[42:43], v[130:131]
    s_waitcnt vmcnt(0)
    v_pk_add_f32 v[16:17], v[16:17], v[132:133]
    v_pk_add_f32 v[18:19], v[18:19], v[134:135]
    v_pk_add_f32 v[20:21], v[20:21], v[136:137]
    v_pk_add_f32 v[22:23], v[22:23], v[138:139]
    v_pk_add_f32 v[24:25], v[24:25], v[140:141]
    v_pk_add_f32 v[26:27], v[26:27], v[142:143]
    v_pk_add_f32 v[28:29], v[28:29], v[144:145]
    v_pk_add_f32 v[30:31], v[30:31], v[146:147]
    v_pk_add_f32 v[32:33], v[32:33], v[148:149]
    v_pk_add_f32 v[34:35], v[34:35], v[150:151]
    v_pk_add_f32 v[36:37], v[36:37], v[152:153]
    v_pk_add_f32 v[38:39], v[38:39], v[154:155]
    v_pk_add_f32 v[40:41], v[40:41], v[156:157]
    v_pk_add_f32 v[42:43], v[42:43], v[158:159]
    s_mul_i32 s24, s3, 7168
    v_add_u32 v6, s24, v5
    ds_write_b128 v6, v[16:19] offset:0
    ds_write_b128 v6, v[20:23] offset:1024
    ds_write_b128 v6, v[24:27] offset:2048
    ds_write_b128 v6, v[28:31] offset:3072
    ds_write_b128 v6, v[32:35] offset:4096
    ds_write_b128 v6, v[36:39] offset:5120
    ds_write_b128 v6, v[40:43] offset:6144
    s_waitcnt lgkmcnt(0)
    s_barrier
    s_mov_b32 s41, 0
    s_cmp_eq_u32 s45, 1
    s_cselect_b32 s41, 4, s41
    s_cmp_eq_u32 s45, 2
    s_cselect_b32 s41, 9, s41
    s_mov_b32 s42, 4
    s_cmp_eq_u32 s45, 1
    s_cselect_b32 s42, 5, s42
    s_cmp_eq_u32 s45, 2
    s_cselect_b32 s42, 5, s42
    s_mul_i32 s43, s92, 131072
    s_mul_i32 s24, s44, 14336
    s_add_u32 s43, s43, s24
    s_add_u32 s43, s43, 22020096
    v_and_b32 v7, 3, v2
    v_lshrrev_b32 v8, 2, v2
    s_add_u32 s40, s3, 0
    s_cmp_lt_u32 s40, s42
    s_cbranch_scc0 interleave_layers__linear_attn_block__memory_aug_recurrent_mem_tr__prompt_kernel_k2f24
    s_add_u32 s40, s40, s41
    s_mov_b32 s47, 67633672
    s_cmp_eq_u32 s40, 1
    s_cselect_b32 s47, 67699226, s47
    s_cmp_eq_u32 s40, 2
    s_cselect_b32 s47, 67702404, s47
    s_cmp_eq_u32 s40, 3
    s_cselect_b32 s47, 67765224, s47
    s_cmp_eq_u32 s40, 4
    s_cselect_b32 s47, 67765896, s47
    s_cmp_eq_u32 s40, 5
    s_cselect_b32 s47, 67831450, s47
    s_cmp_eq_u32 s40, 6
    s_cselect_b32 s47, 67833604, s47
    s_cmp_eq_u32 s40, 7
    s_cselect_b32 s47, 67897320, s47
    s_cmp_eq_u32 s40, 8
    s_cselect_b32 s47, 67899142, s47
    s_cmp_eq_u32 s40, 9
    s_cselect_b32 s47, 75497992, s47
    s_cmp_eq_u32 s40, 10
    s_cselect_b32 s47, 75499162, s47
    s_cmp_eq_u32 s40, 11
    s_cselect_b32 s47, 75501316, s47
    s_cmp_eq_u32 s40, 12
    s_cselect_b32 s47, 247768, s47
    s_cmp_eq_u32 s40, 13
    s_cselect_b32 s47, 249604, s47
    s_bfe_u32 s24, s47, 0x7000c
    s_bfe_u32 s25, s47, 0x50013
    s_bfe_u32 s26, s47, 0x30018
    v_mul_u32_u24 v9, s25, v7
    v_mul_u32_u24 v10, s26, v8
    v_add3_u32 v9, v9, v10, s24
    v_mul_u32_u24 v9, 205, v9
    v_lshrrev_b32 v9, 12, v9
    s_bfe_u32 s24, s47, 196608
    s_lshl_b32 s24, s24, 10
    v_add_u32 v10, s24, v5
    ds_read_b128 v[160:163], v10 offset:0
    ds_read_b128 v[164:167], v10 offset:7168
    ds_read_b128 v[168:171], v10 offset:14336
    ds_read_b128 v[172:175], v10 offset:21504
    s_bfe_u32 s25, s47, 196614
    s_lshl_b32 s25, s25, 4
    v_lshl_add_u32 v11, v3, 2, s25
    v_mul_u32_u24 v11, 205, v11
    v_lshrrev_b32 v11, 12, v11
    v_cmp_eq_u32 vcc, v9, v11
    s_waitcnt lgkmcnt(0)
    v_pk_add_f32 v[160:161], v[160:161], v[164:165]
    v_pk_add_f32 v[168:169], v[168:169], v[172:173]
    v_pk_add_f32 v[162:163], v[162:163], v[166:167]
    v_pk_add_f32 v[170:171], v[170:171], v[174:175]
    v_pk_add_f32 v[160:161], v[160:161], v[168:169]
    v_pk_add_f32 v[162:163], v[162:163], v[170:171]
    v_cvt_pk_bf16_f32 v176, v160, v161
    v_cvt_pk_bf16_f32 v177, v162, v163
    v_cndmask_b32 v176, 0, v176, vcc
    v_cndmask_b32 v177, 0, v177, vcc
    s_bfe_u32 s24, s47, 196611
    s_lshl_b32 s24, s24, 10
    v_add_u32 v10, s24, v5
    ds_read_b128 v[160:163], v10 offset:0
    ds_read_b128 v[164:167], v10 offset:7168
    ds_read_b128 v[168:171], v10 offset:14336
    ds_read_b128 v[172:175], v10 offset:21504
    s_bfe_u32 s25, s47, 196617
    s_lshl_b32 s25, s25, 4
    v_lshl_add_u32 v11, v3, 2, s25
    v_mul_u32_u24 v11, 205, v11
    v_lshrrev_b32 v11, 12, v11
    v_cmp_eq_u32 vcc, v9, v11
    s_waitcnt lgkmcnt(0)
    v_pk_add_f32 v[160:161], v[160:161], v[164:165]
    v_pk_add_f32 v[168:169], v[168:169], v[172:173]
    v_pk_add_f32 v[162:163], v[162:163], v[166:167]
    v_pk_add_f32 v[170:171], v[170:171], v[174:175]
    v_pk_add_f32 v[160:161], v[160:161], v[168:169]
    v_pk_add_f32 v[162:163], v[162:163], v[170:171]
    v_cvt_pk_bf16_f32 v178, v160, v161
    v_cvt_pk_bf16_f32 v179, v162, v163
    v_cndmask_b32 v178, 0, v178, vcc
    v_cndmask_b32 v179, 0, v179, vcc
    s_lshl_b32 s24, s40, 10
    s_add_u32 s24, s24, s43
    buffer_store_dwordx4 v[176:179], v5, s[8:11], s24 offen sc1
interleave_layers__linear_attn_block__memory_aug_recurrent_mem_tr__prompt_kernel_k2f24:
    s_add_u32 s40, s3, 4
    s_cmp_lt_u32 s40, s42
    s_cbranch_scc0 interleave_layers__linear_attn_block__memory_aug_recurrent_mem_tr__prompt_kernel_k2f25
    s_add_u32 s40, s40, s41
    s_mov_b32 s47, 67633672
    s_cmp_eq_u32 s40, 1
    s_cselect_b32 s47, 67699226, s47
    s_cmp_eq_u32 s40, 2
    s_cselect_b32 s47, 67702404, s47
    s_cmp_eq_u32 s40, 3
    s_cselect_b32 s47, 67765224, s47
    s_cmp_eq_u32 s40, 4
    s_cselect_b32 s47, 67765896, s47
    s_cmp_eq_u32 s40, 5
    s_cselect_b32 s47, 67831450, s47
    s_cmp_eq_u32 s40, 6
    s_cselect_b32 s47, 67833604, s47
    s_cmp_eq_u32 s40, 7
    s_cselect_b32 s47, 67897320, s47
    s_cmp_eq_u32 s40, 8
    s_cselect_b32 s47, 67899142, s47
    s_cmp_eq_u32 s40, 9
    s_cselect_b32 s47, 75497992, s47
    s_cmp_eq_u32 s40, 10
    s_cselect_b32 s47, 75499162, s47
    s_cmp_eq_u32 s40, 11
    s_cselect_b32 s47, 75501316, s47
    s_cmp_eq_u32 s40, 12
    s_cselect_b32 s47, 247768, s47
    s_cmp_eq_u32 s40, 13
    s_cselect_b32 s47, 249604, s47
    s_bfe_u32 s24, s47, 0x7000c
    s_bfe_u32 s25, s47, 0x50013
    s_bfe_u32 s26, s47, 0x30018
    v_mul_u32_u24 v9, s25, v7
    v_mul_u32_u24 v10, s26, v8
    v_add3_u32 v9, v9, v10, s24
    v_mul_u32_u24 v9, 205, v9
    v_lshrrev_b32 v9, 12, v9
    s_bfe_u32 s24, s47, 196608
    s_lshl_b32 s24, s24, 10
    v_add_u32 v10, s24, v5
    ds_read_b128 v[160:163], v10 offset:0
    ds_read_b128 v[164:167], v10 offset:7168
    ds_read_b128 v[168:171], v10 offset:14336
    ds_read_b128 v[172:175], v10 offset:21504
    s_bfe_u32 s25, s47, 196614
    s_lshl_b32 s25, s25, 4
    v_lshl_add_u32 v11, v3, 2, s25
    v_mul_u32_u24 v11, 205, v11
    v_lshrrev_b32 v11, 12, v11
    v_cmp_eq_u32 vcc, v9, v11
    s_waitcnt lgkmcnt(0)
    v_pk_add_f32 v[160:161], v[160:161], v[164:165]
    v_pk_add_f32 v[168:169], v[168:169], v[172:173]
    v_pk_add_f32 v[162:163], v[162:163], v[166:167]
    v_pk_add_f32 v[170:171], v[170:171], v[174:175]
    v_pk_add_f32 v[160:161], v[160:161], v[168:169]
    v_pk_add_f32 v[162:163], v[162:163], v[170:171]
    v_cvt_pk_bf16_f32 v176, v160, v161
    v_cvt_pk_bf16_f32 v177, v162, v163
    v_cndmask_b32 v176, 0, v176, vcc
    v_cndmask_b32 v177, 0, v177, vcc
    s_bfe_u32 s24, s47, 196611
    s_lshl_b32 s24, s24, 10
    v_add_u32 v10, s24, v5
    ds_read_b128 v[160:163], v10 offset:0
    ds_read_b128 v[164:167], v10 offset:7168
    ds_read_b128 v[168:171], v10 offset:14336
    ds_read_b128 v[172:175], v10 offset:21504
    s_bfe_u32 s25, s47, 196617
    s_lshl_b32 s25, s25, 4
    v_lshl_add_u32 v11, v3, 2, s25
    v_mul_u32_u24 v11, 205, v11
    v_lshrrev_b32 v11, 12, v11
    v_cmp_eq_u32 vcc, v9, v11
    s_waitcnt lgkmcnt(0)
    v_pk_add_f32 v[160:161], v[160:161], v[164:165]
    v_pk_add_f32 v[168:169], v[168:169], v[172:173]
    v_pk_add_f32 v[162:163], v[162:163], v[166:167]
    v_pk_add_f32 v[170:171], v[170:171], v[174:175]
    v_pk_add_f32 v[160:161], v[160:161], v[168:169]
    v_pk_add_f32 v[162:163], v[162:163], v[170:171]
    v_cvt_pk_bf16_f32 v178, v160, v161
    v_cvt_pk_bf16_f32 v179, v162, v163
    v_cndmask_b32 v178, 0, v178, vcc
    v_cndmask_b32 v179, 0, v179, vcc
    s_lshl_b32 s24, s40, 10
    s_add_u32 s24, s24, s43
    buffer_store_dwordx4 v[176:179], v5, s[8:11], s24 offen sc1
interleave_layers__linear_attn_block__memory_aug_recurrent_mem_tr__prompt_kernel_k2f25:
    s_waitcnt vmcnt(0)
    s_barrier
    s_lshl_b32 s24, s92, 7
    s_sub_u32 s25, s2, 64
    s_lshl_b32 s25, s25, 2
    s_add_u32 s24, s24, s25
    s_add_u32 s24, s24, 23103488
    s_cmp_eq_u32 s3, 0
    s_cbranch_scc0 interleave_layers__linear_attn_block__memory_aug_recurrent_mem_tr__prompt_kernel_pb26
    v_lshlrev_b32 v14, 7, v1
    v_add_u32 v14, s24, v14
    v_mov_b32 v15, 2146435072
    v_cmp_le_u32 vcc, 1, v1
    s_nop 1
    v_cndmask_b32 v14, v14, v15, vcc
    v_mov_b32 v15, 1
    buffer_store_dword v15, v14, s[8:11], 0 offen sc1
interleave_layers__linear_attn_block__memory_aug_recurrent_mem_tr__prompt_kernel_pb26:
interleave_layers__linear_attn_block__memory_aug_recurrent_mem_tr__prompt_kernel_rk22:
    s_sub_u32 s44, s2, 64
    v_lshlrev_b32 v5, 4, v1
    s_lshl_b32 s24, s44, 15
    s_lshl_b32 s25, s3, 13
    s_add_u32 s24, s24, s25
    v_add_u32 v6, s24, v5
    v_add_u32 v7, 4096, v6
    s_lshl_b32 s24, s3, 12
    v_add_u32 v8, s24, v5
    s_lshl_b32 s24, s3, 10
    s_add_u32 s24, s24, 16384
    v_add_u32 v9, s24, v5
    s_lshl_b32 s24, s44, 13
    s_lshl_b32 s25, s3, 11
    s_add_u32 s24, s24, s25
    v_add_u32 v10, s24, v5
    v_and_b32 v204, 7, v2
    v_mul_u32_u24 v11, 80, v204
    v_lshl_add_u32 v11, v3, 4, v11
    s_mul_i32 s24, s3, 640
    v_add_u32 v11, s24, v11
    v_add_u32 v204, 8192, v5
    v_cmp_gt_u32 vcc, 8, v2
    s_nop 1
    v_cndmask_b32 v11, v204, v11, vcc
    v_and_b32 v204, 7, v2
    v_mul_u32_u24 v12, 80, v204
    v_lshrrev_b32 v204, 3, v2
    v_lshl_add_u32 v12, v204, 5, v12
    v_lshlrev_b32 v13, 4, v2
    s_lshl_b32 s24, s44, 8
    v_add_u32 v13, s24, v13
    v_mov_b32 v204, 2146435072
    v_cmp_gt_u32 vcc, 1, v3
    s_nop 1
    v_cndmask_b32 v13, v204, v13, vcc
    v_cmp_le_u32 s[50:51], 8, v2
    s_and_b32 s25, s44, 15
    s_lshr_b32 s25, s25, 2
    s_sub_u32 s26, s44, 32
    s_lshr_b32 s26, s26, 1
    s_cmp_ge_u32 s44, 32
    s_cselect_b32 s25, s26, s25
    s_mul_i32 s24, s25, 16
    v_add_u32 v120, s24, v1
    v_lshlrev_b32 v120, 7, v120
    v_mov_b32 v204, 2146435072
    v_cmp_le_u32 vcc, 16, v1
    s_nop 1
    v_cndmask_b32 v120, v120, v204, vcc
    s_and_b32 s24, s44, 7
    s_mul_i32 s25, s3, 8
    s_add_u32 s24, s24, s25
    s_lshl_b32 s24, s24, 7
    v_mov_b32 v125, s24
    v_mov_b32 v122, 12288
    v_mov_b32 v123, 0
    s_barrier
    ds_write_b32 v122, v123
    v_mov_b32 v123, 1
    s_waitcnt lgkmcnt(0)
    s_barrier
    s_mul_i32 s93, s92, 29360128
    s_add_u32 s93, s93, 117440512
    s_mul_i32 s94, s92, 16384
    s_add_u32 s94, s94, 23068672
    s_mov_b32 s40, 0
    s_mov_b32 s41, 184549376
    s_add_u32 s45, s93, 448512
    s_add_u32 s46, s93, 440320
    s_add_u32 s43, s93, 409600
    s_add_u32 s42, s93, 0
    s_add_u32 s47, s93, 430080
    v_and_b32 v252, 7, v1
    v_lshlrev_b32 v252, 7, v252
    s_lshl_b32 s24, s3, 10
    s_add_u32 s24, s24, 12288
    s_add_u32 s24, s24, s94
    v_add_u32 v252, s24, v252
    s_mov_b32 s62, -1
    s_mov_b32 s63, 1
    s_cmp_ge_i32 s62, s63
    s_cbranch_scc1 interleave_layers__linear_attn_block__memory_aug_recurrent_mem_tr__prompt_kernel_r_en0_ok
    s_mov_b32 s61, 0
interleave_layers__linear_attn_block__memory_aug_recurrent_mem_tr__prompt_kernel_r_en0:
    buffer_load_dword v253, v252, s[8:11], 0 offen sc1
    s_waitcnt vmcnt(0)
    v_readlane_b32 s62, v253, 0
    v_readlane_b32 s24, v253, 1
    s_min_i32 s62, s62, s24
    v_readlane_b32 s24, v253, 2
    s_min_i32 s62, s62, s24
    v_readlane_b32 s24, v253, 3
    s_min_i32 s62, s62, s24
    v_readlane_b32 s24, v253, 4
    s_min_i32 s62, s62, s24
    v_readlane_b32 s24, v253, 5
    s_min_i32 s62, s62, s24
    v_readlane_b32 s24, v253, 6
    s_min_i32 s62, s62, s24
    v_readlane_b32 s24, v253, 7
    s_min_i32 s62, s62, s24
    s_cmp_ge_i32 s62, s63
    s_cbranch_scc1 interleave_layers__linear_attn_block__memory_aug_recurrent_mem_tr__prompt_kernel_r_en0_ok
    s_add_u32 s61, s61, 1
    s_cmp_ge_u32 s61, s60
    s_cbranch_scc1 interleave_layers__linear_attn_block__memory_aug_recurrent_mem_tr__prompt_kernel_r_en0_to
    s_sleep 2
    s_branch interleave_layers__linear_attn_block__memory_aug_recurrent_mem_tr__prompt_kernel_r_en0
interleave_layers__linear_attn_block__memory_aug_recurrent_mem_tr__prompt_kernel_r_en0_to:
    s_mov_b32 s60, 1
interleave_layers__linear_attn_block__memory_aug_recurrent_mem_tr__prompt_kernel_r_en0_ok:
    buffer_load_dwordx4 v[48:51], v6, s[8:11], s41 offen offset:0 sc1
    buffer_load_dwordx4 v[52:55], v6, s[8:11], s41 offen offset:1024 sc1
    buffer_load_dwordx4 v[56:59], v6, s[8:11], s41 offen offset:2048 sc1
    buffer_load_dwordx4 v[60:63], v6, s[8:11], s41 offen offset:3072 sc1
    buffer_load_dwordx4 v[64:67], v7, s[8:11], s41 offen offset:0 sc1
    buffer_load_dwordx4 v[68:71], v7, s[8:11], s41 offen offset:1024 sc1
    buffer_load_dwordx4 v[72:75], v7, s[8:11], s41 offen offset:2048 sc1
    buffer_load_dwordx4 v[76:79], v7, s[8:11], s41 offen offset:3072 sc1
    s_add_u32 s41, s41, 1310720
interleave_layers__linear_attn_block__memory_aug_recurrent_mem_tr__prompt_kernel_r_step:
    s_waitcnt vmcnt(0)
    v_mov_b32 v16, v48
    v_mov_b32 v17, v49
    v_mov_b32 v18, v50
    v_mov_b32 v19, v51
    v_mov_b32 v20, v52
    v_mov_b32 v21, v53
    v_mov_b32 v22, v54
    v_mov_b32 v23, v55
    v_mov_b32 v24, v56
    v_mov_b32 v25, v57
    v_mov_b32 v26, v58
    v_mov_b32 v27, v59
    v_mov_b32 v28, v60
    v_mov_b32 v29, v61
    v_mov_b32 v30, v62
    v_mov_b32 v31, v63
    v_mov_b32 v32, v64
    v_mov_b32 v33, v65
    v_mov_b32 v34, v66
    v_mov_b32 v35, v67
    v_mov_b32 v36, v68
    v_mov_b32 v37, v69
    v_mov_b32 v38, v70
    v_mov_b32 v39, v71
    v_mov_b32 v40, v72
    v_mov_b32 v41, v73
    v_mov_b32 v42, v74
    v_mov_b32 v43, v75
    v_mov_b32 v44, v76
    v_mov_b32 v45, v77
    v_mov_b32 v46, v78
    v_mov_b32 v47, v79
    s_lshl_b32 s95, s92, 6
    s_add_u32 s95, s95, s40
    s_add_u32 s95, s95, 1
    s_cmp_ge_i32 s59, s95
    s_cbranch_scc1 interleave_layers__linear_attn_block__memory_aug_recurrent_mem_tr__prompt_kernel_r_ec_ok
    s_and_b32 s24, s2, 7
    s_lshl_b32 s24, s24, 7
    s_add_u32 s24, s24, 23109632
    v_and_b32 v254, 3, v1
    v_lshl_add_u32 v254, v254, 2, s24
    s_mov_b32 s61, 0
interleave_layers__linear_attn_block__memory_aug_recurrent_mem_tr__prompt_kernel_r_ec:
    buffer_load_dword v253, v254, s[8:11], 0 offen sc1
    s_waitcnt vmcnt(0)
    v_readlane_b32 s59, v253, 0
    v_readlane_b32 s24, v253, 1
    s_min_i32 s59, s59, s24
    v_readlane_b32 s24, v253, 2
    s_min_i32 s59, s59, s24
    s_cmp_ge_i32 s59, s95
    s_cbranch_scc1 interleave_layers__linear_attn_block__memory_aug_recurrent_mem_tr__prompt_kernel_r_ec_ok
    s_add_u32 s61, s61, 1
    s_cmp_ge_u32 s61, s60
    s_cbranch_scc1 interleave_layers__linear_attn_block__memory_aug_recurrent_mem_tr__prompt_kernel_r_ec_to
    s_sleep 2
    s_branch interleave_layers__linear_attn_block__memory_aug_recurrent_mem_tr__prompt_kernel_r_ec
interleave_layers__linear_attn_block__memory_aug_recurrent_mem_tr__prompt_kernel_r_ec_to:
    s_mov_b32 s60, 1
interleave_layers__linear_attn_block__memory_aug_recurrent_mem_tr__prompt_kernel_r_ec_ok:
    s_mov_b64 exec, 1
    s_mov_b32 s61, 0
    v_mov_b32 v117, 0
    buffer_atomic_add v117, v125, s[8:11], s45 offen sc0
    s_sleep 2
    v_mov_b32 v118, 0
    buffer_atomic_add v118, v125, s[8:11], s45 offen sc0
    s_sleep 2
    v_mov_b32 v119, 0
    buffer_atomic_add v119, v125, s[8:11], s45 offen sc0
    s_sleep 2
interleave_layers__linear_attn_block__memory_aug_recurrent_mem_tr__prompt_kernel_r_pr:
    v_mov_b32 v116, 0
    buffer_atomic_add v116, v125, s[8:11], s45 offen sc0
    s_waitcnt vmcnt(3)
    v_cmp_le_i32 vcc, 7, v117
    s_add_u32 s61, s61, 1
    s_cbranch_vccnz interleave_layers__linear_attn_block__memory_aug_recurrent_mem_tr__prompt_kernel_r_pr_out
    s_sleep 2
    v_mov_b32 v117, 0
    buffer_atomic_add v117, v125, s[8:11], s45 offen sc0
    s_waitcnt vmcnt(3)
    v_cmp_le_i32 vcc, 7, v118
    s_add_u32 s61, s61, 1
    s_cbranch_vccnz interleave_layers__linear_attn_block__memory_aug_recurrent_mem_tr__prompt_kernel_r_pr_out
    s_sleep 2
    v_mov_b32 v118, 0
    buffer_atomic_add v118, v125, s[8:11], s45 offen sc0
    s_waitcnt vmcnt(3)
    v_cmp_le_i32 vcc, 7, v119
    s_add_u32 s61, s61, 1
    s_cbranch_vccnz interleave_layers__linear_attn_block__memory_aug_recurrent_mem_tr__prompt_kernel_r_pr_out
    s_sleep 2
    v_mov_b32 v119, 0
    buffer_atomic_add v119, v125, s[8:11], s45 offen sc0
    s_waitcnt vmcnt(3)
    v_cmp_le_i32 vcc, 7, v116
    s_add_u32 s61, s61, 1
    s_cbranch_vccnz interleave_layers__linear_attn_block__memory_aug_recurrent_mem_tr__prompt_kernel_r_pr_out
    s_sleep 2
    s_cmp_ge_u32 s61, s60
    s_cbranch_scc0 interleave_layers__linear_attn_block__memory_aug_recurrent_mem_tr__prompt_kernel_r_pr
    s_mov_b32 s60, 1
interleave_layers__linear_attn_block__memory_aug_recurrent_mem_tr__prompt_kernel_r_pr_out:
    s_mov_b64 exec, -1
    buffer_load_dwordx4 v[100:103], v10, s[8:11], s42 offen offset:0 sc1
    buffer_load_dwordx4 v[104:107], v10, s[8:11], s42 offen offset:1024 sc1
    buffer_load_dwordx4 v[80:83], v8, s[8:11], s43 offen offset:0 sc1
    buffer_load_dwordx4 v[84:87], v8, s[8:11], s43 offen offset:1024 sc1
    buffer_load_dwordx4 v[88:91], v8, s[8:11], s43 offen offset:2048 sc1
    buffer_load_dwordx4 v[92:95], v8, s[8:11], s43 offen offset:3072 sc1
    buffer_load_dwordx4 v[96:99], v9, s[8:11], s43 offen sc1
    s_waitcnt vmcnt(0)
    v_max3_u32 v204, v80, v81, v82
    v_max3_u32 v204, v204, v83, v84
    v_max3_u32 v204, v204, v85, v86
    v_max3_u32 v204, v204, v87, v88
    v_max3_u32 v204, v204, v89, v90
    v_max3_u32 v204, v204, v91, v92
    v_max3_u32 v204, v204, v93, v94
    v_max3_u32 v204, v204, v95, v96
    v_max3_u32 v204, v204, v97, v98
    v_max3_u32 v204, v204, v99, v100
    v_max3_u32 v204, v204, v101, v102
    v_max3_u32 v204, v204, v103, v104
    v_max3_u32 v204, v204, v105, v106
    v_max_u32 v204, v204, v107
    v_cmp_eq_u32 vcc, -1, v204
    s_cbranch_vccz interleave_layers__linear_attn_block__memory_aug_recurrent_mem_tr__prompt_kernel_r_p_out
    s_mov_b32 s61, 0
interleave_layers__linear_attn_block__memory_aug_recurrent_mem_tr__prompt_kernel_r_p:
    buffer_load_dwordx4 v[100:103], v10, s[8:11], s42 offen offset:0 sc1
    buffer_load_dwordx4 v[104:107], v10, s[8:11], s42 offen offset:1024 sc1
    buffer_load_dwordx4 v[80:83], v8, s[8:11], s43 offen offset:0 sc1
    buffer_load_dwordx4 v[84:87], v8, s[8:11], s43 offen offset:1024 sc1
    buffer_load_dwordx4 v[88:91], v8, s[8:11], s43 offen offset:2048 sc1
    buffer_load_dwordx4 v[92:95], v8, s[8:11], s43 offen offset:3072 sc1
    buffer_load_dwordx4 v[96:99], v9, s[8:11], s43 offen sc1
    s_waitcnt vmcnt(0)
    v_max3_u32 v204, v80, v81, v82
    v_max3_u32 v204, v204, v83, v84
    v_max3_u32 v204, v204, v85, v86
    v_max3_u32 v204, v204, v87, v88
    v_max3_u32 v204, v204, v89, v90
    v_max3_u32 v204, v204, v91, v92
    v_max3_u32 v204, v204, v93, v94
    v_max3_u32 v204, v204, v95, v96
    v_max3_u32 v204, v204, v97, v98
    v_max3_u32 v204, v204, v99, v100
    v_max3_u32 v204, v204, v101, v102
    v_max3_u32 v204, v204, v103, v104
    v_max3_u32 v204, v204, v105, v106
    v_max_u32 v204, v204, v107
    v_cmp_eq_u32 vcc, -1, v204
    s_add_u32 s61, s61, 1
    s_cbranch_vccz interleave_layers__linear_attn_block__memory_aug_recurrent_mem_tr__prompt_kernel_r_p_out
    s_cmp_ge_u32 s61, s60
    s_cbranch_scc1 interleave_layers__linear_attn_block__memory_aug_recurrent_mem_tr__prompt_kernel_r_p_to
    s_sleep 1
    s_branch interleave_layers__linear_attn_block__memory_aug_recurrent_mem_tr__prompt_kernel_r_p
interleave_layers__linear_attn_block__memory_aug_recurrent_mem_tr__prompt_kernel_r_p_to:
    s_mov_b32 s60, 1
interleave_layers__linear_attn_block__memory_aug_recurrent_mem_tr__prompt_kernel_r_p_out:
    s_mov_b64 exec, 1
    ds_add_rtn_u32 v124, v122, v123
    s_mov_b64 exec, -1
    v_mfma_f32_16x16x32_bf16 v[108:111], v[100:103], v[96:99], 0
    v_mfma_f32_16x16x32_bf16 v[112:115], v[104:107], v[96:99], 0
    v_mfma_f32_16x16x32_bf16 v[108:111], v[16:19], v[80:83], v[108:111]
    v_mfma_f32_16x16x32_bf16 v[112:115], v[20:23], v[80:83], v[112:115]
    s_waitcnt lgkmcnt(0)
    v_readfirstlane_b32 s24, v124
    s_and_b32 s24, s24, 3
    s_cmp_eq_u32 s24, 3
    s_cbranch_scc0 interleave_layers__linear_attn_block__memory_aug_recurrent_mem_tr__prompt_kernel_nh27
    buffer_atomic_add v123, v120, s[8:11], s46 offen
interleave_layers__linear_attn_block__memory_aug_recurrent_mem_tr__prompt_kernel_nh27:
    v_mfma_f32_16x16x32_bf16 v[108:111], v[24:27], v[84:87], v[108:111]
    v_mfma_f32_16x16x32_bf16 v[112:115], v[28:31], v[84:87], v[112:115]
    v_mfma_f32_16x16x32_bf16 v[108:111], v[32:35], v[88:91], v[108:111]
    v_mfma_f32_16x16x32_bf16 v[112:115], v[36:39], v[88:91], v[112:115]
    v_mfma_f32_16x16x32_bf16 v[108:111], v[40:43], v[92:95], v[108:111]
    v_mfma_f32_16x16x32_bf16 v[112:115], v[44:47], v[92:95], v[112:115]
    s_and_b32 s24, s40, 1
    s_mul_i32 s24, s24, 2560
    v_add_u32 v14, s24, v11
    v_add_u32 v15, s24, v12
    s_nop 3
    v_cndmask_b32 v108, v108, v112, s[50:51]
    v_cndmask_b32 v109, v109, v113, s[50:51]
    v_cndmask_b32 v110, v110, v114, s[50:51]
    v_cndmask_b32 v111, v111, v115, s[50:51]
    v_add_f32 v108, v108, v108 row_ror:8 row_mask:0xf bank_mask:0xf
    v_add_f32 v109, v109, v109 row_ror:8 row_mask:0xf bank_mask:0xf
    v_add_f32 v110, v110, v110 row_ror:8 row_mask:0xf bank_mask:0xf
    v_add_f32 v111, v111, v111 row_ror:8 row_mask:0xf bank_mask:0xf
    ds_write_b128 v14, v[108:111]
    s_waitcnt lgkmcnt(0)
    s_barrier
    s_cmp_eq_u32 s3, 0
    s_cbranch_scc0 interleave_layers__linear_attn_block__memory_aug_recurrent_mem_tr__prompt_kernel_np28
    ds_read_b128 v[220:223], v15 offset:0
    ds_read_b128 v[224:227], v15 offset:16
    ds_read_b128 v[228:231], v15 offset:640
    ds_read_b128 v[232:235], v15 offset:656
    ds_read_b128 v[236:239], v15 offset:1280
    ds_read_b128 v[240:243], v15 offset:1296
    ds_read_b128 v[244:247], v15 offset:1920
    ds_read_b128 v[248:251], v15 offset:1936
    s_waitcnt lgkmcnt(4)
    v_pk_add_f32 v[220:221], v[220:221], v[228:229]
    v_pk_add_f32 v[222:223], v[222:223], v[230:231]
    v_pk_add_f32 v[224:225], v[224:225], v[232:233]
    v_pk_add_f32 v[226:227], v[226:227], v[234:235]
    s_waitcnt lgkmcnt(0)
    v_pk_add_f32 v[236:237], v[236:237], v[244:245]
    v_pk_add_f32 v[238:239], v[238:239], v[246:247]
    v_pk_add_f32 v[240:241], v[240:241], v[248:249]
    v_pk_add_f32 v[242:243], v[242:243], v[250:251]
    v_pk_add_f32 v[220:221], v[220:221], v[236:237]
    v_pk_add_f32 v[222:223], v[222:223], v[238:239]
    v_pk_add_f32 v[224:225], v[224:225], v[240:241]
    v_pk_add_f32 v[226:227], v[226:227], v[242:243]
    v_cvt_pk_bf16_f32 v228, v220, v221
    v_cvt_pk_bf16_f32 v229, v222, v223
    v_cvt_pk_bf16_f32 v230, v224, v225
    v_cvt_pk_bf16_f32 v231, v226, v227
    v_min_u32 v228, -2, v228
    v_min_u32 v229, -2, v229
    v_min_u32 v230, -2, v230
    v_min_u32 v231, -2, v231
    buffer_store_dwordx4 v[228:231], v13, s[8:11], s47 offen sc1
interleave_layers__linear_attn_block__memory_aug_recurrent_mem_tr__prompt_kernel_np28:
    s_add_u32 s63, s40, 2
    s_min_u32 s63, s63, 64
    s_sleep 20
    s_cmp_ge_i32 s62, s63
    s_cbranch_scc1 interleave_layers__linear_attn_block__memory_aug_recurrent_mem_tr__prompt_kernel_r_en_ok
    s_mov_b32 s61, 0
interleave_layers__linear_attn_block__memory_aug_recurrent_mem_tr__prompt_kernel_r_en:
    buffer_load_dword v253, v252, s[8:11], 0 offen sc1
    s_waitcnt vmcnt(0)
    v_readlane_b32 s62, v253, 0
    v_readlane_b32 s24, v253, 1
    s_min_i32 s62, s62, s24
    v_readlane_b32 s24, v253, 2
    s_min_i32 s62, s62, s24
    v_readlane_b32 s24, v253, 3
    s_min_i32 s62, s62, s24
    v_readlane_b32 s24, v253, 4
    s_min_i32 s62, s62, s24
    v_readlane_b32 s24, v253, 5
    s_min_i32 s62, s62, s24
    v_readlane_b32 s24, v253, 6
    s_min_i32 s62, s62, s24
    v_readlane_b32 s24, v253, 7
    s_min_i32 s62, s62, s24
    s_cmp_ge_i32 s62, s63
    s_cbranch_scc1 interleave_layers__linear_attn_block__memory_aug_recurrent_mem_tr__prompt_kernel_r_en_ok
    s_add_u32 s61, s61, 1
    s_cmp_ge_u32 s61, s60
    s_cbranch_scc1 interleave_layers__linear_attn_block__memory_aug_recurrent_mem_tr__prompt_kernel_r_en_to
    s_sleep 2
    s_branch interleave_layers__linear_attn_block__memory_aug_recurrent_mem_tr__prompt_kernel_r_en
interleave_layers__linear_attn_block__memory_aug_recurrent_mem_tr__prompt_kernel_r_en_to:
    s_mov_b32 s60, 1
interleave_layers__linear_attn_block__memory_aug_recurrent_mem_tr__prompt_kernel_r_en_ok:
    buffer_load_dwordx4 v[48:51], v6, s[8:11], s41 offen offset:0 sc1
    buffer_load_dwordx4 v[52:55], v6, s[8:11], s41 offen offset:1024 sc1
    buffer_load_dwordx4 v[56:59], v6, s[8:11], s41 offen offset:2048 sc1
    buffer_load_dwordx4 v[60:63], v6, s[8:11], s41 offen offset:3072 sc1
    buffer_load_dwordx4 v[64:67], v7, s[8:11], s41 offen offset:0 sc1
    buffer_load_dwordx4 v[68:71], v7, s[8:11], s41 offen offset:1024 sc1
    buffer_load_dwordx4 v[72:75], v7, s[8:11], s41 offen offset:2048 sc1
    buffer_load_dwordx4 v[76:79], v7, s[8:11], s41 offen offset:3072 sc1
    s_add_u32 s41, s41, 1310720
    s_add_u32 s40, s40, 1
    s_add_u32 s42, s42, 458752
    s_add_u32 s43, s43, 458752
    s_add_u32 s47, s47, 458752
    s_add_u32 s45, s45, 458752
    s_add_u32 s46, s46, 458752
    s_cmp_lt_u32 s40, 64
    s_cbranch_scc1 interleave_layers__linear_attn_block__memory_aug_recurrent_mem_tr__prompt_kernel_r_step
    s_waitcnt vmcnt(0)
    s_cmp_eq_u32 s92, 0
    s_cbranch_scc0 interleave_layers__linear_attn_block__memory_aug_recurrent_mem_tr__prompt_kernel_end
    s_mov_b32 s92, 1
    s_branch interleave_layers__linear_attn_block__memory_aug_recurrent_mem_tr__prompt_kernel_r_top
interleave_layers__linear_attn_block__memory_aug_recurrent_mem_tr__prompt_kernel_roleP:
    s_sub_u32 s44, s2, 104
    s_lshr_b32 s46, s44, 5
    s_and_b32 s44, s44, 31
    s_load_dwordx2 s[6:7], s[0:1], 40
    s_load_dwordx2 s[24:25], s[0:1], 48
    s_load_dwordx2 s[26:27], s[0:1], 56
    s_waitcnt lgkmcnt(0)
    s_cmp_eq_u32 s46, 1
    s_cselect_b32 s6, s24, s6
    s_cselect_b32 s7, s25, s7
    s_cmp_eq_u32 s46, 2
    s_cselect_b32 s6, s26, s6
    s_cselect_b32 s7, s27, s7
    s_mov_b32 s12, s6
    s_mov_b32 s13, s7
    s_mov_b32 s14, 7864320
    s_mov_b32 s15, 0x00020000
    v_add_u32 v16, 0, v0
    s_mov_b32 s24, 683
    v_mul_lo_u32 v17, v16, s24
    v_lshrrev_b32 v17, 14, v17
    v_mul_u32_u24 v18, 24, v17
    v_sub_u32 v18, v16, v18
    s_mov_b32 s24, 12288
    v_mul_lo_u32 v4, v17, s24
    v_lshl_add_u32 v4, v18, 4, v4
    v_mul_u32_u24 v10, 400, v17
    v_lshl_add_u32 v10, v18, 4, v10
    v_add_u32 v10, 81920, v10
    v_add_u32 v16, 256, v0
    s_mov_b32 s24, 683
    v_mul_lo_u32 v17, v16, s24
    v_lshrrev_b32 v17, 14, v17
    v_mul_u32_u24 v18, 24, v17
    v_sub_u32 v18, v16, v18
    s_mov_b32 s24, 12288
    v_mul_lo_u32 v5, v17, s24
    v_lshl_add_u32 v5, v18, 4, v5
    v_mul_u32_u24 v11, 400, v17
    v_lshl_add_u32 v11, v18, 4, v11
    v_add_u32 v11, 81920, v11
    v_add_u32 v16, 512, v0
    s_mov_b32 s24, 683
    v_mul_lo_u32 v17, v16, s24
    v_lshrrev_b32 v17, 14, v17
    v_mul_u32_u24 v18, 24, v17
    v_sub_u32 v18, v16, v18
    s_mov_b32 s24, 12288
    v_mul_lo_u32 v6, v17, s24
    v_lshl_add_u32 v6, v18, 4, v6
    v_mul_u32_u24 v12, 400, v17
    v_lshl_add_u32 v12, v18, 4, v12
    v_add_u32 v12, 81920, v12
    v_add_u32 v16, 768, v0
    s_mov_b32 s24, 683
    v_mul_lo_u32 v17, v16, s24
    v_lshrrev_b32 v17, 14, v17
    v_mul_u32_u24 v18, 24, v17
    v_sub_u32 v18, v16, v18
    s_mov_b32 s24, 12288
    v_mul_lo_u32 v7, v17, s24
    v_lshl_add_u32 v7, v18, 4, v7
    v_mul_u32_u24 v13, 400, v17
    v_lshl_add_u32 v13, v18, 4, v13
    v_add_u32 v13, 81920, v13
    v_add_u32 v16, 1024, v0
    s_mov_b32 s24, 683
    v_mul_lo_u32 v17, v16, s24
    v_lshrrev_b32 v17, 14, v17
    v_mul_u32_u24 v18, 24, v17
    v_sub_u32 v18, v16, v18
    s_mov_b32 s24, 12288
    v_mul_lo_u32 v8, v17, s24
    v_lshl_add_u32 v8, v18, 4, v8
    v_mul_u32_u24 v14, 400, v17
    v_lshl_add_u32 v14, v18, 4, v14
    v_add_u32 v14, 81920, v14
    v_add_u32 v16, 1280, v0
    s_mov_b32 s24, 683
    v_mul_lo_u32 v17, v16, s24
    v_lshrrev_b32 v17, 14, v17
    v_mul_u32_u24 v18, 24, v17
    v_sub_u32 v18, v16, v18
    s_mov_b32 s24, 12288
    v_mul_lo_u32 v9, v17, s24
    v_lshl_add_u32 v9, v18, 4, v9
    v_mul_u32_u24 v15, 400, v17
    v_lshl_add_u32 v15, v18, 4, v15
    v_add_u32 v15, 81920, v15
    v_lshrrev_b32 v16, 2, v2
    v_lshl_add_u32 v16, v3, 2, v16
    v_mul_u32_u24 v32, 400, v16
    v_and_b32 v16, 3, v2
    v_lshl_add_u32 v32, v16, 3, v32
    s_mul_i32 s24, s3, 96
    s_add_u32 s24, s24, 81920
    v_add_u32 v32, s24, v32
    s_mul_i32 s45, s44, 384
    s_add_u32 s47, s45, 0
    buffer_load_dwordx4 v[56:59], v4, s[12:15], s47 offen
    buffer_load_dwordx4 v[60:63], v5, s[12:15], s47 offen
    buffer_load_dwordx4 v[64:67], v6, s[12:15], s47 offen
    buffer_load_dwordx4 v[68:71], v7, s[12:15], s47 offen
    buffer_load_dwordx4 v[72:75], v8, s[12:15], s47 offen
    buffer_load_dwordx4 v[76:79], v9, s[12:15], s47 offen
    s_add_u32 s47, s45, 786432
    buffer_load_dwordx4 v[80:83], v4, s[12:15], s47 offen
    buffer_load_dwordx4 v[84:87], v5, s[12:15], s47 offen
    buffer_load_dwordx4 v[88:91], v6, s[12:15], s47 offen
    buffer_load_dwordx4 v[92:95], v7, s[12:15], s47 offen
    buffer_load_dwordx4 v[96:99], v8, s[12:15], s47 offen
    buffer_load_dwordx4 v[100:103], v9, s[12:15], s47 offen
    s_add_u32 s47, s45, 1572864
    buffer_load_dwordx4 v[104:107], v4, s[12:15], s47 offen
    buffer_load_dwordx4 v[108:111], v5, s[12:15], s47 offen
    buffer_load_dwordx4 v[112:115], v6, s[12:15], s47 offen
    buffer_load_dwordx4 v[116:119], v7, s[12:15], s47 offen
    buffer_load_dwordx4 v[120:123], v8, s[12:15], s47 offen
    buffer_load_dwordx4 v[124:127], v9, s[12:15], s47 offen
    s_add_u32 s47, s45, 2359296
    buffer_load_dwordx4 v[128:131], v4, s[12:15], s47 offen
    buffer_load_dwordx4 v[132:135], v5, s[12:15], s47 offen
    buffer_load_dwordx4 v[136:139], v6, s[12:15], s47 offen
    buffer_load_dwordx4 v[140:143], v7, s[12:15], s47 offen
    buffer_load_dwordx4 v[144:147], v8, s[12:15], s47 offen
    buffer_load_dwordx4 v[148:151], v9, s[12:15], s47 offen
    s_add_u32 s47, s45, 3145728
    buffer_load_dwordx4 v[152:155], v4, s[12:15], s47 offen
    buffer_load_dwordx4 v[156:159], v5, s[12:15], s47 offen
    buffer_load_dwordx4 v[160:163], v6, s[12:15], s47 offen
    buffer_load_dwordx4 v[164:167], v7, s[12:15], s47 offen
    buffer_load_dwordx4 v[168:171], v8, s[12:15], s47 offen
    buffer_load_dwordx4 v[172:175], v9, s[12:15], s47 offen
    s_add_u32 s47, s45, 3932160
    buffer_load_dwordx4 v[176:179], v4, s[12:15], s47 offen
    buffer_load_dwordx4 v[180:183], v5, s[12:15], s47 offen
    buffer_load_dwordx4 v[184:187], v6, s[12:15], s47 offen
    buffer_load_dwordx4 v[188:191], v7, s[12:15], s47 offen
    buffer_load_dwordx4 v[192:195], v8, s[12:15], s47 offen
    buffer_load_dwordx4 v[196:199], v9, s[12:15], s47 offen
    s_add_u32 s47, s45, 4718592
    buffer_load_dwordx4 v[200:203], v4, s[12:15], s47 offen
    buffer_load_dwordx4 v[204:207], v5, s[12:15], s47 offen
    buffer_load_dwordx4 v[208:211], v6, s[12:15], s47 offen
    buffer_load_dwordx4 v[212:215], v7, s[12:15], s47 offen
    buffer_load_dwordx4 v[216:219], v8, s[12:15], s47 offen
    buffer_load_dwordx4 v[220:223], v9, s[12:15], s47 offen
    s_add_u32 s47, s45, 5505024
    buffer_load_dwordx4 v[224:227], v4, s[12:15], s47 offen
    buffer_load_dwordx4 v[228:231], v5, s[12:15], s47 offen
    buffer_load_dwordx4 v[232:235], v6, s[12:15], s47 offen
    buffer_load_dwordx4 v[236:239], v7, s[12:15], s47 offen
    buffer_load_dwordx4 v[240:243], v8, s[12:15], s47 offen
    buffer_load_dwordx4 v[244:247], v9, s[12:15], s47 offen
    v_mov_b32 v28, 0x3f803f80
    v_mov_b32 v29, 0x3f803f80
    v_mov_b32 v30, 0x3f803f80
    v_mov_b32 v31, 0x3f803f80
    s_waitcnt vmcnt(42)
    ds_write_b128 v10, v[56:59] offset:0
    ds_write_b128 v11, v[60:63] offset:0
    ds_write_b128 v12, v[64:67] offset:0
    ds_write_b128 v13, v[68:71] offset:0
    ds_write_b128 v14, v[72:75] offset:0
    ds_write_b128 v15, v[76:79] offset:0
    s_waitcnt lgkmcnt(0)
    s_add_u32 s47, s45, 6291456
    buffer_load_dwordx4 v[56:59], v4, s[12:15], s47 offen
    buffer_load_dwordx4 v[60:63], v5, s[12:15], s47 offen
    buffer_load_dwordx4 v[64:67], v6, s[12:15], s47 offen
    buffer_load_dwordx4 v[68:71], v7, s[12:15], s47 offen
    buffer_load_dwordx4 v[72:75], v8, s[12:15], s47 offen
    buffer_load_dwordx4 v[76:79], v9, s[12:15], s47 offen
    s_barrier
    ds_read_b64_tr_b16 a[0:1], v32 offset:0
    ds_read_b64_tr_b16 a[2:3], v32 offset:6400
    ds_read_b64_tr_b16 a[4:5], v32 offset:12800
    ds_read_b64_tr_b16 a[6:7], v32 offset:19200
    ds_read_b64_tr_b16 a[80:81], v32 offset:32
    ds_read_b64_tr_b16 a[82:83], v32 offset:6432
    ds_read_b64_tr_b16 a[84:85], v32 offset:12832
    ds_read_b64_tr_b16 a[86:87], v32 offset:19232
    ds_read_b64_tr_b16 a[160:161], v32 offset:64
    ds_read_b64_tr_b16 a[162:163], v32 offset:6464
    ds_read_b64_tr_b16 a[164:165], v32 offset:12864
    ds_read_b64_tr_b16 a[166:167], v32 offset:19264
    s_waitcnt vmcnt(42)
    ds_write_b128 v10, v[80:83] offset:25600
    ds_write_b128 v11, v[84:87] offset:25600
    ds_write_b128 v12, v[88:91] offset:25600
    ds_write_b128 v13, v[92:95] offset:25600
    ds_write_b128 v14, v[96:99] offset:25600
    ds_write_b128 v15, v[100:103] offset:25600
    s_waitcnt lgkmcnt(0)
    s_add_u32 s47, s45, 7077888
    buffer_load_dwordx4 v[80:83], v4, s[12:15], s47 offen
    buffer_load_dwordx4 v[84:87], v5, s[12:15], s47 offen
    buffer_load_dwordx4 v[88:91], v6, s[12:15], s47 offen
    buffer_load_dwordx4 v[92:95], v7, s[12:15], s47 offen
    buffer_load_dwordx4 v[96:99], v8, s[12:15], s47 offen
    buffer_load_dwordx4 v[100:103], v9, s[12:15], s47 offen
    v_mfma_f32_16x16x32_bf16 v[16:19], a[0:3], v[28:31], 0
    v_mfma_f32_16x16x32_bf16 v[20:23], a[80:83], v[28:31], 0
    v_mfma_f32_16x16x32_bf16 v[24:27], a[160:163], v[28:31], 0
    v_mfma_f32_16x16x32_bf16 v[16:19], a[4:7], v[28:31], v[16:19]
    v_mfma_f32_16x16x32_bf16 v[20:23], a[84:87], v[28:31], v[20:23]
    v_mfma_f32_16x16x32_bf16 v[24:27], a[164:167], v[28:31], v[24:27]
    s_barrier
    ds_read_b64_tr_b16 a[8:9], v32 offset:25600
    ds_read_b64_tr_b16 a[10:11], v32 offset:32000
    ds_read_b64_tr_b16 a[12:13], v32 offset:38400
    ds_read_b64_tr_b16 a[14:15], v32 offset:44800
    ds_read_b64_tr_b16 a[88:89], v32 offset:25632
    ds_read_b64_tr_b16 a[90:91], v32 offset:32032
    ds_read_b64_tr_b16 a[92:93], v32 offset:38432
    ds_read_b64_tr_b16 a[94:95], v32 offset:44832
    ds_read_b64_tr_b16 a[168:169], v32 offset:25664
    ds_read_b64_tr_b16 a[170:171], v32 offset:32064
    ds_read_b64_tr_b16 a[172:173], v32 offset:38464
    ds_read_b64_tr_b16 a[174:175], v32 offset:44864
    s_waitcnt vmcnt(42)
    ds_write_b128 v10, v[104:107] offset:0
    ds_write_b128 v11, v[108:111] offset:0
    ds_write_b128 v12, v[112:115] offset:0
    ds_write_b128 v13, v[116:119] offset:0
    ds_write_b128 v14, v[120:123] offset:0
    ds_write_b128 v15, v[124:127] offset:0
    s_waitcnt lgkmcnt(0)
    v_mfma_f32_16x16x32_bf16 v[16:19], a[8:11], v[28:31], v[16:19]
    v_mfma_f32_16x16x32_bf16 v[20:23], a[88:91], v[28:31], v[20:23]
    v_mfma_f32_16x16x32_bf16 v[24:27], a[168:171], v[28:31], v[24:27]
    v_mfma_f32_16x16x32_bf16 v[16:19], a[12:15], v[28:31], v[16:19]
    v_mfma_f32_16x16x32_bf16 v[20:23], a[92:95], v[28:31], v[20:23]
    v_mfma_f32_16x16x32_bf16 v[24:27], a[172:175], v[28:31], v[24:27]
    s_barrier
    ds_read_b64_tr_b16 a[16:17], v32 offset:0
    ds_read_b64_tr_b16 a[18:19], v32 offset:6400
    ds_read_b64_tr_b16 a[20:21], v32 offset:12800
    ds_read_b64_tr_b16 a[22:23], v32 offset:19200
    ds_read_b64_tr_b16 a[96:97], v32 offset:32
    ds_read_b64_tr_b16 a[98:99], v32 offset:6432
    ds_read_b64_tr_b16 a[100:101], v32 offset:12832
    ds_read_b64_tr_b16 a[102:103], v32 offset:19232
    ds_read_b64_tr_b16 a[176:177], v32 offset:64
    ds_read_b64_tr_b16 a[178:179], v32 offset:6464
    ds_read_b64_tr_b16 a[180:181], v32 offset:12864
    ds_read_b64_tr_b16 a[182:183], v32 offset:19264
    s_waitcnt vmcnt(36)
    ds_write_b128 v10, v[128:131] offset:25600
    ds_write_b128 v11, v[132:135] offset:25600
    ds_write_b128 v12, v[136:139] offset:25600
    ds_write_b128 v13, v[140:143] offset:25600
    ds_write_b128 v14, v[144:147] offset:25600
    ds_write_b128 v15, v[148:151] offset:25600
    s_waitcnt lgkmcnt(0)
    v_mfma_f32_16x16x32_bf16 v[16:19], a[16:19], v[28:31], v[16:19]
    v_mfma_f32_16x16x32_bf16 v[20:23], a[96:99], v[28:31], v[20:23]
    v_mfma_f32_16x16x32_bf16 v[24:27], a[176:179], v[28:31], v[24:27]
    v_mfma_f32_16x16x32_bf16 v[16:19], a[20:23], v[28:31], v[16:19]
    v_mfma_f32_16x16x32_bf16 v[20:23], a[100:103], v[28:31], v[20:23]
    v_mfma_f32_16x16x32_bf16 v[24:27], a[180:183], v[28:31], v[24:27]
    s_barrier
    ds_read_b64_tr_b16 a[24:25], v32 offset:25600
    ds_read_b64_tr_b16 a[26:27], v32 offset:32000
    ds_read_b64_tr_b16 a[28:29], v32 offset:38400
    ds_read_b64_tr_b16 a[30:31], v32 offset:44800
    ds_read_b64_tr_b16 a[104:105], v32 offset:25632
    ds_read_b64_tr_b16 a[106:107], v32 offset:32032
    ds_read_b64_tr_b16 a[108:109], v32 offset:38432
    ds_read_b64_tr_b16 a[110:111], v32 offset:44832
    ds_read_b64_tr_b16 a[184:185], v32 offset:25664
    ds_read_b64_tr_b16 a[186:187], v32 offset:32064
    ds_read_b64_tr_b16 a[188:189], v32 offset:38464
    ds_read_b64_tr_b16 a[190:191], v32 offset:44864
    s_waitcnt vmcnt(30)
    ds_write_b128 v10, v[152:155] offset:0
    ds_write_b128 v11, v[156:159] offset:0
    ds_write_b128 v12, v[160:163] offset:0
    ds_write_b128 v13, v[164:167] offset:0
    ds_write_b128 v14, v[168:171] offset:0
    ds_write_b128 v15, v[172:175] offset:0
    s_waitcnt lgkmcnt(0)
    v_mfma_f32_16x16x32_bf16 v[16:19], a[24:27], v[28:31], v[16:19]
    v_mfma_f32_16x16x32_bf16 v[20:23], a[104:107], v[28:31], v[20:23]
    v_mfma_f32_16x16x32_bf16 v[24:27], a[184:187], v[28:31], v[24:27]
    v_mfma_f32_16x16x32_bf16 v[16:19], a[28:31], v[28:31], v[16:19]
    v_mfma_f32_16x16x32_bf16 v[20:23], a[108:111], v[28:31], v[20:23]
    v_mfma_f32_16x16x32_bf16 v[24:27], a[188:191], v[28:31], v[24:27]
    s_barrier
    ds_read_b64_tr_b16 a[32:33], v32 offset:0
    ds_read_b64_tr_b16 a[34:35], v32 offset:6400
    ds_read_b64_tr_b16 a[36:37], v32 offset:12800
    ds_read_b64_tr_b16 a[38:39], v32 offset:19200
    ds_read_b64_tr_b16 a[112:113], v32 offset:32
    ds_read_b64_tr_b16 a[114:115], v32 offset:6432
    ds_read_b64_tr_b16 a[116:117], v32 offset:12832
    ds_read_b64_tr_b16 a[118:119], v32 offset:19232
    ds_read_b64_tr_b16 a[192:193], v32 offset:64
    ds_read_b64_tr_b16 a[194:195], v32 offset:6464
    ds_read_b64_tr_b16 a[196:197], v32 offset:12864
    ds_read_b64_tr_b16 a[198:199], v32 offset:19264
    s_waitcnt vmcnt(24)
    ds_write_b128 v10, v[176:179] offset:25600
    ds_write_b128 v11, v[180:183] offset:25600
    ds_write_b128 v12, v[184:187] offset:25600
    ds_write_b128 v13, v[188:191] offset:25600
    ds_write_b128 v14, v[192:195] offset:25600
    ds_write_b128 v15, v[196:199] offset:25600
    s_waitcnt lgkmcnt(0)
    v_mfma_f32_16x16x32_bf16 v[16:19], a[32:35], v[28:31], v[16:19]
    v_mfma_f32_16x16x32_bf16 v[20:23], a[112:115], v[28:31], v[20:23]
    v_mfma_f32_16x16x32_bf16 v[24:27], a[192:195], v[28:31], v[24:27]
    v_mfma_f32_16x16x32_bf16 v[16:19], a[36:39], v[28:31], v[16:19]
    v_mfma_f32_16x16x32_bf16 v[20:23], a[116:119], v[28:31], v[20:23]
    v_mfma_f32_16x16x32_bf16 v[24:27], a[196:199], v[28:31], v[24:27]
    s_barrier
    ds_read_b64_tr_b16 a[40:41], v32 offset:25600
    ds_read_b64_tr_b16 a[42:43], v32 offset:32000
    ds_read_b64_tr_b16 a[44:45], v32 offset:38400
    ds_read_b64_tr_b16 a[46:47], v32 offset:44800
    ds_read_b64_tr_b16 a[120:121], v32 offset:25632
    ds_read_b64_tr_b16 a[122:123], v32 offset:32032
    ds_read_b64_tr_b16 a[124:125], v32 offset:38432
    ds_read_b64_tr_b16 a[126:127], v32 offset:44832
    ds_read_b64_tr_b16 a[200:201], v32 offset:25664
    ds_read_b64_tr_b16 a[202:203], v32 offset:32064
    ds_read_b64_tr_b16 a[204:205], v32 offset:38464
    ds_read_b64_tr_b16 a[206:207], v32 offset:44864
    s_waitcnt vmcnt(18)
    ds_write_b128 v10, v[200:203] offset:0
    ds_write_b128 v11, v[204:207] offset:0
    ds_write_b128 v12, v[208:211] offset:0
    ds_write_b128 v13, v[212:215] offset:0
    ds_write_b128 v14, v[216:219] offset:0
    ds_write_b128 v15, v[220:223] offset:0
    s_waitcnt lgkmcnt(0)
    v_mfma_f32_16x16x32_bf16 v[16:19], a[40:43], v[28:31], v[16:19]
    v_mfma_f32_16x16x32_bf16 v[20:23], a[120:123], v[28:31], v[20:23]
    v_mfma_f32_16x16x32_bf16 v[24:27], a[200:203], v[28:31], v[24:27]
    v_mfma_f32_16x16x32_bf16 v[16:19], a[44:47], v[28:31], v[16:19]
    v_mfma_f32_16x16x32_bf16 v[20:23], a[124:127], v[28:31], v[20:23]
    v_mfma_f32_16x16x32_bf16 v[24:27], a[204:207], v[28:31], v[24:27]
    s_barrier
    ds_read_b64_tr_b16 a[48:49], v32 offset:0
    ds_read_b64_tr_b16 a[50:51], v32 offset:6400
    ds_read_b64_tr_b16 a[52:53], v32 offset:12800
    ds_read_b64_tr_b16 a[54:55], v32 offset:19200
    ds_read_b64_tr_b16 a[128:129], v32 offset:32
    ds_read_b64_tr_b16 a[130:131], v32 offset:6432
    ds_read_b64_tr_b16 a[132:133], v32 offset:12832
    ds_read_b64_tr_b16 a[134:135], v32 offset:19232
    ds_read_b64_tr_b16 a[208:209], v32 offset:64
    ds_read_b64_tr_b16 a[210:211], v32 offset:6464
    ds_read_b64_tr_b16 a[212:213], v32 offset:12864
    ds_read_b64_tr_b16 a[214:215], v32 offset:19264
    s_waitcnt vmcnt(12)
    ds_write_b128 v10, v[224:227] offset:25600
    ds_write_b128 v11, v[228:231] offset:25600
    ds_write_b128 v12, v[232:235] offset:25600
    ds_write_b128 v13, v[236:239] offset:25600
    ds_write_b128 v14, v[240:243] offset:25600
    ds_write_b128 v15, v[244:247] offset:25600
    s_waitcnt lgkmcnt(0)
    v_mfma_f32_16x16x32_bf16 v[16:19], a[48:51], v[28:31], v[16:19]
    v_mfma_f32_16x16x32_bf16 v[20:23], a[128:131], v[28:31], v[20:23]
    v_mfma_f32_16x16x32_bf16 v[24:27], a[208:211], v[28:31], v[24:27]
    v_mfma_f32_16x16x32_bf16 v[16:19], a[52:55], v[28:31], v[16:19]
    v_mfma_f32_16x16x32_bf16 v[20:23], a[132:135], v[28:31], v[20:23]
    v_mfma_f32_16x16x32_bf16 v[24:27], a[212:215], v[28:31], v[24:27]
    s_barrier
    ds_read_b64_tr_b16 a[56:57], v32 offset:25600
    ds_read_b64_tr_b16 a[58:59], v32 offset:32000
    ds_read_b64_tr_b16 a[60:61], v32 offset:38400
    ds_read_b64_tr_b16 a[62:63], v32 offset:44800
    ds_read_b64_tr_b16 a[136:137], v32 offset:25632
    ds_read_b64_tr_b16 a[138:139], v32 offset:32032
    ds_read_b64_tr_b16 a[140:141], v32 offset:38432
    ds_read_b64_tr_b16 a[142:143], v32 offset:44832
    ds_read_b64_tr_b16 a[216:217], v32 offset:25664
    ds_read_b64_tr_b16 a[218:219], v32 offset:32064
    ds_read_b64_tr_b16 a[220:221], v32 offset:38464
    ds_read_b64_tr_b16 a[222:223], v32 offset:44864
    s_waitcnt vmcnt(6)
    ds_write_b128 v10, v[56:59] offset:0
    ds_write_b128 v11, v[60:63] offset:0
    ds_write_b128 v12, v[64:67] offset:0
    ds_write_b128 v13, v[68:71] offset:0
    ds_write_b128 v14, v[72:75] offset:0
    ds_write_b128 v15, v[76:79] offset:0
    s_waitcnt lgkmcnt(0)
    v_mfma_f32_16x16x32_bf16 v[16:19], a[56:59], v[28:31], v[16:19]
    v_mfma_f32_16x16x32_bf16 v[20:23], a[136:139], v[28:31], v[20:23]
    v_mfma_f32_16x16x32_bf16 v[24:27], a[216:219], v[28:31], v[24:27]
    v_mfma_f32_16x16x32_bf16 v[16:19], a[60:63], v[28:31], v[16:19]
    v_mfma_f32_16x16x32_bf16 v[20:23], a[140:143], v[28:31], v[20:23]
    v_mfma_f32_16x16x32_bf16 v[24:27], a[220:223], v[28:31], v[24:27]
    s_barrier
    ds_read_b64_tr_b16 a[64:65], v32 offset:0
    ds_read_b64_tr_b16 a[66:67], v32 offset:6400
    ds_read_b64_tr_b16 a[68:69], v32 offset:12800
    ds_read_b64_tr_b16 a[70:71], v32 offset:19200
    ds_read_b64_tr_b16 a[144:145], v32 offset:32
    ds_read_b64_tr_b16 a[146:147], v32 offset:6432
    ds_read_b64_tr_b16 a[148:149], v32 offset:12832
    ds_read_b64_tr_b16 a[150:151], v32 offset:19232
    ds_read_b64_tr_b16 a[224:225], v32 offset:64
    ds_read_b64_tr_b16 a[226:227], v32 offset:6464
    ds_read_b64_tr_b16 a[228:229], v32 offset:12864
    ds_read_b64_tr_b16 a[230:231], v32 offset:19264
    s_waitcnt vmcnt(0)
    ds_write_b128 v10, v[80:83] offset:25600
    ds_write_b128 v11, v[84:87] offset:25600
    ds_write_b128 v12, v[88:91] offset:25600
    ds_write_b128 v13, v[92:95] offset:25600
    ds_write_b128 v14, v[96:99] offset:25600
    ds_write_b128 v15, v[100:103] offset:25600
    s_waitcnt lgkmcnt(0)
    v_mfma_f32_16x16x32_bf16 v[16:19], a[64:67], v[28:31], v[16:19]
    v_mfma_f32_16x16x32_bf16 v[20:23], a[144:147], v[28:31], v[20:23]
    v_mfma_f32_16x16x32_bf16 v[24:27], a[224:227], v[28:31], v[24:27]
    v_mfma_f32_16x16x32_bf16 v[16:19], a[68:71], v[28:31], v[16:19]
    v_mfma_f32_16x16x32_bf16 v[20:23], a[148:151], v[28:31], v[20:23]
    v_mfma_f32_16x16x32_bf16 v[24:27], a[228:231], v[28:31], v[24:27]
    s_barrier
    ds_read_b64_tr_b16 a[72:73], v32 offset:25600
    ds_read_b64_tr_b16 a[74:75], v32 offset:32000
    ds_read_b64_tr_b16 a[76:77], v32 offset:38400
    ds_read_b64_tr_b16 a[78:79], v32 offset:44800
    ds_read_b64_tr_b16 a[152:153], v32 offset:25632
    ds_read_b64_tr_b16 a[154:155], v32 offset:32032
    ds_read_b64_tr_b16 a[156:157], v32 offset:38432
    ds_read_b64_tr_b16 a[158:159], v32 offset:44832
    ds_read_b64_tr_b16 a[232:233], v32 offset:25664
    ds_read_b64_tr_b16 a[234:235], v32 offset:32064
    ds_read_b64_tr_b16 a[236:237], v32 offset:38464
    ds_read_b64_tr_b16 a[238:239], v32 offset:44864
    s_waitcnt lgkmcnt(0)
    v_mfma_f32_16x16x32_bf16 v[16:19], a[72:75], v[28:31], v[16:19]
    v_mfma_f32_16x16x32_bf16 v[20:23], a[152:155], v[28:31], v[20:23]
    v_mfma_f32_16x16x32_bf16 v[24:27], a[232:235], v[28:31], v[24:27]
    v_mfma_f32_16x16x32_bf16 v[16:19], a[76:79], v[28:31], v[16:19]
    v_mfma_f32_16x16x32_bf16 v[20:23], a[156:159], v[28:31], v[20:23]
    v_mfma_f32_16x16x32_bf16 v[24:27], a[236:239], v[28:31], v[24:27]
    s_nop 5
    v_mov_b32 v224, v16
    v_mov_b32 v225, v17
    v_mov_b32 v226, v18
    v_mov_b32 v227, v19
    v_mov_b32 v228, v20
    v_mov_b32 v229, v21
    v_mov_b32 v230, v22
    v_mov_b32 v231, v23
    v_mov_b32 v232, v24
    v_mov_b32 v233, v25
    v_mov_b32 v234, v26
    v_mov_b32 v235, v27
    v_mov_b32 v236, v28
    v_mov_b32 v237, v29
    v_mov_b32 v238, v30
    v_mov_b32 v239, v31
    s_barrier
interleave_layers__linear_attn_block__memory_aug_recurrent_mem_tr__prompt_kernel_p_layer:
    s_mul_i32 s93, s92, 29360128
    s_add_u32 s93, s93, 117440512
    s_mul_i32 s94, s92, 16384
    s_add_u32 s94, s94, 23068672
    s_sub_u32 s44, s2, 104
    s_lshr_b32 s46, s44, 5
    s_and_b32 s44, s44, 31
    s_mov_b32 s43, 67108864
    s_cmp_eq_u32 s46, 1
    s_cselect_b32 s43, 92274688, s43
    s_cmp_eq_u32 s46, 2
    s_cselect_b32 s43, 33554432, s43
    s_cmp_eq_u32 s92, 0
    s_cselect_b32 s73, 0, 8388608
    v_lshlrev_b32 v5, 4, v1
    s_mul_i32 s24, s3, 10240
    v_add_u32 v6, s24, v5
    v_add_u32 v7, 4096, v6
    v_add_u32 v8, 8192, v6
    s_mul_i32 s24, s44, 12288
    s_mul_i32 s25, s3, 3072
    s_add_u32 s24, s24, s25
    v_add_u32 v11, s24, v5
    s_lshr_b32 s24, s3, 1
    s_lshl_b32 s24, s24, 8
    s_and_b32 s25, s3, 1
    s_lshl_b32 s25, s25, 3
    s_add_u32 s24, s24, s25
    s_add_u32 s24, s24, 81920
    v_lshlrev_b32 v13, 4, v2
    v_add_u32 v12, s24, v13
    v_add_u32 v13, 81920, v13
    v_lshrrev_b32 v15, 2, v2
    v_cmp_eq_u32 vcc, v15, v3
    v_lshlrev_b32 v15, 3, v1
    v_add_u32 v15, 82944, v15
    v_cndmask_b32 v12, v15, v12, vcc
    v_and_b32 v15, 3, v2
    v_cmp_eq_u32 s[48:49], 1, v15
    v_cmp_eq_u32 s[50:51], 2, v15
    v_cmp_eq_u32 s[54:55], 3, v15
    s_and_b32 s24, s2, 7
    s_lshl_b32 s24, s24, 7
    s_lshl_b32 s25, s92, 10
    s_add_u32 s24, s24, s25
    s_add_u32 s24, s24, 23105536
    s_cmp_eq_u32 s92, 0
    s_cselect_b32 s25, 20, 5
    s_cselect_b32 s75, 2, 0
    s_cselect_b32 s74, 16, 64
    v_cmp_gt_u32 vcc, s25, v1
    s_nop 1
    v_cndmask_b32 v4, 0, v1, vcc
    v_lshlrev_b32 v4, 2, v4
    v_add_u32 v4, s24, v4
    s_lshl_b32 s24, s46, 12
    s_lshl_b32 s25, s44, 7
    s_add_u32 s24, s24, s25
    s_add_u32 s24, s24, s94
    v_mov_b32 v14, s24
    v_mov_b32 v15, 2146435072
    v_cmp_eq_u32 vcc, 0, v1
    s_nop 1
    v_cndmask_b32 v14, v15, v14, vcc
    s_cmp_eq_u32 s3, 0
    s_cselect_b32 s24, 0, 2146435072
    v_or_b32 v14, s24, v14
    s_sub_u32 s70, s2, 104
    s_mul_i32 s71, s70, 205
    s_lshr_b32 s71, s71, 12
    s_mul_i32 s24, s71, 20
    s_sub_u32 s70, s70, s24
    s_cmp_lt_u32 s71, 4
    s_cselect_b32 s64, s71, 64
    s_lshl_b32 s24, s70, 16
    s_lshl_b32 s25, s3, 13
    s_add_u32 s24, s24, s25
    v_add_u32 v240, s24, v5
    v_add_u32 v241, 4096, v240
    s_lshl_b32 s24, s70, 14
    s_lshl_b32 s25, s3, 11
    s_add_u32 s24, s24, s25
    v_add_u32 v242, s24, v5
    s_lshl_b32 s24, s3, 14
    v_add_u32 v193, s24, v5
    v_add_u32 v212, 0, v193
    v_add_u32 v213, 4096, v193
    v_add_u32 v214, 8192, v193
    v_add_u32 v215, 12288, v193
    s_lshl_b32 s24, s3, 12
    s_add_u32 s24, s24, 65536
    v_add_u32 v216, s24, v5
    s_lshl_b32 s24, s3, 12
    s_add_u32 s24, s24, 83968
    v_add_u32 v217, s24, v5
    s_and_b32 s24, s3, 1
    s_lshl_b32 s24, s24, 10
    s_add_u32 s24, s24, 83968
    v_add_u32 v218, s24, v5
    s_and_b32 s24, s3, 1
    s_mul_i32 s24, s24, 20480
    s_lshl_b32 s25, s70, 10
    s_add_u32 s24, s24, s25
    v_add_u32 v219, s24, v5
    s_and_b32 s24, s3, 1
    s_lshl_b32 s24, s24, 4
    v_add_u32 v243, s24, v2
    v_mul_u32_u24 v243, 1280, v243
    v_lshl_add_u32 v243, v3, 3, v243
    s_lshl_b32 s24, s70, 6
    v_add_u32 v243, s24, v243
    s_load_dwordx2 s[26:27], s[0:1], 80
    s_waitcnt lgkmcnt(0)
    s_mov_b32 s12, s26
    s_mov_b32 s13, s27
    s_mov_b32 s14, 2621440
    s_mov_b32 s15, 0x00020000
    s_mul_i32 s65, s71, 1310720
    s_add_u32 s65, s65, 184549376
    s_mul_i32 s24, s71, 458752
    s_add_u32 s24, s24, s93
    s_add_u32 s66, s24, 0
    s_add_u32 s67, s24, 327680
    s_mul_i32 s68, s71, 40960
    v_and_b32 v252, 7, v1
    v_lshlrev_b32 v252, 7, v252
    s_lshl_b32 s24, s3, 10
    s_add_u32 s24, s24, 12288
    s_add_u32 s24, s24, s94
    v_add_u32 v252, s24, v252
    s_mov_b32 s69, -1
    s_lshl_b32 s24, s71, 7
    s_lshl_b32 s25, s70, 2
    s_add_u32 s24, s24, s25
    s_add_u32 s24, s24, 23107584
    s_cmp_eq_u32 s3, 0
    s_cselect_b32 s24, s24, 2146435072
    v_mov_b32 v245, s24
    v_mov_b32 v246, 2146435072
    v_cmp_eq_u32 vcc, 0, v1
    s_nop 1
    v_cndmask_b32 v245, v246, v245, vcc
    s_mov_b32 s79, -1
    s_mov_b32 s62, -1
    s_mov_b32 s63, 1
    s_cmp_ge_i32 s62, s63
    s_cbranch_scc1 interleave_layers__linear_attn_block__memory_aug_recurrent_mem_tr__prompt_kernel_p_en0_ok
    s_mov_b32 s61, 0
interleave_layers__linear_attn_block__memory_aug_recurrent_mem_tr__prompt_kernel_p_en0:
    buffer_load_dword v16, v4, s[8:11], 0 offen sc1
    s_waitcnt vmcnt(0)
    v_readlane_b32 s62, v16, 0
    v_readlane_b32 s24, v16, 1
    s_min_i32 s62, s62, s24
    v_readlane_b32 s24, v16, 2
    s_min_i32 s62, s62, s24
    v_readlane_b32 s24, v16, 3
    s_min_i32 s62, s62, s24
    v_readlane_b32 s24, v16, 4
    s_min_i32 s62, s62, s24
    v_readlane_b32 s24, v16, 5
    s_min_i32 s62, s62, s24
    v_readlane_b32 s24, v16, 6
    s_min_i32 s62, s62, s24
    v_readlane_b32 s24, v16, 7
    s_min_i32 s62, s62, s24
    v_readlane_b32 s24, v16, 8
    s_min_i32 s62, s62, s24
    v_readlane_b32 s24, v16, 9
    s_min_i32 s62, s62, s24
    v_readlane_b32 s24, v16, 10
    s_min_i32 s62, s62, s24
    v_readlane_b32 s24, v16, 11
    s_min_i32 s62, s62, s24
    v_readlane_b32 s24, v16, 12
    s_min_i32 s62, s62, s24
    v_readlane_b32 s24, v16, 13
    s_min_i32 s62, s62, s24
    v_readlane_b32 s24, v16, 14
    s_min_i32 s62, s62, s24
    v_readlane_b32 s24, v16, 15
    s_min_i32 s62, s62, s24
    v_readlane_b32 s24, v16, 16
    s_min_i32 s62, s62, s24
    v_readlane_b32 s24, v16, 17
    s_min_i32 s62, s62, s24
    v_readlane_b32 s24, v16, 18
    s_min_i32 s62, s62, s24
    v_readlane_b32 s24, v16, 19
    s_min_i32 s62, s62, s24
    s_cmp_ge_i32 s62, s63
    s_cbranch_scc1 interleave_layers__linear_attn_block__memory_aug_recurrent_mem_tr__prompt_kernel_p_en0_ok
    s_add_u32 s61, s61, 1
    s_cmp_ge_u32 s61, s60
    s_cbranch_scc1 interleave_layers__linear_attn_block__memory_aug_recurrent_mem_tr__prompt_kernel_p_en0_to
    s_sleep 2
    s_branch interleave_layers__linear_attn_block__memory_aug_recurrent_mem_tr__prompt_kernel_p_en0
interleave_layers__linear_attn_block__memory_aug_recurrent_mem_tr__prompt_kernel_p_en0_to:
    s_mov_b32 s60, 1
interleave_layers__linear_attn_block__memory_aug_recurrent_mem_tr__prompt_kernel_p_en0_ok:
    s_mov_b32 s41, s73
    buffer_load_dwordx4 v[16:19], v6, s[8:11], s41 offen offset:0
    buffer_load_dwordx4 v[20:23], v6, s[8:11], s41 offen offset:1024
    buffer_load_dwordx4 v[24:27], v6, s[8:11], s41 offen offset:2048
    buffer_load_dwordx4 v[28:31], v6, s[8:11], s41 offen offset:3072
    buffer_load_dwordx4 v[32:35], v7, s[8:11], s41 offen offset:0
    buffer_load_dwordx4 v[36:39], v7, s[8:11], s41 offen offset:1024
    buffer_load_dwordx4 v[40:43], v7, s[8:11], s41 offen offset:2048
    buffer_load_dwordx4 v[44:47], v7, s[8:11], s41 offen offset:3072
    buffer_load_dwordx4 v[48:51], v8, s[8:11], s41 offen offset:0
    buffer_load_dwordx4 v[52:55], v8, s[8:11], s41 offen offset:1024
    s_mov_b32 s40, 0
    s_mov_b32 s42, 0
    s_waitcnt vmcnt(0)
    v_mfma_f32_16x16x32_bf16 v[148:151], v[16:19], v[16:19], 0
    v_mfma_f32_16x16x32_bf16 v[144:147], v[236:239], v[16:19], 0
    v_mfma_f32_16x16x32_bf16 v[148:151], v[20:23], v[20:23], v[148:151]
    v_mfma_f32_16x16x32_bf16 v[144:147], v[236:239], v[20:23], v[144:147]
    v_mfma_f32_16x16x32_bf16 v[148:151], v[24:27], v[24:27], v[148:151]
    v_mfma_f32_16x16x32_bf16 v[144:147], v[236:239], v[24:27], v[144:147]
    v_mfma_f32_16x16x32_bf16 v[148:151], v[28:31], v[28:31], v[148:151]
    v_mfma_f32_16x16x32_bf16 v[144:147], v[236:239], v[28:31], v[144:147]
    v_mfma_f32_16x16x32_bf16 v[148:151], v[32:35], v[32:35], v[148:151]
    v_mfma_f32_16x16x32_bf16 v[144:147], v[236:239], v[32:35], v[144:147]
    v_mfma_f32_16x16x32_bf16 v[148:151], v[36:39], v[36:39], v[148:151]
    v_mfma_f32_16x16x32_bf16 v[144:147], v[236:239], v[36:39], v[144:147]
    v_mfma_f32_16x16x32_bf16 v[148:151], v[40:43], v[40:43], v[148:151]
    v_mfma_f32_16x16x32_bf16 v[144:147], v[236:239], v[40:43], v[144:147]
    v_mfma_f32_16x16x32_bf16 v[148:151], v[44:47], v[44:47], v[148:151]
    v_mfma_f32_16x16x32_bf16 v[144:147], v[236:239], v[44:47], v[144:147]
    v_mfma_f32_16x16x32_bf16 v[148:151], v[48:51], v[48:51], v[148:151]
    v_mfma_f32_16x16x32_bf16 v[144:147], v[236:239], v[48:51], v[144:147]
    v_mfma_f32_16x16x32_bf16 v[148:151], v[52:55], v[52:55], v[148:151]
    v_mfma_f32_16x16x32_bf16 v[144:147], v[236:239], v[52:55], v[144:147]
    ds_write_b128 v6, v[16:19] offset:0
    ds_write_b128 v6, v[20:23] offset:1024
    ds_write_b128 v6, v[24:27] offset:2048
    ds_write_b128 v6, v[28:31] offset:3072
    ds_write_b128 v6, v[32:35] offset:4096
    ds_write_b128 v6, v[36:39] offset:5120
    ds_write_b128 v6, v[40:43] offset:6144
    ds_write_b128 v6, v[44:47] offset:7168
    ds_write_b128 v6, v[48:51] offset:8192
    ds_write_b128 v6, v[52:55] offset:9216
    v_cndmask_b32 v145, v148, v149, s[48:49]
    v_cndmask_b32 v145, v145, v150, s[50:51]
    v_cndmask_b32 v145, v145, v151, s[54:55]
    ds_write_b64 v12, v[144:145]
    s_waitcnt lgkmcnt(0)
    s_barrier
interleave_layers__linear_attn_block__memory_aug_recurrent_mem_tr__prompt_kernel_p_segA:
    v_add_u32 v9, s42, v5
    s_xor_b32 s42, s42, 40960
    v_add_u32 v10, s42, v6
    s_and_b32 s24, s40, 1
    s_lshl_b32 s24, s24, 9
    v_add_u32 v124, s24, v13
    s_xor_b32 s24, s24, 512
    v_add_u32 v140, s24, v12
    ds_read_b128 v[112:115], v124
    ds_read_b128 v[116:119], v124 offset:256
    ds_read_b128 v[56:59], v9 offset:0
    ds_read_b128 v[60:63], v9 offset:20480
    ds_read_b128 v[64:67], v9 offset:1024
    ds_read_b128 v[68:71], v9 offset:21504
    ds_read_b128 v[72:75], v9 offset:2048
    ds_read_b128 v[76:79], v9 offset:22528
    ds_read_b128 v[80:83], v9 offset:3072
    ds_read_b128 v[84:87], v9 offset:23552
    s_waitcnt lgkmcnt(6)
    v_mfma_f32_16x16x32_bf16 v[88:91], a[0:3], v[56:59], 0
    v_add_f32 v112, v112, v114
    v_mfma_f32_16x16x32_bf16 v[92:95], a[80:83], v[56:59], 0
    v_add_f32 v113, v113, v115
    v_mfma_f32_16x16x32_bf16 v[96:99], a[160:163], v[56:59], 0
    v_mul_f32 v112, 0x3acccccd, v112
    v_mfma_f32_16x16x32_bf16 v[100:103], a[0:3], v[60:63], 0
    v_mul_f32 v114, v112, v112
    v_mfma_f32_16x16x32_bf16 v[104:107], a[80:83], v[60:63], 0
    v_mov_b32 v115, 0x3acccccd
    v_mfma_f32_16x16x32_bf16 v[108:111], a[160:163], v[60:63], 0
    v_fma_f32 v113, v113, v115, -v114
    ds_read_b128 v[56:59], v9 offset:4096
    ds_read_b128 v[60:63], v9 offset:24576
    s_waitcnt lgkmcnt(6)
    v_mfma_f32_16x16x32_bf16 v[88:91], a[4:7], v[64:67], v[88:91]
    v_max_f32 v113, 0, v113
    v_mfma_f32_16x16x32_bf16 v[92:95], a[84:87], v[64:67], v[92:95]
    v_add_f32 v113, 0x3727c5ac, v113
    v_mfma_f32_16x16x32_bf16 v[96:99], a[164:167], v[64:67], v[96:99]
    v_rsq_f32 v132, v113
    v_mfma_f32_16x16x32_bf16 v[100:103], a[4:7], v[68:71], v[100:103]
    v_mul_f32 v133, v112, v132
    v_mfma_f32_16x16x32_bf16 v[104:107], a[84:87], v[68:71], v[104:107]
    v_sub_f32 v133, 0, v133
    v_mfma_f32_16x16x32_bf16 v[108:111], a[164:167], v[68:71], v[108:111]
    v_add_f32 v116, v116, v118
    ds_read_b128 v[64:67], v9 offset:5120
    ds_read_b128 v[68:71], v9 offset:25600
    s_waitcnt lgkmcnt(6)
    v_mfma_f32_16x16x32_bf16 v[88:91], a[8:11], v[72:75], v[88:91]
    v_add_f32 v117, v117, v119
    v_mfma_f32_16x16x32_bf16 v[92:95], a[88:91], v[72:75], v[92:95]
    v_mul_f32 v116, 0x3acccccd, v116
    v_mfma_f32_16x16x32_bf16 v[96:99], a[168:171], v[72:75], v[96:99]
    v_mul_f32 v118, v116, v116
    v_mfma_f32_16x16x32_bf16 v[100:103], a[8:11], v[76:79], v[100:103]
    v_mov_b32 v119, 0x3acccccd
    v_mfma_f32_16x16x32_bf16 v[104:107], a[88:91], v[76:79], v[104:107]
    v_fma_f32 v117, v117, v119, -v118
    v_mfma_f32_16x16x32_bf16 v[108:111], a[168:171], v[76:79], v[108:111]
    v_max_f32 v117, 0, v117
    ds_read_b128 v[72:75], v9 offset:6144
    ds_read_b128 v[76:79], v9 offset:26624
    s_waitcnt lgkmcnt(6)
    v_mfma_f32_16x16x32_bf16 v[88:91], a[12:15], v[80:83], v[88:91]
    v_add_f32 v117, 0x3727c5ac, v117
    v_mfma_f32_16x16x32_bf16 v[92:95], a[92:95], v[80:83], v[92:95]
    v_rsq_f32 v134, v117
    v_mfma_f32_16x16x32_bf16 v[96:99], a[172:175], v[80:83], v[96:99]
    v_mul_f32 v135, v116, v134
    v_mfma_f32_16x16x32_bf16 v[100:103], a[12:15], v[84:87], v[100:103]
    v_sub_f32 v135, 0, v135
    v_mfma_f32_16x16x32_bf16 v[104:107], a[92:95], v[84:87], v[104:107]
    v_mfma_f32_16x16x32_bf16 v[108:111], a[172:175], v[84:87], v[108:111]
    ds_read_b128 v[80:83], v9 offset:7168
    ds_read_b128 v[84:87], v9 offset:27648
    s_waitcnt lgkmcnt(6)
    v_mfma_f32_16x16x32_bf16 v[88:91], a[16:19], v[56:59], v[88:91]
    v_mfma_f32_16x16x32_bf16 v[92:95], a[96:99], v[56:59], v[92:95]
    v_mfma_f32_16x16x32_bf16 v[96:99], a[176:179], v[56:59], v[96:99]
    v_mfma_f32_16x16x32_bf16 v[100:103], a[16:19], v[60:63], v[100:103]
    v_mfma_f32_16x16x32_bf16 v[104:107], a[96:99], v[60:63], v[104:107]
    v_mfma_f32_16x16x32_bf16 v[108:111], a[176:179], v[60:63], v[108:111]
    ds_read_b128 v[56:59], v9 offset:8192
    ds_read_b128 v[60:63], v9 offset:28672
    s_waitcnt lgkmcnt(6)
    v_mfma_f32_16x16x32_bf16 v[88:91], a[20:23], v[64:67], v[88:91]
    v_mfma_f32_16x16x32_bf16 v[92:95], a[100:103], v[64:67], v[92:95]
    v_mfma_f32_16x16x32_bf16 v[96:99], a[180:183], v[64:67], v[96:99]
    v_mfma_f32_16x16x32_bf16 v[100:103], a[20:23], v[68:71], v[100:103]
    v_mfma_f32_16x16x32_bf16 v[104:107], a[100:103], v[68:71], v[104:107]
    v_mfma_f32_16x16x32_bf16 v[108:111], a[180:183], v[68:71], v[108:111]
    ds_read_b128 v[64:67], v9 offset:9216
    ds_read_b128 v[68:71], v9 offset:29696
    s_waitcnt lgkmcnt(6)
    v_mfma_f32_16x16x32_bf16 v[88:91], a[24:27], v[72:75], v[88:91]
    v_mfma_f32_16x16x32_bf16 v[92:95], a[104:107], v[72:75], v[92:95]
    v_mfma_f32_16x16x32_bf16 v[96:99], a[184:187], v[72:75], v[96:99]
    v_mfma_f32_16x16x32_bf16 v[100:103], a[24:27], v[76:79], v[100:103]
    v_mfma_f32_16x16x32_bf16 v[104:107], a[104:107], v[76:79], v[104:107]
    v_mfma_f32_16x16x32_bf16 v[108:111], a[184:187], v[76:79], v[108:111]
    ds_read_b128 v[72:75], v9 offset:10240
    ds_read_b128 v[76:79], v9 offset:30720
    s_waitcnt lgkmcnt(6)
    v_mfma_f32_16x16x32_bf16 v[88:91], a[28:31], v[80:83], v[88:91]
    v_mfma_f32_16x16x32_bf16 v[92:95], a[108:111], v[80:83], v[92:95]
    v_mfma_f32_16x16x32_bf16 v[96:99], a[188:191], v[80:83], v[96:99]
    v_mfma_f32_16x16x32_bf16 v[100:103], a[28:31], v[84:87], v[100:103]
    v_mfma_f32_16x16x32_bf16 v[104:107], a[108:111], v[84:87], v[104:107]
    v_mfma_f32_16x16x32_bf16 v[108:111], a[188:191], v[84:87], v[108:111]
    ds_read_b128 v[80:83], v9 offset:11264
    ds_read_b128 v[84:87], v9 offset:31744
    s_waitcnt lgkmcnt(6)
    v_mfma_f32_16x16x32_bf16 v[88:91], a[32:35], v[56:59], v[88:91]
    v_mfma_f32_16x16x32_bf16 v[92:95], a[112:115], v[56:59], v[92:95]
    v_mfma_f32_16x16x32_bf16 v[96:99], a[192:195], v[56:59], v[96:99]
    v_mfma_f32_16x16x32_bf16 v[100:103], a[32:35], v[60:63], v[100:103]
    v_mfma_f32_16x16x32_bf16 v[104:107], a[112:115], v[60:63], v[104:107]
    v_mfma_f32_16x16x32_bf16 v[108:111], a[192:195], v[60:63], v[108:111]
    ds_read_b128 v[56:59], v9 offset:12288
    ds_read_b128 v[60:63], v9 offset:32768
    s_waitcnt lgkmcnt(6)
    v_mfma_f32_16x16x32_bf16 v[88:91], a[36:39], v[64:67], v[88:91]
    v_mfma_f32_16x16x32_bf16 v[92:95], a[116:119], v[64:67], v[92:95]
    v_mfma_f32_16x16x32_bf16 v[96:99], a[196:199], v[64:67], v[96:99]
    v_mfma_f32_16x16x32_bf16 v[100:103], a[36:39], v[68:71], v[100:103]
    v_mfma_f32_16x16x32_bf16 v[104:107], a[116:119], v[68:71], v[104:107]
    v_mfma_f32_16x16x32_bf16 v[108:111], a[196:199], v[68:71], v[108:111]
    ds_read_b128 v[64:67], v9 offset:13312
    ds_read_b128 v[68:71], v9 offset:33792
    s_waitcnt lgkmcnt(6)
    v_mfma_f32_16x16x32_bf16 v[88:91], a[40:43], v[72:75], v[88:91]
    v_mfma_f32_16x16x32_bf16 v[92:95], a[120:123], v[72:75], v[92:95]
    v_mfma_f32_16x16x32_bf16 v[96:99], a[200:203], v[72:75], v[96:99]
    v_mfma_f32_16x16x32_bf16 v[100:103], a[40:43], v[76:79], v[100:103]
    v_mfma_f32_16x16x32_bf16 v[104:107], a[120:123], v[76:79], v[104:107]
    v_mfma_f32_16x16x32_bf16 v[108:111], a[200:203], v[76:79], v[108:111]
    ds_read_b128 v[72:75], v9 offset:14336
    ds_read_b128 v[76:79], v9 offset:34816
    s_waitcnt lgkmcnt(6)
    v_mfma_f32_16x16x32_bf16 v[88:91], a[44:47], v[80:83], v[88:91]
    v_mfma_f32_16x16x32_bf16 v[92:95], a[124:127], v[80:83], v[92:95]
    v_mfma_f32_16x16x32_bf16 v[96:99], a[204:207], v[80:83], v[96:99]
    v_mfma_f32_16x16x32_bf16 v[100:103], a[44:47], v[84:87], v[100:103]
    v_mfma_f32_16x16x32_bf16 v[104:107], a[124:127], v[84:87], v[104:107]
    v_mfma_f32_16x16x32_bf16 v[108:111], a[204:207], v[84:87], v[108:111]
    ds_read_b128 v[80:83], v9 offset:15360
    ds_read_b128 v[84:87], v9 offset:35840
    s_waitcnt lgkmcnt(6)
    v_mfma_f32_16x16x32_bf16 v[88:91], a[48:51], v[56:59], v[88:91]
    v_mfma_f32_16x16x32_bf16 v[92:95], a[128:131], v[56:59], v[92:95]
    v_mfma_f32_16x16x32_bf16 v[96:99], a[208:211], v[56:59], v[96:99]
    v_mfma_f32_16x16x32_bf16 v[100:103], a[48:51], v[60:63], v[100:103]
    v_mfma_f32_16x16x32_bf16 v[104:107], a[128:131], v[60:63], v[104:107]
    v_mfma_f32_16x16x32_bf16 v[108:111], a[208:211], v[60:63], v[108:111]
    ds_read_b128 v[56:59], v9 offset:16384
    ds_read_b128 v[60:63], v9 offset:36864
    s_waitcnt lgkmcnt(6)
    v_mfma_f32_16x16x32_bf16 v[88:91], a[52:55], v[64:67], v[88:91]
    v_mfma_f32_16x16x32_bf16 v[92:95], a[132:135], v[64:67], v[92:95]
    v_mfma_f32_16x16x32_bf16 v[96:99], a[212:215], v[64:67], v[96:99]
    v_mfma_f32_16x16x32_bf16 v[100:103], a[52:55], v[68:71], v[100:103]
    v_mfma_f32_16x16x32_bf16 v[104:107], a[132:135], v[68:71], v[104:107]
    v_mfma_f32_16x16x32_bf16 v[108:111], a[212:215], v[68:71], v[108:111]
    ds_read_b128 v[64:67], v9 offset:17408
    ds_read_b128 v[68:71], v9 offset:37888
    s_waitcnt lgkmcnt(6)
    v_mfma_f32_16x16x32_bf16 v[88:91], a[56:59], v[72:75], v[88:91]
    v_mfma_f32_16x16x32_bf16 v[92:95], a[136:139], v[72:75], v[92:95]
    v_mfma_f32_16x16x32_bf16 v[96:99], a[216:219], v[72:75], v[96:99]
    v_mfma_f32_16x16x32_bf16 v[100:103], a[56:59], v[76:79], v[100:103]
    v_mfma_f32_16x16x32_bf16 v[104:107], a[136:139], v[76:79], v[104:107]
    v_mfma_f32_16x16x32_bf16 v[108:111], a[216:219], v[76:79], v[108:111]
    ds_read_b128 v[72:75], v9 offset:18432
    ds_read_b128 v[76:79], v9 offset:38912
    s_waitcnt lgkmcnt(6)
    v_mfma_f32_16x16x32_bf16 v[88:91], a[60:63], v[80:83], v[88:91]
    v_mfma_f32_16x16x32_bf16 v[92:95], a[140:143], v[80:83], v[92:95]
    v_mfma_f32_16x16x32_bf16 v[96:99], a[220:223], v[80:83], v[96:99]
    v_mfma_f32_16x16x32_bf16 v[100:103], a[60:63], v[84:87], v[100:103]
    v_mfma_f32_16x16x32_bf16 v[104:107], a[140:143], v[84:87], v[104:107]
    v_mfma_f32_16x16x32_bf16 v[108:111], a[220:223], v[84:87], v[108:111]
    ds_read_b128 v[80:83], v9 offset:19456
    ds_read_b128 v[84:87], v9 offset:39936
    s_waitcnt lgkmcnt(6)
    v_mfma_f32_16x16x32_bf16 v[88:91], a[64:67], v[56:59], v[88:91]
    v_mfma_f32_16x16x32_bf16 v[92:95], a[144:147], v[56:59], v[92:95]
    v_mfma_f32_16x16x32_bf16 v[96:99], a[224:227], v[56:59], v[96:99]
    v_mfma_f32_16x16x32_bf16 v[100:103], a[64:67], v[60:63], v[100:103]
    v_mfma_f32_16x16x32_bf16 v[104:107], a[144:147], v[60:63], v[104:107]
    v_mfma_f32_16x16x32_bf16 v[108:111], a[224:227], v[60:63], v[108:111]
    s_waitcnt lgkmcnt(4)
    v_mfma_f32_16x16x32_bf16 v[88:91], a[68:71], v[64:67], v[88:91]
    v_mfma_f32_16x16x32_bf16 v[92:95], a[148:151], v[64:67], v[92:95]
    v_mfma_f32_16x16x32_bf16 v[96:99], a[228:231], v[64:67], v[96:99]
    v_mfma_f32_16x16x32_bf16 v[100:103], a[68:71], v[68:71], v[100:103]
    v_mfma_f32_16x16x32_bf16 v[104:107], a[148:151], v[68:71], v[104:107]
    v_mfma_f32_16x16x32_bf16 v[108:111], a[228:231], v[68:71], v[108:111]
    s_waitcnt lgkmcnt(2)
    v_mfma_f32_16x16x32_bf16 v[88:91], a[72:75], v[72:75], v[88:91]
    v_mfma_f32_16x16x32_bf16 v[92:95], a[152:155], v[72:75], v[92:95]
    v_mfma_f32_16x16x32_bf16 v[96:99], a[232:235], v[72:75], v[96:99]
    v_mfma_f32_16x16x32_bf16 v[100:103], a[72:75], v[76:79], v[100:103]
    v_mfma_f32_16x16x32_bf16 v[104:107], a[152:155], v[76:79], v[104:107]
    v_mfma_f32_16x16x32_bf16 v[108:111], a[232:235], v[76:79], v[108:111]
    s_waitcnt lgkmcnt(0)
    v_mfma_f32_16x16x32_bf16 v[88:91], a[76:79], v[80:83], v[88:91]
    v_mfma_f32_16x16x32_bf16 v[92:95], a[156:159], v[80:83], v[92:95]
    v_mfma_f32_16x16x32_bf16 v[96:99], a[236:239], v[80:83], v[96:99]
    v_mfma_f32_16x16x32_bf16 v[100:103], a[76:79], v[84:87], v[100:103]
    v_mfma_f32_16x16x32_bf16 v[104:107], a[156:159], v[84:87], v[104:107]
    v_mfma_f32_16x16x32_bf16 v[108:111], a[236:239], v[84:87], v[108:111]
    v_pk_mul_f32 v[124:125], v[224:225], v[132:133] op_sel:[0,1] op_sel_hi:[1,1]
    v_pk_mul_f32 v[126:127], v[226:227], v[132:133] op_sel:[0,1] op_sel_hi:[1,1]
    s_nop 0
    v_pk_fma_f32 v[88:89], v[88:89], v[132:133], v[124:125] op_sel:[0,0,0] op_sel_hi:[1,0,1]
    v_pk_fma_f32 v[90:91], v[90:91], v[132:133], v[126:127] op_sel:[0,0,0] op_sel_hi:[1,0,1]
    v_pk_mul_f32 v[124:125], v[228:229], v[132:133] op_sel:[0,1] op_sel_hi:[1,1]
    v_pk_mul_f32 v[126:127], v[230:231], v[132:133] op_sel:[0,1] op_sel_hi:[1,1]
    v_pk_fma_f32 v[92:93], v[92:93], v[132:133], v[124:125] op_sel:[0,0,0] op_sel_hi:[1,0,1]
    v_pk_fma_f32 v[94:95], v[94:95], v[132:133], v[126:127] op_sel:[0,0,0] op_sel_hi:[1,0,1]
    v_pk_mul_f32 v[124:125], v[232:233], v[132:133] op_sel:[0,1] op_sel_hi:[1,1]
    v_pk_mul_f32 v[126:127], v[234:235], v[132:133] op_sel:[0,1] op_sel_hi:[1,1]
    v_pk_fma_f32 v[96:97], v[96:97], v[132:133], v[124:125] op_sel:[0,0,0] op_sel_hi:[1,0,1]
    v_pk_fma_f32 v[98:99], v[98:99], v[132:133], v[126:127] op_sel:[0,0,0] op_sel_hi:[1,0,1]
    v_pk_mul_f32 v[124:125], v[224:225], v[134:135] op_sel:[0,1] op_sel_hi:[1,1]
    v_pk_mul_f32 v[126:127], v[226:227], v[134:135] op_sel:[0,1] op_sel_hi:[1,1]
    v_pk_fma_f32 v[100:101], v[100:101], v[134:135], v[124:125] op_sel:[0,0,0] op_sel_hi:[1,0,1]
    v_pk_fma_f32 v[102:103], v[102:103], v[134:135], v[126:127] op_sel:[0,0,0] op_sel_hi:[1,0,1]
    v_pk_mul_f32 v[124:125], v[228:229], v[134:135] op_sel:[0,1] op_sel_hi:[1,1]
    v_pk_mul_f32 v[126:127], v[230:231], v[134:135] op_sel:[0,1] op_sel_hi:[1,1]
    v_pk_fma_f32 v[104:105], v[104:105], v[134:135], v[124:125] op_sel:[0,0,0] op_sel_hi:[1,0,1]
    v_pk_fma_f32 v[106:107], v[106:107], v[134:135], v[126:127] op_sel:[0,0,0] op_sel_hi:[1,0,1]
    v_pk_mul_f32 v[124:125], v[232:233], v[134:135] op_sel:[0,1] op_sel_hi:[1,1]
    v_pk_mul_f32 v[126:127], v[234:235], v[134:135] op_sel:[0,1] op_sel_hi:[1,1]
    v_pk_fma_f32 v[108:109], v[108:109], v[134:135], v[124:125] op_sel:[0,0,0] op_sel_hi:[1,0,1]
    v_pk_fma_f32 v[110:111], v[110:111], v[134:135], v[126:127] op_sel:[0,0,0] op_sel_hi:[1,0,1]
    v_cvt_pk_bf16_f32 v112, v88, v89
    v_cvt_pk_bf16_f32 v113, v90, v91
    v_cvt_pk_bf16_f32 v114, v92, v93
    v_cvt_pk_bf16_f32 v115, v94, v95
    v_cvt_pk_bf16_f32 v116, v100, v101
    v_cvt_pk_bf16_f32 v117, v102, v103
    v_cvt_pk_bf16_f32 v118, v104, v105
    v_cvt_pk_bf16_f32 v119, v106, v107
    v_cvt_pk_bf16_f32 v120, v96, v97
    v_cvt_pk_bf16_f32 v121, v98, v99
    v_cvt_pk_bf16_f32 v122, v108, v109
    v_cvt_pk_bf16_f32 v123, v110, v111
    buffer_store_dwordx4 v[112:115], v11, s[8:11], s43 offen offset:0 sc1
    buffer_store_dwordx4 v[116:119], v11, s[8:11], s43 offen offset:1024 sc1
    buffer_store_dwordx4 v[120:123], v11, s[8:11], s43 offen offset:2048 sc1
    s_add_u32 s43, s43, 393216
    s_waitcnt vmcnt(0)
    s_barrier
    s_add_u32 s24, s40, 1
    v_mov_b32 v15, s24
    buffer_store_dword v15, v14, s[8:11], 0 offen sc1
    s_add_u32 s63, s40, 1
    s_lshr_b32 s63, s63, s75
    s_add_u32 s63, s63, 1
    s_min_u32 s63, s63, s74
    s_cmp_ge_i32 s62, s63
    s_cbranch_scc1 interleave_layers__linear_attn_block__memory_aug_recurrent_mem_tr__prompt_kernel_p_enA_ok
    s_mov_b32 s61, 0
interleave_layers__linear_attn_block__memory_aug_recurrent_mem_tr__prompt_kernel_p_enA:
    buffer_load_dword v16, v4, s[8:11], 0 offen sc1
    s_waitcnt vmcnt(0)
    v_readlane_b32 s62, v16, 0
    v_readlane_b32 s24, v16, 1
    s_min_i32 s62, s62, s24
    v_readlane_b32 s24, v16, 2
    s_min_i32 s62, s62, s24
    v_readlane_b32 s24, v16, 3
    s_min_i32 s62, s62, s24
    v_readlane_b32 s24, v16, 4
    s_min_i32 s62, s62, s24
    v_readlane_b32 s24, v16, 5
    s_min_i32 s62, s62, s24
    v_readlane_b32 s24, v16, 6
    s_min_i32 s62, s62, s24
    v_readlane_b32 s24, v16, 7
    s_min_i32 s62, s62, s24
    v_readlane_b32 s24, v16, 8
    s_min_i32 s62, s62, s24
    v_readlane_b32 s24, v16, 9
    s_min_i32 s62, s62, s24
    v_readlane_b32 s24, v16, 10
    s_min_i32 s62, s62, s24
    v_readlane_b32 s24, v16, 11
    s_min_i32 s62, s62, s24
    v_readlane_b32 s24, v16, 12
    s_min_i32 s62, s62, s24
    v_readlane_b32 s24, v16, 13
    s_min_i32 s62, s62, s24
    v_readlane_b32 s24, v16, 14
    s_min_i32 s62, s62, s24
    v_readlane_b32 s24, v16, 15
    s_min_i32 s62, s62, s24
    v_readlane_b32 s24, v16, 16
    s_min_i32 s62, s62, s24
    v_readlane_b32 s24, v16, 17
    s_min_i32 s62, s62, s24
    v_readlane_b32 s24, v16, 18
    s_min_i32 s62, s62, s24
    v_readlane_b32 s24, v16, 19
    s_min_i32 s62, s62, s24
    s_cmp_ge_i32 s62, s63
    s_cbranch_scc1 interleave_layers__linear_attn_block__memory_aug_recurrent_mem_tr__prompt_kernel_p_enA_ok
    s_add_u32 s61, s61, 1
    s_cmp_ge_u32 s61, s60
    s_cbranch_scc1 interleave_layers__linear_attn_block__memory_aug_recurrent_mem_tr__prompt_kernel_p_enA_to
    s_sleep 2
    s_branch interleave_layers__linear_attn_block__memory_aug_recurrent_mem_tr__prompt_kernel_p_enA
interleave_layers__linear_attn_block__memory_aug_recurrent_mem_tr__prompt_kernel_p_enA_to:
    s_mov_b32 s60, 1
interleave_layers__linear_attn_block__memory_aug_recurrent_mem_tr__prompt_kernel_p_enA_ok:
    s_add_u32 s41, s41, 40960
    buffer_load_dwordx4 v[16:19], v6, s[8:11], s41 offen offset:0
    buffer_load_dwordx4 v[20:23], v6, s[8:11], s41 offen offset:1024
    buffer_load_dwordx4 v[24:27], v6, s[8:11], s41 offen offset:2048
    buffer_load_dwordx4 v[28:31], v6, s[8:11], s41 offen offset:3072
    buffer_load_dwordx4 v[32:35], v7, s[8:11], s41 offen offset:0
    buffer_load_dwordx4 v[36:39], v7, s[8:11], s41 offen offset:1024
    buffer_load_dwordx4 v[40:43], v7, s[8:11], s41 offen offset:2048
    buffer_load_dwordx4 v[44:47], v7, s[8:11], s41 offen offset:3072
    buffer_load_dwordx4 v[48:51], v8, s[8:11], s41 offen offset:0
    buffer_load_dwordx4 v[52:55], v8, s[8:11], s41 offen offset:1024
    s_waitcnt vmcnt(0)
    v_mfma_f32_16x16x32_bf16 v[148:151], v[16:19], v[16:19], 0
    v_mfma_f32_16x16x32_bf16 v[144:147], v[236:239], v[16:19], 0
    v_mfma_f32_16x16x32_bf16 v[148:151], v[20:23], v[20:23], v[148:151]
    v_mfma_f32_16x16x32_bf16 v[144:147], v[236:239], v[20:23], v[144:147]
    v_mfma_f32_16x16x32_bf16 v[148:151], v[24:27], v[24:27], v[148:151]
    v_mfma_f32_16x16x32_bf16 v[144:147], v[236:239], v[24:27], v[144:147]
    v_mfma_f32_16x16x32_bf16 v[148:151], v[28:31], v[28:31], v[148:151]
    v_mfma_f32_16x16x32_bf16 v[144:147], v[236:239], v[28:31], v[144:147]
    v_mfma_f32_16x16x32_bf16 v[148:151], v[32:35], v[32:35], v[148:151]
    v_mfma_f32_16x16x32_bf16 v[144:147], v[236:239], v[32:35], v[144:147]
    v_mfma_f32_16x16x32_bf16 v[148:151], v[36:39], v[36:39], v[148:151]
    v_mfma_f32_16x16x32_bf16 v[144:147], v[236:239], v[36:39], v[144:147]
    v_mfma_f32_16x16x32_bf16 v[148:151], v[40:43], v[40:43], v[148:151]
    v_mfma_f32_16x16x32_bf16 v[144:147], v[236:239], v[40:43], v[144:147]
    v_mfma_f32_16x16x32_bf16 v[148:151], v[44:47], v[44:47], v[148:151]
    v_mfma_f32_16x16x32_bf16 v[144:147], v[236:239], v[44:47], v[144:147]
    v_mfma_f32_16x16x32_bf16 v[148:151], v[48:51], v[48:51], v[148:151]
    v_mfma_f32_16x16x32_bf16 v[144:147], v[236:239], v[48:51], v[144:147]
    v_mfma_f32_16x16x32_bf16 v[148:151], v[52:55], v[52:55], v[148:151]
    v_mfma_f32_16x16x32_bf16 v[144:147], v[236:239], v[52:55], v[144:147]
    ds_write_b128 v10, v[16:19] offset:0
    ds_write_b128 v10, v[20:23] offset:1024
    ds_write_b128 v10, v[24:27] offset:2048
    ds_write_b128 v10, v[28:31] offset:3072
    ds_write_b128 v10, v[32:35] offset:4096
    ds_write_b128 v10, v[36:39] offset:5120
    ds_write_b128 v10, v[40:43] offset:6144
    ds_write_b128 v10, v[44:47] offset:7168
    ds_write_b128 v10, v[48:51] offset:8192
    ds_write_b128 v10, v[52:55] offset:9216
    v_cndmask_b32 v145, v148, v149, s[48:49]
    v_cndmask_b32 v145, v145, v150, s[50:51]
    v_cndmask_b32 v145, v145, v151, s[54:55]
    ds_write_b64 v140, v[144:145]
    s_add_u32 s40, s40, 1
    s_waitcnt lgkmcnt(0)
    s_barrier
    s_cmp_lt_u32 s40, 2
    s_cbranch_scc1 interleave_layers__linear_attn_block__memory_aug_recurrent_mem_tr__prompt_kernel_p_segA
    s_branch interleave_layers__linear_attn_block__memory_aug_recurrent_mem_tr__prompt_kernel_p_next
interleave_layers__linear_attn_block__memory_aug_recurrent_mem_tr__prompt_kernel_p_seg:
    v_add_u32 v9, s42, v5
    s_xor_b32 s42, s42, 40960
    v_add_u32 v10, s42, v6
    s_add_u32 s63, s40, 1
    s_lshr_b32 s63, s63, s75
    s_add_u32 s63, s63, 1
    s_min_u32 s63, s63, s74
    s_cmp_ge_i32 s62, s63
    s_cbranch_scc1 interleave_layers__linear_attn_block__memory_aug_recurrent_mem_tr__prompt_kernel_p_en_ok
    s_mov_b32 s61, 0
interleave_layers__linear_attn_block__memory_aug_recurrent_mem_tr__prompt_kernel_p_en:
    buffer_load_dword v16, v4, s[8:11], 0 offen sc1
    s_waitcnt vmcnt(0)
    v_readlane_b32 s62, v16, 0
    v_readlane_b32 s24, v16, 1
    s_min_i32 s62, s62, s24
    v_readlane_b32 s24, v16, 2
    s_min_i32 s62, s62, s24
    v_readlane_b32 s24, v16, 3
    s_min_i32 s62, s62, s24
    v_readlane_b32 s24, v16, 4
    s_min_i32 s62, s62, s24
    v_readlane_b32 s24, v16, 5
    s_min_i32 s62, s62, s24
    v_readlane_b32 s24, v16, 6
    s_min_i32 s62, s62, s24
    v_readlane_b32 s24, v16, 7
    s_min_i32 s62, s62, s24
    v_readlane_b32 s24, v16, 8
    s_min_i32 s62, s62, s24
    v_readlane_b32 s24, v16, 9
    s_min_i32 s62, s62, s24
    v_readlane_b32 s24, v16, 10
    s_min_i32 s62, s62, s24
    v_readlane_b32 s24, v16, 11
    s_min_i32 s62, s62, s24
    v_readlane_b32 s24, v16, 12
    s_min_i32 s62, s62, s24
    v_readlane_b32 s24, v16, 13
    s_min_i32 s62, s62, s24
    v_readlane_b32 s24, v16, 14
    s_min_i32 s62, s62, s24
    v_readlane_b32 s24, v16, 15
    s_min_i32 s62, s62, s24
    v_readlane_b32 s24, v16, 16
    s_min_i32 s62, s62, s24
    v_readlane_b32 s24, v16, 17
    s_min_i32 s62, s62, s24
    v_readlane_b32 s24, v16, 18
    s_min_i32 s62, s62, s24
    v_readlane_b32 s24, v16, 19
    s_min_i32 s62, s62, s24
    s_cmp_ge_i32 s62, s63
    s_cbranch_scc1 interleave_layers__linear_attn_block__memory_aug_recurrent_mem_tr__prompt_kernel_p_en_ok
    s_add_u32 s61, s61, 1
    s_cmp_ge_u32 s61, s60
    s_cbranch_scc1 interleave_layers__linear_attn_block__memory_aug_recurrent_mem_tr__prompt_kernel_p_en_to
    s_sleep 2
    s_branch interleave_layers__linear_attn_block__memory_aug_recurrent_mem_tr__prompt_kernel_p_en
interleave_layers__linear_attn_block__memory_aug_recurrent_mem_tr__prompt_kernel_p_en_to:
    s_mov_b32 s60, 1
interleave_layers__linear_attn_block__memory_aug_recurrent_mem_tr__prompt_kernel_p_en_ok:
    s_add_u32 s41, s41, 40960
    buffer_load_dwordx4 v[16:19], v6, s[8:11], s41 offen offset:0
    buffer_load_dwordx4 v[20:23], v6, s[8:11], s41 offen offset:1024
    buffer_load_dwordx4 v[24:27], v6, s[8:11], s41 offen offset:2048
    buffer_load_dwordx4 v[28:31], v6, s[8:11], s41 offen offset:3072
    buffer_load_dwordx4 v[32:35], v7, s[8:11], s41 offen offset:0
    buffer_load_dwordx4 v[36:39], v7, s[8:11], s41 offen offset:1024
    buffer_load_dwordx4 v[40:43], v7, s[8:11], s41 offen offset:2048
    buffer_load_dwordx4 v[44:47], v7, s[8:11], s41 offen offset:3072
    buffer_load_dwordx4 v[48:51], v8, s[8:11], s41 offen offset:0
    buffer_load_dwordx4 v[52:55], v8, s[8:11], s41 offen offset:1024
    s_and_b32 s24, s40, 1
    s_lshl_b32 s24, s24, 9
    v_add_u32 v124, s24, v13
    s_xor_b32 s24, s24, 512
    v_add_u32 v140, s24, v12
    ds_read_b128 v[112:115], v124
    ds_read_b128 v[116:119], v124 offset:256
    ds_read_b128 v[56:59], v9 offset:0
    ds_read_b128 v[60:63], v9 offset:20480
    ds_read_b128 v[64:67], v9 offset:1024
    ds_read_b128 v[68:71], v9 offset:21504
    ds_read_b128 v[72:75], v9 offset:2048
    ds_read_b128 v[76:79], v9 offset:22528
    ds_read_b128 v[80:83], v9 offset:3072
    ds_read_b128 v[84:87], v9 offset:23552
    s_waitcnt lgkmcnt(6)
    v_mfma_f32_16x16x32_bf16 v[88:91], a[0:3], v[56:59], 0
    v_add_f32 v112, v112, v114
    v_mfma_f32_16x16x32_bf16 v[92:95], a[80:83], v[56:59], 0
    v_add_f32 v113, v113, v115
    v_mfma_f32_16x16x32_bf16 v[96:99], a[160:163], v[56:59], 0
    v_mul_f32 v112, 0x3acccccd, v112
    v_mfma_f32_16x16x32_bf16 v[100:103], a[0:3], v[60:63], 0
    v_mul_f32 v114, v112, v112
    v_mfma_f32_16x16x32_bf16 v[104:107], a[80:83], v[60:63], 0
    v_mov_b32 v115, 0x3acccccd
    v_mfma_f32_16x16x32_bf16 v[108:111], a[160:163], v[60:63], 0
    v_fma_f32 v113, v113, v115, -v114
    ds_read_b128 v[56:59], v9 offset:4096
    ds_read_b128 v[60:63], v9 offset:24576
    s_waitcnt lgkmcnt(6)
    v_mfma_f32_16x16x32_bf16 v[88:91], a[4:7], v[64:67], v[88:91]
    v_max_f32 v113, 0, v113
    v_mfma_f32_16x16x32_bf16 v[92:95], a[84:87], v[64:67], v[92:95]
    v_add_f32 v113, 0x3727c5ac, v113
    v_mfma_f32_16x16x32_bf16 v[96:99], a[164:167], v[64:67], v[96:99]
    v_rsq_f32 v132, v113
    v_mfma_f32_16x16x32_bf16 v[100:103], a[4:7], v[68:71], v[100:103]
    v_mul_f32 v133, v112, v132
    v_mfma_f32_16x16x32_bf16 v[104:107], a[84:87], v[68:71], v[104:107]
    v_sub_f32 v133, 0, v133
    v_mfma_f32_16x16x32_bf16 v[108:111], a[164:167], v[68:71], v[108:111]
    v_add_f32 v116, v116, v118
    ds_read_b128 v[64:67], v9 offset:5120
    ds_read_b128 v[68:71], v9 offset:25600
    s_waitcnt lgkmcnt(6)
    v_mfma_f32_16x16x32_bf16 v[88:91], a[8:11], v[72:75], v[88:91]
    v_add_f32 v117, v117, v119
    v_mfma_f32_16x16x32_bf16 v[92:95], a[88:91], v[72:75], v[92:95]
    v_mul_f32 v116, 0x3acccccd, v116
    v_mfma_f32_16x16x32_bf16 v[96:99], a[168:171], v[72:75], v[96:99]
    v_mul_f32 v118, v116, v116
    v_mfma_f32_16x16x32_bf16 v[100:103], a[8:11], v[76:79], v[100:103]
    v_mov_b32 v119, 0x3acccccd
    v_mfma_f32_16x16x32_bf16 v[104:107], a[88:91], v[76:79], v[104:107]
    v_fma_f32 v117, v117, v119, -v118
    v_mfma_f32_16x16x32_bf16 v[108:111], a[168:171], v[76:79], v[108:111]
    v_max_f32 v117, 0, v117
    ds_read_b128 v[72:75], v9 offset:6144
    ds_read_b128 v[76:79], v9 offset:26624
    s_waitcnt lgkmcnt(6)
    v_mfma_f32_16x16x32_bf16 v[88:91], a[12:15], v[80:83], v[88:91]
    v_add_f32 v117, 0x3727c5ac, v117
    v_mfma_f32_16x16x32_bf16 v[92:95], a[92:95], v[80:83], v[92:95]
    v_rsq_f32 v134, v117
    v_mfma_f32_16x16x32_bf16 v[96:99], a[172:175], v[80:83], v[96:99]
    v_mul_f32 v135, v116, v134
    v_mfma_f32_16x16x32_bf16 v[100:103], a[12:15], v[84:87], v[100:103]
    v_sub_f32 v135, 0, v135
    v_mfma_f32_16x16x32_bf16 v[104:107], a[92:95], v[84:87], v[104:107]
    v_mfma_f32_16x16x32_bf16 v[108:111], a[172:175], v[84:87], v[108:111]
    ds_read_b128 v[80:83], v9 offset:7168
    ds_read_b128 v[84:87], v9 offset:27648
    s_waitcnt lgkmcnt(6)
    v_mfma_f32_16x16x32_bf16 v[88:91], a[16:19], v[56:59], v[88:91]
    v_mfma_f32_16x16x32_bf16 v[92:95], a[96:99], v[56:59], v[92:95]
    v_mfma_f32_16x16x32_bf16 v[96:99], a[176:179], v[56:59], v[96:99]
    v_mfma_f32_16x16x32_bf16 v[100:103], a[16:19], v[60:63], v[100:103]
    v_mfma_f32_16x16x32_bf16 v[104:107], a[96:99], v[60:63], v[104:107]
    v_mfma_f32_16x16x32_bf16 v[108:111], a[176:179], v[60:63], v[108:111]
    ds_read_b128 v[56:59], v9 offset:8192
    ds_read_b128 v[60:63], v9 offset:28672
    s_waitcnt lgkmcnt(6)
    v_mfma_f32_16x16x32_bf16 v[88:91], a[20:23], v[64:67], v[88:91]
    v_mfma_f32_16x16x32_bf16 v[92:95], a[100:103], v[64:67], v[92:95]
    v_mfma_f32_16x16x32_bf16 v[96:99], a[180:183], v[64:67], v[96:99]
    v_mfma_f32_16x16x32_bf16 v[100:103], a[20:23], v[68:71], v[100:103]
    v_mfma_f32_16x16x32_bf16 v[104:107], a[100:103], v[68:71], v[104:107]
    v_mfma_f32_16x16x32_bf16 v[108:111], a[180:183], v[68:71], v[108:111]
    ds_read_b128 v[64:67], v9 offset:9216
    ds_read_b128 v[68:71], v9 offset:29696
    s_waitcnt lgkmcnt(6)
    v_mfma_f32_16x16x32_bf16 v[88:91], a[24:27], v[72:75], v[88:91]
    v_mfma_f32_16x16x32_bf16 v[92:95], a[104:107], v[72:75], v[92:95]
    v_mfma_f32_16x16x32_bf16 v[96:99], a[184:187], v[72:75], v[96:99]
    v_mfma_f32_16x16x32_bf16 v[100:103], a[24:27], v[76:79], v[100:103]
    v_mfma_f32_16x16x32_bf16 v[104:107], a[104:107], v[76:79], v[104:107]
    v_mfma_f32_16x16x32_bf16 v[108:111], a[184:187], v[76:79], v[108:111]
    ds_read_b128 v[72:75], v9 offset:10240
    ds_read_b128 v[76:79], v9 offset:30720
    s_waitcnt lgkmcnt(6)
    v_mfma_f32_16x16x32_bf16 v[88:91], a[28:31], v[80:83], v[88:91]
    v_mfma_f32_16x16x32_bf16 v[92:95], a[108:111], v[80:83], v[92:95]
    v_mfma_f32_16x16x32_bf16 v[96:99], a[188:191], v[80:83], v[96:99]
    v_mfma_f32_16x16x32_bf16 v[100:103], a[28:31], v[84:87], v[100:103]
    v_mfma_f32_16x16x32_bf16 v[104:107], a[108:111], v[84:87], v[104:107]
    v_mfma_f32_16x16x32_bf16 v[108:111], a[188:191], v[84:87], v[108:111]
    ds_read_b128 v[80:83], v9 offset:11264
    ds_read_b128 v[84:87], v9 offset:31744
    s_waitcnt lgkmcnt(6)
    v_mfma_f32_16x16x32_bf16 v[88:91], a[32:35], v[56:59], v[88:91]
    v_mfma_f32_16x16x32_bf16 v[92:95], a[112:115], v[56:59], v[92:95]
    v_mfma_f32_16x16x32_bf16 v[96:99], a[192:195], v[56:59], v[96:99]
    v_mfma_f32_16x16x32_bf16 v[100:103], a[32:35], v[60:63], v[100:103]
    v_mfma_f32_16x16x32_bf16 v[104:107], a[112:115], v[60:63], v[104:107]
    v_mfma_f32_16x16x32_bf16 v[108:111], a[192:195], v[60:63], v[108:111]
    ds_read_b128 v[56:59], v9 offset:12288
    ds_read_b128 v[60:63], v9 offset:32768
    s_waitcnt lgkmcnt(6)
    v_mfma_f32_16x16x32_bf16 v[88:91], a[36:39], v[64:67], v[88:91]
    v_mfma_f32_16x16x32_bf16 v[92:95], a[116:119], v[64:67], v[92:95]
    v_mfma_f32_16x16x32_bf16 v[96:99], a[196:199], v[64:67], v[96:99]
    v_mfma_f32_16x16x32_bf16 v[100:103], a[36:39], v[68:71], v[100:103]
    v_mfma_f32_16x16x32_bf16 v[104:107], a[116:119], v[68:71], v[104:107]
    v_mfma_f32_16x16x32_bf16 v[108:111], a[196:199], v[68:71], v[108:111]
    s_waitcnt vmcnt(10)
    s_barrier
    v_mov_b32 v15, s40
    buffer_store_dword v15, v14, s[8:11], 0 offen sc1
    s_cmp_ge_i32 s79, 0
    s_cselect_b32 s24, 0, 2146435072
    v_or_b32 v246, s24, v245
    v_mov_b32 v247, s79
    buffer_store_dword v247, v246, s[8:11], 0 offen sc1
    s_mov_b32 s79, -1
    ds_read_b128 v[64:67], v9 offset:13312
    ds_read_b128 v[68:71], v9 offset:33792
    s_waitcnt lgkmcnt(6)
    v_mfma_f32_16x16x32_bf16 v[88:91], a[40:43], v[72:75], v[88:91]
    v_mfma_f32_16x16x32_bf16 v[92:95], a[120:123], v[72:75], v[92:95]
    v_mfma_f32_16x16x32_bf16 v[96:99], a[200:203], v[72:75], v[96:99]
    v_mfma_f32_16x16x32_bf16 v[100:103], a[40:43], v[76:79], v[100:103]
    v_mfma_f32_16x16x32_bf16 v[104:107], a[120:123], v[76:79], v[104:107]
    v_mfma_f32_16x16x32_bf16 v[108:111], a[200:203], v[76:79], v[108:111]
    ds_read_b128 v[72:75], v9 offset:14336
    ds_read_b128 v[76:79], v9 offset:34816
    s_waitcnt lgkmcnt(6)
    s_waitcnt vmcnt(2)
    v_mfma_f32_16x16x32_bf16 v[88:91], a[44:47], v[80:83], v[88:91]
    v_mfma_f32_16x16x32_bf16 v[92:95], a[124:127], v[80:83], v[92:95]
    ds_write_b128 v10, v[16:19] offset:0
    v_mfma_f32_16x16x32_bf16 v[96:99], a[204:207], v[80:83], v[96:99]
    v_mfma_f32_16x16x32_bf16 v[100:103], a[44:47], v[84:87], v[100:103]
    v_mfma_f32_16x16x32_bf16 v[104:107], a[124:127], v[84:87], v[104:107]
    v_mfma_f32_16x16x32_bf16 v[108:111], a[204:207], v[84:87], v[108:111]
    v_mfma_f32_16x16x32_bf16 v[148:151], v[16:19], v[16:19], 0
    v_mfma_f32_16x16x32_bf16 v[144:147], v[236:239], v[16:19], 0
    v_mfma_f32_16x16x32_bf16 v[148:151], v[20:23], v[20:23], v[148:151]
    ds_read_b128 v[80:83], v9 offset:15360
    ds_read_b128 v[84:87], v9 offset:35840
    s_waitcnt lgkmcnt(7)
    v_mfma_f32_16x16x32_bf16 v[88:91], a[48:51], v[56:59], v[88:91]
    v_mfma_f32_16x16x32_bf16 v[92:95], a[128:131], v[56:59], v[92:95]
    ds_write_b128 v10, v[20:23] offset:1024
    v_mfma_f32_16x16x32_bf16 v[96:99], a[208:211], v[56:59], v[96:99]
    v_mfma_f32_16x16x32_bf16 v[100:103], a[48:51], v[60:63], v[100:103]
    v_mfma_f32_16x16x32_bf16 v[104:107], a[128:131], v[60:63], v[104:107]
    v_mfma_f32_16x16x32_bf16 v[108:111], a[208:211], v[60:63], v[108:111]
    v_mfma_f32_16x16x32_bf16 v[144:147], v[236:239], v[20:23], v[144:147]
    v_mfma_f32_16x16x32_bf16 v[148:151], v[24:27], v[24:27], v[148:151]
    v_mfma_f32_16x16x32_bf16 v[144:147], v[236:239], v[24:27], v[144:147]
    ds_read_b128 v[56:59], v9 offset:16384
    ds_read_b128 v[60:63], v9 offset:36864
    s_waitcnt lgkmcnt(8)
    v_mfma_f32_16x16x32_bf16 v[88:91], a[52:55], v[64:67], v[88:91]
    v_mfma_f32_16x16x32_bf16 v[92:95], a[132:135], v[64:67], v[92:95]
    ds_write_b128 v10, v[24:27] offset:2048
    v_mfma_f32_16x16x32_bf16 v[96:99], a[212:215], v[64:67], v[96:99]
    v_mfma_f32_16x16x32_bf16 v[100:103], a[52:55], v[68:71], v[100:103]
    v_mfma_f32_16x16x32_bf16 v[104:107], a[132:135], v[68:71], v[104:107]
    v_mfma_f32_16x16x32_bf16 v[108:111], a[212:215], v[68:71], v[108:111]
    v_mfma_f32_16x16x32_bf16 v[148:151], v[28:31], v[28:31], v[148:151]
    v_mfma_f32_16x16x32_bf16 v[144:147], v[236:239], v[28:31], v[144:147]
    v_mfma_f32_16x16x32_bf16 v[148:151], v[32:35], v[32:35], v[148:151]
    ds_read_b128 v[64:67], v9 offset:17408
    ds_read_b128 v[68:71], v9 offset:37888
    s_waitcnt lgkmcnt(9)
    v_mfma_f32_16x16x32_bf16 v[88:91], a[56:59], v[72:75], v[88:91]
    v_mfma_f32_16x16x32_bf16 v[92:95], a[136:139], v[72:75], v[92:95]
    ds_write_b128 v10, v[28:31] offset:3072
    v_mfma_f32_16x16x32_bf16 v[96:99], a[216:219], v[72:75], v[96:99]
    v_mfma_f32_16x16x32_bf16 v[100:103], a[56:59], v[76:79], v[100:103]
    v_mfma_f32_16x16x32_bf16 v[104:107], a[136:139], v[76:79], v[104:107]
    v_mfma_f32_16x16x32_bf16 v[108:111], a[216:219], v[76:79], v[108:111]
    v_mfma_f32_16x16x32_bf16 v[144:147], v[236:239], v[32:35], v[144:147]
    v_mfma_f32_16x16x32_bf16 v[148:151], v[36:39], v[36:39], v[148:151]
    v_mfma_f32_16x16x32_bf16 v[144:147], v[236:239], v[36:39], v[144:147]
    ds_read_b128 v[72:75], v9 offset:18432
    ds_read_b128 v[76:79], v9 offset:38912
    s_waitcnt lgkmcnt(9)
    v_mfma_f32_16x16x32_bf16 v[88:91], a[60:63], v[80:83], v[88:91]
    v_mfma_f32_16x16x32_bf16 v[92:95], a[140:143], v[80:83], v[92:95]
    ds_write_b128 v10, v[32:35] offset:4096
    v_mfma_f32_16x16x32_bf16 v[96:99], a[220:223], v[80:83], v[96:99]
    v_mfma_f32_16x16x32_bf16 v[100:103], a[60:63], v[84:87], v[100:103]
    v_mfma_f32_16x16x32_bf16 v[104:107], a[140:143], v[84:87], v[104:107]
    v_mfma_f32_16x16x32_bf16 v[108:111], a[220:223], v[84:87], v[108:111]
    v_mfma_f32_16x16x32_bf16 v[148:151], v[40:43], v[40:43], v[148:151]
    v_mfma_f32_16x16x32_bf16 v[144:147], v[236:239], v[40:43], v[144:147]
    v_mfma_f32_16x16x32_bf16 v[148:151], v[44:47], v[44:47], v[148:151]
    ds_read_b128 v[80:83], v9 offset:19456
    ds_read_b128 v[84:87], v9 offset:39936
    s_waitcnt lgkmcnt(9)
    v_mfma_f32_16x16x32_bf16 v[88:91], a[64:67], v[56:59], v[88:91]
    v_mfma_f32_16x16x32_bf16 v[92:95], a[144:147], v[56:59], v[92:95]
    ds_write_b128 v10, v[36:39] offset:5120
    v_mfma_f32_16x16x32_bf16 v[96:99], a[224:227], v[56:59], v[96:99]
    v_mfma_f32_16x16x32_bf16 v[100:103], a[64:67], v[60:63], v[100:103]
    v_mfma_f32_16x16x32_bf16 v[104:107], a[144:147], v[60:63], v[104:107]
    v_mfma_f32_16x16x32_bf16 v[108:111], a[224:227], v[60:63], v[108:111]
    v_mfma_f32_16x16x32_bf16 v[144:147], v[236:239], v[44:47], v[144:147]
    v_mfma_f32_16x16x32_bf16 v[148:151], v[48:51], v[48:51], v[148:151]
    v_mfma_f32_16x16x32_bf16 v[144:147], v[236:239], v[48:51], v[144:147]
    s_waitcnt lgkmcnt(7)
    v_mfma_f32_16x16x32_bf16 v[88:91], a[68:71], v[64:67], v[88:91]
    v_mfma_f32_16x16x32_bf16 v[92:95], a[148:151], v[64:67], v[92:95]
    ds_write_b128 v10, v[40:43] offset:6144
    v_mfma_f32_16x16x32_bf16 v[96:99], a[228:231], v[64:67], v[96:99]
    v_mfma_f32_16x16x32_bf16 v[100:103], a[68:71], v[68:71], v[100:103]
    v_mfma_f32_16x16x32_bf16 v[104:107], a[148:151], v[68:71], v[104:107]
    v_mfma_f32_16x16x32_bf16 v[108:111], a[228:231], v[68:71], v[108:111]
    v_mfma_f32_16x16x32_bf16 v[148:151], v[52:55], v[52:55], v[148:151]
    v_mfma_f32_16x16x32_bf16 v[144:147], v[236:239], v[52:55], v[144:147]
    s_waitcnt lgkmcnt(5)
    v_mfma_f32_16x16x32_bf16 v[88:91], a[72:75], v[72:75], v[88:91]
    v_mfma_f32_16x16x32_bf16 v[92:95], a[152:155], v[72:75], v[92:95]
    ds_write_b128 v10, v[44:47] offset:7168
    v_mfma_f32_16x16x32_bf16 v[96:99], a[232:235], v[72:75], v[96:99]
    v_mfma_f32_16x16x32_bf16 v[100:103], a[72:75], v[76:79], v[100:103]
    v_mfma_f32_16x16x32_bf16 v[104:107], a[152:155], v[76:79], v[104:107]
    v_mfma_f32_16x16x32_bf16 v[108:111], a[232:235], v[76:79], v[108:111]
    s_waitcnt lgkmcnt(3)
    v_mfma_f32_16x16x32_bf16 v[88:91], a[76:79], v[80:83], v[88:91]
    v_mfma_f32_16x16x32_bf16 v[92:95], a[156:159], v[80:83], v[92:95]
    ds_write_b128 v10, v[48:51] offset:8192
    v_mfma_f32_16x16x32_bf16 v[96:99], a[236:239], v[80:83], v[96:99]
    v_mfma_f32_16x16x32_bf16 v[100:103], a[76:79], v[84:87], v[100:103]
    v_mfma_f32_16x16x32_bf16 v[104:107], a[156:159], v[84:87], v[104:107]
    v_mfma_f32_16x16x32_bf16 v[108:111], a[236:239], v[84:87], v[108:111]
    v_cndmask_b32 v145, v148, v149, s[48:49]
    v_cndmask_b32 v145, v145, v150, s[50:51]
    v_cndmask_b32 v145, v145, v151, s[54:55]
    ds_write_b128 v10, v[52:55] offset:9216
    ds_write_b64 v140, v[144:145]
    v_pk_mul_f32 v[124:125], v[224:225], v[132:133] op_sel:[0,1] op_sel_hi:[1,1]
    v_pk_mul_f32 v[126:127], v[226:227], v[132:133] op_sel:[0,1] op_sel_hi:[1,1]
    v_pk_fma_f32 v[88:89], v[88:89], v[132:133], v[124:125] op_sel:[0,0,0] op_sel_hi:[1,0,1]
    v_pk_fma_f32 v[90:91], v[90:91], v[132:133], v[126:127] op_sel:[0,0,0] op_sel_hi:[1,0,1]
    v_pk_mul_f32 v[124:125], v[228:229], v[132:133] op_sel:[0,1] op_sel_hi:[1,1]
    v_pk_mul_f32 v[126:127], v[230:231], v[132:133] op_sel:[0,1] op_sel_hi:[1,1]
    v_pk_fma_f32 v[92:93], v[92:93], v[132:133], v[124:125] op_sel:[0,0,0] op_sel_hi:[1,0,1]
    v_pk_fma_f32 v[94:95], v[94:95], v[132:133], v[126:127] op_sel:[0,0,0] op_sel_hi:[1,0,1]
    v_pk_mul_f32 v[124:125], v[232:233], v[132:133] op_sel:[0,1] op_sel_hi:[1,1]
    v_pk_mul_f32 v[126:127], v[234:235], v[132:133] op_sel:[0,1] op_sel_hi:[1,1]
    v_pk_fma_f32 v[96:97], v[96:97], v[132:133], v[124:125] op_sel:[0,0,0] op_sel_hi:[1,0,1]
    v_pk_fma_f32 v[98:99], v[98:99], v[132:133], v[126:127] op_sel:[0,0,0] op_sel_hi:[1,0,1]
    v_pk_mul_f32 v[124:125], v[224:225], v[134:135] op_sel:[0,1] op_sel_hi:[1,1]
    v_pk_mul_f32 v[126:127], v[226:227], v[134:135] op_sel:[0,1] op_sel_hi:[1,1]
    v_pk_fma_f32 v[100:101], v[100:101], v[134:135], v[124:125] op_sel:[0,0,0] op_sel_hi:[1,0,1]
    v_pk_fma_f32 v[102:103], v[102:103], v[134:135], v[126:127] op_sel:[0,0,0] op_sel_hi:[1,0,1]
    v_pk_mul_f32 v[124:125], v[228:229], v[134:135] op_sel:[0,1] op_sel_hi:[1,1]
    v_pk_mul_f32 v[126:127], v[230:231], v[134:135] op_sel:[0,1] op_sel_hi:[1,1]
    v_pk_fma_f32 v[104:105], v[104:105], v[134:135], v[124:125] op_sel:[0,0,0] op_sel_hi:[1,0,1]
    v_pk_fma_f32 v[106:107], v[106:107], v[134:135], v[126:127] op_sel:[0,0,0] op_sel_hi:[1,0,1]
    v_pk_mul_f32 v[124:125], v[232:233], v[134:135] op_sel:[0,1] op_sel_hi:[1,1]
    v_pk_mul_f32 v[126:127], v[234:235], v[134:135] op_sel:[0,1] op_sel_hi:[1,1]
    v_pk_fma_f32 v[108:109], v[108:109], v[134:135], v[124:125] op_sel:[0,0,0] op_sel_hi:[1,0,1]
    v_pk_fma_f32 v[110:111], v[110:111], v[134:135], v[126:127] op_sel:[0,0,0] op_sel_hi:[1,0,1]
    v_cvt_pk_bf16_f32 v112, v88, v89
    v_cvt_pk_bf16_f32 v113, v90, v91
    v_cvt_pk_bf16_f32 v114, v92, v93
    v_cvt_pk_bf16_f32 v115, v94, v95
    v_cvt_pk_bf16_f32 v116, v100, v101
    v_cvt_pk_bf16_f32 v117, v102, v103
    v_cvt_pk_bf16_f32 v118, v104, v105
    v_cvt_pk_bf16_f32 v119, v106, v107
    v_cvt_pk_bf16_f32 v120, v96, v97
    v_cvt_pk_bf16_f32 v121, v98, v99
    v_cvt_pk_bf16_f32 v122, v108, v109
    v_cvt_pk_bf16_f32 v123, v110, v111
    buffer_store_dwordx4 v[112:115], v11, s[8:11], s43 offen offset:0 sc1
    buffer_store_dwordx4 v[116:119], v11, s[8:11], s43 offen offset:1024 sc1
    buffer_store_dwordx4 v[120:123], v11, s[8:11], s43 offen offset:2048 sc1
    s_add_u32 s43, s43, 393216
    s_add_u32 s40, s40, 1
    s_waitcnt lgkmcnt(0)
    s_barrier
interleave_layers__linear_attn_block__memory_aug_recurrent_mem_tr__prompt_kernel_p_next:
    s_add_u32 s24, s64, 24
    s_cmp_le_u32 s24, s40
    s_cbranch_scc1 interleave_layers__linear_attn_block__memory_aug_recurrent_mem_tr__prompt_kernel_p_pub
    s_cmp_lt_u32 s40, 64
    s_cbranch_scc1 interleave_layers__linear_attn_block__memory_aug_recurrent_mem_tr__prompt_kernel_p_seg
interleave_layers__linear_attn_block__memory_aug_recurrent_mem_tr__prompt_kernel_p_pub:
    s_waitcnt vmcnt(0)
    s_barrier
    s_cmp_eq_u32 s3, 0
    s_cbranch_scc0 interleave_layers__linear_attn_block__memory_aug_recurrent_mem_tr__prompt_kernel_fp29
    v_mov_b32 v15, s40
    buffer_store_dword v15, v14, s[8:11], 0 offen sc1
interleave_layers__linear_attn_block__memory_aug_recurrent_mem_tr__prompt_kernel_fp29:
    s_add_u32 s24, s64, 24
    s_cmp_le_u32 s24, s40
    s_cbranch_scc1 interleave_layers__linear_attn_block__memory_aug_recurrent_mem_tr__prompt_kernel_p_x
    s_cmp_lt_u32 s40, 64
    s_cbranch_scc1 interleave_layers__linear_attn_block__memory_aug_recurrent_mem_tr__prompt_kernel_p_seg
    s_cmp_ge_u32 s64, 64
    s_cbranch_scc1 interleave_layers__linear_attn_block__memory_aug_recurrent_mem_tr__prompt_kernel_p_done
interleave_layers__linear_attn_block__memory_aug_recurrent_mem_tr__prompt_kernel_p_x:
    s_add_u32 s63, s64, 1
    s_cmp_ge_i32 s69, s63
    s_cbranch_scc1 interleave_layers__linear_attn_block__memory_aug_recurrent_mem_tr__prompt_kernel_x_en_ok
    s_mov_b32 s61, 0
interleave_layers__linear_attn_block__memory_aug_recurrent_mem_tr__prompt_kernel_x_en:
    buffer_load_dword v253, v252, s[8:11], 0 offen sc1
    s_waitcnt vmcnt(0)
    v_readlane_b32 s69, v253, 0
    v_readlane_b32 s24, v253, 1
    s_min_i32 s69, s69, s24
    v_readlane_b32 s24, v253, 2
    s_min_i32 s69, s69, s24
    v_readlane_b32 s24, v253, 3
    s_min_i32 s69, s69, s24
    v_readlane_b32 s24, v253, 4
    s_min_i32 s69, s69, s24
    v_readlane_b32 s24, v253, 5
    s_min_i32 s69, s69, s24
    v_readlane_b32 s24, v253, 6
    s_min_i32 s69, s69, s24
    v_readlane_b32 s24, v253, 7
    s_min_i32 s69, s69, s24
    s_cmp_ge_i32 s69, s63
    s_cbranch_scc1 interleave_layers__linear_attn_block__memory_aug_recurrent_mem_tr__prompt_kernel_x_en_ok
    s_add_u32 s61, s61, 1
    s_cmp_ge_u32 s61, s60
    s_cbranch_scc1 interleave_layers__linear_attn_block__memory_aug_recurrent_mem_tr__prompt_kernel_x_en_to
    s_sleep 2
    s_branch interleave_layers__linear_attn_block__memory_aug_recurrent_mem_tr__prompt_kernel_x_en
interleave_layers__linear_attn_block__memory_aug_recurrent_mem_tr__prompt_kernel_x_en_to:
    s_mov_b32 s60, 1
interleave_layers__linear_attn_block__memory_aug_recurrent_mem_tr__prompt_kernel_x_en_ok:
    s_lshl_b32 s95, s92, 6
    s_add_u32 s95, s95, s64
    s_add_u32 s95, s95, 1
    s_cmp_ge_i32 s59, s95
    s_cbranch_scc1 interleave_layers__linear_attn_block__memory_aug_recurrent_mem_tr__prompt_kernel_x_ec_ok
    s_and_b32 s24, s2, 7
    s_lshl_b32 s24, s24, 7
    s_add_u32 s24, s24, 23109632
    v_and_b32 v254, 3, v1
    v_lshl_add_u32 v254, v254, 2, s24
    s_mov_b32 s61, 0
interleave_layers__linear_attn_block__memory_aug_recurrent_mem_tr__prompt_kernel_x_ec:
    buffer_load_dword v253, v254, s[8:11], 0 offen sc1
    s_waitcnt vmcnt(0)
    v_readlane_b32 s59, v253, 0
    v_readlane_b32 s24, v253, 1
    s_min_i32 s59, s59, s24
    v_readlane_b32 s24, v253, 2
    s_min_i32 s59, s59, s24
    s_cmp_ge_i32 s59, s95
    s_cbranch_scc1 interleave_layers__linear_attn_block__memory_aug_recurrent_mem_tr__prompt_kernel_x_ec_ok
    s_add_u32 s61, s61, 1
    s_cmp_ge_u32 s61, s60
    s_cbranch_scc1 interleave_layers__linear_attn_block__memory_aug_recurrent_mem_tr__prompt_kernel_x_ec_to
    s_sleep 2
    s_branch interleave_layers__linear_attn_block__memory_aug_recurrent_mem_tr__prompt_kernel_x_ec
interleave_layers__linear_attn_block__memory_aug_recurrent_mem_tr__prompt_kernel_x_ec_to:
    s_mov_b32 s60, 1
interleave_layers__linear_attn_block__memory_aug_recurrent_mem_tr__prompt_kernel_x_ec_ok:
    s_add_u32 s52, s65, 32768
    buffer_load_dwordx4 v[16:19], v240, s[8:11], s65 offen offset:0 sc1
    buffer_load_dwordx4 v[20:23], v240, s[8:11], s65 offen offset:1024 sc1
    buffer_load_dwordx4 v[24:27], v240, s[8:11], s65 offen offset:2048 sc1
    buffer_load_dwordx4 v[28:31], v240, s[8:11], s65 offen offset:3072 sc1
    buffer_load_dwordx4 v[32:35], v241, s[8:11], s65 offen offset:0 sc1
    buffer_load_dwordx4 v[36:39], v241, s[8:11], s65 offen offset:1024 sc1
    buffer_load_dwordx4 v[40:43], v241, s[8:11], s65 offen offset:2048 sc1
    buffer_load_dwordx4 v[44:47], v241, s[8:11], s65 offen offset:3072 sc1
    buffer_load_dwordx4 v[48:51], v240, s[8:11], s52 offen offset:0 sc1
    buffer_load_dwordx4 v[52:55], v240, s[8:11], s52 offen offset:1024 sc1
    buffer_load_dwordx4 v[56:59], v240, s[8:11], s52 offen offset:2048 sc1
    buffer_load_dwordx4 v[60:63], v240, s[8:11], s52 offen offset:3072 sc1
    buffer_load_dwordx4 v[64:67], v241, s[8:11], s52 offen offset:0 sc1
    buffer_load_dwordx4 v[68:71], v241, s[8:11], s52 offen offset:1024 sc1
    buffer_load_dwordx4 v[72:75], v241, s[8:11], s52 offen offset:2048 sc1
    buffer_load_dwordx4 v[76:79], v241, s[8:11], s52 offen offset:3072 sc1
    s_add_u32 s24, s68, s73
    buffer_load_dwordx4 v[196:199], v219, s[8:11], s24 offen sc1
    s_mov_b32 s61, 0
interleave_layers__linear_attn_block__memory_aug_recurrent_mem_tr__prompt_kernel_x_p0:
    buffer_load_dwordx4 v[140:143], v215, s[8:11], s67 offen offset:3072 sc1
    s_waitcnt vmcnt(0)
    v_max3_u32 v192, v140, v141, v142
    v_max_u32 v192, v192, v143
    v_cmp_eq_u32 vcc, -1, v192
    s_add_u32 s61, s61, 1
    s_cbranch_vccz interleave_layers__linear_attn_block__memory_aug_recurrent_mem_tr__prompt_kernel_x_p0_out
    s_cmp_ge_u32 s61, s60
    s_cbranch_scc1 interleave_layers__linear_attn_block__memory_aug_recurrent_mem_tr__prompt_kernel_x_p0_to
    s_sleep 8
    s_branch interleave_layers__linear_attn_block__memory_aug_recurrent_mem_tr__prompt_kernel_x_p0
interleave_layers__linear_attn_block__memory_aug_recurrent_mem_tr__prompt_kernel_x_p0_to:
    s_mov_b32 s60, 1
interleave_layers__linear_attn_block__memory_aug_recurrent_mem_tr__prompt_kernel_x_p0_out:
    s_add_u32 s53, s66, 8192
    s_mov_b32 s61, 0
interleave_layers__linear_attn_block__memory_aug_recurrent_mem_tr__prompt_kernel_x_p1:
    buffer_load_dwordx4 v[80:83], v212, s[8:11], s67 offen offset:0 sc1
    buffer_load_dwordx4 v[84:87], v212, s[8:11], s67 offen offset:1024 sc1
    buffer_load_dwordx4 v[88:91], v212, s[8:11], s67 offen offset:2048 sc1
    buffer_load_dwordx4 v[92:95], v212, s[8:11], s67 offen offset:3072 sc1
    buffer_load_dwordx4 v[96:99], v213, s[8:11], s67 offen offset:0 sc1
    buffer_load_dwordx4 v[100:103], v213, s[8:11], s67 offen offset:1024 sc1
    buffer_load_dwordx4 v[104:107], v213, s[8:11], s67 offen offset:2048 sc1
    buffer_load_dwordx4 v[108:111], v213, s[8:11], s67 offen offset:3072 sc1
    buffer_load_dwordx4 v[112:115], v214, s[8:11], s67 offen offset:0 sc1
    buffer_load_dwordx4 v[116:119], v214, s[8:11], s67 offen offset:1024 sc1
    buffer_load_dwordx4 v[120:123], v214, s[8:11], s67 offen offset:2048 sc1
    buffer_load_dwordx4 v[124:127], v214, s[8:11], s67 offen offset:3072 sc1
    buffer_load_dwordx4 v[128:131], v215, s[8:11], s67 offen offset:0 sc1
    buffer_load_dwordx4 v[132:135], v215, s[8:11], s67 offen offset:1024 sc1
    buffer_load_dwordx4 v[136:139], v215, s[8:11], s67 offen offset:2048 sc1
    buffer_load_dwordx4 v[140:143], v215, s[8:11], s67 offen offset:3072 sc1
    buffer_load_dwordx4 v[144:147], v216, s[8:11], s67 offen offset:0 sc1
    buffer_load_dwordx4 v[148:151], v216, s[8:11], s67 offen offset:1024 sc1
    buffer_load_dwordx4 v[152:155], v216, s[8:11], s67 offen offset:2048 sc1
    buffer_load_dwordx4 v[156:159], v216, s[8:11], s67 offen offset:3072 sc1
    buffer_load_dwordx4 v[160:163], v242, s[8:11], s66 offen offset:0 sc1
    buffer_load_dwordx4 v[164:167], v242, s[8:11], s66 offen offset:1024 sc1
    buffer_load_dwordx4 v[168:171], v242, s[8:11], s53 offen offset:0 sc1
    buffer_load_dwordx4 v[172:175], v242, s[8:11], s53 offen offset:1024 sc1
    s_waitcnt vmcnt(0)
    v_max3_u32 v192, v80, v81, v82
    v_max3_u32 v192, v192, v83, v84
    v_max3_u32 v192, v192, v85, v86
    v_max3_u32 v192, v192, v87, v88
    v_max3_u32 v192, v192, v89, v90
    v_max3_u32 v192, v192, v91, v92
    v_max3_u32 v192, v192, v93, v94
    v_max3_u32 v192, v192, v95, v96
    v_max3_u32 v192, v192, v97, v98
    v_max3_u32 v192, v192, v99, v100
    v_max3_u32 v192, v192, v101, v102
    v_max3_u32 v192, v192, v103, v104
    v_max3_u32 v192, v192, v105, v106
    v_max3_u32 v192, v192, v107, v108
    v_max3_u32 v192, v192, v109, v110
    v_max3_u32 v192, v192, v111, v112
    v_max3_u32 v192, v192, v113, v114
    v_max3_u32 v192, v192, v115, v116
    v_max3_u32 v192, v192, v117, v118
    v_max3_u32 v192, v192, v119, v120
    v_max3_u32 v192, v192, v121, v122
    v_max3_u32 v192, v192, v123, v124
    v_max3_u32 v192, v192, v125, v126
    v_max3_u32 v192, v192, v127, v128
    v_max3_u32 v192, v192, v129, v130
    v_max3_u32 v192, v192, v131, v132
    v_max3_u32 v192, v192, v133, v134
    v_max3_u32 v192, v192, v135, v136
    v_max3_u32 v192, v192, v137, v138
    v_max3_u32 v192, v192, v139, v140
    v_max3_u32 v192, v192, v141, v142
    v_max3_u32 v192, v192, v143, v144
    v_max3_u32 v192, v192, v145, v146
    v_max3_u32 v192, v192, v147, v148
    v_max3_u32 v192, v192, v149, v150
    v_max3_u32 v192, v192, v151, v152
    v_max3_u32 v192, v192, v153, v154
    v_max3_u32 v192, v192, v155, v156
    v_max3_u32 v192, v192, v157, v158
    v_max3_u32 v192, v192, v159, v160
    v_max3_u32 v192, v192, v161, v162
    v_max3_u32 v192, v192, v163, v164
    v_max3_u32 v192, v192, v165, v166
    v_max3_u32 v192, v192, v167, v168
    v_max3_u32 v192, v192, v169, v170
    v_max3_u32 v192, v192, v171, v172
    v_max3_u32 v192, v192, v173, v174
    v_max_u32 v192, v192, v175
    v_cmp_eq_u32 vcc, -1, v192
    s_add_u32 s61, s61, 1
    s_cbranch_vccz interleave_layers__linear_attn_block__memory_aug_recurrent_mem_tr__prompt_kernel_x_p1_out
    s_cmp_ge_u32 s61, s60
    s_cbranch_scc1 interleave_layers__linear_attn_block__memory_aug_recurrent_mem_tr__prompt_kernel_x_p1_to
    s_sleep 2
    s_branch interleave_layers__linear_attn_block__memory_aug_recurrent_mem_tr__prompt_kernel_x_p1
interleave_layers__linear_attn_block__memory_aug_recurrent_mem_tr__prompt_kernel_x_p1_to:
    s_mov_b32 s60, 1
interleave_layers__linear_attn_block__memory_aug_recurrent_mem_tr__prompt_kernel_x_p1_out:
    v_mfma_f32_16x16x32_bf16 v[176:179], v[16:19], v[80:83], 0
    v_mfma_f32_16x16x32_bf16 v[180:183], v[16:19], v[84:87], 0
    v_mfma_f32_16x16x32_bf16 v[184:187], v[48:51], v[80:83], 0
    v_mfma_f32_16x16x32_bf16 v[188:191], v[48:51], v[84:87], 0
    v_mfma_f32_16x16x32_bf16 v[176:179], v[20:23], v[88:91], v[176:179]
    v_mfma_f32_16x16x32_bf16 v[180:183], v[20:23], v[92:95], v[180:183]
    v_mfma_f32_16x16x32_bf16 v[184:187], v[52:55], v[88:91], v[184:187]
    v_mfma_f32_16x16x32_bf16 v[188:191], v[52:55], v[92:95], v[188:191]
    v_mfma_f32_16x16x32_bf16 v[176:179], v[24:27], v[96:99], v[176:179]
    v_mfma_f32_16x16x32_bf16 v[180:183], v[24:27], v[100:103], v[180:183]
    v_mfma_f32_16x16x32_bf16 v[184:187], v[56:59], v[96:99], v[184:187]
    v_mfma_f32_16x16x32_bf16 v[188:191], v[56:59], v[100:103], v[188:191]
    v_mfma_f32_16x16x32_bf16 v[176:179], v[28:31], v[104:107], v[176:179]
    v_mfma_f32_16x16x32_bf16 v[180:183], v[28:31], v[108:111], v[180:183]
    v_mfma_f32_16x16x32_bf16 v[184:187], v[60:63], v[104:107], v[184:187]
    v_mfma_f32_16x16x32_bf16 v[188:191], v[60:63], v[108:111], v[188:191]
    v_mfma_f32_16x16x32_bf16 v[176:179], v[32:35], v[112:115], v[176:179]
    v_mfma_f32_16x16x32_bf16 v[180:183], v[32:35], v[116:119], v[180:183]
    v_mfma_f32_16x16x32_bf16 v[184:187], v[64:67], v[112:115], v[184:187]
    v_mfma_f32_16x16x32_bf16 v[188:191], v[64:67], v[116:119], v[188:191]
    v_mfma_f32_16x16x32_bf16 v[176:179], v[36:39], v[120:123], v[176:179]
    v_mfma_f32_16x16x32_bf16 v[180:183], v[36:39], v[124:127], v[180:183]
    v_mfma_f32_16x16x32_bf16 v[184:187], v[68:71], v[120:123], v[184:187]
    v_mfma_f32_16x16x32_bf16 v[188:191], v[68:71], v[124:127], v[188:191]
    v_mfma_f32_16x16x32_bf16 v[176:179], v[40:43], v[128:131], v[176:179]
    v_mfma_f32_16x16x32_bf16 v[180:183], v[40:43], v[132:135], v[180:183]
    v_mfma_f32_16x16x32_bf16 v[184:187], v[72:75], v[128:131], v[184:187]
    v_mfma_f32_16x16x32_bf16 v[188:191], v[72:75], v[132:135], v[188:191]
    v_mfma_f32_16x16x32_bf16 v[176:179], v[44:47], v[136:139], v[176:179]
    v_mfma_f32_16x16x32_bf16 v[180:183], v[44:47], v[140:143], v[180:183]
    v_mfma_f32_16x16x32_bf16 v[184:187], v[76:79], v[136:139], v[184:187]
    v_mfma_f32_16x16x32_bf16 v[188:191], v[76:79], v[140:143], v[188:191]
    v_mfma_f32_16x16x32_bf16 v[176:179], v[160:163], v[144:147], v[176:179]
    v_mfma_f32_16x16x32_bf16 v[180:183], v[160:163], v[148:151], v[180:183]
    v_mfma_f32_16x16x32_bf16 v[184:187], v[168:171], v[144:147], v[184:187]
    v_mfma_f32_16x16x32_bf16 v[188:191], v[168:171], v[148:151], v[188:191]
    v_mfma_f32_16x16x32_bf16 v[176:179], v[164:167], v[152:155], v[176:179]
    v_mfma_f32_16x16x32_bf16 v[180:183], v[164:167], v[156:159], v[180:183]
    v_mfma_f32_16x16x32_bf16 v[184:187], v[172:175], v[152:155], v[184:187]
    v_mfma_f32_16x16x32_bf16 v[188:191], v[172:175], v[156:159], v[188:191]
    s_nop 4
    ds_write_b128 v217, v[176:179] offset:0
    ds_write_b128 v217, v[180:183] offset:1024
    ds_write_b128 v217, v[184:187] offset:2048
    ds_write_b128 v217, v[188:191] offset:3072
    s_waitcnt lgkmcnt(0)
    s_barrier
    s_cmp_ge_u32 s3, 2
    s_cbranch_scc1 interleave_layers__linear_attn_block__memory_aug_recurrent_mem_tr__prompt_kernel_xs30
    ds_read_b128 v[16:19], v218 offset:0
    ds_read_b128 v[20:23], v218 offset:4096
    ds_read_b128 v[24:27], v218 offset:8192
    ds_read_b128 v[28:31], v218 offset:12288
    ds_read_b128 v[32:35], v218 offset:2048
    ds_read_b128 v[36:39], v218 offset:6144
    ds_read_b128 v[40:43], v218 offset:10240
    ds_read_b128 v[44:47], v218 offset:14336
    s_waitcnt lgkmcnt(4)
    v_pk_add_f32 v[16:17], v[16:17], v[20:21]
    v_pk_add_f32 v[24:25], v[24:25], v[28:29]
    v_pk_add_f32 v[18:19], v[18:19], v[22:23]
    v_pk_add_f32 v[26:27], v[26:27], v[30:31]
    v_pk_add_f32 v[16:17], v[16:17], v[24:25]
    v_pk_add_f32 v[18:19], v[18:19], v[26:27]
    v_cvt_pk_bf16_f32 v20, v16, v17
    v_cvt_pk_bf16_f32 v21, v18, v19
    v_lshlrev_b32 v16, 16, v20
    v_and_b32 v17, 0xffff0000, v20
    v_lshlrev_b32 v22, 16, v196
    v_and_b32 v23, 0xffff0000, v196
    v_pk_add_f32 v[16:17], v[16:17], v[22:23]
    v_cvt_pk_bf16_f32 v48, v16, v17
    v_lshlrev_b32 v16, 16, v21
    v_and_b32 v17, 0xffff0000, v21
    v_lshlrev_b32 v22, 16, v197
    v_and_b32 v23, 0xffff0000, v197
    v_pk_add_f32 v[16:17], v[16:17], v[22:23]
    v_cvt_pk_bf16_f32 v49, v16, v17
    s_waitcnt lgkmcnt(0)
    v_pk_add_f32 v[32:33], v[32:33], v[36:37]
    v_pk_add_f32 v[40:41], v[40:41], v[44:45]
    v_pk_add_f32 v[34:35], v[34:35], v[38:39]
    v_pk_add_f32 v[42:43], v[42:43], v[46:47]
    v_pk_add_f32 v[32:33], v[32:33], v[40:41]
    v_pk_add_f32 v[34:35], v[34:35], v[42:43]
    v_cvt_pk_bf16_f32 v36, v32, v33
    v_cvt_pk_bf16_f32 v37, v34, v35
    v_lshlrev_b32 v32, 16, v36
    v_and_b32 v33, 0xffff0000, v36
    v_lshlrev_b32 v38, 16, v198
    v_and_b32 v39, 0xffff0000, v198
    v_pk_add_f32 v[32:33], v[32:33], v[38:39]
    v_cvt_pk_bf16_f32 v50, v32, v33
    v_lshlrev_b32 v32, 16, v37
    v_and_b32 v33, 0xffff0000, v37
    v_lshlrev_b32 v38, 16, v199
    v_and_b32 v39, 0xffff0000, v199
    v_pk_add_f32 v[32:33], v[32:33], v[38:39]
    v_cvt_pk_bf16_f32 v51, v32, v33
    s_cmp_eq_u32 s92, 0
    s_cbranch_scc0 interleave_layers__linear_attn_block__memory_aug_recurrent_mem_tr__prompt_kernel_xo31
    s_add_u32 s24, s68, 4194304
    buffer_store_dwordx4 v[48:51], v219, s[8:11], s24 offen sc1
    s_branch interleave_layers__linear_attn_block__memory_aug_recurrent_mem_tr__prompt_kernel_xs30
interleave_layers__linear_attn_block__memory_aug_recurrent_mem_tr__prompt_kernel_xo31:
    buffer_store_dwordx2 v[48:49], v243, s[12:15], s68 offen
    buffer_store_dwordx2 v[50:51], v243, s[12:15], s68 offen offset:32
interleave_layers__linear_attn_block__memory_aug_recurrent_mem_tr__prompt_kernel_xs30:
    s_lshr_b32 s25, s64, 2
    s_add_u32 s25, s25, 1
    s_cmp_eq_u32 s92, 0
    s_cselect_b32 s79, s25, -1
    s_cmp_lt_u32 s40, 64
    s_cbranch_scc1 interleave_layers__linear_attn_block__memory_aug_recurrent_mem_tr__prompt_kernel_xp32
    s_waitcnt vmcnt(0)
    s_barrier
    s_cmp_ge_i32 s79, 0
    s_cselect_b32 s24, 0, 2146435072
    v_or_b32 v246, s24, v245
    v_mov_b32 v247, s79
    buffer_store_dword v247, v246, s[8:11], 0 offen sc1
    s_mov_b32 s79, -1
interleave_layers__linear_attn_block__memory_aug_recurrent_mem_tr__prompt_kernel_xp32:
    s_add_u32 s64, s64, 4
    s_add_u32 s65, s65, 5242880
    s_add_u32 s66, s66, 1835008
    s_add_u32 s67, s67, 1835008
    s_add_u32 s68, s68, 163840
    s_branch interleave_layers__linear_attn_block__memory_aug_recurrent_mem_tr__prompt_kernel_p_next
interleave_layers__linear_attn_block__memory_aug_recurrent_mem_tr__prompt_kernel_p_done:
    s_cmp_eq_u32 s92, 0
    s_cbranch_scc0 interleave_layers__linear_attn_block__memory_aug_recurrent_mem_tr__prompt_kernel_end
    s_mov_b32 s92, 1
    s_branch interleave_layers__linear_attn_block__memory_aug_recurrent_mem_tr__prompt_kernel_p_layer
interleave_layers__linear_attn_block__memory_aug_recurrent_mem_tr__prompt_kernel_roleO:
    s_sub_u32 s44, s2, 200
    s_load_dwordx2 s[6:7], s[0:1], 64
    s_waitcnt lgkmcnt(0)
    s_mov_b32 s12, s6
    s_mov_b32 s13, s7
    s_mov_b32 s14, 7864320
    s_mov_b32 s15, 0x00020000
    v_add_u32 v8, 0, v0
    s_mov_b32 s24, 3277
    v_mul_lo_u32 v9, v8, s24
    v_lshrrev_b32 v9, 18, v9
    v_mul_u32_u24 v10, 80, v9
    v_sub_u32 v10, v8, v10
    v_mul_u32_u24 v16, 1312, v9
    v_lshl_add_u32 v16, v10, 4, v16
    v_add_u32 v8, 256, v0
    s_mov_b32 s24, 3277
    v_mul_lo_u32 v9, v8, s24
    v_lshrrev_b32 v9, 18, v9
    v_mul_u32_u24 v10, 80, v9
    v_sub_u32 v10, v8, v10
    v_mul_u32_u24 v17, 1312, v9
    v_lshl_add_u32 v17, v10, 4, v17
    v_add_u32 v8, 512, v0
    s_mov_b32 s24, 3277
    v_mul_lo_u32 v9, v8, s24
    v_lshrrev_b32 v9, 18, v9
    v_mul_u32_u24 v10, 80, v9
    v_sub_u32 v10, v8, v10
    v_mul_u32_u24 v18, 1312, v9
    v_lshl_add_u32 v18, v10, 4, v18
    v_add_u32 v8, 768, v0
    s_mov_b32 s24, 3277
    v_mul_lo_u32 v9, v8, s24
    v_lshrrev_b32 v9, 18, v9
    v_mul_u32_u24 v10, 80, v9
    v_sub_u32 v10, v8, v10
    v_mul_u32_u24 v19, 1312, v9
    v_lshl_add_u32 v19, v10, 4, v19
    v_add_u32 v8, 1024, v0
    s_mov_b32 s24, 3277
    v_mul_lo_u32 v9, v8, s24
    v_lshrrev_b32 v9, 18, v9
    v_mul_u32_u24 v10, 80, v9
    v_sub_u32 v10, v8, v10
    v_mul_u32_u24 v20, 1312, v9
    v_lshl_add_u32 v20, v10, 4, v20
    v_add_u32 v8, 1280, v0
    s_mov_b32 s24, 3277
    v_mul_lo_u32 v9, v8, s24
    v_lshrrev_b32 v9, 18, v9
    v_mul_u32_u24 v10, 80, v9
    v_sub_u32 v10, v8, v10
    v_mul_u32_u24 v21, 1312, v9
    v_lshl_add_u32 v21, v10, 4, v21
    v_add_u32 v8, 1536, v0
    s_mov_b32 s24, 3277
    v_mul_lo_u32 v9, v8, s24
    v_lshrrev_b32 v9, 18, v9
    v_mul_u32_u24 v10, 80, v9
    v_sub_u32 v10, v8, v10
    v_mul_u32_u24 v22, 1312, v9
    v_lshl_add_u32 v22, v10, 4, v22
    v_add_u32 v8, 1792, v0
    s_mov_b32 s24, 3277
    v_mul_lo_u32 v9, v8, s24
    v_lshrrev_b32 v9, 18, v9
    v_mul_u32_u24 v10, 80, v9
    v_sub_u32 v10, v8, v10
    v_mul_u32_u24 v23, 1312, v9
    v_lshl_add_u32 v23, v10, 4, v23
    v_add_u32 v8, 2048, v0
    s_mov_b32 s24, 3277
    v_mul_lo_u32 v9, v8, s24
    v_lshrrev_b32 v9, 18, v9
    v_mul_u32_u24 v10, 80, v9
    v_sub_u32 v10, v8, v10
    v_mul_u32_u24 v24, 1312, v9
    v_lshl_add_u32 v24, v10, 4, v24
    v_add_u32 v8, 2304, v0
    s_mov_b32 s24, 3277
    v_mul_lo_u32 v9, v8, s24
    v_lshrrev_b32 v9, 18, v9
    v_mul_u32_u24 v10, 80, v9
    v_sub_u32 v10, v8, v10
    v_mul_u32_u24 v25, 1312, v9
    v_lshl_add_u32 v25, v10, 4, v25
    v_add_u32 v8, 2560, v0
    s_mov_b32 s24, 3277
    v_mul_lo_u32 v9, v8, s24
    v_lshrrev_b32 v9, 18, v9
    v_mul_u32_u24 v10, 80, v9
    v_sub_u32 v10, v8, v10
    v_mul_u32_u24 v26, 1312, v9
    v_lshl_add_u32 v26, v10, 4, v26
    v_add_u32 v8, 2816, v0
    s_mov_b32 s24, 3277
    v_mul_lo_u32 v9, v8, s24
    v_lshrrev_b32 v9, 18, v9
    v_mul_u32_u24 v10, 80, v9
    v_sub_u32 v10, v8, v10
    v_mul_u32_u24 v27, 1312, v9
    v_lshl_add_u32 v27, v10, 4, v27
    v_add_u32 v8, 3072, v0
    s_mov_b32 s24, 3277
    v_mul_lo_u32 v9, v8, s24
    v_lshrrev_b32 v9, 18, v9
    v_mul_u32_u24 v10, 80, v9
    v_sub_u32 v10, v8, v10
    v_mul_u32_u24 v28, 1312, v9
    v_lshl_add_u32 v28, v10, 4, v28
    v_add_u32 v8, 3328, v0
    s_mov_b32 s24, 3277
    v_mul_lo_u32 v9, v8, s24
    v_lshrrev_b32 v9, 18, v9
    v_mul_u32_u24 v10, 80, v9
    v_sub_u32 v10, v8, v10
    v_mul_u32_u24 v29, 1312, v9
    v_lshl_add_u32 v29, v10, 4, v29
    v_add_u32 v8, 3584, v0
    s_mov_b32 s24, 3277
    v_mul_lo_u32 v9, v8, s24
    v_lshrrev_b32 v9, 18, v9
    v_mul_u32_u24 v10, 80, v9
    v_sub_u32 v10, v8, v10
    v_mul_u32_u24 v30, 1312, v9
    v_lshl_add_u32 v30, v10, 4, v30
    v_add_u32 v8, 3840, v0
    s_mov_b32 s24, 3277
    v_mul_lo_u32 v9, v8, s24
    v_lshrrev_b32 v9, 18, v9
    v_mul_u32_u24 v10, 80, v9
    v_sub_u32 v10, v8, v10
    v_mul_u32_u24 v31, 1312, v9
    v_lshl_add_u32 v31, v10, 4, v31
    v_add_u32 v8, 4096, v0
    s_mov_b32 s24, 3277
    v_mul_lo_u32 v9, v8, s24
    v_lshrrev_b32 v9, 18, v9
    v_mul_u32_u24 v10, 80, v9
    v_sub_u32 v10, v8, v10
    v_mul_u32_u24 v32, 1312, v9
    v_lshl_add_u32 v32, v10, 4, v32
    v_add_u32 v8, 4352, v0
    s_mov_b32 s24, 3277
    v_mul_lo_u32 v9, v8, s24
    v_lshrrev_b32 v9, 18, v9
    v_mul_u32_u24 v10, 80, v9
    v_sub_u32 v10, v8, v10
    v_mul_u32_u24 v33, 1312, v9
    v_lshl_add_u32 v33, v10, 4, v33
    v_add_u32 v8, 4608, v0
    s_mov_b32 s24, 3277
    v_mul_lo_u32 v9, v8, s24
    v_lshrrev_b32 v9, 18, v9
    v_mul_u32_u24 v10, 80, v9
    v_sub_u32 v10, v8, v10
    v_mul_u32_u24 v34, 1312, v9
    v_lshl_add_u32 v34, v10, 4, v34
    v_add_u32 v8, 4864, v0
    s_mov_b32 s24, 3277
    v_mul_lo_u32 v9, v8, s24
    v_lshrrev_b32 v9, 18, v9
    v_mul_u32_u24 v10, 80, v9
    v_sub_u32 v10, v8, v10
    v_mul_u32_u24 v35, 1312, v9
    v_lshl_add_u32 v35, v10, 4, v35
    v_add_u32 v8, 5120, v0
    s_mov_b32 s24, 3277
    v_mul_lo_u32 v9, v8, s24
    v_lshrrev_b32 v9, 18, v9
    v_mul_u32_u24 v10, 80, v9
    v_sub_u32 v10, v8, v10
    v_mul_u32_u24 v36, 1312, v9
    v_lshl_add_u32 v36, v10, 4, v36
    v_add_u32 v8, 5376, v0
    s_mov_b32 s24, 3277
    v_mul_lo_u32 v9, v8, s24
    v_lshrrev_b32 v9, 18, v9
    v_mul_u32_u24 v10, 80, v9
    v_sub_u32 v10, v8, v10
    v_mul_u32_u24 v37, 1312, v9
    v_lshl_add_u32 v37, v10, 4, v37
    v_add_u32 v8, 5632, v0
    s_mov_b32 s24, 3277
    v_mul_lo_u32 v9, v8, s24
    v_lshrrev_b32 v9, 18, v9
    v_mul_u32_u24 v10, 80, v9
    v_sub_u32 v10, v8, v10
    v_mul_u32_u24 v38, 1312, v9
    v_lshl_add_u32 v38, v10, 4, v38
    v_add_u32 v8, 5888, v0
    s_mov_b32 s24, 3277
    v_mul_lo_u32 v9, v8, s24
    v_lshrrev_b32 v9, 18, v9
    v_mul_u32_u24 v10, 80, v9
    v_sub_u32 v10, v8, v10
    v_mul_u32_u24 v39, 1312, v9
    v_lshl_add_u32 v39, v10, 4, v39
    v_add_u32 v8, 6144, v0
    s_mov_b32 s24, 3277
    v_mul_lo_u32 v9, v8, s24
    v_lshrrev_b32 v9, 18, v9
    v_mul_u32_u24 v10, 80, v9
    v_sub_u32 v10, v8, v10
    v_mul_u32_u24 v40, 1312, v9
    v_lshl_add_u32 v40, v10, 4, v40
    v_add_u32 v8, 6400, v0
    s_mov_b32 s24, 3277
    v_mul_lo_u32 v9, v8, s24
    v_lshrrev_b32 v9, 18, v9
    v_mul_u32_u24 v10, 80, v9
    v_sub_u32 v10, v8, v10
    v_mul_u32_u24 v41, 1312, v9
    v_lshl_add_u32 v41, v10, 4, v41
    v_add_u32 v8, 6656, v0
    s_mov_b32 s24, 3277
    v_mul_lo_u32 v9, v8, s24
    v_lshrrev_b32 v9, 18, v9
    v_mul_u32_u24 v10, 80, v9
    v_sub_u32 v10, v8, v10
    v_mul_u32_u24 v42, 1312, v9
    v_lshl_add_u32 v42, v10, 4, v42
    v_add_u32 v8, 6912, v0
    s_mov_b32 s24, 3277
    v_mul_lo_u32 v9, v8, s24
    v_lshrrev_b32 v9, 18, v9
    v_mul_u32_u24 v10, 80, v9
    v_sub_u32 v10, v8, v10
    v_mul_u32_u24 v43, 1312, v9
    v_lshl_add_u32 v43, v10, 4, v43
    v_add_u32 v8, 7168, v0
    s_mov_b32 s24, 3277
    v_mul_lo_u32 v9, v8, s24
    v_lshrrev_b32 v9, 18, v9
    v_mul_u32_u24 v10, 80, v9
    v_sub_u32 v10, v8, v10
    v_mul_u32_u24 v44, 1312, v9
    v_lshl_add_u32 v44, v10, 4, v44
    v_add_u32 v8, 7424, v0
    s_mov_b32 s24, 3277
    v_mul_lo_u32 v9, v8, s24
    v_lshrrev_b32 v9, 18, v9
    v_mul_u32_u24 v10, 80, v9
    v_sub_u32 v10, v8, v10
    v_mul_u32_u24 v45, 1312, v9
    v_lshl_add_u32 v45, v10, 4, v45
    v_lshlrev_b32 v4, 4, v0
    s_mul_i32 s45, s44, 245760
    s_add_u32 s46, s45, 0
    buffer_load_dwordx4 v[48:51], v4, s[12:15], s46 offen
    s_add_u32 s46, s45, 4096
    buffer_load_dwordx4 v[52:55], v4, s[12:15], s46 offen
    s_add_u32 s46, s45, 8192
    buffer_load_dwordx4 v[56:59], v4, s[12:15], s46 offen
    s_add_u32 s46, s45, 12288
    buffer_load_dwordx4 v[60:63], v4, s[12:15], s46 offen
    s_add_u32 s46, s45, 16384
    buffer_load_dwordx4 v[64:67], v4, s[12:15], s46 offen
    s_add_u32 s46, s45, 20480
    buffer_load_dwordx4 v[68:71], v4, s[12:15], s46 offen
    s_add_u32 s46, s45, 24576
    buffer_load_dwordx4 v[72:75], v4, s[12:15], s46 offen
    s_add_u32 s46, s45, 28672
    buffer_load_dwordx4 v[76:79], v4, s[12:15], s46 offen
    s_add_u32 s46, s45, 32768
    buffer_load_dwordx4 v[80:83], v4, s[12:15], s46 offen
    s_add_u32 s46, s45, 36864
    buffer_load_dwordx4 v[84:87], v4, s[12:15], s46 offen
    s_add_u32 s46, s45, 40960
    buffer_load_dwordx4 v[88:91], v4, s[12:15], s46 offen
    s_add_u32 s46, s45, 45056
    buffer_load_dwordx4 v[92:95], v4, s[12:15], s46 offen
    s_add_u32 s46, s45, 49152
    buffer_load_dwordx4 v[96:99], v4, s[12:15], s46 offen
    s_add_u32 s46, s45, 53248
    buffer_load_dwordx4 v[100:103], v4, s[12:15], s46 offen
    s_add_u32 s46, s45, 57344
    buffer_load_dwordx4 v[104:107], v4, s[12:15], s46 offen
    s_add_u32 s46, s45, 61440
    buffer_load_dwordx4 v[108:111], v4, s[12:15], s46 offen
    s_add_u32 s46, s45, 65536
    buffer_load_dwordx4 v[112:115], v4, s[12:15], s46 offen
    s_add_u32 s46, s45, 69632
    buffer_load_dwordx4 v[116:119], v4, s[12:15], s46 offen
    s_add_u32 s46, s45, 73728
    buffer_load_dwordx4 v[120:123], v4, s[12:15], s46 offen
    s_add_u32 s46, s45, 77824
    buffer_load_dwordx4 v[124:127], v4, s[12:15], s46 offen
    s_add_u32 s46, s45, 81920
    buffer_load_dwordx4 v[128:131], v4, s[12:15], s46 offen
    s_add_u32 s46, s45, 86016
    buffer_load_dwordx4 v[132:135], v4, s[12:15], s46 offen
    s_add_u32 s46, s45, 90112
    buffer_load_dwordx4 v[136:139], v4, s[12:15], s46 offen
    s_add_u32 s46, s45, 94208
    buffer_load_dwordx4 v[140:143], v4, s[12:15], s46 offen
    s_add_u32 s46, s45, 98304
    buffer_load_dwordx4 v[144:147], v4, s[12:15], s46 offen
    s_add_u32 s46, s45, 102400
    buffer_load_dwordx4 v[148:151], v4, s[12:15], s46 offen
    s_add_u32 s46, s45, 106496
    buffer_load_dwordx4 v[152:155], v4, s[12:15], s46 offen
    s_add_u32 s46, s45, 110592
    buffer_load_dwordx4 v[156:159], v4, s[12:15], s46 offen
    s_add_u32 s46, s45, 114688
    buffer_load_dwordx4 v[160:163], v4, s[12:15], s46 offen
    s_add_u32 s46, s45, 118784
    buffer_load_dwordx4 v[164:167], v4, s[12:15], s46 offen
    s_add_u32 s46, s45, 122880
    buffer_load_dwordx4 v[168:171], v4, s[12:15], s46 offen
    s_add_u32 s46, s45, 126976
    buffer_load_dwordx4 v[172:175], v4, s[12:15], s46 offen
    s_add_u32 s46, s45, 131072
    buffer_load_dwordx4 v[176:179], v4, s[12:15], s46 offen
    s_add_u32 s46, s45, 135168
    buffer_load_dwordx4 v[180:183], v4, s[12:15], s46 offen
    s_add_u32 s46, s45, 139264
    buffer_load_dwordx4 v[184:187], v4, s[12:15], s46 offen
    s_add_u32 s46, s45, 143360
    buffer_load_dwordx4 v[188:191], v4, s[12:15], s46 offen
    s_add_u32 s46, s45, 147456
    buffer_load_dwordx4 v[192:195], v4, s[12:15], s46 offen
    s_add_u32 s46, s45, 151552
    buffer_load_dwordx4 v[196:199], v4, s[12:15], s46 offen
    s_add_u32 s46, s45, 155648
    buffer_load_dwordx4 v[200:203], v4, s[12:15], s46 offen
    s_add_u32 s46, s45, 159744
    buffer_load_dwordx4 v[204:207], v4, s[12:15], s46 offen
    s_add_u32 s46, s45, 163840
    buffer_load_dwordx4 v[208:211], v4, s[12:15], s46 offen
    s_add_u32 s46, s45, 167936
    buffer_load_dwordx4 v[212:215], v4, s[12:15], s46 offen
    s_add_u32 s46, s45, 172032
    buffer_load_dwordx4 v[216:219], v4, s[12:15], s46 offen
    s_add_u32 s46, s45, 176128
    buffer_load_dwordx4 v[220:223], v4, s[12:15], s46 offen
    s_add_u32 s46, s45, 180224
    buffer_load_dwordx4 v[224:227], v4, s[12:15], s46 offen
    s_add_u32 s46, s45, 184320
    buffer_load_dwordx4 v[228:231], v4, s[12:15], s46 offen
    s_add_u32 s46, s45, 188416
    buffer_load_dwordx4 v[232:235], v4, s[12:15], s46 offen
    s_add_u32 s46, s45, 192512
    buffer_load_dwordx4 v[236:239], v4, s[12:15], s46 offen
    s_add_u32 s46, s45, 196608
    buffer_load_dwordx4 v[240:243], v4, s[12:15], s46 offen
    s_add_u32 s46, s45, 200704
    buffer_load_dwordx4 v[244:247], v4, s[12:15], s46 offen
    s_add_u32 s46, s45, 204800
    buffer_load_dwordx4 v[248:251], v4, s[12:15], s46 offen
    s_add_u32 s46, s45, 208896
    buffer_load_dwordx4 v[252:255], v4, s[12:15], s46 offen
    v_lshrrev_b32 v8, 2, v2
    v_lshl_add_u32 v8, v3, 2, v8
    v_mul_u32_u24 v5, 1312, v8
    v_and_b32 v8, 3, v2
    v_lshl_add_u32 v5, v8, 3, v5
    s_mul_i32 s24, s3, 320
    v_add_u32 v5, s24, v5
    v_add_u32 v6, 62976, v5
    s_waitcnt vmcnt(22)
    ds_write_b128 v16, v[48:51]
    ds_write_b128 v17, v[52:55]
    ds_write_b128 v18, v[56:59]
    ds_write_b128 v19, v[60:63]
    ds_write_b128 v20, v[64:67]
    ds_write_b128 v21, v[68:71]
    ds_write_b128 v22, v[72:75]
    ds_write_b128 v23, v[76:79]
    ds_write_b128 v24, v[80:83]
    ds_write_b128 v25, v[84:87]
    ds_write_b128 v26, v[88:91]
    ds_write_b128 v27, v[92:95]
    ds_write_b128 v28, v[96:99]
    ds_write_b128 v29, v[100:103]
    ds_write_b128 v30, v[104:107]
    ds_write_b128 v31, v[108:111]
    ds_write_b128 v32, v[112:115]
    ds_write_b128 v33, v[116:119]
    ds_write_b128 v34, v[120:123]
    ds_write_b128 v35, v[124:127]
    ds_write_b128 v36, v[128:131]
    ds_write_b128 v37, v[132:135]
    ds_write_b128 v38, v[136:139]
    ds_write_b128 v39, v[140:143]
    ds_write_b128 v40, v[144:147]
    ds_write_b128 v41, v[148:151]
    ds_write_b128 v42, v[152:155]
    ds_write_b128 v43, v[156:159]
    ds_write_b128 v44, v[160:163]
    ds_write_b128 v45, v[164:167]
    s_waitcnt lgkmcnt(0)
    s_add_u32 s46, s45, 212992
    buffer_load_dwordx4 v[48:51], v4, s[12:15], s46 offen
    s_add_u32 s46, s45, 217088
    buffer_load_dwordx4 v[52:55], v4, s[12:15], s46 offen
    s_add_u32 s46, s45, 221184
    buffer_load_dwordx4 v[56:59], v4, s[12:15], s46 offen
    s_add_u32 s46, s45, 225280
    buffer_load_dwordx4 v[60:63], v4, s[12:15], s46 offen
    s_add_u32 s46, s45, 229376
    buffer_load_dwordx4 v[64:67], v4, s[12:15], s46 offen
    s_add_u32 s46, s45, 233472
    buffer_load_dwordx4 v[68:71], v4, s[12:15], s46 offen
    s_add_u32 s46, s45, 237568
    buffer_load_dwordx4 v[72:75], v4, s[12:15], s46 offen
    s_add_u32 s46, s45, 241664
    buffer_load_dwordx4 v[76:79], v4, s[12:15], s46 offen
    s_barrier
    ds_read_b64_tr_b16 a[0:1], v5 offset:0
    ds_read_b64_tr_b16 a[2:3], v5 offset:20992
    ds_read_b64_tr_b16 a[4:5], v6 offset:0
    ds_read_b64_tr_b16 a[6:7], v6 offset:20992
    ds_read_b64_tr_b16 a[16:17], v5 offset:41984
    ds_read_b64_tr_b16 a[18:19], v6 offset:41984
    ds_read_b64_tr_b16 a[24:25], v5 offset:32
    ds_read_b64_tr_b16 a[26:27], v5 offset:21024
    ds_read_b64_tr_b16 a[28:29], v6 offset:32
    ds_read_b64_tr_b16 a[30:31], v6 offset:21024
    ds_read_b64_tr_b16 a[40:41], v5 offset:42016
    ds_read_b64_tr_b16 a[42:43], v6 offset:42016
    ds_read_b64_tr_b16 a[48:49], v5 offset:64
    ds_read_b64_tr_b16 a[50:51], v5 offset:21056
    ds_read_b64_tr_b16 a[52:53], v6 offset:64
    ds_read_b64_tr_b16 a[54:55], v6 offset:21056
    ds_read_b64_tr_b16 a[64:65], v5 offset:42048
    ds_read_b64_tr_b16 a[66:67], v6 offset:42048
    ds_read_b64_tr_b16 a[72:73], v5 offset:96
    ds_read_b64_tr_b16 a[74:75], v5 offset:21088
    ds_read_b64_tr_b16 a[76:77], v6 offset:96
    ds_read_b64_tr_b16 a[78:79], v6 offset:21088
    ds_read_b64_tr_b16 a[88:89], v5 offset:42080
    ds_read_b64_tr_b16 a[90:91], v6 offset:42080
    ds_read_b64_tr_b16 a[96:97], v5 offset:128
    ds_read_b64_tr_b16 a[98:99], v5 offset:21120
    ds_read_b64_tr_b16 a[100:101], v6 offset:128
    ds_read_b64_tr_b16 a[102:103], v6 offset:21120
    ds_read_b64_tr_b16 a[112:113], v5 offset:42112
    ds_read_b64_tr_b16 a[114:115], v6 offset:42112
    ds_read_b64_tr_b16 a[120:121], v5 offset:160
    ds_read_b64_tr_b16 a[122:123], v5 offset:21152
    ds_read_b64_tr_b16 a[124:125], v6 offset:160
    ds_read_b64_tr_b16 a[126:127], v6 offset:21152
    ds_read_b64_tr_b16 a[136:137], v5 offset:42144
    ds_read_b64_tr_b16 a[138:139], v6 offset:42144
    ds_read_b64_tr_b16 a[144:145], v5 offset:192
    ds_read_b64_tr_b16 a[146:147], v5 offset:21184
    ds_read_b64_tr_b16 a[148:149], v6 offset:192
    ds_read_b64_tr_b16 a[150:151], v6 offset:21184
    ds_read_b64_tr_b16 a[160:161], v5 offset:42176
    ds_read_b64_tr_b16 a[162:163], v6 offset:42176
    ds_read_b64_tr_b16 a[168:169], v5 offset:224
    ds_read_b64_tr_b16 a[170:171], v5 offset:21216
    ds_read_b64_tr_b16 a[172:173], v6 offset:224
    ds_read_b64_tr_b16 a[174:175], v6 offset:21216
    ds_read_b64_tr_b16 a[184:185], v5 offset:42208
    ds_read_b64_tr_b16 a[186:187], v6 offset:42208
    ds_read_b64_tr_b16 a[192:193], v5 offset:256
    ds_read_b64_tr_b16 a[194:195], v5 offset:21248
    ds_read_b64_tr_b16 a[196:197], v6 offset:256
    ds_read_b64_tr_b16 a[198:199], v6 offset:21248
    ds_read_b64_tr_b16 a[208:209], v5 offset:42240
    ds_read_b64_tr_b16 a[210:211], v6 offset:42240
    ds_read_b64_tr_b16 a[216:217], v5 offset:288
    ds_read_b64_tr_b16 a[218:219], v5 offset:21280
    ds_read_b64_tr_b16 a[220:221], v6 offset:288
    ds_read_b64_tr_b16 a[222:223], v6 offset:21280
    ds_read_b64_tr_b16 a[232:233], v5 offset:42272
    ds_read_b64_tr_b16 a[234:235], v6 offset:42272
    s_waitcnt lgkmcnt(0)
    s_barrier
    s_waitcnt vmcnt(0)
    ds_write_b128 v16, v[168:171]
    ds_write_b128 v17, v[172:175]
    ds_write_b128 v18, v[176:179]
    ds_write_b128 v19, v[180:183]
    ds_write_b128 v20, v[184:187]
    ds_write_b128 v21, v[188:191]
    ds_write_b128 v22, v[192:195]
    ds_write_b128 v23, v[196:199]
    ds_write_b128 v24, v[200:203]
    ds_write_b128 v25, v[204:207]
    ds_write_b128 v26, v[208:211]
    ds_write_b128 v27, v[212:215]
    ds_write_b128 v28, v[216:219]
    ds_write_b128 v29, v[220:223]
    ds_write_b128 v30, v[224:227]
    ds_write_b128 v31, v[228:231]
    ds_write_b128 v32, v[232:235]
    ds_write_b128 v33, v[236:239]
    ds_write_b128 v34, v[240:243]
    ds_write_b128 v35, v[244:247]
    ds_write_b128 v36, v[248:251]
    ds_write_b128 v37, v[252:255]
    ds_write_b128 v38, v[48:51]
    ds_write_b128 v39, v[52:55]
    ds_write_b128 v40, v[56:59]
    ds_write_b128 v41, v[60:63]
    ds_write_b128 v42, v[64:67]
    ds_write_b128 v43, v[68:71]
    ds_write_b128 v44, v[72:75]
    ds_write_b128 v45, v[76:79]
    s_waitcnt lgkmcnt(0)
    s_barrier
    ds_read_b64_tr_b16 a[8:9], v5 offset:0
    ds_read_b64_tr_b16 a[10:11], v5 offset:20992
    ds_read_b64_tr_b16 a[12:13], v6 offset:0
    ds_read_b64_tr_b16 a[14:15], v6 offset:20992
    ds_read_b64_tr_b16 a[20:21], v5 offset:41984
    ds_read_b64_tr_b16 a[22:23], v6 offset:41984
    ds_read_b64_tr_b16 a[32:33], v5 offset:32
    ds_read_b64_tr_b16 a[34:35], v5 offset:21024
    ds_read_b64_tr_b16 a[36:37], v6 offset:32
    ds_read_b64_tr_b16 a[38:39], v6 offset:21024
    ds_read_b64_tr_b16 a[44:45], v5 offset:42016
    ds_read_b64_tr_b16 a[46:47], v6 offset:42016
    ds_read_b64_tr_b16 a[56:57], v5 offset:64
    ds_read_b64_tr_b16 a[58:59], v5 offset:21056
    ds_read_b64_tr_b16 a[60:61], v6 offset:64
    ds_read_b64_tr_b16 a[62:63], v6 offset:21056
    ds_read_b64_tr_b16 a[68:69], v5 offset:42048
    ds_read_b64_tr_b16 a[70:71], v6 offset:42048
    ds_read_b64_tr_b16 a[80:81], v5 offset:96
    ds_read_b64_tr_b16 a[82:83], v5 offset:21088
    ds_read_b64_tr_b16 a[84:85], v6 offset:96
    ds_read_b64_tr_b16 a[86:87], v6 offset:21088
    ds_read_b64_tr_b16 a[92:93], v5 offset:42080
    ds_read_b64_tr_b16 a[94:95], v6 offset:42080
    ds_read_b64_tr_b16 a[104:105], v5 offset:128
    ds_read_b64_tr_b16 a[106:107], v5 offset:21120
    ds_read_b64_tr_b16 a[108:109], v6 offset:128
    ds_read_b64_tr_b16 a[110:111], v6 offset:21120
    ds_read_b64_tr_b16 a[116:117], v5 offset:42112
    ds_read_b64_tr_b16 a[118:119], v6 offset:42112
    ds_read_b64_tr_b16 a[128:129], v5 offset:160
    ds_read_b64_tr_b16 a[130:131], v5 offset:21152
    ds_read_b64_tr_b16 a[132:133], v6 offset:160
    ds_read_b64_tr_b16 a[134:135], v6 offset:21152
    ds_read_b64_tr_b16 a[140:141], v5 offset:42144
    ds_read_b64_tr_b16 a[142:143], v6 offset:42144
    ds_read_b64_tr_b16 a[152:153], v5 offset:192
    ds_read_b64_tr_b16 a[154:155], v5 offset:21184
    ds_read_b64_tr_b16 a[156:157], v6 offset:192
    ds_read_b64_tr_b16 a[158:159], v6 offset:21184
    ds_read_b64_tr_b16 a[164:165], v5 offset:42176
    ds_read_b64_tr_b16 a[166:167], v6 offset:42176
    ds_read_b64_tr_b16 a[176:177], v5 offset:224
    ds_read_b64_tr_b16 a[178:179], v5 offset:21216
    ds_read_b64_tr_b16 a[180:181], v6 offset:224
    ds_read_b64_tr_b16 a[182:183], v6 offset:21216
    ds_read_b64_tr_b16 a[188:189], v5 offset:42208
    ds_read_b64_tr_b16 a[190:191], v6 offset:42208
    ds_read_b64_tr_b16 a[200:201], v5 offset:256
    ds_read_b64_tr_b16 a[202:203], v5 offset:21248
    ds_read_b64_tr_b16 a[204:205], v6 offset:256
    ds_read_b64_tr_b16 a[206:207], v6 offset:21248
    ds_read_b64_tr_b16 a[212:213], v5 offset:42240
    ds_read_b64_tr_b16 a[214:215], v6 offset:42240
    ds_read_b64_tr_b16 a[224:225], v5 offset:288
    ds_read_b64_tr_b16 a[226:227], v5 offset:21280
    ds_read_b64_tr_b16 a[228:229], v6 offset:288
    ds_read_b64_tr_b16 a[230:231], v6 offset:21280
    ds_read_b64_tr_b16 a[236:237], v5 offset:42272
    ds_read_b64_tr_b16 a[238:239], v6 offset:42272
    s_waitcnt lgkmcnt(0)
    s_barrier
    v_lshlrev_b32 v5, 4, v1
    s_mul_i32 s24, s44, 12288
    v_add_u32 v6, s24, v5
    v_add_u32 v7, 4096, v6
    v_add_u32 v8, 8192, v6
    s_mul_i32 s24, s3, 327680
    s_lshl_b32 s25, s44, 10
    s_add_u32 s24, s24, s25
    v_add_u32 v9, s24, v5
interleave_layers__linear_attn_block__memory_aug_recurrent_mem_tr__prompt_kernel_o_layer:
    s_mul_i32 s93, s92, 29360128
    s_add_u32 s93, s93, 117440512
    s_mul_i32 s94, s92, 16384
    s_add_u32 s94, s94, 23068672
    s_mov_b32 s24, 12288
    s_lshl_b32 s25, s44, 7
    s_add_u32 s24, s24, s25
    s_add_u32 s24, s24, s94
    v_mov_b32 v14, s24
    v_mov_b32 v15, 2146435072
    v_cmp_eq_u32 vcc, 0, v1
    s_nop 1
    v_cndmask_b32 v14, v15, v14, vcc
    s_lshl_b32 s24, s44, 7
    s_add_u32 s24, s24, 8192
    s_add_u32 s24, s24, s94
    v_mov_b32 v10, s24
    s_mov_b32 s41, 33554432
    s_mov_b32 s43, 184549376
    s_mov_b32 s40, 0
    s_mov_b32 s62, -1
    s_mov_b32 s63, 1
    s_cmp_ge_i32 s62, s63
    s_cbranch_scc1 interleave_layers__linear_attn_block__memory_aug_recurrent_mem_tr__prompt_kernel_o_en0_ok
    s_mov_b32 s61, 0
interleave_layers__linear_attn_block__memory_aug_recurrent_mem_tr__prompt_kernel_o_en0:
    buffer_load_dword v11, v10, s[8:11], 0 offen sc1
    s_waitcnt vmcnt(0)
    v_readlane_b32 s62, v11, 0
    s_cmp_ge_i32 s62, s63
    s_cbranch_scc1 interleave_layers__linear_attn_block__memory_aug_recurrent_mem_tr__prompt_kernel_o_en0_ok
    s_add_u32 s61, s61, 1
    s_cmp_ge_u32 s61, s60
    s_cbranch_scc1 interleave_layers__linear_attn_block__memory_aug_recurrent_mem_tr__prompt_kernel_o_en0_to
    s_sleep 2
    s_branch interleave_layers__linear_attn_block__memory_aug_recurrent_mem_tr__prompt_kernel_o_en0
interleave_layers__linear_attn_block__memory_aug_recurrent_mem_tr__prompt_kernel_o_en0_to:
    s_mov_b32 s60, 1
interleave_layers__linear_attn_block__memory_aug_recurrent_mem_tr__prompt_kernel_o_en0_ok:
    buffer_load_dwordx4 v[16:19], v6, s[8:11], s41 offen offset:0 sc1
    buffer_load_dwordx4 v[20:23], v6, s[8:11], s41 offen offset:1024 sc1
    buffer_load_dwordx4 v[24:27], v6, s[8:11], s41 offen offset:2048 sc1
    buffer_load_dwordx4 v[28:31], v6, s[8:11], s41 offen offset:3072 sc1
    buffer_load_dwordx4 v[32:35], v7, s[8:11], s41 offen offset:0 sc1
    buffer_load_dwordx4 v[36:39], v7, s[8:11], s41 offen offset:1024 sc1
    buffer_load_dwordx4 v[40:43], v7, s[8:11], s41 offen offset:2048 sc1
    buffer_load_dwordx4 v[44:47], v7, s[8:11], s41 offen offset:3072 sc1
    buffer_load_dwordx4 v[48:51], v8, s[8:11], s41 offen offset:0 sc1
    buffer_load_dwordx4 v[52:55], v8, s[8:11], s41 offen offset:1024 sc1
    buffer_load_dwordx4 v[56:59], v8, s[8:11], s41 offen offset:2048 sc1
    buffer_load_dwordx4 v[60:63], v8, s[8:11], s41 offen offset:3072 sc1
    s_add_u32 s41, s41, 393216
    s_waitcnt vmcnt(0)
interleave_layers__linear_attn_block__memory_aug_recurrent_mem_tr__prompt_kernel_o_seg:
    v_swap_b32 v26, v36
    v_swap_b32 v27, v37
    v_swap_b32 v50, v60
    v_swap_b32 v51, v61
    v_mfma_f32_16x16x32_bf16 v[112:115], v[16:19], a[0:3], 0
    v_mfma_f32_16x16x32_bf16 v[116:119], v[20:23], a[0:3], 0
    v_mfma_f32_16x16x32_bf16 v[120:123], v[16:19], a[24:27], 0
    v_mfma_f32_16x16x32_bf16 v[124:127], v[20:23], a[24:27], 0
    v_mfma_f32_16x16x32_bf16 v[128:131], v[16:19], a[48:51], 0
    v_mfma_f32_16x16x32_bf16 v[132:135], v[20:23], a[48:51], 0
    v_mfma_f32_16x16x32_bf16 v[136:139], v[16:19], a[72:75], 0
    v_mfma_f32_16x16x32_bf16 v[140:143], v[20:23], a[72:75], 0
    v_mfma_f32_16x16x32_bf16 v[144:147], v[16:19], a[96:99], 0
    v_mfma_f32_16x16x32_bf16 v[148:151], v[20:23], a[96:99], 0
    v_mfma_f32_16x16x32_bf16 v[152:155], v[16:19], a[120:123], 0
    v_mfma_f32_16x16x32_bf16 v[156:159], v[20:23], a[120:123], 0
    v_mfma_f32_16x16x32_bf16 v[160:163], v[16:19], a[144:147], 0
    v_mfma_f32_16x16x32_bf16 v[164:167], v[20:23], a[144:147], 0
    v_mfma_f32_16x16x32_bf16 v[168:171], v[16:19], a[168:171], 0
    v_mfma_f32_16x16x32_bf16 v[172:175], v[20:23], a[168:171], 0
    v_mfma_f32_16x16x32_bf16 v[176:179], v[16:19], a[192:195], 0
    v_mfma_f32_16x16x32_bf16 v[180:183], v[20:23], a[192:195], 0
    v_mfma_f32_16x16x32_bf16 v[184:187], v[16:19], a[216:219], 0
    v_mfma_f32_16x16x32_bf16 v[188:191], v[20:23], a[216:219], 0
    v_mfma_f32_16x16x32_bf16 v[112:115], v[28:31], a[4:7], v[112:115]
    v_mfma_f32_16x16x32_bf16 v[116:119], v[32:35], a[4:7], v[116:119]
    v_mfma_f32_16x16x32_bf16 v[120:123], v[28:31], a[28:31], v[120:123]
    v_mfma_f32_16x16x32_bf16 v[124:127], v[32:35], a[28:31], v[124:127]
    v_mfma_f32_16x16x32_bf16 v[128:131], v[28:31], a[52:55], v[128:131]
    v_mfma_f32_16x16x32_bf16 v[132:135], v[32:35], a[52:55], v[132:135]
    v_mfma_f32_16x16x32_bf16 v[136:139], v[28:31], a[76:79], v[136:139]
    v_mfma_f32_16x16x32_bf16 v[140:143], v[32:35], a[76:79], v[140:143]
    v_mfma_f32_16x16x32_bf16 v[144:147], v[28:31], a[100:103], v[144:147]
    v_mfma_f32_16x16x32_bf16 v[148:151], v[32:35], a[100:103], v[148:151]
    v_mfma_f32_16x16x32_bf16 v[152:155], v[28:31], a[124:127], v[152:155]
    v_mfma_f32_16x16x32_bf16 v[156:159], v[32:35], a[124:127], v[156:159]
    v_mfma_f32_16x16x32_bf16 v[160:163], v[28:31], a[148:151], v[160:163]
    v_mfma_f32_16x16x32_bf16 v[164:167], v[32:35], a[148:151], v[164:167]
    v_mfma_f32_16x16x32_bf16 v[168:171], v[28:31], a[172:175], v[168:171]
    v_mfma_f32_16x16x32_bf16 v[172:175], v[32:35], a[172:175], v[172:175]
    v_mfma_f32_16x16x32_bf16 v[176:179], v[28:31], a[196:199], v[176:179]
    v_mfma_f32_16x16x32_bf16 v[180:183], v[32:35], a[196:199], v[180:183]
    v_mfma_f32_16x16x32_bf16 v[184:187], v[28:31], a[220:223], v[184:187]
    v_mfma_f32_16x16x32_bf16 v[188:191], v[32:35], a[220:223], v[188:191]
    v_mfma_f32_16x16x32_bf16 v[112:115], v[40:43], a[8:11], v[112:115]
    v_mfma_f32_16x16x32_bf16 v[116:119], v[44:47], a[8:11], v[116:119]
    v_mfma_f32_16x16x32_bf16 v[120:123], v[40:43], a[32:35], v[120:123]
    v_mfma_f32_16x16x32_bf16 v[124:127], v[44:47], a[32:35], v[124:127]
    v_mfma_f32_16x16x32_bf16 v[128:131], v[40:43], a[56:59], v[128:131]
    v_mfma_f32_16x16x32_bf16 v[132:135], v[44:47], a[56:59], v[132:135]
    v_mfma_f32_16x16x32_bf16 v[136:139], v[40:43], a[80:83], v[136:139]
    v_mfma_f32_16x16x32_bf16 v[140:143], v[44:47], a[80:83], v[140:143]
    v_mfma_f32_16x16x32_bf16 v[144:147], v[40:43], a[104:107], v[144:147]
    v_mfma_f32_16x16x32_bf16 v[148:151], v[44:47], a[104:107], v[148:151]
    v_mfma_f32_16x16x32_bf16 v[152:155], v[40:43], a[128:131], v[152:155]
    v_mfma_f32_16x16x32_bf16 v[156:159], v[44:47], a[128:131], v[156:159]
    v_mfma_f32_16x16x32_bf16 v[160:163], v[40:43], a[152:155], v[160:163]
    v_mfma_f32_16x16x32_bf16 v[164:167], v[44:47], a[152:155], v[164:167]
    v_mfma_f32_16x16x32_bf16 v[168:171], v[40:43], a[176:179], v[168:171]
    v_mfma_f32_16x16x32_bf16 v[172:175], v[44:47], a[176:179], v[172:175]
    v_mfma_f32_16x16x32_bf16 v[176:179], v[40:43], a[200:203], v[176:179]
    v_mfma_f32_16x16x32_bf16 v[180:183], v[44:47], a[200:203], v[180:183]
    v_mfma_f32_16x16x32_bf16 v[184:187], v[40:43], a[224:227], v[184:187]
    v_mfma_f32_16x16x32_bf16 v[188:191], v[44:47], a[224:227], v[188:191]
    s_cmp_eq_u32 s40, 0
    s_cbranch_scc1 interleave_layers__linear_attn_block__memory_aug_recurrent_mem_tr__prompt_kernel_of33
    s_waitcnt vmcnt(0)
    s_barrier
    s_cmp_eq_u32 s3, 0
    s_cbranch_scc0 interleave_layers__linear_attn_block__memory_aug_recurrent_mem_tr__prompt_kernel_fp34
    v_mov_b32 v15, s40
    buffer_store_dword v15, v14, s[8:11], 0 offen sc1
interleave_layers__linear_attn_block__memory_aug_recurrent_mem_tr__prompt_kernel_fp34:
    s_add_u32 s63, s40, 2
    s_min_u32 s63, s63, 64
    s_cmp_ge_i32 s62, s63
    s_cbranch_scc1 interleave_layers__linear_attn_block__memory_aug_recurrent_mem_tr__prompt_kernel_o_en1_ok
    s_mov_b32 s61, 0
interleave_layers__linear_attn_block__memory_aug_recurrent_mem_tr__prompt_kernel_o_en1:
    buffer_load_dword v11, v10, s[8:11], 0 offen sc1
    s_waitcnt vmcnt(0)
    v_readlane_b32 s62, v11, 0
    s_cmp_ge_i32 s62, s63
    s_cbranch_scc1 interleave_layers__linear_attn_block__memory_aug_recurrent_mem_tr__prompt_kernel_o_en1_ok
    s_add_u32 s61, s61, 1
    s_cmp_ge_u32 s61, s60
    s_cbranch_scc1 interleave_layers__linear_attn_block__memory_aug_recurrent_mem_tr__prompt_kernel_o_en1_to
    s_sleep 2
    s_branch interleave_layers__linear_attn_block__memory_aug_recurrent_mem_tr__prompt_kernel_o_en1
interleave_layers__linear_attn_block__memory_aug_recurrent_mem_tr__prompt_kernel_o_en1_to:
    s_mov_b32 s60, 1
interleave_layers__linear_attn_block__memory_aug_recurrent_mem_tr__prompt_kernel_o_en1_ok:
    buffer_load_dwordx4 v[64:67], v6, s[8:11], s41 offen offset:0 sc1
    buffer_load_dwordx4 v[68:71], v6, s[8:11], s41 offen offset:1024 sc1
    buffer_load_dwordx4 v[72:75], v6, s[8:11], s41 offen offset:2048 sc1
    buffer_load_dwordx4 v[76:79], v6, s[8:11], s41 offen offset:3072 sc1
    buffer_load_dwordx4 v[80:83], v7, s[8:11], s41 offen offset:0 sc1
    buffer_load_dwordx4 v[84:87], v7, s[8:11], s41 offen offset:1024 sc1
    buffer_load_dwordx4 v[88:91], v7, s[8:11], s41 offen offset:2048 sc1
    buffer_load_dwordx4 v[92:95], v7, s[8:11], s41 offen offset:3072 sc1
    buffer_load_dwordx4 v[96:99], v8, s[8:11], s41 offen offset:0 sc1
    buffer_load_dwordx4 v[100:103], v8, s[8:11], s41 offen offset:1024 sc1
    buffer_load_dwordx4 v[104:107], v8, s[8:11], s41 offen offset:2048 sc1
    buffer_load_dwordx4 v[108:111], v8, s[8:11], s41 offen offset:3072 sc1
    s_add_u32 s41, s41, 393216
interleave_layers__linear_attn_block__memory_aug_recurrent_mem_tr__prompt_kernel_of33:
    v_mfma_f32_16x16x32_bf16 v[112:115], v[52:55], a[12:15], v[112:115]
    v_mfma_f32_16x16x32_bf16 v[116:119], v[56:59], a[12:15], v[116:119]
    v_mfma_f32_16x16x32_bf16 v[120:123], v[52:55], a[36:39], v[120:123]
    v_mfma_f32_16x16x32_bf16 v[124:127], v[56:59], a[36:39], v[124:127]
    v_mfma_f32_16x16x32_bf16 v[128:131], v[52:55], a[60:63], v[128:131]
    v_mfma_f32_16x16x32_bf16 v[132:135], v[56:59], a[60:63], v[132:135]
    v_mfma_f32_16x16x32_bf16 v[136:139], v[52:55], a[84:87], v[136:139]
    v_mfma_f32_16x16x32_bf16 v[140:143], v[56:59], a[84:87], v[140:143]
    v_mfma_f32_16x16x32_bf16 v[144:147], v[52:55], a[108:111], v[144:147]
    v_mfma_f32_16x16x32_bf16 v[148:151], v[56:59], a[108:111], v[148:151]
    v_mfma_f32_16x16x32_bf16 v[152:155], v[52:55], a[132:135], v[152:155]
    v_mfma_f32_16x16x32_bf16 v[156:159], v[56:59], a[132:135], v[156:159]
    v_mfma_f32_16x16x32_bf16 v[160:163], v[52:55], a[156:159], v[160:163]
    v_mfma_f32_16x16x32_bf16 v[164:167], v[56:59], a[156:159], v[164:167]
    v_mfma_f32_16x16x32_bf16 v[168:171], v[52:55], a[180:183], v[168:171]
    v_mfma_f32_16x16x32_bf16 v[172:175], v[56:59], a[180:183], v[172:175]
    v_mfma_f32_16x16x32_bf16 v[176:179], v[52:55], a[204:207], v[176:179]
    v_mfma_f32_16x16x32_bf16 v[180:183], v[56:59], a[204:207], v[180:183]
    v_mfma_f32_16x16x32_bf16 v[184:187], v[52:55], a[228:231], v[184:187]
    v_mfma_f32_16x16x32_bf16 v[188:191], v[56:59], a[228:231], v[188:191]
    v_mfma_f32_16x16x32_bf16 v[112:115], v[24:27], a[16:19], v[112:115]
    v_mfma_f32_16x16x32_bf16 v[116:119], v[36:39], a[16:19], v[116:119]
    v_mfma_f32_16x16x32_bf16 v[120:123], v[24:27], a[40:43], v[120:123]
    v_mfma_f32_16x16x32_bf16 v[124:127], v[36:39], a[40:43], v[124:127]
    v_mfma_f32_16x16x32_bf16 v[128:131], v[24:27], a[64:67], v[128:131]
    v_mfma_f32_16x16x32_bf16 v[132:135], v[36:39], a[64:67], v[132:135]
    v_mfma_f32_16x16x32_bf16 v[136:139], v[24:27], a[88:91], v[136:139]
    v_mfma_f32_16x16x32_bf16 v[140:143], v[36:39], a[88:91], v[140:143]
    v_mfma_f32_16x16x32_bf16 v[144:147], v[24:27], a[112:115], v[144:147]
    v_mfma_f32_16x16x32_bf16 v[148:151], v[36:39], a[112:115], v[148:151]
    v_mfma_f32_16x16x32_bf16 v[152:155], v[24:27], a[136:139], v[152:155]
    v_mfma_f32_16x16x32_bf16 v[156:159], v[36:39], a[136:139], v[156:159]
    v_mfma_f32_16x16x32_bf16 v[160:163], v[24:27], a[160:163], v[160:163]
    v_mfma_f32_16x16x32_bf16 v[164:167], v[36:39], a[160:163], v[164:167]
    v_mfma_f32_16x16x32_bf16 v[168:171], v[24:27], a[184:187], v[168:171]
    v_mfma_f32_16x16x32_bf16 v[172:175], v[36:39], a[184:187], v[172:175]
    v_mfma_f32_16x16x32_bf16 v[176:179], v[24:27], a[208:211], v[176:179]
    v_mfma_f32_16x16x32_bf16 v[180:183], v[36:39], a[208:211], v[180:183]
    v_mfma_f32_16x16x32_bf16 v[184:187], v[24:27], a[232:235], v[184:187]
    v_mfma_f32_16x16x32_bf16 v[188:191], v[36:39], a[232:235], v[188:191]
    v_mfma_f32_16x16x32_bf16 v[112:115], v[48:51], a[20:23], v[112:115]
    v_mfma_f32_16x16x32_bf16 v[116:119], v[60:63], a[20:23], v[116:119]
    v_mfma_f32_16x16x32_bf16 v[120:123], v[48:51], a[44:47], v[120:123]
    v_mfma_f32_16x16x32_bf16 v[124:127], v[60:63], a[44:47], v[124:127]
    v_mfma_f32_16x16x32_bf16 v[128:131], v[48:51], a[68:71], v[128:131]
    v_mfma_f32_16x16x32_bf16 v[132:135], v[60:63], a[68:71], v[132:135]
    v_mfma_f32_16x16x32_bf16 v[136:139], v[48:51], a[92:95], v[136:139]
    v_mfma_f32_16x16x32_bf16 v[140:143], v[60:63], a[92:95], v[140:143]
    v_mfma_f32_16x16x32_bf16 v[144:147], v[48:51], a[116:119], v[144:147]
    v_mfma_f32_16x16x32_bf16 v[148:151], v[60:63], a[116:119], v[148:151]
    v_mfma_f32_16x16x32_bf16 v[152:155], v[48:51], a[140:143], v[152:155]
    v_mfma_f32_16x16x32_bf16 v[156:159], v[60:63], a[140:143], v[156:159]
    v_mfma_f32_16x16x32_bf16 v[160:163], v[48:51], a[164:167], v[160:163]
    v_mfma_f32_16x16x32_bf16 v[164:167], v[60:63], a[164:167], v[164:167]
    v_mfma_f32_16x16x32_bf16 v[168:171], v[48:51], a[188:191], v[168:171]
    v_mfma_f32_16x16x32_bf16 v[172:175], v[60:63], a[188:191], v[172:175]
    v_mfma_f32_16x16x32_bf16 v[176:179], v[48:51], a[212:215], v[176:179]
    v_mfma_f32_16x16x32_bf16 v[180:183], v[60:63], a[212:215], v[180:183]
    v_mfma_f32_16x16x32_bf16 v[184:187], v[48:51], a[236:239], v[184:187]
    v_mfma_f32_16x16x32_bf16 v[188:191], v[60:63], a[236:239], v[188:191]
    s_mov_b32 s46, s43
    v_cvt_pk_bf16_f32 v192, v112, v113
    v_cvt_pk_bf16_f32 v193, v114, v115
    v_cvt_pk_bf16_f32 v194, v116, v117
    v_cvt_pk_bf16_f32 v195, v118, v119
    buffer_store_dwordx4 v[192:195], v9, s[8:11], s46 offen sc1
    s_add_u32 s46, s46, 32768
    v_cvt_pk_bf16_f32 v196, v120, v121
    v_cvt_pk_bf16_f32 v197, v122, v123
    v_cvt_pk_bf16_f32 v198, v124, v125
    v_cvt_pk_bf16_f32 v199, v126, v127
    buffer_store_dwordx4 v[196:199], v9, s[8:11], s46 offen sc1
    s_add_u32 s46, s46, 32768
    v_cvt_pk_bf16_f32 v200, v128, v129
    v_cvt_pk_bf16_f32 v201, v130, v131
    v_cvt_pk_bf16_f32 v202, v132, v133
    v_cvt_pk_bf16_f32 v203, v134, v135
    buffer_store_dwordx4 v[200:203], v9, s[8:11], s46 offen sc1
    s_add_u32 s46, s46, 32768
    v_cvt_pk_bf16_f32 v204, v136, v137
    v_cvt_pk_bf16_f32 v205, v138, v139
    v_cvt_pk_bf16_f32 v206, v140, v141
    v_cvt_pk_bf16_f32 v207, v142, v143
    buffer_store_dwordx4 v[204:207], v9, s[8:11], s46 offen sc1
    s_add_u32 s46, s46, 32768
    v_cvt_pk_bf16_f32 v208, v144, v145
    v_cvt_pk_bf16_f32 v209, v146, v147
    v_cvt_pk_bf16_f32 v210, v148, v149
    v_cvt_pk_bf16_f32 v211, v150, v151
    buffer_store_dwordx4 v[208:211], v9, s[8:11], s46 offen sc1
    s_add_u32 s46, s46, 32768
    v_cvt_pk_bf16_f32 v212, v152, v153
    v_cvt_pk_bf16_f32 v213, v154, v155
    v_cvt_pk_bf16_f32 v214, v156, v157
    v_cvt_pk_bf16_f32 v215, v158, v159
    buffer_store_dwordx4 v[212:215], v9, s[8:11], s46 offen sc1
    s_add_u32 s46, s46, 32768
    v_cvt_pk_bf16_f32 v216, v160, v161
    v_cvt_pk_bf16_f32 v217, v162, v163
    v_cvt_pk_bf16_f32 v218, v164, v165
    v_cvt_pk_bf16_f32 v219, v166, v167
    buffer_store_dwordx4 v[216:219], v9, s[8:11], s46 offen sc1
    s_add_u32 s46, s46, 32768
    v_cvt_pk_bf16_f32 v220, v168, v169
    v_cvt_pk_bf16_f32 v221, v170, v171
    v_cvt_pk_bf16_f32 v222, v172, v173
    v_cvt_pk_bf16_f32 v223, v174, v175
    buffer_store_dwordx4 v[220:223], v9, s[8:11], s46 offen sc1
    s_add_u32 s46, s46, 32768
    v_cvt_pk_bf16_f32 v224, v176, v177
    v_cvt_pk_bf16_f32 v225, v178, v179
    v_cvt_pk_bf16_f32 v226, v180, v181
    v_cvt_pk_bf16_f32 v227, v182, v183
    buffer_store_dwordx4 v[224:227], v9, s[8:11], s46 offen sc1
    s_add_u32 s46, s46, 32768
    v_cvt_pk_bf16_f32 v228, v184, v185
    v_cvt_pk_bf16_f32 v229, v186, v187
    v_cvt_pk_bf16_f32 v230, v188, v189
    v_cvt_pk_bf16_f32 v231, v190, v191
    buffer_store_dwordx4 v[228:231], v9, s[8:11], s46 offen sc1
    s_cmp_eq_u32 s40, 0
    s_cbranch_scc0 interleave_layers__linear_attn_block__memory_aug_recurrent_mem_tr__prompt_kernel_of35
    s_waitcnt vmcnt(0)
    s_barrier
    s_cmp_eq_u32 s3, 0
    s_cbranch_scc0 interleave_layers__linear_attn_block__memory_aug_recurrent_mem_tr__prompt_kernel_fp36
    v_mov_b32 v15, 1
    buffer_store_dword v15, v14, s[8:11], 0 offen sc1
interleave_layers__linear_attn_block__memory_aug_recurrent_mem_tr__prompt_kernel_fp36:
    s_add_u32 s63, s40, 2
    s_min_u32 s63, s63, 64
    s_cmp_ge_i32 s62, s63
    s_cbranch_scc1 interleave_layers__linear_attn_block__memory_aug_recurrent_mem_tr__prompt_kernel_o_en3_ok
    s_mov_b32 s61, 0
interleave_layers__linear_attn_block__memory_aug_recurrent_mem_tr__prompt_kernel_o_en3:
    buffer_load_dword v11, v10, s[8:11], 0 offen sc1
    s_waitcnt vmcnt(0)
    v_readlane_b32 s62, v11, 0
    s_cmp_ge_i32 s62, s63
    s_cbranch_scc1 interleave_layers__linear_attn_block__memory_aug_recurrent_mem_tr__prompt_kernel_o_en3_ok
    s_add_u32 s61, s61, 1
    s_cmp_ge_u32 s61, s60
    s_cbranch_scc1 interleave_layers__linear_attn_block__memory_aug_recurrent_mem_tr__prompt_kernel_o_en3_to
    s_sleep 2
    s_branch interleave_layers__linear_attn_block__memory_aug_recurrent_mem_tr__prompt_kernel_o_en3
interleave_layers__linear_attn_block__memory_aug_recurrent_mem_tr__prompt_kernel_o_en3_to:
    s_mov_b32 s60, 1
interleave_layers__linear_attn_block__memory_aug_recurrent_mem_tr__prompt_kernel_o_en3_ok:
    buffer_load_dwordx4 v[64:67], v6, s[8:11], s41 offen offset:0 sc1
    buffer_load_dwordx4 v[68:71], v6, s[8:11], s41 offen offset:1024 sc1
    buffer_load_dwordx4 v[72:75], v6, s[8:11], s41 offen offset:2048 sc1
    buffer_load_dwordx4 v[76:79], v6, s[8:11], s41 offen offset:3072 sc1
    buffer_load_dwordx4 v[80:83], v7, s[8:11], s41 offen offset:0 sc1
    buffer_load_dwordx4 v[84:87], v7, s[8:11], s41 offen offset:1024 sc1
    buffer_load_dwordx4 v[88:91], v7, s[8:11], s41 offen offset:2048 sc1
    buffer_load_dwordx4 v[92:95], v7, s[8:11], s41 offen offset:3072 sc1
    buffer_load_dwordx4 v[96:99], v8, s[8:11], s41 offen offset:0 sc1
    buffer_load_dwordx4 v[100:103], v8, s[8:11], s41 offen offset:1024 sc1
    buffer_load_dwordx4 v[104:107], v8, s[8:11], s41 offen offset:2048 sc1
    buffer_load_dwordx4 v[108:111], v8, s[8:11], s41 offen offset:3072 sc1
    s_add_u32 s41, s41, 393216
    s_waitcnt vmcnt(0)
interleave_layers__linear_attn_block__memory_aug_recurrent_mem_tr__prompt_kernel_of35:
    s_waitcnt vmcnt(10)
    s_add_u32 s40, s40, 1
    s_add_u32 s43, s43, 1310720
    v_swap_b32 v74, v84
    v_swap_b32 v75, v85
    v_swap_b32 v98, v108
    v_swap_b32 v99, v109
    v_mfma_f32_16x16x32_bf16 v[112:115], v[64:67], a[0:3], 0
    v_mfma_f32_16x16x32_bf16 v[116:119], v[68:71], a[0:3], 0
    v_mfma_f32_16x16x32_bf16 v[120:123], v[64:67], a[24:27], 0
    v_mfma_f32_16x16x32_bf16 v[124:127], v[68:71], a[24:27], 0
    v_mfma_f32_16x16x32_bf16 v[128:131], v[64:67], a[48:51], 0
    v_mfma_f32_16x16x32_bf16 v[132:135], v[68:71], a[48:51], 0
    v_mfma_f32_16x16x32_bf16 v[136:139], v[64:67], a[72:75], 0
    v_mfma_f32_16x16x32_bf16 v[140:143], v[68:71], a[72:75], 0
    v_mfma_f32_16x16x32_bf16 v[144:147], v[64:67], a[96:99], 0
    v_mfma_f32_16x16x32_bf16 v[148:151], v[68:71], a[96:99], 0
    v_mfma_f32_16x16x32_bf16 v[152:155], v[64:67], a[120:123], 0
    v_mfma_f32_16x16x32_bf16 v[156:159], v[68:71], a[120:123], 0
    v_mfma_f32_16x16x32_bf16 v[160:163], v[64:67], a[144:147], 0
    v_mfma_f32_16x16x32_bf16 v[164:167], v[68:71], a[144:147], 0
    v_mfma_f32_16x16x32_bf16 v[168:171], v[64:67], a[168:171], 0
    v_mfma_f32_16x16x32_bf16 v[172:175], v[68:71], a[168:171], 0
    v_mfma_f32_16x16x32_bf16 v[176:179], v[64:67], a[192:195], 0
    v_mfma_f32_16x16x32_bf16 v[180:183], v[68:71], a[192:195], 0
    v_mfma_f32_16x16x32_bf16 v[184:187], v[64:67], a[216:219], 0
    v_mfma_f32_16x16x32_bf16 v[188:191], v[68:71], a[216:219], 0
    v_mfma_f32_16x16x32_bf16 v[112:115], v[76:79], a[4:7], v[112:115]
    v_mfma_f32_16x16x32_bf16 v[116:119], v[80:83], a[4:7], v[116:119]
    v_mfma_f32_16x16x32_bf16 v[120:123], v[76:79], a[28:31], v[120:123]
    v_mfma_f32_16x16x32_bf16 v[124:127], v[80:83], a[28:31], v[124:127]
    v_mfma_f32_16x16x32_bf16 v[128:131], v[76:79], a[52:55], v[128:131]
    v_mfma_f32_16x16x32_bf16 v[132:135], v[80:83], a[52:55], v[132:135]
    v_mfma_f32_16x16x32_bf16 v[136:139], v[76:79], a[76:79], v[136:139]
    v_mfma_f32_16x16x32_bf16 v[140:143], v[80:83], a[76:79], v[140:143]
    v_mfma_f32_16x16x32_bf16 v[144:147], v[76:79], a[100:103], v[144:147]
    v_mfma_f32_16x16x32_bf16 v[148:151], v[80:83], a[100:103], v[148:151]
    v_mfma_f32_16x16x32_bf16 v[152:155], v[76:79], a[124:127], v[152:155]
    v_mfma_f32_16x16x32_bf16 v[156:159], v[80:83], a[124:127], v[156:159]
    v_mfma_f32_16x16x32_bf16 v[160:163], v[76:79], a[148:151], v[160:163]
    v_mfma_f32_16x16x32_bf16 v[164:167], v[80:83], a[148:151], v[164:167]
    v_mfma_f32_16x16x32_bf16 v[168:171], v[76:79], a[172:175], v[168:171]
    v_mfma_f32_16x16x32_bf16 v[172:175], v[80:83], a[172:175], v[172:175]
    v_mfma_f32_16x16x32_bf16 v[176:179], v[76:79], a[196:199], v[176:179]
    v_mfma_f32_16x16x32_bf16 v[180:183], v[80:83], a[196:199], v[180:183]
    v_mfma_f32_16x16x32_bf16 v[184:187], v[76:79], a[220:223], v[184:187]
    v_mfma_f32_16x16x32_bf16 v[188:191], v[80:83], a[220:223], v[188:191]
    v_mfma_f32_16x16x32_bf16 v[112:115], v[88:91], a[8:11], v[112:115]
    v_mfma_f32_16x16x32_bf16 v[116:119], v[92:95], a[8:11], v[116:119]
    v_mfma_f32_16x16x32_bf16 v[120:123], v[88:91], a[32:35], v[120:123]
    v_mfma_f32_16x16x32_bf16 v[124:127], v[92:95], a[32:35], v[124:127]
    v_mfma_f32_16x16x32_bf16 v[128:131], v[88:91], a[56:59], v[128:131]
    v_mfma_f32_16x16x32_bf16 v[132:135], v[92:95], a[56:59], v[132:135]
    v_mfma_f32_16x16x32_bf16 v[136:139], v[88:91], a[80:83], v[136:139]
    v_mfma_f32_16x16x32_bf16 v[140:143], v[92:95], a[80:83], v[140:143]
    v_mfma_f32_16x16x32_bf16 v[144:147], v[88:91], a[104:107], v[144:147]
    v_mfma_f32_16x16x32_bf16 v[148:151], v[92:95], a[104:107], v[148:151]
    v_mfma_f32_16x16x32_bf16 v[152:155], v[88:91], a[128:131], v[152:155]
    v_mfma_f32_16x16x32_bf16 v[156:159], v[92:95], a[128:131], v[156:159]
    v_mfma_f32_16x16x32_bf16 v[160:163], v[88:91], a[152:155], v[160:163]
    v_mfma_f32_16x16x32_bf16 v[164:167], v[92:95], a[152:155], v[164:167]
    v_mfma_f32_16x16x32_bf16 v[168:171], v[88:91], a[176:179], v[168:171]
    v_mfma_f32_16x16x32_bf16 v[172:175], v[92:95], a[176:179], v[172:175]
    v_mfma_f32_16x16x32_bf16 v[176:179], v[88:91], a[200:203], v[176:179]
    v_mfma_f32_16x16x32_bf16 v[180:183], v[92:95], a[200:203], v[180:183]
    v_mfma_f32_16x16x32_bf16 v[184:187], v[88:91], a[224:227], v[184:187]
    v_mfma_f32_16x16x32_bf16 v[188:191], v[92:95], a[224:227], v[188:191]
    s_waitcnt vmcnt(0)
    s_barrier
    s_cmp_eq_u32 s3, 0
    s_cbranch_scc0 interleave_layers__linear_attn_block__memory_aug_recurrent_mem_tr__prompt_kernel_fp38
    v_mov_b32 v15, s40
    buffer_store_dword v15, v14, s[8:11], 0 offen sc1
interleave_layers__linear_attn_block__memory_aug_recurrent_mem_tr__prompt_kernel_fp38:
    s_add_u32 s63, s40, 2
    s_min_u32 s63, s63, 64
    s_cmp_ge_i32 s62, s63
    s_cbranch_scc1 interleave_layers__linear_attn_block__memory_aug_recurrent_mem_tr__prompt_kernel_o_en2_ok
    s_mov_b32 s61, 0
interleave_layers__linear_attn_block__memory_aug_recurrent_mem_tr__prompt_kernel_o_en2:
    buffer_load_dword v11, v10, s[8:11], 0 offen sc1
    s_waitcnt vmcnt(0)
    v_readlane_b32 s62, v11, 0
    s_cmp_ge_i32 s62, s63
    s_cbranch_scc1 interleave_layers__linear_attn_block__memory_aug_recurrent_mem_tr__prompt_kernel_o_en2_ok
    s_add_u32 s61, s61, 1
    s_cmp_ge_u32 s61, s60
    s_cbranch_scc1 interleave_layers__linear_attn_block__memory_aug_recurrent_mem_tr__prompt_kernel_o_en2_to
    s_sleep 2
    s_branch interleave_layers__linear_attn_block__memory_aug_recurrent_mem_tr__prompt_kernel_o_en2
interleave_layers__linear_attn_block__memory_aug_recurrent_mem_tr__prompt_kernel_o_en2_to:
    s_mov_b32 s60, 1
interleave_layers__linear_attn_block__memory_aug_recurrent_mem_tr__prompt_kernel_o_en2_ok:
    buffer_load_dwordx4 v[16:19], v6, s[8:11], s41 offen offset:0 sc1
    buffer_load_dwordx4 v[20:23], v6, s[8:11], s41 offen offset:1024 sc1
    buffer_load_dwordx4 v[24:27], v6, s[8:11], s41 offen offset:2048 sc1
    buffer_load_dwordx4 v[28:31], v6, s[8:11], s41 offen offset:3072 sc1
    buffer_load_dwordx4 v[32:35], v7, s[8:11], s41 offen offset:0 sc1
    buffer_load_dwordx4 v[36:39], v7, s[8:11], s41 offen offset:1024 sc1
    buffer_load_dwordx4 v[40:43], v7, s[8:11], s41 offen offset:2048 sc1
    buffer_load_dwordx4 v[44:47], v7, s[8:11], s41 offen offset:3072 sc1
    buffer_load_dwordx4 v[48:51], v8, s[8:11], s41 offen offset:0 sc1
    buffer_load_dwordx4 v[52:55], v8, s[8:11], s41 offen offset:1024 sc1
    buffer_load_dwordx4 v[56:59], v8, s[8:11], s41 offen offset:2048 sc1
    buffer_load_dwordx4 v[60:63], v8, s[8:11], s41 offen offset:3072 sc1
    s_add_u32 s41, s41, 393216
interleave_layers__linear_attn_block__memory_aug_recurrent_mem_tr__prompt_kernel_of37:
    v_mfma_f32_16x16x32_bf16 v[112:115], v[100:103], a[12:15], v[112:115]
    v_mfma_f32_16x16x32_bf16 v[116:119], v[104:107], a[12:15], v[116:119]
    v_mfma_f32_16x16x32_bf16 v[120:123], v[100:103], a[36:39], v[120:123]
    v_mfma_f32_16x16x32_bf16 v[124:127], v[104:107], a[36:39], v[124:127]
    v_mfma_f32_16x16x32_bf16 v[128:131], v[100:103], a[60:63], v[128:131]
    v_mfma_f32_16x16x32_bf16 v[132:135], v[104:107], a[60:63], v[132:135]
    v_mfma_f32_16x16x32_bf16 v[136:139], v[100:103], a[84:87], v[136:139]
    v_mfma_f32_16x16x32_bf16 v[140:143], v[104:107], a[84:87], v[140:143]
    v_mfma_f32_16x16x32_bf16 v[144:147], v[100:103], a[108:111], v[144:147]
    v_mfma_f32_16x16x32_bf16 v[148:151], v[104:107], a[108:111], v[148:151]
    v_mfma_f32_16x16x32_bf16 v[152:155], v[100:103], a[132:135], v[152:155]
    v_mfma_f32_16x16x32_bf16 v[156:159], v[104:107], a[132:135], v[156:159]
    v_mfma_f32_16x16x32_bf16 v[160:163], v[100:103], a[156:159], v[160:163]
    v_mfma_f32_16x16x32_bf16 v[164:167], v[104:107], a[156:159], v[164:167]
    v_mfma_f32_16x16x32_bf16 v[168:171], v[100:103], a[180:183], v[168:171]
    v_mfma_f32_16x16x32_bf16 v[172:175], v[104:107], a[180:183], v[172:175]
    v_mfma_f32_16x16x32_bf16 v[176:179], v[100:103], a[204:207], v[176:179]
    v_mfma_f32_16x16x32_bf16 v[180:183], v[104:107], a[204:207], v[180:183]
    v_mfma_f32_16x16x32_bf16 v[184:187], v[100:103], a[228:231], v[184:187]
    v_mfma_f32_16x16x32_bf16 v[188:191], v[104:107], a[228:231], v[188:191]
    v_mfma_f32_16x16x32_bf16 v[112:115], v[72:75], a[16:19], v[112:115]
    v_mfma_f32_16x16x32_bf16 v[116:119], v[84:87], a[16:19], v[116:119]
    v_mfma_f32_16x16x32_bf16 v[120:123], v[72:75], a[40:43], v[120:123]
    v_mfma_f32_16x16x32_bf16 v[124:127], v[84:87], a[40:43], v[124:127]
    v_mfma_f32_16x16x32_bf16 v[128:131], v[72:75], a[64:67], v[128:131]
    v_mfma_f32_16x16x32_bf16 v[132:135], v[84:87], a[64:67], v[132:135]
    v_mfma_f32_16x16x32_bf16 v[136:139], v[72:75], a[88:91], v[136:139]
    v_mfma_f32_16x16x32_bf16 v[140:143], v[84:87], a[88:91], v[140:143]
    v_mfma_f32_16x16x32_bf16 v[144:147], v[72:75], a[112:115], v[144:147]
    v_mfma_f32_16x16x32_bf16 v[148:151], v[84:87], a[112:115], v[148:151]
    v_mfma_f32_16x16x32_bf16 v[152:155], v[72:75], a[136:139], v[152:155]
    v_mfma_f32_16x16x32_bf16 v[156:159], v[84:87], a[136:139], v[156:159]
    v_mfma_f32_16x16x32_bf16 v[160:163], v[72:75], a[160:163], v[160:163]
    v_mfma_f32_16x16x32_bf16 v[164:167], v[84:87], a[160:163], v[164:167]
    v_mfma_f32_16x16x32_bf16 v[168:171], v[72:75], a[184:187], v[168:171]
    v_mfma_f32_16x16x32_bf16 v[172:175], v[84:87], a[184:187], v[172:175]
    v_mfma_f32_16x16x32_bf16 v[176:179], v[72:75], a[208:211], v[176:179]
    v_mfma_f32_16x16x32_bf16 v[180:183], v[84:87], a[208:211], v[180:183]
    v_mfma_f32_16x16x32_bf16 v[184:187], v[72:75], a[232:235], v[184:187]
    v_mfma_f32_16x16x32_bf16 v[188:191], v[84:87], a[232:235], v[188:191]
    v_mfma_f32_16x16x32_bf16 v[112:115], v[96:99], a[20:23], v[112:115]
    v_mfma_f32_16x16x32_bf16 v[116:119], v[108:111], a[20:23], v[116:119]
    v_mfma_f32_16x16x32_bf16 v[120:123], v[96:99], a[44:47], v[120:123]
    v_mfma_f32_16x16x32_bf16 v[124:127], v[108:111], a[44:47], v[124:127]
    v_mfma_f32_16x16x32_bf16 v[128:131], v[96:99], a[68:71], v[128:131]
    v_mfma_f32_16x16x32_bf16 v[132:135], v[108:111], a[68:71], v[132:135]
    v_mfma_f32_16x16x32_bf16 v[136:139], v[96:99], a[92:95], v[136:139]
    v_mfma_f32_16x16x32_bf16 v[140:143], v[108:111], a[92:95], v[140:143]
    v_mfma_f32_16x16x32_bf16 v[144:147], v[96:99], a[116:119], v[144:147]
    v_mfma_f32_16x16x32_bf16 v[148:151], v[108:111], a[116:119], v[148:151]
    v_mfma_f32_16x16x32_bf16 v[152:155], v[96:99], a[140:143], v[152:155]
    v_mfma_f32_16x16x32_bf16 v[156:159], v[108:111], a[140:143], v[156:159]
    v_mfma_f32_16x16x32_bf16 v[160:163], v[96:99], a[164:167], v[160:163]
    v_mfma_f32_16x16x32_bf16 v[164:167], v[108:111], a[164:167], v[164:167]
    v_mfma_f32_16x16x32_bf16 v[168:171], v[96:99], a[188:191], v[168:171]
    v_mfma_f32_16x16x32_bf16 v[172:175], v[108:111], a[188:191], v[172:175]
    v_mfma_f32_16x16x32_bf16 v[176:179], v[96:99], a[212:215], v[176:179]
    v_mfma_f32_16x16x32_bf16 v[180:183], v[108:111], a[212:215], v[180:183]
    v_mfma_f32_16x16x32_bf16 v[184:187], v[96:99], a[236:239], v[184:187]
    v_mfma_f32_16x16x32_bf16 v[188:191], v[108:111], a[236:239], v[188:191]
    s_mov_b32 s46, s43
    v_cvt_pk_bf16_f32 v192, v112, v113
    v_cvt_pk_bf16_f32 v193, v114, v115
    v_cvt_pk_bf16_f32 v194, v116, v117
    v_cvt_pk_bf16_f32 v195, v118, v119
    buffer_store_dwordx4 v[192:195], v9, s[8:11], s46 offen sc1
    s_add_u32 s46, s46, 32768
    v_cvt_pk_bf16_f32 v196, v120, v121
    v_cvt_pk_bf16_f32 v197, v122, v123
    v_cvt_pk_bf16_f32 v198, v124, v125
    v_cvt_pk_bf16_f32 v199, v126, v127
    buffer_store_dwordx4 v[196:199], v9, s[8:11], s46 offen sc1
    s_add_u32 s46, s46, 32768
    v_cvt_pk_bf16_f32 v200, v128, v129
    v_cvt_pk_bf16_f32 v201, v130, v131
    v_cvt_pk_bf16_f32 v202, v132, v133
    v_cvt_pk_bf16_f32 v203, v134, v135
    buffer_store_dwordx4 v[200:203], v9, s[8:11], s46 offen sc1
    s_add_u32 s46, s46, 32768
    v_cvt_pk_bf16_f32 v204, v136, v137
    v_cvt_pk_bf16_f32 v205, v138, v139
    v_cvt_pk_bf16_f32 v206, v140, v141
    v_cvt_pk_bf16_f32 v207, v142, v143
    buffer_store_dwordx4 v[204:207], v9, s[8:11], s46 offen sc1
    s_add_u32 s46, s46, 32768
    v_cvt_pk_bf16_f32 v208, v144, v145
    v_cvt_pk_bf16_f32 v209, v146, v147
    v_cvt_pk_bf16_f32 v210, v148, v149
    v_cvt_pk_bf16_f32 v211, v150, v151
    buffer_store_dwordx4 v[208:211], v9, s[8:11], s46 offen sc1
    s_add_u32 s46, s46, 32768
    v_cvt_pk_bf16_f32 v212, v152, v153
    v_cvt_pk_bf16_f32 v213, v154, v155
    v_cvt_pk_bf16_f32 v214, v156, v157
    v_cvt_pk_bf16_f32 v215, v158, v159
    buffer_store_dwordx4 v[212:215], v9, s[8:11], s46 offen sc1
    s_add_u32 s46, s46, 32768
    v_cvt_pk_bf16_f32 v216, v160, v161
    v_cvt_pk_bf16_f32 v217, v162, v163
    v_cvt_pk_bf16_f32 v218, v164, v165
    v_cvt_pk_bf16_f32 v219, v166, v167
    buffer_store_dwordx4 v[216:219], v9, s[8:11], s46 offen sc1
    s_add_u32 s46, s46, 32768
    v_cvt_pk_bf16_f32 v220, v168, v169
    v_cvt_pk_bf16_f32 v221, v170, v171
    v_cvt_pk_bf16_f32 v222, v172, v173
    v_cvt_pk_bf16_f32 v223, v174, v175
    buffer_store_dwordx4 v[220:223], v9, s[8:11], s46 offen sc1
    s_add_u32 s46, s46, 32768
    v_cvt_pk_bf16_f32 v224, v176, v177
    v_cvt_pk_bf16_f32 v225, v178, v179
    v_cvt_pk_bf16_f32 v226, v180, v181
    v_cvt_pk_bf16_f32 v227, v182, v183
    buffer_store_dwordx4 v[224:227], v9, s[8:11], s46 offen sc1
    s_add_u32 s46, s46, 32768
    v_cvt_pk_bf16_f32 v228, v184, v185
    v_cvt_pk_bf16_f32 v229, v186, v187
    v_cvt_pk_bf16_f32 v230, v188, v189
    v_cvt_pk_bf16_f32 v231, v190, v191
    buffer_store_dwordx4 v[228:231], v9, s[8:11], s46 offen sc1
    s_waitcnt vmcnt(10)
    s_add_u32 s40, s40, 1
    s_add_u32 s43, s43, 1310720
    s_cmp_lt_u32 s40, 64
    s_cbranch_scc1 interleave_layers__linear_attn_block__memory_aug_recurrent_mem_tr__prompt_kernel_o_seg
    s_waitcnt vmcnt(0)
    s_barrier
    s_cmp_eq_u32 s3, 0
    s_cbranch_scc0 interleave_layers__linear_attn_block__memory_aug_recurrent_mem_tr__prompt_kernel_fp39
    v_mov_b32 v15, s40
    buffer_store_dword v15, v14, s[8:11], 0 offen sc1
interleave_layers__linear_attn_block__memory_aug_recurrent_mem_tr__prompt_kernel_fp39:
    s_cmp_eq_u32 s92, 0
    s_cbranch_scc0 interleave_layers__linear_attn_block__memory_aug_recurrent_mem_tr__prompt_kernel_end
    s_mov_b32 s92, 1
    s_branch interleave_layers__linear_attn_block__memory_aug_recurrent_mem_tr__prompt_kernel_o_layer
interleave_layers__linear_attn_block__memory_aug_recurrent_mem_tr__prompt_kernel_end:
    s_endpgm
.section .rodata,"a"
.p2align 6
.amdhsa_kernel interleave_layers__linear_attn_block__memory_aug_recurrent_mem_tr__prompt_kernel
  .amdhsa_next_free_vgpr 512
  .amdhsa_next_free_sgpr 100
  .amdhsa_accum_offset 256
  .amdhsa_group_segment_fixed_size 0
  .amdhsa_kernarg_size 104
  .amdhsa_user_sgpr_count 2
  .amdhsa_user_sgpr_kernarg_segment_ptr 1
  .amdhsa_system_sgpr_workgroup_id_x 1
.end_amdhsa_kernel
```

```asm
; @launch kernel=interleave_layers__linear_attn_block__memory_aug_recurrent_mem_tr__prompt_kernel grid=(256,1,1) block=(256,1,1) lds=135168
.amdgcn_target "amdgcn-amd-amdhsa--gfx950"
.text
.globl interleave_layers__linear_attn_block__memory_aug_recurrent_mem_tr__prompt_kernel
.p2align 8
.type interleave_layers__linear_attn_block__memory_aug_recurrent_mem_tr__prompt_kernel,@function
interleave_layers__linear_attn_block__memory_aug_recurrent_mem_tr__prompt_kernel:
    s_cmp_ge_u32 s2, 256
    s_cbranch_scc1 interleave_layers__linear_attn_block__memory_aug_recurrent_mem_tr__prompt_kernel_end
    s_load_dwordx2 s[4:5], s[0:1], 96
    s_load_dwordx2 s[6:7], s[0:1], 88
    s_load_dwordx2 s[24:25], s[0:1], 0
    v_and_b32 v1, 63, v0
    v_lshrrev_b32 v4, 6, v0
    v_and_b32 v2, 15, v1
    v_lshrrev_b32 v3, 4, v1
    v_readfirstlane_b32 s3, v4
    s_mov_b32 s60, 131072
    s_mov_b32 s59, -1
    s_mov_b32 s92, 0
    s_waitcnt lgkmcnt(0)
    s_mov_b32 s8, s4
    s_mov_b32 s9, s5
    s_mov_b32 s10, 268435456
    s_mov_b32 s11, 0x00020000
    s_mov_b32 s72, s6
    s_mov_b32 s73, s7
    s_mov_b32 s74, 256
    s_mov_b32 s75, 0x00020000
    s_mov_b32 s16, s24
    s_mov_b32 s17, s25
    s_mov_b32 s18, 2621440
    s_mov_b32 s19, 0x00020000
    s_cmp_eq_u32 s2, 255
    s_cbranch_scc0 interleave_layers__linear_attn_block__memory_aug_recurrent_mem_tr__prompt_kernel_cf1
    v_lshlrev_b32 v5, 4, v0
    v_mov_b32 v8, -1
    v_mov_b32 v9, -1
    v_mov_b32 v10, -1
    v_mov_b32 v11, -1
    s_mov_b32 s24, 23068672
    buffer_store_dwordx4 v[8:11], v5, s[8:11], s24 offen sc1
    s_add_u32 s24, s24, 4096
    buffer_store_dwordx4 v[8:11], v5, s[8:11], s24 offen sc1
    s_add_u32 s24, s24, 4096
    buffer_store_dwordx4 v[8:11], v5, s[8:11], s24 offen sc1
    s_add_u32 s24, s24, 4096
    buffer_store_dwordx4 v[8:11], v5, s[8:11], s24 offen sc1
    s_add_u32 s24, s24, 4096
    buffer_store_dwordx4 v[8:11], v5, s[8:11], s24 offen sc1
    s_add_u32 s24, s24, 4096
    buffer_store_dwordx4 v[8:11], v5, s[8:11], s24 offen sc1
    s_add_u32 s24, s24, 4096
    buffer_store_dwordx4 v[8:11], v5, s[8:11], s24 offen sc1
    s_add_u32 s24, s24, 4096
    buffer_store_dwordx4 v[8:11], v5, s[8:11], s24 offen sc1
    s_add_u32 s24, s24, 4096
    buffer_store_dwordx4 v[8:11], v5, s[8:11], s24 offen sc1
    s_add_u32 s24, s24, 4096
    buffer_store_dwordx4 v[8:11], v5, s[8:11], s24 offen sc1
    s_add_u32 s24, s24, 4096
    buffer_store_dwordx4 v[8:11], v5, s[8:11], s24 offen sc1
    s_add_u32 s24, s24, 4096
    buffer_store_dwordx4 v[8:11], v5, s[8:11], s24 offen sc1
    s_add_u32 s24, s24, 4096
    buffer_store_dwordx4 v[8:11], v5, s[8:11], s24 offen sc1
    s_add_u32 s24, s24, 4096
    buffer_store_dwordx4 v[8:11], v5, s[8:11], s24 offen sc1
    s_add_u32 s24, s24, 4096
    buffer_store_dwordx4 v[8:11], v5, s[8:11], s24 offen sc1
    s_add_u32 s24, s24, 4096
    buffer_store_dwordx4 v[8:11], v5, s[8:11], s24 offen sc1
    s_add_u32 s24, s24, 4096
interleave_layers__linear_attn_block__memory_aug_recurrent_mem_tr__prompt_kernel_cf1:
    s_mov_b32 s46, 64
    s_mov_b32 s47, 32
    s_mov_b32 s50, 0
    s_and_b32 s44, s2, 7
    s_lshr_b32 s45, s2, 3
    s_lshl_b32 s48, s45, 1
    s_mov_b32 s49, 1
    s_mov_b32 s40, 2
interleave_layers__linear_attn_block__memory_aug_recurrent_mem_tr__prompt_kernel_k1_entry:
    s_load_dwordx2 s[6:7], s[0:1], 8
    s_lshr_b32 s24, s3, 1
    s_mul_i32 s24, s24, 20480
    s_and_b32 s25, s3, 1
    s_mul_i32 s25, s25, 10
    s_mul_i32 s25, s25, s46
    s_add_u32 s24, s24, s25
    s_cmp_eq_u32 s50, 1
    s_cselect_b32 s25, 16, 1280
    s_cselect_b32 s26, 256, 8
    v_mul_u32_u24 v4, s25, v2
    v_mul_u32_u24 v5, s26, v3
    v_add3_u32 v4, v4, v5, s24
    v_add_u32 v5, s47, v4
    s_mul_i32 s43, s48, 40960
    s_mul_i32 s42, s49, 40960
    s_mov_b32 s51, 0
    s_cmp_eq_u32 s92, 0
    s_cbranch_scc0 interleave_layers__linear_attn_block__memory_aug_recurrent_mem_tr__prompt_kernel_k12
    s_mov_b32 s41, s43
    s_mov_b32 s24, s41
    buffer_load_dwordx2 v[16:17], v4, s[16:19], s24 offen sc1
    buffer_load_dwordx2 v[18:19], v5, s[16:19], s24 offen sc1
    s_add_u32 s24, s24, s46
    buffer_load_dwordx2 v[20:21], v4, s[16:19], s24 offen sc1
    buffer_load_dwordx2 v[22:23], v5, s[16:19], s24 offen sc1
    s_add_u32 s24, s24, s46
    buffer_load_dwordx2 v[24:25], v4, s[16:19], s24 offen sc1
    buffer_load_dwordx2 v[26:27], v5, s[16:19], s24 offen sc1
    s_add_u32 s24, s24, s46
    buffer_load_dwordx2 v[28:29], v4, s[16:19], s24 offen sc1
    buffer_load_dwordx2 v[30:31], v5, s[16:19], s24 offen sc1
    s_add_u32 s24, s24, s46
    buffer_load_dwordx2 v[32:33], v4, s[16:19], s24 offen sc1
    buffer_load_dwordx2 v[34:35], v5, s[16:19], s24 offen sc1
    s_add_u32 s24, s24, s46
    buffer_load_dwordx2 v[36:37], v4, s[16:19], s24 offen sc1
    buffer_load_dwordx2 v[38:39], v5, s[16:19], s24 offen sc1
    s_add_u32 s24, s24, s46
    buffer_load_dwordx2 v[40:41], v4, s[16:19], s24 offen sc1
    buffer_load_dwordx2 v[42:43], v5, s[16:19], s24 offen sc1
    s_add_u32 s24, s24, s46
    buffer_load_dwordx2 v[44:45], v4, s[16:19], s24 offen sc1
    buffer_load_dwordx2 v[46:47], v5, s[16:19], s24 offen sc1
    s_add_u32 s24, s24, s46
    buffer_load_dwordx2 v[48:49], v4, s[16:19], s24 offen sc1
    buffer_load_dwordx2 v[50:51], v5, s[16:19], s24 offen sc1
    s_add_u32 s24, s24, s46
    buffer_load_dwordx2 v[52:53], v4, s[16:19], s24 offen sc1
    buffer_load_dwordx2 v[54:55], v5, s[16:19], s24 offen sc1
    s_mov_b32 s51, 1
interleave_layers__linear_attn_block__memory_aug_recurrent_mem_tr__prompt_kernel_k12:
    v_and_b32 v7, 31, v0
    v_lshrrev_b32 v8, 5, v0
    v_mul_u32_u24 v152, 3840, v8
    v_lshlrev_b32 v9, 4, v7
    v_add_u32 v152, v152, v9
    v_cmp_le_u32 vcc, 10, v7
    s_nop 1
    v_cndmask_b32 v10, 0, 1, vcc
    v_cmp_le_u32 vcc, 20, v7
    s_nop 1
    v_cndmask_b32 v11, 0, 1, vcc
    v_add_u32 v10, v10, v11
    v_mul_u32_u24 v10, 1120, v10
    v_add_u32 v152, v152, v10
    v_mov_b32 v10, 2146435072
    v_cmp_le_u32 vcc, 30, v7
    s_nop 1
    v_cndmask_b32 v152, v152, v10, vcc
    v_mul_u32_u24 v153, 544, v8
    v_add_u32 v153, v153, v9
    v_add_u32 v153, 40960, v153
    s_waitcnt lgkmcnt(0)
    s_mov_b32 s12, s6
    s_mov_b32 s13, s7
    s_mov_b32 s14, 2457600
    s_mov_b32 s15, 0x00020000
    s_mul_i32 s52, s44, 160
    s_add_u32 s24, s52, 0
    buffer_load_dwordx4 v[56:59], v152, s[12:15], s24 offen
    s_add_u32 s24, s24, 30720
    buffer_load_dwordx4 v[60:63], v152, s[12:15], s24 offen
    s_add_u32 s24, s24, 30720
    buffer_load_dwordx4 v[64:67], v152, s[12:15], s24 offen
    s_add_u32 s24, s24, 30720
    buffer_load_dwordx4 v[68:71], v152, s[12:15], s24 offen
    s_add_u32 s24, s24, 30720
    buffer_load_dwordx4 v[72:75], v152, s[12:15], s24 offen
    s_add_u32 s24, s24, 30720
    buffer_load_dwordx4 v[76:79], v152, s[12:15], s24 offen
    s_add_u32 s24, s24, 30720
    buffer_load_dwordx4 v[80:83], v152, s[12:15], s24 offen
    s_add_u32 s24, s24, 30720
    buffer_load_dwordx4 v[84:87], v152, s[12:15], s24 offen
    s_add_u32 s24, s52, 245760
    buffer_load_dwordx4 v[88:91], v152, s[12:15], s24 offen
    s_add_u32 s24, s24, 30720
    buffer_load_dwordx4 v[92:95], v152, s[12:15], s24 offen
    s_add_u32 s24, s24, 30720
    buffer_load_dwordx4 v[96:99], v152, s[12:15], s24 offen
    s_add_u32 s24, s24, 30720
    buffer_load_dwordx4 v[100:103], v152, s[12:15], s24 offen
    s_add_u32 s24, s24, 30720
    buffer_load_dwordx4 v[104:107], v152, s[12:15], s24 offen
    s_add_u32 s24, s24, 30720
    buffer_load_dwordx4 v[108:111], v152, s[12:15], s24 offen
    s_add_u32 s24, s24, 30720
    buffer_load_dwordx4 v[112:115], v152, s[12:15], s24 offen
    s_add_u32 s24, s24, 30720
    buffer_load_dwordx4 v[116:119], v152, s[12:15], s24 offen
    s_add_u32 s24, s52, 491520
    buffer_load_dwordx4 v[120:123], v152, s[12:15], s24 offen
    s_add_u32 s24, s24, 30720
    buffer_load_dwordx4 v[124:127], v152, s[12:15], s24 offen
    s_add_u32 s24, s24, 30720
    buffer_load_dwordx4 v[128:131], v152, s[12:15], s24 offen
    s_add_u32 s24, s24, 30720
    buffer_load_dwordx4 v[132:135], v152, s[12:15], s24 offen
    s_add_u32 s24, s24, 30720
    buffer_load_dwordx4 v[136:139], v152, s[12:15], s24 offen
    s_add_u32 s24, s24, 30720
    buffer_load_dwordx4 v[140:143], v152, s[12:15], s24 offen
    s_add_u32 s24, s24, 30720
    buffer_load_dwordx4 v[144:147], v152, s[12:15], s24 offen
    s_add_u32 s24, s24, 30720
    buffer_load_dwordx4 v[148:151], v152, s[12:15], s24 offen
    v_lshrrev_b32 v6, 2, v2
    v_lshl_add_u32 v6, v3, 2, v6
    v_mul_u32_u24 v6, 544, v6
    v_and_b32 v7, 3, v2
    v_lshl_add_u32 v6, v7, 3, v6
    v_add_u32 v6, 40960, v6
    s_mov_b32 s24, 0
    s_cmp_eq_u32 s3, 1
    s_cselect_b32 s24, 64, s24
    s_cmp_eq_u32 s3, 2
    s_cselect_b32 s24, 128, s24
    s_cmp_eq_u32 s3, 3
    s_cselect_b32 s24, 224, s24
    v_add_u32 v12, s24, v6
    s_mov_b32 s24, 32
    s_cmp_eq_u32 s3, 1
    s_cselect_b32 s24, 96, s24
    s_cmp_eq_u32 s3, 2
    s_cselect_b32 s24, 160, s24
    s_cmp_eq_u32 s3, 3
    s_cselect_b32 s24, 256, s24
    v_add_u32 v13, s24, v6
    s_mov_b32 s24, 320
    s_cmp_eq_u32 s3, 1
    s_cselect_b32 s24, 384, s24
    s_cmp_eq_u32 s3, 2
    s_cselect_b32 s24, 192, s24
    s_cmp_eq_u32 s3, 3
    s_cselect_b32 s24, 288, s24
    v_add_u32 v14, s24, v6
    s_mov_b32 s24, 352
    s_cmp_eq_u32 s3, 1
    s_cselect_b32 s24, 416, s24
    s_cmp_eq_u32 s3, 2
    s_cselect_b32 s24, 448, s24
    s_cmp_eq_u32 s3, 3
    s_cselect_b32 s24, 288, s24
    v_add_u32 v15, s24, v6
    v_mov_b32 v172, 0x3f803f80
    v_mov_b32 v173, 0x3f803f80
    v_mov_b32 v174, 0x3f803f80
    v_mov_b32 v175, 0x3f803f80
    s_waitcnt vmcnt(16)
    ds_write_b128 v153, v[56:59] offset:0
    ds_write_b128 v153, v[60:63] offset:4352
    ds_write_b128 v153, v[64:67] offset:8704
    ds_write_b128 v153, v[68:71] offset:13056
    ds_write_b128 v153, v[72:75] offset:17408
    ds_write_b128 v153, v[76:79] offset:21760
    ds_write_b128 v153, v[80:83] offset:26112
    ds_write_b128 v153, v[84:87] offset:30464
    s_waitcnt lgkmcnt(0)
    s_add_u32 s24, s52, 737280
    buffer_load_dwordx4 v[56:59], v152, s[12:15], s24 offen
    s_add_u32 s24, s24, 30720
    buffer_load_dwordx4 v[60:63], v152, s[12:15], s24 offen
    s_add_u32 s24, s24, 30720
    buffer_load_dwordx4 v[64:67], v152, s[12:15], s24 offen
    s_add_u32 s24, s24, 30720
    buffer_load_dwordx4 v[68:71], v152, s[12:15], s24 offen
    s_add_u32 s24, s24, 30720
    buffer_load_dwordx4 v[72:75], v152, s[12:15], s24 offen
    s_add_u32 s24, s24, 30720
    buffer_load_dwordx4 v[76:79], v152, s[12:15], s24 offen
    s_add_u32 s24, s24, 30720
    buffer_load_dwordx4 v[80:83], v152, s[12:15], s24 offen
    s_add_u32 s24, s24, 30720
    buffer_load_dwordx4 v[84:87], v152, s[12:15], s24 offen
    s_barrier
    s_cmp_eq_u32 s2, 255
    s_cbranch_scc0 interleave_layers__linear_attn_block__memory_aug_recurrent_mem_tr__prompt_kernel_fb3
    s_cmp_eq_u32 s92, 0
    s_cbranch_scc0 interleave_layers__linear_attn_block__memory_aug_recurrent_mem_tr__prompt_kernel_fb3
    s_cmp_eq_u32 s3, 0
    s_cbranch_scc0 interleave_layers__linear_attn_block__memory_aug_recurrent_mem_tr__prompt_kernel_fb3
    v_mov_b32 v154, 2146435072
    v_cmp_eq_u32 vcc, 0, v1
    s_nop 1
    v_cndmask_b32 v154, v154, 0, vcc
    v_mov_b32 v155, 1
    buffer_store_dword v155, v154, s[72:75], 0 offen sc1
interleave_layers__linear_attn_block__memory_aug_recurrent_mem_tr__prompt_kernel_fb3:
    ds_read_b64_tr_b16 a[0:1], v12 offset:0
    ds_read_b64_tr_b16 a[2:3], v12 offset:8704
    ds_read_b64_tr_b16 a[4:5], v12 offset:17408
    ds_read_b64_tr_b16 a[6:7], v12 offset:26112
    ds_read_b64_tr_b16 a[80:81], v13 offset:0
    ds_read_b64_tr_b16 a[82:83], v13 offset:8704
    ds_read_b64_tr_b16 a[84:85], v13 offset:17408
    ds_read_b64_tr_b16 a[86:87], v13 offset:26112
    ds_read_b64_tr_b16 a[160:161], v14 offset:0
    ds_read_b64_tr_b16 a[162:163], v14 offset:8704
    ds_read_b64_tr_b16 a[164:165], v14 offset:17408
    ds_read_b64_tr_b16 a[166:167], v14 offset:26112
    ds_read_b64_tr_b16 v[176:177], v15 offset:0
    ds_read_b64_tr_b16 v[178:179], v15 offset:8704
    ds_read_b64_tr_b16 v[180:181], v15 offset:17408
    ds_read_b64_tr_b16 v[182:183], v15 offset:26112
    s_waitcnt vmcnt(16)
    ds_write_b128 v153, v[88:91] offset:34816
    ds_write_b128 v153, v[92:95] offset:39168
    ds_write_b128 v153, v[96:99] offset:43520
    ds_write_b128 v153, v[100:103] offset:47872
    ds_write_b128 v153, v[104:107] offset:52224
    ds_write_b128 v153, v[108:111] offset:56576
    ds_write_b128 v153, v[112:115] offset:60928
    ds_write_b128 v153, v[116:119] offset:65280
    s_waitcnt lgkmcnt(0)
    s_add_u32 s24, s52, 983040
    buffer_load_dwordx4 v[88:91], v152, s[12:15], s24 offen
    s_add_u32 s24, s24, 30720
    buffer_load_dwordx4 v[92:95], v152, s[12:15], s24 offen
    s_add_u32 s24, s24, 30720
    buffer_load_dwordx4 v[96:99], v152, s[12:15], s24 offen
    s_add_u32 s24, s24, 30720
    buffer_load_dwordx4 v[100:103], v152, s[12:15], s24 offen
    s_add_u32 s24, s24, 30720
    buffer_load_dwordx4 v[104:107], v152, s[12:15], s24 offen
    s_add_u32 s24, s24, 30720
    buffer_load_dwordx4 v[108:111], v152, s[12:15], s24 offen
    s_add_u32 s24, s24, 30720
    buffer_load_dwordx4 v[112:115], v152, s[12:15], s24 offen
    s_add_u32 s24, s24, 30720
    buffer_load_dwordx4 v[116:119], v152, s[12:15], s24 offen
    v_mfma_f32_16x16x32_bf16 v[156:159], a[0:3], v[172:175], 0
    v_mfma_f32_16x16x32_bf16 v[160:163], a[80:83], v[172:175], 0
    v_mfma_f32_16x16x32_bf16 v[164:167], a[160:163], v[172:175], 0
    v_mfma_f32_16x16x32_bf16 v[168:171], v[176:179], v[172:175], 0
    v_mfma_f32_16x16x32_bf16 v[156:159], a[4:7], v[172:175], v[156:159]
    v_mfma_f32_16x16x32_bf16 v[160:163], a[84:87], v[172:175], v[160:163]
    v_mfma_f32_16x16x32_bf16 v[164:167], a[164:167], v[172:175], v[164:167]
    v_mfma_f32_16x16x32_bf16 v[168:171], v[180:183], v[172:175], v[168:171]
    s_barrier
    ds_read_b64_tr_b16 a[8:9], v12 offset:34816
    ds_read_b64_tr_b16 a[10:11], v12 offset:43520
    ds_read_b64_tr_b16 a[12:13], v12 offset:52224
    ds_read_b64_tr_b16 a[14:15], v12 offset:60928
    ds_read_b64_tr_b16 a[88:89], v13 offset:34816
    ds_read_b64_tr_b16 a[90:91], v13 offset:43520
    ds_read_b64_tr_b16 a[92:93], v13 offset:52224
    ds_read_b64_tr_b16 a[94:95], v13 offset:60928
    ds_read_b64_tr_b16 a[168:169], v14 offset:34816
    ds_read_b64_tr_b16 a[170:171], v14 offset:43520
    ds_read_b64_tr_b16 a[172:173], v14 offset:52224
    ds_read_b64_tr_b16 a[174:175], v14 offset:60928
    ds_read_b64_tr_b16 v[184:185], v15 offset:34816
    ds_read_b64_tr_b16 v[186:187], v15 offset:43520
    ds_read_b64_tr_b16 v[188:189], v15 offset:52224
    ds_read_b64_tr_b16 v[190:191], v15 offset:60928
    s_waitcnt vmcnt(16)
    ds_write_b128 v153, v[120:123] offset:0
    ds_write_b128 v153, v[124:127] offset:4352
    ds_write_b128 v153, v[128:131] offset:8704
    ds_write_b128 v153, v[132:135] offset:13056
    ds_write_b128 v153, v[136:139] offset:17408
    ds_write_b128 v153, v[140:143] offset:21760
    ds_write_b128 v153, v[144:147] offset:26112
    ds_write_b128 v153, v[148:151] offset:30464
    s_waitcnt lgkmcnt(0)
    s_add_u32 s24, s52, 1228800
    buffer_load_dwordx4 v[120:123], v152, s[12:15], s24 offen
    s_add_u32 s24, s24, 30720
    buffer_load_dwordx4 v[124:127], v152, s[12:15], s24 offen
    s_add_u32 s24, s24, 30720
    buffer_load_dwordx4 v[128:131], v152, s[12:15], s24 offen
    s_add_u32 s24, s24, 30720
    buffer_load_dwordx4 v[132:135], v152, s[12:15], s24 offen
    s_add_u32 s24, s24, 30720
    buffer_load_dwordx4 v[136:139], v152, s[12:15], s24 offen
    s_add_u32 s24, s24, 30720
    buffer_load_dwordx4 v[140:143], v152, s[12:15], s24 offen
    s_add_u32 s24, s24, 30720
    buffer_load_dwordx4 v[144:147], v152, s[12:15], s24 offen
    s_add_u32 s24, s24, 30720
    buffer_load_dwordx4 v[148:151], v152, s[12:15], s24 offen
    v_mfma_f32_16x16x32_bf16 v[156:159], a[8:11], v[172:175], v[156:159]
    v_mfma_f32_16x16x32_bf16 v[160:163], a[88:91], v[172:175], v[160:163]
    v_mfma_f32_16x16x32_bf16 v[164:167], a[168:171], v[172:175], v[164:167]
    v_mfma_f32_16x16x32_bf16 v[168:171], v[184:187], v[172:175], v[168:171]
    v_mfma_f32_16x16x32_bf16 v[156:159], a[12:15], v[172:175], v[156:159]
    v_mfma_f32_16x16x32_bf16 v[160:163], a[92:95], v[172:175], v[160:163]
    v_mfma_f32_16x16x32_bf16 v[164:167], a[172:175], v[172:175], v[164:167]
    v_mfma_f32_16x16x32_bf16 v[168:171], v[188:191], v[172:175], v[168:171]
    s_barrier
    ds_read_b64_tr_b16 a[16:17], v12 offset:0
    ds_read_b64_tr_b16 a[18:19], v12 offset:8704
    ds_read_b64_tr_b16 a[20:21], v12 offset:17408
    ds_read_b64_tr_b16 a[22:23], v12 offset:26112
    ds_read_b64_tr_b16 a[96:97], v13 offset:0
    ds_read_b64_tr_b16 a[98:99], v13 offset:8704
    ds_read_b64_tr_b16 a[100:101], v13 offset:17408
    ds_read_b64_tr_b16 a[102:103], v13 offset:26112
    ds_read_b64_tr_b16 a[176:177], v14 offset:0
    ds_read_b64_tr_b16 a[178:179], v14 offset:8704
    ds_read_b64_tr_b16 a[180:181], v14 offset:17408
    ds_read_b64_tr_b16 a[182:183], v14 offset:26112
    ds_read_b64_tr_b16 v[192:193], v15 offset:0
    ds_read_b64_tr_b16 v[194:195], v15 offset:8704
    ds_read_b64_tr_b16 v[196:197], v15 offset:17408
    ds_read_b64_tr_b16 v[198:199], v15 offset:26112
    s_waitcnt vmcnt(16)
    ds_write_b128 v153, v[56:59] offset:34816
    ds_write_b128 v153, v[60:63] offset:39168
    ds_write_b128 v153, v[64:67] offset:43520
    ds_write_b128 v153, v[68:71] offset:47872
    ds_write_b128 v153, v[72:75] offset:52224
    ds_write_b128 v153, v[76:79] offset:56576
    ds_write_b128 v153, v[80:83] offset:60928
    ds_write_b128 v153, v[84:87] offset:65280
    s_waitcnt lgkmcnt(0)
    s_add_u32 s24, s52, 1474560
    buffer_load_dwordx4 v[56:59], v152, s[12:15], s24 offen
    s_add_u32 s24, s24, 30720
    buffer_load_dwordx4 v[60:63], v152, s[12:15], s24 offen
    s_add_u32 s24, s24, 30720
    buffer_load_dwordx4 v[64:67], v152, s[12:15], s24 offen
    s_add_u32 s24, s24, 30720
    buffer_load_dwordx4 v[68:71], v152, s[12:15], s24 offen
    s_add_u32 s24, s24, 30720
    buffer_load_dwordx4 v[72:75], v152, s[12:15], s24 offen
    s_add_u32 s24, s24, 30720
    buffer_load_dwordx4 v[76:79], v152, s[12:15], s24 offen
    s_add_u32 s24, s24, 30720
    buffer_load_dwordx4 v[80:83], v152, s[12:15], s24 offen
    s_add_u32 s24, s24, 30720
    buffer_load_dwordx4 v[84:87], v152, s[12:15], s24 offen
    v_mfma_f32_16x16x32_bf16 v[156:159], a[16:19], v[172:175], v[156:159]
    v_mfma_f32_16x16x32_bf16 v[160:163], a[96:99], v[172:175], v[160:163]
    v_mfma_f32_16x16x32_bf16 v[164:167], a[176:179], v[172:175], v[164:167]
    v_mfma_f32_16x16x32_bf16 v[168:171], v[192:195], v[172:175], v[168:171]
    v_mfma_f32_16x16x32_bf16 v[156:159], a[20:23], v[172:175], v[156:159]
    v_mfma_f32_16x16x32_bf16 v[160:163], a[100:103], v[172:175], v[160:163]
    v_mfma_f32_16x16x32_bf16 v[164:167], a[180:183], v[172:175], v[164:167]
    v_mfma_f32_16x16x32_bf16 v[168:171], v[196:199], v[172:175], v[168:171]
    s_barrier
    ds_read_b64_tr_b16 a[24:25], v12 offset:34816
    ds_read_b64_tr_b16 a[26:27], v12 offset:43520
    ds_read_b64_tr_b16 a[28:29], v12 offset:52224
    ds_read_b64_tr_b16 a[30:31], v12 offset:60928
    ds_read_b64_tr_b16 a[104:105], v13 offset:34816
    ds_read_b64_tr_b16 a[106:107], v13 offset:43520
    ds_read_b64_tr_b16 a[108:109], v13 offset:52224
    ds_read_b64_tr_b16 a[110:111], v13 offset:60928
    ds_read_b64_tr_b16 a[184:185], v14 offset:34816
    ds_read_b64_tr_b16 a[186:187], v14 offset:43520
    ds_read_b64_tr_b16 a[188:189], v14 offset:52224
    ds_read_b64_tr_b16 a[190:191], v14 offset:60928
    ds_read_b64_tr_b16 v[200:201], v15 offset:34816
    ds_read_b64_tr_b16 v[202:203], v15 offset:43520
    ds_read_b64_tr_b16 v[204:205], v15 offset:52224
    ds_read_b64_tr_b16 v[206:207], v15 offset:60928
    s_waitcnt vmcnt(16)
    ds_write_b128 v153, v[88:91] offset:0
    ds_write_b128 v153, v[92:95] offset:4352
    ds_write_b128 v153, v[96:99] offset:8704
    ds_write_b128 v153, v[100:103] offset:13056
    ds_write_b128 v153, v[104:107] offset:17408
    ds_write_b128 v153, v[108:111] offset:21760
    ds_write_b128 v153, v[112:115] offset:26112
    ds_write_b128 v153, v[116:119] offset:30464
    s_waitcnt lgkmcnt(0)
    s_add_u32 s24, s52, 1720320
    buffer_load_dwordx4 v[88:91], v152, s[12:15], s24 offen
    s_add_u32 s24, s24, 30720
    buffer_load_dwordx4 v[92:95], v152, s[12:15], s24 offen
    s_add_u32 s24, s24, 30720
    buffer_load_dwordx4 v[96:99], v152, s[12:15], s24 offen
    s_add_u32 s24, s24, 30720
    buffer_load_dwordx4 v[100:103], v152, s[12:15], s24 offen
    s_add_u32 s24, s24, 30720
    buffer_load_dwordx4 v[104:107], v152, s[12:15], s24 offen
    s_add_u32 s24, s24, 30720
    buffer_load_dwordx4 v[108:111], v152, s[12:15], s24 offen
    s_add_u32 s24, s24, 30720
    buffer_load_dwordx4 v[112:115], v152, s[12:15], s24 offen
    s_add_u32 s24, s24, 30720
    buffer_load_dwordx4 v[116:119], v152, s[12:15], s24 offen
    v_mfma_f32_16x16x32_bf16 v[156:159], a[24:27], v[172:175], v[156:159]
    v_mfma_f32_16x16x32_bf16 v[160:163], a[104:107], v[172:175], v[160:163]
    v_mfma_f32_16x16x32_bf16 v[164:167], a[184:187], v[172:175], v[164:167]
    v_mfma_f32_16x16x32_bf16 v[168:171], v[200:203], v[172:175], v[168:171]
    v_mfma_f32_16x16x32_bf16 v[156:159], a[28:31], v[172:175], v[156:159]
    v_mfma_f32_16x16x32_bf16 v[160:163], a[108:111], v[172:175], v[160:163]
    v_mfma_f32_16x16x32_bf16 v[164:167], a[188:191], v[172:175], v[164:167]
    v_mfma_f32_16x16x32_bf16 v[168:171], v[204:207], v[172:175], v[168:171]
    s_barrier
    ds_read_b64_tr_b16 a[32:33], v12 offset:0
    ds_read_b64_tr_b16 a[34:35], v12 offset:8704
    ds_read_b64_tr_b16 a[36:37], v12 offset:17408
    ds_read_b64_tr_b16 a[38:39], v12 offset:26112
    ds_read_b64_tr_b16 a[112:113], v13 offset:0
    ds_read_b64_tr_b16 a[114:115], v13 offset:8704
    ds_read_b64_tr_b16 a[116:117], v13 offset:17408
    ds_read_b64_tr_b16 a[118:119], v13 offset:26112
    ds_read_b64_tr_b16 a[192:193], v14 offset:0
    ds_read_b64_tr_b16 a[194:195], v14 offset:8704
    ds_read_b64_tr_b16 a[196:197], v14 offset:17408
    ds_read_b64_tr_b16 a[198:199], v14 offset:26112
    ds_read_b64_tr_b16 v[208:209], v15 offset:0
    ds_read_b64_tr_b16 v[210:211], v15 offset:8704
    ds_read_b64_tr_b16 v[212:213], v15 offset:17408
    ds_read_b64_tr_b16 v[214:215], v15 offset:26112
    s_waitcnt vmcnt(16)
    ds_write_b128 v153, v[120:123] offset:34816
    ds_write_b128 v153, v[124:127] offset:39168
    ds_write_b128 v153, v[128:131] offset:43520
    ds_write_b128 v153, v[132:135] offset:47872
    ds_write_b128 v153, v[136:139] offset:52224
    ds_write_b128 v153, v[140:143] offset:56576
    ds_write_b128 v153, v[144:147] offset:60928
    ds_write_b128 v153, v[148:151] offset:65280
    s_waitcnt lgkmcnt(0)
    s_add_u32 s24, s52, 1966080
    buffer_load_dwordx4 v[120:123], v152, s[12:15], s24 offen
    s_add_u32 s24, s24, 30720
    buffer_load_dwordx4 v[124:127], v152, s[12:15], s24 offen
    s_add_u32 s24, s24, 30720
    buffer_load_dwordx4 v[128:131], v152, s[12:15], s24 offen
    s_add_u32 s24, s24, 30720
    buffer_load_dwordx4 v[132:135], v152, s[12:15], s24 offen
    s_add_u32 s24, s24, 30720
    buffer_load_dwordx4 v[136:139], v152, s[12:15], s24 offen
    s_add_u32 s24, s24, 30720
    buffer_load_dwordx4 v[140:143], v152, s[12:15], s24 offen
    s_add_u32 s24, s24, 30720
    buffer_load_dwordx4 v[144:147], v152, s[12:15], s24 offen
    s_add_u32 s24, s24, 30720
    buffer_load_dwordx4 v[148:151], v152, s[12:15], s24 offen
    v_mfma_f32_16x16x32_bf16 v[156:159], a[32:35], v[172:175], v[156:159]
    v_mfma_f32_16x16x32_bf16 v[160:163], a[112:115], v[172:175], v[160:163]
    v_mfma_f32_16x16x32_bf16 v[164:167], a[192:195], v[172:175], v[164:167]
    v_mfma_f32_16x16x32_bf16 v[168:171], v[208:211], v[172:175], v[168:171]
    v_mfma_f32_16x16x32_bf16 v[156:159], a[36:39], v[172:175], v[156:159]
    v_mfma_f32_16x16x32_bf16 v[160:163], a[116:119], v[172:175], v[160:163]
    v_mfma_f32_16x16x32_bf16 v[164:167], a[196:199], v[172:175], v[164:167]
    v_mfma_f32_16x16x32_bf16 v[168:171], v[212:215], v[172:175], v[168:171]
    s_barrier
    ds_read_b64_tr_b16 a[40:41], v12 offset:34816
    ds_read_b64_tr_b16 a[42:43], v12 offset:43520
    ds_read_b64_tr_b16 a[44:45], v12 offset:52224
    ds_read_b64_tr_b16 a[46:47], v12 offset:60928
    ds_read_b64_tr_b16 a[120:121], v13 offset:34816
    ds_read_b64_tr_b16 a[122:123], v13 offset:43520
    ds_read_b64_tr_b16 a[124:125], v13 offset:52224
    ds_read_b64_tr_b16 a[126:127], v13 offset:60928
    ds_read_b64_tr_b16 a[200:201], v14 offset:34816
    ds_read_b64_tr_b16 a[202:203], v14 offset:43520
    ds_read_b64_tr_b16 a[204:205], v14 offset:52224
    ds_read_b64_tr_b16 a[206:207], v14 offset:60928
    ds_read_b64_tr_b16 v[216:217], v15 offset:34816
    ds_read_b64_tr_b16 v[218:219], v15 offset:43520
    ds_read_b64_tr_b16 v[220:221], v15 offset:52224
    ds_read_b64_tr_b16 v[222:223], v15 offset:60928
    s_waitcnt vmcnt(16)
    ds_write_b128 v153, v[56:59] offset:0
    ds_write_b128 v153, v[60:63] offset:4352
    ds_write_b128 v153, v[64:67] offset:8704
    ds_write_b128 v153, v[68:71] offset:13056
    ds_write_b128 v153, v[72:75] offset:17408
    ds_write_b128 v153, v[76:79] offset:21760
    ds_write_b128 v153, v[80:83] offset:26112
    ds_write_b128 v153, v[84:87] offset:30464
    s_waitcnt lgkmcnt(0)
    s_add_u32 s24, s52, 2211840
    buffer_load_dwordx4 v[56:59], v152, s[12:15], s24 offen
    s_add_u32 s24, s24, 30720
    buffer_load_dwordx4 v[60:63], v152, s[12:15], s24 offen
    s_add_u32 s24, s24, 30720
    buffer_load_dwordx4 v[64:67], v152, s[12:15], s24 offen
    s_add_u32 s24, s24, 30720
    buffer_load_dwordx4 v[68:71], v152, s[12:15], s24 offen
    s_add_u32 s24, s24, 30720
    buffer_load_dwordx4 v[72:75], v152, s[12:15], s24 offen
    s_add_u32 s24, s24, 30720
    buffer_load_dwordx4 v[76:79], v152, s[12:15], s24 offen
    s_add_u32 s24, s24, 30720
    buffer_load_dwordx4 v[80:83], v152, s[12:15], s24 offen
    s_add_u32 s24, s24, 30720
    buffer_load_dwordx4 v[84:87], v152, s[12:15], s24 offen
    v_mfma_f32_16x16x32_bf16 v[156:159], a[40:43], v[172:175], v[156:159]
    v_mfma_f32_16x16x32_bf16 v[160:163], a[120:123], v[172:175], v[160:163]
    v_mfma_f32_16x16x32_bf16 v[164:167], a[200:203], v[172:175], v[164:167]
    v_mfma_f32_16x16x32_bf16 v[168:171], v[216:219], v[172:175], v[168:171]
    v_mfma_f32_16x16x32_bf16 v[156:159], a[44:47], v[172:175], v[156:159]
    v_mfma_f32_16x16x32_bf16 v[160:163], a[124:127], v[172:175], v[160:163]
    v_mfma_f32_16x16x32_bf16 v[164:167], a[204:207], v[172:175], v[164:167]
    v_mfma_f32_16x16x32_bf16 v[168:171], v[220:223], v[172:175], v[168:171]
    s_barrier
    ds_read_b64_tr_b16 a[48:49], v12 offset:0
    ds_read_b64_tr_b16 a[50:51], v12 offset:8704
    ds_read_b64_tr_b16 a[52:53], v12 offset:17408
    ds_read_b64_tr_b16 a[54:55], v12 offset:26112
    ds_read_b64_tr_b16 a[128:129], v13 offset:0
    ds_read_b64_tr_b16 a[130:131], v13 offset:8704
    ds_read_b64_tr_b16 a[132:133], v13 offset:17408
    ds_read_b64_tr_b16 a[134:135], v13 offset:26112
    ds_read_b64_tr_b16 a[208:209], v14 offset:0
    ds_read_b64_tr_b16 a[210:211], v14 offset:8704
    ds_read_b64_tr_b16 a[212:213], v14 offset:17408
    ds_read_b64_tr_b16 a[214:215], v14 offset:26112
    ds_read_b64_tr_b16 v[224:225], v15 offset:0
    ds_read_b64_tr_b16 v[226:227], v15 offset:8704
    ds_read_b64_tr_b16 v[228:229], v15 offset:17408
    ds_read_b64_tr_b16 v[230:231], v15 offset:26112
    s_waitcnt vmcnt(16)
    ds_write_b128 v153, v[88:91] offset:34816
    ds_write_b128 v153, v[92:95] offset:39168
    ds_write_b128 v153, v[96:99] offset:43520
    ds_write_b128 v153, v[100:103] offset:47872
    ds_write_b128 v153, v[104:107] offset:52224
    ds_write_b128 v153, v[108:111] offset:56576
    ds_write_b128 v153, v[112:115] offset:60928
    ds_write_b128 v153, v[116:119] offset:65280
    s_waitcnt lgkmcnt(0)
    v_mfma_f32_16x16x32_bf16 v[156:159], a[48:51], v[172:175], v[156:159]
    v_mfma_f32_16x16x32_bf16 v[160:163], a[128:131], v[172:175], v[160:163]
    v_mfma_f32_16x16x32_bf16 v[164:167], a[208:211], v[172:175], v[164:167]
    v_mfma_f32_16x16x32_bf16 v[168:171], v[224:227], v[172:175], v[168:171]
    v_mfma_f32_16x16x32_bf16 v[156:159], a[52:55], v[172:175], v[156:159]
    v_mfma_f32_16x16x32_bf16 v[160:163], a[132:135], v[172:175], v[160:163]
    v_mfma_f32_16x16x32_bf16 v[164:167], a[212:215], v[172:175], v[164:167]
    v_mfma_f32_16x16x32_bf16 v[168:171], v[228:231], v[172:175], v[168:171]
    s_barrier
    ds_read_b64_tr_b16 a[56:57], v12 offset:34816
    ds_read_b64_tr_b16 a[58:59], v12 offset:43520
    ds_read_b64_tr_b16 a[60:61], v12 offset:52224
    ds_read_b64_tr_b16 a[62:63], v12 offset:60928
    ds_read_b64_tr_b16 a[136:137], v13 offset:34816
    ds_read_b64_tr_b16 a[138:139], v13 offset:43520
    ds_read_b64_tr_b16 a[140:141], v13 offset:52224
    ds_read_b64_tr_b16 a[142:143], v13 offset:60928
    ds_read_b64_tr_b16 a[216:217], v14 offset:34816
    ds_read_b64_tr_b16 a[218:219], v14 offset:43520
    ds_read_b64_tr_b16 a[220:221], v14 offset:52224
    ds_read_b64_tr_b16 a[222:223], v14 offset:60928
    ds_read_b64_tr_b16 v[232:233], v15 offset:34816
    ds_read_b64_tr_b16 v[234:235], v15 offset:43520
    ds_read_b64_tr_b16 v[236:237], v15 offset:52224
    ds_read_b64_tr_b16 v[238:239], v15 offset:60928
    s_waitcnt vmcnt(8)
    ds_write_b128 v153, v[120:123] offset:0
    ds_write_b128 v153, v[124:127] offset:4352
    ds_write_b128 v153, v[128:131] offset:8704
    ds_write_b128 v153, v[132:135] offset:13056
    ds_write_b128 v153, v[136:139] offset:17408
    ds_write_b128 v153, v[140:143] offset:21760
    ds_write_b128 v153, v[144:147] offset:26112
    ds_write_b128 v153, v[148:151] offset:30464
    s_waitcnt lgkmcnt(0)
    v_mfma_f32_16x16x32_bf16 v[156:159], a[56:59], v[172:175], v[156:159]
    v_mfma_f32_16x16x32_bf16 v[160:163], a[136:139], v[172:175], v[160:163]
    v_mfma_f32_16x16x32_bf16 v[164:167], a[216:219], v[172:175], v[164:167]
    v_mfma_f32_16x16x32_bf16 v[168:171], v[232:235], v[172:175], v[168:171]
    v_mfma_f32_16x16x32_bf16 v[156:159], a[60:63], v[172:175], v[156:159]
    v_mfma_f32_16x16x32_bf16 v[160:163], a[140:143], v[172:175], v[160:163]
    v_mfma_f32_16x16x32_bf16 v[164:167], a[220:223], v[172:175], v[164:167]
    v_mfma_f32_16x16x32_bf16 v[168:171], v[236:239], v[172:175], v[168:171]
    s_barrier
    ds_read_b64_tr_b16 a[64:65], v12 offset:0
    ds_read_b64_tr_b16 a[66:67], v12 offset:8704
    ds_read_b64_tr_b16 a[68:69], v12 offset:17408
    ds_read_b64_tr_b16 a[70:71], v12 offset:26112
    ds_read_b64_tr_b16 a[144:145], v13 offset:0
    ds_read_b64_tr_b16 a[146:147], v13 offset:8704
    ds_read_b64_tr_b16 a[148:149], v13 offset:17408
    ds_read_b64_tr_b16 a[150:151], v13 offset:26112
    ds_read_b64_tr_b16 a[224:225], v14 offset:0
    ds_read_b64_tr_b16 a[226:227], v14 offset:8704
    ds_read_b64_tr_b16 a[228:229], v14 offset:17408
    ds_read_b64_tr_b16 a[230:231], v14 offset:26112
    ds_read_b64_tr_b16 v[240:241], v15 offset:0
    ds_read_b64_tr_b16 v[242:243], v15 offset:8704
    ds_read_b64_tr_b16 v[244:245], v15 offset:17408
    ds_read_b64_tr_b16 v[246:247], v15 offset:26112
    s_waitcnt vmcnt(0)
    ds_write_b128 v153, v[56:59] offset:34816
    ds_write_b128 v153, v[60:63] offset:39168
    ds_write_b128 v153, v[64:67] offset:43520
    ds_write_b128 v153, v[68:71] offset:47872
    ds_write_b128 v153, v[72:75] offset:52224
    ds_write_b128 v153, v[76:79] offset:56576
    ds_write_b128 v153, v[80:83] offset:60928
    ds_write_b128 v153, v[84:87] offset:65280
    s_waitcnt lgkmcnt(0)
    v_mfma_f32_16x16x32_bf16 v[156:159], a[64:67], v[172:175], v[156:159]
    v_mfma_f32_16x16x32_bf16 v[160:163], a[144:147], v[172:175], v[160:163]
    v_mfma_f32_16x16x32_bf16 v[164:167], a[224:227], v[172:175], v[164:167]
    v_mfma_f32_16x16x32_bf16 v[168:171], v[240:243], v[172:175], v[168:171]
    v_mfma_f32_16x16x32_bf16 v[156:159], a[68:71], v[172:175], v[156:159]
    v_mfma_f32_16x16x32_bf16 v[160:163], a[148:151], v[172:175], v[160:163]
    v_mfma_f32_16x16x32_bf16 v[164:167], a[228:231], v[172:175], v[164:167]
    v_mfma_f32_16x16x32_bf16 v[168:171], v[244:247], v[172:175], v[168:171]
    s_barrier
    ds_read_b64_tr_b16 a[72:73], v12 offset:34816
    ds_read_b64_tr_b16 a[74:75], v12 offset:43520
    ds_read_b64_tr_b16 a[76:77], v12 offset:52224
    ds_read_b64_tr_b16 a[78:79], v12 offset:60928
    ds_read_b64_tr_b16 a[152:153], v13 offset:34816
    ds_read_b64_tr_b16 a[154:155], v13 offset:43520
    ds_read_b64_tr_b16 a[156:157], v13 offset:52224
    ds_read_b64_tr_b16 a[158:159], v13 offset:60928
    ds_read_b64_tr_b16 a[232:233], v14 offset:34816
    ds_read_b64_tr_b16 a[234:235], v14 offset:43520
    ds_read_b64_tr_b16 a[236:237], v14 offset:52224
    ds_read_b64_tr_b16 a[238:239], v14 offset:60928
    ds_read_b64_tr_b16 v[248:249], v15 offset:34816
    ds_read_b64_tr_b16 v[250:251], v15 offset:43520
    ds_read_b64_tr_b16 v[252:253], v15 offset:52224
    ds_read_b64_tr_b16 v[254:255], v15 offset:60928
    s_cmp_eq_u32 s92, 0
    s_cbranch_scc0 interleave_layers__linear_attn_block__memory_aug_recurrent_mem_tr__prompt_kernel_ri4
    v_mov_b32 v15, 0
    buffer_load_dword v14, v15, s[72:75], 0 offen sc1
interleave_layers__linear_attn_block__memory_aug_recurrent_mem_tr__prompt_kernel_ri4:
    v_lshlrev_b32 v7, 4, v1
    s_lshr_b32 s24, s3, 1
    s_mul_i32 s24, s24, 20
    s_and_b32 s25, s3, 1
    s_mul_i32 s25, s25, 10
    s_add_u32 s24, s24, s25
    s_lshl_b32 s24, s24, 10
    v_add_u32 v6, s24, v7
    s_lshr_b32 s24, s3, 1
    s_lshl_b32 s24, s24, 8
    s_and_b32 s25, s3, 1
    s_lshl_b32 s25, s25, 3
    s_add_u32 s24, s24, s25
    s_add_u32 s24, s24, 51712
    v_lshlrev_b32 v9, 4, v2
    v_add_u32 v8, s24, v9
    v_add_u32 v9, 51712, v9
    v_mul_u32_u24 v10, 336, v2
    v_lshl_add_u32 v10, v3, 3, v10
    v_add_u32 v10, 40960, v10
    v_lshrrev_b32 v11, 2, v2
    v_lshl_add_u32 v11, v3, 3, v11
    v_mul_u32_u24 v11, 336, v11
    v_and_b32 v15, 3, v2
    v_lshl_add_u32 v11, v15, 3, v11
    s_lshl_b32 s24, s3, 5
    s_add_u32 s24, s24, 40960
    v_add_u32 v11, s24, v11
    s_lshl_b32 s24, s3, 10
    v_add_u32 v12, s24, v7
    v_lshlrev_b32 v15, 3, v1
    v_add_u32 v15, 2048, v15
    s_cmp_eq_u32 s3, 2
    s_cselect_b64 vcc, -1, 0
    v_cndmask_b32 v12, v12, v15, vcc
    s_mul_i32 s24, s44, 2560
    s_add_u32 s24, s24, 12582912
    v_add_u32 v12, s24, v12
    s_mov_b32 s52, 0x3fb8aa3b
    s_mov_b32 s53, s52
    s_mov_b32 s54, 0x358637bd
    s_mov_b32 s55, s54
    v_mov_b32 v120, 0
    v_mov_b32 v121, 0
    v_mov_b32 v122, 0
    v_mov_b32 v123, 0
    v_mov_b32 v124, 0
    v_mov_b32 v125, 0
    v_mov_b32 v126, 0
    v_mov_b32 v127, 0
    v_mov_b32 v128, 0
    v_mov_b32 v129, 0
    v_mov_b32 v130, 0
    v_mov_b32 v131, 0
    v_mov_b32 v132, 0
    v_mov_b32 v133, 0
    v_mov_b32 v134, 0
    v_mov_b32 v135, 0
    v_mov_b32 v136, 0
    v_mov_b32 v137, 0
    v_mov_b32 v138, 0
    v_mov_b32 v139, 0
    v_mov_b32 v140, 0
    v_mov_b32 v141, 0
    v_mov_b32 v142, 0
    v_mov_b32 v143, 0
    s_waitcnt lgkmcnt(0)
    v_mfma_f32_16x16x32_bf16 v[156:159], a[72:75], v[172:175], v[156:159]
    v_mfma_f32_16x16x32_bf16 v[160:163], a[152:155], v[172:175], v[160:163]
    v_mfma_f32_16x16x32_bf16 v[164:167], a[232:235], v[172:175], v[164:167]
    v_mfma_f32_16x16x32_bf16 v[168:171], v[248:251], v[172:175], v[168:171]
    v_mfma_f32_16x16x32_bf16 v[156:159], a[76:79], v[172:175], v[156:159]
    v_mfma_f32_16x16x32_bf16 v[160:163], a[156:159], v[172:175], v[160:163]
    v_mfma_f32_16x16x32_bf16 v[164:167], a[236:239], v[172:175], v[164:167]
    v_mfma_f32_16x16x32_bf16 v[168:171], v[252:255], v[172:175], v[168:171]
    s_cmp_eq_u32 s92, 0
    s_cbranch_scc0 interleave_layers__linear_attn_block__memory_aug_recurrent_mem_tr__prompt_kernel_rc5_ok
    s_mov_b32 s61, 0
interleave_layers__linear_attn_block__memory_aug_recurrent_mem_tr__prompt_kernel_rc5:
    s_waitcnt vmcnt(0)
    v_readfirstlane_b32 s24, v14
    s_cmp_eq_u32 s24, 1
    s_cbranch_scc1 interleave_layers__linear_attn_block__memory_aug_recurrent_mem_tr__prompt_kernel_rc5_ok
    s_add_u32 s61, s61, 1
    s_cmp_ge_u32 s61, s60
    s_cbranch_scc1 interleave_layers__linear_attn_block__memory_aug_recurrent_mem_tr__prompt_kernel_rc5_to
    s_sleep 2
    v_mov_b32 v15, 0
    buffer_load_dword v14, v15, s[72:75], 0 offen sc1
    s_branch interleave_layers__linear_attn_block__memory_aug_recurrent_mem_tr__prompt_kernel_rc5
interleave_layers__linear_attn_block__memory_aug_recurrent_mem_tr__prompt_kernel_rc5_to:
    s_mov_b32 s60, 1
interleave_layers__linear_attn_block__memory_aug_recurrent_mem_tr__prompt_kernel_rc5_ok:
interleave_layers__linear_attn_block__memory_aug_recurrent_mem_tr__prompt_kernel_k1_seg:
    s_cmp_eq_u32 s51, 1
    s_cbranch_scc1 interleave_layers__linear_attn_block__memory_aug_recurrent_mem_tr__prompt_kernel_k16
    s_and_b32 s24, s48, 3
    s_lshl_b32 s24, s24, 7
    s_add_u32 s24, s24, 23107584
    v_lshlrev_b32 v15, 2, v1
    v_add_u32 v15, s24, v15
    s_lshr_b32 s95, s48, 2
    s_add_u32 s95, s95, 1
    s_mov_b32 s61, 0
interleave_layers__linear_attn_block__memory_aug_recurrent_mem_tr__prompt_kernel_k1_wx:
    buffer_load_dword v14, v15, s[8:11], 0 offen sc1
    s_waitcnt vmcnt(0)
    v_cmp_le_i32 vcc, s95, v14
    s_mov_b32 s25, 0xfffff
    s_and_b32 s24, vcc_lo, s25
    s_cmp_eq_u32 s24, s25
    s_cbranch_scc1 interleave_layers__linear_attn_block__memory_aug_recurrent_mem_tr__prompt_kernel_k1_wx_ok
    s_add_u32 s61, s61, 1
    s_cmp_ge_u32 s61, s60
    s_cbranch_scc1 interleave_layers__linear_attn_block__memory_aug_recurrent_mem_tr__prompt_kernel_k1_wx_to
    s_sleep 4
    s_branch interleave_layers__linear_attn_block__memory_aug_recurrent_mem_tr__prompt_kernel_k1_wx
interleave_layers__linear_attn_block__memory_aug_recurrent_mem_tr__prompt_kernel_k1_wx_to:
    s_mov_b32 s60, 1
interleave_layers__linear_attn_block__memory_aug_recurrent_mem_tr__prompt_kernel_k1_wx_ok:
    s_mov_b32 s41, s43
    s_mov_b32 s24, s41
    buffer_load_dwordx2 v[16:17], v4, s[16:19], s24 offen sc1
    buffer_load_dwordx2 v[18:19], v5, s[16:19], s24 offen sc1
    s_add_u32 s24, s24, s46
    buffer_load_dwordx2 v[20:21], v4, s[16:19], s24 offen sc1
    buffer_load_dwordx2 v[22:23], v5, s[16:19], s24 offen sc1
    s_add_u32 s24, s24, s46
    buffer_load_dwordx2 v[24:25], v4, s[16:19], s24 offen sc1
    buffer_load_dwordx2 v[26:27], v5, s[16:19], s24 offen sc1
    s_add_u32 s24, s24, s46
    buffer_load_dwordx2 v[28:29], v4, s[16:19], s24 offen sc1
    buffer_load_dwordx2 v[30:31], v5, s[16:19], s24 offen sc1
    s_add_u32 s24, s24, s46
    buffer_load_dwordx2 v[32:33], v4, s[16:19], s24 offen sc1
    buffer_load_dwordx2 v[34:35], v5, s[16:19], s24 offen sc1
    s_add_u32 s24, s24, s46
    buffer_load_dwordx2 v[36:37], v4, s[16:19], s24 offen sc1
    buffer_load_dwordx2 v[38:39], v5, s[16:19], s24 offen sc1
    s_add_u32 s24, s24, s46
    buffer_load_dwordx2 v[40:41], v4, s[16:19], s24 offen sc1
    buffer_load_dwordx2 v[42:43], v5, s[16:19], s24 offen sc1
    s_add_u32 s24, s24, s46
    buffer_load_dwordx2 v[44:45], v4, s[16:19], s24 offen sc1
    buffer_load_dwordx2 v[46:47], v5, s[16:19], s24 offen sc1
    s_add_u32 s24, s24, s46
    buffer_load_dwordx2 v[48:49], v4, s[16:19], s24 offen sc1
    buffer_load_dwordx2 v[50:51], v5, s[16:19], s24 offen sc1
    s_add_u32 s24, s24, s46
    buffer_load_dwordx2 v[52:53], v4, s[16:19], s24 offen sc1
    buffer_load_dwordx2 v[54:55], v5, s[16:19], s24 offen sc1
interleave_layers__linear_attn_block__memory_aug_recurrent_mem_tr__prompt_kernel_k16:
    s_waitcnt vmcnt(0)
    v_mov_b32 v148, 0
    v_mov_b32 v149, 0
    v_mov_b32 v150, 0
    v_mov_b32 v151, 0
    v_dot2c_f32_bf16 v148, v16, v172
    v_dot2c_f32_bf16 v149, v16, v16
    v_dot2c_f32_bf16 v150, v17, v172
    v_dot2c_f32_bf16 v151, v17, v17
    v_dot2c_f32_bf16 v148, v18, v172
    v_dot2c_f32_bf16 v149, v18, v18
    v_dot2c_f32_bf16 v150, v19, v172
    v_dot2c_f32_bf16 v151, v19, v19
    v_dot2c_f32_bf16 v148, v20, v172
    v_dot2c_f32_bf16 v149, v20, v20
    v_dot2c_f32_bf16 v150, v21, v172
    v_dot2c_f32_bf16 v151, v21, v21
    v_dot2c_f32_bf16 v148, v22, v172
    v_dot2c_f32_bf16 v149, v22, v22
    v_dot2c_f32_bf16 v150, v23, v172
    v_dot2c_f32_bf16 v151, v23, v23
    v_dot2c_f32_bf16 v148, v24, v172
    v_dot2c_f32_bf16 v149, v24, v24
    v_dot2c_f32_bf16 v150, v25, v172
    v_dot2c_f32_bf16 v151, v25, v25
    v_dot2c_f32_bf16 v148, v26, v172
    v_dot2c_f32_bf16 v149, v26, v26
    v_dot2c_f32_bf16 v150, v27, v172
    v_dot2c_f32_bf16 v151, v27, v27
    v_dot2c_f32_bf16 v148, v28, v172
    v_dot2c_f32_bf16 v149, v28, v28
    v_dot2c_f32_bf16 v150, v29, v172
    v_dot2c_f32_bf16 v151, v29, v29
    v_dot2c_f32_bf16 v148, v30, v172
    v_dot2c_f32_bf16 v149, v30, v30
    v_dot2c_f32_bf16 v150, v31, v172
    v_dot2c_f32_bf16 v151, v31, v31
    v_dot2c_f32_bf16 v148, v32, v172
    v_dot2c_f32_bf16 v149, v32, v32
    v_dot2c_f32_bf16 v150, v33, v172
    v_dot2c_f32_bf16 v151, v33, v33
    v_dot2c_f32_bf16 v148, v34, v172
    v_dot2c_f32_bf16 v149, v34, v34
    v_dot2c_f32_bf16 v150, v35, v172
    v_dot2c_f32_bf16 v151, v35, v35
    v_dot2c_f32_bf16 v148, v36, v172
    v_dot2c_f32_bf16 v149, v36, v36
    v_dot2c_f32_bf16 v150, v37, v172
    v_dot2c_f32_bf16 v151, v37, v37
    v_dot2c_f32_bf16 v148, v38, v172
    v_dot2c_f32_bf16 v149, v38, v38
    v_dot2c_f32_bf16 v150, v39, v172
    v_dot2c_f32_bf16 v151, v39, v39
    v_dot2c_f32_bf16 v148, v40, v172
    v_dot2c_f32_bf16 v149, v40, v40
    v_dot2c_f32_bf16 v150, v41, v172
    v_dot2c_f32_bf16 v151, v41, v41
    v_dot2c_f32_bf16 v148, v42, v172
    v_dot2c_f32_bf16 v149, v42, v42
    v_dot2c_f32_bf16 v150, v43, v172
    v_dot2c_f32_bf16 v151, v43, v43
    v_dot2c_f32_bf16 v148, v44, v172
    v_dot2c_f32_bf16 v149, v44, v44
    v_dot2c_f32_bf16 v150, v45, v172
    v_dot2c_f32_bf16 v151, v45, v45
    v_dot2c_f32_bf16 v148, v46, v172
    v_dot2c_f32_bf16 v149, v46, v46
    v_dot2c_f32_bf16 v150, v47, v172
    v_dot2c_f32_bf16 v151, v47, v47
    v_dot2c_f32_bf16 v148, v48, v172
    v_dot2c_f32_bf16 v149, v48, v48
    v_dot2c_f32_bf16 v150, v49, v172
    v_dot2c_f32_bf16 v151, v49, v49
    v_dot2c_f32_bf16 v148, v50, v172
    v_dot2c_f32_bf16 v149, v50, v50
    v_dot2c_f32_bf16 v150, v51, v172
    v_dot2c_f32_bf16 v151, v51, v51
    v_dot2c_f32_bf16 v148, v52, v172
    v_dot2c_f32_bf16 v149, v52, v52
    v_dot2c_f32_bf16 v150, v53, v172
    v_dot2c_f32_bf16 v151, v53, v53
    v_dot2c_f32_bf16 v148, v54, v172
    v_dot2c_f32_bf16 v149, v54, v54
    v_dot2c_f32_bf16 v150, v55, v172
    v_dot2c_f32_bf16 v151, v55, v55
    s_nop 1
    v_add_f32 v148, v148, v150
    v_add_f32 v149, v149, v151
    v_mov_b32 v150, v148
    v_mov_b32 v151, v149
    s_nop 0
    v_permlane16_swap_b32 v148, v150
    v_permlane16_swap_b32 v149, v151
    v_add_f32 v148, v148, v150
    v_add_f32 v149, v149, v151
    v_mov_b32 v150, v148
    v_mov_b32 v151, v149
    s_nop 0
    v_permlane32_swap_b32 v148, v150
    v_permlane32_swap_b32 v149, v151
    v_add_f32 v148, v148, v150
    v_add_f32 v149, v149, v151
    ds_write_b128 v6, v[16:19] offset:0
    ds_write_b128 v6, v[20:23] offset:1024
    ds_write_b128 v6, v[24:27] offset:2048
    ds_write_b128 v6, v[28:31] offset:3072
    ds_write_b128 v6, v[32:35] offset:4096
    ds_write_b128 v6, v[36:39] offset:5120
    ds_write_b128 v6, v[40:43] offset:6144
    ds_write_b128 v6, v[44:47] offset:7168
    ds_write_b128 v6, v[48:51] offset:8192
    ds_write_b128 v6, v[52:55] offset:9216
    ds_write_b64 v8, v[148:149]
    s_mov_b32 s51, 0
    s_waitcnt lgkmcnt(0)
    s_cmp_eq_u32 s92, 0
    s_cbranch_scc0 interleave_layers__linear_attn_block__memory_aug_recurrent_mem_tr__prompt_kernel_k17
    s_cmp_gt_u32 s40, 1
    s_cbranch_scc0 interleave_layers__linear_attn_block__memory_aug_recurrent_mem_tr__prompt_kernel_k17
    s_add_u32 s41, s43, s42
    s_mov_b32 s24, s41
    buffer_load_dwordx2 v[16:17], v4, s[16:19], s24 offen sc1
    buffer_load_dwordx2 v[18:19], v5, s[16:19], s24 offen sc1
    s_add_u32 s24, s24, s46
    buffer_load_dwordx2 v[20:21], v4, s[16:19], s24 offen sc1
    buffer_load_dwordx2 v[22:23], v5, s[16:19], s24 offen sc1
    s_add_u32 s24, s24, s46
    buffer_load_dwordx2 v[24:25], v4, s[16:19], s24 offen sc1
    buffer_load_dwordx2 v[26:27], v5, s[16:19], s24 offen sc1
    s_add_u32 s24, s24, s46
    buffer_load_dwordx2 v[28:29], v4, s[16:19], s24 offen sc1
    buffer_load_dwordx2 v[30:31], v5, s[16:19], s24 offen sc1
    s_add_u32 s24, s24, s46
    buffer_load_dwordx2 v[32:33], v4, s[16:19], s24 offen sc1
    buffer_load_dwordx2 v[34:35], v5, s[16:19], s24 offen sc1
    s_add_u32 s24, s24, s46
    buffer_load_dwordx2 v[36:37], v4, s[16:19], s24 offen sc1
    buffer_load_dwordx2 v[38:39], v5, s[16:19], s24 offen sc1
    s_add_u32 s24, s24, s46
    buffer_load_dwordx2 v[40:41], v4, s[16:19], s24 offen sc1
    buffer_load_dwordx2 v[42:43], v5, s[16:19], s24 offen sc1
    s_add_u32 s24, s24, s46
    buffer_load_dwordx2 v[44:45], v4, s[16:19], s24 offen sc1
    buffer_load_dwordx2 v[46:47], v5, s[16:19], s24 offen sc1
    s_add_u32 s24, s24, s46
    buffer_load_dwordx2 v[48:49], v4, s[16:19], s24 offen sc1
    buffer_load_dwordx2 v[50:51], v5, s[16:19], s24 offen sc1
    s_add_u32 s24, s24, s46
    buffer_load_dwordx2 v[52:53], v4, s[16:19], s24 offen sc1
    buffer_load_dwordx2 v[54:55], v5, s[16:19], s24 offen sc1
    s_mov_b32 s51, 1
interleave_layers__linear_attn_block__memory_aug_recurrent_mem_tr__prompt_kernel_k17:
    s_barrier
    ds_read_b128 v[148:151], v9
    ds_read_b128 v[152:155], v9 offset:256
    ds_read_b128 v[56:59], v7 offset:0
    ds_read_b128 v[60:63], v7 offset:20480
    ds_read_b128 v[64:67], v7 offset:1024
    ds_read_b128 v[68:71], v7 offset:21504
    ds_read_b128 v[72:75], v7 offset:2048
    ds_read_b128 v[76:79], v7 offset:22528
    s_waitcnt lgkmcnt(6)
    v_add_f32 v148, v148, v150
    v_add_f32 v149, v149, v151
    v_mul_f32 v148, 0x3acccccd, v148
    v_mul_f32 v150, v148, v148
    v_mov_b32 v151, 0x3acccccd
    v_fma_f32 v149, v149, v151, -v150
    v_max_f32 v149, 0, v149
    v_add_f32 v149, 0x3727c5ac, v149
    v_rsq_f32 v144, v149
    s_nop 0
    v_mul_f32 v145, v148, v144
    v_sub_f32 v145, 0, v145
    v_add_f32 v152, v152, v154
    v_add_f32 v153, v153, v155
    v_mul_f32 v152, 0x3acccccd, v152
    v_mul_f32 v154, v152, v152
    v_mov_b32 v155, 0x3acccccd
    v_fma_f32 v153, v153, v155, -v154
    v_max_f32 v153, 0, v153
    v_add_f32 v153, 0x3727c5ac, v153
    v_rsq_f32 v146, v153
    s_nop 0
    v_mul_f32 v147, v152, v146
    v_sub_f32 v147, 0, v147
    ds_read_b128 v[80:83], v7 offset:3072
    ds_read_b128 v[84:87], v7 offset:23552
    s_waitcnt lgkmcnt(6)
    v_mfma_f32_16x16x32_bf16 v[88:91], a[0:3], v[56:59], 0
    v_mfma_f32_16x16x32_bf16 v[96:99], a[80:83], v[56:59], 0
    v_mfma_f32_16x16x32_bf16 v[104:107], a[160:163], v[56:59], 0
    v_mfma_f32_16x16x32_bf16 v[112:115], v[176:179], v[56:59], 0
    v_mfma_f32_16x16x32_bf16 v[92:95], a[0:3], v[60:63], 0
    v_mfma_f32_16x16x32_bf16 v[100:103], a[80:83], v[60:63], 0
    v_mfma_f32_16x16x32_bf16 v[108:111], a[160:163], v[60:63], 0
    v_mfma_f32_16x16x32_bf16 v[116:119], v[176:179], v[60:63], 0
    ds_read_b128 v[56:59], v7 offset:4096
    ds_read_b128 v[60:63], v7 offset:24576
    s_waitcnt lgkmcnt(6)
    v_mfma_f32_16x16x32_bf16 v[88:91], a[4:7], v[64:67], v[88:91]
    v_mfma_f32_16x16x32_bf16 v[96:99], a[84:87], v[64:67], v[96:99]
    v_mfma_f32_16x16x32_bf16 v[104:107], a[164:167], v[64:67], v[104:107]
    v_mfma_f32_16x16x32_bf16 v[112:115], v[180:183], v[64:67], v[112:115]
    v_mfma_f32_16x16x32_bf16 v[92:95], a[4:7], v[68:71], v[92:95]
    v_mfma_f32_16x16x32_bf16 v[100:103], a[84:87], v[68:71], v[100:103]
    v_mfma_f32_16x16x32_bf16 v[108:111], a[164:167], v[68:71], v[108:111]
    v_mfma_f32_16x16x32_bf16 v[116:119], v[180:183], v[68:71], v[116:119]
    ds_read_b128 v[64:67], v7 offset:5120
    ds_read_b128 v[68:71], v7 offset:25600
    s_waitcnt lgkmcnt(6)
    v_mfma_f32_16x16x32_bf16 v[88:91], a[8:11], v[72:75], v[88:91]
    v_mfma_f32_16x16x32_bf16 v[96:99], a[88:91], v[72:75], v[96:99]
    v_mfma_f32_16x16x32_bf16 v[104:107], a[168:171], v[72:75], v[104:107]
    v_mfma_f32_16x16x32_bf16 v[112:115], v[184:187], v[72:75], v[112:115]
    v_mfma_f32_16x16x32_bf16 v[92:95], a[8:11], v[76:79], v[92:95]
    v_mfma_f32_16x16x32_bf16 v[100:103], a[88:91], v[76:79], v[100:103]
    v_mfma_f32_16x16x32_bf16 v[108:111], a[168:171], v[76:79], v[108:111]
    v_mfma_f32_16x16x32_bf16 v[116:119], v[184:187], v[76:79], v[116:119]
    ds_read_b128 v[72:75], v7 offset:6144
    ds_read_b128 v[76:79], v7 offset:26624
    s_waitcnt lgkmcnt(6)
    v_mfma_f32_16x16x32_bf16 v[88:91], a[12:15], v[80:83], v[88:91]
    v_mfma_f32_16x16x32_bf16 v[96:99], a[92:95], v[80:83], v[96:99]
    v_mfma_f32_16x16x32_bf16 v[104:107], a[172:175], v[80:83], v[104:107]
    v_mfma_f32_16x16x32_bf16 v[112:115], v[188:191], v[80:83], v[112:115]
    v_mfma_f32_16x16x32_bf16 v[92:95], a[12:15], v[84:87], v[92:95]
    v_mfma_f32_16x16x32_bf16 v[100:103], a[92:95], v[84:87], v[100:103]
    v_mfma_f32_16x16x32_bf16 v[108:111], a[172:175], v[84:87], v[108:111]
    v_mfma_f32_16x16x32_bf16 v[116:119], v[188:191], v[84:87], v[116:119]
    ds_read_b128 v[80:83], v7 offset:7168
    ds_read_b128 v[84:87], v7 offset:27648
    s_waitcnt lgkmcnt(6)
    v_mfma_f32_16x16x32_bf16 v[88:91], a[16:19], v[56:59], v[88:91]
    v_mfma_f32_16x16x32_bf16 v[96:99], a[96:99], v[56:59], v[96:99]
    v_mfma_f32_16x16x32_bf16 v[104:107], a[176:179], v[56:59], v[104:107]
    v_mfma_f32_16x16x32_bf16 v[112:115], v[192:195], v[56:59], v[112:115]
    v_mfma_f32_16x16x32_bf16 v[92:95], a[16:19], v[60:63], v[92:95]
    v_mfma_f32_16x16x32_bf16 v[100:103], a[96:99], v[60:63], v[100:103]
    v_mfma_f32_16x16x32_bf16 v[108:111], a[176:179], v[60:63], v[108:111]
    v_mfma_f32_16x16x32_bf16 v[116:119], v[192:195], v[60:63], v[116:119]
    ds_read_b128 v[56:59], v7 offset:8192
    ds_read_b128 v[60:63], v7 offset:28672
    s_waitcnt lgkmcnt(6)
    v_mfma_f32_16x16x32_bf16 v[88:91], a[20:23], v[64:67], v[88:91]
    v_mfma_f32_16x16x32_bf16 v[96:99], a[100:103], v[64:67], v[96:99]
    v_mfma_f32_16x16x32_bf16 v[104:107], a[180:183], v[64:67], v[104:107]
    v_mfma_f32_16x16x32_bf16 v[112:115], v[196:199], v[64:67], v[112:115]
    v_mfma_f32_16x16x32_bf16 v[92:95], a[20:23], v[68:71], v[92:95]
    v_mfma_f32_16x16x32_bf16 v[100:103], a[100:103], v[68:71], v[100:103]
    v_mfma_f32_16x16x32_bf16 v[108:111], a[180:183], v[68:71], v[108:111]
    v_mfma_f32_16x16x32_bf16 v[116:119], v[196:199], v[68:71], v[116:119]
    ds_read_b128 v[64:67], v7 offset:9216
    ds_read_b128 v[68:71], v7 offset:29696
    s_waitcnt lgkmcnt(6)
    v_mfma_f32_16x16x32_bf16 v[88:91], a[24:27], v[72:75], v[88:91]
    v_mfma_f32_16x16x32_bf16 v[96:99], a[104:107], v[72:75], v[96:99]
    v_mfma_f32_16x16x32_bf16 v[104:107], a[184:187], v[72:75], v[104:107]
    v_mfma_f32_16x16x32_bf16 v[112:115], v[200:203], v[72:75], v[112:115]
    v_mfma_f32_16x16x32_bf16 v[92:95], a[24:27], v[76:79], v[92:95]
    v_mfma_f32_16x16x32_bf16 v[100:103], a[104:107], v[76:79], v[100:103]
    v_mfma_f32_16x16x32_bf16 v[108:111], a[184:187], v[76:79], v[108:111]
    v_mfma_f32_16x16x32_bf16 v[116:119], v[200:203], v[76:79], v[116:119]
    ds_read_b128 v[72:75], v7 offset:10240
    ds_read_b128 v[76:79], v7 offset:30720
    s_waitcnt lgkmcnt(6)
    v_mfma_f32_16x16x32_bf16 v[88:91], a[28:31], v[80:83], v[88:91]
    v_mfma_f32_16x16x32_bf16 v[96:99], a[108:111], v[80:83], v[96:99]
    v_mfma_f32_16x16x32_bf16 v[104:107], a[188:191], v[80:83], v[104:107]
    v_mfma_f32_16x16x32_bf16 v[112:115], v[204:207], v[80:83], v[112:115]
    v_mfma_f32_16x16x32_bf16 v[92:95], a[28:31], v[84:87], v[92:95]
    v_mfma_f32_16x16x32_bf16 v[100:103], a[108:111], v[84:87], v[100:103]
    v_mfma_f32_16x16x32_bf16 v[108:111], a[188:191], v[84:87], v[108:111]
    v_mfma_f32_16x16x32_bf16 v[116:119], v[204:207], v[84:87], v[116:119]
    ds_read_b128 v[80:83], v7 offset:11264
    ds_read_b128 v[84:87], v7 offset:31744
    s_waitcnt lgkmcnt(6)
    v_mfma_f32_16x16x32_bf16 v[88:91], a[32:35], v[56:59], v[88:91]
    v_mfma_f32_16x16x32_bf16 v[96:99], a[112:115], v[56:59], v[96:99]
    v_mfma_f32_16x16x32_bf16 v[104:107], a[192:195], v[56:59], v[104:107]
    v_mfma_f32_16x16x32_bf16 v[112:115], v[208:211], v[56:59], v[112:115]
    v_mfma_f32_16x16x32_bf16 v[92:95], a[32:35], v[60:63], v[92:95]
    v_mfma_f32_16x16x32_bf16 v[100:103], a[112:115], v[60:63], v[100:103]
    v_mfma_f32_16x16x32_bf16 v[108:111], a[192:195], v[60:63], v[108:111]
    v_mfma_f32_16x16x32_bf16 v[116:119], v[208:211], v[60:63], v[116:119]
    ds_read_b128 v[56:59], v7 offset:12288
    ds_read_b128 v[60:63], v7 offset:32768
    s_waitcnt lgkmcnt(6)
    v_mfma_f32_16x16x32_bf16 v[88:91], a[36:39], v[64:67], v[88:91]
    v_mfma_f32_16x16x32_bf16 v[96:99], a[116:119], v[64:67], v[96:99]
    v_mfma_f32_16x16x32_bf16 v[104:107], a[196:199], v[64:67], v[104:107]
    v_mfma_f32_16x16x32_bf16 v[112:115], v[212:215], v[64:67], v[112:115]
    v_mfma_f32_16x16x32_bf16 v[92:95], a[36:39], v[68:71], v[92:95]
    v_mfma_f32_16x16x32_bf16 v[100:103], a[116:119], v[68:71], v[100:103]
    v_mfma_f32_16x16x32_bf16 v[108:111], a[196:199], v[68:71], v[108:111]
    v_mfma_f32_16x16x32_bf16 v[116:119], v[212:215], v[68:71], v[116:119]
    ds_read_b128 v[64:67], v7 offset:13312
    ds_read_b128 v[68:71], v7 offset:33792
    s_waitcnt lgkmcnt(6)
    v_mfma_f32_16x16x32_bf16 v[88:91], a[40:43], v[72:75], v[88:91]
    v_mfma_f32_16x16x32_bf16 v[96:99], a[120:123], v[72:75], v[96:99]
    v_mfma_f32_16x16x32_bf16 v[104:107], a[200:203], v[72:75], v[104:107]
    v_mfma_f32_16x16x32_bf16 v[112:115], v[216:219], v[72:75], v[112:115]
    v_mfma_f32_16x16x32_bf16 v[92:95], a[40:43], v[76:79], v[92:95]
    v_mfma_f32_16x16x32_bf16 v[100:103], a[120:123], v[76:79], v[100:103]
    v_mfma_f32_16x16x32_bf16 v[108:111], a[200:203], v[76:79], v[108:111]
    v_mfma_f32_16x16x32_bf16 v[116:119], v[216:219], v[76:79], v[116:119]
    ds_read_b128 v[72:75], v7 offset:14336
    ds_read_b128 v[76:79], v7 offset:34816
    s_waitcnt lgkmcnt(6)
    v_mfma_f32_16x16x32_bf16 v[88:91], a[44:47], v[80:83], v[88:91]
    v_mfma_f32_16x16x32_bf16 v[96:99], a[124:127], v[80:83], v[96:99]
    v_mfma_f32_16x16x32_bf16 v[104:107], a[204:207], v[80:83], v[104:107]
    v_mfma_f32_16x16x32_bf16 v[112:115], v[220:223], v[80:83], v[112:115]
    v_mfma_f32_16x16x32_bf16 v[92:95], a[44:47], v[84:87], v[92:95]
    v_mfma_f32_16x16x32_bf16 v[100:103], a[124:127], v[84:87], v[100:103]
    v_mfma_f32_16x16x32_bf16 v[108:111], a[204:207], v[84:87], v[108:111]
    v_mfma_f32_16x16x32_bf16 v[116:119], v[220:223], v[84:87], v[116:119]
    ds_read_b128 v[80:83], v7 offset:15360
    ds_read_b128 v[84:87], v7 offset:35840
    s_waitcnt lgkmcnt(6)
    v_mfma_f32_16x16x32_bf16 v[88:91], a[48:51], v[56:59], v[88:91]
    v_mfma_f32_16x16x32_bf16 v[96:99], a[128:131], v[56:59], v[96:99]
    v_mfma_f32_16x16x32_bf16 v[104:107], a[208:211], v[56:59], v[104:107]
    v_mfma_f32_16x16x32_bf16 v[112:115], v[224:227], v[56:59], v[112:115]
    v_mfma_f32_16x16x32_bf16 v[92:95], a[48:51], v[60:63], v[92:95]
    v_mfma_f32_16x16x32_bf16 v[100:103], a[128:131], v[60:63], v[100:103]
    v_mfma_f32_16x16x32_bf16 v[108:111], a[208:211], v[60:63], v[108:111]
    v_mfma_f32_16x16x32_bf16 v[116:119], v[224:227], v[60:63], v[116:119]
    ds_read_b128 v[56:59], v7 offset:16384
    ds_read_b128 v[60:63], v7 offset:36864
    s_waitcnt lgkmcnt(6)
    v_mfma_f32_16x16x32_bf16 v[88:91], a[52:55], v[64:67], v[88:91]
    v_mfma_f32_16x16x32_bf16 v[96:99], a[132:135], v[64:67], v[96:99]
    v_mfma_f32_16x16x32_bf16 v[104:107], a[212:215], v[64:67], v[104:107]
    v_mfma_f32_16x16x32_bf16 v[112:115], v[228:231], v[64:67], v[112:115]
    v_mfma_f32_16x16x32_bf16 v[92:95], a[52:55], v[68:71], v[92:95]
    v_mfma_f32_16x16x32_bf16 v[100:103], a[132:135], v[68:71], v[100:103]
    v_mfma_f32_16x16x32_bf16 v[108:111], a[212:215], v[68:71], v[108:111]
    v_mfma_f32_16x16x32_bf16 v[116:119], v[228:231], v[68:71], v[116:119]
    ds_read_b128 v[64:67], v7 offset:17408
    ds_read_b128 v[68:71], v7 offset:37888
    s_waitcnt lgkmcnt(6)
    v_mfma_f32_16x16x32_bf16 v[88:91], a[56:59], v[72:75], v[88:91]
    v_mfma_f32_16x16x32_bf16 v[96:99], a[136:139], v[72:75], v[96:99]
    v_mfma_f32_16x16x32_bf16 v[104:107], a[216:219], v[72:75], v[104:107]
    v_mfma_f32_16x16x32_bf16 v[112:115], v[232:235], v[72:75], v[112:115]
    v_mfma_f32_16x16x32_bf16 v[92:95], a[56:59], v[76:79], v[92:95]
    v_mfma_f32_16x16x32_bf16 v[100:103], a[136:139], v[76:79], v[100:103]
    v_mfma_f32_16x16x32_bf16 v[108:111], a[216:219], v[76:79], v[108:111]
    v_mfma_f32_16x16x32_bf16 v[116:119], v[232:235], v[76:79], v[116:119]
    ds_read_b128 v[72:75], v7 offset:18432
    ds_read_b128 v[76:79], v7 offset:38912
    s_waitcnt lgkmcnt(6)
    v_mfma_f32_16x16x32_bf16 v[88:91], a[60:63], v[80:83], v[88:91]
    v_mfma_f32_16x16x32_bf16 v[96:99], a[140:143], v[80:83], v[96:99]
    v_mfma_f32_16x16x32_bf16 v[104:107], a[220:223], v[80:83], v[104:107]
    v_mfma_f32_16x16x32_bf16 v[112:115], v[236:239], v[80:83], v[112:115]
    v_mfma_f32_16x16x32_bf16 v[92:95], a[60:63], v[84:87], v[92:95]
    v_mfma_f32_16x16x32_bf16 v[100:103], a[140:143], v[84:87], v[100:103]
    v_mfma_f32_16x16x32_bf16 v[108:111], a[220:223], v[84:87], v[108:111]
    v_mfma_f32_16x16x32_bf16 v[116:119], v[236:239], v[84:87], v[116:119]
    ds_read_b128 v[80:83], v7 offset:19456
    ds_read_b128 v[84:87], v7 offset:39936
    s_waitcnt lgkmcnt(6)
    v_mfma_f32_16x16x32_bf16 v[88:91], a[64:67], v[56:59], v[88:91]
    v_mfma_f32_16x16x32_bf16 v[96:99], a[144:147], v[56:59], v[96:99]
    v_mfma_f32_16x16x32_bf16 v[104:107], a[224:227], v[56:59], v[104:107]
    v_mfma_f32_16x16x32_bf16 v[112:115], v[240:243], v[56:59], v[112:115]
    v_mfma_f32_16x16x32_bf16 v[92:95], a[64:67], v[60:63], v[92:95]
    v_mfma_f32_16x16x32_bf16 v[100:103], a[144:147], v[60:63], v[100:103]
    v_mfma_f32_16x16x32_bf16 v[108:111], a[224:227], v[60:63], v[108:111]
    v_mfma_f32_16x16x32_bf16 v[116:119], v[240:243], v[60:63], v[116:119]
    s_waitcnt lgkmcnt(4)
    v_mfma_f32_16x16x32_bf16 v[88:91], a[68:71], v[64:67], v[88:91]
    v_mfma_f32_16x16x32_bf16 v[96:99], a[148:151], v[64:67], v[96:99]
    v_mfma_f32_16x16x32_bf16 v[104:107], a[228:231], v[64:67], v[104:107]
    v_mfma_f32_16x16x32_bf16 v[112:115], v[244:247], v[64:67], v[112:115]
    v_mfma_f32_16x16x32_bf16 v[92:95], a[68:71], v[68:71], v[92:95]
    v_mfma_f32_16x16x32_bf16 v[100:103], a[148:151], v[68:71], v[100:103]
    v_mfma_f32_16x16x32_bf16 v[108:111], a[228:231], v[68:71], v[108:111]
    v_mfma_f32_16x16x32_bf16 v[116:119], v[244:247], v[68:71], v[116:119]
    s_waitcnt lgkmcnt(2)
    v_mfma_f32_16x16x32_bf16 v[88:91], a[72:75], v[72:75], v[88:91]
    v_mfma_f32_16x16x32_bf16 v[96:99], a[152:155], v[72:75], v[96:99]
    v_mfma_f32_16x16x32_bf16 v[104:107], a[232:235], v[72:75], v[104:107]
    v_mfma_f32_16x16x32_bf16 v[112:115], v[248:251], v[72:75], v[112:115]
    v_mfma_f32_16x16x32_bf16 v[92:95], a[72:75], v[76:79], v[92:95]
    v_mfma_f32_16x16x32_bf16 v[100:103], a[152:155], v[76:79], v[100:103]
    v_mfma_f32_16x16x32_bf16 v[108:111], a[232:235], v[76:79], v[108:111]
    v_mfma_f32_16x16x32_bf16 v[116:119], v[248:251], v[76:79], v[116:119]
    s_waitcnt lgkmcnt(0)
    v_mfma_f32_16x16x32_bf16 v[88:91], a[76:79], v[80:83], v[88:91]
    v_mfma_f32_16x16x32_bf16 v[96:99], a[156:159], v[80:83], v[96:99]
    v_mfma_f32_16x16x32_bf16 v[104:107], a[236:239], v[80:83], v[104:107]
    v_mfma_f32_16x16x32_bf16 v[112:115], v[252:255], v[80:83], v[112:115]
    v_mfma_f32_16x16x32_bf16 v[92:95], a[76:79], v[84:87], v[92:95]
    v_mfma_f32_16x16x32_bf16 v[100:103], a[156:159], v[84:87], v[100:103]
    v_mfma_f32_16x16x32_bf16 v[108:111], a[236:239], v[84:87], v[108:111]
    v_mfma_f32_16x16x32_bf16 v[116:119], v[252:255], v[84:87], v[116:119]
    v_pk_mul_f32 v[148:149], v[156:157], v[144:145] op_sel:[0,1] op_sel_hi:[1,1]
    v_pk_mul_f32 v[150:151], v[158:159], v[144:145] op_sel:[0,1] op_sel_hi:[1,1]
    v_pk_fma_f32 v[88:89], v[88:89], v[144:145], v[148:149] op_sel:[0,0,0] op_sel_hi:[1,0,1]
    v_pk_fma_f32 v[90:91], v[90:91], v[144:145], v[150:151] op_sel:[0,0,0] op_sel_hi:[1,0,1]
    v_pk_mul_f32 v[148:149], v[156:157], v[146:147] op_sel:[0,1] op_sel_hi:[1,1]
    v_pk_mul_f32 v[150:151], v[158:159], v[146:147] op_sel:[0,1] op_sel_hi:[1,1]
    v_pk_fma_f32 v[92:93], v[92:93], v[146:147], v[148:149] op_sel:[0,0,0] op_sel_hi:[1,0,1]
    v_pk_fma_f32 v[94:95], v[94:95], v[146:147], v[150:151] op_sel:[0,0,0] op_sel_hi:[1,0,1]
    v_pk_mul_f32 v[148:149], v[160:161], v[144:145] op_sel:[0,1] op_sel_hi:[1,1]
    v_pk_mul_f32 v[150:151], v[162:163], v[144:145] op_sel:[0,1] op_sel_hi:[1,1]
    v_pk_fma_f32 v[96:97], v[96:97], v[144:145], v[148:149] op_sel:[0,0,0] op_sel_hi:[1,0,1]
    v_pk_fma_f32 v[98:99], v[98:99], v[144:145], v[150:151] op_sel:[0,0,0] op_sel_hi:[1,0,1]
    v_pk_mul_f32 v[148:149], v[160:161], v[146:147] op_sel:[0,1] op_sel_hi:[1,1]
    v_pk_mul_f32 v[150:151], v[162:163], v[146:147] op_sel:[0,1] op_sel_hi:[1,1]
    v_pk_fma_f32 v[100:101], v[100:101], v[146:147], v[148:149] op_sel:[0,0,0] op_sel_hi:[1,0,1]
    v_pk_fma_f32 v[102:103], v[102:103], v[146:147], v[150:151] op_sel:[0,0,0] op_sel_hi:[1,0,1]
    v_pk_mul_f32 v[148:149], v[164:165], v[144:145] op_sel:[0,1] op_sel_hi:[1,1]
    v_pk_mul_f32 v[150:151], v[166:167], v[144:145] op_sel:[0,1] op_sel_hi:[1,1]
    v_pk_fma_f32 v[104:105], v[104:105], v[144:145], v[148:149] op_sel:[0,0,0] op_sel_hi:[1,0,1]
    v_pk_fma_f32 v[106:107], v[106:107], v[144:145], v[150:151] op_sel:[0,0,0] op_sel_hi:[1,0,1]
    v_pk_mul_f32 v[148:149], v[164:165], v[146:147] op_sel:[0,1] op_sel_hi:[1,1]
    v_pk_mul_f32 v[150:151], v[166:167], v[146:147] op_sel:[0,1] op_sel_hi:[1,1]
    v_pk_fma_f32 v[108:109], v[108:109], v[146:147], v[148:149] op_sel:[0,0,0] op_sel_hi:[1,0,1]
    v_pk_fma_f32 v[110:111], v[110:111], v[146:147], v[150:151] op_sel:[0,0,0] op_sel_hi:[1,0,1]
    v_pk_mul_f32 v[148:149], v[168:169], v[144:145] op_sel:[0,1] op_sel_hi:[1,1]
    v_pk_mul_f32 v[150:151], v[170:171], v[144:145] op_sel:[0,1] op_sel_hi:[1,1]
    v_pk_fma_f32 v[112:113], v[112:113], v[144:145], v[148:149] op_sel:[0,0,0] op_sel_hi:[1,0,1]
    v_pk_fma_f32 v[114:115], v[114:115], v[144:145], v[150:151] op_sel:[0,0,0] op_sel_hi:[1,0,1]
    v_pk_mul_f32 v[148:149], v[168:169], v[146:147] op_sel:[0,1] op_sel_hi:[1,1]
    v_pk_mul_f32 v[150:151], v[170:171], v[146:147] op_sel:[0,1] op_sel_hi:[1,1]
    v_pk_fma_f32 v[116:117], v[116:117], v[146:147], v[148:149] op_sel:[0,0,0] op_sel_hi:[1,0,1]
    v_pk_fma_f32 v[118:119], v[118:119], v[146:147], v[150:151] op_sel:[0,0,0] op_sel_hi:[1,0,1]
    s_add_u32 s25, s43, 20480
    s_cmp_ge_u32 s3, 2
    s_cbranch_scc1 interleave_layers__linear_attn_block__memory_aug_recurrent_mem_tr__prompt_kernel_k1_e2
    s_lshl_b32 s24, s3, 6
    v_add_u32 v15, s24, v10
    v_cvt_pk_bf16_f32 v64, v104, v105
    v_cvt_pk_bf16_f32 v65, v106, v107
    ds_write_b64 v15, v[64:65] offset:160
    v_cvt_pk_bf16_f32 v66, v108, v109
    v_cvt_pk_bf16_f32 v67, v110, v111
    ds_write_b64 v15, v[66:67] offset:5536
    v_cvt_pk_bf16_f32 v68, v112, v113
    v_cvt_pk_bf16_f32 v69, v114, v115
    ds_write_b64 v15, v[68:69] offset:192
    v_cvt_pk_bf16_f32 v70, v116, v117
    v_cvt_pk_bf16_f32 v71, v118, v119
    ds_write_b64 v15, v[70:71] offset:5568
    v_min_f32 v148, 0, v88
    v_min_f32 v149, 0, v89
    v_pk_mul_f32 v[148:149], v[148:149], s[52:53]
    v_min_f32 v150, 0, v90
    v_min_f32 v151, 0, v91
    v_pk_mul_f32 v[150:151], v[150:151], s[52:53]
    v_exp_f32 v148, v148
    v_exp_f32 v149, v149
    v_exp_f32 v150, v150
    v_exp_f32 v151, v151
    v_max_f32 v88, 0, v88
    v_max_f32 v89, 0, v89
    v_max_f32 v90, 0, v90
    v_max_f32 v91, 0, v91
    v_pk_add_f32 v[88:89], v[88:89], v[148:149]
    v_pk_add_f32 v[90:91], v[90:91], v[150:151]
    v_pk_add_f32 v[88:89], v[88:89], s[54:55]
    v_pk_add_f32 v[90:91], v[90:91], s[54:55]
    v_min_f32 v148, 0, v96
    v_min_f32 v149, 0, v97
    v_pk_mul_f32 v[148:149], v[148:149], s[52:53]
    v_min_f32 v150, 0, v98
    v_min_f32 v151, 0, v99
    v_pk_mul_f32 v[150:151], v[150:151], s[52:53]
    v_exp_f32 v148, v148
    v_exp_f32 v149, v149
    v_exp_f32 v150, v150
    v_exp_f32 v151, v151
    v_max_f32 v96, 0, v96
    v_max_f32 v97, 0, v97
    v_max_f32 v98, 0, v98
    v_max_f32 v99, 0, v99
    v_pk_add_f32 v[96:97], v[96:97], v[148:149]
    v_pk_add_f32 v[98:99], v[98:99], v[150:151]
    v_pk_add_f32 v[96:97], v[96:97], s[54:55]
    v_pk_add_f32 v[98:99], v[98:99], s[54:55]
    v_cvt_pk_bf16_f32 v56, v88, v89
    v_cvt_pk_bf16_f32 v57, v90, v91
    v_cvt_pk_bf16_f32 v58, v96, v97
    v_cvt_pk_bf16_f32 v59, v98, v99
    buffer_store_dwordx4 v[56:59], v12, s[8:11], s43 offen sc1
    v_min_f32 v148, 0, v92
    v_min_f32 v149, 0, v93
    v_pk_mul_f32 v[148:149], v[148:149], s[52:53]
    v_min_f32 v150, 0, v94
    v_min_f32 v151, 0, v95
    v_pk_mul_f32 v[150:151], v[150:151], s[52:53]
    v_exp_f32 v148, v148
    v_exp_f32 v149, v149
    v_exp_f32 v150, v150
    v_exp_f32 v151, v151
    v_max_f32 v92, 0, v92
    v_max_f32 v93, 0, v93
    v_max_f32 v94, 0, v94
    v_max_f32 v95, 0, v95
    v_pk_add_f32 v[92:93], v[92:93], v[148:149]
    v_pk_add_f32 v[94:95], v[94:95], v[150:151]
    v_pk_add_f32 v[92:93], v[92:93], s[54:55]
    v_pk_add_f32 v[94:95], v[94:95], s[54:55]
    v_min_f32 v148, 0, v100
    v_min_f32 v149, 0, v101
    v_pk_mul_f32 v[148:149], v[148:149], s[52:53]
    v_min_f32 v150, 0, v102
    v_min_f32 v151, 0, v103
    v_pk_mul_f32 v[150:151], v[150:151], s[52:53]
    v_exp_f32 v148, v148
    v_exp_f32 v149, v149
    v_exp_f32 v150, v150
    v_exp_f32 v151, v151
    v_max_f32 v100, 0, v100
    v_max_f32 v101, 0, v101
    v_max_f32 v102, 0, v102
    v_max_f32 v103, 0, v103
    v_pk_add_f32 v[100:101], v[100:101], v[148:149]
    v_pk_add_f32 v[102:103], v[102:103], v[150:151]
    v_pk_add_f32 v[100:101], v[100:101], s[54:55]
    v_pk_add_f32 v[102:103], v[102:103], s[54:55]
    v_cvt_pk_bf16_f32 v60, v92, v93
    v_cvt_pk_bf16_f32 v61, v94, v95
    v_cvt_pk_bf16_f32 v62, v100, v101
    v_cvt_pk_bf16_f32 v63, v102, v103
    buffer_store_dwordx4 v[60:63], v12, s[8:11], s25 offen sc1
    s_branch interleave_layers__linear_attn_block__memory_aug_recurrent_mem_tr__prompt_kernel_k1_ej
interleave_layers__linear_attn_block__memory_aug_recurrent_mem_tr__prompt_kernel_k1_e2:
    s_cmp_eq_u32 s3, 3
    s_cbranch_scc1 interleave_layers__linear_attn_block__memory_aug_recurrent_mem_tr__prompt_kernel_k1_e3
    v_cvt_pk_bf16_f32 v68, v112, v113
    v_cvt_pk_bf16_f32 v69, v114, v115
    ds_write_b64 v10, v[68:69] offset:288
    v_cvt_pk_bf16_f32 v70, v116, v117
    v_cvt_pk_bf16_f32 v71, v118, v119
    ds_write_b64 v10, v[70:71] offset:5664
    v_min_f32 v148, 0, v96
    v_min_f32 v149, 0, v97
    v_pk_mul_f32 v[148:149], v[148:149], s[52:53]
    v_min_f32 v150, 0, v98
    v_min_f32 v151, 0, v99
    v_pk_mul_f32 v[150:151], v[150:151], s[52:53]
    v_exp_f32 v148, v148
    v_exp_f32 v149, v149
    v_exp_f32 v150, v150
    v_exp_f32 v151, v151
    v_max_f32 v96, 0, v96
    v_max_f32 v97, 0, v97
    v_max_f32 v98, 0, v98
    v_max_f32 v99, 0, v99
    v_pk_add_f32 v[96:97], v[96:97], v[148:149]
    v_pk_add_f32 v[98:99], v[98:99], v[150:151]
    v_pk_add_f32 v[96:97], v[96:97], s[54:55]
    v_pk_add_f32 v[98:99], v[98:99], s[54:55]
    v_min_f32 v148, 0, v104
    v_min_f32 v149, 0, v105
    v_pk_mul_f32 v[148:149], v[148:149], s[52:53]
    v_min_f32 v150, 0, v106
    v_min_f32 v151, 0, v107
    v_pk_mul_f32 v[150:151], v[150:151], s[52:53]
    v_exp_f32 v148, v148
    v_exp_f32 v149, v149
    v_exp_f32 v150, v150
    v_exp_f32 v151, v151
    v_max_f32 v104, 0, v104
    v_max_f32 v105, 0, v105
    v_max_f32 v106, 0, v106
    v_max_f32 v107, 0, v107
    v_pk_add_f32 v[104:105], v[104:105], v[148:149]
    v_pk_add_f32 v[106:107], v[106:107], v[150:151]
    v_pk_add_f32 v[104:105], v[104:105], s[54:55]
    v_pk_add_f32 v[106:107], v[106:107], s[54:55]
    v_min_f32 v148, 0, v100
    v_min_f32 v149, 0, v101
    v_pk_mul_f32 v[148:149], v[148:149], s[52:53]
    v_min_f32 v150, 0, v102
    v_min_f32 v151, 0, v103
    v_pk_mul_f32 v[150:151], v[150:151], s[52:53]
    v_exp_f32 v148, v148
    v_exp_f32 v149, v149
    v_exp_f32 v150, v150
    v_exp_f32 v151, v151
    v_max_f32 v100, 0, v100
    v_max_f32 v101, 0, v101
    v_max_f32 v102, 0, v102
    v_max_f32 v103, 0, v103
    v_pk_add_f32 v[100:101], v[100:101], v[148:149]
    v_pk_add_f32 v[102:103], v[102:103], v[150:151]
    v_pk_add_f32 v[100:101], v[100:101], s[54:55]
    v_pk_add_f32 v[102:103], v[102:103], s[54:55]
    v_min_f32 v148, 0, v108
    v_min_f32 v149, 0, v109
    v_pk_mul_f32 v[148:149], v[148:149], s[52:53]
    v_min_f32 v150, 0, v110
    v_min_f32 v151, 0, v111
    v_pk_mul_f32 v[150:151], v[150:151], s[52:53]
    v_exp_f32 v148, v148
    v_exp_f32 v149, v149
    v_exp_f32 v150, v150
    v_exp_f32 v151, v151
    v_max_f32 v108, 0, v108
    v_max_f32 v109, 0, v109
    v_max_f32 v110, 0, v110
    v_max_f32 v111, 0, v111
    v_pk_add_f32 v[108:109], v[108:109], v[148:149]
    v_pk_add_f32 v[110:111], v[110:111], v[150:151]
    v_pk_add_f32 v[108:109], v[108:109], s[54:55]
    v_pk_add_f32 v[110:111], v[110:111], s[54:55]
    v_cvt_pk_bf16_f32 v60, v96, v97
    v_cvt_pk_bf16_f32 v61, v98, v99
    ds_write_b64 v10, v[60:61] offset:0
    v_cvt_pk_bf16_f32 v62, v100, v101
    v_cvt_pk_bf16_f32 v63, v102, v103
    ds_write_b64 v10, v[62:63] offset:5376
    v_cvt_pk_bf16_f32 v64, v104, v105
    v_cvt_pk_bf16_f32 v65, v106, v107
    ds_write_b64 v10, v[64:65] offset:32
    v_cvt_pk_bf16_f32 v66, v108, v109
    v_cvt_pk_bf16_f32 v67, v110, v111
    ds_write_b64 v10, v[66:67] offset:5408
    v_min_f32 v148, 0, v88
    v_min_f32 v149, 0, v89
    v_pk_mul_f32 v[148:149], v[148:149], s[52:53]
    v_min_f32 v150, 0, v90
    v_min_f32 v151, 0, v91
    v_pk_mul_f32 v[150:151], v[150:151], s[52:53]
    v_exp_f32 v148, v148
    v_exp_f32 v149, v149
    v_exp_f32 v150, v150
    v_exp_f32 v151, v151
    v_max_f32 v88, 0, v88
    v_max_f32 v89, 0, v89
    v_max_f32 v90, 0, v90
    v_max_f32 v91, 0, v91
    v_pk_add_f32 v[88:89], v[88:89], v[148:149]
    v_pk_add_f32 v[90:91], v[90:91], v[150:151]
    v_pk_add_f32 v[88:89], v[88:89], s[54:55]
    v_pk_add_f32 v[90:91], v[90:91], s[54:55]
    v_cvt_pk_bf16_f32 v56, v88, v89
    v_cvt_pk_bf16_f32 v57, v90, v91
    buffer_store_dwordx2 v[56:57], v12, s[8:11], s43 offen sc1
    v_min_f32 v148, 0, v92
    v_min_f32 v149, 0, v93
    v_pk_mul_f32 v[148:149], v[148:149], s[52:53]
    v_min_f32 v150, 0, v94
    v_min_f32 v151, 0, v95
    v_pk_mul_f32 v[150:151], v[150:151], s[52:53]
    v_exp_f32 v148, v148
    v_exp_f32 v149, v149
    v_exp_f32 v150, v150
    v_exp_f32 v151, v151
    v_max_f32 v92, 0, v92
    v_max_f32 v93, 0, v93
    v_max_f32 v94, 0, v94
    v_max_f32 v95, 0, v95
    v_pk_add_f32 v[92:93], v[92:93], v[148:149]
    v_pk_add_f32 v[94:95], v[94:95], v[150:151]
    v_pk_add_f32 v[92:93], v[92:93], s[54:55]
    v_pk_add_f32 v[94:95], v[94:95], s[54:55]
    v_cvt_pk_bf16_f32 v58, v92, v93
    v_cvt_pk_bf16_f32 v59, v94, v95
    buffer_store_dwordx2 v[58:59], v12, s[8:11], s25 offen sc1
    s_branch interleave_layers__linear_attn_block__memory_aug_recurrent_mem_tr__prompt_kernel_k1_ej
interleave_layers__linear_attn_block__memory_aug_recurrent_mem_tr__prompt_kernel_k1_e3:
    v_min_f32 v148, 0, v88
    v_min_f32 v149, 0, v89
    v_pk_mul_f32 v[148:149], v[148:149], s[52:53]
    v_min_f32 v150, 0, v90
    v_min_f32 v151, 0, v91
    v_pk_mul_f32 v[150:151], v[150:151], s[52:53]
    v_exp_f32 v148, v148
    v_exp_f32 v149, v149
    v_exp_f32 v150, v150
    v_exp_f32 v151, v151
    v_max_f32 v88, 0, v88
    v_max_f32 v89, 0, v89
    v_max_f32 v90, 0, v90
    v_max_f32 v91, 0, v91
    v_pk_add_f32 v[88:89], v[88:89], v[148:149]
    v_pk_add_f32 v[90:91], v[90:91], v[150:151]
    v_pk_add_f32 v[88:89], v[88:89], s[54:55]
    v_pk_add_f32 v[90:91], v[90:91], s[54:55]
    v_min_f32 v148, 0, v92
    v_min_f32 v149, 0, v93
    v_pk_mul_f32 v[148:149], v[148:149], s[52:53]
    v_min_f32 v150, 0, v94
    v_min_f32 v151, 0, v95
    v_pk_mul_f32 v[150:151], v[150:151], s[52:53]
    v_exp_f32 v148, v148
    v_exp_f32 v149, v149
    v_exp_f32 v150, v150
    v_exp_f32 v151, v151
    v_max_f32 v92, 0, v92
    v_max_f32 v93, 0, v93
    v_max_f32 v94, 0, v94
    v_max_f32 v95, 0, v95
    v_pk_add_f32 v[92:93], v[92:93], v[148:149]
    v_pk_add_f32 v[94:95], v[94:95], v[150:151]
    v_pk_add_f32 v[92:93], v[92:93], s[54:55]
    v_pk_add_f32 v[94:95], v[94:95], s[54:55]
    v_cvt_pk_bf16_f32 v56, v88, v89
    v_cvt_pk_bf16_f32 v57, v90, v91
    ds_write_b64 v10, v[56:57] offset:64
    v_cvt_pk_bf16_f32 v58, v92, v93
    v_cvt_pk_bf16_f32 v59, v94, v95
    ds_write_b64 v10, v[58:59] offset:5440
    v_min_f32 v148, 0, v96
    v_min_f32 v149, 0, v97
    v_pk_mul_f32 v[148:149], v[148:149], s[52:53]
    v_min_f32 v150, 0, v98
    v_min_f32 v151, 0, v99
    v_pk_mul_f32 v[150:151], v[150:151], s[52:53]
    v_exp_f32 v148, v148
    v_exp_f32 v149, v149
    v_exp_f32 v150, v150
    v_exp_f32 v151, v151
    v_max_f32 v96, 0, v96
    v_max_f32 v97, 0, v97
    v_max_f32 v98, 0, v98
    v_max_f32 v99, 0, v99
    v_pk_add_f32 v[96:97], v[96:97], v[148:149]
    v_pk_add_f32 v[98:99], v[98:99], v[150:151]
    v_pk_add_f32 v[96:97], v[96:97], s[54:55]
    v_pk_add_f32 v[98:99], v[98:99], s[54:55]
    v_min_f32 v148, 0, v100
    v_min_f32 v149, 0, v101
    v_pk_mul_f32 v[148:149], v[148:149], s[52:53]
    v_min_f32 v150, 0, v102
    v_min_f32 v151, 0, v103
    v_pk_mul_f32 v[150:151], v[150:151], s[52:53]
    v_exp_f32 v148, v148
    v_exp_f32 v149, v149
    v_exp_f32 v150, v150
    v_exp_f32 v151, v151
    v_max_f32 v100, 0, v100
    v_max_f32 v101, 0, v101
    v_max_f32 v102, 0, v102
    v_max_f32 v103, 0, v103
    v_pk_add_f32 v[100:101], v[100:101], v[148:149]
    v_pk_add_f32 v[102:103], v[102:103], v[150:151]
    v_pk_add_f32 v[100:101], v[100:101], s[54:55]
    v_pk_add_f32 v[102:103], v[102:103], s[54:55]
    v_cvt_pk_bf16_f32 v60, v96, v97
    v_cvt_pk_bf16_f32 v61, v98, v99
    ds_write_b64 v10, v[60:61] offset:96
    v_cvt_pk_bf16_f32 v62, v100, v101
    v_cvt_pk_bf16_f32 v63, v102, v103
    ds_write_b64 v10, v[62:63] offset:5472
    v_min_f32 v148, 0, v104
    v_min_f32 v149, 0, v105
    v_pk_mul_f32 v[148:149], v[148:149], s[52:53]
    v_min_f32 v150, 0, v106
    v_min_f32 v151, 0, v107
    v_pk_mul_f32 v[150:151], v[150:151], s[52:53]
    v_exp_f32 v148, v148
    v_exp_f32 v149, v149
    v_exp_f32 v150, v150
    v_exp_f32 v151, v151
    v_max_f32 v104, 0, v104
    v_max_f32 v105, 0, v105
    v_max_f32 v106, 0, v106
    v_max_f32 v107, 0, v107
    v_pk_add_f32 v[104:105], v[104:105], v[148:149]
    v_pk_add_f32 v[106:107], v[106:107], v[150:151]
    v_pk_add_f32 v[104:105], v[104:105], s[54:55]
    v_pk_add_f32 v[106:107], v[106:107], s[54:55]
    v_min_f32 v148, 0, v108
    v_min_f32 v149, 0, v109
    v_pk_mul_f32 v[148:149], v[148:149], s[52:53]
    v_min_f32 v150, 0, v110
    v_min_f32 v151, 0, v111
    v_pk_mul_f32 v[150:151], v[150:151], s[52:53]
    v_exp_f32 v148, v148
    v_exp_f32 v149, v149
    v_exp_f32 v150, v150
    v_exp_f32 v151, v151
    v_max_f32 v108, 0, v108
    v_max_f32 v109, 0, v109
    v_max_f32 v110, 0, v110
    v_max_f32 v111, 0, v111
    v_pk_add_f32 v[108:109], v[108:109], v[148:149]
    v_pk_add_f32 v[110:111], v[110:111], v[150:151]
    v_pk_add_f32 v[108:109], v[108:109], s[54:55]
    v_pk_add_f32 v[110:111], v[110:111], s[54:55]
    v_cvt_pk_bf16_f32 v64, v104, v105
    v_cvt_pk_bf16_f32 v65, v106, v107
    ds_write_b64 v10, v[64:65] offset:128
    v_cvt_pk_bf16_f32 v66, v108, v109
    v_cvt_pk_bf16_f32 v67, v110, v111
    ds_write_b64 v10, v[66:67] offset:5504
interleave_layers__linear_attn_block__memory_aug_recurrent_mem_tr__prompt_kernel_k1_ej:
    s_waitcnt lgkmcnt(0)
    s_barrier
    ds_read_b64_tr_b16 v[72:73], v11 offset:0
    ds_read_b64_tr_b16 v[74:75], v11 offset:1344
    ds_read_b64_tr_b16 v[76:77], v11 offset:32
    ds_read_b64_tr_b16 v[78:79], v11 offset:1376
    ds_read_b64_tr_b16 v[80:81], v11 offset:160
    ds_read_b64_tr_b16 v[82:83], v11 offset:1504
    ds_read_b64_tr_b16 v[84:85], v11 offset:192
    ds_read_b64_tr_b16 v[86:87], v11 offset:1536
    s_waitcnt lgkmcnt(0)
    v_mfma_f32_16x16x32_bf16 v[120:123], v[72:75], v[84:87], v[120:123]
    v_mfma_f32_16x16x32_bf16 v[124:127], v[76:79], v[80:83], v[124:127]
    v_mfma_f32_16x16x32_bf16 v[128:131], v[76:79], v[84:87], v[128:131]
    v_mfma_f32_16x16x32_bf16 v[132:135], v[76:79], v[172:175], v[132:135]
    v_mfma_f32_16x16x32_bf16 v[136:139], v[72:75], v[80:83], v[136:139]
    v_mfma_f32_16x16x32_bf16 v[140:143], v[72:75], v[172:175], v[140:143]
    s_add_u32 s43, s43, s42
    s_add_u32 s48, s48, s49
    s_sub_u32 s40, s40, 1
    s_cmp_gt_u32 s40, 0
    s_cbranch_scc1 interleave_layers__linear_attn_block__memory_aug_recurrent_mem_tr__prompt_kernel_k1_seg
    s_mul_i32 s24, s45, 147456
    s_mul_i32 s25, s44, 18432
    s_add_u32 s24, s24, s25
    s_add_u32 s24, s24, 16777216
    s_mul_i32 s25, s3, 3072
    s_add_u32 s25, s25, s24
    s_lshl_b32 s26, s3, 10
    s_add_u32 s26, s26, s24
    s_add_u32 s26, s26, 13312
    s_cmp_eq_u32 s3, 0
    s_cselect_b32 s27, 0, 2146435072
    s_add_u32 s27, s27, s24
    s_add_u32 s28, s27, 17408
    s_add_u32 s27, s27, 12288
    buffer_store_dwordx4 v[120:123], v7, s[8:11], s25 offen offset:0 sc1
    buffer_store_dwordx4 v[124:127], v7, s[8:11], s25 offen offset:1024 sc1
    buffer_store_dwordx4 v[128:131], v7, s[8:11], s25 offen offset:2048 sc1
    buffer_store_dwordx4 v[132:135], v7, s[8:11], s26 offen sc1
    buffer_store_dwordx4 v[136:139], v7, s[8:11], s27 offen sc1
    buffer_store_dwordx4 v[140:143], v7, s[8:11], s28 offen sc1
    s_waitcnt vmcnt(0)
    s_barrier
    s_lshl_b32 s24, s92, 3
    s_add_u32 s24, s24, s44
    s_lshl_b32 s24, s24, 7
    s_lshl_b32 s25, s45, 2
    s_add_u32 s24, s24, s25
    s_add_u32 s24, s24, 23101440
    s_cmp_eq_u32 s3, 0
    s_cbranch_scc0 interleave_layers__linear_attn_block__memory_aug_recurrent_mem_tr__prompt_kernel_pb8
    v_lshlrev_b32 v14, 7, v1
    v_add_u32 v14, s24, v14
    v_mov_b32 v15, 2146435072
    v_cmp_le_u32 vcc, 1, v1
    s_nop 1
    v_cndmask_b32 v14, v14, v15, vcc
    v_mov_b32 v15, 1
    buffer_store_dword v15, v14, s[8:11], 0 offen sc1
interleave_layers__linear_attn_block__memory_aug_recurrent_mem_tr__prompt_kernel_pb8:
    s_cmp_eq_u32 s92, 0
    s_cbranch_scc0 interleave_layers__linear_attn_block__memory_aug_recurrent_mem_tr__prompt_kernel_end
    s_cmp_ge_u32 s2, 232
    s_cbranch_scc1 interleave_layers__linear_attn_block__memory_aug_recurrent_mem_tr__prompt_kernel_helper
    s_cmp_ge_u32 s2, 200
    s_cbranch_scc1 interleave_layers__linear_attn_block__memory_aug_recurrent_mem_tr__prompt_kernel_toO
    s_cmp_ge_u32 s2, 104
    s_cbranch_scc1 interleave_layers__linear_attn_block__memory_aug_recurrent_mem_tr__prompt_kernel_toP
    s_cmp_ge_u32 s2, 64
    s_cbranch_scc1 interleave_layers__linear_attn_block__memory_aug_recurrent_mem_tr__prompt_kernel_toR
    s_cmp_ge_u32 s2, 32
    s_cbranch_scc1 interleave_layers__linear_attn_block__memory_aug_recurrent_mem_tr__prompt_kernel_toV
    s_branch interleave_layers__linear_attn_block__memory_aug_recurrent_mem_tr__prompt_kernel_roleS
interleave_layers__linear_attn_block__memory_aug_recurrent_mem_tr__prompt_kernel_toV:
    s_branch interleave_layers__linear_attn_block__memory_aug_recurrent_mem_tr__prompt_kernel_roleV
interleave_layers__linear_attn_block__memory_aug_recurrent_mem_tr__prompt_kernel_toR:
    s_branch interleave_layers__linear_attn_block__memory_aug_recurrent_mem_tr__prompt_kernel_roleR
interleave_layers__linear_attn_block__memory_aug_recurrent_mem_tr__prompt_kernel_toP:
    s_branch interleave_layers__linear_attn_block__memory_aug_recurrent_mem_tr__prompt_kernel_roleP
interleave_layers__linear_attn_block__memory_aug_recurrent_mem_tr__prompt_kernel_toO:
    s_branch interleave_layers__linear_attn_block__memory_aug_recurrent_mem_tr__prompt_kernel_roleO
interleave_layers__linear_attn_block__memory_aug_recurrent_mem_tr__prompt_kernel_helper:
    s_sub_u32 s24, s2, 232
    s_cmp_ge_u32 s24, 21
    s_cbranch_scc1 interleave_layers__linear_attn_block__memory_aug_recurrent_mem_tr__prompt_kernel_helper_clr
    s_cmp_eq_u32 s24, 15
    s_cbranch_scc1 interleave_layers__linear_attn_block__memory_aug_recurrent_mem_tr__prompt_kernel_helper_k1
    s_mul_i32 s57, s24, 52
    s_lshr_b32 s57, s57, 8
    s_mul_i32 s56, s57, 5
    s_sub_u32 s56, s24, s56
    s_add_u32 s57, s57, 1
    s_sub_u32 s25, s24, 16
    s_cmp_ge_u32 s24, 16
    s_cselect_b32 s56, s25, s56
    s_cselect_b32 s57, 0, s57
    s_mul_i32 s78, s57, 5
    s_add_u32 s78, s78, s56
    s_load_dwordx2 s[6:7], s[0:1], 16
    v_lshrrev_b32 v12, 4, v0
    v_mul_u32_u24 v12, 1280, v12
    v_and_b32 v13, 15, v0
    v_lshl_add_u32 v12, v13, 4, v12
    s_waitcnt lgkmcnt(0)
    s_mov_b32 s12, s6
    s_mov_b32 s13, s7
    s_mov_b32 s14, 819200
    s_mov_b32 s15, 0x00020000
    s_lshl_b32 s52, s56, 8
    s_add_u32 s24, s52, 0
    buffer_load_dwordx4 a[0:3], v12, s[12:15], s24 offen
    s_add_u32 s24, s52, 20480
    buffer_load_dwordx4 a[4:7], v12, s[12:15], s24 offen
    s_add_u32 s24, s52, 40960
    buffer_load_dwordx4 a[8:11], v12, s[12:15], s24 offen
    s_add_u32 s24, s52, 61440
    buffer_load_dwordx4 a[12:15], v12, s[12:15], s24 offen
    s_add_u32 s24, s52, 81920
    buffer_load_dwordx4 a[16:19], v12, s[12:15], s24 offen
    s_add_u32 s24, s52, 102400
    buffer_load_dwordx4 a[20:23], v12, s[12:15], s24 offen
    s_add_u32 s24, s52, 122880
    buffer_load_dwordx4 a[24:27], v12, s[12:15], s24 offen
    s_add_u32 s24, s52, 143360
    buffer_load_dwordx4 a[28:31], v12, s[12:15], s24 offen
    s_add_u32 s24, s52, 163840
    buffer_load_dwordx4 a[32:35], v12, s[12:15], s24 offen
    s_add_u32 s24, s52, 184320
    buffer_load_dwordx4 a[36:39], v12, s[12:15], s24 offen
    s_add_u32 s24, s52, 204800
    buffer_load_dwordx4 a[40:43], v12, s[12:15], s24 offen
    s_add_u32 s24, s52, 225280
    buffer_load_dwordx4 a[44:47], v12, s[12:15], s24 offen
    s_add_u32 s24, s52, 245760
    buffer_load_dwordx4 a[48:51], v12, s[12:15], s24 offen
    s_add_u32 s24, s52, 266240
    buffer_load_dwordx4 a[52:55], v12, s[12:15], s24 offen
    s_add_u32 s24, s52, 286720
    buffer_load_dwordx4 a[56:59], v12, s[12:15], s24 offen
    s_add_u32 s24, s52, 307200
    buffer_load_dwordx4 a[60:63], v12, s[12:15], s24 offen
    s_add_u32 s24, s52, 327680
    buffer_load_dwordx4 a[64:67], v12, s[12:15], s24 offen
    s_add_u32 s24, s52, 348160
    buffer_load_dwordx4 a[68:71], v12, s[12:15], s24 offen
    s_add_u32 s24, s52, 368640
    buffer_load_dwordx4 a[72:75], v12, s[12:15], s24 offen
    s_add_u32 s24, s52, 389120
    buffer_load_dwordx4 a[76:79], v12, s[12:15], s24 offen
    s_add_u32 s24, s52, 409600
    buffer_load_dwordx4 a[80:83], v12, s[12:15], s24 offen
    s_add_u32 s24, s52, 430080
    buffer_load_dwordx4 a[84:87], v12, s[12:15], s24 offen
    s_add_u32 s24, s52, 450560
    buffer_load_dwordx4 a[88:91], v12, s[12:15], s24 offen
    s_add_u32 s24, s52, 471040
    buffer_load_dwordx4 a[92:95], v12, s[12:15], s24 offen
    s_add_u32 s24, s52, 491520
    buffer_load_dwordx4 a[96:99], v12, s[12:15], s24 offen
    s_add_u32 s24, s52, 512000
    buffer_load_dwordx4 a[100:103], v12, s[12:15], s24 offen
    s_add_u32 s24, s52, 532480
    buffer_load_dwordx4 a[104:107], v12, s[12:15], s24 offen
    s_add_u32 s24, s52, 552960
    buffer_load_dwordx4 a[108:111], v12, s[12:15], s24 offen
    s_add_u32 s24, s52, 573440
    buffer_load_dwordx4 a[112:115], v12, s[12:15], s24 offen
    s_add_u32 s24, s52, 593920
    buffer_load_dwordx4 a[116:119], v12, s[12:15], s24 offen
    s_add_u32 s24, s52, 614400
    buffer_load_dwordx4 a[120:123], v12, s[12:15], s24 offen
    s_add_u32 s24, s52, 634880
    buffer_load_dwordx4 a[124:127], v12, s[12:15], s24 offen
    s_add_u32 s24, s52, 655360
    buffer_load_dwordx4 a[128:131], v12, s[12:15], s24 offen
    s_add_u32 s24, s52, 675840
    buffer_load_dwordx4 a[132:135], v12, s[12:15], s24 offen
    s_add_u32 s24, s52, 696320
    buffer_load_dwordx4 a[136:139], v12, s[12:15], s24 offen
    s_add_u32 s24, s52, 716800
    buffer_load_dwordx4 a[140:143], v12, s[12:15], s24 offen
    s_add_u32 s24, s52, 737280
    buffer_load_dwordx4 a[144:147], v12, s[12:15], s24 offen
    s_add_u32 s24, s52, 757760
    buffer_load_dwordx4 a[148:151], v12, s[12:15], s24 offen
    s_add_u32 s24, s52, 778240
    buffer_load_dwordx4 a[152:155], v12, s[12:15], s24 offen
    s_add_u32 s24, s52, 798720
    buffer_load_dwordx4 a[156:159], v12, s[12:15], s24 offen
    v_lshrrev_b32 v6, 4, v0
    v_mul_u32_u24 v6, 288, v6
    v_and_b32 v7, 15, v0
    v_lshl_add_u32 v6, v7, 4, v6
    v_add_u32 v6, 81920, v6
    v_lshrrev_b32 v7, 2, v2
    v_lshl_add_u32 v7, v3, 2, v7
    v_mul_u32_u24 v7, 288, v7
    v_and_b32 v8, 3, v2
    v_lshl_add_u32 v7, v8, 3, v7
    s_lshl_b32 s24, s3, 6
    s_add_u32 s24, s24, 81920
    v_add_u32 v7, s24, v7
    s_waitcnt vmcnt(36)
    ds_write_b128 v6, a[0:3] offset:0
    ds_write_b128 v6, a[4:7] offset:4608
    ds_write_b128 v6, a[8:11] offset:9216
    ds_write_b128 v6, a[12:15] offset:13824
    s_waitcnt lgkmcnt(0)
    s_barrier
    ds_read_b64_tr_b16 a[0:1], v7 offset:0
    ds_read_b64_tr_b16 a[2:3], v7 offset:4608
    ds_read_b64_tr_b16 a[4:5], v7 offset:32
    ds_read_b64_tr_b16 a[6:7], v7 offset:4640
    ds_read_b64_tr_b16 a[8:9], v7 offset:9216
    ds_read_b64_tr_b16 a[10:11], v7 offset:13824
    ds_read_b64_tr_b16 a[12:13], v7 offset:9248
    ds_read_b64_tr_b16 a[14:15], v7 offset:13856
    s_waitcnt vmcnt(32)
    ds_write_b128 v6, a[16:19] offset:18432
    ds_write_b128 v6, a[20:23] offset:23040
    ds_write_b128 v6, a[24:27] offset:27648
    ds_write_b128 v6, a[28:31] offset:32256
    s_waitcnt lgkmcnt(0)
    s_barrier
    ds_read_b64_tr_b16 a[16:17], v7 offset:18432
    ds_read_b64_tr_b16 a[18:19], v7 offset:23040
    ds_read_b64_tr_b16 a[20:21], v7 offset:18464
    ds_read_b64_tr_b16 a[22:23], v7 offset:23072
    ds_read_b64_tr_b16 a[24:25], v7 offset:27648
    ds_read_b64_tr_b16 a[26:27], v7 offset:32256
    ds_read_b64_tr_b16 a[28:29], v7 offset:27680
    ds_read_b64_tr_b16 a[30:31], v7 offset:32288
    s_waitcnt vmcnt(28)
    ds_write_b128 v6, a[32:35] offset:0
    ds_write_b128 v6, a[36:39] offset:4608
    ds_write_b128 v6, a[40:43] offset:9216
    ds_write_b128 v6, a[44:47] offset:13824
    s_waitcnt lgkmcnt(0)
    s_barrier
    ds_read_b64_tr_b16 a[32:33], v7 offset:0
    ds_read_b64_tr_b16 a[34:35], v7 offset:4608
    ds_read_b64_tr_b16 a[36:37], v7 offset:32
    ds_read_b64_tr_b16 a[38:39], v7 offset:4640
    ds_read_b64_tr_b16 a[40:41], v7 offset:9216
    ds_read_b64_tr_b16 a[42:43], v7 offset:13824
    ds_read_b64_tr_b16 a[44:45], v7 offset:9248
    ds_read_b64_tr_b16 a[46:47], v7 offset:13856
    s_waitcnt vmcnt(24)
    ds_write_b128 v6, a[48:51] offset:18432
    ds_write_b128 v6, a[52:55] offset:23040
    ds_write_b128 v6, a[56:59] offset:27648
    ds_write_b128 v6, a[60:63] offset:32256
    s_waitcnt lgkmcnt(0)
    s_barrier
    ds_read_b64_tr_b16 a[48:49], v7 offset:18432
    ds_read_b64_tr_b16 a[50:51], v7 offset:23040
    ds_read_b64_tr_b16 a[52:53], v7 offset:18464
    ds_read_b64_tr_b16 a[54:55], v7 offset:23072
    ds_read_b64_tr_b16 a[56:57], v7 offset:27648
    ds_read_b64_tr_b16 a[58:59], v7 offset:32256
    ds_read_b64_tr_b16 a[60:61], v7 offset:27680
    ds_read_b64_tr_b16 a[62:63], v7 offset:32288
    s_waitcnt vmcnt(20)
    ds_write_b128 v6, a[64:67] offset:0
    ds_write_b128 v6, a[68:71] offset:4608
    ds_write_b128 v6, a[72:75] offset:9216
    ds_write_b128 v6, a[76:79] offset:13824
    s_waitcnt lgkmcnt(0)
    s_barrier
    ds_read_b64_tr_b16 a[64:65], v7 offset:0
    ds_read_b64_tr_b16 a[66:67], v7 offset:4608
    ds_read_b64_tr_b16 a[68:69], v7 offset:32
    ds_read_b64_tr_b16 a[70:71], v7 offset:4640
    ds_read_b64_tr_b16 a[72:73], v7 offset:9216
    ds_read_b64_tr_b16 a[74:75], v7 offset:13824
    ds_read_b64_tr_b16 a[76:77], v7 offset:9248
    ds_read_b64_tr_b16 a[78:79], v7 offset:13856
    s_waitcnt vmcnt(16)
    ds_write_b128 v6, a[80:83] offset:18432
    ds_write_b128 v6, a[84:87] offset:23040
    ds_write_b128 v6, a[88:91] offset:27648
    ds_write_b128 v6, a[92:95] offset:32256
    s_waitcnt lgkmcnt(0)
    s_barrier
    ds_read_b64_tr_b16 a[80:81], v7 offset:18432
    ds_read_b64_tr_b16 a[82:83], v7 offset:23040
    ds_read_b64_tr_b16 a[84:85], v7 offset:18464
    ds_read_b64_tr_b16 a[86:87], v7 offset:23072
    ds_read_b64_tr_b16 a[88:89], v7 offset:27648
    ds_read_b64_tr_b16 a[90:91], v7 offset:32256
    ds_read_b64_tr_b16 a[92:93], v7 offset:27680
    ds_read_b64_tr_b16 a[94:95], v7 offset:32288
    s_waitcnt vmcnt(12)
    ds_write_b128 v6, a[96:99] offset:0
    ds_write_b128 v6, a[100:103] offset:4608
    ds_write_b128 v6, a[104:107] offset:9216
    ds_write_b128 v6, a[108:111] offset:13824
    s_waitcnt lgkmcnt(0)
    s_barrier
    ds_read_b64_tr_b16 a[96:97], v7 offset:0
    ds_read_b64_tr_b16 a[98:99], v7 offset:4608
    ds_read_b64_tr_b16 a[100:101], v7 offset:32
    ds_read_b64_tr_b16 a[102:103], v7 offset:4640
    ds_read_b64_tr_b16 a[104:105], v7 offset:9216
    ds_read_b64_tr_b16 a[106:107], v7 offset:13824
    ds_read_b64_tr_b16 a[108:109], v7 offset:9248
    ds_read_b64_tr_b16 a[110:111], v7 offset:13856
    s_waitcnt vmcnt(8)
    ds_write_b128 v6, a[112:115] offset:18432
    ds_write_b128 v6, a[116:119] offset:23040
    ds_write_b128 v6, a[120:123] offset:27648
    ds_write_b128 v6, a[124:127] offset:32256
    s_waitcnt lgkmcnt(0)
    s_barrier
    ds_read_b64_tr_b16 a[112:113], v7 offset:18432
    ds_read_b64_tr_b16 a[114:115], v7 offset:23040
    ds_read_b64_tr_b16 a[116:117], v7 offset:18464
    ds_read_b64_tr_b16 a[118:119], v7 offset:23072
    ds_read_b64_tr_b16 a[120:121], v7 offset:27648
    ds_read_b64_tr_b16 a[122:123], v7 offset:32256
    ds_read_b64_tr_b16 a[124:125], v7 offset:27680
    ds_read_b64_tr_b16 a[126:127], v7 offset:32288
    s_waitcnt vmcnt(4)
    ds_write_b128 v6, a[128:131] offset:0
    ds_write_b128 v6, a[132:135] offset:4608
    ds_write_b128 v6, a[136:139] offset:9216
    ds_write_b128 v6, a[140:143] offset:13824
    s_waitcnt lgkmcnt(0)
    s_barrier
    ds_read_b64_tr_b16 a[128:129], v7 offset:0
    ds_read_b64_tr_b16 a[130:131], v7 offset:4608
    ds_read_b64_tr_b16 a[132:133], v7 offset:32
    ds_read_b64_tr_b16 a[134:135], v7 offset:4640
    ds_read_b64_tr_b16 a[136:137], v7 offset:9216
    ds_read_b64_tr_b16 a[138:139], v7 offset:13824
    ds_read_b64_tr_b16 a[140:141], v7 offset:9248
    ds_read_b64_tr_b16 a[142:143], v7 offset:13856
    s_waitcnt vmcnt(0)
    ds_write_b128 v6, a[144:147] offset:18432
    ds_write_b128 v6, a[148:151] offset:23040
    ds_write_b128 v6, a[152:155] offset:27648
    ds_write_b128 v6, a[156:159] offset:32256
    s_waitcnt lgkmcnt(0)
    s_barrier
    ds_read_b64_tr_b16 a[144:145], v7 offset:18432
    ds_read_b64_tr_b16 a[146:147], v7 offset:23040
    ds_read_b64_tr_b16 a[148:149], v7 offset:18464
    ds_read_b64_tr_b16 a[150:151], v7 offset:23072
    ds_read_b64_tr_b16 a[152:153], v7 offset:27648
    ds_read_b64_tr_b16 a[154:155], v7 offset:32256
    ds_read_b64_tr_b16 a[156:157], v7 offset:27680
    ds_read_b64_tr_b16 a[158:159], v7 offset:32288
    s_waitcnt lgkmcnt(0)
    s_load_dwordx2 s[6:7], s[0:1], 0
    s_waitcnt lgkmcnt(0)
    s_mov_b32 s16, s6
    s_mov_b32 s17, s7
    s_mov_b32 s18, 2621440
    s_mov_b32 s19, 0x00020000
    s_mov_b32 s46, 64
    s_mov_b32 s47, 32
    s_mov_b32 s50, 0
    s_mov_b32 s58, 0
    s_mov_b32 s76, 16
    s_mov_b32 s77, 163840
interleave_layers__linear_attn_block__memory_aug_recurrent_mem_tr__prompt_kernel_k3_entry:
    v_lshlrev_b32 v5, 4, v1
    s_mul_i32 s24, s3, 5120
    s_add_u32 s24, s24, 12582912
    v_add_u32 v8, s24, v5
    v_lshlrev_b32 v9, 3, v1
    s_add_u32 s24, s24, 2048
    v_add_u32 v9, s24, v9
    s_cmp_eq_u32 s50, 1
    s_cselect_b32 s25, 16, 1280
    s_cselect_b32 s26, 256, 8
    v_mul_u32_u24 v10, s25, v2
    v_mul_u32_u24 v11, s26, v3
    s_lshl_b32 s24, s56, 2
    s_add_u32 s24, s24, s3
    s_mul_i32 s25, s24, s46
    v_add3_u32 v10, v10, v11, s25
    v_add_u32 v11, s47, v10
    s_lshl_b32 s24, s24, 10
    s_add_u32 s24, s24, s58
    v_add_u32 v12, s24, v5
    s_mul_i32 s24, s3, 5120
    s_add_u32 s24, s24, 0
    v_add_u32 v13, s24, v5
    s_mov_b32 s54, 0x358637bd
    s_mul_i32 s43, s57, 40960
    s_mov_b32 s40, 0
    s_mov_b32 s42, 0
    s_cmp_eq_u32 s92, 0
    s_cselect_b32 s26, 32, 0
    s_cselect_b32 s27, 7, 1
    s_lshl_b32 s24, s92, 10
    s_add_u32 s24, s24, 23101440
    v_and_b32 v15, 7, v1
    v_lshlrev_b32 v15, 7, v15
    v_lshrrev_b32 v14, 3, v1
    v_and_b32 v14, s27, v14
    v_lshl_add_u32 v15, v14, 2, v15
    v_add_u32 v15, s24, v15
    s_lshl_b32 s27, s26, 1
    s_add_u32 s28, s27, s26
    s_mov_b32 s61, 0
interleave_layers__linear_attn_block__memory_aug_recurrent_mem_tr__prompt_kernel_k3_w0:
    buffer_load_dword v16, v15, s[8:11], 0 offen sc1
    buffer_load_dword v17, v15, s[8:11], s26 offen sc1
    buffer_load_dword v18, v15, s[8:11], s27 offen sc1
    buffer_load_dword v19, v15, s[8:11], s28 offen sc1
    s_waitcnt vmcnt(0)
    v_min_i32 v16, v16, v17
    v_min3_i32 v16, v16, v18, v19
    v_cmp_le_i32 vcc, 1, v16
    s_cmp_eq_u64 vcc, -1
    s_cbranch_scc1 interleave_layers__linear_attn_block__memory_aug_recurrent_mem_tr__prompt_kernel_k3_w0_ok
    s_add_u32 s61, s61, 1
    s_cmp_ge_u32 s61, s60
    s_cbranch_scc1 interleave_layers__linear_attn_block__memory_aug_recurrent_mem_tr__prompt_kernel_k3_w0_to
    s_sleep 4
    s_branch interleave_layers__linear_attn_block__memory_aug_recurrent_mem_tr__prompt_kernel_k3_w0
interleave_layers__linear_attn_block__memory_aug_recurrent_mem_tr__prompt_kernel_k3_w0_to:
    s_mov_b32 s60, 1
interleave_layers__linear_attn_block__memory_aug_recurrent_mem_tr__prompt_kernel_k3_w0_ok:
    s_mov_b32 s41, s43
    s_add_u32 s25, s41, 20480
    buffer_load_dwordx4 v[16:19], v8, s[8:11], s41 offen offset:0 sc1
    buffer_load_dwordx4 v[20:23], v8, s[8:11], s41 offen offset:1024 sc1
    buffer_load_dwordx2 v[24:25], v9, s[8:11], s41 offen offset:0 sc1
    buffer_load_dwordx4 v[26:29], v8, s[8:11], s41 offen offset:2560 sc1
    buffer_load_dwordx4 v[30:33], v8, s[8:11], s41 offen offset:3584 sc1
    buffer_load_dwordx2 v[34:35], v9, s[8:11], s41 offen offset:2560 sc1
    buffer_load_dwordx4 v[36:39], v8, s[8:11], s25 offen offset:0 sc1
    buffer_load_dwordx4 v[40:43], v8, s[8:11], s25 offen offset:1024 sc1
    buffer_load_dwordx2 v[44:45], v9, s[8:11], s25 offen offset:0 sc1
    buffer_load_dwordx4 v[46:49], v8, s[8:11], s25 offen offset:2560 sc1
    buffer_load_dwordx4 v[50:53], v8, s[8:11], s25 offen offset:3584 sc1
    buffer_load_dwordx2 v[54:55], v9, s[8:11], s25 offen offset:2560 sc1
    buffer_load_dwordx2 v[96:97], v10, s[16:19], s41 offen sc1
    buffer_load_dwordx2 v[98:99], v11, s[16:19], s41 offen sc1
    buffer_load_dwordx2 v[100:101], v10, s[16:19], s25 offen sc1
    buffer_load_dwordx2 v[102:103], v11, s[16:19], s25 offen sc1
    s_add_u32 s41, s43, s77
    s_add_u32 s25, s41, 20480
    buffer_load_dwordx4 v[56:59], v8, s[8:11], s41 offen offset:0 sc1
    buffer_load_dwordx4 v[60:63], v8, s[8:11], s41 offen offset:1024 sc1
    buffer_load_dwordx2 v[64:65], v9, s[8:11], s41 offen offset:0 sc1
    buffer_load_dwordx4 v[66:69], v8, s[8:11], s41 offen offset:2560 sc1
    buffer_load_dwordx4 v[70:73], v8, s[8:11], s41 offen offset:3584 sc1
    buffer_load_dwordx2 v[74:75], v9, s[8:11], s41 offen offset:2560 sc1
    buffer_load_dwordx4 v[76:79], v8, s[8:11], s25 offen offset:0 sc1
    buffer_load_dwordx4 v[80:83], v8, s[8:11], s25 offen offset:1024 sc1
    buffer_load_dwordx2 v[84:85], v9, s[8:11], s25 offen offset:0 sc1
    buffer_load_dwordx4 v[86:89], v8, s[8:11], s25 offen offset:2560 sc1
    buffer_load_dwordx4 v[90:93], v8, s[8:11], s25 offen offset:3584 sc1
    buffer_load_dwordx2 v[94:95], v9, s[8:11], s25 offen offset:2560 sc1
    buffer_load_dwordx2 v[104:105], v10, s[16:19], s41 offen sc1
    buffer_load_dwordx2 v[106:107], v11, s[16:19], s41 offen sc1
    buffer_load_dwordx2 v[108:109], v10, s[16:19], s25 offen sc1
    buffer_load_dwordx2 v[110:111], v11, s[16:19], s25 offen sc1
    s_lshl_b32 s24, s92, 7
    s_add_u32 s24, s24, 23103488
    v_lshlrev_b32 v15, 2, v1
    v_add_u32 v15, s24, v15
    s_mov_b32 s61, 0
interleave_layers__linear_attn_block__memory_aug_recurrent_mem_tr__prompt_kernel_k3_w:
    buffer_load_dword v14, v15, s[8:11], 0 offen sc1
    s_waitcnt vmcnt(0)
    v_cmp_le_i32 vcc, 1, v14
    s_mov_b32 s25, 0xffffff
    s_and_b32 s24, vcc_lo, s25
    s_cmp_eq_u32 s24, s25
    s_cbranch_scc1 interleave_layers__linear_attn_block__memory_aug_recurrent_mem_tr__prompt_kernel_k3_w_ok
    s_add_u32 s61, s61, 1
    s_cmp_ge_u32 s61, s60
    s_cbranch_scc1 interleave_layers__linear_attn_block__memory_aug_recurrent_mem_tr__prompt_kernel_k3_w_to
    s_sleep 2
    s_branch interleave_layers__linear_attn_block__memory_aug_recurrent_mem_tr__prompt_kernel_k3_w
interleave_layers__linear_attn_block__memory_aug_recurrent_mem_tr__prompt_kernel_k3_w_to:
    s_mov_b32 s60, 1
interleave_layers__linear_attn_block__memory_aug_recurrent_mem_tr__prompt_kernel_k3_w_ok:
    s_mul_i32 s24, s92, 131072
    s_mul_i32 s25, s3, 28672
    s_add_u32 s24, s24, s25
    s_add_u32 s24, s24, 22020096
    s_add_u32 s25, s24, 0
    buffer_load_dwordx4 a[160:163], v5, s[8:11], s25 offen sc1
    s_add_u32 s25, s24, 1024
    buffer_load_dwordx4 a[164:167], v5, s[8:11], s25 offen sc1
    s_add_u32 s25, s24, 2048
    buffer_load_dwordx4 a[168:171], v5, s[8:11], s25 offen sc1
    s_add_u32 s25, s24, 3072
    buffer_load_dwordx4 a[172:175], v5, s[8:11], s25 offen sc1
    s_add_u32 s25, s24, 4096
    buffer_load_dwordx4 a[176:179], v5, s[8:11], s25 offen sc1
    s_add_u32 s25, s24, 5120
    buffer_load_dwordx4 a[180:183], v5, s[8:11], s25 offen sc1
    s_add_u32 s25, s24, 6144
    buffer_load_dwordx2 a[184:185], v5, s[8:11], s25 offen sc1
    s_add_u32 s25, s24, 7168
    buffer_load_dwordx4 a[186:189], v5, s[8:11], s25 offen sc1
    s_add_u32 s25, s24, 8192
    buffer_load_dwordx2 a[190:191], v5, s[8:11], s25 offen sc1
    s_add_u32 s25, s24, 9216
    buffer_load_dwordx4 a[192:195], v5, s[8:11], s25 offen sc1
    s_add_u32 s25, s24, 10240
    buffer_load_dwordx4 a[196:199], v5, s[8:11], s25 offen sc1
    s_add_u32 s25, s24, 11264
    buffer_load_dwordx2 a[200:201], v5, s[8:11], s25 offen sc1
    s_add_u32 s25, s24, 12288
    buffer_load_dwordx4 a[202:205], v5, s[8:11], s25 offen sc1
    s_add_u32 s25, s24, 13312
    buffer_load_dwordx2 a[206:207], v5, s[8:11], s25 offen sc1
    s_add_u32 s25, s24, 14336
    buffer_load_dwordx4 a[208:211], v5, s[8:11], s25 offen sc1
    s_add_u32 s25, s24, 15360
    buffer_load_dwordx4 a[212:215], v5, s[8:11], s25 offen sc1
    s_add_u32 s25, s24, 16384
    buffer_load_dwordx4 a[216:219], v5, s[8:11], s25 offen sc1
    s_add_u32 s25, s24, 17408
    buffer_load_dwordx4 a[220:223], v5, s[8:11], s25 offen sc1
    s_add_u32 s25, s24, 18432
    buffer_load_dwordx4 a[224:227], v5, s[8:11], s25 offen sc1
    s_add_u32 s25, s24, 19456
    buffer_load_dwordx4 a[228:231], v5, s[8:11], s25 offen sc1
    s_add_u32 s25, s24, 20480
    buffer_load_dwordx2 a[232:233], v5, s[8:11], s25 offen sc1
    s_add_u32 s25, s24, 21504
    buffer_load_dwordx4 a[234:237], v5, s[8:11], s25 offen sc1
    s_add_u32 s25, s24, 22528
    buffer_load_dwordx2 a[238:239], v5, s[8:11], s25 offen sc1
    s_add_u32 s25, s24, 23552
    buffer_load_dwordx4 a[240:243], v5, s[8:11], s25 offen sc1
    s_add_u32 s25, s24, 24576
    buffer_load_dwordx4 a[244:247], v5, s[8:11], s25 offen sc1
    s_add_u32 s25, s24, 25600
    buffer_load_dwordx2 a[248:249], v5, s[8:11], s25 offen sc1
    s_add_u32 s25, s24, 26624
    buffer_load_dwordx4 a[250:253], v5, s[8:11], s25 offen sc1
    s_add_u32 s25, s24, 27648
    buffer_load_dwordx2 a[254:255], v5, s[8:11], s25 offen sc1
    s_waitcnt vmcnt(0)
    v_mfma_f32_16x16x32_bf16 v[132:135], a[192:195], v[16:19], 0
    v_mfma_f32_16x16x32_bf16 v[136:139], a[202:205], v[20:23], 0
    v_mfma_f32_16x16x32_bf16 v[112:115], a[160:163], v[16:19], 0
    v_mfma_f32_16x16x32_bf16 v[116:119], a[164:167], v[16:19], 0
    v_mfma_f32_16x16x32_bf16 v[120:123], a[172:175], v[16:19], 0
    v_mfma_f32_16x16x32_bf16 v[124:127], a[180:183], v[20:23], 0
    v_mfma_f32_16x16x32_bf16 v[128:131], a[186:189], v[20:23], 0
    v_mfma_f32_16x16x32_bf16 v[132:135], a[196:199], v[20:23], v[132:135]
    v_mfma_f32_16x16x32_bf16 v[116:119], a[168:171], v[20:23], v[116:119]
    v_mfma_f32_16x16x32_bf16 v[120:123], a[176:179], v[20:23], v[120:123]
    v_mfma_f32_16x16x16_bf16 v[136:139], a[206:207], v[24:25], v[136:139]
    s_nop 0
    v_mfma_f32_16x16x16_bf16 v[124:127], a[184:185], v[24:25], v[124:127]
    v_mfma_f32_16x16x16_bf16 v[128:131], a[190:191], v[24:25], v[128:131]
    v_mfma_f32_16x16x16_bf16 v[132:135], a[200:201], v[24:25], v[132:135]
    v_mfma_f32_16x16x32_bf16 v[160:163], a[240:243], v[26:29], 0
    v_mfma_f32_16x16x32_bf16 v[164:167], a[250:253], v[30:33], 0
    v_mfma_f32_16x16x32_bf16 v[140:143], a[208:211], v[26:29], 0
    v_mfma_f32_16x16x32_bf16 v[144:147], a[212:215], v[26:29], 0
    v_mfma_f32_16x16x32_bf16 v[148:151], a[220:223], v[26:29], 0
    v_mfma_f32_16x16x32_bf16 v[152:155], a[228:231], v[30:33], 0
    v_mfma_f32_16x16x32_bf16 v[156:159], a[234:237], v[30:33], 0
    v_mfma_f32_16x16x32_bf16 v[160:163], a[244:247], v[30:33], v[160:163]
    v_mfma_f32_16x16x32_bf16 v[144:147], a[216:219], v[30:33], v[144:147]
    v_mfma_f32_16x16x32_bf16 v[148:151], a[224:227], v[30:33], v[148:151]
    v_mfma_f32_16x16x16_bf16 v[164:167], a[254:255], v[34:35], v[164:167]
    s_nop 0
    v_mfma_f32_16x16x16_bf16 v[152:155], a[232:233], v[34:35], v[152:155]
    v_mfma_f32_16x16x16_bf16 v[156:159], a[238:239], v[34:35], v[156:159]
    v_mfma_f32_16x16x16_bf16 v[160:163], a[248:249], v[34:35], v[160:163]
    v_add_f32 v132, s54, v132
    v_add_f32 v133, s54, v133
    v_add_f32 v134, s54, v134
    v_add_f32 v135, s54, v135
    v_add_f32 v136, s54, v136
    v_rcp_f32 v132, v132
    v_rcp_f32 v133, v133
    v_rcp_f32 v134, v134
    v_rcp_f32 v135, v135
    v_rcp_f32 v136, v136
    v_mul_f32 v112, v112, v132
    v_mul_f32 v113, v113, v132
    v_mul_f32 v114, v114, v132
    v_mul_f32 v115, v115, v132
    v_cvt_pk_bf16_f32 v168, v112, v113
    v_cvt_pk_bf16_f32 v169, v114, v115
    v_mul_f32 v116, v116, v133
    v_mul_f32 v117, v117, v133
    v_mul_f32 v118, v118, v133
    v_mul_f32 v119, v119, v133
    v_cvt_pk_bf16_f32 v170, v116, v117
    v_cvt_pk_bf16_f32 v171, v118, v119
    v_mul_f32 v120, v120, v134
    v_mul_f32 v121, v121, v134
    v_mul_f32 v122, v122, v134
    v_mul_f32 v123, v123, v134
    v_cvt_pk_bf16_f32 v172, v120, v121
    v_cvt_pk_bf16_f32 v173, v122, v123
    v_mul_f32 v124, v124, v135
    v_mul_f32 v125, v125, v135
    v_mul_f32 v126, v126, v135
    v_mul_f32 v127, v127, v135
    v_cvt_pk_bf16_f32 v174, v124, v125
    v_cvt_pk_bf16_f32 v175, v126, v127
    v_mul_f32 v128, v128, v136
    v_mul_f32 v129, v129, v136
    v_mul_f32 v130, v130, v136
    v_mul_f32 v131, v131, v136
    v_cvt_pk_bf16_f32 v176, v128, v129
    v_cvt_pk_bf16_f32 v177, v130, v131
    v_add_f32 v160, s54, v160
    v_add_f32 v161, s54, v161
    v_add_f32 v162, s54, v162
    v_add_f32 v163, s54, v163
    v_add_f32 v164, s54, v164
    v_rcp_f32 v160, v160
    v_rcp_f32 v161, v161
    v_rcp_f32 v162, v162
    v_rcp_f32 v163, v163
    v_rcp_f32 v164, v164
    v_mul_f32 v140, v140, v160
    v_mul_f32 v141, v141, v160
    v_mul_f32 v142, v142, v160
    v_mul_f32 v143, v143, v160
    v_cvt_pk_bf16_f32 v178, v140, v141
    v_cvt_pk_bf16_f32 v179, v142, v143
    v_mul_f32 v144, v144, v161
    v_mul_f32 v145, v145, v161
    v_mul_f32 v146, v146, v161
    v_mul_f32 v147, v147, v161
    v_cvt_pk_bf16_f32 v180, v144, v145
    v_cvt_pk_bf16_f32 v181, v146, v147
    v_mul_f32 v148, v148, v162
    v_mul_f32 v149, v149, v162
    v_mul_f32 v150, v150, v162
    v_mul_f32 v151, v151, v162
    v_cvt_pk_bf16_f32 v182, v148, v149
    v_cvt_pk_bf16_f32 v183, v150, v151
    v_mul_f32 v152, v152, v163
    v_mul_f32 v153, v153, v163
    v_mul_f32 v154, v154, v163
    v_mul_f32 v155, v155, v163
    v_cvt_pk_bf16_f32 v184, v152, v153
    v_cvt_pk_bf16_f32 v185, v154, v155
    v_mul_f32 v156, v156, v164
    v_mul_f32 v157, v157, v164
    v_mul_f32 v158, v158, v164
    v_mul_f32 v159, v159, v164
    v_cvt_pk_bf16_f32 v186, v156, v157
    v_cvt_pk_bf16_f32 v187, v158, v159
    v_mfma_f32_16x16x32_bf16 v[132:135], a[192:195], v[36:39], 0
    v_mfma_f32_16x16x32_bf16 v[136:139], a[202:205], v[40:43], 0
    v_mfma_f32_16x16x32_bf16 v[112:115], a[160:163], v[36:39], 0
    v_mfma_f32_16x16x32_bf16 v[116:119], a[164:167], v[36:39], 0
    v_mfma_f32_16x16x32_bf16 v[120:123], a[172:175], v[36:39], 0
    v_mfma_f32_16x16x32_bf16 v[124:127], a[180:183], v[40:43], 0
    v_mfma_f32_16x16x32_bf16 v[128:131], a[186:189], v[40:43], 0
    v_mfma_f32_16x16x32_bf16 v[132:135], a[196:199], v[40:43], v[132:135]
    v_mfma_f32_16x16x32_bf16 v[116:119], a[168:171], v[40:43], v[116:119]
    v_mfma_f32_16x16x32_bf16 v[120:123], a[176:179], v[40:43], v[120:123]
    v_mfma_f32_16x16x16_bf16 v[136:139], a[206:207], v[44:45], v[136:139]
    s_nop 0
    v_mfma_f32_16x16x16_bf16 v[124:127], a[184:185], v[44:45], v[124:127]
    v_mfma_f32_16x16x16_bf16 v[128:131], a[190:191], v[44:45], v[128:131]
    v_mfma_f32_16x16x16_bf16 v[132:135], a[200:201], v[44:45], v[132:135]
    v_mfma_f32_16x16x32_bf16 v[160:163], a[240:243], v[46:49], 0
    v_mfma_f32_16x16x32_bf16 v[164:167], a[250:253], v[50:53], 0
    v_mfma_f32_16x16x32_bf16 v[140:143], a[208:211], v[46:49], 0
    v_mfma_f32_16x16x32_bf16 v[144:147], a[212:215], v[46:49], 0
    v_mfma_f32_16x16x32_bf16 v[148:151], a[220:223], v[46:49], 0
    v_mfma_f32_16x16x32_bf16 v[152:155], a[228:231], v[50:53], 0
    v_mfma_f32_16x16x32_bf16 v[156:159], a[234:237], v[50:53], 0
    v_mfma_f32_16x16x32_bf16 v[160:163], a[244:247], v[50:53], v[160:163]
    v_mfma_f32_16x16x32_bf16 v[144:147], a[216:219], v[50:53], v[144:147]
    v_mfma_f32_16x16x32_bf16 v[148:151], a[224:227], v[50:53], v[148:151]
    v_mfma_f32_16x16x16_bf16 v[164:167], a[254:255], v[54:55], v[164:167]
    s_nop 0
    v_mfma_f32_16x16x16_bf16 v[152:155], a[232:233], v[54:55], v[152:155]
    v_mfma_f32_16x16x16_bf16 v[156:159], a[238:239], v[54:55], v[156:159]
    v_mfma_f32_16x16x16_bf16 v[160:163], a[248:249], v[54:55], v[160:163]
    v_add_f32 v132, s54, v132
    v_add_f32 v133, s54, v133
    v_add_f32 v134, s54, v134
    v_add_f32 v135, s54, v135
    v_add_f32 v136, s54, v136
    v_rcp_f32 v132, v132
    v_rcp_f32 v133, v133
    v_rcp_f32 v134, v134
    v_rcp_f32 v135, v135
    v_rcp_f32 v136, v136
    v_mul_f32 v112, v112, v132
    v_mul_f32 v113, v113, v132
    v_mul_f32 v114, v114, v132
    v_mul_f32 v115, v115, v132
    v_cvt_pk_bf16_f32 v188, v112, v113
    v_cvt_pk_bf16_f32 v189, v114, v115
    v_mul_f32 v116, v116, v133
    v_mul_f32 v117, v117, v133
    v_mul_f32 v118, v118, v133
    v_mul_f32 v119, v119, v133
    v_cvt_pk_bf16_f32 v190, v116, v117
    v_cvt_pk_bf16_f32 v191, v118, v119
    v_mul_f32 v120, v120, v134
    v_mul_f32 v121, v121, v134
    v_mul_f32 v122, v122, v134
    v_mul_f32 v123, v123, v134
    v_cvt_pk_bf16_f32 v192, v120, v121
    v_cvt_pk_bf16_f32 v193, v122, v123
    v_mul_f32 v124, v124, v135
    v_mul_f32 v125, v125, v135
    v_mul_f32 v126, v126, v135
    v_mul_f32 v127, v127, v135
    v_cvt_pk_bf16_f32 v194, v124, v125
    v_cvt_pk_bf16_f32 v195, v126, v127
    v_mul_f32 v128, v128, v136
    v_mul_f32 v129, v129, v136
    v_mul_f32 v130, v130, v136
    v_mul_f32 v131, v131, v136
    v_cvt_pk_bf16_f32 v196, v128, v129
    v_cvt_pk_bf16_f32 v197, v130, v131
    v_add_f32 v160, s54, v160
    v_add_f32 v161, s54, v161
    v_add_f32 v162, s54, v162
    v_add_f32 v163, s54, v163
    v_add_f32 v164, s54, v164
    v_rcp_f32 v160, v160
    v_rcp_f32 v161, v161
    v_rcp_f32 v162, v162
    v_rcp_f32 v163, v163
    v_rcp_f32 v164, v164
    v_mul_f32 v140, v140, v160
    v_mul_f32 v141, v141, v160
    v_mul_f32 v142, v142, v160
    v_mul_f32 v143, v143, v160
    v_cvt_pk_bf16_f32 v198, v140, v141
    v_cvt_pk_bf16_f32 v199, v142, v143
    v_mul_f32 v144, v144, v161
    v_mul_f32 v145, v145, v161
    v_mul_f32 v146, v146, v161
    v_mul_f32 v147, v147, v161
    v_cvt_pk_bf16_f32 v200, v144, v145
    v_cvt_pk_bf16_f32 v201, v146, v147
    v_mul_f32 v148, v148, v162
    v_mul_f32 v149, v149, v162
    v_mul_f32 v150, v150, v162
    v_mul_f32 v151, v151, v162
    v_cvt_pk_bf16_f32 v202, v148, v149
    v_cvt_pk_bf16_f32 v203, v150, v151
    v_mul_f32 v152, v152, v163
    v_mul_f32 v153, v153, v163
    v_mul_f32 v154, v154, v163
    v_mul_f32 v155, v155, v163
    v_cvt_pk_bf16_f32 v204, v152, v153
    v_cvt_pk_bf16_f32 v205, v154, v155
    v_mul_f32 v156, v156, v164
    v_mul_f32 v157, v157, v164
    v_mul_f32 v158, v158, v164
    v_mul_f32 v159, v159, v164
    v_cvt_pk_bf16_f32 v206, v156, v157
    v_cvt_pk_bf16_f32 v207, v158, v159
    v_add_u32 v14, s42, v13
    ds_write_b128 v14, v[168:171] offset:0
    ds_write_b128 v14, v[172:175] offset:1024
    ds_write_b128 v14, v[176:179] offset:2048
    ds_write_b128 v14, v[180:183] offset:3072
    ds_write_b128 v14, v[184:187] offset:4096
    ds_write_b128 v14, v[188:191] offset:20480
    ds_write_b128 v14, v[192:195] offset:21504
    ds_write_b128 v14, v[196:199] offset:22528
    ds_write_b128 v14, v[200:203] offset:23552
    ds_write_b128 v14, v[204:207] offset:24576
    s_waitcnt lgkmcnt(0)
    s_barrier
interleave_layers__linear_attn_block__memory_aug_recurrent_mem_tr__prompt_kernel_k3_seg:
    v_add_u32 v15, s42, v5
    ds_read_b128 v[208:211], v15 offset:0
    ds_read_b128 v[212:215], v15 offset:20480
    ds_read_b128 v[216:219], v15 offset:1024
    ds_read_b128 v[220:223], v15 offset:21504
    ds_read_b128 v[224:227], v15 offset:2048
    ds_read_b128 v[228:231], v15 offset:22528
    ds_read_b128 v[232:235], v15 offset:3072
    ds_read_b128 v[236:239], v15 offset:23552
    s_waitcnt lgkmcnt(6)
    v_mfma_f32_16x16x32_bf16 v[240:243], a[0:3], v[208:211], 0
    v_mfma_f32_16x16x32_bf16 v[244:247], a[4:7], v[208:211], 0
    v_mfma_f32_16x16x32_bf16 v[248:251], a[0:3], v[212:215], 0
    v_mfma_f32_16x16x32_bf16 v[252:255], a[4:7], v[212:215], 0
    ds_read_b128 v[208:211], v15 offset:4096
    ds_read_b128 v[212:215], v15 offset:24576
    s_waitcnt lgkmcnt(6)
    v_mfma_f32_16x16x32_bf16 v[240:243], a[8:11], v[216:219], v[240:243]
    v_mfma_f32_16x16x32_bf16 v[244:247], a[12:15], v[216:219], v[244:247]
    v_mfma_f32_16x16x32_bf16 v[248:251], a[8:11], v[220:223], v[248:251]
    v_mfma_f32_16x16x32_bf16 v[252:255], a[12:15], v[220:223], v[252:255]
    ds_read_b128 v[216:219], v15 offset:5120
    ds_read_b128 v[220:223], v15 offset:25600
    s_waitcnt lgkmcnt(6)
    v_mfma_f32_16x16x32_bf16 v[240:243], a[16:19], v[224:227], v[240:243]
    v_mfma_f32_16x16x32_bf16 v[244:247], a[20:23], v[224:227], v[244:247]
    v_mfma_f32_16x16x32_bf16 v[248:251], a[16:19], v[228:231], v[248:251]
    v_mfma_f32_16x16x32_bf16 v[252:255], a[20:23], v[228:231], v[252:255]
    ds_read_b128 v[224:227], v15 offset:6144
    ds_read_b128 v[228:231], v15 offset:26624
    s_waitcnt lgkmcnt(6)
    v_mfma_f32_16x16x32_bf16 v[240:243], a[24:27], v[232:235], v[240:243]
    v_mfma_f32_16x16x32_bf16 v[244:247], a[28:31], v[232:235], v[244:247]
    v_mfma_f32_16x16x32_bf16 v[248:251], a[24:27], v[236:239], v[248:251]
    v_mfma_f32_16x16x32_bf16 v[252:255], a[28:31], v[236:239], v[252:255]
    ds_read_b128 v[232:235], v15 offset:7168
    ds_read_b128 v[236:239], v15 offset:27648
    s_waitcnt lgkmcnt(6)
    v_mfma_f32_16x16x32_bf16 v[240:243], a[32:35], v[208:211], v[240:243]
    v_mfma_f32_16x16x32_bf16 v[244:247], a[36:39], v[208:211], v[244:247]
    v_mfma_f32_16x16x32_bf16 v[248:251], a[32:35], v[212:215], v[248:251]
    v_mfma_f32_16x16x32_bf16 v[252:255], a[36:39], v[212:215], v[252:255]
    ds_read_b128 v[208:211], v15 offset:8192
    ds_read_b128 v[212:215], v15 offset:28672
    s_waitcnt lgkmcnt(6)
    v_mfma_f32_16x16x32_bf16 v[240:243], a[40:43], v[216:219], v[240:243]
    v_mfma_f32_16x16x32_bf16 v[244:247], a[44:47], v[216:219], v[244:247]
    v_mfma_f32_16x16x32_bf16 v[248:251], a[40:43], v[220:223], v[248:251]
    v_mfma_f32_16x16x32_bf16 v[252:255], a[44:47], v[220:223], v[252:255]
    ds_read_b128 v[216:219], v15 offset:9216
    ds_read_b128 v[220:223], v15 offset:29696
    s_waitcnt lgkmcnt(6)
    v_mfma_f32_16x16x32_bf16 v[240:243], a[48:51], v[224:227], v[240:243]
    v_mfma_f32_16x16x32_bf16 v[244:247], a[52:55], v[224:227], v[244:247]
    v_mfma_f32_16x16x32_bf16 v[248:251], a[48:51], v[228:231], v[248:251]
    v_mfma_f32_16x16x32_bf16 v[252:255], a[52:55], v[228:231], v[252:255]
    ds_read_b128 v[224:227], v15 offset:10240
    ds_read_b128 v[228:231], v15 offset:30720
    s_waitcnt lgkmcnt(6)
    v_mfma_f32_16x16x32_bf16 v[240:243], a[56:59], v[232:235], v[240:243]
    v_mfma_f32_16x16x32_bf16 v[244:247], a[60:63], v[232:235], v[244:247]
    v_mfma_f32_16x16x32_bf16 v[248:251], a[56:59], v[236:239], v[248:251]
    v_mfma_f32_16x16x32_bf16 v[252:255], a[60:63], v[236:239], v[252:255]
    ds_read_b128 v[232:235], v15 offset:11264
    ds_read_b128 v[236:239], v15 offset:31744
    s_waitcnt lgkmcnt(6)
    v_mfma_f32_16x16x32_bf16 v[240:243], a[64:67], v[208:211], v[240:243]
    v_mfma_f32_16x16x32_bf16 v[244:247], a[68:71], v[208:211], v[244:247]
    v_mfma_f32_16x16x32_bf16 v[248:251], a[64:67], v[212:215], v[248:251]
    v_mfma_f32_16x16x32_bf16 v[252:255], a[68:71], v[212:215], v[252:255]
    ds_read_b128 v[208:211], v15 offset:12288
    ds_read_b128 v[212:215], v15 offset:32768
    s_waitcnt lgkmcnt(6)
    v_mfma_f32_16x16x32_bf16 v[240:243], a[72:75], v[216:219], v[240:243]
    v_mfma_f32_16x16x32_bf16 v[244:247], a[76:79], v[216:219], v[244:247]
    v_mfma_f32_16x16x32_bf16 v[248:251], a[72:75], v[220:223], v[248:251]
    v_mfma_f32_16x16x32_bf16 v[252:255], a[76:79], v[220:223], v[252:255]
    ds_read_b128 v[216:219], v15 offset:13312
    ds_read_b128 v[220:223], v15 offset:33792
    s_waitcnt lgkmcnt(6)
    v_mfma_f32_16x16x32_bf16 v[240:243], a[80:83], v[224:227], v[240:243]
    v_mfma_f32_16x16x32_bf16 v[244:247], a[84:87], v[224:227], v[244:247]
    v_mfma_f32_16x16x32_bf16 v[248:251], a[80:83], v[228:231], v[248:251]
    v_mfma_f32_16x16x32_bf16 v[252:255], a[84:87], v[228:231], v[252:255]
    ds_read_b128 v[224:227], v15 offset:14336
    ds_read_b128 v[228:231], v15 offset:34816
    s_waitcnt lgkmcnt(6)
    v_mfma_f32_16x16x32_bf16 v[240:243], a[88:91], v[232:235], v[240:243]
    v_mfma_f32_16x16x32_bf16 v[244:247], a[92:95], v[232:235], v[244:247]
    v_mfma_f32_16x16x32_bf16 v[248:251], a[88:91], v[236:239], v[248:251]
    v_mfma_f32_16x16x32_bf16 v[252:255], a[92:95], v[236:239], v[252:255]
    ds_read_b128 v[232:235], v15 offset:15360
    ds_read_b128 v[236:239], v15 offset:35840
    s_waitcnt lgkmcnt(6)
    v_mfma_f32_16x16x32_bf16 v[240:243], a[96:99], v[208:211], v[240:243]
    v_mfma_f32_16x16x32_bf16 v[244:247], a[100:103], v[208:211], v[244:247]
    v_mfma_f32_16x16x32_bf16 v[248:251], a[96:99], v[212:215], v[248:251]
    v_mfma_f32_16x16x32_bf16 v[252:255], a[100:103], v[212:215], v[252:255]
    ds_read_b128 v[208:211], v15 offset:16384
    ds_read_b128 v[212:215], v15 offset:36864
    s_waitcnt lgkmcnt(6)
    v_mfma_f32_16x16x32_bf16 v[240:243], a[104:107], v[216:219], v[240:243]
    v_mfma_f32_16x16x32_bf16 v[244:247], a[108:111], v[216:219], v[244:247]
    v_mfma_f32_16x16x32_bf16 v[248:251], a[104:107], v[220:223], v[248:251]
    v_mfma_f32_16x16x32_bf16 v[252:255], a[108:111], v[220:223], v[252:255]
    ds_read_b128 v[216:219], v15 offset:17408
    ds_read_b128 v[220:223], v15 offset:37888
    s_waitcnt lgkmcnt(6)
    v_mfma_f32_16x16x32_bf16 v[240:243], a[112:115], v[224:227], v[240:243]
    v_mfma_f32_16x16x32_bf16 v[244:247], a[116:119], v[224:227], v[244:247]
    v_mfma_f32_16x16x32_bf16 v[248:251], a[112:115], v[228:231], v[248:251]
    v_mfma_f32_16x16x32_bf16 v[252:255], a[116:119], v[228:231], v[252:255]
    ds_read_b128 v[224:227], v15 offset:18432
    ds_read_b128 v[228:231], v15 offset:38912
    s_waitcnt lgkmcnt(6)
    v_mfma_f32_16x16x32_bf16 v[240:243], a[120:123], v[232:235], v[240:243]
    v_mfma_f32_16x16x32_bf16 v[244:247], a[124:127], v[232:235], v[244:247]
    v_mfma_f32_16x16x32_bf16 v[248:251], a[120:123], v[236:239], v[248:251]
    v_mfma_f32_16x16x32_bf16 v[252:255], a[124:127], v[236:239], v[252:255]
    ds_read_b128 v[232:235], v15 offset:19456
    ds_read_b128 v[236:239], v15 offset:39936
    s_waitcnt lgkmcnt(6)
    v_mfma_f32_16x16x32_bf16 v[240:243], a[128:131], v[208:211], v[240:243]
    v_mfma_f32_16x16x32_bf16 v[244:247], a[132:135], v[208:211], v[244:247]
    v_mfma_f32_16x16x32_bf16 v[248:251], a[128:131], v[212:215], v[248:251]
    v_mfma_f32_16x16x32_bf16 v[252:255], a[132:135], v[212:215], v[252:255]
    s_waitcnt lgkmcnt(4)
    v_mfma_f32_16x16x32_bf16 v[240:243], a[136:139], v[216:219], v[240:243]
    v_mfma_f32_16x16x32_bf16 v[244:247], a[140:143], v[216:219], v[244:247]
    v_mfma_f32_16x16x32_bf16 v[248:251], a[136:139], v[220:223], v[248:251]
    v_mfma_f32_16x16x32_bf16 v[252:255], a[140:143], v[220:223], v[252:255]
    s_waitcnt lgkmcnt(2)
    v_mfma_f32_16x16x32_bf16 v[240:243], a[144:147], v[224:227], v[240:243]
    v_mfma_f32_16x16x32_bf16 v[244:247], a[148:151], v[224:227], v[244:247]
    v_mfma_f32_16x16x32_bf16 v[248:251], a[144:147], v[228:231], v[248:251]
    v_mfma_f32_16x16x32_bf16 v[252:255], a[148:151], v[228:231], v[252:255]
    s_waitcnt lgkmcnt(0)
    v_mfma_f32_16x16x32_bf16 v[240:243], a[152:155], v[232:235], v[240:243]
    v_mfma_f32_16x16x32_bf16 v[244:247], a[156:159], v[232:235], v[244:247]
    v_mfma_f32_16x16x32_bf16 v[248:251], a[152:155], v[236:239], v[248:251]
    v_mfma_f32_16x16x32_bf16 v[252:255], a[156:159], v[236:239], v[252:255]
    s_nop 4
    v_cvt_pk_bf16_f32 v208, v240, v241
    v_cvt_pk_bf16_f32 v209, v242, v243
    v_lshlrev_b32 v210, 16, v208
    v_and_b32 v211, 0xffff0000, v208
    v_lshlrev_b32 v212, 16, v96
    v_and_b32 v213, 0xffff0000, v96
    v_pk_add_f32 v[210:211], v[210:211], v[212:213]
    v_cvt_pk_bf16_f32 v216, v210, v211
    v_lshlrev_b32 v210, 16, v209
    v_and_b32 v211, 0xffff0000, v209
    v_lshlrev_b32 v212, 16, v97
    v_and_b32 v213, 0xffff0000, v97
    v_pk_add_f32 v[210:211], v[210:211], v[212:213]
    v_cvt_pk_bf16_f32 v217, v210, v211
    v_cvt_pk_bf16_f32 v208, v244, v245
    v_cvt_pk_bf16_f32 v209, v246, v247
    v_lshlrev_b32 v210, 16, v208
    v_and_b32 v211, 0xffff0000, v208
    v_lshlrev_b32 v212, 16, v98
    v_and_b32 v213, 0xffff0000, v98
    v_pk_add_f32 v[210:211], v[210:211], v[212:213]
    v_cvt_pk_bf16_f32 v218, v210, v211
    v_lshlrev_b32 v210, 16, v209
    v_and_b32 v211, 0xffff0000, v209
    v_lshlrev_b32 v212, 16, v99
    v_and_b32 v213, 0xffff0000, v99
    v_pk_add_f32 v[210:211], v[210:211], v[212:213]
    v_cvt_pk_bf16_f32 v219, v210, v211
    v_cvt_pk_bf16_f32 v208, v248, v249
    v_cvt_pk_bf16_f32 v209, v250, v251
    v_lshlrev_b32 v210, 16, v208
    v_and_b32 v211, 0xffff0000, v208
    v_lshlrev_b32 v212, 16, v100
    v_and_b32 v213, 0xffff0000, v100
    v_pk_add_f32 v[210:211], v[210:211], v[212:213]
    v_cvt_pk_bf16_f32 v220, v210, v211
    v_lshlrev_b32 v210, 16, v209
    v_and_b32 v211, 0xffff0000, v209
    v_lshlrev_b32 v212, 16, v101
    v_and_b32 v213, 0xffff0000, v101
    v_pk_add_f32 v[210:211], v[210:211], v[212:213]
    v_cvt_pk_bf16_f32 v221, v210, v211
    v_cvt_pk_bf16_f32 v208, v252, v253
    v_cvt_pk_bf16_f32 v209, v254, v255
    v_lshlrev_b32 v210, 16, v208
    v_and_b32 v211, 0xffff0000, v208
    v_lshlrev_b32 v212, 16, v102
    v_and_b32 v213, 0xffff0000, v102
    v_pk_add_f32 v[210:211], v[210:211], v[212:213]
    v_cvt_pk_bf16_f32 v222, v210, v211
    v_lshlrev_b32 v210, 16, v209
    v_and_b32 v211, 0xffff0000, v209
    v_lshlrev_b32 v212, 16, v103
    v_and_b32 v213, 0xffff0000, v103
    v_pk_add_f32 v[210:211], v[210:211], v[212:213]
    v_cvt_pk_bf16_f32 v223, v210, v211
    s_add_u32 s25, s43, 20480
    buffer_store_dwordx4 v[216:219], v12, s[8:11], s43 offen sc1
    buffer_store_dwordx4 v[220:223], v12, s[8:11], s25 offen sc1
    s_add_u32 s40, s40, 1
    s_add_u32 s43, s43, s77
    s_cmp_ge_u32 s40, s76
    s_cbranch_scc1 interleave_layers__linear_attn_block__memory_aug_recurrent_mem_tr__prompt_kernel_k3_done
    s_cmp_eq_u32 s40, 1
    s_cbranch_scc0 interleave_layers__linear_attn_block__memory_aug_recurrent_mem_tr__prompt_kernel_k3q9
    s_waitcnt vmcnt(0)
    s_barrier
    s_lshl_b32 s24, s92, 10
    s_lshl_b32 s25, s78, 2
    s_add_u32 s24, s24, s25
    s_add_u32 s24, s24, 23105536
    s_cmp_eq_u32 s3, 0
    s_cbranch_scc0 interleave_layers__linear_attn_block__memory_aug_recurrent_mem_tr__prompt_kernel_pb10
    v_lshlrev_b32 v14, 7, v1
    v_add_u32 v14, s24, v14
    v_mov_b32 v15, 2146435072
    v_cmp_le_u32 vcc, 8, v1
    s_nop 1
    v_cndmask_b32 v14, v14, v15, vcc
    v_mov_b32 v15, s40
    buffer_store_dword v15, v14, s[8:11], 0 offen sc1
interleave_layers__linear_attn_block__memory_aug_recurrent_mem_tr__prompt_kernel_pb10:
interleave_layers__linear_attn_block__memory_aug_recurrent_mem_tr__prompt_kernel_k3q9:
    s_xor_b32 s42, s42, 40960
    s_waitcnt vmcnt(2)
    v_mfma_f32_16x16x32_bf16 v[132:135], a[192:195], v[56:59], 0
    v_mfma_f32_16x16x32_bf16 v[136:139], a[202:205], v[60:63], 0
    v_mfma_f32_16x16x32_bf16 v[112:115], a[160:163], v[56:59], 0
    v_mfma_f32_16x16x32_bf16 v[116:119], a[164:167], v[56:59], 0
    v_mfma_f32_16x16x32_bf16 v[120:123], a[172:175], v[56:59], 0
    v_mfma_f32_16x16x32_bf16 v[124:127], a[180:183], v[60:63], 0
    v_mfma_f32_16x16x32_bf16 v[128:131], a[186:189], v[60:63], 0
    v_mfma_f32_16x16x32_bf16 v[132:135], a[196:199], v[60:63], v[132:135]
    v_mfma_f32_16x16x32_bf16 v[116:119], a[168:171], v[60:63], v[116:119]
    v_mfma_f32_16x16x32_bf16 v[120:123], a[176:179], v[60:63], v[120:123]
    v_mfma_f32_16x16x16_bf16 v[136:139], a[206:207], v[64:65], v[136:139]
    s_nop 0
    v_mfma_f32_16x16x16_bf16 v[124:127], a[184:185], v[64:65], v[124:127]
    v_mfma_f32_16x16x16_bf16 v[128:131], a[190:191], v[64:65], v[128:131]
    v_mfma_f32_16x16x16_bf16 v[132:135], a[200:201], v[64:65], v[132:135]
    v_mfma_f32_16x16x32_bf16 v[160:163], a[240:243], v[66:69], 0
    v_mfma_f32_16x16x32_bf16 v[164:167], a[250:253], v[70:73], 0
    v_mfma_f32_16x16x32_bf16 v[140:143], a[208:211], v[66:69], 0
    v_mfma_f32_16x16x32_bf16 v[144:147], a[212:215], v[66:69], 0
    v_mfma_f32_16x16x32_bf16 v[148:151], a[220:223], v[66:69], 0
    v_mfma_f32_16x16x32_bf16 v[152:155], a[228:231], v[70:73], 0
    v_mfma_f32_16x16x32_bf16 v[156:159], a[234:237], v[70:73], 0
    v_mfma_f32_16x16x32_bf16 v[160:163], a[244:247], v[70:73], v[160:163]
    v_mfma_f32_16x16x32_bf16 v[144:147], a[216:219], v[70:73], v[144:147]
    v_mfma_f32_16x16x32_bf16 v[148:151], a[224:227], v[70:73], v[148:151]
    v_mfma_f32_16x16x16_bf16 v[164:167], a[254:255], v[74:75], v[164:167]
    s_nop 0
    v_mfma_f32_16x16x16_bf16 v[152:155], a[232:233], v[74:75], v[152:155]
    v_mfma_f32_16x16x16_bf16 v[156:159], a[238:239], v[74:75], v[156:159]
    v_mfma_f32_16x16x16_bf16 v[160:163], a[248:249], v[74:75], v[160:163]
    v_add_f32 v132, s54, v132
    v_add_f32 v133, s54, v133
    v_add_f32 v134, s54, v134
    v_add_f32 v135, s54, v135
    v_add_f32 v136, s54, v136
    v_rcp_f32 v132, v132
    v_rcp_f32 v133, v133
    v_rcp_f32 v134, v134
    v_rcp_f32 v135, v135
    v_rcp_f32 v136, v136
    v_mul_f32 v112, v112, v132
    v_mul_f32 v113, v113, v132
    v_mul_f32 v114, v114, v132
    v_mul_f32 v115, v115, v132
    v_cvt_pk_bf16_f32 v168, v112, v113
    v_cvt_pk_bf16_f32 v169, v114, v115
    v_mul_f32 v116, v116, v133
    v_mul_f32 v117, v117, v133
    v_mul_f32 v118, v118, v133
    v_mul_f32 v119, v119, v133
    v_cvt_pk_bf16_f32 v170, v116, v117
    v_cvt_pk_bf16_f32 v171, v118, v119
    v_mul_f32 v120, v120, v134
    v_mul_f32 v121, v121, v134
    v_mul_f32 v122, v122, v134
    v_mul_f32 v123, v123, v134
    v_cvt_pk_bf16_f32 v172, v120, v121
    v_cvt_pk_bf16_f32 v173, v122, v123
    v_mul_f32 v124, v124, v135
    v_mul_f32 v125, v125, v135
    v_mul_f32 v126, v126, v135
    v_mul_f32 v127, v127, v135
    v_cvt_pk_bf16_f32 v174, v124, v125
    v_cvt_pk_bf16_f32 v175, v126, v127
    v_mul_f32 v128, v128, v136
    v_mul_f32 v129, v129, v136
    v_mul_f32 v130, v130, v136
    v_mul_f32 v131, v131, v136
    v_cvt_pk_bf16_f32 v176, v128, v129
    v_cvt_pk_bf16_f32 v177, v130, v131
    v_add_f32 v160, s54, v160
    v_add_f32 v161, s54, v161
    v_add_f32 v162, s54, v162
    v_add_f32 v163, s54, v163
    v_add_f32 v164, s54, v164
    v_rcp_f32 v160, v160
    v_rcp_f32 v161, v161
    v_rcp_f32 v162, v162
    v_rcp_f32 v163, v163
    v_rcp_f32 v164, v164
    v_mul_f32 v140, v140, v160
    v_mul_f32 v141, v141, v160
    v_mul_f32 v142, v142, v160
    v_mul_f32 v143, v143, v160
    v_cvt_pk_bf16_f32 v178, v140, v141
    v_cvt_pk_bf16_f32 v179, v142, v143
    v_mul_f32 v144, v144, v161
    v_mul_f32 v145, v145, v161
    v_mul_f32 v146, v146, v161
    v_mul_f32 v147, v147, v161
    v_cvt_pk_bf16_f32 v180, v144, v145
    v_cvt_pk_bf16_f32 v181, v146, v147
    v_mul_f32 v148, v148, v162
    v_mul_f32 v149, v149, v162
    v_mul_f32 v150, v150, v162
    v_mul_f32 v151, v151, v162
    v_cvt_pk_bf16_f32 v182, v148, v149
    v_cvt_pk_bf16_f32 v183, v150, v151
    v_mul_f32 v152, v152, v163
    v_mul_f32 v153, v153, v163
    v_mul_f32 v154, v154, v163
    v_mul_f32 v155, v155, v163
    v_cvt_pk_bf16_f32 v184, v152, v153
    v_cvt_pk_bf16_f32 v185, v154, v155
    v_mul_f32 v156, v156, v164
    v_mul_f32 v157, v157, v164
    v_mul_f32 v158, v158, v164
    v_mul_f32 v159, v159, v164
    v_cvt_pk_bf16_f32 v186, v156, v157
    v_cvt_pk_bf16_f32 v187, v158, v159
    v_mfma_f32_16x16x32_bf16 v[132:135], a[192:195], v[76:79], 0
    v_mfma_f32_16x16x32_bf16 v[136:139], a[202:205], v[80:83], 0
    v_mfma_f32_16x16x32_bf16 v[112:115], a[160:163], v[76:79], 0
    v_mfma_f32_16x16x32_bf16 v[116:119], a[164:167], v[76:79], 0
    v_mfma_f32_16x16x32_bf16 v[120:123], a[172:175], v[76:79], 0
    v_mfma_f32_16x16x32_bf16 v[124:127], a[180:183], v[80:83], 0
    v_mfma_f32_16x16x32_bf16 v[128:131], a[186:189], v[80:83], 0
    v_mfma_f32_16x16x32_bf16 v[132:135], a[196:199], v[80:83], v[132:135]
    v_mfma_f32_16x16x32_bf16 v[116:119], a[168:171], v[80:83], v[116:119]
    v_mfma_f32_16x16x32_bf16 v[120:123], a[176:179], v[80:83], v[120:123]
    v_mfma_f32_16x16x16_bf16 v[136:139], a[206:207], v[84:85], v[136:139]
    s_nop 0
    v_mfma_f32_16x16x16_bf16 v[124:127], a[184:185], v[84:85], v[124:127]
    v_mfma_f32_16x16x16_bf16 v[128:131], a[190:191], v[84:85], v[128:131]
    v_mfma_f32_16x16x16_bf16 v[132:135], a[200:201], v[84:85], v[132:135]
    v_mfma_f32_16x16x32_bf16 v[160:163], a[240:243], v[86:89], 0
    v_mfma_f32_16x16x32_bf16 v[164:167], a[250:253], v[90:93], 0
    v_mfma_f32_16x16x32_bf16 v[140:143], a[208:211], v[86:89], 0
    v_mfma_f32_16x16x32_bf16 v[144:147], a[212:215], v[86:89], 0
    v_mfma_f32_16x16x32_bf16 v[148:151], a[220:223], v[86:89], 0
    v_mfma_f32_16x16x32_bf16 v[152:155], a[228:231], v[90:93], 0
    v_mfma_f32_16x16x32_bf16 v[156:159], a[234:237], v[90:93], 0
    v_mfma_f32_16x16x32_bf16 v[160:163], a[244:247], v[90:93], v[160:163]
    v_mfma_f32_16x16x32_bf16 v[144:147], a[216:219], v[90:93], v[144:147]
    v_mfma_f32_16x16x32_bf16 v[148:151], a[224:227], v[90:93], v[148:151]
    v_mfma_f32_16x16x16_bf16 v[164:167], a[254:255], v[94:95], v[164:167]
    s_nop 0
    v_mfma_f32_16x16x16_bf16 v[152:155], a[232:233], v[94:95], v[152:155]
    v_mfma_f32_16x16x16_bf16 v[156:159], a[238:239], v[94:95], v[156:159]
    v_mfma_f32_16x16x16_bf16 v[160:163], a[248:249], v[94:95], v[160:163]
    v_add_f32 v132, s54, v132
    v_add_f32 v133, s54, v133
    v_add_f32 v134, s54, v134
    v_add_f32 v135, s54, v135
    v_add_f32 v136, s54, v136
    v_rcp_f32 v132, v132
    v_rcp_f32 v133, v133
    v_rcp_f32 v134, v134
    v_rcp_f32 v135, v135
    v_rcp_f32 v136, v136
    v_mul_f32 v112, v112, v132
    v_mul_f32 v113, v113, v132
    v_mul_f32 v114, v114, v132
    v_mul_f32 v115, v115, v132
    v_cvt_pk_bf16_f32 v188, v112, v113
    v_cvt_pk_bf16_f32 v189, v114, v115
    v_mul_f32 v116, v116, v133
    v_mul_f32 v117, v117, v133
    v_mul_f32 v118, v118, v133
    v_mul_f32 v119, v119, v133
    v_cvt_pk_bf16_f32 v190, v116, v117
    v_cvt_pk_bf16_f32 v191, v118, v119
    v_mul_f32 v120, v120, v134
    v_mul_f32 v121, v121, v134
    v_mul_f32 v122, v122, v134
    v_mul_f32 v123, v123, v134
    v_cvt_pk_bf16_f32 v192, v120, v121
    v_cvt_pk_bf16_f32 v193, v122, v123
    v_mul_f32 v124, v124, v135
    v_mul_f32 v125, v125, v135
    v_mul_f32 v126, v126, v135
    v_mul_f32 v127, v127, v135
    v_cvt_pk_bf16_f32 v194, v124, v125
    v_cvt_pk_bf16_f32 v195, v126, v127
    v_mul_f32 v128, v128, v136
    v_mul_f32 v129, v129, v136
    v_mul_f32 v130, v130, v136
    v_mul_f32 v131, v131, v136
    v_cvt_pk_bf16_f32 v196, v128, v129
    v_cvt_pk_bf16_f32 v197, v130, v131
    v_add_f32 v160, s54, v160
    v_add_f32 v161, s54, v161
    v_add_f32 v162, s54, v162
    v_add_f32 v163, s54, v163
    v_add_f32 v164, s54, v164
    v_rcp_f32 v160, v160
    v_rcp_f32 v161, v161
    v_rcp_f32 v162, v162
    v_rcp_f32 v163, v163
    v_rcp_f32 v164, v164
    v_mul_f32 v140, v140, v160
    v_mul_f32 v141, v141, v160
    v_mul_f32 v142, v142, v160
    v_mul_f32 v143, v143, v160
    v_cvt_pk_bf16_f32 v198, v140, v141
    v_cvt_pk_bf16_f32 v199, v142, v143
    v_mul_f32 v144, v144, v161
    v_mul_f32 v145, v145, v161
    v_mul_f32 v146, v146, v161
    v_mul_f32 v147, v147, v161
    v_cvt_pk_bf16_f32 v200, v144, v145
    v_cvt_pk_bf16_f32 v201, v146, v147
    v_mul_f32 v148, v148, v162
    v_mul_f32 v149, v149, v162
    v_mul_f32 v150, v150, v162
    v_mul_f32 v151, v151, v162
    v_cvt_pk_bf16_f32 v202, v148, v149
    v_cvt_pk_bf16_f32 v203, v150, v151
    v_mul_f32 v152, v152, v163
    v_mul_f32 v153, v153, v163
    v_mul_f32 v154, v154, v163
    v_mul_f32 v155, v155, v163
    v_cvt_pk_bf16_f32 v204, v152, v153
    v_cvt_pk_bf16_f32 v205, v154, v155
    v_mul_f32 v156, v156, v164
    v_mul_f32 v157, v157, v164
    v_mul_f32 v158, v158, v164
    v_mul_f32 v159, v159, v164
    v_cvt_pk_bf16_f32 v206, v156, v157
    v_cvt_pk_bf16_f32 v207, v158, v159
    v_add_u32 v14, s42, v13
    ds_write_b128 v14, v[168:171] offset:0
    ds_write_b128 v14, v[172:175] offset:1024
    ds_write_b128 v14, v[176:179] offset:2048
    ds_write_b128 v14, v[180:183] offset:3072
    ds_write_b128 v14, v[184:187] offset:4096
    ds_write_b128 v14, v[188:191] offset:20480
    ds_write_b128 v14, v[192:195] offset:21504
    ds_write_b128 v14, v[196:199] offset:22528
    ds_write_b128 v14, v[200:203] offset:23552
    ds_write_b128 v14, v[204:207] offset:24576
    s_add_u32 s41, s43, s77
    s_add_u32 s24, s40, 1
    s_cmp_lt_u32 s24, s76
    s_cselect_b32 s41, s41, 2146435072
    s_waitcnt vmcnt(0)
    s_add_u32 s25, s41, 20480
    buffer_load_dwordx4 v[16:19], v8, s[8:11], s41 offen offset:0 sc1
    buffer_load_dwordx4 v[20:23], v8, s[8:11], s41 offen offset:1024 sc1
    buffer_load_dwordx2 v[24:25], v9, s[8:11], s41 offen offset:0 sc1
    buffer_load_dwordx4 v[26:29], v8, s[8:11], s41 offen offset:2560 sc1
    buffer_load_dwordx4 v[30:33], v8, s[8:11], s41 offen offset:3584 sc1
    buffer_load_dwordx2 v[34:35], v9, s[8:11], s41 offen offset:2560 sc1
    buffer_load_dwordx4 v[36:39], v8, s[8:11], s25 offen offset:0 sc1
    buffer_load_dwordx4 v[40:43], v8, s[8:11], s25 offen offset:1024 sc1
    buffer_load_dwordx2 v[44:45], v9, s[8:11], s25 offen offset:0 sc1
    buffer_load_dwordx4 v[46:49], v8, s[8:11], s25 offen offset:2560 sc1
    buffer_load_dwordx4 v[50:53], v8, s[8:11], s25 offen offset:3584 sc1
    buffer_load_dwordx2 v[54:55], v9, s[8:11], s25 offen offset:2560 sc1
    buffer_load_dwordx2 v[96:97], v10, s[16:19], s41 offen sc1
    buffer_load_dwordx2 v[98:99], v11, s[16:19], s41 offen sc1
    buffer_load_dwordx2 v[100:101], v10, s[16:19], s25 offen sc1
    buffer_load_dwordx2 v[102:103], v11, s[16:19], s25 offen sc1
    s_waitcnt lgkmcnt(0)
    s_barrier
    s_lshl_b32 s24, s92, 10
    s_lshl_b32 s25, s78, 2
    s_add_u32 s24, s24, s25
    s_add_u32 s24, s24, 23105536
    s_cmp_eq_u32 s3, 0
    s_cbranch_scc0 interleave_layers__linear_attn_block__memory_aug_recurrent_mem_tr__prompt_kernel_pb11
    v_lshlrev_b32 v14, 7, v1
    v_add_u32 v14, s24, v14
    v_mov_b32 v15, 2146435072
    v_cmp_le_u32 vcc, 8, v1
    s_nop 1
    v_cndmask_b32 v14, v14, v15, vcc
    v_mov_b32 v15, s40
    buffer_store_dword v15, v14, s[8:11], 0 offen sc1
interleave_layers__linear_attn_block__memory_aug_recurrent_mem_tr__prompt_kernel_pb11:
    v_add_u32 v15, s42, v5
    ds_read_b128 v[208:211], v15 offset:0
    ds_read_b128 v[212:215], v15 offset:20480
    ds_read_b128 v[216:219], v15 offset:1024
    ds_read_b128 v[220:223], v15 offset:21504
    ds_read_b128 v[224:227], v15 offset:2048
    ds_read_b128 v[228:231], v15 offset:22528
    ds_read_b128 v[232:235], v15 offset:3072
    ds_read_b128 v[236:239], v15 offset:23552
    s_waitcnt lgkmcnt(6)
    v_mfma_f32_16x16x32_bf16 v[240:243], a[0:3], v[208:211], 0
    v_mfma_f32_16x16x32_bf16 v[244:247], a[4:7], v[208:211], 0
    v_mfma_f32_16x16x32_bf16 v[248:251], a[0:3], v[212:215], 0
    v_mfma_f32_16x16x32_bf16 v[252:255], a[4:7], v[212:215], 0
    ds_read_b128 v[208:211], v15 offset:4096
    ds_read_b128 v[212:215], v15 offset:24576
    s_waitcnt lgkmcnt(6)
    v_mfma_f32_16x16x32_bf16 v[240:243], a[8:11], v[216:219], v[240:243]
    v_mfma_f32_16x16x32_bf16 v[244:247], a[12:15], v[216:219], v[244:247]
    v_mfma_f32_16x16x32_bf16 v[248:251], a[8:11], v[220:223], v[248:251]
    v_mfma_f32_16x16x32_bf16 v[252:255], a[12:15], v[220:223], v[252:255]
    ds_read_b128 v[216:219], v15 offset:5120
    ds_read_b128 v[220:223], v15 offset:25600
    s_waitcnt lgkmcnt(6)
    v_mfma_f32_16x16x32_bf16 v[240:243], a[16:19], v[224:227], v[240:243]
    v_mfma_f32_16x16x32_bf16 v[244:247], a[20:23], v[224:227], v[244:247]
    v_mfma_f32_16x16x32_bf16 v[248:251], a[16:19], v[228:231], v[248:251]
    v_mfma_f32_16x16x32_bf16 v[252:255], a[20:23], v[228:231], v[252:255]
    ds_read_b128 v[224:227], v15 offset:6144
    ds_read_b128 v[228:231], v15 offset:26624
    s_waitcnt lgkmcnt(6)
    v_mfma_f32_16x16x32_bf16 v[240:243], a[24:27], v[232:235], v[240:243]
    v_mfma_f32_16x16x32_bf16 v[244:247], a[28:31], v[232:235], v[244:247]
    v_mfma_f32_16x16x32_bf16 v[248:251], a[24:27], v[236:239], v[248:251]
    v_mfma_f32_16x16x32_bf16 v[252:255], a[28:31], v[236:239], v[252:255]
    ds_read_b128 v[232:235], v15 offset:7168
    ds_read_b128 v[236:239], v15 offset:27648
    s_waitcnt lgkmcnt(6)
    v_mfma_f32_16x16x32_bf16 v[240:243], a[32:35], v[208:211], v[240:243]
    v_mfma_f32_16x16x32_bf16 v[244:247], a[36:39], v[208:211], v[244:247]
    v_mfma_f32_16x16x32_bf16 v[248:251], a[32:35], v[212:215], v[248:251]
    v_mfma_f32_16x16x32_bf16 v[252:255], a[36:39], v[212:215], v[252:255]
    ds_read_b128 v[208:211], v15 offset:8192
    ds_read_b128 v[212:215], v15 offset:28672
    s_waitcnt lgkmcnt(6)
    v_mfma_f32_16x16x32_bf16 v[240:243], a[40:43], v[216:219], v[240:243]
    v_mfma_f32_16x16x32_bf16 v[244:247], a[44:47], v[216:219], v[244:247]
    v_mfma_f32_16x16x32_bf16 v[248:251], a[40:43], v[220:223], v[248:251]
    v_mfma_f32_16x16x32_bf16 v[252:255], a[44:47], v[220:223], v[252:255]
    ds_read_b128 v[216:219], v15 offset:9216
    ds_read_b128 v[220:223], v15 offset:29696
    s_waitcnt lgkmcnt(6)
    v_mfma_f32_16x16x32_bf16 v[240:243], a[48:51], v[224:227], v[240:243]
    v_mfma_f32_16x16x32_bf16 v[244:247], a[52:55], v[224:227], v[244:247]
    v_mfma_f32_16x16x32_bf16 v[248:251], a[48:51], v[228:231], v[248:251]
    v_mfma_f32_16x16x32_bf16 v[252:255], a[52:55], v[228:231], v[252:255]
    ds_read_b128 v[224:227], v15 offset:10240
    ds_read_b128 v[228:231], v15 offset:30720
    s_waitcnt lgkmcnt(6)
    v_mfma_f32_16x16x32_bf16 v[240:243], a[56:59], v[232:235], v[240:243]
    v_mfma_f32_16x16x32_bf16 v[244:247], a[60:63], v[232:235], v[244:247]
    v_mfma_f32_16x16x32_bf16 v[248:251], a[56:59], v[236:239], v[248:251]
    v_mfma_f32_16x16x32_bf16 v[252:255], a[60:63], v[236:239], v[252:255]
    ds_read_b128 v[232:235], v15 offset:11264
    ds_read_b128 v[236:239], v15 offset:31744
    s_waitcnt lgkmcnt(6)
    v_mfma_f32_16x16x32_bf16 v[240:243], a[64:67], v[208:211], v[240:243]
    v_mfma_f32_16x16x32_bf16 v[244:247], a[68:71], v[208:211], v[244:247]
    v_mfma_f32_16x16x32_bf16 v[248:251], a[64:67], v[212:215], v[248:251]
    v_mfma_f32_16x16x32_bf16 v[252:255], a[68:71], v[212:215], v[252:255]
    ds_read_b128 v[208:211], v15 offset:12288
    ds_read_b128 v[212:215], v15 offset:32768
    s_waitcnt lgkmcnt(6)
    v_mfma_f32_16x16x32_bf16 v[240:243], a[72:75], v[216:219], v[240:243]
    v_mfma_f32_16x16x32_bf16 v[244:247], a[76:79], v[216:219], v[244:247]
    v_mfma_f32_16x16x32_bf16 v[248:251], a[72:75], v[220:223], v[248:251]
    v_mfma_f32_16x16x32_bf16 v[252:255], a[76:79], v[220:223], v[252:255]
    ds_read_b128 v[216:219], v15 offset:13312
    ds_read_b128 v[220:223], v15 offset:33792
    s_waitcnt lgkmcnt(6)
    v_mfma_f32_16x16x32_bf16 v[240:243], a[80:83], v[224:227], v[240:243]
    v_mfma_f32_16x16x32_bf16 v[244:247], a[84:87], v[224:227], v[244:247]
    v_mfma_f32_16x16x32_bf16 v[248:251], a[80:83], v[228:231], v[248:251]
    v_mfma_f32_16x16x32_bf16 v[252:255], a[84:87], v[228:231], v[252:255]
    ds_read_b128 v[224:227], v15 offset:14336
    ds_read_b128 v[228:231], v15 offset:34816
    s_waitcnt lgkmcnt(6)
    v_mfma_f32_16x16x32_bf16 v[240:243], a[88:91], v[232:235], v[240:243]
    v_mfma_f32_16x16x32_bf16 v[244:247], a[92:95], v[232:235], v[244:247]
    v_mfma_f32_16x16x32_bf16 v[248:251], a[88:91], v[236:239], v[248:251]
    v_mfma_f32_16x16x32_bf16 v[252:255], a[92:95], v[236:239], v[252:255]
    ds_read_b128 v[232:235], v15 offset:15360
    ds_read_b128 v[236:239], v15 offset:35840
    s_waitcnt lgkmcnt(6)
    v_mfma_f32_16x16x32_bf16 v[240:243], a[96:99], v[208:211], v[240:243]
    v_mfma_f32_16x16x32_bf16 v[244:247], a[100:103], v[208:211], v[244:247]
    v_mfma_f32_16x16x32_bf16 v[248:251], a[96:99], v[212:215], v[248:251]
    v_mfma_f32_16x16x32_bf16 v[252:255], a[100:103], v[212:215], v[252:255]
    ds_read_b128 v[208:211], v15 offset:16384
    ds_read_b128 v[212:215], v15 offset:36864
    s_waitcnt lgkmcnt(6)
    v_mfma_f32_16x16x32_bf16 v[240:243], a[104:107], v[216:219], v[240:243]
    v_mfma_f32_16x16x32_bf16 v[244:247], a[108:111], v[216:219], v[244:247]
    v_mfma_f32_16x16x32_bf16 v[248:251], a[104:107], v[220:223], v[248:251]
    v_mfma_f32_16x16x32_bf16 v[252:255], a[108:111], v[220:223], v[252:255]
    ds_read_b128 v[216:219], v15 offset:17408
    ds_read_b128 v[220:223], v15 offset:37888
    s_waitcnt lgkmcnt(6)
    v_mfma_f32_16x16x32_bf16 v[240:243], a[112:115], v[224:227], v[240:243]
    v_mfma_f32_16x16x32_bf16 v[244:247], a[116:119], v[224:227], v[244:247]
    v_mfma_f32_16x16x32_bf16 v[248:251], a[112:115], v[228:231], v[248:251]
    v_mfma_f32_16x16x32_bf16 v[252:255], a[116:119], v[228:231], v[252:255]
    ds_read_b128 v[224:227], v15 offset:18432
    ds_read_b128 v[228:231], v15 offset:38912
    s_waitcnt lgkmcnt(6)
    v_mfma_f32_16x16x32_bf16 v[240:243], a[120:123], v[232:235], v[240:243]
    v_mfma_f32_16x16x32_bf16 v[244:247], a[124:127], v[232:235], v[244:247]
    v_mfma_f32_16x16x32_bf16 v[248:251], a[120:123], v[236:239], v[248:251]
    v_mfma_f32_16x16x32_bf16 v[252:255], a[124:127], v[236:239], v[252:255]
    ds_read_b128 v[232:235], v15 offset:19456
    ds_read_b128 v[236:239], v15 offset:39936
    s_waitcnt lgkmcnt(6)
    v_mfma_f32_16x16x32_bf16 v[240:243], a[128:131], v[208:211], v[240:243]
    v_mfma_f32_16x16x32_bf16 v[244:247], a[132:135], v[208:211], v[244:247]
    v_mfma_f32_16x16x32_bf16 v[248:251], a[128:131], v[212:215], v[248:251]
    v_mfma_f32_16x16x32_bf16 v[252:255], a[132:135], v[212:215], v[252:255]
    s_waitcnt lgkmcnt(4)
    v_mfma_f32_16x16x32_bf16 v[240:243], a[136:139], v[216:219], v[240:243]
    v_mfma_f32_16x16x32_bf16 v[244:247], a[140:143], v[216:219], v[244:247]
    v_mfma_f32_16x16x32_bf16 v[248:251], a[136:139], v[220:223], v[248:251]
    v_mfma_f32_16x16x32_bf16 v[252:255], a[140:143], v[220:223], v[252:255]
    s_waitcnt lgkmcnt(2)
    v_mfma_f32_16x16x32_bf16 v[240:243], a[144:147], v[224:227], v[240:243]
    v_mfma_f32_16x16x32_bf16 v[244:247], a[148:151], v[224:227], v[244:247]
    v_mfma_f32_16x16x32_bf16 v[248:251], a[144:147], v[228:231], v[248:251]
    v_mfma_f32_16x16x32_bf16 v[252:255], a[148:151], v[228:231], v[252:255]
    s_waitcnt lgkmcnt(0)
    v_mfma_f32_16x16x32_bf16 v[240:243], a[152:155], v[232:235], v[240:243]
    v_mfma_f32_16x16x32_bf16 v[244:247], a[156:159], v[232:235], v[244:247]
    v_mfma_f32_16x16x32_bf16 v[248:251], a[152:155], v[236:239], v[248:251]
    v_mfma_f32_16x16x32_bf16 v[252:255], a[156:159], v[236:239], v[252:255]
    s_nop 4
    v_cvt_pk_bf16_f32 v208, v240, v241
    v_cvt_pk_bf16_f32 v209, v242, v243
    v_lshlrev_b32 v210, 16, v208
    v_and_b32 v211, 0xffff0000, v208
    v_lshlrev_b32 v212, 16, v104
    v_and_b32 v213, 0xffff0000, v104
    v_pk_add_f32 v[210:211], v[210:211], v[212:213]
    v_cvt_pk_bf16_f32 v216, v210, v211
    v_lshlrev_b32 v210, 16, v209
    v_and_b32 v211, 0xffff0000, v209
    v_lshlrev_b32 v212, 16, v105
    v_and_b32 v213, 0xffff0000, v105
    v_pk_add_f32 v[210:211], v[210:211], v[212:213]
    v_cvt_pk_bf16_f32 v217, v210, v211
    v_cvt_pk_bf16_f32 v208, v244, v245
    v_cvt_pk_bf16_f32 v209, v246, v247
    v_lshlrev_b32 v210, 16, v208
    v_and_b32 v211, 0xffff0000, v208
    v_lshlrev_b32 v212, 16, v106
    v_and_b32 v213, 0xffff0000, v106
    v_pk_add_f32 v[210:211], v[210:211], v[212:213]
    v_cvt_pk_bf16_f32 v218, v210, v211
    v_lshlrev_b32 v210, 16, v209
    v_and_b32 v211, 0xffff0000, v209
    v_lshlrev_b32 v212, 16, v107
    v_and_b32 v213, 0xffff0000, v107
    v_pk_add_f32 v[210:211], v[210:211], v[212:213]
    v_cvt_pk_bf16_f32 v219, v210, v211
    v_cvt_pk_bf16_f32 v208, v248, v249
    v_cvt_pk_bf16_f32 v209, v250, v251
    v_lshlrev_b32 v210, 16, v208
    v_and_b32 v211, 0xffff0000, v208
    v_lshlrev_b32 v212, 16, v108
    v_and_b32 v213, 0xffff0000, v108
    v_pk_add_f32 v[210:211], v[210:211], v[212:213]
    v_cvt_pk_bf16_f32 v220, v210, v211
    v_lshlrev_b32 v210, 16, v209
    v_and_b32 v211, 0xffff0000, v209
    v_lshlrev_b32 v212, 16, v109
    v_and_b32 v213, 0xffff0000, v109
    v_pk_add_f32 v[210:211], v[210:211], v[212:213]
    v_cvt_pk_bf16_f32 v221, v210, v211
    v_cvt_pk_bf16_f32 v208, v252, v253
    v_cvt_pk_bf16_f32 v209, v254, v255
    v_lshlrev_b32 v210, 16, v208
    v_and_b32 v211, 0xffff0000, v208
    v_lshlrev_b32 v212, 16, v110
    v_and_b32 v213, 0xffff0000, v110
    v_pk_add_f32 v[210:211], v[210:211], v[212:213]
    v_cvt_pk_bf16_f32 v222, v210, v211
    v_lshlrev_b32 v210, 16, v209
    v_and_b32 v211, 0xffff0000, v209
    v_lshlrev_b32 v212, 16, v111
    v_and_b32 v213, 0xffff0000, v111
    v_pk_add_f32 v[210:211], v[210:211], v[212:213]
    v_cvt_pk_bf16_f32 v223, v210, v211
    s_add_u32 s25, s43, 20480
    buffer_store_dwordx4 v[216:219], v12, s[8:11], s43 offen sc1
    buffer_store_dwordx4 v[220:223], v12, s[8:11], s25 offen sc1
    s_add_u32 s40, s40, 1
    s_add_u32 s43, s43, s77
    s_cmp_ge_u32 s40, s76
    s_cbranch_scc1 interleave_layers__linear_attn_block__memory_aug_recurrent_mem_tr__prompt_kernel_k3_done
    s_xor_b32 s42, s42, 40960
    s_waitcnt vmcnt(2)
    v_mfma_f32_16x16x32_bf16 v[132:135], a[192:195], v[16:19], 0
    v_mfma_f32_16x16x32_bf16 v[136:139], a[202:205], v[20:23], 0
    v_mfma_f32_16x16x32_bf16 v[112:115], a[160:163], v[16:19], 0
    v_mfma_f32_16x16x32_bf16 v[116:119], a[164:167], v[16:19], 0
    v_mfma_f32_16x16x32_bf16 v[120:123], a[172:175], v[16:19], 0
    v_mfma_f32_16x16x32_bf16 v[124:127], a[180:183], v[20:23], 0
    v_mfma_f32_16x16x32_bf16 v[128:131], a[186:189], v[20:23], 0
    v_mfma_f32_16x16x32_bf16 v[132:135], a[196:199], v[20:23], v[132:135]
    v_mfma_f32_16x16x32_bf16 v[116:119], a[168:171], v[20:23], v[116:119]
    v_mfma_f32_16x16x32_bf16 v[120:123], a[176:179], v[20:23], v[120:123]
    v_mfma_f32_16x16x16_bf16 v[136:139], a[206:207], v[24:25], v[136:139]
    s_nop 0
    v_mfma_f32_16x16x16_bf16 v[124:127], a[184:185], v[24:25], v[124:127]
    v_mfma_f32_16x16x16_bf16 v[128:131], a[190:191], v[24:25], v[128:131]
    v_mfma_f32_16x16x16_bf16 v[132:135], a[200:201], v[24:25], v[132:135]
    v_mfma_f32_16x16x32_bf16 v[160:163], a[240:243], v[26:29], 0
    v_mfma_f32_16x16x32_bf16 v[164:167], a[250:253], v[30:33], 0
    v_mfma_f32_16x16x32_bf16 v[140:143], a[208:211], v[26:29], 0
    v_mfma_f32_16x16x32_bf16 v[144:147], a[212:215], v[26:29], 0
    v_mfma_f32_16x16x32_bf16 v[148:151], a[220:223], v[26:29], 0
    v_mfma_f32_16x16x32_bf16 v[152:155], a[228:231], v[30:33], 0
    v_mfma_f32_16x16x32_bf16 v[156:159], a[234:237], v[30:33], 0
    v_mfma_f32_16x16x32_bf16 v[160:163], a[244:247], v[30:33], v[160:163]
    v_mfma_f32_16x16x32_bf16 v[144:147], a[216:219], v[30:33], v[144:147]
    v_mfma_f32_16x16x32_bf16 v[148:151], a[224:227], v[30:33], v[148:151]
    v_mfma_f32_16x16x16_bf16 v[164:167], a[254:255], v[34:35], v[164:167]
    s_nop 0
    v_mfma_f32_16x16x16_bf16 v[152:155], a[232:233], v[34:35], v[152:155]
    v_mfma_f32_16x16x16_bf16 v[156:159], a[238:239], v[34:35], v[156:159]
    v_mfma_f32_16x16x16_bf16 v[160:163], a[248:249], v[34:35], v[160:163]
    v_add_f32 v132, s54, v132
    v_add_f32 v133, s54, v133
    v_add_f32 v134, s54, v134
    v_add_f32 v135, s54, v135
    v_add_f32 v136, s54, v136
    v_rcp_f32 v132, v132
    v_rcp_f32 v133, v133
    v_rcp_f32 v134, v134
    v_rcp_f32 v135, v135
    v_rcp_f32 v136, v136
    v_mul_f32 v112, v112, v132
    v_mul_f32 v113, v113, v132
    v_mul_f32 v114, v114, v132
    v_mul_f32 v115, v115, v132
    v_cvt_pk_bf16_f32 v168, v112, v113
    v_cvt_pk_bf16_f32 v169, v114, v115
    v_mul_f32 v116, v116, v133
    v_mul_f32 v117, v117, v133
    v_mul_f32 v118, v118, v133
    v_mul_f32 v119, v119, v133
    v_cvt_pk_bf16_f32 v170, v116, v117
    v_cvt_pk_bf16_f32 v171, v118, v119
    v_mul_f32 v120, v120, v134
    v_mul_f32 v121, v121, v134
    v_mul_f32 v122, v122, v134
    v_mul_f32 v123, v123, v134
    v_cvt_pk_bf16_f32 v172, v120, v121
    v_cvt_pk_bf16_f32 v173, v122, v123
    v_mul_f32 v124, v124, v135
    v_mul_f32 v125, v125, v135
    v_mul_f32 v126, v126, v135
    v_mul_f32 v127, v127, v135
    v_cvt_pk_bf16_f32 v174, v124, v125
    v_cvt_pk_bf16_f32 v175, v126, v127
    v_mul_f32 v128, v128, v136
    v_mul_f32 v129, v129, v136
    v_mul_f32 v130, v130, v136
    v_mul_f32 v131, v131, v136
    v_cvt_pk_bf16_f32 v176, v128, v129
    v_cvt_pk_bf16_f32 v177, v130, v131
    v_add_f32 v160, s54, v160
    v_add_f32 v161, s54, v161
    v_add_f32 v162, s54, v162
    v_add_f32 v163, s54, v163
    v_add_f32 v164, s54, v164
    v_rcp_f32 v160, v160
    v_rcp_f32 v161, v161
    v_rcp_f32 v162, v162
    v_rcp_f32 v163, v163
    v_rcp_f32 v164, v164
    v_mul_f32 v140, v140, v160
    v_mul_f32 v141, v141, v160
    v_mul_f32 v142, v142, v160
    v_mul_f32 v143, v143, v160
    v_cvt_pk_bf16_f32 v178, v140, v141
    v_cvt_pk_bf16_f32 v179, v142, v143
    v_mul_f32 v144, v144, v161
    v_mul_f32 v145, v145, v161
    v_mul_f32 v146, v146, v161
    v_mul_f32 v147, v147, v161
    v_cvt_pk_bf16_f32 v180, v144, v145
    v_cvt_pk_bf16_f32 v181, v146, v147
    v_mul_f32 v148, v148, v162
    v_mul_f32 v149, v149, v162
    v_mul_f32 v150, v150, v162
    v_mul_f32 v151, v151, v162
    v_cvt_pk_bf16_f32 v182, v148, v149
    v_cvt_pk_bf16_f32 v183, v150, v151
    v_mul_f32 v152, v152, v163
    v_mul_f32 v153, v153, v163
    v_mul_f32 v154, v154, v163
    v_mul_f32 v155, v155, v163
    v_cvt_pk_bf16_f32 v184, v152, v153
    v_cvt_pk_bf16_f32 v185, v154, v155
    v_mul_f32 v156, v156, v164
    v_mul_f32 v157, v157, v164
    v_mul_f32 v158, v158, v164
    v_mul_f32 v159, v159, v164
    v_cvt_pk_bf16_f32 v186, v156, v157
    v_cvt_pk_bf16_f32 v187, v158, v159
    v_mfma_f32_16x16x32_bf16 v[132:135], a[192:195], v[36:39], 0
    v_mfma_f32_16x16x32_bf16 v[136:139], a[202:205], v[40:43], 0
    v_mfma_f32_16x16x32_bf16 v[112:115], a[160:163], v[36:39], 0
    v_mfma_f32_16x16x32_bf16 v[116:119], a[164:167], v[36:39], 0
    v_mfma_f32_16x16x32_bf16 v[120:123], a[172:175], v[36:39], 0
    v_mfma_f32_16x16x32_bf16 v[124:127], a[180:183], v[40:43], 0
    v_mfma_f32_16x16x32_bf16 v[128:131], a[186:189], v[40:43], 0
    v_mfma_f32_16x16x32_bf16 v[132:135], a[196:199], v[40:43], v[132:135]
    v_mfma_f32_16x16x32_bf16 v[116:119], a[168:171], v[40:43], v[116:119]
    v_mfma_f32_16x16x32_bf16 v[120:123], a[176:179], v[40:43], v[120:123]
    v_mfma_f32_16x16x16_bf16 v[136:139], a[206:207], v[44:45], v[136:139]
    s_nop 0
    v_mfma_f32_16x16x16_bf16 v[124:127], a[184:185], v[44:45], v[124:127]
    v_mfma_f32_16x16x16_bf16 v[128:131], a[190:191], v[44:45], v[128:131]
    v_mfma_f32_16x16x16_bf16 v[132:135], a[200:201], v[44:45], v[132:135]
    v_mfma_f32_16x16x32_bf16 v[160:163], a[240:243], v[46:49], 0
    v_mfma_f32_16x16x32_bf16 v[164:167], a[250:253], v[50:53], 0
    v_mfma_f32_16x16x32_bf16 v[140:143], a[208:211], v[46:49], 0
    v_mfma_f32_16x16x32_bf16 v[144:147], a[212:215], v[46:49], 0
    v_mfma_f32_16x16x32_bf16 v[148:151], a[220:223], v[46:49], 0
    v_mfma_f32_16x16x32_bf16 v[152:155], a[228:231], v[50:53], 0
    v_mfma_f32_16x16x32_bf16 v[156:159], a[234:237], v[50:53], 0
    v_mfma_f32_16x16x32_bf16 v[160:163], a[244:247], v[50:53], v[160:163]
    v_mfma_f32_16x16x32_bf16 v[144:147], a[216:219], v[50:53], v[144:147]
    v_mfma_f32_16x16x32_bf16 v[148:151], a[224:227], v[50:53], v[148:151]
    v_mfma_f32_16x16x16_bf16 v[164:167], a[254:255], v[54:55], v[164:167]
    s_nop 0
    v_mfma_f32_16x16x16_bf16 v[152:155], a[232:233], v[54:55], v[152:155]
    v_mfma_f32_16x16x16_bf16 v[156:159], a[238:239], v[54:55], v[156:159]
    v_mfma_f32_16x16x16_bf16 v[160:163], a[248:249], v[54:55], v[160:163]
    v_add_f32 v132, s54, v132
    v_add_f32 v133, s54, v133
    v_add_f32 v134, s54, v134
    v_add_f32 v135, s54, v135
    v_add_f32 v136, s54, v136
    v_rcp_f32 v132, v132
    v_rcp_f32 v133, v133
    v_rcp_f32 v134, v134
    v_rcp_f32 v135, v135
    v_rcp_f32 v136, v136
    v_mul_f32 v112, v112, v132
    v_mul_f32 v113, v113, v132
    v_mul_f32 v114, v114, v132
    v_mul_f32 v115, v115, v132
    v_cvt_pk_bf16_f32 v188, v112, v113
    v_cvt_pk_bf16_f32 v189, v114, v115
    v_mul_f32 v116, v116, v133
    v_mul_f32 v117, v117, v133
    v_mul_f32 v118, v118, v133
    v_mul_f32 v119, v119, v133
    v_cvt_pk_bf16_f32 v190, v116, v117
    v_cvt_pk_bf16_f32 v191, v118, v119
    v_mul_f32 v120, v120, v134
    v_mul_f32 v121, v121, v134
    v_mul_f32 v122, v122, v134
    v_mul_f32 v123, v123, v134
    v_cvt_pk_bf16_f32 v192, v120, v121
    v_cvt_pk_bf16_f32 v193, v122, v123
    v_mul_f32 v124, v124, v135
    v_mul_f32 v125, v125, v135
    v_mul_f32 v126, v126, v135
    v_mul_f32 v127, v127, v135
    v_cvt_pk_bf16_f32 v194, v124, v125
    v_cvt_pk_bf16_f32 v195, v126, v127
    v_mul_f32 v128, v128, v136
    v_mul_f32 v129, v129, v136
    v_mul_f32 v130, v130, v136
    v_mul_f32 v131, v131, v136
    v_cvt_pk_bf16_f32 v196, v128, v129
    v_cvt_pk_bf16_f32 v197, v130, v131
    v_add_f32 v160, s54, v160
    v_add_f32 v161, s54, v161
    v_add_f32 v162, s54, v162
    v_add_f32 v163, s54, v163
    v_add_f32 v164, s54, v164
    v_rcp_f32 v160, v160
    v_rcp_f32 v161, v161
    v_rcp_f32 v162, v162
    v_rcp_f32 v163, v163
    v_rcp_f32 v164, v164
    v_mul_f32 v140, v140, v160
    v_mul_f32 v141, v141, v160
    v_mul_f32 v142, v142, v160
    v_mul_f32 v143, v143, v160
    v_cvt_pk_bf16_f32 v198, v140, v141
    v_cvt_pk_bf16_f32 v199, v142, v143
    v_mul_f32 v144, v144, v161
    v_mul_f32 v145, v145, v161
    v_mul_f32 v146, v146, v161
    v_mul_f32 v147, v147, v161
    v_cvt_pk_bf16_f32 v200, v144, v145
    v_cvt_pk_bf16_f32 v201, v146, v147
    v_mul_f32 v148, v148, v162
    v_mul_f32 v149, v149, v162
    v_mul_f32 v150, v150, v162
    v_mul_f32 v151, v151, v162
    v_cvt_pk_bf16_f32 v202, v148, v149
    v_cvt_pk_bf16_f32 v203, v150, v151
    v_mul_f32 v152, v152, v163
    v_mul_f32 v153, v153, v163
    v_mul_f32 v154, v154, v163
    v_mul_f32 v155, v155, v163
    v_cvt_pk_bf16_f32 v204, v152, v153
    v_cvt_pk_bf16_f32 v205, v154, v155
    v_mul_f32 v156, v156, v164
    v_mul_f32 v157, v157, v164
    v_mul_f32 v158, v158, v164
    v_mul_f32 v159, v159, v164
    v_cvt_pk_bf16_f32 v206, v156, v157
    v_cvt_pk_bf16_f32 v207, v158, v159
    v_add_u32 v14, s42, v13
    ds_write_b128 v14, v[168:171] offset:0
    ds_write_b128 v14, v[172:175] offset:1024
    ds_write_b128 v14, v[176:179] offset:2048
    ds_write_b128 v14, v[180:183] offset:3072
    ds_write_b128 v14, v[184:187] offset:4096
    ds_write_b128 v14, v[188:191] offset:20480
    ds_write_b128 v14, v[192:195] offset:21504
    ds_write_b128 v14, v[196:199] offset:22528
    ds_write_b128 v14, v[200:203] offset:23552
    ds_write_b128 v14, v[204:207] offset:24576
    s_add_u32 s41, s43, s77
    s_add_u32 s24, s40, 1
    s_cmp_lt_u32 s24, s76
    s_cselect_b32 s41, s41, 2146435072
    s_waitcnt vmcnt(0)
    s_add_u32 s25, s41, 20480
    buffer_load_dwordx4 v[56:59], v8, s[8:11], s41 offen offset:0 sc1
    buffer_load_dwordx4 v[60:63], v8, s[8:11], s41 offen offset:1024 sc1
    buffer_load_dwordx2 v[64:65], v9, s[8:11], s41 offen offset:0 sc1
    buffer_load_dwordx4 v[66:69], v8, s[8:11], s41 offen offset:2560 sc1
    buffer_load_dwordx4 v[70:73], v8, s[8:11], s41 offen offset:3584 sc1
    buffer_load_dwordx2 v[74:75], v9, s[8:11], s41 offen offset:2560 sc1
    buffer_load_dwordx4 v[76:79], v8, s[8:11], s25 offen offset:0 sc1
    buffer_load_dwordx4 v[80:83], v8, s[8:11], s25 offen offset:1024 sc1
    buffer_load_dwordx2 v[84:85], v9, s[8:11], s25 offen offset:0 sc1
    buffer_load_dwordx4 v[86:89], v8, s[8:11], s25 offen offset:2560 sc1
    buffer_load_dwordx4 v[90:93], v8, s[8:11], s25 offen offset:3584 sc1
    buffer_load_dwordx2 v[94:95], v9, s[8:11], s25 offen offset:2560 sc1
    buffer_load_dwordx2 v[104:105], v10, s[16:19], s41 offen sc1
    buffer_load_dwordx2 v[106:107], v11, s[16:19], s41 offen sc1
    buffer_load_dwordx2 v[108:109], v10, s[16:19], s25 offen sc1
    buffer_load_dwordx2 v[110:111], v11, s[16:19], s25 offen sc1
    s_waitcnt lgkmcnt(0)
    s_barrier
    s_lshl_b32 s24, s92, 10
    s_lshl_b32 s25, s78, 2
    s_add_u32 s24, s24, s25
    s_add_u32 s24, s24, 23105536
    s_cmp_eq_u32 s3, 0
    s_cbranch_scc0 interleave_layers__linear_attn_block__memory_aug_recurrent_mem_tr__prompt_kernel_pb12
    v_lshlrev_b32 v14, 7, v1
    v_add_u32 v14, s24, v14
    v_mov_b32 v15, 2146435072
    v_cmp_le_u32 vcc, 8, v1
    s_nop 1
    v_cndmask_b32 v14, v14, v15, vcc
    v_mov_b32 v15, s40
    buffer_store_dword v15, v14, s[8:11], 0 offen sc1
interleave_layers__linear_attn_block__memory_aug_recurrent_mem_tr__prompt_kernel_pb12:
    s_branch interleave_layers__linear_attn_block__memory_aug_recurrent_mem_tr__prompt_kernel_k3_seg
interleave_layers__linear_attn_block__memory_aug_recurrent_mem_tr__prompt_kernel_k3_done:
    s_waitcnt vmcnt(0)
    s_barrier
    s_lshl_b32 s24, s92, 10
    s_lshl_b32 s25, s78, 2
    s_add_u32 s24, s24, s25
    s_add_u32 s24, s24, 23105536
    s_cmp_eq_u32 s3, 0
    s_cbranch_scc0 interleave_layers__linear_attn_block__memory_aug_recurrent_mem_tr__prompt_kernel_pb13
    v_lshlrev_b32 v14, 7, v1
    v_add_u32 v14, s24, v14
    v_mov_b32 v15, 2146435072
    v_cmp_le_u32 vcc, 8, v1
    s_nop 1
    v_cndmask_b32 v14, v14, v15, vcc
    v_mov_b32 v15, s40
    buffer_store_dword v15, v14, s[8:11], 0 offen sc1
interleave_layers__linear_attn_block__memory_aug_recurrent_mem_tr__prompt_kernel_pb13:
    s_cmp_eq_u32 s92, 0
    s_cbranch_scc0 interleave_layers__linear_attn_block__memory_aug_recurrent_mem_tr__prompt_kernel_end
    s_mov_b32 s92, 1
    s_cmp_lt_u32 s2, 248
    s_cbranch_scc1 interleave_layers__linear_attn_block__memory_aug_recurrent_mem_tr__prompt_kernel_helper_k1
    s_add_u32 s16, s4, 4194304
    s_addc_u32 s17, s5, 0
    s_mov_b32 s18, 2621440
    s_mov_b32 s19, 0x00020000
    s_mov_b32 s46, 1024
    s_mov_b32 s47, 8
    s_mov_b32 s50, 1
    s_mov_b32 s58, 8388608
    s_mov_b32 s76, 64
    s_mov_b32 s77, 40960
    s_branch interleave_layers__linear_attn_block__memory_aug_recurrent_mem_tr__prompt_kernel_k3_entry
interleave_layers__linear_attn_block__memory_aug_recurrent_mem_tr__prompt_kernel_helper_k1:
    s_mov_b32 s92, 1
    s_sub_u32 s24, s2, 232
    s_add_u32 s16, s4, 4194304
    s_addc_u32 s17, s5, 0
    s_mov_b32 s18, 2621440
    s_mov_b32 s19, 0x00020000
    s_mov_b32 s46, 1024
    s_mov_b32 s47, 8
    s_mov_b32 s50, 1
    s_and_b32 s44, s24, 7
    s_lshr_b32 s45, s24, 3
    s_mov_b32 s48, s45
    s_mov_b32 s49, 2
    s_mov_b32 s40, 32
    s_branch interleave_layers__linear_attn_block__memory_aug_recurrent_mem_tr__prompt_kernel_k1_entry
interleave_layers__linear_attn_block__memory_aug_recurrent_mem_tr__prompt_kernel_helper_clr:
    s_sub_u32 s44, s2, 253
    s_lshl_b32 s24, s44, 2
    s_add_u32 s24, s24, s3
    s_mul_i32 s24, s24, 38912
    s_add_u32 s41, s24, 117440512
    v_lshlrev_b32 v5, 4, v1
    v_mov_b32 v8, -1
    v_mov_b32 v9, -1
    v_mov_b32 v10, -1
    v_mov_b32 v11, -1
    s_lshl_b32 s24, s44, 2
    s_add_u32 s42, s24, 23109632
    s_mov_b32 s40, 0
interleave_layers__linear_attn_block__memory_aug_recurrent_mem_tr__prompt_kernel_clr_blk:
    s_mov_b32 s43, s41
    buffer_store_dwordx4 v[8:11], v5, s[8:11], s43 offen offset:0 sc1
    buffer_store_dwordx4 v[8:11], v5, s[8:11], s43 offen offset:1024 sc1
    buffer_store_dwordx4 v[8:11], v5, s[8:11], s43 offen offset:2048 sc1
    buffer_store_dwordx4 v[8:11], v5, s[8:11], s43 offen offset:3072 sc1
    s_add_u32 s43, s43, 4096
    buffer_store_dwordx4 v[8:11], v5, s[8:11], s43 offen offset:0 sc1
    buffer_store_dwordx4 v[8:11], v5, s[8:11], s43 offen offset:1024 sc1
    buffer_store_dwordx4 v[8:11], v5, s[8:11], s43 offen offset:2048 sc1
    buffer_store_dwordx4 v[8:11], v5, s[8:11], s43 offen offset:3072 sc1
    s_add_u32 s43, s43, 4096
    buffer_store_dwordx4 v[8:11], v5, s[8:11], s43 offen offset:0 sc1
    buffer_store_dwordx4 v[8:11], v5, s[8:11], s43 offen offset:1024 sc1
    buffer_store_dwordx4 v[8:11], v5, s[8:11], s43 offen offset:2048 sc1
    buffer_store_dwordx4 v[8:11], v5, s[8:11], s43 offen offset:3072 sc1
    s_add_u32 s43, s43, 4096
    buffer_store_dwordx4 v[8:11], v5, s[8:11], s43 offen offset:0 sc1
    buffer_store_dwordx4 v[8:11], v5, s[8:11], s43 offen offset:1024 sc1
    buffer_store_dwordx4 v[8:11], v5, s[8:11], s43 offen offset:2048 sc1
    buffer_store_dwordx4 v[8:11], v5, s[8:11], s43 offen offset:3072 sc1
    s_add_u32 s43, s43, 4096
    buffer_store_dwordx4 v[8:11], v5, s[8:11], s43 offen offset:0 sc1
    buffer_store_dwordx4 v[8:11], v5, s[8:11], s43 offen offset:1024 sc1
    buffer_store_dwordx4 v[8:11], v5, s[8:11], s43 offen offset:2048 sc1
    buffer_store_dwordx4 v[8:11], v5, s[8:11], s43 offen offset:3072 sc1
    s_add_u32 s43, s43, 4096
    buffer_store_dwordx4 v[8:11], v5, s[8:11], s43 offen offset:0 sc1
    buffer_store_dwordx4 v[8:11], v5, s[8:11], s43 offen offset:1024 sc1
    buffer_store_dwordx4 v[8:11], v5, s[8:11], s43 offen offset:2048 sc1
    buffer_store_dwordx4 v[8:11], v5, s[8:11], s43 offen offset:3072 sc1
    s_add_u32 s43, s43, 4096
    buffer_store_dwordx4 v[8:11], v5, s[8:11], s43 offen offset:0 sc1
    buffer_store_dwordx4 v[8:11], v5, s[8:11], s43 offen offset:1024 sc1
    buffer_store_dwordx4 v[8:11], v5, s[8:11], s43 offen offset:2048 sc1
    buffer_store_dwordx4 v[8:11], v5, s[8:11], s43 offen offset:3072 sc1
    s_add_u32 s43, s43, 4096
    buffer_store_dwordx4 v[8:11], v5, s[8:11], s43 offen offset:0 sc1
    buffer_store_dwordx4 v[8:11], v5, s[8:11], s43 offen offset:1024 sc1
    buffer_store_dwordx4 v[8:11], v5, s[8:11], s43 offen offset:2048 sc1
    buffer_store_dwordx4 v[8:11], v5, s[8:11], s43 offen offset:3072 sc1
    s_add_u32 s43, s43, 4096
    buffer_store_dwordx4 v[8:11], v5, s[8:11], s43 offen offset:0 sc1
    buffer_store_dwordx4 v[8:11], v5, s[8:11], s43 offen offset:1024 sc1
    buffer_store_dwordx4 v[8:11], v5, s[8:11], s43 offen offset:2048 sc1
    buffer_store_dwordx4 v[8:11], v5, s[8:11], s43 offen offset:3072 sc1
    s_add_u32 s43, s43, 4096
    buffer_store_dwordx4 v[8:11], v5, s[8:11], s43 offen offset:0 sc1
    buffer_store_dwordx4 v[8:11], v5, s[8:11], s43 offen offset:1024 sc1
    s_waitcnt vmcnt(38)
    s_barrier
    s_cmp_eq_u32 s3, 0
    s_cbranch_scc0 interleave_layers__linear_attn_block__memory_aug_recurrent_mem_tr__prompt_kernel_pb14
    v_lshlrev_b32 v14, 7, v1
    v_add_u32 v14, s42, v14
    v_mov_b32 v15, 2146435072
    v_cmp_le_u32 vcc, 8, v1
    s_nop 1
    v_cndmask_b32 v14, v14, v15, vcc
    v_mov_b32 v15, s40
    buffer_store_dword v15, v14, s[8:11], 0 offen sc1
interleave_layers__linear_attn_block__memory_aug_recurrent_mem_tr__prompt_kernel_pb14:
    s_add_u32 s40, s40, 1
    s_add_u32 s41, s41, 458752
    s_cmp_lt_u32 s40, 128
    s_cbranch_scc1 interleave_layers__linear_attn_block__memory_aug_recurrent_mem_tr__prompt_kernel_clr_blk
    s_waitcnt vmcnt(0)
    s_barrier
    s_cmp_eq_u32 s3, 0
    s_cbranch_scc0 interleave_layers__linear_attn_block__memory_aug_recurrent_mem_tr__prompt_kernel_pb15
    v_lshlrev_b32 v14, 7, v1
    v_add_u32 v14, s42, v14
    v_mov_b32 v15, 2146435072
    v_cmp_le_u32 vcc, 8, v1
    s_nop 1
    v_cndmask_b32 v14, v14, v15, vcc
    v_mov_b32 v15, s40
    buffer_store_dword v15, v14, s[8:11], 0 offen sc1
interleave_layers__linear_attn_block__memory_aug_recurrent_mem_tr__prompt_kernel_pb15:
    s_branch interleave_layers__linear_attn_block__memory_aug_recurrent_mem_tr__prompt_kernel_end
interleave_layers__linear_attn_block__memory_aug_recurrent_mem_tr__prompt_kernel_roleS:
    s_mov_b32 s44, s2
    s_load_dwordx2 s[6:7], s[0:1], 40
    s_load_dwordx2 s[24:25], s[0:1], 48
    s_load_dwordx2 s[26:27], s[0:1], 32
    s_waitcnt lgkmcnt(0)
    s_mov_b32 s12, s6
    s_mov_b32 s13, s7
    s_mov_b32 s14, 7864320
    s_mov_b32 s15, 0x00020000
    s_mov_b32 s16, s24
    s_mov_b32 s17, s25
    s_mov_b32 s18, 7864320
    s_mov_b32 s19, 0x00020000
    s_mov_b32 s20, s26
    s_mov_b32 s21, s27
    s_mov_b32 s22, 10240
    s_mov_b32 s23, 0x00020000
    v_add_u32 v16, 0, v0
    s_mov_b32 s24, 683
    v_mul_lo_u32 v17, v16, s24
    v_lshrrev_b32 v17, 14, v17
    v_mul_u32_u24 v18, 24, v17
    v_sub_u32 v18, v16, v18
    s_mov_b32 s24, 12288
    v_mul_lo_u32 v4, v17, s24
    v_lshl_add_u32 v4, v18, 4, v4
    v_mul_u32_u24 v10, 400, v17
    v_lshl_add_u32 v10, v18, 4, v10
    v_add_u32 v10, 106496, v10
    v_add_u32 v16, 256, v0
    s_mov_b32 s24, 683
    v_mul_lo_u32 v17, v16, s24
    v_lshrrev_b32 v17, 14, v17
    v_mul_u32_u24 v18, 24, v17
    v_sub_u32 v18, v16, v18
    s_mov_b32 s24, 12288
    v_mul_lo_u32 v5, v17, s24
    v_lshl_add_u32 v5, v18, 4, v5
    v_mul_u32_u24 v11, 400, v17
    v_lshl_add_u32 v11, v18, 4, v11
    v_add_u32 v11, 106496, v11
    v_add_u32 v16, 512, v0
    s_mov_b32 s24, 683
    v_mul_lo_u32 v17, v16, s24
    v_lshrrev_b32 v17, 14, v17
    v_mul_u32_u24 v18, 24, v17
    v_sub_u32 v18, v16, v18
    s_mov_b32 s24, 12288
    v_mul_lo_u32 v6, v17, s24
    v_lshl_add_u32 v6, v18, 4, v6
    v_mul_u32_u24 v12, 400, v17
    v_lshl_add_u32 v12, v18, 4, v12
    v_add_u32 v12, 106496, v12
    v_add_u32 v16, 768, v0
    s_mov_b32 s24, 683
    v_mul_lo_u32 v17, v16, s24
    v_lshrrev_b32 v17, 14, v17
    v_mul_u32_u24 v18, 24, v17
    v_sub_u32 v18, v16, v18
    s_mov_b32 s24, 12288
    v_mul_lo_u32 v7, v17, s24
    v_lshl_add_u32 v7, v18, 4, v7
    v_mul_u32_u24 v13, 400, v17
    v_lshl_add_u32 v13, v18, 4, v13
    v_add_u32 v13, 106496, v13
    v_add_u32 v16, 1024, v0
    s_mov_b32 s24, 683
    v_mul_lo_u32 v17, v16, s24
    v_lshrrev_b32 v17, 14, v17
    v_mul_u32_u24 v18, 24, v17
    v_sub_u32 v18, v16, v18
    s_mov_b32 s24, 12288
    v_mul_lo_u32 v8, v17, s24
    v_lshl_add_u32 v8, v18, 4, v8
    v_mul_u32_u24 v14, 400, v17
    v_lshl_add_u32 v14, v18, 4, v14
    v_add_u32 v14, 106496, v14
    v_add_u32 v16, 1280, v0
    s_mov_b32 s24, 683
    v_mul_lo_u32 v17, v16, s24
    v_lshrrev_b32 v17, 14, v17
    v_mul_u32_u24 v18, 24, v17
    v_sub_u32 v18, v16, v18
    s_mov_b32 s24, 12288
    v_mul_lo_u32 v9, v17, s24
    v_lshl_add_u32 v9, v18, 4, v9
    v_mul_u32_u24 v15, 400, v17
    v_lshl_add_u32 v15, v18, 4, v15
    v_add_u32 v15, 106496, v15
    v_lshrrev_b32 v17, 1, v3
    v_lshlrev_b32 v17, 4, v17
    v_and_b32 v18, 1, v3
    v_lshl_add_u32 v17, v18, 2, v17
    v_lshrrev_b32 v18, 2, v2
    v_and_b32 v19, 1, v18
    v_add_u32 v17, v17, v19
    v_lshrrev_b32 v18, 1, v18
    v_lshl_add_u32 v17, v18, 3, v17
    v_mul_u32_u24 v16, 400, v17
    v_and_b32 v18, 3, v2
    v_lshl_add_u32 v16, v18, 3, v16
    v_add_u32 v16, 106496, v16
    s_mul_i32 s24, s3, 96
    v_add_u32 v16, s24, v16
    v_lshlrev_b32 v17, 4, v1
    s_mul_i32 s24, s3, 20480
    s_add_u32 s24, s24, 24576
    v_add_u32 v17, s24, v17
    s_mul_i32 s45, s44, 384
    s_add_u32 s46, s45, 0
    buffer_load_dwordx4 v[24:27], v4, s[12:15], s46 offen
    buffer_load_dwordx4 v[28:31], v5, s[12:15], s46 offen
    buffer_load_dwordx4 v[32:35], v6, s[12:15], s46 offen
    buffer_load_dwordx4 v[36:39], v7, s[12:15], s46 offen
    buffer_load_dwordx4 v[40:43], v8, s[12:15], s46 offen
    buffer_load_dwordx4 v[44:47], v9, s[12:15], s46 offen
    s_add_u32 s46, s45, 0
    buffer_load_dwordx4 v[48:51], v4, s[16:19], s46 offen
    buffer_load_dwordx4 v[52:55], v5, s[16:19], s46 offen
    buffer_load_dwordx4 v[56:59], v6, s[16:19], s46 offen
    buffer_load_dwordx4 v[60:63], v7, s[16:19], s46 offen
    buffer_load_dwordx4 v[64:67], v8, s[16:19], s46 offen
    buffer_load_dwordx4 v[68:71], v9, s[16:19], s46 offen
    s_waitcnt vmcnt(6)
    ds_write_b128 v10, v[24:27]
    ds_write_b128 v11, v[28:31]
    ds_write_b128 v12, v[32:35]
    ds_write_b128 v13, v[36:39]
    ds_write_b128 v14, v[40:43]
    ds_write_b128 v15, v[44:47]
    s_add_u32 s46, s45, 786432
    buffer_load_dwordx4 v[72:75], v4, s[12:15], s46 offen
    buffer_load_dwordx4 v[76:79], v5, s[12:15], s46 offen
    buffer_load_dwordx4 v[80:83], v6, s[12:15], s46 offen
    buffer_load_dwordx4 v[84:87], v7, s[12:15], s46 offen
    buffer_load_dwordx4 v[88:91], v8, s[12:15], s46 offen
    buffer_load_dwordx4 v[92:95], v9, s[12:15], s46 offen
    s_waitcnt lgkmcnt(0)
    s_barrier
    ds_read_b64_tr_b16 a[0:1], v16 offset:0
    ds_read_b64_tr_b16 a[2:3], v16 offset:800
    ds_read_b64_tr_b16 a[4:5], v16 offset:12800
    ds_read_b64_tr_b16 a[6:7], v16 offset:13600
    ds_read_b64_tr_b16 a[80:81], v16 offset:32
    ds_read_b64_tr_b16 a[82:83], v16 offset:832
    ds_read_b64_tr_b16 a[84:85], v16 offset:12832
    ds_read_b64_tr_b16 a[86:87], v16 offset:13632
    ds_read_b64_tr_b16 a[160:161], v16 offset:64
    ds_read_b64_tr_b16 a[162:163], v16 offset:864
    ds_read_b64_tr_b16 a[164:165], v16 offset:12864
    ds_read_b64_tr_b16 a[166:167], v16 offset:13664
    s_waitcnt lgkmcnt(0)
    s_barrier
    s_waitcnt vmcnt(6)
    ds_write_b128 v10, v[48:51]
    ds_write_b128 v11, v[52:55]
    ds_write_b128 v12, v[56:59]
    ds_write_b128 v13, v[60:63]
    ds_write_b128 v14, v[64:67]
    ds_write_b128 v15, v[68:71]
    s_add_u32 s46, s45, 786432
    buffer_load_dwordx4 v[24:27], v4, s[16:19], s46 offen
    buffer_load_dwordx4 v[28:31], v5, s[16:19], s46 offen
    buffer_load_dwordx4 v[32:35], v6, s[16:19], s46 offen
    buffer_load_dwordx4 v[36:39], v7, s[16:19], s46 offen
    buffer_load_dwordx4 v[40:43], v8, s[16:19], s46 offen
    buffer_load_dwordx4 v[44:47], v9, s[16:19], s46 offen
    s_waitcnt lgkmcnt(0)
    s_barrier
    ds_read_b64_tr_b16 v[96:97], v16 offset:32
    ds_read_b64_tr_b16 v[98:99], v16 offset:832
    ds_read_b64_tr_b16 v[100:101], v16 offset:12832
    ds_read_b64_tr_b16 v[102:103], v16 offset:13632
    ds_read_b64_tr_b16 v[176:177], v16 offset:64
    ds_read_b64_tr_b16 v[178:179], v16 offset:864
    ds_read_b64_tr_b16 v[180:181], v16 offset:12864
    ds_read_b64_tr_b16 v[182:183], v16 offset:13664
    ds_read_b64_tr_b16 v[48:49], v16 offset:0
    ds_read_b64_tr_b16 v[50:51], v16 offset:800
    ds_read_b64_tr_b16 v[52:53], v16 offset:12800
    ds_read_b64_tr_b16 v[54:55], v16 offset:13600
    s_waitcnt lgkmcnt(0)
    ds_write_b128 v17, v[48:51] offset:0
    ds_write_b128 v17, v[52:55] offset:1024
    s_waitcnt lgkmcnt(0)
    s_barrier
    s_waitcnt vmcnt(6)
    ds_write_b128 v10, v[72:75]
    ds_write_b128 v11, v[76:79]
    ds_write_b128 v12, v[80:83]
    ds_write_b128 v13, v[84:87]
    ds_write_b128 v14, v[88:91]
    ds_write_b128 v15, v[92:95]
    s_add_u32 s46, s45, 1572864
    buffer_load_dwordx4 v[48:51], v4, s[12:15], s46 offen
    buffer_load_dwordx4 v[52:55], v5, s[12:15], s46 offen
    buffer_load_dwordx4 v[56:59], v6, s[12:15], s46 offen
    buffer_load_dwordx4 v[60:63], v7, s[12:15], s46 offen
    buffer_load_dwordx4 v[64:67], v8, s[12:15], s46 offen
    buffer_load_dwordx4 v[68:71], v9, s[12:15], s46 offen
    s_waitcnt lgkmcnt(0)
    s_barrier
    ds_read_b64_tr_b16 a[8:9], v16 offset:0
    ds_read_b64_tr_b16 a[10:11], v16 offset:800
    ds_read_b64_tr_b16 a[12:13], v16 offset:12800
    ds_read_b64_tr_b16 a[14:15], v16 offset:13600
    ds_read_b64_tr_b16 a[88:89], v16 offset:32
    ds_read_b64_tr_b16 a[90:91], v16 offset:832
    ds_read_b64_tr_b16 a[92:93], v16 offset:12832
    ds_read_b64_tr_b16 a[94:95], v16 offset:13632
    ds_read_b64_tr_b16 a[168:169], v16 offset:64
    ds_read_b64_tr_b16 a[170:171], v16 offset:864
    ds_read_b64_tr_b16 a[172:173], v16 offset:12864
    ds_read_b64_tr_b16 a[174:175], v16 offset:13664
    s_waitcnt lgkmcnt(0)
    s_barrier
    s_waitcnt vmcnt(6)
    ds_write_b128 v10, v[24:27]
    ds_write_b128 v11, v[28:31]
    ds_write_b128 v12, v[32:35]
    ds_write_b128 v13, v[36:39]
    ds_write_b128 v14, v[40:43]
    ds_write_b128 v15, v[44:47]
    s_add_u32 s46, s45, 1572864
    buffer_load_dwordx4 v[72:75], v4, s[16:19], s46 offen
    buffer_load_dwordx4 v[76:79], v5, s[16:19], s46 offen
    buffer_load_dwordx4 v[80:83], v6, s[16:19], s46 offen
    buffer_load_dwordx4 v[84:87], v7, s[16:19], s46 offen
    buffer_load_dwordx4 v[88:91], v8, s[16:19], s46 offen
    buffer_load_dwordx4 v[92:95], v9, s[16:19], s46 offen
    s_waitcnt lgkmcnt(0)
    s_barrier
    ds_read_b64_tr_b16 v[104:105], v16 offset:32
    ds_read_b64_tr_b16 v[106:107], v16 offset:832
    ds_read_b64_tr_b16 v[108:109], v16 offset:12832
    ds_read_b64_tr_b16 v[110:111], v16 offset:13632
    ds_read_b64_tr_b16 v[184:185], v16 offset:64
    ds_read_b64_tr_b16 v[186:187], v16 offset:864
    ds_read_b64_tr_b16 v[188:189], v16 offset:12864
    ds_read_b64_tr_b16 v[190:191], v16 offset:13664
    ds_read_b64_tr_b16 v[24:25], v16 offset:0
    ds_read_b64_tr_b16 v[26:27], v16 offset:800
    ds_read_b64_tr_b16 v[28:29], v16 offset:12800
    ds_read_b64_tr_b16 v[30:31], v16 offset:13600
    s_waitcnt lgkmcnt(0)
    ds_write_b128 v17, v[24:27] offset:2048
    ds_write_b128 v17, v[28:31] offset:3072
    s_waitcnt lgkmcnt(0)
    s_barrier
    s_waitcnt vmcnt(6)
    ds_write_b128 v10, v[48:51]
    ds_write_b128 v11, v[52:55]
    ds_write_b128 v12, v[56:59]
    ds_write_b128 v13, v[60:63]
    ds_write_b128 v14, v[64:67]
    ds_write_b128 v15, v[68:71]
    s_add_u32 s46, s45, 2359296
    buffer_load_dwordx4 v[24:27], v4, s[12:15], s46 offen
    buffer_load_dwordx4 v[28:31], v5, s[12:15], s46 offen
    buffer_load_dwordx4 v[32:35], v6, s[12:15], s46 offen
    buffer_load_dwordx4 v[36:39], v7, s[12:15], s46 offen
    buffer_load_dwordx4 v[40:43], v8, s[12:15], s46 offen
    buffer_load_dwordx4 v[44:47], v9, s[12:15], s46 offen
    s_waitcnt lgkmcnt(0)
    s_barrier
    ds_read_b64_tr_b16 a[16:17], v16 offset:0
    ds_read_b64_tr_b16 a[18:19], v16 offset:800
    ds_read_b64_tr_b16 a[20:21], v16 offset:12800
    ds_read_b64_tr_b16 a[22:23], v16 offset:13600
    ds_read_b64_tr_b16 a[96:97], v16 offset:32
    ds_read_b64_tr_b16 a[98:99], v16 offset:832
    ds_read_b64_tr_b16 a[100:101], v16 offset:12832
    ds_read_b64_tr_b16 a[102:103], v16 offset:13632
    ds_read_b64_tr_b16 a[176:177], v16 offset:64
    ds_read_b64_tr_b16 a[178:179], v16 offset:864
    ds_read_b64_tr_b16 a[180:181], v16 offset:12864
    ds_read_b64_tr_b16 a[182:183], v16 offset:13664
    s_waitcnt lgkmcnt(0)
    s_barrier
    s_waitcnt vmcnt(6)
    ds_write_b128 v10, v[72:75]
    ds_write_b128 v11, v[76:79]
    ds_write_b128 v12, v[80:83]
    ds_write_b128 v13, v[84:87]
    ds_write_b128 v14, v[88:91]
    ds_write_b128 v15, v[92:95]
    s_add_u32 s46, s45, 2359296
    buffer_load_dwordx4 v[48:51], v4, s[16:19], s46 offen
    buffer_load_dwordx4 v[52:55], v5, s[16:19], s46 offen
    buffer_load_dwordx4 v[56:59], v6, s[16:19], s46 offen
    buffer_load_dwordx4 v[60:63], v7, s[16:19], s46 offen
    buffer_load_dwordx4 v[64:67], v8, s[16:19], s46 offen
    buffer_load_dwordx4 v[68:71], v9, s[16:19], s46 offen
    s_waitcnt lgkmcnt(0)
    s_barrier
    ds_read_b64_tr_b16 v[112:113], v16 offset:32
    ds_read_b64_tr_b16 v[114:115], v16 offset:832
    ds_read_b64_tr_b16 v[116:117], v16 offset:12832
    ds_read_b64_tr_b16 v[118:119], v16 offset:13632
    ds_read_b64_tr_b16 v[192:193], v16 offset:64
    ds_read_b64_tr_b16 v[194:195], v16 offset:864
    ds_read_b64_tr_b16 v[196:197], v16 offset:12864
    ds_read_b64_tr_b16 v[198:199], v16 offset:13664
    ds_read_b64_tr_b16 v[72:73], v16 offset:0
    ds_read_b64_tr_b16 v[74:75], v16 offset:800
    ds_read_b64_tr_b16 v[76:77], v16 offset:12800
    ds_read_b64_tr_b16 v[78:79], v16 offset:13600
    s_waitcnt lgkmcnt(0)
    ds_write_b128 v17, v[72:75] offset:4096
    ds_write_b128 v17, v[76:79] offset:5120
    s_waitcnt lgkmcnt(0)
    s_barrier
    s_waitcnt vmcnt(6)
    ds_write_b128 v10, v[24:27]
    ds_write_b128 v11, v[28:31]
    ds_write_b128 v12, v[32:35]
    ds_write_b128 v13, v[36:39]
    ds_write_b128 v14, v[40:43]
    ds_write_b128 v15, v[44:47]
    s_add_u32 s46, s45, 3145728
    buffer_load_dwordx4 v[72:75], v4, s[12:15], s46 offen
    buffer_load_dwordx4 v[76:79], v5, s[12:15], s46 offen
    buffer_load_dwordx4 v[80:83], v6, s[12:15], s46 offen
    buffer_load_dwordx4 v[84:87], v7, s[12:15], s46 offen
    buffer_load_dwordx4 v[88:91], v8, s[12:15], s46 offen
    buffer_load_dwordx4 v[92:95], v9, s[12:15], s46 offen
    s_waitcnt lgkmcnt(0)
    s_barrier
    ds_read_b64_tr_b16 a[24:25], v16 offset:0
    ds_read_b64_tr_b16 a[26:27], v16 offset:800
    ds_read_b64_tr_b16 a[28:29], v16 offset:12800
    ds_read_b64_tr_b16 a[30:31], v16 offset:13600
    ds_read_b64_tr_b16 a[104:105], v16 offset:32
    ds_read_b64_tr_b16 a[106:107], v16 offset:832
    ds_read_b64_tr_b16 a[108:109], v16 offset:12832
    ds_read_b64_tr_b16 a[110:111], v16 offset:13632
    ds_read_b64_tr_b16 a[184:185], v16 offset:64
    ds_read_b64_tr_b16 a[186:187], v16 offset:864
    ds_read_b64_tr_b16 a[188:189], v16 offset:12864
    ds_read_b64_tr_b16 a[190:191], v16 offset:13664
    s_waitcnt lgkmcnt(0)
    s_barrier
    s_waitcnt vmcnt(6)
    ds_write_b128 v10, v[48:51]
    ds_write_b128 v11, v[52:55]
    ds_write_b128 v12, v[56:59]
    ds_write_b128 v13, v[60:63]
    ds_write_b128 v14, v[64:67]
    ds_write_b128 v15, v[68:71]
    s_add_u32 s46, s45, 3145728
    buffer_load_dwordx4 v[24:27], v4, s[16:19], s46 offen
    buffer_load_dwordx4 v[28:31], v5, s[16:19], s46 offen
    buffer_load_dwordx4 v[32:35], v6, s[16:19], s46 offen
    buffer_load_dwordx4 v[36:39], v7, s[16:19], s46 offen
    buffer_load_dwordx4 v[40:43], v8, s[16:19], s46 offen
    buffer_load_dwordx4 v[44:47], v9, s[16:19], s46 offen
    s_waitcnt lgkmcnt(0)
    s_barrier
    ds_read_b64_tr_b16 v[120:121], v16 offset:32
    ds_read_b64_tr_b16 v[122:123], v16 offset:832
    ds_read_b64_tr_b16 v[124:125], v16 offset:12832
    ds_read_b64_tr_b16 v[126:127], v16 offset:13632
    ds_read_b64_tr_b16 v[200:201], v16 offset:64
    ds_read_b64_tr_b16 v[202:203], v16 offset:864
    ds_read_b64_tr_b16 v[204:205], v16 offset:12864
    ds_read_b64_tr_b16 v[206:207], v16 offset:13664
    ds_read_b64_tr_b16 v[48:49], v16 offset:0
    ds_read_b64_tr_b16 v[50:51], v16 offset:800
    ds_read_b64_tr_b16 v[52:53], v16 offset:12800
    ds_read_b64_tr_b16 v[54:55], v16 offset:13600
    s_waitcnt lgkmcnt(0)
    ds_write_b128 v17, v[48:51] offset:6144
    ds_write_b128 v17, v[52:55] offset:7168
    s_waitcnt lgkmcnt(0)
    s_barrier
    s_waitcnt vmcnt(6)
    ds_write_b128 v10, v[72:75]
    ds_write_b128 v11, v[76:79]
    ds_write_b128 v12, v[80:83]
    ds_write_b128 v13, v[84:87]
    ds_write_b128 v14, v[88:91]
    ds_write_b128 v15, v[92:95]
    s_add_u32 s46, s45, 3932160
    buffer_load_dwordx4 v[48:51], v4, s[12:15], s46 offen
    buffer_load_dwordx4 v[52:55], v5, s[12:15], s46 offen
    buffer_load_dwordx4 v[56:59], v6, s[12:15], s46 offen
    buffer_load_dwordx4 v[60:63], v7, s[12:15], s46 offen
    buffer_load_dwordx4 v[64:67], v8, s[12:15], s46 offen
    buffer_load_dwordx4 v[68:71], v9, s[12:15], s46 offen
    s_waitcnt lgkmcnt(0)
    s_barrier
    ds_read_b64_tr_b16 a[32:33], v16 offset:0
    ds_read_b64_tr_b16 a[34:35], v16 offset:800
    ds_read_b64_tr_b16 a[36:37], v16 offset:12800
    ds_read_b64_tr_b16 a[38:39], v16 offset:13600
    ds_read_b64_tr_b16 a[112:113], v16 offset:32
    ds_read_b64_tr_b16 a[114:115], v16 offset:832
    ds_read_b64_tr_b16 a[116:117], v16 offset:12832
    ds_read_b64_tr_b16 a[118:119], v16 offset:13632
    ds_read_b64_tr_b16 a[192:193], v16 offset:64
    ds_read_b64_tr_b16 a[194:195], v16 offset:864
    ds_read_b64_tr_b16 a[196:197], v16 offset:12864
    ds_read_b64_tr_b16 a[198:199], v16 offset:13664
    s_waitcnt lgkmcnt(0)
    s_barrier
    s_waitcnt vmcnt(6)
    ds_write_b128 v10, v[24:27]
    ds_write_b128 v11, v[28:31]
    ds_write_b128 v12, v[32:35]
    ds_write_b128 v13, v[36:39]
    ds_write_b128 v14, v[40:43]
    ds_write_b128 v15, v[44:47]
    s_add_u32 s46, s45, 3932160
    buffer_load_dwordx4 v[72:75], v4, s[16:19], s46 offen
    buffer_load_dwordx4 v[76:79], v5, s[16:19], s46 offen
    buffer_load_dwordx4 v[80:83], v6, s[16:19], s46 offen
    buffer_load_dwordx4 v[84:87], v7, s[16:19], s46 offen
    buffer_load_dwordx4 v[88:91], v8, s[16:19], s46 offen
    buffer_load_dwordx4 v[92:95], v9, s[16:19], s46 offen
    s_waitcnt lgkmcnt(0)
    s_barrier
    ds_read_b64_tr_b16 v[128:129], v16 offset:32
    ds_read_b64_tr_b16 v[130:131], v16 offset:832
    ds_read_b64_tr_b16 v[132:133], v16 offset:12832
    ds_read_b64_tr_b16 v[134:135], v16 offset:13632
    ds_read_b64_tr_b16 v[208:209], v16 offset:64
    ds_read_b64_tr_b16 v[210:211], v16 offset:864
    ds_read_b64_tr_b16 v[212:213], v16 offset:12864
    ds_read_b64_tr_b16 v[214:215], v16 offset:13664
    ds_read_b64_tr_b16 v[24:25], v16 offset:0
    ds_read_b64_tr_b16 v[26:27], v16 offset:800
    ds_read_b64_tr_b16 v[28:29], v16 offset:12800
    ds_read_b64_tr_b16 v[30:31], v16 offset:13600
    s_waitcnt lgkmcnt(0)
    ds_write_b128 v17, v[24:27] offset:8192
    ds_write_b128 v17, v[28:31] offset:9216
    s_waitcnt lgkmcnt(0)
    s_barrier
    s_waitcnt vmcnt(6)
    ds_write_b128 v10, v[48:51]
    ds_write_b128 v11, v[52:55]
    ds_write_b128 v12, v[56:59]
    ds_write_b128 v13, v[60:63]
    ds_write_b128 v14, v[64:67]
    ds_write_b128 v15, v[68:71]
    s_add_u32 s46, s45, 4718592
    buffer_load_dwordx4 v[24:27], v4, s[12:15], s46 offen
    buffer_load_dwordx4 v[28:31], v5, s[12:15], s46 offen
    buffer_load_dwordx4 v[32:35], v6, s[12:15], s46 offen
    buffer_load_dwordx4 v[36:39], v7, s[12:15], s46 offen
    buffer_load_dwordx4 v[40:43], v8, s[12:15], s46 offen
    buffer_load_dwordx4 v[44:47], v9, s[12:15], s46 offen
    s_waitcnt lgkmcnt(0)
    s_barrier
    ds_read_b64_tr_b16 a[40:41], v16 offset:0
    ds_read_b64_tr_b16 a[42:43], v16 offset:800
    ds_read_b64_tr_b16 a[44:45], v16 offset:12800
    ds_read_b64_tr_b16 a[46:47], v16 offset:13600
    ds_read_b64_tr_b16 a[120:121], v16 offset:32
    ds_read_b64_tr_b16 a[122:123], v16 offset:832
    ds_read_b64_tr_b16 a[124:125], v16 offset:12832
    ds_read_b64_tr_b16 a[126:127], v16 offset:13632
    ds_read_b64_tr_b16 a[200:201], v16 offset:64
    ds_read_b64_tr_b16 a[202:203], v16 offset:864
    ds_read_b64_tr_b16 a[204:205], v16 offset:12864
    ds_read_b64_tr_b16 a[206:207], v16 offset:13664
    s_waitcnt lgkmcnt(0)
    s_barrier
    s_waitcnt vmcnt(6)
    ds_write_b128 v10, v[72:75]
    ds_write_b128 v11, v[76:79]
    ds_write_b128 v12, v[80:83]
    ds_write_b128 v13, v[84:87]
    ds_write_b128 v14, v[88:91]
    ds_write_b128 v15, v[92:95]
    s_add_u32 s46, s45, 4718592
    buffer_load_dwordx4 v[48:51], v4, s[16:19], s46 offen
    buffer_load_dwordx4 v[52:55], v5, s[16:19], s46 offen
    buffer_load_dwordx4 v[56:59], v6, s[16:19], s46 offen
    buffer_load_dwordx4 v[60:63], v7, s[16:19], s46 offen
    buffer_load_dwordx4 v[64:67], v8, s[16:19], s46 offen
    buffer_load_dwordx4 v[68:71], v9, s[16:19], s46 offen
    s_waitcnt lgkmcnt(0)
    s_barrier
    ds_read_b64_tr_b16 v[136:137], v16 offset:32
    ds_read_b64_tr_b16 v[138:139], v16 offset:832
    ds_read_b64_tr_b16 v[140:141], v16 offset:12832
    ds_read_b64_tr_b16 v[142:143], v16 offset:13632
    ds_read_b64_tr_b16 v[216:217], v16 offset:64
    ds_read_b64_tr_b16 v[218:219], v16 offset:864
    ds_read_b64_tr_b16 v[220:221], v16 offset:12864
    ds_read_b64_tr_b16 v[222:223], v16 offset:13664
    ds_read_b64_tr_b16 v[72:73], v16 offset:0
    ds_read_b64_tr_b16 v[74:75], v16 offset:800
    ds_read_b64_tr_b16 v[76:77], v16 offset:12800
    ds_read_b64_tr_b16 v[78:79], v16 offset:13600
    s_waitcnt lgkmcnt(0)
    ds_write_b128 v17, v[72:75] offset:10240
    ds_write_b128 v17, v[76:79] offset:11264
    s_waitcnt lgkmcnt(0)
    s_barrier
    s_waitcnt vmcnt(6)
    ds_write_b128 v10, v[24:27]
    ds_write_b128 v11, v[28:31]
    ds_write_b128 v12, v[32:35]
    ds_write_b128 v13, v[36:39]
    ds_write_b128 v14, v[40:43]
    ds_write_b128 v15, v[44:47]
    s_add_u32 s46, s45, 5505024
    buffer_load_dwordx4 v[72:75], v4, s[12:15], s46 offen
    buffer_load_dwordx4 v[76:79], v5, s[12:15], s46 offen
    buffer_load_dwordx4 v[80:83], v6, s[12:15], s46 offen
    buffer_load_dwordx4 v[84:87], v7, s[12:15], s46 offen
    buffer_load_dwordx4 v[88:91], v8, s[12:15], s46 offen
    buffer_load_dwordx4 v[92:95], v9, s[12:15], s46 offen
    s_waitcnt lgkmcnt(0)
    s_barrier
    ds_read_b64_tr_b16 a[48:49], v16 offset:0
    ds_read_b64_tr_b16 a[50:51], v16 offset:800
    ds_read_b64_tr_b16 a[52:53], v16 offset:12800
    ds_read_b64_tr_b16 a[54:55], v16 offset:13600
    ds_read_b64_tr_b16 a[128:129], v16 offset:32
    ds_read_b64_tr_b16 a[130:131], v16 offset:832
    ds_read_b64_tr_b16 a[132:133], v16 offset:12832
    ds_read_b64_tr_b16 a[134:135], v16 offset:13632
    ds_read_b64_tr_b16 a[208:209], v16 offset:64
    ds_read_b64_tr_b16 a[210:211], v16 offset:864
    ds_read_b64_tr_b16 a[212:213], v16 offset:12864
    ds_read_b64_tr_b16 a[214:215], v16 offset:13664
    s_waitcnt lgkmcnt(0)
    s_barrier
    s_waitcnt vmcnt(6)
    ds_write_b128 v10, v[48:51]
    ds_write_b128 v11, v[52:55]
    ds_write_b128 v12, v[56:59]
    ds_write_b128 v13, v[60:63]
    ds_write_b128 v14, v[64:67]
    ds_write_b128 v15, v[68:71]
    s_add_u32 s46, s45, 5505024
    buffer_load_dwordx4 v[24:27], v4, s[16:19], s46 offen
    buffer_load_dwordx4 v[28:31], v5, s[16:19], s46 offen
    buffer_load_dwordx4 v[32:35], v6, s[16:19], s46 offen
    buffer_load_dwordx4 v[36:39], v7, s[16:19], s46 offen
    buffer_load_dwordx4 v[40:43], v8, s[16:19], s46 offen
    buffer_load_dwordx4 v[44:47], v9, s[16:19], s46 offen
    s_waitcnt lgkmcnt(0)
    s_barrier
    ds_read_b64_tr_b16 v[144:145], v16 offset:32
    ds_read_b64_tr_b16 v[146:147], v16 offset:832
    ds_read_b64_tr_b16 v[148:149], v16 offset:12832
    ds_read_b64_tr_b16 v[150:151], v16 offset:13632
    ds_read_b64_tr_b16 v[224:225], v16 offset:64
    ds_read_b64_tr_b16 v[226:227], v16 offset:864
    ds_read_b64_tr_b16 v[228:229], v16 offset:12864
    ds_read_b64_tr_b16 v[230:231], v16 offset:13664
    ds_read_b64_tr_b16 v[48:49], v16 offset:0
    ds_read_b64_tr_b16 v[50:51], v16 offset:800
    ds_read_b64_tr_b16 v[52:53], v16 offset:12800
    ds_read_b64_tr_b16 v[54:55], v16 offset:13600
    s_waitcnt lgkmcnt(0)
    ds_write_b128 v17, v[48:51] offset:12288
    ds_write_b128 v17, v[52:55] offset:13312
    s_waitcnt lgkmcnt(0)
    s_barrier
    s_waitcnt vmcnt(6)
    ds_write_b128 v10, v[72:75]
    ds_write_b128 v11, v[76:79]
    ds_write_b128 v12, v[80:83]
    ds_write_b128 v13, v[84:87]
    ds_write_b128 v14, v[88:91]
    ds_write_b128 v15, v[92:95]
    s_add_u32 s46, s45, 6291456
    buffer_load_dwordx4 v[48:51], v4, s[12:15], s46 offen
    buffer_load_dwordx4 v[52:55], v5, s[12:15], s46 offen
    buffer_load_dwordx4 v[56:59], v6, s[12:15], s46 offen
    buffer_load_dwordx4 v[60:63], v7, s[12:15], s46 offen
    buffer_load_dwordx4 v[64:67], v8, s[12:15], s46 offen
    buffer_load_dwordx4 v[68:71], v9, s[12:15], s46 offen
    s_waitcnt lgkmcnt(0)
    s_barrier
    ds_read_b64_tr_b16 a[56:57], v16 offset:0
    ds_read_b64_tr_b16 a[58:59], v16 offset:800
    ds_read_b64_tr_b16 a[60:61], v16 offset:12800
    ds_read_b64_tr_b16 a[62:63], v16 offset:13600
    ds_read_b64_tr_b16 a[136:137], v16 offset:32
    ds_read_b64_tr_b16 a[138:139], v16 offset:832
    ds_read_b64_tr_b16 a[140:141], v16 offset:12832
    ds_read_b64_tr_b16 a[142:143], v16 offset:13632
    ds_read_b64_tr_b16 a[216:217], v16 offset:64
    ds_read_b64_tr_b16 a[218:219], v16 offset:864
    ds_read_b64_tr_b16 a[220:221], v16 offset:12864
    ds_read_b64_tr_b16 a[222:223], v16 offset:13664
    s_waitcnt lgkmcnt(0)
    s_barrier
    s_waitcnt vmcnt(6)
    ds_write_b128 v10, v[24:27]
    ds_write_b128 v11, v[28:31]
    ds_write_b128 v12, v[32:35]
    ds_write_b128 v13, v[36:39]
    ds_write_b128 v14, v[40:43]
    ds_write_b128 v15, v[44:47]
    s_add_u32 s46, s45, 6291456
    buffer_load_dwordx4 v[72:75], v4, s[16:19], s46 offen
    buffer_load_dwordx4 v[76:79], v5, s[16:19], s46 offen
    buffer_load_dwordx4 v[80:83], v6, s[16:19], s46 offen
    buffer_load_dwordx4 v[84:87], v7, s[16:19], s46 offen
    buffer_load_dwordx4 v[88:91], v8, s[16:19], s46 offen
    buffer_load_dwordx4 v[92:95], v9, s[16:19], s46 offen
    s_waitcnt lgkmcnt(0)
    s_barrier
    ds_read_b64_tr_b16 v[152:153], v16 offset:32
    ds_read_b64_tr_b16 v[154:155], v16 offset:832
    ds_read_b64_tr_b16 v[156:157], v16 offset:12832
    ds_read_b64_tr_b16 v[158:159], v16 offset:13632
    ds_read_b64_tr_b16 v[232:233], v16 offset:64
    ds_read_b64_tr_b16 v[234:235], v16 offset:864
    ds_read_b64_tr_b16 v[236:237], v16 offset:12864
    ds_read_b64_tr_b16 v[238:239], v16 offset:13664
    ds_read_b64_tr_b16 v[24:25], v16 offset:0
    ds_read_b64_tr_b16 v[26:27], v16 offset:800
    ds_read_b64_tr_b16 v[28:29], v16 offset:12800
    ds_read_b64_tr_b16 v[30:31], v16 offset:13600
    s_waitcnt lgkmcnt(0)
    ds_write_b128 v17, v[24:27] offset:14336
    ds_write_b128 v17, v[28:31] offset:15360
    s_waitcnt lgkmcnt(0)
    s_barrier
    s_waitcnt vmcnt(6)
    ds_write_b128 v10, v[48:51]
    ds_write_b128 v11, v[52:55]
    ds_write_b128 v12, v[56:59]
    ds_write_b128 v13, v[60:63]
    ds_write_b128 v14, v[64:67]
    ds_write_b128 v15, v[68:71]
    s_add_u32 s46, s45, 7077888
    buffer_load_dwordx4 v[24:27], v4, s[12:15], s46 offen
    buffer_load_dwordx4 v[28:31], v5, s[12:15], s46 offen
    buffer_load_dwordx4 v[32:35], v6, s[12:15], s46 offen
    buffer_load_dwordx4 v[36:39], v7, s[12:15], s46 offen
    buffer_load_dwordx4 v[40:43], v8, s[12:15], s46 offen
    buffer_load_dwordx4 v[44:47], v9, s[12:15], s46 offen
    s_waitcnt lgkmcnt(0)
    s_barrier
    ds_read_b64_tr_b16 a[64:65], v16 offset:0
    ds_read_b64_tr_b16 a[66:67], v16 offset:800
    ds_read_b64_tr_b16 a[68:69], v16 offset:12800
    ds_read_b64_tr_b16 a[70:71], v16 offset:13600
    ds_read_b64_tr_b16 a[144:145], v16 offset:32
    ds_read_b64_tr_b16 a[146:147], v16 offset:832
    ds_read_b64_tr_b16 a[148:149], v16 offset:12832
    ds_read_b64_tr_b16 a[150:151], v16 offset:13632
    ds_read_b64_tr_b16 a[224:225], v16 offset:64
    ds_read_b64_tr_b16 a[226:227], v16 offset:864
    ds_read_b64_tr_b16 a[228:229], v16 offset:12864
    ds_read_b64_tr_b16 a[230:231], v16 offset:13664
    s_waitcnt lgkmcnt(0)
    s_barrier
    s_waitcnt vmcnt(6)
    ds_write_b128 v10, v[72:75]
    ds_write_b128 v11, v[76:79]
    ds_write_b128 v12, v[80:83]
    ds_write_b128 v13, v[84:87]
    ds_write_b128 v14, v[88:91]
    ds_write_b128 v15, v[92:95]
    s_add_u32 s46, s45, 7077888
    buffer_load_dwordx4 v[48:51], v4, s[16:19], s46 offen
    buffer_load_dwordx4 v[52:55], v5, s[16:19], s46 offen
    buffer_load_dwordx4 v[56:59], v6, s[16:19], s46 offen
    buffer_load_dwordx4 v[60:63], v7, s[16:19], s46 offen
    buffer_load_dwordx4 v[64:67], v8, s[16:19], s46 offen
    buffer_load_dwordx4 v[68:71], v9, s[16:19], s46 offen
    s_waitcnt lgkmcnt(0)
    s_barrier
    ds_read_b64_tr_b16 v[160:161], v16 offset:32
    ds_read_b64_tr_b16 v[162:163], v16 offset:832
    ds_read_b64_tr_b16 v[164:165], v16 offset:12832
    ds_read_b64_tr_b16 v[166:167], v16 offset:13632
    ds_read_b64_tr_b16 v[240:241], v16 offset:64
    ds_read_b64_tr_b16 v[242:243], v16 offset:864
    ds_read_b64_tr_b16 v[244:245], v16 offset:12864
    ds_read_b64_tr_b16 v[246:247], v16 offset:13664
    ds_read_b64_tr_b16 v[72:73], v16 offset:0
    ds_read_b64_tr_b16 v[74:75], v16 offset:800
    ds_read_b64_tr_b16 v[76:77], v16 offset:12800
    ds_read_b64_tr_b16 v[78:79], v16 offset:13600
    s_waitcnt lgkmcnt(0)
    ds_write_b128 v17, v[72:75] offset:16384
    ds_write_b128 v17, v[76:79] offset:17408
    s_waitcnt lgkmcnt(0)
    s_barrier
    s_waitcnt vmcnt(6)
    ds_write_b128 v10, v[24:27]
    ds_write_b128 v11, v[28:31]
    ds_write_b128 v12, v[32:35]
    ds_write_b128 v13, v[36:39]
    ds_write_b128 v14, v[40:43]
    ds_write_b128 v15, v[44:47]
    s_waitcnt lgkmcnt(0)
    s_barrier
    ds_read_b64_tr_b16 a[72:73], v16 offset:0
    ds_read_b64_tr_b16 a[74:75], v16 offset:800
    ds_read_b64_tr_b16 a[76:77], v16 offset:12800
    ds_read_b64_tr_b16 a[78:79], v16 offset:13600
    ds_read_b64_tr_b16 a[152:153], v16 offset:32
    ds_read_b64_tr_b16 a[154:155], v16 offset:832
    ds_read_b64_tr_b16 a[156:157], v16 offset:12832
    ds_read_b64_tr_b16 a[158:159], v16 offset:13632
    ds_read_b64_tr_b16 a[232:233], v16 offset:64
    ds_read_b64_tr_b16 a[234:235], v16 offset:864
    ds_read_b64_tr_b16 a[236:237], v16 offset:12864
    ds_read_b64_tr_b16 a[238:239], v16 offset:13664
    s_waitcnt lgkmcnt(0)
    s_barrier
    s_waitcnt vmcnt(0)
    ds_write_b128 v10, v[48:51]
    ds_write_b128 v11, v[52:55]
    ds_write_b128 v12, v[56:59]
    ds_write_b128 v13, v[60:63]
    ds_write_b128 v14, v[64:67]
    ds_write_b128 v15, v[68:71]
    s_waitcnt lgkmcnt(0)
    s_barrier
    ds_read_b64_tr_b16 v[168:169], v16 offset:32
    ds_read_b64_tr_b16 v[170:171], v16 offset:832
    ds_read_b64_tr_b16 v[172:173], v16 offset:12832
    ds_read_b64_tr_b16 v[174:175], v16 offset:13632
    ds_read_b64_tr_b16 v[248:249], v16 offset:64
    ds_read_b64_tr_b16 v[250:251], v16 offset:864
    ds_read_b64_tr_b16 v[252:253], v16 offset:12864
    ds_read_b64_tr_b16 v[254:255], v16 offset:13664
    ds_read_b64_tr_b16 v[48:49], v16 offset:0
    ds_read_b64_tr_b16 v[50:51], v16 offset:800
    ds_read_b64_tr_b16 v[52:53], v16 offset:12800
    ds_read_b64_tr_b16 v[54:55], v16 offset:13600
    s_waitcnt lgkmcnt(0)
    ds_write_b128 v17, v[48:51] offset:18432
    ds_write_b128 v17, v[52:55] offset:19456
    s_waitcnt lgkmcnt(0)
    s_barrier
    v_mov_b32 v6, v17
    v_mov_b32 v30, 0xeeee
    v_mov_b32 v4, 0x4444
    v_cmp_gt_u32 vcc, 8, v2
    s_nop 1
    v_cndmask_b32 v4, v30, v4, vcc
    v_lshlrev_b32 v5, 4, v1
    s_lshl_b32 s24, s3, 10
    v_add_u32 v7, s24, v5
    s_lshl_b32 s24, s3, 9
    s_add_u32 s24, s24, 8192
    v_lshlrev_b32 v8, 3, v1
    v_add_u32 v8, s24, v8
    v_and_b32 v30, 1, v2
    v_lshlrev_b32 v30, 4, v30
    v_mov_b32 v31, 0x3f80
    v_lshlrev_b32 v31, v30, v31
    v_lshrrev_b32 v30, 2, v2
    v_cmp_eq_u32 vcc, v30, v3
    s_nop 1
    v_cndmask_b32 v31, 0, v31, vcc
    v_and_b32 v30, 2, v2
    v_cmp_eq_u32 vcc, 0, v30
    s_nop 1
    v_cndmask_b32 v10, 0, v31, vcc
    v_cndmask_b32 v11, v31, 0, vcc
    v_add_u32 v33, 22528, v5
    s_mul_i32 s24, s3, 1408
    s_add_u32 s24, s24, 16384
    v_mul_u32_u24 v30, 176, v2
    v_add_u32 v30, s24, v30
    v_lshl_add_u32 v12, v3, 5, v30
    v_cmp_gt_u32 vcc, 8, v2
    s_nop 1
    v_cndmask_b32 v12, v33, v12, vcc
    v_lshl_add_u32 v13, v3, 4, v30
    v_add_u32 v13, 96, v13
    v_cmp_le_u32 s[24:25], 2, v3
    s_and_b64 vcc, vcc, s[24:25]
    v_cndmask_b32 v13, v33, v13, vcc
    s_mul_i32 s24, s3, 5632
    s_add_u32 s24, s24, 106496
    v_mul_u32_u24 v30, 176, v2
    v_add_u32 v30, s24, v30
    v_lshl_add_u32 v16, v3, 5, v30
    v_lshl_add_u32 v17, v3, 4, v30
    v_add_u32 v17, 96, v17
    v_add_u32 v18, 2816, v17
    v_cmp_le_u32 vcc, 2, v3
    s_nop 1
    v_cndmask_b32 v17, v33, v17, vcc
    v_cndmask_b32 v18, v33, v18, vcc
    v_lshrrev_b32 v30, 3, v1
    v_and_b32 v31, 7, v1
    v_min_u32 v32, 4, v31
    v_mul_u32_u24 v14, 176, v30
    v_lshl_add_u32 v14, v32, 5, v14
    s_mul_i32 s24, s3, 1408
    s_add_u32 s24, s24, 106496
    v_add_u32 v21, s24, v14
    v_add_u32 v14, 16384, v14
    v_cmp_gt_u32 s[50:51], 5, v31
    s_lshl_b32 s24, s3, 3
    v_add_u32 v32, s24, v30
    v_lshlrev_b32 v33, 2, v31
    v_sub_u32 v32, v32, v33
    v_mov_b32 v33, 100
    v_cmp_gt_u32 vcc, 4, v31
    s_nop 1
    v_cndmask_b32 v32, v33, v32, vcc
    v_cmp_le_i32 s[64:65], 0, v32
    v_cmp_le_i32 s[66:67], 1, v32
    v_cmp_le_i32 s[68:69], 2, v32
    v_cmp_le_i32 s[70:71], 3, v32
    v_cmp_le_i32 s[72:73], 16, v32
    v_cmp_le_i32 s[74:75], 17, v32
    v_cmp_le_i32 s[76:77], 18, v32
    v_cmp_le_i32 s[78:79], 19, v32
    s_lshr_b32 s24, s44, 1
    s_lshl_b32 s24, s24, 10
    s_and_b32 s25, s44, 1
    s_lshl_b32 s25, s25, 7
    s_add_u32 s24, s24, s25
    v_lshlrev_b32 v15, 8, v31
    v_lshl_add_u32 v15, v30, 4, v15
    v_add_u32 v15, s24, v15
    s_lshr_b32 s24, s44, 3
    s_lshl_b32 s24, s24, 10
    s_and_b32 s25, s44, 3
    s_lshl_b32 s25, s25, 8
    s_add_u32 s24, s24, s25
    s_lshr_b32 s25, s44, 2
    s_and_b32 s25, s25, 1
    s_lshl_b32 s25, s25, 7
    s_add_u32 s24, s24, s25
    s_add_u32 s24, s24, 16384
    v_lshlrev_b32 v32, 4, v30
    v_add_u32 v32, s24, v32
    v_cmp_eq_u32 vcc, 4, v31
    s_nop 1
    v_cndmask_b32 v15, v15, v32, vcc
    v_mov_b32 v32, 2146435072
    v_cndmask_b32 v15, v32, v15, s[50:51]
    s_cmp_lt_u32 s3, 1
    s_cselect_b32 s24, 0, 2146435072
    v_or_b32 v15, s24, v15
    s_and_b32 s24, s3, 1
    s_lshl_b32 s24, s24, 7
    s_lshr_b32 s25, s3, 1
    s_lshl_b32 s25, s25, 10
    s_add_u32 s24, s24, s25
    s_lshl_b32 s25, s44, 11
    s_add_u32 s25, s25, s24
    v_lshlrev_b32 v22, 8, v31
    v_lshl_add_u32 v22, v30, 4, v22
    v_add_u32 v22, s25, v22
    s_lshr_b32 s25, s44, 2
    s_lshl_b32 s25, s25, 11
    s_add_u32 s25, s25, s24
    s_and_b32 s26, s44, 3
    s_lshl_b32 s26, s26, 8
    s_add_u32 s25, s25, s26
    s_add_u32 s25, s25, 65536
    v_lshlrev_b32 v32, 4, v30
    v_add_u32 v32, s25, v32
    v_cmp_eq_u32 vcc, 4, v31
    s_nop 1
    v_cndmask_b32 v22, v22, v32, vcc
    v_mov_b32 v32, 2146435072
    v_cndmask_b32 v22, v32, v22, s[50:51]
    s_mul_i32 s24, s44, 12288
    s_mul_i32 s25, s3, 3072
    s_add_u32 s24, s24, s25
    v_add_u32 v19, s24, v5
    s_and_b32 s24, s2, 15
    s_mul_i32 s25, s3, 16
    s_add_u32 s24, s24, s25
    s_lshl_b32 s24, s24, 7
    v_mov_b32 v23, s24
    s_lshr_b32 s25, s44, 3
    s_mul_i32 s24, s25, 8
    v_add_u32 v20, s24, v1
    v_lshlrev_b32 v20, 7, v20
    v_mov_b32 v30, 2146435072
    v_cmp_le_u32 vcc, 8, v1
    s_nop 1
    v_cndmask_b32 v20, v20, v30, vcc
    s_cmp_eq_u32 s3, 0
    s_cselect_b32 s24, 0, 2146435072
    v_or_b32 v20, s24, v20
    v_mov_b32 v0, 1
interleave_layers__linear_attn_block__memory_aug_recurrent_mem_tr__prompt_kernel_s_layer:
    s_mul_i32 s93, s92, 29360128
    s_add_u32 s93, s93, 117440512
    s_mul_i32 s94, s92, 16384
    s_add_u32 s94, s94, 23068672
    v_and_b32 v9, 1, v1
    v_lshlrev_b32 v9, 12, v9
    s_lshl_b32 s24, s44, 7
    s_add_u32 s24, s24, s94
    v_add_u32 v9, s24, v9
    s_lshl_b32 s24, s3, 6
    s_add_u32 s24, s24, 0
    v_add_u32 v48, s24, v1
    v_and_b32 v49, 7, v48
    v_mul_u32_u24 v49, 1280, v49
    v_lshrrev_b32 v50, 3, v48
    v_lshl_add_u32 v49, v50, 4, v49
    v_cmp_gt_u32 vcc, 640, v48
    v_mov_b32 v51, 2146435072
    s_nop 0
    v_cndmask_b32 v49, v51, v49, vcc
    buffer_load_dwordx4 v[52:55], v49, s[20:23], 0 offen
    v_lshlrev_b32 v48, 4, v48
    s_waitcnt vmcnt(0)
    s_and_saveexec_b64 s[30:31], vcc
    ds_write_b128 v48, v[52:55]
    s_mov_b64 exec, s[30:31]
    s_lshl_b32 s24, s3, 6
    s_add_u32 s24, s24, 256
    v_add_u32 v48, s24, v1
    v_and_b32 v49, 7, v48
    v_mul_u32_u24 v49, 1280, v49
    v_lshrrev_b32 v50, 3, v48
    v_lshl_add_u32 v49, v50, 4, v49
    v_cmp_gt_u32 vcc, 640, v48
    v_mov_b32 v51, 2146435072
    s_nop 0
    v_cndmask_b32 v49, v51, v49, vcc
    buffer_load_dwordx4 v[52:55], v49, s[20:23], 0 offen
    v_lshlrev_b32 v48, 4, v48
    s_waitcnt vmcnt(0)
    s_and_saveexec_b64 s[30:31], vcc
    ds_write_b128 v48, v[52:55]
    s_mov_b64 exec, s[30:31]
    s_lshl_b32 s24, s3, 6
    s_add_u32 s24, s24, 512
    v_add_u32 v48, s24, v1
    v_and_b32 v49, 7, v48
    v_mul_u32_u24 v49, 1280, v49
    v_lshrrev_b32 v50, 3, v48
    v_lshl_add_u32 v49, v50, 4, v49
    v_cmp_gt_u32 vcc, 640, v48
    v_mov_b32 v51, 2146435072
    s_nop 0
    v_cndmask_b32 v49, v51, v49, vcc
    buffer_load_dwordx4 v[52:55], v49, s[20:23], 0 offen
    v_lshlrev_b32 v48, 4, v48
    s_waitcnt vmcnt(0)
    s_and_saveexec_b64 s[30:31], vcc
    ds_write_b128 v48, v[52:55]
    s_mov_b64 exec, s[30:31]
    s_mov_b32 s40, 0
    s_mov_b32 s41, 92274688
    s_add_u32 s42, s93, 327680
    s_add_u32 s43, s93, 409600
    s_mov_b32 s45, 67108864
    s_add_u32 s47, s93, -28672
    s_add_u32 s48, s93, -18432
    s_add_u32 s49, s93, 448512
    s_lshl_b32 s95, s92, 6
    s_add_u32 s95, s95, s40
    s_add_u32 s95, s95, 1
    s_cmp_ge_i32 s59, s95
    s_cbranch_scc1 interleave_layers__linear_attn_block__memory_aug_recurrent_mem_tr__prompt_kernel_s_ec0_ok
    s_and_b32 s24, s2, 7
    s_lshl_b32 s24, s24, 7
    s_add_u32 s24, s24, 23109632
    v_and_b32 v49, 3, v1
    v_lshl_add_u32 v49, v49, 2, s24
    s_mov_b32 s61, 0
interleave_layers__linear_attn_block__memory_aug_recurrent_mem_tr__prompt_kernel_s_ec0:
    buffer_load_dword v48, v49, s[8:11], 0 offen sc1
    s_waitcnt vmcnt(0)
    v_readlane_b32 s59, v48, 0
    v_readlane_b32 s24, v48, 1
    s_min_i32 s59, s59, s24
    v_readlane_b32 s24, v48, 2
    s_min_i32 s59, s59, s24
    s_cmp_ge_i32 s59, s95
    s_cbranch_scc1 interleave_layers__linear_attn_block__memory_aug_recurrent_mem_tr__prompt_kernel_s_ec0_ok
    s_add_u32 s61, s61, 1
    s_cmp_ge_u32 s61, s60
    s_cbranch_scc1 interleave_layers__linear_attn_block__memory_aug_recurrent_mem_tr__prompt_kernel_s_ec0_to
    s_sleep 2
    s_branch interleave_layers__linear_attn_block__memory_aug_recurrent_mem_tr__prompt_kernel_s_ec0
interleave_layers__linear_attn_block__memory_aug_recurrent_mem_tr__prompt_kernel_s_ec0_to:
    s_mov_b32 s60, 1
interleave_layers__linear_attn_block__memory_aug_recurrent_mem_tr__prompt_kernel_s_ec0_ok:
    s_mov_b32 s62, -1
    s_mov_b32 s63, 1
    s_cmp_ge_i32 s62, s63
    s_cbranch_scc1 interleave_layers__linear_attn_block__memory_aug_recurrent_mem_tr__prompt_kernel_s_en0_ok
    s_mov_b32 s61, 0
interleave_layers__linear_attn_block__memory_aug_recurrent_mem_tr__prompt_kernel_s_en0:
    buffer_load_dword v48, v9, s[8:11], 0 offen sc1
    s_waitcnt vmcnt(0)
    v_readlane_b32 s62, v48, 0
    v_readlane_b32 s24, v48, 1
    s_min_i32 s62, s62, s24
    s_cmp_ge_i32 s62, s63
    s_cbranch_scc1 interleave_layers__linear_attn_block__memory_aug_recurrent_mem_tr__prompt_kernel_s_en0_ok
    s_add_u32 s61, s61, 1
    s_cmp_ge_u32 s61, s60
    s_cbranch_scc1 interleave_layers__linear_attn_block__memory_aug_recurrent_mem_tr__prompt_kernel_s_en0_to
    s_sleep 2
    s_branch interleave_layers__linear_attn_block__memory_aug_recurrent_mem_tr__prompt_kernel_s_en0
interleave_layers__linear_attn_block__memory_aug_recurrent_mem_tr__prompt_kernel_s_en0_to:
    s_mov_b32 s60, 1
interleave_layers__linear_attn_block__memory_aug_recurrent_mem_tr__prompt_kernel_s_en0_ok:
    buffer_load_dwordx4 a[240:243], v19, s[8:11], s41 offen offset:0 sc1
    buffer_load_dwordx4 a[244:247], v19, s[8:11], s41 offen offset:1024 sc1
    buffer_load_dwordx4 a[248:251], v19, s[8:11], s41 offen offset:2048 sc1
    s_waitcnt lgkmcnt(0)
    v_mov_b32 v24, 0
    v_mov_b32 v25, 0
    v_mov_b32 v26, 0
    v_mov_b32 v27, 0
    v_mov_b32 v28, 0
    v_mov_b32 v29, 0
    v_mov_b32 v30, 0
    v_mov_b32 v31, 0
    v_mov_b32 v32, 0
    v_mov_b32 v33, 0
    v_mov_b32 v34, 0
    v_mov_b32 v35, 0
    v_mov_b32 v36, 0
    v_mov_b32 v37, 0
    v_mov_b32 v38, 0
    v_mov_b32 v39, 0
    v_mov_b32 v40, 0
    v_mov_b32 v41, 0
    v_mov_b32 v42, 0
    v_mov_b32 v43, 0
    v_mov_b32 v44, 0
    v_mov_b32 v45, 0
    v_mov_b32 v46, 0
    v_mov_b32 v47, 0
    s_barrier
    ds_read_b128 v[84:87], v7
    ds_read_b128 v[88:91], v7 offset:4096
    s_waitcnt vmcnt(0) lgkmcnt(0)
    s_cmp_eq_u32 s3, 0
    s_cbranch_scc1 interleave_layers__linear_attn_block__memory_aug_recurrent_mem_tr__prompt_kernel_s_gow0
    s_cmp_eq_u32 s3, 1
    s_cbranch_scc1 interleave_layers__linear_attn_block__memory_aug_recurrent_mem_tr__prompt_kernel_s_gow1
    s_cmp_eq_u32 s3, 2
    s_cbranch_scc1 interleave_layers__linear_attn_block__memory_aug_recurrent_mem_tr__prompt_kernel_s_gow2
    s_branch interleave_layers__linear_attn_block__memory_aug_recurrent_mem_tr__prompt_kernel_s_gow3
interleave_layers__linear_attn_block__memory_aug_recurrent_mem_tr__prompt_kernel_s_stepw0:
    v_mov_b32 v24, 0
    v_mov_b32 v25, 0
    v_mov_b32 v26, 0
    v_mov_b32 v27, 0
    v_mov_b32 v28, 0
    v_mov_b32 v29, 0
    v_mov_b32 v30, 0
    v_mov_b32 v31, 0
    v_mov_b32 v32, 0
    v_mov_b32 v33, 0
    v_mov_b32 v34, 0
    v_mov_b32 v35, 0
    v_mov_b32 v36, 0
    v_mov_b32 v37, 0
    v_mov_b32 v38, 0
    v_mov_b32 v39, 0
    v_mov_b32 v40, 0
    v_mov_b32 v41, 0
    v_mov_b32 v42, 0
    v_mov_b32 v43, 0
    v_mov_b32 v44, 0
    v_mov_b32 v45, 0
    v_mov_b32 v46, 0
    v_mov_b32 v47, 0
    s_add_u32 s46, s47, 4096
    s_lshl_b32 s95, s92, 6
    s_add_u32 s95, s95, s40
    s_add_u32 s95, s95, 1
    s_cmp_ge_i32 s59, s95
    s_cbranch_scc1 interleave_layers__linear_attn_block__memory_aug_recurrent_mem_tr__prompt_kernel_s_ecw0_ok
    s_and_b32 s24, s2, 7
    s_lshl_b32 s24, s24, 7
    s_add_u32 s24, s24, 23109632
    v_and_b32 v49, 3, v1
    v_lshl_add_u32 v49, v49, 2, s24
    s_mov_b32 s61, 0
interleave_layers__linear_attn_block__memory_aug_recurrent_mem_tr__prompt_kernel_s_ecw0:
    buffer_load_dword v48, v49, s[8:11], 0 offen sc1
    s_waitcnt vmcnt(0)
    v_readlane_b32 s59, v48, 0
    v_readlane_b32 s24, v48, 1
    s_min_i32 s59, s59, s24
    v_readlane_b32 s24, v48, 2
    s_min_i32 s59, s59, s24
    s_cmp_ge_i32 s59, s95
    s_cbranch_scc1 interleave_layers__linear_attn_block__memory_aug_recurrent_mem_tr__prompt_kernel_s_ecw0_ok
    s_add_u32 s61, s61, 1
    s_cmp_ge_u32 s61, s60
    s_cbranch_scc1 interleave_layers__linear_attn_block__memory_aug_recurrent_mem_tr__prompt_kernel_s_ecw0_to
    s_sleep 2
    s_branch interleave_layers__linear_attn_block__memory_aug_recurrent_mem_tr__prompt_kernel_s_ecw0
interleave_layers__linear_attn_block__memory_aug_recurrent_mem_tr__prompt_kernel_s_ecw0_to:
    s_mov_b32 s60, 1
interleave_layers__linear_attn_block__memory_aug_recurrent_mem_tr__prompt_kernel_s_ecw0_ok:
    s_add_u32 s63, s40, 1
    s_cmp_ge_i32 s62, s63
    s_cbranch_scc1 interleave_layers__linear_attn_block__memory_aug_recurrent_mem_tr__prompt_kernel_s_enw0_ok
    s_mov_b32 s61, 0
interleave_layers__linear_attn_block__memory_aug_recurrent_mem_tr__prompt_kernel_s_enw0:
    buffer_load_dword v48, v9, s[8:11], 0 offen sc1
    s_waitcnt vmcnt(0)
    v_readlane_b32 s62, v48, 0
    v_readlane_b32 s24, v48, 1
    s_min_i32 s62, s62, s24
    s_cmp_ge_i32 s62, s63
    s_cbranch_scc1 interleave_layers__linear_attn_block__memory_aug_recurrent_mem_tr__prompt_kernel_s_enw0_ok
    s_add_u32 s61, s61, 1
    s_cmp_ge_u32 s61, s60
    s_cbranch_scc1 interleave_layers__linear_attn_block__memory_aug_recurrent_mem_tr__prompt_kernel_s_enw0_to
    s_sleep 2
    s_branch interleave_layers__linear_attn_block__memory_aug_recurrent_mem_tr__prompt_kernel_s_enw0
interleave_layers__linear_attn_block__memory_aug_recurrent_mem_tr__prompt_kernel_s_enw0_to:
    s_mov_b32 s60, 1
interleave_layers__linear_attn_block__memory_aug_recurrent_mem_tr__prompt_kernel_s_enw0_ok:
    buffer_load_dwordx4 a[240:243], v19, s[8:11], s41 offen offset:0 sc1
    buffer_load_dwordx4 a[244:247], v19, s[8:11], s41 offen offset:1024 sc1
    buffer_load_dwordx4 a[248:251], v19, s[8:11], s41 offen offset:2048 sc1
    s_sleep 5
    s_mov_b64 exec, 1
    s_mov_b32 s61, 0
    v_mov_b32 v83, 0
    buffer_atomic_add v83, v23, s[8:11], s48 offen sc0
    s_sleep 3
    v_mov_b32 v94, 0
    buffer_atomic_add v94, v23, s[8:11], s48 offen sc0
    s_sleep 3
    v_mov_b32 v95, 0
    buffer_atomic_add v95, v23, s[8:11], s48 offen sc0
    s_sleep 3
interleave_layers__linear_attn_block__memory_aug_recurrent_mem_tr__prompt_kernel_s_prw0:
    v_mov_b32 v82, 0
    buffer_atomic_add v82, v23, s[8:11], s48 offen sc0
    s_waitcnt vmcnt(3)
    v_cmp_le_i32 vcc, 8, v83
    s_add_u32 s61, s61, 1
    s_cbranch_vccnz interleave_layers__linear_attn_block__memory_aug_recurrent_mem_tr__prompt_kernel_s_prw0_out
    s_sleep 3
    v_mov_b32 v83, 0
    buffer_atomic_add v83, v23, s[8:11], s48 offen sc0
    s_waitcnt vmcnt(3)
    v_cmp_le_i32 vcc, 8, v94
    s_add_u32 s61, s61, 1
    s_cbranch_vccnz interleave_layers__linear_attn_block__memory_aug_recurrent_mem_tr__prompt_kernel_s_prw0_out
    s_sleep 3
    v_mov_b32 v94, 0
    buffer_atomic_add v94, v23, s[8:11], s48 offen sc0
    s_waitcnt vmcnt(3)
    v_cmp_le_i32 vcc, 8, v95
    s_add_u32 s61, s61, 1
    s_cbranch_vccnz interleave_layers__linear_attn_block__memory_aug_recurrent_mem_tr__prompt_kernel_s_prw0_out
    s_sleep 3
    v_mov_b32 v95, 0
    buffer_atomic_add v95, v23, s[8:11], s48 offen sc0
    s_waitcnt vmcnt(3)
    v_cmp_le_i32 vcc, 8, v82
    s_add_u32 s61, s61, 1
    s_cbranch_vccnz interleave_layers__linear_attn_block__memory_aug_recurrent_mem_tr__prompt_kernel_s_prw0_out
    s_sleep 3
    s_cmp_ge_u32 s61, s60
    s_cbranch_scc0 interleave_layers__linear_attn_block__memory_aug_recurrent_mem_tr__prompt_kernel_s_prw0
    s_mov_b32 s60, 1
interleave_layers__linear_attn_block__memory_aug_recurrent_mem_tr__prompt_kernel_s_prw0_out:
    s_mov_b64 exec, -1
    buffer_load_dwordx4 v[84:87], v7, s[8:11], s47 offen sc1
    buffer_load_dwordx4 v[88:91], v7, s[8:11], s46 offen sc1
    buffer_load_dwordx2 v[92:93], v8, s[8:11], s47 offen sc1
    ds_read_b128 v[48:51], v21 offset:0
    ds_read_b128 v[52:55], v21 offset:16
    ds_read_b128 v[56:59], v21 offset:5632
    ds_read_b128 v[60:63], v21 offset:5648
    ds_read_b128 v[64:67], v21 offset:11264
    ds_read_b128 v[68:71], v21 offset:11280
    ds_read_b128 v[72:75], v21 offset:16896
    ds_read_b128 v[76:79], v21 offset:16912
    s_waitcnt lgkmcnt(4)
    v_pk_add_f32 v[48:49], v[48:49], v[56:57]
    v_pk_add_f32 v[50:51], v[50:51], v[58:59]
    v_pk_add_f32 v[52:53], v[52:53], v[60:61]
    v_pk_add_f32 v[54:55], v[54:55], v[62:63]
    s_waitcnt lgkmcnt(0)
    v_pk_add_f32 v[64:65], v[64:65], v[72:73]
    v_pk_add_f32 v[66:67], v[66:67], v[74:75]
    v_pk_add_f32 v[68:69], v[68:69], v[76:77]
    v_pk_add_f32 v[70:71], v[70:71], v[78:79]
    v_pk_add_f32 v[48:49], v[48:49], v[64:65]
    v_pk_add_f32 v[50:51], v[50:51], v[66:67]
    v_pk_add_f32 v[52:53], v[52:53], v[68:69]
    v_pk_add_f32 v[54:55], v[54:55], v[70:71]
    v_mov_b32 v81, 0xff800000
    v_cndmask_b32 v48, v81, v48, s[64:65]
    v_cndmask_b32 v49, v81, v49, s[66:67]
    v_cndmask_b32 v50, v81, v50, s[68:69]
    v_cndmask_b32 v51, v81, v51, s[70:71]
    v_cndmask_b32 v52, v81, v52, s[72:73]
    v_cndmask_b32 v53, v81, v53, s[74:75]
    v_cndmask_b32 v54, v81, v54, s[76:77]
    v_cndmask_b32 v55, v81, v55, s[78:79]
    v_max3_f32 v80, v48, v49, v50
    v_max3_f32 v80, v80, v51, v52
    v_max3_f32 v80, v80, v53, v54
    v_max_f32 v80, v80, v55
    v_mov_b32 v81, 0xff800000
    v_cndmask_b32 v80, v81, v80, s[50:51]
    s_nop 1
    v_max_f32 v80, v80, v80 quad_perm:[1,0,3,2] row_mask:0xf bank_mask:0xf
    s_nop 1
    v_max_f32 v80, v80, v80 quad_perm:[2,3,0,1] row_mask:0xf bank_mask:0xf
    s_nop 1
    v_max_f32 v80, v80, v80 row_half_mirror row_mask:0xf bank_mask:0xf
    s_mov_b32 s24, 0x3dd53b95
    v_mul_f32 v80, s24, v80
    v_fma_f32 v48, v48, s24, -v80
    v_fma_f32 v49, v49, s24, -v80
    v_fma_f32 v50, v50, s24, -v80
    v_fma_f32 v51, v51, s24, -v80
    v_fma_f32 v52, v52, s24, -v80
    v_fma_f32 v53, v53, s24, -v80
    v_fma_f32 v54, v54, s24, -v80
    v_fma_f32 v55, v55, s24, -v80
    v_exp_f32 v48, v48
    v_exp_f32 v49, v49
    v_exp_f32 v50, v50
    v_exp_f32 v51, v51
    v_exp_f32 v52, v52
    v_exp_f32 v53, v53
    v_exp_f32 v54, v54
    v_exp_f32 v55, v55
    v_add_f32 v80, v48, v49
    v_add_f32 v81, v50, v51
    v_add_f32 v80, v80, v52
    v_add_f32 v81, v81, v53
    v_add_f32 v80, v80, v54
    v_add_f32 v81, v81, v55
    v_add_f32 v80, v80, v81
    v_cndmask_b32 v80, 0, v80, s[50:51]
    s_nop 1
    v_add_f32 v80, v80, v80 quad_perm:[1,0,3,2] row_mask:0xf bank_mask:0xf
    s_nop 1
    v_add_f32 v80, v80, v80 quad_perm:[2,3,0,1] row_mask:0xf bank_mask:0xf
    s_nop 1
    v_add_f32 v80, v80, v80 row_half_mirror row_mask:0xf bank_mask:0xf
    v_rcp_f32 v80, v80
    s_nop 0
    v_mul_f32 v48, v48, v80
    v_mul_f32 v49, v49, v80
    v_mul_f32 v50, v50, v80
    v_mul_f32 v51, v51, v80
    v_mul_f32 v52, v52, v80
    v_mul_f32 v53, v53, v80
    v_mul_f32 v54, v54, v80
    v_mul_f32 v55, v55, v80
    v_cvt_pk_bf16_f32 v56, v48, v49
    v_cvt_pk_bf16_f32 v57, v50, v51
    v_cvt_pk_bf16_f32 v58, v52, v53
    v_cvt_pk_bf16_f32 v59, v54, v55
    v_min_u32 v56, -2, v56
    v_min_u32 v57, -2, v57
    v_min_u32 v58, -2, v58
    v_min_u32 v59, -2, v59
    buffer_store_dwordx4 v[56:59], v22, s[8:11], s42 offen sc1
    s_add_u32 s42, s42, 458752
    s_waitcnt vmcnt(1)
    v_max3_u32 v58, v84, v85, v86
    v_max3_u32 v58, v58, v87, v88
    v_max3_u32 v58, v58, v89, v90
    v_max3_u32 v58, v58, v91, v92
    v_max_u32 v58, v58, v93
    v_cmp_eq_u32 vcc, -1, v58
    s_cbranch_vccz interleave_layers__linear_attn_block__memory_aug_recurrent_mem_tr__prompt_kernel_s_pmw0_out
    s_mov_b32 s61, 0
interleave_layers__linear_attn_block__memory_aug_recurrent_mem_tr__prompt_kernel_s_pmw0:
    buffer_load_dwordx4 v[84:87], v7, s[8:11], s47 offen sc1
    buffer_load_dwordx4 v[88:91], v7, s[8:11], s46 offen sc1
    buffer_load_dwordx2 v[92:93], v8, s[8:11], s47 offen sc1
    s_waitcnt vmcnt(0)
    v_max3_u32 v58, v84, v85, v86
    v_max3_u32 v58, v58, v87, v88
    v_max3_u32 v58, v58, v89, v90
    v_max3_u32 v58, v58, v91, v92
    v_max_u32 v58, v58, v93
    v_cmp_eq_u32 vcc, -1, v58
    s_add_u32 s61, s61, 1
    s_cbranch_vccz interleave_layers__linear_attn_block__memory_aug_recurrent_mem_tr__prompt_kernel_s_pmw0_out
    s_cmp_ge_u32 s61, s60
    s_cbranch_scc1 interleave_layers__linear_attn_block__memory_aug_recurrent_mem_tr__prompt_kernel_s_pmw0_to
    s_sleep 1
    s_branch interleave_layers__linear_attn_block__memory_aug_recurrent_mem_tr__prompt_kernel_s_pmw0
interleave_layers__linear_attn_block__memory_aug_recurrent_mem_tr__prompt_kernel_s_pmw0_to:
    s_mov_b32 s60, 1
interleave_layers__linear_attn_block__memory_aug_recurrent_mem_tr__prompt_kernel_s_pmw0_out:
    ds_write_b128 v7, v[84:87]
    ds_write_b128 v7, v[88:91] offset:4096
    ds_write_b64 v8, v[92:93]
interleave_layers__linear_attn_block__memory_aug_recurrent_mem_tr__prompt_kernel_s_gow0:
    ds_read_b128 v[68:71], v6 offset:0
    ds_read_b128 v[72:75], v6 offset:1024
    ds_read_b128 v[76:79], v6 offset:8192
    ds_read_b128 v[80:83], v6 offset:9216
    v_smfmac_f32_16x16x64_bf16 v[24:27], v[84:87], a[0:7], v4
    v_smfmac_f32_16x16x64_bf16 v[28:31], v[84:87], a[80:87], v4
    v_smfmac_f32_16x16x64_bf16 v[32:35], v[84:87], a[160:167], v4
    v_smfmac_f32_16x16x64_bf16 v[40:43], v[84:87], v[96:103], v4
    v_smfmac_f32_16x16x64_bf16 v[44:47], v[84:87], v[176:183], v4
    s_waitcnt lgkmcnt(2)
    v_smfmac_f32_16x16x64_bf16 v[36:39], v[84:87], v[68:75], v4
    ds_read_b128 v[68:71], v6 offset:2048
    ds_read_b128 v[72:75], v6 offset:3072
    s_barrier
    ds_read_b128 v[48:51], v5 offset:1024
    ds_read_b128 v[52:55], v5 offset:2048
    ds_read_b128 v[56:59], v5 offset:3072
    ds_read_b128 v[60:63], v5 offset:5120
    ds_read_b128 v[64:67], v5 offset:6144
    v_smfmac_f32_16x16x64_bf16 v[24:27], v[88:91], a[32:39], v4
    v_smfmac_f32_16x16x64_bf16 v[28:31], v[88:91], a[112:119], v4
    v_smfmac_f32_16x16x64_bf16 v[32:35], v[88:91], a[192:199], v4
    v_smfmac_f32_16x16x64_bf16 v[40:43], v[88:91], v[128:135], v4
    v_smfmac_f32_16x16x64_bf16 v[44:47], v[88:91], v[208:215], v4
    s_waitcnt lgkmcnt(7)
    v_smfmac_f32_16x16x64_bf16 v[36:39], v[88:91], v[76:83], v4
    ds_read_b128 v[76:79], v6 offset:4096
    ds_read_b128 v[80:83], v6 offset:5120
    s_waitcnt lgkmcnt(6)
    v_smfmac_f32_16x16x64_bf16 v[24:27], v[48:51], a[8:15], v4
    v_smfmac_f32_16x16x64_bf16 v[28:31], v[48:51], a[88:95], v4
    v_smfmac_f32_16x16x64_bf16 v[40:43], v[48:51], v[104:111], v4
    v_smfmac_f32_16x16x64_bf16 v[36:39], v[48:51], v[68:75], v4
    ds_read_b128 v[68:71], v6 offset:6144
    ds_read_b128 v[72:75], v6 offset:7168
    ds_read_b128 v[48:51], v5 offset:7168
    s_waitcnt lgkmcnt(8)
    v_smfmac_f32_16x16x64_bf16 v[24:27], v[52:55], a[16:23], v4
    v_smfmac_f32_16x16x64_bf16 v[28:31], v[52:55], a[96:103], v4
    v_smfmac_f32_16x16x64_bf16 v[40:43], v[52:55], v[112:119], v4
    s_waitcnt lgkmcnt(3)
    v_smfmac_f32_16x16x64_bf16 v[36:39], v[52:55], v[76:83], v4
    ds_read_b128 v[76:79], v6 offset:10240
    ds_read_b128 v[80:83], v6 offset:11264
    ds_read_b128 v[52:55], v5 offset:8192
    v_smfmac_f32_16x16x64_bf16 v[24:27], v[56:59], a[24:31], v4
    v_smfmac_f32_16x16x64_bf16 v[28:31], v[56:59], a[104:111], v4
    v_smfmac_f32_16x16x64_bf16 v[40:43], v[56:59], v[120:127], v4
    s_waitcnt lgkmcnt(4)
    v_smfmac_f32_16x16x64_bf16 v[36:39], v[56:59], v[68:75], v4
    ds_read_b128 v[68:71], v6 offset:12288
    ds_read_b128 v[72:75], v6 offset:13312
    ds_read_b128 v[56:59], v5 offset:9216
    v_smfmac_f32_16x16x64_bf16 v[24:27], v[60:63], a[40:47], v4
    v_smfmac_f32_16x16x64_bf16 v[28:31], v[60:63], a[120:127], v4
    v_smfmac_f32_16x16x64_bf16 v[40:43], v[60:63], v[136:143], v4
    s_waitcnt lgkmcnt(4)
    v_smfmac_f32_16x16x64_bf16 v[36:39], v[60:63], v[76:83], v4
    ds_read_b128 v[76:79], v6 offset:14336
    ds_read_b128 v[80:83], v6 offset:15360
    ds_read_b128 v[60:63], v5 offset:1024
    v_smfmac_f32_16x16x64_bf16 v[24:27], v[64:67], a[48:55], v4
    v_smfmac_f32_16x16x64_bf16 v[28:31], v[64:67], a[128:135], v4
    v_smfmac_f32_16x16x64_bf16 v[40:43], v[64:67], v[144:151], v4
    s_waitcnt lgkmcnt(4)
    v_smfmac_f32_16x16x64_bf16 v[36:39], v[64:67], v[68:75], v4
    ds_read_b128 v[68:71], v6 offset:16384
    ds_read_b128 v[72:75], v6 offset:17408
    ds_read_b128 v[64:67], v5 offset:2048
    v_smfmac_f32_16x16x64_bf16 v[24:27], v[48:51], a[56:63], v4
    v_smfmac_f32_16x16x64_bf16 v[28:31], v[48:51], a[136:143], v4
    v_smfmac_f32_16x16x64_bf16 v[40:43], v[48:51], v[152:159], v4
    s_waitcnt lgkmcnt(4)
    v_smfmac_f32_16x16x64_bf16 v[36:39], v[48:51], v[76:83], v4
    ds_read_b128 v[76:79], v6 offset:18432
    ds_read_b128 v[80:83], v6 offset:19456
    ds_read_b128 v[48:51], v5 offset:3072
    v_smfmac_f32_16x16x64_bf16 v[24:27], v[52:55], a[64:71], v4
    v_smfmac_f32_16x16x64_bf16 v[28:31], v[52:55], a[144:151], v4
    v_smfmac_f32_16x16x64_bf16 v[40:43], v[52:55], v[160:167], v4
    s_waitcnt lgkmcnt(4)
    v_smfmac_f32_16x16x64_bf16 v[36:39], v[52:55], v[68:75], v4
    ds_read_b128 v[52:55], v5 offset:5120
    v_smfmac_f32_16x16x64_bf16 v[24:27], v[56:59], a[72:79], v4
    v_smfmac_f32_16x16x64_bf16 v[28:31], v[56:59], a[152:159], v4
    v_smfmac_f32_16x16x64_bf16 v[40:43], v[56:59], v[168:175], v4
    s_waitcnt lgkmcnt(2)
    v_smfmac_f32_16x16x64_bf16 v[36:39], v[56:59], v[76:83], v4
    ds_read_b128 v[56:59], v5 offset:6144
    buffer_load_dwordx4 v[80:83], v19, s[8:11], s45 offen offset:0 sc1
    buffer_load_dwordx4 v[84:87], v19, s[8:11], s45 offen offset:1024 sc1
    buffer_load_dwordx4 v[88:91], v19, s[8:11], s45 offen offset:2048 sc1
    v_smfmac_f32_16x16x64_bf16 v[32:35], v[60:63], a[168:175], v4
    v_smfmac_f32_16x16x64_bf16 v[44:47], v[60:63], v[184:191], v4
    v_permlane32_swap_b32 v28, v40
    v_permlane32_swap_b32 v29, v41
    ds_read_b128 v[60:63], v5 offset:7168
    v_smfmac_f32_16x16x64_bf16 v[32:35], v[64:67], a[176:183], v4
    v_permlane32_swap_b32 v30, v42
    v_permlane32_swap_b32 v31, v43
    v_smfmac_f32_16x16x64_bf16 v[44:47], v[64:67], v[192:199], v4
    v_add_f32 v28, v28, v40
    v_add_f32 v29, v29, v41
    ds_read_b128 v[64:67], v5 offset:8192
    s_waitcnt lgkmcnt(4)
    v_smfmac_f32_16x16x64_bf16 v[32:35], v[48:51], a[184:191], v4
    v_add_f32 v30, v30, v42
    v_add_f32 v31, v31, v43
    v_smfmac_f32_16x16x64_bf16 v[44:47], v[48:51], v[200:207], v4
    v_cvt_pk_bf16_f32 v40, v28, v29
    v_cvt_pk_bf16_f32 v41, v30, v31
    ds_read_b128 v[48:51], v5 offset:9216
    s_waitcnt lgkmcnt(4)
    v_smfmac_f32_16x16x64_bf16 v[32:35], v[52:55], a[200:207], v4
    v_mfma_f32_16x16x16_bf16 v[28:31], v[40:41], v[10:11], 0
    v_permlane32_swap_b32 v24, v36
    v_smfmac_f32_16x16x64_bf16 v[44:47], v[52:55], v[216:223], v4
    v_permlane32_swap_b32 v25, v37
    v_permlane32_swap_b32 v26, v38
    s_waitcnt lgkmcnt(3)
    v_smfmac_f32_16x16x64_bf16 v[32:35], v[56:59], a[208:215], v4
    v_permlane32_swap_b32 v27, v39
    v_add_f32 v24, v24, v36
    v_smfmac_f32_16x16x64_bf16 v[44:47], v[56:59], v[224:231], v4
    v_add_f32 v25, v25, v37
    v_add_f32 v26, v26, v38
    s_waitcnt lgkmcnt(2)
    v_smfmac_f32_16x16x64_bf16 v[32:35], v[60:63], a[216:223], v4
    v_add_f32 v27, v27, v39
    v_cvt_pk_bf16_f32 v36, v24, v25
    v_smfmac_f32_16x16x64_bf16 v[44:47], v[60:63], v[232:239], v4
    v_cvt_pk_bf16_f32 v37, v26, v27
    s_nop 1
    v_mfma_f32_16x16x16_bf16 v[24:27], v[36:37], v[10:11], 0
    s_waitcnt lgkmcnt(1)
    v_smfmac_f32_16x16x64_bf16 v[32:35], v[64:67], a[224:231], v4
    s_nop 5
    v_cvt_pk_bf16_f32 v24, v24, v25
    v_smfmac_f32_16x16x64_bf16 v[44:47], v[64:67], v[240:247], v4
    v_cvt_pk_bf16_f32 v25, v26, v27
    v_cvt_pk_bf16_f32 v26, v28, v29
    s_waitcnt lgkmcnt(0)
    v_smfmac_f32_16x16x64_bf16 v[32:35], v[48:51], a[232:239], v4
    v_cvt_pk_bf16_f32 v27, v30, v31
    s_waitcnt vmcnt(3)
    v_smfmac_f32_16x16x64_bf16 v[44:47], v[48:51], v[248:255], v4
    v_mfma_f32_16x16x32_bf16 v[28:31], a[240:243], v[24:27], 0
    v_mfma_f32_16x16x32_bf16 v[36:39], a[244:247], v[24:27], 0
    v_mfma_f32_16x16x32_bf16 v[40:43], v[24:27], v[24:27], 0
    s_nop 4
    v_permlane32_swap_b32 v32, v44
    v_permlane32_swap_b32 v33, v45
    v_permlane32_swap_b32 v34, v46
    v_permlane32_swap_b32 v35, v47
    v_add_f32 v32, v32, v44
    v_add_f32 v33, v33, v45
    v_add_f32 v34, v34, v46
    v_add_f32 v35, v35, v47
    v_cvt_pk_bf16_f32 v44, v32, v33
    v_cvt_pk_bf16_f32 v45, v34, v35
    s_nop 1
    v_mfma_f32_16x16x16_bf16 v[32:35], v[44:45], v[10:11], 0
    s_nop 7
    v_cvt_pk_bf16_f32 v32, v32, v33
    v_cvt_pk_bf16_f32 v33, v34, v35
    s_nop 1
    v_mfma_f32_16x16x16_bf16 v[28:31], a[248:249], v[32:33], v[28:31]
    v_mfma_f32_16x16x16_bf16 v[36:39], a[250:251], v[32:33], v[36:39]
    v_mfma_f32_16x16x16_bf16 v[40:43], v[32:33], v[32:33], v[40:43]
    buffer_atomic_add v0, v20, s[8:11], s49 offen
    s_nop 4
    ds_write_b128 v12, v[28:31]
    ds_write_b128 v12, v[36:39] offset:16
    ds_write_b128 v13, v[40:43]
    s_waitcnt lgkmcnt(0)
    s_barrier
    ds_read_b128 v[48:51], v14 offset:0
    ds_read_b128 v[52:55], v14 offset:16
    ds_read_b128 v[56:59], v14 offset:1408
    ds_read_b128 v[60:63], v14 offset:1424
    ds_read_b128 v[64:67], v14 offset:2816
    ds_read_b128 v[68:71], v14 offset:2832
    ds_read_b128 v[72:75], v14 offset:4224
    ds_read_b128 v[76:79], v14 offset:4240
    s_waitcnt lgkmcnt(4)
    v_pk_add_f32 v[48:49], v[48:49], v[56:57]
    v_pk_add_f32 v[50:51], v[50:51], v[58:59]
    v_pk_add_f32 v[52:53], v[52:53], v[60:61]
    v_pk_add_f32 v[54:55], v[54:55], v[62:63]
    s_waitcnt lgkmcnt(0)
    v_pk_add_f32 v[64:65], v[64:65], v[72:73]
    v_pk_add_f32 v[66:67], v[66:67], v[74:75]
    v_pk_add_f32 v[68:69], v[68:69], v[76:77]
    v_pk_add_f32 v[70:71], v[70:71], v[78:79]
    v_pk_add_f32 v[48:49], v[48:49], v[64:65]
    v_pk_add_f32 v[50:51], v[50:51], v[66:67]
    v_pk_add_f32 v[52:53], v[52:53], v[68:69]
    v_pk_add_f32 v[54:55], v[54:55], v[70:71]
    v_max3_f32 v92, v48, v49, v50
    v_max3_f32 v92, v92, v51, v52
    v_max3_f32 v92, v92, v53, v54
    v_max_f32 v92, v92, v55
    v_mov_b32 v93, 0xff800000
    v_cndmask_b32 v92, v93, v92, s[50:51]
    s_nop 1
    v_max_f32 v92, v92, v92 quad_perm:[1,0,3,2] row_mask:0xf bank_mask:0xf
    s_nop 1
    v_max_f32 v92, v92, v92 quad_perm:[2,3,0,1] row_mask:0xf bank_mask:0xf
    s_nop 1
    v_max_f32 v92, v92, v92 row_half_mirror row_mask:0xf bank_mask:0xf
    s_mov_b32 s24, 0x3dd53b95
    v_mul_f32 v92, s24, v92
    v_fma_f32 v48, v48, s24, -v92
    v_fma_f32 v49, v49, s24, -v92
    v_fma_f32 v50, v50, s24, -v92
    v_fma_f32 v51, v51, s24, -v92
    v_fma_f32 v52, v52, s24, -v92
    v_fma_f32 v53, v53, s24, -v92
    v_fma_f32 v54, v54, s24, -v92
    v_fma_f32 v55, v55, s24, -v92
    v_exp_f32 v48, v48
    v_exp_f32 v49, v49
    v_exp_f32 v50, v50
    v_exp_f32 v51, v51
    v_exp_f32 v52, v52
    v_exp_f32 v53, v53
    v_exp_f32 v54, v54
    v_exp_f32 v55, v55
    v_add_f32 v92, v48, v49
    v_add_f32 v93, v50, v51
    v_add_f32 v92, v92, v52
    v_add_f32 v93, v93, v53
    v_add_f32 v92, v92, v54
    v_add_f32 v93, v93, v55
    v_add_f32 v92, v92, v93
    v_cndmask_b32 v92, 0, v92, s[50:51]
    s_nop 1
    v_add_f32 v92, v92, v92 quad_perm:[1,0,3,2] row_mask:0xf bank_mask:0xf
    s_nop 1
    v_add_f32 v92, v92, v92 quad_perm:[2,3,0,1] row_mask:0xf bank_mask:0xf
    s_nop 1
    v_add_f32 v92, v92, v92 row_half_mirror row_mask:0xf bank_mask:0xf
    v_rcp_f32 v92, v92
    s_nop 0
    v_mul_f32 v48, v48, v92
    v_mul_f32 v49, v49, v92
    v_mul_f32 v50, v50, v92
    v_mul_f32 v51, v51, v92
    v_mul_f32 v52, v52, v92
    v_mul_f32 v53, v53, v92
    v_mul_f32 v54, v54, v92
    v_mul_f32 v55, v55, v92
    v_cvt_pk_bf16_f32 v56, v48, v49
    v_cvt_pk_bf16_f32 v57, v50, v51
    v_cvt_pk_bf16_f32 v58, v52, v53
    v_cvt_pk_bf16_f32 v59, v54, v55
    v_min_u32 v56, -2, v56
    v_min_u32 v57, -2, v57
    v_min_u32 v58, -2, v58
    v_min_u32 v59, -2, v59
    buffer_store_dwordx4 v[56:59], v15, s[8:11], s43 offen sc1
    s_waitcnt vmcnt(2)
    v_mfma_f32_16x16x32_bf16 v[36:39], a[240:243], v[80:83], 0
    v_mfma_f32_16x16x32_bf16 v[44:47], a[244:247], v[80:83], 0
    v_mfma_f32_16x16x32_bf16 v[68:71], v[24:27], v[80:83], 0
    v_mfma_f32_16x16x32_bf16 v[40:43], a[240:243], v[84:87], 0
    v_mfma_f32_16x16x32_bf16 v[64:67], a[244:247], v[84:87], 0
    v_mfma_f32_16x16x32_bf16 v[72:75], v[24:27], v[84:87], 0
    s_nop 0
    v_mfma_f32_16x16x16_bf16 v[36:39], a[248:249], v[88:89], v[36:39]
    v_mfma_f32_16x16x16_bf16 v[44:47], a[250:251], v[88:89], v[44:47]
    v_mfma_f32_16x16x16_bf16 v[68:71], v[32:33], v[88:89], v[68:71]
    v_mfma_f32_16x16x16_bf16 v[40:43], a[248:249], v[90:91], v[40:43]
    v_mfma_f32_16x16x16_bf16 v[64:67], a[250:251], v[90:91], v[64:67]
    v_mfma_f32_16x16x16_bf16 v[72:75], v[32:33], v[90:91], v[72:75]
    s_nop 2
    ds_write_b128 v16, v[36:39] offset:0
    ds_write_b128 v16, v[44:47] offset:16
    ds_write_b128 v17, v[68:71]
    ds_write_b128 v16, v[40:43] offset:2816
    ds_write_b128 v16, v[64:67] offset:2832
    ds_write_b128 v18, v[72:75]
    s_add_u32 s40, s40, 1
    s_add_u32 s41, s41, 393216
    s_add_u32 s45, s45, 393216
    s_add_u32 s43, s43, 458752
    s_add_u32 s47, s47, 458752
    s_add_u32 s48, s48, 458752
    s_add_u32 s49, s49, 458752
    s_waitcnt lgkmcnt(0)
    s_barrier
    s_cmp_lt_u32 s40, 64
    s_cbranch_scc1 interleave_layers__linear_attn_block__memory_aug_recurrent_mem_tr__prompt_kernel_s_stepw0
    s_branch interleave_layers__linear_attn_block__memory_aug_recurrent_mem_tr__prompt_kernel_s_end
interleave_layers__linear_attn_block__memory_aug_recurrent_mem_tr__prompt_kernel_s_stepw1:
    v_mov_b32 v24, 0
    v_mov_b32 v25, 0
    v_mov_b32 v26, 0
    v_mov_b32 v27, 0
    v_mov_b32 v28, 0
    v_mov_b32 v29, 0
    v_mov_b32 v30, 0
    v_mov_b32 v31, 0
    v_mov_b32 v32, 0
    v_mov_b32 v33, 0
    v_mov_b32 v34, 0
    v_mov_b32 v35, 0
    v_mov_b32 v36, 0
    v_mov_b32 v37, 0
    v_mov_b32 v38, 0
    v_mov_b32 v39, 0
    v_mov_b32 v40, 0
    v_mov_b32 v41, 0
    v_mov_b32 v42, 0
    v_mov_b32 v43, 0
    v_mov_b32 v44, 0
    v_mov_b32 v45, 0
    v_mov_b32 v46, 0
    v_mov_b32 v47, 0
    s_add_u32 s46, s47, 4096
    s_lshl_b32 s95, s92, 6
    s_add_u32 s95, s95, s40
    s_add_u32 s95, s95, 1
    s_cmp_ge_i32 s59, s95
    s_cbranch_scc1 interleave_layers__linear_attn_block__memory_aug_recurrent_mem_tr__prompt_kernel_s_ecw1_ok
    s_and_b32 s24, s2, 7
    s_lshl_b32 s24, s24, 7
    s_add_u32 s24, s24, 23109632
    v_and_b32 v49, 3, v1
    v_lshl_add_u32 v49, v49, 2, s24
    s_mov_b32 s61, 0
interleave_layers__linear_attn_block__memory_aug_recurrent_mem_tr__prompt_kernel_s_ecw1:
    buffer_load_dword v48, v49, s[8:11], 0 offen sc1
    s_waitcnt vmcnt(0)
    v_readlane_b32 s59, v48, 0
    v_readlane_b32 s24, v48, 1
    s_min_i32 s59, s59, s24
    v_readlane_b32 s24, v48, 2
    s_min_i32 s59, s59, s24
    s_cmp_ge_i32 s59, s95
    s_cbranch_scc1 interleave_layers__linear_attn_block__memory_aug_recurrent_mem_tr__prompt_kernel_s_ecw1_ok
    s_add_u32 s61, s61, 1
    s_cmp_ge_u32 s61, s60
    s_cbranch_scc1 interleave_layers__linear_attn_block__memory_aug_recurrent_mem_tr__prompt_kernel_s_ecw1_to
    s_sleep 2
    s_branch interleave_layers__linear_attn_block__memory_aug_recurrent_mem_tr__prompt_kernel_s_ecw1
interleave_layers__linear_attn_block__memory_aug_recurrent_mem_tr__prompt_kernel_s_ecw1_to:
    s_mov_b32 s60, 1
interleave_layers__linear_attn_block__memory_aug_recurrent_mem_tr__prompt_kernel_s_ecw1_ok:
    s_add_u32 s63, s40, 1
    s_cmp_ge_i32 s62, s63
    s_cbranch_scc1 interleave_layers__linear_attn_block__memory_aug_recurrent_mem_tr__prompt_kernel_s_enw1_ok
    s_mov_b32 s61, 0
interleave_layers__linear_attn_block__memory_aug_recurrent_mem_tr__prompt_kernel_s_enw1:
    buffer_load_dword v48, v9, s[8:11], 0 offen sc1
    s_waitcnt vmcnt(0)
    v_readlane_b32 s62, v48, 0
    v_readlane_b32 s24, v48, 1
    s_min_i32 s62, s62, s24
    s_cmp_ge_i32 s62, s63
    s_cbranch_scc1 interleave_layers__linear_attn_block__memory_aug_recurrent_mem_tr__prompt_kernel_s_enw1_ok
    s_add_u32 s61, s61, 1
    s_cmp_ge_u32 s61, s60
    s_cbranch_scc1 interleave_layers__linear_attn_block__memory_aug_recurrent_mem_tr__prompt_kernel_s_enw1_to
    s_sleep 2
    s_branch interleave_layers__linear_attn_block__memory_aug_recurrent_mem_tr__prompt_kernel_s_enw1
interleave_layers__linear_attn_block__memory_aug_recurrent_mem_tr__prompt_kernel_s_enw1_to:
    s_mov_b32 s60, 1
interleave_layers__linear_attn_block__memory_aug_recurrent_mem_tr__prompt_kernel_s_enw1_ok:
    buffer_load_dwordx4 a[240:243], v19, s[8:11], s41 offen offset:0 sc1
    buffer_load_dwordx4 a[244:247], v19, s[8:11], s41 offen offset:1024 sc1
    buffer_load_dwordx4 a[248:251], v19, s[8:11], s41 offen offset:2048 sc1
    s_sleep 5
    s_mov_b64 exec, 1
    s_mov_b32 s61, 0
    v_mov_b32 v83, 0
    buffer_atomic_add v83, v23, s[8:11], s48 offen sc0
    s_sleep 3
    v_mov_b32 v94, 0
    buffer_atomic_add v94, v23, s[8:11], s48 offen sc0
    s_sleep 3
    v_mov_b32 v95, 0
    buffer_atomic_add v95, v23, s[8:11], s48 offen sc0
    s_sleep 3
interleave_layers__linear_attn_block__memory_aug_recurrent_mem_tr__prompt_kernel_s_prw1:
    v_mov_b32 v82, 0
    buffer_atomic_add v82, v23, s[8:11], s48 offen sc0
    s_waitcnt vmcnt(3)
    v_cmp_le_i32 vcc, 8, v83
    s_add_u32 s61, s61, 1
    s_cbranch_vccnz interleave_layers__linear_attn_block__memory_aug_recurrent_mem_tr__prompt_kernel_s_prw1_out
    s_sleep 3
    v_mov_b32 v83, 0
    buffer_atomic_add v83, v23, s[8:11], s48 offen sc0
    s_waitcnt vmcnt(3)
    v_cmp_le_i32 vcc, 8, v94
    s_add_u32 s61, s61, 1
    s_cbranch_vccnz interleave_layers__linear_attn_block__memory_aug_recurrent_mem_tr__prompt_kernel_s_prw1_out
    s_sleep 3
    v_mov_b32 v94, 0
    buffer_atomic_add v94, v23, s[8:11], s48 offen sc0
    s_waitcnt vmcnt(3)
    v_cmp_le_i32 vcc, 8, v95
    s_add_u32 s61, s61, 1
    s_cbranch_vccnz interleave_layers__linear_attn_block__memory_aug_recurrent_mem_tr__prompt_kernel_s_prw1_out
    s_sleep 3
    v_mov_b32 v95, 0
    buffer_atomic_add v95, v23, s[8:11], s48 offen sc0
    s_waitcnt vmcnt(3)
    v_cmp_le_i32 vcc, 8, v82
    s_add_u32 s61, s61, 1
    s_cbranch_vccnz interleave_layers__linear_attn_block__memory_aug_recurrent_mem_tr__prompt_kernel_s_prw1_out
    s_sleep 3
    s_cmp_ge_u32 s61, s60
    s_cbranch_scc0 interleave_layers__linear_attn_block__memory_aug_recurrent_mem_tr__prompt_kernel_s_prw1
    s_mov_b32 s60, 1
interleave_layers__linear_attn_block__memory_aug_recurrent_mem_tr__prompt_kernel_s_prw1_out:
    s_mov_b64 exec, -1
    buffer_load_dwordx4 v[84:87], v7, s[8:11], s47 offen sc1
    buffer_load_dwordx4 v[88:91], v7, s[8:11], s46 offen sc1
    buffer_load_dwordx2 v[92:93], v8, s[8:11], s47 offen sc1
    ds_read_b128 v[48:51], v21 offset:0
    ds_read_b128 v[52:55], v21 offset:16
    ds_read_b128 v[56:59], v21 offset:5632
    ds_read_b128 v[60:63], v21 offset:5648
    ds_read_b128 v[64:67], v21 offset:11264
    ds_read_b128 v[68:71], v21 offset:11280
    ds_read_b128 v[72:75], v21 offset:16896
    ds_read_b128 v[76:79], v21 offset:16912
    s_waitcnt lgkmcnt(4)
    v_pk_add_f32 v[48:49], v[48:49], v[56:57]
    v_pk_add_f32 v[50:51], v[50:51], v[58:59]
    v_pk_add_f32 v[52:53], v[52:53], v[60:61]
    v_pk_add_f32 v[54:55], v[54:55], v[62:63]
    s_waitcnt lgkmcnt(0)
    v_pk_add_f32 v[64:65], v[64:65], v[72:73]
    v_pk_add_f32 v[66:67], v[66:67], v[74:75]
    v_pk_add_f32 v[68:69], v[68:69], v[76:77]
    v_pk_add_f32 v[70:71], v[70:71], v[78:79]
    v_pk_add_f32 v[48:49], v[48:49], v[64:65]
    v_pk_add_f32 v[50:51], v[50:51], v[66:67]
    v_pk_add_f32 v[52:53], v[52:53], v[68:69]
    v_pk_add_f32 v[54:55], v[54:55], v[70:71]
    v_mov_b32 v81, 0xff800000
    v_cndmask_b32 v48, v81, v48, s[64:65]
    v_cndmask_b32 v49, v81, v49, s[66:67]
    v_cndmask_b32 v50, v81, v50, s[68:69]
    v_cndmask_b32 v51, v81, v51, s[70:71]
    v_cndmask_b32 v52, v81, v52, s[72:73]
    v_cndmask_b32 v53, v81, v53, s[74:75]
    v_cndmask_b32 v54, v81, v54, s[76:77]
    v_cndmask_b32 v55, v81, v55, s[78:79]
    v_max3_f32 v80, v48, v49, v50
    v_max3_f32 v80, v80, v51, v52
    v_max3_f32 v80, v80, v53, v54
    v_max_f32 v80, v80, v55
    v_mov_b32 v81, 0xff800000
    v_cndmask_b32 v80, v81, v80, s[50:51]
    s_nop 1
    v_max_f32 v80, v80, v80 quad_perm:[1,0,3,2] row_mask:0xf bank_mask:0xf
    s_nop 1
    v_max_f32 v80, v80, v80 quad_perm:[2,3,0,1] row_mask:0xf bank_mask:0xf
    s_nop 1
    v_max_f32 v80, v80, v80 row_half_mirror row_mask:0xf bank_mask:0xf
    s_mov_b32 s24, 0x3dd53b95
    v_mul_f32 v80, s24, v80
    v_fma_f32 v48, v48, s24, -v80
    v_fma_f32 v49, v49, s24, -v80
    v_fma_f32 v50, v50, s24, -v80
    v_fma_f32 v51, v51, s24, -v80
    v_fma_f32 v52, v52, s24, -v80
    v_fma_f32 v53, v53, s24, -v80
    v_fma_f32 v54, v54, s24, -v80
    v_fma_f32 v55, v55, s24, -v80
    v_exp_f32 v48, v48
    v_exp_f32 v49, v49
    v_exp_f32 v50, v50
    v_exp_f32 v51, v51
    v_exp_f32 v52, v52
    v_exp_f32 v53, v53
    v_exp_f32 v54, v54
    v_exp_f32 v55, v55
    v_add_f32 v80, v48, v49
    v_add_f32 v81, v50, v51
    v_add_f32 v80, v80, v52
    v_add_f32 v81, v81, v53
    v_add_f32 v80, v80, v54
    v_add_f32 v81, v81, v55
    v_add_f32 v80, v80, v81
    v_cndmask_b32 v80, 0, v80, s[50:51]
    s_nop 1
    v_add_f32 v80, v80, v80 quad_perm:[1,0,3,2] row_mask:0xf bank_mask:0xf
    s_nop 1
    v_add_f32 v80, v80, v80 quad_perm:[2,3,0,1] row_mask:0xf bank_mask:0xf
    s_nop 1
    v_add_f32 v80, v80, v80 row_half_mirror row_mask:0xf bank_mask:0xf
    v_rcp_f32 v80, v80
    s_nop 0
    v_mul_f32 v48, v48, v80
    v_mul_f32 v49, v49, v80
    v_mul_f32 v50, v50, v80
    v_mul_f32 v51, v51, v80
    v_mul_f32 v52, v52, v80
    v_mul_f32 v53, v53, v80
    v_mul_f32 v54, v54, v80
    v_mul_f32 v55, v55, v80
    v_cvt_pk_bf16_f32 v56, v48, v49
    v_cvt_pk_bf16_f32 v57, v50, v51
    v_cvt_pk_bf16_f32 v58, v52, v53
    v_cvt_pk_bf16_f32 v59, v54, v55
    v_min_u32 v56, -2, v56
    v_min_u32 v57, -2, v57
    v_min_u32 v58, -2, v58
    v_min_u32 v59, -2, v59
    buffer_store_dwordx4 v[56:59], v22, s[8:11], s42 offen sc1
    s_add_u32 s42, s42, 458752
    s_waitcnt vmcnt(1)
    v_max3_u32 v58, v84, v85, v86
    v_max3_u32 v58, v58, v87, v88
    v_max3_u32 v58, v58, v89, v90
    v_max3_u32 v58, v58, v91, v92
    v_max_u32 v58, v58, v93
    v_cmp_eq_u32 vcc, -1, v58
    s_cbranch_vccz interleave_layers__linear_attn_block__memory_aug_recurrent_mem_tr__prompt_kernel_s_pmw1_out
    s_mov_b32 s61, 0
interleave_layers__linear_attn_block__memory_aug_recurrent_mem_tr__prompt_kernel_s_pmw1:
    buffer_load_dwordx4 v[84:87], v7, s[8:11], s47 offen sc1
    buffer_load_dwordx4 v[88:91], v7, s[8:11], s46 offen sc1
    buffer_load_dwordx2 v[92:93], v8, s[8:11], s47 offen sc1
    s_waitcnt vmcnt(0)
    v_max3_u32 v58, v84, v85, v86
    v_max3_u32 v58, v58, v87, v88
    v_max3_u32 v58, v58, v89, v90
    v_max3_u32 v58, v58, v91, v92
    v_max_u32 v58, v58, v93
    v_cmp_eq_u32 vcc, -1, v58
    s_add_u32 s61, s61, 1
    s_cbranch_vccz interleave_layers__linear_attn_block__memory_aug_recurrent_mem_tr__prompt_kernel_s_pmw1_out
    s_cmp_ge_u32 s61, s60
    s_cbranch_scc1 interleave_layers__linear_attn_block__memory_aug_recurrent_mem_tr__prompt_kernel_s_pmw1_to
    s_sleep 1
    s_branch interleave_layers__linear_attn_block__memory_aug_recurrent_mem_tr__prompt_kernel_s_pmw1
interleave_layers__linear_attn_block__memory_aug_recurrent_mem_tr__prompt_kernel_s_pmw1_to:
    s_mov_b32 s60, 1
interleave_layers__linear_attn_block__memory_aug_recurrent_mem_tr__prompt_kernel_s_pmw1_out:
    ds_write_b128 v7, v[84:87]
    ds_write_b128 v7, v[88:91] offset:4096
    ds_write_b64 v8, v[92:93]
interleave_layers__linear_attn_block__memory_aug_recurrent_mem_tr__prompt_kernel_s_gow1:
    ds_read_b128 v[68:71], v6 offset:2048
    ds_read_b128 v[72:75], v6 offset:3072
    ds_read_b128 v[76:79], v6 offset:10240
    ds_read_b128 v[80:83], v6 offset:11264
    v_smfmac_f32_16x16x64_bf16 v[24:27], v[84:87], a[8:15], v4
    v_smfmac_f32_16x16x64_bf16 v[28:31], v[84:87], a[88:95], v4
    v_smfmac_f32_16x16x64_bf16 v[32:35], v[84:87], a[168:175], v4
    v_smfmac_f32_16x16x64_bf16 v[40:43], v[84:87], v[104:111], v4
    v_smfmac_f32_16x16x64_bf16 v[44:47], v[84:87], v[184:191], v4
    s_waitcnt lgkmcnt(2)
    v_smfmac_f32_16x16x64_bf16 v[36:39], v[84:87], v[68:75], v4
    ds_read_b128 v[68:71], v6 offset:0
    ds_read_b128 v[72:75], v6 offset:1024
    s_barrier
    ds_read_b128 v[48:51], v5 offset:0
    ds_read_b128 v[52:55], v5 offset:2048
    ds_read_b128 v[56:59], v5 offset:3072
    ds_read_b128 v[60:63], v5 offset:4096
    ds_read_b128 v[64:67], v5 offset:6144
    v_smfmac_f32_16x16x64_bf16 v[24:27], v[88:91], a[40:47], v4
    v_smfmac_f32_16x16x64_bf16 v[28:31], v[88:91], a[120:127], v4
    v_smfmac_f32_16x16x64_bf16 v[32:35], v[88:91], a[200:207], v4
    v_smfmac_f32_16x16x64_bf16 v[40:43], v[88:91], v[136:143], v4
    v_smfmac_f32_16x16x64_bf16 v[44:47], v[88:91], v[216:223], v4
    s_waitcnt lgkmcnt(7)
    v_smfmac_f32_16x16x64_bf16 v[36:39], v[88:91], v[76:83], v4
    ds_read_b128 v[76:79], v6 offset:4096
    ds_read_b128 v[80:83], v6 offset:5120
    s_waitcnt lgkmcnt(6)
    v_smfmac_f32_16x16x64_bf16 v[24:27], v[48:51], a[0:7], v4
    v_smfmac_f32_16x16x64_bf16 v[28:31], v[48:51], a[80:87], v4
    v_smfmac_f32_16x16x64_bf16 v[40:43], v[48:51], v[96:103], v4
    v_smfmac_f32_16x16x64_bf16 v[36:39], v[48:51], v[68:75], v4
    ds_read_b128 v[68:71], v6 offset:6144
    ds_read_b128 v[72:75], v6 offset:7168
    ds_read_b128 v[48:51], v5 offset:7168
    s_waitcnt lgkmcnt(8)
    v_smfmac_f32_16x16x64_bf16 v[24:27], v[52:55], a[16:23], v4
    v_smfmac_f32_16x16x64_bf16 v[28:31], v[52:55], a[96:103], v4
    v_smfmac_f32_16x16x64_bf16 v[40:43], v[52:55], v[112:119], v4
    s_waitcnt lgkmcnt(3)
    v_smfmac_f32_16x16x64_bf16 v[36:39], v[52:55], v[76:83], v4
    ds_read_b128 v[76:79], v6 offset:8192
    ds_read_b128 v[80:83], v6 offset:9216
    ds_read_b128 v[52:55], v5 offset:8192
    v_smfmac_f32_16x16x64_bf16 v[24:27], v[56:59], a[24:31], v4
    v_smfmac_f32_16x16x64_bf16 v[28:31], v[56:59], a[104:111], v4
    v_smfmac_f32_16x16x64_bf16 v[40:43], v[56:59], v[120:127], v4
    s_waitcnt lgkmcnt(4)
    v_smfmac_f32_16x16x64_bf16 v[36:39], v[56:59], v[68:75], v4
    ds_read_b128 v[68:71], v6 offset:12288
    ds_read_b128 v[72:75], v6 offset:13312
    ds_read_b128 v[56:59], v5 offset:9216
    v_smfmac_f32_16x16x64_bf16 v[24:27], v[60:63], a[32:39], v4
    v_smfmac_f32_16x16x64_bf16 v[28:31], v[60:63], a[112:119], v4
    v_smfmac_f32_16x16x64_bf16 v[40:43], v[60:63], v[128:135], v4
    s_waitcnt lgkmcnt(4)
    v_smfmac_f32_16x16x64_bf16 v[36:39], v[60:63], v[76:83], v4
    ds_read_b128 v[76:79], v6 offset:14336
    ds_read_b128 v[80:83], v6 offset:15360
    ds_read_b128 v[60:63], v5 offset:0
    v_smfmac_f32_16x16x64_bf16 v[24:27], v[64:67], a[48:55], v4
    v_smfmac_f32_16x16x64_bf16 v[28:31], v[64:67], a[128:135], v4
    v_smfmac_f32_16x16x64_bf16 v[40:43], v[64:67], v[144:151], v4
    s_waitcnt lgkmcnt(4)
    v_smfmac_f32_16x16x64_bf16 v[36:39], v[64:67], v[68:75], v4
    ds_read_b128 v[68:71], v6 offset:16384
    ds_read_b128 v[72:75], v6 offset:17408
    ds_read_b128 v[64:67], v5 offset:2048
    v_smfmac_f32_16x16x64_bf16 v[24:27], v[48:51], a[56:63], v4
    v_smfmac_f32_16x16x64_bf16 v[28:31], v[48:51], a[136:143], v4
    v_smfmac_f32_16x16x64_bf16 v[40:43], v[48:51], v[152:159], v4
    s_waitcnt lgkmcnt(4)
    v_smfmac_f32_16x16x64_bf16 v[36:39], v[48:51], v[76:83], v4
    ds_read_b128 v[76:79], v6 offset:18432
    ds_read_b128 v[80:83], v6 offset:19456
    ds_read_b128 v[48:51], v5 offset:3072
    v_smfmac_f32_16x16x64_bf16 v[24:27], v[52:55], a[64:71], v4
    v_smfmac_f32_16x16x64_bf16 v[28:31], v[52:55], a[144:151], v4
    v_smfmac_f32_16x16x64_bf16 v[40:43], v[52:55], v[160:167], v4
    s_waitcnt lgkmcnt(4)
    v_smfmac_f32_16x16x64_bf16 v[36:39], v[52:55], v[68:75], v4
    ds_read_b128 v[52:55], v5 offset:4096
    v_smfmac_f32_16x16x64_bf16 v[24:27], v[56:59], a[72:79], v4
    v_smfmac_f32_16x16x64_bf16 v[28:31], v[56:59], a[152:159], v4
    v_smfmac_f32_16x16x64_bf16 v[40:43], v[56:59], v[168:175], v4
    s_waitcnt lgkmcnt(2)
    v_smfmac_f32_16x16x64_bf16 v[36:39], v[56:59], v[76:83], v4
    ds_read_b128 v[56:59], v5 offset:6144
    buffer_load_dwordx4 v[80:83], v19, s[8:11], s45 offen offset:0 sc1
    buffer_load_dwordx4 v[84:87], v19, s[8:11], s45 offen offset:1024 sc1
    buffer_load_dwordx4 v[88:91], v19, s[8:11], s45 offen offset:2048 sc1
    v_smfmac_f32_16x16x64_bf16 v[32:35], v[60:63], a[160:167], v4
    v_smfmac_f32_16x16x64_bf16 v[44:47], v[60:63], v[176:183], v4
    v_permlane32_swap_b32 v28, v40
    v_permlane32_swap_b32 v29, v41
    ds_read_b128 v[60:63], v5 offset:7168
    v_smfmac_f32_16x16x64_bf16 v[32:35], v[64:67], a[176:183], v4
    v_permlane32_swap_b32 v30, v42
    v_permlane32_swap_b32 v31, v43
    v_smfmac_f32_16x16x64_bf16 v[44:47], v[64:67], v[192:199], v4
    v_add_f32 v28, v28, v40
    v_add_f32 v29, v29, v41
    ds_read_b128 v[64:67], v5 offset:8192
    s_waitcnt lgkmcnt(4)
    v_smfmac_f32_16x16x64_bf16 v[32:35], v[48:51], a[184:191], v4
    v_add_f32 v30, v30, v42
    v_add_f32 v31, v31, v43
    v_smfmac_f32_16x16x64_bf16 v[44:47], v[48:51], v[200:207], v4
    v_cvt_pk_bf16_f32 v40, v28, v29
    v_cvt_pk_bf16_f32 v41, v30, v31
    ds_read_b128 v[48:51], v5 offset:9216
    s_waitcnt lgkmcnt(4)
    v_smfmac_f32_16x16x64_bf16 v[32:35], v[52:55], a[192:199], v4
    v_mfma_f32_16x16x16_bf16 v[28:31], v[40:41], v[10:11], 0
    v_permlane32_swap_b32 v24, v36
    v_smfmac_f32_16x16x64_bf16 v[44:47], v[52:55], v[208:215], v4
    v_permlane32_swap_b32 v25, v37
    v_permlane32_swap_b32 v26, v38
    s_waitcnt lgkmcnt(3)
    v_smfmac_f32_16x16x64_bf16 v[32:35], v[56:59], a[208:215], v4
    v_permlane32_swap_b32 v27, v39
    v_add_f32 v24, v24, v36
    v_smfmac_f32_16x16x64_bf16 v[44:47], v[56:59], v[224:231], v4
    v_add_f32 v25, v25, v37
    v_add_f32 v26, v26, v38
    s_waitcnt lgkmcnt(2)
    v_smfmac_f32_16x16x64_bf16 v[32:35], v[60:63], a[216:223], v4
    v_add_f32 v27, v27, v39
    v_cvt_pk_bf16_f32 v36, v24, v25
    v_smfmac_f32_16x16x64_bf16 v[44:47], v[60:63], v[232:239], v4
    v_cvt_pk_bf16_f32 v37, v26, v27
    s_nop 1
    v_mfma_f32_16x16x16_bf16 v[24:27], v[36:37], v[10:11], 0
    s_waitcnt lgkmcnt(1)
    v_smfmac_f32_16x16x64_bf16 v[32:35], v[64:67], a[224:231], v4
    s_nop 5
    v_cvt_pk_bf16_f32 v24, v24, v25
    v_smfmac_f32_16x16x64_bf16 v[44:47], v[64:67], v[240:247], v4
    v_cvt_pk_bf16_f32 v25, v26, v27
    v_cvt_pk_bf16_f32 v26, v28, v29
    s_waitcnt lgkmcnt(0)
    v_smfmac_f32_16x16x64_bf16 v[32:35], v[48:51], a[232:239], v4
    v_cvt_pk_bf16_f32 v27, v30, v31
    s_waitcnt vmcnt(3)
    v_smfmac_f32_16x16x64_bf16 v[44:47], v[48:51], v[248:255], v4
    v_mfma_f32_16x16x32_bf16 v[28:31], a[240:243], v[24:27], 0
    v_mfma_f32_16x16x32_bf16 v[36:39], a[244:247], v[24:27], 0
    v_mfma_f32_16x16x32_bf16 v[40:43], v[24:27], v[24:27], 0
    s_nop 4
    v_permlane32_swap_b32 v32, v44
    v_permlane32_swap_b32 v33, v45
    v_permlane32_swap_b32 v34, v46
    v_permlane32_swap_b32 v35, v47
    v_add_f32 v32, v32, v44
    v_add_f32 v33, v33, v45
    v_add_f32 v34, v34, v46
    v_add_f32 v35, v35, v47
    v_cvt_pk_bf16_f32 v44, v32, v33
    v_cvt_pk_bf16_f32 v45, v34, v35
    s_nop 1
    v_mfma_f32_16x16x16_bf16 v[32:35], v[44:45], v[10:11], 0
    s_nop 7
    v_cvt_pk_bf16_f32 v32, v32, v33
    v_cvt_pk_bf16_f32 v33, v34, v35
    s_nop 1
    v_mfma_f32_16x16x16_bf16 v[28:31], a[248:249], v[32:33], v[28:31]
    v_mfma_f32_16x16x16_bf16 v[36:39], a[250:251], v[32:33], v[36:39]
    v_mfma_f32_16x16x16_bf16 v[40:43], v[32:33], v[32:33], v[40:43]
    s_nop 5
    ds_write_b128 v12, v[28:31]
    ds_write_b128 v12, v[36:39] offset:16
    ds_write_b128 v13, v[40:43]
    s_waitcnt lgkmcnt(0)
    s_barrier
    s_waitcnt vmcnt(0)
    v_mfma_f32_16x16x32_bf16 v[36:39], a[240:243], v[80:83], 0
    v_mfma_f32_16x16x32_bf16 v[44:47], a[244:247], v[80:83], 0
    v_mfma_f32_16x16x32_bf16 v[68:71], v[24:27], v[80:83], 0
    v_mfma_f32_16x16x32_bf16 v[40:43], a[240:243], v[84:87], 0
    v_mfma_f32_16x16x32_bf16 v[64:67], a[244:247], v[84:87], 0
    v_mfma_f32_16x16x32_bf16 v[72:75], v[24:27], v[84:87], 0
    s_nop 0
    v_mfma_f32_16x16x16_bf16 v[36:39], a[248:249], v[88:89], v[36:39]
    v_mfma_f32_16x16x16_bf16 v[44:47], a[250:251], v[88:89], v[44:47]
    v_mfma_f32_16x16x16_bf16 v[68:71], v[32:33], v[88:89], v[68:71]
    v_mfma_f32_16x16x16_bf16 v[40:43], a[248:249], v[90:91], v[40:43]
    v_mfma_f32_16x16x16_bf16 v[64:67], a[250:251], v[90:91], v[64:67]
    v_mfma_f32_16x16x16_bf16 v[72:75], v[32:33], v[90:91], v[72:75]
    s_nop 2
    ds_write_b128 v16, v[36:39] offset:0
    ds_write_b128 v16, v[44:47] offset:16
    ds_write_b128 v17, v[68:71]
    ds_write_b128 v16, v[40:43] offset:2816
    ds_write_b128 v16, v[64:67] offset:2832
    ds_write_b128 v18, v[72:75]
    s_add_u32 s40, s40, 1
    s_add_u32 s41, s41, 393216
    s_add_u32 s45, s45, 393216
    s_add_u32 s43, s43, 458752
    s_add_u32 s47, s47, 458752
    s_add_u32 s48, s48, 458752
    s_add_u32 s49, s49, 458752
    s_waitcnt lgkmcnt(0)
    s_barrier
    s_cmp_lt_u32 s40, 64
    s_cbranch_scc1 interleave_layers__linear_attn_block__memory_aug_recurrent_mem_tr__prompt_kernel_s_stepw1
    s_branch interleave_layers__linear_attn_block__memory_aug_recurrent_mem_tr__prompt_kernel_s_end
interleave_layers__linear_attn_block__memory_aug_recurrent_mem_tr__prompt_kernel_s_stepw2:
    v_mov_b32 v24, 0
    v_mov_b32 v25, 0
    v_mov_b32 v26, 0
    v_mov_b32 v27, 0
    v_mov_b32 v28, 0
    v_mov_b32 v29, 0
    v_mov_b32 v30, 0
    v_mov_b32 v31, 0
    v_mov_b32 v32, 0
    v_mov_b32 v33, 0
    v_mov_b32 v34, 0
    v_mov_b32 v35, 0
    v_mov_b32 v36, 0
    v_mov_b32 v37, 0
    v_mov_b32 v38, 0
    v_mov_b32 v39, 0
    v_mov_b32 v40, 0
    v_mov_b32 v41, 0
    v_mov_b32 v42, 0
    v_mov_b32 v43, 0
    v_mov_b32 v44, 0
    v_mov_b32 v45, 0
    v_mov_b32 v46, 0
    v_mov_b32 v47, 0
    s_add_u32 s46, s47, 4096
    s_lshl_b32 s95, s92, 6
    s_add_u32 s95, s95, s40
    s_add_u32 s95, s95, 1
    s_cmp_ge_i32 s59, s95
    s_cbranch_scc1 interleave_layers__linear_attn_block__memory_aug_recurrent_mem_tr__prompt_kernel_s_ecw2_ok
    s_and_b32 s24, s2, 7
    s_lshl_b32 s24, s24, 7
    s_add_u32 s24, s24, 23109632
    v_and_b32 v49, 3, v1
    v_lshl_add_u32 v49, v49, 2, s24
    s_mov_b32 s61, 0
interleave_layers__linear_attn_block__memory_aug_recurrent_mem_tr__prompt_kernel_s_ecw2:
    buffer_load_dword v48, v49, s[8:11], 0 offen sc1
    s_waitcnt vmcnt(0)
    v_readlane_b32 s59, v48, 0
    v_readlane_b32 s24, v48, 1
    s_min_i32 s59, s59, s24
    v_readlane_b32 s24, v48, 2
    s_min_i32 s59, s59, s24
    s_cmp_ge_i32 s59, s95
    s_cbranch_scc1 interleave_layers__linear_attn_block__memory_aug_recurrent_mem_tr__prompt_kernel_s_ecw2_ok
    s_add_u32 s61, s61, 1
    s_cmp_ge_u32 s61, s60
    s_cbranch_scc1 interleave_layers__linear_attn_block__memory_aug_recurrent_mem_tr__prompt_kernel_s_ecw2_to
    s_sleep 2
    s_branch interleave_layers__linear_attn_block__memory_aug_recurrent_mem_tr__prompt_kernel_s_ecw2
interleave_layers__linear_attn_block__memory_aug_recurrent_mem_tr__prompt_kernel_s_ecw2_to:
    s_mov_b32 s60, 1
interleave_layers__linear_attn_block__memory_aug_recurrent_mem_tr__prompt_kernel_s_ecw2_ok:
    s_add_u32 s63, s40, 1
    s_cmp_ge_i32 s62, s63
    s_cbranch_scc1 interleave_layers__linear_attn_block__memory_aug_recurrent_mem_tr__prompt_kernel_s_enw2_ok
    s_mov_b32 s61, 0
interleave_layers__linear_attn_block__memory_aug_recurrent_mem_tr__prompt_kernel_s_enw2:
    buffer_load_dword v48, v9, s[8:11], 0 offen sc1
    s_waitcnt vmcnt(0)
    v_readlane_b32 s62, v48, 0
    v_readlane_b32 s24, v48, 1
    s_min_i32 s62, s62, s24
    s_cmp_ge_i32 s62, s63
    s_cbranch_scc1 interleave_layers__linear_attn_block__memory_aug_recurrent_mem_tr__prompt_kernel_s_enw2_ok
    s_add_u32 s61, s61, 1
    s_cmp_ge_u32 s61, s60
    s_cbranch_scc1 interleave_layers__linear_attn_block__memory_aug_recurrent_mem_tr__prompt_kernel_s_enw2_to
    s_sleep 2
    s_branch interleave_layers__linear_attn_block__memory_aug_recurrent_mem_tr__prompt_kernel_s_enw2
interleave_layers__linear_attn_block__memory_aug_recurrent_mem_tr__prompt_kernel_s_enw2_to:
    s_mov_b32 s60, 1
interleave_layers__linear_attn_block__memory_aug_recurrent_mem_tr__prompt_kernel_s_enw2_ok:
    buffer_load_dwordx4 a[240:243], v19, s[8:11], s41 offen offset:0 sc1
    buffer_load_dwordx4 a[244:247], v19, s[8:11], s41 offen offset:1024 sc1
    buffer_load_dwordx4 a[248:251], v19, s[8:11], s41 offen offset:2048 sc1
    s_sleep 5
    s_mov_b64 exec, 1
    s_mov_b32 s61, 0
    v_mov_b32 v83, 0
    buffer_atomic_add v83, v23, s[8:11], s48 offen sc0
    s_sleep 3
    v_mov_b32 v94, 0
    buffer_atomic_add v94, v23, s[8:11], s48 offen sc0
    s_sleep 3
    v_mov_b32 v95, 0
    buffer_atomic_add v95, v23, s[8:11], s48 offen sc0
    s_sleep 3
interleave_layers__linear_attn_block__memory_aug_recurrent_mem_tr__prompt_kernel_s_prw2:
    v_mov_b32 v82, 0
    buffer_atomic_add v82, v23, s[8:11], s48 offen sc0
    s_waitcnt vmcnt(3)
    v_cmp_le_i32 vcc, 8, v83
    s_add_u32 s61, s61, 1
    s_cbranch_vccnz interleave_layers__linear_attn_block__memory_aug_recurrent_mem_tr__prompt_kernel_s_prw2_out
    s_sleep 3
    v_mov_b32 v83, 0
    buffer_atomic_add v83, v23, s[8:11], s48 offen sc0
    s_waitcnt vmcnt(3)
    v_cmp_le_i32 vcc, 8, v94
    s_add_u32 s61, s61, 1
    s_cbranch_vccnz interleave_layers__linear_attn_block__memory_aug_recurrent_mem_tr__prompt_kernel_s_prw2_out
    s_sleep 3
    v_mov_b32 v94, 0
    buffer_atomic_add v94, v23, s[8:11], s48 offen sc0
    s_waitcnt vmcnt(3)
    v_cmp_le_i32 vcc, 8, v95
    s_add_u32 s61, s61, 1
    s_cbranch_vccnz interleave_layers__linear_attn_block__memory_aug_recurrent_mem_tr__prompt_kernel_s_prw2_out
    s_sleep 3
    v_mov_b32 v95, 0
    buffer_atomic_add v95, v23, s[8:11], s48 offen sc0
    s_waitcnt vmcnt(3)
    v_cmp_le_i32 vcc, 8, v82
    s_add_u32 s61, s61, 1
    s_cbranch_vccnz interleave_layers__linear_attn_block__memory_aug_recurrent_mem_tr__prompt_kernel_s_prw2_out
    s_sleep 3
    s_cmp_ge_u32 s61, s60
    s_cbranch_scc0 interleave_layers__linear_attn_block__memory_aug_recurrent_mem_tr__prompt_kernel_s_prw2
    s_mov_b32 s60, 1
interleave_layers__linear_attn_block__memory_aug_recurrent_mem_tr__prompt_kernel_s_prw2_out:
    s_mov_b64 exec, -1
    buffer_load_dwordx4 v[84:87], v7, s[8:11], s47 offen sc1
    buffer_load_dwordx4 v[88:91], v7, s[8:11], s46 offen sc1
    buffer_load_dwordx2 v[92:93], v8, s[8:11], s47 offen sc1
    ds_read_b128 v[48:51], v21 offset:0
    ds_read_b128 v[52:55], v21 offset:16
    ds_read_b128 v[56:59], v21 offset:5632
    ds_read_b128 v[60:63], v21 offset:5648
    ds_read_b128 v[64:67], v21 offset:11264
    ds_read_b128 v[68:71], v21 offset:11280
    ds_read_b128 v[72:75], v21 offset:16896
    ds_read_b128 v[76:79], v21 offset:16912
    s_waitcnt lgkmcnt(4)
    v_pk_add_f32 v[48:49], v[48:49], v[56:57]
    v_pk_add_f32 v[50:51], v[50:51], v[58:59]
    v_pk_add_f32 v[52:53], v[52:53], v[60:61]
    v_pk_add_f32 v[54:55], v[54:55], v[62:63]
    s_waitcnt lgkmcnt(0)
    v_pk_add_f32 v[64:65], v[64:65], v[72:73]
    v_pk_add_f32 v[66:67], v[66:67], v[74:75]
    v_pk_add_f32 v[68:69], v[68:69], v[76:77]
    v_pk_add_f32 v[70:71], v[70:71], v[78:79]
    v_pk_add_f32 v[48:49], v[48:49], v[64:65]
    v_pk_add_f32 v[50:51], v[50:51], v[66:67]
    v_pk_add_f32 v[52:53], v[52:53], v[68:69]
    v_pk_add_f32 v[54:55], v[54:55], v[70:71]
    v_mov_b32 v81, 0xff800000
    v_cndmask_b32 v48, v81, v48, s[64:65]
    v_cndmask_b32 v49, v81, v49, s[66:67]
    v_cndmask_b32 v50, v81, v50, s[68:69]
    v_cndmask_b32 v51, v81, v51, s[70:71]
    v_cndmask_b32 v52, v81, v52, s[72:73]
    v_cndmask_b32 v53, v81, v53, s[74:75]
    v_cndmask_b32 v54, v81, v54, s[76:77]
    v_cndmask_b32 v55, v81, v55, s[78:79]
    v_max3_f32 v80, v48, v49, v50
    v_max3_f32 v80, v80, v51, v52
    v_max3_f32 v80, v80, v53, v54
    v_max_f32 v80, v80, v55
    v_mov_b32 v81, 0xff800000
    v_cndmask_b32 v80, v81, v80, s[50:51]
    s_nop 1
    v_max_f32 v80, v80, v80 quad_perm:[1,0,3,2] row_mask:0xf bank_mask:0xf
    s_nop 1
    v_max_f32 v80, v80, v80 quad_perm:[2,3,0,1] row_mask:0xf bank_mask:0xf
    s_nop 1
    v_max_f32 v80, v80, v80 row_half_mirror row_mask:0xf bank_mask:0xf
    s_mov_b32 s24, 0x3dd53b95
    v_mul_f32 v80, s24, v80
    v_fma_f32 v48, v48, s24, -v80
    v_fma_f32 v49, v49, s24, -v80
    v_fma_f32 v50, v50, s24, -v80
    v_fma_f32 v51, v51, s24, -v80
    v_fma_f32 v52, v52, s24, -v80
    v_fma_f32 v53, v53, s24, -v80
    v_fma_f32 v54, v54, s24, -v80
    v_fma_f32 v55, v55, s24, -v80
    v_exp_f32 v48, v48
    v_exp_f32 v49, v49
    v_exp_f32 v50, v50
    v_exp_f32 v51, v51
    v_exp_f32 v52, v52
    v_exp_f32 v53, v53
    v_exp_f32 v54, v54
    v_exp_f32 v55, v55
    v_add_f32 v80, v48, v49
    v_add_f32 v81, v50, v51
    v_add_f32 v80, v80, v52
    v_add_f32 v81, v81, v53
    v_add_f32 v80, v80, v54
    v_add_f32 v81, v81, v55
    v_add_f32 v80, v80, v81
    v_cndmask_b32 v80, 0, v80, s[50:51]
    s_nop 1
    v_add_f32 v80, v80, v80 quad_perm:[1,0,3,2] row_mask:0xf bank_mask:0xf
    s_nop 1
    v_add_f32 v80, v80, v80 quad_perm:[2,3,0,1] row_mask:0xf bank_mask:0xf
    s_nop 1
    v_add_f32 v80, v80, v80 row_half_mirror row_mask:0xf bank_mask:0xf
    v_rcp_f32 v80, v80
    s_nop 0
    v_mul_f32 v48, v48, v80
    v_mul_f32 v49, v49, v80
    v_mul_f32 v50, v50, v80
    v_mul_f32 v51, v51, v80
    v_mul_f32 v52, v52, v80
    v_mul_f32 v53, v53, v80
    v_mul_f32 v54, v54, v80
    v_mul_f32 v55, v55, v80
    v_cvt_pk_bf16_f32 v56, v48, v49
    v_cvt_pk_bf16_f32 v57, v50, v51
    v_cvt_pk_bf16_f32 v58, v52, v53
    v_cvt_pk_bf16_f32 v59, v54, v55
    v_min_u32 v56, -2, v56
    v_min_u32 v57, -2, v57
    v_min_u32 v58, -2, v58
    v_min_u32 v59, -2, v59
    buffer_store_dwordx4 v[56:59], v22, s[8:11], s42 offen sc1
    s_add_u32 s42, s42, 458752
    s_waitcnt vmcnt(1)
    v_max3_u32 v58, v84, v85, v86
    v_max3_u32 v58, v58, v87, v88
    v_max3_u32 v58, v58, v89, v90
    v_max3_u32 v58, v58, v91, v92
    v_max_u32 v58, v58, v93
    v_cmp_eq_u32 vcc, -1, v58
    s_cbranch_vccz interleave_layers__linear_attn_block__memory_aug_recurrent_mem_tr__prompt_kernel_s_pmw2_out
    s_mov_b32 s61, 0
interleave_layers__linear_attn_block__memory_aug_recurrent_mem_tr__prompt_kernel_s_pmw2:
    buffer_load_dwordx4 v[84:87], v7, s[8:11], s47 offen sc1
    buffer_load_dwordx4 v[88:91], v7, s[8:11], s46 offen sc1
    buffer_load_dwordx2 v[92:93], v8, s[8:11], s47 offen sc1
    s_waitcnt vmcnt(0)
    v_max3_u32 v58, v84, v85, v86
    v_max3_u32 v58, v58, v87, v88
    v_max3_u32 v58, v58, v89, v90
    v_max3_u32 v58, v58, v91, v92
    v_max_u32 v58, v58, v93
    v_cmp_eq_u32 vcc, -1, v58
    s_add_u32 s61, s61, 1
    s_cbranch_vccz interleave_layers__linear_attn_block__memory_aug_recurrent_mem_tr__prompt_kernel_s_pmw2_out
    s_cmp_ge_u32 s61, s60
    s_cbranch_scc1 interleave_layers__linear_attn_block__memory_aug_recurrent_mem_tr__prompt_kernel_s_pmw2_to
    s_sleep 1
    s_branch interleave_layers__linear_attn_block__memory_aug_recurrent_mem_tr__prompt_kernel_s_pmw2
interleave_layers__linear_attn_block__memory_aug_recurrent_mem_tr__prompt_kernel_s_pmw2_to:
    s_mov_b32 s60, 1
interleave_layers__linear_attn_block__memory_aug_recurrent_mem_tr__prompt_kernel_s_pmw2_out:
    ds_write_b128 v7, v[84:87]
    ds_write_b128 v7, v[88:91] offset:4096
    ds_write_b64 v8, v[92:93]
interleave_layers__linear_attn_block__memory_aug_recurrent_mem_tr__prompt_kernel_s_gow2:
    ds_read_b128 v[68:71], v6 offset:4096
    ds_read_b128 v[72:75], v6 offset:5120
    ds_read_b128 v[76:79], v6 offset:12288
    ds_read_b128 v[80:83], v6 offset:13312
    v_smfmac_f32_16x16x64_bf16 v[24:27], v[84:87], a[16:23], v4
    v_smfmac_f32_16x16x64_bf16 v[28:31], v[84:87], a[96:103], v4
    v_smfmac_f32_16x16x64_bf16 v[32:35], v[84:87], a[176:183], v4
    v_smfmac_f32_16x16x64_bf16 v[40:43], v[84:87], v[112:119], v4
    v_smfmac_f32_16x16x64_bf16 v[44:47], v[84:87], v[192:199], v4
    s_waitcnt lgkmcnt(2)
    v_smfmac_f32_16x16x64_bf16 v[36:39], v[84:87], v[68:75], v4
    ds_read_b128 v[68:71], v6 offset:0
    ds_read_b128 v[72:75], v6 offset:1024
    s_barrier
    ds_read_b128 v[48:51], v5 offset:0
    ds_read_b128 v[52:55], v5 offset:1024
    ds_read_b128 v[56:59], v5 offset:3072
    ds_read_b128 v[60:63], v5 offset:4096
    ds_read_b128 v[64:67], v5 offset:5120
    v_smfmac_f32_16x16x64_bf16 v[24:27], v[88:91], a[48:55], v4
    v_smfmac_f32_16x16x64_bf16 v[28:31], v[88:91], a[128:135], v4
    v_smfmac_f32_16x16x64_bf16 v[32:35], v[88:91], a[208:215], v4
    v_smfmac_f32_16x16x64_bf16 v[40:43], v[88:91], v[144:151], v4
    v_smfmac_f32_16x16x64_bf16 v[44:47], v[88:91], v[224:231], v4
    s_waitcnt lgkmcnt(7)
    v_smfmac_f32_16x16x64_bf16 v[36:39], v[88:91], v[76:83], v4
    ds_read_b128 v[76:79], v6 offset:2048
    ds_read_b128 v[80:83], v6 offset:3072
    s_waitcnt lgkmcnt(6)
    v_smfmac_f32_16x16x64_bf16 v[24:27], v[48:51], a[0:7], v4
    v_smfmac_f32_16x16x64_bf16 v[28:31], v[48:51], a[80:87], v4
    v_smfmac_f32_16x16x64_bf16 v[40:43], v[48:51], v[96:103], v4
    v_smfmac_f32_16x16x64_bf16 v[36:39], v[48:51], v[68:75], v4
    ds_read_b128 v[68:71], v6 offset:6144
    ds_read_b128 v[72:75], v6 offset:7168
    ds_read_b128 v[48:51], v5 offset:7168
    s_waitcnt lgkmcnt(8)
    v_smfmac_f32_16x16x64_bf16 v[24:27], v[52:55], a[8:15], v4
    v_smfmac_f32_16x16x64_bf16 v[28:31], v[52:55], a[88:95], v4
    v_smfmac_f32_16x16x64_bf16 v[40:43], v[52:55], v[104:111], v4
    s_waitcnt lgkmcnt(3)
    v_smfmac_f32_16x16x64_bf16 v[36:39], v[52:55], v[76:83], v4
    ds_read_b128 v[76:79], v6 offset:8192
    ds_read_b128 v[80:83], v6 offset:9216
    ds_read_b128 v[52:55], v5 offset:8192
    v_smfmac_f32_16x16x64_bf16 v[24:27], v[56:59], a[24:31], v4
    v_smfmac_f32_16x16x64_bf16 v[28:31], v[56:59], a[104:111], v4
    v_smfmac_f32_16x16x64_bf16 v[40:43], v[56:59], v[120:127], v4
    s_waitcnt lgkmcnt(4)
    v_smfmac_f32_16x16x64_bf16 v[36:39], v[56:59], v[68:75], v4
    ds_read_b128 v[68:71], v6 offset:10240
    ds_read_b128 v[72:75], v6 offset:11264
    ds_read_b128 v[56:59], v5 offset:9216
    v_smfmac_f32_16x16x64_bf16 v[24:27], v[60:63], a[32:39], v4
    v_smfmac_f32_16x16x64_bf16 v[28:31], v[60:63], a[112:119], v4
    v_smfmac_f32_16x16x64_bf16 v[40:43], v[60:63], v[128:135], v4
    s_waitcnt lgkmcnt(4)
    v_smfmac_f32_16x16x64_bf16 v[36:39], v[60:63], v[76:83], v4
    ds_read_b128 v[76:79], v6 offset:14336
    ds_read_b128 v[80:83], v6 offset:15360
    ds_read_b128 v[60:63], v5 offset:0
    v_smfmac_f32_16x16x64_bf16 v[24:27], v[64:67], a[40:47], v4
    v_smfmac_f32_16x16x64_bf16 v[28:31], v[64:67], a[120:127], v4
    v_smfmac_f32_16x16x64_bf16 v[40:43], v[64:67], v[136:143], v4
    s_waitcnt lgkmcnt(4)
    v_smfmac_f32_16x16x64_bf16 v[36:39], v[64:67], v[68:75], v4
    ds_read_b128 v[68:71], v6 offset:16384
    ds_read_b128 v[72:75], v6 offset:17408
    ds_read_b128 v[64:67], v5 offset:1024
    v_smfmac_f32_16x16x64_bf16 v[24:27], v[48:51], a[56:63], v4
    v_smfmac_f32_16x16x64_bf16 v[28:31], v[48:51], a[136:143], v4
    v_smfmac_f32_16x16x64_bf16 v[40:43], v[48:51], v[152:159], v4
    s_waitcnt lgkmcnt(4)
    v_smfmac_f32_16x16x64_bf16 v[36:39], v[48:51], v[76:83], v4
    ds_read_b128 v[76:79], v6 offset:18432
    ds_read_b128 v[80:83], v6 offset:19456
    ds_read_b128 v[48:51], v5 offset:3072
    v_smfmac_f32_16x16x64_bf16 v[24:27], v[52:55], a[64:71], v4
    v_smfmac_f32_16x16x64_bf16 v[28:31], v[52:55], a[144:151], v4
    v_smfmac_f32_16x16x64_bf16 v[40:43], v[52:55], v[160:167], v4
    s_waitcnt lgkmcnt(4)
    v_smfmac_f32_16x16x64_bf16 v[36:39], v[52:55], v[68:75], v4
    ds_read_b128 v[52:55], v5 offset:4096
    v_smfmac_f32_16x16x64_bf16 v[24:27], v[56:59], a[72:79], v4
    v_smfmac_f32_16x16x64_bf16 v[28:31], v[56:59], a[152:159], v4
    v_smfmac_f32_16x16x64_bf16 v[40:43], v[56:59], v[168:175], v4
    s_waitcnt lgkmcnt(2)
    v_smfmac_f32_16x16x64_bf16 v[36:39], v[56:59], v[76:83], v4
    ds_read_b128 v[56:59], v5 offset:5120
    buffer_load_dwordx4 v[80:83], v19, s[8:11], s45 offen offset:0 sc1
    buffer_load_dwordx4 v[84:87], v19, s[8:11], s45 offen offset:1024 sc1
    buffer_load_dwordx4 v[88:91], v19, s[8:11], s45 offen offset:2048 sc1
    v_smfmac_f32_16x16x64_bf16 v[32:35], v[60:63], a[160:167], v4
    v_smfmac_f32_16x16x64_bf16 v[44:47], v[60:63], v[176:183], v4
    v_permlane32_swap_b32 v28, v40
    v_permlane32_swap_b32 v29, v41
    ds_read_b128 v[60:63], v5 offset:7168
    v_smfmac_f32_16x16x64_bf16 v[32:35], v[64:67], a[168:175], v4
    v_permlane32_swap_b32 v30, v42
    v_permlane32_swap_b32 v31, v43
    v_smfmac_f32_16x16x64_bf16 v[44:47], v[64:67], v[184:191], v4
    v_add_f32 v28, v28, v40
    v_add_f32 v29, v29, v41
    ds_read_b128 v[64:67], v5 offset:8192
    s_waitcnt lgkmcnt(4)
    v_smfmac_f32_16x16x64_bf16 v[32:35], v[48:51], a[184:191], v4
    v_add_f32 v30, v30, v42
    v_add_f32 v31, v31, v43
    v_smfmac_f32_16x16x64_bf16 v[44:47], v[48:51], v[200:207], v4
    v_cvt_pk_bf16_f32 v40, v28, v29
    v_cvt_pk_bf16_f32 v41, v30, v31
    ds_read_b128 v[48:51], v5 offset:9216
    s_waitcnt lgkmcnt(4)
    v_smfmac_f32_16x16x64_bf16 v[32:35], v[52:55], a[192:199], v4
    v_mfma_f32_16x16x16_bf16 v[28:31], v[40:41], v[10:11], 0
    v_permlane32_swap_b32 v24, v36
    v_smfmac_f32_16x16x64_bf16 v[44:47], v[52:55], v[208:215], v4
    v_permlane32_swap_b32 v25, v37
    v_permlane32_swap_b32 v26, v38
    s_waitcnt lgkmcnt(3)
    v_smfmac_f32_16x16x64_bf16 v[32:35], v[56:59], a[200:207], v4
    v_permlane32_swap_b32 v27, v39
    v_add_f32 v24, v24, v36
    v_smfmac_f32_16x16x64_bf16 v[44:47], v[56:59], v[216:223], v4
    v_add_f32 v25, v25, v37
    v_add_f32 v26, v26, v38
    s_waitcnt lgkmcnt(2)
    v_smfmac_f32_16x16x64_bf16 v[32:35], v[60:63], a[216:223], v4
    v_add_f32 v27, v27, v39
    v_cvt_pk_bf16_f32 v36, v24, v25
    v_smfmac_f32_16x16x64_bf16 v[44:47], v[60:63], v[232:239], v4
    v_cvt_pk_bf16_f32 v37, v26, v27
    s_nop 1
    v_mfma_f32_16x16x16_bf16 v[24:27], v[36:37], v[10:11], 0
    s_waitcnt lgkmcnt(1)
    v_smfmac_f32_16x16x64_bf16 v[32:35], v[64:67], a[224:231], v4
    s_nop 5
    v_cvt_pk_bf16_f32 v24, v24, v25
    v_smfmac_f32_16x16x64_bf16 v[44:47], v[64:67], v[240:247], v4
    v_cvt_pk_bf16_f32 v25, v26, v27
    v_cvt_pk_bf16_f32 v26, v28, v29
    s_waitcnt lgkmcnt(0)
    v_smfmac_f32_16x16x64_bf16 v[32:35], v[48:51], a[232:239], v4
    v_cvt_pk_bf16_f32 v27, v30, v31
    s_waitcnt vmcnt(3)
    v_smfmac_f32_16x16x64_bf16 v[44:47], v[48:51], v[248:255], v4
    v_mfma_f32_16x16x32_bf16 v[28:31], a[240:243], v[24:27], 0
    v_mfma_f32_16x16x32_bf16 v[36:39], a[244:247], v[24:27], 0
    v_mfma_f32_16x16x32_bf16 v[40:43], v[24:27], v[24:27], 0
    s_nop 4
    v_permlane32_swap_b32 v32, v44
    v_permlane32_swap_b32 v33, v45
    v_permlane32_swap_b32 v34, v46
    v_permlane32_swap_b32 v35, v47
    v_add_f32 v32, v32, v44
    v_add_f32 v33, v33, v45
    v_add_f32 v34, v34, v46
    v_add_f32 v35, v35, v47
    v_cvt_pk_bf16_f32 v44, v32, v33
    v_cvt_pk_bf16_f32 v45, v34, v35
    s_nop 1
    v_mfma_f32_16x16x16_bf16 v[32:35], v[44:45], v[10:11], 0
    s_nop 7
    v_cvt_pk_bf16_f32 v32, v32, v33
    v_cvt_pk_bf16_f32 v33, v34, v35
    s_nop 1
    v_mfma_f32_16x16x16_bf16 v[28:31], a[248:249], v[32:33], v[28:31]
    v_mfma_f32_16x16x16_bf16 v[36:39], a[250:251], v[32:33], v[36:39]
    v_mfma_f32_16x16x16_bf16 v[40:43], v[32:33], v[32:33], v[40:43]
    s_nop 5
    ds_write_b128 v12, v[28:31]
    ds_write_b128 v12, v[36:39] offset:16
    ds_write_b128 v13, v[40:43]
    s_waitcnt lgkmcnt(0)
    s_barrier
    s_waitcnt vmcnt(0)
    v_mfma_f32_16x16x32_bf16 v[36:39], a[240:243], v[80:83], 0
    v_mfma_f32_16x16x32_bf16 v[44:47], a[244:247], v[80:83], 0
    v_mfma_f32_16x16x32_bf16 v[68:71], v[24:27], v[80:83], 0
    v_mfma_f32_16x16x32_bf16 v[40:43], a[240:243], v[84:87], 0
    v_mfma_f32_16x16x32_bf16 v[64:67], a[244:247], v[84:87], 0
    v_mfma_f32_16x16x32_bf16 v[72:75], v[24:27], v[84:87], 0
    s_nop 0
    v_mfma_f32_16x16x16_bf16 v[36:39], a[248:249], v[88:89], v[36:39]
    v_mfma_f32_16x16x16_bf16 v[44:47], a[250:251], v[88:89], v[44:47]
    v_mfma_f32_16x16x16_bf16 v[68:71], v[32:33], v[88:89], v[68:71]
    v_mfma_f32_16x16x16_bf16 v[40:43], a[248:249], v[90:91], v[40:43]
    v_mfma_f32_16x16x16_bf16 v[64:67], a[250:251], v[90:91], v[64:67]
    v_mfma_f32_16x16x16_bf16 v[72:75], v[32:33], v[90:91], v[72:75]
    s_nop 2
    ds_write_b128 v16, v[36:39] offset:0
    ds_write_b128 v16, v[44:47] offset:16
    ds_write_b128 v17, v[68:71]
    ds_write_b128 v16, v[40:43] offset:2816
    ds_write_b128 v16, v[64:67] offset:2832
    ds_write_b128 v18, v[72:75]
    s_add_u32 s40, s40, 1
    s_add_u32 s41, s41, 393216
    s_add_u32 s45, s45, 393216
    s_add_u32 s43, s43, 458752
    s_add_u32 s47, s47, 458752
    s_add_u32 s48, s48, 458752
    s_add_u32 s49, s49, 458752
    s_waitcnt lgkmcnt(0)
    s_barrier
    s_cmp_lt_u32 s40, 64
    s_cbranch_scc1 interleave_layers__linear_attn_block__memory_aug_recurrent_mem_tr__prompt_kernel_s_stepw2
    s_branch interleave_layers__linear_attn_block__memory_aug_recurrent_mem_tr__prompt_kernel_s_end
interleave_layers__linear_attn_block__memory_aug_recurrent_mem_tr__prompt_kernel_s_stepw3:
    v_mov_b32 v24, 0
    v_mov_b32 v25, 0
    v_mov_b32 v26, 0
    v_mov_b32 v27, 0
    v_mov_b32 v28, 0
    v_mov_b32 v29, 0
    v_mov_b32 v30, 0
    v_mov_b32 v31, 0
    v_mov_b32 v32, 0
    v_mov_b32 v33, 0
    v_mov_b32 v34, 0
    v_mov_b32 v35, 0
    v_mov_b32 v36, 0
    v_mov_b32 v37, 0
    v_mov_b32 v38, 0
    v_mov_b32 v39, 0
    v_mov_b32 v40, 0
    v_mov_b32 v41, 0
    v_mov_b32 v42, 0
    v_mov_b32 v43, 0
    v_mov_b32 v44, 0
    v_mov_b32 v45, 0
    v_mov_b32 v46, 0
    v_mov_b32 v47, 0
    s_add_u32 s46, s47, 4096
    s_lshl_b32 s95, s92, 6
    s_add_u32 s95, s95, s40
    s_add_u32 s95, s95, 1
    s_cmp_ge_i32 s59, s95
    s_cbranch_scc1 interleave_layers__linear_attn_block__memory_aug_recurrent_mem_tr__prompt_kernel_s_ecw3_ok
    s_and_b32 s24, s2, 7
    s_lshl_b32 s24, s24, 7
    s_add_u32 s24, s24, 23109632
    v_and_b32 v49, 3, v1
    v_lshl_add_u32 v49, v49, 2, s24
    s_mov_b32 s61, 0
interleave_layers__linear_attn_block__memory_aug_recurrent_mem_tr__prompt_kernel_s_ecw3:
    buffer_load_dword v48, v49, s[8:11], 0 offen sc1
    s_waitcnt vmcnt(0)
    v_readlane_b32 s59, v48, 0
    v_readlane_b32 s24, v48, 1
    s_min_i32 s59, s59, s24
    v_readlane_b32 s24, v48, 2
    s_min_i32 s59, s59, s24
    s_cmp_ge_i32 s59, s95
    s_cbranch_scc1 interleave_layers__linear_attn_block__memory_aug_recurrent_mem_tr__prompt_kernel_s_ecw3_ok
    s_add_u32 s61, s61, 1
    s_cmp_ge_u32 s61, s60
    s_cbranch_scc1 interleave_layers__linear_attn_block__memory_aug_recurrent_mem_tr__prompt_kernel_s_ecw3_to
    s_sleep 2
    s_branch interleave_layers__linear_attn_block__memory_aug_recurrent_mem_tr__prompt_kernel_s_ecw3
interleave_layers__linear_attn_block__memory_aug_recurrent_mem_tr__prompt_kernel_s_ecw3_to:
    s_mov_b32 s60, 1
interleave_layers__linear_attn_block__memory_aug_recurrent_mem_tr__prompt_kernel_s_ecw3_ok:
    s_add_u32 s63, s40, 1
    s_cmp_ge_i32 s62, s63
    s_cbranch_scc1 interleave_layers__linear_attn_block__memory_aug_recurrent_mem_tr__prompt_kernel_s_enw3_ok
    s_mov_b32 s61, 0
interleave_layers__linear_attn_block__memory_aug_recurrent_mem_tr__prompt_kernel_s_enw3:
    buffer_load_dword v48, v9, s[8:11], 0 offen sc1
    s_waitcnt vmcnt(0)
    v_readlane_b32 s62, v48, 0
    v_readlane_b32 s24, v48, 1
    s_min_i32 s62, s62, s24
    s_cmp_ge_i32 s62, s63
    s_cbranch_scc1 interleave_layers__linear_attn_block__memory_aug_recurrent_mem_tr__prompt_kernel_s_enw3_ok
    s_add_u32 s61, s61, 1
    s_cmp_ge_u32 s61, s60
    s_cbranch_scc1 interleave_layers__linear_attn_block__memory_aug_recurrent_mem_tr__prompt_kernel_s_enw3_to
    s_sleep 2
    s_branch interleave_layers__linear_attn_block__memory_aug_recurrent_mem_tr__prompt_kernel_s_enw3
interleave_layers__linear_attn_block__memory_aug_recurrent_mem_tr__prompt_kernel_s_enw3_to:
    s_mov_b32 s60, 1
interleave_layers__linear_attn_block__memory_aug_recurrent_mem_tr__prompt_kernel_s_enw3_ok:
    buffer_load_dwordx4 a[240:243], v19, s[8:11], s41 offen offset:0 sc1
    buffer_load_dwordx4 a[244:247], v19, s[8:11], s41 offen offset:1024 sc1
    buffer_load_dwordx4 a[248:251], v19, s[8:11], s41 offen offset:2048 sc1
    s_sleep 5
    s_mov_b64 exec, 1
    s_mov_b32 s61, 0
    v_mov_b32 v83, 0
    buffer_atomic_add v83, v23, s[8:11], s48 offen sc0
    s_sleep 3
    v_mov_b32 v94, 0
    buffer_atomic_add v94, v23, s[8:11], s48 offen sc0
    s_sleep 3
    v_mov_b32 v95, 0
    buffer_atomic_add v95, v23, s[8:11], s48 offen sc0
    s_sleep 3
interleave_layers__linear_attn_block__memory_aug_recurrent_mem_tr__prompt_kernel_s_prw3:
    v_mov_b32 v82, 0
    buffer_atomic_add v82, v23, s[8:11], s48 offen sc0
    s_waitcnt vmcnt(3)
    v_cmp_le_i32 vcc, 8, v83
    s_add_u32 s61, s61, 1
    s_cbranch_vccnz interleave_layers__linear_attn_block__memory_aug_recurrent_mem_tr__prompt_kernel_s_prw3_out
    s_sleep 3
    v_mov_b32 v83, 0
    buffer_atomic_add v83, v23, s[8:11], s48 offen sc0
    s_waitcnt vmcnt(3)
    v_cmp_le_i32 vcc, 8, v94
    s_add_u32 s61, s61, 1
    s_cbranch_vccnz interleave_layers__linear_attn_block__memory_aug_recurrent_mem_tr__prompt_kernel_s_prw3_out
    s_sleep 3
    v_mov_b32 v94, 0
    buffer_atomic_add v94, v23, s[8:11], s48 offen sc0
    s_waitcnt vmcnt(3)
    v_cmp_le_i32 vcc, 8, v95
    s_add_u32 s61, s61, 1
    s_cbranch_vccnz interleave_layers__linear_attn_block__memory_aug_recurrent_mem_tr__prompt_kernel_s_prw3_out
    s_sleep 3
    v_mov_b32 v95, 0
    buffer_atomic_add v95, v23, s[8:11], s48 offen sc0
    s_waitcnt vmcnt(3)
    v_cmp_le_i32 vcc, 8, v82
    s_add_u32 s61, s61, 1
    s_cbranch_vccnz interleave_layers__linear_attn_block__memory_aug_recurrent_mem_tr__prompt_kernel_s_prw3_out
    s_sleep 3
    s_cmp_ge_u32 s61, s60
    s_cbranch_scc0 interleave_layers__linear_attn_block__memory_aug_recurrent_mem_tr__prompt_kernel_s_prw3
    s_mov_b32 s60, 1
interleave_layers__linear_attn_block__memory_aug_recurrent_mem_tr__prompt_kernel_s_prw3_out:
    s_mov_b64 exec, -1
    buffer_load_dwordx4 v[84:87], v7, s[8:11], s47 offen sc1
    buffer_load_dwordx4 v[88:91], v7, s[8:11], s46 offen sc1
    buffer_load_dwordx2 v[92:93], v8, s[8:11], s47 offen sc1
    ds_read_b128 v[48:51], v21 offset:0
    ds_read_b128 v[52:55], v21 offset:16
    ds_read_b128 v[56:59], v21 offset:5632
    ds_read_b128 v[60:63], v21 offset:5648
    ds_read_b128 v[64:67], v21 offset:11264
    ds_read_b128 v[68:71], v21 offset:11280
    ds_read_b128 v[72:75], v21 offset:16896
    ds_read_b128 v[76:79], v21 offset:16912
    s_waitcnt lgkmcnt(4)
    v_pk_add_f32 v[48:49], v[48:49], v[56:57]
    v_pk_add_f32 v[50:51], v[50:51], v[58:59]
    v_pk_add_f32 v[52:53], v[52:53], v[60:61]
    v_pk_add_f32 v[54:55], v[54:55], v[62:63]
    s_waitcnt lgkmcnt(0)
    v_pk_add_f32 v[64:65], v[64:65], v[72:73]
    v_pk_add_f32 v[66:67], v[66:67], v[74:75]
    v_pk_add_f32 v[68:69], v[68:69], v[76:77]
    v_pk_add_f32 v[70:71], v[70:71], v[78:79]
    v_pk_add_f32 v[48:49], v[48:49], v[64:65]
    v_pk_add_f32 v[50:51], v[50:51], v[66:67]
    v_pk_add_f32 v[52:53], v[52:53], v[68:69]
    v_pk_add_f32 v[54:55], v[54:55], v[70:71]
    v_mov_b32 v81, 0xff800000
    v_cndmask_b32 v48, v81, v48, s[64:65]
    v_cndmask_b32 v49, v81, v49, s[66:67]
    v_cndmask_b32 v50, v81, v50, s[68:69]
    v_cndmask_b32 v51, v81, v51, s[70:71]
    v_cndmask_b32 v52, v81, v52, s[72:73]
    v_cndmask_b32 v53, v81, v53, s[74:75]
    v_cndmask_b32 v54, v81, v54, s[76:77]
    v_cndmask_b32 v55, v81, v55, s[78:79]
    v_max3_f32 v80, v48, v49, v50
    v_max3_f32 v80, v80, v51, v52
    v_max3_f32 v80, v80, v53, v54
    v_max_f32 v80, v80, v55
    v_mov_b32 v81, 0xff800000
    v_cndmask_b32 v80, v81, v80, s[50:51]
    s_nop 1
    v_max_f32 v80, v80, v80 quad_perm:[1,0,3,2] row_mask:0xf bank_mask:0xf
    s_nop 1
    v_max_f32 v80, v80, v80 quad_perm:[2,3,0,1] row_mask:0xf bank_mask:0xf
    s_nop 1
    v_max_f32 v80, v80, v80 row_half_mirror row_mask:0xf bank_mask:0xf
    s_mov_b32 s24, 0x3dd53b95
    v_mul_f32 v80, s24, v80
    v_fma_f32 v48, v48, s24, -v80
    v_fma_f32 v49, v49, s24, -v80
    v_fma_f32 v50, v50, s24, -v80
    v_fma_f32 v51, v51, s24, -v80
    v_fma_f32 v52, v52, s24, -v80
    v_fma_f32 v53, v53, s24, -v80
    v_fma_f32 v54, v54, s24, -v80
    v_fma_f32 v55, v55, s24, -v80
    v_exp_f32 v48, v48
    v_exp_f32 v49, v49
    v_exp_f32 v50, v50
    v_exp_f32 v51, v51
    v_exp_f32 v52, v52
    v_exp_f32 v53, v53
    v_exp_f32 v54, v54
    v_exp_f32 v55, v55
    v_add_f32 v80, v48, v49
    v_add_f32 v81, v50, v51
    v_add_f32 v80, v80, v52
    v_add_f32 v81, v81, v53
    v_add_f32 v80, v80, v54
    v_add_f32 v81, v81, v55
    v_add_f32 v80, v80, v81
    v_cndmask_b32 v80, 0, v80, s[50:51]
    s_nop 1
    v_add_f32 v80, v80, v80 quad_perm:[1,0,3,2] row_mask:0xf bank_mask:0xf
    s_nop 1
    v_add_f32 v80, v80, v80 quad_perm:[2,3,0,1] row_mask:0xf bank_mask:0xf
    s_nop 1
    v_add_f32 v80, v80, v80 row_half_mirror row_mask:0xf bank_mask:0xf
    v_rcp_f32 v80, v80
    s_nop 0
    v_mul_f32 v48, v48, v80
    v_mul_f32 v49, v49, v80
    v_mul_f32 v50, v50, v80
    v_mul_f32 v51, v51, v80
    v_mul_f32 v52, v52, v80
    v_mul_f32 v53, v53, v80
    v_mul_f32 v54, v54, v80
    v_mul_f32 v55, v55, v80
    v_cvt_pk_bf16_f32 v56, v48, v49
    v_cvt_pk_bf16_f32 v57, v50, v51
    v_cvt_pk_bf16_f32 v58, v52, v53
    v_cvt_pk_bf16_f32 v59, v54, v55
    v_min_u32 v56, -2, v56
    v_min_u32 v57, -2, v57
    v_min_u32 v58, -2, v58
    v_min_u32 v59, -2, v59
    buffer_store_dwordx4 v[56:59], v22, s[8:11], s42 offen sc1
    s_add_u32 s42, s42, 458752
    s_waitcnt vmcnt(1)
    v_max3_u32 v58, v84, v85, v86
    v_max3_u32 v58, v58, v87, v88
    v_max3_u32 v58, v58, v89, v90
    v_max3_u32 v58, v58, v91, v92
    v_max_u32 v58, v58, v93
    v_cmp_eq_u32 vcc, -1, v58
    s_cbranch_vccz interleave_layers__linear_attn_block__memory_aug_recurrent_mem_tr__prompt_kernel_s_pmw3_out
    s_mov_b32 s61, 0
interleave_layers__linear_attn_block__memory_aug_recurrent_mem_tr__prompt_kernel_s_pmw3:
    buffer_load_dwordx4 v[84:87], v7, s[8:11], s47 offen sc1
    buffer_load_dwordx4 v[88:91], v7, s[8:11], s46 offen sc1
    buffer_load_dwordx2 v[92:93], v8, s[8:11], s47 offen sc1
    s_waitcnt vmcnt(0)
    v_max3_u32 v58, v84, v85, v86
    v_max3_u32 v58, v58, v87, v88
    v_max3_u32 v58, v58, v89, v90
    v_max3_u32 v58, v58, v91, v92
    v_max_u32 v58, v58, v93
    v_cmp_eq_u32 vcc, -1, v58
    s_add_u32 s61, s61, 1
    s_cbranch_vccz interleave_layers__linear_attn_block__memory_aug_recurrent_mem_tr__prompt_kernel_s_pmw3_out
    s_cmp_ge_u32 s61, s60
    s_cbranch_scc1 interleave_layers__linear_attn_block__memory_aug_recurrent_mem_tr__prompt_kernel_s_pmw3_to
    s_sleep 1
    s_branch interleave_layers__linear_attn_block__memory_aug_recurrent_mem_tr__prompt_kernel_s_pmw3
interleave_layers__linear_attn_block__memory_aug_recurrent_mem_tr__prompt_kernel_s_pmw3_to:
    s_mov_b32 s60, 1
interleave_layers__linear_attn_block__memory_aug_recurrent_mem_tr__prompt_kernel_s_pmw3_out:
    ds_write_b128 v7, v[84:87]
    ds_write_b128 v7, v[88:91] offset:4096
    ds_write_b64 v8, v[92:93]
interleave_layers__linear_attn_block__memory_aug_recurrent_mem_tr__prompt_kernel_s_gow3:
    ds_read_b128 v[68:71], v6 offset:6144
    ds_read_b128 v[72:75], v6 offset:7168
    ds_read_b128 v[76:79], v6 offset:14336
    ds_read_b128 v[80:83], v6 offset:15360
    v_smfmac_f32_16x16x64_bf16 v[24:27], v[84:87], a[24:31], v4
    v_smfmac_f32_16x16x64_bf16 v[28:31], v[84:87], a[104:111], v4
    v_smfmac_f32_16x16x64_bf16 v[32:35], v[84:87], a[184:191], v4
    v_smfmac_f32_16x16x64_bf16 v[40:43], v[84:87], v[120:127], v4
    v_smfmac_f32_16x16x64_bf16 v[44:47], v[84:87], v[200:207], v4
    s_waitcnt lgkmcnt(2)
    v_smfmac_f32_16x16x64_bf16 v[36:39], v[84:87], v[68:75], v4
    ds_read_b128 v[68:71], v6 offset:0
    ds_read_b128 v[72:75], v6 offset:1024
    s_barrier
    ds_read_b128 v[48:51], v5 offset:0
    ds_read_b128 v[52:55], v5 offset:1024
    ds_read_b128 v[56:59], v5 offset:2048
    ds_read_b128 v[60:63], v5 offset:4096
    ds_read_b128 v[64:67], v5 offset:5120
    v_smfmac_f32_16x16x64_bf16 v[24:27], v[88:91], a[56:63], v4
    v_smfmac_f32_16x16x64_bf16 v[28:31], v[88:91], a[136:143], v4
    v_smfmac_f32_16x16x64_bf16 v[32:35], v[88:91], a[216:223], v4
    v_smfmac_f32_16x16x64_bf16 v[40:43], v[88:91], v[152:159], v4
    v_smfmac_f32_16x16x64_bf16 v[44:47], v[88:91], v[232:239], v4
    s_waitcnt lgkmcnt(7)
    v_smfmac_f32_16x16x64_bf16 v[36:39], v[88:91], v[76:83], v4
    ds_read_b128 v[76:79], v6 offset:2048
    ds_read_b128 v[80:83], v6 offset:3072
    s_waitcnt lgkmcnt(6)
    v_smfmac_f32_16x16x64_bf16 v[24:27], v[48:51], a[0:7], v4
    v_smfmac_f32_16x16x64_bf16 v[28:31], v[48:51], a[80:87], v4
    v_smfmac_f32_16x16x64_bf16 v[40:43], v[48:51], v[96:103], v4
    v_smfmac_f32_16x16x64_bf16 v[36:39], v[48:51], v[68:75], v4
    ds_read_b128 v[68:71], v6 offset:4096
    ds_read_b128 v[72:75], v6 offset:5120
    ds_read_b128 v[48:51], v5 offset:6144
    s_waitcnt lgkmcnt(8)
    v_smfmac_f32_16x16x64_bf16 v[24:27], v[52:55], a[8:15], v4
    v_smfmac_f32_16x16x64_bf16 v[28:31], v[52:55], a[88:95], v4
    v_smfmac_f32_16x16x64_bf16 v[40:43], v[52:55], v[104:111], v4
    s_waitcnt lgkmcnt(3)
    v_smfmac_f32_16x16x64_bf16 v[36:39], v[52:55], v[76:83], v4
    ds_read_b128 v[76:79], v6 offset:8192
    ds_read_b128 v[80:83], v6 offset:9216
    ds_read_b128 v[52:55], v5 offset:8192
    v_smfmac_f32_16x16x64_bf16 v[24:27], v[56:59], a[16:23], v4
    v_smfmac_f32_16x16x64_bf16 v[28:31], v[56:59], a[96:103], v4
    v_smfmac_f32_16x16x64_bf16 v[40:43], v[56:59], v[112:119], v4
    s_waitcnt lgkmcnt(4)
    v_smfmac_f32_16x16x64_bf16 v[36:39], v[56:59], v[68:75], v4
    ds_read_b128 v[68:71], v6 offset:10240
    ds_read_b128 v[72:75], v6 offset:11264
    ds_read_b128 v[56:59], v5 offset:9216
    v_smfmac_f32_16x16x64_bf16 v[24:27], v[60:63], a[32:39], v4
    v_smfmac_f32_16x16x64_bf16 v[28:31], v[60:63], a[112:119], v4
    v_smfmac_f32_16x16x64_bf16 v[40:43], v[60:63], v[128:135], v4
    s_waitcnt lgkmcnt(4)
    v_smfmac_f32_16x16x64_bf16 v[36:39], v[60:63], v[76:83], v4
    ds_read_b128 v[76:79], v6 offset:12288
    ds_read_b128 v[80:83], v6 offset:13312
    ds_read_b128 v[60:63], v5 offset:0
    v_smfmac_f32_16x16x64_bf16 v[24:27], v[64:67], a[40:47], v4
    v_smfmac_f32_16x16x64_bf16 v[28:31], v[64:67], a[120:127], v4
    v_smfmac_f32_16x16x64_bf16 v[40:43], v[64:67], v[136:143], v4
    s_waitcnt lgkmcnt(4)
    v_smfmac_f32_16x16x64_bf16 v[36:39], v[64:67], v[68:75], v4
    ds_read_b128 v[68:71], v6 offset:16384
    ds_read_b128 v[72:75], v6 offset:17408
    ds_read_b128 v[64:67], v5 offset:1024
    v_smfmac_f32_16x16x64_bf16 v[24:27], v[48:51], a[48:55], v4
    v_smfmac_f32_16x16x64_bf16 v[28:31], v[48:51], a[128:135], v4
    v_smfmac_f32_16x16x64_bf16 v[40:43], v[48:51], v[144:151], v4
    s_waitcnt lgkmcnt(4)
    v_smfmac_f32_16x16x64_bf16 v[36:39], v[48:51], v[76:83], v4
    ds_read_b128 v[76:79], v6 offset:18432
    ds_read_b128 v[80:83], v6 offset:19456
    ds_read_b128 v[48:51], v5 offset:2048
    v_smfmac_f32_16x16x64_bf16 v[24:27], v[52:55], a[64:71], v4
    v_smfmac_f32_16x16x64_bf16 v[28:31], v[52:55], a[144:151], v4
    v_smfmac_f32_16x16x64_bf16 v[40:43], v[52:55], v[160:167], v4
    s_waitcnt lgkmcnt(4)
    v_smfmac_f32_16x16x64_bf16 v[36:39], v[52:55], v[68:75], v4
    ds_read_b128 v[52:55], v5 offset:4096
    v_smfmac_f32_16x16x64_bf16 v[24:27], v[56:59], a[72:79], v4
    v_smfmac_f32_16x16x64_bf16 v[28:31], v[56:59], a[152:159], v4
    v_smfmac_f32_16x16x64_bf16 v[40:43], v[56:59], v[168:175], v4
    s_waitcnt lgkmcnt(2)
    v_smfmac_f32_16x16x64_bf16 v[36:39], v[56:59], v[76:83], v4
    ds_read_b128 v[56:59], v5 offset:5120
    buffer_load_dwordx4 v[80:83], v19, s[8:11], s45 offen offset:0 sc1
    buffer_load_dwordx4 v[84:87], v19, s[8:11], s45 offen offset:1024 sc1
    buffer_load_dwordx4 v[88:91], v19, s[8:11], s45 offen offset:2048 sc1
    v_smfmac_f32_16x16x64_bf16 v[32:35], v[60:63], a[160:167], v4
    v_smfmac_f32_16x16x64_bf16 v[44:47], v[60:63], v[176:183], v4
    v_permlane32_swap_b32 v28, v40
    v_permlane32_swap_b32 v29, v41
    ds_read_b128 v[60:63], v5 offset:6144
    v_smfmac_f32_16x16x64_bf16 v[32:35], v[64:67], a[168:175], v4
    v_permlane32_swap_b32 v30, v42
    v_permlane32_swap_b32 v31, v43
    v_smfmac_f32_16x16x64_bf16 v[44:47], v[64:67], v[184:191], v4
    v_add_f32 v28, v28, v40
    v_add_f32 v29, v29, v41
    ds_read_b128 v[64:67], v5 offset:8192
    s_waitcnt lgkmcnt(4)
    v_smfmac_f32_16x16x64_bf16 v[32:35], v[48:51], a[176:183], v4
    v_add_f32 v30, v30, v42
    v_add_f32 v31, v31, v43
    v_smfmac_f32_16x16x64_bf16 v[44:47], v[48:51], v[192:199], v4
    v_cvt_pk_bf16_f32 v40, v28, v29
    v_cvt_pk_bf16_f32 v41, v30, v31
    ds_read_b128 v[48:51], v5 offset:9216
    s_waitcnt lgkmcnt(4)
    v_smfmac_f32_16x16x64_bf16 v[32:35], v[52:55], a[192:199], v4
    v_mfma_f32_16x16x16_bf16 v[28:31], v[40:41], v[10:11], 0
    v_permlane32_swap_b32 v24, v36
    v_smfmac_f32_16x16x64_bf16 v[44:47], v[52:55], v[208:215], v4
    v_permlane32_swap_b32 v25, v37
    v_permlane32_swap_b32 v26, v38
    s_waitcnt lgkmcnt(3)
    v_smfmac_f32_16x16x64_bf16 v[32:35], v[56:59], a[200:207], v4
    v_permlane32_swap_b32 v27, v39
    v_add_f32 v24, v24, v36
    v_smfmac_f32_16x16x64_bf16 v[44:47], v[56:59], v[216:223], v4
    v_add_f32 v25, v25, v37
    v_add_f32 v26, v26, v38
    s_waitcnt lgkmcnt(2)
    v_smfmac_f32_16x16x64_bf16 v[32:35], v[60:63], a[208:215], v4
    v_add_f32 v27, v27, v39
    v_cvt_pk_bf16_f32 v36, v24, v25
    v_smfmac_f32_16x16x64_bf16 v[44:47], v[60:63], v[224:231], v4
    v_cvt_pk_bf16_f32 v37, v26, v27
    s_nop 1
    v_mfma_f32_16x16x16_bf16 v[24:27], v[36:37], v[10:11], 0
    s_waitcnt lgkmcnt(1)
    v_smfmac_f32_16x16x64_bf16 v[32:35], v[64:67], a[224:231], v4
    s_nop 5
    v_cvt_pk_bf16_f32 v24, v24, v25
    v_smfmac_f32_16x16x64_bf16 v[44:47], v[64:67], v[240:247], v4
    v_cvt_pk_bf16_f32 v25, v26, v27
    v_cvt_pk_bf16_f32 v26, v28, v29
    s_waitcnt lgkmcnt(0)
    v_smfmac_f32_16x16x64_bf16 v[32:35], v[48:51], a[232:239], v4
    v_cvt_pk_bf16_f32 v27, v30, v31
    s_waitcnt vmcnt(3)
    v_smfmac_f32_16x16x64_bf16 v[44:47], v[48:51], v[248:255], v4
    v_mfma_f32_16x16x32_bf16 v[28:31], a[240:243], v[24:27], 0
    v_mfma_f32_16x16x32_bf16 v[36:39], a[244:247], v[24:27], 0
    v_mfma_f32_16x16x32_bf16 v[40:43], v[24:27], v[24:27], 0
    s_nop 4
    v_permlane32_swap_b32 v32, v44
    v_permlane32_swap_b32 v33, v45
    v_permlane32_swap_b32 v34, v46
    v_permlane32_swap_b32 v35, v47
    v_add_f32 v32, v32, v44
    v_add_f32 v33, v33, v45
    v_add_f32 v34, v34, v46
    v_add_f32 v35, v35, v47
    v_cvt_pk_bf16_f32 v44, v32, v33
    v_cvt_pk_bf16_f32 v45, v34, v35
    s_nop 1
    v_mfma_f32_16x16x16_bf16 v[32:35], v[44:45], v[10:11], 0
    s_nop 7
    v_cvt_pk_bf16_f32 v32, v32, v33
    v_cvt_pk_bf16_f32 v33, v34, v35
    s_nop 1
    v_mfma_f32_16x16x16_bf16 v[28:31], a[248:249], v[32:33], v[28:31]
    v_mfma_f32_16x16x16_bf16 v[36:39], a[250:251], v[32:33], v[36:39]
    v_mfma_f32_16x16x16_bf16 v[40:43], v[32:33], v[32:33], v[40:43]
    s_nop 5
    ds_write_b128 v12, v[28:31]
    ds_write_b128 v12, v[36:39] offset:16
    ds_write_b128 v13, v[40:43]
    s_waitcnt lgkmcnt(0)
    s_barrier
    s_waitcnt vmcnt(0)
    v_mfma_f32_16x16x32_bf16 v[36:39], a[240:243], v[80:83], 0
    v_mfma_f32_16x16x32_bf16 v[44:47], a[244:247], v[80:83], 0
    v_mfma_f32_16x16x32_bf16 v[68:71], v[24:27], v[80:83], 0
    v_mfma_f32_16x16x32_bf16 v[40:43], a[240:243], v[84:87], 0
    v_mfma_f32_16x16x32_bf16 v[64:67], a[244:247], v[84:87], 0
    v_mfma_f32_16x16x32_bf16 v[72:75], v[24:27], v[84:87], 0
    s_nop 0
    v_mfma_f32_16x16x16_bf16 v[36:39], a[248:249], v[88:89], v[36:39]
    v_mfma_f32_16x16x16_bf16 v[44:47], a[250:251], v[88:89], v[44:47]
    v_mfma_f32_16x16x16_bf16 v[68:71], v[32:33], v[88:89], v[68:71]
    v_mfma_f32_16x16x16_bf16 v[40:43], a[248:249], v[90:91], v[40:43]
    v_mfma_f32_16x16x16_bf16 v[64:67], a[250:251], v[90:91], v[64:67]
    v_mfma_f32_16x16x16_bf16 v[72:75], v[32:33], v[90:91], v[72:75]
    s_nop 2
    ds_write_b128 v16, v[36:39] offset:0
    ds_write_b128 v16, v[44:47] offset:16
    ds_write_b128 v17, v[68:71]
    ds_write_b128 v16, v[40:43] offset:2816
    ds_write_b128 v16, v[64:67] offset:2832
    ds_write_b128 v18, v[72:75]
    s_add_u32 s40, s40, 1
    s_add_u32 s41, s41, 393216
    s_add_u32 s45, s45, 393216
    s_add_u32 s43, s43, 458752
    s_add_u32 s47, s47, 458752
    s_add_u32 s48, s48, 458752
    s_add_u32 s49, s49, 458752
    s_waitcnt lgkmcnt(0)
    s_barrier
    s_cmp_lt_u32 s40, 64
    s_cbranch_scc1 interleave_layers__linear_attn_block__memory_aug_recurrent_mem_tr__prompt_kernel_s_stepw3
interleave_layers__linear_attn_block__memory_aug_recurrent_mem_tr__prompt_kernel_s_end:
    ds_read_b128 v[48:51], v21 offset:0
    ds_read_b128 v[52:55], v21 offset:16
    ds_read_b128 v[56:59], v21 offset:5632
    ds_read_b128 v[60:63], v21 offset:5648
    ds_read_b128 v[64:67], v21 offset:11264
    ds_read_b128 v[68:71], v21 offset:11280
    ds_read_b128 v[72:75], v21 offset:16896
    ds_read_b128 v[76:79], v21 offset:16912
    s_waitcnt lgkmcnt(4)
    v_pk_add_f32 v[48:49], v[48:49], v[56:57]
    v_pk_add_f32 v[50:51], v[50:51], v[58:59]
    v_pk_add_f32 v[52:53], v[52:53], v[60:61]
    v_pk_add_f32 v[54:55], v[54:55], v[62:63]
    s_waitcnt lgkmcnt(0)
    v_pk_add_f32 v[64:65], v[64:65], v[72:73]
    v_pk_add_f32 v[66:67], v[66:67], v[74:75]
    v_pk_add_f32 v[68:69], v[68:69], v[76:77]
    v_pk_add_f32 v[70:71], v[70:71], v[78:79]
    v_pk_add_f32 v[48:49], v[48:49], v[64:65]
    v_pk_add_f32 v[50:51], v[50:51], v[66:67]
    v_pk_add_f32 v[52:53], v[52:53], v[68:69]
    v_pk_add_f32 v[54:55], v[54:55], v[70:71]
    v_mov_b32 v81, 0xff800000
    v_cndmask_b32 v48, v81, v48, s[64:65]
    v_cndmask_b32 v49, v81, v49, s[66:67]
    v_cndmask_b32 v50, v81, v50, s[68:69]
    v_cndmask_b32 v51, v81, v51, s[70:71]
    v_cndmask_b32 v52, v81, v52, s[72:73]
    v_cndmask_b32 v53, v81, v53, s[74:75]
    v_cndmask_b32 v54, v81, v54, s[76:77]
    v_cndmask_b32 v55, v81, v55, s[78:79]
    v_max3_f32 v80, v48, v49, v50
    v_max3_f32 v80, v80, v51, v52
    v_max3_f32 v80, v80, v53, v54
    v_max_f32 v80, v80, v55
    v_mov_b32 v81, 0xff800000
    v_cndmask_b32 v80, v81, v80, s[50:51]
    s_nop 1
    v_max_f32 v80, v80, v80 quad_perm:[1,0,3,2] row_mask:0xf bank_mask:0xf
    s_nop 1
    v_max_f32 v80, v80, v80 quad_perm:[2,3,0,1] row_mask:0xf bank_mask:0xf
    s_nop 1
    v_max_f32 v80, v80, v80 row_half_mirror row_mask:0xf bank_mask:0xf
    s_mov_b32 s24, 0x3dd53b95
    v_mul_f32 v80, s24, v80
    v_fma_f32 v48, v48, s24, -v80
    v_fma_f32 v49, v49, s24, -v80
    v_fma_f32 v50, v50, s24, -v80
    v_fma_f32 v51, v51, s24, -v80
    v_fma_f32 v52, v52, s24, -v80
    v_fma_f32 v53, v53, s24, -v80
    v_fma_f32 v54, v54, s24, -v80
    v_fma_f32 v55, v55, s24, -v80
    v_exp_f32 v48, v48
    v_exp_f32 v49, v49
    v_exp_f32 v50, v50
    v_exp_f32 v51, v51
    v_exp_f32 v52, v52
    v_exp_f32 v53, v53
    v_exp_f32 v54, v54
    v_exp_f32 v55, v55
    v_add_f32 v80, v48, v49
    v_add_f32 v81, v50, v51
    v_add_f32 v80, v80, v52
    v_add_f32 v81, v81, v53
    v_add_f32 v80, v80, v54
    v_add_f32 v81, v81, v55
    v_add_f32 v80, v80, v81
    v_cndmask_b32 v80, 0, v80, s[50:51]
    s_nop 1
    v_add_f32 v80, v80, v80 quad_perm:[1,0,3,2] row_mask:0xf bank_mask:0xf
    s_nop 1
    v_add_f32 v80, v80, v80 quad_perm:[2,3,0,1] row_mask:0xf bank_mask:0xf
    s_nop 1
    v_add_f32 v80, v80, v80 row_half_mirror row_mask:0xf bank_mask:0xf
    v_rcp_f32 v80, v80
    s_nop 0
    v_mul_f32 v48, v48, v80
    v_mul_f32 v49, v49, v80
    v_mul_f32 v50, v50, v80
    v_mul_f32 v51, v51, v80
    v_mul_f32 v52, v52, v80
    v_mul_f32 v53, v53, v80
    v_mul_f32 v54, v54, v80
    v_mul_f32 v55, v55, v80
    v_cvt_pk_bf16_f32 v56, v48, v49
    v_cvt_pk_bf16_f32 v57, v50, v51
    v_cvt_pk_bf16_f32 v58, v52, v53
    v_cvt_pk_bf16_f32 v59, v54, v55
    v_min_u32 v56, -2, v56
    v_min_u32 v57, -2, v57
    v_min_u32 v58, -2, v58
    v_min_u32 v59, -2, v59
    buffer_store_dwordx4 v[56:59], v22, s[8:11], s42 offen sc1
    s_add_u32 s42, s42, 458752
    s_cmp_eq_u32 s92, 0
    s_cbranch_scc0 interleave_layers__linear_attn_block__memory_aug_recurrent_mem_tr__prompt_kernel_end
    s_mov_b32 s92, 1
    s_branch interleave_layers__linear_attn_block__memory_aug_recurrent_mem_tr__prompt_kernel_s_layer
interleave_layers__linear_attn_block__memory_aug_recurrent_mem_tr__prompt_kernel_roleV:
    s_sub_u32 s44, s2, 32
    s_load_dwordx2 s[6:7], s[0:1], 56
    s_load_dwordx2 s[24:25], s[0:1], 64
    s_load_dwordx2 s[26:27], s[0:1], 32
    s_waitcnt lgkmcnt(0)
    s_mov_b32 s12, s6
    s_mov_b32 s13, s7
    s_mov_b32 s14, 7864320
    s_mov_b32 s15, 0x00020000
    s_mov_b32 s16, s24
    s_mov_b32 s17, s25
    s_mov_b32 s18, 7864320
    s_mov_b32 s19, 0x00020000
    s_mov_b32 s20, s26
    s_mov_b32 s21, s27
    s_mov_b32 s22, 10240
    s_mov_b32 s23, 0x00020000
    v_add_u32 v16, 0, v0
    s_mov_b32 s24, 683
    v_mul_lo_u32 v17, v16, s24
    v_lshrrev_b32 v17, 14, v17
    v_mul_u32_u24 v18, 24, v17
    v_sub_u32 v18, v16, v18
    s_mov_b32 s24, 12288
    v_mul_lo_u32 v4, v17, s24
    v_lshl_add_u32 v4, v18, 4, v4
    v_mul_u32_u24 v10, 400, v17
    v_lshl_add_u32 v10, v18, 4, v10
    v_add_u32 v10, 90112, v10
    v_add_u32 v16, 256, v0
    s_mov_b32 s24, 683
    v_mul_lo_u32 v17, v16, s24
    v_lshrrev_b32 v17, 14, v17
    v_mul_u32_u24 v18, 24, v17
    v_sub_u32 v18, v16, v18
    s_mov_b32 s24, 12288
    v_mul_lo_u32 v5, v17, s24
    v_lshl_add_u32 v5, v18, 4, v5
    v_mul_u32_u24 v11, 400, v17
    v_lshl_add_u32 v11, v18, 4, v11
    v_add_u32 v11, 90112, v11
    v_add_u32 v16, 512, v0
    s_mov_b32 s24, 683
    v_mul_lo_u32 v17, v16, s24
    v_lshrrev_b32 v17, 14, v17
    v_mul_u32_u24 v18, 24, v17
    v_sub_u32 v18, v16, v18
    s_mov_b32 s24, 12288
    v_mul_lo_u32 v6, v17, s24
    v_lshl_add_u32 v6, v18, 4, v6
    v_mul_u32_u24 v12, 400, v17
    v_lshl_add_u32 v12, v18, 4, v12
    v_add_u32 v12, 90112, v12
    v_add_u32 v16, 768, v0
    s_mov_b32 s24, 683
    v_mul_lo_u32 v17, v16, s24
    v_lshrrev_b32 v17, 14, v17
    v_mul_u32_u24 v18, 24, v17
    v_sub_u32 v18, v16, v18
    s_mov_b32 s24, 12288
    v_mul_lo_u32 v7, v17, s24
    v_lshl_add_u32 v7, v18, 4, v7
    v_mul_u32_u24 v13, 400, v17
    v_lshl_add_u32 v13, v18, 4, v13
    v_add_u32 v13, 90112, v13
    v_add_u32 v16, 1024, v0
    s_mov_b32 s24, 683
    v_mul_lo_u32 v17, v16, s24
    v_lshrrev_b32 v17, 14, v17
    v_mul_u32_u24 v18, 24, v17
    v_sub_u32 v18, v16, v18
    s_mov_b32 s24, 12288
    v_mul_lo_u32 v8, v17, s24
    v_lshl_add_u32 v8, v18, 4, v8
    v_mul_u32_u24 v14, 400, v17
    v_lshl_add_u32 v14, v18, 4, v14
    v_add_u32 v14, 90112, v14
    v_add_u32 v16, 1280, v0
    s_mov_b32 s24, 683
    v_mul_lo_u32 v17, v16, s24
    v_lshrrev_b32 v17, 14, v17
    v_mul_u32_u24 v18, 24, v17
    v_sub_u32 v18, v16, v18
    s_mov_b32 s24, 12288
    v_mul_lo_u32 v9, v17, s24
    v_lshl_add_u32 v9, v18, 4, v9
    v_mul_u32_u24 v15, 400, v17
    v_lshl_add_u32 v15, v18, 4, v15
    v_add_u32 v15, 90112, v15
    v_lshrrev_b32 v17, 1, v3
    v_lshlrev_b32 v17, 4, v17
    v_and_b32 v18, 1, v3
    v_lshl_add_u32 v17, v18, 2, v17
    v_lshrrev_b32 v18, 2, v2
    v_and_b32 v19, 1, v18
    v_add_u32 v17, v17, v19
    v_lshrrev_b32 v18, 1, v18
    v_lshl_add_u32 v17, v18, 3, v17
    v_mul_u32_u24 v16, 400, v17
    v_and_b32 v18, 3, v2
    v_lshl_add_u32 v16, v18, 3, v16
    v_add_u32 v16, 90112, v16
    s_mul_i32 s24, s3, 96
    v_add_u32 v16, s24, v16
    s_mul_i32 s45, s44, 384
    s_add_u32 s46, s45, 0
    buffer_load_dwordx4 v[24:27], v4, s[12:15], s46 offen
    buffer_load_dwordx4 v[28:31], v5, s[12:15], s46 offen
    buffer_load_dwordx4 v[32:35], v6, s[12:15], s46 offen
    buffer_load_dwordx4 v[36:39], v7, s[12:15], s46 offen
    buffer_load_dwordx4 v[40:43], v8, s[12:15], s46 offen
    buffer_load_dwordx4 v[44:47], v9, s[12:15], s46 offen
    s_add_u32 s46, s45, 786432
    buffer_load_dwordx4 v[48:51], v4, s[12:15], s46 offen
    buffer_load_dwordx4 v[52:55], v5, s[12:15], s46 offen
    buffer_load_dwordx4 v[56:59], v6, s[12:15], s46 offen
    buffer_load_dwordx4 v[60:63], v7, s[12:15], s46 offen
    buffer_load_dwordx4 v[64:67], v8, s[12:15], s46 offen
    buffer_load_dwordx4 v[68:71], v9, s[12:15], s46 offen
    s_waitcnt vmcnt(6)
    ds_write_b128 v10, v[24:27]
    ds_write_b128 v11, v[28:31]
    ds_write_b128 v12, v[32:35]
    ds_write_b128 v13, v[36:39]
    ds_write_b128 v14, v[40:43]
    ds_write_b128 v15, v[44:47]
    s_add_u32 s46, s45, 1572864
    buffer_load_dwordx4 v[72:75], v4, s[12:15], s46 offen
    buffer_load_dwordx4 v[76:79], v5, s[12:15], s46 offen
    buffer_load_dwordx4 v[80:83], v6, s[12:15], s46 offen
    buffer_load_dwordx4 v[84:87], v7, s[12:15], s46 offen
    buffer_load_dwordx4 v[88:91], v8, s[12:15], s46 offen
    buffer_load_dwordx4 v[92:95], v9, s[12:15], s46 offen
    s_waitcnt lgkmcnt(0)
    s_barrier
    ds_read_b64_tr_b16 a[0:1], v16 offset:0
    ds_read_b64_tr_b16 a[2:3], v16 offset:800
    ds_read_b64_tr_b16 a[4:5], v16 offset:12800
    ds_read_b64_tr_b16 a[6:7], v16 offset:13600
    ds_read_b64_tr_b16 a[80:81], v16 offset:32
    ds_read_b64_tr_b16 a[82:83], v16 offset:832
    ds_read_b64_tr_b16 a[84:85], v16 offset:12832
    ds_read_b64_tr_b16 a[86:87], v16 offset:13632
    ds_read_b64_tr_b16 a[160:161], v16 offset:64
    ds_read_b64_tr_b16 a[162:163], v16 offset:864
    ds_read_b64_tr_b16 a[164:165], v16 offset:12864
    ds_read_b64_tr_b16 a[166:167], v16 offset:13664
    s_waitcnt lgkmcnt(0)
    s_barrier
    s_waitcnt vmcnt(6)
    ds_write_b128 v10, v[48:51]
    ds_write_b128 v11, v[52:55]
    ds_write_b128 v12, v[56:59]
    ds_write_b128 v13, v[60:63]
    ds_write_b128 v14, v[64:67]
    ds_write_b128 v15, v[68:71]
    s_add_u32 s46, s45, 2359296
    buffer_load_dwordx4 v[24:27], v4, s[12:15], s46 offen
    buffer_load_dwordx4 v[28:31], v5, s[12:15], s46 offen
    buffer_load_dwordx4 v[32:35], v6, s[12:15], s46 offen
    buffer_load_dwordx4 v[36:39], v7, s[12:15], s46 offen
    buffer_load_dwordx4 v[40:43], v8, s[12:15], s46 offen
    buffer_load_dwordx4 v[44:47], v9, s[12:15], s46 offen
    s_waitcnt lgkmcnt(0)
    s_barrier
    ds_read_b64_tr_b16 a[8:9], v16 offset:0
    ds_read_b64_tr_b16 a[10:11], v16 offset:800
    ds_read_b64_tr_b16 a[12:13], v16 offset:12800
    ds_read_b64_tr_b16 a[14:15], v16 offset:13600
    ds_read_b64_tr_b16 a[88:89], v16 offset:32
    ds_read_b64_tr_b16 a[90:91], v16 offset:832
    ds_read_b64_tr_b16 a[92:93], v16 offset:12832
    ds_read_b64_tr_b16 a[94:95], v16 offset:13632
    ds_read_b64_tr_b16 a[168:169], v16 offset:64
    ds_read_b64_tr_b16 a[170:171], v16 offset:864
    ds_read_b64_tr_b16 a[172:173], v16 offset:12864
    ds_read_b64_tr_b16 a[174:175], v16 offset:13664
    s_waitcnt lgkmcnt(0)
    s_barrier
    s_waitcnt vmcnt(6)
    ds_write_b128 v10, v[72:75]
    ds_write_b128 v11, v[76:79]
    ds_write_b128 v12, v[80:83]
    ds_write_b128 v13, v[84:87]
    ds_write_b128 v14, v[88:91]
    ds_write_b128 v15, v[92:95]
    s_add_u32 s46, s45, 3145728
    buffer_load_dwordx4 v[48:51], v4, s[12:15], s46 offen
    buffer_load_dwordx4 v[52:55], v5, s[12:15], s46 offen
    buffer_load_dwordx4 v[56:59], v6, s[12:15], s46 offen
    buffer_load_dwordx4 v[60:63], v7, s[12:15], s46 offen
    buffer_load_dwordx4 v[64:67], v8, s[12:15], s46 offen
    buffer_load_dwordx4 v[68:71], v9, s[12:15], s46 offen
    s_waitcnt lgkmcnt(0)
    s_barrier
    ds_read_b64_tr_b16 a[16:17], v16 offset:0
    ds_read_b64_tr_b16 a[18:19], v16 offset:800
    ds_read_b64_tr_b16 a[20:21], v16 offset:12800
    ds_read_b64_tr_b16 a[22:23], v16 offset:13600
    ds_read_b64_tr_b16 a[96:97], v16 offset:32
    ds_read_b64_tr_b16 a[98:99], v16 offset:832
    ds_read_b64_tr_b16 a[100:101], v16 offset:12832
    ds_read_b64_tr_b16 a[102:103], v16 offset:13632
    ds_read_b64_tr_b16 a[176:177], v16 offset:64
    ds_read_b64_tr_b16 a[178:179], v16 offset:864
    ds_read_b64_tr_b16 a[180:181], v16 offset:12864
    ds_read_b64_tr_b16 a[182:183], v16 offset:13664
    s_waitcnt lgkmcnt(0)
    s_barrier
    s_waitcnt vmcnt(6)
    ds_write_b128 v10, v[24:27]
    ds_write_b128 v11, v[28:31]
    ds_write_b128 v12, v[32:35]
    ds_write_b128 v13, v[36:39]
    ds_write_b128 v14, v[40:43]
    ds_write_b128 v15, v[44:47]
    s_add_u32 s46, s45, 3932160
    buffer_load_dwordx4 v[72:75], v4, s[12:15], s46 offen
    buffer_load_dwordx4 v[76:79], v5, s[12:15], s46 offen
    buffer_load_dwordx4 v[80:83], v6, s[12:15], s46 offen
    buffer_load_dwordx4 v[84:87], v7, s[12:15], s46 offen
    buffer_load_dwordx4 v[88:91], v8, s[12:15], s46 offen
    buffer_load_dwordx4 v[92:95], v9, s[12:15], s46 offen
    s_waitcnt lgkmcnt(0)
    s_barrier
    ds_read_b64_tr_b16 a[24:25], v16 offset:0
    ds_read_b64_tr_b16 a[26:27], v16 offset:800
    ds_read_b64_tr_b16 a[28:29], v16 offset:12800
    ds_read_b64_tr_b16 a[30:31], v16 offset:13600
    ds_read_b64_tr_b16 a[104:105], v16 offset:32
    ds_read_b64_tr_b16 a[106:107], v16 offset:832
    ds_read_b64_tr_b16 a[108:109], v16 offset:12832
    ds_read_b64_tr_b16 a[110:111], v16 offset:13632
    ds_read_b64_tr_b16 a[184:185], v16 offset:64
    ds_read_b64_tr_b16 a[186:187], v16 offset:864
    ds_read_b64_tr_b16 a[188:189], v16 offset:12864
    ds_read_b64_tr_b16 a[190:191], v16 offset:13664
    s_waitcnt lgkmcnt(0)
    s_barrier
    s_waitcnt vmcnt(6)
    ds_write_b128 v10, v[48:51]
    ds_write_b128 v11, v[52:55]
    ds_write_b128 v12, v[56:59]
    ds_write_b128 v13, v[60:63]
    ds_write_b128 v14, v[64:67]
    ds_write_b128 v15, v[68:71]
    s_add_u32 s46, s45, 4718592
    buffer_load_dwordx4 v[24:27], v4, s[12:15], s46 offen
    buffer_load_dwordx4 v[28:31], v5, s[12:15], s46 offen
    buffer_load_dwordx4 v[32:35], v6, s[12:15], s46 offen
    buffer_load_dwordx4 v[36:39], v7, s[12:15], s46 offen
    buffer_load_dwordx4 v[40:43], v8, s[12:15], s46 offen
    buffer_load_dwordx4 v[44:47], v9, s[12:15], s46 offen
    s_waitcnt lgkmcnt(0)
    s_barrier
    ds_read_b64_tr_b16 a[32:33], v16 offset:0
    ds_read_b64_tr_b16 a[34:35], v16 offset:800
    ds_read_b64_tr_b16 a[36:37], v16 offset:12800
    ds_read_b64_tr_b16 a[38:39], v16 offset:13600
    ds_read_b64_tr_b16 a[112:113], v16 offset:32
    ds_read_b64_tr_b16 a[114:115], v16 offset:832
    ds_read_b64_tr_b16 a[116:117], v16 offset:12832
    ds_read_b64_tr_b16 a[118:119], v16 offset:13632
    ds_read_b64_tr_b16 a[192:193], v16 offset:64
    ds_read_b64_tr_b16 a[194:195], v16 offset:864
    ds_read_b64_tr_b16 a[196:197], v16 offset:12864
    ds_read_b64_tr_b16 a[198:199], v16 offset:13664
    s_waitcnt lgkmcnt(0)
    s_barrier
    s_waitcnt vmcnt(6)
    ds_write_b128 v10, v[72:75]
    ds_write_b128 v11, v[76:79]
    ds_write_b128 v12, v[80:83]
    ds_write_b128 v13, v[84:87]
    ds_write_b128 v14, v[88:91]
    ds_write_b128 v15, v[92:95]
    s_add_u32 s46, s45, 5505024
    buffer_load_dwordx4 v[48:51], v4, s[12:15], s46 offen
    buffer_load_dwordx4 v[52:55], v5, s[12:15], s46 offen
    buffer_load_dwordx4 v[56:59], v6, s[12:15], s46 offen
    buffer_load_dwordx4 v[60:63], v7, s[12:15], s46 offen
    buffer_load_dwordx4 v[64:67], v8, s[12:15], s46 offen
    buffer_load_dwordx4 v[68:71], v9, s[12:15], s46 offen
    s_waitcnt lgkmcnt(0)
    s_barrier
    ds_read_b64_tr_b16 a[40:41], v16 offset:0
    ds_read_b64_tr_b16 a[42:43], v16 offset:800
    ds_read_b64_tr_b16 a[44:45], v16 offset:12800
    ds_read_b64_tr_b16 a[46:47], v16 offset:13600
    ds_read_b64_tr_b16 a[120:121], v16 offset:32
    ds_read_b64_tr_b16 a[122:123], v16 offset:832
    ds_read_b64_tr_b16 a[124:125], v16 offset:12832
    ds_read_b64_tr_b16 a[126:127], v16 offset:13632
    ds_read_b64_tr_b16 a[200:201], v16 offset:64
    ds_read_b64_tr_b16 a[202:203], v16 offset:864
    ds_read_b64_tr_b16 a[204:205], v16 offset:12864
    ds_read_b64_tr_b16 a[206:207], v16 offset:13664
    s_waitcnt lgkmcnt(0)
    s_barrier
    s_waitcnt vmcnt(6)
    ds_write_b128 v10, v[24:27]
    ds_write_b128 v11, v[28:31]
    ds_write_b128 v12, v[32:35]
    ds_write_b128 v13, v[36:39]
    ds_write_b128 v14, v[40:43]
    ds_write_b128 v15, v[44:47]
    s_add_u32 s46, s45, 6291456
    buffer_load_dwordx4 v[72:75], v4, s[12:15], s46 offen
    buffer_load_dwordx4 v[76:79], v5, s[12:15], s46 offen
    buffer_load_dwordx4 v[80:83], v6, s[12:15], s46 offen
    buffer_load_dwordx4 v[84:87], v7, s[12:15], s46 offen
    buffer_load_dwordx4 v[88:91], v8, s[12:15], s46 offen
    buffer_load_dwordx4 v[92:95], v9, s[12:15], s46 offen
    s_waitcnt lgkmcnt(0)
    s_barrier
    ds_read_b64_tr_b16 a[48:49], v16 offset:0
    ds_read_b64_tr_b16 a[50:51], v16 offset:800
    ds_read_b64_tr_b16 a[52:53], v16 offset:12800
    ds_read_b64_tr_b16 a[54:55], v16 offset:13600
    ds_read_b64_tr_b16 a[128:129], v16 offset:32
    ds_read_b64_tr_b16 a[130:131], v16 offset:832
    ds_read_b64_tr_b16 a[132:133], v16 offset:12832
    ds_read_b64_tr_b16 a[134:135], v16 offset:13632
    ds_read_b64_tr_b16 a[208:209], v16 offset:64
    ds_read_b64_tr_b16 a[210:211], v16 offset:864
    ds_read_b64_tr_b16 a[212:213], v16 offset:12864
    ds_read_b64_tr_b16 a[214:215], v16 offset:13664
    s_waitcnt lgkmcnt(0)
    s_barrier
    s_waitcnt vmcnt(6)
    ds_write_b128 v10, v[48:51]
    ds_write_b128 v11, v[52:55]
    ds_write_b128 v12, v[56:59]
    ds_write_b128 v13, v[60:63]
    ds_write_b128 v14, v[64:67]
    ds_write_b128 v15, v[68:71]
    s_add_u32 s46, s45, 7077888
    buffer_load_dwordx4 v[24:27], v4, s[12:15], s46 offen
    buffer_load_dwordx4 v[28:31], v5, s[12:15], s46 offen
    buffer_load_dwordx4 v[32:35], v6, s[12:15], s46 offen
    buffer_load_dwordx4 v[36:39], v7, s[12:15], s46 offen
    buffer_load_dwordx4 v[40:43], v8, s[12:15], s46 offen
    buffer_load_dwordx4 v[44:47], v9, s[12:15], s46 offen
    s_waitcnt lgkmcnt(0)
    s_barrier
    ds_read_b64_tr_b16 a[56:57], v16 offset:0
    ds_read_b64_tr_b16 a[58:59], v16 offset:800
    ds_read_b64_tr_b16 a[60:61], v16 offset:12800
    ds_read_b64_tr_b16 a[62:63], v16 offset:13600
    ds_read_b64_tr_b16 a[136:137], v16 offset:32
    ds_read_b64_tr_b16 a[138:139], v16 offset:832
    ds_read_b64_tr_b16 a[140:141], v16 offset:12832
    ds_read_b64_tr_b16 a[142:143], v16 offset:13632
    ds_read_b64_tr_b16 a[216:217], v16 offset:64
    ds_read_b64_tr_b16 a[218:219], v16 offset:864
    ds_read_b64_tr_b16 a[220:221], v16 offset:12864
    ds_read_b64_tr_b16 a[222:223], v16 offset:13664
    s_waitcnt lgkmcnt(0)
    s_barrier
    s_waitcnt vmcnt(6)
    ds_write_b128 v10, v[72:75]
    ds_write_b128 v11, v[76:79]
    ds_write_b128 v12, v[80:83]
    ds_write_b128 v13, v[84:87]
    ds_write_b128 v14, v[88:91]
    ds_write_b128 v15, v[92:95]
    s_waitcnt lgkmcnt(0)
    s_barrier
    ds_read_b64_tr_b16 a[64:65], v16 offset:0
    ds_read_b64_tr_b16 a[66:67], v16 offset:800
    ds_read_b64_tr_b16 a[68:69], v16 offset:12800
    ds_read_b64_tr_b16 a[70:71], v16 offset:13600
    ds_read_b64_tr_b16 a[144:145], v16 offset:32
    ds_read_b64_tr_b16 a[146:147], v16 offset:832
    ds_read_b64_tr_b16 a[148:149], v16 offset:12832
    ds_read_b64_tr_b16 a[150:151], v16 offset:13632
    ds_read_b64_tr_b16 a[224:225], v16 offset:64
    ds_read_b64_tr_b16 a[226:227], v16 offset:864
    ds_read_b64_tr_b16 a[228:229], v16 offset:12864
    ds_read_b64_tr_b16 a[230:231], v16 offset:13664
    s_waitcnt lgkmcnt(0)
    s_barrier
    s_waitcnt vmcnt(0)
    ds_write_b128 v10, v[24:27]
    ds_write_b128 v11, v[28:31]
    ds_write_b128 v12, v[32:35]
    ds_write_b128 v13, v[36:39]
    ds_write_b128 v14, v[40:43]
    ds_write_b128 v15, v[44:47]
    s_waitcnt lgkmcnt(0)
    s_barrier
    ds_read_b64_tr_b16 a[72:73], v16 offset:0
    ds_read_b64_tr_b16 a[74:75], v16 offset:800
    ds_read_b64_tr_b16 a[76:77], v16 offset:12800
    ds_read_b64_tr_b16 a[78:79], v16 offset:13600
    ds_read_b64_tr_b16 a[152:153], v16 offset:32
    ds_read_b64_tr_b16 a[154:155], v16 offset:832
    ds_read_b64_tr_b16 a[156:157], v16 offset:12832
    ds_read_b64_tr_b16 a[158:159], v16 offset:13632
    ds_read_b64_tr_b16 a[232:233], v16 offset:64
    ds_read_b64_tr_b16 a[234:235], v16 offset:864
    ds_read_b64_tr_b16 a[236:237], v16 offset:12864
    ds_read_b64_tr_b16 a[238:239], v16 offset:13664
    s_waitcnt lgkmcnt(0)
    s_barrier
    v_add_u32 v64, 0, v0
    s_mov_b32 s24, 1639
    v_mul_lo_u32 v65, v64, s24
    v_lshrrev_b32 v65, 16, v65
    v_mul_u32_u24 v66, 40, v65
    v_sub_u32 v66, v64, v66
    s_mov_b32 s24, 1280
    v_mul_lo_u32 v4, v65, s24
    v_lshl_add_u32 v4, v66, 4, v4
    v_mul_u32_u24 v14, 656, v65
    v_lshl_add_u32 v14, v66, 4, v14
    v_add_u32 v14, 90112, v14
    v_add_u32 v64, 256, v0
    s_mov_b32 s24, 1639
    v_mul_lo_u32 v65, v64, s24
    v_lshrrev_b32 v65, 16, v65
    v_mul_u32_u24 v66, 40, v65
    v_sub_u32 v66, v64, v66
    s_mov_b32 s24, 1280
    v_mul_lo_u32 v5, v65, s24
    v_lshl_add_u32 v5, v66, 4, v5
    v_mul_u32_u24 v15, 656, v65
    v_lshl_add_u32 v15, v66, 4, v15
    v_add_u32 v15, 90112, v15
    v_add_u32 v64, 512, v0
    s_mov_b32 s24, 1639
    v_mul_lo_u32 v65, v64, s24
    v_lshrrev_b32 v65, 16, v65
    v_mul_u32_u24 v66, 40, v65
    v_sub_u32 v66, v64, v66
    s_mov_b32 s24, 1280
    v_mul_lo_u32 v6, v65, s24
    v_lshl_add_u32 v6, v66, 4, v6
    v_mul_u32_u24 v16, 656, v65
    v_lshl_add_u32 v16, v66, 4, v16
    v_add_u32 v16, 90112, v16
    v_add_u32 v64, 768, v0
    s_mov_b32 s24, 1639
    v_mul_lo_u32 v65, v64, s24
    v_lshrrev_b32 v65, 16, v65
    v_mul_u32_u24 v66, 40, v65
    v_sub_u32 v66, v64, v66
    s_mov_b32 s24, 1280
    v_mul_lo_u32 v7, v65, s24
    v_lshl_add_u32 v7, v66, 4, v7
    v_mul_u32_u24 v17, 656, v65
    v_lshl_add_u32 v17, v66, 4, v17
    v_add_u32 v17, 90112, v17
    v_add_u32 v64, 1024, v0
    s_mov_b32 s24, 1639
    v_mul_lo_u32 v65, v64, s24
    v_lshrrev_b32 v65, 16, v65
    v_mul_u32_u24 v66, 40, v65
    v_sub_u32 v66, v64, v66
    s_mov_b32 s24, 1280
    v_mul_lo_u32 v8, v65, s24
    v_lshl_add_u32 v8, v66, 4, v8
    v_mul_u32_u24 v18, 656, v65
    v_lshl_add_u32 v18, v66, 4, v18
    v_add_u32 v18, 90112, v18
    v_add_u32 v64, 1280, v0
    s_mov_b32 s24, 1639
    v_mul_lo_u32 v65, v64, s24
    v_lshrrev_b32 v65, 16, v65
    v_mul_u32_u24 v66, 40, v65
    v_sub_u32 v66, v64, v66
    s_mov_b32 s24, 1280
    v_mul_lo_u32 v9, v65, s24
    v_lshl_add_u32 v9, v66, 4, v9
    v_mul_u32_u24 v19, 656, v65
    v_lshl_add_u32 v19, v66, 4, v19
    v_add_u32 v19, 90112, v19
    v_add_u32 v64, 1536, v0
    s_mov_b32 s24, 1639
    v_mul_lo_u32 v65, v64, s24
    v_lshrrev_b32 v65, 16, v65
    v_mul_u32_u24 v66, 40, v65
    v_sub_u32 v66, v64, v66
    s_mov_b32 s24, 1280
    v_mul_lo_u32 v10, v65, s24
    v_lshl_add_u32 v10, v66, 4, v10
    v_mul_u32_u24 v20, 656, v65
    v_lshl_add_u32 v20, v66, 4, v20
    v_add_u32 v20, 90112, v20
    v_add_u32 v64, 1792, v0
    s_mov_b32 s24, 1639
    v_mul_lo_u32 v65, v64, s24
    v_lshrrev_b32 v65, 16, v65
    v_mul_u32_u24 v66, 40, v65
    v_sub_u32 v66, v64, v66
    s_mov_b32 s24, 1280
    v_mul_lo_u32 v11, v65, s24
    v_lshl_add_u32 v11, v66, 4, v11
    v_mul_u32_u24 v21, 656, v65
    v_lshl_add_u32 v21, v66, 4, v21
    v_add_u32 v21, 90112, v21
    v_add_u32 v64, 2048, v0
    s_mov_b32 s24, 1639
    v_mul_lo_u32 v65, v64, s24
    v_lshrrev_b32 v65, 16, v65
    v_mul_u32_u24 v66, 40, v65
    v_sub_u32 v66, v64, v66
    s_mov_b32 s24, 1280
    v_mul_lo_u32 v12, v65, s24
    v_lshl_add_u32 v12, v66, 4, v12
    v_mul_u32_u24 v22, 656, v65
    v_lshl_add_u32 v22, v66, 4, v22
    v_add_u32 v22, 90112, v22
    v_add_u32 v64, 2304, v0
    s_mov_b32 s24, 1639
    v_mul_lo_u32 v65, v64, s24
    v_lshrrev_b32 v65, 16, v65
    v_mul_u32_u24 v66, 40, v65
    v_sub_u32 v66, v64, v66
    s_mov_b32 s24, 1280
    v_mul_lo_u32 v13, v65, s24
    v_lshl_add_u32 v13, v66, 4, v13
    v_mul_u32_u24 v23, 656, v65
    v_lshl_add_u32 v23, v66, 4, v23
    v_add_u32 v23, 90112, v23
    v_lshrrev_b32 v64, 1, v3
    v_lshlrev_b32 v64, 4, v64
    v_and_b32 v65, 1, v3
    v_lshl_add_u32 v64, v65, 2, v64
    v_lshrrev_b32 v65, 2, v2
    v_and_b32 v66, 1, v65
    v_add_u32 v64, v64, v66
    v_lshrrev_b32 v65, 1, v65
    v_lshl_add_u32 v64, v65, 3, v64
    v_mul_u32_u24 v72, 656, v64
    v_and_b32 v65, 3, v2
    v_lshl_add_u32 v72, v65, 3, v72
    v_add_u32 v72, 90112, v72
    s_and_b32 s24, s3, 1
    s_mul_i32 s24, s24, 320
    v_add_u32 v72, s24, v72
    v_lshlrev_b32 v73, 4, v1
    s_mul_i32 s24, s3, 18432
    s_add_u32 s24, s24, 16384
    v_add_u32 v73, s24, v73
    s_mul_i32 s45, s44, 245760
    s_add_u32 s46, s45, 0
    buffer_load_dwordx4 v[24:27], v4, s[16:19], s46 offen
    buffer_load_dwordx4 v[28:31], v5, s[16:19], s46 offen
    buffer_load_dwordx4 v[32:35], v6, s[16:19], s46 offen
    buffer_load_dwordx4 v[36:39], v7, s[16:19], s46 offen
    buffer_load_dwordx4 v[40:43], v8, s[16:19], s46 offen
    buffer_load_dwordx4 v[44:47], v9, s[16:19], s46 offen
    buffer_load_dwordx4 v[48:51], v10, s[16:19], s46 offen
    buffer_load_dwordx4 v[52:55], v11, s[16:19], s46 offen
    buffer_load_dwordx4 v[56:59], v12, s[16:19], s46 offen
    buffer_load_dwordx4 v[60:63], v13, s[16:19], s46 offen
    s_waitcnt vmcnt(0)
    ds_write_b128 v14, v[24:27]
    ds_write_b128 v15, v[28:31]
    ds_write_b128 v16, v[32:35]
    ds_write_b128 v17, v[36:39]
    ds_write_b128 v18, v[40:43]
    ds_write_b128 v19, v[44:47]
    ds_write_b128 v20, v[48:51]
    ds_write_b128 v21, v[52:55]
    ds_write_b128 v22, v[56:59]
    ds_write_b128 v23, v[60:63]
    s_waitcnt lgkmcnt(0)
    s_barrier
    s_lshr_b32 s24, s3, 1
    s_cmp_eq_u32 s24, 0
    s_cbranch_scc0 interleave_layers__linear_attn_block__memory_aug_recurrent_mem_tr__prompt_kernel_wo16
    ds_read_b64_tr_b16 a[240:241], v72 offset:0
    ds_read_b64_tr_b16 a[242:243], v72 offset:1312
    ds_read_b64_tr_b16 a[244:245], v72 offset:20992
    ds_read_b64_tr_b16 a[246:247], v72 offset:22304
    ds_read_b64_tr_b16 v[112:113], v72 offset:32
    ds_read_b64_tr_b16 v[114:115], v72 offset:1344
    ds_read_b64_tr_b16 v[116:117], v72 offset:21024
    ds_read_b64_tr_b16 v[118:119], v72 offset:22336
    ds_read_b64_tr_b16 v[136:137], v72 offset:64
    ds_read_b64_tr_b16 v[138:139], v72 offset:1376
    ds_read_b64_tr_b16 v[140:141], v72 offset:21056
    ds_read_b64_tr_b16 v[142:143], v72 offset:22368
    ds_read_b64_tr_b16 v[160:161], v72 offset:96
    ds_read_b64_tr_b16 v[162:163], v72 offset:1408
    ds_read_b64_tr_b16 v[164:165], v72 offset:21088
    ds_read_b64_tr_b16 v[166:167], v72 offset:22400
    ds_read_b64_tr_b16 v[184:185], v72 offset:128
    ds_read_b64_tr_b16 v[186:187], v72 offset:1440
    ds_read_b64_tr_b16 v[188:189], v72 offset:21120
    ds_read_b64_tr_b16 v[190:191], v72 offset:22432
    ds_read_b64_tr_b16 v[208:209], v72 offset:160
    ds_read_b64_tr_b16 v[210:211], v72 offset:1472
    ds_read_b64_tr_b16 v[212:213], v72 offset:21152
    ds_read_b64_tr_b16 v[214:215], v72 offset:22464
    ds_read_b64_tr_b16 v[232:233], v72 offset:192
    ds_read_b64_tr_b16 v[234:235], v72 offset:1504
    ds_read_b64_tr_b16 v[236:237], v72 offset:21184
    ds_read_b64_tr_b16 v[238:239], v72 offset:22496
    ds_read_b64_tr_b16 v[64:65], v72 offset:224
    ds_read_b64_tr_b16 v[66:67], v72 offset:1536
    ds_read_b64_tr_b16 v[68:69], v72 offset:21216
    ds_read_b64_tr_b16 v[70:71], v72 offset:22528
    s_waitcnt lgkmcnt(0)
    ds_write_b128 v73, v[64:67] offset:0
    ds_write_b128 v73, v[68:71] offset:1024
    s_waitcnt lgkmcnt(0)
    ds_read_b64_tr_b16 v[64:65], v72 offset:256
    ds_read_b64_tr_b16 v[66:67], v72 offset:1568
    ds_read_b64_tr_b16 v[68:69], v72 offset:21248
    ds_read_b64_tr_b16 v[70:71], v72 offset:22560
    s_waitcnt lgkmcnt(0)
    ds_write_b128 v73, v[64:67] offset:6144
    ds_write_b128 v73, v[68:71] offset:7168
    s_waitcnt lgkmcnt(0)
    ds_read_b64_tr_b16 v[64:65], v72 offset:288
    ds_read_b64_tr_b16 v[66:67], v72 offset:1600
    ds_read_b64_tr_b16 v[68:69], v72 offset:21280
    ds_read_b64_tr_b16 v[70:71], v72 offset:22592
    s_waitcnt lgkmcnt(0)
    ds_write_b128 v73, v[64:67] offset:12288
    ds_write_b128 v73, v[68:71] offset:13312
    s_waitcnt lgkmcnt(0)
    s_waitcnt lgkmcnt(0)
interleave_layers__linear_attn_block__memory_aug_recurrent_mem_tr__prompt_kernel_wo16:
    s_barrier
    s_add_u32 s46, s45, 640
    buffer_load_dwordx4 v[24:27], v4, s[16:19], s46 offen
    buffer_load_dwordx4 v[28:31], v5, s[16:19], s46 offen
    buffer_load_dwordx4 v[32:35], v6, s[16:19], s46 offen
    buffer_load_dwordx4 v[36:39], v7, s[16:19], s46 offen
    buffer_load_dwordx4 v[40:43], v8, s[16:19], s46 offen
    buffer_load_dwordx4 v[44:47], v9, s[16:19], s46 offen
    buffer_load_dwordx4 v[48:51], v10, s[16:19], s46 offen
    buffer_load_dwordx4 v[52:55], v11, s[16:19], s46 offen
    buffer_load_dwordx4 v[56:59], v12, s[16:19], s46 offen
    buffer_load_dwordx4 v[60:63], v13, s[16:19], s46 offen
    s_waitcnt vmcnt(0)
    ds_write_b128 v14, v[24:27]
    ds_write_b128 v15, v[28:31]
    ds_write_b128 v16, v[32:35]
    ds_write_b128 v17, v[36:39]
    ds_write_b128 v18, v[40:43]
    ds_write_b128 v19, v[44:47]
    ds_write_b128 v20, v[48:51]
    ds_write_b128 v21, v[52:55]
    ds_write_b128 v22, v[56:59]
    ds_write_b128 v23, v[60:63]
    s_waitcnt lgkmcnt(0)
    s_barrier
    s_lshr_b32 s24, s3, 1
    s_cmp_eq_u32 s24, 1
    s_cbranch_scc0 interleave_layers__linear_attn_block__memory_aug_recurrent_mem_tr__prompt_kernel_wo17
    ds_read_b64_tr_b16 a[240:241], v72 offset:0
    ds_read_b64_tr_b16 a[242:243], v72 offset:1312
    ds_read_b64_tr_b16 a[244:245], v72 offset:20992
    ds_read_b64_tr_b16 a[246:247], v72 offset:22304
    ds_read_b64_tr_b16 v[112:113], v72 offset:32
    ds_read_b64_tr_b16 v[114:115], v72 offset:1344
    ds_read_b64_tr_b16 v[116:117], v72 offset:21024
    ds_read_b64_tr_b16 v[118:119], v72 offset:22336
    ds_read_b64_tr_b16 v[136:137], v72 offset:64
    ds_read_b64_tr_b16 v[138:139], v72 offset:1376
    ds_read_b64_tr_b16 v[140:141], v72 offset:21056
    ds_read_b64_tr_b16 v[142:143], v72 offset:22368
    ds_read_b64_tr_b16 v[160:161], v72 offset:96
    ds_read_b64_tr_b16 v[162:163], v72 offset:1408
    ds_read_b64_tr_b16 v[164:165], v72 offset:21088
    ds_read_b64_tr_b16 v[166:167], v72 offset:22400
    ds_read_b64_tr_b16 v[184:185], v72 offset:128
    ds_read_b64_tr_b16 v[186:187], v72 offset:1440
    ds_read_b64_tr_b16 v[188:189], v72 offset:21120
    ds_read_b64_tr_b16 v[190:191], v72 offset:22432
    ds_read_b64_tr_b16 v[208:209], v72 offset:160
    ds_read_b64_tr_b16 v[210:211], v72 offset:1472
    ds_read_b64_tr_b16 v[212:213], v72 offset:21152
    ds_read_b64_tr_b16 v[214:215], v72 offset:22464
    ds_read_b64_tr_b16 v[232:233], v72 offset:192
    ds_read_b64_tr_b16 v[234:235], v72 offset:1504
    ds_read_b64_tr_b16 v[236:237], v72 offset:21184
    ds_read_b64_tr_b16 v[238:239], v72 offset:22496
    ds_read_b64_tr_b16 v[64:65], v72 offset:224
    ds_read_b64_tr_b16 v[66:67], v72 offset:1536
    ds_read_b64_tr_b16 v[68:69], v72 offset:21216
    ds_read_b64_tr_b16 v[70:71], v72 offset:22528
    s_waitcnt lgkmcnt(0)
    ds_write_b128 v73, v[64:67] offset:0
    ds_write_b128 v73, v[68:71] offset:1024
    s_waitcnt lgkmcnt(0)
    ds_read_b64_tr_b16 v[64:65], v72 offset:256
    ds_read_b64_tr_b16 v[66:67], v72 offset:1568
    ds_read_b64_tr_b16 v[68:69], v72 offset:21248
    ds_read_b64_tr_b16 v[70:71], v72 offset:22560
    s_waitcnt lgkmcnt(0)
    ds_write_b128 v73, v[64:67] offset:6144
    ds_write_b128 v73, v[68:71] offset:7168
    s_waitcnt lgkmcnt(0)
    ds_read_b64_tr_b16 v[64:65], v72 offset:288
    ds_read_b64_tr_b16 v[66:67], v72 offset:1600
    ds_read_b64_tr_b16 v[68:69], v72 offset:21280
    ds_read_b64_tr_b16 v[70:71], v72 offset:22592
    s_waitcnt lgkmcnt(0)
    ds_write_b128 v73, v[64:67] offset:12288
    ds_write_b128 v73, v[68:71] offset:13312
    s_waitcnt lgkmcnt(0)
    s_waitcnt lgkmcnt(0)
interleave_layers__linear_attn_block__memory_aug_recurrent_mem_tr__prompt_kernel_wo17:
    s_barrier
    s_add_u32 s46, s45, 81920
    buffer_load_dwordx4 v[24:27], v4, s[16:19], s46 offen
    buffer_load_dwordx4 v[28:31], v5, s[16:19], s46 offen
    buffer_load_dwordx4 v[32:35], v6, s[16:19], s46 offen
    buffer_load_dwordx4 v[36:39], v7, s[16:19], s46 offen
    buffer_load_dwordx4 v[40:43], v8, s[16:19], s46 offen
    buffer_load_dwordx4 v[44:47], v9, s[16:19], s46 offen
    buffer_load_dwordx4 v[48:51], v10, s[16:19], s46 offen
    buffer_load_dwordx4 v[52:55], v11, s[16:19], s46 offen
    buffer_load_dwordx4 v[56:59], v12, s[16:19], s46 offen
    buffer_load_dwordx4 v[60:63], v13, s[16:19], s46 offen
    s_waitcnt vmcnt(0)
    ds_write_b128 v14, v[24:27]
    ds_write_b128 v15, v[28:31]
    ds_write_b128 v16, v[32:35]
    ds_write_b128 v17, v[36:39]
    ds_write_b128 v18, v[40:43]
    ds_write_b128 v19, v[44:47]
    ds_write_b128 v20, v[48:51]
    ds_write_b128 v21, v[52:55]
    ds_write_b128 v22, v[56:59]
    ds_write_b128 v23, v[60:63]
    s_waitcnt lgkmcnt(0)
    s_barrier
    s_lshr_b32 s24, s3, 1
    s_cmp_eq_u32 s24, 0
    s_cbranch_scc0 interleave_layers__linear_attn_block__memory_aug_recurrent_mem_tr__prompt_kernel_wo18
    ds_read_b64_tr_b16 a[248:249], v72 offset:0
    ds_read_b64_tr_b16 a[250:251], v72 offset:1312
    ds_read_b64_tr_b16 a[252:253], v72 offset:20992
    ds_read_b64_tr_b16 a[254:255], v72 offset:22304
    ds_read_b64_tr_b16 v[120:121], v72 offset:32
    ds_read_b64_tr_b16 v[122:123], v72 offset:1344
    ds_read_b64_tr_b16 v[124:125], v72 offset:21024
    ds_read_b64_tr_b16 v[126:127], v72 offset:22336
    ds_read_b64_tr_b16 v[144:145], v72 offset:64
    ds_read_b64_tr_b16 v[146:147], v72 offset:1376
    ds_read_b64_tr_b16 v[148:149], v72 offset:21056
    ds_read_b64_tr_b16 v[150:151], v72 offset:22368
    ds_read_b64_tr_b16 v[168:169], v72 offset:96
    ds_read_b64_tr_b16 v[170:171], v72 offset:1408
    ds_read_b64_tr_b16 v[172:173], v72 offset:21088
    ds_read_b64_tr_b16 v[174:175], v72 offset:22400
    ds_read_b64_tr_b16 v[192:193], v72 offset:128
    ds_read_b64_tr_b16 v[194:195], v72 offset:1440
    ds_read_b64_tr_b16 v[196:197], v72 offset:21120
    ds_read_b64_tr_b16 v[198:199], v72 offset:22432
    ds_read_b64_tr_b16 v[216:217], v72 offset:160
    ds_read_b64_tr_b16 v[218:219], v72 offset:1472
    ds_read_b64_tr_b16 v[220:221], v72 offset:21152
    ds_read_b64_tr_b16 v[222:223], v72 offset:22464
    ds_read_b64_tr_b16 v[240:241], v72 offset:192
    ds_read_b64_tr_b16 v[242:243], v72 offset:1504
    ds_read_b64_tr_b16 v[244:245], v72 offset:21184
    ds_read_b64_tr_b16 v[246:247], v72 offset:22496
    ds_read_b64_tr_b16 v[64:65], v72 offset:224
    ds_read_b64_tr_b16 v[66:67], v72 offset:1536
    ds_read_b64_tr_b16 v[68:69], v72 offset:21216
    ds_read_b64_tr_b16 v[70:71], v72 offset:22528
    s_waitcnt lgkmcnt(0)
    ds_write_b128 v73, v[64:67] offset:2048
    ds_write_b128 v73, v[68:71] offset:3072
    s_waitcnt lgkmcnt(0)
    ds_read_b64_tr_b16 v[64:65], v72 offset:256
    ds_read_b64_tr_b16 v[66:67], v72 offset:1568
    ds_read_b64_tr_b16 v[68:69], v72 offset:21248
    ds_read_b64_tr_b16 v[70:71], v72 offset:22560
    s_waitcnt lgkmcnt(0)
    ds_write_b128 v73, v[64:67] offset:8192
    ds_write_b128 v73, v[68:71] offset:9216
    s_waitcnt lgkmcnt(0)
    ds_read_b64_tr_b16 v[64:65], v72 offset:288
    ds_read_b64_tr_b16 v[66:67], v72 offset:1600
    ds_read_b64_tr_b16 v[68:69], v72 offset:21280
    ds_read_b64_tr_b16 v[70:71], v72 offset:22592
    s_waitcnt lgkmcnt(0)
    ds_write_b128 v73, v[64:67] offset:14336
    ds_write_b128 v73, v[68:71] offset:15360
    s_waitcnt lgkmcnt(0)
    s_waitcnt lgkmcnt(0)
interleave_layers__linear_attn_block__memory_aug_recurrent_mem_tr__prompt_kernel_wo18:
    s_barrier
    s_add_u32 s46, s45, 82560
    buffer_load_dwordx4 v[24:27], v4, s[16:19], s46 offen
    buffer_load_dwordx4 v[28:31], v5, s[16:19], s46 offen
    buffer_load_dwordx4 v[32:35], v6, s[16:19], s46 offen
    buffer_load_dwordx4 v[36:39], v7, s[16:19], s46 offen
    buffer_load_dwordx4 v[40:43], v8, s[16:19], s46 offen
    buffer_load_dwordx4 v[44:47], v9, s[16:19], s46 offen
    buffer_load_dwordx4 v[48:51], v10, s[16:19], s46 offen
    buffer_load_dwordx4 v[52:55], v11, s[16:19], s46 offen
    buffer_load_dwordx4 v[56:59], v12, s[16:19], s46 offen
    buffer_load_dwordx4 v[60:63], v13, s[16:19], s46 offen
    s_waitcnt vmcnt(0)
    ds_write_b128 v14, v[24:27]
    ds_write_b128 v15, v[28:31]
    ds_write_b128 v16, v[32:35]
    ds_write_b128 v17, v[36:39]
    ds_write_b128 v18, v[40:43]
    ds_write_b128 v19, v[44:47]
    ds_write_b128 v20, v[48:51]
    ds_write_b128 v21, v[52:55]
    ds_write_b128 v22, v[56:59]
    ds_write_b128 v23, v[60:63]
    s_waitcnt lgkmcnt(0)
    s_barrier
    s_lshr_b32 s24, s3, 1
    s_cmp_eq_u32 s24, 1
    s_cbranch_scc0 interleave_layers__linear_attn_block__memory_aug_recurrent_mem_tr__prompt_kernel_wo19
    ds_read_b64_tr_b16 a[248:249], v72 offset:0
    ds_read_b64_tr_b16 a[250:251], v72 offset:1312
    ds_read_b64_tr_b16 a[252:253], v72 offset:20992
    ds_read_b64_tr_b16 a[254:255], v72 offset:22304
    ds_read_b64_tr_b16 v[120:121], v72 offset:32
    ds_read_b64_tr_b16 v[122:123], v72 offset:1344
    ds_read_b64_tr_b16 v[124:125], v72 offset:21024
    ds_read_b64_tr_b16 v[126:127], v72 offset:22336
    ds_read_b64_tr_b16 v[144:145], v72 offset:64
    ds_read_b64_tr_b16 v[146:147], v72 offset:1376
    ds_read_b64_tr_b16 v[148:149], v72 offset:21056
    ds_read_b64_tr_b16 v[150:151], v72 offset:22368
    ds_read_b64_tr_b16 v[168:169], v72 offset:96
    ds_read_b64_tr_b16 v[170:171], v72 offset:1408
    ds_read_b64_tr_b16 v[172:173], v72 offset:21088
    ds_read_b64_tr_b16 v[174:175], v72 offset:22400
    ds_read_b64_tr_b16 v[192:193], v72 offset:128
    ds_read_b64_tr_b16 v[194:195], v72 offset:1440
    ds_read_b64_tr_b16 v[196:197], v72 offset:21120
    ds_read_b64_tr_b16 v[198:199], v72 offset:22432
    ds_read_b64_tr_b16 v[216:217], v72 offset:160
    ds_read_b64_tr_b16 v[218:219], v72 offset:1472
    ds_read_b64_tr_b16 v[220:221], v72 offset:21152
    ds_read_b64_tr_b16 v[222:223], v72 offset:22464
    ds_read_b64_tr_b16 v[240:241], v72 offset:192
    ds_read_b64_tr_b16 v[242:243], v72 offset:1504
    ds_read_b64_tr_b16 v[244:245], v72 offset:21184
    ds_read_b64_tr_b16 v[246:247], v72 offset:22496
    ds_read_b64_tr_b16 v[64:65], v72 offset:224
    ds_read_b64_tr_b16 v[66:67], v72 offset:1536
    ds_read_b64_tr_b16 v[68:69], v72 offset:21216
    ds_read_b64_tr_b16 v[70:71], v72 offset:22528
    s_waitcnt lgkmcnt(0)
    ds_write_b128 v73, v[64:67] offset:2048
    ds_write_b128 v73, v[68:71] offset:3072
    s_waitcnt lgkmcnt(0)
    ds_read_b64_tr_b16 v[64:65], v72 offset:256
    ds_read_b64_tr_b16 v[66:67], v72 offset:1568
    ds_read_b64_tr_b16 v[68:69], v72 offset:21248
    ds_read_b64_tr_b16 v[70:71], v72 offset:22560
    s_waitcnt lgkmcnt(0)
    ds_write_b128 v73, v[64:67] offset:8192
    ds_write_b128 v73, v[68:71] offset:9216
    s_waitcnt lgkmcnt(0)
    ds_read_b64_tr_b16 v[64:65], v72 offset:288
    ds_read_b64_tr_b16 v[66:67], v72 offset:1600
    ds_read_b64_tr_b16 v[68:69], v72 offset:21280
    ds_read_b64_tr_b16 v[70:71], v72 offset:22592
    s_waitcnt lgkmcnt(0)
    ds_write_b128 v73, v[64:67] offset:14336
    ds_write_b128 v73, v[68:71] offset:15360
    s_waitcnt lgkmcnt(0)
    s_waitcnt lgkmcnt(0)
interleave_layers__linear_attn_block__memory_aug_recurrent_mem_tr__prompt_kernel_wo19:
    s_barrier
    s_add_u32 s46, s45, 163840
    buffer_load_dwordx4 v[24:27], v4, s[16:19], s46 offen
    buffer_load_dwordx4 v[28:31], v5, s[16:19], s46 offen
    buffer_load_dwordx4 v[32:35], v6, s[16:19], s46 offen
    buffer_load_dwordx4 v[36:39], v7, s[16:19], s46 offen
    buffer_load_dwordx4 v[40:43], v8, s[16:19], s46 offen
    buffer_load_dwordx4 v[44:47], v9, s[16:19], s46 offen
    buffer_load_dwordx4 v[48:51], v10, s[16:19], s46 offen
    buffer_load_dwordx4 v[52:55], v11, s[16:19], s46 offen
    buffer_load_dwordx4 v[56:59], v12, s[16:19], s46 offen
    buffer_load_dwordx4 v[60:63], v13, s[16:19], s46 offen
    s_waitcnt vmcnt(0)
    ds_write_b128 v14, v[24:27]
    ds_write_b128 v15, v[28:31]
    ds_write_b128 v16, v[32:35]
    ds_write_b128 v17, v[36:39]
    ds_write_b128 v18, v[40:43]
    ds_write_b128 v19, v[44:47]
    ds_write_b128 v20, v[48:51]
    ds_write_b128 v21, v[52:55]
    ds_write_b128 v22, v[56:59]
    ds_write_b128 v23, v[60:63]
    s_waitcnt lgkmcnt(0)
    s_barrier
    s_lshr_b32 s24, s3, 1
    s_cmp_eq_u32 s24, 0
    s_cbranch_scc0 interleave_layers__linear_attn_block__memory_aug_recurrent_mem_tr__prompt_kernel_wo20
    ds_read_b64_tr_b16 v[104:105], v72 offset:0
    ds_read_b64_tr_b16 v[106:107], v72 offset:1312
    ds_read_b64_tr_b16 v[108:109], v72 offset:20992
    ds_read_b64_tr_b16 v[110:111], v72 offset:22304
    ds_read_b64_tr_b16 v[128:129], v72 offset:32
    ds_read_b64_tr_b16 v[130:131], v72 offset:1344
    ds_read_b64_tr_b16 v[132:133], v72 offset:21024
    ds_read_b64_tr_b16 v[134:135], v72 offset:22336
    ds_read_b64_tr_b16 v[152:153], v72 offset:64
    ds_read_b64_tr_b16 v[154:155], v72 offset:1376
    ds_read_b64_tr_b16 v[156:157], v72 offset:21056
    ds_read_b64_tr_b16 v[158:159], v72 offset:22368
    ds_read_b64_tr_b16 v[176:177], v72 offset:96
    ds_read_b64_tr_b16 v[178:179], v72 offset:1408
    ds_read_b64_tr_b16 v[180:181], v72 offset:21088
    ds_read_b64_tr_b16 v[182:183], v72 offset:22400
    ds_read_b64_tr_b16 v[200:201], v72 offset:128
    ds_read_b64_tr_b16 v[202:203], v72 offset:1440
    ds_read_b64_tr_b16 v[204:205], v72 offset:21120
    ds_read_b64_tr_b16 v[206:207], v72 offset:22432
    ds_read_b64_tr_b16 v[224:225], v72 offset:160
    ds_read_b64_tr_b16 v[226:227], v72 offset:1472
    ds_read_b64_tr_b16 v[228:229], v72 offset:21152
    ds_read_b64_tr_b16 v[230:231], v72 offset:22464
    ds_read_b64_tr_b16 v[248:249], v72 offset:192
    ds_read_b64_tr_b16 v[250:251], v72 offset:1504
    ds_read_b64_tr_b16 v[252:253], v72 offset:21184
    ds_read_b64_tr_b16 v[254:255], v72 offset:22496
    ds_read_b64_tr_b16 v[64:65], v72 offset:224
    ds_read_b64_tr_b16 v[66:67], v72 offset:1536
    ds_read_b64_tr_b16 v[68:69], v72 offset:21216
    ds_read_b64_tr_b16 v[70:71], v72 offset:22528
    s_waitcnt lgkmcnt(0)
    ds_write_b128 v73, v[64:67] offset:4096
    ds_write_b128 v73, v[68:71] offset:5120
    s_waitcnt lgkmcnt(0)
    ds_read_b64_tr_b16 v[64:65], v72 offset:256
    ds_read_b64_tr_b16 v[66:67], v72 offset:1568
    ds_read_b64_tr_b16 v[68:69], v72 offset:21248
    ds_read_b64_tr_b16 v[70:71], v72 offset:22560
    s_waitcnt lgkmcnt(0)
    ds_write_b128 v73, v[64:67] offset:10240
    ds_write_b128 v73, v[68:71] offset:11264
    s_waitcnt lgkmcnt(0)
    ds_read_b64_tr_b16 v[64:65], v72 offset:288
    ds_read_b64_tr_b16 v[66:67], v72 offset:1600
    ds_read_b64_tr_b16 v[68:69], v72 offset:21280
    ds_read_b64_tr_b16 v[70:71], v72 offset:22592
    s_waitcnt lgkmcnt(0)
    ds_write_b128 v73, v[64:67] offset:16384
    ds_write_b128 v73, v[68:71] offset:17408
    s_waitcnt lgkmcnt(0)
    s_waitcnt lgkmcnt(0)
interleave_layers__linear_attn_block__memory_aug_recurrent_mem_tr__prompt_kernel_wo20:
    s_barrier
    s_add_u32 s46, s45, 164480
    buffer_load_dwordx4 v[24:27], v4, s[16:19], s46 offen
    buffer_load_dwordx4 v[28:31], v5, s[16:19], s46 offen
    buffer_load_dwordx4 v[32:35], v6, s[16:19], s46 offen
    buffer_load_dwordx4 v[36:39], v7, s[16:19], s46 offen
    buffer_load_dwordx4 v[40:43], v8, s[16:19], s46 offen
    buffer_load_dwordx4 v[44:47], v9, s[16:19], s46 offen
    buffer_load_dwordx4 v[48:51], v10, s[16:19], s46 offen
    buffer_load_dwordx4 v[52:55], v11, s[16:19], s46 offen
    buffer_load_dwordx4 v[56:59], v12, s[16:19], s46 offen
    buffer_load_dwordx4 v[60:63], v13, s[16:19], s46 offen
    s_waitcnt vmcnt(0)
    ds_write_b128 v14, v[24:27]
    ds_write_b128 v15, v[28:31]
    ds_write_b128 v16, v[32:35]
    ds_write_b128 v17, v[36:39]
    ds_write_b128 v18, v[40:43]
    ds_write_b128 v19, v[44:47]
    ds_write_b128 v20, v[48:51]
    ds_write_b128 v21, v[52:55]
    ds_write_b128 v22, v[56:59]
    ds_write_b128 v23, v[60:63]
    s_waitcnt lgkmcnt(0)
    s_barrier
    s_lshr_b32 s24, s3, 1
    s_cmp_eq_u32 s24, 1
    s_cbranch_scc0 interleave_layers__linear_attn_block__memory_aug_recurrent_mem_tr__prompt_kernel_wo21
    ds_read_b64_tr_b16 v[104:105], v72 offset:0
    ds_read_b64_tr_b16 v[106:107], v72 offset:1312
    ds_read_b64_tr_b16 v[108:109], v72 offset:20992
    ds_read_b64_tr_b16 v[110:111], v72 offset:22304
    ds_read_b64_tr_b16 v[128:129], v72 offset:32
    ds_read_b64_tr_b16 v[130:131], v72 offset:1344
    ds_read_b64_tr_b16 v[132:133], v72 offset:21024
    ds_read_b64_tr_b16 v[134:135], v72 offset:22336
    ds_read_b64_tr_b16 v[152:153], v72 offset:64
    ds_read_b64_tr_b16 v[154:155], v72 offset:1376
    ds_read_b64_tr_b16 v[156:157], v72 offset:21056
    ds_read_b64_tr_b16 v[158:159], v72 offset:22368
    ds_read_b64_tr_b16 v[176:177], v72 offset:96
    ds_read_b64_tr_b16 v[178:179], v72 offset:1408
    ds_read_b64_tr_b16 v[180:181], v72 offset:21088
    ds_read_b64_tr_b16 v[182:183], v72 offset:22400
    ds_read_b64_tr_b16 v[200:201], v72 offset:128
    ds_read_b64_tr_b16 v[202:203], v72 offset:1440
    ds_read_b64_tr_b16 v[204:205], v72 offset:21120
    ds_read_b64_tr_b16 v[206:207], v72 offset:22432
    ds_read_b64_tr_b16 v[224:225], v72 offset:160
    ds_read_b64_tr_b16 v[226:227], v72 offset:1472
    ds_read_b64_tr_b16 v[228:229], v72 offset:21152
    ds_read_b64_tr_b16 v[230:231], v72 offset:22464
    ds_read_b64_tr_b16 v[248:249], v72 offset:192
    ds_read_b64_tr_b16 v[250:251], v72 offset:1504
    ds_read_b64_tr_b16 v[252:253], v72 offset:21184
    ds_read_b64_tr_b16 v[254:255], v72 offset:22496
    ds_read_b64_tr_b16 v[64:65], v72 offset:224
    ds_read_b64_tr_b16 v[66:67], v72 offset:1536
    ds_read_b64_tr_b16 v[68:69], v72 offset:21216
    ds_read_b64_tr_b16 v[70:71], v72 offset:22528
    s_waitcnt lgkmcnt(0)
    ds_write_b128 v73, v[64:67] offset:4096
    ds_write_b128 v73, v[68:71] offset:5120
    s_waitcnt lgkmcnt(0)
    ds_read_b64_tr_b16 v[64:65], v72 offset:256
    ds_read_b64_tr_b16 v[66:67], v72 offset:1568
    ds_read_b64_tr_b16 v[68:69], v72 offset:21248
    ds_read_b64_tr_b16 v[70:71], v72 offset:22560
    s_waitcnt lgkmcnt(0)
    ds_write_b128 v73, v[64:67] offset:10240
    ds_write_b128 v73, v[68:71] offset:11264
    s_waitcnt lgkmcnt(0)
    ds_read_b64_tr_b16 v[64:65], v72 offset:288
    ds_read_b64_tr_b16 v[66:67], v72 offset:1600
    ds_read_b64_tr_b16 v[68:69], v72 offset:21280
    ds_read_b64_tr_b16 v[70:71], v72 offset:22592
    s_waitcnt lgkmcnt(0)
    ds_write_b128 v73, v[64:67] offset:16384
    ds_write_b128 v73, v[68:71] offset:17408
    s_waitcnt lgkmcnt(0)
    s_waitcnt lgkmcnt(0)
interleave_layers__linear_attn_block__memory_aug_recurrent_mem_tr__prompt_kernel_wo21:
    s_barrier
    v_mov_b32 v6, v73
    v_mov_b32 v4, 0x4444
    v_mov_b32 v5, 0xeeee
    v_cmp_gt_u32 vcc, 8, v2
    s_nop 1
    v_cndmask_b32 v4, v5, v4, vcc
    v_lshlrev_b32 v5, 4, v1
    s_lshl_b32 s24, s3, 10
    v_add_u32 v7, s24, v5
    s_lshl_b32 s24, s3, 9
    s_add_u32 s24, s24, 8192
    v_lshlrev_b32 v8, 3, v1
    v_add_u32 v8, s24, v8
    v_and_b32 v64, 7, v2
    v_lshlrev_b32 v9, 5, v64
    v_lshrrev_b32 v64, 3, v2
    v_lshl_add_u32 v9, v64, 4, v9
    v_and_b32 v64, 1, v3
    v_lshl_add_u32 v9, v64, 3, v9
    s_mul_i32 s24, s3, 768
    s_add_u32 s24, s24, 10240
    v_add_u32 v9, s24, v9
    v_lshrrev_b32 v65, 1, v3
    v_lshl_add_u32 v10, v65, 8, v9
    v_lshrrev_b32 v64, 2, v2
    v_lshlrev_b32 v11, 5, v64
    v_and_b32 v64, 3, v2
    v_lshl_add_u32 v11, v64, 3, v11
    v_lshl_add_u32 v11, v3, 8, v11
    v_add_u32 v11, 10240, v11
    s_mul_i32 s24, s3, 10
    s_lshl_b32 s24, s24, 13
    s_lshl_b32 s25, s44, 8
    s_add_u32 s24, s24, s25
    v_lshlrev_b32 v14, 13, v3
    v_lshl_add_u32 v14, v2, 4, v14
    v_add_u32 v14, s24, v14
    v_lshrrev_b32 v64, 1, v3
    v_lshlrev_b32 v15, 13, v64
    v_lshl_add_u32 v15, v2, 4, v15
    v_add_u32 v15, s24, v15
    v_add_u32 v15, 65536, v15
    v_and_b32 v64, 1, v3
    v_cmp_eq_u32 vcc, 0, v64
    v_mov_b32 v64, 2146435072
    s_nop 0
    v_cndmask_b32 v15, v64, v15, vcc
    s_and_b32 s24, s2, 15
    s_mul_i32 s25, s3, 16
    s_add_u32 s24, s24, s25
    s_lshl_b32 s24, s24, 7
    v_mov_b32 v12, s24
    v_mov_b32 v0, 1
interleave_layers__linear_attn_block__memory_aug_recurrent_mem_tr__prompt_kernel_v_layer:
    s_mul_i32 s93, s92, 29360128
    s_add_u32 s93, s93, 117440512
    s_mul_i32 s94, s92, 16384
    s_add_u32 s94, s94, 23068672
    s_lshl_b32 s24, s3, 6
    s_add_u32 s24, s24, 0
    v_add_u32 v64, s24, v1
    v_and_b32 v65, 7, v64
    v_mul_u32_u24 v65, 1280, v65
    v_lshrrev_b32 v66, 3, v64
    v_lshl_add_u32 v65, v66, 4, v65
    v_cmp_gt_u32 vcc, 640, v64
    v_mov_b32 v67, 2146435072
    s_nop 0
    v_cndmask_b32 v65, v67, v65, vcc
    buffer_load_dwordx4 v[68:71], v65, s[20:23], 0 offen
    v_lshlrev_b32 v64, 4, v64
    s_waitcnt vmcnt(0)
    s_and_saveexec_b64 s[30:31], vcc
    ds_write_b128 v64, v[68:71]
    s_mov_b64 exec, s[30:31]
    s_lshl_b32 s24, s3, 6
    s_add_u32 s24, s24, 256
    v_add_u32 v64, s24, v1
    v_and_b32 v65, 7, v64
    v_mul_u32_u24 v65, 1280, v65
    v_lshrrev_b32 v66, 3, v64
    v_lshl_add_u32 v65, v66, 4, v65
    v_cmp_gt_u32 vcc, 640, v64
    v_mov_b32 v67, 2146435072
    s_nop 0
    v_cndmask_b32 v65, v67, v65, vcc
    buffer_load_dwordx4 v[68:71], v65, s[20:23], 0 offen
    v_lshlrev_b32 v64, 4, v64
    s_waitcnt vmcnt(0)
    s_and_saveexec_b64 s[30:31], vcc
    ds_write_b128 v64, v[68:71]
    s_mov_b64 exec, s[30:31]
    s_lshl_b32 s24, s3, 6
    s_add_u32 s24, s24, 512
    v_add_u32 v64, s24, v1
    v_and_b32 v65, 7, v64
    v_mul_u32_u24 v65, 1280, v65
    v_lshrrev_b32 v66, 3, v64
    v_lshl_add_u32 v65, v66, 4, v65
    v_cmp_gt_u32 vcc, 640, v64
    v_mov_b32 v67, 2146435072
    s_nop 0
    v_cndmask_b32 v65, v67, v65, vcc
    buffer_load_dwordx4 v[68:71], v65, s[20:23], 0 offen
    v_lshlrev_b32 v64, 4, v64
    s_waitcnt vmcnt(0)
    s_and_saveexec_b64 s[30:31], vcc
    ds_write_b128 v64, v[68:71]
    s_mov_b64 exec, s[30:31]
    s_mov_b32 s40, 0
    s_add_u32 s43, s93, 0
    s_add_u32 s47, s93, -28672
    s_add_u32 s45, s93, -18432
    s_lshl_b32 s95, s92, 6
    s_add_u32 s95, s95, s40
    s_add_u32 s95, s95, 1
    s_cmp_ge_i32 s59, s95
    s_cbranch_scc1 interleave_layers__linear_attn_block__memory_aug_recurrent_mem_tr__prompt_kernel_v_ec0_ok
    s_and_b32 s24, s2, 7
    s_lshl_b32 s24, s24, 7
    s_add_u32 s24, s24, 23109632
    v_and_b32 v65, 3, v1
    v_lshl_add_u32 v65, v65, 2, s24
    s_mov_b32 s61, 0
interleave_layers__linear_attn_block__memory_aug_recurrent_mem_tr__prompt_kernel_v_ec0:
    buffer_load_dword v64, v65, s[8:11], 0 offen sc1
    s_waitcnt vmcnt(0)
    v_readlane_b32 s59, v64, 0
    v_readlane_b32 s24, v64, 1
    s_min_i32 s59, s59, s24
    v_readlane_b32 s24, v64, 2
    s_min_i32 s59, s59, s24
    s_cmp_ge_i32 s59, s95
    s_cbranch_scc1 interleave_layers__linear_attn_block__memory_aug_recurrent_mem_tr__prompt_kernel_v_ec0_ok
    s_add_u32 s61, s61, 1
    s_cmp_ge_u32 s61, s60
    s_cbranch_scc1 interleave_layers__linear_attn_block__memory_aug_recurrent_mem_tr__prompt_kernel_v_ec0_to
    s_sleep 2
    s_branch interleave_layers__linear_attn_block__memory_aug_recurrent_mem_tr__prompt_kernel_v_ec0
interleave_layers__linear_attn_block__memory_aug_recurrent_mem_tr__prompt_kernel_v_ec0_to:
    s_mov_b32 s60, 1
interleave_layers__linear_attn_block__memory_aug_recurrent_mem_tr__prompt_kernel_v_ec0_ok:
    v_mov_b32 v16, 0
    v_mov_b32 v17, 0
    v_mov_b32 v18, 0
    v_mov_b32 v19, 0
    v_mov_b32 v20, 0
    v_mov_b32 v21, 0
    v_mov_b32 v22, 0
    v_mov_b32 v23, 0
    v_mov_b32 v24, 0
    v_mov_b32 v25, 0
    v_mov_b32 v26, 0
    v_mov_b32 v27, 0
    v_mov_b32 v28, 0
    v_mov_b32 v29, 0
    v_mov_b32 v30, 0
    v_mov_b32 v31, 0
    v_mov_b32 v32, 0
    v_mov_b32 v33, 0
    v_mov_b32 v34, 0
    v_mov_b32 v35, 0
    v_mov_b32 v36, 0
    v_mov_b32 v37, 0
    v_mov_b32 v38, 0
    v_mov_b32 v39, 0
    v_mov_b32 v40, 0
    v_mov_b32 v41, 0
    v_mov_b32 v42, 0
    v_mov_b32 v43, 0
    v_mov_b32 v44, 0
    v_mov_b32 v45, 0
    v_mov_b32 v46, 0
    v_mov_b32 v47, 0
    v_mov_b32 v48, 0
    v_mov_b32 v49, 0
    v_mov_b32 v50, 0
    v_mov_b32 v51, 0
    v_mov_b32 v52, 0
    v_mov_b32 v53, 0
    v_mov_b32 v54, 0
    v_mov_b32 v55, 0
    v_mov_b32 v56, 0
    v_mov_b32 v57, 0
    v_mov_b32 v58, 0
    v_mov_b32 v59, 0
    v_mov_b32 v60, 0
    v_mov_b32 v61, 0
    v_mov_b32 v62, 0
    v_mov_b32 v63, 0
    v_mov_b32 v64, 0
    v_mov_b32 v65, 0
    v_mov_b32 v66, 0
    v_mov_b32 v67, 0
    s_waitcnt lgkmcnt(0)
    s_barrier
    ds_read_b128 v[68:71], v7
    ds_read_b128 v[72:75], v7 offset:4096
    s_waitcnt lgkmcnt(0)
    s_cmp_eq_u32 s3, 0
    s_cbranch_scc1 interleave_layers__linear_attn_block__memory_aug_recurrent_mem_tr__prompt_kernel_v_gow0
    s_cmp_eq_u32 s3, 1
    s_cbranch_scc1 interleave_layers__linear_attn_block__memory_aug_recurrent_mem_tr__prompt_kernel_v_gow1
    s_cmp_eq_u32 s3, 2
    s_cbranch_scc1 interleave_layers__linear_attn_block__memory_aug_recurrent_mem_tr__prompt_kernel_v_gow2
    s_branch interleave_layers__linear_attn_block__memory_aug_recurrent_mem_tr__prompt_kernel_v_gow3
interleave_layers__linear_attn_block__memory_aug_recurrent_mem_tr__prompt_kernel_v_stepw0:
    v_mov_b32 v16, 0
    v_mov_b32 v17, 0
    v_mov_b32 v18, 0
    v_mov_b32 v19, 0
    v_mov_b32 v20, 0
    v_mov_b32 v21, 0
    v_mov_b32 v22, 0
    v_mov_b32 v23, 0
    v_mov_b32 v24, 0
    v_mov_b32 v25, 0
    v_mov_b32 v26, 0
    v_mov_b32 v27, 0
    v_mov_b32 v28, 0
    v_mov_b32 v29, 0
    v_mov_b32 v30, 0
    v_mov_b32 v31, 0
    v_mov_b32 v32, 0
    v_mov_b32 v33, 0
    v_mov_b32 v34, 0
    v_mov_b32 v35, 0
    v_mov_b32 v36, 0
    v_mov_b32 v37, 0
    v_mov_b32 v38, 0
    v_mov_b32 v39, 0
    v_mov_b32 v40, 0
    v_mov_b32 v41, 0
    v_mov_b32 v42, 0
    v_mov_b32 v43, 0
    v_mov_b32 v44, 0
    v_mov_b32 v45, 0
    v_mov_b32 v46, 0
    v_mov_b32 v47, 0
    v_mov_b32 v48, 0
    v_mov_b32 v49, 0
    v_mov_b32 v50, 0
    v_mov_b32 v51, 0
    v_mov_b32 v52, 0
    v_mov_b32 v53, 0
    v_mov_b32 v54, 0
    v_mov_b32 v55, 0
    v_mov_b32 v56, 0
    v_mov_b32 v57, 0
    v_mov_b32 v58, 0
    v_mov_b32 v59, 0
    v_mov_b32 v60, 0
    v_mov_b32 v61, 0
    v_mov_b32 v62, 0
    v_mov_b32 v63, 0
    v_mov_b32 v64, 0
    v_mov_b32 v65, 0
    v_mov_b32 v66, 0
    v_mov_b32 v67, 0
    s_add_u32 s48, s47, 4096
    s_lshl_b32 s95, s92, 6
    s_add_u32 s95, s95, s40
    s_add_u32 s95, s95, 1
    s_cmp_ge_i32 s59, s95
    s_cbranch_scc1 interleave_layers__linear_attn_block__memory_aug_recurrent_mem_tr__prompt_kernel_v_ecw0_ok
    s_and_b32 s24, s2, 7
    s_lshl_b32 s24, s24, 7
    s_add_u32 s24, s24, 23109632
    v_and_b32 v79, 3, v1
    v_lshl_add_u32 v79, v79, 2, s24
    s_mov_b32 s61, 0
interleave_layers__linear_attn_block__memory_aug_recurrent_mem_tr__prompt_kernel_v_ecw0:
    buffer_load_dword v78, v79, s[8:11], 0 offen sc1
    s_waitcnt vmcnt(0)
    v_readlane_b32 s59, v78, 0
    v_readlane_b32 s24, v78, 1
    s_min_i32 s59, s59, s24
    v_readlane_b32 s24, v78, 2
    s_min_i32 s59, s59, s24
    s_cmp_ge_i32 s59, s95
    s_cbranch_scc1 interleave_layers__linear_attn_block__memory_aug_recurrent_mem_tr__prompt_kernel_v_ecw0_ok
    s_add_u32 s61, s61, 1
    s_cmp_ge_u32 s61, s60
    s_cbranch_scc1 interleave_layers__linear_attn_block__memory_aug_recurrent_mem_tr__prompt_kernel_v_ecw0_to
    s_sleep 2
    s_branch interleave_layers__linear_attn_block__memory_aug_recurrent_mem_tr__prompt_kernel_v_ecw0
interleave_layers__linear_attn_block__memory_aug_recurrent_mem_tr__prompt_kernel_v_ecw0_to:
    s_mov_b32 s60, 1
interleave_layers__linear_attn_block__memory_aug_recurrent_mem_tr__prompt_kernel_v_ecw0_ok:
    s_sleep 20
    s_mov_b64 exec, 1
    s_mov_b32 s61, 0
    v_mov_b32 v81, 0
    buffer_atomic_add v81, v12, s[8:11], s45 offen sc0
    s_sleep 3
    v_mov_b32 v82, 0
    buffer_atomic_add v82, v12, s[8:11], s45 offen sc0
    s_sleep 3
    v_mov_b32 v83, 0
    buffer_atomic_add v83, v12, s[8:11], s45 offen sc0
    s_sleep 3
interleave_layers__linear_attn_block__memory_aug_recurrent_mem_tr__prompt_kernel_v_prw0:
    v_mov_b32 v80, 0
    buffer_atomic_add v80, v12, s[8:11], s45 offen sc0
    s_waitcnt vmcnt(3)
    v_cmp_le_i32 vcc, 8, v81
    s_add_u32 s61, s61, 1
    s_cbranch_vccnz interleave_layers__linear_attn_block__memory_aug_recurrent_mem_tr__prompt_kernel_v_prw0_out
    s_sleep 3
    v_mov_b32 v81, 0
    buffer_atomic_add v81, v12, s[8:11], s45 offen sc0
    s_waitcnt vmcnt(3)
    v_cmp_le_i32 vcc, 8, v82
    s_add_u32 s61, s61, 1
    s_cbranch_vccnz interleave_layers__linear_attn_block__memory_aug_recurrent_mem_tr__prompt_kernel_v_prw0_out
    s_sleep 3
    v_mov_b32 v82, 0
    buffer_atomic_add v82, v12, s[8:11], s45 offen sc0
    s_waitcnt vmcnt(3)
    v_cmp_le_i32 vcc, 8, v83
    s_add_u32 s61, s61, 1
    s_cbranch_vccnz interleave_layers__linear_attn_block__memory_aug_recurrent_mem_tr__prompt_kernel_v_prw0_out
    s_sleep 3
    v_mov_b32 v83, 0
    buffer_atomic_add v83, v12, s[8:11], s45 offen sc0
    s_waitcnt vmcnt(3)
    v_cmp_le_i32 vcc, 8, v80
    s_add_u32 s61, s61, 1
    s_cbranch_vccnz interleave_layers__linear_attn_block__memory_aug_recurrent_mem_tr__prompt_kernel_v_prw0_out
    s_sleep 3
    s_cmp_ge_u32 s61, s60
    s_cbranch_scc0 interleave_layers__linear_attn_block__memory_aug_recurrent_mem_tr__prompt_kernel_v_prw0
    s_mov_b32 s60, 1
interleave_layers__linear_attn_block__memory_aug_recurrent_mem_tr__prompt_kernel_v_prw0_out:
    s_mov_b64 exec, -1
    buffer_load_dwordx4 v[68:71], v7, s[8:11], s47 offen sc1
    buffer_load_dwordx4 v[72:75], v7, s[8:11], s48 offen sc1
    buffer_load_dwordx2 v[76:77], v8, s[8:11], s47 offen sc1
    s_waitcnt vmcnt(0)
    v_max3_u32 v103, v68, v69, v70
    v_max3_u32 v103, v103, v71, v72
    v_max3_u32 v103, v103, v73, v74
    v_max3_u32 v103, v103, v75, v76
    v_max_u32 v103, v103, v77
    v_cmp_eq_u32 vcc, -1, v103
    s_cbranch_vccz interleave_layers__linear_attn_block__memory_aug_recurrent_mem_tr__prompt_kernel_v_pmw0_out
    s_mov_b32 s61, 0
interleave_layers__linear_attn_block__memory_aug_recurrent_mem_tr__prompt_kernel_v_pmw0:
    buffer_load_dwordx4 v[68:71], v7, s[8:11], s47 offen sc1
    buffer_load_dwordx4 v[72:75], v7, s[8:11], s48 offen sc1
    buffer_load_dwordx2 v[76:77], v8, s[8:11], s47 offen sc1
    s_waitcnt vmcnt(0)
    v_max3_u32 v103, v68, v69, v70
    v_max3_u32 v103, v103, v71, v72
    v_max3_u32 v103, v103, v73, v74
    v_max3_u32 v103, v103, v75, v76
    v_max_u32 v103, v103, v77
    v_cmp_eq_u32 vcc, -1, v103
    s_add_u32 s61, s61, 1
    s_cbranch_vccz interleave_layers__linear_attn_block__memory_aug_recurrent_mem_tr__prompt_kernel_v_pmw0_out
    s_cmp_ge_u32 s61, s60
    s_cbranch_scc1 interleave_layers__linear_attn_block__memory_aug_recurrent_mem_tr__prompt_kernel_v_pmw0_to
    s_sleep 1
    s_branch interleave_layers__linear_attn_block__memory_aug_recurrent_mem_tr__prompt_kernel_v_pmw0
interleave_layers__linear_attn_block__memory_aug_recurrent_mem_tr__prompt_kernel_v_pmw0_to:
    s_mov_b32 s60, 1
interleave_layers__linear_attn_block__memory_aug_recurrent_mem_tr__prompt_kernel_v_pmw0_out:
    ds_write_b128 v7, v[68:71]
    ds_write_b128 v7, v[72:75] offset:4096
    ds_write_b64 v8, v[76:77]
interleave_layers__linear_attn_block__memory_aug_recurrent_mem_tr__prompt_kernel_v_gow0:
    v_smfmac_f32_16x16x64_bf16 v[56:59], v[68:71], a[0:7], v4
    v_smfmac_f32_16x16x64_bf16 v[60:63], v[68:71], a[80:87], v4
    v_smfmac_f32_16x16x64_bf16 v[64:67], v[68:71], a[160:167], v4
    s_waitcnt lgkmcnt(0)
    s_barrier
    ds_read_b128 v[80:83], v5 offset:1024
    ds_read_b128 v[84:87], v5 offset:2048
    ds_read_b128 v[88:91], v5 offset:3072
    ds_read_b128 v[92:95], v5 offset:5120
    ds_read_b128 v[96:99], v5 offset:6144
    ds_read_b128 v[100:103], v5 offset:7168
    ds_read_b128 v[76:79], v5 offset:8192
    ds_read_b128 v[68:71], v5 offset:9216
    v_smfmac_f32_16x16x64_bf16 v[64:67], v[72:75], a[192:199], v4
    v_smfmac_f32_16x16x64_bf16 v[56:59], v[72:75], a[32:39], v4
    v_smfmac_f32_16x16x64_bf16 v[60:63], v[72:75], a[112:119], v4
    s_waitcnt lgkmcnt(7)
    v_smfmac_f32_16x16x64_bf16 v[64:67], v[80:83], a[168:175], v4
    s_waitcnt lgkmcnt(6)
    v_smfmac_f32_16x16x64_bf16 v[64:67], v[84:87], a[176:183], v4
    s_waitcnt lgkmcnt(5)
    v_smfmac_f32_16x16x64_bf16 v[64:67], v[88:91], a[184:191], v4
    s_waitcnt lgkmcnt(4)
    v_smfmac_f32_16x16x64_bf16 v[64:67], v[92:95], a[200:207], v4
    s_waitcnt lgkmcnt(3)
    v_smfmac_f32_16x16x64_bf16 v[64:67], v[96:99], a[208:215], v4
    s_waitcnt lgkmcnt(2)
    v_smfmac_f32_16x16x64_bf16 v[64:67], v[100:103], a[216:223], v4
    s_waitcnt lgkmcnt(1)
    v_smfmac_f32_16x16x64_bf16 v[64:67], v[76:79], a[224:231], v4
    s_waitcnt lgkmcnt(0)
    v_smfmac_f32_16x16x64_bf16 v[64:67], v[68:71], a[232:239], v4
    v_smfmac_f32_16x16x64_bf16 v[56:59], v[80:83], a[8:15], v4
    v_smfmac_f32_16x16x64_bf16 v[60:63], v[80:83], a[88:95], v4
    v_smfmac_f32_16x16x64_bf16 v[56:59], v[84:87], a[16:23], v4
    s_nop 4
    v_mov_b32 v72, v64
    v_smfmac_f32_16x16x64_bf16 v[60:63], v[84:87], a[96:103], v4
    v_mov_b32 v73, v65
    v_mov_b32 v74, v66
    v_smfmac_f32_16x16x64_bf16 v[56:59], v[88:91], a[24:31], v4
    v_mov_b32 v75, v67
    v_smfmac_f32_16x16x64_bf16 v[60:63], v[88:91], a[104:111], v4
    v_permlane32_swap_b32 v64, v72
    v_permlane32_swap_b32 v65, v73
    v_smfmac_f32_16x16x64_bf16 v[56:59], v[92:95], a[40:47], v4
    v_permlane32_swap_b32 v66, v74
    v_permlane32_swap_b32 v67, v75
    v_smfmac_f32_16x16x64_bf16 v[60:63], v[92:95], a[120:127], v4
    v_add_f32 v64, v64, v72
    v_add_f32 v65, v65, v73
    v_smfmac_f32_16x16x64_bf16 v[56:59], v[96:99], a[48:55], v4
    v_add_f32 v66, v66, v74
    v_add_f32 v67, v67, v75
    v_smfmac_f32_16x16x64_bf16 v[60:63], v[96:99], a[128:135], v4
    v_cvt_pk_bf16_f32 v72, v64, v65
    v_cvt_pk_bf16_f32 v73, v66, v67
    v_smfmac_f32_16x16x64_bf16 v[56:59], v[100:103], a[56:63], v4
    ds_write_b64 v9, v[72:73] offset:512
    v_smfmac_f32_16x16x64_bf16 v[60:63], v[100:103], a[136:143], v4
    v_smfmac_f32_16x16x64_bf16 v[56:59], v[76:79], a[64:71], v4
    v_smfmac_f32_16x16x64_bf16 v[60:63], v[76:79], a[144:151], v4
    v_smfmac_f32_16x16x64_bf16 v[56:59], v[68:71], a[72:79], v4
    v_smfmac_f32_16x16x64_bf16 v[60:63], v[68:71], a[152:159], v4
    s_nop 7
    v_permlane32_swap_b32 v56, v60
    v_permlane32_swap_b32 v57, v61
    v_permlane32_swap_b32 v58, v62
    v_permlane32_swap_b32 v59, v63
    v_add_f32 v56, v56, v60
    v_add_f32 v57, v57, v61
    v_add_f32 v58, v58, v62
    v_add_f32 v59, v59, v63
    v_cvt_pk_bf16_f32 v68, v56, v57
    v_cvt_pk_bf16_f32 v69, v58, v59
    ds_write_b64 v10, v[68:69]
    s_waitcnt lgkmcnt(0)
    s_barrier
    ds_read_b64_tr_b16 v[68:69], v11 offset:0
    ds_read_b64_tr_b16 v[70:71], v11 offset:128
    ds_read_b64_tr_b16 v[72:73], v11 offset:1024
    ds_read_b64_tr_b16 v[74:75], v11 offset:1152
    ds_read_b64_tr_b16 v[76:77], v11 offset:2048
    ds_read_b64_tr_b16 v[78:79], v11 offset:2176
    ds_read_b128 v[80:83], v6 offset:0
    ds_read_b128 v[84:87], v6 offset:1024
    ds_read_b128 v[88:91], v6 offset:2048
    ds_read_b128 v[92:95], v6 offset:3072
    ds_read_b128 v[96:99], v6 offset:4096
    ds_read_b128 v[100:103], v6 offset:5120
    s_waitcnt lgkmcnt(10)
    v_smfmac_f32_16x16x64_bf16 v[16:19], v[68:71], a[240:247], v4
    v_smfmac_f32_16x16x64_bf16 v[20:23], v[68:71], v[112:119], v4
    v_smfmac_f32_16x16x64_bf16 v[24:27], v[68:71], v[136:143], v4
    v_smfmac_f32_16x16x64_bf16 v[28:31], v[68:71], v[160:167], v4
    s_waitcnt lgkmcnt(8)
    v_smfmac_f32_16x16x64_bf16 v[16:19], v[72:75], a[248:255], v4
    v_smfmac_f32_16x16x64_bf16 v[20:23], v[72:75], v[120:127], v4
    v_smfmac_f32_16x16x64_bf16 v[24:27], v[72:75], v[144:151], v4
    v_smfmac_f32_16x16x64_bf16 v[28:31], v[72:75], v[168:175], v4
    s_waitcnt lgkmcnt(6)
    v_smfmac_f32_16x16x64_bf16 v[16:19], v[76:79], v[104:111], v4
    v_smfmac_f32_16x16x64_bf16 v[20:23], v[76:79], v[128:135], v4
    v_smfmac_f32_16x16x64_bf16 v[24:27], v[76:79], v[152:159], v4
    v_smfmac_f32_16x16x64_bf16 v[28:31], v[76:79], v[176:183], v4
    v_smfmac_f32_16x16x64_bf16 v[32:35], v[68:71], v[184:191], v4
    v_smfmac_f32_16x16x64_bf16 v[36:39], v[68:71], v[208:215], v4
    s_nop 4
    v_permlane32_swap_b32 v16, v24
    v_permlane32_swap_b32 v17, v25
    v_smfmac_f32_16x16x64_bf16 v[40:43], v[68:71], v[232:239], v4
    v_permlane32_swap_b32 v18, v26
    v_permlane32_swap_b32 v19, v27
    s_waitcnt lgkmcnt(4)
    v_smfmac_f32_16x16x64_bf16 v[44:47], v[68:71], v[80:87], v4
    v_add_f32 v16, v16, v24
    v_add_f32 v17, v17, v25
    ds_read_b128 v[80:83], v6 offset:6144
    ds_read_b128 v[84:87], v6 offset:7168
    v_smfmac_f32_16x16x64_bf16 v[32:35], v[72:75], v[192:199], v4
    v_add_f32 v18, v18, v26
    v_add_f32 v19, v19, v27
    v_smfmac_f32_16x16x64_bf16 v[36:39], v[72:75], v[216:223], v4
    v_permlane32_swap_b32 v20, v28
    v_permlane32_swap_b32 v21, v29
    v_smfmac_f32_16x16x64_bf16 v[40:43], v[72:75], v[240:247], v4
    v_permlane32_swap_b32 v22, v30
    v_permlane32_swap_b32 v23, v31
    s_waitcnt lgkmcnt(4)
    v_smfmac_f32_16x16x64_bf16 v[44:47], v[72:75], v[88:95], v4
    v_add_f32 v20, v20, v28
    v_add_f32 v21, v21, v29
    ds_read_b128 v[88:91], v6 offset:8192
    ds_read_b128 v[92:95], v6 offset:9216
    v_smfmac_f32_16x16x64_bf16 v[32:35], v[76:79], v[200:207], v4
    v_add_f32 v22, v22, v30
    v_add_f32 v23, v23, v31
    v_smfmac_f32_16x16x64_bf16 v[36:39], v[76:79], v[224:231], v4
    v_cvt_pk_bf16_f32 v56, v16, v17
    v_cvt_pk_bf16_f32 v57, v18, v19
    v_smfmac_f32_16x16x64_bf16 v[40:43], v[76:79], v[248:255], v4
    v_cvt_pk_bf16_f32 v58, v20, v21
    v_cvt_pk_bf16_f32 v59, v22, v23
    s_waitcnt lgkmcnt(4)
    v_smfmac_f32_16x16x64_bf16 v[44:47], v[76:79], v[96:103], v4
    v_permlane16_swap_b32 v56, v58
    ds_read_b128 v[96:99], v6 offset:10240
    ds_read_b128 v[100:103], v6 offset:11264
    v_permlane16_swap_b32 v57, v59
    v_min_u32 v56, -2, v56
    v_min_u32 v57, -2, v57
    v_min_u32 v58, -2, v58
    v_min_u32 v59, -2, v59
    buffer_store_dwordx4 v[56:59], v14, s[8:11], s43 offen sc1
    s_add_u32 s49, s43, 32768
    s_waitcnt lgkmcnt(4)
    v_smfmac_f32_16x16x64_bf16 v[48:51], v[68:71], v[80:87], v4
    v_permlane32_swap_b32 v32, v40
    v_permlane32_swap_b32 v33, v41
    v_permlane32_swap_b32 v34, v42
    ds_read_b128 v[80:83], v6 offset:12288
    ds_read_b128 v[84:87], v6 offset:13312
    s_waitcnt lgkmcnt(4)
    v_smfmac_f32_16x16x64_bf16 v[48:51], v[72:75], v[88:95], v4
    v_permlane32_swap_b32 v35, v43
    v_add_f32 v32, v32, v40
    v_add_f32 v33, v33, v41
    v_add_f32 v34, v34, v42
    ds_read_b128 v[88:91], v6 offset:14336
    ds_read_b128 v[92:95], v6 offset:15360
    s_waitcnt lgkmcnt(4)
    v_smfmac_f32_16x16x64_bf16 v[48:51], v[76:79], v[96:103], v4
    v_add_f32 v35, v35, v43
    v_permlane32_swap_b32 v36, v44
    v_permlane32_swap_b32 v37, v45
    v_permlane32_swap_b32 v38, v46
    ds_read_b128 v[96:99], v6 offset:16384
    ds_read_b128 v[100:103], v6 offset:17408
    v_permlane32_swap_b32 v39, v47
    v_add_f32 v36, v36, v44
    v_add_f32 v37, v37, v45
    v_add_f32 v38, v38, v46
    s_waitcnt lgkmcnt(4)
    v_smfmac_f32_16x16x64_bf16 v[52:55], v[68:71], v[80:87], v4
    v_add_f32 v39, v39, v47
    v_cvt_pk_bf16_f32 v60, v32, v33
    v_cvt_pk_bf16_f32 v61, v34, v35
    s_waitcnt lgkmcnt(2)
    v_smfmac_f32_16x16x64_bf16 v[52:55], v[72:75], v[88:95], v4
    v_cvt_pk_bf16_f32 v62, v36, v37
    v_cvt_pk_bf16_f32 v63, v38, v39
    s_waitcnt lgkmcnt(0)
    v_smfmac_f32_16x16x64_bf16 v[52:55], v[76:79], v[96:103], v4
    v_permlane16_swap_b32 v60, v62
    v_permlane16_swap_b32 v61, v63
    v_min_u32 v60, -2, v60
    v_min_u32 v61, -2, v61
    v_min_u32 v62, -2, v62
    v_min_u32 v63, -2, v63
    buffer_store_dwordx4 v[60:63], v14, s[8:11], s49 offen sc1
    s_nop 0
    v_permlane32_swap_b32 v48, v52
    v_permlane32_swap_b32 v49, v53
    v_permlane32_swap_b32 v50, v54
    v_permlane32_swap_b32 v51, v55
    v_add_f32 v48, v48, v52
    v_add_f32 v49, v49, v53
    v_add_f32 v50, v50, v54
    v_add_f32 v51, v51, v55
    v_cvt_pk_bf16_f32 v64, v48, v49
    v_cvt_pk_bf16_f32 v65, v50, v51
    v_mov_b32 v66, v64
    v_mov_b32 v67, v65
    s_nop 0
    v_permlane16_swap_b32 v64, v66
    v_permlane16_swap_b32 v65, v67
    v_min_u32 v64, -2, v64
    v_min_u32 v65, -2, v65
    v_min_u32 v66, -2, v66
    v_min_u32 v67, -2, v67
    buffer_store_dwordx4 v[64:67], v15, s[8:11], s43 offen sc1
    s_add_u32 s40, s40, 1
    s_add_u32 s43, s43, 458752
    s_add_u32 s47, s47, 458752
    s_add_u32 s45, s45, 458752
    s_cmp_lt_u32 s40, 64
    s_cbranch_scc1 interleave_layers__linear_attn_block__memory_aug_recurrent_mem_tr__prompt_kernel_v_stepw0
    s_branch interleave_layers__linear_attn_block__memory_aug_recurrent_mem_tr__prompt_kernel_v_end
interleave_layers__linear_attn_block__memory_aug_recurrent_mem_tr__prompt_kernel_v_stepw1:
    v_mov_b32 v16, 0
    v_mov_b32 v17, 0
    v_mov_b32 v18, 0
    v_mov_b32 v19, 0
    v_mov_b32 v20, 0
    v_mov_b32 v21, 0
    v_mov_b32 v22, 0
    v_mov_b32 v23, 0
    v_mov_b32 v24, 0
    v_mov_b32 v25, 0
    v_mov_b32 v26, 0
    v_mov_b32 v27, 0
    v_mov_b32 v28, 0
    v_mov_b32 v29, 0
    v_mov_b32 v30, 0
    v_mov_b32 v31, 0
    v_mov_b32 v32, 0
    v_mov_b32 v33, 0
    v_mov_b32 v34, 0
    v_mov_b32 v35, 0
    v_mov_b32 v36, 0
    v_mov_b32 v37, 0
    v_mov_b32 v38, 0
    v_mov_b32 v39, 0
    v_mov_b32 v40, 0
    v_mov_b32 v41, 0
    v_mov_b32 v42, 0
    v_mov_b32 v43, 0
    v_mov_b32 v44, 0
    v_mov_b32 v45, 0
    v_mov_b32 v46, 0
    v_mov_b32 v47, 0
    v_mov_b32 v48, 0
    v_mov_b32 v49, 0
    v_mov_b32 v50, 0
    v_mov_b32 v51, 0
    v_mov_b32 v52, 0
    v_mov_b32 v53, 0
    v_mov_b32 v54, 0
    v_mov_b32 v55, 0
    v_mov_b32 v56, 0
    v_mov_b32 v57, 0
    v_mov_b32 v58, 0
    v_mov_b32 v59, 0
    v_mov_b32 v60, 0
    v_mov_b32 v61, 0
    v_mov_b32 v62, 0
    v_mov_b32 v63, 0
    v_mov_b32 v64, 0
    v_mov_b32 v65, 0
    v_mov_b32 v66, 0
    v_mov_b32 v67, 0
    s_add_u32 s48, s47, 4096
    s_lshl_b32 s95, s92, 6
    s_add_u32 s95, s95, s40
    s_add_u32 s95, s95, 1
    s_cmp_ge_i32 s59, s95
    s_cbranch_scc1 interleave_layers__linear_attn_block__memory_aug_recurrent_mem_tr__prompt_kernel_v_ecw1_ok
    s_and_b32 s24, s2, 7
    s_lshl_b32 s24, s24, 7
    s_add_u32 s24, s24, 23109632
    v_and_b32 v79, 3, v1
    v_lshl_add_u32 v79, v79, 2, s24
    s_mov_b32 s61, 0
interleave_layers__linear_attn_block__memory_aug_recurrent_mem_tr__prompt_kernel_v_ecw1:
    buffer_load_dword v78, v79, s[8:11], 0 offen sc1
    s_waitcnt vmcnt(0)
    v_readlane_b32 s59, v78, 0
    v_readlane_b32 s24, v78, 1
    s_min_i32 s59, s59, s24
    v_readlane_b32 s24, v78, 2
    s_min_i32 s59, s59, s24
    s_cmp_ge_i32 s59, s95
    s_cbranch_scc1 interleave_layers__linear_attn_block__memory_aug_recurrent_mem_tr__prompt_kernel_v_ecw1_ok
    s_add_u32 s61, s61, 1
    s_cmp_ge_u32 s61, s60
    s_cbranch_scc1 interleave_layers__linear_attn_block__memory_aug_recurrent_mem_tr__prompt_kernel_v_ecw1_to
    s_sleep 2
    s_branch interleave_layers__linear_attn_block__memory_aug_recurrent_mem_tr__prompt_kernel_v_ecw1
interleave_layers__linear_attn_block__memory_aug_recurrent_mem_tr__prompt_kernel_v_ecw1_to:
    s_mov_b32 s60, 1
interleave_layers__linear_attn_block__memory_aug_recurrent_mem_tr__prompt_kernel_v_ecw1_ok:
    s_sleep 20
    s_mov_b64 exec, 1
    s_mov_b32 s61, 0
    v_mov_b32 v81, 0
    buffer_atomic_add v81, v12, s[8:11], s45 offen sc0
    s_sleep 3
    v_mov_b32 v82, 0
    buffer_atomic_add v82, v12, s[8:11], s45 offen sc0
    s_sleep 3
    v_mov_b32 v83, 0
    buffer_atomic_add v83, v12, s[8:11], s45 offen sc0
    s_sleep 3
interleave_layers__linear_attn_block__memory_aug_recurrent_mem_tr__prompt_kernel_v_prw1:
    v_mov_b32 v80, 0
    buffer_atomic_add v80, v12, s[8:11], s45 offen sc0
    s_waitcnt vmcnt(3)
    v_cmp_le_i32 vcc, 8, v81
    s_add_u32 s61, s61, 1
    s_cbranch_vccnz interleave_layers__linear_attn_block__memory_aug_recurrent_mem_tr__prompt_kernel_v_prw1_out
    s_sleep 3
    v_mov_b32 v81, 0
    buffer_atomic_add v81, v12, s[8:11], s45 offen sc0
    s_waitcnt vmcnt(3)
    v_cmp_le_i32 vcc, 8, v82
    s_add_u32 s61, s61, 1
    s_cbranch_vccnz interleave_layers__linear_attn_block__memory_aug_recurrent_mem_tr__prompt_kernel_v_prw1_out
    s_sleep 3
    v_mov_b32 v82, 0
    buffer_atomic_add v82, v12, s[8:11], s45 offen sc0
    s_waitcnt vmcnt(3)
    v_cmp_le_i32 vcc, 8, v83
    s_add_u32 s61, s61, 1
    s_cbranch_vccnz interleave_layers__linear_attn_block__memory_aug_recurrent_mem_tr__prompt_kernel_v_prw1_out
    s_sleep 3
    v_mov_b32 v83, 0
    buffer_atomic_add v83, v12, s[8:11], s45 offen sc0
    s_waitcnt vmcnt(3)
    v_cmp_le_i32 vcc, 8, v80
    s_add_u32 s61, s61, 1
    s_cbranch_vccnz interleave_layers__linear_attn_block__memory_aug_recurrent_mem_tr__prompt_kernel_v_prw1_out
    s_sleep 3
    s_cmp_ge_u32 s61, s60
    s_cbranch_scc0 interleave_layers__linear_attn_block__memory_aug_recurrent_mem_tr__prompt_kernel_v_prw1
    s_mov_b32 s60, 1
interleave_layers__linear_attn_block__memory_aug_recurrent_mem_tr__prompt_kernel_v_prw1_out:
    s_mov_b64 exec, -1
    buffer_load_dwordx4 v[68:71], v7, s[8:11], s47 offen sc1
    buffer_load_dwordx4 v[72:75], v7, s[8:11], s48 offen sc1
    buffer_load_dwordx2 v[76:77], v8, s[8:11], s47 offen sc1
    s_waitcnt vmcnt(0)
    v_max3_u32 v103, v68, v69, v70
    v_max3_u32 v103, v103, v71, v72
    v_max3_u32 v103, v103, v73, v74
    v_max3_u32 v103, v103, v75, v76
    v_max_u32 v103, v103, v77
    v_cmp_eq_u32 vcc, -1, v103
    s_cbranch_vccz interleave_layers__linear_attn_block__memory_aug_recurrent_mem_tr__prompt_kernel_v_pmw1_out
    s_mov_b32 s61, 0
interleave_layers__linear_attn_block__memory_aug_recurrent_mem_tr__prompt_kernel_v_pmw1:
    buffer_load_dwordx4 v[68:71], v7, s[8:11], s47 offen sc1
    buffer_load_dwordx4 v[72:75], v7, s[8:11], s48 offen sc1
    buffer_load_dwordx2 v[76:77], v8, s[8:11], s47 offen sc1
    s_waitcnt vmcnt(0)
    v_max3_u32 v103, v68, v69, v70
    v_max3_u32 v103, v103, v71, v72
    v_max3_u32 v103, v103, v73, v74
    v_max3_u32 v103, v103, v75, v76
    v_max_u32 v103, v103, v77
    v_cmp_eq_u32 vcc, -1, v103
    s_add_u32 s61, s61, 1
    s_cbranch_vccz interleave_layers__linear_attn_block__memory_aug_recurrent_mem_tr__prompt_kernel_v_pmw1_out
    s_cmp_ge_u32 s61, s60
    s_cbranch_scc1 interleave_layers__linear_attn_block__memory_aug_recurrent_mem_tr__prompt_kernel_v_pmw1_to
    s_sleep 1
    s_branch interleave_layers__linear_attn_block__memory_aug_recurrent_mem_tr__prompt_kernel_v_pmw1
interleave_layers__linear_attn_block__memory_aug_recurrent_mem_tr__prompt_kernel_v_pmw1_to:
    s_mov_b32 s60, 1
interleave_layers__linear_attn_block__memory_aug_recurrent_mem_tr__prompt_kernel_v_pmw1_out:
    ds_write_b128 v7, v[68:71]
    ds_write_b128 v7, v[72:75] offset:4096
    ds_write_b64 v8, v[76:77]
interleave_layers__linear_attn_block__memory_aug_recurrent_mem_tr__prompt_kernel_v_gow1:
    v_smfmac_f32_16x16x64_bf16 v[56:59], v[68:71], a[8:15], v4
    v_smfmac_f32_16x16x64_bf16 v[60:63], v[68:71], a[88:95], v4
    v_smfmac_f32_16x16x64_bf16 v[64:67], v[68:71], a[168:175], v4
    s_waitcnt lgkmcnt(0)
    s_barrier
    ds_read_b128 v[80:83], v5 offset:0
    ds_read_b128 v[84:87], v5 offset:2048
    ds_read_b128 v[88:91], v5 offset:3072
    ds_read_b128 v[92:95], v5 offset:4096
    ds_read_b128 v[96:99], v5 offset:6144
    ds_read_b128 v[100:103], v5 offset:7168
    ds_read_b128 v[76:79], v5 offset:8192
    ds_read_b128 v[68:71], v5 offset:9216
    v_smfmac_f32_16x16x64_bf16 v[64:67], v[72:75], a[200:207], v4
    v_smfmac_f32_16x16x64_bf16 v[56:59], v[72:75], a[40:47], v4
    v_smfmac_f32_16x16x64_bf16 v[60:63], v[72:75], a[120:127], v4
    s_waitcnt lgkmcnt(7)
    v_smfmac_f32_16x16x64_bf16 v[64:67], v[80:83], a[160:167], v4
    s_waitcnt lgkmcnt(6)
    v_smfmac_f32_16x16x64_bf16 v[64:67], v[84:87], a[176:183], v4
    s_waitcnt lgkmcnt(5)
    v_smfmac_f32_16x16x64_bf16 v[64:67], v[88:91], a[184:191], v4
    s_waitcnt lgkmcnt(4)
    v_smfmac_f32_16x16x64_bf16 v[64:67], v[92:95], a[192:199], v4
    s_waitcnt lgkmcnt(3)
    v_smfmac_f32_16x16x64_bf16 v[64:67], v[96:99], a[208:215], v4
    s_waitcnt lgkmcnt(2)
    v_smfmac_f32_16x16x64_bf16 v[64:67], v[100:103], a[216:223], v4
    s_waitcnt lgkmcnt(1)
    v_smfmac_f32_16x16x64_bf16 v[64:67], v[76:79], a[224:231], v4
    s_waitcnt lgkmcnt(0)
    v_smfmac_f32_16x16x64_bf16 v[64:67], v[68:71], a[232:239], v4
    v_smfmac_f32_16x16x64_bf16 v[56:59], v[80:83], a[0:7], v4
    v_smfmac_f32_16x16x64_bf16 v[60:63], v[80:83], a[80:87], v4
    v_smfmac_f32_16x16x64_bf16 v[56:59], v[84:87], a[16:23], v4
    s_nop 4
    v_mov_b32 v72, v64
    v_smfmac_f32_16x16x64_bf16 v[60:63], v[84:87], a[96:103], v4
    v_mov_b32 v73, v65
    v_mov_b32 v74, v66
    v_smfmac_f32_16x16x64_bf16 v[56:59], v[88:91], a[24:31], v4
    v_mov_b32 v75, v67
    v_smfmac_f32_16x16x64_bf16 v[60:63], v[88:91], a[104:111], v4
    v_permlane32_swap_b32 v64, v72
    v_permlane32_swap_b32 v65, v73
    v_smfmac_f32_16x16x64_bf16 v[56:59], v[92:95], a[32:39], v4
    v_permlane32_swap_b32 v66, v74
    v_permlane32_swap_b32 v67, v75
    v_smfmac_f32_16x16x64_bf16 v[60:63], v[92:95], a[112:119], v4
    v_add_f32 v64, v64, v72
    v_add_f32 v65, v65, v73
    v_smfmac_f32_16x16x64_bf16 v[56:59], v[96:99], a[48:55], v4
    v_add_f32 v66, v66, v74
    v_add_f32 v67, v67, v75
    v_smfmac_f32_16x16x64_bf16 v[60:63], v[96:99], a[128:135], v4
    v_cvt_pk_bf16_f32 v72, v64, v65
    v_cvt_pk_bf16_f32 v73, v66, v67
    v_smfmac_f32_16x16x64_bf16 v[56:59], v[100:103], a[56:63], v4
    ds_write_b64 v9, v[72:73] offset:512
    v_smfmac_f32_16x16x64_bf16 v[60:63], v[100:103], a[136:143], v4
    v_smfmac_f32_16x16x64_bf16 v[56:59], v[76:79], a[64:71], v4
    v_smfmac_f32_16x16x64_bf16 v[60:63], v[76:79], a[144:151], v4
    v_smfmac_f32_16x16x64_bf16 v[56:59], v[68:71], a[72:79], v4
    v_smfmac_f32_16x16x64_bf16 v[60:63], v[68:71], a[152:159], v4
    s_nop 7
    v_permlane32_swap_b32 v56, v60
    v_permlane32_swap_b32 v57, v61
    v_permlane32_swap_b32 v58, v62
    v_permlane32_swap_b32 v59, v63
    v_add_f32 v56, v56, v60
    v_add_f32 v57, v57, v61
    v_add_f32 v58, v58, v62
    v_add_f32 v59, v59, v63
    v_cvt_pk_bf16_f32 v68, v56, v57
    v_cvt_pk_bf16_f32 v69, v58, v59
    ds_write_b64 v10, v[68:69]
    s_waitcnt lgkmcnt(0)
    s_barrier
    ds_read_b64_tr_b16 v[68:69], v11 offset:0
    ds_read_b64_tr_b16 v[70:71], v11 offset:128
    ds_read_b64_tr_b16 v[72:73], v11 offset:1024
    ds_read_b64_tr_b16 v[74:75], v11 offset:1152
    ds_read_b64_tr_b16 v[76:77], v11 offset:2048
    ds_read_b64_tr_b16 v[78:79], v11 offset:2176
    ds_read_b128 v[80:83], v6 offset:0
    ds_read_b128 v[84:87], v6 offset:1024
    ds_read_b128 v[88:91], v6 offset:2048
    ds_read_b128 v[92:95], v6 offset:3072
    ds_read_b128 v[96:99], v6 offset:4096
    ds_read_b128 v[100:103], v6 offset:5120
    s_waitcnt lgkmcnt(10)
    v_smfmac_f32_16x16x64_bf16 v[16:19], v[68:71], a[240:247], v4
    v_smfmac_f32_16x16x64_bf16 v[20:23], v[68:71], v[112:119], v4
    v_smfmac_f32_16x16x64_bf16 v[24:27], v[68:71], v[136:143], v4
    v_smfmac_f32_16x16x64_bf16 v[28:31], v[68:71], v[160:167], v4
    s_waitcnt lgkmcnt(8)
    v_smfmac_f32_16x16x64_bf16 v[16:19], v[72:75], a[248:255], v4
    v_smfmac_f32_16x16x64_bf16 v[20:23], v[72:75], v[120:127], v4
    v_smfmac_f32_16x16x64_bf16 v[24:27], v[72:75], v[144:151], v4
    v_smfmac_f32_16x16x64_bf16 v[28:31], v[72:75], v[168:175], v4
    s_waitcnt lgkmcnt(6)
    v_smfmac_f32_16x16x64_bf16 v[16:19], v[76:79], v[104:111], v4
    v_smfmac_f32_16x16x64_bf16 v[20:23], v[76:79], v[128:135], v4
    v_smfmac_f32_16x16x64_bf16 v[24:27], v[76:79], v[152:159], v4
    v_smfmac_f32_16x16x64_bf16 v[28:31], v[76:79], v[176:183], v4
    v_smfmac_f32_16x16x64_bf16 v[32:35], v[68:71], v[184:191], v4
    v_smfmac_f32_16x16x64_bf16 v[36:39], v[68:71], v[208:215], v4
    s_nop 4
    v_permlane32_swap_b32 v16, v24
    v_permlane32_swap_b32 v17, v25
    v_smfmac_f32_16x16x64_bf16 v[40:43], v[68:71], v[232:239], v4
    v_permlane32_swap_b32 v18, v26
    v_permlane32_swap_b32 v19, v27
    s_waitcnt lgkmcnt(4)
    v_smfmac_f32_16x16x64_bf16 v[44:47], v[68:71], v[80:87], v4
    v_add_f32 v16, v16, v24
    v_add_f32 v17, v17, v25
    ds_read_b128 v[80:83], v6 offset:6144
    ds_read_b128 v[84:87], v6 offset:7168
    v_smfmac_f32_16x16x64_bf16 v[32:35], v[72:75], v[192:199], v4
    v_add_f32 v18, v18, v26
    v_add_f32 v19, v19, v27
    v_smfmac_f32_16x16x64_bf16 v[36:39], v[72:75], v[216:223], v4
    v_permlane32_swap_b32 v20, v28
    v_permlane32_swap_b32 v21, v29
    v_smfmac_f32_16x16x64_bf16 v[40:43], v[72:75], v[240:247], v4
    v_permlane32_swap_b32 v22, v30
    v_permlane32_swap_b32 v23, v31
    s_waitcnt lgkmcnt(4)
    v_smfmac_f32_16x16x64_bf16 v[44:47], v[72:75], v[88:95], v4
    v_add_f32 v20, v20, v28
    v_add_f32 v21, v21, v29
    ds_read_b128 v[88:91], v6 offset:8192
    ds_read_b128 v[92:95], v6 offset:9216
    v_smfmac_f32_16x16x64_bf16 v[32:35], v[76:79], v[200:207], v4
    v_add_f32 v22, v22, v30
    v_add_f32 v23, v23, v31
    v_smfmac_f32_16x16x64_bf16 v[36:39], v[76:79], v[224:231], v4
    v_cvt_pk_bf16_f32 v56, v16, v17
    v_cvt_pk_bf16_f32 v57, v18, v19
    v_smfmac_f32_16x16x64_bf16 v[40:43], v[76:79], v[248:255], v4
    v_cvt_pk_bf16_f32 v58, v20, v21
    v_cvt_pk_bf16_f32 v59, v22, v23
    s_waitcnt lgkmcnt(4)
    v_smfmac_f32_16x16x64_bf16 v[44:47], v[76:79], v[96:103], v4
    v_permlane16_swap_b32 v56, v58
    ds_read_b128 v[96:99], v6 offset:10240
    ds_read_b128 v[100:103], v6 offset:11264
    v_permlane16_swap_b32 v57, v59
    v_min_u32 v56, -2, v56
    v_min_u32 v57, -2, v57
    v_min_u32 v58, -2, v58
    v_min_u32 v59, -2, v59
    buffer_store_dwordx4 v[56:59], v14, s[8:11], s43 offen sc1
    s_add_u32 s49, s43, 32768
    s_waitcnt lgkmcnt(4)
    v_smfmac_f32_16x16x64_bf16 v[48:51], v[68:71], v[80:87], v4
    v_permlane32_swap_b32 v32, v40
    v_permlane32_swap_b32 v33, v41
    v_permlane32_swap_b32 v34, v42
    ds_read_b128 v[80:83], v6 offset:12288
    ds_read_b128 v[84:87], v6 offset:13312
    s_waitcnt lgkmcnt(4)
    v_smfmac_f32_16x16x64_bf16 v[48:51], v[72:75], v[88:95], v4
    v_permlane32_swap_b32 v35, v43
    v_add_f32 v32, v32, v40
    v_add_f32 v33, v33, v41
    v_add_f32 v34, v34, v42
    ds_read_b128 v[88:91], v6 offset:14336
    ds_read_b128 v[92:95], v6 offset:15360
    s_waitcnt lgkmcnt(4)
    v_smfmac_f32_16x16x64_bf16 v[48:51], v[76:79], v[96:103], v4
    v_add_f32 v35, v35, v43
    v_permlane32_swap_b32 v36, v44
    v_permlane32_swap_b32 v37, v45
    v_permlane32_swap_b32 v38, v46
    ds_read_b128 v[96:99], v6 offset:16384
    ds_read_b128 v[100:103], v6 offset:17408
    v_permlane32_swap_b32 v39, v47
    v_add_f32 v36, v36, v44
    v_add_f32 v37, v37, v45
    v_add_f32 v38, v38, v46
    s_waitcnt lgkmcnt(4)
    v_smfmac_f32_16x16x64_bf16 v[52:55], v[68:71], v[80:87], v4
    v_add_f32 v39, v39, v47
    v_cvt_pk_bf16_f32 v60, v32, v33
    v_cvt_pk_bf16_f32 v61, v34, v35
    s_waitcnt lgkmcnt(2)
    v_smfmac_f32_16x16x64_bf16 v[52:55], v[72:75], v[88:95], v4
    v_cvt_pk_bf16_f32 v62, v36, v37
    v_cvt_pk_bf16_f32 v63, v38, v39
    s_waitcnt lgkmcnt(0)
    v_smfmac_f32_16x16x64_bf16 v[52:55], v[76:79], v[96:103], v4
    v_permlane16_swap_b32 v60, v62
    v_permlane16_swap_b32 v61, v63
    v_min_u32 v60, -2, v60
    v_min_u32 v61, -2, v61
    v_min_u32 v62, -2, v62
    v_min_u32 v63, -2, v63
    buffer_store_dwordx4 v[60:63], v14, s[8:11], s49 offen sc1
    s_nop 0
    v_permlane32_swap_b32 v48, v52
    v_permlane32_swap_b32 v49, v53
    v_permlane32_swap_b32 v50, v54
    v_permlane32_swap_b32 v51, v55
    v_add_f32 v48, v48, v52
    v_add_f32 v49, v49, v53
    v_add_f32 v50, v50, v54
    v_add_f32 v51, v51, v55
    v_cvt_pk_bf16_f32 v64, v48, v49
    v_cvt_pk_bf16_f32 v65, v50, v51
    v_mov_b32 v66, v64
    v_mov_b32 v67, v65
    s_nop 0
    v_permlane16_swap_b32 v64, v66
    v_permlane16_swap_b32 v65, v67
    v_min_u32 v64, -2, v64
    v_min_u32 v65, -2, v65
    v_min_u32 v66, -2, v66
    v_min_u32 v67, -2, v67
    buffer_store_dwordx4 v[64:67], v15, s[8:11], s43 offen sc1
    s_add_u32 s40, s40, 1
    s_add_u32 s43, s43, 458752
    s_add_u32 s47, s47, 458752
    s_add_u32 s45, s45, 458752
    s_cmp_lt_u32 s40, 64
    s_cbranch_scc1 interleave_layers__linear_attn_block__memory_aug_recurrent_mem_tr__prompt_kernel_v_stepw1
    s_branch interleave_layers__linear_attn_block__memory_aug_recurrent_mem_tr__prompt_kernel_v_end
interleave_layers__linear_attn_block__memory_aug_recurrent_mem_tr__prompt_kernel_v_stepw2:
    v_mov_b32 v16, 0
    v_mov_b32 v17, 0
    v_mov_b32 v18, 0
    v_mov_b32 v19, 0
    v_mov_b32 v20, 0
    v_mov_b32 v21, 0
    v_mov_b32 v22, 0
    v_mov_b32 v23, 0
    v_mov_b32 v24, 0
    v_mov_b32 v25, 0
    v_mov_b32 v26, 0
    v_mov_b32 v27, 0
    v_mov_b32 v28, 0
    v_mov_b32 v29, 0
    v_mov_b32 v30, 0
    v_mov_b32 v31, 0
    v_mov_b32 v32, 0
    v_mov_b32 v33, 0
    v_mov_b32 v34, 0
    v_mov_b32 v35, 0
    v_mov_b32 v36, 0
    v_mov_b32 v37, 0
    v_mov_b32 v38, 0
    v_mov_b32 v39, 0
    v_mov_b32 v40, 0
    v_mov_b32 v41, 0
    v_mov_b32 v42, 0
    v_mov_b32 v43, 0
    v_mov_b32 v44, 0
    v_mov_b32 v45, 0
    v_mov_b32 v46, 0
    v_mov_b32 v47, 0
    v_mov_b32 v48, 0
    v_mov_b32 v49, 0
    v_mov_b32 v50, 0
    v_mov_b32 v51, 0
    v_mov_b32 v52, 0
    v_mov_b32 v53, 0
    v_mov_b32 v54, 0
    v_mov_b32 v55, 0
    v_mov_b32 v56, 0
    v_mov_b32 v57, 0
    v_mov_b32 v58, 0
    v_mov_b32 v59, 0
    v_mov_b32 v60, 0
    v_mov_b32 v61, 0
    v_mov_b32 v62, 0
    v_mov_b32 v63, 0
    v_mov_b32 v64, 0
    v_mov_b32 v65, 0
    v_mov_b32 v66, 0
    v_mov_b32 v67, 0
    s_add_u32 s48, s47, 4096
    s_lshl_b32 s95, s92, 6
    s_add_u32 s95, s95, s40
    s_add_u32 s95, s95, 1
    s_cmp_ge_i32 s59, s95
    s_cbranch_scc1 interleave_layers__linear_attn_block__memory_aug_recurrent_mem_tr__prompt_kernel_v_ecw2_ok
    s_and_b32 s24, s2, 7
    s_lshl_b32 s24, s24, 7
    s_add_u32 s24, s24, 23109632
    v_and_b32 v79, 3, v1
    v_lshl_add_u32 v79, v79, 2, s24
    s_mov_b32 s61, 0
interleave_layers__linear_attn_block__memory_aug_recurrent_mem_tr__prompt_kernel_v_ecw2:
    buffer_load_dword v78, v79, s[8:11], 0 offen sc1
    s_waitcnt vmcnt(0)
    v_readlane_b32 s59, v78, 0
    v_readlane_b32 s24, v78, 1
    s_min_i32 s59, s59, s24
    v_readlane_b32 s24, v78, 2
    s_min_i32 s59, s59, s24
    s_cmp_ge_i32 s59, s95
    s_cbranch_scc1 interleave_layers__linear_attn_block__memory_aug_recurrent_mem_tr__prompt_kernel_v_ecw2_ok
    s_add_u32 s61, s61, 1
    s_cmp_ge_u32 s61, s60
    s_cbranch_scc1 interleave_layers__linear_attn_block__memory_aug_recurrent_mem_tr__prompt_kernel_v_ecw2_to
    s_sleep 2
    s_branch interleave_layers__linear_attn_block__memory_aug_recurrent_mem_tr__prompt_kernel_v_ecw2
interleave_layers__linear_attn_block__memory_aug_recurrent_mem_tr__prompt_kernel_v_ecw2_to:
    s_mov_b32 s60, 1
interleave_layers__linear_attn_block__memory_aug_recurrent_mem_tr__prompt_kernel_v_ecw2_ok:
    s_sleep 20
    s_mov_b64 exec, 1
    s_mov_b32 s61, 0
    v_mov_b32 v81, 0
    buffer_atomic_add v81, v12, s[8:11], s45 offen sc0
    s_sleep 3
    v_mov_b32 v82, 0
    buffer_atomic_add v82, v12, s[8:11], s45 offen sc0
    s_sleep 3
    v_mov_b32 v83, 0
    buffer_atomic_add v83, v12, s[8:11], s45 offen sc0
    s_sleep 3
interleave_layers__linear_attn_block__memory_aug_recurrent_mem_tr__prompt_kernel_v_prw2:
    v_mov_b32 v80, 0
    buffer_atomic_add v80, v12, s[8:11], s45 offen sc0
    s_waitcnt vmcnt(3)
    v_cmp_le_i32 vcc, 8, v81
    s_add_u32 s61, s61, 1
    s_cbranch_vccnz interleave_layers__linear_attn_block__memory_aug_recurrent_mem_tr__prompt_kernel_v_prw2_out
    s_sleep 3
    v_mov_b32 v81, 0
    buffer_atomic_add v81, v12, s[8:11], s45 offen sc0
    s_waitcnt vmcnt(3)
    v_cmp_le_i32 vcc, 8, v82
    s_add_u32 s61, s61, 1
    s_cbranch_vccnz interleave_layers__linear_attn_block__memory_aug_recurrent_mem_tr__prompt_kernel_v_prw2_out
    s_sleep 3
    v_mov_b32 v82, 0
    buffer_atomic_add v82, v12, s[8:11], s45 offen sc0
    s_waitcnt vmcnt(3)
    v_cmp_le_i32 vcc, 8, v83
    s_add_u32 s61, s61, 1
    s_cbranch_vccnz interleave_layers__linear_attn_block__memory_aug_recurrent_mem_tr__prompt_kernel_v_prw2_out
    s_sleep 3
    v_mov_b32 v83, 0
    buffer_atomic_add v83, v12, s[8:11], s45 offen sc0
    s_waitcnt vmcnt(3)
    v_cmp_le_i32 vcc, 8, v80
    s_add_u32 s61, s61, 1
    s_cbranch_vccnz interleave_layers__linear_attn_block__memory_aug_recurrent_mem_tr__prompt_kernel_v_prw2_out
    s_sleep 3
    s_cmp_ge_u32 s61, s60
    s_cbranch_scc0 interleave_layers__linear_attn_block__memory_aug_recurrent_mem_tr__prompt_kernel_v_prw2
    s_mov_b32 s60, 1
interleave_layers__linear_attn_block__memory_aug_recurrent_mem_tr__prompt_kernel_v_prw2_out:
    s_mov_b64 exec, -1
    buffer_load_dwordx4 v[68:71], v7, s[8:11], s47 offen sc1
    buffer_load_dwordx4 v[72:75], v7, s[8:11], s48 offen sc1
    buffer_load_dwordx2 v[76:77], v8, s[8:11], s47 offen sc1
    s_waitcnt vmcnt(0)
    v_max3_u32 v103, v68, v69, v70
    v_max3_u32 v103, v103, v71, v72
    v_max3_u32 v103, v103, v73, v74
    v_max3_u32 v103, v103, v75, v76
    v_max_u32 v103, v103, v77
    v_cmp_eq_u32 vcc, -1, v103
    s_cbranch_vccz interleave_layers__linear_attn_block__memory_aug_recurrent_mem_tr__prompt_kernel_v_pmw2_out
    s_mov_b32 s61, 0
interleave_layers__linear_attn_block__memory_aug_recurrent_mem_tr__prompt_kernel_v_pmw2:
    buffer_load_dwordx4 v[68:71], v7, s[8:11], s47 offen sc1
    buffer_load_dwordx4 v[72:75], v7, s[8:11], s48 offen sc1
    buffer_load_dwordx2 v[76:77], v8, s[8:11], s47 offen sc1
    s_waitcnt vmcnt(0)
    v_max3_u32 v103, v68, v69, v70
    v_max3_u32 v103, v103, v71, v72
    v_max3_u32 v103, v103, v73, v74
    v_max3_u32 v103, v103, v75, v76
    v_max_u32 v103, v103, v77
    v_cmp_eq_u32 vcc, -1, v103
    s_add_u32 s61, s61, 1
    s_cbranch_vccz interleave_layers__linear_attn_block__memory_aug_recurrent_mem_tr__prompt_kernel_v_pmw2_out
    s_cmp_ge_u32 s61, s60
    s_cbranch_scc1 interleave_layers__linear_attn_block__memory_aug_recurrent_mem_tr__prompt_kernel_v_pmw2_to
    s_sleep 1
    s_branch interleave_layers__linear_attn_block__memory_aug_recurrent_mem_tr__prompt_kernel_v_pmw2
interleave_layers__linear_attn_block__memory_aug_recurrent_mem_tr__prompt_kernel_v_pmw2_to:
    s_mov_b32 s60, 1
interleave_layers__linear_attn_block__memory_aug_recurrent_mem_tr__prompt_kernel_v_pmw2_out:
    ds_write_b128 v7, v[68:71]
    ds_write_b128 v7, v[72:75] offset:4096
    ds_write_b64 v8, v[76:77]
interleave_layers__linear_attn_block__memory_aug_recurrent_mem_tr__prompt_kernel_v_gow2:
    v_smfmac_f32_16x16x64_bf16 v[56:59], v[68:71], a[16:23], v4
    v_smfmac_f32_16x16x64_bf16 v[60:63], v[68:71], a[96:103], v4
    v_smfmac_f32_16x16x64_bf16 v[64:67], v[68:71], a[176:183], v4
    s_waitcnt lgkmcnt(0)
    s_barrier
    ds_read_b128 v[80:83], v5 offset:0
    ds_read_b128 v[84:87], v5 offset:1024
    ds_read_b128 v[88:91], v5 offset:3072
    ds_read_b128 v[92:95], v5 offset:4096
    ds_read_b128 v[96:99], v5 offset:5120
    ds_read_b128 v[100:103], v5 offset:7168
    ds_read_b128 v[76:79], v5 offset:8192
    ds_read_b128 v[68:71], v5 offset:9216
    v_smfmac_f32_16x16x64_bf16 v[64:67], v[72:75], a[208:215], v4
    v_smfmac_f32_16x16x64_bf16 v[56:59], v[72:75], a[48:55], v4
    v_smfmac_f32_16x16x64_bf16 v[60:63], v[72:75], a[128:135], v4
    s_waitcnt lgkmcnt(7)
    v_smfmac_f32_16x16x64_bf16 v[64:67], v[80:83], a[160:167], v4
    s_waitcnt lgkmcnt(6)
    v_smfmac_f32_16x16x64_bf16 v[64:67], v[84:87], a[168:175], v4
    s_waitcnt lgkmcnt(5)
    v_smfmac_f32_16x16x64_bf16 v[64:67], v[88:91], a[184:191], v4
    s_waitcnt lgkmcnt(4)
    v_smfmac_f32_16x16x64_bf16 v[64:67], v[92:95], a[192:199], v4
    s_waitcnt lgkmcnt(3)
    v_smfmac_f32_16x16x64_bf16 v[64:67], v[96:99], a[200:207], v4
    s_waitcnt lgkmcnt(2)
    v_smfmac_f32_16x16x64_bf16 v[64:67], v[100:103], a[216:223], v4
    s_waitcnt lgkmcnt(1)
    v_smfmac_f32_16x16x64_bf16 v[64:67], v[76:79], a[224:231], v4
    s_waitcnt lgkmcnt(0)
    v_smfmac_f32_16x16x64_bf16 v[64:67], v[68:71], a[232:239], v4
    v_smfmac_f32_16x16x64_bf16 v[56:59], v[80:83], a[0:7], v4
    v_smfmac_f32_16x16x64_bf16 v[60:63], v[80:83], a[80:87], v4
    v_smfmac_f32_16x16x64_bf16 v[56:59], v[84:87], a[8:15], v4
    s_nop 4
    v_mov_b32 v72, v64
    v_smfmac_f32_16x16x64_bf16 v[60:63], v[84:87], a[88:95], v4
    v_mov_b32 v73, v65
    v_mov_b32 v74, v66
    v_smfmac_f32_16x16x64_bf16 v[56:59], v[88:91], a[24:31], v4
    v_mov_b32 v75, v67
    v_smfmac_f32_16x16x64_bf16 v[60:63], v[88:91], a[104:111], v4
    v_permlane32_swap_b32 v64, v72
    v_permlane32_swap_b32 v65, v73
    v_smfmac_f32_16x16x64_bf16 v[56:59], v[92:95], a[32:39], v4
    v_permlane32_swap_b32 v66, v74
    v_permlane32_swap_b32 v67, v75
    v_smfmac_f32_16x16x64_bf16 v[60:63], v[92:95], a[112:119], v4
    v_add_f32 v64, v64, v72
    v_add_f32 v65, v65, v73
    v_smfmac_f32_16x16x64_bf16 v[56:59], v[96:99], a[40:47], v4
    v_add_f32 v66, v66, v74
    v_add_f32 v67, v67, v75
    v_smfmac_f32_16x16x64_bf16 v[60:63], v[96:99], a[120:127], v4
    v_cvt_pk_bf16_f32 v72, v64, v65
    v_cvt_pk_bf16_f32 v73, v66, v67
    v_smfmac_f32_16x16x64_bf16 v[56:59], v[100:103], a[56:63], v4
    ds_write_b64 v9, v[72:73] offset:512
    v_smfmac_f32_16x16x64_bf16 v[60:63], v[100:103], a[136:143], v4
    v_smfmac_f32_16x16x64_bf16 v[56:59], v[76:79], a[64:71], v4
    v_smfmac_f32_16x16x64_bf16 v[60:63], v[76:79], a[144:151], v4
    v_smfmac_f32_16x16x64_bf16 v[56:59], v[68:71], a[72:79], v4
    v_smfmac_f32_16x16x64_bf16 v[60:63], v[68:71], a[152:159], v4
    s_nop 7
    v_permlane32_swap_b32 v56, v60
    v_permlane32_swap_b32 v57, v61
    v_permlane32_swap_b32 v58, v62
    v_permlane32_swap_b32 v59, v63
    v_add_f32 v56, v56, v60
    v_add_f32 v57, v57, v61
    v_add_f32 v58, v58, v62
    v_add_f32 v59, v59, v63
    v_cvt_pk_bf16_f32 v68, v56, v57
    v_cvt_pk_bf16_f32 v69, v58, v59
    ds_write_b64 v10, v[68:69]
    s_waitcnt lgkmcnt(0)
    s_barrier
    ds_read_b64_tr_b16 v[68:69], v11 offset:0
    ds_read_b64_tr_b16 v[70:71], v11 offset:128
    ds_read_b64_tr_b16 v[72:73], v11 offset:1024
    ds_read_b64_tr_b16 v[74:75], v11 offset:1152
    ds_read_b64_tr_b16 v[76:77], v11 offset:2048
    ds_read_b64_tr_b16 v[78:79], v11 offset:2176
    ds_read_b128 v[80:83], v6 offset:0
    ds_read_b128 v[84:87], v6 offset:1024
    ds_read_b128 v[88:91], v6 offset:2048
    ds_read_b128 v[92:95], v6 offset:3072
    ds_read_b128 v[96:99], v6 offset:4096
    ds_read_b128 v[100:103], v6 offset:5120
    s_waitcnt lgkmcnt(10)
    v_smfmac_f32_16x16x64_bf16 v[16:19], v[68:71], a[240:247], v4
    v_smfmac_f32_16x16x64_bf16 v[20:23], v[68:71], v[112:119], v4
    v_smfmac_f32_16x16x64_bf16 v[24:27], v[68:71], v[136:143], v4
    v_smfmac_f32_16x16x64_bf16 v[28:31], v[68:71], v[160:167], v4
    s_waitcnt lgkmcnt(8)
    v_smfmac_f32_16x16x64_bf16 v[16:19], v[72:75], a[248:255], v4
    v_smfmac_f32_16x16x64_bf16 v[20:23], v[72:75], v[120:127], v4
    v_smfmac_f32_16x16x64_bf16 v[24:27], v[72:75], v[144:151], v4
    v_smfmac_f32_16x16x64_bf16 v[28:31], v[72:75], v[168:175], v4
    s_waitcnt lgkmcnt(6)
    v_smfmac_f32_16x16x64_bf16 v[16:19], v[76:79], v[104:111], v4
    v_smfmac_f32_16x16x64_bf16 v[20:23], v[76:79], v[128:135], v4
    v_smfmac_f32_16x16x64_bf16 v[24:27], v[76:79], v[152:159], v4
    v_smfmac_f32_16x16x64_bf16 v[28:31], v[76:79], v[176:183], v4
    v_smfmac_f32_16x16x64_bf16 v[32:35], v[68:71], v[184:191], v4
    v_smfmac_f32_16x16x64_bf16 v[36:39], v[68:71], v[208:215], v4
    s_nop 4
    v_permlane32_swap_b32 v16, v24
    v_permlane32_swap_b32 v17, v25
    v_smfmac_f32_16x16x64_bf16 v[40:43], v[68:71], v[232:239], v4
    v_permlane32_swap_b32 v18, v26
    v_permlane32_swap_b32 v19, v27
    s_waitcnt lgkmcnt(4)
    v_smfmac_f32_16x16x64_bf16 v[44:47], v[68:71], v[80:87], v4
    v_add_f32 v16, v16, v24
    v_add_f32 v17, v17, v25
    ds_read_b128 v[80:83], v6 offset:6144
    ds_read_b128 v[84:87], v6 offset:7168
    v_smfmac_f32_16x16x64_bf16 v[32:35], v[72:75], v[192:199], v4
    v_add_f32 v18, v18, v26
    v_add_f32 v19, v19, v27
    v_smfmac_f32_16x16x64_bf16 v[36:39], v[72:75], v[216:223], v4
    v_permlane32_swap_b32 v20, v28
    v_permlane32_swap_b32 v21, v29
    v_smfmac_f32_16x16x64_bf16 v[40:43], v[72:75], v[240:247], v4
    v_permlane32_swap_b32 v22, v30
    v_permlane32_swap_b32 v23, v31
    s_waitcnt lgkmcnt(4)
    v_smfmac_f32_16x16x64_bf16 v[44:47], v[72:75], v[88:95], v4
    v_add_f32 v20, v20, v28
    v_add_f32 v21, v21, v29
    ds_read_b128 v[88:91], v6 offset:8192
    ds_read_b128 v[92:95], v6 offset:9216
    v_smfmac_f32_16x16x64_bf16 v[32:35], v[76:79], v[200:207], v4
    v_add_f32 v22, v22, v30
    v_add_f32 v23, v23, v31
    v_smfmac_f32_16x16x64_bf16 v[36:39], v[76:79], v[224:231], v4
    v_cvt_pk_bf16_f32 v56, v16, v17
    v_cvt_pk_bf16_f32 v57, v18, v19
    v_smfmac_f32_16x16x64_bf16 v[40:43], v[76:79], v[248:255], v4
    v_cvt_pk_bf16_f32 v58, v20, v21
    v_cvt_pk_bf16_f32 v59, v22, v23
    s_waitcnt lgkmcnt(4)
    v_smfmac_f32_16x16x64_bf16 v[44:47], v[76:79], v[96:103], v4
    v_permlane16_swap_b32 v56, v58
    ds_read_b128 v[96:99], v6 offset:10240
    ds_read_b128 v[100:103], v6 offset:11264
    v_permlane16_swap_b32 v57, v59
    v_min_u32 v56, -2, v56
    v_min_u32 v57, -2, v57
    v_min_u32 v58, -2, v58
    v_min_u32 v59, -2, v59
    buffer_store_dwordx4 v[56:59], v14, s[8:11], s43 offen sc1
    s_add_u32 s49, s43, 32768
    s_waitcnt lgkmcnt(4)
    v_smfmac_f32_16x16x64_bf16 v[48:51], v[68:71], v[80:87], v4
    v_permlane32_swap_b32 v32, v40
    v_permlane32_swap_b32 v33, v41
    v_permlane32_swap_b32 v34, v42
    ds_read_b128 v[80:83], v6 offset:12288
    ds_read_b128 v[84:87], v6 offset:13312
    s_waitcnt lgkmcnt(4)
    v_smfmac_f32_16x16x64_bf16 v[48:51], v[72:75], v[88:95], v4
    v_permlane32_swap_b32 v35, v43
    v_add_f32 v32, v32, v40
    v_add_f32 v33, v33, v41
    v_add_f32 v34, v34, v42
    ds_read_b128 v[88:91], v6 offset:14336
    ds_read_b128 v[92:95], v6 offset:15360
    s_waitcnt lgkmcnt(4)
    v_smfmac_f32_16x16x64_bf16 v[48:51], v[76:79], v[96:103], v4
    v_add_f32 v35, v35, v43
    v_permlane32_swap_b32 v36, v44
    v_permlane32_swap_b32 v37, v45
    v_permlane32_swap_b32 v38, v46
    ds_read_b128 v[96:99], v6 offset:16384
    ds_read_b128 v[100:103], v6 offset:17408
    v_permlane32_swap_b32 v39, v47
    v_add_f32 v36, v36, v44
    v_add_f32 v37, v37, v45
    v_add_f32 v38, v38, v46
    s_waitcnt lgkmcnt(4)
    v_smfmac_f32_16x16x64_bf16 v[52:55], v[68:71], v[80:87], v4
    v_add_f32 v39, v39, v47
    v_cvt_pk_bf16_f32 v60, v32, v33
    v_cvt_pk_bf16_f32 v61, v34, v35
    s_waitcnt lgkmcnt(2)
    v_smfmac_f32_16x16x64_bf16 v[52:55], v[72:75], v[88:95], v4
    v_cvt_pk_bf16_f32 v62, v36, v37
    v_cvt_pk_bf16_f32 v63, v38, v39
    s_waitcnt lgkmcnt(0)
    v_smfmac_f32_16x16x64_bf16 v[52:55], v[76:79], v[96:103], v4
    v_permlane16_swap_b32 v60, v62
    v_permlane16_swap_b32 v61, v63
    v_min_u32 v60, -2, v60
    v_min_u32 v61, -2, v61
    v_min_u32 v62, -2, v62
    v_min_u32 v63, -2, v63
    buffer_store_dwordx4 v[60:63], v14, s[8:11], s49 offen sc1
    s_nop 0
    v_permlane32_swap_b32 v48, v52
    v_permlane32_swap_b32 v49, v53
    v_permlane32_swap_b32 v50, v54
    v_permlane32_swap_b32 v51, v55
    v_add_f32 v48, v48, v52
    v_add_f32 v49, v49, v53
    v_add_f32 v50, v50, v54
    v_add_f32 v51, v51, v55
    v_cvt_pk_bf16_f32 v64, v48, v49
    v_cvt_pk_bf16_f32 v65, v50, v51
    v_mov_b32 v66, v64
    v_mov_b32 v67, v65
    s_nop 0
    v_permlane16_swap_b32 v64, v66
    v_permlane16_swap_b32 v65, v67
    v_min_u32 v64, -2, v64
    v_min_u32 v65, -2, v65
    v_min_u32 v66, -2, v66
    v_min_u32 v67, -2, v67
    buffer_store_dwordx4 v[64:67], v15, s[8:11], s43 offen sc1
    s_add_u32 s40, s40, 1
    s_add_u32 s43, s43, 458752
    s_add_u32 s47, s47, 458752
    s_add_u32 s45, s45, 458752
    s_cmp_lt_u32 s40, 64
    s_cbranch_scc1 interleave_layers__linear_attn_block__memory_aug_recurrent_mem_tr__prompt_kernel_v_stepw2
    s_branch interleave_layers__linear_attn_block__memory_aug_recurrent_mem_tr__prompt_kernel_v_end
interleave_layers__linear_attn_block__memory_aug_recurrent_mem_tr__prompt_kernel_v_stepw3:
    v_mov_b32 v16, 0
    v_mov_b32 v17, 0
    v_mov_b32 v18, 0
    v_mov_b32 v19, 0
    v_mov_b32 v20, 0
    v_mov_b32 v21, 0
    v_mov_b32 v22, 0
    v_mov_b32 v23, 0
    v_mov_b32 v24, 0
    v_mov_b32 v25, 0
    v_mov_b32 v26, 0
    v_mov_b32 v27, 0
    v_mov_b32 v28, 0
    v_mov_b32 v29, 0
    v_mov_b32 v30, 0
    v_mov_b32 v31, 0
    v_mov_b32 v32, 0
    v_mov_b32 v33, 0
    v_mov_b32 v34, 0
    v_mov_b32 v35, 0
    v_mov_b32 v36, 0
    v_mov_b32 v37, 0
    v_mov_b32 v38, 0
    v_mov_b32 v39, 0
    v_mov_b32 v40, 0
    v_mov_b32 v41, 0
    v_mov_b32 v42, 0
    v_mov_b32 v43, 0
    v_mov_b32 v44, 0
    v_mov_b32 v45, 0
    v_mov_b32 v46, 0
    v_mov_b32 v47, 0
    v_mov_b32 v48, 0
    v_mov_b32 v49, 0
    v_mov_b32 v50, 0
    v_mov_b32 v51, 0
    v_mov_b32 v52, 0
    v_mov_b32 v53, 0
    v_mov_b32 v54, 0
    v_mov_b32 v55, 0
    v_mov_b32 v56, 0
    v_mov_b32 v57, 0
    v_mov_b32 v58, 0
    v_mov_b32 v59, 0
    v_mov_b32 v60, 0
    v_mov_b32 v61, 0
    v_mov_b32 v62, 0
    v_mov_b32 v63, 0
    v_mov_b32 v64, 0
    v_mov_b32 v65, 0
    v_mov_b32 v66, 0
    v_mov_b32 v67, 0
    s_add_u32 s48, s47, 4096
    s_lshl_b32 s95, s92, 6
    s_add_u32 s95, s95, s40
    s_add_u32 s95, s95, 1
    s_cmp_ge_i32 s59, s95
    s_cbranch_scc1 interleave_layers__linear_attn_block__memory_aug_recurrent_mem_tr__prompt_kernel_v_ecw3_ok
    s_and_b32 s24, s2, 7
    s_lshl_b32 s24, s24, 7
    s_add_u32 s24, s24, 23109632
    v_and_b32 v79, 3, v1
    v_lshl_add_u32 v79, v79, 2, s24
    s_mov_b32 s61, 0
interleave_layers__linear_attn_block__memory_aug_recurrent_mem_tr__prompt_kernel_v_ecw3:
    buffer_load_dword v78, v79, s[8:11], 0 offen sc1
    s_waitcnt vmcnt(0)
    v_readlane_b32 s59, v78, 0
    v_readlane_b32 s24, v78, 1
    s_min_i32 s59, s59, s24
    v_readlane_b32 s24, v78, 2
    s_min_i32 s59, s59, s24
    s_cmp_ge_i32 s59, s95
    s_cbranch_scc1 interleave_layers__linear_attn_block__memory_aug_recurrent_mem_tr__prompt_kernel_v_ecw3_ok
    s_add_u32 s61, s61, 1
    s_cmp_ge_u32 s61, s60
    s_cbranch_scc1 interleave_layers__linear_attn_block__memory_aug_recurrent_mem_tr__prompt_kernel_v_ecw3_to
    s_sleep 2
    s_branch interleave_layers__linear_attn_block__memory_aug_recurrent_mem_tr__prompt_kernel_v_ecw3
interleave_layers__linear_attn_block__memory_aug_recurrent_mem_tr__prompt_kernel_v_ecw3_to:
    s_mov_b32 s60, 1
interleave_layers__linear_attn_block__memory_aug_recurrent_mem_tr__prompt_kernel_v_ecw3_ok:
    s_sleep 20
    s_mov_b64 exec, 1
    s_mov_b32 s61, 0
    v_mov_b32 v81, 0
    buffer_atomic_add v81, v12, s[8:11], s45 offen sc0
    s_sleep 3
    v_mov_b32 v82, 0
    buffer_atomic_add v82, v12, s[8:11], s45 offen sc0
    s_sleep 3
    v_mov_b32 v83, 0
    buffer_atomic_add v83, v12, s[8:11], s45 offen sc0
    s_sleep 3
interleave_layers__linear_attn_block__memory_aug_recurrent_mem_tr__prompt_kernel_v_prw3:
    v_mov_b32 v80, 0
    buffer_atomic_add v80, v12, s[8:11], s45 offen sc0
    s_waitcnt vmcnt(3)
    v_cmp_le_i32 vcc, 8, v81
    s_add_u32 s61, s61, 1
    s_cbranch_vccnz interleave_layers__linear_attn_block__memory_aug_recurrent_mem_tr__prompt_kernel_v_prw3_out
    s_sleep 3
    v_mov_b32 v81, 0
    buffer_atomic_add v81, v12, s[8:11], s45 offen sc0
    s_waitcnt vmcnt(3)
    v_cmp_le_i32 vcc, 8, v82
    s_add_u32 s61, s61, 1
    s_cbranch_vccnz interleave_layers__linear_attn_block__memory_aug_recurrent_mem_tr__prompt_kernel_v_prw3_out
    s_sleep 3
    v_mov_b32 v82, 0
    buffer_atomic_add v82, v12, s[8:11], s45 offen sc0
    s_waitcnt vmcnt(3)
    v_cmp_le_i32 vcc, 8, v83
    s_add_u32 s61, s61, 1
    s_cbranch_vccnz interleave_layers__linear_attn_block__memory_aug_recurrent_mem_tr__prompt_kernel_v_prw3_out
    s_sleep 3
    v_mov_b32 v83, 0
    buffer_atomic_add v83, v12, s[8:11], s45 offen sc0
    s_waitcnt vmcnt(3)
    v_cmp_le_i32 vcc, 8, v80
    s_add_u32 s61, s61, 1
    s_cbranch_vccnz interleave_layers__linear_attn_block__memory_aug_recurrent_mem_tr__prompt_kernel_v_prw3_out
    s_sleep 3
    s_cmp_ge_u32 s61, s60
    s_cbranch_scc0 interleave_layers__linear_attn_block__memory_aug_recurrent_mem_tr__prompt_kernel_v_prw3
    s_mov_b32 s60, 1
interleave_layers__linear_attn_block__memory_aug_recurrent_mem_tr__prompt_kernel_v_prw3_out:
    s_mov_b64 exec, -1
    buffer_load_dwordx4 v[68:71], v7, s[8:11], s47 offen sc1
    buffer_load_dwordx4 v[72:75], v7, s[8:11], s48 offen sc1
    buffer_load_dwordx2 v[76:77], v8, s[8:11], s47 offen sc1
    s_waitcnt vmcnt(0)
    v_max3_u32 v103, v68, v69, v70
    v_max3_u32 v103, v103, v71, v72
    v_max3_u32 v103, v103, v73, v74
    v_max3_u32 v103, v103, v75, v76
    v_max_u32 v103, v103, v77
    v_cmp_eq_u32 vcc, -1, v103
    s_cbranch_vccz interleave_layers__linear_attn_block__memory_aug_recurrent_mem_tr__prompt_kernel_v_pmw3_out
    s_mov_b32 s61, 0
interleave_layers__linear_attn_block__memory_aug_recurrent_mem_tr__prompt_kernel_v_pmw3:
    buffer_load_dwordx4 v[68:71], v7, s[8:11], s47 offen sc1
    buffer_load_dwordx4 v[72:75], v7, s[8:11], s48 offen sc1
    buffer_load_dwordx2 v[76:77], v8, s[8:11], s47 offen sc1
    s_waitcnt vmcnt(0)
    v_max3_u32 v103, v68, v69, v70
    v_max3_u32 v103, v103, v71, v72
    v_max3_u32 v103, v103, v73, v74
    v_max3_u32 v103, v103, v75, v76
    v_max_u32 v103, v103, v77
    v_cmp_eq_u32 vcc, -1, v103
    s_add_u32 s61, s61, 1
    s_cbranch_vccz interleave_layers__linear_attn_block__memory_aug_recurrent_mem_tr__prompt_kernel_v_pmw3_out
    s_cmp_ge_u32 s61, s60
    s_cbranch_scc1 interleave_layers__linear_attn_block__memory_aug_recurrent_mem_tr__prompt_kernel_v_pmw3_to
    s_sleep 1
    s_branch interleave_layers__linear_attn_block__memory_aug_recurrent_mem_tr__prompt_kernel_v_pmw3
interleave_layers__linear_attn_block__memory_aug_recurrent_mem_tr__prompt_kernel_v_pmw3_to:
    s_mov_b32 s60, 1
interleave_layers__linear_attn_block__memory_aug_recurrent_mem_tr__prompt_kernel_v_pmw3_out:
    ds_write_b128 v7, v[68:71]
    ds_write_b128 v7, v[72:75] offset:4096
    ds_write_b64 v8, v[76:77]
interleave_layers__linear_attn_block__memory_aug_recurrent_mem_tr__prompt_kernel_v_gow3:
    v_smfmac_f32_16x16x64_bf16 v[56:59], v[68:71], a[24:31], v4
    v_smfmac_f32_16x16x64_bf16 v[60:63], v[68:71], a[104:111], v4
    v_smfmac_f32_16x16x64_bf16 v[64:67], v[68:71], a[184:191], v4
    s_waitcnt lgkmcnt(0)
    s_barrier
    ds_read_b128 v[80:83], v5 offset:0
    ds_read_b128 v[84:87], v5 offset:1024
    ds_read_b128 v[88:91], v5 offset:2048
    ds_read_b128 v[92:95], v5 offset:4096
    ds_read_b128 v[96:99], v5 offset:5120
    ds_read_b128 v[100:103], v5 offset:6144
    ds_read_b128 v[76:79], v5 offset:8192
    ds_read_b128 v[68:71], v5 offset:9216
    v_smfmac_f32_16x16x64_bf16 v[64:67], v[72:75], a[216:223], v4
    v_smfmac_f32_16x16x64_bf16 v[56:59], v[72:75], a[56:63], v4
    v_smfmac_f32_16x16x64_bf16 v[60:63], v[72:75], a[136:143], v4
    s_waitcnt lgkmcnt(7)
    v_smfmac_f32_16x16x64_bf16 v[64:67], v[80:83], a[160:167], v4
    s_waitcnt lgkmcnt(6)
    v_smfmac_f32_16x16x64_bf16 v[64:67], v[84:87], a[168:175], v4
    s_waitcnt lgkmcnt(5)
    v_smfmac_f32_16x16x64_bf16 v[64:67], v[88:91], a[176:183], v4
    s_waitcnt lgkmcnt(4)
    v_smfmac_f32_16x16x64_bf16 v[64:67], v[92:95], a[192:199], v4
    s_waitcnt lgkmcnt(3)
    v_smfmac_f32_16x16x64_bf16 v[64:67], v[96:99], a[200:207], v4
    s_waitcnt lgkmcnt(2)
    v_smfmac_f32_16x16x64_bf16 v[64:67], v[100:103], a[208:215], v4
    s_waitcnt lgkmcnt(1)
    v_smfmac_f32_16x16x64_bf16 v[64:67], v[76:79], a[224:231], v4
    s_waitcnt lgkmcnt(0)
    v_smfmac_f32_16x16x64_bf16 v[64:67], v[68:71], a[232:239], v4
    v_smfmac_f32_16x16x64_bf16 v[56:59], v[80:83], a[0:7], v4
    v_smfmac_f32_16x16x64_bf16 v[60:63], v[80:83], a[80:87], v4
    v_smfmac_f32_16x16x64_bf16 v[56:59], v[84:87], a[8:15], v4
    s_nop 4
    v_mov_b32 v72, v64
    v_smfmac_f32_16x16x64_bf16 v[60:63], v[84:87], a[88:95], v4
    v_mov_b32 v73, v65
    v_mov_b32 v74, v66
    v_smfmac_f32_16x16x64_bf16 v[56:59], v[88:91], a[16:23], v4
    v_mov_b32 v75, v67
    v_smfmac_f32_16x16x64_bf16 v[60:63], v[88:91], a[96:103], v4
    v_permlane32_swap_b32 v64, v72
    v_permlane32_swap_b32 v65, v73
    v_smfmac_f32_16x16x64_bf16 v[56:59], v[92:95], a[32:39], v4
    v_permlane32_swap_b32 v66, v74
    v_permlane32_swap_b32 v67, v75
    v_smfmac_f32_16x16x64_bf16 v[60:63], v[92:95], a[112:119], v4
    v_add_f32 v64, v64, v72
    v_add_f32 v65, v65, v73
    v_smfmac_f32_16x16x64_bf16 v[56:59], v[96:99], a[40:47], v4
    v_add_f32 v66, v66, v74
    v_add_f32 v67, v67, v75
    v_smfmac_f32_16x16x64_bf16 v[60:63], v[96:99], a[120:127], v4
    v_cvt_pk_bf16_f32 v72, v64, v65
    v_cvt_pk_bf16_f32 v73, v66, v67
    v_smfmac_f32_16x16x64_bf16 v[56:59], v[100:103], a[48:55], v4
    ds_write_b64 v9, v[72:73] offset:512
    v_smfmac_f32_16x16x64_bf16 v[60:63], v[100:103], a[128:135], v4
    v_smfmac_f32_16x16x64_bf16 v[56:59], v[76:79], a[64:71], v4
    v_smfmac_f32_16x16x64_bf16 v[60:63], v[76:79], a[144:151], v4
    v_smfmac_f32_16x16x64_bf16 v[56:59], v[68:71], a[72:79], v4
    v_smfmac_f32_16x16x64_bf16 v[60:63], v[68:71], a[152:159], v4
    s_nop 7
    v_permlane32_swap_b32 v56, v60
    v_permlane32_swap_b32 v57, v61
    v_permlane32_swap_b32 v58, v62
    v_permlane32_swap_b32 v59, v63
    v_add_f32 v56, v56, v60
    v_add_f32 v57, v57, v61
    v_add_f32 v58, v58, v62
    v_add_f32 v59, v59, v63
    v_cvt_pk_bf16_f32 v68, v56, v57
    v_cvt_pk_bf16_f32 v69, v58, v59
    ds_write_b64 v10, v[68:69]
    s_waitcnt lgkmcnt(0)
    s_barrier
    ds_read_b64_tr_b16 v[68:69], v11 offset:0
    ds_read_b64_tr_b16 v[70:71], v11 offset:128
    ds_read_b64_tr_b16 v[72:73], v11 offset:1024
    ds_read_b64_tr_b16 v[74:75], v11 offset:1152
    ds_read_b64_tr_b16 v[76:77], v11 offset:2048
    ds_read_b64_tr_b16 v[78:79], v11 offset:2176
    ds_read_b128 v[80:83], v6 offset:0
    ds_read_b128 v[84:87], v6 offset:1024
    ds_read_b128 v[88:91], v6 offset:2048
    ds_read_b128 v[92:95], v6 offset:3072
    ds_read_b128 v[96:99], v6 offset:4096
    ds_read_b128 v[100:103], v6 offset:5120
    s_waitcnt lgkmcnt(10)
    v_smfmac_f32_16x16x64_bf16 v[16:19], v[68:71], a[240:247], v4
    v_smfmac_f32_16x16x64_bf16 v[20:23], v[68:71], v[112:119], v4
    v_smfmac_f32_16x16x64_bf16 v[24:27], v[68:71], v[136:143], v4
    v_smfmac_f32_16x16x64_bf16 v[28:31], v[68:71], v[160:167], v4
    s_waitcnt lgkmcnt(8)
    v_smfmac_f32_16x16x64_bf16 v[16:19], v[72:75], a[248:255], v4
    v_smfmac_f32_16x16x64_bf16 v[20:23], v[72:75], v[120:127], v4
    v_smfmac_f32_16x16x64_bf16 v[24:27], v[72:75], v[144:151], v4
    v_smfmac_f32_16x16x64_bf16 v[28:31], v[72:75], v[168:175], v4
    s_waitcnt lgkmcnt(6)
    v_smfmac_f32_16x16x64_bf16 v[16:19], v[76:79], v[104:111], v4
    v_smfmac_f32_16x16x64_bf16 v[20:23], v[76:79], v[128:135], v4
    v_smfmac_f32_16x16x64_bf16 v[24:27], v[76:79], v[152:159], v4
    v_smfmac_f32_16x16x64_bf16 v[28:31], v[76:79], v[176:183], v4
    v_smfmac_f32_16x16x64_bf16 v[32:35], v[68:71], v[184:191], v4
    v_smfmac_f32_16x16x64_bf16 v[36:39], v[68:71], v[208:215], v4
    s_nop 4
    v_permlane32_swap_b32 v16, v24
    v_permlane32_swap_b32 v17, v25
    v_smfmac_f32_16x16x64_bf16 v[40:43], v[68:71], v[232:239], v4
    v_permlane32_swap_b32 v18, v26
    v_permlane32_swap_b32 v19, v27
    s_waitcnt lgkmcnt(4)
    v_smfmac_f32_16x16x64_bf16 v[44:47], v[68:71], v[80:87], v4
    v_add_f32 v16, v16, v24
    v_add_f32 v17, v17, v25
    ds_read_b128 v[80:83], v6 offset:6144
    ds_read_b128 v[84:87], v6 offset:7168
    v_smfmac_f32_16x16x64_bf16 v[32:35], v[72:75], v[192:199], v4
    v_add_f32 v18, v18, v26
    v_add_f32 v19, v19, v27
    v_smfmac_f32_16x16x64_bf16 v[36:39], v[72:75], v[216:223], v4
    v_permlane32_swap_b32 v20, v28
    v_permlane32_swap_b32 v21, v29
    v_smfmac_f32_16x16x64_bf16 v[40:43], v[72:75], v[240:247], v4
    v_permlane32_swap_b32 v22, v30
    v_permlane32_swap_b32 v23, v31
    s_waitcnt lgkmcnt(4)
    v_smfmac_f32_16x16x64_bf16 v[44:47], v[72:75], v[88:95], v4
    v_add_f32 v20, v20, v28
    v_add_f32 v21, v21, v29
    ds_read_b128 v[88:91], v6 offset:8192
    ds_read_b128 v[92:95], v6 offset:9216
    v_smfmac_f32_16x16x64_bf16 v[32:35], v[76:79], v[200:207], v4
    v_add_f32 v22, v22, v30
    v_add_f32 v23, v23, v31
    v_smfmac_f32_16x16x64_bf16 v[36:39], v[76:79], v[224:231], v4
    v_cvt_pk_bf16_f32 v56, v16, v17
    v_cvt_pk_bf16_f32 v57, v18, v19
    v_smfmac_f32_16x16x64_bf16 v[40:43], v[76:79], v[248:255], v4
    v_cvt_pk_bf16_f32 v58, v20, v21
    v_cvt_pk_bf16_f32 v59, v22, v23
    s_waitcnt lgkmcnt(4)
    v_smfmac_f32_16x16x64_bf16 v[44:47], v[76:79], v[96:103], v4
    v_permlane16_swap_b32 v56, v58
    ds_read_b128 v[96:99], v6 offset:10240
    ds_read_b128 v[100:103], v6 offset:11264
    v_permlane16_swap_b32 v57, v59
    v_min_u32 v56, -2, v56
    v_min_u32 v57, -2, v57
    v_min_u32 v58, -2, v58
    v_min_u32 v59, -2, v59
    buffer_store_dwordx4 v[56:59], v14, s[8:11], s43 offen sc1
    s_add_u32 s49, s43, 32768
    s_waitcnt lgkmcnt(4)
    v_smfmac_f32_16x16x64_bf16 v[48:51], v[68:71], v[80:87], v4
    v_permlane32_swap_b32 v32, v40
    v_permlane32_swap_b32 v33, v41
    v_permlane32_swap_b32 v34, v42
    ds_read_b128 v[80:83], v6 offset:12288
    ds_read_b128 v[84:87], v6 offset:13312
    s_waitcnt lgkmcnt(4)
    v_smfmac_f32_16x16x64_bf16 v[48:51], v[72:75], v[88:95], v4
    v_permlane32_swap_b32 v35, v43
    v_add_f32 v32, v32, v40
    v_add_f32 v33, v33, v41
    v_add_f32 v34, v34, v42
    ds_read_b128 v[88:91], v6 offset:14336
    ds_read_b128 v[92:95], v6 offset:15360
    s_waitcnt lgkmcnt(4)
    v_smfmac_f32_16x16x64_bf16 v[48:51], v[76:79], v[96:103], v4
    v_add_f32 v35, v35, v43
    v_permlane32_swap_b32 v36, v44
    v_permlane32_swap_b32 v37, v45
    v_permlane32_swap_b32 v38, v46
    ds_read_b128 v[96:99], v6 offset:16384
    ds_read_b128 v[100:103], v6 offset:17408
    v_permlane32_swap_b32 v39, v47
    v_add_f32 v36, v36, v44
    v_add_f32 v37, v37, v45
    v_add_f32 v38, v38, v46
    s_waitcnt lgkmcnt(4)
    v_smfmac_f32_16x16x64_bf16 v[52:55], v[68:71], v[80:87], v4
    v_add_f32 v39, v39, v47
    v_cvt_pk_bf16_f32 v60, v32, v33
    v_cvt_pk_bf16_f32 v61, v34, v35
    s_waitcnt lgkmcnt(2)
    v_smfmac_f32_16x16x64_bf16 v[52:55], v[72:75], v[88:95], v4
    v_cvt_pk_bf16_f32 v62, v36, v37
    v_cvt_pk_bf16_f32 v63, v38, v39
    s_waitcnt lgkmcnt(0)
    v_smfmac_f32_16x16x64_bf16 v[52:55], v[76:79], v[96:103], v4
    v_permlane16_swap_b32 v60, v62
    v_permlane16_swap_b32 v61, v63
    v_min_u32 v60, -2, v60
    v_min_u32 v61, -2, v61
    v_min_u32 v62, -2, v62
    v_min_u32 v63, -2, v63
    buffer_store_dwordx4 v[60:63], v14, s[8:11], s49 offen sc1
    s_nop 0
    v_permlane32_swap_b32 v48, v52
    v_permlane32_swap_b32 v49, v53
    v_permlane32_swap_b32 v50, v54
    v_permlane32_swap_b32 v51, v55
    v_add_f32 v48, v48, v52
    v_add_f32 v49, v49, v53
    v_add_f32 v50, v50, v54
    v_add_f32 v51, v51, v55
    v_cvt_pk_bf16_f32 v64, v48, v49
    v_cvt_pk_bf16_f32 v65, v50, v51
    v_mov_b32 v66, v64
    v_mov_b32 v67, v65
    s_nop 0
    v_permlane16_swap_b32 v64, v66
    v_permlane16_swap_b32 v65, v67
    v_min_u32 v64, -2, v64
    v_min_u32 v65, -2, v65
    v_min_u32 v66, -2, v66
    v_min_u32 v67, -2, v67
    buffer_store_dwordx4 v[64:67], v15, s[8:11], s43 offen sc1
    s_add_u32 s40, s40, 1
    s_add_u32 s43, s43, 458752
    s_add_u32 s47, s47, 458752
    s_add_u32 s45, s45, 458752
    s_cmp_lt_u32 s40, 64
    s_cbranch_scc1 interleave_layers__linear_attn_block__memory_aug_recurrent_mem_tr__prompt_kernel_v_stepw3
interleave_layers__linear_attn_block__memory_aug_recurrent_mem_tr__prompt_kernel_v_end:
    s_cmp_eq_u32 s92, 0
    s_cbranch_scc0 interleave_layers__linear_attn_block__memory_aug_recurrent_mem_tr__prompt_kernel_end
    s_mov_b32 s92, 1
    s_branch interleave_layers__linear_attn_block__memory_aug_recurrent_mem_tr__prompt_kernel_v_layer
interleave_layers__linear_attn_block__memory_aug_recurrent_mem_tr__prompt_kernel_roleR:
interleave_layers__linear_attn_block__memory_aug_recurrent_mem_tr__prompt_kernel_r_top:
    s_barrier
    s_sub_u32 s24, s2, 64
    s_cmp_ge_u32 s24, 24
    s_cbranch_scc1 interleave_layers__linear_attn_block__memory_aug_recurrent_mem_tr__prompt_kernel_rk22
    s_and_b32 s44, s24, 7
    s_lshr_b32 s45, s24, 3
    s_cmp_eq_u32 s92, 0
    s_cselect_b32 s46, 32, 2
    v_lshlrev_b32 v5, 4, v1
    s_mov_b32 s64, 12288
    s_cmp_eq_u32 s45, 1
    s_cselect_b32 s64, 5120, s64
    s_cmp_eq_u32 s45, 2
    s_cselect_b32 s64, 17408, s64
    s_mov_b32 s65, 1024
    s_cmp_eq_u32 s45, 1
    s_cselect_b32 s65, 7168, s65
    s_cmp_eq_u32 s45, 2
    s_cselect_b32 s65, 13312, s65
    s_mov_b32 s66, 0
    s_cmp_eq_u32 s45, 1
    s_cselect_b32 s66, 6144, s66
    s_cmp_eq_u32 s45, 2
    s_cselect_b32 s66, 14336, s66
    s_mov_b32 s67, 2048
    s_cmp_eq_u32 s45, 1
    s_cselect_b32 s67, 8192, s67
    s_cmp_eq_u32 s45, 2
    s_cselect_b32 s67, 15360, s67
    s_mov_b32 s68, 4096
    s_cmp_eq_u32 s45, 1
    s_cselect_b32 s68, 10240, s68
    s_cmp_eq_u32 s45, 2
    s_cselect_b32 s68, 16384, s68
    s_mov_b32 s69, 3072
    s_cmp_eq_u32 s45, 1
    s_cselect_b32 s69, 9216, s69
    s_cmp_eq_u32 s45, 2
    s_cselect_b32 s69, 16384, s69
    s_mov_b32 s70, 3072
    s_cmp_eq_u32 s45, 1
    s_cselect_b32 s70, 11264, s70
    s_cmp_eq_u32 s45, 2
    s_cselect_b32 s70, 16384, s70
    v_mov_b32 v16, 0
    v_mov_b32 v17, 0
    v_mov_b32 v18, 0
    v_mov_b32 v19, 0
    v_mov_b32 v20, 0
    v_mov_b32 v21, 0
    v_mov_b32 v22, 0
    v_mov_b32 v23, 0
    v_mov_b32 v24, 0
    v_mov_b32 v25, 0
    v_mov_b32 v26, 0
    v_mov_b32 v27, 0
    v_mov_b32 v28, 0
    v_mov_b32 v29, 0
    v_mov_b32 v30, 0
    v_mov_b32 v31, 0
    v_mov_b32 v32, 0
    v_mov_b32 v33, 0
    v_mov_b32 v34, 0
    v_mov_b32 v35, 0
    v_mov_b32 v36, 0
    v_mov_b32 v37, 0
    v_mov_b32 v38, 0
    v_mov_b32 v39, 0
    v_mov_b32 v40, 0
    v_mov_b32 v41, 0
    v_mov_b32 v42, 0
    v_mov_b32 v43, 0
    s_lshl_b32 s24, s92, 3
    s_add_u32 s24, s24, s44
    s_lshl_b32 s24, s24, 7
    s_add_u32 s24, s24, 23101440
    v_lshlrev_b32 v15, 2, v1
    v_add_u32 v15, s24, v15
    s_cmp_eq_u32 s92, 0
    s_cselect_b32 s26, -1, 3
    s_mov_b32 s61, 0
interleave_layers__linear_attn_block__memory_aug_recurrent_mem_tr__prompt_kernel_k2_w:
    buffer_load_dword v14, v15, s[8:11], 0 offen sc1
    s_waitcnt vmcnt(0)
    v_cmp_le_i32 vcc, 1, v14
    s_and_b32 s24, vcc_lo, s26
    s_cmp_eq_u32 s24, s26
    s_cbranch_scc1 interleave_layers__linear_attn_block__memory_aug_recurrent_mem_tr__prompt_kernel_k2_w_ok
    s_add_u32 s61, s61, 1
    s_cmp_ge_u32 s61, s60
    s_cbranch_scc1 interleave_layers__linear_attn_block__memory_aug_recurrent_mem_tr__prompt_kernel_k2_w_to
    s_sleep 2
    s_branch interleave_layers__linear_attn_block__memory_aug_recurrent_mem_tr__prompt_kernel_k2_w
interleave_layers__linear_attn_block__memory_aug_recurrent_mem_tr__prompt_kernel_k2_w_to:
    s_mov_b32 s60, 1
interleave_layers__linear_attn_block__memory_aug_recurrent_mem_tr__prompt_kernel_k2_w_ok:
    s_mov_b32 s40, s3
interleave_layers__linear_attn_block__memory_aug_recurrent_mem_tr__prompt_kernel_k2_rd:
    s_add_u32 s25, s40, 0
    s_mul_i32 s24, s25, 147456
    s_mul_i32 s26, s44, 18432
    s_add_u32 s24, s24, s26
    s_add_u32 s24, s24, 16777216
    s_cmp_lt_u32 s25, s46
    s_cselect_b32 s24, s24, 2146435072
    s_add_u32 s26, s24, s64
    buffer_load_dwordx4 v[48:51], v5, s[8:11], s26 offen sc1
    s_add_u32 s26, s24, s65
    buffer_load_dwordx4 v[52:55], v5, s[8:11], s26 offen sc1
    s_add_u32 s26, s24, s66
    buffer_load_dwordx4 v[56:59], v5, s[8:11], s26 offen sc1
    s_add_u32 s26, s24, s67
    buffer_load_dwordx4 v[60:63], v5, s[8:11], s26 offen sc1
    s_add_u32 s26, s24, s68
    buffer_load_dwordx4 v[64:67], v5, s[8:11], s26 offen sc1
    s_add_u32 s26, s24, s69
    buffer_load_dwordx4 v[68:71], v5, s[8:11], s26 offen sc1
    s_add_u32 s26, s24, s70
    buffer_load_dwordx4 v[72:75], v5, s[8:11], s26 offen sc1
    s_add_u32 s25, s40, 4
    s_mul_i32 s24, s25, 147456
    s_mul_i32 s26, s44, 18432
    s_add_u32 s24, s24, s26
    s_add_u32 s24, s24, 16777216
    s_cmp_lt_u32 s25, s46
    s_cselect_b32 s24, s24, 2146435072
    s_add_u32 s26, s24, s64
    buffer_load_dwordx4 v[76:79], v5, s[8:11], s26 offen sc1
    s_add_u32 s26, s24, s65
    buffer_load_dwordx4 v[80:83], v5, s[8:11], s26 offen sc1
    s_add_u32 s26, s24, s66
    buffer_load_dwordx4 v[84:87], v5, s[8:11], s26 offen sc1
    s_add_u32 s26, s24, s67
    buffer_load_dwordx4 v[88:91], v5, s[8:11], s26 offen sc1
    s_add_u32 s26, s24, s68
    buffer_load_dwordx4 v[92:95], v5, s[8:11], s26 offen sc1
    s_add_u32 s26, s24, s69
    buffer_load_dwordx4 v[96:99], v5, s[8:11], s26 offen sc1
    s_add_u32 s26, s24, s70
    buffer_load_dwordx4 v[100:103], v5, s[8:11], s26 offen sc1
    s_add_u32 s25, s40, 8
    s_mul_i32 s24, s25, 147456
    s_mul_i32 s26, s44, 18432
    s_add_u32 s24, s24, s26
    s_add_u32 s24, s24, 16777216
    s_cmp_lt_u32 s25, s46
    s_cselect_b32 s24, s24, 2146435072
    s_add_u32 s26, s24, s64
    buffer_load_dwordx4 v[104:107], v5, s[8:11], s26 offen sc1
    s_add_u32 s26, s24, s65
    buffer_load_dwordx4 v[108:111], v5, s[8:11], s26 offen sc1
    s_add_u32 s26, s24, s66
    buffer_load_dwordx4 v[112:115], v5, s[8:11], s26 offen sc1
    s_add_u32 s26, s24, s67
    buffer_load_dwordx4 v[116:119], v5, s[8:11], s26 offen sc1
    s_add_u32 s26, s24, s68
    buffer_load_dwordx4 v[120:123], v5, s[8:11], s26 offen sc1
    s_add_u32 s26, s24, s69
    buffer_load_dwordx4 v[124:127], v5, s[8:11], s26 offen sc1
    s_add_u32 s26, s24, s70
    buffer_load_dwordx4 v[128:131], v5, s[8:11], s26 offen sc1
    s_add_u32 s25, s40, 12
    s_mul_i32 s24, s25, 147456
    s_mul_i32 s26, s44, 18432
    s_add_u32 s24, s24, s26
    s_add_u32 s24, s24, 16777216
    s_cmp_lt_u32 s25, s46
    s_cselect_b32 s24, s24, 2146435072
    s_add_u32 s26, s24, s64
    buffer_load_dwordx4 v[132:135], v5, s[8:11], s26 offen sc1
    s_add_u32 s26, s24, s65
    buffer_load_dwordx4 v[136:139], v5, s[8:11], s26 offen sc1
    s_add_u32 s26, s24, s66
    buffer_load_dwordx4 v[140:143], v5, s[8:11], s26 offen sc1
    s_add_u32 s26, s24, s67
    buffer_load_dwordx4 v[144:147], v5, s[8:11], s26 offen sc1
    s_add_u32 s26, s24, s68
    buffer_load_dwordx4 v[148:151], v5, s[8:11], s26 offen sc1
    s_add_u32 s26, s24, s69
    buffer_load_dwordx4 v[152:155], v5, s[8:11], s26 offen sc1
    s_add_u32 s26, s24, s70
    buffer_load_dwordx4 v[156:159], v5, s[8:11], s26 offen sc1
    s_add_u32 s40, s40, 16
    s_cmp_lt_u32 s40, s46
    s_cbranch_scc0 interleave_layers__linear_attn_block__memory_aug_recurrent_mem_tr__prompt_kernel_k2m23
    s_waitcnt vmcnt(21)
    v_pk_add_f32 v[16:17], v[16:17], v[48:49]
    v_pk_add_f32 v[18:19], v[18:19], v[50:51]
    v_pk_add_f32 v[20:21], v[20:21], v[52:53]
    v_pk_add_f32 v[22:23], v[22:23], v[54:55]
    v_pk_add_f32 v[24:25], v[24:25], v[56:57]
    v_pk_add_f32 v[26:27], v[26:27], v[58:59]
    v_pk_add_f32 v[28:29], v[28:29], v[60:61]
    v_pk_add_f32 v[30:31], v[30:31], v[62:63]
    v_pk_add_f32 v[32:33], v[32:33], v[64:65]
    v_pk_add_f32 v[34:35], v[34:35], v[66:67]
    v_pk_add_f32 v[36:37], v[36:37], v[68:69]
    v_pk_add_f32 v[38:39], v[38:39], v[70:71]
    v_pk_add_f32 v[40:41], v[40:41], v[72:73]
    v_pk_add_f32 v[42:43], v[42:43], v[74:75]
    s_waitcnt vmcnt(14)
    v_pk_add_f32 v[16:17], v[16:17], v[76:77]
    v_pk_add_f32 v[18:19], v[18:19], v[78:79]
    v_pk_add_f32 v[20:21], v[20:21], v[80:81]
    v_pk_add_f32 v[22:23], v[22:23], v[82:83]
    v_pk_add_f32 v[24:25], v[24:25], v[84:85]
    v_pk_add_f32 v[26:27], v[26:27], v[86:87]
    v_pk_add_f32 v[28:29], v[28:29], v[88:89]
    v_pk_add_f32 v[30:31], v[30:31], v[90:91]
    v_pk_add_f32 v[32:33], v[32:33], v[92:93]
    v_pk_add_f32 v[34:35], v[34:35], v[94:95]
    v_pk_add_f32 v[36:37], v[36:37], v[96:97]
    v_pk_add_f32 v[38:39], v[38:39], v[98:99]
    v_pk_add_f32 v[40:41], v[40:41], v[100:101]
    v_pk_add_f32 v[42:43], v[42:43], v[102:103]
    s_waitcnt vmcnt(7)
    v_pk_add_f32 v[16:17], v[16:17], v[104:105]
    v_pk_add_f32 v[18:19], v[18:19], v[106:107]
    v_pk_add_f32 v[20:21], v[20:21], v[108:109]
    v_pk_add_f32 v[22:23], v[22:23], v[110:111]
    v_pk_add_f32 v[24:25], v[24:25], v[112:113]
    v_pk_add_f32 v[26:27], v[26:27], v[114:115]
    v_pk_add_f32 v[28:29], v[28:29], v[116:117]
    v_pk_add_f32 v[30:31], v[30:31], v[118:119]
    v_pk_add_f32 v[32:33], v[32:33], v[120:121]
    v_pk_add_f32 v[34:35], v[34:35], v[122:123]
    v_pk_add_f32 v[36:37], v[36:37], v[124:125]
    v_pk_add_f32 v[38:39], v[38:39], v[126:127]
    v_pk_add_f32 v[40:41], v[40:41], v[128:129]
    v_pk_add_f32 v[42:43], v[42:43], v[130:131]
    s_waitcnt vmcnt(0)
    v_pk_add_f32 v[16:17], v[16:17], v[132:133]
    v_pk_add_f32 v[18:19], v[18:19], v[134:135]
    v_pk_add_f32 v[20:21], v[20:21], v[136:137]
    v_pk_add_f32 v[22:23], v[22:23], v[138:139]
    v_pk_add_f32 v[24:25], v[24:25], v[140:141]
    v_pk_add_f32 v[26:27], v[26:27], v[142:143]
    v_pk_add_f32 v[28:29], v[28:29], v[144:145]
    v_pk_add_f32 v[30:31], v[30:31], v[146:147]
    v_pk_add_f32 v[32:33], v[32:33], v[148:149]
    v_pk_add_f32 v[34:35], v[34:35], v[150:151]
    v_pk_add_f32 v[36:37], v[36:37], v[152:153]
    v_pk_add_f32 v[38:39], v[38:39], v[154:155]
    v_pk_add_f32 v[40:41], v[40:41], v[156:157]
    v_pk_add_f32 v[42:43], v[42:43], v[158:159]
    s_branch interleave_layers__linear_attn_block__memory_aug_recurrent_mem_tr__prompt_kernel_k2_rd
interleave_layers__linear_attn_block__memory_aug_recurrent_mem_tr__prompt_kernel_k2m23:
    s_waitcnt vmcnt(21)
    v_pk_add_f32 v[16:17], v[16:17], v[48:49]
    v_pk_add_f32 v[18:19], v[18:19], v[50:51]
    v_pk_add_f32 v[20:21], v[20:21], v[52:53]
    v_pk_add_f32 v[22:23], v[22:23], v[54:55]
    v_pk_add_f32 v[24:25], v[24:25], v[56:57]
    v_pk_add_f32 v[26:27], v[26:27], v[58:59]
    v_pk_add_f32 v[28:29], v[28:29], v[60:61]
    v_pk_add_f32 v[30:31], v[30:31], v[62:63]
    v_pk_add_f32 v[32:33], v[32:33], v[64:65]
    v_pk_add_f32 v[34:35], v[34:35], v[66:67]
    v_pk_add_f32 v[36:37], v[36:37], v[68:69]
    v_pk_add_f32 v[38:39], v[38:39], v[70:71]
    v_pk_add_f32 v[40:41], v[40:41], v[72:73]
    v_pk_add_f32 v[42:43], v[42:43], v[74:75]
    s_waitcnt vmcnt(14)
    v_pk_add_f32 v[16:17], v[16:17], v[76:77]
    v_pk_add_f32 v[18:19], v[18:19], v[78:79]
    v_pk_add_f32 v[20:21], v[20:21], v[80:81]
    v_pk_add_f32 v[22:23], v[22:23], v[82:83]
    v_pk_add_f32 v[24:25], v[24:25], v[84:85]
    v_pk_add_f32 v[26:27], v[26:27], v[86:87]
    v_pk_add_f32 v[28:29], v[28:29], v[88:89]
    v_pk_add_f32 v[30:31], v[30:31], v[90:91]
    v_pk_add_f32 v[32:33], v[32:33], v[92:93]
    v_pk_add_f32 v[34:35], v[34:35], v[94:95]
    v_pk_add_f32 v[36:37], v[36:37], v[96:97]
    v_pk_add_f32 v[38:39], v[38:39], v[98:99]
    v_pk_add_f32 v[40:41], v[40:41], v[100:101]
    v_pk_add_f32 v[42:43], v[42:43], v[102:103]
    s_waitcnt vmcnt(7)
    v_pk_add_f32 v[16:17], v[16:17], v[104:105]
    v_pk_add_f32 v[18:19], v[18:19], v[106:107]
    v_pk_add_f32 v[20:21], v[20:21], v[108:109]
    v_pk_add_f32 v[22:23], v[22:23], v[110:111]
    v_pk_add_f32 v[24:25], v[24:25], v[112:113]
    v_pk_add_f32 v[26:27], v[26:27], v[114:115]
    v_pk_add_f32 v[28:29], v[28:29], v[116:117]
    v_pk_add_f32 v[30:31], v[30:31], v[118:119]
    v_pk_add_f32 v[32:33], v[32:33], v[120:121]
    v_pk_add_f32 v[34:35], v[34:35], v[122:123]
    v_pk_add_f32 v[36:37], v[36:37], v[124:125]
    v_pk_add_f32 v[38:39], v[38:39], v[126:127]
    v_pk_add_f32 v[40:41], v[40:41], v[128:129]
    v_pk_add_f32 v[42:43], v[42:43], v[130:131]
    s_waitcnt vmcnt(0)
    v_pk_add_f32 v[16:17], v[16:17], v[132:133]
    v_pk_add_f32 v[18:19], v[18:19], v[134:135]
    v_pk_add_f32 v[20:21], v[20:21], v[136:137]
    v_pk_add_f32 v[22:23], v[22:23], v[138:139]
    v_pk_add_f32 v[24:25], v[24:25], v[140:141]
    v_pk_add_f32 v[26:27], v[26:27], v[142:143]
    v_pk_add_f32 v[28:29], v[28:29], v[144:145]
    v_pk_add_f32 v[30:31], v[30:31], v[146:147]
    v_pk_add_f32 v[32:33], v[32:33], v[148:149]
    v_pk_add_f32 v[34:35], v[34:35], v[150:151]
    v_pk_add_f32 v[36:37], v[36:37], v[152:153]
    v_pk_add_f32 v[38:39], v[38:39], v[154:155]
    v_pk_add_f32 v[40:41], v[40:41], v[156:157]
    v_pk_add_f32 v[42:43], v[42:43], v[158:159]
    s_mul_i32 s24, s3, 7168
    v_add_u32 v6, s24, v5
    ds_write_b128 v6, v[16:19] offset:0
    ds_write_b128 v6, v[20:23] offset:1024
    ds_write_b128 v6, v[24:27] offset:2048
    ds_write_b128 v6, v[28:31] offset:3072
    ds_write_b128 v6, v[32:35] offset:4096
    ds_write_b128 v6, v[36:39] offset:5120
    ds_write_b128 v6, v[40:43] offset:6144
    s_waitcnt lgkmcnt(0)
    s_barrier
    s_mov_b32 s41, 0
    s_cmp_eq_u32 s45, 1
    s_cselect_b32 s41, 4, s41
    s_cmp_eq_u32 s45, 2
    s_cselect_b32 s41, 9, s41
    s_mov_b32 s42, 4
    s_cmp_eq_u32 s45, 1
    s_cselect_b32 s42, 5, s42
    s_cmp_eq_u32 s45, 2
    s_cselect_b32 s42, 5, s42
    s_mul_i32 s43, s92, 131072
    s_mul_i32 s24, s44, 14336
    s_add_u32 s43, s43, s24
    s_add_u32 s43, s43, 22020096
    v_and_b32 v7, 3, v2
    v_lshrrev_b32 v8, 2, v2
    s_add_u32 s40, s3, 0
    s_cmp_lt_u32 s40, s42
    s_cbranch_scc0 interleave_layers__linear_attn_block__memory_aug_recurrent_mem_tr__prompt_kernel_k2f24
    s_add_u32 s40, s40, s41
    s_mov_b32 s47, 67633672
    s_cmp_eq_u32 s40, 1
    s_cselect_b32 s47, 67699226, s47
    s_cmp_eq_u32 s40, 2
    s_cselect_b32 s47, 67702404, s47
    s_cmp_eq_u32 s40, 3
    s_cselect_b32 s47, 67765224, s47
    s_cmp_eq_u32 s40, 4
    s_cselect_b32 s47, 67765896, s47
    s_cmp_eq_u32 s40, 5
    s_cselect_b32 s47, 67831450, s47
    s_cmp_eq_u32 s40, 6
    s_cselect_b32 s47, 67833604, s47
    s_cmp_eq_u32 s40, 7
    s_cselect_b32 s47, 67897320, s47
    s_cmp_eq_u32 s40, 8
    s_cselect_b32 s47, 67899142, s47
    s_cmp_eq_u32 s40, 9
    s_cselect_b32 s47, 75497992, s47
    s_cmp_eq_u32 s40, 10
    s_cselect_b32 s47, 75499162, s47
    s_cmp_eq_u32 s40, 11
    s_cselect_b32 s47, 75501316, s47
    s_cmp_eq_u32 s40, 12
    s_cselect_b32 s47, 247768, s47
    s_cmp_eq_u32 s40, 13
    s_cselect_b32 s47, 249604, s47
    s_bfe_u32 s24, s47, 0x7000c
    s_bfe_u32 s25, s47, 0x50013
    s_bfe_u32 s26, s47, 0x30018
    v_mul_u32_u24 v9, s25, v7
    v_mul_u32_u24 v10, s26, v8
    v_add3_u32 v9, v9, v10, s24
    v_mul_u32_u24 v9, 205, v9
    v_lshrrev_b32 v9, 12, v9
    s_bfe_u32 s24, s47, 196608
    s_lshl_b32 s24, s24, 10
    v_add_u32 v10, s24, v5
    ds_read_b128 v[160:163], v10 offset:0
    ds_read_b128 v[164:167], v10 offset:7168
    ds_read_b128 v[168:171], v10 offset:14336
    ds_read_b128 v[172:175], v10 offset:21504
    s_bfe_u32 s25, s47, 196614
    s_lshl_b32 s25, s25, 4
    v_lshl_add_u32 v11, v3, 2, s25
    v_mul_u32_u24 v11, 205, v11
    v_lshrrev_b32 v11, 12, v11
    v_cmp_eq_u32 vcc, v9, v11
    s_waitcnt lgkmcnt(0)
    v_pk_add_f32 v[160:161], v[160:161], v[164:165]
    v_pk_add_f32 v[168:169], v[168:169], v[172:173]
    v_pk_add_f32 v[162:163], v[162:163], v[166:167]
    v_pk_add_f32 v[170:171], v[170:171], v[174:175]
    v_pk_add_f32 v[160:161], v[160:161], v[168:169]
    v_pk_add_f32 v[162:163], v[162:163], v[170:171]
    v_cvt_pk_bf16_f32 v176, v160, v161
    v_cvt_pk_bf16_f32 v177, v162, v163
    v_cndmask_b32 v176, 0, v176, vcc
    v_cndmask_b32 v177, 0, v177, vcc
    s_bfe_u32 s24, s47, 196611
    s_lshl_b32 s24, s24, 10
    v_add_u32 v10, s24, v5
    ds_read_b128 v[160:163], v10 offset:0
    ds_read_b128 v[164:167], v10 offset:7168
    ds_read_b128 v[168:171], v10 offset:14336
    ds_read_b128 v[172:175], v10 offset:21504
    s_bfe_u32 s25, s47, 196617
    s_lshl_b32 s25, s25, 4
    v_lshl_add_u32 v11, v3, 2, s25
    v_mul_u32_u24 v11, 205, v11
    v_lshrrev_b32 v11, 12, v11
    v_cmp_eq_u32 vcc, v9, v11
    s_waitcnt lgkmcnt(0)
    v_pk_add_f32 v[160:161], v[160:161], v[164:165]
    v_pk_add_f32 v[168:169], v[168:169], v[172:173]
    v_pk_add_f32 v[162:163], v[162:163], v[166:167]
    v_pk_add_f32 v[170:171], v[170:171], v[174:175]
    v_pk_add_f32 v[160:161], v[160:161], v[168:169]
    v_pk_add_f32 v[162:163], v[162:163], v[170:171]
    v_cvt_pk_bf16_f32 v178, v160, v161
    v_cvt_pk_bf16_f32 v179, v162, v163
    v_cndmask_b32 v178, 0, v178, vcc
    v_cndmask_b32 v179, 0, v179, vcc
    s_lshl_b32 s24, s40, 10
    s_add_u32 s24, s24, s43
    buffer_store_dwordx4 v[176:179], v5, s[8:11], s24 offen sc1
interleave_layers__linear_attn_block__memory_aug_recurrent_mem_tr__prompt_kernel_k2f24:
    s_add_u32 s40, s3, 4
    s_cmp_lt_u32 s40, s42
    s_cbranch_scc0 interleave_layers__linear_attn_block__memory_aug_recurrent_mem_tr__prompt_kernel_k2f25
    s_add_u32 s40, s40, s41
    s_mov_b32 s47, 67633672
    s_cmp_eq_u32 s40, 1
    s_cselect_b32 s47, 67699226, s47
    s_cmp_eq_u32 s40, 2
    s_cselect_b32 s47, 67702404, s47
    s_cmp_eq_u32 s40, 3
    s_cselect_b32 s47, 67765224, s47
    s_cmp_eq_u32 s40, 4
    s_cselect_b32 s47, 67765896, s47
    s_cmp_eq_u32 s40, 5
    s_cselect_b32 s47, 67831450, s47
    s_cmp_eq_u32 s40, 6
    s_cselect_b32 s47, 67833604, s47
    s_cmp_eq_u32 s40, 7
    s_cselect_b32 s47, 67897320, s47
    s_cmp_eq_u32 s40, 8
    s_cselect_b32 s47, 67899142, s47
    s_cmp_eq_u32 s40, 9
    s_cselect_b32 s47, 75497992, s47
    s_cmp_eq_u32 s40, 10
    s_cselect_b32 s47, 75499162, s47
    s_cmp_eq_u32 s40, 11
    s_cselect_b32 s47, 75501316, s47
    s_cmp_eq_u32 s40, 12
    s_cselect_b32 s47, 247768, s47
    s_cmp_eq_u32 s40, 13
    s_cselect_b32 s47, 249604, s47
    s_bfe_u32 s24, s47, 0x7000c
    s_bfe_u32 s25, s47, 0x50013
    s_bfe_u32 s26, s47, 0x30018
    v_mul_u32_u24 v9, s25, v7
    v_mul_u32_u24 v10, s26, v8
    v_add3_u32 v9, v9, v10, s24
    v_mul_u32_u24 v9, 205, v9
    v_lshrrev_b32 v9, 12, v9
    s_bfe_u32 s24, s47, 196608
    s_lshl_b32 s24, s24, 10
    v_add_u32 v10, s24, v5
    ds_read_b128 v[160:163], v10 offset:0
    ds_read_b128 v[164:167], v10 offset:7168
    ds_read_b128 v[168:171], v10 offset:14336
    ds_read_b128 v[172:175], v10 offset:21504
    s_bfe_u32 s25, s47, 196614
    s_lshl_b32 s25, s25, 4
    v_lshl_add_u32 v11, v3, 2, s25
    v_mul_u32_u24 v11, 205, v11
    v_lshrrev_b32 v11, 12, v11
    v_cmp_eq_u32 vcc, v9, v11
    s_waitcnt lgkmcnt(0)
    v_pk_add_f32 v[160:161], v[160:161], v[164:165]
    v_pk_add_f32 v[168:169], v[168:169], v[172:173]
    v_pk_add_f32 v[162:163], v[162:163], v[166:167]
    v_pk_add_f32 v[170:171], v[170:171], v[174:175]
    v_pk_add_f32 v[160:161], v[160:161], v[168:169]
    v_pk_add_f32 v[162:163], v[162:163], v[170:171]
    v_cvt_pk_bf16_f32 v176, v160, v161
    v_cvt_pk_bf16_f32 v177, v162, v163
    v_cndmask_b32 v176, 0, v176, vcc
    v_cndmask_b32 v177, 0, v177, vcc
    s_bfe_u32 s24, s47, 196611
    s_lshl_b32 s24, s24, 10
    v_add_u32 v10, s24, v5
    ds_read_b128 v[160:163], v10 offset:0
    ds_read_b128 v[164:167], v10 offset:7168
    ds_read_b128 v[168:171], v10 offset:14336
    ds_read_b128 v[172:175], v10 offset:21504
    s_bfe_u32 s25, s47, 196617
    s_lshl_b32 s25, s25, 4
    v_lshl_add_u32 v11, v3, 2, s25
    v_mul_u32_u24 v11, 205, v11
    v_lshrrev_b32 v11, 12, v11
    v_cmp_eq_u32 vcc, v9, v11
    s_waitcnt lgkmcnt(0)
    v_pk_add_f32 v[160:161], v[160:161], v[164:165]
    v_pk_add_f32 v[168:169], v[168:169], v[172:173]
    v_pk_add_f32 v[162:163], v[162:163], v[166:167]
    v_pk_add_f32 v[170:171], v[170:171], v[174:175]
    v_pk_add_f32 v[160:161], v[160:161], v[168:169]
    v_pk_add_f32 v[162:163], v[162:163], v[170:171]
    v_cvt_pk_bf16_f32 v178, v160, v161
    v_cvt_pk_bf16_f32 v179, v162, v163
    v_cndmask_b32 v178, 0, v178, vcc
    v_cndmask_b32 v179, 0, v179, vcc
    s_lshl_b32 s24, s40, 10
    s_add_u32 s24, s24, s43
    buffer_store_dwordx4 v[176:179], v5, s[8:11], s24 offen sc1
interleave_layers__linear_attn_block__memory_aug_recurrent_mem_tr__prompt_kernel_k2f25:
    s_waitcnt vmcnt(0)
    s_barrier
    s_lshl_b32 s24, s92, 7
    s_sub_u32 s25, s2, 64
    s_lshl_b32 s25, s25, 2
    s_add_u32 s24, s24, s25
    s_add_u32 s24, s24, 23103488
    s_cmp_eq_u32 s3, 0
    s_cbranch_scc0 interleave_layers__linear_attn_block__memory_aug_recurrent_mem_tr__prompt_kernel_pb26
    v_lshlrev_b32 v14, 7, v1
    v_add_u32 v14, s24, v14
    v_mov_b32 v15, 2146435072
    v_cmp_le_u32 vcc, 1, v1
    s_nop 1
    v_cndmask_b32 v14, v14, v15, vcc
    v_mov_b32 v15, 1
    buffer_store_dword v15, v14, s[8:11], 0 offen sc1
interleave_layers__linear_attn_block__memory_aug_recurrent_mem_tr__prompt_kernel_pb26:
interleave_layers__linear_attn_block__memory_aug_recurrent_mem_tr__prompt_kernel_rk22:
    s_sub_u32 s44, s2, 64
    v_lshlrev_b32 v5, 4, v1
    s_lshl_b32 s24, s44, 15
    s_lshl_b32 s25, s3, 13
    s_add_u32 s24, s24, s25
    v_add_u32 v6, s24, v5
    v_add_u32 v7, 4096, v6
    s_lshl_b32 s24, s3, 12
    v_add_u32 v8, s24, v5
    s_lshl_b32 s24, s3, 10
    s_add_u32 s24, s24, 16384
    v_add_u32 v9, s24, v5
    s_lshl_b32 s24, s44, 13
    s_lshl_b32 s25, s3, 11
    s_add_u32 s24, s24, s25
    v_add_u32 v10, s24, v5
    v_and_b32 v204, 7, v2
    v_mul_u32_u24 v11, 80, v204
    v_lshl_add_u32 v11, v3, 4, v11
    s_mul_i32 s24, s3, 640
    v_add_u32 v11, s24, v11
    v_add_u32 v204, 8192, v5
    v_cmp_gt_u32 vcc, 8, v2
    s_nop 1
    v_cndmask_b32 v11, v204, v11, vcc
    v_and_b32 v204, 7, v2
    v_mul_u32_u24 v12, 80, v204
    v_lshrrev_b32 v204, 3, v2
    v_lshl_add_u32 v12, v204, 5, v12
    v_lshlrev_b32 v13, 4, v2
    s_lshl_b32 s24, s44, 8
    v_add_u32 v13, s24, v13
    v_mov_b32 v204, 2146435072
    v_cmp_gt_u32 vcc, 1, v3
    s_nop 1
    v_cndmask_b32 v13, v204, v13, vcc
    v_cmp_le_u32 s[50:51], 8, v2
    s_and_b32 s25, s44, 15
    s_lshr_b32 s25, s25, 2
    s_sub_u32 s26, s44, 32
    s_lshr_b32 s26, s26, 1
    s_cmp_ge_u32 s44, 32
    s_cselect_b32 s25, s26, s25
    s_mul_i32 s24, s25, 16
    v_add_u32 v120, s24, v1
    v_lshlrev_b32 v120, 7, v120
    v_mov_b32 v204, 2146435072
    v_cmp_le_u32 vcc, 16, v1
    s_nop 1
    v_cndmask_b32 v120, v120, v204, vcc
    s_and_b32 s24, s44, 7
    s_mul_i32 s25, s3, 8
    s_add_u32 s24, s24, s25
    s_lshl_b32 s24, s24, 7
    v_mov_b32 v125, s24
    v_mov_b32 v122, 12288
    v_mov_b32 v123, 0
    s_barrier
    ds_write_b32 v122, v123
    v_mov_b32 v123, 1
    s_waitcnt lgkmcnt(0)
    s_barrier
    s_mul_i32 s93, s92, 29360128
    s_add_u32 s93, s93, 117440512
    s_mul_i32 s94, s92, 16384
    s_add_u32 s94, s94, 23068672
    s_mov_b32 s40, 0
    s_mov_b32 s41, 184549376
    s_add_u32 s45, s93, 448512
    s_add_u32 s46, s93, 440320
    s_add_u32 s43, s93, 409600
    s_add_u32 s42, s93, 0
    s_add_u32 s47, s93, 430080
    v_and_b32 v252, 7, v1
    v_lshlrev_b32 v252, 7, v252
    s_lshl_b32 s24, s3, 10
    s_add_u32 s24, s24, 12288
    s_add_u32 s24, s24, s94
    v_add_u32 v252, s24, v252
    s_mov_b32 s62, -1
    s_mov_b32 s63, 1
    s_cmp_ge_i32 s62, s63
    s_cbranch_scc1 interleave_layers__linear_attn_block__memory_aug_recurrent_mem_tr__prompt_kernel_r_en0_ok
    s_mov_b32 s61, 0
interleave_layers__linear_attn_block__memory_aug_recurrent_mem_tr__prompt_kernel_r_en0:
    buffer_load_dword v253, v252, s[8:11], 0 offen sc1
    s_waitcnt vmcnt(0)
    v_readlane_b32 s62, v253, 0
    v_readlane_b32 s24, v253, 1
    s_min_i32 s62, s62, s24
    v_readlane_b32 s24, v253, 2
    s_min_i32 s62, s62, s24
    v_readlane_b32 s24, v253, 3
    s_min_i32 s62, s62, s24
    v_readlane_b32 s24, v253, 4
    s_min_i32 s62, s62, s24
    v_readlane_b32 s24, v253, 5
    s_min_i32 s62, s62, s24
    v_readlane_b32 s24, v253, 6
    s_min_i32 s62, s62, s24
    v_readlane_b32 s24, v253, 7
    s_min_i32 s62, s62, s24
    s_cmp_ge_i32 s62, s63
    s_cbranch_scc1 interleave_layers__linear_attn_block__memory_aug_recurrent_mem_tr__prompt_kernel_r_en0_ok
    s_add_u32 s61, s61, 1
    s_cmp_ge_u32 s61, s60
    s_cbranch_scc1 interleave_layers__linear_attn_block__memory_aug_recurrent_mem_tr__prompt_kernel_r_en0_to
    s_sleep 2
    s_branch interleave_layers__linear_attn_block__memory_aug_recurrent_mem_tr__prompt_kernel_r_en0
interleave_layers__linear_attn_block__memory_aug_recurrent_mem_tr__prompt_kernel_r_en0_to:
    s_mov_b32 s60, 1
interleave_layers__linear_attn_block__memory_aug_recurrent_mem_tr__prompt_kernel_r_en0_ok:
    buffer_load_dwordx4 v[48:51], v6, s[8:11], s41 offen offset:0 sc1
    buffer_load_dwordx4 v[52:55], v6, s[8:11], s41 offen offset:1024 sc1
    buffer_load_dwordx4 v[56:59], v6, s[8:11], s41 offen offset:2048 sc1
    buffer_load_dwordx4 v[60:63], v6, s[8:11], s41 offen offset:3072 sc1
    buffer_load_dwordx4 v[64:67], v7, s[8:11], s41 offen offset:0 sc1
    buffer_load_dwordx4 v[68:71], v7, s[8:11], s41 offen offset:1024 sc1
    buffer_load_dwordx4 v[72:75], v7, s[8:11], s41 offen offset:2048 sc1
    buffer_load_dwordx4 v[76:79], v7, s[8:11], s41 offen offset:3072 sc1
    s_add_u32 s41, s41, 1310720
interleave_layers__linear_attn_block__memory_aug_recurrent_mem_tr__prompt_kernel_r_step:
    s_waitcnt vmcnt(0)
    v_mov_b32 v16, v48
    v_mov_b32 v17, v49
    v_mov_b32 v18, v50
    v_mov_b32 v19, v51
    v_mov_b32 v20, v52
    v_mov_b32 v21, v53
    v_mov_b32 v22, v54
    v_mov_b32 v23, v55
    v_mov_b32 v24, v56
    v_mov_b32 v25, v57
    v_mov_b32 v26, v58
    v_mov_b32 v27, v59
    v_mov_b32 v28, v60
    v_mov_b32 v29, v61
    v_mov_b32 v30, v62
    v_mov_b32 v31, v63
    v_mov_b32 v32, v64
    v_mov_b32 v33, v65
    v_mov_b32 v34, v66
    v_mov_b32 v35, v67
    v_mov_b32 v36, v68
    v_mov_b32 v37, v69
    v_mov_b32 v38, v70
    v_mov_b32 v39, v71
    v_mov_b32 v40, v72
    v_mov_b32 v41, v73
    v_mov_b32 v42, v74
    v_mov_b32 v43, v75
    v_mov_b32 v44, v76
    v_mov_b32 v45, v77
    v_mov_b32 v46, v78
    v_mov_b32 v47, v79
    s_lshl_b32 s95, s92, 6
    s_add_u32 s95, s95, s40
    s_add_u32 s95, s95, 1
    s_cmp_ge_i32 s59, s95
    s_cbranch_scc1 interleave_layers__linear_attn_block__memory_aug_recurrent_mem_tr__prompt_kernel_r_ec_ok
    s_and_b32 s24, s2, 7
    s_lshl_b32 s24, s24, 7
    s_add_u32 s24, s24, 23109632
    v_and_b32 v254, 3, v1
    v_lshl_add_u32 v254, v254, 2, s24
    s_mov_b32 s61, 0
interleave_layers__linear_attn_block__memory_aug_recurrent_mem_tr__prompt_kernel_r_ec:
    buffer_load_dword v253, v254, s[8:11], 0 offen sc1
    s_waitcnt vmcnt(0)
    v_readlane_b32 s59, v253, 0
    v_readlane_b32 s24, v253, 1
    s_min_i32 s59, s59, s24
    v_readlane_b32 s24, v253, 2
    s_min_i32 s59, s59, s24
    s_cmp_ge_i32 s59, s95
    s_cbranch_scc1 interleave_layers__linear_attn_block__memory_aug_recurrent_mem_tr__prompt_kernel_r_ec_ok
    s_add_u32 s61, s61, 1
    s_cmp_ge_u32 s61, s60
    s_cbranch_scc1 interleave_layers__linear_attn_block__memory_aug_recurrent_mem_tr__prompt_kernel_r_ec_to
    s_sleep 2
    s_branch interleave_layers__linear_attn_block__memory_aug_recurrent_mem_tr__prompt_kernel_r_ec
interleave_layers__linear_attn_block__memory_aug_recurrent_mem_tr__prompt_kernel_r_ec_to:
    s_mov_b32 s60, 1
interleave_layers__linear_attn_block__memory_aug_recurrent_mem_tr__prompt_kernel_r_ec_ok:
    s_mov_b64 exec, 1
    s_mov_b32 s61, 0
    v_mov_b32 v117, 0
    buffer_atomic_add v117, v125, s[8:11], s45 offen sc0
    s_sleep 2
    v_mov_b32 v118, 0
    buffer_atomic_add v118, v125, s[8:11], s45 offen sc0
    s_sleep 2
    v_mov_b32 v119, 0
    buffer_atomic_add v119, v125, s[8:11], s45 offen sc0
    s_sleep 2
interleave_layers__linear_attn_block__memory_aug_recurrent_mem_tr__prompt_kernel_r_pr:
    v_mov_b32 v116, 0
    buffer_atomic_add v116, v125, s[8:11], s45 offen sc0
    s_waitcnt vmcnt(3)
    v_cmp_le_i32 vcc, 7, v117
    s_add_u32 s61, s61, 1
    s_cbranch_vccnz interleave_layers__linear_attn_block__memory_aug_recurrent_mem_tr__prompt_kernel_r_pr_out
    s_sleep 2
    v_mov_b32 v117, 0
    buffer_atomic_add v117, v125, s[8:11], s45 offen sc0
    s_waitcnt vmcnt(3)
    v_cmp_le_i32 vcc, 7, v118
    s_add_u32 s61, s61, 1
    s_cbranch_vccnz interleave_layers__linear_attn_block__memory_aug_recurrent_mem_tr__prompt_kernel_r_pr_out
    s_sleep 2
    v_mov_b32 v118, 0
    buffer_atomic_add v118, v125, s[8:11], s45 offen sc0
    s_waitcnt vmcnt(3)
    v_cmp_le_i32 vcc, 7, v119
    s_add_u32 s61, s61, 1
    s_cbranch_vccnz interleave_layers__linear_attn_block__memory_aug_recurrent_mem_tr__prompt_kernel_r_pr_out
    s_sleep 2
    v_mov_b32 v119, 0
    buffer_atomic_add v119, v125, s[8:11], s45 offen sc0
    s_waitcnt vmcnt(3)
    v_cmp_le_i32 vcc, 7, v116
    s_add_u32 s61, s61, 1
    s_cbranch_vccnz interleave_layers__linear_attn_block__memory_aug_recurrent_mem_tr__prompt_kernel_r_pr_out
    s_sleep 2
    s_cmp_ge_u32 s61, s60
    s_cbranch_scc0 interleave_layers__linear_attn_block__memory_aug_recurrent_mem_tr__prompt_kernel_r_pr
    s_mov_b32 s60, 1
interleave_layers__linear_attn_block__memory_aug_recurrent_mem_tr__prompt_kernel_r_pr_out:
    s_mov_b64 exec, -1
    buffer_load_dwordx4 v[100:103], v10, s[8:11], s42 offen offset:0 sc1
    buffer_load_dwordx4 v[104:107], v10, s[8:11], s42 offen offset:1024 sc1
    buffer_load_dwordx4 v[80:83], v8, s[8:11], s43 offen offset:0 sc1
    buffer_load_dwordx4 v[84:87], v8, s[8:11], s43 offen offset:1024 sc1
    buffer_load_dwordx4 v[88:91], v8, s[8:11], s43 offen offset:2048 sc1
    buffer_load_dwordx4 v[92:95], v8, s[8:11], s43 offen offset:3072 sc1
    buffer_load_dwordx4 v[96:99], v9, s[8:11], s43 offen sc1
    s_waitcnt vmcnt(0)
    v_max3_u32 v204, v80, v81, v82
    v_max3_u32 v204, v204, v83, v84
    v_max3_u32 v204, v204, v85, v86
    v_max3_u32 v204, v204, v87, v88
    v_max3_u32 v204, v204, v89, v90
    v_max3_u32 v204, v204, v91, v92
    v_max3_u32 v204, v204, v93, v94
    v_max3_u32 v204, v204, v95, v96
    v_max3_u32 v204, v204, v97, v98
    v_max3_u32 v204, v204, v99, v100
    v_max3_u32 v204, v204, v101, v102
    v_max3_u32 v204, v204, v103, v104
    v_max3_u32 v204, v204, v105, v106
    v_max_u32 v204, v204, v107
    v_cmp_eq_u32 vcc, -1, v204
    s_cbranch_vccz interleave_layers__linear_attn_block__memory_aug_recurrent_mem_tr__prompt_kernel_r_p_out
    s_mov_b32 s61, 0
interleave_layers__linear_attn_block__memory_aug_recurrent_mem_tr__prompt_kernel_r_p:
    buffer_load_dwordx4 v[100:103], v10, s[8:11], s42 offen offset:0 sc1
    buffer_load_dwordx4 v[104:107], v10, s[8:11], s42 offen offset:1024 sc1
    buffer_load_dwordx4 v[80:83], v8, s[8:11], s43 offen offset:0 sc1
    buffer_load_dwordx4 v[84:87], v8, s[8:11], s43 offen offset:1024 sc1
    buffer_load_dwordx4 v[88:91], v8, s[8:11], s43 offen offset:2048 sc1
    buffer_load_dwordx4 v[92:95], v8, s[8:11], s43 offen offset:3072 sc1
    buffer_load_dwordx4 v[96:99], v9, s[8:11], s43 offen sc1
    s_waitcnt vmcnt(0)
    v_max3_u32 v204, v80, v81, v82
    v_max3_u32 v204, v204, v83, v84
    v_max3_u32 v204, v204, v85, v86
    v_max3_u32 v204, v204, v87, v88
    v_max3_u32 v204, v204, v89, v90
    v_max3_u32 v204, v204, v91, v92
    v_max3_u32 v204, v204, v93, v94
    v_max3_u32 v204, v204, v95, v96
    v_max3_u32 v204, v204, v97, v98
    v_max3_u32 v204, v204, v99, v100
    v_max3_u32 v204, v204, v101, v102
    v_max3_u32 v204, v204, v103, v104
    v_max3_u32 v204, v204, v105, v106
    v_max_u32 v204, v204, v107
    v_cmp_eq_u32 vcc, -1, v204
    s_add_u32 s61, s61, 1
    s_cbranch_vccz interleave_layers__linear_attn_block__memory_aug_recurrent_mem_tr__prompt_kernel_r_p_out
    s_cmp_ge_u32 s61, s60
    s_cbranch_scc1 interleave_layers__linear_attn_block__memory_aug_recurrent_mem_tr__prompt_kernel_r_p_to
    s_sleep 1
    s_branch interleave_layers__linear_attn_block__memory_aug_recurrent_mem_tr__prompt_kernel_r_p
interleave_layers__linear_attn_block__memory_aug_recurrent_mem_tr__prompt_kernel_r_p_to:
    s_mov_b32 s60, 1
interleave_layers__linear_attn_block__memory_aug_recurrent_mem_tr__prompt_kernel_r_p_out:
    s_mov_b64 exec, 1
    ds_add_rtn_u32 v124, v122, v123
    s_mov_b64 exec, -1
    v_mfma_f32_16x16x32_bf16 v[108:111], v[100:103], v[96:99], 0
    v_mfma_f32_16x16x32_bf16 v[112:115], v[104:107], v[96:99], 0
    v_mfma_f32_16x16x32_bf16 v[108:111], v[16:19], v[80:83], v[108:111]
    v_mfma_f32_16x16x32_bf16 v[112:115], v[20:23], v[80:83], v[112:115]
    s_waitcnt lgkmcnt(0)
    v_readfirstlane_b32 s24, v124
    s_and_b32 s24, s24, 3
    s_cmp_eq_u32 s24, 3
    s_cbranch_scc0 interleave_layers__linear_attn_block__memory_aug_recurrent_mem_tr__prompt_kernel_nh27
    buffer_atomic_add v123, v120, s[8:11], s46 offen
interleave_layers__linear_attn_block__memory_aug_recurrent_mem_tr__prompt_kernel_nh27:
    v_mfma_f32_16x16x32_bf16 v[108:111], v[24:27], v[84:87], v[108:111]
    v_mfma_f32_16x16x32_bf16 v[112:115], v[28:31], v[84:87], v[112:115]
    v_mfma_f32_16x16x32_bf16 v[108:111], v[32:35], v[88:91], v[108:111]
    v_mfma_f32_16x16x32_bf16 v[112:115], v[36:39], v[88:91], v[112:115]
    v_mfma_f32_16x16x32_bf16 v[108:111], v[40:43], v[92:95], v[108:111]
    v_mfma_f32_16x16x32_bf16 v[112:115], v[44:47], v[92:95], v[112:115]
    s_and_b32 s24, s40, 1
    s_mul_i32 s24, s24, 2560
    v_add_u32 v14, s24, v11
    v_add_u32 v15, s24, v12
    s_nop 3
    v_cndmask_b32 v108, v108, v112, s[50:51]
    v_cndmask_b32 v109, v109, v113, s[50:51]
    v_cndmask_b32 v110, v110, v114, s[50:51]
    v_cndmask_b32 v111, v111, v115, s[50:51]
    v_add_f32 v108, v108, v108 row_ror:8 row_mask:0xf bank_mask:0xf
    v_add_f32 v109, v109, v109 row_ror:8 row_mask:0xf bank_mask:0xf
    v_add_f32 v110, v110, v110 row_ror:8 row_mask:0xf bank_mask:0xf
    v_add_f32 v111, v111, v111 row_ror:8 row_mask:0xf bank_mask:0xf
    ds_write_b128 v14, v[108:111]
    s_waitcnt lgkmcnt(0)
    s_barrier
    s_cmp_eq_u32 s3, 0
    s_cbranch_scc0 interleave_layers__linear_attn_block__memory_aug_recurrent_mem_tr__prompt_kernel_np28
    ds_read_b128 v[220:223], v15 offset:0
    ds_read_b128 v[224:227], v15 offset:16
    ds_read_b128 v[228:231], v15 offset:640
    ds_read_b128 v[232:235], v15 offset:656
    ds_read_b128 v[236:239], v15 offset:1280
    ds_read_b128 v[240:243], v15 offset:1296
    ds_read_b128 v[244:247], v15 offset:1920
    ds_read_b128 v[248:251], v15 offset:1936
    s_waitcnt lgkmcnt(4)
    v_pk_add_f32 v[220:221], v[220:221], v[228:229]
    v_pk_add_f32 v[222:223], v[222:223], v[230:231]
    v_pk_add_f32 v[224:225], v[224:225], v[232:233]
    v_pk_add_f32 v[226:227], v[226:227], v[234:235]
    s_waitcnt lgkmcnt(0)
    v_pk_add_f32 v[236:237], v[236:237], v[244:245]
    v_pk_add_f32 v[238:239], v[238:239], v[246:247]
    v_pk_add_f32 v[240:241], v[240:241], v[248:249]
    v_pk_add_f32 v[242:243], v[242:243], v[250:251]
    v_pk_add_f32 v[220:221], v[220:221], v[236:237]
    v_pk_add_f32 v[222:223], v[222:223], v[238:239]
    v_pk_add_f32 v[224:225], v[224:225], v[240:241]
    v_pk_add_f32 v[226:227], v[226:227], v[242:243]
    v_cvt_pk_bf16_f32 v228, v220, v221
    v_cvt_pk_bf16_f32 v229, v222, v223
    v_cvt_pk_bf16_f32 v230, v224, v225
    v_cvt_pk_bf16_f32 v231, v226, v227
    v_min_u32 v228, -2, v228
    v_min_u32 v229, -2, v229
    v_min_u32 v230, -2, v230
    v_min_u32 v231, -2, v231
    buffer_store_dwordx4 v[228:231], v13, s[8:11], s47 offen sc1
interleave_layers__linear_attn_block__memory_aug_recurrent_mem_tr__prompt_kernel_np28:
    s_add_u32 s63, s40, 2
    s_min_u32 s63, s63, 64
    s_sleep 20
    s_cmp_ge_i32 s62, s63
    s_cbranch_scc1 interleave_layers__linear_attn_block__memory_aug_recurrent_mem_tr__prompt_kernel_r_en_ok
    s_mov_b32 s61, 0
interleave_layers__linear_attn_block__memory_aug_recurrent_mem_tr__prompt_kernel_r_en:
    buffer_load_dword v253, v252, s[8:11], 0 offen sc1
    s_waitcnt vmcnt(0)
    v_readlane_b32 s62, v253, 0
    v_readlane_b32 s24, v253, 1
    s_min_i32 s62, s62, s24
    v_readlane_b32 s24, v253, 2
    s_min_i32 s62, s62, s24
    v_readlane_b32 s24, v253, 3
    s_min_i32 s62, s62, s24
    v_readlane_b32 s24, v253, 4
    s_min_i32 s62, s62, s24
    v_readlane_b32 s24, v253, 5
    s_min_i32 s62, s62, s24
    v_readlane_b32 s24, v253, 6
    s_min_i32 s62, s62, s24
    v_readlane_b32 s24, v253, 7
    s_min_i32 s62, s62, s24
    s_cmp_ge_i32 s62, s63
    s_cbranch_scc1 interleave_layers__linear_attn_block__memory_aug_recurrent_mem_tr__prompt_kernel_r_en_ok
    s_add_u32 s61, s61, 1
    s_cmp_ge_u32 s61, s60
    s_cbranch_scc1 interleave_layers__linear_attn_block__memory_aug_recurrent_mem_tr__prompt_kernel_r_en_to
    s_sleep 2
    s_branch interleave_layers__linear_attn_block__memory_aug_recurrent_mem_tr__prompt_kernel_r_en
interleave_layers__linear_attn_block__memory_aug_recurrent_mem_tr__prompt_kernel_r_en_to:
    s_mov_b32 s60, 1
interleave_layers__linear_attn_block__memory_aug_recurrent_mem_tr__prompt_kernel_r_en_ok:
    buffer_load_dwordx4 v[48:51], v6, s[8:11], s41 offen offset:0 sc1
    buffer_load_dwordx4 v[52:55], v6, s[8:11], s41 offen offset:1024 sc1
    buffer_load_dwordx4 v[56:59], v6, s[8:11], s41 offen offset:2048 sc1
    buffer_load_dwordx4 v[60:63], v6, s[8:11], s41 offen offset:3072 sc1
    buffer_load_dwordx4 v[64:67], v7, s[8:11], s41 offen offset:0 sc1
    buffer_load_dwordx4 v[68:71], v7, s[8:11], s41 offen offset:1024 sc1
    buffer_load_dwordx4 v[72:75], v7, s[8:11], s41 offen offset:2048 sc1
    buffer_load_dwordx4 v[76:79], v7, s[8:11], s41 offen offset:3072 sc1
    s_add_u32 s41, s41, 1310720
    s_add_u32 s40, s40, 1
    s_add_u32 s42, s42, 458752
    s_add_u32 s43, s43, 458752
    s_add_u32 s47, s47, 458752
    s_add_u32 s45, s45, 458752
    s_add_u32 s46, s46, 458752
    s_cmp_lt_u32 s40, 64
    s_cbranch_scc1 interleave_layers__linear_attn_block__memory_aug_recurrent_mem_tr__prompt_kernel_r_step
    s_waitcnt vmcnt(0)
    s_cmp_eq_u32 s92, 0
    s_cbranch_scc0 interleave_layers__linear_attn_block__memory_aug_recurrent_mem_tr__prompt_kernel_end
    s_mov_b32 s92, 1
    s_branch interleave_layers__linear_attn_block__memory_aug_recurrent_mem_tr__prompt_kernel_r_top
interleave_layers__linear_attn_block__memory_aug_recurrent_mem_tr__prompt_kernel_roleP:
    s_sub_u32 s44, s2, 104
    s_lshr_b32 s46, s44, 5
    s_and_b32 s44, s44, 31
    s_load_dwordx2 s[6:7], s[0:1], 40
    s_load_dwordx2 s[24:25], s[0:1], 48
    s_load_dwordx2 s[26:27], s[0:1], 56
    s_waitcnt lgkmcnt(0)
    s_cmp_eq_u32 s46, 1
    s_cselect_b32 s6, s24, s6
    s_cselect_b32 s7, s25, s7
    s_cmp_eq_u32 s46, 2
    s_cselect_b32 s6, s26, s6
    s_cselect_b32 s7, s27, s7
    s_mov_b32 s12, s6
    s_mov_b32 s13, s7
    s_mov_b32 s14, 7864320
    s_mov_b32 s15, 0x00020000
    v_add_u32 v16, 0, v0
    s_mov_b32 s24, 683
    v_mul_lo_u32 v17, v16, s24
    v_lshrrev_b32 v17, 14, v17
    v_mul_u32_u24 v18, 24, v17
    v_sub_u32 v18, v16, v18
    s_mov_b32 s24, 12288
    v_mul_lo_u32 v4, v17, s24
    v_lshl_add_u32 v4, v18, 4, v4
    v_mul_u32_u24 v10, 400, v17
    v_lshl_add_u32 v10, v18, 4, v10
    v_add_u32 v10, 81920, v10
    v_add_u32 v16, 256, v0
    s_mov_b32 s24, 683
    v_mul_lo_u32 v17, v16, s24
    v_lshrrev_b32 v17, 14, v17
    v_mul_u32_u24 v18, 24, v17
    v_sub_u32 v18, v16, v18
    s_mov_b32 s24, 12288
    v_mul_lo_u32 v5, v17, s24
    v_lshl_add_u32 v5, v18, 4, v5
    v_mul_u32_u24 v11, 400, v17
    v_lshl_add_u32 v11, v18, 4, v11
    v_add_u32 v11, 81920, v11
    v_add_u32 v16, 512, v0
    s_mov_b32 s24, 683
    v_mul_lo_u32 v17, v16, s24
    v_lshrrev_b32 v17, 14, v17
    v_mul_u32_u24 v18, 24, v17
    v_sub_u32 v18, v16, v18
    s_mov_b32 s24, 12288
    v_mul_lo_u32 v6, v17, s24
    v_lshl_add_u32 v6, v18, 4, v6
    v_mul_u32_u24 v12, 400, v17
    v_lshl_add_u32 v12, v18, 4, v12
    v_add_u32 v12, 81920, v12
    v_add_u32 v16, 768, v0
    s_mov_b32 s24, 683
    v_mul_lo_u32 v17, v16, s24
    v_lshrrev_b32 v17, 14, v17
    v_mul_u32_u24 v18, 24, v17
    v_sub_u32 v18, v16, v18
    s_mov_b32 s24, 12288
    v_mul_lo_u32 v7, v17, s24
    v_lshl_add_u32 v7, v18, 4, v7
    v_mul_u32_u24 v13, 400, v17
    v_lshl_add_u32 v13, v18, 4, v13
    v_add_u32 v13, 81920, v13
    v_add_u32 v16, 1024, v0
    s_mov_b32 s24, 683
    v_mul_lo_u32 v17, v16, s24
    v_lshrrev_b32 v17, 14, v17
    v_mul_u32_u24 v18, 24, v17
    v_sub_u32 v18, v16, v18
    s_mov_b32 s24, 12288
    v_mul_lo_u32 v8, v17, s24
    v_lshl_add_u32 v8, v18, 4, v8
    v_mul_u32_u24 v14, 400, v17
    v_lshl_add_u32 v14, v18, 4, v14
    v_add_u32 v14, 81920, v14
    v_add_u32 v16, 1280, v0
    s_mov_b32 s24, 683
    v_mul_lo_u32 v17, v16, s24
    v_lshrrev_b32 v17, 14, v17
    v_mul_u32_u24 v18, 24, v17
    v_sub_u32 v18, v16, v18
    s_mov_b32 s24, 12288
    v_mul_lo_u32 v9, v17, s24
    v_lshl_add_u32 v9, v18, 4, v9
    v_mul_u32_u24 v15, 400, v17
    v_lshl_add_u32 v15, v18, 4, v15
    v_add_u32 v15, 81920, v15
    v_lshrrev_b32 v16, 2, v2
    v_lshl_add_u32 v16, v3, 2, v16
    v_mul_u32_u24 v32, 400, v16
    v_and_b32 v16, 3, v2
    v_lshl_add_u32 v32, v16, 3, v32
    s_mul_i32 s24, s3, 96
    s_add_u32 s24, s24, 81920
    v_add_u32 v32, s24, v32
    s_mul_i32 s45, s44, 384
    s_add_u32 s47, s45, 0
    buffer_load_dwordx4 v[56:59], v4, s[12:15], s47 offen
    buffer_load_dwordx4 v[60:63], v5, s[12:15], s47 offen
    buffer_load_dwordx4 v[64:67], v6, s[12:15], s47 offen
    buffer_load_dwordx4 v[68:71], v7, s[12:15], s47 offen
    buffer_load_dwordx4 v[72:75], v8, s[12:15], s47 offen
    buffer_load_dwordx4 v[76:79], v9, s[12:15], s47 offen
    s_add_u32 s47, s45, 786432
    buffer_load_dwordx4 v[80:83], v4, s[12:15], s47 offen
    buffer_load_dwordx4 v[84:87], v5, s[12:15], s47 offen
    buffer_load_dwordx4 v[88:91], v6, s[12:15], s47 offen
    buffer_load_dwordx4 v[92:95], v7, s[12:15], s47 offen
    buffer_load_dwordx4 v[96:99], v8, s[12:15], s47 offen
    buffer_load_dwordx4 v[100:103], v9, s[12:15], s47 offen
    s_add_u32 s47, s45, 1572864
    buffer_load_dwordx4 v[104:107], v4, s[12:15], s47 offen
    buffer_load_dwordx4 v[108:111], v5, s[12:15], s47 offen
    buffer_load_dwordx4 v[112:115], v6, s[12:15], s47 offen
    buffer_load_dwordx4 v[116:119], v7, s[12:15], s47 offen
    buffer_load_dwordx4 v[120:123], v8, s[12:15], s47 offen
    buffer_load_dwordx4 v[124:127], v9, s[12:15], s47 offen
    s_add_u32 s47, s45, 2359296
    buffer_load_dwordx4 v[128:131], v4, s[12:15], s47 offen
    buffer_load_dwordx4 v[132:135], v5, s[12:15], s47 offen
    buffer_load_dwordx4 v[136:139], v6, s[12:15], s47 offen
    buffer_load_dwordx4 v[140:143], v7, s[12:15], s47 offen
    buffer_load_dwordx4 v[144:147], v8, s[12:15], s47 offen
    buffer_load_dwordx4 v[148:151], v9, s[12:15], s47 offen
    s_add_u32 s47, s45, 3145728
    buffer_load_dwordx4 v[152:155], v4, s[12:15], s47 offen
    buffer_load_dwordx4 v[156:159], v5, s[12:15], s47 offen
    buffer_load_dwordx4 v[160:163], v6, s[12:15], s47 offen
    buffer_load_dwordx4 v[164:167], v7, s[12:15], s47 offen
    buffer_load_dwordx4 v[168:171], v8, s[12:15], s47 offen
    buffer_load_dwordx4 v[172:175], v9, s[12:15], s47 offen
    s_add_u32 s47, s45, 3932160
    buffer_load_dwordx4 v[176:179], v4, s[12:15], s47 offen
    buffer_load_dwordx4 v[180:183], v5, s[12:15], s47 offen
    buffer_load_dwordx4 v[184:187], v6, s[12:15], s47 offen
    buffer_load_dwordx4 v[188:191], v7, s[12:15], s47 offen
    buffer_load_dwordx4 v[192:195], v8, s[12:15], s47 offen
    buffer_load_dwordx4 v[196:199], v9, s[12:15], s47 offen
    s_add_u32 s47, s45, 4718592
    buffer_load_dwordx4 v[200:203], v4, s[12:15], s47 offen
    buffer_load_dwordx4 v[204:207], v5, s[12:15], s47 offen
    buffer_load_dwordx4 v[208:211], v6, s[12:15], s47 offen
    buffer_load_dwordx4 v[212:215], v7, s[12:15], s47 offen
    buffer_load_dwordx4 v[216:219], v8, s[12:15], s47 offen
    buffer_load_dwordx4 v[220:223], v9, s[12:15], s47 offen
    s_add_u32 s47, s45, 5505024
    buffer_load_dwordx4 v[224:227], v4, s[12:15], s47 offen
    buffer_load_dwordx4 v[228:231], v5, s[12:15], s47 offen
    buffer_load_dwordx4 v[232:235], v6, s[12:15], s47 offen
    buffer_load_dwordx4 v[236:239], v7, s[12:15], s47 offen
    buffer_load_dwordx4 v[240:243], v8, s[12:15], s47 offen
    buffer_load_dwordx4 v[244:247], v9, s[12:15], s47 offen
    v_mov_b32 v28, 0x3f803f80
    v_mov_b32 v29, 0x3f803f80
    v_mov_b32 v30, 0x3f803f80
    v_mov_b32 v31, 0x3f803f80
    s_waitcnt vmcnt(42)
    ds_write_b128 v10, v[56:59] offset:0
    ds_write_b128 v11, v[60:63] offset:0
    ds_write_b128 v12, v[64:67] offset:0
    ds_write_b128 v13, v[68:71] offset:0
    ds_write_b128 v14, v[72:75] offset:0
    ds_write_b128 v15, v[76:79] offset:0
    s_waitcnt lgkmcnt(0)
    s_add_u32 s47, s45, 6291456
    buffer_load_dwordx4 v[56:59], v4, s[12:15], s47 offen
    buffer_load_dwordx4 v[60:63], v5, s[12:15], s47 offen
    buffer_load_dwordx4 v[64:67], v6, s[12:15], s47 offen
    buffer_load_dwordx4 v[68:71], v7, s[12:15], s47 offen
    buffer_load_dwordx4 v[72:75], v8, s[12:15], s47 offen
    buffer_load_dwordx4 v[76:79], v9, s[12:15], s47 offen
    s_barrier
    ds_read_b64_tr_b16 a[0:1], v32 offset:0
    ds_read_b64_tr_b16 a[2:3], v32 offset:6400
    ds_read_b64_tr_b16 a[4:5], v32 offset:12800
    ds_read_b64_tr_b16 a[6:7], v32 offset:19200
    ds_read_b64_tr_b16 a[80:81], v32 offset:32
    ds_read_b64_tr_b16 a[82:83], v32 offset:6432
    ds_read_b64_tr_b16 a[84:85], v32 offset:12832
    ds_read_b64_tr_b16 a[86:87], v32 offset:19232
    ds_read_b64_tr_b16 a[160:161], v32 offset:64
    ds_read_b64_tr_b16 a[162:163], v32 offset:6464
    ds_read_b64_tr_b16 a[164:165], v32 offset:12864
    ds_read_b64_tr_b16 a[166:167], v32 offset:19264
    s_waitcnt vmcnt(42)
    ds_write_b128 v10, v[80:83] offset:25600
    ds_write_b128 v11, v[84:87] offset:25600
    ds_write_b128 v12, v[88:91] offset:25600
    ds_write_b128 v13, v[92:95] offset:25600
    ds_write_b128 v14, v[96:99] offset:25600
    ds_write_b128 v15, v[100:103] offset:25600
    s_waitcnt lgkmcnt(0)
    s_add_u32 s47, s45, 7077888
    buffer_load_dwordx4 v[80:83], v4, s[12:15], s47 offen
    buffer_load_dwordx4 v[84:87], v5, s[12:15], s47 offen
    buffer_load_dwordx4 v[88:91], v6, s[12:15], s47 offen
    buffer_load_dwordx4 v[92:95], v7, s[12:15], s47 offen
    buffer_load_dwordx4 v[96:99], v8, s[12:15], s47 offen
    buffer_load_dwordx4 v[100:103], v9, s[12:15], s47 offen
    v_mfma_f32_16x16x32_bf16 v[16:19], a[0:3], v[28:31], 0
    v_mfma_f32_16x16x32_bf16 v[20:23], a[80:83], v[28:31], 0
    v_mfma_f32_16x16x32_bf16 v[24:27], a[160:163], v[28:31], 0
    v_mfma_f32_16x16x32_bf16 v[16:19], a[4:7], v[28:31], v[16:19]
    v_mfma_f32_16x16x32_bf16 v[20:23], a[84:87], v[28:31], v[20:23]
    v_mfma_f32_16x16x32_bf16 v[24:27], a[164:167], v[28:31], v[24:27]
    s_barrier
    ds_read_b64_tr_b16 a[8:9], v32 offset:25600
    ds_read_b64_tr_b16 a[10:11], v32 offset:32000
    ds_read_b64_tr_b16 a[12:13], v32 offset:38400
    ds_read_b64_tr_b16 a[14:15], v32 offset:44800
    ds_read_b64_tr_b16 a[88:89], v32 offset:25632
    ds_read_b64_tr_b16 a[90:91], v32 offset:32032
    ds_read_b64_tr_b16 a[92:93], v32 offset:38432
    ds_read_b64_tr_b16 a[94:95], v32 offset:44832
    ds_read_b64_tr_b16 a[168:169], v32 offset:25664
    ds_read_b64_tr_b16 a[170:171], v32 offset:32064
    ds_read_b64_tr_b16 a[172:173], v32 offset:38464
    ds_read_b64_tr_b16 a[174:175], v32 offset:44864
    s_waitcnt vmcnt(42)
    ds_write_b128 v10, v[104:107] offset:0
    ds_write_b128 v11, v[108:111] offset:0
    ds_write_b128 v12, v[112:115] offset:0
    ds_write_b128 v13, v[116:119] offset:0
    ds_write_b128 v14, v[120:123] offset:0
    ds_write_b128 v15, v[124:127] offset:0
    s_waitcnt lgkmcnt(0)
    v_mfma_f32_16x16x32_bf16 v[16:19], a[8:11], v[28:31], v[16:19]
    v_mfma_f32_16x16x32_bf16 v[20:23], a[88:91], v[28:31], v[20:23]
    v_mfma_f32_16x16x32_bf16 v[24:27], a[168:171], v[28:31], v[24:27]
    v_mfma_f32_16x16x32_bf16 v[16:19], a[12:15], v[28:31], v[16:19]
    v_mfma_f32_16x16x32_bf16 v[20:23], a[92:95], v[28:31], v[20:23]
    v_mfma_f32_16x16x32_bf16 v[24:27], a[172:175], v[28:31], v[24:27]
    s_barrier
    ds_read_b64_tr_b16 a[16:17], v32 offset:0
    ds_read_b64_tr_b16 a[18:19], v32 offset:6400
    ds_read_b64_tr_b16 a[20:21], v32 offset:12800
    ds_read_b64_tr_b16 a[22:23], v32 offset:19200
    ds_read_b64_tr_b16 a[96:97], v32 offset:32
    ds_read_b64_tr_b16 a[98:99], v32 offset:6432
    ds_read_b64_tr_b16 a[100:101], v32 offset:12832
    ds_read_b64_tr_b16 a[102:103], v32 offset:19232
    ds_read_b64_tr_b16 a[176:177], v32 offset:64
    ds_read_b64_tr_b16 a[178:179], v32 offset:6464
    ds_read_b64_tr_b16 a[180:181], v32 offset:12864
    ds_read_b64_tr_b16 a[182:183], v32 offset:19264
    s_waitcnt vmcnt(36)
    ds_write_b128 v10, v[128:131] offset:25600
    ds_write_b128 v11, v[132:135] offset:25600
    ds_write_b128 v12, v[136:139] offset:25600
    ds_write_b128 v13, v[140:143] offset:25600
    ds_write_b128 v14, v[144:147] offset:25600
    ds_write_b128 v15, v[148:151] offset:25600
    s_waitcnt lgkmcnt(0)
    v_mfma_f32_16x16x32_bf16 v[16:19], a[16:19], v[28:31], v[16:19]
    v_mfma_f32_16x16x32_bf16 v[20:23], a[96:99], v[28:31], v[20:23]
    v_mfma_f32_16x16x32_bf16 v[24:27], a[176:179], v[28:31], v[24:27]
    v_mfma_f32_16x16x32_bf16 v[16:19], a[20:23], v[28:31], v[16:19]
    v_mfma_f32_16x16x32_bf16 v[20:23], a[100:103], v[28:31], v[20:23]
    v_mfma_f32_16x16x32_bf16 v[24:27], a[180:183], v[28:31], v[24:27]
    s_barrier
    ds_read_b64_tr_b16 a[24:25], v32 offset:25600
    ds_read_b64_tr_b16 a[26:27], v32 offset:32000
    ds_read_b64_tr_b16 a[28:29], v32 offset:38400
    ds_read_b64_tr_b16 a[30:31], v32 offset:44800
    ds_read_b64_tr_b16 a[104:105], v32 offset:25632
    ds_read_b64_tr_b16 a[106:107], v32 offset:32032
    ds_read_b64_tr_b16 a[108:109], v32 offset:38432
    ds_read_b64_tr_b16 a[110:111], v32 offset:44832
    ds_read_b64_tr_b16 a[184:185], v32 offset:25664
    ds_read_b64_tr_b16 a[186:187], v32 offset:32064
    ds_read_b64_tr_b16 a[188:189], v32 offset:38464
    ds_read_b64_tr_b16 a[190:191], v32 offset:44864
    s_waitcnt vmcnt(30)
    ds_write_b128 v10, v[152:155] offset:0
    ds_write_b128 v11, v[156:159] offset:0
    ds_write_b128 v12, v[160:163] offset:0
    ds_write_b128 v13, v[164:167] offset:0
    ds_write_b128 v14, v[168:171] offset:0
    ds_write_b128 v15, v[172:175] offset:0
    s_waitcnt lgkmcnt(0)
    v_mfma_f32_16x16x32_bf16 v[16:19], a[24:27], v[28:31], v[16:19]
    v_mfma_f32_16x16x32_bf16 v[20:23], a[104:107], v[28:31], v[20:23]
    v_mfma_f32_16x16x32_bf16 v[24:27], a[184:187], v[28:31], v[24:27]
    v_mfma_f32_16x16x32_bf16 v[16:19], a[28:31], v[28:31], v[16:19]
    v_mfma_f32_16x16x32_bf16 v[20:23], a[108:111], v[28:31], v[20:23]
    v_mfma_f32_16x16x32_bf16 v[24:27], a[188:191], v[28:31], v[24:27]
    s_barrier
    ds_read_b64_tr_b16 a[32:33], v32 offset:0
    ds_read_b64_tr_b16 a[34:35], v32 offset:6400
    ds_read_b64_tr_b16 a[36:37], v32 offset:12800
    ds_read_b64_tr_b16 a[38:39], v32 offset:19200
    ds_read_b64_tr_b16 a[112:113], v32 offset:32
    ds_read_b64_tr_b16 a[114:115], v32 offset:6432
    ds_read_b64_tr_b16 a[116:117], v32 offset:12832
    ds_read_b64_tr_b16 a[118:119], v32 offset:19232
    ds_read_b64_tr_b16 a[192:193], v32 offset:64
    ds_read_b64_tr_b16 a[194:195], v32 offset:6464
    ds_read_b64_tr_b16 a[196:197], v32 offset:12864
    ds_read_b64_tr_b16 a[198:199], v32 offset:19264
    s_waitcnt vmcnt(24)
    ds_write_b128 v10, v[176:179] offset:25600
    ds_write_b128 v11, v[180:183] offset:25600
    ds_write_b128 v12, v[184:187] offset:25600
    ds_write_b128 v13, v[188:191] offset:25600
    ds_write_b128 v14, v[192:195] offset:25600
    ds_write_b128 v15, v[196:199] offset:25600
    s_waitcnt lgkmcnt(0)
    v_mfma_f32_16x16x32_bf16 v[16:19], a[32:35], v[28:31], v[16:19]
    v_mfma_f32_16x16x32_bf16 v[20:23], a[112:115], v[28:31], v[20:23]
    v_mfma_f32_16x16x32_bf16 v[24:27], a[192:195], v[28:31], v[24:27]
    v_mfma_f32_16x16x32_bf16 v[16:19], a[36:39], v[28:31], v[16:19]
    v_mfma_f32_16x16x32_bf16 v[20:23], a[116:119], v[28:31], v[20:23]
    v_mfma_f32_16x16x32_bf16 v[24:27], a[196:199], v[28:31], v[24:27]
    s_barrier
    ds_read_b64_tr_b16 a[40:41], v32 offset:25600
    ds_read_b64_tr_b16 a[42:43], v32 offset:32000
    ds_read_b64_tr_b16 a[44:45], v32 offset:38400
    ds_read_b64_tr_b16 a[46:47], v32 offset:44800
    ds_read_b64_tr_b16 a[120:121], v32 offset:25632
    ds_read_b64_tr_b16 a[122:123], v32 offset:32032
    ds_read_b64_tr_b16 a[124:125], v32 offset:38432
    ds_read_b64_tr_b16 a[126:127], v32 offset:44832
    ds_read_b64_tr_b16 a[200:201], v32 offset:25664
    ds_read_b64_tr_b16 a[202:203], v32 offset:32064
    ds_read_b64_tr_b16 a[204:205], v32 offset:38464
    ds_read_b64_tr_b16 a[206:207], v32 offset:44864
    s_waitcnt vmcnt(18)
    ds_write_b128 v10, v[200:203] offset:0
    ds_write_b128 v11, v[204:207] offset:0
    ds_write_b128 v12, v[208:211] offset:0
    ds_write_b128 v13, v[212:215] offset:0
    ds_write_b128 v14, v[216:219] offset:0
    ds_write_b128 v15, v[220:223] offset:0
    s_waitcnt lgkmcnt(0)
    v_mfma_f32_16x16x32_bf16 v[16:19], a[40:43], v[28:31], v[16:19]
    v_mfma_f32_16x16x32_bf16 v[20:23], a[120:123], v[28:31], v[20:23]
    v_mfma_f32_16x16x32_bf16 v[24:27], a[200:203], v[28:31], v[24:27]
    v_mfma_f32_16x16x32_bf16 v[16:19], a[44:47], v[28:31], v[16:19]
    v_mfma_f32_16x16x32_bf16 v[20:23], a[124:127], v[28:31], v[20:23]
    v_mfma_f32_16x16x32_bf16 v[24:27], a[204:207], v[28:31], v[24:27]
    s_barrier
    ds_read_b64_tr_b16 a[48:49], v32 offset:0
    ds_read_b64_tr_b16 a[50:51], v32 offset:6400
    ds_read_b64_tr_b16 a[52:53], v32 offset:12800
    ds_read_b64_tr_b16 a[54:55], v32 offset:19200
    ds_read_b64_tr_b16 a[128:129], v32 offset:32
    ds_read_b64_tr_b16 a[130:131], v32 offset:6432
    ds_read_b64_tr_b16 a[132:133], v32 offset:12832
    ds_read_b64_tr_b16 a[134:135], v32 offset:19232
    ds_read_b64_tr_b16 a[208:209], v32 offset:64
    ds_read_b64_tr_b16 a[210:211], v32 offset:6464
    ds_read_b64_tr_b16 a[212:213], v32 offset:12864
    ds_read_b64_tr_b16 a[214:215], v32 offset:19264
    s_waitcnt vmcnt(12)
    ds_write_b128 v10, v[224:227] offset:25600
    ds_write_b128 v11, v[228:231] offset:25600
    ds_write_b128 v12, v[232:235] offset:25600
    ds_write_b128 v13, v[236:239] offset:25600
    ds_write_b128 v14, v[240:243] offset:25600
    ds_write_b128 v15, v[244:247] offset:25600
    s_waitcnt lgkmcnt(0)
    v_mfma_f32_16x16x32_bf16 v[16:19], a[48:51], v[28:31], v[16:19]
    v_mfma_f32_16x16x32_bf16 v[20:23], a[128:131], v[28:31], v[20:23]
    v_mfma_f32_16x16x32_bf16 v[24:27], a[208:211], v[28:31], v[24:27]
    v_mfma_f32_16x16x32_bf16 v[16:19], a[52:55], v[28:31], v[16:19]
    v_mfma_f32_16x16x32_bf16 v[20:23], a[132:135], v[28:31], v[20:23]
    v_mfma_f32_16x16x32_bf16 v[24:27], a[212:215], v[28:31], v[24:27]
    s_barrier
    ds_read_b64_tr_b16 a[56:57], v32 offset:25600
    ds_read_b64_tr_b16 a[58:59], v32 offset:32000
    ds_read_b64_tr_b16 a[60:61], v32 offset:38400
    ds_read_b64_tr_b16 a[62:63], v32 offset:44800
    ds_read_b64_tr_b16 a[136:137], v32 offset:25632
    ds_read_b64_tr_b16 a[138:139], v32 offset:32032
    ds_read_b64_tr_b16 a[140:141], v32 offset:38432
    ds_read_b64_tr_b16 a[142:143], v32 offset:44832
    ds_read_b64_tr_b16 a[216:217], v32 offset:25664
    ds_read_b64_tr_b16 a[218:219], v32 offset:32064
    ds_read_b64_tr_b16 a[220:221], v32 offset:38464
    ds_read_b64_tr_b16 a[222:223], v32 offset:44864
    s_waitcnt vmcnt(6)
    ds_write_b128 v10, v[56:59] offset:0
    ds_write_b128 v11, v[60:63] offset:0
    ds_write_b128 v12, v[64:67] offset:0
    ds_write_b128 v13, v[68:71] offset:0
    ds_write_b128 v14, v[72:75] offset:0
    ds_write_b128 v15, v[76:79] offset:0
    s_waitcnt lgkmcnt(0)
    v_mfma_f32_16x16x32_bf16 v[16:19], a[56:59], v[28:31], v[16:19]
    v_mfma_f32_16x16x32_bf16 v[20:23], a[136:139], v[28:31], v[20:23]
    v_mfma_f32_16x16x32_bf16 v[24:27], a[216:219], v[28:31], v[24:27]
    v_mfma_f32_16x16x32_bf16 v[16:19], a[60:63], v[28:31], v[16:19]
    v_mfma_f32_16x16x32_bf16 v[20:23], a[140:143], v[28:31], v[20:23]
    v_mfma_f32_16x16x32_bf16 v[24:27], a[220:223], v[28:31], v[24:27]
    s_barrier
    ds_read_b64_tr_b16 a[64:65], v32 offset:0
    ds_read_b64_tr_b16 a[66:67], v32 offset:6400
    ds_read_b64_tr_b16 a[68:69], v32 offset:12800
    ds_read_b64_tr_b16 a[70:71], v32 offset:19200
    ds_read_b64_tr_b16 a[144:145], v32 offset:32
    ds_read_b64_tr_b16 a[146:147], v32 offset:6432
    ds_read_b64_tr_b16 a[148:149], v32 offset:12832
    ds_read_b64_tr_b16 a[150:151], v32 offset:19232
    ds_read_b64_tr_b16 a[224:225], v32 offset:64
    ds_read_b64_tr_b16 a[226:227], v32 offset:6464
    ds_read_b64_tr_b16 a[228:229], v32 offset:12864
    ds_read_b64_tr_b16 a[230:231], v32 offset:19264
    s_waitcnt vmcnt(0)
    ds_write_b128 v10, v[80:83] offset:25600
    ds_write_b128 v11, v[84:87] offset:25600
    ds_write_b128 v12, v[88:91] offset:25600
    ds_write_b128 v13, v[92:95] offset:25600
    ds_write_b128 v14, v[96:99] offset:25600
    ds_write_b128 v15, v[100:103] offset:25600
    s_waitcnt lgkmcnt(0)
    v_mfma_f32_16x16x32_bf16 v[16:19], a[64:67], v[28:31], v[16:19]
    v_mfma_f32_16x16x32_bf16 v[20:23], a[144:147], v[28:31], v[20:23]
    v_mfma_f32_16x16x32_bf16 v[24:27], a[224:227], v[28:31], v[24:27]
    v_mfma_f32_16x16x32_bf16 v[16:19], a[68:71], v[28:31], v[16:19]
    v_mfma_f32_16x16x32_bf16 v[20:23], a[148:151], v[28:31], v[20:23]
    v_mfma_f32_16x16x32_bf16 v[24:27], a[228:231], v[28:31], v[24:27]
    s_barrier
    ds_read_b64_tr_b16 a[72:73], v32 offset:25600
    ds_read_b64_tr_b16 a[74:75], v32 offset:32000
    ds_read_b64_tr_b16 a[76:77], v32 offset:38400
    ds_read_b64_tr_b16 a[78:79], v32 offset:44800
    ds_read_b64_tr_b16 a[152:153], v32 offset:25632
    ds_read_b64_tr_b16 a[154:155], v32 offset:32032
    ds_read_b64_tr_b16 a[156:157], v32 offset:38432
    ds_read_b64_tr_b16 a[158:159], v32 offset:44832
    ds_read_b64_tr_b16 a[232:233], v32 offset:25664
    ds_read_b64_tr_b16 a[234:235], v32 offset:32064
    ds_read_b64_tr_b16 a[236:237], v32 offset:38464
    ds_read_b64_tr_b16 a[238:239], v32 offset:44864
    s_waitcnt lgkmcnt(0)
    v_mfma_f32_16x16x32_bf16 v[16:19], a[72:75], v[28:31], v[16:19]
    v_mfma_f32_16x16x32_bf16 v[20:23], a[152:155], v[28:31], v[20:23]
    v_mfma_f32_16x16x32_bf16 v[24:27], a[232:235], v[28:31], v[24:27]
    v_mfma_f32_16x16x32_bf16 v[16:19], a[76:79], v[28:31], v[16:19]
    v_mfma_f32_16x16x32_bf16 v[20:23], a[156:159], v[28:31], v[20:23]
    v_mfma_f32_16x16x32_bf16 v[24:27], a[236:239], v[28:31], v[24:27]
    s_nop 5
    v_mov_b32 v224, v16
    v_mov_b32 v225, v17
    v_mov_b32 v226, v18
    v_mov_b32 v227, v19
    v_mov_b32 v228, v20
    v_mov_b32 v229, v21
    v_mov_b32 v230, v22
    v_mov_b32 v231, v23
    v_mov_b32 v232, v24
    v_mov_b32 v233, v25
    v_mov_b32 v234, v26
    v_mov_b32 v235, v27
    v_mov_b32 v236, v28
    v_mov_b32 v237, v29
    v_mov_b32 v238, v30
    v_mov_b32 v239, v31
    s_barrier
interleave_layers__linear_attn_block__memory_aug_recurrent_mem_tr__prompt_kernel_p_layer:
    s_mul_i32 s93, s92, 29360128
    s_add_u32 s93, s93, 117440512
    s_mul_i32 s94, s92, 16384
    s_add_u32 s94, s94, 23068672
    s_sub_u32 s44, s2, 104
    s_lshr_b32 s46, s44, 5
    s_and_b32 s44, s44, 31
    s_mov_b32 s43, 67108864
    s_cmp_eq_u32 s46, 1
    s_cselect_b32 s43, 92274688, s43
    s_cmp_eq_u32 s46, 2
    s_cselect_b32 s43, 33554432, s43
    s_cmp_eq_u32 s92, 0
    s_cselect_b32 s73, 0, 8388608
    v_lshlrev_b32 v5, 4, v1
    s_mul_i32 s24, s3, 10240
    v_add_u32 v6, s24, v5
    v_add_u32 v7, 4096, v6
    v_add_u32 v8, 8192, v6
    s_mul_i32 s24, s44, 12288
    s_mul_i32 s25, s3, 3072
    s_add_u32 s24, s24, s25
    v_add_u32 v11, s24, v5
    s_lshr_b32 s24, s3, 1
    s_lshl_b32 s24, s24, 8
    s_and_b32 s25, s3, 1
    s_lshl_b32 s25, s25, 3
    s_add_u32 s24, s24, s25
    s_add_u32 s24, s24, 81920
    v_lshlrev_b32 v13, 4, v2
    v_add_u32 v12, s24, v13
    v_add_u32 v13, 81920, v13
    v_lshrrev_b32 v15, 2, v2
    v_cmp_eq_u32 vcc, v15, v3
    v_lshlrev_b32 v15, 3, v1
    v_add_u32 v15, 82944, v15
    v_cndmask_b32 v12, v15, v12, vcc
    v_and_b32 v15, 3, v2
    v_cmp_eq_u32 s[48:49], 1, v15
    v_cmp_eq_u32 s[50:51], 2, v15
    v_cmp_eq_u32 s[54:55], 3, v15
    s_and_b32 s24, s2, 7
    s_lshl_b32 s24, s24, 7
    s_lshl_b32 s25, s92, 10
    s_add_u32 s24, s24, s25
    s_add_u32 s24, s24, 23105536
    s_cmp_eq_u32 s92, 0
    s_cselect_b32 s25, 20, 5
    s_cselect_b32 s75, 2, 0
    s_cselect_b32 s74, 16, 64
    v_cmp_gt_u32 vcc, s25, v1
    s_nop 1
    v_cndmask_b32 v4, 0, v1, vcc
    v_lshlrev_b32 v4, 2, v4
    v_add_u32 v4, s24, v4
    s_lshl_b32 s24, s46, 12
    s_lshl_b32 s25, s44, 7
    s_add_u32 s24, s24, s25
    s_add_u32 s24, s24, s94
    v_mov_b32 v14, s24
    v_mov_b32 v15, 2146435072
    v_cmp_eq_u32 vcc, 0, v1
    s_nop 1
    v_cndmask_b32 v14, v15, v14, vcc
    s_cmp_eq_u32 s3, 0
    s_cselect_b32 s24, 0, 2146435072
    v_or_b32 v14, s24, v14
    s_sub_u32 s70, s2, 104
    s_mul_i32 s71, s70, 205
    s_lshr_b32 s71, s71, 12
    s_mul_i32 s24, s71, 20
    s_sub_u32 s70, s70, s24
    s_cmp_lt_u32 s71, 4
    s_cselect_b32 s64, s71, 64
    s_lshl_b32 s24, s70, 16
    s_lshl_b32 s25, s3, 13
    s_add_u32 s24, s24, s25
    v_add_u32 v240, s24, v5
    v_add_u32 v241, 4096, v240
    s_lshl_b32 s24, s70, 14
    s_lshl_b32 s25, s3, 11
    s_add_u32 s24, s24, s25
    v_add_u32 v242, s24, v5
    s_lshl_b32 s24, s3, 14
    v_add_u32 v193, s24, v5
    v_add_u32 v212, 0, v193
    v_add_u32 v213, 4096, v193
    v_add_u32 v214, 8192, v193
    v_add_u32 v215, 12288, v193
    s_lshl_b32 s24, s3, 12
    s_add_u32 s24, s24, 65536
    v_add_u32 v216, s24, v5
    s_lshl_b32 s24, s3, 12
    s_add_u32 s24, s24, 83968
    v_add_u32 v217, s24, v5
    s_and_b32 s24, s3, 1
    s_lshl_b32 s24, s24, 10
    s_add_u32 s24, s24, 83968
    v_add_u32 v218, s24, v5
    s_and_b32 s24, s3, 1
    s_mul_i32 s24, s24, 20480
    s_lshl_b32 s25, s70, 10
    s_add_u32 s24, s24, s25
    v_add_u32 v219, s24, v5
    s_and_b32 s24, s3, 1
    s_lshl_b32 s24, s24, 4
    v_add_u32 v243, s24, v2
    v_mul_u32_u24 v243, 1280, v243
    v_lshl_add_u32 v243, v3, 3, v243
    s_lshl_b32 s24, s70, 6
    v_add_u32 v243, s24, v243
    s_load_dwordx2 s[26:27], s[0:1], 80
    s_waitcnt lgkmcnt(0)
    s_mov_b32 s12, s26
    s_mov_b32 s13, s27
    s_mov_b32 s14, 2621440
    s_mov_b32 s15, 0x00020000
    s_mul_i32 s65, s71, 1310720
    s_add_u32 s65, s65, 184549376
    s_mul_i32 s24, s71, 458752
    s_add_u32 s24, s24, s93
    s_add_u32 s66, s24, 0
    s_add_u32 s67, s24, 327680
    s_mul_i32 s68, s71, 40960
    v_and_b32 v252, 7, v1
    v_lshlrev_b32 v252, 7, v252
    s_lshl_b32 s24, s3, 10
    s_add_u32 s24, s24, 12288
    s_add_u32 s24, s24, s94
    v_add_u32 v252, s24, v252
    s_mov_b32 s69, -1
    s_lshl_b32 s24, s71, 7
    s_lshl_b32 s25, s70, 2
    s_add_u32 s24, s24, s25
    s_add_u32 s24, s24, 23107584
    s_cmp_eq_u32 s3, 0
    s_cselect_b32 s24, s24, 2146435072
    v_mov_b32 v245, s24
    v_mov_b32 v246, 2146435072
    v_cmp_eq_u32 vcc, 0, v1
    s_nop 1
    v_cndmask_b32 v245, v246, v245, vcc
    s_mov_b32 s79, -1
    s_mov_b32 s62, -1
    s_mov_b32 s63, 1
    s_cmp_ge_i32 s62, s63
    s_cbranch_scc1 interleave_layers__linear_attn_block__memory_aug_recurrent_mem_tr__prompt_kernel_p_en0_ok
    s_mov_b32 s61, 0
interleave_layers__linear_attn_block__memory_aug_recurrent_mem_tr__prompt_kernel_p_en0:
    buffer_load_dword v16, v4, s[8:11], 0 offen sc1
    s_waitcnt vmcnt(0)
    v_readlane_b32 s62, v16, 0
    v_readlane_b32 s24, v16, 1
    s_min_i32 s62, s62, s24
    v_readlane_b32 s24, v16, 2
    s_min_i32 s62, s62, s24
    v_readlane_b32 s24, v16, 3
    s_min_i32 s62, s62, s24
    v_readlane_b32 s24, v16, 4
    s_min_i32 s62, s62, s24
    v_readlane_b32 s24, v16, 5
    s_min_i32 s62, s62, s24
    v_readlane_b32 s24, v16, 6
    s_min_i32 s62, s62, s24
    v_readlane_b32 s24, v16, 7
    s_min_i32 s62, s62, s24
    v_readlane_b32 s24, v16, 8
    s_min_i32 s62, s62, s24
    v_readlane_b32 s24, v16, 9
    s_min_i32 s62, s62, s24
    v_readlane_b32 s24, v16, 10
    s_min_i32 s62, s62, s24
    v_readlane_b32 s24, v16, 11
    s_min_i32 s62, s62, s24
    v_readlane_b32 s24, v16, 12
    s_min_i32 s62, s62, s24
    v_readlane_b32 s24, v16, 13
    s_min_i32 s62, s62, s24
    v_readlane_b32 s24, v16, 14
    s_min_i32 s62, s62, s24
    v_readlane_b32 s24, v16, 15
    s_min_i32 s62, s62, s24
    v_readlane_b32 s24, v16, 16
    s_min_i32 s62, s62, s24
    v_readlane_b32 s24, v16, 17
    s_min_i32 s62, s62, s24
    v_readlane_b32 s24, v16, 18
    s_min_i32 s62, s62, s24
    v_readlane_b32 s24, v16, 19
    s_min_i32 s62, s62, s24
    s_cmp_ge_i32 s62, s63
    s_cbranch_scc1 interleave_layers__linear_attn_block__memory_aug_recurrent_mem_tr__prompt_kernel_p_en0_ok
    s_add_u32 s61, s61, 1
    s_cmp_ge_u32 s61, s60
    s_cbranch_scc1 interleave_layers__linear_attn_block__memory_aug_recurrent_mem_tr__prompt_kernel_p_en0_to
    s_sleep 2
    s_branch interleave_layers__linear_attn_block__memory_aug_recurrent_mem_tr__prompt_kernel_p_en0
interleave_layers__linear_attn_block__memory_aug_recurrent_mem_tr__prompt_kernel_p_en0_to:
    s_mov_b32 s60, 1
interleave_layers__linear_attn_block__memory_aug_recurrent_mem_tr__prompt_kernel_p_en0_ok:
    s_mov_b32 s41, s73
    buffer_load_dwordx4 v[16:19], v6, s[8:11], s41 offen offset:0
    buffer_load_dwordx4 v[20:23], v6, s[8:11], s41 offen offset:1024
    buffer_load_dwordx4 v[24:27], v6, s[8:11], s41 offen offset:2048
    buffer_load_dwordx4 v[28:31], v6, s[8:11], s41 offen offset:3072
    buffer_load_dwordx4 v[32:35], v7, s[8:11], s41 offen offset:0
    buffer_load_dwordx4 v[36:39], v7, s[8:11], s41 offen offset:1024
    buffer_load_dwordx4 v[40:43], v7, s[8:11], s41 offen offset:2048
    buffer_load_dwordx4 v[44:47], v7, s[8:11], s41 offen offset:3072
    buffer_load_dwordx4 v[48:51], v8, s[8:11], s41 offen offset:0
    buffer_load_dwordx4 v[52:55], v8, s[8:11], s41 offen offset:1024
    s_mov_b32 s40, 0
    s_mov_b32 s42, 0
    s_waitcnt vmcnt(0)
    v_mfma_f32_16x16x32_bf16 v[148:151], v[16:19], v[16:19], 0
    v_mfma_f32_16x16x32_bf16 v[144:147], v[236:239], v[16:19], 0
    v_mfma_f32_16x16x32_bf16 v[148:151], v[20:23], v[20:23], v[148:151]
    v_mfma_f32_16x16x32_bf16 v[144:147], v[236:239], v[20:23], v[144:147]
    v_mfma_f32_16x16x32_bf16 v[148:151], v[24:27], v[24:27], v[148:151]
    v_mfma_f32_16x16x32_bf16 v[144:147], v[236:239], v[24:27], v[144:147]
    v_mfma_f32_16x16x32_bf16 v[148:151], v[28:31], v[28:31], v[148:151]
    v_mfma_f32_16x16x32_bf16 v[144:147], v[236:239], v[28:31], v[144:147]
    v_mfma_f32_16x16x32_bf16 v[148:151], v[32:35], v[32:35], v[148:151]
    v_mfma_f32_16x16x32_bf16 v[144:147], v[236:239], v[32:35], v[144:147]
    v_mfma_f32_16x16x32_bf16 v[148:151], v[36:39], v[36:39], v[148:151]
    v_mfma_f32_16x16x32_bf16 v[144:147], v[236:239], v[36:39], v[144:147]
    v_mfma_f32_16x16x32_bf16 v[148:151], v[40:43], v[40:43], v[148:151]
    v_mfma_f32_16x16x32_bf16 v[144:147], v[236:239], v[40:43], v[144:147]
    v_mfma_f32_16x16x32_bf16 v[148:151], v[44:47], v[44:47], v[148:151]
    v_mfma_f32_16x16x32_bf16 v[144:147], v[236:239], v[44:47], v[144:147]
    v_mfma_f32_16x16x32_bf16 v[148:151], v[48:51], v[48:51], v[148:151]
    v_mfma_f32_16x16x32_bf16 v[144:147], v[236:239], v[48:51], v[144:147]
    v_mfma_f32_16x16x32_bf16 v[148:151], v[52:55], v[52:55], v[148:151]
    v_mfma_f32_16x16x32_bf16 v[144:147], v[236:239], v[52:55], v[144:147]
    ds_write_b128 v6, v[16:19] offset:0
    ds_write_b128 v6, v[20:23] offset:1024
    ds_write_b128 v6, v[24:27] offset:2048
    ds_write_b128 v6, v[28:31] offset:3072
    ds_write_b128 v6, v[32:35] offset:4096
    ds_write_b128 v6, v[36:39] offset:5120
    ds_write_b128 v6, v[40:43] offset:6144
    ds_write_b128 v6, v[44:47] offset:7168
    ds_write_b128 v6, v[48:51] offset:8192
    ds_write_b128 v6, v[52:55] offset:9216
    v_cndmask_b32 v145, v148, v149, s[48:49]
    v_cndmask_b32 v145, v145, v150, s[50:51]
    v_cndmask_b32 v145, v145, v151, s[54:55]
    ds_write_b64 v12, v[144:145]
    s_waitcnt lgkmcnt(0)
    s_barrier
interleave_layers__linear_attn_block__memory_aug_recurrent_mem_tr__prompt_kernel_p_segA:
    v_add_u32 v9, s42, v5
    s_xor_b32 s42, s42, 40960
    v_add_u32 v10, s42, v6
    s_and_b32 s24, s40, 1
    s_lshl_b32 s24, s24, 9
    v_add_u32 v124, s24, v13
    s_xor_b32 s24, s24, 512
    v_add_u32 v140, s24, v12
    ds_read_b128 v[112:115], v124
    ds_read_b128 v[116:119], v124 offset:256
    ds_read_b128 v[56:59], v9 offset:0
    ds_read_b128 v[60:63], v9 offset:20480
    ds_read_b128 v[64:67], v9 offset:1024
    ds_read_b128 v[68:71], v9 offset:21504
    ds_read_b128 v[72:75], v9 offset:2048
    ds_read_b128 v[76:79], v9 offset:22528
    ds_read_b128 v[80:83], v9 offset:3072
    ds_read_b128 v[84:87], v9 offset:23552
    s_waitcnt lgkmcnt(6)
    v_mfma_f32_16x16x32_bf16 v[88:91], a[0:3], v[56:59], 0
    v_add_f32 v112, v112, v114
    v_mfma_f32_16x16x32_bf16 v[92:95], a[80:83], v[56:59], 0
    v_add_f32 v113, v113, v115
    v_mfma_f32_16x16x32_bf16 v[96:99], a[160:163], v[56:59], 0
    v_mul_f32 v112, 0x3acccccd, v112
    v_mfma_f32_16x16x32_bf16 v[100:103], a[0:3], v[60:63], 0
    v_mul_f32 v114, v112, v112
    v_mfma_f32_16x16x32_bf16 v[104:107], a[80:83], v[60:63], 0
    v_mov_b32 v115, 0x3acccccd
    v_mfma_f32_16x16x32_bf16 v[108:111], a[160:163], v[60:63], 0
    v_fma_f32 v113, v113, v115, -v114
    ds_read_b128 v[56:59], v9 offset:4096
    ds_read_b128 v[60:63], v9 offset:24576
    s_waitcnt lgkmcnt(6)
    v_mfma_f32_16x16x32_bf16 v[88:91], a[4:7], v[64:67], v[88:91]
    v_max_f32 v113, 0, v113
    v_mfma_f32_16x16x32_bf16 v[92:95], a[84:87], v[64:67], v[92:95]
    v_add_f32 v113, 0x3727c5ac, v113
    v_mfma_f32_16x16x32_bf16 v[96:99], a[164:167], v[64:67], v[96:99]
    v_rsq_f32 v132, v113
    v_mfma_f32_16x16x32_bf16 v[100:103], a[4:7], v[68:71], v[100:103]
    v_mul_f32 v133, v112, v132
    v_mfma_f32_16x16x32_bf16 v[104:107], a[84:87], v[68:71], v[104:107]
    v_sub_f32 v133, 0, v133
    v_mfma_f32_16x16x32_bf16 v[108:111], a[164:167], v[68:71], v[108:111]
    v_add_f32 v116, v116, v118
    ds_read_b128 v[64:67], v9 offset:5120
    ds_read_b128 v[68:71], v9 offset:25600
    s_waitcnt lgkmcnt(6)
    v_mfma_f32_16x16x32_bf16 v[88:91], a[8:11], v[72:75], v[88:91]
    v_add_f32 v117, v117, v119
    v_mfma_f32_16x16x32_bf16 v[92:95], a[88:91], v[72:75], v[92:95]
    v_mul_f32 v116, 0x3acccccd, v116
    v_mfma_f32_16x16x32_bf16 v[96:99], a[168:171], v[72:75], v[96:99]
    v_mul_f32 v118, v116, v116
    v_mfma_f32_16x16x32_bf16 v[100:103], a[8:11], v[76:79], v[100:103]
    v_mov_b32 v119, 0x3acccccd
    v_mfma_f32_16x16x32_bf16 v[104:107], a[88:91], v[76:79], v[104:107]
    v_fma_f32 v117, v117, v119, -v118
    v_mfma_f32_16x16x32_bf16 v[108:111], a[168:171], v[76:79], v[108:111]
    v_max_f32 v117, 0, v117
    ds_read_b128 v[72:75], v9 offset:6144
    ds_read_b128 v[76:79], v9 offset:26624
    s_waitcnt lgkmcnt(6)
    v_mfma_f32_16x16x32_bf16 v[88:91], a[12:15], v[80:83], v[88:91]
    v_add_f32 v117, 0x3727c5ac, v117
    v_mfma_f32_16x16x32_bf16 v[92:95], a[92:95], v[80:83], v[92:95]
    v_rsq_f32 v134, v117
    v_mfma_f32_16x16x32_bf16 v[96:99], a[172:175], v[80:83], v[96:99]
    v_mul_f32 v135, v116, v134
    v_mfma_f32_16x16x32_bf16 v[100:103], a[12:15], v[84:87], v[100:103]
    v_sub_f32 v135, 0, v135
    v_mfma_f32_16x16x32_bf16 v[104:107], a[92:95], v[84:87], v[104:107]
    v_mfma_f32_16x16x32_bf16 v[108:111], a[172:175], v[84:87], v[108:111]
    ds_read_b128 v[80:83], v9 offset:7168
    ds_read_b128 v[84:87], v9 offset:27648
    s_waitcnt lgkmcnt(6)
    v_mfma_f32_16x16x32_bf16 v[88:91], a[16:19], v[56:59], v[88:91]
    v_mfma_f32_16x16x32_bf16 v[92:95], a[96:99], v[56:59], v[92:95]
    v_mfma_f32_16x16x32_bf16 v[96:99], a[176:179], v[56:59], v[96:99]
    v_mfma_f32_16x16x32_bf16 v[100:103], a[16:19], v[60:63], v[100:103]
    v_mfma_f32_16x16x32_bf16 v[104:107], a[96:99], v[60:63], v[104:107]
    v_mfma_f32_16x16x32_bf16 v[108:111], a[176:179], v[60:63], v[108:111]
    ds_read_b128 v[56:59], v9 offset:8192
    ds_read_b128 v[60:63], v9 offset:28672
    s_waitcnt lgkmcnt(6)
    v_mfma_f32_16x16x32_bf16 v[88:91], a[20:23], v[64:67], v[88:91]
    v_mfma_f32_16x16x32_bf16 v[92:95], a[100:103], v[64:67], v[92:95]
    v_mfma_f32_16x16x32_bf16 v[96:99], a[180:183], v[64:67], v[96:99]
    v_mfma_f32_16x16x32_bf16 v[100:103], a[20:23], v[68:71], v[100:103]
    v_mfma_f32_16x16x32_bf16 v[104:107], a[100:103], v[68:71], v[104:107]
    v_mfma_f32_16x16x32_bf16 v[108:111], a[180:183], v[68:71], v[108:111]
    ds_read_b128 v[64:67], v9 offset:9216
    ds_read_b128 v[68:71], v9 offset:29696
    s_waitcnt lgkmcnt(6)
    v_mfma_f32_16x16x32_bf16 v[88:91], a[24:27], v[72:75], v[88:91]
    v_mfma_f32_16x16x32_bf16 v[92:95], a[104:107], v[72:75], v[92:95]
    v_mfma_f32_16x16x32_bf16 v[96:99], a[184:187], v[72:75], v[96:99]
    v_mfma_f32_16x16x32_bf16 v[100:103], a[24:27], v[76:79], v[100:103]
    v_mfma_f32_16x16x32_bf16 v[104:107], a[104:107], v[76:79], v[104:107]
    v_mfma_f32_16x16x32_bf16 v[108:111], a[184:187], v[76:79], v[108:111]
    ds_read_b128 v[72:75], v9 offset:10240
    ds_read_b128 v[76:79], v9 offset:30720
    s_waitcnt lgkmcnt(6)
    v_mfma_f32_16x16x32_bf16 v[88:91], a[28:31], v[80:83], v[88:91]
    v_mfma_f32_16x16x32_bf16 v[92:95], a[108:111], v[80:83], v[92:95]
    v_mfma_f32_16x16x32_bf16 v[96:99], a[188:191], v[80:83], v[96:99]
    v_mfma_f32_16x16x32_bf16 v[100:103], a[28:31], v[84:87], v[100:103]
    v_mfma_f32_16x16x32_bf16 v[104:107], a[108:111], v[84:87], v[104:107]
    v_mfma_f32_16x16x32_bf16 v[108:111], a[188:191], v[84:87], v[108:111]
    ds_read_b128 v[80:83], v9 offset:11264
    ds_read_b128 v[84:87], v9 offset:31744
    s_waitcnt lgkmcnt(6)
    v_mfma_f32_16x16x32_bf16 v[88:91], a[32:35], v[56:59], v[88:91]
    v_mfma_f32_16x16x32_bf16 v[92:95], a[112:115], v[56:59], v[92:95]
    v_mfma_f32_16x16x32_bf16 v[96:99], a[192:195], v[56:59], v[96:99]
    v_mfma_f32_16x16x32_bf16 v[100:103], a[32:35], v[60:63], v[100:103]
    v_mfma_f32_16x16x32_bf16 v[104:107], a[112:115], v[60:63], v[104:107]
    v_mfma_f32_16x16x32_bf16 v[108:111], a[192:195], v[60:63], v[108:111]
    ds_read_b128 v[56:59], v9 offset:12288
    ds_read_b128 v[60:63], v9 offset:32768
    s_waitcnt lgkmcnt(6)
    v_mfma_f32_16x16x32_bf16 v[88:91], a[36:39], v[64:67], v[88:91]
    v_mfma_f32_16x16x32_bf16 v[92:95], a[116:119], v[64:67], v[92:95]
    v_mfma_f32_16x16x32_bf16 v[96:99], a[196:199], v[64:67], v[96:99]
    v_mfma_f32_16x16x32_bf16 v[100:103], a[36:39], v[68:71], v[100:103]
    v_mfma_f32_16x16x32_bf16 v[104:107], a[116:119], v[68:71], v[104:107]
    v_mfma_f32_16x16x32_bf16 v[108:111], a[196:199], v[68:71], v[108:111]
    ds_read_b128 v[64:67], v9 offset:13312
    ds_read_b128 v[68:71], v9 offset:33792
    s_waitcnt lgkmcnt(6)
    v_mfma_f32_16x16x32_bf16 v[88:91], a[40:43], v[72:75], v[88:91]
    v_mfma_f32_16x16x32_bf16 v[92:95], a[120:123], v[72:75], v[92:95]
    v_mfma_f32_16x16x32_bf16 v[96:99], a[200:203], v[72:75], v[96:99]
    v_mfma_f32_16x16x32_bf16 v[100:103], a[40:43], v[76:79], v[100:103]
    v_mfma_f32_16x16x32_bf16 v[104:107], a[120:123], v[76:79], v[104:107]
    v_mfma_f32_16x16x32_bf16 v[108:111], a[200:203], v[76:79], v[108:111]
    ds_read_b128 v[72:75], v9 offset:14336
    ds_read_b128 v[76:79], v9 offset:34816
    s_waitcnt lgkmcnt(6)
    v_mfma_f32_16x16x32_bf16 v[88:91], a[44:47], v[80:83], v[88:91]
    v_mfma_f32_16x16x32_bf16 v[92:95], a[124:127], v[80:83], v[92:95]
    v_mfma_f32_16x16x32_bf16 v[96:99], a[204:207], v[80:83], v[96:99]
    v_mfma_f32_16x16x32_bf16 v[100:103], a[44:47], v[84:87], v[100:103]
    v_mfma_f32_16x16x32_bf16 v[104:107], a[124:127], v[84:87], v[104:107]
    v_mfma_f32_16x16x32_bf16 v[108:111], a[204:207], v[84:87], v[108:111]
    ds_read_b128 v[80:83], v9 offset:15360
    ds_read_b128 v[84:87], v9 offset:35840
    s_waitcnt lgkmcnt(6)
    v_mfma_f32_16x16x32_bf16 v[88:91], a[48:51], v[56:59], v[88:91]
    v_mfma_f32_16x16x32_bf16 v[92:95], a[128:131], v[56:59], v[92:95]
    v_mfma_f32_16x16x32_bf16 v[96:99], a[208:211], v[56:59], v[96:99]
    v_mfma_f32_16x16x32_bf16 v[100:103], a[48:51], v[60:63], v[100:103]
    v_mfma_f32_16x16x32_bf16 v[104:107], a[128:131], v[60:63], v[104:107]
    v_mfma_f32_16x16x32_bf16 v[108:111], a[208:211], v[60:63], v[108:111]
    ds_read_b128 v[56:59], v9 offset:16384
    ds_read_b128 v[60:63], v9 offset:36864
    s_waitcnt lgkmcnt(6)
    v_mfma_f32_16x16x32_bf16 v[88:91], a[52:55], v[64:67], v[88:91]
    v_mfma_f32_16x16x32_bf16 v[92:95], a[132:135], v[64:67], v[92:95]
    v_mfma_f32_16x16x32_bf16 v[96:99], a[212:215], v[64:67], v[96:99]
    v_mfma_f32_16x16x32_bf16 v[100:103], a[52:55], v[68:71], v[100:103]
    v_mfma_f32_16x16x32_bf16 v[104:107], a[132:135], v[68:71], v[104:107]
    v_mfma_f32_16x16x32_bf16 v[108:111], a[212:215], v[68:71], v[108:111]
    ds_read_b128 v[64:67], v9 offset:17408
    ds_read_b128 v[68:71], v9 offset:37888
    s_waitcnt lgkmcnt(6)
    v_mfma_f32_16x16x32_bf16 v[88:91], a[56:59], v[72:75], v[88:91]
    v_mfma_f32_16x16x32_bf16 v[92:95], a[136:139], v[72:75], v[92:95]
    v_mfma_f32_16x16x32_bf16 v[96:99], a[216:219], v[72:75], v[96:99]
    v_mfma_f32_16x16x32_bf16 v[100:103], a[56:59], v[76:79], v[100:103]
    v_mfma_f32_16x16x32_bf16 v[104:107], a[136:139], v[76:79], v[104:107]
    v_mfma_f32_16x16x32_bf16 v[108:111], a[216:219], v[76:79], v[108:111]
    ds_read_b128 v[72:75], v9 offset:18432
    ds_read_b128 v[76:79], v9 offset:38912
    s_waitcnt lgkmcnt(6)
    v_mfma_f32_16x16x32_bf16 v[88:91], a[60:63], v[80:83], v[88:91]
    v_mfma_f32_16x16x32_bf16 v[92:95], a[140:143], v[80:83], v[92:95]
    v_mfma_f32_16x16x32_bf16 v[96:99], a[220:223], v[80:83], v[96:99]
    v_mfma_f32_16x16x32_bf16 v[100:103], a[60:63], v[84:87], v[100:103]
    v_mfma_f32_16x16x32_bf16 v[104:107], a[140:143], v[84:87], v[104:107]
    v_mfma_f32_16x16x32_bf16 v[108:111], a[220:223], v[84:87], v[108:111]
    ds_read_b128 v[80:83], v9 offset:19456
    ds_read_b128 v[84:87], v9 offset:39936
    s_waitcnt lgkmcnt(6)
    v_mfma_f32_16x16x32_bf16 v[88:91], a[64:67], v[56:59], v[88:91]
    v_mfma_f32_16x16x32_bf16 v[92:95], a[144:147], v[56:59], v[92:95]
    v_mfma_f32_16x16x32_bf16 v[96:99], a[224:227], v[56:59], v[96:99]
    v_mfma_f32_16x16x32_bf16 v[100:103], a[64:67], v[60:63], v[100:103]
    v_mfma_f32_16x16x32_bf16 v[104:107], a[144:147], v[60:63], v[104:107]
    v_mfma_f32_16x16x32_bf16 v[108:111], a[224:227], v[60:63], v[108:111]
    s_waitcnt lgkmcnt(4)
    v_mfma_f32_16x16x32_bf16 v[88:91], a[68:71], v[64:67], v[88:91]
    v_mfma_f32_16x16x32_bf16 v[92:95], a[148:151], v[64:67], v[92:95]
    v_mfma_f32_16x16x32_bf16 v[96:99], a[228:231], v[64:67], v[96:99]
    v_mfma_f32_16x16x32_bf16 v[100:103], a[68:71], v[68:71], v[100:103]
    v_mfma_f32_16x16x32_bf16 v[104:107], a[148:151], v[68:71], v[104:107]
    v_mfma_f32_16x16x32_bf16 v[108:111], a[228:231], v[68:71], v[108:111]
    s_waitcnt lgkmcnt(2)
    v_mfma_f32_16x16x32_bf16 v[88:91], a[72:75], v[72:75], v[88:91]
    v_mfma_f32_16x16x32_bf16 v[92:95], a[152:155], v[72:75], v[92:95]
    v_mfma_f32_16x16x32_bf16 v[96:99], a[232:235], v[72:75], v[96:99]
    v_mfma_f32_16x16x32_bf16 v[100:103], a[72:75], v[76:79], v[100:103]
    v_mfma_f32_16x16x32_bf16 v[104:107], a[152:155], v[76:79], v[104:107]
    v_mfma_f32_16x16x32_bf16 v[108:111], a[232:235], v[76:79], v[108:111]
    s_waitcnt lgkmcnt(0)
    v_mfma_f32_16x16x32_bf16 v[88:91], a[76:79], v[80:83], v[88:91]
    v_mfma_f32_16x16x32_bf16 v[92:95], a[156:159], v[80:83], v[92:95]
    v_mfma_f32_16x16x32_bf16 v[96:99], a[236:239], v[80:83], v[96:99]
    v_mfma_f32_16x16x32_bf16 v[100:103], a[76:79], v[84:87], v[100:103]
    v_mfma_f32_16x16x32_bf16 v[104:107], a[156:159], v[84:87], v[104:107]
    v_mfma_f32_16x16x32_bf16 v[108:111], a[236:239], v[84:87], v[108:111]
    v_pk_mul_f32 v[124:125], v[224:225], v[132:133] op_sel:[0,1] op_sel_hi:[1,1]
    v_pk_mul_f32 v[126:127], v[226:227], v[132:133] op_sel:[0,1] op_sel_hi:[1,1]
    s_nop 0
    v_pk_fma_f32 v[88:89], v[88:89], v[132:133], v[124:125] op_sel:[0,0,0] op_sel_hi:[1,0,1]
    v_pk_fma_f32 v[90:91], v[90:91], v[132:133], v[126:127] op_sel:[0,0,0] op_sel_hi:[1,0,1]
    v_pk_mul_f32 v[124:125], v[228:229], v[132:133] op_sel:[0,1] op_sel_hi:[1,1]
    v_pk_mul_f32 v[126:127], v[230:231], v[132:133] op_sel:[0,1] op_sel_hi:[1,1]
    v_pk_fma_f32 v[92:93], v[92:93], v[132:133], v[124:125] op_sel:[0,0,0] op_sel_hi:[1,0,1]
    v_pk_fma_f32 v[94:95], v[94:95], v[132:133], v[126:127] op_sel:[0,0,0] op_sel_hi:[1,0,1]
    v_pk_mul_f32 v[124:125], v[232:233], v[132:133] op_sel:[0,1] op_sel_hi:[1,1]
    v_pk_mul_f32 v[126:127], v[234:235], v[132:133] op_sel:[0,1] op_sel_hi:[1,1]
    v_pk_fma_f32 v[96:97], v[96:97], v[132:133], v[124:125] op_sel:[0,0,0] op_sel_hi:[1,0,1]
    v_pk_fma_f32 v[98:99], v[98:99], v[132:133], v[126:127] op_sel:[0,0,0] op_sel_hi:[1,0,1]
    v_pk_mul_f32 v[124:125], v[224:225], v[134:135] op_sel:[0,1] op_sel_hi:[1,1]
    v_pk_mul_f32 v[126:127], v[226:227], v[134:135] op_sel:[0,1] op_sel_hi:[1,1]
    v_pk_fma_f32 v[100:101], v[100:101], v[134:135], v[124:125] op_sel:[0,0,0] op_sel_hi:[1,0,1]
    v_pk_fma_f32 v[102:103], v[102:103], v[134:135], v[126:127] op_sel:[0,0,0] op_sel_hi:[1,0,1]
    v_pk_mul_f32 v[124:125], v[228:229], v[134:135] op_sel:[0,1] op_sel_hi:[1,1]
    v_pk_mul_f32 v[126:127], v[230:231], v[134:135] op_sel:[0,1] op_sel_hi:[1,1]
    v_pk_fma_f32 v[104:105], v[104:105], v[134:135], v[124:125] op_sel:[0,0,0] op_sel_hi:[1,0,1]
    v_pk_fma_f32 v[106:107], v[106:107], v[134:135], v[126:127] op_sel:[0,0,0] op_sel_hi:[1,0,1]
    v_pk_mul_f32 v[124:125], v[232:233], v[134:135] op_sel:[0,1] op_sel_hi:[1,1]
    v_pk_mul_f32 v[126:127], v[234:235], v[134:135] op_sel:[0,1] op_sel_hi:[1,1]
    v_pk_fma_f32 v[108:109], v[108:109], v[134:135], v[124:125] op_sel:[0,0,0] op_sel_hi:[1,0,1]
    v_pk_fma_f32 v[110:111], v[110:111], v[134:135], v[126:127] op_sel:[0,0,0] op_sel_hi:[1,0,1]
    v_cvt_pk_bf16_f32 v112, v88, v89
    v_cvt_pk_bf16_f32 v113, v90, v91
    v_cvt_pk_bf16_f32 v114, v92, v93
    v_cvt_pk_bf16_f32 v115, v94, v95
    v_cvt_pk_bf16_f32 v116, v100, v101
    v_cvt_pk_bf16_f32 v117, v102, v103
    v_cvt_pk_bf16_f32 v118, v104, v105
    v_cvt_pk_bf16_f32 v119, v106, v107
    v_cvt_pk_bf16_f32 v120, v96, v97
    v_cvt_pk_bf16_f32 v121, v98, v99
    v_cvt_pk_bf16_f32 v122, v108, v109
    v_cvt_pk_bf16_f32 v123, v110, v111
    buffer_store_dwordx4 v[112:115], v11, s[8:11], s43 offen offset:0 sc1
    buffer_store_dwordx4 v[116:119], v11, s[8:11], s43 offen offset:1024 sc1
    buffer_store_dwordx4 v[120:123], v11, s[8:11], s43 offen offset:2048 sc1
    s_add_u32 s43, s43, 393216
    s_waitcnt vmcnt(0)
    s_barrier
    s_add_u32 s24, s40, 1
    v_mov_b32 v15, s24
    buffer_store_dword v15, v14, s[8:11], 0 offen sc1
    s_add_u32 s63, s40, 1
    s_lshr_b32 s63, s63, s75
    s_add_u32 s63, s63, 1
    s_min_u32 s63, s63, s74
    s_cmp_ge_i32 s62, s63
    s_cbranch_scc1 interleave_layers__linear_attn_block__memory_aug_recurrent_mem_tr__prompt_kernel_p_enA_ok
    s_mov_b32 s61, 0
interleave_layers__linear_attn_block__memory_aug_recurrent_mem_tr__prompt_kernel_p_enA:
    buffer_load_dword v16, v4, s[8:11], 0 offen sc1
    s_waitcnt vmcnt(0)
    v_readlane_b32 s62, v16, 0
    v_readlane_b32 s24, v16, 1
    s_min_i32 s62, s62, s24
    v_readlane_b32 s24, v16, 2
    s_min_i32 s62, s62, s24
    v_readlane_b32 s24, v16, 3
    s_min_i32 s62, s62, s24
    v_readlane_b32 s24, v16, 4
    s_min_i32 s62, s62, s24
    v_readlane_b32 s24, v16, 5
    s_min_i32 s62, s62, s24
    v_readlane_b32 s24, v16, 6
    s_min_i32 s62, s62, s24
    v_readlane_b32 s24, v16, 7
    s_min_i32 s62, s62, s24
    v_readlane_b32 s24, v16, 8
    s_min_i32 s62, s62, s24
    v_readlane_b32 s24, v16, 9
    s_min_i32 s62, s62, s24
    v_readlane_b32 s24, v16, 10
    s_min_i32 s62, s62, s24
    v_readlane_b32 s24, v16, 11
    s_min_i32 s62, s62, s24
    v_readlane_b32 s24, v16, 12
    s_min_i32 s62, s62, s24
    v_readlane_b32 s24, v16, 13
    s_min_i32 s62, s62, s24
    v_readlane_b32 s24, v16, 14
    s_min_i32 s62, s62, s24
    v_readlane_b32 s24, v16, 15
    s_min_i32 s62, s62, s24
    v_readlane_b32 s24, v16, 16
    s_min_i32 s62, s62, s24
    v_readlane_b32 s24, v16, 17
    s_min_i32 s62, s62, s24
    v_readlane_b32 s24, v16, 18
    s_min_i32 s62, s62, s24
    v_readlane_b32 s24, v16, 19
    s_min_i32 s62, s62, s24
    s_cmp_ge_i32 s62, s63
    s_cbranch_scc1 interleave_layers__linear_attn_block__memory_aug_recurrent_mem_tr__prompt_kernel_p_enA_ok
    s_add_u32 s61, s61, 1
    s_cmp_ge_u32 s61, s60
    s_cbranch_scc1 interleave_layers__linear_attn_block__memory_aug_recurrent_mem_tr__prompt_kernel_p_enA_to
    s_sleep 2
    s_branch interleave_layers__linear_attn_block__memory_aug_recurrent_mem_tr__prompt_kernel_p_enA
interleave_layers__linear_attn_block__memory_aug_recurrent_mem_tr__prompt_kernel_p_enA_to:
    s_mov_b32 s60, 1
interleave_layers__linear_attn_block__memory_aug_recurrent_mem_tr__prompt_kernel_p_enA_ok:
    s_add_u32 s41, s41, 40960
    buffer_load_dwordx4 v[16:19], v6, s[8:11], s41 offen offset:0
    buffer_load_dwordx4 v[20:23], v6, s[8:11], s41 offen offset:1024
    buffer_load_dwordx4 v[24:27], v6, s[8:11], s41 offen offset:2048
    buffer_load_dwordx4 v[28:31], v6, s[8:11], s41 offen offset:3072
    buffer_load_dwordx4 v[32:35], v7, s[8:11], s41 offen offset:0
    buffer_load_dwordx4 v[36:39], v7, s[8:11], s41 offen offset:1024
    buffer_load_dwordx4 v[40:43], v7, s[8:11], s41 offen offset:2048
    buffer_load_dwordx4 v[44:47], v7, s[8:11], s41 offen offset:3072
    buffer_load_dwordx4 v[48:51], v8, s[8:11], s41 offen offset:0
    buffer_load_dwordx4 v[52:55], v8, s[8:11], s41 offen offset:1024
    s_waitcnt vmcnt(0)
    v_mfma_f32_16x16x32_bf16 v[148:151], v[16:19], v[16:19], 0
    v_mfma_f32_16x16x32_bf16 v[144:147], v[236:239], v[16:19], 0
    v_mfma_f32_16x16x32_bf16 v[148:151], v[20:23], v[20:23], v[148:151]
    v_mfma_f32_16x16x32_bf16 v[144:147], v[236:239], v[20:23], v[144:147]
    v_mfma_f32_16x16x32_bf16 v[148:151], v[24:27], v[24:27], v[148:151]
    v_mfma_f32_16x16x32_bf16 v[144:147], v[236:239], v[24:27], v[144:147]
    v_mfma_f32_16x16x32_bf16 v[148:151], v[28:31], v[28:31], v[148:151]
    v_mfma_f32_16x16x32_bf16 v[144:147], v[236:239], v[28:31], v[144:147]
    v_mfma_f32_16x16x32_bf16 v[148:151], v[32:35], v[32:35], v[148:151]
    v_mfma_f32_16x16x32_bf16 v[144:147], v[236:239], v[32:35], v[144:147]
    v_mfma_f32_16x16x32_bf16 v[148:151], v[36:39], v[36:39], v[148:151]
    v_mfma_f32_16x16x32_bf16 v[144:147], v[236:239], v[36:39], v[144:147]
    v_mfma_f32_16x16x32_bf16 v[148:151], v[40:43], v[40:43], v[148:151]
    v_mfma_f32_16x16x32_bf16 v[144:147], v[236:239], v[40:43], v[144:147]
    v_mfma_f32_16x16x32_bf16 v[148:151], v[44:47], v[44:47], v[148:151]
    v_mfma_f32_16x16x32_bf16 v[144:147], v[236:239], v[44:47], v[144:147]
    v_mfma_f32_16x16x32_bf16 v[148:151], v[48:51], v[48:51], v[148:151]
    v_mfma_f32_16x16x32_bf16 v[144:147], v[236:239], v[48:51], v[144:147]
    v_mfma_f32_16x16x32_bf16 v[148:151], v[52:55], v[52:55], v[148:151]
    v_mfma_f32_16x16x32_bf16 v[144:147], v[236:239], v[52:55], v[144:147]
    ds_write_b128 v10, v[16:19] offset:0
    ds_write_b128 v10, v[20:23] offset:1024
    ds_write_b128 v10, v[24:27] offset:2048
    ds_write_b128 v10, v[28:31] offset:3072
    ds_write_b128 v10, v[32:35] offset:4096
    ds_write_b128 v10, v[36:39] offset:5120
    ds_write_b128 v10, v[40:43] offset:6144
    ds_write_b128 v10, v[44:47] offset:7168
    ds_write_b128 v10, v[48:51] offset:8192
    ds_write_b128 v10, v[52:55] offset:9216
    v_cndmask_b32 v145, v148, v149, s[48:49]
    v_cndmask_b32 v145, v145, v150, s[50:51]
    v_cndmask_b32 v145, v145, v151, s[54:55]
    ds_write_b64 v140, v[144:145]
    s_add_u32 s40, s40, 1
    s_waitcnt lgkmcnt(0)
    s_barrier
    s_cmp_lt_u32 s40, 2
    s_cbranch_scc1 interleave_layers__linear_attn_block__memory_aug_recurrent_mem_tr__prompt_kernel_p_segA
    s_branch interleave_layers__linear_attn_block__memory_aug_recurrent_mem_tr__prompt_kernel_p_next
interleave_layers__linear_attn_block__memory_aug_recurrent_mem_tr__prompt_kernel_p_seg:
    v_add_u32 v9, s42, v5
    s_xor_b32 s42, s42, 40960
    v_add_u32 v10, s42, v6
    s_add_u32 s63, s40, 1
    s_lshr_b32 s63, s63, s75
    s_add_u32 s63, s63, 1
    s_min_u32 s63, s63, s74
    s_cmp_ge_i32 s62, s63
    s_cbranch_scc1 interleave_layers__linear_attn_block__memory_aug_recurrent_mem_tr__prompt_kernel_p_en_ok
    s_mov_b32 s61, 0
interleave_layers__linear_attn_block__memory_aug_recurrent_mem_tr__prompt_kernel_p_en:
    buffer_load_dword v16, v4, s[8:11], 0 offen sc1
    s_waitcnt vmcnt(0)
    v_readlane_b32 s62, v16, 0
    v_readlane_b32 s24, v16, 1
    s_min_i32 s62, s62, s24
    v_readlane_b32 s24, v16, 2
    s_min_i32 s62, s62, s24
    v_readlane_b32 s24, v16, 3
    s_min_i32 s62, s62, s24
    v_readlane_b32 s24, v16, 4
    s_min_i32 s62, s62, s24
    v_readlane_b32 s24, v16, 5
    s_min_i32 s62, s62, s24
    v_readlane_b32 s24, v16, 6
    s_min_i32 s62, s62, s24
    v_readlane_b32 s24, v16, 7
    s_min_i32 s62, s62, s24
    v_readlane_b32 s24, v16, 8
    s_min_i32 s62, s62, s24
    v_readlane_b32 s24, v16, 9
    s_min_i32 s62, s62, s24
    v_readlane_b32 s24, v16, 10
    s_min_i32 s62, s62, s24
    v_readlane_b32 s24, v16, 11
    s_min_i32 s62, s62, s24
    v_readlane_b32 s24, v16, 12
    s_min_i32 s62, s62, s24
    v_readlane_b32 s24, v16, 13
    s_min_i32 s62, s62, s24
    v_readlane_b32 s24, v16, 14
    s_min_i32 s62, s62, s24
    v_readlane_b32 s24, v16, 15
    s_min_i32 s62, s62, s24
    v_readlane_b32 s24, v16, 16
    s_min_i32 s62, s62, s24
    v_readlane_b32 s24, v16, 17
    s_min_i32 s62, s62, s24
    v_readlane_b32 s24, v16, 18
    s_min_i32 s62, s62, s24
    v_readlane_b32 s24, v16, 19
    s_min_i32 s62, s62, s24
    s_cmp_ge_i32 s62, s63
    s_cbranch_scc1 interleave_layers__linear_attn_block__memory_aug_recurrent_mem_tr__prompt_kernel_p_en_ok
    s_add_u32 s61, s61, 1
    s_cmp_ge_u32 s61, s60
    s_cbranch_scc1 interleave_layers__linear_attn_block__memory_aug_recurrent_mem_tr__prompt_kernel_p_en_to
    s_sleep 2
    s_branch interleave_layers__linear_attn_block__memory_aug_recurrent_mem_tr__prompt_kernel_p_en
interleave_layers__linear_attn_block__memory_aug_recurrent_mem_tr__prompt_kernel_p_en_to:
    s_mov_b32 s60, 1
interleave_layers__linear_attn_block__memory_aug_recurrent_mem_tr__prompt_kernel_p_en_ok:
    s_add_u32 s41, s41, 40960
    buffer_load_dwordx4 v[16:19], v6, s[8:11], s41 offen offset:0
    buffer_load_dwordx4 v[20:23], v6, s[8:11], s41 offen offset:1024
    buffer_load_dwordx4 v[24:27], v6, s[8:11], s41 offen offset:2048
    buffer_load_dwordx4 v[28:31], v6, s[8:11], s41 offen offset:3072
    buffer_load_dwordx4 v[32:35], v7, s[8:11], s41 offen offset:0
    buffer_load_dwordx4 v[36:39], v7, s[8:11], s41 offen offset:1024
    buffer_load_dwordx4 v[40:43], v7, s[8:11], s41 offen offset:2048
    buffer_load_dwordx4 v[44:47], v7, s[8:11], s41 offen offset:3072
    buffer_load_dwordx4 v[48:51], v8, s[8:11], s41 offen offset:0
    buffer_load_dwordx4 v[52:55], v8, s[8:11], s41 offen offset:1024
    s_and_b32 s24, s40, 1
    s_lshl_b32 s24, s24, 9
    v_add_u32 v124, s24, v13
    s_xor_b32 s24, s24, 512
    v_add_u32 v140, s24, v12
    ds_read_b128 v[112:115], v124
    ds_read_b128 v[116:119], v124 offset:256
    ds_read_b128 v[56:59], v9 offset:0
    ds_read_b128 v[60:63], v9 offset:20480
    ds_read_b128 v[64:67], v9 offset:1024
    ds_read_b128 v[68:71], v9 offset:21504
    ds_read_b128 v[72:75], v9 offset:2048
    ds_read_b128 v[76:79], v9 offset:22528
    ds_read_b128 v[80:83], v9 offset:3072
    ds_read_b128 v[84:87], v9 offset:23552
    s_waitcnt lgkmcnt(6)
    v_mfma_f32_16x16x32_bf16 v[88:91], a[0:3], v[56:59], 0
    v_add_f32 v112, v112, v114
    v_mfma_f32_16x16x32_bf16 v[92:95], a[80:83], v[56:59], 0
    v_add_f32 v113, v113, v115
    v_mfma_f32_16x16x32_bf16 v[96:99], a[160:163], v[56:59], 0
    v_mul_f32 v112, 0x3acccccd, v112
    v_mfma_f32_16x16x32_bf16 v[100:103], a[0:3], v[60:63], 0
    v_mul_f32 v114, v112, v112
    v_mfma_f32_16x16x32_bf16 v[104:107], a[80:83], v[60:63], 0
    v_mov_b32 v115, 0x3acccccd
    v_mfma_f32_16x16x32_bf16 v[108:111], a[160:163], v[60:63], 0
    v_fma_f32 v113, v113, v115, -v114
    ds_read_b128 v[56:59], v9 offset:4096
    ds_read_b128 v[60:63], v9 offset:24576
    s_waitcnt lgkmcnt(6)
    v_mfma_f32_16x16x32_bf16 v[88:91], a[4:7], v[64:67], v[88:91]
    v_max_f32 v113, 0, v113
    v_mfma_f32_16x16x32_bf16 v[92:95], a[84:87], v[64:67], v[92:95]
    v_add_f32 v113, 0x3727c5ac, v113
    v_mfma_f32_16x16x32_bf16 v[96:99], a[164:167], v[64:67], v[96:99]
    v_rsq_f32 v132, v113
    v_mfma_f32_16x16x32_bf16 v[100:103], a[4:7], v[68:71], v[100:103]
    v_mul_f32 v133, v112, v132
    v_mfma_f32_16x16x32_bf16 v[104:107], a[84:87], v[68:71], v[104:107]
    v_sub_f32 v133, 0, v133
    v_mfma_f32_16x16x32_bf16 v[108:111], a[164:167], v[68:71], v[108:111]
    v_add_f32 v116, v116, v118
    ds_read_b128 v[64:67], v9 offset:5120
    ds_read_b128 v[68:71], v9 offset:25600
    s_waitcnt lgkmcnt(6)
    v_mfma_f32_16x16x32_bf16 v[88:91], a[8:11], v[72:75], v[88:91]
    v_add_f32 v117, v117, v119
    v_mfma_f32_16x16x32_bf16 v[92:95], a[88:91], v[72:75], v[92:95]
    v_mul_f32 v116, 0x3acccccd, v116
    v_mfma_f32_16x16x32_bf16 v[96:99], a[168:171], v[72:75], v[96:99]
    v_mul_f32 v118, v116, v116
    v_mfma_f32_16x16x32_bf16 v[100:103], a[8:11], v[76:79], v[100:103]
    v_mov_b32 v119, 0x3acccccd
    v_mfma_f32_16x16x32_bf16 v[104:107], a[88:91], v[76:79], v[104:107]
    v_fma_f32 v117, v117, v119, -v118
    v_mfma_f32_16x16x32_bf16 v[108:111], a[168:171], v[76:79], v[108:111]
    v_max_f32 v117, 0, v117
    ds_read_b128 v[72:75], v9 offset:6144
    ds_read_b128 v[76:79], v9 offset:26624
    s_waitcnt lgkmcnt(6)
    v_mfma_f32_16x16x32_bf16 v[88:91], a[12:15], v[80:83], v[88:91]
    v_add_f32 v117, 0x3727c5ac, v117
    v_mfma_f32_16x16x32_bf16 v[92:95], a[92:95], v[80:83], v[92:95]
    v_rsq_f32 v134, v117
    v_mfma_f32_16x16x32_bf16 v[96:99], a[172:175], v[80:83], v[96:99]
    v_mul_f32 v135, v116, v134
    v_mfma_f32_16x16x32_bf16 v[100:103], a[12:15], v[84:87], v[100:103]
    v_sub_f32 v135, 0, v135
    v_mfma_f32_16x16x32_bf16 v[104:107], a[92:95], v[84:87], v[104:107]
    v_mfma_f32_16x16x32_bf16 v[108:111], a[172:175], v[84:87], v[108:111]
    ds_read_b128 v[80:83], v9 offset:7168
    ds_read_b128 v[84:87], v9 offset:27648
    s_waitcnt lgkmcnt(6)
    v_mfma_f32_16x16x32_bf16 v[88:91], a[16:19], v[56:59], v[88:91]
    v_mfma_f32_16x16x32_bf16 v[92:95], a[96:99], v[56:59], v[92:95]
    v_mfma_f32_16x16x32_bf16 v[96:99], a[176:179], v[56:59], v[96:99]
    v_mfma_f32_16x16x32_bf16 v[100:103], a[16:19], v[60:63], v[100:103]
    v_mfma_f32_16x16x32_bf16 v[104:107], a[96:99], v[60:63], v[104:107]
    v_mfma_f32_16x16x32_bf16 v[108:111], a[176:179], v[60:63], v[108:111]
    ds_read_b128 v[56:59], v9 offset:8192
    ds_read_b128 v[60:63], v9 offset:28672
    s_waitcnt lgkmcnt(6)
    v_mfma_f32_16x16x32_bf16 v[88:91], a[20:23], v[64:67], v[88:91]
    v_mfma_f32_16x16x32_bf16 v[92:95], a[100:103], v[64:67], v[92:95]
    v_mfma_f32_16x16x32_bf16 v[96:99], a[180:183], v[64:67], v[96:99]
    v_mfma_f32_16x16x32_bf16 v[100:103], a[20:23], v[68:71], v[100:103]
    v_mfma_f32_16x16x32_bf16 v[104:107], a[100:103], v[68:71], v[104:107]
    v_mfma_f32_16x16x32_bf16 v[108:111], a[180:183], v[68:71], v[108:111]
    ds_read_b128 v[64:67], v9 offset:9216
    ds_read_b128 v[68:71], v9 offset:29696
    s_waitcnt lgkmcnt(6)
    v_mfma_f32_16x16x32_bf16 v[88:91], a[24:27], v[72:75], v[88:91]
    v_mfma_f32_16x16x32_bf16 v[92:95], a[104:107], v[72:75], v[92:95]
    v_mfma_f32_16x16x32_bf16 v[96:99], a[184:187], v[72:75], v[96:99]
    v_mfma_f32_16x16x32_bf16 v[100:103], a[24:27], v[76:79], v[100:103]
    v_mfma_f32_16x16x32_bf16 v[104:107], a[104:107], v[76:79], v[104:107]
    v_mfma_f32_16x16x32_bf16 v[108:111], a[184:187], v[76:79], v[108:111]
    ds_read_b128 v[72:75], v9 offset:10240
    ds_read_b128 v[76:79], v9 offset:30720
    s_waitcnt lgkmcnt(6)
    v_mfma_f32_16x16x32_bf16 v[88:91], a[28:31], v[80:83], v[88:91]
    v_mfma_f32_16x16x32_bf16 v[92:95], a[108:111], v[80:83], v[92:95]
    v_mfma_f32_16x16x32_bf16 v[96:99], a[188:191], v[80:83], v[96:99]
    v_mfma_f32_16x16x32_bf16 v[100:103], a[28:31], v[84:87], v[100:103]
    v_mfma_f32_16x16x32_bf16 v[104:107], a[108:111], v[84:87], v[104:107]
    v_mfma_f32_16x16x32_bf16 v[108:111], a[188:191], v[84:87], v[108:111]
    ds_read_b128 v[80:83], v9 offset:11264
    ds_read_b128 v[84:87], v9 offset:31744
    s_waitcnt lgkmcnt(6)
    v_mfma_f32_16x16x32_bf16 v[88:91], a[32:35], v[56:59], v[88:91]
    v_mfma_f32_16x16x32_bf16 v[92:95], a[112:115], v[56:59], v[92:95]
    v_mfma_f32_16x16x32_bf16 v[96:99], a[192:195], v[56:59], v[96:99]
    v_mfma_f32_16x16x32_bf16 v[100:103], a[32:35], v[60:63], v[100:103]
    v_mfma_f32_16x16x32_bf16 v[104:107], a[112:115], v[60:63], v[104:107]
    v_mfma_f32_16x16x32_bf16 v[108:111], a[192:195], v[60:63], v[108:111]
    ds_read_b128 v[56:59], v9 offset:12288
    ds_read_b128 v[60:63], v9 offset:32768
    s_waitcnt lgkmcnt(6)
    v_mfma_f32_16x16x32_bf16 v[88:91], a[36:39], v[64:67], v[88:91]
    v_mfma_f32_16x16x32_bf16 v[92:95], a[116:119], v[64:67], v[92:95]
    v_mfma_f32_16x16x32_bf16 v[96:99], a[196:199], v[64:67], v[96:99]
    v_mfma_f32_16x16x32_bf16 v[100:103], a[36:39], v[68:71], v[100:103]
    v_mfma_f32_16x16x32_bf16 v[104:107], a[116:119], v[68:71], v[104:107]
    v_mfma_f32_16x16x32_bf16 v[108:111], a[196:199], v[68:71], v[108:111]
    s_waitcnt vmcnt(10)
    s_barrier
    v_mov_b32 v15, s40
    buffer_store_dword v15, v14, s[8:11], 0 offen sc1
    s_cmp_ge_i32 s79, 0
    s_cselect_b32 s24, 0, 2146435072
    v_or_b32 v246, s24, v245
    v_mov_b32 v247, s79
    buffer_store_dword v247, v246, s[8:11], 0 offen sc1
    s_mov_b32 s79, -1
    ds_read_b128 v[64:67], v9 offset:13312
    ds_read_b128 v[68:71], v9 offset:33792
    s_waitcnt lgkmcnt(6)
    v_mfma_f32_16x16x32_bf16 v[88:91], a[40:43], v[72:75], v[88:91]
    v_mfma_f32_16x16x32_bf16 v[92:95], a[120:123], v[72:75], v[92:95]
    v_mfma_f32_16x16x32_bf16 v[96:99], a[200:203], v[72:75], v[96:99]
    v_mfma_f32_16x16x32_bf16 v[100:103], a[40:43], v[76:79], v[100:103]
    v_mfma_f32_16x16x32_bf16 v[104:107], a[120:123], v[76:79], v[104:107]
    v_mfma_f32_16x16x32_bf16 v[108:111], a[200:203], v[76:79], v[108:111]
    ds_read_b128 v[72:75], v9 offset:14336
    ds_read_b128 v[76:79], v9 offset:34816
    s_waitcnt lgkmcnt(6)
    s_waitcnt vmcnt(2)
    v_mfma_f32_16x16x32_bf16 v[88:91], a[44:47], v[80:83], v[88:91]
    v_mfma_f32_16x16x32_bf16 v[92:95], a[124:127], v[80:83], v[92:95]
    ds_write_b128 v10, v[16:19] offset:0
    v_mfma_f32_16x16x32_bf16 v[96:99], a[204:207], v[80:83], v[96:99]
    v_mfma_f32_16x16x32_bf16 v[100:103], a[44:47], v[84:87], v[100:103]
    v_mfma_f32_16x16x32_bf16 v[104:107], a[124:127], v[84:87], v[104:107]
    v_mfma_f32_16x16x32_bf16 v[108:111], a[204:207], v[84:87], v[108:111]
    v_mfma_f32_16x16x32_bf16 v[148:151], v[16:19], v[16:19], 0
    v_mfma_f32_16x16x32_bf16 v[144:147], v[236:239], v[16:19], 0
    v_mfma_f32_16x16x32_bf16 v[148:151], v[20:23], v[20:23], v[148:151]
    ds_read_b128 v[80:83], v9 offset:15360
    ds_read_b128 v[84:87], v9 offset:35840
    s_waitcnt lgkmcnt(7)
    v_mfma_f32_16x16x32_bf16 v[88:91], a[48:51], v[56:59], v[88:91]
    v_mfma_f32_16x16x32_bf16 v[92:95], a[128:131], v[56:59], v[92:95]
    ds_write_b128 v10, v[20:23] offset:1024
    v_mfma_f32_16x16x32_bf16 v[96:99], a[208:211], v[56:59], v[96:99]
    v_mfma_f32_16x16x32_bf16 v[100:103], a[48:51], v[60:63], v[100:103]
    v_mfma_f32_16x16x32_bf16 v[104:107], a[128:131], v[60:63], v[104:107]
    v_mfma_f32_16x16x32_bf16 v[108:111], a[208:211], v[60:63], v[108:111]
    v_mfma_f32_16x16x32_bf16 v[144:147], v[236:239], v[20:23], v[144:147]
    v_mfma_f32_16x16x32_bf16 v[148:151], v[24:27], v[24:27], v[148:151]
    v_mfma_f32_16x16x32_bf16 v[144:147], v[236:239], v[24:27], v[144:147]
    ds_read_b128 v[56:59], v9 offset:16384
    ds_read_b128 v[60:63], v9 offset:36864
    s_waitcnt lgkmcnt(8)
    v_mfma_f32_16x16x32_bf16 v[88:91], a[52:55], v[64:67], v[88:91]
    v_mfma_f32_16x16x32_bf16 v[92:95], a[132:135], v[64:67], v[92:95]
    ds_write_b128 v10, v[24:27] offset:2048
    v_mfma_f32_16x16x32_bf16 v[96:99], a[212:215], v[64:67], v[96:99]
    v_mfma_f32_16x16x32_bf16 v[100:103], a[52:55], v[68:71], v[100:103]
    v_mfma_f32_16x16x32_bf16 v[104:107], a[132:135], v[68:71], v[104:107]
    v_mfma_f32_16x16x32_bf16 v[108:111], a[212:215], v[68:71], v[108:111]
    v_mfma_f32_16x16x32_bf16 v[148:151], v[28:31], v[28:31], v[148:151]
    v_mfma_f32_16x16x32_bf16 v[144:147], v[236:239], v[28:31], v[144:147]
    v_mfma_f32_16x16x32_bf16 v[148:151], v[32:35], v[32:35], v[148:151]
    ds_read_b128 v[64:67], v9 offset:17408
    ds_read_b128 v[68:71], v9 offset:37888
    s_waitcnt lgkmcnt(9)
    v_mfma_f32_16x16x32_bf16 v[88:91], a[56:59], v[72:75], v[88:91]
    v_mfma_f32_16x16x32_bf16 v[92:95], a[136:139], v[72:75], v[92:95]
    ds_write_b128 v10, v[28:31] offset:3072
    v_mfma_f32_16x16x32_bf16 v[96:99], a[216:219], v[72:75], v[96:99]
    v_mfma_f32_16x16x32_bf16 v[100:103], a[56:59], v[76:79], v[100:103]
    v_mfma_f32_16x16x32_bf16 v[104:107], a[136:139], v[76:79], v[104:107]
    v_mfma_f32_16x16x32_bf16 v[108:111], a[216:219], v[76:79], v[108:111]
    v_mfma_f32_16x16x32_bf16 v[144:147], v[236:239], v[32:35], v[144:147]
    v_mfma_f32_16x16x32_bf16 v[148:151], v[36:39], v[36:39], v[148:151]
    v_mfma_f32_16x16x32_bf16 v[144:147], v[236:239], v[36:39], v[144:147]
    ds_read_b128 v[72:75], v9 offset:18432
    ds_read_b128 v[76:79], v9 offset:38912
    s_waitcnt lgkmcnt(9)
    v_mfma_f32_16x16x32_bf16 v[88:91], a[60:63], v[80:83], v[88:91]
    v_mfma_f32_16x16x32_bf16 v[92:95], a[140:143], v[80:83], v[92:95]
    ds_write_b128 v10, v[32:35] offset:4096
    v_mfma_f32_16x16x32_bf16 v[96:99], a[220:223], v[80:83], v[96:99]
    v_mfma_f32_16x16x32_bf16 v[100:103], a[60:63], v[84:87], v[100:103]
    v_mfma_f32_16x16x32_bf16 v[104:107], a[140:143], v[84:87], v[104:107]
    v_mfma_f32_16x16x32_bf16 v[108:111], a[220:223], v[84:87], v[108:111]
    v_mfma_f32_16x16x32_bf16 v[148:151], v[40:43], v[40:43], v[148:151]
    v_mfma_f32_16x16x32_bf16 v[144:147], v[236:239], v[40:43], v[144:147]
    v_mfma_f32_16x16x32_bf16 v[148:151], v[44:47], v[44:47], v[148:151]
    ds_read_b128 v[80:83], v9 offset:19456
    ds_read_b128 v[84:87], v9 offset:39936
    s_waitcnt lgkmcnt(9)
    v_mfma_f32_16x16x32_bf16 v[88:91], a[64:67], v[56:59], v[88:91]
    v_mfma_f32_16x16x32_bf16 v[92:95], a[144:147], v[56:59], v[92:95]
    ds_write_b128 v10, v[36:39] offset:5120
    v_mfma_f32_16x16x32_bf16 v[96:99], a[224:227], v[56:59], v[96:99]
    v_mfma_f32_16x16x32_bf16 v[100:103], a[64:67], v[60:63], v[100:103]
    v_mfma_f32_16x16x32_bf16 v[104:107], a[144:147], v[60:63], v[104:107]
    v_mfma_f32_16x16x32_bf16 v[108:111], a[224:227], v[60:63], v[108:111]
    v_mfma_f32_16x16x32_bf16 v[144:147], v[236:239], v[44:47], v[144:147]
    v_mfma_f32_16x16x32_bf16 v[148:151], v[48:51], v[48:51], v[148:151]
    v_mfma_f32_16x16x32_bf16 v[144:147], v[236:239], v[48:51], v[144:147]
    s_waitcnt lgkmcnt(7)
    v_mfma_f32_16x16x32_bf16 v[88:91], a[68:71], v[64:67], v[88:91]
    v_mfma_f32_16x16x32_bf16 v[92:95], a[148:151], v[64:67], v[92:95]
    ds_write_b128 v10, v[40:43] offset:6144
    v_mfma_f32_16x16x32_bf16 v[96:99], a[228:231], v[64:67], v[96:99]
    v_mfma_f32_16x16x32_bf16 v[100:103], a[68:71], v[68:71], v[100:103]
    v_mfma_f32_16x16x32_bf16 v[104:107], a[148:151], v[68:71], v[104:107]
    v_mfma_f32_16x16x32_bf16 v[108:111], a[228:231], v[68:71], v[108:111]
    v_mfma_f32_16x16x32_bf16 v[148:151], v[52:55], v[52:55], v[148:151]
    v_mfma_f32_16x16x32_bf16 v[144:147], v[236:239], v[52:55], v[144:147]
    s_waitcnt lgkmcnt(5)
    v_mfma_f32_16x16x32_bf16 v[88:91], a[72:75], v[72:75], v[88:91]
    v_mfma_f32_16x16x32_bf16 v[92:95], a[152:155], v[72:75], v[92:95]
    ds_write_b128 v10, v[44:47] offset:7168
    v_mfma_f32_16x16x32_bf16 v[96:99], a[232:235], v[72:75], v[96:99]
    v_mfma_f32_16x16x32_bf16 v[100:103], a[72:75], v[76:79], v[100:103]
    v_mfma_f32_16x16x32_bf16 v[104:107], a[152:155], v[76:79], v[104:107]
    v_mfma_f32_16x16x32_bf16 v[108:111], a[232:235], v[76:79], v[108:111]
    s_waitcnt lgkmcnt(3)
    v_mfma_f32_16x16x32_bf16 v[88:91], a[76:79], v[80:83], v[88:91]
    v_mfma_f32_16x16x32_bf16 v[92:95], a[156:159], v[80:83], v[92:95]
    ds_write_b128 v10, v[48:51] offset:8192
    v_mfma_f32_16x16x32_bf16 v[96:99], a[236:239], v[80:83], v[96:99]
    v_mfma_f32_16x16x32_bf16 v[100:103], a[76:79], v[84:87], v[100:103]
    v_mfma_f32_16x16x32_bf16 v[104:107], a[156:159], v[84:87], v[104:107]
    v_mfma_f32_16x16x32_bf16 v[108:111], a[236:239], v[84:87], v[108:111]
    v_cndmask_b32 v145, v148, v149, s[48:49]
    v_cndmask_b32 v145, v145, v150, s[50:51]
    v_cndmask_b32 v145, v145, v151, s[54:55]
    ds_write_b128 v10, v[52:55] offset:9216
    ds_write_b64 v140, v[144:145]
    v_pk_mul_f32 v[124:125], v[224:225], v[132:133] op_sel:[0,1] op_sel_hi:[1,1]
    v_pk_mul_f32 v[126:127], v[226:227], v[132:133] op_sel:[0,1] op_sel_hi:[1,1]
    v_pk_fma_f32 v[88:89], v[88:89], v[132:133], v[124:125] op_sel:[0,0,0] op_sel_hi:[1,0,1]
    v_pk_fma_f32 v[90:91], v[90:91], v[132:133], v[126:127] op_sel:[0,0,0] op_sel_hi:[1,0,1]
    v_pk_mul_f32 v[124:125], v[228:229], v[132:133] op_sel:[0,1] op_sel_hi:[1,1]
    v_pk_mul_f32 v[126:127], v[230:231], v[132:133] op_sel:[0,1] op_sel_hi:[1,1]
    v_pk_fma_f32 v[92:93], v[92:93], v[132:133], v[124:125] op_sel:[0,0,0] op_sel_hi:[1,0,1]
    v_pk_fma_f32 v[94:95], v[94:95], v[132:133], v[126:127] op_sel:[0,0,0] op_sel_hi:[1,0,1]
    v_pk_mul_f32 v[124:125], v[232:233], v[132:133] op_sel:[0,1] op_sel_hi:[1,1]
    v_pk_mul_f32 v[126:127], v[234:235], v[132:133] op_sel:[0,1] op_sel_hi:[1,1]
    v_pk_fma_f32 v[96:97], v[96:97], v[132:133], v[124:125] op_sel:[0,0,0] op_sel_hi:[1,0,1]
    v_pk_fma_f32 v[98:99], v[98:99], v[132:133], v[126:127] op_sel:[0,0,0] op_sel_hi:[1,0,1]
    v_pk_mul_f32 v[124:125], v[224:225], v[134:135] op_sel:[0,1] op_sel_hi:[1,1]
    v_pk_mul_f32 v[126:127], v[226:227], v[134:135] op_sel:[0,1] op_sel_hi:[1,1]
    v_pk_fma_f32 v[100:101], v[100:101], v[134:135], v[124:125] op_sel:[0,0,0] op_sel_hi:[1,0,1]
    v_pk_fma_f32 v[102:103], v[102:103], v[134:135], v[126:127] op_sel:[0,0,0] op_sel_hi:[1,0,1]
    v_pk_mul_f32 v[124:125], v[228:229], v[134:135] op_sel:[0,1] op_sel_hi:[1,1]
    v_pk_mul_f32 v[126:127], v[230:231], v[134:135] op_sel:[0,1] op_sel_hi:[1,1]
    v_pk_fma_f32 v[104:105], v[104:105], v[134:135], v[124:125] op_sel:[0,0,0] op_sel_hi:[1,0,1]
    v_pk_fma_f32 v[106:107], v[106:107], v[134:135], v[126:127] op_sel:[0,0,0] op_sel_hi:[1,0,1]
    v_pk_mul_f32 v[124:125], v[232:233], v[134:135] op_sel:[0,1] op_sel_hi:[1,1]
    v_pk_mul_f32 v[126:127], v[234:235], v[134:135] op_sel:[0,1] op_sel_hi:[1,1]
    v_pk_fma_f32 v[108:109], v[108:109], v[134:135], v[124:125] op_sel:[0,0,0] op_sel_hi:[1,0,1]
    v_pk_fma_f32 v[110:111], v[110:111], v[134:135], v[126:127] op_sel:[0,0,0] op_sel_hi:[1,0,1]
    v_cvt_pk_bf16_f32 v112, v88, v89
    v_cvt_pk_bf16_f32 v113, v90, v91
    v_cvt_pk_bf16_f32 v114, v92, v93
    v_cvt_pk_bf16_f32 v115, v94, v95
    v_cvt_pk_bf16_f32 v116, v100, v101
    v_cvt_pk_bf16_f32 v117, v102, v103
    v_cvt_pk_bf16_f32 v118, v104, v105
    v_cvt_pk_bf16_f32 v119, v106, v107
    v_cvt_pk_bf16_f32 v120, v96, v97
    v_cvt_pk_bf16_f32 v121, v98, v99
    v_cvt_pk_bf16_f32 v122, v108, v109
    v_cvt_pk_bf16_f32 v123, v110, v111
    buffer_store_dwordx4 v[112:115], v11, s[8:11], s43 offen offset:0 sc1
    buffer_store_dwordx4 v[116:119], v11, s[8:11], s43 offen offset:1024 sc1
    buffer_store_dwordx4 v[120:123], v11, s[8:11], s43 offen offset:2048 sc1
    s_add_u32 s43, s43, 393216
    s_add_u32 s40, s40, 1
    s_waitcnt lgkmcnt(0)
    s_barrier
interleave_layers__linear_attn_block__memory_aug_recurrent_mem_tr__prompt_kernel_p_next:
    s_add_u32 s24, s64, 24
    s_cmp_le_u32 s24, s40
    s_cbranch_scc1 interleave_layers__linear_attn_block__memory_aug_recurrent_mem_tr__prompt_kernel_p_pub
    s_cmp_lt_u32 s40, 64
    s_cbranch_scc1 interleave_layers__linear_attn_block__memory_aug_recurrent_mem_tr__prompt_kernel_p_seg
interleave_layers__linear_attn_block__memory_aug_recurrent_mem_tr__prompt_kernel_p_pub:
    s_waitcnt vmcnt(0)
    s_barrier
    s_cmp_eq_u32 s3, 0
    s_cbranch_scc0 interleave_layers__linear_attn_block__memory_aug_recurrent_mem_tr__prompt_kernel_fp29
    v_mov_b32 v15, s40
    buffer_store_dword v15, v14, s[8:11], 0 offen sc1
interleave_layers__linear_attn_block__memory_aug_recurrent_mem_tr__prompt_kernel_fp29:
    s_add_u32 s24, s64, 24
    s_cmp_le_u32 s24, s40
    s_cbranch_scc1 interleave_layers__linear_attn_block__memory_aug_recurrent_mem_tr__prompt_kernel_p_x
    s_cmp_lt_u32 s40, 64
    s_cbranch_scc1 interleave_layers__linear_attn_block__memory_aug_recurrent_mem_tr__prompt_kernel_p_seg
    s_cmp_ge_u32 s64, 64
    s_cbranch_scc1 interleave_layers__linear_attn_block__memory_aug_recurrent_mem_tr__prompt_kernel_p_done
interleave_layers__linear_attn_block__memory_aug_recurrent_mem_tr__prompt_kernel_p_x:
    s_add_u32 s63, s64, 1
    s_cmp_ge_i32 s69, s63
    s_cbranch_scc1 interleave_layers__linear_attn_block__memory_aug_recurrent_mem_tr__prompt_kernel_x_en_ok
    s_mov_b32 s61, 0
interleave_layers__linear_attn_block__memory_aug_recurrent_mem_tr__prompt_kernel_x_en:
    buffer_load_dword v253, v252, s[8:11], 0 offen sc1
    s_waitcnt vmcnt(0)
    v_readlane_b32 s69, v253, 0
    v_readlane_b32 s24, v253, 1
    s_min_i32 s69, s69, s24
    v_readlane_b32 s24, v253, 2
    s_min_i32 s69, s69, s24
    v_readlane_b32 s24, v253, 3
    s_min_i32 s69, s69, s24
    v_readlane_b32 s24, v253, 4
    s_min_i32 s69, s69, s24
    v_readlane_b32 s24, v253, 5
    s_min_i32 s69, s69, s24
    v_readlane_b32 s24, v253, 6
    s_min_i32 s69, s69, s24
    v_readlane_b32 s24, v253, 7
    s_min_i32 s69, s69, s24
    s_cmp_ge_i32 s69, s63
    s_cbranch_scc1 interleave_layers__linear_attn_block__memory_aug_recurrent_mem_tr__prompt_kernel_x_en_ok
    s_add_u32 s61, s61, 1
    s_cmp_ge_u32 s61, s60
    s_cbranch_scc1 interleave_layers__linear_attn_block__memory_aug_recurrent_mem_tr__prompt_kernel_x_en_to
    s_sleep 2
    s_branch interleave_layers__linear_attn_block__memory_aug_recurrent_mem_tr__prompt_kernel_x_en
interleave_layers__linear_attn_block__memory_aug_recurrent_mem_tr__prompt_kernel_x_en_to:
    s_mov_b32 s60, 1
interleave_layers__linear_attn_block__memory_aug_recurrent_mem_tr__prompt_kernel_x_en_ok:
    s_lshl_b32 s95, s92, 6
    s_add_u32 s95, s95, s64
    s_add_u32 s95, s95, 1
    s_cmp_ge_i32 s59, s95
    s_cbranch_scc1 interleave_layers__linear_attn_block__memory_aug_recurrent_mem_tr__prompt_kernel_x_ec_ok
    s_and_b32 s24, s2, 7
    s_lshl_b32 s24, s24, 7
    s_add_u32 s24, s24, 23109632
    v_and_b32 v254, 3, v1
    v_lshl_add_u32 v254, v254, 2, s24
    s_mov_b32 s61, 0
interleave_layers__linear_attn_block__memory_aug_recurrent_mem_tr__prompt_kernel_x_ec:
    buffer_load_dword v253, v254, s[8:11], 0 offen sc1
    s_waitcnt vmcnt(0)
    v_readlane_b32 s59, v253, 0
    v_readlane_b32 s24, v253, 1
    s_min_i32 s59, s59, s24
    v_readlane_b32 s24, v253, 2
    s_min_i32 s59, s59, s24
    s_cmp_ge_i32 s59, s95
    s_cbranch_scc1 interleave_layers__linear_attn_block__memory_aug_recurrent_mem_tr__prompt_kernel_x_ec_ok
    s_add_u32 s61, s61, 1
    s_cmp_ge_u32 s61, s60
    s_cbranch_scc1 interleave_layers__linear_attn_block__memory_aug_recurrent_mem_tr__prompt_kernel_x_ec_to
    s_sleep 2
    s_branch interleave_layers__linear_attn_block__memory_aug_recurrent_mem_tr__prompt_kernel_x_ec
interleave_layers__linear_attn_block__memory_aug_recurrent_mem_tr__prompt_kernel_x_ec_to:
    s_mov_b32 s60, 1
interleave_layers__linear_attn_block__memory_aug_recurrent_mem_tr__prompt_kernel_x_ec_ok:
    s_add_u32 s52, s65, 32768
    buffer_load_dwordx4 v[16:19], v240, s[8:11], s65 offen offset:0 sc1
    buffer_load_dwordx4 v[20:23], v240, s[8:11], s65 offen offset:1024 sc1
    buffer_load_dwordx4 v[24:27], v240, s[8:11], s65 offen offset:2048 sc1
    buffer_load_dwordx4 v[28:31], v240, s[8:11], s65 offen offset:3072 sc1
    buffer_load_dwordx4 v[32:35], v241, s[8:11], s65 offen offset:0 sc1
    buffer_load_dwordx4 v[36:39], v241, s[8:11], s65 offen offset:1024 sc1
    buffer_load_dwordx4 v[40:43], v241, s[8:11], s65 offen offset:2048 sc1
    buffer_load_dwordx4 v[44:47], v241, s[8:11], s65 offen offset:3072 sc1
    buffer_load_dwordx4 v[48:51], v240, s[8:11], s52 offen offset:0 sc1
    buffer_load_dwordx4 v[52:55], v240, s[8:11], s52 offen offset:1024 sc1
    buffer_load_dwordx4 v[56:59], v240, s[8:11], s52 offen offset:2048 sc1
    buffer_load_dwordx4 v[60:63], v240, s[8:11], s52 offen offset:3072 sc1
    buffer_load_dwordx4 v[64:67], v241, s[8:11], s52 offen offset:0 sc1
    buffer_load_dwordx4 v[68:71], v241, s[8:11], s52 offen offset:1024 sc1
    buffer_load_dwordx4 v[72:75], v241, s[8:11], s52 offen offset:2048 sc1
    buffer_load_dwordx4 v[76:79], v241, s[8:11], s52 offen offset:3072 sc1
    s_add_u32 s24, s68, s73
    buffer_load_dwordx4 v[196:199], v219, s[8:11], s24 offen sc1
    s_mov_b32 s61, 0
interleave_layers__linear_attn_block__memory_aug_recurrent_mem_tr__prompt_kernel_x_p0:
    buffer_load_dwordx4 v[140:143], v215, s[8:11], s67 offen offset:3072 sc1
    s_waitcnt vmcnt(0)
    v_max3_u32 v192, v140, v141, v142
    v_max_u32 v192, v192, v143
    v_cmp_eq_u32 vcc, -1, v192
    s_add_u32 s61, s61, 1
    s_cbranch_vccz interleave_layers__linear_attn_block__memory_aug_recurrent_mem_tr__prompt_kernel_x_p0_out
    s_cmp_ge_u32 s61, s60
    s_cbranch_scc1 interleave_layers__linear_attn_block__memory_aug_recurrent_mem_tr__prompt_kernel_x_p0_to
    s_sleep 8
    s_branch interleave_layers__linear_attn_block__memory_aug_recurrent_mem_tr__prompt_kernel_x_p0
interleave_layers__linear_attn_block__memory_aug_recurrent_mem_tr__prompt_kernel_x_p0_to:
    s_mov_b32 s60, 1
interleave_layers__linear_attn_block__memory_aug_recurrent_mem_tr__prompt_kernel_x_p0_out:
    s_add_u32 s53, s66, 8192
    s_mov_b32 s61, 0
interleave_layers__linear_attn_block__memory_aug_recurrent_mem_tr__prompt_kernel_x_p1:
    buffer_load_dwordx4 v[80:83], v212, s[8:11], s67 offen offset:0 sc1
    buffer_load_dwordx4 v[84:87], v212, s[8:11], s67 offen offset:1024 sc1
    buffer_load_dwordx4 v[88:91], v212, s[8:11], s67 offen offset:2048 sc1
    buffer_load_dwordx4 v[92:95], v212, s[8:11], s67 offen offset:3072 sc1
    buffer_load_dwordx4 v[96:99], v213, s[8:11], s67 offen offset:0 sc1
    buffer_load_dwordx4 v[100:103], v213, s[8:11], s67 offen offset:1024 sc1
    buffer_load_dwordx4 v[104:107], v213, s[8:11], s67 offen offset:2048 sc1
    buffer_load_dwordx4 v[108:111], v213, s[8:11], s67 offen offset:3072 sc1
    buffer_load_dwordx4 v[112:115], v214, s[8:11], s67 offen offset:0 sc1
    buffer_load_dwordx4 v[116:119], v214, s[8:11], s67 offen offset:1024 sc1
    buffer_load_dwordx4 v[120:123], v214, s[8:11], s67 offen offset:2048 sc1
    buffer_load_dwordx4 v[124:127], v214, s[8:11], s67 offen offset:3072 sc1
    buffer_load_dwordx4 v[128:131], v215, s[8:11], s67 offen offset:0 sc1
    buffer_load_dwordx4 v[132:135], v215, s[8:11], s67 offen offset:1024 sc1
    buffer_load_dwordx4 v[136:139], v215, s[8:11], s67 offen offset:2048 sc1
    buffer_load_dwordx4 v[140:143], v215, s[8:11], s67 offen offset:3072 sc1
    buffer_load_dwordx4 v[144:147], v216, s[8:11], s67 offen offset:0 sc1
    buffer_load_dwordx4 v[148:151], v216, s[8:11], s67 offen offset:1024 sc1
    buffer_load_dwordx4 v[152:155], v216, s[8:11], s67 offen offset:2048 sc1
    buffer_load_dwordx4 v[156:159], v216, s[8:11], s67 offen offset:3072 sc1
    buffer_load_dwordx4 v[160:163], v242, s[8:11], s66 offen offset:0 sc1
    buffer_load_dwordx4 v[164:167], v242, s[8:11], s66 offen offset:1024 sc1
    buffer_load_dwordx4 v[168:171], v242, s[8:11], s53 offen offset:0 sc1
    buffer_load_dwordx4 v[172:175], v242, s[8:11], s53 offen offset:1024 sc1
    s_waitcnt vmcnt(0)
    v_max3_u32 v192, v80, v81, v82
    v_max3_u32 v192, v192, v83, v84
    v_max3_u32 v192, v192, v85, v86
    v_max3_u32 v192, v192, v87, v88
    v_max3_u32 v192, v192, v89, v90
    v_max3_u32 v192, v192, v91, v92
    v_max3_u32 v192, v192, v93, v94
    v_max3_u32 v192, v192, v95, v96
    v_max3_u32 v192, v192, v97, v98
    v_max3_u32 v192, v192, v99, v100
    v_max3_u32 v192, v192, v101, v102
    v_max3_u32 v192, v192, v103, v104
    v_max3_u32 v192, v192, v105, v106
    v_max3_u32 v192, v192, v107, v108
    v_max3_u32 v192, v192, v109, v110
    v_max3_u32 v192, v192, v111, v112
    v_max3_u32 v192, v192, v113, v114
    v_max3_u32 v192, v192, v115, v116
    v_max3_u32 v192, v192, v117, v118
    v_max3_u32 v192, v192, v119, v120
    v_max3_u32 v192, v192, v121, v122
    v_max3_u32 v192, v192, v123, v124
    v_max3_u32 v192, v192, v125, v126
    v_max3_u32 v192, v192, v127, v128
    v_max3_u32 v192, v192, v129, v130
    v_max3_u32 v192, v192, v131, v132
    v_max3_u32 v192, v192, v133, v134
    v_max3_u32 v192, v192, v135, v136
    v_max3_u32 v192, v192, v137, v138
    v_max3_u32 v192, v192, v139, v140
    v_max3_u32 v192, v192, v141, v142
    v_max3_u32 v192, v192, v143, v144
    v_max3_u32 v192, v192, v145, v146
    v_max3_u32 v192, v192, v147, v148
    v_max3_u32 v192, v192, v149, v150
    v_max3_u32 v192, v192, v151, v152
    v_max3_u32 v192, v192, v153, v154
    v_max3_u32 v192, v192, v155, v156
    v_max3_u32 v192, v192, v157, v158
    v_max3_u32 v192, v192, v159, v160
    v_max3_u32 v192, v192, v161, v162
    v_max3_u32 v192, v192, v163, v164
    v_max3_u32 v192, v192, v165, v166
    v_max3_u32 v192, v192, v167, v168
    v_max3_u32 v192, v192, v169, v170
    v_max3_u32 v192, v192, v171, v172
    v_max3_u32 v192, v192, v173, v174
    v_max_u32 v192, v192, v175
    v_cmp_eq_u32 vcc, -1, v192
    s_add_u32 s61, s61, 1
    s_cbranch_vccz interleave_layers__linear_attn_block__memory_aug_recurrent_mem_tr__prompt_kernel_x_p1_out
    s_cmp_ge_u32 s61, s60
    s_cbranch_scc1 interleave_layers__linear_attn_block__memory_aug_recurrent_mem_tr__prompt_kernel_x_p1_to
    s_sleep 2
    s_branch interleave_layers__linear_attn_block__memory_aug_recurrent_mem_tr__prompt_kernel_x_p1
interleave_layers__linear_attn_block__memory_aug_recurrent_mem_tr__prompt_kernel_x_p1_to:
    s_mov_b32 s60, 1
interleave_layers__linear_attn_block__memory_aug_recurrent_mem_tr__prompt_kernel_x_p1_out:
    v_mfma_f32_16x16x32_bf16 v[176:179], v[16:19], v[80:83], 0
    v_mfma_f32_16x16x32_bf16 v[180:183], v[16:19], v[84:87], 0
    v_mfma_f32_16x16x32_bf16 v[184:187], v[48:51], v[80:83], 0
    v_mfma_f32_16x16x32_bf16 v[188:191], v[48:51], v[84:87], 0
    v_mfma_f32_16x16x32_bf16 v[176:179], v[20:23], v[88:91], v[176:179]
    v_mfma_f32_16x16x32_bf16 v[180:183], v[20:23], v[92:95], v[180:183]
    v_mfma_f32_16x16x32_bf16 v[184:187], v[52:55], v[88:91], v[184:187]
    v_mfma_f32_16x16x32_bf16 v[188:191], v[52:55], v[92:95], v[188:191]
    v_mfma_f32_16x16x32_bf16 v[176:179], v[24:27], v[96:99], v[176:179]
    v_mfma_f32_16x16x32_bf16 v[180:183], v[24:27], v[100:103], v[180:183]
    v_mfma_f32_16x16x32_bf16 v[184:187], v[56:59], v[96:99], v[184:187]
    v_mfma_f32_16x16x32_bf16 v[188:191], v[56:59], v[100:103], v[188:191]
    v_mfma_f32_16x16x32_bf16 v[176:179], v[28:31], v[104:107], v[176:179]
    v_mfma_f32_16x16x32_bf16 v[180:183], v[28:31], v[108:111], v[180:183]
    v_mfma_f32_16x16x32_bf16 v[184:187], v[60:63], v[104:107], v[184:187]
    v_mfma_f32_16x16x32_bf16 v[188:191], v[60:63], v[108:111], v[188:191]
    v_mfma_f32_16x16x32_bf16 v[176:179], v[32:35], v[112:115], v[176:179]
    v_mfma_f32_16x16x32_bf16 v[180:183], v[32:35], v[116:119], v[180:183]
    v_mfma_f32_16x16x32_bf16 v[184:187], v[64:67], v[112:115], v[184:187]
    v_mfma_f32_16x16x32_bf16 v[188:191], v[64:67], v[116:119], v[188:191]
    v_mfma_f32_16x16x32_bf16 v[176:179], v[36:39], v[120:123], v[176:179]
    v_mfma_f32_16x16x32_bf16 v[180:183], v[36:39], v[124:127], v[180:183]
    v_mfma_f32_16x16x32_bf16 v[184:187], v[68:71], v[120:123], v[184:187]
    v_mfma_f32_16x16x32_bf16 v[188:191], v[68:71], v[124:127], v[188:191]
    v_mfma_f32_16x16x32_bf16 v[176:179], v[40:43], v[128:131], v[176:179]
    v_mfma_f32_16x16x32_bf16 v[180:183], v[40:43], v[132:135], v[180:183]
    v_mfma_f32_16x16x32_bf16 v[184:187], v[72:75], v[128:131], v[184:187]
    v_mfma_f32_16x16x32_bf16 v[188:191], v[72:75], v[132:135], v[188:191]
    v_mfma_f32_16x16x32_bf16 v[176:179], v[44:47], v[136:139], v[176:179]
    v_mfma_f32_16x16x32_bf16 v[180:183], v[44:47], v[140:143], v[180:183]
    v_mfma_f32_16x16x32_bf16 v[184:187], v[76:79], v[136:139], v[184:187]
    v_mfma_f32_16x16x32_bf16 v[188:191], v[76:79], v[140:143], v[188:191]
    v_mfma_f32_16x16x32_bf16 v[176:179], v[160:163], v[144:147], v[176:179]
    v_mfma_f32_16x16x32_bf16 v[180:183], v[160:163], v[148:151], v[180:183]
    v_mfma_f32_16x16x32_bf16 v[184:187], v[168:171], v[144:147], v[184:187]
    v_mfma_f32_16x16x32_bf16 v[188:191], v[168:171], v[148:151], v[188:191]
    v_mfma_f32_16x16x32_bf16 v[176:179], v[164:167], v[152:155], v[176:179]
    v_mfma_f32_16x16x32_bf16 v[180:183], v[164:167], v[156:159], v[180:183]
    v_mfma_f32_16x16x32_bf16 v[184:187], v[172:175], v[152:155], v[184:187]
    v_mfma_f32_16x16x32_bf16 v[188:191], v[172:175], v[156:159], v[188:191]
    s_nop 4
    ds_write_b128 v217, v[176:179] offset:0
    ds_write_b128 v217, v[180:183] offset:1024
    ds_write_b128 v217, v[184:187] offset:2048
    ds_write_b128 v217, v[188:191] offset:3072
    s_waitcnt lgkmcnt(0)
    s_barrier
    s_cmp_ge_u32 s3, 2
    s_cbranch_scc1 interleave_layers__linear_attn_block__memory_aug_recurrent_mem_tr__prompt_kernel_xs30
    ds_read_b128 v[16:19], v218 offset:0
    ds_read_b128 v[20:23], v218 offset:4096
    ds_read_b128 v[24:27], v218 offset:8192
    ds_read_b128 v[28:31], v218 offset:12288
    ds_read_b128 v[32:35], v218 offset:2048
    ds_read_b128 v[36:39], v218 offset:6144
    ds_read_b128 v[40:43], v218 offset:10240
    ds_read_b128 v[44:47], v218 offset:14336
    s_waitcnt lgkmcnt(4)
    v_pk_add_f32 v[16:17], v[16:17], v[20:21]
    v_pk_add_f32 v[24:25], v[24:25], v[28:29]
    v_pk_add_f32 v[18:19], v[18:19], v[22:23]
    v_pk_add_f32 v[26:27], v[26:27], v[30:31]
    v_pk_add_f32 v[16:17], v[16:17], v[24:25]
    v_pk_add_f32 v[18:19], v[18:19], v[26:27]
    v_cvt_pk_bf16_f32 v20, v16, v17
    v_cvt_pk_bf16_f32 v21, v18, v19
    v_lshlrev_b32 v16, 16, v20
    v_and_b32 v17, 0xffff0000, v20
    v_lshlrev_b32 v22, 16, v196
    v_and_b32 v23, 0xffff0000, v196
    v_pk_add_f32 v[16:17], v[16:17], v[22:23]
    v_cvt_pk_bf16_f32 v48, v16, v17
    v_lshlrev_b32 v16, 16, v21
    v_and_b32 v17, 0xffff0000, v21
    v_lshlrev_b32 v22, 16, v197
    v_and_b32 v23, 0xffff0000, v197
    v_pk_add_f32 v[16:17], v[16:17], v[22:23]
    v_cvt_pk_bf16_f32 v49, v16, v17
    s_waitcnt lgkmcnt(0)
    v_pk_add_f32 v[32:33], v[32:33], v[36:37]
    v_pk_add_f32 v[40:41], v[40:41], v[44:45]
    v_pk_add_f32 v[34:35], v[34:35], v[38:39]
    v_pk_add_f32 v[42:43], v[42:43], v[46:47]
    v_pk_add_f32 v[32:33], v[32:33], v[40:41]
    v_pk_add_f32 v[34:35], v[34:35], v[42:43]
    v_cvt_pk_bf16_f32 v36, v32, v33
    v_cvt_pk_bf16_f32 v37, v34, v35
    v_lshlrev_b32 v32, 16, v36
    v_and_b32 v33, 0xffff0000, v36
    v_lshlrev_b32 v38, 16, v198
    v_and_b32 v39, 0xffff0000, v198
    v_pk_add_f32 v[32:33], v[32:33], v[38:39]
    v_cvt_pk_bf16_f32 v50, v32, v33
    v_lshlrev_b32 v32, 16, v37
    v_and_b32 v33, 0xffff0000, v37
    v_lshlrev_b32 v38, 16, v199
    v_and_b32 v39, 0xffff0000, v199
    v_pk_add_f32 v[32:33], v[32:33], v[38:39]
    v_cvt_pk_bf16_f32 v51, v32, v33
    s_cmp_eq_u32 s92, 0
    s_cbranch_scc0 interleave_layers__linear_attn_block__memory_aug_recurrent_mem_tr__prompt_kernel_xo31
    s_add_u32 s24, s68, 4194304
    buffer_store_dwordx4 v[48:51], v219, s[8:11], s24 offen sc1
    s_branch interleave_layers__linear_attn_block__memory_aug_recurrent_mem_tr__prompt_kernel_xs30
interleave_layers__linear_attn_block__memory_aug_recurrent_mem_tr__prompt_kernel_xo31:
    buffer_store_dwordx2 v[48:49], v243, s[12:15], s68 offen
    buffer_store_dwordx2 v[50:51], v243, s[12:15], s68 offen offset:32
interleave_layers__linear_attn_block__memory_aug_recurrent_mem_tr__prompt_kernel_xs30:
    s_lshr_b32 s25, s64, 2
    s_add_u32 s25, s25, 1
    s_cmp_eq_u32 s92, 0
    s_cselect_b32 s79, s25, -1
    s_cmp_lt_u32 s40, 64
    s_cbranch_scc1 interleave_layers__linear_attn_block__memory_aug_recurrent_mem_tr__prompt_kernel_xp32
    s_waitcnt vmcnt(0)
    s_barrier
    s_cmp_ge_i32 s79, 0
    s_cselect_b32 s24, 0, 2146435072
    v_or_b32 v246, s24, v245
    v_mov_b32 v247, s79
    buffer_store_dword v247, v246, s[8:11], 0 offen sc1
    s_mov_b32 s79, -1
interleave_layers__linear_attn_block__memory_aug_recurrent_mem_tr__prompt_kernel_xp32:
    s_add_u32 s64, s64, 4
    s_add_u32 s65, s65, 5242880
    s_add_u32 s66, s66, 1835008
    s_add_u32 s67, s67, 1835008
    s_add_u32 s68, s68, 163840
    s_branch interleave_layers__linear_attn_block__memory_aug_recurrent_mem_tr__prompt_kernel_p_next
interleave_layers__linear_attn_block__memory_aug_recurrent_mem_tr__prompt_kernel_p_done:
    s_cmp_eq_u32 s92, 0
    s_cbranch_scc0 interleave_layers__linear_attn_block__memory_aug_recurrent_mem_tr__prompt_kernel_end
    s_mov_b32 s92, 1
    s_branch interleave_layers__linear_attn_block__memory_aug_recurrent_mem_tr__prompt_kernel_p_layer
interleave_layers__linear_attn_block__memory_aug_recurrent_mem_tr__prompt_kernel_roleO:
    s_sub_u32 s44, s2, 200
    s_load_dwordx2 s[6:7], s[0:1], 64
    s_waitcnt lgkmcnt(0)
    s_mov_b32 s12, s6
    s_mov_b32 s13, s7
    s_mov_b32 s14, 7864320
    s_mov_b32 s15, 0x00020000
    v_add_u32 v8, 0, v0
    s_mov_b32 s24, 3277
    v_mul_lo_u32 v9, v8, s24
    v_lshrrev_b32 v9, 18, v9
    v_mul_u32_u24 v10, 80, v9
    v_sub_u32 v10, v8, v10
    v_mul_u32_u24 v16, 1312, v9
    v_lshl_add_u32 v16, v10, 4, v16
    v_add_u32 v8, 256, v0
    s_mov_b32 s24, 3277
    v_mul_lo_u32 v9, v8, s24
    v_lshrrev_b32 v9, 18, v9
    v_mul_u32_u24 v10, 80, v9
    v_sub_u32 v10, v8, v10
    v_mul_u32_u24 v17, 1312, v9
    v_lshl_add_u32 v17, v10, 4, v17
    v_add_u32 v8, 512, v0
    s_mov_b32 s24, 3277
    v_mul_lo_u32 v9, v8, s24
    v_lshrrev_b32 v9, 18, v9
    v_mul_u32_u24 v10, 80, v9
    v_sub_u32 v10, v8, v10
    v_mul_u32_u24 v18, 1312, v9
    v_lshl_add_u32 v18, v10, 4, v18
    v_add_u32 v8, 768, v0
    s_mov_b32 s24, 3277
    v_mul_lo_u32 v9, v8, s24
    v_lshrrev_b32 v9, 18, v9
    v_mul_u32_u24 v10, 80, v9
    v_sub_u32 v10, v8, v10
    v_mul_u32_u24 v19, 1312, v9
    v_lshl_add_u32 v19, v10, 4, v19
    v_add_u32 v8, 1024, v0
    s_mov_b32 s24, 3277
    v_mul_lo_u32 v9, v8, s24
    v_lshrrev_b32 v9, 18, v9
    v_mul_u32_u24 v10, 80, v9
    v_sub_u32 v10, v8, v10
    v_mul_u32_u24 v20, 1312, v9
    v_lshl_add_u32 v20, v10, 4, v20
    v_add_u32 v8, 1280, v0
    s_mov_b32 s24, 3277
    v_mul_lo_u32 v9, v8, s24
    v_lshrrev_b32 v9, 18, v9
    v_mul_u32_u24 v10, 80, v9
    v_sub_u32 v10, v8, v10
    v_mul_u32_u24 v21, 1312, v9
    v_lshl_add_u32 v21, v10, 4, v21
    v_add_u32 v8, 1536, v0
    s_mov_b32 s24, 3277
    v_mul_lo_u32 v9, v8, s24
    v_lshrrev_b32 v9, 18, v9
    v_mul_u32_u24 v10, 80, v9
    v_sub_u32 v10, v8, v10
    v_mul_u32_u24 v22, 1312, v9
    v_lshl_add_u32 v22, v10, 4, v22
    v_add_u32 v8, 1792, v0
    s_mov_b32 s24, 3277
    v_mul_lo_u32 v9, v8, s24
    v_lshrrev_b32 v9, 18, v9
    v_mul_u32_u24 v10, 80, v9
    v_sub_u32 v10, v8, v10
    v_mul_u32_u24 v23, 1312, v9
    v_lshl_add_u32 v23, v10, 4, v23
    v_add_u32 v8, 2048, v0
    s_mov_b32 s24, 3277
    v_mul_lo_u32 v9, v8, s24
    v_lshrrev_b32 v9, 18, v9
    v_mul_u32_u24 v10, 80, v9
    v_sub_u32 v10, v8, v10
    v_mul_u32_u24 v24, 1312, v9
    v_lshl_add_u32 v24, v10, 4, v24
    v_add_u32 v8, 2304, v0
    s_mov_b32 s24, 3277
    v_mul_lo_u32 v9, v8, s24
    v_lshrrev_b32 v9, 18, v9
    v_mul_u32_u24 v10, 80, v9
    v_sub_u32 v10, v8, v10
    v_mul_u32_u24 v25, 1312, v9
    v_lshl_add_u32 v25, v10, 4, v25
    v_add_u32 v8, 2560, v0
    s_mov_b32 s24, 3277
    v_mul_lo_u32 v9, v8, s24
    v_lshrrev_b32 v9, 18, v9
    v_mul_u32_u24 v10, 80, v9
    v_sub_u32 v10, v8, v10
    v_mul_u32_u24 v26, 1312, v9
    v_lshl_add_u32 v26, v10, 4, v26
    v_add_u32 v8, 2816, v0
    s_mov_b32 s24, 3277
    v_mul_lo_u32 v9, v8, s24
    v_lshrrev_b32 v9, 18, v9
    v_mul_u32_u24 v10, 80, v9
    v_sub_u32 v10, v8, v10
    v_mul_u32_u24 v27, 1312, v9
    v_lshl_add_u32 v27, v10, 4, v27
    v_add_u32 v8, 3072, v0
    s_mov_b32 s24, 3277
    v_mul_lo_u32 v9, v8, s24
    v_lshrrev_b32 v9, 18, v9
    v_mul_u32_u24 v10, 80, v9
    v_sub_u32 v10, v8, v10
    v_mul_u32_u24 v28, 1312, v9
    v_lshl_add_u32 v28, v10, 4, v28
    v_add_u32 v8, 3328, v0
    s_mov_b32 s24, 3277
    v_mul_lo_u32 v9, v8, s24
    v_lshrrev_b32 v9, 18, v9
    v_mul_u32_u24 v10, 80, v9
    v_sub_u32 v10, v8, v10
    v_mul_u32_u24 v29, 1312, v9
    v_lshl_add_u32 v29, v10, 4, v29
    v_add_u32 v8, 3584, v0
    s_mov_b32 s24, 3277
    v_mul_lo_u32 v9, v8, s24
    v_lshrrev_b32 v9, 18, v9
    v_mul_u32_u24 v10, 80, v9
    v_sub_u32 v10, v8, v10
    v_mul_u32_u24 v30, 1312, v9
    v_lshl_add_u32 v30, v10, 4, v30
    v_add_u32 v8, 3840, v0
    s_mov_b32 s24, 3277
    v_mul_lo_u32 v9, v8, s24
    v_lshrrev_b32 v9, 18, v9
    v_mul_u32_u24 v10, 80, v9
    v_sub_u32 v10, v8, v10
    v_mul_u32_u24 v31, 1312, v9
    v_lshl_add_u32 v31, v10, 4, v31
    v_add_u32 v8, 4096, v0
    s_mov_b32 s24, 3277
    v_mul_lo_u32 v9, v8, s24
    v_lshrrev_b32 v9, 18, v9
    v_mul_u32_u24 v10, 80, v9
    v_sub_u32 v10, v8, v10
    v_mul_u32_u24 v32, 1312, v9
    v_lshl_add_u32 v32, v10, 4, v32
    v_add_u32 v8, 4352, v0
    s_mov_b32 s24, 3277
    v_mul_lo_u32 v9, v8, s24
    v_lshrrev_b32 v9, 18, v9
    v_mul_u32_u24 v10, 80, v9
    v_sub_u32 v10, v8, v10
    v_mul_u32_u24 v33, 1312, v9
    v_lshl_add_u32 v33, v10, 4, v33
    v_add_u32 v8, 4608, v0
    s_mov_b32 s24, 3277
    v_mul_lo_u32 v9, v8, s24
    v_lshrrev_b32 v9, 18, v9
    v_mul_u32_u24 v10, 80, v9
    v_sub_u32 v10, v8, v10
    v_mul_u32_u24 v34, 1312, v9
    v_lshl_add_u32 v34, v10, 4, v34
    v_add_u32 v8, 4864, v0
    s_mov_b32 s24, 3277
    v_mul_lo_u32 v9, v8, s24
    v_lshrrev_b32 v9, 18, v9
    v_mul_u32_u24 v10, 80, v9
    v_sub_u32 v10, v8, v10
    v_mul_u32_u24 v35, 1312, v9
    v_lshl_add_u32 v35, v10, 4, v35
    v_add_u32 v8, 5120, v0
    s_mov_b32 s24, 3277
    v_mul_lo_u32 v9, v8, s24
    v_lshrrev_b32 v9, 18, v9
    v_mul_u32_u24 v10, 80, v9
    v_sub_u32 v10, v8, v10
    v_mul_u32_u24 v36, 1312, v9
    v_lshl_add_u32 v36, v10, 4, v36
    v_add_u32 v8, 5376, v0
    s_mov_b32 s24, 3277
    v_mul_lo_u32 v9, v8, s24
    v_lshrrev_b32 v9, 18, v9
    v_mul_u32_u24 v10, 80, v9
    v_sub_u32 v10, v8, v10
    v_mul_u32_u24 v37, 1312, v9
    v_lshl_add_u32 v37, v10, 4, v37
    v_add_u32 v8, 5632, v0
    s_mov_b32 s24, 3277
    v_mul_lo_u32 v9, v8, s24
    v_lshrrev_b32 v9, 18, v9
    v_mul_u32_u24 v10, 80, v9
    v_sub_u32 v10, v8, v10
    v_mul_u32_u24 v38, 1312, v9
    v_lshl_add_u32 v38, v10, 4, v38
    v_add_u32 v8, 5888, v0
    s_mov_b32 s24, 3277
    v_mul_lo_u32 v9, v8, s24
    v_lshrrev_b32 v9, 18, v9
    v_mul_u32_u24 v10, 80, v9
    v_sub_u32 v10, v8, v10
    v_mul_u32_u24 v39, 1312, v9
    v_lshl_add_u32 v39, v10, 4, v39
    v_add_u32 v8, 6144, v0
    s_mov_b32 s24, 3277
    v_mul_lo_u32 v9, v8, s24
    v_lshrrev_b32 v9, 18, v9
    v_mul_u32_u24 v10, 80, v9
    v_sub_u32 v10, v8, v10
    v_mul_u32_u24 v40, 1312, v9
    v_lshl_add_u32 v40, v10, 4, v40
    v_add_u32 v8, 6400, v0
    s_mov_b32 s24, 3277
    v_mul_lo_u32 v9, v8, s24
    v_lshrrev_b32 v9, 18, v9
    v_mul_u32_u24 v10, 80, v9
    v_sub_u32 v10, v8, v10
    v_mul_u32_u24 v41, 1312, v9
    v_lshl_add_u32 v41, v10, 4, v41
    v_add_u32 v8, 6656, v0
    s_mov_b32 s24, 3277
    v_mul_lo_u32 v9, v8, s24
    v_lshrrev_b32 v9, 18, v9
    v_mul_u32_u24 v10, 80, v9
    v_sub_u32 v10, v8, v10
    v_mul_u32_u24 v42, 1312, v9
    v_lshl_add_u32 v42, v10, 4, v42
    v_add_u32 v8, 6912, v0
    s_mov_b32 s24, 3277
    v_mul_lo_u32 v9, v8, s24
    v_lshrrev_b32 v9, 18, v9
    v_mul_u32_u24 v10, 80, v9
    v_sub_u32 v10, v8, v10
    v_mul_u32_u24 v43, 1312, v9
    v_lshl_add_u32 v43, v10, 4, v43
    v_add_u32 v8, 7168, v0
    s_mov_b32 s24, 3277
    v_mul_lo_u32 v9, v8, s24
    v_lshrrev_b32 v9, 18, v9
    v_mul_u32_u24 v10, 80, v9
    v_sub_u32 v10, v8, v10
    v_mul_u32_u24 v44, 1312, v9
    v_lshl_add_u32 v44, v10, 4, v44
    v_add_u32 v8, 7424, v0
    s_mov_b32 s24, 3277
    v_mul_lo_u32 v9, v8, s24
    v_lshrrev_b32 v9, 18, v9
    v_mul_u32_u24 v10, 80, v9
    v_sub_u32 v10, v8, v10
    v_mul_u32_u24 v45, 1312, v9
    v_lshl_add_u32 v45, v10, 4, v45
    v_lshlrev_b32 v4, 4, v0
    s_mul_i32 s45, s44, 245760
    s_add_u32 s46, s45, 0
    buffer_load_dwordx4 v[48:51], v4, s[12:15], s46 offen
    s_add_u32 s46, s45, 4096
    buffer_load_dwordx4 v[52:55], v4, s[12:15], s46 offen
    s_add_u32 s46, s45, 8192
    buffer_load_dwordx4 v[56:59], v4, s[12:15], s46 offen
    s_add_u32 s46, s45, 12288
    buffer_load_dwordx4 v[60:63], v4, s[12:15], s46 offen
    s_add_u32 s46, s45, 16384
    buffer_load_dwordx4 v[64:67], v4, s[12:15], s46 offen
    s_add_u32 s46, s45, 20480
    buffer_load_dwordx4 v[68:71], v4, s[12:15], s46 offen
    s_add_u32 s46, s45, 24576
    buffer_load_dwordx4 v[72:75], v4, s[12:15], s46 offen
    s_add_u32 s46, s45, 28672
    buffer_load_dwordx4 v[76:79], v4, s[12:15], s46 offen
    s_add_u32 s46, s45, 32768
    buffer_load_dwordx4 v[80:83], v4, s[12:15], s46 offen
    s_add_u32 s46, s45, 36864
    buffer_load_dwordx4 v[84:87], v4, s[12:15], s46 offen
    s_add_u32 s46, s45, 40960
    buffer_load_dwordx4 v[88:91], v4, s[12:15], s46 offen
    s_add_u32 s46, s45, 45056
    buffer_load_dwordx4 v[92:95], v4, s[12:15], s46 offen
    s_add_u32 s46, s45, 49152
    buffer_load_dwordx4 v[96:99], v4, s[12:15], s46 offen
    s_add_u32 s46, s45, 53248
    buffer_load_dwordx4 v[100:103], v4, s[12:15], s46 offen
    s_add_u32 s46, s45, 57344
    buffer_load_dwordx4 v[104:107], v4, s[12:15], s46 offen
    s_add_u32 s46, s45, 61440
    buffer_load_dwordx4 v[108:111], v4, s[12:15], s46 offen
    s_add_u32 s46, s45, 65536
    buffer_load_dwordx4 v[112:115], v4, s[12:15], s46 offen
    s_add_u32 s46, s45, 69632
    buffer_load_dwordx4 v[116:119], v4, s[12:15], s46 offen
    s_add_u32 s46, s45, 73728
    buffer_load_dwordx4 v[120:123], v4, s[12:15], s46 offen
    s_add_u32 s46, s45, 77824
    buffer_load_dwordx4 v[124:127], v4, s[12:15], s46 offen
    s_add_u32 s46, s45, 81920
    buffer_load_dwordx4 v[128:131], v4, s[12:15], s46 offen
    s_add_u32 s46, s45, 86016
    buffer_load_dwordx4 v[132:135], v4, s[12:15], s46 offen
    s_add_u32 s46, s45, 90112
    buffer_load_dwordx4 v[136:139], v4, s[12:15], s46 offen
    s_add_u32 s46, s45, 94208
    buffer_load_dwordx4 v[140:143], v4, s[12:15], s46 offen
    s_add_u32 s46, s45, 98304
    buffer_load_dwordx4 v[144:147], v4, s[12:15], s46 offen
    s_add_u32 s46, s45, 102400
    buffer_load_dwordx4 v[148:151], v4, s[12:15], s46 offen
    s_add_u32 s46, s45, 106496
    buffer_load_dwordx4 v[152:155], v4, s[12:15], s46 offen
    s_add_u32 s46, s45, 110592
    buffer_load_dwordx4 v[156:159], v4, s[12:15], s46 offen
    s_add_u32 s46, s45, 114688
    buffer_load_dwordx4 v[160:163], v4, s[12:15], s46 offen
    s_add_u32 s46, s45, 118784
    buffer_load_dwordx4 v[164:167], v4, s[12:15], s46 offen
    s_add_u32 s46, s45, 122880
    buffer_load_dwordx4 v[168:171], v4, s[12:15], s46 offen
    s_add_u32 s46, s45, 126976
    buffer_load_dwordx4 v[172:175], v4, s[12:15], s46 offen
    s_add_u32 s46, s45, 131072
    buffer_load_dwordx4 v[176:179], v4, s[12:15], s46 offen
    s_add_u32 s46, s45, 135168
    buffer_load_dwordx4 v[180:183], v4, s[12:15], s46 offen
    s_add_u32 s46, s45, 139264
    buffer_load_dwordx4 v[184:187], v4, s[12:15], s46 offen
    s_add_u32 s46, s45, 143360
    buffer_load_dwordx4 v[188:191], v4, s[12:15], s46 offen
    s_add_u32 s46, s45, 147456
    buffer_load_dwordx4 v[192:195], v4, s[12:15], s46 offen
    s_add_u32 s46, s45, 151552
    buffer_load_dwordx4 v[196:199], v4, s[12:15], s46 offen
    s_add_u32 s46, s45, 155648
    buffer_load_dwordx4 v[200:203], v4, s[12:15], s46 offen
    s_add_u32 s46, s45, 159744
    buffer_load_dwordx4 v[204:207], v4, s[12:15], s46 offen
    s_add_u32 s46, s45, 163840
    buffer_load_dwordx4 v[208:211], v4, s[12:15], s46 offen
    s_add_u32 s46, s45, 167936
    buffer_load_dwordx4 v[212:215], v4, s[12:15], s46 offen
    s_add_u32 s46, s45, 172032
    buffer_load_dwordx4 v[216:219], v4, s[12:15], s46 offen
    s_add_u32 s46, s45, 176128
    buffer_load_dwordx4 v[220:223], v4, s[12:15], s46 offen
    s_add_u32 s46, s45, 180224
    buffer_load_dwordx4 v[224:227], v4, s[12:15], s46 offen
    s_add_u32 s46, s45, 184320
    buffer_load_dwordx4 v[228:231], v4, s[12:15], s46 offen
    s_add_u32 s46, s45, 188416
    buffer_load_dwordx4 v[232:235], v4, s[12:15], s46 offen
    s_add_u32 s46, s45, 192512
    buffer_load_dwordx4 v[236:239], v4, s[12:15], s46 offen
    s_add_u32 s46, s45, 196608
    buffer_load_dwordx4 v[240:243], v4, s[12:15], s46 offen
    s_add_u32 s46, s45, 200704
    buffer_load_dwordx4 v[244:247], v4, s[12:15], s46 offen
    s_add_u32 s46, s45, 204800
    buffer_load_dwordx4 v[248:251], v4, s[12:15], s46 offen
    s_add_u32 s46, s45, 208896
    buffer_load_dwordx4 v[252:255], v4, s[12:15], s46 offen
    v_lshrrev_b32 v8, 2, v2
    v_lshl_add_u32 v8, v3, 2, v8
    v_mul_u32_u24 v5, 1312, v8
    v_and_b32 v8, 3, v2
    v_lshl_add_u32 v5, v8, 3, v5
    s_mul_i32 s24, s3, 320
    v_add_u32 v5, s24, v5
    v_add_u32 v6, 62976, v5
    s_waitcnt vmcnt(22)
    ds_write_b128 v16, v[48:51]
    ds_write_b128 v17, v[52:55]
    ds_write_b128 v18, v[56:59]
    ds_write_b128 v19, v[60:63]
    ds_write_b128 v20, v[64:67]
    ds_write_b128 v21, v[68:71]
    ds_write_b128 v22, v[72:75]
    ds_write_b128 v23, v[76:79]
    ds_write_b128 v24, v[80:83]
    ds_write_b128 v25, v[84:87]
    ds_write_b128 v26, v[88:91]
    ds_write_b128 v27, v[92:95]
    ds_write_b128 v28, v[96:99]
    ds_write_b128 v29, v[100:103]
    ds_write_b128 v30, v[104:107]
    ds_write_b128 v31, v[108:111]
    ds_write_b128 v32, v[112:115]
    ds_write_b128 v33, v[116:119]
    ds_write_b128 v34, v[120:123]
    ds_write_b128 v35, v[124:127]
    ds_write_b128 v36, v[128:131]
    ds_write_b128 v37, v[132:135]
    ds_write_b128 v38, v[136:139]
    ds_write_b128 v39, v[140:143]
    ds_write_b128 v40, v[144:147]
    ds_write_b128 v41, v[148:151]
    ds_write_b128 v42, v[152:155]
    ds_write_b128 v43, v[156:159]
    ds_write_b128 v44, v[160:163]
    ds_write_b128 v45, v[164:167]
    s_waitcnt lgkmcnt(0)
    s_add_u32 s46, s45, 212992
    buffer_load_dwordx4 v[48:51], v4, s[12:15], s46 offen
    s_add_u32 s46, s45, 217088
    buffer_load_dwordx4 v[52:55], v4, s[12:15], s46 offen
    s_add_u32 s46, s45, 221184
    buffer_load_dwordx4 v[56:59], v4, s[12:15], s46 offen
    s_add_u32 s46, s45, 225280
    buffer_load_dwordx4 v[60:63], v4, s[12:15], s46 offen
    s_add_u32 s46, s45, 229376
    buffer_load_dwordx4 v[64:67], v4, s[12:15], s46 offen
    s_add_u32 s46, s45, 233472
    buffer_load_dwordx4 v[68:71], v4, s[12:15], s46 offen
    s_add_u32 s46, s45, 237568
    buffer_load_dwordx4 v[72:75], v4, s[12:15], s46 offen
    s_add_u32 s46, s45, 241664
    buffer_load_dwordx4 v[76:79], v4, s[12:15], s46 offen
    s_barrier
    ds_read_b64_tr_b16 a[0:1], v5 offset:0
    ds_read_b64_tr_b16 a[2:3], v5 offset:20992
    ds_read_b64_tr_b16 a[4:5], v6 offset:0
    ds_read_b64_tr_b16 a[6:7], v6 offset:20992
    ds_read_b64_tr_b16 a[16:17], v5 offset:41984
    ds_read_b64_tr_b16 a[18:19], v6 offset:41984
    ds_read_b64_tr_b16 a[24:25], v5 offset:32
    ds_read_b64_tr_b16 a[26:27], v5 offset:21024
    ds_read_b64_tr_b16 a[28:29], v6 offset:32
    ds_read_b64_tr_b16 a[30:31], v6 offset:21024
    ds_read_b64_tr_b16 a[40:41], v5 offset:42016
    ds_read_b64_tr_b16 a[42:43], v6 offset:42016
    ds_read_b64_tr_b16 a[48:49], v5 offset:64
    ds_read_b64_tr_b16 a[50:51], v5 offset:21056
    ds_read_b64_tr_b16 a[52:53], v6 offset:64
    ds_read_b64_tr_b16 a[54:55], v6 offset:21056
    ds_read_b64_tr_b16 a[64:65], v5 offset:42048
    ds_read_b64_tr_b16 a[66:67], v6 offset:42048
    ds_read_b64_tr_b16 a[72:73], v5 offset:96
    ds_read_b64_tr_b16 a[74:75], v5 offset:21088
    ds_read_b64_tr_b16 a[76:77], v6 offset:96
    ds_read_b64_tr_b16 a[78:79], v6 offset:21088
    ds_read_b64_tr_b16 a[88:89], v5 offset:42080
    ds_read_b64_tr_b16 a[90:91], v6 offset:42080
    ds_read_b64_tr_b16 a[96:97], v5 offset:128
    ds_read_b64_tr_b16 a[98:99], v5 offset:21120
    ds_read_b64_tr_b16 a[100:101], v6 offset:128
    ds_read_b64_tr_b16 a[102:103], v6 offset:21120
    ds_read_b64_tr_b16 a[112:113], v5 offset:42112
    ds_read_b64_tr_b16 a[114:115], v6 offset:42112
    ds_read_b64_tr_b16 a[120:121], v5 offset:160
    ds_read_b64_tr_b16 a[122:123], v5 offset:21152
    ds_read_b64_tr_b16 a[124:125], v6 offset:160
    ds_read_b64_tr_b16 a[126:127], v6 offset:21152
    ds_read_b64_tr_b16 a[136:137], v5 offset:42144
    ds_read_b64_tr_b16 a[138:139], v6 offset:42144
    ds_read_b64_tr_b16 a[144:145], v5 offset:192
    ds_read_b64_tr_b16 a[146:147], v5 offset:21184
    ds_read_b64_tr_b16 a[148:149], v6 offset:192
    ds_read_b64_tr_b16 a[150:151], v6 offset:21184
    ds_read_b64_tr_b16 a[160:161], v5 offset:42176
    ds_read_b64_tr_b16 a[162:163], v6 offset:42176
    ds_read_b64_tr_b16 a[168:169], v5 offset:224
    ds_read_b64_tr_b16 a[170:171], v5 offset:21216
    ds_read_b64_tr_b16 a[172:173], v6 offset:224
    ds_read_b64_tr_b16 a[174:175], v6 offset:21216
    ds_read_b64_tr_b16 a[184:185], v5 offset:42208
    ds_read_b64_tr_b16 a[186:187], v6 offset:42208
    ds_read_b64_tr_b16 a[192:193], v5 offset:256
    ds_read_b64_tr_b16 a[194:195], v5 offset:21248
    ds_read_b64_tr_b16 a[196:197], v6 offset:256
    ds_read_b64_tr_b16 a[198:199], v6 offset:21248
    ds_read_b64_tr_b16 a[208:209], v5 offset:42240
    ds_read_b64_tr_b16 a[210:211], v6 offset:42240
    ds_read_b64_tr_b16 a[216:217], v5 offset:288
    ds_read_b64_tr_b16 a[218:219], v5 offset:21280
    ds_read_b64_tr_b16 a[220:221], v6 offset:288
    ds_read_b64_tr_b16 a[222:223], v6 offset:21280
    ds_read_b64_tr_b16 a[232:233], v5 offset:42272
    ds_read_b64_tr_b16 a[234:235], v6 offset:42272
    s_waitcnt lgkmcnt(0)
    s_barrier
    s_waitcnt vmcnt(0)
    ds_write_b128 v16, v[168:171]
    ds_write_b128 v17, v[172:175]
    ds_write_b128 v18, v[176:179]
    ds_write_b128 v19, v[180:183]
    ds_write_b128 v20, v[184:187]
    ds_write_b128 v21, v[188:191]
    ds_write_b128 v22, v[192:195]
    ds_write_b128 v23, v[196:199]
    ds_write_b128 v24, v[200:203]
    ds_write_b128 v25, v[204:207]
    ds_write_b128 v26, v[208:211]
    ds_write_b128 v27, v[212:215]
    ds_write_b128 v28, v[216:219]
    ds_write_b128 v29, v[220:223]
    ds_write_b128 v30, v[224:227]
    ds_write_b128 v31, v[228:231]
    ds_write_b128 v32, v[232:235]
    ds_write_b128 v33, v[236:239]
    ds_write_b128 v34, v[240:243]
    ds_write_b128 v35, v[244:247]
    ds_write_b128 v36, v[248:251]
    ds_write_b128 v37, v[252:255]
    ds_write_b128 v38, v[48:51]
    ds_write_b128 v39, v[52:55]
    ds_write_b128 v40, v[56:59]
    ds_write_b128 v41, v[60:63]
    ds_write_b128 v42, v[64:67]
    ds_write_b128 v43, v[68:71]
    ds_write_b128 v44, v[72:75]
    ds_write_b128 v45, v[76:79]
    s_waitcnt lgkmcnt(0)
    s_barrier
    ds_read_b64_tr_b16 a[8:9], v5 offset:0
    ds_read_b64_tr_b16 a[10:11], v5 offset:20992
    ds_read_b64_tr_b16 a[12:13], v6 offset:0
    ds_read_b64_tr_b16 a[14:15], v6 offset:20992
    ds_read_b64_tr_b16 a[20:21], v5 offset:41984
    ds_read_b64_tr_b16 a[22:23], v6 offset:41984
    ds_read_b64_tr_b16 a[32:33], v5 offset:32
    ds_read_b64_tr_b16 a[34:35], v5 offset:21024
    ds_read_b64_tr_b16 a[36:37], v6 offset:32
    ds_read_b64_tr_b16 a[38:39], v6 offset:21024
    ds_read_b64_tr_b16 a[44:45], v5 offset:42016
    ds_read_b64_tr_b16 a[46:47], v6 offset:42016
    ds_read_b64_tr_b16 a[56:57], v5 offset:64
    ds_read_b64_tr_b16 a[58:59], v5 offset:21056
    ds_read_b64_tr_b16 a[60:61], v6 offset:64
    ds_read_b64_tr_b16 a[62:63], v6 offset:21056
    ds_read_b64_tr_b16 a[68:69], v5 offset:42048
    ds_read_b64_tr_b16 a[70:71], v6 offset:42048
    ds_read_b64_tr_b16 a[80:81], v5 offset:96
    ds_read_b64_tr_b16 a[82:83], v5 offset:21088
    ds_read_b64_tr_b16 a[84:85], v6 offset:96
    ds_read_b64_tr_b16 a[86:87], v6 offset:21088
    ds_read_b64_tr_b16 a[92:93], v5 offset:42080
    ds_read_b64_tr_b16 a[94:95], v6 offset:42080
    ds_read_b64_tr_b16 a[104:105], v5 offset:128
    ds_read_b64_tr_b16 a[106:107], v5 offset:21120
    ds_read_b64_tr_b16 a[108:109], v6 offset:128
    ds_read_b64_tr_b16 a[110:111], v6 offset:21120
    ds_read_b64_tr_b16 a[116:117], v5 offset:42112
    ds_read_b64_tr_b16 a[118:119], v6 offset:42112
    ds_read_b64_tr_b16 a[128:129], v5 offset:160
    ds_read_b64_tr_b16 a[130:131], v5 offset:21152
    ds_read_b64_tr_b16 a[132:133], v6 offset:160
    ds_read_b64_tr_b16 a[134:135], v6 offset:21152
    ds_read_b64_tr_b16 a[140:141], v5 offset:42144
    ds_read_b64_tr_b16 a[142:143], v6 offset:42144
    ds_read_b64_tr_b16 a[152:153], v5 offset:192
    ds_read_b64_tr_b16 a[154:155], v5 offset:21184
    ds_read_b64_tr_b16 a[156:157], v6 offset:192
    ds_read_b64_tr_b16 a[158:159], v6 offset:21184
    ds_read_b64_tr_b16 a[164:165], v5 offset:42176
    ds_read_b64_tr_b16 a[166:167], v6 offset:42176
    ds_read_b64_tr_b16 a[176:177], v5 offset:224
    ds_read_b64_tr_b16 a[178:179], v5 offset:21216
    ds_read_b64_tr_b16 a[180:181], v6 offset:224
    ds_read_b64_tr_b16 a[182:183], v6 offset:21216
    ds_read_b64_tr_b16 a[188:189], v5 offset:42208
    ds_read_b64_tr_b16 a[190:191], v6 offset:42208
    ds_read_b64_tr_b16 a[200:201], v5 offset:256
    ds_read_b64_tr_b16 a[202:203], v5 offset:21248
    ds_read_b64_tr_b16 a[204:205], v6 offset:256
    ds_read_b64_tr_b16 a[206:207], v6 offset:21248
    ds_read_b64_tr_b16 a[212:213], v5 offset:42240
    ds_read_b64_tr_b16 a[214:215], v6 offset:42240
    ds_read_b64_tr_b16 a[224:225], v5 offset:288
    ds_read_b64_tr_b16 a[226:227], v5 offset:21280
    ds_read_b64_tr_b16 a[228:229], v6 offset:288
    ds_read_b64_tr_b16 a[230:231], v6 offset:21280
    ds_read_b64_tr_b16 a[236:237], v5 offset:42272
    ds_read_b64_tr_b16 a[238:239], v6 offset:42272
    s_waitcnt lgkmcnt(0)
    s_barrier
    v_lshlrev_b32 v5, 4, v1
    s_mul_i32 s24, s44, 12288
    v_add_u32 v6, s24, v5
    v_add_u32 v7, 4096, v6
    v_add_u32 v8, 8192, v6
    s_mul_i32 s24, s3, 327680
    s_lshl_b32 s25, s44, 10
    s_add_u32 s24, s24, s25
    v_add_u32 v9, s24, v5
interleave_layers__linear_attn_block__memory_aug_recurrent_mem_tr__prompt_kernel_o_layer:
    s_mul_i32 s93, s92, 29360128
    s_add_u32 s93, s93, 117440512
    s_mul_i32 s94, s92, 16384
    s_add_u32 s94, s94, 23068672
    s_mov_b32 s24, 12288
    s_lshl_b32 s25, s44, 7
    s_add_u32 s24, s24, s25
    s_add_u32 s24, s24, s94
    v_mov_b32 v14, s24
    v_mov_b32 v15, 2146435072
    v_cmp_eq_u32 vcc, 0, v1
    s_nop 1
    v_cndmask_b32 v14, v15, v14, vcc
    s_lshl_b32 s24, s44, 7
    s_add_u32 s24, s24, 8192
    s_add_u32 s24, s24, s94
    v_mov_b32 v10, s24
    s_mov_b32 s41, 33554432
    s_mov_b32 s43, 184549376
    s_mov_b32 s40, 0
    s_mov_b32 s62, -1
    s_mov_b32 s63, 1
    s_cmp_ge_i32 s62, s63
    s_cbranch_scc1 interleave_layers__linear_attn_block__memory_aug_recurrent_mem_tr__prompt_kernel_o_en0_ok
    s_mov_b32 s61, 0
interleave_layers__linear_attn_block__memory_aug_recurrent_mem_tr__prompt_kernel_o_en0:
    buffer_load_dword v11, v10, s[8:11], 0 offen sc1
    s_waitcnt vmcnt(0)
    v_readlane_b32 s62, v11, 0
    s_cmp_ge_i32 s62, s63
    s_cbranch_scc1 interleave_layers__linear_attn_block__memory_aug_recurrent_mem_tr__prompt_kernel_o_en0_ok
    s_add_u32 s61, s61, 1
    s_cmp_ge_u32 s61, s60
    s_cbranch_scc1 interleave_layers__linear_attn_block__memory_aug_recurrent_mem_tr__prompt_kernel_o_en0_to
    s_sleep 2
    s_branch interleave_layers__linear_attn_block__memory_aug_recurrent_mem_tr__prompt_kernel_o_en0
interleave_layers__linear_attn_block__memory_aug_recurrent_mem_tr__prompt_kernel_o_en0_to:
    s_mov_b32 s60, 1
interleave_layers__linear_attn_block__memory_aug_recurrent_mem_tr__prompt_kernel_o_en0_ok:
    buffer_load_dwordx4 v[16:19], v6, s[8:11], s41 offen offset:0 sc1
    buffer_load_dwordx4 v[20:23], v6, s[8:11], s41 offen offset:1024 sc1
    buffer_load_dwordx4 v[24:27], v6, s[8:11], s41 offen offset:2048 sc1
    buffer_load_dwordx4 v[28:31], v6, s[8:11], s41 offen offset:3072 sc1
    buffer_load_dwordx4 v[32:35], v7, s[8:11], s41 offen offset:0 sc1
    buffer_load_dwordx4 v[36:39], v7, s[8:11], s41 offen offset:1024 sc1
    buffer_load_dwordx4 v[40:43], v7, s[8:11], s41 offen offset:2048 sc1
    buffer_load_dwordx4 v[44:47], v7, s[8:11], s41 offen offset:3072 sc1
    buffer_load_dwordx4 v[48:51], v8, s[8:11], s41 offen offset:0 sc1
    buffer_load_dwordx4 v[52:55], v8, s[8:11], s41 offen offset:1024 sc1
    buffer_load_dwordx4 v[56:59], v8, s[8:11], s41 offen offset:2048 sc1
    buffer_load_dwordx4 v[60:63], v8, s[8:11], s41 offen offset:3072 sc1
    s_add_u32 s41, s41, 393216
    s_waitcnt vmcnt(0)
interleave_layers__linear_attn_block__memory_aug_recurrent_mem_tr__prompt_kernel_o_seg:
    v_swap_b32 v26, v36
    v_swap_b32 v27, v37
    v_swap_b32 v50, v60
    v_swap_b32 v51, v61
    v_mfma_f32_16x16x32_bf16 v[112:115], v[16:19], a[0:3], 0
    v_mfma_f32_16x16x32_bf16 v[116:119], v[20:23], a[0:3], 0
    v_mfma_f32_16x16x32_bf16 v[120:123], v[16:19], a[24:27], 0
    v_mfma_f32_16x16x32_bf16 v[124:127], v[20:23], a[24:27], 0
    v_mfma_f32_16x16x32_bf16 v[128:131], v[16:19], a[48:51], 0
    v_mfma_f32_16x16x32_bf16 v[132:135], v[20:23], a[48:51], 0
    v_mfma_f32_16x16x32_bf16 v[136:139], v[16:19], a[72:75], 0
    v_mfma_f32_16x16x32_bf16 v[140:143], v[20:23], a[72:75], 0
    v_mfma_f32_16x16x32_bf16 v[144:147], v[16:19], a[96:99], 0
    v_mfma_f32_16x16x32_bf16 v[148:151], v[20:23], a[96:99], 0
    v_mfma_f32_16x16x32_bf16 v[152:155], v[16:19], a[120:123], 0
    v_mfma_f32_16x16x32_bf16 v[156:159], v[20:23], a[120:123], 0
    v_mfma_f32_16x16x32_bf16 v[160:163], v[16:19], a[144:147], 0
    v_mfma_f32_16x16x32_bf16 v[164:167], v[20:23], a[144:147], 0
    v_mfma_f32_16x16x32_bf16 v[168:171], v[16:19], a[168:171], 0
    v_mfma_f32_16x16x32_bf16 v[172:175], v[20:23], a[168:171], 0
    v_mfma_f32_16x16x32_bf16 v[176:179], v[16:19], a[192:195], 0
    v_mfma_f32_16x16x32_bf16 v[180:183], v[20:23], a[192:195], 0
    v_mfma_f32_16x16x32_bf16 v[184:187], v[16:19], a[216:219], 0
    v_mfma_f32_16x16x32_bf16 v[188:191], v[20:23], a[216:219], 0
    v_mfma_f32_16x16x32_bf16 v[112:115], v[28:31], a[4:7], v[112:115]
    v_mfma_f32_16x16x32_bf16 v[116:119], v[32:35], a[4:7], v[116:119]
    v_mfma_f32_16x16x32_bf16 v[120:123], v[28:31], a[28:31], v[120:123]
    v_mfma_f32_16x16x32_bf16 v[124:127], v[32:35], a[28:31], v[124:127]
    v_mfma_f32_16x16x32_bf16 v[128:131], v[28:31], a[52:55], v[128:131]
    v_mfma_f32_16x16x32_bf16 v[132:135], v[32:35], a[52:55], v[132:135]
    v_mfma_f32_16x16x32_bf16 v[136:139], v[28:31], a[76:79], v[136:139]
    v_mfma_f32_16x16x32_bf16 v[140:143], v[32:35], a[76:79], v[140:143]
    v_mfma_f32_16x16x32_bf16 v[144:147], v[28:31], a[100:103], v[144:147]
    v_mfma_f32_16x16x32_bf16 v[148:151], v[32:35], a[100:103], v[148:151]
    v_mfma_f32_16x16x32_bf16 v[152:155], v[28:31], a[124:127], v[152:155]
    v_mfma_f32_16x16x32_bf16 v[156:159], v[32:35], a[124:127], v[156:159]
    v_mfma_f32_16x16x32_bf16 v[160:163], v[28:31], a[148:151], v[160:163]
    v_mfma_f32_16x16x32_bf16 v[164:167], v[32:35], a[148:151], v[164:167]
    v_mfma_f32_16x16x32_bf16 v[168:171], v[28:31], a[172:175], v[168:171]
    v_mfma_f32_16x16x32_bf16 v[172:175], v[32:35], a[172:175], v[172:175]
    v_mfma_f32_16x16x32_bf16 v[176:179], v[28:31], a[196:199], v[176:179]
    v_mfma_f32_16x16x32_bf16 v[180:183], v[32:35], a[196:199], v[180:183]
    v_mfma_f32_16x16x32_bf16 v[184:187], v[28:31], a[220:223], v[184:187]
    v_mfma_f32_16x16x32_bf16 v[188:191], v[32:35], a[220:223], v[188:191]
    v_mfma_f32_16x16x32_bf16 v[112:115], v[40:43], a[8:11], v[112:115]
    v_mfma_f32_16x16x32_bf16 v[116:119], v[44:47], a[8:11], v[116:119]
    v_mfma_f32_16x16x32_bf16 v[120:123], v[40:43], a[32:35], v[120:123]
    v_mfma_f32_16x16x32_bf16 v[124:127], v[44:47], a[32:35], v[124:127]
    v_mfma_f32_16x16x32_bf16 v[128:131], v[40:43], a[56:59], v[128:131]
    v_mfma_f32_16x16x32_bf16 v[132:135], v[44:47], a[56:59], v[132:135]
    v_mfma_f32_16x16x32_bf16 v[136:139], v[40:43], a[80:83], v[136:139]
    v_mfma_f32_16x16x32_bf16 v[140:143], v[44:47], a[80:83], v[140:143]
    v_mfma_f32_16x16x32_bf16 v[144:147], v[40:43], a[104:107], v[144:147]
    v_mfma_f32_16x16x32_bf16 v[148:151], v[44:47], a[104:107], v[148:151]
    v_mfma_f32_16x16x32_bf16 v[152:155], v[40:43], a[128:131], v[152:155]
    v_mfma_f32_16x16x32_bf16 v[156:159], v[44:47], a[128:131], v[156:159]
    v_mfma_f32_16x16x32_bf16 v[160:163], v[40:43], a[152:155], v[160:163]
    v_mfma_f32_16x16x32_bf16 v[164:167], v[44:47], a[152:155], v[164:167]
    v_mfma_f32_16x16x32_bf16 v[168:171], v[40:43], a[176:179], v[168:171]
    v_mfma_f32_16x16x32_bf16 v[172:175], v[44:47], a[176:179], v[172:175]
    v_mfma_f32_16x16x32_bf16 v[176:179], v[40:43], a[200:203], v[176:179]
    v_mfma_f32_16x16x32_bf16 v[180:183], v[44:47], a[200:203], v[180:183]
    v_mfma_f32_16x16x32_bf16 v[184:187], v[40:43], a[224:227], v[184:187]
    v_mfma_f32_16x16x32_bf16 v[188:191], v[44:47], a[224:227], v[188:191]
    s_cmp_eq_u32 s40, 0
    s_cbranch_scc1 interleave_layers__linear_attn_block__memory_aug_recurrent_mem_tr__prompt_kernel_of33
    s_waitcnt vmcnt(0)
    s_barrier
    s_cmp_eq_u32 s3, 0
    s_cbranch_scc0 interleave_layers__linear_attn_block__memory_aug_recurrent_mem_tr__prompt_kernel_fp34
    v_mov_b32 v15, s40
    buffer_store_dword v15, v14, s[8:11], 0 offen sc1
interleave_layers__linear_attn_block__memory_aug_recurrent_mem_tr__prompt_kernel_fp34:
    s_add_u32 s63, s40, 2
    s_min_u32 s63, s63, 64
    s_cmp_ge_i32 s62, s63
    s_cbranch_scc1 interleave_layers__linear_attn_block__memory_aug_recurrent_mem_tr__prompt_kernel_o_en1_ok
    s_mov_b32 s61, 0
interleave_layers__linear_attn_block__memory_aug_recurrent_mem_tr__prompt_kernel_o_en1:
    buffer_load_dword v11, v10, s[8:11], 0 offen sc1
    s_waitcnt vmcnt(0)
    v_readlane_b32 s62, v11, 0
    s_cmp_ge_i32 s62, s63
    s_cbranch_scc1 interleave_layers__linear_attn_block__memory_aug_recurrent_mem_tr__prompt_kernel_o_en1_ok
    s_add_u32 s61, s61, 1
    s_cmp_ge_u32 s61, s60
    s_cbranch_scc1 interleave_layers__linear_attn_block__memory_aug_recurrent_mem_tr__prompt_kernel_o_en1_to
    s_sleep 2
    s_branch interleave_layers__linear_attn_block__memory_aug_recurrent_mem_tr__prompt_kernel_o_en1
interleave_layers__linear_attn_block__memory_aug_recurrent_mem_tr__prompt_kernel_o_en1_to:
    s_mov_b32 s60, 1
interleave_layers__linear_attn_block__memory_aug_recurrent_mem_tr__prompt_kernel_o_en1_ok:
    buffer_load_dwordx4 v[64:67], v6, s[8:11], s41 offen offset:0 sc1
    buffer_load_dwordx4 v[68:71], v6, s[8:11], s41 offen offset:1024 sc1
    buffer_load_dwordx4 v[72:75], v6, s[8:11], s41 offen offset:2048 sc1
    buffer_load_dwordx4 v[76:79], v6, s[8:11], s41 offen offset:3072 sc1
    buffer_load_dwordx4 v[80:83], v7, s[8:11], s41 offen offset:0 sc1
    buffer_load_dwordx4 v[84:87], v7, s[8:11], s41 offen offset:1024 sc1
    buffer_load_dwordx4 v[88:91], v7, s[8:11], s41 offen offset:2048 sc1
    buffer_load_dwordx4 v[92:95], v7, s[8:11], s41 offen offset:3072 sc1
    buffer_load_dwordx4 v[96:99], v8, s[8:11], s41 offen offset:0 sc1
    buffer_load_dwordx4 v[100:103], v8, s[8:11], s41 offen offset:1024 sc1
    buffer_load_dwordx4 v[104:107], v8, s[8:11], s41 offen offset:2048 sc1
    buffer_load_dwordx4 v[108:111], v8, s[8:11], s41 offen offset:3072 sc1
    s_add_u32 s41, s41, 393216
interleave_layers__linear_attn_block__memory_aug_recurrent_mem_tr__prompt_kernel_of33:
    v_mfma_f32_16x16x32_bf16 v[112:115], v[52:55], a[12:15], v[112:115]
    v_mfma_f32_16x16x32_bf16 v[116:119], v[56:59], a[12:15], v[116:119]
    v_mfma_f32_16x16x32_bf16 v[120:123], v[52:55], a[36:39], v[120:123]
    v_mfma_f32_16x16x32_bf16 v[124:127], v[56:59], a[36:39], v[124:127]
    v_mfma_f32_16x16x32_bf16 v[128:131], v[52:55], a[60:63], v[128:131]
    v_mfma_f32_16x16x32_bf16 v[132:135], v[56:59], a[60:63], v[132:135]
    v_mfma_f32_16x16x32_bf16 v[136:139], v[52:55], a[84:87], v[136:139]
    v_mfma_f32_16x16x32_bf16 v[140:143], v[56:59], a[84:87], v[140:143]
    v_mfma_f32_16x16x32_bf16 v[144:147], v[52:55], a[108:111], v[144:147]
    v_mfma_f32_16x16x32_bf16 v[148:151], v[56:59], a[108:111], v[148:151]
    v_mfma_f32_16x16x32_bf16 v[152:155], v[52:55], a[132:135], v[152:155]
    v_mfma_f32_16x16x32_bf16 v[156:159], v[56:59], a[132:135], v[156:159]
    v_mfma_f32_16x16x32_bf16 v[160:163], v[52:55], a[156:159], v[160:163]
    v_mfma_f32_16x16x32_bf16 v[164:167], v[56:59], a[156:159], v[164:167]
    v_mfma_f32_16x16x32_bf16 v[168:171], v[52:55], a[180:183], v[168:171]
    v_mfma_f32_16x16x32_bf16 v[172:175], v[56:59], a[180:183], v[172:175]
    v_mfma_f32_16x16x32_bf16 v[176:179], v[52:55], a[204:207], v[176:179]
    v_mfma_f32_16x16x32_bf16 v[180:183], v[56:59], a[204:207], v[180:183]
    v_mfma_f32_16x16x32_bf16 v[184:187], v[52:55], a[228:231], v[184:187]
    v_mfma_f32_16x16x32_bf16 v[188:191], v[56:59], a[228:231], v[188:191]
    v_mfma_f32_16x16x32_bf16 v[112:115], v[24:27], a[16:19], v[112:115]
    v_mfma_f32_16x16x32_bf16 v[116:119], v[36:39], a[16:19], v[116:119]
    v_mfma_f32_16x16x32_bf16 v[120:123], v[24:27], a[40:43], v[120:123]
    v_mfma_f32_16x16x32_bf16 v[124:127], v[36:39], a[40:43], v[124:127]
    v_mfma_f32_16x16x32_bf16 v[128:131], v[24:27], a[64:67], v[128:131]
    v_mfma_f32_16x16x32_bf16 v[132:135], v[36:39], a[64:67], v[132:135]
    v_mfma_f32_16x16x32_bf16 v[136:139], v[24:27], a[88:91], v[136:139]
    v_mfma_f32_16x16x32_bf16 v[140:143], v[36:39], a[88:91], v[140:143]
    v_mfma_f32_16x16x32_bf16 v[144:147], v[24:27], a[112:115], v[144:147]
    v_mfma_f32_16x16x32_bf16 v[148:151], v[36:39], a[112:115], v[148:151]
    v_mfma_f32_16x16x32_bf16 v[152:155], v[24:27], a[136:139], v[152:155]
    v_mfma_f32_16x16x32_bf16 v[156:159], v[36:39], a[136:139], v[156:159]
    v_mfma_f32_16x16x32_bf16 v[160:163], v[24:27], a[160:163], v[160:163]
    v_mfma_f32_16x16x32_bf16 v[164:167], v[36:39], a[160:163], v[164:167]
    v_mfma_f32_16x16x32_bf16 v[168:171], v[24:27], a[184:187], v[168:171]
    v_mfma_f32_16x16x32_bf16 v[172:175], v[36:39], a[184:187], v[172:175]
    v_mfma_f32_16x16x32_bf16 v[176:179], v[24:27], a[208:211], v[176:179]
    v_mfma_f32_16x16x32_bf16 v[180:183], v[36:39], a[208:211], v[180:183]
    v_mfma_f32_16x16x32_bf16 v[184:187], v[24:27], a[232:235], v[184:187]
    v_mfma_f32_16x16x32_bf16 v[188:191], v[36:39], a[232:235], v[188:191]
    v_mfma_f32_16x16x32_bf16 v[112:115], v[48:51], a[20:23], v[112:115]
    v_mfma_f32_16x16x32_bf16 v[116:119], v[60:63], a[20:23], v[116:119]
    v_mfma_f32_16x16x32_bf16 v[120:123], v[48:51], a[44:47], v[120:123]
    v_mfma_f32_16x16x32_bf16 v[124:127], v[60:63], a[44:47], v[124:127]
    v_mfma_f32_16x16x32_bf16 v[128:131], v[48:51], a[68:71], v[128:131]
    v_mfma_f32_16x16x32_bf16 v[132:135], v[60:63], a[68:71], v[132:135]
    v_mfma_f32_16x16x32_bf16 v[136:139], v[48:51], a[92:95], v[136:139]
    v_mfma_f32_16x16x32_bf16 v[140:143], v[60:63], a[92:95], v[140:143]
    v_mfma_f32_16x16x32_bf16 v[144:147], v[48:51], a[116:119], v[144:147]
    v_mfma_f32_16x16x32_bf16 v[148:151], v[60:63], a[116:119], v[148:151]
    v_mfma_f32_16x16x32_bf16 v[152:155], v[48:51], a[140:143], v[152:155]
    v_mfma_f32_16x16x32_bf16 v[156:159], v[60:63], a[140:143], v[156:159]
    v_mfma_f32_16x16x32_bf16 v[160:163], v[48:51], a[164:167], v[160:163]
    v_mfma_f32_16x16x32_bf16 v[164:167], v[60:63], a[164:167], v[164:167]
    v_mfma_f32_16x16x32_bf16 v[168:171], v[48:51], a[188:191], v[168:171]
    v_mfma_f32_16x16x32_bf16 v[172:175], v[60:63], a[188:191], v[172:175]
    v_mfma_f32_16x16x32_bf16 v[176:179], v[48:51], a[212:215], v[176:179]
    v_mfma_f32_16x16x32_bf16 v[180:183], v[60:63], a[212:215], v[180:183]
    v_mfma_f32_16x16x32_bf16 v[184:187], v[48:51], a[236:239], v[184:187]
    v_mfma_f32_16x16x32_bf16 v[188:191], v[60:63], a[236:239], v[188:191]
    s_mov_b32 s46, s43
    v_cvt_pk_bf16_f32 v192, v112, v113
    v_cvt_pk_bf16_f32 v193, v114, v115
    v_cvt_pk_bf16_f32 v194, v116, v117
    v_cvt_pk_bf16_f32 v195, v118, v119
    buffer_store_dwordx4 v[192:195], v9, s[8:11], s46 offen sc1
    s_add_u32 s46, s46, 32768
    v_cvt_pk_bf16_f32 v196, v120, v121
    v_cvt_pk_bf16_f32 v197, v122, v123
    v_cvt_pk_bf16_f32 v198, v124, v125
    v_cvt_pk_bf16_f32 v199, v126, v127
    buffer_store_dwordx4 v[196:199], v9, s[8:11], s46 offen sc1
    s_add_u32 s46, s46, 32768
    v_cvt_pk_bf16_f32 v200, v128, v129
    v_cvt_pk_bf16_f32 v201, v130, v131
    v_cvt_pk_bf16_f32 v202, v132, v133
    v_cvt_pk_bf16_f32 v203, v134, v135
    buffer_store_dwordx4 v[200:203], v9, s[8:11], s46 offen sc1
    s_add_u32 s46, s46, 32768
    v_cvt_pk_bf16_f32 v204, v136, v137
    v_cvt_pk_bf16_f32 v205, v138, v139
    v_cvt_pk_bf16_f32 v206, v140, v141
    v_cvt_pk_bf16_f32 v207, v142, v143
    buffer_store_dwordx4 v[204:207], v9, s[8:11], s46 offen sc1
    s_add_u32 s46, s46, 32768
    v_cvt_pk_bf16_f32 v208, v144, v145
    v_cvt_pk_bf16_f32 v209, v146, v147
    v_cvt_pk_bf16_f32 v210, v148, v149
    v_cvt_pk_bf16_f32 v211, v150, v151
    buffer_store_dwordx4 v[208:211], v9, s[8:11], s46 offen sc1
    s_add_u32 s46, s46, 32768
    v_cvt_pk_bf16_f32 v212, v152, v153
    v_cvt_pk_bf16_f32 v213, v154, v155
    v_cvt_pk_bf16_f32 v214, v156, v157
    v_cvt_pk_bf16_f32 v215, v158, v159
    buffer_store_dwordx4 v[212:215], v9, s[8:11], s46 offen sc1
    s_add_u32 s46, s46, 32768
    v_cvt_pk_bf16_f32 v216, v160, v161
    v_cvt_pk_bf16_f32 v217, v162, v163
    v_cvt_pk_bf16_f32 v218, v164, v165
    v_cvt_pk_bf16_f32 v219, v166, v167
    buffer_store_dwordx4 v[216:219], v9, s[8:11], s46 offen sc1
    s_add_u32 s46, s46, 32768
    v_cvt_pk_bf16_f32 v220, v168, v169
    v_cvt_pk_bf16_f32 v221, v170, v171
    v_cvt_pk_bf16_f32 v222, v172, v173
    v_cvt_pk_bf16_f32 v223, v174, v175
    buffer_store_dwordx4 v[220:223], v9, s[8:11], s46 offen sc1
    s_add_u32 s46, s46, 32768
    v_cvt_pk_bf16_f32 v224, v176, v177
    v_cvt_pk_bf16_f32 v225, v178, v179
    v_cvt_pk_bf16_f32 v226, v180, v181
    v_cvt_pk_bf16_f32 v227, v182, v183
    buffer_store_dwordx4 v[224:227], v9, s[8:11], s46 offen sc1
    s_add_u32 s46, s46, 32768
    v_cvt_pk_bf16_f32 v228, v184, v185
    v_cvt_pk_bf16_f32 v229, v186, v187
    v_cvt_pk_bf16_f32 v230, v188, v189
    v_cvt_pk_bf16_f32 v231, v190, v191
    buffer_store_dwordx4 v[228:231], v9, s[8:11], s46 offen sc1
    s_cmp_eq_u32 s40, 0
    s_cbranch_scc0 interleave_layers__linear_attn_block__memory_aug_recurrent_mem_tr__prompt_kernel_of35
    s_waitcnt vmcnt(0)
    s_barrier
    s_cmp_eq_u32 s3, 0
    s_cbranch_scc0 interleave_layers__linear_attn_block__memory_aug_recurrent_mem_tr__prompt_kernel_fp36
    v_mov_b32 v15, 1
    buffer_store_dword v15, v14, s[8:11], 0 offen sc1
interleave_layers__linear_attn_block__memory_aug_recurrent_mem_tr__prompt_kernel_fp36:
    s_add_u32 s63, s40, 2
    s_min_u32 s63, s63, 64
    s_cmp_ge_i32 s62, s63
    s_cbranch_scc1 interleave_layers__linear_attn_block__memory_aug_recurrent_mem_tr__prompt_kernel_o_en3_ok
    s_mov_b32 s61, 0
interleave_layers__linear_attn_block__memory_aug_recurrent_mem_tr__prompt_kernel_o_en3:
    buffer_load_dword v11, v10, s[8:11], 0 offen sc1
    s_waitcnt vmcnt(0)
    v_readlane_b32 s62, v11, 0
    s_cmp_ge_i32 s62, s63
    s_cbranch_scc1 interleave_layers__linear_attn_block__memory_aug_recurrent_mem_tr__prompt_kernel_o_en3_ok
    s_add_u32 s61, s61, 1
    s_cmp_ge_u32 s61, s60
    s_cbranch_scc1 interleave_layers__linear_attn_block__memory_aug_recurrent_mem_tr__prompt_kernel_o_en3_to
    s_sleep 2
    s_branch interleave_layers__linear_attn_block__memory_aug_recurrent_mem_tr__prompt_kernel_o_en3
interleave_layers__linear_attn_block__memory_aug_recurrent_mem_tr__prompt_kernel_o_en3_to:
    s_mov_b32 s60, 1
interleave_layers__linear_attn_block__memory_aug_recurrent_mem_tr__prompt_kernel_o_en3_ok:
    buffer_load_dwordx4 v[64:67], v6, s[8:11], s41 offen offset:0 sc1
    buffer_load_dwordx4 v[68:71], v6, s[8:11], s41 offen offset:1024 sc1
    buffer_load_dwordx4 v[72:75], v6, s[8:11], s41 offen offset:2048 sc1
    buffer_load_dwordx4 v[76:79], v6, s[8:11], s41 offen offset:3072 sc1
    buffer_load_dwordx4 v[80:83], v7, s[8:11], s41 offen offset:0 sc1
    buffer_load_dwordx4 v[84:87], v7, s[8:11], s41 offen offset:1024 sc1
    buffer_load_dwordx4 v[88:91], v7, s[8:11], s41 offen offset:2048 sc1
    buffer_load_dwordx4 v[92:95], v7, s[8:11], s41 offen offset:3072 sc1
    buffer_load_dwordx4 v[96:99], v8, s[8:11], s41 offen offset:0 sc1
    buffer_load_dwordx4 v[100:103], v8, s[8:11], s41 offen offset:1024 sc1
    buffer_load_dwordx4 v[104:107], v8, s[8:11], s41 offen offset:2048 sc1
    buffer_load_dwordx4 v[108:111], v8, s[8:11], s41 offen offset:3072 sc1
    s_add_u32 s41, s41, 393216
    s_waitcnt vmcnt(0)
interleave_layers__linear_attn_block__memory_aug_recurrent_mem_tr__prompt_kernel_of35:
    s_waitcnt vmcnt(10)
    s_add_u32 s40, s40, 1
    s_add_u32 s43, s43, 1310720
    v_swap_b32 v74, v84
    v_swap_b32 v75, v85
    v_swap_b32 v98, v108
    v_swap_b32 v99, v109
    v_mfma_f32_16x16x32_bf16 v[112:115], v[64:67], a[0:3], 0
    v_mfma_f32_16x16x32_bf16 v[116:119], v[68:71], a[0:3], 0
    v_mfma_f32_16x16x32_bf16 v[120:123], v[64:67], a[24:27], 0
    v_mfma_f32_16x16x32_bf16 v[124:127], v[68:71], a[24:27], 0
    v_mfma_f32_16x16x32_bf16 v[128:131], v[64:67], a[48:51], 0
    v_mfma_f32_16x16x32_bf16 v[132:135], v[68:71], a[48:51], 0
    v_mfma_f32_16x16x32_bf16 v[136:139], v[64:67], a[72:75], 0
    v_mfma_f32_16x16x32_bf16 v[140:143], v[68:71], a[72:75], 0
    v_mfma_f32_16x16x32_bf16 v[144:147], v[64:67], a[96:99], 0
    v_mfma_f32_16x16x32_bf16 v[148:151], v[68:71], a[96:99], 0
    v_mfma_f32_16x16x32_bf16 v[152:155], v[64:67], a[120:123], 0
    v_mfma_f32_16x16x32_bf16 v[156:159], v[68:71], a[120:123], 0
    v_mfma_f32_16x16x32_bf16 v[160:163], v[64:67], a[144:147], 0
    v_mfma_f32_16x16x32_bf16 v[164:167], v[68:71], a[144:147], 0
    v_mfma_f32_16x16x32_bf16 v[168:171], v[64:67], a[168:171], 0
    v_mfma_f32_16x16x32_bf16 v[172:175], v[68:71], a[168:171], 0
    v_mfma_f32_16x16x32_bf16 v[176:179], v[64:67], a[192:195], 0
    v_mfma_f32_16x16x32_bf16 v[180:183], v[68:71], a[192:195], 0
    v_mfma_f32_16x16x32_bf16 v[184:187], v[64:67], a[216:219], 0
    v_mfma_f32_16x16x32_bf16 v[188:191], v[68:71], a[216:219], 0
    v_mfma_f32_16x16x32_bf16 v[112:115], v[76:79], a[4:7], v[112:115]
    v_mfma_f32_16x16x32_bf16 v[116:119], v[80:83], a[4:7], v[116:119]
    v_mfma_f32_16x16x32_bf16 v[120:123], v[76:79], a[28:31], v[120:123]
    v_mfma_f32_16x16x32_bf16 v[124:127], v[80:83], a[28:31], v[124:127]
    v_mfma_f32_16x16x32_bf16 v[128:131], v[76:79], a[52:55], v[128:131]
    v_mfma_f32_16x16x32_bf16 v[132:135], v[80:83], a[52:55], v[132:135]
    v_mfma_f32_16x16x32_bf16 v[136:139], v[76:79], a[76:79], v[136:139]
    v_mfma_f32_16x16x32_bf16 v[140:143], v[80:83], a[76:79], v[140:143]
    v_mfma_f32_16x16x32_bf16 v[144:147], v[76:79], a[100:103], v[144:147]
    v_mfma_f32_16x16x32_bf16 v[148:151], v[80:83], a[100:103], v[148:151]
    v_mfma_f32_16x16x32_bf16 v[152:155], v[76:79], a[124:127], v[152:155]
    v_mfma_f32_16x16x32_bf16 v[156:159], v[80:83], a[124:127], v[156:159]
    v_mfma_f32_16x16x32_bf16 v[160:163], v[76:79], a[148:151], v[160:163]
    v_mfma_f32_16x16x32_bf16 v[164:167], v[80:83], a[148:151], v[164:167]
    v_mfma_f32_16x16x32_bf16 v[168:171], v[76:79], a[172:175], v[168:171]
    v_mfma_f32_16x16x32_bf16 v[172:175], v[80:83], a[172:175], v[172:175]
    v_mfma_f32_16x16x32_bf16 v[176:179], v[76:79], a[196:199], v[176:179]
    v_mfma_f32_16x16x32_bf16 v[180:183], v[80:83], a[196:199], v[180:183]
    v_mfma_f32_16x16x32_bf16 v[184:187], v[76:79], a[220:223], v[184:187]
    v_mfma_f32_16x16x32_bf16 v[188:191], v[80:83], a[220:223], v[188:191]
    v_mfma_f32_16x16x32_bf16 v[112:115], v[88:91], a[8:11], v[112:115]
    v_mfma_f32_16x16x32_bf16 v[116:119], v[92:95], a[8:11], v[116:119]
    v_mfma_f32_16x16x32_bf16 v[120:123], v[88:91], a[32:35], v[120:123]
    v_mfma_f32_16x16x32_bf16 v[124:127], v[92:95], a[32:35], v[124:127]
    v_mfma_f32_16x16x32_bf16 v[128:131], v[88:91], a[56:59], v[128:131]
    v_mfma_f32_16x16x32_bf16 v[132:135], v[92:95], a[56:59], v[132:135]
    v_mfma_f32_16x16x32_bf16 v[136:139], v[88:91], a[80:83], v[136:139]
    v_mfma_f32_16x16x32_bf16 v[140:143], v[92:95], a[80:83], v[140:143]
    v_mfma_f32_16x16x32_bf16 v[144:147], v[88:91], a[104:107], v[144:147]
    v_mfma_f32_16x16x32_bf16 v[148:151], v[92:95], a[104:107], v[148:151]
    v_mfma_f32_16x16x32_bf16 v[152:155], v[88:91], a[128:131], v[152:155]
    v_mfma_f32_16x16x32_bf16 v[156:159], v[92:95], a[128:131], v[156:159]
    v_mfma_f32_16x16x32_bf16 v[160:163], v[88:91], a[152:155], v[160:163]
    v_mfma_f32_16x16x32_bf16 v[164:167], v[92:95], a[152:155], v[164:167]
    v_mfma_f32_16x16x32_bf16 v[168:171], v[88:91], a[176:179], v[168:171]
    v_mfma_f32_16x16x32_bf16 v[172:175], v[92:95], a[176:179], v[172:175]
    v_mfma_f32_16x16x32_bf16 v[176:179], v[88:91], a[200:203], v[176:179]
    v_mfma_f32_16x16x32_bf16 v[180:183], v[92:95], a[200:203], v[180:183]
    v_mfma_f32_16x16x32_bf16 v[184:187], v[88:91], a[224:227], v[184:187]
    v_mfma_f32_16x16x32_bf16 v[188:191], v[92:95], a[224:227], v[188:191]
    s_waitcnt vmcnt(0)
    s_barrier
    s_cmp_eq_u32 s3, 0
    s_cbranch_scc0 interleave_layers__linear_attn_block__memory_aug_recurrent_mem_tr__prompt_kernel_fp38
    v_mov_b32 v15, s40
    buffer_store_dword v15, v14, s[8:11], 0 offen sc1
interleave_layers__linear_attn_block__memory_aug_recurrent_mem_tr__prompt_kernel_fp38:
    s_add_u32 s63, s40, 2
    s_min_u32 s63, s63, 64
    s_cmp_ge_i32 s62, s63
    s_cbranch_scc1 interleave_layers__linear_attn_block__memory_aug_recurrent_mem_tr__prompt_kernel_o_en2_ok
    s_mov_b32 s61, 0
interleave_layers__linear_attn_block__memory_aug_recurrent_mem_tr__prompt_kernel_o_en2:
    buffer_load_dword v11, v10, s[8:11], 0 offen sc1
    s_waitcnt vmcnt(0)
    v_readlane_b32 s62, v11, 0
    s_cmp_ge_i32 s62, s63
    s_cbranch_scc1 interleave_layers__linear_attn_block__memory_aug_recurrent_mem_tr__prompt_kernel_o_en2_ok
    s_add_u32 s61, s61, 1
    s_cmp_ge_u32 s61, s60
    s_cbranch_scc1 interleave_layers__linear_attn_block__memory_aug_recurrent_mem_tr__prompt_kernel_o_en2_to
    s_sleep 2
    s_branch interleave_layers__linear_attn_block__memory_aug_recurrent_mem_tr__prompt_kernel_o_en2
interleave_layers__linear_attn_block__memory_aug_recurrent_mem_tr__prompt_kernel_o_en2_to:
    s_mov_b32 s60, 1
interleave_layers__linear_attn_block__memory_aug_recurrent_mem_tr__prompt_kernel_o_en2_ok:
    buffer_load_dwordx4 v[16:19], v6, s[8:11], s41 offen offset:0 sc1
    buffer_load_dwordx4 v[20:23], v6, s[8:11], s41 offen offset:1024 sc1
    buffer_load_dwordx4 v[24:27], v6, s[8:11], s41 offen offset:2048 sc1
    buffer_load_dwordx4 v[28:31], v6, s[8:11], s41 offen offset:3072 sc1
    buffer_load_dwordx4 v[32:35], v7, s[8:11], s41 offen offset:0 sc1
    buffer_load_dwordx4 v[36:39], v7, s[8:11], s41 offen offset:1024 sc1
    buffer_load_dwordx4 v[40:43], v7, s[8:11], s41 offen offset:2048 sc1
    buffer_load_dwordx4 v[44:47], v7, s[8:11], s41 offen offset:3072 sc1
    buffer_load_dwordx4 v[48:51], v8, s[8:11], s41 offen offset:0 sc1
    buffer_load_dwordx4 v[52:55], v8, s[8:11], s41 offen offset:1024 sc1
    buffer_load_dwordx4 v[56:59], v8, s[8:11], s41 offen offset:2048 sc1
    buffer_load_dwordx4 v[60:63], v8, s[8:11], s41 offen offset:3072 sc1
    s_add_u32 s41, s41, 393216
interleave_layers__linear_attn_block__memory_aug_recurrent_mem_tr__prompt_kernel_of37:
    v_mfma_f32_16x16x32_bf16 v[112:115], v[100:103], a[12:15], v[112:115]
    v_mfma_f32_16x16x32_bf16 v[116:119], v[104:107], a[12:15], v[116:119]
    v_mfma_f32_16x16x32_bf16 v[120:123], v[100:103], a[36:39], v[120:123]
    v_mfma_f32_16x16x32_bf16 v[124:127], v[104:107], a[36:39], v[124:127]
    v_mfma_f32_16x16x32_bf16 v[128:131], v[100:103], a[60:63], v[128:131]
    v_mfma_f32_16x16x32_bf16 v[132:135], v[104:107], a[60:63], v[132:135]
    v_mfma_f32_16x16x32_bf16 v[136:139], v[100:103], a[84:87], v[136:139]
    v_mfma_f32_16x16x32_bf16 v[140:143], v[104:107], a[84:87], v[140:143]
    v_mfma_f32_16x16x32_bf16 v[144:147], v[100:103], a[108:111], v[144:147]
    v_mfma_f32_16x16x32_bf16 v[148:151], v[104:107], a[108:111], v[148:151]
    v_mfma_f32_16x16x32_bf16 v[152:155], v[100:103], a[132:135], v[152:155]
    v_mfma_f32_16x16x32_bf16 v[156:159], v[104:107], a[132:135], v[156:159]
    v_mfma_f32_16x16x32_bf16 v[160:163], v[100:103], a[156:159], v[160:163]
    v_mfma_f32_16x16x32_bf16 v[164:167], v[104:107], a[156:159], v[164:167]
    v_mfma_f32_16x16x32_bf16 v[168:171], v[100:103], a[180:183], v[168:171]
    v_mfma_f32_16x16x32_bf16 v[172:175], v[104:107], a[180:183], v[172:175]
    v_mfma_f32_16x16x32_bf16 v[176:179], v[100:103], a[204:207], v[176:179]
    v_mfma_f32_16x16x32_bf16 v[180:183], v[104:107], a[204:207], v[180:183]
    v_mfma_f32_16x16x32_bf16 v[184:187], v[100:103], a[228:231], v[184:187]
    v_mfma_f32_16x16x32_bf16 v[188:191], v[104:107], a[228:231], v[188:191]
    v_mfma_f32_16x16x32_bf16 v[112:115], v[72:75], a[16:19], v[112:115]
    v_mfma_f32_16x16x32_bf16 v[116:119], v[84:87], a[16:19], v[116:119]
    v_mfma_f32_16x16x32_bf16 v[120:123], v[72:75], a[40:43], v[120:123]
    v_mfma_f32_16x16x32_bf16 v[124:127], v[84:87], a[40:43], v[124:127]
    v_mfma_f32_16x16x32_bf16 v[128:131], v[72:75], a[64:67], v[128:131]
    v_mfma_f32_16x16x32_bf16 v[132:135], v[84:87], a[64:67], v[132:135]
    v_mfma_f32_16x16x32_bf16 v[136:139], v[72:75], a[88:91], v[136:139]
    v_mfma_f32_16x16x32_bf16 v[140:143], v[84:87], a[88:91], v[140:143]
    v_mfma_f32_16x16x32_bf16 v[144:147], v[72:75], a[112:115], v[144:147]
    v_mfma_f32_16x16x32_bf16 v[148:151], v[84:87], a[112:115], v[148:151]
    v_mfma_f32_16x16x32_bf16 v[152:155], v[72:75], a[136:139], v[152:155]
    v_mfma_f32_16x16x32_bf16 v[156:159], v[84:87], a[136:139], v[156:159]
    v_mfma_f32_16x16x32_bf16 v[160:163], v[72:75], a[160:163], v[160:163]
    v_mfma_f32_16x16x32_bf16 v[164:167], v[84:87], a[160:163], v[164:167]
    v_mfma_f32_16x16x32_bf16 v[168:171], v[72:75], a[184:187], v[168:171]
    v_mfma_f32_16x16x32_bf16 v[172:175], v[84:87], a[184:187], v[172:175]
    v_mfma_f32_16x16x32_bf16 v[176:179], v[72:75], a[208:211], v[176:179]
    v_mfma_f32_16x16x32_bf16 v[180:183], v[84:87], a[208:211], v[180:183]
    v_mfma_f32_16x16x32_bf16 v[184:187], v[72:75], a[232:235], v[184:187]
    v_mfma_f32_16x16x32_bf16 v[188:191], v[84:87], a[232:235], v[188:191]
    v_mfma_f32_16x16x32_bf16 v[112:115], v[96:99], a[20:23], v[112:115]
    v_mfma_f32_16x16x32_bf16 v[116:119], v[108:111], a[20:23], v[116:119]
    v_mfma_f32_16x16x32_bf16 v[120:123], v[96:99], a[44:47], v[120:123]
    v_mfma_f32_16x16x32_bf16 v[124:127], v[108:111], a[44:47], v[124:127]
    v_mfma_f32_16x16x32_bf16 v[128:131], v[96:99], a[68:71], v[128:131]
    v_mfma_f32_16x16x32_bf16 v[132:135], v[108:111], a[68:71], v[132:135]
    v_mfma_f32_16x16x32_bf16 v[136:139], v[96:99], a[92:95], v[136:139]
    v_mfma_f32_16x16x32_bf16 v[140:143], v[108:111], a[92:95], v[140:143]
    v_mfma_f32_16x16x32_bf16 v[144:147], v[96:99], a[116:119], v[144:147]
    v_mfma_f32_16x16x32_bf16 v[148:151], v[108:111], a[116:119], v[148:151]
    v_mfma_f32_16x16x32_bf16 v[152:155], v[96:99], a[140:143], v[152:155]
    v_mfma_f32_16x16x32_bf16 v[156:159], v[108:111], a[140:143], v[156:159]
    v_mfma_f32_16x16x32_bf16 v[160:163], v[96:99], a[164:167], v[160:163]
    v_mfma_f32_16x16x32_bf16 v[164:167], v[108:111], a[164:167], v[164:167]
    v_mfma_f32_16x16x32_bf16 v[168:171], v[96:99], a[188:191], v[168:171]
    v_mfma_f32_16x16x32_bf16 v[172:175], v[108:111], a[188:191], v[172:175]
    v_mfma_f32_16x16x32_bf16 v[176:179], v[96:99], a[212:215], v[176:179]
    v_mfma_f32_16x16x32_bf16 v[180:183], v[108:111], a[212:215], v[180:183]
    v_mfma_f32_16x16x32_bf16 v[184:187], v[96:99], a[236:239], v[184:187]
    v_mfma_f32_16x16x32_bf16 v[188:191], v[108:111], a[236:239], v[188:191]
    s_mov_b32 s46, s43
    v_cvt_pk_bf16_f32 v192, v112, v113
    v_cvt_pk_bf16_f32 v193, v114, v115
    v_cvt_pk_bf16_f32 v194, v116, v117
    v_cvt_pk_bf16_f32 v195, v118, v119
    buffer_store_dwordx4 v[192:195], v9, s[8:11], s46 offen sc1
    s_add_u32 s46, s46, 32768
    v_cvt_pk_bf16_f32 v196, v120, v121
    v_cvt_pk_bf16_f32 v197, v122, v123
    v_cvt_pk_bf16_f32 v198, v124, v125
    v_cvt_pk_bf16_f32 v199, v126, v127
    buffer_store_dwordx4 v[196:199], v9, s[8:11], s46 offen sc1
    s_add_u32 s46, s46, 32768
    v_cvt_pk_bf16_f32 v200, v128, v129
    v_cvt_pk_bf16_f32 v201, v130, v131
    v_cvt_pk_bf16_f32 v202, v132, v133
    v_cvt_pk_bf16_f32 v203, v134, v135
    buffer_store_dwordx4 v[200:203], v9, s[8:11], s46 offen sc1
    s_add_u32 s46, s46, 32768
    v_cvt_pk_bf16_f32 v204, v136, v137
    v_cvt_pk_bf16_f32 v205, v138, v139
    v_cvt_pk_bf16_f32 v206, v140, v141
    v_cvt_pk_bf16_f32 v207, v142, v143
    buffer_store_dwordx4 v[204:207], v9, s[8:11], s46 offen sc1
    s_add_u32 s46, s46, 32768
    v_cvt_pk_bf16_f32 v208, v144, v145
    v_cvt_pk_bf16_f32 v209, v146, v147
    v_cvt_pk_bf16_f32 v210, v148, v149
    v_cvt_pk_bf16_f32 v211, v150, v151
    buffer_store_dwordx4 v[208:211], v9, s[8:11], s46 offen sc1
    s_add_u32 s46, s46, 32768
    v_cvt_pk_bf16_f32 v212, v152, v153
    v_cvt_pk_bf16_f32 v213, v154, v155
    v_cvt_pk_bf16_f32 v214, v156, v157
    v_cvt_pk_bf16_f32 v215, v158, v159
    buffer_store_dwordx4 v[212:215], v9, s[8:11], s46 offen sc1
    s_add_u32 s46, s46, 32768
    v_cvt_pk_bf16_f32 v216, v160, v161
    v_cvt_pk_bf16_f32 v217, v162, v163
    v_cvt_pk_bf16_f32 v218, v164, v165
    v_cvt_pk_bf16_f32 v219, v166, v167
    buffer_store_dwordx4 v[216:219], v9, s[8:11], s46 offen sc1
    s_add_u32 s46, s46, 32768
    v_cvt_pk_bf16_f32 v220, v168, v169
    v_cvt_pk_bf16_f32 v221, v170, v171
    v_cvt_pk_bf16_f32 v222, v172, v173
    v_cvt_pk_bf16_f32 v223, v174, v175
    buffer_store_dwordx4 v[220:223], v9, s[8:11], s46 offen sc1
    s_add_u32 s46, s46, 32768
    v_cvt_pk_bf16_f32 v224, v176, v177
    v_cvt_pk_bf16_f32 v225, v178, v179
    v_cvt_pk_bf16_f32 v226, v180, v181
    v_cvt_pk_bf16_f32 v227, v182, v183
    buffer_store_dwordx4 v[224:227], v9, s[8:11], s46 offen sc1
    s_add_u32 s46, s46, 32768
    v_cvt_pk_bf16_f32 v228, v184, v185
    v_cvt_pk_bf16_f32 v229, v186, v187
    v_cvt_pk_bf16_f32 v230, v188, v189
    v_cvt_pk_bf16_f32 v231, v190, v191
    buffer_store_dwordx4 v[228:231], v9, s[8:11], s46 offen sc1
    s_waitcnt vmcnt(10)
    s_add_u32 s40, s40, 1
    s_add_u32 s43, s43, 1310720
    s_cmp_lt_u32 s40, 64
    s_cbranch_scc1 interleave_layers__linear_attn_block__memory_aug_recurrent_mem_tr__prompt_kernel_o_seg
    s_waitcnt vmcnt(0)
    s_barrier
    s_cmp_eq_u32 s3, 0
    s_cbranch_scc0 interleave_layers__linear_attn_block__memory_aug_recurrent_mem_tr__prompt_kernel_fp39
    v_mov_b32 v15, s40
    buffer_store_dword v15, v14, s[8:11], 0 offen sc1
interleave_layers__linear_attn_block__memory_aug_recurrent_mem_tr__prompt_kernel_fp39:
    s_cmp_eq_u32 s92, 0
    s_cbranch_scc0 interleave_layers__linear_attn_block__memory_aug_recurrent_mem_tr__prompt_kernel_end
    s_mov_b32 s92, 1
    s_branch interleave_layers__linear_attn_block__memory_aug_recurrent_mem_tr__prompt_kernel_o_layer
interleave_layers__linear_attn_block__memory_aug_recurrent_mem_tr__prompt_kernel_end:
    s_endpgm
.section .rodata,"a"
.p2align 6
.amdhsa_kernel interleave_layers__linear_attn_block__memory_aug_recurrent_mem_tr__prompt_kernel
  .amdhsa_next_free_vgpr 512
  .amdhsa_next_free_sgpr 100
  .amdhsa_accum_offset 256
  .amdhsa_group_segment_fixed_size 0
  .amdhsa_kernarg_size 104
  .amdhsa_user_sgpr_count 2
  .amdhsa_user_sgpr_kernarg_segment_ptr 1
  .amdhsa_system_sgpr_workgroup_id_x 1
.end_amdhsa_kernel
```

```asm
; @launch kernel=interleave_layers__linear_attn_block__memory_aug_recurrent_mem_tr__prompt_kernel grid=(256,1,1) block=(256,1,1) lds=135168
.amdgcn_target "amdgcn-amd-amdhsa--gfx950"
.text
.globl interleave_layers__linear_attn_block__memory_aug_recurrent_mem_tr__prompt_kernel
.p2align 8
.type interleave_layers__linear_attn_block__memory_aug_recurrent_mem_tr__prompt_kernel,@function
interleave_layers__linear_attn_block__memory_aug_recurrent_mem_tr__prompt_kernel:
    s_cmp_ge_u32 s2, 256
    s_cbranch_scc1 interleave_layers__linear_attn_block__memory_aug_recurrent_mem_tr__prompt_kernel_end
    s_load_dwordx2 s[4:5], s[0:1], 96
    s_load_dwordx2 s[6:7], s[0:1], 88
    s_load_dwordx2 s[24:25], s[0:1], 0
    s_and_b32 s44, s2, 7
    s_lshr_b32 s45, s2, 3
    s_and_b32 s26, s44, 3
    s_lshl_b32 s27, s45, 2
    s_add_u32 s26, s26, s27
    s_add_u32 s27, s26, 128
    s_cmp_lt_u32 s26, 104
    s_cselect_b32 s27, s26, s27
    s_add_u32 s26, s26, 104
    s_cmp_lt_u32 s44, 4
    s_cselect_b32 s2, s27, s26
    v_and_b32 v1, 63, v0
    v_lshrrev_b32 v4, 6, v0
    v_and_b32 v2, 15, v1
    v_lshrrev_b32 v3, 4, v1
    v_readfirstlane_b32 s3, v4
    s_mov_b32 s60, 131072
    s_mov_b32 s59, -1
    s_mov_b32 s92, 0
    s_waitcnt lgkmcnt(0)
    s_mov_b32 s8, s4
    s_mov_b32 s9, s5
    s_mov_b32 s10, 268435456
    s_mov_b32 s11, 0x00020000
    s_mov_b32 s72, s6
    s_mov_b32 s73, s7
    s_mov_b32 s74, 256
    s_mov_b32 s75, 0x00020000
    s_mov_b32 s16, s24
    s_mov_b32 s17, s25
    s_mov_b32 s18, 2621440
    s_mov_b32 s19, 0x00020000
    s_cmp_eq_u32 s2, 255
    s_cbranch_scc0 interleave_layers__linear_attn_block__memory_aug_recurrent_mem_tr__prompt_kernel_cf1
    v_lshlrev_b32 v5, 4, v0
    v_mov_b32 v8, -1
    v_mov_b32 v9, -1
    v_mov_b32 v10, -1
    v_mov_b32 v11, -1
    s_mov_b32 s24, 23068672
    buffer_store_dwordx4 v[8:11], v5, s[8:11], s24 offen sc1
    s_add_u32 s24, s24, 4096
    buffer_store_dwordx4 v[8:11], v5, s[8:11], s24 offen sc1
    s_add_u32 s24, s24, 4096
    buffer_store_dwordx4 v[8:11], v5, s[8:11], s24 offen sc1
    s_add_u32 s24, s24, 4096
    buffer_store_dwordx4 v[8:11], v5, s[8:11], s24 offen sc1
    s_add_u32 s24, s24, 4096
    buffer_store_dwordx4 v[8:11], v5, s[8:11], s24 offen sc1
    s_add_u32 s24, s24, 4096
    buffer_store_dwordx4 v[8:11], v5, s[8:11], s24 offen sc1
    s_add_u32 s24, s24, 4096
    buffer_store_dwordx4 v[8:11], v5, s[8:11], s24 offen sc1
    s_add_u32 s24, s24, 4096
    buffer_store_dwordx4 v[8:11], v5, s[8:11], s24 offen sc1
    s_add_u32 s24, s24, 4096
    buffer_store_dwordx4 v[8:11], v5, s[8:11], s24 offen sc1
    s_add_u32 s24, s24, 4096
    buffer_store_dwordx4 v[8:11], v5, s[8:11], s24 offen sc1
    s_add_u32 s24, s24, 4096
    buffer_store_dwordx4 v[8:11], v5, s[8:11], s24 offen sc1
    s_add_u32 s24, s24, 4096
    buffer_store_dwordx4 v[8:11], v5, s[8:11], s24 offen sc1
    s_add_u32 s24, s24, 4096
    buffer_store_dwordx4 v[8:11], v5, s[8:11], s24 offen sc1
    s_add_u32 s24, s24, 4096
    buffer_store_dwordx4 v[8:11], v5, s[8:11], s24 offen sc1
    s_add_u32 s24, s24, 4096
    buffer_store_dwordx4 v[8:11], v5, s[8:11], s24 offen sc1
    s_add_u32 s24, s24, 4096
    buffer_store_dwordx4 v[8:11], v5, s[8:11], s24 offen sc1
    s_add_u32 s24, s24, 4096
interleave_layers__linear_attn_block__memory_aug_recurrent_mem_tr__prompt_kernel_cf1:
    s_mov_b32 s46, 64
    s_mov_b32 s47, 32
    s_mov_b32 s50, 0
    s_lshl_b32 s48, s45, 1
    s_mov_b32 s49, 1
    s_mov_b32 s40, 2
interleave_layers__linear_attn_block__memory_aug_recurrent_mem_tr__prompt_kernel_k1_entry:
    s_load_dwordx2 s[6:7], s[0:1], 8
    s_lshr_b32 s24, s3, 1
    s_mul_i32 s24, s24, 20480
    s_and_b32 s25, s3, 1
    s_mul_i32 s25, s25, 10
    s_mul_i32 s25, s25, s46
    s_add_u32 s24, s24, s25
    s_cmp_eq_u32 s50, 1
    s_cselect_b32 s25, 16, 1280
    s_cselect_b32 s26, 256, 8
    v_mul_u32_u24 v4, s25, v2
    v_mul_u32_u24 v5, s26, v3
    v_add3_u32 v4, v4, v5, s24
    v_add_u32 v5, s47, v4
    s_mul_i32 s43, s48, 40960
    s_mul_i32 s42, s49, 40960
    s_mov_b32 s51, 0
    s_cmp_eq_u32 s92, 0
    s_cbranch_scc0 interleave_layers__linear_attn_block__memory_aug_recurrent_mem_tr__prompt_kernel_k12
    s_mov_b32 s41, s43
    s_mov_b32 s24, s41
    buffer_load_dwordx2 v[16:17], v4, s[16:19], s24 offen sc1
    buffer_load_dwordx2 v[18:19], v5, s[16:19], s24 offen sc1
    s_add_u32 s24, s24, s46
    buffer_load_dwordx2 v[20:21], v4, s[16:19], s24 offen sc1
    buffer_load_dwordx2 v[22:23], v5, s[16:19], s24 offen sc1
    s_add_u32 s24, s24, s46
    buffer_load_dwordx2 v[24:25], v4, s[16:19], s24 offen sc1
    buffer_load_dwordx2 v[26:27], v5, s[16:19], s24 offen sc1
    s_add_u32 s24, s24, s46
    buffer_load_dwordx2 v[28:29], v4, s[16:19], s24 offen sc1
    buffer_load_dwordx2 v[30:31], v5, s[16:19], s24 offen sc1
    s_add_u32 s24, s24, s46
    buffer_load_dwordx2 v[32:33], v4, s[16:19], s24 offen sc1
    buffer_load_dwordx2 v[34:35], v5, s[16:19], s24 offen sc1
    s_add_u32 s24, s24, s46
    buffer_load_dwordx2 v[36:37], v4, s[16:19], s24 offen sc1
    buffer_load_dwordx2 v[38:39], v5, s[16:19], s24 offen sc1
    s_add_u32 s24, s24, s46
    buffer_load_dwordx2 v[40:41], v4, s[16:19], s24 offen sc1
    buffer_load_dwordx2 v[42:43], v5, s[16:19], s24 offen sc1
    s_add_u32 s24, s24, s46
    buffer_load_dwordx2 v[44:45], v4, s[16:19], s24 offen sc1
    buffer_load_dwordx2 v[46:47], v5, s[16:19], s24 offen sc1
    s_add_u32 s24, s24, s46
    buffer_load_dwordx2 v[48:49], v4, s[16:19], s24 offen sc1
    buffer_load_dwordx2 v[50:51], v5, s[16:19], s24 offen sc1
    s_add_u32 s24, s24, s46
    buffer_load_dwordx2 v[52:53], v4, s[16:19], s24 offen sc1
    buffer_load_dwordx2 v[54:55], v5, s[16:19], s24 offen sc1
    s_mov_b32 s51, 1
interleave_layers__linear_attn_block__memory_aug_recurrent_mem_tr__prompt_kernel_k12:
    v_and_b32 v7, 31, v0
    v_lshrrev_b32 v8, 5, v0
    v_mul_u32_u24 v152, 3840, v8
    v_lshlrev_b32 v9, 4, v7
    v_add_u32 v152, v152, v9
    v_cmp_le_u32 vcc, 10, v7
    s_nop 1
    v_cndmask_b32 v10, 0, 1, vcc
    v_cmp_le_u32 vcc, 20, v7
    s_nop 1
    v_cndmask_b32 v11, 0, 1, vcc
    v_add_u32 v10, v10, v11
    v_mul_u32_u24 v10, 1120, v10
    v_add_u32 v152, v152, v10
    v_mov_b32 v10, 2146435072
    v_cmp_le_u32 vcc, 30, v7
    s_nop 1
    v_cndmask_b32 v152, v152, v10, vcc
    v_mul_u32_u24 v153, 544, v8
    v_add_u32 v153, v153, v9
    v_add_u32 v153, 40960, v153
    s_waitcnt lgkmcnt(0)
    s_mov_b32 s12, s6
    s_mov_b32 s13, s7
    s_mov_b32 s14, 2457600
    s_mov_b32 s15, 0x00020000
    s_mul_i32 s52, s44, 160
    s_add_u32 s24, s52, 0
    buffer_load_dwordx4 v[56:59], v152, s[12:15], s24 offen
    s_add_u32 s24, s24, 30720
    buffer_load_dwordx4 v[60:63], v152, s[12:15], s24 offen
    s_add_u32 s24, s24, 30720
    buffer_load_dwordx4 v[64:67], v152, s[12:15], s24 offen
    s_add_u32 s24, s24, 30720
    buffer_load_dwordx4 v[68:71], v152, s[12:15], s24 offen
    s_add_u32 s24, s24, 30720
    buffer_load_dwordx4 v[72:75], v152, s[12:15], s24 offen
    s_add_u32 s24, s24, 30720
    buffer_load_dwordx4 v[76:79], v152, s[12:15], s24 offen
    s_add_u32 s24, s24, 30720
    buffer_load_dwordx4 v[80:83], v152, s[12:15], s24 offen
    s_add_u32 s24, s24, 30720
    buffer_load_dwordx4 v[84:87], v152, s[12:15], s24 offen
    s_add_u32 s24, s52, 245760
    buffer_load_dwordx4 v[88:91], v152, s[12:15], s24 offen
    s_add_u32 s24, s24, 30720
    buffer_load_dwordx4 v[92:95], v152, s[12:15], s24 offen
    s_add_u32 s24, s24, 30720
    buffer_load_dwordx4 v[96:99], v152, s[12:15], s24 offen
    s_add_u32 s24, s24, 30720
    buffer_load_dwordx4 v[100:103], v152, s[12:15], s24 offen
    s_add_u32 s24, s24, 30720
    buffer_load_dwordx4 v[104:107], v152, s[12:15], s24 offen
    s_add_u32 s24, s24, 30720
    buffer_load_dwordx4 v[108:111], v152, s[12:15], s24 offen
    s_add_u32 s24, s24, 30720
    buffer_load_dwordx4 v[112:115], v152, s[12:15], s24 offen
    s_add_u32 s24, s24, 30720
    buffer_load_dwordx4 v[116:119], v152, s[12:15], s24 offen
    s_add_u32 s24, s52, 491520
    buffer_load_dwordx4 v[120:123], v152, s[12:15], s24 offen
    s_add_u32 s24, s24, 30720
    buffer_load_dwordx4 v[124:127], v152, s[12:15], s24 offen
    s_add_u32 s24, s24, 30720
    buffer_load_dwordx4 v[128:131], v152, s[12:15], s24 offen
    s_add_u32 s24, s24, 30720
    buffer_load_dwordx4 v[132:135], v152, s[12:15], s24 offen
    s_add_u32 s24, s24, 30720
    buffer_load_dwordx4 v[136:139], v152, s[12:15], s24 offen
    s_add_u32 s24, s24, 30720
    buffer_load_dwordx4 v[140:143], v152, s[12:15], s24 offen
    s_add_u32 s24, s24, 30720
    buffer_load_dwordx4 v[144:147], v152, s[12:15], s24 offen
    s_add_u32 s24, s24, 30720
    buffer_load_dwordx4 v[148:151], v152, s[12:15], s24 offen
    v_lshrrev_b32 v6, 2, v2
    v_lshl_add_u32 v6, v3, 2, v6
    v_mul_u32_u24 v6, 544, v6
    v_and_b32 v7, 3, v2
    v_lshl_add_u32 v6, v7, 3, v6
    v_add_u32 v6, 40960, v6
    s_mov_b32 s24, 0
    s_cmp_eq_u32 s3, 1
    s_cselect_b32 s24, 64, s24
    s_cmp_eq_u32 s3, 2
    s_cselect_b32 s24, 128, s24
    s_cmp_eq_u32 s3, 3
    s_cselect_b32 s24, 224, s24
    v_add_u32 v12, s24, v6
    s_mov_b32 s24, 32
    s_cmp_eq_u32 s3, 1
    s_cselect_b32 s24, 96, s24
    s_cmp_eq_u32 s3, 2
    s_cselect_b32 s24, 160, s24
    s_cmp_eq_u32 s3, 3
    s_cselect_b32 s24, 256, s24
    v_add_u32 v13, s24, v6
    s_mov_b32 s24, 320
    s_cmp_eq_u32 s3, 1
    s_cselect_b32 s24, 384, s24
    s_cmp_eq_u32 s3, 2
    s_cselect_b32 s24, 192, s24
    s_cmp_eq_u32 s3, 3
    s_cselect_b32 s24, 288, s24
    v_add_u32 v14, s24, v6
    s_mov_b32 s24, 352
    s_cmp_eq_u32 s3, 1
    s_cselect_b32 s24, 416, s24
    s_cmp_eq_u32 s3, 2
    s_cselect_b32 s24, 448, s24
    s_cmp_eq_u32 s3, 3
    s_cselect_b32 s24, 288, s24
    v_add_u32 v15, s24, v6
    v_mov_b32 v172, 0x3f803f80
    v_mov_b32 v173, 0x3f803f80
    v_mov_b32 v174, 0x3f803f80
    v_mov_b32 v175, 0x3f803f80
    s_waitcnt vmcnt(16)
    ds_write_b128 v153, v[56:59] offset:0
    ds_write_b128 v153, v[60:63] offset:4352
    ds_write_b128 v153, v[64:67] offset:8704
    ds_write_b128 v153, v[68:71] offset:13056
    ds_write_b128 v153, v[72:75] offset:17408
    ds_write_b128 v153, v[76:79] offset:21760
    ds_write_b128 v153, v[80:83] offset:26112
    ds_write_b128 v153, v[84:87] offset:30464
    s_waitcnt lgkmcnt(0)
    s_add_u32 s24, s52, 737280
    buffer_load_dwordx4 v[56:59], v152, s[12:15], s24 offen
    s_add_u32 s24, s24, 30720
    buffer_load_dwordx4 v[60:63], v152, s[12:15], s24 offen
    s_add_u32 s24, s24, 30720
    buffer_load_dwordx4 v[64:67], v152, s[12:15], s24 offen
    s_add_u32 s24, s24, 30720
    buffer_load_dwordx4 v[68:71], v152, s[12:15], s24 offen
    s_add_u32 s24, s24, 30720
    buffer_load_dwordx4 v[72:75], v152, s[12:15], s24 offen
    s_add_u32 s24, s24, 30720
    buffer_load_dwordx4 v[76:79], v152, s[12:15], s24 offen
    s_add_u32 s24, s24, 30720
    buffer_load_dwordx4 v[80:83], v152, s[12:15], s24 offen
    s_add_u32 s24, s24, 30720
    buffer_load_dwordx4 v[84:87], v152, s[12:15], s24 offen
    s_barrier
    s_cmp_eq_u32 s2, 255
    s_cbranch_scc0 interleave_layers__linear_attn_block__memory_aug_recurrent_mem_tr__prompt_kernel_fb3
    s_cmp_eq_u32 s92, 0
    s_cbranch_scc0 interleave_layers__linear_attn_block__memory_aug_recurrent_mem_tr__prompt_kernel_fb3
    s_cmp_eq_u32 s3, 0
    s_cbranch_scc0 interleave_layers__linear_attn_block__memory_aug_recurrent_mem_tr__prompt_kernel_fb3
    v_mov_b32 v154, 2146435072
    v_cmp_eq_u32 vcc, 0, v1
    s_nop 1
    v_cndmask_b32 v154, v154, 0, vcc
    v_mov_b32 v155, 1
    buffer_store_dword v155, v154, s[72:75], 0 offen sc1
interleave_layers__linear_attn_block__memory_aug_recurrent_mem_tr__prompt_kernel_fb3:
    ds_read_b64_tr_b16 a[0:1], v12 offset:0
    ds_read_b64_tr_b16 a[2:3], v12 offset:8704
    ds_read_b64_tr_b16 a[4:5], v12 offset:17408
    ds_read_b64_tr_b16 a[6:7], v12 offset:26112
    ds_read_b64_tr_b16 a[80:81], v13 offset:0
    ds_read_b64_tr_b16 a[82:83], v13 offset:8704
    ds_read_b64_tr_b16 a[84:85], v13 offset:17408
    ds_read_b64_tr_b16 a[86:87], v13 offset:26112
    ds_read_b64_tr_b16 a[160:161], v14 offset:0
    ds_read_b64_tr_b16 a[162:163], v14 offset:8704
    ds_read_b64_tr_b16 a[164:165], v14 offset:17408
    ds_read_b64_tr_b16 a[166:167], v14 offset:26112
    ds_read_b64_tr_b16 v[176:177], v15 offset:0
    ds_read_b64_tr_b16 v[178:179], v15 offset:8704
    ds_read_b64_tr_b16 v[180:181], v15 offset:17408
    ds_read_b64_tr_b16 v[182:183], v15 offset:26112
    s_waitcnt vmcnt(16)
    ds_write_b128 v153, v[88:91] offset:34816
    ds_write_b128 v153, v[92:95] offset:39168
    ds_write_b128 v153, v[96:99] offset:43520
    ds_write_b128 v153, v[100:103] offset:47872
    ds_write_b128 v153, v[104:107] offset:52224
    ds_write_b128 v153, v[108:111] offset:56576
    ds_write_b128 v153, v[112:115] offset:60928
    ds_write_b128 v153, v[116:119] offset:65280
    s_waitcnt lgkmcnt(0)
    s_add_u32 s24, s52, 983040
    buffer_load_dwordx4 v[88:91], v152, s[12:15], s24 offen
    s_add_u32 s24, s24, 30720
    buffer_load_dwordx4 v[92:95], v152, s[12:15], s24 offen
    s_add_u32 s24, s24, 30720
    buffer_load_dwordx4 v[96:99], v152, s[12:15], s24 offen
    s_add_u32 s24, s24, 30720
    buffer_load_dwordx4 v[100:103], v152, s[12:15], s24 offen
    s_add_u32 s24, s24, 30720
    buffer_load_dwordx4 v[104:107], v152, s[12:15], s24 offen
    s_add_u32 s24, s24, 30720
    buffer_load_dwordx4 v[108:111], v152, s[12:15], s24 offen
    s_add_u32 s24, s24, 30720
    buffer_load_dwordx4 v[112:115], v152, s[12:15], s24 offen
    s_add_u32 s24, s24, 30720
    buffer_load_dwordx4 v[116:119], v152, s[12:15], s24 offen
    v_mfma_f32_16x16x32_bf16 v[156:159], a[0:3], v[172:175], 0
    v_mfma_f32_16x16x32_bf16 v[160:163], a[80:83], v[172:175], 0
    v_mfma_f32_16x16x32_bf16 v[164:167], a[160:163], v[172:175], 0
    v_mfma_f32_16x16x32_bf16 v[168:171], v[176:179], v[172:175], 0
    v_mfma_f32_16x16x32_bf16 v[156:159], a[4:7], v[172:175], v[156:159]
    v_mfma_f32_16x16x32_bf16 v[160:163], a[84:87], v[172:175], v[160:163]
    v_mfma_f32_16x16x32_bf16 v[164:167], a[164:167], v[172:175], v[164:167]
    v_mfma_f32_16x16x32_bf16 v[168:171], v[180:183], v[172:175], v[168:171]
    s_barrier
    ds_read_b64_tr_b16 a[8:9], v12 offset:34816
    ds_read_b64_tr_b16 a[10:11], v12 offset:43520
    ds_read_b64_tr_b16 a[12:13], v12 offset:52224
    ds_read_b64_tr_b16 a[14:15], v12 offset:60928
    ds_read_b64_tr_b16 a[88:89], v13 offset:34816
    ds_read_b64_tr_b16 a[90:91], v13 offset:43520
    ds_read_b64_tr_b16 a[92:93], v13 offset:52224
    ds_read_b64_tr_b16 a[94:95], v13 offset:60928
    ds_read_b64_tr_b16 a[168:169], v14 offset:34816
    ds_read_b64_tr_b16 a[170:171], v14 offset:43520
    ds_read_b64_tr_b16 a[172:173], v14 offset:52224
    ds_read_b64_tr_b16 a[174:175], v14 offset:60928
    ds_read_b64_tr_b16 v[184:185], v15 offset:34816
    ds_read_b64_tr_b16 v[186:187], v15 offset:43520
    ds_read_b64_tr_b16 v[188:189], v15 offset:52224
    ds_read_b64_tr_b16 v[190:191], v15 offset:60928
    s_waitcnt vmcnt(16)
    ds_write_b128 v153, v[120:123] offset:0
    ds_write_b128 v153, v[124:127] offset:4352
    ds_write_b128 v153, v[128:131] offset:8704
    ds_write_b128 v153, v[132:135] offset:13056
    ds_write_b128 v153, v[136:139] offset:17408
    ds_write_b128 v153, v[140:143] offset:21760
    ds_write_b128 v153, v[144:147] offset:26112
    ds_write_b128 v153, v[148:151] offset:30464
    s_waitcnt lgkmcnt(0)
    s_add_u32 s24, s52, 1228800
    buffer_load_dwordx4 v[120:123], v152, s[12:15], s24 offen
    s_add_u32 s24, s24, 30720
    buffer_load_dwordx4 v[124:127], v152, s[12:15], s24 offen
    s_add_u32 s24, s24, 30720
    buffer_load_dwordx4 v[128:131], v152, s[12:15], s24 offen
    s_add_u32 s24, s24, 30720
    buffer_load_dwordx4 v[132:135], v152, s[12:15], s24 offen
    s_add_u32 s24, s24, 30720
    buffer_load_dwordx4 v[136:139], v152, s[12:15], s24 offen
    s_add_u32 s24, s24, 30720
    buffer_load_dwordx4 v[140:143], v152, s[12:15], s24 offen
    s_add_u32 s24, s24, 30720
    buffer_load_dwordx4 v[144:147], v152, s[12:15], s24 offen
    s_add_u32 s24, s24, 30720
    buffer_load_dwordx4 v[148:151], v152, s[12:15], s24 offen
    v_mfma_f32_16x16x32_bf16 v[156:159], a[8:11], v[172:175], v[156:159]
    v_mfma_f32_16x16x32_bf16 v[160:163], a[88:91], v[172:175], v[160:163]
    v_mfma_f32_16x16x32_bf16 v[164:167], a[168:171], v[172:175], v[164:167]
    v_mfma_f32_16x16x32_bf16 v[168:171], v[184:187], v[172:175], v[168:171]
    v_mfma_f32_16x16x32_bf16 v[156:159], a[12:15], v[172:175], v[156:159]
    v_mfma_f32_16x16x32_bf16 v[160:163], a[92:95], v[172:175], v[160:163]
    v_mfma_f32_16x16x32_bf16 v[164:167], a[172:175], v[172:175], v[164:167]
    v_mfma_f32_16x16x32_bf16 v[168:171], v[188:191], v[172:175], v[168:171]
    s_barrier
    ds_read_b64_tr_b16 a[16:17], v12 offset:0
    ds_read_b64_tr_b16 a[18:19], v12 offset:8704
    ds_read_b64_tr_b16 a[20:21], v12 offset:17408
    ds_read_b64_tr_b16 a[22:23], v12 offset:26112
    ds_read_b64_tr_b16 a[96:97], v13 offset:0
    ds_read_b64_tr_b16 a[98:99], v13 offset:8704
    ds_read_b64_tr_b16 a[100:101], v13 offset:17408
    ds_read_b64_tr_b16 a[102:103], v13 offset:26112
    ds_read_b64_tr_b16 a[176:177], v14 offset:0
    ds_read_b64_tr_b16 a[178:179], v14 offset:8704
    ds_read_b64_tr_b16 a[180:181], v14 offset:17408
    ds_read_b64_tr_b16 a[182:183], v14 offset:26112
    ds_read_b64_tr_b16 v[192:193], v15 offset:0
    ds_read_b64_tr_b16 v[194:195], v15 offset:8704
    ds_read_b64_tr_b16 v[196:197], v15 offset:17408
    ds_read_b64_tr_b16 v[198:199], v15 offset:26112
    s_waitcnt vmcnt(16)
    ds_write_b128 v153, v[56:59] offset:34816
    ds_write_b128 v153, v[60:63] offset:39168
    ds_write_b128 v153, v[64:67] offset:43520
    ds_write_b128 v153, v[68:71] offset:47872
    ds_write_b128 v153, v[72:75] offset:52224
    ds_write_b128 v153, v[76:79] offset:56576
    ds_write_b128 v153, v[80:83] offset:60928
    ds_write_b128 v153, v[84:87] offset:65280
    s_waitcnt lgkmcnt(0)
    s_add_u32 s24, s52, 1474560
    buffer_load_dwordx4 v[56:59], v152, s[12:15], s24 offen
    s_add_u32 s24, s24, 30720
    buffer_load_dwordx4 v[60:63], v152, s[12:15], s24 offen
    s_add_u32 s24, s24, 30720
    buffer_load_dwordx4 v[64:67], v152, s[12:15], s24 offen
    s_add_u32 s24, s24, 30720
    buffer_load_dwordx4 v[68:71], v152, s[12:15], s24 offen
    s_add_u32 s24, s24, 30720
    buffer_load_dwordx4 v[72:75], v152, s[12:15], s24 offen
    s_add_u32 s24, s24, 30720
    buffer_load_dwordx4 v[76:79], v152, s[12:15], s24 offen
    s_add_u32 s24, s24, 30720
    buffer_load_dwordx4 v[80:83], v152, s[12:15], s24 offen
    s_add_u32 s24, s24, 30720
    buffer_load_dwordx4 v[84:87], v152, s[12:15], s24 offen
    v_mfma_f32_16x16x32_bf16 v[156:159], a[16:19], v[172:175], v[156:159]
    v_mfma_f32_16x16x32_bf16 v[160:163], a[96:99], v[172:175], v[160:163]
    v_mfma_f32_16x16x32_bf16 v[164:167], a[176:179], v[172:175], v[164:167]
    v_mfma_f32_16x16x32_bf16 v[168:171], v[192:195], v[172:175], v[168:171]
    v_mfma_f32_16x16x32_bf16 v[156:159], a[20:23], v[172:175], v[156:159]
    v_mfma_f32_16x16x32_bf16 v[160:163], a[100:103], v[172:175], v[160:163]
    v_mfma_f32_16x16x32_bf16 v[164:167], a[180:183], v[172:175], v[164:167]
    v_mfma_f32_16x16x32_bf16 v[168:171], v[196:199], v[172:175], v[168:171]
    s_barrier
    ds_read_b64_tr_b16 a[24:25], v12 offset:34816
    ds_read_b64_tr_b16 a[26:27], v12 offset:43520
    ds_read_b64_tr_b16 a[28:29], v12 offset:52224
    ds_read_b64_tr_b16 a[30:31], v12 offset:60928
    ds_read_b64_tr_b16 a[104:105], v13 offset:34816
    ds_read_b64_tr_b16 a[106:107], v13 offset:43520
    ds_read_b64_tr_b16 a[108:109], v13 offset:52224
    ds_read_b64_tr_b16 a[110:111], v13 offset:60928
    ds_read_b64_tr_b16 a[184:185], v14 offset:34816
    ds_read_b64_tr_b16 a[186:187], v14 offset:43520
    ds_read_b64_tr_b16 a[188:189], v14 offset:52224
    ds_read_b64_tr_b16 a[190:191], v14 offset:60928
    ds_read_b64_tr_b16 v[200:201], v15 offset:34816
    ds_read_b64_tr_b16 v[202:203], v15 offset:43520
    ds_read_b64_tr_b16 v[204:205], v15 offset:52224
    ds_read_b64_tr_b16 v[206:207], v15 offset:60928
    s_waitcnt vmcnt(16)
    ds_write_b128 v153, v[88:91] offset:0
    ds_write_b128 v153, v[92:95] offset:4352
    ds_write_b128 v153, v[96:99] offset:8704
    ds_write_b128 v153, v[100:103] offset:13056
    ds_write_b128 v153, v[104:107] offset:17408
    ds_write_b128 v153, v[108:111] offset:21760
    ds_write_b128 v153, v[112:115] offset:26112
    ds_write_b128 v153, v[116:119] offset:30464
    s_waitcnt lgkmcnt(0)
    s_add_u32 s24, s52, 1720320
    buffer_load_dwordx4 v[88:91], v152, s[12:15], s24 offen
    s_add_u32 s24, s24, 30720
    buffer_load_dwordx4 v[92:95], v152, s[12:15], s24 offen
    s_add_u32 s24, s24, 30720
    buffer_load_dwordx4 v[96:99], v152, s[12:15], s24 offen
    s_add_u32 s24, s24, 30720
    buffer_load_dwordx4 v[100:103], v152, s[12:15], s24 offen
    s_add_u32 s24, s24, 30720
    buffer_load_dwordx4 v[104:107], v152, s[12:15], s24 offen
    s_add_u32 s24, s24, 30720
    buffer_load_dwordx4 v[108:111], v152, s[12:15], s24 offen
    s_add_u32 s24, s24, 30720
    buffer_load_dwordx4 v[112:115], v152, s[12:15], s24 offen
    s_add_u32 s24, s24, 30720
    buffer_load_dwordx4 v[116:119], v152, s[12:15], s24 offen
    v_mfma_f32_16x16x32_bf16 v[156:159], a[24:27], v[172:175], v[156:159]
    v_mfma_f32_16x16x32_bf16 v[160:163], a[104:107], v[172:175], v[160:163]
    v_mfma_f32_16x16x32_bf16 v[164:167], a[184:187], v[172:175], v[164:167]
    v_mfma_f32_16x16x32_bf16 v[168:171], v[200:203], v[172:175], v[168:171]
    v_mfma_f32_16x16x32_bf16 v[156:159], a[28:31], v[172:175], v[156:159]
    v_mfma_f32_16x16x32_bf16 v[160:163], a[108:111], v[172:175], v[160:163]
    v_mfma_f32_16x16x32_bf16 v[164:167], a[188:191], v[172:175], v[164:167]
    v_mfma_f32_16x16x32_bf16 v[168:171], v[204:207], v[172:175], v[168:171]
    s_barrier
    ds_read_b64_tr_b16 a[32:33], v12 offset:0
    ds_read_b64_tr_b16 a[34:35], v12 offset:8704
    ds_read_b64_tr_b16 a[36:37], v12 offset:17408
    ds_read_b64_tr_b16 a[38:39], v12 offset:26112
    ds_read_b64_tr_b16 a[112:113], v13 offset:0
    ds_read_b64_tr_b16 a[114:115], v13 offset:8704
    ds_read_b64_tr_b16 a[116:117], v13 offset:17408
    ds_read_b64_tr_b16 a[118:119], v13 offset:26112
    ds_read_b64_tr_b16 a[192:193], v14 offset:0
    ds_read_b64_tr_b16 a[194:195], v14 offset:8704
    ds_read_b64_tr_b16 a[196:197], v14 offset:17408
    ds_read_b64_tr_b16 a[198:199], v14 offset:26112
    ds_read_b64_tr_b16 v[208:209], v15 offset:0
    ds_read_b64_tr_b16 v[210:211], v15 offset:8704
    ds_read_b64_tr_b16 v[212:213], v15 offset:17408
    ds_read_b64_tr_b16 v[214:215], v15 offset:26112
    s_waitcnt vmcnt(16)
    ds_write_b128 v153, v[120:123] offset:34816
    ds_write_b128 v153, v[124:127] offset:39168
    ds_write_b128 v153, v[128:131] offset:43520
    ds_write_b128 v153, v[132:135] offset:47872
    ds_write_b128 v153, v[136:139] offset:52224
    ds_write_b128 v153, v[140:143] offset:56576
    ds_write_b128 v153, v[144:147] offset:60928
    ds_write_b128 v153, v[148:151] offset:65280
    s_waitcnt lgkmcnt(0)
    s_add_u32 s24, s52, 1966080
    buffer_load_dwordx4 v[120:123], v152, s[12:15], s24 offen
    s_add_u32 s24, s24, 30720
    buffer_load_dwordx4 v[124:127], v152, s[12:15], s24 offen
    s_add_u32 s24, s24, 30720
    buffer_load_dwordx4 v[128:131], v152, s[12:15], s24 offen
    s_add_u32 s24, s24, 30720
    buffer_load_dwordx4 v[132:135], v152, s[12:15], s24 offen
    s_add_u32 s24, s24, 30720
    buffer_load_dwordx4 v[136:139], v152, s[12:15], s24 offen
    s_add_u32 s24, s24, 30720
    buffer_load_dwordx4 v[140:143], v152, s[12:15], s24 offen
    s_add_u32 s24, s24, 30720
    buffer_load_dwordx4 v[144:147], v152, s[12:15], s24 offen
    s_add_u32 s24, s24, 30720
    buffer_load_dwordx4 v[148:151], v152, s[12:15], s24 offen
    v_mfma_f32_16x16x32_bf16 v[156:159], a[32:35], v[172:175], v[156:159]
    v_mfma_f32_16x16x32_bf16 v[160:163], a[112:115], v[172:175], v[160:163]
    v_mfma_f32_16x16x32_bf16 v[164:167], a[192:195], v[172:175], v[164:167]
    v_mfma_f32_16x16x32_bf16 v[168:171], v[208:211], v[172:175], v[168:171]
    v_mfma_f32_16x16x32_bf16 v[156:159], a[36:39], v[172:175], v[156:159]
    v_mfma_f32_16x16x32_bf16 v[160:163], a[116:119], v[172:175], v[160:163]
    v_mfma_f32_16x16x32_bf16 v[164:167], a[196:199], v[172:175], v[164:167]
    v_mfma_f32_16x16x32_bf16 v[168:171], v[212:215], v[172:175], v[168:171]
    s_barrier
    ds_read_b64_tr_b16 a[40:41], v12 offset:34816
    ds_read_b64_tr_b16 a[42:43], v12 offset:43520
    ds_read_b64_tr_b16 a[44:45], v12 offset:52224
    ds_read_b64_tr_b16 a[46:47], v12 offset:60928
    ds_read_b64_tr_b16 a[120:121], v13 offset:34816
    ds_read_b64_tr_b16 a[122:123], v13 offset:43520
    ds_read_b64_tr_b16 a[124:125], v13 offset:52224
    ds_read_b64_tr_b16 a[126:127], v13 offset:60928
    ds_read_b64_tr_b16 a[200:201], v14 offset:34816
    ds_read_b64_tr_b16 a[202:203], v14 offset:43520
    ds_read_b64_tr_b16 a[204:205], v14 offset:52224
    ds_read_b64_tr_b16 a[206:207], v14 offset:60928
    ds_read_b64_tr_b16 v[216:217], v15 offset:34816
    ds_read_b64_tr_b16 v[218:219], v15 offset:43520
    ds_read_b64_tr_b16 v[220:221], v15 offset:52224
    ds_read_b64_tr_b16 v[222:223], v15 offset:60928
    s_waitcnt vmcnt(16)
    ds_write_b128 v153, v[56:59] offset:0
    ds_write_b128 v153, v[60:63] offset:4352
    ds_write_b128 v153, v[64:67] offset:8704
    ds_write_b128 v153, v[68:71] offset:13056
    ds_write_b128 v153, v[72:75] offset:17408
    ds_write_b128 v153, v[76:79] offset:21760
    ds_write_b128 v153, v[80:83] offset:26112
    ds_write_b128 v153, v[84:87] offset:30464
    s_waitcnt lgkmcnt(0)
    s_add_u32 s24, s52, 2211840
    buffer_load_dwordx4 v[56:59], v152, s[12:15], s24 offen
    s_add_u32 s24, s24, 30720
    buffer_load_dwordx4 v[60:63], v152, s[12:15], s24 offen
    s_add_u32 s24, s24, 30720
    buffer_load_dwordx4 v[64:67], v152, s[12:15], s24 offen
    s_add_u32 s24, s24, 30720
    buffer_load_dwordx4 v[68:71], v152, s[12:15], s24 offen
    s_add_u32 s24, s24, 30720
    buffer_load_dwordx4 v[72:75], v152, s[12:15], s24 offen
    s_add_u32 s24, s24, 30720
    buffer_load_dwordx4 v[76:79], v152, s[12:15], s24 offen
    s_add_u32 s24, s24, 30720
    buffer_load_dwordx4 v[80:83], v152, s[12:15], s24 offen
    s_add_u32 s24, s24, 30720
    buffer_load_dwordx4 v[84:87], v152, s[12:15], s24 offen
    v_mfma_f32_16x16x32_bf16 v[156:159], a[40:43], v[172:175], v[156:159]
    v_mfma_f32_16x16x32_bf16 v[160:163], a[120:123], v[172:175], v[160:163]
    v_mfma_f32_16x16x32_bf16 v[164:167], a[200:203], v[172:175], v[164:167]
    v_mfma_f32_16x16x32_bf16 v[168:171], v[216:219], v[172:175], v[168:171]
    v_mfma_f32_16x16x32_bf16 v[156:159], a[44:47], v[172:175], v[156:159]
    v_mfma_f32_16x16x32_bf16 v[160:163], a[124:127], v[172:175], v[160:163]
    v_mfma_f32_16x16x32_bf16 v[164:167], a[204:207], v[172:175], v[164:167]
    v_mfma_f32_16x16x32_bf16 v[168:171], v[220:223], v[172:175], v[168:171]
    s_barrier
    ds_read_b64_tr_b16 a[48:49], v12 offset:0
    ds_read_b64_tr_b16 a[50:51], v12 offset:8704
    ds_read_b64_tr_b16 a[52:53], v12 offset:17408
    ds_read_b64_tr_b16 a[54:55], v12 offset:26112
    ds_read_b64_tr_b16 a[128:129], v13 offset:0
    ds_read_b64_tr_b16 a[130:131], v13 offset:8704
    ds_read_b64_tr_b16 a[132:133], v13 offset:17408
    ds_read_b64_tr_b16 a[134:135], v13 offset:26112
    ds_read_b64_tr_b16 a[208:209], v14 offset:0
    ds_read_b64_tr_b16 a[210:211], v14 offset:8704
    ds_read_b64_tr_b16 a[212:213], v14 offset:17408
    ds_read_b64_tr_b16 a[214:215], v14 offset:26112
    ds_read_b64_tr_b16 v[224:225], v15 offset:0
    ds_read_b64_tr_b16 v[226:227], v15 offset:8704
    ds_read_b64_tr_b16 v[228:229], v15 offset:17408
    ds_read_b64_tr_b16 v[230:231], v15 offset:26112
    s_waitcnt vmcnt(16)
    ds_write_b128 v153, v[88:91] offset:34816
    ds_write_b128 v153, v[92:95] offset:39168
    ds_write_b128 v153, v[96:99] offset:43520
    ds_write_b128 v153, v[100:103] offset:47872
    ds_write_b128 v153, v[104:107] offset:52224
    ds_write_b128 v153, v[108:111] offset:56576
    ds_write_b128 v153, v[112:115] offset:60928
    ds_write_b128 v153, v[116:119] offset:65280
    s_waitcnt lgkmcnt(0)
    v_mfma_f32_16x16x32_bf16 v[156:159], a[48:51], v[172:175], v[156:159]
    v_mfma_f32_16x16x32_bf16 v[160:163], a[128:131], v[172:175], v[160:163]
    v_mfma_f32_16x16x32_bf16 v[164:167], a[208:211], v[172:175], v[164:167]
    v_mfma_f32_16x16x32_bf16 v[168:171], v[224:227], v[172:175], v[168:171]
    v_mfma_f32_16x16x32_bf16 v[156:159], a[52:55], v[172:175], v[156:159]
    v_mfma_f32_16x16x32_bf16 v[160:163], a[132:135], v[172:175], v[160:163]
    v_mfma_f32_16x16x32_bf16 v[164:167], a[212:215], v[172:175], v[164:167]
    v_mfma_f32_16x16x32_bf16 v[168:171], v[228:231], v[172:175], v[168:171]
    s_barrier
    ds_read_b64_tr_b16 a[56:57], v12 offset:34816
    ds_read_b64_tr_b16 a[58:59], v12 offset:43520
    ds_read_b64_tr_b16 a[60:61], v12 offset:52224
    ds_read_b64_tr_b16 a[62:63], v12 offset:60928
    ds_read_b64_tr_b16 a[136:137], v13 offset:34816
    ds_read_b64_tr_b16 a[138:139], v13 offset:43520
    ds_read_b64_tr_b16 a[140:141], v13 offset:52224
    ds_read_b64_tr_b16 a[142:143], v13 offset:60928
    ds_read_b64_tr_b16 a[216:217], v14 offset:34816
    ds_read_b64_tr_b16 a[218:219], v14 offset:43520
    ds_read_b64_tr_b16 a[220:221], v14 offset:52224
    ds_read_b64_tr_b16 a[222:223], v14 offset:60928
    ds_read_b64_tr_b16 v[232:233], v15 offset:34816
    ds_read_b64_tr_b16 v[234:235], v15 offset:43520
    ds_read_b64_tr_b16 v[236:237], v15 offset:52224
    ds_read_b64_tr_b16 v[238:239], v15 offset:60928
    s_waitcnt vmcnt(8)
    ds_write_b128 v153, v[120:123] offset:0
    ds_write_b128 v153, v[124:127] offset:4352
    ds_write_b128 v153, v[128:131] offset:8704
    ds_write_b128 v153, v[132:135] offset:13056
    ds_write_b128 v153, v[136:139] offset:17408
    ds_write_b128 v153, v[140:143] offset:21760
    ds_write_b128 v153, v[144:147] offset:26112
    ds_write_b128 v153, v[148:151] offset:30464
    s_waitcnt lgkmcnt(0)
    v_mfma_f32_16x16x32_bf16 v[156:159], a[56:59], v[172:175], v[156:159]
    v_mfma_f32_16x16x32_bf16 v[160:163], a[136:139], v[172:175], v[160:163]
    v_mfma_f32_16x16x32_bf16 v[164:167], a[216:219], v[172:175], v[164:167]
    v_mfma_f32_16x16x32_bf16 v[168:171], v[232:235], v[172:175], v[168:171]
    v_mfma_f32_16x16x32_bf16 v[156:159], a[60:63], v[172:175], v[156:159]
    v_mfma_f32_16x16x32_bf16 v[160:163], a[140:143], v[172:175], v[160:163]
    v_mfma_f32_16x16x32_bf16 v[164:167], a[220:223], v[172:175], v[164:167]
    v_mfma_f32_16x16x32_bf16 v[168:171], v[236:239], v[172:175], v[168:171]
    s_barrier
    ds_read_b64_tr_b16 a[64:65], v12 offset:0
    ds_read_b64_tr_b16 a[66:67], v12 offset:8704
    ds_read_b64_tr_b16 a[68:69], v12 offset:17408
    ds_read_b64_tr_b16 a[70:71], v12 offset:26112
    ds_read_b64_tr_b16 a[144:145], v13 offset:0
    ds_read_b64_tr_b16 a[146:147], v13 offset:8704
    ds_read_b64_tr_b16 a[148:149], v13 offset:17408
    ds_read_b64_tr_b16 a[150:151], v13 offset:26112
    ds_read_b64_tr_b16 a[224:225], v14 offset:0
    ds_read_b64_tr_b16 a[226:227], v14 offset:8704
    ds_read_b64_tr_b16 a[228:229], v14 offset:17408
    ds_read_b64_tr_b16 a[230:231], v14 offset:26112
    ds_read_b64_tr_b16 v[240:241], v15 offset:0
    ds_read_b64_tr_b16 v[242:243], v15 offset:8704
    ds_read_b64_tr_b16 v[244:245], v15 offset:17408
    ds_read_b64_tr_b16 v[246:247], v15 offset:26112
    s_waitcnt vmcnt(0)
    ds_write_b128 v153, v[56:59] offset:34816
    ds_write_b128 v153, v[60:63] offset:39168
    ds_write_b128 v153, v[64:67] offset:43520
    ds_write_b128 v153, v[68:71] offset:47872
    ds_write_b128 v153, v[72:75] offset:52224
    ds_write_b128 v153, v[76:79] offset:56576
    ds_write_b128 v153, v[80:83] offset:60928
    ds_write_b128 v153, v[84:87] offset:65280
    s_waitcnt lgkmcnt(0)
    v_mfma_f32_16x16x32_bf16 v[156:159], a[64:67], v[172:175], v[156:159]
    v_mfma_f32_16x16x32_bf16 v[160:163], a[144:147], v[172:175], v[160:163]
    v_mfma_f32_16x16x32_bf16 v[164:167], a[224:227], v[172:175], v[164:167]
    v_mfma_f32_16x16x32_bf16 v[168:171], v[240:243], v[172:175], v[168:171]
    v_mfma_f32_16x16x32_bf16 v[156:159], a[68:71], v[172:175], v[156:159]
    v_mfma_f32_16x16x32_bf16 v[160:163], a[148:151], v[172:175], v[160:163]
    v_mfma_f32_16x16x32_bf16 v[164:167], a[228:231], v[172:175], v[164:167]
    v_mfma_f32_16x16x32_bf16 v[168:171], v[244:247], v[172:175], v[168:171]
    s_barrier
    ds_read_b64_tr_b16 a[72:73], v12 offset:34816
    ds_read_b64_tr_b16 a[74:75], v12 offset:43520
    ds_read_b64_tr_b16 a[76:77], v12 offset:52224
    ds_read_b64_tr_b16 a[78:79], v12 offset:60928
    ds_read_b64_tr_b16 a[152:153], v13 offset:34816
    ds_read_b64_tr_b16 a[154:155], v13 offset:43520
    ds_read_b64_tr_b16 a[156:157], v13 offset:52224
    ds_read_b64_tr_b16 a[158:159], v13 offset:60928
    ds_read_b64_tr_b16 a[232:233], v14 offset:34816
    ds_read_b64_tr_b16 a[234:235], v14 offset:43520
    ds_read_b64_tr_b16 a[236:237], v14 offset:52224
    ds_read_b64_tr_b16 a[238:239], v14 offset:60928
    ds_read_b64_tr_b16 v[248:249], v15 offset:34816
    ds_read_b64_tr_b16 v[250:251], v15 offset:43520
    ds_read_b64_tr_b16 v[252:253], v15 offset:52224
    ds_read_b64_tr_b16 v[254:255], v15 offset:60928
    s_cmp_eq_u32 s92, 0
    s_cbranch_scc0 interleave_layers__linear_attn_block__memory_aug_recurrent_mem_tr__prompt_kernel_ri4
    v_mov_b32 v15, 0
    buffer_load_dword v14, v15, s[72:75], 0 offen sc1
interleave_layers__linear_attn_block__memory_aug_recurrent_mem_tr__prompt_kernel_ri4:
    v_lshlrev_b32 v7, 4, v1
    s_lshr_b32 s24, s3, 1
    s_mul_i32 s24, s24, 20
    s_and_b32 s25, s3, 1
    s_mul_i32 s25, s25, 10
    s_add_u32 s24, s24, s25
    s_lshl_b32 s24, s24, 10
    v_add_u32 v6, s24, v7
    s_lshr_b32 s24, s3, 1
    s_lshl_b32 s24, s24, 8
    s_and_b32 s25, s3, 1
    s_lshl_b32 s25, s25, 3
    s_add_u32 s24, s24, s25
    s_add_u32 s24, s24, 51712
    v_lshlrev_b32 v9, 4, v2
    v_add_u32 v8, s24, v9
    v_add_u32 v9, 51712, v9
    v_mul_u32_u24 v10, 336, v2
    v_lshl_add_u32 v10, v3, 3, v10
    v_add_u32 v10, 40960, v10
    v_lshrrev_b32 v11, 2, v2
    v_lshl_add_u32 v11, v3, 3, v11
    v_mul_u32_u24 v11, 336, v11
    v_and_b32 v15, 3, v2
    v_lshl_add_u32 v11, v15, 3, v11
    s_lshl_b32 s24, s3, 5
    s_add_u32 s24, s24, 40960
    v_add_u32 v11, s24, v11
    s_lshl_b32 s24, s3, 10
    v_add_u32 v12, s24, v7
    v_lshlrev_b32 v15, 3, v1
    v_add_u32 v15, 2048, v15
    s_cmp_eq_u32 s3, 2
    s_cselect_b64 vcc, -1, 0
    v_cndmask_b32 v12, v12, v15, vcc
    s_mul_i32 s24, s44, 2560
    s_add_u32 s24, s24, 12582912
    v_add_u32 v12, s24, v12
    s_mov_b32 s52, 0x3fb8aa3b
    s_mov_b32 s53, s52
    s_mov_b32 s54, 0x358637bd
    s_mov_b32 s55, s54
    v_mov_b32 v120, 0
    v_mov_b32 v121, 0
    v_mov_b32 v122, 0
    v_mov_b32 v123, 0
    v_mov_b32 v124, 0
    v_mov_b32 v125, 0
    v_mov_b32 v126, 0
    v_mov_b32 v127, 0
    v_mov_b32 v128, 0
    v_mov_b32 v129, 0
    v_mov_b32 v130, 0
    v_mov_b32 v131, 0
    v_mov_b32 v132, 0
    v_mov_b32 v133, 0
    v_mov_b32 v134, 0
    v_mov_b32 v135, 0
    v_mov_b32 v136, 0
    v_mov_b32 v137, 0
    v_mov_b32 v138, 0
    v_mov_b32 v139, 0
    v_mov_b32 v140, 0
    v_mov_b32 v141, 0
    v_mov_b32 v142, 0
    v_mov_b32 v143, 0
    s_waitcnt lgkmcnt(0)
    v_mfma_f32_16x16x32_bf16 v[156:159], a[72:75], v[172:175], v[156:159]
    v_mfma_f32_16x16x32_bf16 v[160:163], a[152:155], v[172:175], v[160:163]
    v_mfma_f32_16x16x32_bf16 v[164:167], a[232:235], v[172:175], v[164:167]
    v_mfma_f32_16x16x32_bf16 v[168:171], v[248:251], v[172:175], v[168:171]
    v_mfma_f32_16x16x32_bf16 v[156:159], a[76:79], v[172:175], v[156:159]
    v_mfma_f32_16x16x32_bf16 v[160:163], a[156:159], v[172:175], v[160:163]
    v_mfma_f32_16x16x32_bf16 v[164:167], a[236:239], v[172:175], v[164:167]
    v_mfma_f32_16x16x32_bf16 v[168:171], v[252:255], v[172:175], v[168:171]
    s_cmp_eq_u32 s92, 0
    s_cbranch_scc0 interleave_layers__linear_attn_block__memory_aug_recurrent_mem_tr__prompt_kernel_rc5_ok
    s_mov_b32 s61, 0
interleave_layers__linear_attn_block__memory_aug_recurrent_mem_tr__prompt_kernel_rc5:
    s_waitcnt vmcnt(0)
    v_readfirstlane_b32 s24, v14
    s_cmp_eq_u32 s24, 1
    s_cbranch_scc1 interleave_layers__linear_attn_block__memory_aug_recurrent_mem_tr__prompt_kernel_rc5_ok
    s_add_u32 s61, s61, 1
    s_cmp_ge_u32 s61, s60
    s_cbranch_scc1 interleave_layers__linear_attn_block__memory_aug_recurrent_mem_tr__prompt_kernel_rc5_to
    s_sleep 2
    v_mov_b32 v15, 0
    buffer_load_dword v14, v15, s[72:75], 0 offen sc1
    s_branch interleave_layers__linear_attn_block__memory_aug_recurrent_mem_tr__prompt_kernel_rc5
interleave_layers__linear_attn_block__memory_aug_recurrent_mem_tr__prompt_kernel_rc5_to:
    s_mov_b32 s60, 1
interleave_layers__linear_attn_block__memory_aug_recurrent_mem_tr__prompt_kernel_rc5_ok:
interleave_layers__linear_attn_block__memory_aug_recurrent_mem_tr__prompt_kernel_k1_seg:
    s_cmp_eq_u32 s51, 1
    s_cbranch_scc1 interleave_layers__linear_attn_block__memory_aug_recurrent_mem_tr__prompt_kernel_k16
    s_and_b32 s24, s48, 3
    s_lshl_b32 s24, s24, 7
    s_add_u32 s24, s24, 23107584
    v_lshlrev_b32 v15, 2, v1
    v_add_u32 v15, s24, v15
    s_lshr_b32 s95, s48, 2
    s_add_u32 s95, s95, 1
    s_mov_b32 s61, 0
interleave_layers__linear_attn_block__memory_aug_recurrent_mem_tr__prompt_kernel_k1_wx:
    buffer_load_dword v14, v15, s[8:11], 0 offen sc1
    s_waitcnt vmcnt(0)
    v_cmp_le_i32 vcc, s95, v14
    s_mov_b32 s25, 0xfffff
    s_and_b32 s24, vcc_lo, s25
    s_cmp_eq_u32 s24, s25
    s_cbranch_scc1 interleave_layers__linear_attn_block__memory_aug_recurrent_mem_tr__prompt_kernel_k1_wx_ok
    s_add_u32 s61, s61, 1
    s_cmp_ge_u32 s61, s60
    s_cbranch_scc1 interleave_layers__linear_attn_block__memory_aug_recurrent_mem_tr__prompt_kernel_k1_wx_to
    s_sleep 4
    s_branch interleave_layers__linear_attn_block__memory_aug_recurrent_mem_tr__prompt_kernel_k1_wx
interleave_layers__linear_attn_block__memory_aug_recurrent_mem_tr__prompt_kernel_k1_wx_to:
    s_mov_b32 s60, 1
interleave_layers__linear_attn_block__memory_aug_recurrent_mem_tr__prompt_kernel_k1_wx_ok:
    s_mov_b32 s41, s43
    s_mov_b32 s24, s41
    buffer_load_dwordx2 v[16:17], v4, s[16:19], s24 offen sc1
    buffer_load_dwordx2 v[18:19], v5, s[16:19], s24 offen sc1
    s_add_u32 s24, s24, s46
    buffer_load_dwordx2 v[20:21], v4, s[16:19], s24 offen sc1
    buffer_load_dwordx2 v[22:23], v5, s[16:19], s24 offen sc1
    s_add_u32 s24, s24, s46
    buffer_load_dwordx2 v[24:25], v4, s[16:19], s24 offen sc1
    buffer_load_dwordx2 v[26:27], v5, s[16:19], s24 offen sc1
    s_add_u32 s24, s24, s46
    buffer_load_dwordx2 v[28:29], v4, s[16:19], s24 offen sc1
    buffer_load_dwordx2 v[30:31], v5, s[16:19], s24 offen sc1
    s_add_u32 s24, s24, s46
    buffer_load_dwordx2 v[32:33], v4, s[16:19], s24 offen sc1
    buffer_load_dwordx2 v[34:35], v5, s[16:19], s24 offen sc1
    s_add_u32 s24, s24, s46
    buffer_load_dwordx2 v[36:37], v4, s[16:19], s24 offen sc1
    buffer_load_dwordx2 v[38:39], v5, s[16:19], s24 offen sc1
    s_add_u32 s24, s24, s46
    buffer_load_dwordx2 v[40:41], v4, s[16:19], s24 offen sc1
    buffer_load_dwordx2 v[42:43], v5, s[16:19], s24 offen sc1
    s_add_u32 s24, s24, s46
    buffer_load_dwordx2 v[44:45], v4, s[16:19], s24 offen sc1
    buffer_load_dwordx2 v[46:47], v5, s[16:19], s24 offen sc1
    s_add_u32 s24, s24, s46
    buffer_load_dwordx2 v[48:49], v4, s[16:19], s24 offen sc1
    buffer_load_dwordx2 v[50:51], v5, s[16:19], s24 offen sc1
    s_add_u32 s24, s24, s46
    buffer_load_dwordx2 v[52:53], v4, s[16:19], s24 offen sc1
    buffer_load_dwordx2 v[54:55], v5, s[16:19], s24 offen sc1
interleave_layers__linear_attn_block__memory_aug_recurrent_mem_tr__prompt_kernel_k16:
    s_waitcnt vmcnt(0)
    v_mov_b32 v148, 0
    v_mov_b32 v149, 0
    v_mov_b32 v150, 0
    v_mov_b32 v151, 0
    v_dot2c_f32_bf16 v148, v16, v172
    v_dot2c_f32_bf16 v149, v16, v16
    v_dot2c_f32_bf16 v150, v17, v172
    v_dot2c_f32_bf16 v151, v17, v17
    v_dot2c_f32_bf16 v148, v18, v172
    v_dot2c_f32_bf16 v149, v18, v18
    v_dot2c_f32_bf16 v150, v19, v172
    v_dot2c_f32_bf16 v151, v19, v19
    v_dot2c_f32_bf16 v148, v20, v172
    v_dot2c_f32_bf16 v149, v20, v20
    v_dot2c_f32_bf16 v150, v21, v172
    v_dot2c_f32_bf16 v151, v21, v21
    v_dot2c_f32_bf16 v148, v22, v172
    v_dot2c_f32_bf16 v149, v22, v22
    v_dot2c_f32_bf16 v150, v23, v172
    v_dot2c_f32_bf16 v151, v23, v23
    v_dot2c_f32_bf16 v148, v24, v172
    v_dot2c_f32_bf16 v149, v24, v24
    v_dot2c_f32_bf16 v150, v25, v172
    v_dot2c_f32_bf16 v151, v25, v25
    v_dot2c_f32_bf16 v148, v26, v172
    v_dot2c_f32_bf16 v149, v26, v26
    v_dot2c_f32_bf16 v150, v27, v172
    v_dot2c_f32_bf16 v151, v27, v27
    v_dot2c_f32_bf16 v148, v28, v172
    v_dot2c_f32_bf16 v149, v28, v28
    v_dot2c_f32_bf16 v150, v29, v172
    v_dot2c_f32_bf16 v151, v29, v29
    v_dot2c_f32_bf16 v148, v30, v172
    v_dot2c_f32_bf16 v149, v30, v30
    v_dot2c_f32_bf16 v150, v31, v172
    v_dot2c_f32_bf16 v151, v31, v31
    v_dot2c_f32_bf16 v148, v32, v172
    v_dot2c_f32_bf16 v149, v32, v32
    v_dot2c_f32_bf16 v150, v33, v172
    v_dot2c_f32_bf16 v151, v33, v33
    v_dot2c_f32_bf16 v148, v34, v172
    v_dot2c_f32_bf16 v149, v34, v34
    v_dot2c_f32_bf16 v150, v35, v172
    v_dot2c_f32_bf16 v151, v35, v35
    v_dot2c_f32_bf16 v148, v36, v172
    v_dot2c_f32_bf16 v149, v36, v36
    v_dot2c_f32_bf16 v150, v37, v172
    v_dot2c_f32_bf16 v151, v37, v37
    v_dot2c_f32_bf16 v148, v38, v172
    v_dot2c_f32_bf16 v149, v38, v38
    v_dot2c_f32_bf16 v150, v39, v172
    v_dot2c_f32_bf16 v151, v39, v39
    v_dot2c_f32_bf16 v148, v40, v172
    v_dot2c_f32_bf16 v149, v40, v40
    v_dot2c_f32_bf16 v150, v41, v172
    v_dot2c_f32_bf16 v151, v41, v41
    v_dot2c_f32_bf16 v148, v42, v172
    v_dot2c_f32_bf16 v149, v42, v42
    v_dot2c_f32_bf16 v150, v43, v172
    v_dot2c_f32_bf16 v151, v43, v43
    v_dot2c_f32_bf16 v148, v44, v172
    v_dot2c_f32_bf16 v149, v44, v44
    v_dot2c_f32_bf16 v150, v45, v172
    v_dot2c_f32_bf16 v151, v45, v45
    v_dot2c_f32_bf16 v148, v46, v172
    v_dot2c_f32_bf16 v149, v46, v46
    v_dot2c_f32_bf16 v150, v47, v172
    v_dot2c_f32_bf16 v151, v47, v47
    v_dot2c_f32_bf16 v148, v48, v172
    v_dot2c_f32_bf16 v149, v48, v48
    v_dot2c_f32_bf16 v150, v49, v172
    v_dot2c_f32_bf16 v151, v49, v49
    v_dot2c_f32_bf16 v148, v50, v172
    v_dot2c_f32_bf16 v149, v50, v50
    v_dot2c_f32_bf16 v150, v51, v172
    v_dot2c_f32_bf16 v151, v51, v51
    v_dot2c_f32_bf16 v148, v52, v172
    v_dot2c_f32_bf16 v149, v52, v52
    v_dot2c_f32_bf16 v150, v53, v172
    v_dot2c_f32_bf16 v151, v53, v53
    v_dot2c_f32_bf16 v148, v54, v172
    v_dot2c_f32_bf16 v149, v54, v54
    v_dot2c_f32_bf16 v150, v55, v172
    v_dot2c_f32_bf16 v151, v55, v55
    s_nop 1
    v_add_f32 v148, v148, v150
    v_add_f32 v149, v149, v151
    v_mov_b32 v150, v148
    v_mov_b32 v151, v149
    s_nop 0
    v_permlane16_swap_b32 v148, v150
    v_permlane16_swap_b32 v149, v151
    v_add_f32 v148, v148, v150
    v_add_f32 v149, v149, v151
    v_mov_b32 v150, v148
    v_mov_b32 v151, v149
    s_nop 0
    v_permlane32_swap_b32 v148, v150
    v_permlane32_swap_b32 v149, v151
    v_add_f32 v148, v148, v150
    v_add_f32 v149, v149, v151
    ds_write_b128 v6, v[16:19] offset:0
    ds_write_b128 v6, v[20:23] offset:1024
    ds_write_b128 v6, v[24:27] offset:2048
    ds_write_b128 v6, v[28:31] offset:3072
    ds_write_b128 v6, v[32:35] offset:4096
    ds_write_b128 v6, v[36:39] offset:5120
    ds_write_b128 v6, v[40:43] offset:6144
    ds_write_b128 v6, v[44:47] offset:7168
    ds_write_b128 v6, v[48:51] offset:8192
    ds_write_b128 v6, v[52:55] offset:9216
    ds_write_b64 v8, v[148:149]
    s_mov_b32 s51, 0
    s_waitcnt lgkmcnt(0)
    s_cmp_eq_u32 s92, 0
    s_cbranch_scc0 interleave_layers__linear_attn_block__memory_aug_recurrent_mem_tr__prompt_kernel_k17
    s_cmp_gt_u32 s40, 1
    s_cbranch_scc0 interleave_layers__linear_attn_block__memory_aug_recurrent_mem_tr__prompt_kernel_k17
    s_add_u32 s41, s43, s42
    s_mov_b32 s24, s41
    buffer_load_dwordx2 v[16:17], v4, s[16:19], s24 offen sc1
    buffer_load_dwordx2 v[18:19], v5, s[16:19], s24 offen sc1
    s_add_u32 s24, s24, s46
    buffer_load_dwordx2 v[20:21], v4, s[16:19], s24 offen sc1
    buffer_load_dwordx2 v[22:23], v5, s[16:19], s24 offen sc1
    s_add_u32 s24, s24, s46
    buffer_load_dwordx2 v[24:25], v4, s[16:19], s24 offen sc1
    buffer_load_dwordx2 v[26:27], v5, s[16:19], s24 offen sc1
    s_add_u32 s24, s24, s46
    buffer_load_dwordx2 v[28:29], v4, s[16:19], s24 offen sc1
    buffer_load_dwordx2 v[30:31], v5, s[16:19], s24 offen sc1
    s_add_u32 s24, s24, s46
    buffer_load_dwordx2 v[32:33], v4, s[16:19], s24 offen sc1
    buffer_load_dwordx2 v[34:35], v5, s[16:19], s24 offen sc1
    s_add_u32 s24, s24, s46
    buffer_load_dwordx2 v[36:37], v4, s[16:19], s24 offen sc1
    buffer_load_dwordx2 v[38:39], v5, s[16:19], s24 offen sc1
    s_add_u32 s24, s24, s46
    buffer_load_dwordx2 v[40:41], v4, s[16:19], s24 offen sc1
    buffer_load_dwordx2 v[42:43], v5, s[16:19], s24 offen sc1
    s_add_u32 s24, s24, s46
    buffer_load_dwordx2 v[44:45], v4, s[16:19], s24 offen sc1
    buffer_load_dwordx2 v[46:47], v5, s[16:19], s24 offen sc1
    s_add_u32 s24, s24, s46
    buffer_load_dwordx2 v[48:49], v4, s[16:19], s24 offen sc1
    buffer_load_dwordx2 v[50:51], v5, s[16:19], s24 offen sc1
    s_add_u32 s24, s24, s46
    buffer_load_dwordx2 v[52:53], v4, s[16:19], s24 offen sc1
    buffer_load_dwordx2 v[54:55], v5, s[16:19], s24 offen sc1
    s_mov_b32 s51, 1
interleave_layers__linear_attn_block__memory_aug_recurrent_mem_tr__prompt_kernel_k17:
    s_barrier
    ds_read_b128 v[148:151], v9
    ds_read_b128 v[152:155], v9 offset:256
    ds_read_b128 v[56:59], v7 offset:0
    ds_read_b128 v[60:63], v7 offset:20480
    ds_read_b128 v[64:67], v7 offset:1024
    ds_read_b128 v[68:71], v7 offset:21504
    ds_read_b128 v[72:75], v7 offset:2048
    ds_read_b128 v[76:79], v7 offset:22528
    s_waitcnt lgkmcnt(6)
    v_add_f32 v148, v148, v150
    v_add_f32 v149, v149, v151
    v_mul_f32 v148, 0x3acccccd, v148
    v_mul_f32 v150, v148, v148
    v_mov_b32 v151, 0x3acccccd
    v_fma_f32 v149, v149, v151, -v150
    v_max_f32 v149, 0, v149
    v_add_f32 v149, 0x3727c5ac, v149
    v_rsq_f32 v144, v149
    s_nop 0
    v_mul_f32 v145, v148, v144
    v_sub_f32 v145, 0, v145
    v_add_f32 v152, v152, v154
    v_add_f32 v153, v153, v155
    v_mul_f32 v152, 0x3acccccd, v152
    v_mul_f32 v154, v152, v152
    v_mov_b32 v155, 0x3acccccd
    v_fma_f32 v153, v153, v155, -v154
    v_max_f32 v153, 0, v153
    v_add_f32 v153, 0x3727c5ac, v153
    v_rsq_f32 v146, v153
    s_nop 0
    v_mul_f32 v147, v152, v146
    v_sub_f32 v147, 0, v147
    ds_read_b128 v[80:83], v7 offset:3072
    ds_read_b128 v[84:87], v7 offset:23552
    s_waitcnt lgkmcnt(6)
    v_mfma_f32_16x16x32_bf16 v[88:91], a[0:3], v[56:59], 0
    v_mfma_f32_16x16x32_bf16 v[96:99], a[80:83], v[56:59], 0
    v_mfma_f32_16x16x32_bf16 v[104:107], a[160:163], v[56:59], 0
    v_mfma_f32_16x16x32_bf16 v[112:115], v[176:179], v[56:59], 0
    v_mfma_f32_16x16x32_bf16 v[92:95], a[0:3], v[60:63], 0
    v_mfma_f32_16x16x32_bf16 v[100:103], a[80:83], v[60:63], 0
    v_mfma_f32_16x16x32_bf16 v[108:111], a[160:163], v[60:63], 0
    v_mfma_f32_16x16x32_bf16 v[116:119], v[176:179], v[60:63], 0
    ds_read_b128 v[56:59], v7 offset:4096
    ds_read_b128 v[60:63], v7 offset:24576
    s_waitcnt lgkmcnt(6)
    v_mfma_f32_16x16x32_bf16 v[88:91], a[4:7], v[64:67], v[88:91]
    v_mfma_f32_16x16x32_bf16 v[96:99], a[84:87], v[64:67], v[96:99]
    v_mfma_f32_16x16x32_bf16 v[104:107], a[164:167], v[64:67], v[104:107]
    v_mfma_f32_16x16x32_bf16 v[112:115], v[180:183], v[64:67], v[112:115]
    v_mfma_f32_16x16x32_bf16 v[92:95], a[4:7], v[68:71], v[92:95]
    v_mfma_f32_16x16x32_bf16 v[100:103], a[84:87], v[68:71], v[100:103]
    v_mfma_f32_16x16x32_bf16 v[108:111], a[164:167], v[68:71], v[108:111]
    v_mfma_f32_16x16x32_bf16 v[116:119], v[180:183], v[68:71], v[116:119]
    ds_read_b128 v[64:67], v7 offset:5120
    ds_read_b128 v[68:71], v7 offset:25600
    s_waitcnt lgkmcnt(6)
    v_mfma_f32_16x16x32_bf16 v[88:91], a[8:11], v[72:75], v[88:91]
    v_mfma_f32_16x16x32_bf16 v[96:99], a[88:91], v[72:75], v[96:99]
    v_mfma_f32_16x16x32_bf16 v[104:107], a[168:171], v[72:75], v[104:107]
    v_mfma_f32_16x16x32_bf16 v[112:115], v[184:187], v[72:75], v[112:115]
    v_mfma_f32_16x16x32_bf16 v[92:95], a[8:11], v[76:79], v[92:95]
    v_mfma_f32_16x16x32_bf16 v[100:103], a[88:91], v[76:79], v[100:103]
    v_mfma_f32_16x16x32_bf16 v[108:111], a[168:171], v[76:79], v[108:111]
    v_mfma_f32_16x16x32_bf16 v[116:119], v[184:187], v[76:79], v[116:119]
    ds_read_b128 v[72:75], v7 offset:6144
    ds_read_b128 v[76:79], v7 offset:26624
    s_waitcnt lgkmcnt(6)
    v_mfma_f32_16x16x32_bf16 v[88:91], a[12:15], v[80:83], v[88:91]
    v_mfma_f32_16x16x32_bf16 v[96:99], a[92:95], v[80:83], v[96:99]
    v_mfma_f32_16x16x32_bf16 v[104:107], a[172:175], v[80:83], v[104:107]
    v_mfma_f32_16x16x32_bf16 v[112:115], v[188:191], v[80:83], v[112:115]
    v_mfma_f32_16x16x32_bf16 v[92:95], a[12:15], v[84:87], v[92:95]
    v_mfma_f32_16x16x32_bf16 v[100:103], a[92:95], v[84:87], v[100:103]
    v_mfma_f32_16x16x32_bf16 v[108:111], a[172:175], v[84:87], v[108:111]
    v_mfma_f32_16x16x32_bf16 v[116:119], v[188:191], v[84:87], v[116:119]
    ds_read_b128 v[80:83], v7 offset:7168
    ds_read_b128 v[84:87], v7 offset:27648
    s_waitcnt lgkmcnt(6)
    v_mfma_f32_16x16x32_bf16 v[88:91], a[16:19], v[56:59], v[88:91]
    v_mfma_f32_16x16x32_bf16 v[96:99], a[96:99], v[56:59], v[96:99]
    v_mfma_f32_16x16x32_bf16 v[104:107], a[176:179], v[56:59], v[104:107]
    v_mfma_f32_16x16x32_bf16 v[112:115], v[192:195], v[56:59], v[112:115]
    v_mfma_f32_16x16x32_bf16 v[92:95], a[16:19], v[60:63], v[92:95]
    v_mfma_f32_16x16x32_bf16 v[100:103], a[96:99], v[60:63], v[100:103]
    v_mfma_f32_16x16x32_bf16 v[108:111], a[176:179], v[60:63], v[108:111]
    v_mfma_f32_16x16x32_bf16 v[116:119], v[192:195], v[60:63], v[116:119]
    ds_read_b128 v[56:59], v7 offset:8192
    ds_read_b128 v[60:63], v7 offset:28672
    s_waitcnt lgkmcnt(6)
    v_mfma_f32_16x16x32_bf16 v[88:91], a[20:23], v[64:67], v[88:91]
    v_mfma_f32_16x16x32_bf16 v[96:99], a[100:103], v[64:67], v[96:99]
    v_mfma_f32_16x16x32_bf16 v[104:107], a[180:183], v[64:67], v[104:107]
    v_mfma_f32_16x16x32_bf16 v[112:115], v[196:199], v[64:67], v[112:115]
    v_mfma_f32_16x16x32_bf16 v[92:95], a[20:23], v[68:71], v[92:95]
    v_mfma_f32_16x16x32_bf16 v[100:103], a[100:103], v[68:71], v[100:103]
    v_mfma_f32_16x16x32_bf16 v[108:111], a[180:183], v[68:71], v[108:111]
    v_mfma_f32_16x16x32_bf16 v[116:119], v[196:199], v[68:71], v[116:119]
    ds_read_b128 v[64:67], v7 offset:9216
    ds_read_b128 v[68:71], v7 offset:29696
    s_waitcnt lgkmcnt(6)
    v_mfma_f32_16x16x32_bf16 v[88:91], a[24:27], v[72:75], v[88:91]
    v_mfma_f32_16x16x32_bf16 v[96:99], a[104:107], v[72:75], v[96:99]
    v_mfma_f32_16x16x32_bf16 v[104:107], a[184:187], v[72:75], v[104:107]
    v_mfma_f32_16x16x32_bf16 v[112:115], v[200:203], v[72:75], v[112:115]
    v_mfma_f32_16x16x32_bf16 v[92:95], a[24:27], v[76:79], v[92:95]
    v_mfma_f32_16x16x32_bf16 v[100:103], a[104:107], v[76:79], v[100:103]
    v_mfma_f32_16x16x32_bf16 v[108:111], a[184:187], v[76:79], v[108:111]
    v_mfma_f32_16x16x32_bf16 v[116:119], v[200:203], v[76:79], v[116:119]
    ds_read_b128 v[72:75], v7 offset:10240
    ds_read_b128 v[76:79], v7 offset:30720
    s_waitcnt lgkmcnt(6)
    v_mfma_f32_16x16x32_bf16 v[88:91], a[28:31], v[80:83], v[88:91]
    v_mfma_f32_16x16x32_bf16 v[96:99], a[108:111], v[80:83], v[96:99]
    v_mfma_f32_16x16x32_bf16 v[104:107], a[188:191], v[80:83], v[104:107]
    v_mfma_f32_16x16x32_bf16 v[112:115], v[204:207], v[80:83], v[112:115]
    v_mfma_f32_16x16x32_bf16 v[92:95], a[28:31], v[84:87], v[92:95]
    v_mfma_f32_16x16x32_bf16 v[100:103], a[108:111], v[84:87], v[100:103]
    v_mfma_f32_16x16x32_bf16 v[108:111], a[188:191], v[84:87], v[108:111]
    v_mfma_f32_16x16x32_bf16 v[116:119], v[204:207], v[84:87], v[116:119]
    ds_read_b128 v[80:83], v7 offset:11264
    ds_read_b128 v[84:87], v7 offset:31744
    s_waitcnt lgkmcnt(6)
    v_mfma_f32_16x16x32_bf16 v[88:91], a[32:35], v[56:59], v[88:91]
    v_mfma_f32_16x16x32_bf16 v[96:99], a[112:115], v[56:59], v[96:99]
    v_mfma_f32_16x16x32_bf16 v[104:107], a[192:195], v[56:59], v[104:107]
    v_mfma_f32_16x16x32_bf16 v[112:115], v[208:211], v[56:59], v[112:115]
    v_mfma_f32_16x16x32_bf16 v[92:95], a[32:35], v[60:63], v[92:95]
    v_mfma_f32_16x16x32_bf16 v[100:103], a[112:115], v[60:63], v[100:103]
    v_mfma_f32_16x16x32_bf16 v[108:111], a[192:195], v[60:63], v[108:111]
    v_mfma_f32_16x16x32_bf16 v[116:119], v[208:211], v[60:63], v[116:119]
    ds_read_b128 v[56:59], v7 offset:12288
    ds_read_b128 v[60:63], v7 offset:32768
    s_waitcnt lgkmcnt(6)
    v_mfma_f32_16x16x32_bf16 v[88:91], a[36:39], v[64:67], v[88:91]
    v_mfma_f32_16x16x32_bf16 v[96:99], a[116:119], v[64:67], v[96:99]
    v_mfma_f32_16x16x32_bf16 v[104:107], a[196:199], v[64:67], v[104:107]
    v_mfma_f32_16x16x32_bf16 v[112:115], v[212:215], v[64:67], v[112:115]
    v_mfma_f32_16x16x32_bf16 v[92:95], a[36:39], v[68:71], v[92:95]
    v_mfma_f32_16x16x32_bf16 v[100:103], a[116:119], v[68:71], v[100:103]
    v_mfma_f32_16x16x32_bf16 v[108:111], a[196:199], v[68:71], v[108:111]
    v_mfma_f32_16x16x32_bf16 v[116:119], v[212:215], v[68:71], v[116:119]
    ds_read_b128 v[64:67], v7 offset:13312
    ds_read_b128 v[68:71], v7 offset:33792
    s_waitcnt lgkmcnt(6)
    v_mfma_f32_16x16x32_bf16 v[88:91], a[40:43], v[72:75], v[88:91]
    v_mfma_f32_16x16x32_bf16 v[96:99], a[120:123], v[72:75], v[96:99]
    v_mfma_f32_16x16x32_bf16 v[104:107], a[200:203], v[72:75], v[104:107]
    v_mfma_f32_16x16x32_bf16 v[112:115], v[216:219], v[72:75], v[112:115]
    v_mfma_f32_16x16x32_bf16 v[92:95], a[40:43], v[76:79], v[92:95]
    v_mfma_f32_16x16x32_bf16 v[100:103], a[120:123], v[76:79], v[100:103]
    v_mfma_f32_16x16x32_bf16 v[108:111], a[200:203], v[76:79], v[108:111]
    v_mfma_f32_16x16x32_bf16 v[116:119], v[216:219], v[76:79], v[116:119]
    ds_read_b128 v[72:75], v7 offset:14336
    ds_read_b128 v[76:79], v7 offset:34816
    s_waitcnt lgkmcnt(6)
    v_mfma_f32_16x16x32_bf16 v[88:91], a[44:47], v[80:83], v[88:91]
    v_mfma_f32_16x16x32_bf16 v[96:99], a[124:127], v[80:83], v[96:99]
    v_mfma_f32_16x16x32_bf16 v[104:107], a[204:207], v[80:83], v[104:107]
    v_mfma_f32_16x16x32_bf16 v[112:115], v[220:223], v[80:83], v[112:115]
    v_mfma_f32_16x16x32_bf16 v[92:95], a[44:47], v[84:87], v[92:95]
    v_mfma_f32_16x16x32_bf16 v[100:103], a[124:127], v[84:87], v[100:103]
    v_mfma_f32_16x16x32_bf16 v[108:111], a[204:207], v[84:87], v[108:111]
    v_mfma_f32_16x16x32_bf16 v[116:119], v[220:223], v[84:87], v[116:119]
    ds_read_b128 v[80:83], v7 offset:15360
    ds_read_b128 v[84:87], v7 offset:35840
    s_waitcnt lgkmcnt(6)
    v_mfma_f32_16x16x32_bf16 v[88:91], a[48:51], v[56:59], v[88:91]
    v_mfma_f32_16x16x32_bf16 v[96:99], a[128:131], v[56:59], v[96:99]
    v_mfma_f32_16x16x32_bf16 v[104:107], a[208:211], v[56:59], v[104:107]
    v_mfma_f32_16x16x32_bf16 v[112:115], v[224:227], v[56:59], v[112:115]
    v_mfma_f32_16x16x32_bf16 v[92:95], a[48:51], v[60:63], v[92:95]
    v_mfma_f32_16x16x32_bf16 v[100:103], a[128:131], v[60:63], v[100:103]
    v_mfma_f32_16x16x32_bf16 v[108:111], a[208:211], v[60:63], v[108:111]
    v_mfma_f32_16x16x32_bf16 v[116:119], v[224:227], v[60:63], v[116:119]
    ds_read_b128 v[56:59], v7 offset:16384
    ds_read_b128 v[60:63], v7 offset:36864
    s_waitcnt lgkmcnt(6)
    v_mfma_f32_16x16x32_bf16 v[88:91], a[52:55], v[64:67], v[88:91]
    v_mfma_f32_16x16x32_bf16 v[96:99], a[132:135], v[64:67], v[96:99]
    v_mfma_f32_16x16x32_bf16 v[104:107], a[212:215], v[64:67], v[104:107]
    v_mfma_f32_16x16x32_bf16 v[112:115], v[228:231], v[64:67], v[112:115]
    v_mfma_f32_16x16x32_bf16 v[92:95], a[52:55], v[68:71], v[92:95]
    v_mfma_f32_16x16x32_bf16 v[100:103], a[132:135], v[68:71], v[100:103]
    v_mfma_f32_16x16x32_bf16 v[108:111], a[212:215], v[68:71], v[108:111]
    v_mfma_f32_16x16x32_bf16 v[116:119], v[228:231], v[68:71], v[116:119]
    ds_read_b128 v[64:67], v7 offset:17408
    ds_read_b128 v[68:71], v7 offset:37888
    s_waitcnt lgkmcnt(6)
    v_mfma_f32_16x16x32_bf16 v[88:91], a[56:59], v[72:75], v[88:91]
    v_mfma_f32_16x16x32_bf16 v[96:99], a[136:139], v[72:75], v[96:99]
    v_mfma_f32_16x16x32_bf16 v[104:107], a[216:219], v[72:75], v[104:107]
    v_mfma_f32_16x16x32_bf16 v[112:115], v[232:235], v[72:75], v[112:115]
    v_mfma_f32_16x16x32_bf16 v[92:95], a[56:59], v[76:79], v[92:95]
    v_mfma_f32_16x16x32_bf16 v[100:103], a[136:139], v[76:79], v[100:103]
    v_mfma_f32_16x16x32_bf16 v[108:111], a[216:219], v[76:79], v[108:111]
    v_mfma_f32_16x16x32_bf16 v[116:119], v[232:235], v[76:79], v[116:119]
    ds_read_b128 v[72:75], v7 offset:18432
    ds_read_b128 v[76:79], v7 offset:38912
    s_waitcnt lgkmcnt(6)
    v_mfma_f32_16x16x32_bf16 v[88:91], a[60:63], v[80:83], v[88:91]
    v_mfma_f32_16x16x32_bf16 v[96:99], a[140:143], v[80:83], v[96:99]
    v_mfma_f32_16x16x32_bf16 v[104:107], a[220:223], v[80:83], v[104:107]
    v_mfma_f32_16x16x32_bf16 v[112:115], v[236:239], v[80:83], v[112:115]
    v_mfma_f32_16x16x32_bf16 v[92:95], a[60:63], v[84:87], v[92:95]
    v_mfma_f32_16x16x32_bf16 v[100:103], a[140:143], v[84:87], v[100:103]
    v_mfma_f32_16x16x32_bf16 v[108:111], a[220:223], v[84:87], v[108:111]
    v_mfma_f32_16x16x32_bf16 v[116:119], v[236:239], v[84:87], v[116:119]
    ds_read_b128 v[80:83], v7 offset:19456
    ds_read_b128 v[84:87], v7 offset:39936
    s_waitcnt lgkmcnt(6)
    v_mfma_f32_16x16x32_bf16 v[88:91], a[64:67], v[56:59], v[88:91]
    v_mfma_f32_16x16x32_bf16 v[96:99], a[144:147], v[56:59], v[96:99]
    v_mfma_f32_16x16x32_bf16 v[104:107], a[224:227], v[56:59], v[104:107]
    v_mfma_f32_16x16x32_bf16 v[112:115], v[240:243], v[56:59], v[112:115]
    v_mfma_f32_16x16x32_bf16 v[92:95], a[64:67], v[60:63], v[92:95]
    v_mfma_f32_16x16x32_bf16 v[100:103], a[144:147], v[60:63], v[100:103]
    v_mfma_f32_16x16x32_bf16 v[108:111], a[224:227], v[60:63], v[108:111]
    v_mfma_f32_16x16x32_bf16 v[116:119], v[240:243], v[60:63], v[116:119]
    s_waitcnt lgkmcnt(4)
    v_mfma_f32_16x16x32_bf16 v[88:91], a[68:71], v[64:67], v[88:91]
    v_mfma_f32_16x16x32_bf16 v[96:99], a[148:151], v[64:67], v[96:99]
    v_mfma_f32_16x16x32_bf16 v[104:107], a[228:231], v[64:67], v[104:107]
    v_mfma_f32_16x16x32_bf16 v[112:115], v[244:247], v[64:67], v[112:115]
    v_mfma_f32_16x16x32_bf16 v[92:95], a[68:71], v[68:71], v[92:95]
    v_mfma_f32_16x16x32_bf16 v[100:103], a[148:151], v[68:71], v[100:103]
    v_mfma_f32_16x16x32_bf16 v[108:111], a[228:231], v[68:71], v[108:111]
    v_mfma_f32_16x16x32_bf16 v[116:119], v[244:247], v[68:71], v[116:119]
    s_waitcnt lgkmcnt(2)
    v_mfma_f32_16x16x32_bf16 v[88:91], a[72:75], v[72:75], v[88:91]
    v_mfma_f32_16x16x32_bf16 v[96:99], a[152:155], v[72:75], v[96:99]
    v_mfma_f32_16x16x32_bf16 v[104:107], a[232:235], v[72:75], v[104:107]
    v_mfma_f32_16x16x32_bf16 v[112:115], v[248:251], v[72:75], v[112:115]
    v_mfma_f32_16x16x32_bf16 v[92:95], a[72:75], v[76:79], v[92:95]
    v_mfma_f32_16x16x32_bf16 v[100:103], a[152:155], v[76:79], v[100:103]
    v_mfma_f32_16x16x32_bf16 v[108:111], a[232:235], v[76:79], v[108:111]
    v_mfma_f32_16x16x32_bf16 v[116:119], v[248:251], v[76:79], v[116:119]
    s_waitcnt lgkmcnt(0)
    v_mfma_f32_16x16x32_bf16 v[88:91], a[76:79], v[80:83], v[88:91]
    v_mfma_f32_16x16x32_bf16 v[96:99], a[156:159], v[80:83], v[96:99]
    v_mfma_f32_16x16x32_bf16 v[104:107], a[236:239], v[80:83], v[104:107]
    v_mfma_f32_16x16x32_bf16 v[112:115], v[252:255], v[80:83], v[112:115]
    v_mfma_f32_16x16x32_bf16 v[92:95], a[76:79], v[84:87], v[92:95]
    v_mfma_f32_16x16x32_bf16 v[100:103], a[156:159], v[84:87], v[100:103]
    v_mfma_f32_16x16x32_bf16 v[108:111], a[236:239], v[84:87], v[108:111]
    v_mfma_f32_16x16x32_bf16 v[116:119], v[252:255], v[84:87], v[116:119]
    v_pk_mul_f32 v[148:149], v[156:157], v[144:145] op_sel:[0,1] op_sel_hi:[1,1]
    v_pk_mul_f32 v[150:151], v[158:159], v[144:145] op_sel:[0,1] op_sel_hi:[1,1]
    v_pk_fma_f32 v[88:89], v[88:89], v[144:145], v[148:149] op_sel:[0,0,0] op_sel_hi:[1,0,1]
    v_pk_fma_f32 v[90:91], v[90:91], v[144:145], v[150:151] op_sel:[0,0,0] op_sel_hi:[1,0,1]
    v_pk_mul_f32 v[148:149], v[156:157], v[146:147] op_sel:[0,1] op_sel_hi:[1,1]
    v_pk_mul_f32 v[150:151], v[158:159], v[146:147] op_sel:[0,1] op_sel_hi:[1,1]
    v_pk_fma_f32 v[92:93], v[92:93], v[146:147], v[148:149] op_sel:[0,0,0] op_sel_hi:[1,0,1]
    v_pk_fma_f32 v[94:95], v[94:95], v[146:147], v[150:151] op_sel:[0,0,0] op_sel_hi:[1,0,1]
    v_pk_mul_f32 v[148:149], v[160:161], v[144:145] op_sel:[0,1] op_sel_hi:[1,1]
    v_pk_mul_f32 v[150:151], v[162:163], v[144:145] op_sel:[0,1] op_sel_hi:[1,1]
    v_pk_fma_f32 v[96:97], v[96:97], v[144:145], v[148:149] op_sel:[0,0,0] op_sel_hi:[1,0,1]
    v_pk_fma_f32 v[98:99], v[98:99], v[144:145], v[150:151] op_sel:[0,0,0] op_sel_hi:[1,0,1]
    v_pk_mul_f32 v[148:149], v[160:161], v[146:147] op_sel:[0,1] op_sel_hi:[1,1]
    v_pk_mul_f32 v[150:151], v[162:163], v[146:147] op_sel:[0,1] op_sel_hi:[1,1]
    v_pk_fma_f32 v[100:101], v[100:101], v[146:147], v[148:149] op_sel:[0,0,0] op_sel_hi:[1,0,1]
    v_pk_fma_f32 v[102:103], v[102:103], v[146:147], v[150:151] op_sel:[0,0,0] op_sel_hi:[1,0,1]
    v_pk_mul_f32 v[148:149], v[164:165], v[144:145] op_sel:[0,1] op_sel_hi:[1,1]
    v_pk_mul_f32 v[150:151], v[166:167], v[144:145] op_sel:[0,1] op_sel_hi:[1,1]
    v_pk_fma_f32 v[104:105], v[104:105], v[144:145], v[148:149] op_sel:[0,0,0] op_sel_hi:[1,0,1]
    v_pk_fma_f32 v[106:107], v[106:107], v[144:145], v[150:151] op_sel:[0,0,0] op_sel_hi:[1,0,1]
    v_pk_mul_f32 v[148:149], v[164:165], v[146:147] op_sel:[0,1] op_sel_hi:[1,1]
    v_pk_mul_f32 v[150:151], v[166:167], v[146:147] op_sel:[0,1] op_sel_hi:[1,1]
    v_pk_fma_f32 v[108:109], v[108:109], v[146:147], v[148:149] op_sel:[0,0,0] op_sel_hi:[1,0,1]
    v_pk_fma_f32 v[110:111], v[110:111], v[146:147], v[150:151] op_sel:[0,0,0] op_sel_hi:[1,0,1]
    v_pk_mul_f32 v[148:149], v[168:169], v[144:145] op_sel:[0,1] op_sel_hi:[1,1]
    v_pk_mul_f32 v[150:151], v[170:171], v[144:145] op_sel:[0,1] op_sel_hi:[1,1]
    v_pk_fma_f32 v[112:113], v[112:113], v[144:145], v[148:149] op_sel:[0,0,0] op_sel_hi:[1,0,1]
    v_pk_fma_f32 v[114:115], v[114:115], v[144:145], v[150:151] op_sel:[0,0,0] op_sel_hi:[1,0,1]
    v_pk_mul_f32 v[148:149], v[168:169], v[146:147] op_sel:[0,1] op_sel_hi:[1,1]
    v_pk_mul_f32 v[150:151], v[170:171], v[146:147] op_sel:[0,1] op_sel_hi:[1,1]
    v_pk_fma_f32 v[116:117], v[116:117], v[146:147], v[148:149] op_sel:[0,0,0] op_sel_hi:[1,0,1]
    v_pk_fma_f32 v[118:119], v[118:119], v[146:147], v[150:151] op_sel:[0,0,0] op_sel_hi:[1,0,1]
    s_add_u32 s25, s43, 20480
    s_cmp_ge_u32 s3, 2
    s_cbranch_scc1 interleave_layers__linear_attn_block__memory_aug_recurrent_mem_tr__prompt_kernel_k1_e2
    s_lshl_b32 s24, s3, 6
    v_add_u32 v15, s24, v10
    v_cvt_pk_bf16_f32 v64, v104, v105
    v_cvt_pk_bf16_f32 v65, v106, v107
    ds_write_b64 v15, v[64:65] offset:160
    v_cvt_pk_bf16_f32 v66, v108, v109
    v_cvt_pk_bf16_f32 v67, v110, v111
    ds_write_b64 v15, v[66:67] offset:5536
    v_cvt_pk_bf16_f32 v68, v112, v113
    v_cvt_pk_bf16_f32 v69, v114, v115
    ds_write_b64 v15, v[68:69] offset:192
    v_cvt_pk_bf16_f32 v70, v116, v117
    v_cvt_pk_bf16_f32 v71, v118, v119
    ds_write_b64 v15, v[70:71] offset:5568
    v_min_f32 v148, 0, v88
    v_min_f32 v149, 0, v89
    v_pk_mul_f32 v[148:149], v[148:149], s[52:53]
    v_min_f32 v150, 0, v90
    v_min_f32 v151, 0, v91
    v_pk_mul_f32 v[150:151], v[150:151], s[52:53]
    v_exp_f32 v148, v148
    v_exp_f32 v149, v149
    v_exp_f32 v150, v150
    v_exp_f32 v151, v151
    v_max_f32 v88, 0, v88
    v_max_f32 v89, 0, v89
    v_max_f32 v90, 0, v90
    v_max_f32 v91, 0, v91
    v_pk_add_f32 v[88:89], v[88:89], v[148:149]
    v_pk_add_f32 v[90:91], v[90:91], v[150:151]
    v_pk_add_f32 v[88:89], v[88:89], s[54:55]
    v_pk_add_f32 v[90:91], v[90:91], s[54:55]
    v_min_f32 v148, 0, v96
    v_min_f32 v149, 0, v97
    v_pk_mul_f32 v[148:149], v[148:149], s[52:53]
    v_min_f32 v150, 0, v98
    v_min_f32 v151, 0, v99
    v_pk_mul_f32 v[150:151], v[150:151], s[52:53]
    v_exp_f32 v148, v148
    v_exp_f32 v149, v149
    v_exp_f32 v150, v150
    v_exp_f32 v151, v151
    v_max_f32 v96, 0, v96
    v_max_f32 v97, 0, v97
    v_max_f32 v98, 0, v98
    v_max_f32 v99, 0, v99
    v_pk_add_f32 v[96:97], v[96:97], v[148:149]
    v_pk_add_f32 v[98:99], v[98:99], v[150:151]
    v_pk_add_f32 v[96:97], v[96:97], s[54:55]
    v_pk_add_f32 v[98:99], v[98:99], s[54:55]
    v_cvt_pk_bf16_f32 v56, v88, v89
    v_cvt_pk_bf16_f32 v57, v90, v91
    v_cvt_pk_bf16_f32 v58, v96, v97
    v_cvt_pk_bf16_f32 v59, v98, v99
    buffer_store_dwordx4 v[56:59], v12, s[8:11], s43 offen sc1
    v_min_f32 v148, 0, v92
    v_min_f32 v149, 0, v93
    v_pk_mul_f32 v[148:149], v[148:149], s[52:53]
    v_min_f32 v150, 0, v94
    v_min_f32 v151, 0, v95
    v_pk_mul_f32 v[150:151], v[150:151], s[52:53]
    v_exp_f32 v148, v148
    v_exp_f32 v149, v149
    v_exp_f32 v150, v150
    v_exp_f32 v151, v151
    v_max_f32 v92, 0, v92
    v_max_f32 v93, 0, v93
    v_max_f32 v94, 0, v94
    v_max_f32 v95, 0, v95
    v_pk_add_f32 v[92:93], v[92:93], v[148:149]
    v_pk_add_f32 v[94:95], v[94:95], v[150:151]
    v_pk_add_f32 v[92:93], v[92:93], s[54:55]
    v_pk_add_f32 v[94:95], v[94:95], s[54:55]
    v_min_f32 v148, 0, v100
    v_min_f32 v149, 0, v101
    v_pk_mul_f32 v[148:149], v[148:149], s[52:53]
    v_min_f32 v150, 0, v102
    v_min_f32 v151, 0, v103
    v_pk_mul_f32 v[150:151], v[150:151], s[52:53]
    v_exp_f32 v148, v148
    v_exp_f32 v149, v149
    v_exp_f32 v150, v150
    v_exp_f32 v151, v151
    v_max_f32 v100, 0, v100
    v_max_f32 v101, 0, v101
    v_max_f32 v102, 0, v102
    v_max_f32 v103, 0, v103
    v_pk_add_f32 v[100:101], v[100:101], v[148:149]
    v_pk_add_f32 v[102:103], v[102:103], v[150:151]
    v_pk_add_f32 v[100:101], v[100:101], s[54:55]
    v_pk_add_f32 v[102:103], v[102:103], s[54:55]
    v_cvt_pk_bf16_f32 v60, v92, v93
    v_cvt_pk_bf16_f32 v61, v94, v95
    v_cvt_pk_bf16_f32 v62, v100, v101
    v_cvt_pk_bf16_f32 v63, v102, v103
    buffer_store_dwordx4 v[60:63], v12, s[8:11], s25 offen sc1
    s_branch interleave_layers__linear_attn_block__memory_aug_recurrent_mem_tr__prompt_kernel_k1_ej
interleave_layers__linear_attn_block__memory_aug_recurrent_mem_tr__prompt_kernel_k1_e2:
    s_cmp_eq_u32 s3, 3
    s_cbranch_scc1 interleave_layers__linear_attn_block__memory_aug_recurrent_mem_tr__prompt_kernel_k1_e3
    v_cvt_pk_bf16_f32 v68, v112, v113
    v_cvt_pk_bf16_f32 v69, v114, v115
    ds_write_b64 v10, v[68:69] offset:288
    v_cvt_pk_bf16_f32 v70, v116, v117
    v_cvt_pk_bf16_f32 v71, v118, v119
    ds_write_b64 v10, v[70:71] offset:5664
    v_min_f32 v148, 0, v96
    v_min_f32 v149, 0, v97
    v_pk_mul_f32 v[148:149], v[148:149], s[52:53]
    v_min_f32 v150, 0, v98
    v_min_f32 v151, 0, v99
    v_pk_mul_f32 v[150:151], v[150:151], s[52:53]
    v_exp_f32 v148, v148
    v_exp_f32 v149, v149
    v_exp_f32 v150, v150
    v_exp_f32 v151, v151
    v_max_f32 v96, 0, v96
    v_max_f32 v97, 0, v97
    v_max_f32 v98, 0, v98
    v_max_f32 v99, 0, v99
    v_pk_add_f32 v[96:97], v[96:97], v[148:149]
    v_pk_add_f32 v[98:99], v[98:99], v[150:151]
    v_pk_add_f32 v[96:97], v[96:97], s[54:55]
    v_pk_add_f32 v[98:99], v[98:99], s[54:55]
    v_min_f32 v148, 0, v104
    v_min_f32 v149, 0, v105
    v_pk_mul_f32 v[148:149], v[148:149], s[52:53]
    v_min_f32 v150, 0, v106
    v_min_f32 v151, 0, v107
    v_pk_mul_f32 v[150:151], v[150:151], s[52:53]
    v_exp_f32 v148, v148
    v_exp_f32 v149, v149
    v_exp_f32 v150, v150
    v_exp_f32 v151, v151
    v_max_f32 v104, 0, v104
    v_max_f32 v105, 0, v105
    v_max_f32 v106, 0, v106
    v_max_f32 v107, 0, v107
    v_pk_add_f32 v[104:105], v[104:105], v[148:149]
    v_pk_add_f32 v[106:107], v[106:107], v[150:151]
    v_pk_add_f32 v[104:105], v[104:105], s[54:55]
    v_pk_add_f32 v[106:107], v[106:107], s[54:55]
    v_min_f32 v148, 0, v100
    v_min_f32 v149, 0, v101
    v_pk_mul_f32 v[148:149], v[148:149], s[52:53]
    v_min_f32 v150, 0, v102
    v_min_f32 v151, 0, v103
    v_pk_mul_f32 v[150:151], v[150:151], s[52:53]
    v_exp_f32 v148, v148
    v_exp_f32 v149, v149
    v_exp_f32 v150, v150
    v_exp_f32 v151, v151
    v_max_f32 v100, 0, v100
    v_max_f32 v101, 0, v101
    v_max_f32 v102, 0, v102
    v_max_f32 v103, 0, v103
    v_pk_add_f32 v[100:101], v[100:101], v[148:149]
    v_pk_add_f32 v[102:103], v[102:103], v[150:151]
    v_pk_add_f32 v[100:101], v[100:101], s[54:55]
    v_pk_add_f32 v[102:103], v[102:103], s[54:55]
    v_min_f32 v148, 0, v108
    v_min_f32 v149, 0, v109
    v_pk_mul_f32 v[148:149], v[148:149], s[52:53]
    v_min_f32 v150, 0, v110
    v_min_f32 v151, 0, v111
    v_pk_mul_f32 v[150:151], v[150:151], s[52:53]
    v_exp_f32 v148, v148
    v_exp_f32 v149, v149
    v_exp_f32 v150, v150
    v_exp_f32 v151, v151
    v_max_f32 v108, 0, v108
    v_max_f32 v109, 0, v109
    v_max_f32 v110, 0, v110
    v_max_f32 v111, 0, v111
    v_pk_add_f32 v[108:109], v[108:109], v[148:149]
    v_pk_add_f32 v[110:111], v[110:111], v[150:151]
    v_pk_add_f32 v[108:109], v[108:109], s[54:55]
    v_pk_add_f32 v[110:111], v[110:111], s[54:55]
    v_cvt_pk_bf16_f32 v60, v96, v97
    v_cvt_pk_bf16_f32 v61, v98, v99
    ds_write_b64 v10, v[60:61] offset:0
    v_cvt_pk_bf16_f32 v62, v100, v101
    v_cvt_pk_bf16_f32 v63, v102, v103
    ds_write_b64 v10, v[62:63] offset:5376
    v_cvt_pk_bf16_f32 v64, v104, v105
    v_cvt_pk_bf16_f32 v65, v106, v107
    ds_write_b64 v10, v[64:65] offset:32
    v_cvt_pk_bf16_f32 v66, v108, v109
    v_cvt_pk_bf16_f32 v67, v110, v111
    ds_write_b64 v10, v[66:67] offset:5408
    v_min_f32 v148, 0, v88
    v_min_f32 v149, 0, v89
    v_pk_mul_f32 v[148:149], v[148:149], s[52:53]
    v_min_f32 v150, 0, v90
    v_min_f32 v151, 0, v91
    v_pk_mul_f32 v[150:151], v[150:151], s[52:53]
    v_exp_f32 v148, v148
    v_exp_f32 v149, v149
    v_exp_f32 v150, v150
    v_exp_f32 v151, v151
    v_max_f32 v88, 0, v88
    v_max_f32 v89, 0, v89
    v_max_f32 v90, 0, v90
    v_max_f32 v91, 0, v91
    v_pk_add_f32 v[88:89], v[88:89], v[148:149]
    v_pk_add_f32 v[90:91], v[90:91], v[150:151]
    v_pk_add_f32 v[88:89], v[88:89], s[54:55]
    v_pk_add_f32 v[90:91], v[90:91], s[54:55]
    v_cvt_pk_bf16_f32 v56, v88, v89
    v_cvt_pk_bf16_f32 v57, v90, v91
    buffer_store_dwordx2 v[56:57], v12, s[8:11], s43 offen sc1
    v_min_f32 v148, 0, v92
    v_min_f32 v149, 0, v93
    v_pk_mul_f32 v[148:149], v[148:149], s[52:53]
    v_min_f32 v150, 0, v94
    v_min_f32 v151, 0, v95
    v_pk_mul_f32 v[150:151], v[150:151], s[52:53]
    v_exp_f32 v148, v148
    v_exp_f32 v149, v149
    v_exp_f32 v150, v150
    v_exp_f32 v151, v151
    v_max_f32 v92, 0, v92
    v_max_f32 v93, 0, v93
    v_max_f32 v94, 0, v94
    v_max_f32 v95, 0, v95
    v_pk_add_f32 v[92:93], v[92:93], v[148:149]
    v_pk_add_f32 v[94:95], v[94:95], v[150:151]
    v_pk_add_f32 v[92:93], v[92:93], s[54:55]
    v_pk_add_f32 v[94:95], v[94:95], s[54:55]
    v_cvt_pk_bf16_f32 v58, v92, v93
    v_cvt_pk_bf16_f32 v59, v94, v95
    buffer_store_dwordx2 v[58:59], v12, s[8:11], s25 offen sc1
    s_branch interleave_layers__linear_attn_block__memory_aug_recurrent_mem_tr__prompt_kernel_k1_ej
interleave_layers__linear_attn_block__memory_aug_recurrent_mem_tr__prompt_kernel_k1_e3:
    v_min_f32 v148, 0, v88
    v_min_f32 v149, 0, v89
    v_pk_mul_f32 v[148:149], v[148:149], s[52:53]
    v_min_f32 v150, 0, v90
    v_min_f32 v151, 0, v91
    v_pk_mul_f32 v[150:151], v[150:151], s[52:53]
    v_exp_f32 v148, v148
    v_exp_f32 v149, v149
    v_exp_f32 v150, v150
    v_exp_f32 v151, v151
    v_max_f32 v88, 0, v88
    v_max_f32 v89, 0, v89
    v_max_f32 v90, 0, v90
    v_max_f32 v91, 0, v91
    v_pk_add_f32 v[88:89], v[88:89], v[148:149]
    v_pk_add_f32 v[90:91], v[90:91], v[150:151]
    v_pk_add_f32 v[88:89], v[88:89], s[54:55]
    v_pk_add_f32 v[90:91], v[90:91], s[54:55]
    v_min_f32 v148, 0, v92
    v_min_f32 v149, 0, v93
    v_pk_mul_f32 v[148:149], v[148:149], s[52:53]
    v_min_f32 v150, 0, v94
    v_min_f32 v151, 0, v95
    v_pk_mul_f32 v[150:151], v[150:151], s[52:53]
    v_exp_f32 v148, v148
    v_exp_f32 v149, v149
    v_exp_f32 v150, v150
    v_exp_f32 v151, v151
    v_max_f32 v92, 0, v92
    v_max_f32 v93, 0, v93
    v_max_f32 v94, 0, v94
    v_max_f32 v95, 0, v95
    v_pk_add_f32 v[92:93], v[92:93], v[148:149]
    v_pk_add_f32 v[94:95], v[94:95], v[150:151]
    v_pk_add_f32 v[92:93], v[92:93], s[54:55]
    v_pk_add_f32 v[94:95], v[94:95], s[54:55]
    v_cvt_pk_bf16_f32 v56, v88, v89
    v_cvt_pk_bf16_f32 v57, v90, v91
    ds_write_b64 v10, v[56:57] offset:64
    v_cvt_pk_bf16_f32 v58, v92, v93
    v_cvt_pk_bf16_f32 v59, v94, v95
    ds_write_b64 v10, v[58:59] offset:5440
    v_min_f32 v148, 0, v96
    v_min_f32 v149, 0, v97
    v_pk_mul_f32 v[148:149], v[148:149], s[52:53]
    v_min_f32 v150, 0, v98
    v_min_f32 v151, 0, v99
    v_pk_mul_f32 v[150:151], v[150:151], s[52:53]
    v_exp_f32 v148, v148
    v_exp_f32 v149, v149
    v_exp_f32 v150, v150
    v_exp_f32 v151, v151
    v_max_f32 v96, 0, v96
    v_max_f32 v97, 0, v97
    v_max_f32 v98, 0, v98
    v_max_f32 v99, 0, v99
    v_pk_add_f32 v[96:97], v[96:97], v[148:149]
    v_pk_add_f32 v[98:99], v[98:99], v[150:151]
    v_pk_add_f32 v[96:97], v[96:97], s[54:55]
    v_pk_add_f32 v[98:99], v[98:99], s[54:55]
    v_min_f32 v148, 0, v100
    v_min_f32 v149, 0, v101
    v_pk_mul_f32 v[148:149], v[148:149], s[52:53]
    v_min_f32 v150, 0, v102
    v_min_f32 v151, 0, v103
    v_pk_mul_f32 v[150:151], v[150:151], s[52:53]
    v_exp_f32 v148, v148
    v_exp_f32 v149, v149
    v_exp_f32 v150, v150
    v_exp_f32 v151, v151
    v_max_f32 v100, 0, v100
    v_max_f32 v101, 0, v101
    v_max_f32 v102, 0, v102
    v_max_f32 v103, 0, v103
    v_pk_add_f32 v[100:101], v[100:101], v[148:149]
    v_pk_add_f32 v[102:103], v[102:103], v[150:151]
    v_pk_add_f32 v[100:101], v[100:101], s[54:55]
    v_pk_add_f32 v[102:103], v[102:103], s[54:55]
    v_cvt_pk_bf16_f32 v60, v96, v97
    v_cvt_pk_bf16_f32 v61, v98, v99
    ds_write_b64 v10, v[60:61] offset:96
    v_cvt_pk_bf16_f32 v62, v100, v101
    v_cvt_pk_bf16_f32 v63, v102, v103
    ds_write_b64 v10, v[62:63] offset:5472
    v_min_f32 v148, 0, v104
    v_min_f32 v149, 0, v105
    v_pk_mul_f32 v[148:149], v[148:149], s[52:53]
    v_min_f32 v150, 0, v106
    v_min_f32 v151, 0, v107
    v_pk_mul_f32 v[150:151], v[150:151], s[52:53]
    v_exp_f32 v148, v148
    v_exp_f32 v149, v149
    v_exp_f32 v150, v150
    v_exp_f32 v151, v151
    v_max_f32 v104, 0, v104
    v_max_f32 v105, 0, v105
    v_max_f32 v106, 0, v106
    v_max_f32 v107, 0, v107
    v_pk_add_f32 v[104:105], v[104:105], v[148:149]
    v_pk_add_f32 v[106:107], v[106:107], v[150:151]
    v_pk_add_f32 v[104:105], v[104:105], s[54:55]
    v_pk_add_f32 v[106:107], v[106:107], s[54:55]
    v_min_f32 v148, 0, v108
    v_min_f32 v149, 0, v109
    v_pk_mul_f32 v[148:149], v[148:149], s[52:53]
    v_min_f32 v150, 0, v110
    v_min_f32 v151, 0, v111
    v_pk_mul_f32 v[150:151], v[150:151], s[52:53]
    v_exp_f32 v148, v148
    v_exp_f32 v149, v149
    v_exp_f32 v150, v150
    v_exp_f32 v151, v151
    v_max_f32 v108, 0, v108
    v_max_f32 v109, 0, v109
    v_max_f32 v110, 0, v110
    v_max_f32 v111, 0, v111
    v_pk_add_f32 v[108:109], v[108:109], v[148:149]
    v_pk_add_f32 v[110:111], v[110:111], v[150:151]
    v_pk_add_f32 v[108:109], v[108:109], s[54:55]
    v_pk_add_f32 v[110:111], v[110:111], s[54:55]
    v_cvt_pk_bf16_f32 v64, v104, v105
    v_cvt_pk_bf16_f32 v65, v106, v107
    ds_write_b64 v10, v[64:65] offset:128
    v_cvt_pk_bf16_f32 v66, v108, v109
    v_cvt_pk_bf16_f32 v67, v110, v111
    ds_write_b64 v10, v[66:67] offset:5504
interleave_layers__linear_attn_block__memory_aug_recurrent_mem_tr__prompt_kernel_k1_ej:
    s_waitcnt lgkmcnt(0)
    s_barrier
    ds_read_b64_tr_b16 v[72:73], v11 offset:0
    ds_read_b64_tr_b16 v[74:75], v11 offset:1344
    ds_read_b64_tr_b16 v[76:77], v11 offset:32
    ds_read_b64_tr_b16 v[78:79], v11 offset:1376
    ds_read_b64_tr_b16 v[80:81], v11 offset:160
    ds_read_b64_tr_b16 v[82:83], v11 offset:1504
    ds_read_b64_tr_b16 v[84:85], v11 offset:192
    ds_read_b64_tr_b16 v[86:87], v11 offset:1536
    s_waitcnt lgkmcnt(0)
    v_mfma_f32_16x16x32_bf16 v[120:123], v[72:75], v[84:87], v[120:123]
    v_mfma_f32_16x16x32_bf16 v[124:127], v[76:79], v[80:83], v[124:127]
    v_mfma_f32_16x16x32_bf16 v[128:131], v[76:79], v[84:87], v[128:131]
    v_mfma_f32_16x16x32_bf16 v[132:135], v[76:79], v[172:175], v[132:135]
    v_mfma_f32_16x16x32_bf16 v[136:139], v[72:75], v[80:83], v[136:139]
    v_mfma_f32_16x16x32_bf16 v[140:143], v[72:75], v[172:175], v[140:143]
    s_add_u32 s43, s43, s42
    s_add_u32 s48, s48, s49
    s_sub_u32 s40, s40, 1
    s_cmp_gt_u32 s40, 0
    s_cbranch_scc1 interleave_layers__linear_attn_block__memory_aug_recurrent_mem_tr__prompt_kernel_k1_seg
    s_mul_i32 s24, s45, 147456
    s_mul_i32 s25, s44, 18432
    s_add_u32 s24, s24, s25
    s_add_u32 s24, s24, 16777216
    s_mul_i32 s25, s3, 3072
    s_add_u32 s25, s25, s24
    s_lshl_b32 s26, s3, 10
    s_add_u32 s26, s26, s24
    s_add_u32 s26, s26, 13312
    s_cmp_eq_u32 s3, 0
    s_cselect_b32 s27, 0, 2146435072
    s_add_u32 s27, s27, s24
    s_add_u32 s28, s27, 17408
    s_add_u32 s27, s27, 12288
    buffer_store_dwordx4 v[120:123], v7, s[8:11], s25 offen offset:0 sc1
    buffer_store_dwordx4 v[124:127], v7, s[8:11], s25 offen offset:1024 sc1
    buffer_store_dwordx4 v[128:131], v7, s[8:11], s25 offen offset:2048 sc1
    buffer_store_dwordx4 v[132:135], v7, s[8:11], s26 offen sc1
    buffer_store_dwordx4 v[136:139], v7, s[8:11], s27 offen sc1
    buffer_store_dwordx4 v[140:143], v7, s[8:11], s28 offen sc1
    s_waitcnt vmcnt(0)
    s_barrier
    s_lshl_b32 s24, s92, 3
    s_add_u32 s24, s24, s44
    s_lshl_b32 s24, s24, 7
    s_lshl_b32 s25, s45, 2
    s_add_u32 s24, s24, s25
    s_add_u32 s24, s24, 23101440
    s_cmp_eq_u32 s3, 0
    s_cbranch_scc0 interleave_layers__linear_attn_block__memory_aug_recurrent_mem_tr__prompt_kernel_pb8
    v_lshlrev_b32 v14, 7, v1
    v_add_u32 v14, s24, v14
    v_mov_b32 v15, 2146435072
    v_cmp_le_u32 vcc, 1, v1
    s_nop 1
    v_cndmask_b32 v14, v14, v15, vcc
    v_mov_b32 v15, 1
    buffer_store_dword v15, v14, s[8:11], 0 offen sc1
interleave_layers__linear_attn_block__memory_aug_recurrent_mem_tr__prompt_kernel_pb8:
    s_cmp_eq_u32 s92, 0
    s_cbranch_scc0 interleave_layers__linear_attn_block__memory_aug_recurrent_mem_tr__prompt_kernel_end
    s_cmp_ge_u32 s2, 232
    s_cbranch_scc1 interleave_layers__linear_attn_block__memory_aug_recurrent_mem_tr__prompt_kernel_helper
    s_cmp_ge_u32 s2, 200
    s_cbranch_scc1 interleave_layers__linear_attn_block__memory_aug_recurrent_mem_tr__prompt_kernel_toO
    s_cmp_ge_u32 s2, 104
    s_cbranch_scc1 interleave_layers__linear_attn_block__memory_aug_recurrent_mem_tr__prompt_kernel_toP
    s_cmp_ge_u32 s2, 64
    s_cbranch_scc1 interleave_layers__linear_attn_block__memory_aug_recurrent_mem_tr__prompt_kernel_toR
    s_cmp_ge_u32 s2, 32
    s_cbranch_scc1 interleave_layers__linear_attn_block__memory_aug_recurrent_mem_tr__prompt_kernel_toV
    s_branch interleave_layers__linear_attn_block__memory_aug_recurrent_mem_tr__prompt_kernel_roleS
interleave_layers__linear_attn_block__memory_aug_recurrent_mem_tr__prompt_kernel_toV:
    s_branch interleave_layers__linear_attn_block__memory_aug_recurrent_mem_tr__prompt_kernel_roleV
interleave_layers__linear_attn_block__memory_aug_recurrent_mem_tr__prompt_kernel_toR:
    s_branch interleave_layers__linear_attn_block__memory_aug_recurrent_mem_tr__prompt_kernel_roleR
interleave_layers__linear_attn_block__memory_aug_recurrent_mem_tr__prompt_kernel_toP:
    s_branch interleave_layers__linear_attn_block__memory_aug_recurrent_mem_tr__prompt_kernel_roleP
interleave_layers__linear_attn_block__memory_aug_recurrent_mem_tr__prompt_kernel_toO:
    s_branch interleave_layers__linear_attn_block__memory_aug_recurrent_mem_tr__prompt_kernel_roleO
interleave_layers__linear_attn_block__memory_aug_recurrent_mem_tr__prompt_kernel_helper:
    s_sub_u32 s24, s2, 232
    s_cmp_ge_u32 s24, 21
    s_cbranch_scc1 interleave_layers__linear_attn_block__memory_aug_recurrent_mem_tr__prompt_kernel_helper_clr
    s_cmp_eq_u32 s24, 15
    s_cbranch_scc1 interleave_layers__linear_attn_block__memory_aug_recurrent_mem_tr__prompt_kernel_helper_k1
    s_mul_i32 s57, s24, 52
    s_lshr_b32 s57, s57, 8
    s_mul_i32 s56, s57, 5
    s_sub_u32 s56, s24, s56
    s_add_u32 s57, s57, 1
    s_sub_u32 s25, s24, 16
    s_cmp_ge_u32 s24, 16
    s_cselect_b32 s56, s25, s56
    s_cselect_b32 s57, 0, s57
    s_mul_i32 s78, s57, 5
    s_add_u32 s78, s78, s56
    s_load_dwordx2 s[6:7], s[0:1], 16
    v_lshrrev_b32 v12, 4, v0
    v_mul_u32_u24 v12, 1280, v12
    v_and_b32 v13, 15, v0
    v_lshl_add_u32 v12, v13, 4, v12
    s_waitcnt lgkmcnt(0)
    s_mov_b32 s12, s6
    s_mov_b32 s13, s7
    s_mov_b32 s14, 819200
    s_mov_b32 s15, 0x00020000
    s_lshl_b32 s52, s56, 8
    s_add_u32 s24, s52, 0
    buffer_load_dwordx4 a[0:3], v12, s[12:15], s24 offen
    s_add_u32 s24, s52, 20480
    buffer_load_dwordx4 a[4:7], v12, s[12:15], s24 offen
    s_add_u32 s24, s52, 40960
    buffer_load_dwordx4 a[8:11], v12, s[12:15], s24 offen
    s_add_u32 s24, s52, 61440
    buffer_load_dwordx4 a[12:15], v12, s[12:15], s24 offen
    s_add_u32 s24, s52, 81920
    buffer_load_dwordx4 a[16:19], v12, s[12:15], s24 offen
    s_add_u32 s24, s52, 102400
    buffer_load_dwordx4 a[20:23], v12, s[12:15], s24 offen
    s_add_u32 s24, s52, 122880
    buffer_load_dwordx4 a[24:27], v12, s[12:15], s24 offen
    s_add_u32 s24, s52, 143360
    buffer_load_dwordx4 a[28:31], v12, s[12:15], s24 offen
    s_add_u32 s24, s52, 163840
    buffer_load_dwordx4 a[32:35], v12, s[12:15], s24 offen
    s_add_u32 s24, s52, 184320
    buffer_load_dwordx4 a[36:39], v12, s[12:15], s24 offen
    s_add_u32 s24, s52, 204800
    buffer_load_dwordx4 a[40:43], v12, s[12:15], s24 offen
    s_add_u32 s24, s52, 225280
    buffer_load_dwordx4 a[44:47], v12, s[12:15], s24 offen
    s_add_u32 s24, s52, 245760
    buffer_load_dwordx4 a[48:51], v12, s[12:15], s24 offen
    s_add_u32 s24, s52, 266240
    buffer_load_dwordx4 a[52:55], v12, s[12:15], s24 offen
    s_add_u32 s24, s52, 286720
    buffer_load_dwordx4 a[56:59], v12, s[12:15], s24 offen
    s_add_u32 s24, s52, 307200
    buffer_load_dwordx4 a[60:63], v12, s[12:15], s24 offen
    s_add_u32 s24, s52, 327680
    buffer_load_dwordx4 a[64:67], v12, s[12:15], s24 offen
    s_add_u32 s24, s52, 348160
    buffer_load_dwordx4 a[68:71], v12, s[12:15], s24 offen
    s_add_u32 s24, s52, 368640
    buffer_load_dwordx4 a[72:75], v12, s[12:15], s24 offen
    s_add_u32 s24, s52, 389120
    buffer_load_dwordx4 a[76:79], v12, s[12:15], s24 offen
    s_add_u32 s24, s52, 409600
    buffer_load_dwordx4 a[80:83], v12, s[12:15], s24 offen
    s_add_u32 s24, s52, 430080
    buffer_load_dwordx4 a[84:87], v12, s[12:15], s24 offen
    s_add_u32 s24, s52, 450560
    buffer_load_dwordx4 a[88:91], v12, s[12:15], s24 offen
    s_add_u32 s24, s52, 471040
    buffer_load_dwordx4 a[92:95], v12, s[12:15], s24 offen
    s_add_u32 s24, s52, 491520
    buffer_load_dwordx4 a[96:99], v12, s[12:15], s24 offen
    s_add_u32 s24, s52, 512000
    buffer_load_dwordx4 a[100:103], v12, s[12:15], s24 offen
    s_add_u32 s24, s52, 532480
    buffer_load_dwordx4 a[104:107], v12, s[12:15], s24 offen
    s_add_u32 s24, s52, 552960
    buffer_load_dwordx4 a[108:111], v12, s[12:15], s24 offen
    s_add_u32 s24, s52, 573440
    buffer_load_dwordx4 a[112:115], v12, s[12:15], s24 offen
    s_add_u32 s24, s52, 593920
    buffer_load_dwordx4 a[116:119], v12, s[12:15], s24 offen
    s_add_u32 s24, s52, 614400
    buffer_load_dwordx4 a[120:123], v12, s[12:15], s24 offen
    s_add_u32 s24, s52, 634880
    buffer_load_dwordx4 a[124:127], v12, s[12:15], s24 offen
    s_add_u32 s24, s52, 655360
    buffer_load_dwordx4 a[128:131], v12, s[12:15], s24 offen
    s_add_u32 s24, s52, 675840
    buffer_load_dwordx4 a[132:135], v12, s[12:15], s24 offen
    s_add_u32 s24, s52, 696320
    buffer_load_dwordx4 a[136:139], v12, s[12:15], s24 offen
    s_add_u32 s24, s52, 716800
    buffer_load_dwordx4 a[140:143], v12, s[12:15], s24 offen
    s_add_u32 s24, s52, 737280
    buffer_load_dwordx4 a[144:147], v12, s[12:15], s24 offen
    s_add_u32 s24, s52, 757760
    buffer_load_dwordx4 a[148:151], v12, s[12:15], s24 offen
    s_add_u32 s24, s52, 778240
    buffer_load_dwordx4 a[152:155], v12, s[12:15], s24 offen
    s_add_u32 s24, s52, 798720
    buffer_load_dwordx4 a[156:159], v12, s[12:15], s24 offen
    v_lshrrev_b32 v6, 4, v0
    v_mul_u32_u24 v6, 288, v6
    v_and_b32 v7, 15, v0
    v_lshl_add_u32 v6, v7, 4, v6
    v_add_u32 v6, 81920, v6
    v_lshrrev_b32 v7, 2, v2
    v_lshl_add_u32 v7, v3, 2, v7
    v_mul_u32_u24 v7, 288, v7
    v_and_b32 v8, 3, v2
    v_lshl_add_u32 v7, v8, 3, v7
    s_lshl_b32 s24, s3, 6
    s_add_u32 s24, s24, 81920
    v_add_u32 v7, s24, v7
    s_waitcnt vmcnt(36)
    ds_write_b128 v6, a[0:3] offset:0
    ds_write_b128 v6, a[4:7] offset:4608
    ds_write_b128 v6, a[8:11] offset:9216
    ds_write_b128 v6, a[12:15] offset:13824
    s_waitcnt lgkmcnt(0)
    s_barrier
    ds_read_b64_tr_b16 a[0:1], v7 offset:0
    ds_read_b64_tr_b16 a[2:3], v7 offset:4608
    ds_read_b64_tr_b16 a[4:5], v7 offset:32
    ds_read_b64_tr_b16 a[6:7], v7 offset:4640
    ds_read_b64_tr_b16 a[8:9], v7 offset:9216
    ds_read_b64_tr_b16 a[10:11], v7 offset:13824
    ds_read_b64_tr_b16 a[12:13], v7 offset:9248
    ds_read_b64_tr_b16 a[14:15], v7 offset:13856
    s_waitcnt vmcnt(32)
    ds_write_b128 v6, a[16:19] offset:18432
    ds_write_b128 v6, a[20:23] offset:23040
    ds_write_b128 v6, a[24:27] offset:27648
    ds_write_b128 v6, a[28:31] offset:32256
    s_waitcnt lgkmcnt(0)
    s_barrier
    ds_read_b64_tr_b16 a[16:17], v7 offset:18432
    ds_read_b64_tr_b16 a[18:19], v7 offset:23040
    ds_read_b64_tr_b16 a[20:21], v7 offset:18464
    ds_read_b64_tr_b16 a[22:23], v7 offset:23072
    ds_read_b64_tr_b16 a[24:25], v7 offset:27648
    ds_read_b64_tr_b16 a[26:27], v7 offset:32256
    ds_read_b64_tr_b16 a[28:29], v7 offset:27680
    ds_read_b64_tr_b16 a[30:31], v7 offset:32288
    s_waitcnt vmcnt(28)
    ds_write_b128 v6, a[32:35] offset:0
    ds_write_b128 v6, a[36:39] offset:4608
    ds_write_b128 v6, a[40:43] offset:9216
    ds_write_b128 v6, a[44:47] offset:13824
    s_waitcnt lgkmcnt(0)
    s_barrier
    ds_read_b64_tr_b16 a[32:33], v7 offset:0
    ds_read_b64_tr_b16 a[34:35], v7 offset:4608
    ds_read_b64_tr_b16 a[36:37], v7 offset:32
    ds_read_b64_tr_b16 a[38:39], v7 offset:4640
    ds_read_b64_tr_b16 a[40:41], v7 offset:9216
    ds_read_b64_tr_b16 a[42:43], v7 offset:13824
    ds_read_b64_tr_b16 a[44:45], v7 offset:9248
    ds_read_b64_tr_b16 a[46:47], v7 offset:13856
    s_waitcnt vmcnt(24)
    ds_write_b128 v6, a[48:51] offset:18432
    ds_write_b128 v6, a[52:55] offset:23040
    ds_write_b128 v6, a[56:59] offset:27648
    ds_write_b128 v6, a[60:63] offset:32256
    s_waitcnt lgkmcnt(0)
    s_barrier
    ds_read_b64_tr_b16 a[48:49], v7 offset:18432
    ds_read_b64_tr_b16 a[50:51], v7 offset:23040
    ds_read_b64_tr_b16 a[52:53], v7 offset:18464
    ds_read_b64_tr_b16 a[54:55], v7 offset:23072
    ds_read_b64_tr_b16 a[56:57], v7 offset:27648
    ds_read_b64_tr_b16 a[58:59], v7 offset:32256
    ds_read_b64_tr_b16 a[60:61], v7 offset:27680
    ds_read_b64_tr_b16 a[62:63], v7 offset:32288
    s_waitcnt vmcnt(20)
    ds_write_b128 v6, a[64:67] offset:0
    ds_write_b128 v6, a[68:71] offset:4608
    ds_write_b128 v6, a[72:75] offset:9216
    ds_write_b128 v6, a[76:79] offset:13824
    s_waitcnt lgkmcnt(0)
    s_barrier
    ds_read_b64_tr_b16 a[64:65], v7 offset:0
    ds_read_b64_tr_b16 a[66:67], v7 offset:4608
    ds_read_b64_tr_b16 a[68:69], v7 offset:32
    ds_read_b64_tr_b16 a[70:71], v7 offset:4640
    ds_read_b64_tr_b16 a[72:73], v7 offset:9216
    ds_read_b64_tr_b16 a[74:75], v7 offset:13824
    ds_read_b64_tr_b16 a[76:77], v7 offset:9248
    ds_read_b64_tr_b16 a[78:79], v7 offset:13856
    s_waitcnt vmcnt(16)
    ds_write_b128 v6, a[80:83] offset:18432
    ds_write_b128 v6, a[84:87] offset:23040
    ds_write_b128 v6, a[88:91] offset:27648
    ds_write_b128 v6, a[92:95] offset:32256
    s_waitcnt lgkmcnt(0)
    s_barrier
    ds_read_b64_tr_b16 a[80:81], v7 offset:18432
    ds_read_b64_tr_b16 a[82:83], v7 offset:23040
    ds_read_b64_tr_b16 a[84:85], v7 offset:18464
    ds_read_b64_tr_b16 a[86:87], v7 offset:23072
    ds_read_b64_tr_b16 a[88:89], v7 offset:27648
    ds_read_b64_tr_b16 a[90:91], v7 offset:32256
    ds_read_b64_tr_b16 a[92:93], v7 offset:27680
    ds_read_b64_tr_b16 a[94:95], v7 offset:32288
    s_waitcnt vmcnt(12)
    ds_write_b128 v6, a[96:99] offset:0
    ds_write_b128 v6, a[100:103] offset:4608
    ds_write_b128 v6, a[104:107] offset:9216
    ds_write_b128 v6, a[108:111] offset:13824
    s_waitcnt lgkmcnt(0)
    s_barrier
    ds_read_b64_tr_b16 a[96:97], v7 offset:0
    ds_read_b64_tr_b16 a[98:99], v7 offset:4608
    ds_read_b64_tr_b16 a[100:101], v7 offset:32
    ds_read_b64_tr_b16 a[102:103], v7 offset:4640
    ds_read_b64_tr_b16 a[104:105], v7 offset:9216
    ds_read_b64_tr_b16 a[106:107], v7 offset:13824
    ds_read_b64_tr_b16 a[108:109], v7 offset:9248
    ds_read_b64_tr_b16 a[110:111], v7 offset:13856
    s_waitcnt vmcnt(8)
    ds_write_b128 v6, a[112:115] offset:18432
    ds_write_b128 v6, a[116:119] offset:23040
    ds_write_b128 v6, a[120:123] offset:27648
    ds_write_b128 v6, a[124:127] offset:32256
    s_waitcnt lgkmcnt(0)
    s_barrier
    ds_read_b64_tr_b16 a[112:113], v7 offset:18432
    ds_read_b64_tr_b16 a[114:115], v7 offset:23040
    ds_read_b64_tr_b16 a[116:117], v7 offset:18464
    ds_read_b64_tr_b16 a[118:119], v7 offset:23072
    ds_read_b64_tr_b16 a[120:121], v7 offset:27648
    ds_read_b64_tr_b16 a[122:123], v7 offset:32256
    ds_read_b64_tr_b16 a[124:125], v7 offset:27680
    ds_read_b64_tr_b16 a[126:127], v7 offset:32288
    s_waitcnt vmcnt(4)
    ds_write_b128 v6, a[128:131] offset:0
    ds_write_b128 v6, a[132:135] offset:4608
    ds_write_b128 v6, a[136:139] offset:9216
    ds_write_b128 v6, a[140:143] offset:13824
    s_waitcnt lgkmcnt(0)
    s_barrier
    ds_read_b64_tr_b16 a[128:129], v7 offset:0
    ds_read_b64_tr_b16 a[130:131], v7 offset:4608
    ds_read_b64_tr_b16 a[132:133], v7 offset:32
    ds_read_b64_tr_b16 a[134:135], v7 offset:4640
    ds_read_b64_tr_b16 a[136:137], v7 offset:9216
    ds_read_b64_tr_b16 a[138:139], v7 offset:13824
    ds_read_b64_tr_b16 a[140:141], v7 offset:9248
    ds_read_b64_tr_b16 a[142:143], v7 offset:13856
    s_waitcnt vmcnt(0)
    ds_write_b128 v6, a[144:147] offset:18432
    ds_write_b128 v6, a[148:151] offset:23040
    ds_write_b128 v6, a[152:155] offset:27648
    ds_write_b128 v6, a[156:159] offset:32256
    s_waitcnt lgkmcnt(0)
    s_barrier
    ds_read_b64_tr_b16 a[144:145], v7 offset:18432
    ds_read_b64_tr_b16 a[146:147], v7 offset:23040
    ds_read_b64_tr_b16 a[148:149], v7 offset:18464
    ds_read_b64_tr_b16 a[150:151], v7 offset:23072
    ds_read_b64_tr_b16 a[152:153], v7 offset:27648
    ds_read_b64_tr_b16 a[154:155], v7 offset:32256
    ds_read_b64_tr_b16 a[156:157], v7 offset:27680
    ds_read_b64_tr_b16 a[158:159], v7 offset:32288
    s_waitcnt lgkmcnt(0)
    s_load_dwordx2 s[6:7], s[0:1], 0
    s_waitcnt lgkmcnt(0)
    s_mov_b32 s16, s6
    s_mov_b32 s17, s7
    s_mov_b32 s18, 2621440
    s_mov_b32 s19, 0x00020000
    s_mov_b32 s46, 64
    s_mov_b32 s47, 32
    s_mov_b32 s50, 0
    s_mov_b32 s58, 0
    s_mov_b32 s76, 16
    s_mov_b32 s77, 163840
interleave_layers__linear_attn_block__memory_aug_recurrent_mem_tr__prompt_kernel_k3_entry:
    v_lshlrev_b32 v5, 4, v1
    s_mul_i32 s24, s3, 5120
    s_add_u32 s24, s24, 12582912
    v_add_u32 v8, s24, v5
    v_lshlrev_b32 v9, 3, v1
    s_add_u32 s24, s24, 2048
    v_add_u32 v9, s24, v9
    s_cmp_eq_u32 s50, 1
    s_cselect_b32 s25, 16, 1280
    s_cselect_b32 s26, 256, 8
    v_mul_u32_u24 v10, s25, v2
    v_mul_u32_u24 v11, s26, v3
    s_lshl_b32 s24, s56, 2
    s_add_u32 s24, s24, s3
    s_mul_i32 s25, s24, s46
    v_add3_u32 v10, v10, v11, s25
    v_add_u32 v11, s47, v10
    s_lshl_b32 s24, s24, 10
    s_add_u32 s24, s24, s58
    v_add_u32 v12, s24, v5
    s_mul_i32 s24, s3, 5120
    s_add_u32 s24, s24, 0
    v_add_u32 v13, s24, v5
    s_mov_b32 s54, 0x358637bd
    s_mul_i32 s43, s57, 40960
    s_mov_b32 s40, 0
    s_mov_b32 s42, 0
    s_cmp_eq_u32 s92, 0
    s_cselect_b32 s26, 32, 0
    s_cselect_b32 s27, 7, 1
    s_lshl_b32 s24, s92, 10
    s_add_u32 s24, s24, 23101440
    v_and_b32 v15, 7, v1
    v_lshlrev_b32 v15, 7, v15
    v_lshrrev_b32 v14, 3, v1
    v_and_b32 v14, s27, v14
    v_lshl_add_u32 v15, v14, 2, v15
    v_add_u32 v15, s24, v15
    s_lshl_b32 s27, s26, 1
    s_add_u32 s28, s27, s26
    s_mov_b32 s61, 0
interleave_layers__linear_attn_block__memory_aug_recurrent_mem_tr__prompt_kernel_k3_w0:
    buffer_load_dword v16, v15, s[8:11], 0 offen sc1
    buffer_load_dword v17, v15, s[8:11], s26 offen sc1
    buffer_load_dword v18, v15, s[8:11], s27 offen sc1
    buffer_load_dword v19, v15, s[8:11], s28 offen sc1
    s_waitcnt vmcnt(0)
    v_min_i32 v16, v16, v17
    v_min3_i32 v16, v16, v18, v19
    v_cmp_le_i32 vcc, 1, v16
    s_cmp_eq_u64 vcc, -1
    s_cbranch_scc1 interleave_layers__linear_attn_block__memory_aug_recurrent_mem_tr__prompt_kernel_k3_w0_ok
    s_add_u32 s61, s61, 1
    s_cmp_ge_u32 s61, s60
    s_cbranch_scc1 interleave_layers__linear_attn_block__memory_aug_recurrent_mem_tr__prompt_kernel_k3_w0_to
    s_sleep 4
    s_branch interleave_layers__linear_attn_block__memory_aug_recurrent_mem_tr__prompt_kernel_k3_w0
interleave_layers__linear_attn_block__memory_aug_recurrent_mem_tr__prompt_kernel_k3_w0_to:
    s_mov_b32 s60, 1
interleave_layers__linear_attn_block__memory_aug_recurrent_mem_tr__prompt_kernel_k3_w0_ok:
    s_mov_b32 s41, s43
    s_add_u32 s25, s41, 20480
    buffer_load_dwordx4 v[16:19], v8, s[8:11], s41 offen offset:0 sc1
    buffer_load_dwordx4 v[20:23], v8, s[8:11], s41 offen offset:1024 sc1
    buffer_load_dwordx2 v[24:25], v9, s[8:11], s41 offen offset:0 sc1
    buffer_load_dwordx4 v[26:29], v8, s[8:11], s41 offen offset:2560 sc1
    buffer_load_dwordx4 v[30:33], v8, s[8:11], s41 offen offset:3584 sc1
    buffer_load_dwordx2 v[34:35], v9, s[8:11], s41 offen offset:2560 sc1
    buffer_load_dwordx4 v[36:39], v8, s[8:11], s25 offen offset:0 sc1
    buffer_load_dwordx4 v[40:43], v8, s[8:11], s25 offen offset:1024 sc1
    buffer_load_dwordx2 v[44:45], v9, s[8:11], s25 offen offset:0 sc1
    buffer_load_dwordx4 v[46:49], v8, s[8:11], s25 offen offset:2560 sc1
    buffer_load_dwordx4 v[50:53], v8, s[8:11], s25 offen offset:3584 sc1
    buffer_load_dwordx2 v[54:55], v9, s[8:11], s25 offen offset:2560 sc1
    buffer_load_dwordx2 v[96:97], v10, s[16:19], s41 offen sc1
    buffer_load_dwordx2 v[98:99], v11, s[16:19], s41 offen sc1
    buffer_load_dwordx2 v[100:101], v10, s[16:19], s25 offen sc1
    buffer_load_dwordx2 v[102:103], v11, s[16:19], s25 offen sc1
    s_add_u32 s41, s43, s77
    s_add_u32 s25, s41, 20480
    buffer_load_dwordx4 v[56:59], v8, s[8:11], s41 offen offset:0 sc1
    buffer_load_dwordx4 v[60:63], v8, s[8:11], s41 offen offset:1024 sc1
    buffer_load_dwordx2 v[64:65], v9, s[8:11], s41 offen offset:0 sc1
    buffer_load_dwordx4 v[66:69], v8, s[8:11], s41 offen offset:2560 sc1
    buffer_load_dwordx4 v[70:73], v8, s[8:11], s41 offen offset:3584 sc1
    buffer_load_dwordx2 v[74:75], v9, s[8:11], s41 offen offset:2560 sc1
    buffer_load_dwordx4 v[76:79], v8, s[8:11], s25 offen offset:0 sc1
    buffer_load_dwordx4 v[80:83], v8, s[8:11], s25 offen offset:1024 sc1
    buffer_load_dwordx2 v[84:85], v9, s[8:11], s25 offen offset:0 sc1
    buffer_load_dwordx4 v[86:89], v8, s[8:11], s25 offen offset:2560 sc1
    buffer_load_dwordx4 v[90:93], v8, s[8:11], s25 offen offset:3584 sc1
    buffer_load_dwordx2 v[94:95], v9, s[8:11], s25 offen offset:2560 sc1
    buffer_load_dwordx2 v[104:105], v10, s[16:19], s41 offen sc1
    buffer_load_dwordx2 v[106:107], v11, s[16:19], s41 offen sc1
    buffer_load_dwordx2 v[108:109], v10, s[16:19], s25 offen sc1
    buffer_load_dwordx2 v[110:111], v11, s[16:19], s25 offen sc1
    s_lshl_b32 s24, s92, 7
    s_add_u32 s24, s24, 23103488
    v_lshlrev_b32 v15, 2, v1
    v_add_u32 v15, s24, v15
    s_mov_b32 s61, 0
interleave_layers__linear_attn_block__memory_aug_recurrent_mem_tr__prompt_kernel_k3_w:
    buffer_load_dword v14, v15, s[8:11], 0 offen sc1
    s_waitcnt vmcnt(0)
    v_cmp_le_i32 vcc, 1, v14
    s_mov_b32 s25, 0xffffff
    s_and_b32 s24, vcc_lo, s25
    s_cmp_eq_u32 s24, s25
    s_cbranch_scc1 interleave_layers__linear_attn_block__memory_aug_recurrent_mem_tr__prompt_kernel_k3_w_ok
    s_add_u32 s61, s61, 1
    s_cmp_ge_u32 s61, s60
    s_cbranch_scc1 interleave_layers__linear_attn_block__memory_aug_recurrent_mem_tr__prompt_kernel_k3_w_to
    s_sleep 2
    s_branch interleave_layers__linear_attn_block__memory_aug_recurrent_mem_tr__prompt_kernel_k3_w
interleave_layers__linear_attn_block__memory_aug_recurrent_mem_tr__prompt_kernel_k3_w_to:
    s_mov_b32 s60, 1
interleave_layers__linear_attn_block__memory_aug_recurrent_mem_tr__prompt_kernel_k3_w_ok:
    s_mul_i32 s24, s92, 131072
    s_mul_i32 s25, s3, 28672
    s_add_u32 s24, s24, s25
    s_add_u32 s24, s24, 22020096
    s_add_u32 s25, s24, 0
    buffer_load_dwordx4 a[160:163], v5, s[8:11], s25 offen sc1
    s_add_u32 s25, s24, 1024
    buffer_load_dwordx4 a[164:167], v5, s[8:11], s25 offen sc1
    s_add_u32 s25, s24, 2048
    buffer_load_dwordx4 a[168:171], v5, s[8:11], s25 offen sc1
    s_add_u32 s25, s24, 3072
    buffer_load_dwordx4 a[172:175], v5, s[8:11], s25 offen sc1
    s_add_u32 s25, s24, 4096
    buffer_load_dwordx4 a[176:179], v5, s[8:11], s25 offen sc1
    s_add_u32 s25, s24, 5120
    buffer_load_dwordx4 a[180:183], v5, s[8:11], s25 offen sc1
    s_add_u32 s25, s24, 6144
    buffer_load_dwordx2 a[184:185], v5, s[8:11], s25 offen sc1
    s_add_u32 s25, s24, 7168
    buffer_load_dwordx4 a[186:189], v5, s[8:11], s25 offen sc1
    s_add_u32 s25, s24, 8192
    buffer_load_dwordx2 a[190:191], v5, s[8:11], s25 offen sc1
    s_add_u32 s25, s24, 9216
    buffer_load_dwordx4 a[192:195], v5, s[8:11], s25 offen sc1
    s_add_u32 s25, s24, 10240
    buffer_load_dwordx4 a[196:199], v5, s[8:11], s25 offen sc1
    s_add_u32 s25, s24, 11264
    buffer_load_dwordx2 a[200:201], v5, s[8:11], s25 offen sc1
    s_add_u32 s25, s24, 12288
    buffer_load_dwordx4 a[202:205], v5, s[8:11], s25 offen sc1
    s_add_u32 s25, s24, 13312
    buffer_load_dwordx2 a[206:207], v5, s[8:11], s25 offen sc1
    s_add_u32 s25, s24, 14336
    buffer_load_dwordx4 a[208:211], v5, s[8:11], s25 offen sc1
    s_add_u32 s25, s24, 15360
    buffer_load_dwordx4 a[212:215], v5, s[8:11], s25 offen sc1
    s_add_u32 s25, s24, 16384
    buffer_load_dwordx4 a[216:219], v5, s[8:11], s25 offen sc1
    s_add_u32 s25, s24, 17408
    buffer_load_dwordx4 a[220:223], v5, s[8:11], s25 offen sc1
    s_add_u32 s25, s24, 18432
    buffer_load_dwordx4 a[224:227], v5, s[8:11], s25 offen sc1
    s_add_u32 s25, s24, 19456
    buffer_load_dwordx4 a[228:231], v5, s[8:11], s25 offen sc1
    s_add_u32 s25, s24, 20480
    buffer_load_dwordx2 a[232:233], v5, s[8:11], s25 offen sc1
    s_add_u32 s25, s24, 21504
    buffer_load_dwordx4 a[234:237], v5, s[8:11], s25 offen sc1
    s_add_u32 s25, s24, 22528
    buffer_load_dwordx2 a[238:239], v5, s[8:11], s25 offen sc1
    s_add_u32 s25, s24, 23552
    buffer_load_dwordx4 a[240:243], v5, s[8:11], s25 offen sc1
    s_add_u32 s25, s24, 24576
    buffer_load_dwordx4 a[244:247], v5, s[8:11], s25 offen sc1
    s_add_u32 s25, s24, 25600
    buffer_load_dwordx2 a[248:249], v5, s[8:11], s25 offen sc1
    s_add_u32 s25, s24, 26624
    buffer_load_dwordx4 a[250:253], v5, s[8:11], s25 offen sc1
    s_add_u32 s25, s24, 27648
    buffer_load_dwordx2 a[254:255], v5, s[8:11], s25 offen sc1
    s_waitcnt vmcnt(0)
    v_mfma_f32_16x16x32_bf16 v[132:135], a[192:195], v[16:19], 0
    v_mfma_f32_16x16x32_bf16 v[136:139], a[202:205], v[20:23], 0
    v_mfma_f32_16x16x32_bf16 v[112:115], a[160:163], v[16:19], 0
    v_mfma_f32_16x16x32_bf16 v[116:119], a[164:167], v[16:19], 0
    v_mfma_f32_16x16x32_bf16 v[120:123], a[172:175], v[16:19], 0
    v_mfma_f32_16x16x32_bf16 v[124:127], a[180:183], v[20:23], 0
    v_mfma_f32_16x16x32_bf16 v[128:131], a[186:189], v[20:23], 0
    v_mfma_f32_16x16x32_bf16 v[132:135], a[196:199], v[20:23], v[132:135]
    v_mfma_f32_16x16x32_bf16 v[116:119], a[168:171], v[20:23], v[116:119]
    v_mfma_f32_16x16x32_bf16 v[120:123], a[176:179], v[20:23], v[120:123]
    v_mfma_f32_16x16x16_bf16 v[136:139], a[206:207], v[24:25], v[136:139]
    s_nop 0
    v_mfma_f32_16x16x16_bf16 v[124:127], a[184:185], v[24:25], v[124:127]
    v_mfma_f32_16x16x16_bf16 v[128:131], a[190:191], v[24:25], v[128:131]
    v_mfma_f32_16x16x16_bf16 v[132:135], a[200:201], v[24:25], v[132:135]
    v_mfma_f32_16x16x32_bf16 v[160:163], a[240:243], v[26:29], 0
    v_mfma_f32_16x16x32_bf16 v[164:167], a[250:253], v[30:33], 0
    v_mfma_f32_16x16x32_bf16 v[140:143], a[208:211], v[26:29], 0
    v_mfma_f32_16x16x32_bf16 v[144:147], a[212:215], v[26:29], 0
    v_mfma_f32_16x16x32_bf16 v[148:151], a[220:223], v[26:29], 0
    v_mfma_f32_16x16x32_bf16 v[152:155], a[228:231], v[30:33], 0
    v_mfma_f32_16x16x32_bf16 v[156:159], a[234:237], v[30:33], 0
    v_mfma_f32_16x16x32_bf16 v[160:163], a[244:247], v[30:33], v[160:163]
    v_mfma_f32_16x16x32_bf16 v[144:147], a[216:219], v[30:33], v[144:147]
    v_mfma_f32_16x16x32_bf16 v[148:151], a[224:227], v[30:33], v[148:151]
    v_mfma_f32_16x16x16_bf16 v[164:167], a[254:255], v[34:35], v[164:167]
    s_nop 0
    v_mfma_f32_16x16x16_bf16 v[152:155], a[232:233], v[34:35], v[152:155]
    v_mfma_f32_16x16x16_bf16 v[156:159], a[238:239], v[34:35], v[156:159]
    v_mfma_f32_16x16x16_bf16 v[160:163], a[248:249], v[34:35], v[160:163]
    v_add_f32 v132, s54, v132
    v_add_f32 v133, s54, v133
    v_add_f32 v134, s54, v134
    v_add_f32 v135, s54, v135
    v_add_f32 v136, s54, v136
    v_rcp_f32 v132, v132
    v_rcp_f32 v133, v133
    v_rcp_f32 v134, v134
    v_rcp_f32 v135, v135
    v_rcp_f32 v136, v136
    v_mul_f32 v112, v112, v132
    v_mul_f32 v113, v113, v132
    v_mul_f32 v114, v114, v132
    v_mul_f32 v115, v115, v132
    v_cvt_pk_bf16_f32 v168, v112, v113
    v_cvt_pk_bf16_f32 v169, v114, v115
    v_mul_f32 v116, v116, v133
    v_mul_f32 v117, v117, v133
    v_mul_f32 v118, v118, v133
    v_mul_f32 v119, v119, v133
    v_cvt_pk_bf16_f32 v170, v116, v117
    v_cvt_pk_bf16_f32 v171, v118, v119
    v_mul_f32 v120, v120, v134
    v_mul_f32 v121, v121, v134
    v_mul_f32 v122, v122, v134
    v_mul_f32 v123, v123, v134
    v_cvt_pk_bf16_f32 v172, v120, v121
    v_cvt_pk_bf16_f32 v173, v122, v123
    v_mul_f32 v124, v124, v135
    v_mul_f32 v125, v125, v135
    v_mul_f32 v126, v126, v135
    v_mul_f32 v127, v127, v135
    v_cvt_pk_bf16_f32 v174, v124, v125
    v_cvt_pk_bf16_f32 v175, v126, v127
    v_mul_f32 v128, v128, v136
    v_mul_f32 v129, v129, v136
    v_mul_f32 v130, v130, v136
    v_mul_f32 v131, v131, v136
    v_cvt_pk_bf16_f32 v176, v128, v129
    v_cvt_pk_bf16_f32 v177, v130, v131
    v_add_f32 v160, s54, v160
    v_add_f32 v161, s54, v161
    v_add_f32 v162, s54, v162
    v_add_f32 v163, s54, v163
    v_add_f32 v164, s54, v164
    v_rcp_f32 v160, v160
    v_rcp_f32 v161, v161
    v_rcp_f32 v162, v162
    v_rcp_f32 v163, v163
    v_rcp_f32 v164, v164
    v_mul_f32 v140, v140, v160
    v_mul_f32 v141, v141, v160
    v_mul_f32 v142, v142, v160
    v_mul_f32 v143, v143, v160
    v_cvt_pk_bf16_f32 v178, v140, v141
    v_cvt_pk_bf16_f32 v179, v142, v143
    v_mul_f32 v144, v144, v161
    v_mul_f32 v145, v145, v161
    v_mul_f32 v146, v146, v161
    v_mul_f32 v147, v147, v161
    v_cvt_pk_bf16_f32 v180, v144, v145
    v_cvt_pk_bf16_f32 v181, v146, v147
    v_mul_f32 v148, v148, v162
    v_mul_f32 v149, v149, v162
    v_mul_f32 v150, v150, v162
    v_mul_f32 v151, v151, v162
    v_cvt_pk_bf16_f32 v182, v148, v149
    v_cvt_pk_bf16_f32 v183, v150, v151
    v_mul_f32 v152, v152, v163
    v_mul_f32 v153, v153, v163
    v_mul_f32 v154, v154, v163
    v_mul_f32 v155, v155, v163
    v_cvt_pk_bf16_f32 v184, v152, v153
    v_cvt_pk_bf16_f32 v185, v154, v155
    v_mul_f32 v156, v156, v164
    v_mul_f32 v157, v157, v164
    v_mul_f32 v158, v158, v164
    v_mul_f32 v159, v159, v164
    v_cvt_pk_bf16_f32 v186, v156, v157
    v_cvt_pk_bf16_f32 v187, v158, v159
    v_mfma_f32_16x16x32_bf16 v[132:135], a[192:195], v[36:39], 0
    v_mfma_f32_16x16x32_bf16 v[136:139], a[202:205], v[40:43], 0
    v_mfma_f32_16x16x32_bf16 v[112:115], a[160:163], v[36:39], 0
    v_mfma_f32_16x16x32_bf16 v[116:119], a[164:167], v[36:39], 0
    v_mfma_f32_16x16x32_bf16 v[120:123], a[172:175], v[36:39], 0
    v_mfma_f32_16x16x32_bf16 v[124:127], a[180:183], v[40:43], 0
    v_mfma_f32_16x16x32_bf16 v[128:131], a[186:189], v[40:43], 0
    v_mfma_f32_16x16x32_bf16 v[132:135], a[196:199], v[40:43], v[132:135]
    v_mfma_f32_16x16x32_bf16 v[116:119], a[168:171], v[40:43], v[116:119]
    v_mfma_f32_16x16x32_bf16 v[120:123], a[176:179], v[40:43], v[120:123]
    v_mfma_f32_16x16x16_bf16 v[136:139], a[206:207], v[44:45], v[136:139]
    s_nop 0
    v_mfma_f32_16x16x16_bf16 v[124:127], a[184:185], v[44:45], v[124:127]
    v_mfma_f32_16x16x16_bf16 v[128:131], a[190:191], v[44:45], v[128:131]
    v_mfma_f32_16x16x16_bf16 v[132:135], a[200:201], v[44:45], v[132:135]
    v_mfma_f32_16x16x32_bf16 v[160:163], a[240:243], v[46:49], 0
    v_mfma_f32_16x16x32_bf16 v[164:167], a[250:253], v[50:53], 0
    v_mfma_f32_16x16x32_bf16 v[140:143], a[208:211], v[46:49], 0
    v_mfma_f32_16x16x32_bf16 v[144:147], a[212:215], v[46:49], 0
    v_mfma_f32_16x16x32_bf16 v[148:151], a[220:223], v[46:49], 0
    v_mfma_f32_16x16x32_bf16 v[152:155], a[228:231], v[50:53], 0
    v_mfma_f32_16x16x32_bf16 v[156:159], a[234:237], v[50:53], 0
    v_mfma_f32_16x16x32_bf16 v[160:163], a[244:247], v[50:53], v[160:163]
    v_mfma_f32_16x16x32_bf16 v[144:147], a[216:219], v[50:53], v[144:147]
    v_mfma_f32_16x16x32_bf16 v[148:151], a[224:227], v[50:53], v[148:151]
    v_mfma_f32_16x16x16_bf16 v[164:167], a[254:255], v[54:55], v[164:167]
    s_nop 0
    v_mfma_f32_16x16x16_bf16 v[152:155], a[232:233], v[54:55], v[152:155]
    v_mfma_f32_16x16x16_bf16 v[156:159], a[238:239], v[54:55], v[156:159]
    v_mfma_f32_16x16x16_bf16 v[160:163], a[248:249], v[54:55], v[160:163]
    v_add_f32 v132, s54, v132
    v_add_f32 v133, s54, v133
    v_add_f32 v134, s54, v134
    v_add_f32 v135, s54, v135
    v_add_f32 v136, s54, v136
    v_rcp_f32 v132, v132
    v_rcp_f32 v133, v133
    v_rcp_f32 v134, v134
    v_rcp_f32 v135, v135
    v_rcp_f32 v136, v136
    v_mul_f32 v112, v112, v132
    v_mul_f32 v113, v113, v132
    v_mul_f32 v114, v114, v132
    v_mul_f32 v115, v115, v132
    v_cvt_pk_bf16_f32 v188, v112, v113
    v_cvt_pk_bf16_f32 v189, v114, v115
    v_mul_f32 v116, v116, v133
    v_mul_f32 v117, v117, v133
    v_mul_f32 v118, v118, v133
    v_mul_f32 v119, v119, v133
    v_cvt_pk_bf16_f32 v190, v116, v117
    v_cvt_pk_bf16_f32 v191, v118, v119
    v_mul_f32 v120, v120, v134
    v_mul_f32 v121, v121, v134
    v_mul_f32 v122, v122, v134
    v_mul_f32 v123, v123, v134
    v_cvt_pk_bf16_f32 v192, v120, v121
    v_cvt_pk_bf16_f32 v193, v122, v123
    v_mul_f32 v124, v124, v135
    v_mul_f32 v125, v125, v135
    v_mul_f32 v126, v126, v135
    v_mul_f32 v127, v127, v135
    v_cvt_pk_bf16_f32 v194, v124, v125
    v_cvt_pk_bf16_f32 v195, v126, v127
    v_mul_f32 v128, v128, v136
    v_mul_f32 v129, v129, v136
    v_mul_f32 v130, v130, v136
    v_mul_f32 v131, v131, v136
    v_cvt_pk_bf16_f32 v196, v128, v129
    v_cvt_pk_bf16_f32 v197, v130, v131
    v_add_f32 v160, s54, v160
    v_add_f32 v161, s54, v161
    v_add_f32 v162, s54, v162
    v_add_f32 v163, s54, v163
    v_add_f32 v164, s54, v164
    v_rcp_f32 v160, v160
    v_rcp_f32 v161, v161
    v_rcp_f32 v162, v162
    v_rcp_f32 v163, v163
    v_rcp_f32 v164, v164
    v_mul_f32 v140, v140, v160
    v_mul_f32 v141, v141, v160
    v_mul_f32 v142, v142, v160
    v_mul_f32 v143, v143, v160
    v_cvt_pk_bf16_f32 v198, v140, v141
    v_cvt_pk_bf16_f32 v199, v142, v143
    v_mul_f32 v144, v144, v161
    v_mul_f32 v145, v145, v161
    v_mul_f32 v146, v146, v161
    v_mul_f32 v147, v147, v161
    v_cvt_pk_bf16_f32 v200, v144, v145
    v_cvt_pk_bf16_f32 v201, v146, v147
    v_mul_f32 v148, v148, v162
    v_mul_f32 v149, v149, v162
    v_mul_f32 v150, v150, v162
    v_mul_f32 v151, v151, v162
    v_cvt_pk_bf16_f32 v202, v148, v149
    v_cvt_pk_bf16_f32 v203, v150, v151
    v_mul_f32 v152, v152, v163
    v_mul_f32 v153, v153, v163
    v_mul_f32 v154, v154, v163
    v_mul_f32 v155, v155, v163
    v_cvt_pk_bf16_f32 v204, v152, v153
    v_cvt_pk_bf16_f32 v205, v154, v155
    v_mul_f32 v156, v156, v164
    v_mul_f32 v157, v157, v164
    v_mul_f32 v158, v158, v164
    v_mul_f32 v159, v159, v164
    v_cvt_pk_bf16_f32 v206, v156, v157
    v_cvt_pk_bf16_f32 v207, v158, v159
    v_add_u32 v14, s42, v13
    ds_write_b128 v14, v[168:171] offset:0
    ds_write_b128 v14, v[172:175] offset:1024
    ds_write_b128 v14, v[176:179] offset:2048
    ds_write_b128 v14, v[180:183] offset:3072
    ds_write_b128 v14, v[184:187] offset:4096
    ds_write_b128 v14, v[188:191] offset:20480
    ds_write_b128 v14, v[192:195] offset:21504
    ds_write_b128 v14, v[196:199] offset:22528
    ds_write_b128 v14, v[200:203] offset:23552
    ds_write_b128 v14, v[204:207] offset:24576
    s_waitcnt lgkmcnt(0)
    s_barrier
interleave_layers__linear_attn_block__memory_aug_recurrent_mem_tr__prompt_kernel_k3_seg:
    v_add_u32 v15, s42, v5
    ds_read_b128 v[208:211], v15 offset:0
    ds_read_b128 v[212:215], v15 offset:20480
    ds_read_b128 v[216:219], v15 offset:1024
    ds_read_b128 v[220:223], v15 offset:21504
    ds_read_b128 v[224:227], v15 offset:2048
    ds_read_b128 v[228:231], v15 offset:22528
    ds_read_b128 v[232:235], v15 offset:3072
    ds_read_b128 v[236:239], v15 offset:23552
    s_waitcnt lgkmcnt(6)
    v_mfma_f32_16x16x32_bf16 v[240:243], a[0:3], v[208:211], 0
    v_mfma_f32_16x16x32_bf16 v[244:247], a[4:7], v[208:211], 0
    v_mfma_f32_16x16x32_bf16 v[248:251], a[0:3], v[212:215], 0
    v_mfma_f32_16x16x32_bf16 v[252:255], a[4:7], v[212:215], 0
    ds_read_b128 v[208:211], v15 offset:4096
    ds_read_b128 v[212:215], v15 offset:24576
    s_waitcnt lgkmcnt(6)
    v_mfma_f32_16x16x32_bf16 v[240:243], a[8:11], v[216:219], v[240:243]
    v_mfma_f32_16x16x32_bf16 v[244:247], a[12:15], v[216:219], v[244:247]
    v_mfma_f32_16x16x32_bf16 v[248:251], a[8:11], v[220:223], v[248:251]
    v_mfma_f32_16x16x32_bf16 v[252:255], a[12:15], v[220:223], v[252:255]
    ds_read_b128 v[216:219], v15 offset:5120
    ds_read_b128 v[220:223], v15 offset:25600
    s_waitcnt lgkmcnt(6)
    v_mfma_f32_16x16x32_bf16 v[240:243], a[16:19], v[224:227], v[240:243]
    v_mfma_f32_16x16x32_bf16 v[244:247], a[20:23], v[224:227], v[244:247]
    v_mfma_f32_16x16x32_bf16 v[248:251], a[16:19], v[228:231], v[248:251]
    v_mfma_f32_16x16x32_bf16 v[252:255], a[20:23], v[228:231], v[252:255]
    ds_read_b128 v[224:227], v15 offset:6144
    ds_read_b128 v[228:231], v15 offset:26624
    s_waitcnt lgkmcnt(6)
    v_mfma_f32_16x16x32_bf16 v[240:243], a[24:27], v[232:235], v[240:243]
    v_mfma_f32_16x16x32_bf16 v[244:247], a[28:31], v[232:235], v[244:247]
    v_mfma_f32_16x16x32_bf16 v[248:251], a[24:27], v[236:239], v[248:251]
    v_mfma_f32_16x16x32_bf16 v[252:255], a[28:31], v[236:239], v[252:255]
    ds_read_b128 v[232:235], v15 offset:7168
    ds_read_b128 v[236:239], v15 offset:27648
    s_waitcnt lgkmcnt(6)
    v_mfma_f32_16x16x32_bf16 v[240:243], a[32:35], v[208:211], v[240:243]
    v_mfma_f32_16x16x32_bf16 v[244:247], a[36:39], v[208:211], v[244:247]
    v_mfma_f32_16x16x32_bf16 v[248:251], a[32:35], v[212:215], v[248:251]
    v_mfma_f32_16x16x32_bf16 v[252:255], a[36:39], v[212:215], v[252:255]
    ds_read_b128 v[208:211], v15 offset:8192
    ds_read_b128 v[212:215], v15 offset:28672
    s_waitcnt lgkmcnt(6)
    v_mfma_f32_16x16x32_bf16 v[240:243], a[40:43], v[216:219], v[240:243]
    v_mfma_f32_16x16x32_bf16 v[244:247], a[44:47], v[216:219], v[244:247]
    v_mfma_f32_16x16x32_bf16 v[248:251], a[40:43], v[220:223], v[248:251]
    v_mfma_f32_16x16x32_bf16 v[252:255], a[44:47], v[220:223], v[252:255]
    ds_read_b128 v[216:219], v15 offset:9216
    ds_read_b128 v[220:223], v15 offset:29696
    s_waitcnt lgkmcnt(6)
    v_mfma_f32_16x16x32_bf16 v[240:243], a[48:51], v[224:227], v[240:243]
    v_mfma_f32_16x16x32_bf16 v[244:247], a[52:55], v[224:227], v[244:247]
    v_mfma_f32_16x16x32_bf16 v[248:251], a[48:51], v[228:231], v[248:251]
    v_mfma_f32_16x16x32_bf16 v[252:255], a[52:55], v[228:231], v[252:255]
    ds_read_b128 v[224:227], v15 offset:10240
    ds_read_b128 v[228:231], v15 offset:30720
    s_waitcnt lgkmcnt(6)
    v_mfma_f32_16x16x32_bf16 v[240:243], a[56:59], v[232:235], v[240:243]
    v_mfma_f32_16x16x32_bf16 v[244:247], a[60:63], v[232:235], v[244:247]
    v_mfma_f32_16x16x32_bf16 v[248:251], a[56:59], v[236:239], v[248:251]
    v_mfma_f32_16x16x32_bf16 v[252:255], a[60:63], v[236:239], v[252:255]
    ds_read_b128 v[232:235], v15 offset:11264
    ds_read_b128 v[236:239], v15 offset:31744
    s_waitcnt lgkmcnt(6)
    v_mfma_f32_16x16x32_bf16 v[240:243], a[64:67], v[208:211], v[240:243]
    v_mfma_f32_16x16x32_bf16 v[244:247], a[68:71], v[208:211], v[244:247]
    v_mfma_f32_16x16x32_bf16 v[248:251], a[64:67], v[212:215], v[248:251]
    v_mfma_f32_16x16x32_bf16 v[252:255], a[68:71], v[212:215], v[252:255]
    ds_read_b128 v[208:211], v15 offset:12288
    ds_read_b128 v[212:215], v15 offset:32768
    s_waitcnt lgkmcnt(6)
    v_mfma_f32_16x16x32_bf16 v[240:243], a[72:75], v[216:219], v[240:243]
    v_mfma_f32_16x16x32_bf16 v[244:247], a[76:79], v[216:219], v[244:247]
    v_mfma_f32_16x16x32_bf16 v[248:251], a[72:75], v[220:223], v[248:251]
    v_mfma_f32_16x16x32_bf16 v[252:255], a[76:79], v[220:223], v[252:255]
    ds_read_b128 v[216:219], v15 offset:13312
    ds_read_b128 v[220:223], v15 offset:33792
    s_waitcnt lgkmcnt(6)
    v_mfma_f32_16x16x32_bf16 v[240:243], a[80:83], v[224:227], v[240:243]
    v_mfma_f32_16x16x32_bf16 v[244:247], a[84:87], v[224:227], v[244:247]
    v_mfma_f32_16x16x32_bf16 v[248:251], a[80:83], v[228:231], v[248:251]
    v_mfma_f32_16x16x32_bf16 v[252:255], a[84:87], v[228:231], v[252:255]
    ds_read_b128 v[224:227], v15 offset:14336
    ds_read_b128 v[228:231], v15 offset:34816
    s_waitcnt lgkmcnt(6)
    v_mfma_f32_16x16x32_bf16 v[240:243], a[88:91], v[232:235], v[240:243]
    v_mfma_f32_16x16x32_bf16 v[244:247], a[92:95], v[232:235], v[244:247]
    v_mfma_f32_16x16x32_bf16 v[248:251], a[88:91], v[236:239], v[248:251]
    v_mfma_f32_16x16x32_bf16 v[252:255], a[92:95], v[236:239], v[252:255]
    ds_read_b128 v[232:235], v15 offset:15360
    ds_read_b128 v[236:239], v15 offset:35840
    s_waitcnt lgkmcnt(6)
    v_mfma_f32_16x16x32_bf16 v[240:243], a[96:99], v[208:211], v[240:243]
    v_mfma_f32_16x16x32_bf16 v[244:247], a[100:103], v[208:211], v[244:247]
    v_mfma_f32_16x16x32_bf16 v[248:251], a[96:99], v[212:215], v[248:251]
    v_mfma_f32_16x16x32_bf16 v[252:255], a[100:103], v[212:215], v[252:255]
    ds_read_b128 v[208:211], v15 offset:16384
    ds_read_b128 v[212:215], v15 offset:36864
    s_waitcnt lgkmcnt(6)
    v_mfma_f32_16x16x32_bf16 v[240:243], a[104:107], v[216:219], v[240:243]
    v_mfma_f32_16x16x32_bf16 v[244:247], a[108:111], v[216:219], v[244:247]
    v_mfma_f32_16x16x32_bf16 v[248:251], a[104:107], v[220:223], v[248:251]
    v_mfma_f32_16x16x32_bf16 v[252:255], a[108:111], v[220:223], v[252:255]
    ds_read_b128 v[216:219], v15 offset:17408
    ds_read_b128 v[220:223], v15 offset:37888
    s_waitcnt lgkmcnt(6)
    v_mfma_f32_16x16x32_bf16 v[240:243], a[112:115], v[224:227], v[240:243]
    v_mfma_f32_16x16x32_bf16 v[244:247], a[116:119], v[224:227], v[244:247]
    v_mfma_f32_16x16x32_bf16 v[248:251], a[112:115], v[228:231], v[248:251]
    v_mfma_f32_16x16x32_bf16 v[252:255], a[116:119], v[228:231], v[252:255]
    ds_read_b128 v[224:227], v15 offset:18432
    ds_read_b128 v[228:231], v15 offset:38912
    s_waitcnt lgkmcnt(6)
    v_mfma_f32_16x16x32_bf16 v[240:243], a[120:123], v[232:235], v[240:243]
    v_mfma_f32_16x16x32_bf16 v[244:247], a[124:127], v[232:235], v[244:247]
    v_mfma_f32_16x16x32_bf16 v[248:251], a[120:123], v[236:239], v[248:251]
    v_mfma_f32_16x16x32_bf16 v[252:255], a[124:127], v[236:239], v[252:255]
    ds_read_b128 v[232:235], v15 offset:19456
    ds_read_b128 v[236:239], v15 offset:39936
    s_waitcnt lgkmcnt(6)
    v_mfma_f32_16x16x32_bf16 v[240:243], a[128:131], v[208:211], v[240:243]
    v_mfma_f32_16x16x32_bf16 v[244:247], a[132:135], v[208:211], v[244:247]
    v_mfma_f32_16x16x32_bf16 v[248:251], a[128:131], v[212:215], v[248:251]
    v_mfma_f32_16x16x32_bf16 v[252:255], a[132:135], v[212:215], v[252:255]
    s_waitcnt lgkmcnt(4)
    v_mfma_f32_16x16x32_bf16 v[240:243], a[136:139], v[216:219], v[240:243]
    v_mfma_f32_16x16x32_bf16 v[244:247], a[140:143], v[216:219], v[244:247]
    v_mfma_f32_16x16x32_bf16 v[248:251], a[136:139], v[220:223], v[248:251]
    v_mfma_f32_16x16x32_bf16 v[252:255], a[140:143], v[220:223], v[252:255]
    s_waitcnt lgkmcnt(2)
    v_mfma_f32_16x16x32_bf16 v[240:243], a[144:147], v[224:227], v[240:243]
    v_mfma_f32_16x16x32_bf16 v[244:247], a[148:151], v[224:227], v[244:247]
    v_mfma_f32_16x16x32_bf16 v[248:251], a[144:147], v[228:231], v[248:251]
    v_mfma_f32_16x16x32_bf16 v[252:255], a[148:151], v[228:231], v[252:255]
    s_waitcnt lgkmcnt(0)
    v_mfma_f32_16x16x32_bf16 v[240:243], a[152:155], v[232:235], v[240:243]
    v_mfma_f32_16x16x32_bf16 v[244:247], a[156:159], v[232:235], v[244:247]
    v_mfma_f32_16x16x32_bf16 v[248:251], a[152:155], v[236:239], v[248:251]
    v_mfma_f32_16x16x32_bf16 v[252:255], a[156:159], v[236:239], v[252:255]
    s_nop 4
    v_cvt_pk_bf16_f32 v208, v240, v241
    v_cvt_pk_bf16_f32 v209, v242, v243
    v_lshlrev_b32 v210, 16, v208
    v_and_b32 v211, 0xffff0000, v208
    v_lshlrev_b32 v212, 16, v96
    v_and_b32 v213, 0xffff0000, v96
    v_pk_add_f32 v[210:211], v[210:211], v[212:213]
    v_cvt_pk_bf16_f32 v216, v210, v211
    v_lshlrev_b32 v210, 16, v209
    v_and_b32 v211, 0xffff0000, v209
    v_lshlrev_b32 v212, 16, v97
    v_and_b32 v213, 0xffff0000, v97
    v_pk_add_f32 v[210:211], v[210:211], v[212:213]
    v_cvt_pk_bf16_f32 v217, v210, v211
    v_cvt_pk_bf16_f32 v208, v244, v245
    v_cvt_pk_bf16_f32 v209, v246, v247
    v_lshlrev_b32 v210, 16, v208
    v_and_b32 v211, 0xffff0000, v208
    v_lshlrev_b32 v212, 16, v98
    v_and_b32 v213, 0xffff0000, v98
    v_pk_add_f32 v[210:211], v[210:211], v[212:213]
    v_cvt_pk_bf16_f32 v218, v210, v211
    v_lshlrev_b32 v210, 16, v209
    v_and_b32 v211, 0xffff0000, v209
    v_lshlrev_b32 v212, 16, v99
    v_and_b32 v213, 0xffff0000, v99
    v_pk_add_f32 v[210:211], v[210:211], v[212:213]
    v_cvt_pk_bf16_f32 v219, v210, v211
    v_cvt_pk_bf16_f32 v208, v248, v249
    v_cvt_pk_bf16_f32 v209, v250, v251
    v_lshlrev_b32 v210, 16, v208
    v_and_b32 v211, 0xffff0000, v208
    v_lshlrev_b32 v212, 16, v100
    v_and_b32 v213, 0xffff0000, v100
    v_pk_add_f32 v[210:211], v[210:211], v[212:213]
    v_cvt_pk_bf16_f32 v220, v210, v211
    v_lshlrev_b32 v210, 16, v209
    v_and_b32 v211, 0xffff0000, v209
    v_lshlrev_b32 v212, 16, v101
    v_and_b32 v213, 0xffff0000, v101
    v_pk_add_f32 v[210:211], v[210:211], v[212:213]
    v_cvt_pk_bf16_f32 v221, v210, v211
    v_cvt_pk_bf16_f32 v208, v252, v253
    v_cvt_pk_bf16_f32 v209, v254, v255
    v_lshlrev_b32 v210, 16, v208
    v_and_b32 v211, 0xffff0000, v208
    v_lshlrev_b32 v212, 16, v102
    v_and_b32 v213, 0xffff0000, v102
    v_pk_add_f32 v[210:211], v[210:211], v[212:213]
    v_cvt_pk_bf16_f32 v222, v210, v211
    v_lshlrev_b32 v210, 16, v209
    v_and_b32 v211, 0xffff0000, v209
    v_lshlrev_b32 v212, 16, v103
    v_and_b32 v213, 0xffff0000, v103
    v_pk_add_f32 v[210:211], v[210:211], v[212:213]
    v_cvt_pk_bf16_f32 v223, v210, v211
    s_add_u32 s25, s43, 20480
    buffer_store_dwordx4 v[216:219], v12, s[8:11], s43 offen sc1
    buffer_store_dwordx4 v[220:223], v12, s[8:11], s25 offen sc1
    s_add_u32 s40, s40, 1
    s_add_u32 s43, s43, s77
    s_cmp_ge_u32 s40, s76
    s_cbranch_scc1 interleave_layers__linear_attn_block__memory_aug_recurrent_mem_tr__prompt_kernel_k3_done
    s_cmp_eq_u32 s40, 1
    s_cbranch_scc0 interleave_layers__linear_attn_block__memory_aug_recurrent_mem_tr__prompt_kernel_k3q9
    s_waitcnt vmcnt(0)
    s_barrier
    s_lshl_b32 s24, s92, 10
    s_lshl_b32 s25, s78, 2
    s_add_u32 s24, s24, s25
    s_add_u32 s24, s24, 23105536
    s_cmp_eq_u32 s3, 0
    s_cbranch_scc0 interleave_layers__linear_attn_block__memory_aug_recurrent_mem_tr__prompt_kernel_pb10
    v_lshlrev_b32 v14, 7, v1
    v_add_u32 v14, s24, v14
    v_mov_b32 v15, 2146435072
    v_cmp_le_u32 vcc, 8, v1
    s_nop 1
    v_cndmask_b32 v14, v14, v15, vcc
    v_mov_b32 v15, s40
    buffer_store_dword v15, v14, s[8:11], 0 offen sc1
interleave_layers__linear_attn_block__memory_aug_recurrent_mem_tr__prompt_kernel_pb10:
interleave_layers__linear_attn_block__memory_aug_recurrent_mem_tr__prompt_kernel_k3q9:
    s_xor_b32 s42, s42, 40960
    s_waitcnt vmcnt(2)
    v_mfma_f32_16x16x32_bf16 v[132:135], a[192:195], v[56:59], 0
    v_mfma_f32_16x16x32_bf16 v[136:139], a[202:205], v[60:63], 0
    v_mfma_f32_16x16x32_bf16 v[112:115], a[160:163], v[56:59], 0
    v_mfma_f32_16x16x32_bf16 v[116:119], a[164:167], v[56:59], 0
    v_mfma_f32_16x16x32_bf16 v[120:123], a[172:175], v[56:59], 0
    v_mfma_f32_16x16x32_bf16 v[124:127], a[180:183], v[60:63], 0
    v_mfma_f32_16x16x32_bf16 v[128:131], a[186:189], v[60:63], 0
    v_mfma_f32_16x16x32_bf16 v[132:135], a[196:199], v[60:63], v[132:135]
    v_mfma_f32_16x16x32_bf16 v[116:119], a[168:171], v[60:63], v[116:119]
    v_mfma_f32_16x16x32_bf16 v[120:123], a[176:179], v[60:63], v[120:123]
    v_mfma_f32_16x16x16_bf16 v[136:139], a[206:207], v[64:65], v[136:139]
    s_nop 0
    v_mfma_f32_16x16x16_bf16 v[124:127], a[184:185], v[64:65], v[124:127]
    v_mfma_f32_16x16x16_bf16 v[128:131], a[190:191], v[64:65], v[128:131]
    v_mfma_f32_16x16x16_bf16 v[132:135], a[200:201], v[64:65], v[132:135]
    v_mfma_f32_16x16x32_bf16 v[160:163], a[240:243], v[66:69], 0
    v_mfma_f32_16x16x32_bf16 v[164:167], a[250:253], v[70:73], 0
    v_mfma_f32_16x16x32_bf16 v[140:143], a[208:211], v[66:69], 0
    v_mfma_f32_16x16x32_bf16 v[144:147], a[212:215], v[66:69], 0
    v_mfma_f32_16x16x32_bf16 v[148:151], a[220:223], v[66:69], 0
    v_mfma_f32_16x16x32_bf16 v[152:155], a[228:231], v[70:73], 0
    v_mfma_f32_16x16x32_bf16 v[156:159], a[234:237], v[70:73], 0
    v_mfma_f32_16x16x32_bf16 v[160:163], a[244:247], v[70:73], v[160:163]
    v_mfma_f32_16x16x32_bf16 v[144:147], a[216:219], v[70:73], v[144:147]
    v_mfma_f32_16x16x32_bf16 v[148:151], a[224:227], v[70:73], v[148:151]
    v_mfma_f32_16x16x16_bf16 v[164:167], a[254:255], v[74:75], v[164:167]
    s_nop 0
    v_mfma_f32_16x16x16_bf16 v[152:155], a[232:233], v[74:75], v[152:155]
    v_mfma_f32_16x16x16_bf16 v[156:159], a[238:239], v[74:75], v[156:159]
    v_mfma_f32_16x16x16_bf16 v[160:163], a[248:249], v[74:75], v[160:163]
    v_add_f32 v132, s54, v132
    v_add_f32 v133, s54, v133
    v_add_f32 v134, s54, v134
    v_add_f32 v135, s54, v135
    v_add_f32 v136, s54, v136
    v_rcp_f32 v132, v132
    v_rcp_f32 v133, v133
    v_rcp_f32 v134, v134
    v_rcp_f32 v135, v135
    v_rcp_f32 v136, v136
    v_mul_f32 v112, v112, v132
    v_mul_f32 v113, v113, v132
    v_mul_f32 v114, v114, v132
    v_mul_f32 v115, v115, v132
    v_cvt_pk_bf16_f32 v168, v112, v113
    v_cvt_pk_bf16_f32 v169, v114, v115
    v_mul_f32 v116, v116, v133
    v_mul_f32 v117, v117, v133
    v_mul_f32 v118, v118, v133
    v_mul_f32 v119, v119, v133
    v_cvt_pk_bf16_f32 v170, v116, v117
    v_cvt_pk_bf16_f32 v171, v118, v119
    v_mul_f32 v120, v120, v134
    v_mul_f32 v121, v121, v134
    v_mul_f32 v122, v122, v134
    v_mul_f32 v123, v123, v134
    v_cvt_pk_bf16_f32 v172, v120, v121
    v_cvt_pk_bf16_f32 v173, v122, v123
    v_mul_f32 v124, v124, v135
    v_mul_f32 v125, v125, v135
    v_mul_f32 v126, v126, v135
    v_mul_f32 v127, v127, v135
    v_cvt_pk_bf16_f32 v174, v124, v125
    v_cvt_pk_bf16_f32 v175, v126, v127
    v_mul_f32 v128, v128, v136
    v_mul_f32 v129, v129, v136
    v_mul_f32 v130, v130, v136
    v_mul_f32 v131, v131, v136
    v_cvt_pk_bf16_f32 v176, v128, v129
    v_cvt_pk_bf16_f32 v177, v130, v131
    v_add_f32 v160, s54, v160
    v_add_f32 v161, s54, v161
    v_add_f32 v162, s54, v162
    v_add_f32 v163, s54, v163
    v_add_f32 v164, s54, v164
    v_rcp_f32 v160, v160
    v_rcp_f32 v161, v161
    v_rcp_f32 v162, v162
    v_rcp_f32 v163, v163
    v_rcp_f32 v164, v164
    v_mul_f32 v140, v140, v160
    v_mul_f32 v141, v141, v160
    v_mul_f32 v142, v142, v160
    v_mul_f32 v143, v143, v160
    v_cvt_pk_bf16_f32 v178, v140, v141
    v_cvt_pk_bf16_f32 v179, v142, v143
    v_mul_f32 v144, v144, v161
    v_mul_f32 v145, v145, v161
    v_mul_f32 v146, v146, v161
    v_mul_f32 v147, v147, v161
    v_cvt_pk_bf16_f32 v180, v144, v145
    v_cvt_pk_bf16_f32 v181, v146, v147
    v_mul_f32 v148, v148, v162
    v_mul_f32 v149, v149, v162
    v_mul_f32 v150, v150, v162
    v_mul_f32 v151, v151, v162
    v_cvt_pk_bf16_f32 v182, v148, v149
    v_cvt_pk_bf16_f32 v183, v150, v151
    v_mul_f32 v152, v152, v163
    v_mul_f32 v153, v153, v163
    v_mul_f32 v154, v154, v163
    v_mul_f32 v155, v155, v163
    v_cvt_pk_bf16_f32 v184, v152, v153
    v_cvt_pk_bf16_f32 v185, v154, v155
    v_mul_f32 v156, v156, v164
    v_mul_f32 v157, v157, v164
    v_mul_f32 v158, v158, v164
    v_mul_f32 v159, v159, v164
    v_cvt_pk_bf16_f32 v186, v156, v157
    v_cvt_pk_bf16_f32 v187, v158, v159
    v_mfma_f32_16x16x32_bf16 v[132:135], a[192:195], v[76:79], 0
    v_mfma_f32_16x16x32_bf16 v[136:139], a[202:205], v[80:83], 0
    v_mfma_f32_16x16x32_bf16 v[112:115], a[160:163], v[76:79], 0
    v_mfma_f32_16x16x32_bf16 v[116:119], a[164:167], v[76:79], 0
    v_mfma_f32_16x16x32_bf16 v[120:123], a[172:175], v[76:79], 0
    v_mfma_f32_16x16x32_bf16 v[124:127], a[180:183], v[80:83], 0
    v_mfma_f32_16x16x32_bf16 v[128:131], a[186:189], v[80:83], 0
    v_mfma_f32_16x16x32_bf16 v[132:135], a[196:199], v[80:83], v[132:135]
    v_mfma_f32_16x16x32_bf16 v[116:119], a[168:171], v[80:83], v[116:119]
    v_mfma_f32_16x16x32_bf16 v[120:123], a[176:179], v[80:83], v[120:123]
    v_mfma_f32_16x16x16_bf16 v[136:139], a[206:207], v[84:85], v[136:139]
    s_nop 0
    v_mfma_f32_16x16x16_bf16 v[124:127], a[184:185], v[84:85], v[124:127]
    v_mfma_f32_16x16x16_bf16 v[128:131], a[190:191], v[84:85], v[128:131]
    v_mfma_f32_16x16x16_bf16 v[132:135], a[200:201], v[84:85], v[132:135]
    v_mfma_f32_16x16x32_bf16 v[160:163], a[240:243], v[86:89], 0
    v_mfma_f32_16x16x32_bf16 v[164:167], a[250:253], v[90:93], 0
    v_mfma_f32_16x16x32_bf16 v[140:143], a[208:211], v[86:89], 0
    v_mfma_f32_16x16x32_bf16 v[144:147], a[212:215], v[86:89], 0
    v_mfma_f32_16x16x32_bf16 v[148:151], a[220:223], v[86:89], 0
    v_mfma_f32_16x16x32_bf16 v[152:155], a[228:231], v[90:93], 0
    v_mfma_f32_16x16x32_bf16 v[156:159], a[234:237], v[90:93], 0
    v_mfma_f32_16x16x32_bf16 v[160:163], a[244:247], v[90:93], v[160:163]
    v_mfma_f32_16x16x32_bf16 v[144:147], a[216:219], v[90:93], v[144:147]
    v_mfma_f32_16x16x32_bf16 v[148:151], a[224:227], v[90:93], v[148:151]
    v_mfma_f32_16x16x16_bf16 v[164:167], a[254:255], v[94:95], v[164:167]
    s_nop 0
    v_mfma_f32_16x16x16_bf16 v[152:155], a[232:233], v[94:95], v[152:155]
    v_mfma_f32_16x16x16_bf16 v[156:159], a[238:239], v[94:95], v[156:159]
    v_mfma_f32_16x16x16_bf16 v[160:163], a[248:249], v[94:95], v[160:163]
    v_add_f32 v132, s54, v132
    v_add_f32 v133, s54, v133
    v_add_f32 v134, s54, v134
    v_add_f32 v135, s54, v135
    v_add_f32 v136, s54, v136
    v_rcp_f32 v132, v132
    v_rcp_f32 v133, v133
    v_rcp_f32 v134, v134
    v_rcp_f32 v135, v135
    v_rcp_f32 v136, v136
    v_mul_f32 v112, v112, v132
    v_mul_f32 v113, v113, v132
    v_mul_f32 v114, v114, v132
    v_mul_f32 v115, v115, v132
    v_cvt_pk_bf16_f32 v188, v112, v113
    v_cvt_pk_bf16_f32 v189, v114, v115
    v_mul_f32 v116, v116, v133
    v_mul_f32 v117, v117, v133
    v_mul_f32 v118, v118, v133
    v_mul_f32 v119, v119, v133
    v_cvt_pk_bf16_f32 v190, v116, v117
    v_cvt_pk_bf16_f32 v191, v118, v119
    v_mul_f32 v120, v120, v134
    v_mul_f32 v121, v121, v134
    v_mul_f32 v122, v122, v134
    v_mul_f32 v123, v123, v134
    v_cvt_pk_bf16_f32 v192, v120, v121
    v_cvt_pk_bf16_f32 v193, v122, v123
    v_mul_f32 v124, v124, v135
    v_mul_f32 v125, v125, v135
    v_mul_f32 v126, v126, v135
    v_mul_f32 v127, v127, v135
    v_cvt_pk_bf16_f32 v194, v124, v125
    v_cvt_pk_bf16_f32 v195, v126, v127
    v_mul_f32 v128, v128, v136
    v_mul_f32 v129, v129, v136
    v_mul_f32 v130, v130, v136
    v_mul_f32 v131, v131, v136
    v_cvt_pk_bf16_f32 v196, v128, v129
    v_cvt_pk_bf16_f32 v197, v130, v131
    v_add_f32 v160, s54, v160
    v_add_f32 v161, s54, v161
    v_add_f32 v162, s54, v162
    v_add_f32 v163, s54, v163
    v_add_f32 v164, s54, v164
    v_rcp_f32 v160, v160
    v_rcp_f32 v161, v161
    v_rcp_f32 v162, v162
    v_rcp_f32 v163, v163
    v_rcp_f32 v164, v164
    v_mul_f32 v140, v140, v160
    v_mul_f32 v141, v141, v160
    v_mul_f32 v142, v142, v160
    v_mul_f32 v143, v143, v160
    v_cvt_pk_bf16_f32 v198, v140, v141
    v_cvt_pk_bf16_f32 v199, v142, v143
    v_mul_f32 v144, v144, v161
    v_mul_f32 v145, v145, v161
    v_mul_f32 v146, v146, v161
    v_mul_f32 v147, v147, v161
    v_cvt_pk_bf16_f32 v200, v144, v145
    v_cvt_pk_bf16_f32 v201, v146, v147
    v_mul_f32 v148, v148, v162
    v_mul_f32 v149, v149, v162
    v_mul_f32 v150, v150, v162
    v_mul_f32 v151, v151, v162
    v_cvt_pk_bf16_f32 v202, v148, v149
    v_cvt_pk_bf16_f32 v203, v150, v151
    v_mul_f32 v152, v152, v163
    v_mul_f32 v153, v153, v163
    v_mul_f32 v154, v154, v163
    v_mul_f32 v155, v155, v163
    v_cvt_pk_bf16_f32 v204, v152, v153
    v_cvt_pk_bf16_f32 v205, v154, v155
    v_mul_f32 v156, v156, v164
    v_mul_f32 v157, v157, v164
    v_mul_f32 v158, v158, v164
    v_mul_f32 v159, v159, v164
    v_cvt_pk_bf16_f32 v206, v156, v157
    v_cvt_pk_bf16_f32 v207, v158, v159
    v_add_u32 v14, s42, v13
    ds_write_b128 v14, v[168:171] offset:0
    ds_write_b128 v14, v[172:175] offset:1024
    ds_write_b128 v14, v[176:179] offset:2048
    ds_write_b128 v14, v[180:183] offset:3072
    ds_write_b128 v14, v[184:187] offset:4096
    ds_write_b128 v14, v[188:191] offset:20480
    ds_write_b128 v14, v[192:195] offset:21504
    ds_write_b128 v14, v[196:199] offset:22528
    ds_write_b128 v14, v[200:203] offset:23552
    ds_write_b128 v14, v[204:207] offset:24576
    s_add_u32 s41, s43, s77
    s_add_u32 s24, s40, 1
    s_cmp_lt_u32 s24, s76
    s_cselect_b32 s41, s41, 2146435072
    s_waitcnt vmcnt(0)
    s_add_u32 s25, s41, 20480
    buffer_load_dwordx4 v[16:19], v8, s[8:11], s41 offen offset:0 sc1
    buffer_load_dwordx4 v[20:23], v8, s[8:11], s41 offen offset:1024 sc1
    buffer_load_dwordx2 v[24:25], v9, s[8:11], s41 offen offset:0 sc1
    buffer_load_dwordx4 v[26:29], v8, s[8:11], s41 offen offset:2560 sc1
    buffer_load_dwordx4 v[30:33], v8, s[8:11], s41 offen offset:3584 sc1
    buffer_load_dwordx2 v[34:35], v9, s[8:11], s41 offen offset:2560 sc1
    buffer_load_dwordx4 v[36:39], v8, s[8:11], s25 offen offset:0 sc1
    buffer_load_dwordx4 v[40:43], v8, s[8:11], s25 offen offset:1024 sc1
    buffer_load_dwordx2 v[44:45], v9, s[8:11], s25 offen offset:0 sc1
    buffer_load_dwordx4 v[46:49], v8, s[8:11], s25 offen offset:2560 sc1
    buffer_load_dwordx4 v[50:53], v8, s[8:11], s25 offen offset:3584 sc1
    buffer_load_dwordx2 v[54:55], v9, s[8:11], s25 offen offset:2560 sc1
    buffer_load_dwordx2 v[96:97], v10, s[16:19], s41 offen sc1
    buffer_load_dwordx2 v[98:99], v11, s[16:19], s41 offen sc1
    buffer_load_dwordx2 v[100:101], v10, s[16:19], s25 offen sc1
    buffer_load_dwordx2 v[102:103], v11, s[16:19], s25 offen sc1
    s_waitcnt lgkmcnt(0)
    s_barrier
    s_lshl_b32 s24, s92, 10
    s_lshl_b32 s25, s78, 2
    s_add_u32 s24, s24, s25
    s_add_u32 s24, s24, 23105536
    s_cmp_eq_u32 s3, 0
    s_cbranch_scc0 interleave_layers__linear_attn_block__memory_aug_recurrent_mem_tr__prompt_kernel_pb11
    v_lshlrev_b32 v14, 7, v1
    v_add_u32 v14, s24, v14
    v_mov_b32 v15, 2146435072
    v_cmp_le_u32 vcc, 8, v1
    s_nop 1
    v_cndmask_b32 v14, v14, v15, vcc
    v_mov_b32 v15, s40
    buffer_store_dword v15, v14, s[8:11], 0 offen sc1
interleave_layers__linear_attn_block__memory_aug_recurrent_mem_tr__prompt_kernel_pb11:
    v_add_u32 v15, s42, v5
    ds_read_b128 v[208:211], v15 offset:0
    ds_read_b128 v[212:215], v15 offset:20480
    ds_read_b128 v[216:219], v15 offset:1024
    ds_read_b128 v[220:223], v15 offset:21504
    ds_read_b128 v[224:227], v15 offset:2048
    ds_read_b128 v[228:231], v15 offset:22528
    ds_read_b128 v[232:235], v15 offset:3072
    ds_read_b128 v[236:239], v15 offset:23552
    s_waitcnt lgkmcnt(6)
    v_mfma_f32_16x16x32_bf16 v[240:243], a[0:3], v[208:211], 0
    v_mfma_f32_16x16x32_bf16 v[244:247], a[4:7], v[208:211], 0
    v_mfma_f32_16x16x32_bf16 v[248:251], a[0:3], v[212:215], 0
    v_mfma_f32_16x16x32_bf16 v[252:255], a[4:7], v[212:215], 0
    ds_read_b128 v[208:211], v15 offset:4096
    ds_read_b128 v[212:215], v15 offset:24576
    s_waitcnt lgkmcnt(6)
    v_mfma_f32_16x16x32_bf16 v[240:243], a[8:11], v[216:219], v[240:243]
    v_mfma_f32_16x16x32_bf16 v[244:247], a[12:15], v[216:219], v[244:247]
    v_mfma_f32_16x16x32_bf16 v[248:251], a[8:11], v[220:223], v[248:251]
    v_mfma_f32_16x16x32_bf16 v[252:255], a[12:15], v[220:223], v[252:255]
    ds_read_b128 v[216:219], v15 offset:5120
    ds_read_b128 v[220:223], v15 offset:25600
    s_waitcnt lgkmcnt(6)
    v_mfma_f32_16x16x32_bf16 v[240:243], a[16:19], v[224:227], v[240:243]
    v_mfma_f32_16x16x32_bf16 v[244:247], a[20:23], v[224:227], v[244:247]
    v_mfma_f32_16x16x32_bf16 v[248:251], a[16:19], v[228:231], v[248:251]
    v_mfma_f32_16x16x32_bf16 v[252:255], a[20:23], v[228:231], v[252:255]
    ds_read_b128 v[224:227], v15 offset:6144
    ds_read_b128 v[228:231], v15 offset:26624
    s_waitcnt lgkmcnt(6)
    v_mfma_f32_16x16x32_bf16 v[240:243], a[24:27], v[232:235], v[240:243]
    v_mfma_f32_16x16x32_bf16 v[244:247], a[28:31], v[232:235], v[244:247]
    v_mfma_f32_16x16x32_bf16 v[248:251], a[24:27], v[236:239], v[248:251]
    v_mfma_f32_16x16x32_bf16 v[252:255], a[28:31], v[236:239], v[252:255]
    ds_read_b128 v[232:235], v15 offset:7168
    ds_read_b128 v[236:239], v15 offset:27648
    s_waitcnt lgkmcnt(6)
    v_mfma_f32_16x16x32_bf16 v[240:243], a[32:35], v[208:211], v[240:243]
    v_mfma_f32_16x16x32_bf16 v[244:247], a[36:39], v[208:211], v[244:247]
    v_mfma_f32_16x16x32_bf16 v[248:251], a[32:35], v[212:215], v[248:251]
    v_mfma_f32_16x16x32_bf16 v[252:255], a[36:39], v[212:215], v[252:255]
    ds_read_b128 v[208:211], v15 offset:8192
    ds_read_b128 v[212:215], v15 offset:28672
    s_waitcnt lgkmcnt(6)
    v_mfma_f32_16x16x32_bf16 v[240:243], a[40:43], v[216:219], v[240:243]
    v_mfma_f32_16x16x32_bf16 v[244:247], a[44:47], v[216:219], v[244:247]
    v_mfma_f32_16x16x32_bf16 v[248:251], a[40:43], v[220:223], v[248:251]
    v_mfma_f32_16x16x32_bf16 v[252:255], a[44:47], v[220:223], v[252:255]
    ds_read_b128 v[216:219], v15 offset:9216
    ds_read_b128 v[220:223], v15 offset:29696
    s_waitcnt lgkmcnt(6)
    v_mfma_f32_16x16x32_bf16 v[240:243], a[48:51], v[224:227], v[240:243]
    v_mfma_f32_16x16x32_bf16 v[244:247], a[52:55], v[224:227], v[244:247]
    v_mfma_f32_16x16x32_bf16 v[248:251], a[48:51], v[228:231], v[248:251]
    v_mfma_f32_16x16x32_bf16 v[252:255], a[52:55], v[228:231], v[252:255]
    ds_read_b128 v[224:227], v15 offset:10240
    ds_read_b128 v[228:231], v15 offset:30720
    s_waitcnt lgkmcnt(6)
    v_mfma_f32_16x16x32_bf16 v[240:243], a[56:59], v[232:235], v[240:243]
    v_mfma_f32_16x16x32_bf16 v[244:247], a[60:63], v[232:235], v[244:247]
    v_mfma_f32_16x16x32_bf16 v[248:251], a[56:59], v[236:239], v[248:251]
    v_mfma_f32_16x16x32_bf16 v[252:255], a[60:63], v[236:239], v[252:255]
    ds_read_b128 v[232:235], v15 offset:11264
    ds_read_b128 v[236:239], v15 offset:31744
    s_waitcnt lgkmcnt(6)
    v_mfma_f32_16x16x32_bf16 v[240:243], a[64:67], v[208:211], v[240:243]
    v_mfma_f32_16x16x32_bf16 v[244:247], a[68:71], v[208:211], v[244:247]
    v_mfma_f32_16x16x32_bf16 v[248:251], a[64:67], v[212:215], v[248:251]
    v_mfma_f32_16x16x32_bf16 v[252:255], a[68:71], v[212:215], v[252:255]
    ds_read_b128 v[208:211], v15 offset:12288
    ds_read_b128 v[212:215], v15 offset:32768
    s_waitcnt lgkmcnt(6)
    v_mfma_f32_16x16x32_bf16 v[240:243], a[72:75], v[216:219], v[240:243]
    v_mfma_f32_16x16x32_bf16 v[244:247], a[76:79], v[216:219], v[244:247]
    v_mfma_f32_16x16x32_bf16 v[248:251], a[72:75], v[220:223], v[248:251]
    v_mfma_f32_16x16x32_bf16 v[252:255], a[76:79], v[220:223], v[252:255]
    ds_read_b128 v[216:219], v15 offset:13312
    ds_read_b128 v[220:223], v15 offset:33792
    s_waitcnt lgkmcnt(6)
    v_mfma_f32_16x16x32_bf16 v[240:243], a[80:83], v[224:227], v[240:243]
    v_mfma_f32_16x16x32_bf16 v[244:247], a[84:87], v[224:227], v[244:247]
    v_mfma_f32_16x16x32_bf16 v[248:251], a[80:83], v[228:231], v[248:251]
    v_mfma_f32_16x16x32_bf16 v[252:255], a[84:87], v[228:231], v[252:255]
    ds_read_b128 v[224:227], v15 offset:14336
    ds_read_b128 v[228:231], v15 offset:34816
    s_waitcnt lgkmcnt(6)
    v_mfma_f32_16x16x32_bf16 v[240:243], a[88:91], v[232:235], v[240:243]
    v_mfma_f32_16x16x32_bf16 v[244:247], a[92:95], v[232:235], v[244:247]
    v_mfma_f32_16x16x32_bf16 v[248:251], a[88:91], v[236:239], v[248:251]
    v_mfma_f32_16x16x32_bf16 v[252:255], a[92:95], v[236:239], v[252:255]
    ds_read_b128 v[232:235], v15 offset:15360
    ds_read_b128 v[236:239], v15 offset:35840
    s_waitcnt lgkmcnt(6)
    v_mfma_f32_16x16x32_bf16 v[240:243], a[96:99], v[208:211], v[240:243]
    v_mfma_f32_16x16x32_bf16 v[244:247], a[100:103], v[208:211], v[244:247]
    v_mfma_f32_16x16x32_bf16 v[248:251], a[96:99], v[212:215], v[248:251]
    v_mfma_f32_16x16x32_bf16 v[252:255], a[100:103], v[212:215], v[252:255]
    ds_read_b128 v[208:211], v15 offset:16384
    ds_read_b128 v[212:215], v15 offset:36864
    s_waitcnt lgkmcnt(6)
    v_mfma_f32_16x16x32_bf16 v[240:243], a[104:107], v[216:219], v[240:243]
    v_mfma_f32_16x16x32_bf16 v[244:247], a[108:111], v[216:219], v[244:247]
    v_mfma_f32_16x16x32_bf16 v[248:251], a[104:107], v[220:223], v[248:251]
    v_mfma_f32_16x16x32_bf16 v[252:255], a[108:111], v[220:223], v[252:255]
    ds_read_b128 v[216:219], v15 offset:17408
    ds_read_b128 v[220:223], v15 offset:37888
    s_waitcnt lgkmcnt(6)
    v_mfma_f32_16x16x32_bf16 v[240:243], a[112:115], v[224:227], v[240:243]
    v_mfma_f32_16x16x32_bf16 v[244:247], a[116:119], v[224:227], v[244:247]
    v_mfma_f32_16x16x32_bf16 v[248:251], a[112:115], v[228:231], v[248:251]
    v_mfma_f32_16x16x32_bf16 v[252:255], a[116:119], v[228:231], v[252:255]
    ds_read_b128 v[224:227], v15 offset:18432
    ds_read_b128 v[228:231], v15 offset:38912
    s_waitcnt lgkmcnt(6)
    v_mfma_f32_16x16x32_bf16 v[240:243], a[120:123], v[232:235], v[240:243]
    v_mfma_f32_16x16x32_bf16 v[244:247], a[124:127], v[232:235], v[244:247]
    v_mfma_f32_16x16x32_bf16 v[248:251], a[120:123], v[236:239], v[248:251]
    v_mfma_f32_16x16x32_bf16 v[252:255], a[124:127], v[236:239], v[252:255]
    ds_read_b128 v[232:235], v15 offset:19456
    ds_read_b128 v[236:239], v15 offset:39936
    s_waitcnt lgkmcnt(6)
    v_mfma_f32_16x16x32_bf16 v[240:243], a[128:131], v[208:211], v[240:243]
    v_mfma_f32_16x16x32_bf16 v[244:247], a[132:135], v[208:211], v[244:247]
    v_mfma_f32_16x16x32_bf16 v[248:251], a[128:131], v[212:215], v[248:251]
    v_mfma_f32_16x16x32_bf16 v[252:255], a[132:135], v[212:215], v[252:255]
    s_waitcnt lgkmcnt(4)
    v_mfma_f32_16x16x32_bf16 v[240:243], a[136:139], v[216:219], v[240:243]
    v_mfma_f32_16x16x32_bf16 v[244:247], a[140:143], v[216:219], v[244:247]
    v_mfma_f32_16x16x32_bf16 v[248:251], a[136:139], v[220:223], v[248:251]
    v_mfma_f32_16x16x32_bf16 v[252:255], a[140:143], v[220:223], v[252:255]
    s_waitcnt lgkmcnt(2)
    v_mfma_f32_16x16x32_bf16 v[240:243], a[144:147], v[224:227], v[240:243]
    v_mfma_f32_16x16x32_bf16 v[244:247], a[148:151], v[224:227], v[244:247]
    v_mfma_f32_16x16x32_bf16 v[248:251], a[144:147], v[228:231], v[248:251]
    v_mfma_f32_16x16x32_bf16 v[252:255], a[148:151], v[228:231], v[252:255]
    s_waitcnt lgkmcnt(0)
    v_mfma_f32_16x16x32_bf16 v[240:243], a[152:155], v[232:235], v[240:243]
    v_mfma_f32_16x16x32_bf16 v[244:247], a[156:159], v[232:235], v[244:247]
    v_mfma_f32_16x16x32_bf16 v[248:251], a[152:155], v[236:239], v[248:251]
    v_mfma_f32_16x16x32_bf16 v[252:255], a[156:159], v[236:239], v[252:255]
    s_nop 4
    v_cvt_pk_bf16_f32 v208, v240, v241
    v_cvt_pk_bf16_f32 v209, v242, v243
    v_lshlrev_b32 v210, 16, v208
    v_and_b32 v211, 0xffff0000, v208
    v_lshlrev_b32 v212, 16, v104
    v_and_b32 v213, 0xffff0000, v104
    v_pk_add_f32 v[210:211], v[210:211], v[212:213]
    v_cvt_pk_bf16_f32 v216, v210, v211
    v_lshlrev_b32 v210, 16, v209
    v_and_b32 v211, 0xffff0000, v209
    v_lshlrev_b32 v212, 16, v105
    v_and_b32 v213, 0xffff0000, v105
    v_pk_add_f32 v[210:211], v[210:211], v[212:213]
    v_cvt_pk_bf16_f32 v217, v210, v211
    v_cvt_pk_bf16_f32 v208, v244, v245
    v_cvt_pk_bf16_f32 v209, v246, v247
    v_lshlrev_b32 v210, 16, v208
    v_and_b32 v211, 0xffff0000, v208
    v_lshlrev_b32 v212, 16, v106
    v_and_b32 v213, 0xffff0000, v106
    v_pk_add_f32 v[210:211], v[210:211], v[212:213]
    v_cvt_pk_bf16_f32 v218, v210, v211
    v_lshlrev_b32 v210, 16, v209
    v_and_b32 v211, 0xffff0000, v209
    v_lshlrev_b32 v212, 16, v107
    v_and_b32 v213, 0xffff0000, v107
    v_pk_add_f32 v[210:211], v[210:211], v[212:213]
    v_cvt_pk_bf16_f32 v219, v210, v211
    v_cvt_pk_bf16_f32 v208, v248, v249
    v_cvt_pk_bf16_f32 v209, v250, v251
    v_lshlrev_b32 v210, 16, v208
    v_and_b32 v211, 0xffff0000, v208
    v_lshlrev_b32 v212, 16, v108
    v_and_b32 v213, 0xffff0000, v108
    v_pk_add_f32 v[210:211], v[210:211], v[212:213]
    v_cvt_pk_bf16_f32 v220, v210, v211
    v_lshlrev_b32 v210, 16, v209
    v_and_b32 v211, 0xffff0000, v209
    v_lshlrev_b32 v212, 16, v109
    v_and_b32 v213, 0xffff0000, v109
    v_pk_add_f32 v[210:211], v[210:211], v[212:213]
    v_cvt_pk_bf16_f32 v221, v210, v211
    v_cvt_pk_bf16_f32 v208, v252, v253
    v_cvt_pk_bf16_f32 v209, v254, v255
    v_lshlrev_b32 v210, 16, v208
    v_and_b32 v211, 0xffff0000, v208
    v_lshlrev_b32 v212, 16, v110
    v_and_b32 v213, 0xffff0000, v110
    v_pk_add_f32 v[210:211], v[210:211], v[212:213]
    v_cvt_pk_bf16_f32 v222, v210, v211
    v_lshlrev_b32 v210, 16, v209
    v_and_b32 v211, 0xffff0000, v209
    v_lshlrev_b32 v212, 16, v111
    v_and_b32 v213, 0xffff0000, v111
    v_pk_add_f32 v[210:211], v[210:211], v[212:213]
    v_cvt_pk_bf16_f32 v223, v210, v211
    s_add_u32 s25, s43, 20480
    buffer_store_dwordx4 v[216:219], v12, s[8:11], s43 offen sc1
    buffer_store_dwordx4 v[220:223], v12, s[8:11], s25 offen sc1
    s_add_u32 s40, s40, 1
    s_add_u32 s43, s43, s77
    s_cmp_ge_u32 s40, s76
    s_cbranch_scc1 interleave_layers__linear_attn_block__memory_aug_recurrent_mem_tr__prompt_kernel_k3_done
    s_xor_b32 s42, s42, 40960
    s_waitcnt vmcnt(2)
    v_mfma_f32_16x16x32_bf16 v[132:135], a[192:195], v[16:19], 0
    v_mfma_f32_16x16x32_bf16 v[136:139], a[202:205], v[20:23], 0
    v_mfma_f32_16x16x32_bf16 v[112:115], a[160:163], v[16:19], 0
    v_mfma_f32_16x16x32_bf16 v[116:119], a[164:167], v[16:19], 0
    v_mfma_f32_16x16x32_bf16 v[120:123], a[172:175], v[16:19], 0
    v_mfma_f32_16x16x32_bf16 v[124:127], a[180:183], v[20:23], 0
    v_mfma_f32_16x16x32_bf16 v[128:131], a[186:189], v[20:23], 0
    v_mfma_f32_16x16x32_bf16 v[132:135], a[196:199], v[20:23], v[132:135]
    v_mfma_f32_16x16x32_bf16 v[116:119], a[168:171], v[20:23], v[116:119]
    v_mfma_f32_16x16x32_bf16 v[120:123], a[176:179], v[20:23], v[120:123]
    v_mfma_f32_16x16x16_bf16 v[136:139], a[206:207], v[24:25], v[136:139]
    s_nop 0
    v_mfma_f32_16x16x16_bf16 v[124:127], a[184:185], v[24:25], v[124:127]
    v_mfma_f32_16x16x16_bf16 v[128:131], a[190:191], v[24:25], v[128:131]
    v_mfma_f32_16x16x16_bf16 v[132:135], a[200:201], v[24:25], v[132:135]
    v_mfma_f32_16x16x32_bf16 v[160:163], a[240:243], v[26:29], 0
    v_mfma_f32_16x16x32_bf16 v[164:167], a[250:253], v[30:33], 0
    v_mfma_f32_16x16x32_bf16 v[140:143], a[208:211], v[26:29], 0
    v_mfma_f32_16x16x32_bf16 v[144:147], a[212:215], v[26:29], 0
    v_mfma_f32_16x16x32_bf16 v[148:151], a[220:223], v[26:29], 0
    v_mfma_f32_16x16x32_bf16 v[152:155], a[228:231], v[30:33], 0
    v_mfma_f32_16x16x32_bf16 v[156:159], a[234:237], v[30:33], 0
    v_mfma_f32_16x16x32_bf16 v[160:163], a[244:247], v[30:33], v[160:163]
    v_mfma_f32_16x16x32_bf16 v[144:147], a[216:219], v[30:33], v[144:147]
    v_mfma_f32_16x16x32_bf16 v[148:151], a[224:227], v[30:33], v[148:151]
    v_mfma_f32_16x16x16_bf16 v[164:167], a[254:255], v[34:35], v[164:167]
    s_nop 0
    v_mfma_f32_16x16x16_bf16 v[152:155], a[232:233], v[34:35], v[152:155]
    v_mfma_f32_16x16x16_bf16 v[156:159], a[238:239], v[34:35], v[156:159]
    v_mfma_f32_16x16x16_bf16 v[160:163], a[248:249], v[34:35], v[160:163]
    v_add_f32 v132, s54, v132
    v_add_f32 v133, s54, v133
    v_add_f32 v134, s54, v134
    v_add_f32 v135, s54, v135
    v_add_f32 v136, s54, v136
    v_rcp_f32 v132, v132
    v_rcp_f32 v133, v133
    v_rcp_f32 v134, v134
    v_rcp_f32 v135, v135
    v_rcp_f32 v136, v136
    v_mul_f32 v112, v112, v132
    v_mul_f32 v113, v113, v132
    v_mul_f32 v114, v114, v132
    v_mul_f32 v115, v115, v132
    v_cvt_pk_bf16_f32 v168, v112, v113
    v_cvt_pk_bf16_f32 v169, v114, v115
    v_mul_f32 v116, v116, v133
    v_mul_f32 v117, v117, v133
    v_mul_f32 v118, v118, v133
    v_mul_f32 v119, v119, v133
    v_cvt_pk_bf16_f32 v170, v116, v117
    v_cvt_pk_bf16_f32 v171, v118, v119
    v_mul_f32 v120, v120, v134
    v_mul_f32 v121, v121, v134
    v_mul_f32 v122, v122, v134
    v_mul_f32 v123, v123, v134
    v_cvt_pk_bf16_f32 v172, v120, v121
    v_cvt_pk_bf16_f32 v173, v122, v123
    v_mul_f32 v124, v124, v135
    v_mul_f32 v125, v125, v135
    v_mul_f32 v126, v126, v135
    v_mul_f32 v127, v127, v135
    v_cvt_pk_bf16_f32 v174, v124, v125
    v_cvt_pk_bf16_f32 v175, v126, v127
    v_mul_f32 v128, v128, v136
    v_mul_f32 v129, v129, v136
    v_mul_f32 v130, v130, v136
    v_mul_f32 v131, v131, v136
    v_cvt_pk_bf16_f32 v176, v128, v129
    v_cvt_pk_bf16_f32 v177, v130, v131
    v_add_f32 v160, s54, v160
    v_add_f32 v161, s54, v161
    v_add_f32 v162, s54, v162
    v_add_f32 v163, s54, v163
    v_add_f32 v164, s54, v164
    v_rcp_f32 v160, v160
    v_rcp_f32 v161, v161
    v_rcp_f32 v162, v162
    v_rcp_f32 v163, v163
    v_rcp_f32 v164, v164
    v_mul_f32 v140, v140, v160
    v_mul_f32 v141, v141, v160
    v_mul_f32 v142, v142, v160
    v_mul_f32 v143, v143, v160
    v_cvt_pk_bf16_f32 v178, v140, v141
    v_cvt_pk_bf16_f32 v179, v142, v143
    v_mul_f32 v144, v144, v161
    v_mul_f32 v145, v145, v161
    v_mul_f32 v146, v146, v161
    v_mul_f32 v147, v147, v161
    v_cvt_pk_bf16_f32 v180, v144, v145
    v_cvt_pk_bf16_f32 v181, v146, v147
    v_mul_f32 v148, v148, v162
    v_mul_f32 v149, v149, v162
    v_mul_f32 v150, v150, v162
    v_mul_f32 v151, v151, v162
    v_cvt_pk_bf16_f32 v182, v148, v149
    v_cvt_pk_bf16_f32 v183, v150, v151
    v_mul_f32 v152, v152, v163
    v_mul_f32 v153, v153, v163
    v_mul_f32 v154, v154, v163
    v_mul_f32 v155, v155, v163
    v_cvt_pk_bf16_f32 v184, v152, v153
    v_cvt_pk_bf16_f32 v185, v154, v155
    v_mul_f32 v156, v156, v164
    v_mul_f32 v157, v157, v164
    v_mul_f32 v158, v158, v164
    v_mul_f32 v159, v159, v164
    v_cvt_pk_bf16_f32 v186, v156, v157
    v_cvt_pk_bf16_f32 v187, v158, v159
    v_mfma_f32_16x16x32_bf16 v[132:135], a[192:195], v[36:39], 0
    v_mfma_f32_16x16x32_bf16 v[136:139], a[202:205], v[40:43], 0
    v_mfma_f32_16x16x32_bf16 v[112:115], a[160:163], v[36:39], 0
    v_mfma_f32_16x16x32_bf16 v[116:119], a[164:167], v[36:39], 0
    v_mfma_f32_16x16x32_bf16 v[120:123], a[172:175], v[36:39], 0
    v_mfma_f32_16x16x32_bf16 v[124:127], a[180:183], v[40:43], 0
    v_mfma_f32_16x16x32_bf16 v[128:131], a[186:189], v[40:43], 0
    v_mfma_f32_16x16x32_bf16 v[132:135], a[196:199], v[40:43], v[132:135]
    v_mfma_f32_16x16x32_bf16 v[116:119], a[168:171], v[40:43], v[116:119]
    v_mfma_f32_16x16x32_bf16 v[120:123], a[176:179], v[40:43], v[120:123]
    v_mfma_f32_16x16x16_bf16 v[136:139], a[206:207], v[44:45], v[136:139]
    s_nop 0
    v_mfma_f32_16x16x16_bf16 v[124:127], a[184:185], v[44:45], v[124:127]
    v_mfma_f32_16x16x16_bf16 v[128:131], a[190:191], v[44:45], v[128:131]
    v_mfma_f32_16x16x16_bf16 v[132:135], a[200:201], v[44:45], v[132:135]
    v_mfma_f32_16x16x32_bf16 v[160:163], a[240:243], v[46:49], 0
    v_mfma_f32_16x16x32_bf16 v[164:167], a[250:253], v[50:53], 0
    v_mfma_f32_16x16x32_bf16 v[140:143], a[208:211], v[46:49], 0
    v_mfma_f32_16x16x32_bf16 v[144:147], a[212:215], v[46:49], 0
    v_mfma_f32_16x16x32_bf16 v[148:151], a[220:223], v[46:49], 0
    v_mfma_f32_16x16x32_bf16 v[152:155], a[228:231], v[50:53], 0
    v_mfma_f32_16x16x32_bf16 v[156:159], a[234:237], v[50:53], 0
    v_mfma_f32_16x16x32_bf16 v[160:163], a[244:247], v[50:53], v[160:163]
    v_mfma_f32_16x16x32_bf16 v[144:147], a[216:219], v[50:53], v[144:147]
    v_mfma_f32_16x16x32_bf16 v[148:151], a[224:227], v[50:53], v[148:151]
    v_mfma_f32_16x16x16_bf16 v[164:167], a[254:255], v[54:55], v[164:167]
    s_nop 0
    v_mfma_f32_16x16x16_bf16 v[152:155], a[232:233], v[54:55], v[152:155]
    v_mfma_f32_16x16x16_bf16 v[156:159], a[238:239], v[54:55], v[156:159]
    v_mfma_f32_16x16x16_bf16 v[160:163], a[248:249], v[54:55], v[160:163]
    v_add_f32 v132, s54, v132
    v_add_f32 v133, s54, v133
    v_add_f32 v134, s54, v134
    v_add_f32 v135, s54, v135
    v_add_f32 v136, s54, v136
    v_rcp_f32 v132, v132
    v_rcp_f32 v133, v133
    v_rcp_f32 v134, v134
    v_rcp_f32 v135, v135
    v_rcp_f32 v136, v136
    v_mul_f32 v112, v112, v132
    v_mul_f32 v113, v113, v132
    v_mul_f32 v114, v114, v132
    v_mul_f32 v115, v115, v132
    v_cvt_pk_bf16_f32 v188, v112, v113
    v_cvt_pk_bf16_f32 v189, v114, v115
    v_mul_f32 v116, v116, v133
    v_mul_f32 v117, v117, v133
    v_mul_f32 v118, v118, v133
    v_mul_f32 v119, v119, v133
    v_cvt_pk_bf16_f32 v190, v116, v117
    v_cvt_pk_bf16_f32 v191, v118, v119
    v_mul_f32 v120, v120, v134
    v_mul_f32 v121, v121, v134
    v_mul_f32 v122, v122, v134
    v_mul_f32 v123, v123, v134
    v_cvt_pk_bf16_f32 v192, v120, v121
    v_cvt_pk_bf16_f32 v193, v122, v123
    v_mul_f32 v124, v124, v135
    v_mul_f32 v125, v125, v135
    v_mul_f32 v126, v126, v135
    v_mul_f32 v127, v127, v135
    v_cvt_pk_bf16_f32 v194, v124, v125
    v_cvt_pk_bf16_f32 v195, v126, v127
    v_mul_f32 v128, v128, v136
    v_mul_f32 v129, v129, v136
    v_mul_f32 v130, v130, v136
    v_mul_f32 v131, v131, v136
    v_cvt_pk_bf16_f32 v196, v128, v129
    v_cvt_pk_bf16_f32 v197, v130, v131
    v_add_f32 v160, s54, v160
    v_add_f32 v161, s54, v161
    v_add_f32 v162, s54, v162
    v_add_f32 v163, s54, v163
    v_add_f32 v164, s54, v164
    v_rcp_f32 v160, v160
    v_rcp_f32 v161, v161
    v_rcp_f32 v162, v162
    v_rcp_f32 v163, v163
    v_rcp_f32 v164, v164
    v_mul_f32 v140, v140, v160
    v_mul_f32 v141, v141, v160
    v_mul_f32 v142, v142, v160
    v_mul_f32 v143, v143, v160
    v_cvt_pk_bf16_f32 v198, v140, v141
    v_cvt_pk_bf16_f32 v199, v142, v143
    v_mul_f32 v144, v144, v161
    v_mul_f32 v145, v145, v161
    v_mul_f32 v146, v146, v161
    v_mul_f32 v147, v147, v161
    v_cvt_pk_bf16_f32 v200, v144, v145
    v_cvt_pk_bf16_f32 v201, v146, v147
    v_mul_f32 v148, v148, v162
    v_mul_f32 v149, v149, v162
    v_mul_f32 v150, v150, v162
    v_mul_f32 v151, v151, v162
    v_cvt_pk_bf16_f32 v202, v148, v149
    v_cvt_pk_bf16_f32 v203, v150, v151
    v_mul_f32 v152, v152, v163
    v_mul_f32 v153, v153, v163
    v_mul_f32 v154, v154, v163
    v_mul_f32 v155, v155, v163
    v_cvt_pk_bf16_f32 v204, v152, v153
    v_cvt_pk_bf16_f32 v205, v154, v155
    v_mul_f32 v156, v156, v164
    v_mul_f32 v157, v157, v164
    v_mul_f32 v158, v158, v164
    v_mul_f32 v159, v159, v164
    v_cvt_pk_bf16_f32 v206, v156, v157
    v_cvt_pk_bf16_f32 v207, v158, v159
    v_add_u32 v14, s42, v13
    ds_write_b128 v14, v[168:171] offset:0
    ds_write_b128 v14, v[172:175] offset:1024
    ds_write_b128 v14, v[176:179] offset:2048
    ds_write_b128 v14, v[180:183] offset:3072
    ds_write_b128 v14, v[184:187] offset:4096
    ds_write_b128 v14, v[188:191] offset:20480
    ds_write_b128 v14, v[192:195] offset:21504
    ds_write_b128 v14, v[196:199] offset:22528
    ds_write_b128 v14, v[200:203] offset:23552
    ds_write_b128 v14, v[204:207] offset:24576
    s_add_u32 s41, s43, s77
    s_add_u32 s24, s40, 1
    s_cmp_lt_u32 s24, s76
    s_cselect_b32 s41, s41, 2146435072
    s_waitcnt vmcnt(0)
    s_add_u32 s25, s41, 20480
    buffer_load_dwordx4 v[56:59], v8, s[8:11], s41 offen offset:0 sc1
    buffer_load_dwordx4 v[60:63], v8, s[8:11], s41 offen offset:1024 sc1
    buffer_load_dwordx2 v[64:65], v9, s[8:11], s41 offen offset:0 sc1
    buffer_load_dwordx4 v[66:69], v8, s[8:11], s41 offen offset:2560 sc1
    buffer_load_dwordx4 v[70:73], v8, s[8:11], s41 offen offset:3584 sc1
    buffer_load_dwordx2 v[74:75], v9, s[8:11], s41 offen offset:2560 sc1
    buffer_load_dwordx4 v[76:79], v8, s[8:11], s25 offen offset:0 sc1
    buffer_load_dwordx4 v[80:83], v8, s[8:11], s25 offen offset:1024 sc1
    buffer_load_dwordx2 v[84:85], v9, s[8:11], s25 offen offset:0 sc1
    buffer_load_dwordx4 v[86:89], v8, s[8:11], s25 offen offset:2560 sc1
    buffer_load_dwordx4 v[90:93], v8, s[8:11], s25 offen offset:3584 sc1
    buffer_load_dwordx2 v[94:95], v9, s[8:11], s25 offen offset:2560 sc1
    buffer_load_dwordx2 v[104:105], v10, s[16:19], s41 offen sc1
    buffer_load_dwordx2 v[106:107], v11, s[16:19], s41 offen sc1
    buffer_load_dwordx2 v[108:109], v10, s[16:19], s25 offen sc1
    buffer_load_dwordx2 v[110:111], v11, s[16:19], s25 offen sc1
    s_waitcnt lgkmcnt(0)
    s_barrier
    s_lshl_b32 s24, s92, 10
    s_lshl_b32 s25, s78, 2
    s_add_u32 s24, s24, s25
    s_add_u32 s24, s24, 23105536
    s_cmp_eq_u32 s3, 0
    s_cbranch_scc0 interleave_layers__linear_attn_block__memory_aug_recurrent_mem_tr__prompt_kernel_pb12
    v_lshlrev_b32 v14, 7, v1
    v_add_u32 v14, s24, v14
    v_mov_b32 v15, 2146435072
    v_cmp_le_u32 vcc, 8, v1
    s_nop 1
    v_cndmask_b32 v14, v14, v15, vcc
    v_mov_b32 v15, s40
    buffer_store_dword v15, v14, s[8:11], 0 offen sc1
interleave_layers__linear_attn_block__memory_aug_recurrent_mem_tr__prompt_kernel_pb12:
    s_branch interleave_layers__linear_attn_block__memory_aug_recurrent_mem_tr__prompt_kernel_k3_seg
interleave_layers__linear_attn_block__memory_aug_recurrent_mem_tr__prompt_kernel_k3_done:
    s_waitcnt vmcnt(0)
    s_barrier
    s_lshl_b32 s24, s92, 10
    s_lshl_b32 s25, s78, 2
    s_add_u32 s24, s24, s25
    s_add_u32 s24, s24, 23105536
    s_cmp_eq_u32 s3, 0
    s_cbranch_scc0 interleave_layers__linear_attn_block__memory_aug_recurrent_mem_tr__prompt_kernel_pb13
    v_lshlrev_b32 v14, 7, v1
    v_add_u32 v14, s24, v14
    v_mov_b32 v15, 2146435072
    v_cmp_le_u32 vcc, 8, v1
    s_nop 1
    v_cndmask_b32 v14, v14, v15, vcc
    v_mov_b32 v15, s40
    buffer_store_dword v15, v14, s[8:11], 0 offen sc1
interleave_layers__linear_attn_block__memory_aug_recurrent_mem_tr__prompt_kernel_pb13:
    s_cmp_eq_u32 s92, 0
    s_cbranch_scc0 interleave_layers__linear_attn_block__memory_aug_recurrent_mem_tr__prompt_kernel_end
    s_mov_b32 s92, 1
    s_cmp_lt_u32 s2, 248
    s_cbranch_scc1 interleave_layers__linear_attn_block__memory_aug_recurrent_mem_tr__prompt_kernel_helper_k1
    s_add_u32 s16, s4, 4194304
    s_addc_u32 s17, s5, 0
    s_mov_b32 s18, 2621440
    s_mov_b32 s19, 0x00020000
    s_mov_b32 s46, 1024
    s_mov_b32 s47, 8
    s_mov_b32 s50, 1
    s_mov_b32 s58, 8388608
    s_mov_b32 s76, 64
    s_mov_b32 s77, 40960
    s_branch interleave_layers__linear_attn_block__memory_aug_recurrent_mem_tr__prompt_kernel_k3_entry
interleave_layers__linear_attn_block__memory_aug_recurrent_mem_tr__prompt_kernel_helper_k1:
    s_mov_b32 s92, 1
    s_sub_u32 s24, s2, 232
    s_add_u32 s16, s4, 4194304
    s_addc_u32 s17, s5, 0
    s_mov_b32 s18, 2621440
    s_mov_b32 s19, 0x00020000
    s_mov_b32 s46, 1024
    s_mov_b32 s47, 8
    s_mov_b32 s50, 1
    s_and_b32 s44, s24, 7
    s_lshr_b32 s45, s24, 3
    s_mov_b32 s48, s45
    s_mov_b32 s49, 2
    s_mov_b32 s40, 32
    s_branch interleave_layers__linear_attn_block__memory_aug_recurrent_mem_tr__prompt_kernel_k1_entry
interleave_layers__linear_attn_block__memory_aug_recurrent_mem_tr__prompt_kernel_helper_clr:
    s_sub_u32 s44, s2, 253
    s_lshl_b32 s24, s44, 2
    s_add_u32 s24, s24, s3
    s_mul_i32 s24, s24, 38912
    s_add_u32 s41, s24, 117440512
    v_lshlrev_b32 v5, 4, v1
    v_mov_b32 v8, -1
    v_mov_b32 v9, -1
    v_mov_b32 v10, -1
    v_mov_b32 v11, -1
    s_lshl_b32 s24, s44, 2
    s_add_u32 s42, s24, 23109632
    s_mov_b32 s40, 0
interleave_layers__linear_attn_block__memory_aug_recurrent_mem_tr__prompt_kernel_clr_blk:
    s_mov_b32 s43, s41
    buffer_store_dwordx4 v[8:11], v5, s[8:11], s43 offen offset:0 sc1
    buffer_store_dwordx4 v[8:11], v5, s[8:11], s43 offen offset:1024 sc1
    buffer_store_dwordx4 v[8:11], v5, s[8:11], s43 offen offset:2048 sc1
    buffer_store_dwordx4 v[8:11], v5, s[8:11], s43 offen offset:3072 sc1
    s_add_u32 s43, s43, 4096
    buffer_store_dwordx4 v[8:11], v5, s[8:11], s43 offen offset:0 sc1
    buffer_store_dwordx4 v[8:11], v5, s[8:11], s43 offen offset:1024 sc1
    buffer_store_dwordx4 v[8:11], v5, s[8:11], s43 offen offset:2048 sc1
    buffer_store_dwordx4 v[8:11], v5, s[8:11], s43 offen offset:3072 sc1
    s_add_u32 s43, s43, 4096
    buffer_store_dwordx4 v[8:11], v5, s[8:11], s43 offen offset:0 sc1
    buffer_store_dwordx4 v[8:11], v5, s[8:11], s43 offen offset:1024 sc1
    buffer_store_dwordx4 v[8:11], v5, s[8:11], s43 offen offset:2048 sc1
    buffer_store_dwordx4 v[8:11], v5, s[8:11], s43 offen offset:3072 sc1
    s_add_u32 s43, s43, 4096
    buffer_store_dwordx4 v[8:11], v5, s[8:11], s43 offen offset:0 sc1
    buffer_store_dwordx4 v[8:11], v5, s[8:11], s43 offen offset:1024 sc1
    buffer_store_dwordx4 v[8:11], v5, s[8:11], s43 offen offset:2048 sc1
    buffer_store_dwordx4 v[8:11], v5, s[8:11], s43 offen offset:3072 sc1
    s_add_u32 s43, s43, 4096
    buffer_store_dwordx4 v[8:11], v5, s[8:11], s43 offen offset:0 sc1
    buffer_store_dwordx4 v[8:11], v5, s[8:11], s43 offen offset:1024 sc1
    buffer_store_dwordx4 v[8:11], v5, s[8:11], s43 offen offset:2048 sc1
    buffer_store_dwordx4 v[8:11], v5, s[8:11], s43 offen offset:3072 sc1
    s_add_u32 s43, s43, 4096
    buffer_store_dwordx4 v[8:11], v5, s[8:11], s43 offen offset:0 sc1
    buffer_store_dwordx4 v[8:11], v5, s[8:11], s43 offen offset:1024 sc1
    buffer_store_dwordx4 v[8:11], v5, s[8:11], s43 offen offset:2048 sc1
    buffer_store_dwordx4 v[8:11], v5, s[8:11], s43 offen offset:3072 sc1
    s_add_u32 s43, s43, 4096
    buffer_store_dwordx4 v[8:11], v5, s[8:11], s43 offen offset:0 sc1
    buffer_store_dwordx4 v[8:11], v5, s[8:11], s43 offen offset:1024 sc1
    buffer_store_dwordx4 v[8:11], v5, s[8:11], s43 offen offset:2048 sc1
    buffer_store_dwordx4 v[8:11], v5, s[8:11], s43 offen offset:3072 sc1
    s_add_u32 s43, s43, 4096
    buffer_store_dwordx4 v[8:11], v5, s[8:11], s43 offen offset:0 sc1
    buffer_store_dwordx4 v[8:11], v5, s[8:11], s43 offen offset:1024 sc1
    buffer_store_dwordx4 v[8:11], v5, s[8:11], s43 offen offset:2048 sc1
    buffer_store_dwordx4 v[8:11], v5, s[8:11], s43 offen offset:3072 sc1
    s_add_u32 s43, s43, 4096
    buffer_store_dwordx4 v[8:11], v5, s[8:11], s43 offen offset:0 sc1
    buffer_store_dwordx4 v[8:11], v5, s[8:11], s43 offen offset:1024 sc1
    buffer_store_dwordx4 v[8:11], v5, s[8:11], s43 offen offset:2048 sc1
    buffer_store_dwordx4 v[8:11], v5, s[8:11], s43 offen offset:3072 sc1
    s_add_u32 s43, s43, 4096
    buffer_store_dwordx4 v[8:11], v5, s[8:11], s43 offen offset:0 sc1
    buffer_store_dwordx4 v[8:11], v5, s[8:11], s43 offen offset:1024 sc1
    s_waitcnt vmcnt(38)
    s_barrier
    s_cmp_eq_u32 s3, 0
    s_cbranch_scc0 interleave_layers__linear_attn_block__memory_aug_recurrent_mem_tr__prompt_kernel_pb14
    v_lshlrev_b32 v14, 7, v1
    v_add_u32 v14, s42, v14
    v_mov_b32 v15, 2146435072
    v_cmp_le_u32 vcc, 8, v1
    s_nop 1
    v_cndmask_b32 v14, v14, v15, vcc
    v_mov_b32 v15, s40
    buffer_store_dword v15, v14, s[8:11], 0 offen sc1
interleave_layers__linear_attn_block__memory_aug_recurrent_mem_tr__prompt_kernel_pb14:
    s_add_u32 s40, s40, 1
    s_add_u32 s41, s41, 458752
    s_cmp_lt_u32 s40, 128
    s_cbranch_scc1 interleave_layers__linear_attn_block__memory_aug_recurrent_mem_tr__prompt_kernel_clr_blk
    s_waitcnt vmcnt(0)
    s_barrier
    s_cmp_eq_u32 s3, 0
    s_cbranch_scc0 interleave_layers__linear_attn_block__memory_aug_recurrent_mem_tr__prompt_kernel_pb15
    v_lshlrev_b32 v14, 7, v1
    v_add_u32 v14, s42, v14
    v_mov_b32 v15, 2146435072
    v_cmp_le_u32 vcc, 8, v1
    s_nop 1
    v_cndmask_b32 v14, v14, v15, vcc
    v_mov_b32 v15, s40
    buffer_store_dword v15, v14, s[8:11], 0 offen sc1
interleave_layers__linear_attn_block__memory_aug_recurrent_mem_tr__prompt_kernel_pb15:
    s_branch interleave_layers__linear_attn_block__memory_aug_recurrent_mem_tr__prompt_kernel_end
interleave_layers__linear_attn_block__memory_aug_recurrent_mem_tr__prompt_kernel_roleS:
    s_mov_b32 s44, s2
    s_load_dwordx2 s[6:7], s[0:1], 40
    s_load_dwordx2 s[24:25], s[0:1], 48
    s_load_dwordx2 s[26:27], s[0:1], 32
    s_waitcnt lgkmcnt(0)
    s_mov_b32 s12, s6
    s_mov_b32 s13, s7
    s_mov_b32 s14, 7864320
    s_mov_b32 s15, 0x00020000
    s_mov_b32 s16, s24
    s_mov_b32 s17, s25
    s_mov_b32 s18, 7864320
    s_mov_b32 s19, 0x00020000
    s_mov_b32 s20, s26
    s_mov_b32 s21, s27
    s_mov_b32 s22, 10240
    s_mov_b32 s23, 0x00020000
    v_add_u32 v16, 0, v0
    s_mov_b32 s24, 683
    v_mul_lo_u32 v17, v16, s24
    v_lshrrev_b32 v17, 14, v17
    v_mul_u32_u24 v18, 24, v17
    v_sub_u32 v18, v16, v18
    s_mov_b32 s24, 12288
    v_mul_lo_u32 v4, v17, s24
    v_lshl_add_u32 v4, v18, 4, v4
    v_mul_u32_u24 v10, 400, v17
    v_lshl_add_u32 v10, v18, 4, v10
    v_add_u32 v10, 106496, v10
    v_add_u32 v16, 256, v0
    s_mov_b32 s24, 683
    v_mul_lo_u32 v17, v16, s24
    v_lshrrev_b32 v17, 14, v17
    v_mul_u32_u24 v18, 24, v17
    v_sub_u32 v18, v16, v18
    s_mov_b32 s24, 12288
    v_mul_lo_u32 v5, v17, s24
    v_lshl_add_u32 v5, v18, 4, v5
    v_mul_u32_u24 v11, 400, v17
    v_lshl_add_u32 v11, v18, 4, v11
    v_add_u32 v11, 106496, v11
    v_add_u32 v16, 512, v0
    s_mov_b32 s24, 683
    v_mul_lo_u32 v17, v16, s24
    v_lshrrev_b32 v17, 14, v17
    v_mul_u32_u24 v18, 24, v17
    v_sub_u32 v18, v16, v18
    s_mov_b32 s24, 12288
    v_mul_lo_u32 v6, v17, s24
    v_lshl_add_u32 v6, v18, 4, v6
    v_mul_u32_u24 v12, 400, v17
    v_lshl_add_u32 v12, v18, 4, v12
    v_add_u32 v12, 106496, v12
    v_add_u32 v16, 768, v0
    s_mov_b32 s24, 683
    v_mul_lo_u32 v17, v16, s24
    v_lshrrev_b32 v17, 14, v17
    v_mul_u32_u24 v18, 24, v17
    v_sub_u32 v18, v16, v18
    s_mov_b32 s24, 12288
    v_mul_lo_u32 v7, v17, s24
    v_lshl_add_u32 v7, v18, 4, v7
    v_mul_u32_u24 v13, 400, v17
    v_lshl_add_u32 v13, v18, 4, v13
    v_add_u32 v13, 106496, v13
    v_add_u32 v16, 1024, v0
    s_mov_b32 s24, 683
    v_mul_lo_u32 v17, v16, s24
    v_lshrrev_b32 v17, 14, v17
    v_mul_u32_u24 v18, 24, v17
    v_sub_u32 v18, v16, v18
    s_mov_b32 s24, 12288
    v_mul_lo_u32 v8, v17, s24
    v_lshl_add_u32 v8, v18, 4, v8
    v_mul_u32_u24 v14, 400, v17
    v_lshl_add_u32 v14, v18, 4, v14
    v_add_u32 v14, 106496, v14
    v_add_u32 v16, 1280, v0
    s_mov_b32 s24, 683
    v_mul_lo_u32 v17, v16, s24
    v_lshrrev_b32 v17, 14, v17
    v_mul_u32_u24 v18, 24, v17
    v_sub_u32 v18, v16, v18
    s_mov_b32 s24, 12288
    v_mul_lo_u32 v9, v17, s24
    v_lshl_add_u32 v9, v18, 4, v9
    v_mul_u32_u24 v15, 400, v17
    v_lshl_add_u32 v15, v18, 4, v15
    v_add_u32 v15, 106496, v15
    v_lshrrev_b32 v17, 1, v3
    v_lshlrev_b32 v17, 4, v17
    v_and_b32 v18, 1, v3
    v_lshl_add_u32 v17, v18, 2, v17
    v_lshrrev_b32 v18, 2, v2
    v_and_b32 v19, 1, v18
    v_add_u32 v17, v17, v19
    v_lshrrev_b32 v18, 1, v18
    v_lshl_add_u32 v17, v18, 3, v17
    v_mul_u32_u24 v16, 400, v17
    v_and_b32 v18, 3, v2
    v_lshl_add_u32 v16, v18, 3, v16
    v_add_u32 v16, 106496, v16
    s_mul_i32 s24, s3, 96
    v_add_u32 v16, s24, v16
    v_lshlrev_b32 v17, 4, v1
    s_mul_i32 s24, s3, 20480
    s_add_u32 s24, s24, 24576
    v_add_u32 v17, s24, v17
    s_mul_i32 s45, s44, 384
    s_add_u32 s46, s45, 0
    buffer_load_dwordx4 v[24:27], v4, s[12:15], s46 offen
    buffer_load_dwordx4 v[28:31], v5, s[12:15], s46 offen
    buffer_load_dwordx4 v[32:35], v6, s[12:15], s46 offen
    buffer_load_dwordx4 v[36:39], v7, s[12:15], s46 offen
    buffer_load_dwordx4 v[40:43], v8, s[12:15], s46 offen
    buffer_load_dwordx4 v[44:47], v9, s[12:15], s46 offen
    s_add_u32 s46, s45, 0
    buffer_load_dwordx4 v[48:51], v4, s[16:19], s46 offen
    buffer_load_dwordx4 v[52:55], v5, s[16:19], s46 offen
    buffer_load_dwordx4 v[56:59], v6, s[16:19], s46 offen
    buffer_load_dwordx4 v[60:63], v7, s[16:19], s46 offen
    buffer_load_dwordx4 v[64:67], v8, s[16:19], s46 offen
    buffer_load_dwordx4 v[68:71], v9, s[16:19], s46 offen
    s_waitcnt vmcnt(6)
    ds_write_b128 v10, v[24:27]
    ds_write_b128 v11, v[28:31]
    ds_write_b128 v12, v[32:35]
    ds_write_b128 v13, v[36:39]
    ds_write_b128 v14, v[40:43]
    ds_write_b128 v15, v[44:47]
    s_add_u32 s46, s45, 786432
    buffer_load_dwordx4 v[72:75], v4, s[12:15], s46 offen
    buffer_load_dwordx4 v[76:79], v5, s[12:15], s46 offen
    buffer_load_dwordx4 v[80:83], v6, s[12:15], s46 offen
    buffer_load_dwordx4 v[84:87], v7, s[12:15], s46 offen
    buffer_load_dwordx4 v[88:91], v8, s[12:15], s46 offen
    buffer_load_dwordx4 v[92:95], v9, s[12:15], s46 offen
    s_waitcnt lgkmcnt(0)
    s_barrier
    ds_read_b64_tr_b16 a[0:1], v16 offset:0
    ds_read_b64_tr_b16 a[2:3], v16 offset:800
    ds_read_b64_tr_b16 a[4:5], v16 offset:12800
    ds_read_b64_tr_b16 a[6:7], v16 offset:13600
    ds_read_b64_tr_b16 a[80:81], v16 offset:32
    ds_read_b64_tr_b16 a[82:83], v16 offset:832
    ds_read_b64_tr_b16 a[84:85], v16 offset:12832
    ds_read_b64_tr_b16 a[86:87], v16 offset:13632
    ds_read_b64_tr_b16 a[160:161], v16 offset:64
    ds_read_b64_tr_b16 a[162:163], v16 offset:864
    ds_read_b64_tr_b16 a[164:165], v16 offset:12864
    ds_read_b64_tr_b16 a[166:167], v16 offset:13664
    s_waitcnt lgkmcnt(0)
    s_barrier
    s_waitcnt vmcnt(6)
    ds_write_b128 v10, v[48:51]
    ds_write_b128 v11, v[52:55]
    ds_write_b128 v12, v[56:59]
    ds_write_b128 v13, v[60:63]
    ds_write_b128 v14, v[64:67]
    ds_write_b128 v15, v[68:71]
    s_add_u32 s46, s45, 786432
    buffer_load_dwordx4 v[24:27], v4, s[16:19], s46 offen
    buffer_load_dwordx4 v[28:31], v5, s[16:19], s46 offen
    buffer_load_dwordx4 v[32:35], v6, s[16:19], s46 offen
    buffer_load_dwordx4 v[36:39], v7, s[16:19], s46 offen
    buffer_load_dwordx4 v[40:43], v8, s[16:19], s46 offen
    buffer_load_dwordx4 v[44:47], v9, s[16:19], s46 offen
    s_waitcnt lgkmcnt(0)
    s_barrier
    ds_read_b64_tr_b16 v[96:97], v16 offset:32
    ds_read_b64_tr_b16 v[98:99], v16 offset:832
    ds_read_b64_tr_b16 v[100:101], v16 offset:12832
    ds_read_b64_tr_b16 v[102:103], v16 offset:13632
    ds_read_b64_tr_b16 v[176:177], v16 offset:64
    ds_read_b64_tr_b16 v[178:179], v16 offset:864
    ds_read_b64_tr_b16 v[180:181], v16 offset:12864
    ds_read_b64_tr_b16 v[182:183], v16 offset:13664
    ds_read_b64_tr_b16 v[48:49], v16 offset:0
    ds_read_b64_tr_b16 v[50:51], v16 offset:800
    ds_read_b64_tr_b16 v[52:53], v16 offset:12800
    ds_read_b64_tr_b16 v[54:55], v16 offset:13600
    s_waitcnt lgkmcnt(0)
    ds_write_b128 v17, v[48:51] offset:0
    ds_write_b128 v17, v[52:55] offset:1024
    s_waitcnt lgkmcnt(0)
    s_barrier
    s_waitcnt vmcnt(6)
    ds_write_b128 v10, v[72:75]
    ds_write_b128 v11, v[76:79]
    ds_write_b128 v12, v[80:83]
    ds_write_b128 v13, v[84:87]
    ds_write_b128 v14, v[88:91]
    ds_write_b128 v15, v[92:95]
    s_add_u32 s46, s45, 1572864
    buffer_load_dwordx4 v[48:51], v4, s[12:15], s46 offen
    buffer_load_dwordx4 v[52:55], v5, s[12:15], s46 offen
    buffer_load_dwordx4 v[56:59], v6, s[12:15], s46 offen
    buffer_load_dwordx4 v[60:63], v7, s[12:15], s46 offen
    buffer_load_dwordx4 v[64:67], v8, s[12:15], s46 offen
    buffer_load_dwordx4 v[68:71], v9, s[12:15], s46 offen
    s_waitcnt lgkmcnt(0)
    s_barrier
    ds_read_b64_tr_b16 a[8:9], v16 offset:0
    ds_read_b64_tr_b16 a[10:11], v16 offset:800
    ds_read_b64_tr_b16 a[12:13], v16 offset:12800
    ds_read_b64_tr_b16 a[14:15], v16 offset:13600
    ds_read_b64_tr_b16 a[88:89], v16 offset:32
    ds_read_b64_tr_b16 a[90:91], v16 offset:832
    ds_read_b64_tr_b16 a[92:93], v16 offset:12832
    ds_read_b64_tr_b16 a[94:95], v16 offset:13632
    ds_read_b64_tr_b16 a[168:169], v16 offset:64
    ds_read_b64_tr_b16 a[170:171], v16 offset:864
    ds_read_b64_tr_b16 a[172:173], v16 offset:12864
    ds_read_b64_tr_b16 a[174:175], v16 offset:13664
    s_waitcnt lgkmcnt(0)
    s_barrier
    s_waitcnt vmcnt(6)
    ds_write_b128 v10, v[24:27]
    ds_write_b128 v11, v[28:31]
    ds_write_b128 v12, v[32:35]
    ds_write_b128 v13, v[36:39]
    ds_write_b128 v14, v[40:43]
    ds_write_b128 v15, v[44:47]
    s_add_u32 s46, s45, 1572864
    buffer_load_dwordx4 v[72:75], v4, s[16:19], s46 offen
    buffer_load_dwordx4 v[76:79], v5, s[16:19], s46 offen
    buffer_load_dwordx4 v[80:83], v6, s[16:19], s46 offen
    buffer_load_dwordx4 v[84:87], v7, s[16:19], s46 offen
    buffer_load_dwordx4 v[88:91], v8, s[16:19], s46 offen
    buffer_load_dwordx4 v[92:95], v9, s[16:19], s46 offen
    s_waitcnt lgkmcnt(0)
    s_barrier
    ds_read_b64_tr_b16 v[104:105], v16 offset:32
    ds_read_b64_tr_b16 v[106:107], v16 offset:832
    ds_read_b64_tr_b16 v[108:109], v16 offset:12832
    ds_read_b64_tr_b16 v[110:111], v16 offset:13632
    ds_read_b64_tr_b16 v[184:185], v16 offset:64
    ds_read_b64_tr_b16 v[186:187], v16 offset:864
    ds_read_b64_tr_b16 v[188:189], v16 offset:12864
    ds_read_b64_tr_b16 v[190:191], v16 offset:13664
    ds_read_b64_tr_b16 v[24:25], v16 offset:0
    ds_read_b64_tr_b16 v[26:27], v16 offset:800
    ds_read_b64_tr_b16 v[28:29], v16 offset:12800
    ds_read_b64_tr_b16 v[30:31], v16 offset:13600
    s_waitcnt lgkmcnt(0)
    ds_write_b128 v17, v[24:27] offset:2048
    ds_write_b128 v17, v[28:31] offset:3072
    s_waitcnt lgkmcnt(0)
    s_barrier
    s_waitcnt vmcnt(6)
    ds_write_b128 v10, v[48:51]
    ds_write_b128 v11, v[52:55]
    ds_write_b128 v12, v[56:59]
    ds_write_b128 v13, v[60:63]
    ds_write_b128 v14, v[64:67]
    ds_write_b128 v15, v[68:71]
    s_add_u32 s46, s45, 2359296
    buffer_load_dwordx4 v[24:27], v4, s[12:15], s46 offen
    buffer_load_dwordx4 v[28:31], v5, s[12:15], s46 offen
    buffer_load_dwordx4 v[32:35], v6, s[12:15], s46 offen
    buffer_load_dwordx4 v[36:39], v7, s[12:15], s46 offen
    buffer_load_dwordx4 v[40:43], v8, s[12:15], s46 offen
    buffer_load_dwordx4 v[44:47], v9, s[12:15], s46 offen
    s_waitcnt lgkmcnt(0)
    s_barrier
    ds_read_b64_tr_b16 a[16:17], v16 offset:0
    ds_read_b64_tr_b16 a[18:19], v16 offset:800
    ds_read_b64_tr_b16 a[20:21], v16 offset:12800
    ds_read_b64_tr_b16 a[22:23], v16 offset:13600
    ds_read_b64_tr_b16 a[96:97], v16 offset:32
    ds_read_b64_tr_b16 a[98:99], v16 offset:832
    ds_read_b64_tr_b16 a[100:101], v16 offset:12832
    ds_read_b64_tr_b16 a[102:103], v16 offset:13632
    ds_read_b64_tr_b16 a[176:177], v16 offset:64
    ds_read_b64_tr_b16 a[178:179], v16 offset:864
    ds_read_b64_tr_b16 a[180:181], v16 offset:12864
    ds_read_b64_tr_b16 a[182:183], v16 offset:13664
    s_waitcnt lgkmcnt(0)
    s_barrier
    s_waitcnt vmcnt(6)
    ds_write_b128 v10, v[72:75]
    ds_write_b128 v11, v[76:79]
    ds_write_b128 v12, v[80:83]
    ds_write_b128 v13, v[84:87]
    ds_write_b128 v14, v[88:91]
    ds_write_b128 v15, v[92:95]
    s_add_u32 s46, s45, 2359296
    buffer_load_dwordx4 v[48:51], v4, s[16:19], s46 offen
    buffer_load_dwordx4 v[52:55], v5, s[16:19], s46 offen
    buffer_load_dwordx4 v[56:59], v6, s[16:19], s46 offen
    buffer_load_dwordx4 v[60:63], v7, s[16:19], s46 offen
    buffer_load_dwordx4 v[64:67], v8, s[16:19], s46 offen
    buffer_load_dwordx4 v[68:71], v9, s[16:19], s46 offen
    s_waitcnt lgkmcnt(0)
    s_barrier
    ds_read_b64_tr_b16 v[112:113], v16 offset:32
    ds_read_b64_tr_b16 v[114:115], v16 offset:832
    ds_read_b64_tr_b16 v[116:117], v16 offset:12832
    ds_read_b64_tr_b16 v[118:119], v16 offset:13632
    ds_read_b64_tr_b16 v[192:193], v16 offset:64
    ds_read_b64_tr_b16 v[194:195], v16 offset:864
    ds_read_b64_tr_b16 v[196:197], v16 offset:12864
    ds_read_b64_tr_b16 v[198:199], v16 offset:13664
    ds_read_b64_tr_b16 v[72:73], v16 offset:0
    ds_read_b64_tr_b16 v[74:75], v16 offset:800
    ds_read_b64_tr_b16 v[76:77], v16 offset:12800
    ds_read_b64_tr_b16 v[78:79], v16 offset:13600
    s_waitcnt lgkmcnt(0)
    ds_write_b128 v17, v[72:75] offset:4096
    ds_write_b128 v17, v[76:79] offset:5120
    s_waitcnt lgkmcnt(0)
    s_barrier
    s_waitcnt vmcnt(6)
    ds_write_b128 v10, v[24:27]
    ds_write_b128 v11, v[28:31]
    ds_write_b128 v12, v[32:35]
    ds_write_b128 v13, v[36:39]
    ds_write_b128 v14, v[40:43]
    ds_write_b128 v15, v[44:47]
    s_add_u32 s46, s45, 3145728
    buffer_load_dwordx4 v[72:75], v4, s[12:15], s46 offen
    buffer_load_dwordx4 v[76:79], v5, s[12:15], s46 offen
    buffer_load_dwordx4 v[80:83], v6, s[12:15], s46 offen
    buffer_load_dwordx4 v[84:87], v7, s[12:15], s46 offen
    buffer_load_dwordx4 v[88:91], v8, s[12:15], s46 offen
    buffer_load_dwordx4 v[92:95], v9, s[12:15], s46 offen
    s_waitcnt lgkmcnt(0)
    s_barrier
    ds_read_b64_tr_b16 a[24:25], v16 offset:0
    ds_read_b64_tr_b16 a[26:27], v16 offset:800
    ds_read_b64_tr_b16 a[28:29], v16 offset:12800
    ds_read_b64_tr_b16 a[30:31], v16 offset:13600
    ds_read_b64_tr_b16 a[104:105], v16 offset:32
    ds_read_b64_tr_b16 a[106:107], v16 offset:832
    ds_read_b64_tr_b16 a[108:109], v16 offset:12832
    ds_read_b64_tr_b16 a[110:111], v16 offset:13632
    ds_read_b64_tr_b16 a[184:185], v16 offset:64
    ds_read_b64_tr_b16 a[186:187], v16 offset:864
    ds_read_b64_tr_b16 a[188:189], v16 offset:12864
    ds_read_b64_tr_b16 a[190:191], v16 offset:13664
    s_waitcnt lgkmcnt(0)
    s_barrier
    s_waitcnt vmcnt(6)
    ds_write_b128 v10, v[48:51]
    ds_write_b128 v11, v[52:55]
    ds_write_b128 v12, v[56:59]
    ds_write_b128 v13, v[60:63]
    ds_write_b128 v14, v[64:67]
    ds_write_b128 v15, v[68:71]
    s_add_u32 s46, s45, 3145728
    buffer_load_dwordx4 v[24:27], v4, s[16:19], s46 offen
    buffer_load_dwordx4 v[28:31], v5, s[16:19], s46 offen
    buffer_load_dwordx4 v[32:35], v6, s[16:19], s46 offen
    buffer_load_dwordx4 v[36:39], v7, s[16:19], s46 offen
    buffer_load_dwordx4 v[40:43], v8, s[16:19], s46 offen
    buffer_load_dwordx4 v[44:47], v9, s[16:19], s46 offen
    s_waitcnt lgkmcnt(0)
    s_barrier
    ds_read_b64_tr_b16 v[120:121], v16 offset:32
    ds_read_b64_tr_b16 v[122:123], v16 offset:832
    ds_read_b64_tr_b16 v[124:125], v16 offset:12832
    ds_read_b64_tr_b16 v[126:127], v16 offset:13632
    ds_read_b64_tr_b16 v[200:201], v16 offset:64
    ds_read_b64_tr_b16 v[202:203], v16 offset:864
    ds_read_b64_tr_b16 v[204:205], v16 offset:12864
    ds_read_b64_tr_b16 v[206:207], v16 offset:13664
    ds_read_b64_tr_b16 v[48:49], v16 offset:0
    ds_read_b64_tr_b16 v[50:51], v16 offset:800
    ds_read_b64_tr_b16 v[52:53], v16 offset:12800
    ds_read_b64_tr_b16 v[54:55], v16 offset:13600
    s_waitcnt lgkmcnt(0)
    ds_write_b128 v17, v[48:51] offset:6144
    ds_write_b128 v17, v[52:55] offset:7168
    s_waitcnt lgkmcnt(0)
    s_barrier
    s_waitcnt vmcnt(6)
    ds_write_b128 v10, v[72:75]
    ds_write_b128 v11, v[76:79]
    ds_write_b128 v12, v[80:83]
    ds_write_b128 v13, v[84:87]
    ds_write_b128 v14, v[88:91]
    ds_write_b128 v15, v[92:95]
    s_add_u32 s46, s45, 3932160
    buffer_load_dwordx4 v[48:51], v4, s[12:15], s46 offen
    buffer_load_dwordx4 v[52:55], v5, s[12:15], s46 offen
    buffer_load_dwordx4 v[56:59], v6, s[12:15], s46 offen
    buffer_load_dwordx4 v[60:63], v7, s[12:15], s46 offen
    buffer_load_dwordx4 v[64:67], v8, s[12:15], s46 offen
    buffer_load_dwordx4 v[68:71], v9, s[12:15], s46 offen
    s_waitcnt lgkmcnt(0)
    s_barrier
    ds_read_b64_tr_b16 a[32:33], v16 offset:0
    ds_read_b64_tr_b16 a[34:35], v16 offset:800
    ds_read_b64_tr_b16 a[36:37], v16 offset:12800
    ds_read_b64_tr_b16 a[38:39], v16 offset:13600
    ds_read_b64_tr_b16 a[112:113], v16 offset:32
    ds_read_b64_tr_b16 a[114:115], v16 offset:832
    ds_read_b64_tr_b16 a[116:117], v16 offset:12832
    ds_read_b64_tr_b16 a[118:119], v16 offset:13632
    ds_read_b64_tr_b16 a[192:193], v16 offset:64
    ds_read_b64_tr_b16 a[194:195], v16 offset:864
    ds_read_b64_tr_b16 a[196:197], v16 offset:12864
    ds_read_b64_tr_b16 a[198:199], v16 offset:13664
    s_waitcnt lgkmcnt(0)
    s_barrier
    s_waitcnt vmcnt(6)
    ds_write_b128 v10, v[24:27]
    ds_write_b128 v11, v[28:31]
    ds_write_b128 v12, v[32:35]
    ds_write_b128 v13, v[36:39]
    ds_write_b128 v14, v[40:43]
    ds_write_b128 v15, v[44:47]
    s_add_u32 s46, s45, 3932160
    buffer_load_dwordx4 v[72:75], v4, s[16:19], s46 offen
    buffer_load_dwordx4 v[76:79], v5, s[16:19], s46 offen
    buffer_load_dwordx4 v[80:83], v6, s[16:19], s46 offen
    buffer_load_dwordx4 v[84:87], v7, s[16:19], s46 offen
    buffer_load_dwordx4 v[88:91], v8, s[16:19], s46 offen
    buffer_load_dwordx4 v[92:95], v9, s[16:19], s46 offen
    s_waitcnt lgkmcnt(0)
    s_barrier
    ds_read_b64_tr_b16 v[128:129], v16 offset:32
    ds_read_b64_tr_b16 v[130:131], v16 offset:832
    ds_read_b64_tr_b16 v[132:133], v16 offset:12832
    ds_read_b64_tr_b16 v[134:135], v16 offset:13632
    ds_read_b64_tr_b16 v[208:209], v16 offset:64
    ds_read_b64_tr_b16 v[210:211], v16 offset:864
    ds_read_b64_tr_b16 v[212:213], v16 offset:12864
    ds_read_b64_tr_b16 v[214:215], v16 offset:13664
    ds_read_b64_tr_b16 v[24:25], v16 offset:0
    ds_read_b64_tr_b16 v[26:27], v16 offset:800
    ds_read_b64_tr_b16 v[28:29], v16 offset:12800
    ds_read_b64_tr_b16 v[30:31], v16 offset:13600
    s_waitcnt lgkmcnt(0)
    ds_write_b128 v17, v[24:27] offset:8192
    ds_write_b128 v17, v[28:31] offset:9216
    s_waitcnt lgkmcnt(0)
    s_barrier
    s_waitcnt vmcnt(6)
    ds_write_b128 v10, v[48:51]
    ds_write_b128 v11, v[52:55]
    ds_write_b128 v12, v[56:59]
    ds_write_b128 v13, v[60:63]
    ds_write_b128 v14, v[64:67]
    ds_write_b128 v15, v[68:71]
    s_add_u32 s46, s45, 4718592
    buffer_load_dwordx4 v[24:27], v4, s[12:15], s46 offen
    buffer_load_dwordx4 v[28:31], v5, s[12:15], s46 offen
    buffer_load_dwordx4 v[32:35], v6, s[12:15], s46 offen
    buffer_load_dwordx4 v[36:39], v7, s[12:15], s46 offen
    buffer_load_dwordx4 v[40:43], v8, s[12:15], s46 offen
    buffer_load_dwordx4 v[44:47], v9, s[12:15], s46 offen
    s_waitcnt lgkmcnt(0)
    s_barrier
    ds_read_b64_tr_b16 a[40:41], v16 offset:0
    ds_read_b64_tr_b16 a[42:43], v16 offset:800
    ds_read_b64_tr_b16 a[44:45], v16 offset:12800
    ds_read_b64_tr_b16 a[46:47], v16 offset:13600
    ds_read_b64_tr_b16 a[120:121], v16 offset:32
    ds_read_b64_tr_b16 a[122:123], v16 offset:832
    ds_read_b64_tr_b16 a[124:125], v16 offset:12832
    ds_read_b64_tr_b16 a[126:127], v16 offset:13632
    ds_read_b64_tr_b16 a[200:201], v16 offset:64
    ds_read_b64_tr_b16 a[202:203], v16 offset:864
    ds_read_b64_tr_b16 a[204:205], v16 offset:12864
    ds_read_b64_tr_b16 a[206:207], v16 offset:13664
    s_waitcnt lgkmcnt(0)
    s_barrier
    s_waitcnt vmcnt(6)
    ds_write_b128 v10, v[72:75]
    ds_write_b128 v11, v[76:79]
    ds_write_b128 v12, v[80:83]
    ds_write_b128 v13, v[84:87]
    ds_write_b128 v14, v[88:91]
    ds_write_b128 v15, v[92:95]
    s_add_u32 s46, s45, 4718592
    buffer_load_dwordx4 v[48:51], v4, s[16:19], s46 offen
    buffer_load_dwordx4 v[52:55], v5, s[16:19], s46 offen
    buffer_load_dwordx4 v[56:59], v6, s[16:19], s46 offen
    buffer_load_dwordx4 v[60:63], v7, s[16:19], s46 offen
    buffer_load_dwordx4 v[64:67], v8, s[16:19], s46 offen
    buffer_load_dwordx4 v[68:71], v9, s[16:19], s46 offen
    s_waitcnt lgkmcnt(0)
    s_barrier
    ds_read_b64_tr_b16 v[136:137], v16 offset:32
    ds_read_b64_tr_b16 v[138:139], v16 offset:832
    ds_read_b64_tr_b16 v[140:141], v16 offset:12832
    ds_read_b64_tr_b16 v[142:143], v16 offset:13632
    ds_read_b64_tr_b16 v[216:217], v16 offset:64
    ds_read_b64_tr_b16 v[218:219], v16 offset:864
    ds_read_b64_tr_b16 v[220:221], v16 offset:12864
    ds_read_b64_tr_b16 v[222:223], v16 offset:13664
    ds_read_b64_tr_b16 v[72:73], v16 offset:0
    ds_read_b64_tr_b16 v[74:75], v16 offset:800
    ds_read_b64_tr_b16 v[76:77], v16 offset:12800
    ds_read_b64_tr_b16 v[78:79], v16 offset:13600
    s_waitcnt lgkmcnt(0)
    ds_write_b128 v17, v[72:75] offset:10240
    ds_write_b128 v17, v[76:79] offset:11264
    s_waitcnt lgkmcnt(0)
    s_barrier
    s_waitcnt vmcnt(6)
    ds_write_b128 v10, v[24:27]
    ds_write_b128 v11, v[28:31]
    ds_write_b128 v12, v[32:35]
    ds_write_b128 v13, v[36:39]
    ds_write_b128 v14, v[40:43]
    ds_write_b128 v15, v[44:47]
    s_add_u32 s46, s45, 5505024
    buffer_load_dwordx4 v[72:75], v4, s[12:15], s46 offen
    buffer_load_dwordx4 v[76:79], v5, s[12:15], s46 offen
    buffer_load_dwordx4 v[80:83], v6, s[12:15], s46 offen
    buffer_load_dwordx4 v[84:87], v7, s[12:15], s46 offen
    buffer_load_dwordx4 v[88:91], v8, s[12:15], s46 offen
    buffer_load_dwordx4 v[92:95], v9, s[12:15], s46 offen
    s_waitcnt lgkmcnt(0)
    s_barrier
    ds_read_b64_tr_b16 a[48:49], v16 offset:0
    ds_read_b64_tr_b16 a[50:51], v16 offset:800
    ds_read_b64_tr_b16 a[52:53], v16 offset:12800
    ds_read_b64_tr_b16 a[54:55], v16 offset:13600
    ds_read_b64_tr_b16 a[128:129], v16 offset:32
    ds_read_b64_tr_b16 a[130:131], v16 offset:832
    ds_read_b64_tr_b16 a[132:133], v16 offset:12832
    ds_read_b64_tr_b16 a[134:135], v16 offset:13632
    ds_read_b64_tr_b16 a[208:209], v16 offset:64
    ds_read_b64_tr_b16 a[210:211], v16 offset:864
    ds_read_b64_tr_b16 a[212:213], v16 offset:12864
    ds_read_b64_tr_b16 a[214:215], v16 offset:13664
    s_waitcnt lgkmcnt(0)
    s_barrier
    s_waitcnt vmcnt(6)
    ds_write_b128 v10, v[48:51]
    ds_write_b128 v11, v[52:55]
    ds_write_b128 v12, v[56:59]
    ds_write_b128 v13, v[60:63]
    ds_write_b128 v14, v[64:67]
    ds_write_b128 v15, v[68:71]
    s_add_u32 s46, s45, 5505024
    buffer_load_dwordx4 v[24:27], v4, s[16:19], s46 offen
    buffer_load_dwordx4 v[28:31], v5, s[16:19], s46 offen
    buffer_load_dwordx4 v[32:35], v6, s[16:19], s46 offen
    buffer_load_dwordx4 v[36:39], v7, s[16:19], s46 offen
    buffer_load_dwordx4 v[40:43], v8, s[16:19], s46 offen
    buffer_load_dwordx4 v[44:47], v9, s[16:19], s46 offen
    s_waitcnt lgkmcnt(0)
    s_barrier
    ds_read_b64_tr_b16 v[144:145], v16 offset:32
    ds_read_b64_tr_b16 v[146:147], v16 offset:832
    ds_read_b64_tr_b16 v[148:149], v16 offset:12832
    ds_read_b64_tr_b16 v[150:151], v16 offset:13632
    ds_read_b64_tr_b16 v[224:225], v16 offset:64
    ds_read_b64_tr_b16 v[226:227], v16 offset:864
    ds_read_b64_tr_b16 v[228:229], v16 offset:12864
    ds_read_b64_tr_b16 v[230:231], v16 offset:13664
    ds_read_b64_tr_b16 v[48:49], v16 offset:0
    ds_read_b64_tr_b16 v[50:51], v16 offset:800
    ds_read_b64_tr_b16 v[52:53], v16 offset:12800
    ds_read_b64_tr_b16 v[54:55], v16 offset:13600
    s_waitcnt lgkmcnt(0)
    ds_write_b128 v17, v[48:51] offset:12288
    ds_write_b128 v17, v[52:55] offset:13312
    s_waitcnt lgkmcnt(0)
    s_barrier
    s_waitcnt vmcnt(6)
    ds_write_b128 v10, v[72:75]
    ds_write_b128 v11, v[76:79]
    ds_write_b128 v12, v[80:83]
    ds_write_b128 v13, v[84:87]
    ds_write_b128 v14, v[88:91]
    ds_write_b128 v15, v[92:95]
    s_add_u32 s46, s45, 6291456
    buffer_load_dwordx4 v[48:51], v4, s[12:15], s46 offen
    buffer_load_dwordx4 v[52:55], v5, s[12:15], s46 offen
    buffer_load_dwordx4 v[56:59], v6, s[12:15], s46 offen
    buffer_load_dwordx4 v[60:63], v7, s[12:15], s46 offen
    buffer_load_dwordx4 v[64:67], v8, s[12:15], s46 offen
    buffer_load_dwordx4 v[68:71], v9, s[12:15], s46 offen
    s_waitcnt lgkmcnt(0)
    s_barrier
    ds_read_b64_tr_b16 a[56:57], v16 offset:0
    ds_read_b64_tr_b16 a[58:59], v16 offset:800
    ds_read_b64_tr_b16 a[60:61], v16 offset:12800
    ds_read_b64_tr_b16 a[62:63], v16 offset:13600
    ds_read_b64_tr_b16 a[136:137], v16 offset:32
    ds_read_b64_tr_b16 a[138:139], v16 offset:832
    ds_read_b64_tr_b16 a[140:141], v16 offset:12832
    ds_read_b64_tr_b16 a[142:143], v16 offset:13632
    ds_read_b64_tr_b16 a[216:217], v16 offset:64
    ds_read_b64_tr_b16 a[218:219], v16 offset:864
    ds_read_b64_tr_b16 a[220:221], v16 offset:12864
    ds_read_b64_tr_b16 a[222:223], v16 offset:13664
    s_waitcnt lgkmcnt(0)
    s_barrier
    s_waitcnt vmcnt(6)
    ds_write_b128 v10, v[24:27]
    ds_write_b128 v11, v[28:31]
    ds_write_b128 v12, v[32:35]
    ds_write_b128 v13, v[36:39]
    ds_write_b128 v14, v[40:43]
    ds_write_b128 v15, v[44:47]
    s_add_u32 s46, s45, 6291456
    buffer_load_dwordx4 v[72:75], v4, s[16:19], s46 offen
    buffer_load_dwordx4 v[76:79], v5, s[16:19], s46 offen
    buffer_load_dwordx4 v[80:83], v6, s[16:19], s46 offen
    buffer_load_dwordx4 v[84:87], v7, s[16:19], s46 offen
    buffer_load_dwordx4 v[88:91], v8, s[16:19], s46 offen
    buffer_load_dwordx4 v[92:95], v9, s[16:19], s46 offen
    s_waitcnt lgkmcnt(0)
    s_barrier
    ds_read_b64_tr_b16 v[152:153], v16 offset:32
    ds_read_b64_tr_b16 v[154:155], v16 offset:832
    ds_read_b64_tr_b16 v[156:157], v16 offset:12832
    ds_read_b64_tr_b16 v[158:159], v16 offset:13632
    ds_read_b64_tr_b16 v[232:233], v16 offset:64
    ds_read_b64_tr_b16 v[234:235], v16 offset:864
    ds_read_b64_tr_b16 v[236:237], v16 offset:12864
    ds_read_b64_tr_b16 v[238:239], v16 offset:13664
    ds_read_b64_tr_b16 v[24:25], v16 offset:0
    ds_read_b64_tr_b16 v[26:27], v16 offset:800
    ds_read_b64_tr_b16 v[28:29], v16 offset:12800
    ds_read_b64_tr_b16 v[30:31], v16 offset:13600
    s_waitcnt lgkmcnt(0)
    ds_write_b128 v17, v[24:27] offset:14336
    ds_write_b128 v17, v[28:31] offset:15360
    s_waitcnt lgkmcnt(0)
    s_barrier
    s_waitcnt vmcnt(6)
    ds_write_b128 v10, v[48:51]
    ds_write_b128 v11, v[52:55]
    ds_write_b128 v12, v[56:59]
    ds_write_b128 v13, v[60:63]
    ds_write_b128 v14, v[64:67]
    ds_write_b128 v15, v[68:71]
    s_add_u32 s46, s45, 7077888
    buffer_load_dwordx4 v[24:27], v4, s[12:15], s46 offen
    buffer_load_dwordx4 v[28:31], v5, s[12:15], s46 offen
    buffer_load_dwordx4 v[32:35], v6, s[12:15], s46 offen
    buffer_load_dwordx4 v[36:39], v7, s[12:15], s46 offen
    buffer_load_dwordx4 v[40:43], v8, s[12:15], s46 offen
    buffer_load_dwordx4 v[44:47], v9, s[12:15], s46 offen
    s_waitcnt lgkmcnt(0)
    s_barrier
    ds_read_b64_tr_b16 a[64:65], v16 offset:0
    ds_read_b64_tr_b16 a[66:67], v16 offset:800
    ds_read_b64_tr_b16 a[68:69], v16 offset:12800
    ds_read_b64_tr_b16 a[70:71], v16 offset:13600
    ds_read_b64_tr_b16 a[144:145], v16 offset:32
    ds_read_b64_tr_b16 a[146:147], v16 offset:832
    ds_read_b64_tr_b16 a[148:149], v16 offset:12832
    ds_read_b64_tr_b16 a[150:151], v16 offset:13632
    ds_read_b64_tr_b16 a[224:225], v16 offset:64
    ds_read_b64_tr_b16 a[226:227], v16 offset:864
    ds_read_b64_tr_b16 a[228:229], v16 offset:12864
    ds_read_b64_tr_b16 a[230:231], v16 offset:13664
    s_waitcnt lgkmcnt(0)
    s_barrier
    s_waitcnt vmcnt(6)
    ds_write_b128 v10, v[72:75]
    ds_write_b128 v11, v[76:79]
    ds_write_b128 v12, v[80:83]
    ds_write_b128 v13, v[84:87]
    ds_write_b128 v14, v[88:91]
    ds_write_b128 v15, v[92:95]
    s_add_u32 s46, s45, 7077888
    buffer_load_dwordx4 v[48:51], v4, s[16:19], s46 offen
    buffer_load_dwordx4 v[52:55], v5, s[16:19], s46 offen
    buffer_load_dwordx4 v[56:59], v6, s[16:19], s46 offen
    buffer_load_dwordx4 v[60:63], v7, s[16:19], s46 offen
    buffer_load_dwordx4 v[64:67], v8, s[16:19], s46 offen
    buffer_load_dwordx4 v[68:71], v9, s[16:19], s46 offen
    s_waitcnt lgkmcnt(0)
    s_barrier
    ds_read_b64_tr_b16 v[160:161], v16 offset:32
    ds_read_b64_tr_b16 v[162:163], v16 offset:832
    ds_read_b64_tr_b16 v[164:165], v16 offset:12832
    ds_read_b64_tr_b16 v[166:167], v16 offset:13632
    ds_read_b64_tr_b16 v[240:241], v16 offset:64
    ds_read_b64_tr_b16 v[242:243], v16 offset:864
    ds_read_b64_tr_b16 v[244:245], v16 offset:12864
    ds_read_b64_tr_b16 v[246:247], v16 offset:13664
    ds_read_b64_tr_b16 v[72:73], v16 offset:0
    ds_read_b64_tr_b16 v[74:75], v16 offset:800
    ds_read_b64_tr_b16 v[76:77], v16 offset:12800
    ds_read_b64_tr_b16 v[78:79], v16 offset:13600
    s_waitcnt lgkmcnt(0)
    ds_write_b128 v17, v[72:75] offset:16384
    ds_write_b128 v17, v[76:79] offset:17408
    s_waitcnt lgkmcnt(0)
    s_barrier
    s_waitcnt vmcnt(6)
    ds_write_b128 v10, v[24:27]
    ds_write_b128 v11, v[28:31]
    ds_write_b128 v12, v[32:35]
    ds_write_b128 v13, v[36:39]
    ds_write_b128 v14, v[40:43]
    ds_write_b128 v15, v[44:47]
    s_waitcnt lgkmcnt(0)
    s_barrier
    ds_read_b64_tr_b16 a[72:73], v16 offset:0
    ds_read_b64_tr_b16 a[74:75], v16 offset:800
    ds_read_b64_tr_b16 a[76:77], v16 offset:12800
    ds_read_b64_tr_b16 a[78:79], v16 offset:13600
    ds_read_b64_tr_b16 a[152:153], v16 offset:32
    ds_read_b64_tr_b16 a[154:155], v16 offset:832
    ds_read_b64_tr_b16 a[156:157], v16 offset:12832
    ds_read_b64_tr_b16 a[158:159], v16 offset:13632
    ds_read_b64_tr_b16 a[232:233], v16 offset:64
    ds_read_b64_tr_b16 a[234:235], v16 offset:864
    ds_read_b64_tr_b16 a[236:237], v16 offset:12864
    ds_read_b64_tr_b16 a[238:239], v16 offset:13664
    s_waitcnt lgkmcnt(0)
    s_barrier
    s_waitcnt vmcnt(0)
    ds_write_b128 v10, v[48:51]
    ds_write_b128 v11, v[52:55]
    ds_write_b128 v12, v[56:59]
    ds_write_b128 v13, v[60:63]
    ds_write_b128 v14, v[64:67]
    ds_write_b128 v15, v[68:71]
    s_waitcnt lgkmcnt(0)
    s_barrier
    ds_read_b64_tr_b16 v[168:169], v16 offset:32
    ds_read_b64_tr_b16 v[170:171], v16 offset:832
    ds_read_b64_tr_b16 v[172:173], v16 offset:12832
    ds_read_b64_tr_b16 v[174:175], v16 offset:13632
    ds_read_b64_tr_b16 v[248:249], v16 offset:64
    ds_read_b64_tr_b16 v[250:251], v16 offset:864
    ds_read_b64_tr_b16 v[252:253], v16 offset:12864
    ds_read_b64_tr_b16 v[254:255], v16 offset:13664
    ds_read_b64_tr_b16 v[48:49], v16 offset:0
    ds_read_b64_tr_b16 v[50:51], v16 offset:800
    ds_read_b64_tr_b16 v[52:53], v16 offset:12800
    ds_read_b64_tr_b16 v[54:55], v16 offset:13600
    s_waitcnt lgkmcnt(0)
    ds_write_b128 v17, v[48:51] offset:18432
    ds_write_b128 v17, v[52:55] offset:19456
    s_waitcnt lgkmcnt(0)
    s_barrier
    v_mov_b32 v6, v17
    v_mov_b32 v30, 0xeeee
    v_mov_b32 v4, 0x4444
    v_cmp_gt_u32 vcc, 8, v2
    s_nop 1
    v_cndmask_b32 v4, v30, v4, vcc
    v_lshlrev_b32 v5, 4, v1
    s_lshl_b32 s24, s3, 10
    v_add_u32 v7, s24, v5
    s_lshl_b32 s24, s3, 9
    s_add_u32 s24, s24, 8192
    v_lshlrev_b32 v8, 3, v1
    v_add_u32 v8, s24, v8
    v_and_b32 v30, 1, v2
    v_lshlrev_b32 v30, 4, v30
    v_mov_b32 v31, 0x3f80
    v_lshlrev_b32 v31, v30, v31
    v_lshrrev_b32 v30, 2, v2
    v_cmp_eq_u32 vcc, v30, v3
    s_nop 1
    v_cndmask_b32 v31, 0, v31, vcc
    v_and_b32 v30, 2, v2
    v_cmp_eq_u32 vcc, 0, v30
    s_nop 1
    v_cndmask_b32 v10, 0, v31, vcc
    v_cndmask_b32 v11, v31, 0, vcc
    v_add_u32 v33, 22528, v5
    s_mul_i32 s24, s3, 1408
    s_add_u32 s24, s24, 16384
    v_mul_u32_u24 v30, 176, v2
    v_add_u32 v30, s24, v30
    v_lshl_add_u32 v12, v3, 5, v30
    v_cmp_gt_u32 vcc, 8, v2
    s_nop 1
    v_cndmask_b32 v12, v33, v12, vcc
    v_lshl_add_u32 v13, v3, 4, v30
    v_add_u32 v13, 96, v13
    v_cmp_le_u32 s[24:25], 2, v3
    s_and_b64 vcc, vcc, s[24:25]
    v_cndmask_b32 v13, v33, v13, vcc
    s_mul_i32 s24, s3, 5632
    s_add_u32 s24, s24, 106496
    v_mul_u32_u24 v30, 176, v2
    v_add_u32 v30, s24, v30
    v_lshl_add_u32 v16, v3, 5, v30
    v_lshl_add_u32 v17, v3, 4, v30
    v_add_u32 v17, 96, v17
    v_add_u32 v18, 2816, v17
    v_cmp_le_u32 vcc, 2, v3
    s_nop 1
    v_cndmask_b32 v17, v33, v17, vcc
    v_cndmask_b32 v18, v33, v18, vcc
    v_lshrrev_b32 v30, 3, v1
    v_and_b32 v31, 7, v1
    v_min_u32 v32, 4, v31
    v_mul_u32_u24 v14, 176, v30
    v_lshl_add_u32 v14, v32, 5, v14
    s_mul_i32 s24, s3, 1408
    s_add_u32 s24, s24, 106496
    v_add_u32 v21, s24, v14
    v_add_u32 v14, 16384, v14
    v_cmp_gt_u32 s[50:51], 5, v31
    s_lshl_b32 s24, s3, 3
    v_add_u32 v32, s24, v30
    v_lshlrev_b32 v33, 2, v31
    v_sub_u32 v32, v32, v33
    v_mov_b32 v33, 100
    v_cmp_gt_u32 vcc, 4, v31
    s_nop 1
    v_cndmask_b32 v32, v33, v32, vcc
    v_cmp_le_i32 s[64:65], 0, v32
    v_cmp_le_i32 s[66:67], 1, v32
    v_cmp_le_i32 s[68:69], 2, v32
    v_cmp_le_i32 s[70:71], 3, v32
    v_cmp_le_i32 s[72:73], 16, v32
    v_cmp_le_i32 s[74:75], 17, v32
    v_cmp_le_i32 s[76:77], 18, v32
    v_cmp_le_i32 s[78:79], 19, v32
    s_lshr_b32 s24, s44, 1
    s_lshl_b32 s24, s24, 10
    s_and_b32 s25, s44, 1
    s_lshl_b32 s25, s25, 7
    s_add_u32 s24, s24, s25
    v_lshlrev_b32 v15, 8, v31
    v_lshl_add_u32 v15, v30, 4, v15
    v_add_u32 v15, s24, v15
    s_lshr_b32 s24, s44, 3
    s_lshl_b32 s24, s24, 10
    s_and_b32 s25, s44, 3
    s_lshl_b32 s25, s25, 8
    s_add_u32 s24, s24, s25
    s_lshr_b32 s25, s44, 2
    s_and_b32 s25, s25, 1
    s_lshl_b32 s25, s25, 7
    s_add_u32 s24, s24, s25
    s_add_u32 s24, s24, 16384
    v_lshlrev_b32 v32, 4, v30
    v_add_u32 v32, s24, v32
    v_cmp_eq_u32 vcc, 4, v31
    s_nop 1
    v_cndmask_b32 v15, v15, v32, vcc
    v_mov_b32 v32, 2146435072
    v_cndmask_b32 v15, v32, v15, s[50:51]
    s_cmp_lt_u32 s3, 1
    s_cselect_b32 s24, 0, 2146435072
    v_or_b32 v15, s24, v15
    s_and_b32 s24, s3, 1
    s_lshl_b32 s24, s24, 7
    s_lshr_b32 s25, s3, 1
    s_lshl_b32 s25, s25, 10
    s_add_u32 s24, s24, s25
    s_lshl_b32 s25, s44, 11
    s_add_u32 s25, s25, s24
    v_lshlrev_b32 v22, 8, v31
    v_lshl_add_u32 v22, v30, 4, v22
    v_add_u32 v22, s25, v22
    s_lshr_b32 s25, s44, 2
    s_lshl_b32 s25, s25, 11
    s_add_u32 s25, s25, s24
    s_and_b32 s26, s44, 3
    s_lshl_b32 s26, s26, 8
    s_add_u32 s25, s25, s26
    s_add_u32 s25, s25, 65536
    v_lshlrev_b32 v32, 4, v30
    v_add_u32 v32, s25, v32
    v_cmp_eq_u32 vcc, 4, v31
    s_nop 1
    v_cndmask_b32 v22, v22, v32, vcc
    v_mov_b32 v32, 2146435072
    v_cndmask_b32 v22, v32, v22, s[50:51]
    s_mul_i32 s24, s44, 12288
    s_mul_i32 s25, s3, 3072
    s_add_u32 s24, s24, s25
    v_add_u32 v19, s24, v5
    s_and_b32 s24, s2, 15
    s_mul_i32 s25, s3, 16
    s_add_u32 s24, s24, s25
    s_lshl_b32 s24, s24, 7
    v_mov_b32 v23, s24
    s_lshr_b32 s25, s44, 3
    s_mul_i32 s24, s25, 8
    v_add_u32 v20, s24, v1
    v_lshlrev_b32 v20, 7, v20
    v_mov_b32 v30, 2146435072
    v_cmp_le_u32 vcc, 8, v1
    s_nop 1
    v_cndmask_b32 v20, v20, v30, vcc
    s_cmp_eq_u32 s3, 0
    s_cselect_b32 s24, 0, 2146435072
    v_or_b32 v20, s24, v20
    v_mov_b32 v0, 1
interleave_layers__linear_attn_block__memory_aug_recurrent_mem_tr__prompt_kernel_s_layer:
    s_mul_i32 s93, s92, 29360128
    s_add_u32 s93, s93, 117440512
    s_mul_i32 s94, s92, 16384
    s_add_u32 s94, s94, 23068672
    v_and_b32 v9, 1, v1
    v_lshlrev_b32 v9, 12, v9
    s_lshl_b32 s24, s44, 7
    s_add_u32 s24, s24, s94
    v_add_u32 v9, s24, v9
    s_lshl_b32 s24, s3, 6
    s_add_u32 s24, s24, 0
    v_add_u32 v48, s24, v1
    v_and_b32 v49, 7, v48
    v_mul_u32_u24 v49, 1280, v49
    v_lshrrev_b32 v50, 3, v48
    v_lshl_add_u32 v49, v50, 4, v49
    v_cmp_gt_u32 vcc, 640, v48
    v_mov_b32 v51, 2146435072
    s_nop 0
    v_cndmask_b32 v49, v51, v49, vcc
    buffer_load_dwordx4 v[52:55], v49, s[20:23], 0 offen
    v_lshlrev_b32 v48, 4, v48
    s_waitcnt vmcnt(0)
    s_and_saveexec_b64 s[30:31], vcc
    ds_write_b128 v48, v[52:55]
    s_mov_b64 exec, s[30:31]
    s_lshl_b32 s24, s3, 6
    s_add_u32 s24, s24, 256
    v_add_u32 v48, s24, v1
    v_and_b32 v49, 7, v48
    v_mul_u32_u24 v49, 1280, v49
    v_lshrrev_b32 v50, 3, v48
    v_lshl_add_u32 v49, v50, 4, v49
    v_cmp_gt_u32 vcc, 640, v48
    v_mov_b32 v51, 2146435072
    s_nop 0
    v_cndmask_b32 v49, v51, v49, vcc
    buffer_load_dwordx4 v[52:55], v49, s[20:23], 0 offen
    v_lshlrev_b32 v48, 4, v48
    s_waitcnt vmcnt(0)
    s_and_saveexec_b64 s[30:31], vcc
    ds_write_b128 v48, v[52:55]
    s_mov_b64 exec, s[30:31]
    s_lshl_b32 s24, s3, 6
    s_add_u32 s24, s24, 512
    v_add_u32 v48, s24, v1
    v_and_b32 v49, 7, v48
    v_mul_u32_u24 v49, 1280, v49
    v_lshrrev_b32 v50, 3, v48
    v_lshl_add_u32 v49, v50, 4, v49
    v_cmp_gt_u32 vcc, 640, v48
    v_mov_b32 v51, 2146435072
    s_nop 0
    v_cndmask_b32 v49, v51, v49, vcc
    buffer_load_dwordx4 v[52:55], v49, s[20:23], 0 offen
    v_lshlrev_b32 v48, 4, v48
    s_waitcnt vmcnt(0)
    s_and_saveexec_b64 s[30:31], vcc
    ds_write_b128 v48, v[52:55]
    s_mov_b64 exec, s[30:31]
    s_mov_b32 s40, 0
    s_mov_b32 s41, 92274688
    s_add_u32 s42, s93, 327680
    s_add_u32 s43, s93, 409600
    s_mov_b32 s45, 67108864
    s_add_u32 s47, s93, -28672
    s_add_u32 s48, s93, -18432
    s_add_u32 s49, s93, 448512
    s_lshl_b32 s95, s92, 6
    s_add_u32 s95, s95, s40
    s_add_u32 s95, s95, 1
    s_cmp_ge_i32 s59, s95
    s_cbranch_scc1 interleave_layers__linear_attn_block__memory_aug_recurrent_mem_tr__prompt_kernel_s_ec0_ok
    s_and_b32 s24, s2, 7
    s_lshl_b32 s24, s24, 7
    s_add_u32 s24, s24, 23109632
    v_and_b32 v49, 3, v1
    v_lshl_add_u32 v49, v49, 2, s24
    s_mov_b32 s61, 0
interleave_layers__linear_attn_block__memory_aug_recurrent_mem_tr__prompt_kernel_s_ec0:
    buffer_load_dword v48, v49, s[8:11], 0 offen sc1
    s_waitcnt vmcnt(0)
    v_readlane_b32 s59, v48, 0
    v_readlane_b32 s24, v48, 1
    s_min_i32 s59, s59, s24
    v_readlane_b32 s24, v48, 2
    s_min_i32 s59, s59, s24
    s_cmp_ge_i32 s59, s95
    s_cbranch_scc1 interleave_layers__linear_attn_block__memory_aug_recurrent_mem_tr__prompt_kernel_s_ec0_ok
    s_add_u32 s61, s61, 1
    s_cmp_ge_u32 s61, s60
    s_cbranch_scc1 interleave_layers__linear_attn_block__memory_aug_recurrent_mem_tr__prompt_kernel_s_ec0_to
    s_sleep 2
    s_branch interleave_layers__linear_attn_block__memory_aug_recurrent_mem_tr__prompt_kernel_s_ec0
interleave_layers__linear_attn_block__memory_aug_recurrent_mem_tr__prompt_kernel_s_ec0_to:
    s_mov_b32 s60, 1
interleave_layers__linear_attn_block__memory_aug_recurrent_mem_tr__prompt_kernel_s_ec0_ok:
    s_mov_b32 s62, -1
    s_mov_b32 s63, 1
    s_cmp_ge_i32 s62, s63
    s_cbranch_scc1 interleave_layers__linear_attn_block__memory_aug_recurrent_mem_tr__prompt_kernel_s_en0_ok
    s_mov_b32 s61, 0
interleave_layers__linear_attn_block__memory_aug_recurrent_mem_tr__prompt_kernel_s_en0:
    buffer_load_dword v48, v9, s[8:11], 0 offen sc1
    s_waitcnt vmcnt(0)
    v_readlane_b32 s62, v48, 0
    v_readlane_b32 s24, v48, 1
    s_min_i32 s62, s62, s24
    s_cmp_ge_i32 s62, s63
    s_cbranch_scc1 interleave_layers__linear_attn_block__memory_aug_recurrent_mem_tr__prompt_kernel_s_en0_ok
    s_add_u32 s61, s61, 1
    s_cmp_ge_u32 s61, s60
    s_cbranch_scc1 interleave_layers__linear_attn_block__memory_aug_recurrent_mem_tr__prompt_kernel_s_en0_to
    s_sleep 2
    s_branch interleave_layers__linear_attn_block__memory_aug_recurrent_mem_tr__prompt_kernel_s_en0
interleave_layers__linear_attn_block__memory_aug_recurrent_mem_tr__prompt_kernel_s_en0_to:
    s_mov_b32 s60, 1
interleave_layers__linear_attn_block__memory_aug_recurrent_mem_tr__prompt_kernel_s_en0_ok:
    buffer_load_dwordx4 a[240:243], v19, s[8:11], s41 offen offset:0 sc1
    buffer_load_dwordx4 a[244:247], v19, s[8:11], s41 offen offset:1024 sc1
    buffer_load_dwordx4 a[248:251], v19, s[8:11], s41 offen offset:2048 sc1
    s_waitcnt lgkmcnt(0)
    v_mov_b32 v24, 0
    v_mov_b32 v25, 0
    v_mov_b32 v26, 0
    v_mov_b32 v27, 0
    v_mov_b32 v28, 0
    v_mov_b32 v29, 0
    v_mov_b32 v30, 0
    v_mov_b32 v31, 0
    v_mov_b32 v32, 0
    v_mov_b32 v33, 0
    v_mov_b32 v34, 0
    v_mov_b32 v35, 0
    v_mov_b32 v36, 0
    v_mov_b32 v37, 0
    v_mov_b32 v38, 0
    v_mov_b32 v39, 0
    v_mov_b32 v40, 0
    v_mov_b32 v41, 0
    v_mov_b32 v42, 0
    v_mov_b32 v43, 0
    v_mov_b32 v44, 0
    v_mov_b32 v45, 0
    v_mov_b32 v46, 0
    v_mov_b32 v47, 0
    s_barrier
    ds_read_b128 v[84:87], v7
    ds_read_b128 v[88:91], v7 offset:4096
    s_waitcnt vmcnt(0) lgkmcnt(0)
    s_cmp_eq_u32 s3, 0
    s_cbranch_scc1 interleave_layers__linear_attn_block__memory_aug_recurrent_mem_tr__prompt_kernel_s_gow0
    s_cmp_eq_u32 s3, 1
    s_cbranch_scc1 interleave_layers__linear_attn_block__memory_aug_recurrent_mem_tr__prompt_kernel_s_gow1
    s_cmp_eq_u32 s3, 2
    s_cbranch_scc1 interleave_layers__linear_attn_block__memory_aug_recurrent_mem_tr__prompt_kernel_s_gow2
    s_branch interleave_layers__linear_attn_block__memory_aug_recurrent_mem_tr__prompt_kernel_s_gow3
interleave_layers__linear_attn_block__memory_aug_recurrent_mem_tr__prompt_kernel_s_stepw0:
    v_mov_b32 v24, 0
    v_mov_b32 v25, 0
    v_mov_b32 v26, 0
    v_mov_b32 v27, 0
    v_mov_b32 v28, 0
    v_mov_b32 v29, 0
    v_mov_b32 v30, 0
    v_mov_b32 v31, 0
    v_mov_b32 v32, 0
    v_mov_b32 v33, 0
    v_mov_b32 v34, 0
    v_mov_b32 v35, 0
    v_mov_b32 v36, 0
    v_mov_b32 v37, 0
    v_mov_b32 v38, 0
    v_mov_b32 v39, 0
    v_mov_b32 v40, 0
    v_mov_b32 v41, 0
    v_mov_b32 v42, 0
    v_mov_b32 v43, 0
    v_mov_b32 v44, 0
    v_mov_b32 v45, 0
    v_mov_b32 v46, 0
    v_mov_b32 v47, 0
    s_add_u32 s46, s47, 4096
    s_lshl_b32 s95, s92, 6
    s_add_u32 s95, s95, s40
    s_add_u32 s95, s95, 1
    s_cmp_ge_i32 s59, s95
    s_cbranch_scc1 interleave_layers__linear_attn_block__memory_aug_recurrent_mem_tr__prompt_kernel_s_ecw0_ok
    s_and_b32 s24, s2, 7
    s_lshl_b32 s24, s24, 7
    s_add_u32 s24, s24, 23109632
    v_and_b32 v49, 3, v1
    v_lshl_add_u32 v49, v49, 2, s24
    s_mov_b32 s61, 0
interleave_layers__linear_attn_block__memory_aug_recurrent_mem_tr__prompt_kernel_s_ecw0:
    buffer_load_dword v48, v49, s[8:11], 0 offen sc1
    s_waitcnt vmcnt(0)
    v_readlane_b32 s59, v48, 0
    v_readlane_b32 s24, v48, 1
    s_min_i32 s59, s59, s24
    v_readlane_b32 s24, v48, 2
    s_min_i32 s59, s59, s24
    s_cmp_ge_i32 s59, s95
    s_cbranch_scc1 interleave_layers__linear_attn_block__memory_aug_recurrent_mem_tr__prompt_kernel_s_ecw0_ok
    s_add_u32 s61, s61, 1
    s_cmp_ge_u32 s61, s60
    s_cbranch_scc1 interleave_layers__linear_attn_block__memory_aug_recurrent_mem_tr__prompt_kernel_s_ecw0_to
    s_sleep 2
    s_branch interleave_layers__linear_attn_block__memory_aug_recurrent_mem_tr__prompt_kernel_s_ecw0
interleave_layers__linear_attn_block__memory_aug_recurrent_mem_tr__prompt_kernel_s_ecw0_to:
    s_mov_b32 s60, 1
interleave_layers__linear_attn_block__memory_aug_recurrent_mem_tr__prompt_kernel_s_ecw0_ok:
    s_add_u32 s63, s40, 1
    s_cmp_ge_i32 s62, s63
    s_cbranch_scc1 interleave_layers__linear_attn_block__memory_aug_recurrent_mem_tr__prompt_kernel_s_enw0_ok
    s_mov_b32 s61, 0
interleave_layers__linear_attn_block__memory_aug_recurrent_mem_tr__prompt_kernel_s_enw0:
    buffer_load_dword v48, v9, s[8:11], 0 offen sc1
    s_waitcnt vmcnt(0)
    v_readlane_b32 s62, v48, 0
    v_readlane_b32 s24, v48, 1
    s_min_i32 s62, s62, s24
    s_cmp_ge_i32 s62, s63
    s_cbranch_scc1 interleave_layers__linear_attn_block__memory_aug_recurrent_mem_tr__prompt_kernel_s_enw0_ok
    s_add_u32 s61, s61, 1
    s_cmp_ge_u32 s61, s60
    s_cbranch_scc1 interleave_layers__linear_attn_block__memory_aug_recurrent_mem_tr__prompt_kernel_s_enw0_to
    s_sleep 2
    s_branch interleave_layers__linear_attn_block__memory_aug_recurrent_mem_tr__prompt_kernel_s_enw0
interleave_layers__linear_attn_block__memory_aug_recurrent_mem_tr__prompt_kernel_s_enw0_to:
    s_mov_b32 s60, 1
interleave_layers__linear_attn_block__memory_aug_recurrent_mem_tr__prompt_kernel_s_enw0_ok:
    buffer_load_dwordx4 a[240:243], v19, s[8:11], s41 offen offset:0 sc1
    buffer_load_dwordx4 a[244:247], v19, s[8:11], s41 offen offset:1024 sc1
    buffer_load_dwordx4 a[248:251], v19, s[8:11], s41 offen offset:2048 sc1
    s_sleep 5
    s_mov_b64 exec, 1
    s_mov_b32 s61, 0
    v_mov_b32 v83, 0
    buffer_atomic_add v83, v23, s[8:11], s48 offen sc0
    s_sleep 3
    v_mov_b32 v94, 0
    buffer_atomic_add v94, v23, s[8:11], s48 offen sc0
    s_sleep 3
    v_mov_b32 v95, 0
    buffer_atomic_add v95, v23, s[8:11], s48 offen sc0
    s_sleep 3
interleave_layers__linear_attn_block__memory_aug_recurrent_mem_tr__prompt_kernel_s_prw0:
    v_mov_b32 v82, 0
    buffer_atomic_add v82, v23, s[8:11], s48 offen sc0
    s_waitcnt vmcnt(3)
    v_cmp_le_i32 vcc, 8, v83
    s_add_u32 s61, s61, 1
    s_cbranch_vccnz interleave_layers__linear_attn_block__memory_aug_recurrent_mem_tr__prompt_kernel_s_prw0_out
    s_sleep 3
    v_mov_b32 v83, 0
    buffer_atomic_add v83, v23, s[8:11], s48 offen sc0
    s_waitcnt vmcnt(3)
    v_cmp_le_i32 vcc, 8, v94
    s_add_u32 s61, s61, 1
    s_cbranch_vccnz interleave_layers__linear_attn_block__memory_aug_recurrent_mem_tr__prompt_kernel_s_prw0_out
    s_sleep 3
    v_mov_b32 v94, 0
    buffer_atomic_add v94, v23, s[8:11], s48 offen sc0
    s_waitcnt vmcnt(3)
    v_cmp_le_i32 vcc, 8, v95
    s_add_u32 s61, s61, 1
    s_cbranch_vccnz interleave_layers__linear_attn_block__memory_aug_recurrent_mem_tr__prompt_kernel_s_prw0_out
    s_sleep 3
    v_mov_b32 v95, 0
    buffer_atomic_add v95, v23, s[8:11], s48 offen sc0
    s_waitcnt vmcnt(3)
    v_cmp_le_i32 vcc, 8, v82
    s_add_u32 s61, s61, 1
    s_cbranch_vccnz interleave_layers__linear_attn_block__memory_aug_recurrent_mem_tr__prompt_kernel_s_prw0_out
    s_sleep 3
    s_cmp_ge_u32 s61, s60
    s_cbranch_scc0 interleave_layers__linear_attn_block__memory_aug_recurrent_mem_tr__prompt_kernel_s_prw0
    s_mov_b32 s60, 1
interleave_layers__linear_attn_block__memory_aug_recurrent_mem_tr__prompt_kernel_s_prw0_out:
    s_mov_b64 exec, -1
    buffer_load_dwordx4 v[84:87], v7, s[8:11], s47 offen sc1
    buffer_load_dwordx4 v[88:91], v7, s[8:11], s46 offen sc1
    buffer_load_dwordx2 v[92:93], v8, s[8:11], s47 offen sc1
    ds_read_b128 v[48:51], v21 offset:0
    ds_read_b128 v[52:55], v21 offset:16
    ds_read_b128 v[56:59], v21 offset:5632
    ds_read_b128 v[60:63], v21 offset:5648
    ds_read_b128 v[64:67], v21 offset:11264
    ds_read_b128 v[68:71], v21 offset:11280
    ds_read_b128 v[72:75], v21 offset:16896
    ds_read_b128 v[76:79], v21 offset:16912
    s_waitcnt lgkmcnt(4)
    v_pk_add_f32 v[48:49], v[48:49], v[56:57]
    v_pk_add_f32 v[50:51], v[50:51], v[58:59]
    v_pk_add_f32 v[52:53], v[52:53], v[60:61]
    v_pk_add_f32 v[54:55], v[54:55], v[62:63]
    s_waitcnt lgkmcnt(0)
    v_pk_add_f32 v[64:65], v[64:65], v[72:73]
    v_pk_add_f32 v[66:67], v[66:67], v[74:75]
    v_pk_add_f32 v[68:69], v[68:69], v[76:77]
    v_pk_add_f32 v[70:71], v[70:71], v[78:79]
    v_pk_add_f32 v[48:49], v[48:49], v[64:65]
    v_pk_add_f32 v[50:51], v[50:51], v[66:67]
    v_pk_add_f32 v[52:53], v[52:53], v[68:69]
    v_pk_add_f32 v[54:55], v[54:55], v[70:71]
    v_mov_b32 v81, 0xff800000
    v_cndmask_b32 v48, v81, v48, s[64:65]
    v_cndmask_b32 v49, v81, v49, s[66:67]
    v_cndmask_b32 v50, v81, v50, s[68:69]
    v_cndmask_b32 v51, v81, v51, s[70:71]
    v_cndmask_b32 v52, v81, v52, s[72:73]
    v_cndmask_b32 v53, v81, v53, s[74:75]
    v_cndmask_b32 v54, v81, v54, s[76:77]
    v_cndmask_b32 v55, v81, v55, s[78:79]
    v_max3_f32 v80, v48, v49, v50
    v_max3_f32 v80, v80, v51, v52
    v_max3_f32 v80, v80, v53, v54
    v_max_f32 v80, v80, v55
    v_mov_b32 v81, 0xff800000
    v_cndmask_b32 v80, v81, v80, s[50:51]
    s_nop 1
    v_max_f32 v80, v80, v80 quad_perm:[1,0,3,2] row_mask:0xf bank_mask:0xf
    s_nop 1
    v_max_f32 v80, v80, v80 quad_perm:[2,3,0,1] row_mask:0xf bank_mask:0xf
    s_nop 1
    v_max_f32 v80, v80, v80 row_half_mirror row_mask:0xf bank_mask:0xf
    s_mov_b32 s24, 0x3dd53b95
    v_mul_f32 v80, s24, v80
    v_fma_f32 v48, v48, s24, -v80
    v_fma_f32 v49, v49, s24, -v80
    v_fma_f32 v50, v50, s24, -v80
    v_fma_f32 v51, v51, s24, -v80
    v_fma_f32 v52, v52, s24, -v80
    v_fma_f32 v53, v53, s24, -v80
    v_fma_f32 v54, v54, s24, -v80
    v_fma_f32 v55, v55, s24, -v80
    v_exp_f32 v48, v48
    v_exp_f32 v49, v49
    v_exp_f32 v50, v50
    v_exp_f32 v51, v51
    v_exp_f32 v52, v52
    v_exp_f32 v53, v53
    v_exp_f32 v54, v54
    v_exp_f32 v55, v55
    v_add_f32 v80, v48, v49
    v_add_f32 v81, v50, v51
    v_add_f32 v80, v80, v52
    v_add_f32 v81, v81, v53
    v_add_f32 v80, v80, v54
    v_add_f32 v81, v81, v55
    v_add_f32 v80, v80, v81
    v_cndmask_b32 v80, 0, v80, s[50:51]
    s_nop 1
    v_add_f32 v80, v80, v80 quad_perm:[1,0,3,2] row_mask:0xf bank_mask:0xf
    s_nop 1
    v_add_f32 v80, v80, v80 quad_perm:[2,3,0,1] row_mask:0xf bank_mask:0xf
    s_nop 1
    v_add_f32 v80, v80, v80 row_half_mirror row_mask:0xf bank_mask:0xf
    v_rcp_f32 v80, v80
    s_nop 0
    v_mul_f32 v48, v48, v80
    v_mul_f32 v49, v49, v80
    v_mul_f32 v50, v50, v80
    v_mul_f32 v51, v51, v80
    v_mul_f32 v52, v52, v80
    v_mul_f32 v53, v53, v80
    v_mul_f32 v54, v54, v80
    v_mul_f32 v55, v55, v80
    v_cvt_pk_bf16_f32 v56, v48, v49
    v_cvt_pk_bf16_f32 v57, v50, v51
    v_cvt_pk_bf16_f32 v58, v52, v53
    v_cvt_pk_bf16_f32 v59, v54, v55
    v_min_u32 v56, -2, v56
    v_min_u32 v57, -2, v57
    v_min_u32 v58, -2, v58
    v_min_u32 v59, -2, v59
    buffer_store_dwordx4 v[56:59], v22, s[8:11], s42 offen sc1
    s_add_u32 s42, s42, 458752
    s_waitcnt vmcnt(1)
    v_max3_u32 v58, v84, v85, v86
    v_max3_u32 v58, v58, v87, v88
    v_max3_u32 v58, v58, v89, v90
    v_max3_u32 v58, v58, v91, v92
    v_max_u32 v58, v58, v93
    v_cmp_eq_u32 vcc, -1, v58
    s_cbranch_vccz interleave_layers__linear_attn_block__memory_aug_recurrent_mem_tr__prompt_kernel_s_pmw0_out
    s_mov_b32 s61, 0
interleave_layers__linear_attn_block__memory_aug_recurrent_mem_tr__prompt_kernel_s_pmw0:
    buffer_load_dwordx4 v[84:87], v7, s[8:11], s47 offen sc1
    buffer_load_dwordx4 v[88:91], v7, s[8:11], s46 offen sc1
    buffer_load_dwordx2 v[92:93], v8, s[8:11], s47 offen sc1
    s_waitcnt vmcnt(0)
    v_max3_u32 v58, v84, v85, v86
    v_max3_u32 v58, v58, v87, v88
    v_max3_u32 v58, v58, v89, v90
    v_max3_u32 v58, v58, v91, v92
    v_max_u32 v58, v58, v93
    v_cmp_eq_u32 vcc, -1, v58
    s_add_u32 s61, s61, 1
    s_cbranch_vccz interleave_layers__linear_attn_block__memory_aug_recurrent_mem_tr__prompt_kernel_s_pmw0_out
    s_cmp_ge_u32 s61, s60
    s_cbranch_scc1 interleave_layers__linear_attn_block__memory_aug_recurrent_mem_tr__prompt_kernel_s_pmw0_to
    s_sleep 1
    s_branch interleave_layers__linear_attn_block__memory_aug_recurrent_mem_tr__prompt_kernel_s_pmw0
interleave_layers__linear_attn_block__memory_aug_recurrent_mem_tr__prompt_kernel_s_pmw0_to:
    s_mov_b32 s60, 1
interleave_layers__linear_attn_block__memory_aug_recurrent_mem_tr__prompt_kernel_s_pmw0_out:
    ds_write_b128 v7, v[84:87]
    ds_write_b128 v7, v[88:91] offset:4096
    ds_write_b64 v8, v[92:93]
interleave_layers__linear_attn_block__memory_aug_recurrent_mem_tr__prompt_kernel_s_gow0:
    ds_read_b128 v[68:71], v6 offset:0
    ds_read_b128 v[72:75], v6 offset:1024
    ds_read_b128 v[76:79], v6 offset:8192
    ds_read_b128 v[80:83], v6 offset:9216
    v_smfmac_f32_16x16x64_bf16 v[24:27], v[84:87], a[0:7], v4
    v_smfmac_f32_16x16x64_bf16 v[28:31], v[84:87], a[80:87], v4
    v_smfmac_f32_16x16x64_bf16 v[32:35], v[84:87], a[160:167], v4
    v_smfmac_f32_16x16x64_bf16 v[40:43], v[84:87], v[96:103], v4
    v_smfmac_f32_16x16x64_bf16 v[44:47], v[84:87], v[176:183], v4
    s_waitcnt lgkmcnt(2)
    v_smfmac_f32_16x16x64_bf16 v[36:39], v[84:87], v[68:75], v4
    ds_read_b128 v[68:71], v6 offset:2048
    ds_read_b128 v[72:75], v6 offset:3072
    s_barrier
    ds_read_b128 v[48:51], v5 offset:1024
    ds_read_b128 v[52:55], v5 offset:2048
    ds_read_b128 v[56:59], v5 offset:3072
    ds_read_b128 v[60:63], v5 offset:5120
    ds_read_b128 v[64:67], v5 offset:6144
    v_smfmac_f32_16x16x64_bf16 v[24:27], v[88:91], a[32:39], v4
    v_smfmac_f32_16x16x64_bf16 v[28:31], v[88:91], a[112:119], v4
    v_smfmac_f32_16x16x64_bf16 v[32:35], v[88:91], a[192:199], v4
    v_smfmac_f32_16x16x64_bf16 v[40:43], v[88:91], v[128:135], v4
    v_smfmac_f32_16x16x64_bf16 v[44:47], v[88:91], v[208:215], v4
    s_waitcnt lgkmcnt(7)
    v_smfmac_f32_16x16x64_bf16 v[36:39], v[88:91], v[76:83], v4
    ds_read_b128 v[76:79], v6 offset:4096
    ds_read_b128 v[80:83], v6 offset:5120
    s_waitcnt lgkmcnt(6)
    v_smfmac_f32_16x16x64_bf16 v[24:27], v[48:51], a[8:15], v4
    v_smfmac_f32_16x16x64_bf16 v[28:31], v[48:51], a[88:95], v4
    v_smfmac_f32_16x16x64_bf16 v[40:43], v[48:51], v[104:111], v4
    v_smfmac_f32_16x16x64_bf16 v[36:39], v[48:51], v[68:75], v4
    ds_read_b128 v[68:71], v6 offset:6144
    ds_read_b128 v[72:75], v6 offset:7168
    ds_read_b128 v[48:51], v5 offset:7168
    s_waitcnt lgkmcnt(8)
    v_smfmac_f32_16x16x64_bf16 v[24:27], v[52:55], a[16:23], v4
    v_smfmac_f32_16x16x64_bf16 v[28:31], v[52:55], a[96:103], v4
    v_smfmac_f32_16x16x64_bf16 v[40:43], v[52:55], v[112:119], v4
    s_waitcnt lgkmcnt(3)
    v_smfmac_f32_16x16x64_bf16 v[36:39], v[52:55], v[76:83], v4
    ds_read_b128 v[76:79], v6 offset:10240
    ds_read_b128 v[80:83], v6 offset:11264
    ds_read_b128 v[52:55], v5 offset:8192
    v_smfmac_f32_16x16x64_bf16 v[24:27], v[56:59], a[24:31], v4
    v_smfmac_f32_16x16x64_bf16 v[28:31], v[56:59], a[104:111], v4
    v_smfmac_f32_16x16x64_bf16 v[40:43], v[56:59], v[120:127], v4
    s_waitcnt lgkmcnt(4)
    v_smfmac_f32_16x16x64_bf16 v[36:39], v[56:59], v[68:75], v4
    ds_read_b128 v[68:71], v6 offset:12288
    ds_read_b128 v[72:75], v6 offset:13312
    ds_read_b128 v[56:59], v5 offset:9216
    v_smfmac_f32_16x16x64_bf16 v[24:27], v[60:63], a[40:47], v4
    v_smfmac_f32_16x16x64_bf16 v[28:31], v[60:63], a[120:127], v4
    v_smfmac_f32_16x16x64_bf16 v[40:43], v[60:63], v[136:143], v4
    s_waitcnt lgkmcnt(4)
    v_smfmac_f32_16x16x64_bf16 v[36:39], v[60:63], v[76:83], v4
    ds_read_b128 v[76:79], v6 offset:14336
    ds_read_b128 v[80:83], v6 offset:15360
    ds_read_b128 v[60:63], v5 offset:1024
    v_smfmac_f32_16x16x64_bf16 v[24:27], v[64:67], a[48:55], v4
    v_smfmac_f32_16x16x64_bf16 v[28:31], v[64:67], a[128:135], v4
    v_smfmac_f32_16x16x64_bf16 v[40:43], v[64:67], v[144:151], v4
    s_waitcnt lgkmcnt(4)
    v_smfmac_f32_16x16x64_bf16 v[36:39], v[64:67], v[68:75], v4
    ds_read_b128 v[68:71], v6 offset:16384
    ds_read_b128 v[72:75], v6 offset:17408
    ds_read_b128 v[64:67], v5 offset:2048
    v_smfmac_f32_16x16x64_bf16 v[24:27], v[48:51], a[56:63], v4
    v_smfmac_f32_16x16x64_bf16 v[28:31], v[48:51], a[136:143], v4
    v_smfmac_f32_16x16x64_bf16 v[40:43], v[48:51], v[152:159], v4
    s_waitcnt lgkmcnt(4)
    v_smfmac_f32_16x16x64_bf16 v[36:39], v[48:51], v[76:83], v4
    ds_read_b128 v[76:79], v6 offset:18432
    ds_read_b128 v[80:83], v6 offset:19456
    ds_read_b128 v[48:51], v5 offset:3072
    v_smfmac_f32_16x16x64_bf16 v[24:27], v[52:55], a[64:71], v4
    v_smfmac_f32_16x16x64_bf16 v[28:31], v[52:55], a[144:151], v4
    v_smfmac_f32_16x16x64_bf16 v[40:43], v[52:55], v[160:167], v4
    s_waitcnt lgkmcnt(4)
    v_smfmac_f32_16x16x64_bf16 v[36:39], v[52:55], v[68:75], v4
    ds_read_b128 v[52:55], v5 offset:5120
    v_smfmac_f32_16x16x64_bf16 v[24:27], v[56:59], a[72:79], v4
    v_smfmac_f32_16x16x64_bf16 v[28:31], v[56:59], a[152:159], v4
    v_smfmac_f32_16x16x64_bf16 v[40:43], v[56:59], v[168:175], v4
    s_waitcnt lgkmcnt(2)
    v_smfmac_f32_16x16x64_bf16 v[36:39], v[56:59], v[76:83], v4
    ds_read_b128 v[56:59], v5 offset:6144
    buffer_load_dwordx4 v[80:83], v19, s[8:11], s45 offen offset:0 sc1
    buffer_load_dwordx4 v[84:87], v19, s[8:11], s45 offen offset:1024 sc1
    buffer_load_dwordx4 v[88:91], v19, s[8:11], s45 offen offset:2048 sc1
    v_smfmac_f32_16x16x64_bf16 v[32:35], v[60:63], a[168:175], v4
    v_smfmac_f32_16x16x64_bf16 v[44:47], v[60:63], v[184:191], v4
    v_permlane32_swap_b32 v28, v40
    v_permlane32_swap_b32 v29, v41
    ds_read_b128 v[60:63], v5 offset:7168
    v_smfmac_f32_16x16x64_bf16 v[32:35], v[64:67], a[176:183], v4
    v_permlane32_swap_b32 v30, v42
    v_permlane32_swap_b32 v31, v43
    v_smfmac_f32_16x16x64_bf16 v[44:47], v[64:67], v[192:199], v4
    v_add_f32 v28, v28, v40
    v_add_f32 v29, v29, v41
    ds_read_b128 v[64:67], v5 offset:8192
    s_waitcnt lgkmcnt(4)
    v_smfmac_f32_16x16x64_bf16 v[32:35], v[48:51], a[184:191], v4
    v_add_f32 v30, v30, v42
    v_add_f32 v31, v31, v43
    v_smfmac_f32_16x16x64_bf16 v[44:47], v[48:51], v[200:207], v4
    v_cvt_pk_bf16_f32 v40, v28, v29
    v_cvt_pk_bf16_f32 v41, v30, v31
    ds_read_b128 v[48:51], v5 offset:9216
    s_waitcnt lgkmcnt(4)
    v_smfmac_f32_16x16x64_bf16 v[32:35], v[52:55], a[200:207], v4
    v_mfma_f32_16x16x16_bf16 v[28:31], v[40:41], v[10:11], 0
    v_permlane32_swap_b32 v24, v36
    v_smfmac_f32_16x16x64_bf16 v[44:47], v[52:55], v[216:223], v4
    v_permlane32_swap_b32 v25, v37
    v_permlane32_swap_b32 v26, v38
    s_waitcnt lgkmcnt(3)
    v_smfmac_f32_16x16x64_bf16 v[32:35], v[56:59], a[208:215], v4
    v_permlane32_swap_b32 v27, v39
    v_add_f32 v24, v24, v36
    v_smfmac_f32_16x16x64_bf16 v[44:47], v[56:59], v[224:231], v4
    v_add_f32 v25, v25, v37
    v_add_f32 v26, v26, v38
    s_waitcnt lgkmcnt(2)
    v_smfmac_f32_16x16x64_bf16 v[32:35], v[60:63], a[216:223], v4
    v_add_f32 v27, v27, v39
    v_cvt_pk_bf16_f32 v36, v24, v25
    v_smfmac_f32_16x16x64_bf16 v[44:47], v[60:63], v[232:239], v4
    v_cvt_pk_bf16_f32 v37, v26, v27
    s_nop 1
    v_mfma_f32_16x16x16_bf16 v[24:27], v[36:37], v[10:11], 0
    s_waitcnt lgkmcnt(1)
    v_smfmac_f32_16x16x64_bf16 v[32:35], v[64:67], a[224:231], v4
    s_nop 5
    v_cvt_pk_bf16_f32 v24, v24, v25
    v_smfmac_f32_16x16x64_bf16 v[44:47], v[64:67], v[240:247], v4
    v_cvt_pk_bf16_f32 v25, v26, v27
    v_cvt_pk_bf16_f32 v26, v28, v29
    s_waitcnt lgkmcnt(0)
    v_smfmac_f32_16x16x64_bf16 v[32:35], v[48:51], a[232:239], v4
    v_cvt_pk_bf16_f32 v27, v30, v31
    s_waitcnt vmcnt(3)
    v_smfmac_f32_16x16x64_bf16 v[44:47], v[48:51], v[248:255], v4
    v_mfma_f32_16x16x32_bf16 v[28:31], a[240:243], v[24:27], 0
    v_mfma_f32_16x16x32_bf16 v[36:39], a[244:247], v[24:27], 0
    v_mfma_f32_16x16x32_bf16 v[40:43], v[24:27], v[24:27], 0
    s_nop 4
    v_permlane32_swap_b32 v32, v44
    v_permlane32_swap_b32 v33, v45
    v_permlane32_swap_b32 v34, v46
    v_permlane32_swap_b32 v35, v47
    v_add_f32 v32, v32, v44
    v_add_f32 v33, v33, v45
    v_add_f32 v34, v34, v46
    v_add_f32 v35, v35, v47
    v_cvt_pk_bf16_f32 v44, v32, v33
    v_cvt_pk_bf16_f32 v45, v34, v35
    s_nop 1
    v_mfma_f32_16x16x16_bf16 v[32:35], v[44:45], v[10:11], 0
    s_nop 7
    v_cvt_pk_bf16_f32 v32, v32, v33
    v_cvt_pk_bf16_f32 v33, v34, v35
    s_nop 1
    v_mfma_f32_16x16x16_bf16 v[28:31], a[248:249], v[32:33], v[28:31]
    v_mfma_f32_16x16x16_bf16 v[36:39], a[250:251], v[32:33], v[36:39]
    v_mfma_f32_16x16x16_bf16 v[40:43], v[32:33], v[32:33], v[40:43]
    buffer_atomic_add v0, v20, s[8:11], s49 offen
    s_nop 4
    ds_write_b128 v12, v[28:31]
    ds_write_b128 v12, v[36:39] offset:16
    ds_write_b128 v13, v[40:43]
    s_waitcnt lgkmcnt(0)
    s_barrier
    ds_read_b128 v[48:51], v14 offset:0
    ds_read_b128 v[52:55], v14 offset:16
    ds_read_b128 v[56:59], v14 offset:1408
    ds_read_b128 v[60:63], v14 offset:1424
    ds_read_b128 v[64:67], v14 offset:2816
    ds_read_b128 v[68:71], v14 offset:2832
    ds_read_b128 v[72:75], v14 offset:4224
    ds_read_b128 v[76:79], v14 offset:4240
    s_waitcnt lgkmcnt(4)
    v_pk_add_f32 v[48:49], v[48:49], v[56:57]
    v_pk_add_f32 v[50:51], v[50:51], v[58:59]
    v_pk_add_f32 v[52:53], v[52:53], v[60:61]
    v_pk_add_f32 v[54:55], v[54:55], v[62:63]
    s_waitcnt lgkmcnt(0)
    v_pk_add_f32 v[64:65], v[64:65], v[72:73]
    v_pk_add_f32 v[66:67], v[66:67], v[74:75]
    v_pk_add_f32 v[68:69], v[68:69], v[76:77]
    v_pk_add_f32 v[70:71], v[70:71], v[78:79]
    v_pk_add_f32 v[48:49], v[48:49], v[64:65]
    v_pk_add_f32 v[50:51], v[50:51], v[66:67]
    v_pk_add_f32 v[52:53], v[52:53], v[68:69]
    v_pk_add_f32 v[54:55], v[54:55], v[70:71]
    v_max3_f32 v92, v48, v49, v50
    v_max3_f32 v92, v92, v51, v52
    v_max3_f32 v92, v92, v53, v54
    v_max_f32 v92, v92, v55
    v_mov_b32 v93, 0xff800000
    v_cndmask_b32 v92, v93, v92, s[50:51]
    s_nop 1
    v_max_f32 v92, v92, v92 quad_perm:[1,0,3,2] row_mask:0xf bank_mask:0xf
    s_nop 1
    v_max_f32 v92, v92, v92 quad_perm:[2,3,0,1] row_mask:0xf bank_mask:0xf
    s_nop 1
    v_max_f32 v92, v92, v92 row_half_mirror row_mask:0xf bank_mask:0xf
    s_mov_b32 s24, 0x3dd53b95
    v_mul_f32 v92, s24, v92
    v_fma_f32 v48, v48, s24, -v92
    v_fma_f32 v49, v49, s24, -v92
    v_fma_f32 v50, v50, s24, -v92
    v_fma_f32 v51, v51, s24, -v92
    v_fma_f32 v52, v52, s24, -v92
    v_fma_f32 v53, v53, s24, -v92
    v_fma_f32 v54, v54, s24, -v92
    v_fma_f32 v55, v55, s24, -v92
    v_exp_f32 v48, v48
    v_exp_f32 v49, v49
    v_exp_f32 v50, v50
    v_exp_f32 v51, v51
    v_exp_f32 v52, v52
    v_exp_f32 v53, v53
    v_exp_f32 v54, v54
    v_exp_f32 v55, v55
    v_add_f32 v92, v48, v49
    v_add_f32 v93, v50, v51
    v_add_f32 v92, v92, v52
    v_add_f32 v93, v93, v53
    v_add_f32 v92, v92, v54
    v_add_f32 v93, v93, v55
    v_add_f32 v92, v92, v93
    v_cndmask_b32 v92, 0, v92, s[50:51]
    s_nop 1
    v_add_f32 v92, v92, v92 quad_perm:[1,0,3,2] row_mask:0xf bank_mask:0xf
    s_nop 1
    v_add_f32 v92, v92, v92 quad_perm:[2,3,0,1] row_mask:0xf bank_mask:0xf
    s_nop 1
    v_add_f32 v92, v92, v92 row_half_mirror row_mask:0xf bank_mask:0xf
    v_rcp_f32 v92, v92
    s_nop 0
    v_mul_f32 v48, v48, v92
    v_mul_f32 v49, v49, v92
    v_mul_f32 v50, v50, v92
    v_mul_f32 v51, v51, v92
    v_mul_f32 v52, v52, v92
    v_mul_f32 v53, v53, v92
    v_mul_f32 v54, v54, v92
    v_mul_f32 v55, v55, v92
    v_cvt_pk_bf16_f32 v56, v48, v49
    v_cvt_pk_bf16_f32 v57, v50, v51
    v_cvt_pk_bf16_f32 v58, v52, v53
    v_cvt_pk_bf16_f32 v59, v54, v55
    v_min_u32 v56, -2, v56
    v_min_u32 v57, -2, v57
    v_min_u32 v58, -2, v58
    v_min_u32 v59, -2, v59
    buffer_store_dwordx4 v[56:59], v15, s[8:11], s43 offen sc1
    s_waitcnt vmcnt(2)
    v_mfma_f32_16x16x32_bf16 v[36:39], a[240:243], v[80:83], 0
    v_mfma_f32_16x16x32_bf16 v[44:47], a[244:247], v[80:83], 0
    v_mfma_f32_16x16x32_bf16 v[68:71], v[24:27], v[80:83], 0
    v_mfma_f32_16x16x32_bf16 v[40:43], a[240:243], v[84:87], 0
    v_mfma_f32_16x16x32_bf16 v[64:67], a[244:247], v[84:87], 0
    v_mfma_f32_16x16x32_bf16 v[72:75], v[24:27], v[84:87], 0
    s_nop 0
    v_mfma_f32_16x16x16_bf16 v[36:39], a[248:249], v[88:89], v[36:39]
    v_mfma_f32_16x16x16_bf16 v[44:47], a[250:251], v[88:89], v[44:47]
    v_mfma_f32_16x16x16_bf16 v[68:71], v[32:33], v[88:89], v[68:71]
    v_mfma_f32_16x16x16_bf16 v[40:43], a[248:249], v[90:91], v[40:43]
    v_mfma_f32_16x16x16_bf16 v[64:67], a[250:251], v[90:91], v[64:67]
    v_mfma_f32_16x16x16_bf16 v[72:75], v[32:33], v[90:91], v[72:75]
    s_nop 2
    ds_write_b128 v16, v[36:39] offset:0
    ds_write_b128 v16, v[44:47] offset:16
    ds_write_b128 v17, v[68:71]
    ds_write_b128 v16, v[40:43] offset:2816
    ds_write_b128 v16, v[64:67] offset:2832
    ds_write_b128 v18, v[72:75]
    s_add_u32 s40, s40, 1
    s_add_u32 s41, s41, 393216
    s_add_u32 s45, s45, 393216
    s_add_u32 s43, s43, 458752
    s_add_u32 s47, s47, 458752
    s_add_u32 s48, s48, 458752
    s_add_u32 s49, s49, 458752
    s_waitcnt lgkmcnt(0)
    s_barrier
    s_cmp_lt_u32 s40, 64
    s_cbranch_scc1 interleave_layers__linear_attn_block__memory_aug_recurrent_mem_tr__prompt_kernel_s_stepw0
    s_branch interleave_layers__linear_attn_block__memory_aug_recurrent_mem_tr__prompt_kernel_s_end
interleave_layers__linear_attn_block__memory_aug_recurrent_mem_tr__prompt_kernel_s_stepw1:
    v_mov_b32 v24, 0
    v_mov_b32 v25, 0
    v_mov_b32 v26, 0
    v_mov_b32 v27, 0
    v_mov_b32 v28, 0
    v_mov_b32 v29, 0
    v_mov_b32 v30, 0
    v_mov_b32 v31, 0
    v_mov_b32 v32, 0
    v_mov_b32 v33, 0
    v_mov_b32 v34, 0
    v_mov_b32 v35, 0
    v_mov_b32 v36, 0
    v_mov_b32 v37, 0
    v_mov_b32 v38, 0
    v_mov_b32 v39, 0
    v_mov_b32 v40, 0
    v_mov_b32 v41, 0
    v_mov_b32 v42, 0
    v_mov_b32 v43, 0
    v_mov_b32 v44, 0
    v_mov_b32 v45, 0
    v_mov_b32 v46, 0
    v_mov_b32 v47, 0
    s_add_u32 s46, s47, 4096
    s_lshl_b32 s95, s92, 6
    s_add_u32 s95, s95, s40
    s_add_u32 s95, s95, 1
    s_cmp_ge_i32 s59, s95
    s_cbranch_scc1 interleave_layers__linear_attn_block__memory_aug_recurrent_mem_tr__prompt_kernel_s_ecw1_ok
    s_and_b32 s24, s2, 7
    s_lshl_b32 s24, s24, 7
    s_add_u32 s24, s24, 23109632
    v_and_b32 v49, 3, v1
    v_lshl_add_u32 v49, v49, 2, s24
    s_mov_b32 s61, 0
interleave_layers__linear_attn_block__memory_aug_recurrent_mem_tr__prompt_kernel_s_ecw1:
    buffer_load_dword v48, v49, s[8:11], 0 offen sc1
    s_waitcnt vmcnt(0)
    v_readlane_b32 s59, v48, 0
    v_readlane_b32 s24, v48, 1
    s_min_i32 s59, s59, s24
    v_readlane_b32 s24, v48, 2
    s_min_i32 s59, s59, s24
    s_cmp_ge_i32 s59, s95
    s_cbranch_scc1 interleave_layers__linear_attn_block__memory_aug_recurrent_mem_tr__prompt_kernel_s_ecw1_ok
    s_add_u32 s61, s61, 1
    s_cmp_ge_u32 s61, s60
    s_cbranch_scc1 interleave_layers__linear_attn_block__memory_aug_recurrent_mem_tr__prompt_kernel_s_ecw1_to
    s_sleep 2
    s_branch interleave_layers__linear_attn_block__memory_aug_recurrent_mem_tr__prompt_kernel_s_ecw1
interleave_layers__linear_attn_block__memory_aug_recurrent_mem_tr__prompt_kernel_s_ecw1_to:
    s_mov_b32 s60, 1
interleave_layers__linear_attn_block__memory_aug_recurrent_mem_tr__prompt_kernel_s_ecw1_ok:
    s_add_u32 s63, s40, 1
    s_cmp_ge_i32 s62, s63
    s_cbranch_scc1 interleave_layers__linear_attn_block__memory_aug_recurrent_mem_tr__prompt_kernel_s_enw1_ok
    s_mov_b32 s61, 0
interleave_layers__linear_attn_block__memory_aug_recurrent_mem_tr__prompt_kernel_s_enw1:
    buffer_load_dword v48, v9, s[8:11], 0 offen sc1
    s_waitcnt vmcnt(0)
    v_readlane_b32 s62, v48, 0
    v_readlane_b32 s24, v48, 1
    s_min_i32 s62, s62, s24
    s_cmp_ge_i32 s62, s63
    s_cbranch_scc1 interleave_layers__linear_attn_block__memory_aug_recurrent_mem_tr__prompt_kernel_s_enw1_ok
    s_add_u32 s61, s61, 1
    s_cmp_ge_u32 s61, s60
    s_cbranch_scc1 interleave_layers__linear_attn_block__memory_aug_recurrent_mem_tr__prompt_kernel_s_enw1_to
    s_sleep 2
    s_branch interleave_layers__linear_attn_block__memory_aug_recurrent_mem_tr__prompt_kernel_s_enw1
interleave_layers__linear_attn_block__memory_aug_recurrent_mem_tr__prompt_kernel_s_enw1_to:
    s_mov_b32 s60, 1
interleave_layers__linear_attn_block__memory_aug_recurrent_mem_tr__prompt_kernel_s_enw1_ok:
    buffer_load_dwordx4 a[240:243], v19, s[8:11], s41 offen offset:0 sc1
    buffer_load_dwordx4 a[244:247], v19, s[8:11], s41 offen offset:1024 sc1
    buffer_load_dwordx4 a[248:251], v19, s[8:11], s41 offen offset:2048 sc1
    s_sleep 5
    s_mov_b64 exec, 1
    s_mov_b32 s61, 0
    v_mov_b32 v83, 0
    buffer_atomic_add v83, v23, s[8:11], s48 offen sc0
    s_sleep 3
    v_mov_b32 v94, 0
    buffer_atomic_add v94, v23, s[8:11], s48 offen sc0
    s_sleep 3
    v_mov_b32 v95, 0
    buffer_atomic_add v95, v23, s[8:11], s48 offen sc0
    s_sleep 3
interleave_layers__linear_attn_block__memory_aug_recurrent_mem_tr__prompt_kernel_s_prw1:
    v_mov_b32 v82, 0
    buffer_atomic_add v82, v23, s[8:11], s48 offen sc0
    s_waitcnt vmcnt(3)
    v_cmp_le_i32 vcc, 8, v83
    s_add_u32 s61, s61, 1
    s_cbranch_vccnz interleave_layers__linear_attn_block__memory_aug_recurrent_mem_tr__prompt_kernel_s_prw1_out
    s_sleep 3
    v_mov_b32 v83, 0
    buffer_atomic_add v83, v23, s[8:11], s48 offen sc0
    s_waitcnt vmcnt(3)
    v_cmp_le_i32 vcc, 8, v94
    s_add_u32 s61, s61, 1
    s_cbranch_vccnz interleave_layers__linear_attn_block__memory_aug_recurrent_mem_tr__prompt_kernel_s_prw1_out
    s_sleep 3
    v_mov_b32 v94, 0
    buffer_atomic_add v94, v23, s[8:11], s48 offen sc0
    s_waitcnt vmcnt(3)
    v_cmp_le_i32 vcc, 8, v95
    s_add_u32 s61, s61, 1
    s_cbranch_vccnz interleave_layers__linear_attn_block__memory_aug_recurrent_mem_tr__prompt_kernel_s_prw1_out
    s_sleep 3
    v_mov_b32 v95, 0
    buffer_atomic_add v95, v23, s[8:11], s48 offen sc0
    s_waitcnt vmcnt(3)
    v_cmp_le_i32 vcc, 8, v82
    s_add_u32 s61, s61, 1
    s_cbranch_vccnz interleave_layers__linear_attn_block__memory_aug_recurrent_mem_tr__prompt_kernel_s_prw1_out
    s_sleep 3
    s_cmp_ge_u32 s61, s60
    s_cbranch_scc0 interleave_layers__linear_attn_block__memory_aug_recurrent_mem_tr__prompt_kernel_s_prw1
    s_mov_b32 s60, 1
interleave_layers__linear_attn_block__memory_aug_recurrent_mem_tr__prompt_kernel_s_prw1_out:
    s_mov_b64 exec, -1
    buffer_load_dwordx4 v[84:87], v7, s[8:11], s47 offen sc1
    buffer_load_dwordx4 v[88:91], v7, s[8:11], s46 offen sc1
    buffer_load_dwordx2 v[92:93], v8, s[8:11], s47 offen sc1
    ds_read_b128 v[48:51], v21 offset:0
    ds_read_b128 v[52:55], v21 offset:16
    ds_read_b128 v[56:59], v21 offset:5632
    ds_read_b128 v[60:63], v21 offset:5648
    ds_read_b128 v[64:67], v21 offset:11264
    ds_read_b128 v[68:71], v21 offset:11280
    ds_read_b128 v[72:75], v21 offset:16896
    ds_read_b128 v[76:79], v21 offset:16912
    s_waitcnt lgkmcnt(4)
    v_pk_add_f32 v[48:49], v[48:49], v[56:57]
    v_pk_add_f32 v[50:51], v[50:51], v[58:59]
    v_pk_add_f32 v[52:53], v[52:53], v[60:61]
    v_pk_add_f32 v[54:55], v[54:55], v[62:63]
    s_waitcnt lgkmcnt(0)
    v_pk_add_f32 v[64:65], v[64:65], v[72:73]
    v_pk_add_f32 v[66:67], v[66:67], v[74:75]
    v_pk_add_f32 v[68:69], v[68:69], v[76:77]
    v_pk_add_f32 v[70:71], v[70:71], v[78:79]
    v_pk_add_f32 v[48:49], v[48:49], v[64:65]
    v_pk_add_f32 v[50:51], v[50:51], v[66:67]
    v_pk_add_f32 v[52:53], v[52:53], v[68:69]
    v_pk_add_f32 v[54:55], v[54:55], v[70:71]
    v_mov_b32 v81, 0xff800000
    v_cndmask_b32 v48, v81, v48, s[64:65]
    v_cndmask_b32 v49, v81, v49, s[66:67]
    v_cndmask_b32 v50, v81, v50, s[68:69]
    v_cndmask_b32 v51, v81, v51, s[70:71]
    v_cndmask_b32 v52, v81, v52, s[72:73]
    v_cndmask_b32 v53, v81, v53, s[74:75]
    v_cndmask_b32 v54, v81, v54, s[76:77]
    v_cndmask_b32 v55, v81, v55, s[78:79]
    v_max3_f32 v80, v48, v49, v50
    v_max3_f32 v80, v80, v51, v52
    v_max3_f32 v80, v80, v53, v54
    v_max_f32 v80, v80, v55
    v_mov_b32 v81, 0xff800000
    v_cndmask_b32 v80, v81, v80, s[50:51]
    s_nop 1
    v_max_f32 v80, v80, v80 quad_perm:[1,0,3,2] row_mask:0xf bank_mask:0xf
    s_nop 1
    v_max_f32 v80, v80, v80 quad_perm:[2,3,0,1] row_mask:0xf bank_mask:0xf
    s_nop 1
    v_max_f32 v80, v80, v80 row_half_mirror row_mask:0xf bank_mask:0xf
    s_mov_b32 s24, 0x3dd53b95
    v_mul_f32 v80, s24, v80
    v_fma_f32 v48, v48, s24, -v80
    v_fma_f32 v49, v49, s24, -v80
    v_fma_f32 v50, v50, s24, -v80
    v_fma_f32 v51, v51, s24, -v80
    v_fma_f32 v52, v52, s24, -v80
    v_fma_f32 v53, v53, s24, -v80
    v_fma_f32 v54, v54, s24, -v80
    v_fma_f32 v55, v55, s24, -v80
    v_exp_f32 v48, v48
    v_exp_f32 v49, v49
    v_exp_f32 v50, v50
    v_exp_f32 v51, v51
    v_exp_f32 v52, v52
    v_exp_f32 v53, v53
    v_exp_f32 v54, v54
    v_exp_f32 v55, v55
    v_add_f32 v80, v48, v49
    v_add_f32 v81, v50, v51
    v_add_f32 v80, v80, v52
    v_add_f32 v81, v81, v53
    v_add_f32 v80, v80, v54
    v_add_f32 v81, v81, v55
    v_add_f32 v80, v80, v81
    v_cndmask_b32 v80, 0, v80, s[50:51]
    s_nop 1
    v_add_f32 v80, v80, v80 quad_perm:[1,0,3,2] row_mask:0xf bank_mask:0xf
    s_nop 1
    v_add_f32 v80, v80, v80 quad_perm:[2,3,0,1] row_mask:0xf bank_mask:0xf
    s_nop 1
    v_add_f32 v80, v80, v80 row_half_mirror row_mask:0xf bank_mask:0xf
    v_rcp_f32 v80, v80
    s_nop 0
    v_mul_f32 v48, v48, v80
    v_mul_f32 v49, v49, v80
    v_mul_f32 v50, v50, v80
    v_mul_f32 v51, v51, v80
    v_mul_f32 v52, v52, v80
    v_mul_f32 v53, v53, v80
    v_mul_f32 v54, v54, v80
    v_mul_f32 v55, v55, v80
    v_cvt_pk_bf16_f32 v56, v48, v49
    v_cvt_pk_bf16_f32 v57, v50, v51
    v_cvt_pk_bf16_f32 v58, v52, v53
    v_cvt_pk_bf16_f32 v59, v54, v55
    v_min_u32 v56, -2, v56
    v_min_u32 v57, -2, v57
    v_min_u32 v58, -2, v58
    v_min_u32 v59, -2, v59
    buffer_store_dwordx4 v[56:59], v22, s[8:11], s42 offen sc1
    s_add_u32 s42, s42, 458752
    s_waitcnt vmcnt(1)
    v_max3_u32 v58, v84, v85, v86
    v_max3_u32 v58, v58, v87, v88
    v_max3_u32 v58, v58, v89, v90
    v_max3_u32 v58, v58, v91, v92
    v_max_u32 v58, v58, v93
    v_cmp_eq_u32 vcc, -1, v58
    s_cbranch_vccz interleave_layers__linear_attn_block__memory_aug_recurrent_mem_tr__prompt_kernel_s_pmw1_out
    s_mov_b32 s61, 0
interleave_layers__linear_attn_block__memory_aug_recurrent_mem_tr__prompt_kernel_s_pmw1:
    buffer_load_dwordx4 v[84:87], v7, s[8:11], s47 offen sc1
    buffer_load_dwordx4 v[88:91], v7, s[8:11], s46 offen sc1
    buffer_load_dwordx2 v[92:93], v8, s[8:11], s47 offen sc1
    s_waitcnt vmcnt(0)
    v_max3_u32 v58, v84, v85, v86
    v_max3_u32 v58, v58, v87, v88
    v_max3_u32 v58, v58, v89, v90
    v_max3_u32 v58, v58, v91, v92
    v_max_u32 v58, v58, v93
    v_cmp_eq_u32 vcc, -1, v58
    s_add_u32 s61, s61, 1
    s_cbranch_vccz interleave_layers__linear_attn_block__memory_aug_recurrent_mem_tr__prompt_kernel_s_pmw1_out
    s_cmp_ge_u32 s61, s60
    s_cbranch_scc1 interleave_layers__linear_attn_block__memory_aug_recurrent_mem_tr__prompt_kernel_s_pmw1_to
    s_sleep 1
    s_branch interleave_layers__linear_attn_block__memory_aug_recurrent_mem_tr__prompt_kernel_s_pmw1
interleave_layers__linear_attn_block__memory_aug_recurrent_mem_tr__prompt_kernel_s_pmw1_to:
    s_mov_b32 s60, 1
interleave_layers__linear_attn_block__memory_aug_recurrent_mem_tr__prompt_kernel_s_pmw1_out:
    ds_write_b128 v7, v[84:87]
    ds_write_b128 v7, v[88:91] offset:4096
    ds_write_b64 v8, v[92:93]
interleave_layers__linear_attn_block__memory_aug_recurrent_mem_tr__prompt_kernel_s_gow1:
    ds_read_b128 v[68:71], v6 offset:2048
    ds_read_b128 v[72:75], v6 offset:3072
    ds_read_b128 v[76:79], v6 offset:10240
    ds_read_b128 v[80:83], v6 offset:11264
    v_smfmac_f32_16x16x64_bf16 v[24:27], v[84:87], a[8:15], v4
    v_smfmac_f32_16x16x64_bf16 v[28:31], v[84:87], a[88:95], v4
    v_smfmac_f32_16x16x64_bf16 v[32:35], v[84:87], a[168:175], v4
    v_smfmac_f32_16x16x64_bf16 v[40:43], v[84:87], v[104:111], v4
    v_smfmac_f32_16x16x64_bf16 v[44:47], v[84:87], v[184:191], v4
    s_waitcnt lgkmcnt(2)
    v_smfmac_f32_16x16x64_bf16 v[36:39], v[84:87], v[68:75], v4
    ds_read_b128 v[68:71], v6 offset:0
    ds_read_b128 v[72:75], v6 offset:1024
    s_barrier
    ds_read_b128 v[48:51], v5 offset:0
    ds_read_b128 v[52:55], v5 offset:2048
    ds_read_b128 v[56:59], v5 offset:3072
    ds_read_b128 v[60:63], v5 offset:4096
    ds_read_b128 v[64:67], v5 offset:6144
    v_smfmac_f32_16x16x64_bf16 v[24:27], v[88:91], a[40:47], v4
    v_smfmac_f32_16x16x64_bf16 v[28:31], v[88:91], a[120:127], v4
    v_smfmac_f32_16x16x64_bf16 v[32:35], v[88:91], a[200:207], v4
    v_smfmac_f32_16x16x64_bf16 v[40:43], v[88:91], v[136:143], v4
    v_smfmac_f32_16x16x64_bf16 v[44:47], v[88:91], v[216:223], v4
    s_waitcnt lgkmcnt(7)
    v_smfmac_f32_16x16x64_bf16 v[36:39], v[88:91], v[76:83], v4
    ds_read_b128 v[76:79], v6 offset:4096
    ds_read_b128 v[80:83], v6 offset:5120
    s_waitcnt lgkmcnt(6)
    v_smfmac_f32_16x16x64_bf16 v[24:27], v[48:51], a[0:7], v4
    v_smfmac_f32_16x16x64_bf16 v[28:31], v[48:51], a[80:87], v4
    v_smfmac_f32_16x16x64_bf16 v[40:43], v[48:51], v[96:103], v4
    v_smfmac_f32_16x16x64_bf16 v[36:39], v[48:51], v[68:75], v4
    ds_read_b128 v[68:71], v6 offset:6144
    ds_read_b128 v[72:75], v6 offset:7168
    ds_read_b128 v[48:51], v5 offset:7168
    s_waitcnt lgkmcnt(8)
    v_smfmac_f32_16x16x64_bf16 v[24:27], v[52:55], a[16:23], v4
    v_smfmac_f32_16x16x64_bf16 v[28:31], v[52:55], a[96:103], v4
    v_smfmac_f32_16x16x64_bf16 v[40:43], v[52:55], v[112:119], v4
    s_waitcnt lgkmcnt(3)
    v_smfmac_f32_16x16x64_bf16 v[36:39], v[52:55], v[76:83], v4
    ds_read_b128 v[76:79], v6 offset:8192
    ds_read_b128 v[80:83], v6 offset:9216
    ds_read_b128 v[52:55], v5 offset:8192
    v_smfmac_f32_16x16x64_bf16 v[24:27], v[56:59], a[24:31], v4
    v_smfmac_f32_16x16x64_bf16 v[28:31], v[56:59], a[104:111], v4
    v_smfmac_f32_16x16x64_bf16 v[40:43], v[56:59], v[120:127], v4
    s_waitcnt lgkmcnt(4)
    v_smfmac_f32_16x16x64_bf16 v[36:39], v[56:59], v[68:75], v4
    ds_read_b128 v[68:71], v6 offset:12288
    ds_read_b128 v[72:75], v6 offset:13312
    ds_read_b128 v[56:59], v5 offset:9216
    v_smfmac_f32_16x16x64_bf16 v[24:27], v[60:63], a[32:39], v4
    v_smfmac_f32_16x16x64_bf16 v[28:31], v[60:63], a[112:119], v4
    v_smfmac_f32_16x16x64_bf16 v[40:43], v[60:63], v[128:135], v4
    s_waitcnt lgkmcnt(4)
    v_smfmac_f32_16x16x64_bf16 v[36:39], v[60:63], v[76:83], v4
    ds_read_b128 v[76:79], v6 offset:14336
    ds_read_b128 v[80:83], v6 offset:15360
    ds_read_b128 v[60:63], v5 offset:0
    v_smfmac_f32_16x16x64_bf16 v[24:27], v[64:67], a[48:55], v4
    v_smfmac_f32_16x16x64_bf16 v[28:31], v[64:67], a[128:135], v4
    v_smfmac_f32_16x16x64_bf16 v[40:43], v[64:67], v[144:151], v4
    s_waitcnt lgkmcnt(4)
    v_smfmac_f32_16x16x64_bf16 v[36:39], v[64:67], v[68:75], v4
    ds_read_b128 v[68:71], v6 offset:16384
    ds_read_b128 v[72:75], v6 offset:17408
    ds_read_b128 v[64:67], v5 offset:2048
    v_smfmac_f32_16x16x64_bf16 v[24:27], v[48:51], a[56:63], v4
    v_smfmac_f32_16x16x64_bf16 v[28:31], v[48:51], a[136:143], v4
    v_smfmac_f32_16x16x64_bf16 v[40:43], v[48:51], v[152:159], v4
    s_waitcnt lgkmcnt(4)
    v_smfmac_f32_16x16x64_bf16 v[36:39], v[48:51], v[76:83], v4
    ds_read_b128 v[76:79], v6 offset:18432
    ds_read_b128 v[80:83], v6 offset:19456
    ds_read_b128 v[48:51], v5 offset:3072
    v_smfmac_f32_16x16x64_bf16 v[24:27], v[52:55], a[64:71], v4
    v_smfmac_f32_16x16x64_bf16 v[28:31], v[52:55], a[144:151], v4
    v_smfmac_f32_16x16x64_bf16 v[40:43], v[52:55], v[160:167], v4
    s_waitcnt lgkmcnt(4)
    v_smfmac_f32_16x16x64_bf16 v[36:39], v[52:55], v[68:75], v4
    ds_read_b128 v[52:55], v5 offset:4096
    v_smfmac_f32_16x16x64_bf16 v[24:27], v[56:59], a[72:79], v4
    v_smfmac_f32_16x16x64_bf16 v[28:31], v[56:59], a[152:159], v4
    v_smfmac_f32_16x16x64_bf16 v[40:43], v[56:59], v[168:175], v4
    s_waitcnt lgkmcnt(2)
    v_smfmac_f32_16x16x64_bf16 v[36:39], v[56:59], v[76:83], v4
    ds_read_b128 v[56:59], v5 offset:6144
    buffer_load_dwordx4 v[80:83], v19, s[8:11], s45 offen offset:0 sc1
    buffer_load_dwordx4 v[84:87], v19, s[8:11], s45 offen offset:1024 sc1
    buffer_load_dwordx4 v[88:91], v19, s[8:11], s45 offen offset:2048 sc1
    v_smfmac_f32_16x16x64_bf16 v[32:35], v[60:63], a[160:167], v4
    v_smfmac_f32_16x16x64_bf16 v[44:47], v[60:63], v[176:183], v4
    v_permlane32_swap_b32 v28, v40
    v_permlane32_swap_b32 v29, v41
    ds_read_b128 v[60:63], v5 offset:7168
    v_smfmac_f32_16x16x64_bf16 v[32:35], v[64:67], a[176:183], v4
    v_permlane32_swap_b32 v30, v42
    v_permlane32_swap_b32 v31, v43
    v_smfmac_f32_16x16x64_bf16 v[44:47], v[64:67], v[192:199], v4
    v_add_f32 v28, v28, v40
    v_add_f32 v29, v29, v41
    ds_read_b128 v[64:67], v5 offset:8192
    s_waitcnt lgkmcnt(4)
    v_smfmac_f32_16x16x64_bf16 v[32:35], v[48:51], a[184:191], v4
    v_add_f32 v30, v30, v42
    v_add_f32 v31, v31, v43
    v_smfmac_f32_16x16x64_bf16 v[44:47], v[48:51], v[200:207], v4
    v_cvt_pk_bf16_f32 v40, v28, v29
    v_cvt_pk_bf16_f32 v41, v30, v31
    ds_read_b128 v[48:51], v5 offset:9216
    s_waitcnt lgkmcnt(4)
    v_smfmac_f32_16x16x64_bf16 v[32:35], v[52:55], a[192:199], v4
    v_mfma_f32_16x16x16_bf16 v[28:31], v[40:41], v[10:11], 0
    v_permlane32_swap_b32 v24, v36
    v_smfmac_f32_16x16x64_bf16 v[44:47], v[52:55], v[208:215], v4
    v_permlane32_swap_b32 v25, v37
    v_permlane32_swap_b32 v26, v38
    s_waitcnt lgkmcnt(3)
    v_smfmac_f32_16x16x64_bf16 v[32:35], v[56:59], a[208:215], v4
    v_permlane32_swap_b32 v27, v39
    v_add_f32 v24, v24, v36
    v_smfmac_f32_16x16x64_bf16 v[44:47], v[56:59], v[224:231], v4
    v_add_f32 v25, v25, v37
    v_add_f32 v26, v26, v38
    s_waitcnt lgkmcnt(2)
    v_smfmac_f32_16x16x64_bf16 v[32:35], v[60:63], a[216:223], v4
    v_add_f32 v27, v27, v39
    v_cvt_pk_bf16_f32 v36, v24, v25
    v_smfmac_f32_16x16x64_bf16 v[44:47], v[60:63], v[232:239], v4
    v_cvt_pk_bf16_f32 v37, v26, v27
    s_nop 1
    v_mfma_f32_16x16x16_bf16 v[24:27], v[36:37], v[10:11], 0
    s_waitcnt lgkmcnt(1)
    v_smfmac_f32_16x16x64_bf16 v[32:35], v[64:67], a[224:231], v4
    s_nop 5
    v_cvt_pk_bf16_f32 v24, v24, v25
    v_smfmac_f32_16x16x64_bf16 v[44:47], v[64:67], v[240:247], v4
    v_cvt_pk_bf16_f32 v25, v26, v27
    v_cvt_pk_bf16_f32 v26, v28, v29
    s_waitcnt lgkmcnt(0)
    v_smfmac_f32_16x16x64_bf16 v[32:35], v[48:51], a[232:239], v4
    v_cvt_pk_bf16_f32 v27, v30, v31
    s_waitcnt vmcnt(3)
    v_smfmac_f32_16x16x64_bf16 v[44:47], v[48:51], v[248:255], v4
    v_mfma_f32_16x16x32_bf16 v[28:31], a[240:243], v[24:27], 0
    v_mfma_f32_16x16x32_bf16 v[36:39], a[244:247], v[24:27], 0
    v_mfma_f32_16x16x32_bf16 v[40:43], v[24:27], v[24:27], 0
    s_nop 4
    v_permlane32_swap_b32 v32, v44
    v_permlane32_swap_b32 v33, v45
    v_permlane32_swap_b32 v34, v46
    v_permlane32_swap_b32 v35, v47
    v_add_f32 v32, v32, v44
    v_add_f32 v33, v33, v45
    v_add_f32 v34, v34, v46
    v_add_f32 v35, v35, v47
    v_cvt_pk_bf16_f32 v44, v32, v33
    v_cvt_pk_bf16_f32 v45, v34, v35
    s_nop 1
    v_mfma_f32_16x16x16_bf16 v[32:35], v[44:45], v[10:11], 0
    s_nop 7
    v_cvt_pk_bf16_f32 v32, v32, v33
    v_cvt_pk_bf16_f32 v33, v34, v35
    s_nop 1
    v_mfma_f32_16x16x16_bf16 v[28:31], a[248:249], v[32:33], v[28:31]
    v_mfma_f32_16x16x16_bf16 v[36:39], a[250:251], v[32:33], v[36:39]
    v_mfma_f32_16x16x16_bf16 v[40:43], v[32:33], v[32:33], v[40:43]
    s_nop 5
    ds_write_b128 v12, v[28:31]
    ds_write_b128 v12, v[36:39] offset:16
    ds_write_b128 v13, v[40:43]
    s_waitcnt lgkmcnt(0)
    s_barrier
    s_waitcnt vmcnt(0)
    v_mfma_f32_16x16x32_bf16 v[36:39], a[240:243], v[80:83], 0
    v_mfma_f32_16x16x32_bf16 v[44:47], a[244:247], v[80:83], 0
    v_mfma_f32_16x16x32_bf16 v[68:71], v[24:27], v[80:83], 0
    v_mfma_f32_16x16x32_bf16 v[40:43], a[240:243], v[84:87], 0
    v_mfma_f32_16x16x32_bf16 v[64:67], a[244:247], v[84:87], 0
    v_mfma_f32_16x16x32_bf16 v[72:75], v[24:27], v[84:87], 0
    s_nop 0
    v_mfma_f32_16x16x16_bf16 v[36:39], a[248:249], v[88:89], v[36:39]
    v_mfma_f32_16x16x16_bf16 v[44:47], a[250:251], v[88:89], v[44:47]
    v_mfma_f32_16x16x16_bf16 v[68:71], v[32:33], v[88:89], v[68:71]
    v_mfma_f32_16x16x16_bf16 v[40:43], a[248:249], v[90:91], v[40:43]
    v_mfma_f32_16x16x16_bf16 v[64:67], a[250:251], v[90:91], v[64:67]
    v_mfma_f32_16x16x16_bf16 v[72:75], v[32:33], v[90:91], v[72:75]
    s_nop 2
    ds_write_b128 v16, v[36:39] offset:0
    ds_write_b128 v16, v[44:47] offset:16
    ds_write_b128 v17, v[68:71]
    ds_write_b128 v16, v[40:43] offset:2816
    ds_write_b128 v16, v[64:67] offset:2832
    ds_write_b128 v18, v[72:75]
    s_add_u32 s40, s40, 1
    s_add_u32 s41, s41, 393216
    s_add_u32 s45, s45, 393216
    s_add_u32 s43, s43, 458752
    s_add_u32 s47, s47, 458752
    s_add_u32 s48, s48, 458752
    s_add_u32 s49, s49, 458752
    s_waitcnt lgkmcnt(0)
    s_barrier
    s_cmp_lt_u32 s40, 64
    s_cbranch_scc1 interleave_layers__linear_attn_block__memory_aug_recurrent_mem_tr__prompt_kernel_s_stepw1
    s_branch interleave_layers__linear_attn_block__memory_aug_recurrent_mem_tr__prompt_kernel_s_end
interleave_layers__linear_attn_block__memory_aug_recurrent_mem_tr__prompt_kernel_s_stepw2:
    v_mov_b32 v24, 0
    v_mov_b32 v25, 0
    v_mov_b32 v26, 0
    v_mov_b32 v27, 0
    v_mov_b32 v28, 0
    v_mov_b32 v29, 0
    v_mov_b32 v30, 0
    v_mov_b32 v31, 0
    v_mov_b32 v32, 0
    v_mov_b32 v33, 0
    v_mov_b32 v34, 0
    v_mov_b32 v35, 0
    v_mov_b32 v36, 0
    v_mov_b32 v37, 0
    v_mov_b32 v38, 0
    v_mov_b32 v39, 0
    v_mov_b32 v40, 0
    v_mov_b32 v41, 0
    v_mov_b32 v42, 0
    v_mov_b32 v43, 0
    v_mov_b32 v44, 0
    v_mov_b32 v45, 0
    v_mov_b32 v46, 0
    v_mov_b32 v47, 0
    s_add_u32 s46, s47, 4096
    s_lshl_b32 s95, s92, 6
    s_add_u32 s95, s95, s40
    s_add_u32 s95, s95, 1
    s_cmp_ge_i32 s59, s95
    s_cbranch_scc1 interleave_layers__linear_attn_block__memory_aug_recurrent_mem_tr__prompt_kernel_s_ecw2_ok
    s_and_b32 s24, s2, 7
    s_lshl_b32 s24, s24, 7
    s_add_u32 s24, s24, 23109632
    v_and_b32 v49, 3, v1
    v_lshl_add_u32 v49, v49, 2, s24
    s_mov_b32 s61, 0
interleave_layers__linear_attn_block__memory_aug_recurrent_mem_tr__prompt_kernel_s_ecw2:
    buffer_load_dword v48, v49, s[8:11], 0 offen sc1
    s_waitcnt vmcnt(0)
    v_readlane_b32 s59, v48, 0
    v_readlane_b32 s24, v48, 1
    s_min_i32 s59, s59, s24
    v_readlane_b32 s24, v48, 2
    s_min_i32 s59, s59, s24
    s_cmp_ge_i32 s59, s95
    s_cbranch_scc1 interleave_layers__linear_attn_block__memory_aug_recurrent_mem_tr__prompt_kernel_s_ecw2_ok
    s_add_u32 s61, s61, 1
    s_cmp_ge_u32 s61, s60
    s_cbranch_scc1 interleave_layers__linear_attn_block__memory_aug_recurrent_mem_tr__prompt_kernel_s_ecw2_to
    s_sleep 2
    s_branch interleave_layers__linear_attn_block__memory_aug_recurrent_mem_tr__prompt_kernel_s_ecw2
interleave_layers__linear_attn_block__memory_aug_recurrent_mem_tr__prompt_kernel_s_ecw2_to:
    s_mov_b32 s60, 1
interleave_layers__linear_attn_block__memory_aug_recurrent_mem_tr__prompt_kernel_s_ecw2_ok:
    s_add_u32 s63, s40, 1
    s_cmp_ge_i32 s62, s63
    s_cbranch_scc1 interleave_layers__linear_attn_block__memory_aug_recurrent_mem_tr__prompt_kernel_s_enw2_ok
    s_mov_b32 s61, 0
interleave_layers__linear_attn_block__memory_aug_recurrent_mem_tr__prompt_kernel_s_enw2:
    buffer_load_dword v48, v9, s[8:11], 0 offen sc1
    s_waitcnt vmcnt(0)
    v_readlane_b32 s62, v48, 0
    v_readlane_b32 s24, v48, 1
    s_min_i32 s62, s62, s24
    s_cmp_ge_i32 s62, s63
    s_cbranch_scc1 interleave_layers__linear_attn_block__memory_aug_recurrent_mem_tr__prompt_kernel_s_enw2_ok
    s_add_u32 s61, s61, 1
    s_cmp_ge_u32 s61, s60
    s_cbranch_scc1 interleave_layers__linear_attn_block__memory_aug_recurrent_mem_tr__prompt_kernel_s_enw2_to
    s_sleep 2
    s_branch interleave_layers__linear_attn_block__memory_aug_recurrent_mem_tr__prompt_kernel_s_enw2
interleave_layers__linear_attn_block__memory_aug_recurrent_mem_tr__prompt_kernel_s_enw2_to:
    s_mov_b32 s60, 1
interleave_layers__linear_attn_block__memory_aug_recurrent_mem_tr__prompt_kernel_s_enw2_ok:
    buffer_load_dwordx4 a[240:243], v19, s[8:11], s41 offen offset:0 sc1
    buffer_load_dwordx4 a[244:247], v19, s[8:11], s41 offen offset:1024 sc1
    buffer_load_dwordx4 a[248:251], v19, s[8:11], s41 offen offset:2048 sc1
    s_sleep 5
    s_mov_b64 exec, 1
    s_mov_b32 s61, 0
    v_mov_b32 v83, 0
    buffer_atomic_add v83, v23, s[8:11], s48 offen sc0
    s_sleep 3
    v_mov_b32 v94, 0
    buffer_atomic_add v94, v23, s[8:11], s48 offen sc0
    s_sleep 3
    v_mov_b32 v95, 0
    buffer_atomic_add v95, v23, s[8:11], s48 offen sc0
    s_sleep 3
interleave_layers__linear_attn_block__memory_aug_recurrent_mem_tr__prompt_kernel_s_prw2:
    v_mov_b32 v82, 0
    buffer_atomic_add v82, v23, s[8:11], s48 offen sc0
    s_waitcnt vmcnt(3)
    v_cmp_le_i32 vcc, 8, v83
    s_add_u32 s61, s61, 1
    s_cbranch_vccnz interleave_layers__linear_attn_block__memory_aug_recurrent_mem_tr__prompt_kernel_s_prw2_out
    s_sleep 3
    v_mov_b32 v83, 0
    buffer_atomic_add v83, v23, s[8:11], s48 offen sc0
    s_waitcnt vmcnt(3)
    v_cmp_le_i32 vcc, 8, v94
    s_add_u32 s61, s61, 1
    s_cbranch_vccnz interleave_layers__linear_attn_block__memory_aug_recurrent_mem_tr__prompt_kernel_s_prw2_out
    s_sleep 3
    v_mov_b32 v94, 0
    buffer_atomic_add v94, v23, s[8:11], s48 offen sc0
    s_waitcnt vmcnt(3)
    v_cmp_le_i32 vcc, 8, v95
    s_add_u32 s61, s61, 1
    s_cbranch_vccnz interleave_layers__linear_attn_block__memory_aug_recurrent_mem_tr__prompt_kernel_s_prw2_out
    s_sleep 3
    v_mov_b32 v95, 0
    buffer_atomic_add v95, v23, s[8:11], s48 offen sc0
    s_waitcnt vmcnt(3)
    v_cmp_le_i32 vcc, 8, v82
    s_add_u32 s61, s61, 1
    s_cbranch_vccnz interleave_layers__linear_attn_block__memory_aug_recurrent_mem_tr__prompt_kernel_s_prw2_out
    s_sleep 3
    s_cmp_ge_u32 s61, s60
    s_cbranch_scc0 interleave_layers__linear_attn_block__memory_aug_recurrent_mem_tr__prompt_kernel_s_prw2
    s_mov_b32 s60, 1
interleave_layers__linear_attn_block__memory_aug_recurrent_mem_tr__prompt_kernel_s_prw2_out:
    s_mov_b64 exec, -1
    buffer_load_dwordx4 v[84:87], v7, s[8:11], s47 offen sc1
    buffer_load_dwordx4 v[88:91], v7, s[8:11], s46 offen sc1
    buffer_load_dwordx2 v[92:93], v8, s[8:11], s47 offen sc1
    ds_read_b128 v[48:51], v21 offset:0
    ds_read_b128 v[52:55], v21 offset:16
    ds_read_b128 v[56:59], v21 offset:5632
    ds_read_b128 v[60:63], v21 offset:5648
    ds_read_b128 v[64:67], v21 offset:11264
    ds_read_b128 v[68:71], v21 offset:11280
    ds_read_b128 v[72:75], v21 offset:16896
    ds_read_b128 v[76:79], v21 offset:16912
    s_waitcnt lgkmcnt(4)
    v_pk_add_f32 v[48:49], v[48:49], v[56:57]
    v_pk_add_f32 v[50:51], v[50:51], v[58:59]
    v_pk_add_f32 v[52:53], v[52:53], v[60:61]
    v_pk_add_f32 v[54:55], v[54:55], v[62:63]
    s_waitcnt lgkmcnt(0)
    v_pk_add_f32 v[64:65], v[64:65], v[72:73]
    v_pk_add_f32 v[66:67], v[66:67], v[74:75]
    v_pk_add_f32 v[68:69], v[68:69], v[76:77]
    v_pk_add_f32 v[70:71], v[70:71], v[78:79]
    v_pk_add_f32 v[48:49], v[48:49], v[64:65]
    v_pk_add_f32 v[50:51], v[50:51], v[66:67]
    v_pk_add_f32 v[52:53], v[52:53], v[68:69]
    v_pk_add_f32 v[54:55], v[54:55], v[70:71]
    v_mov_b32 v81, 0xff800000
    v_cndmask_b32 v48, v81, v48, s[64:65]
    v_cndmask_b32 v49, v81, v49, s[66:67]
    v_cndmask_b32 v50, v81, v50, s[68:69]
    v_cndmask_b32 v51, v81, v51, s[70:71]
    v_cndmask_b32 v52, v81, v52, s[72:73]
    v_cndmask_b32 v53, v81, v53, s[74:75]
    v_cndmask_b32 v54, v81, v54, s[76:77]
    v_cndmask_b32 v55, v81, v55, s[78:79]
    v_max3_f32 v80, v48, v49, v50
    v_max3_f32 v80, v80, v51, v52
    v_max3_f32 v80, v80, v53, v54
    v_max_f32 v80, v80, v55
    v_mov_b32 v81, 0xff800000
    v_cndmask_b32 v80, v81, v80, s[50:51]
    s_nop 1
    v_max_f32 v80, v80, v80 quad_perm:[1,0,3,2] row_mask:0xf bank_mask:0xf
    s_nop 1
    v_max_f32 v80, v80, v80 quad_perm:[2,3,0,1] row_mask:0xf bank_mask:0xf
    s_nop 1
    v_max_f32 v80, v80, v80 row_half_mirror row_mask:0xf bank_mask:0xf
    s_mov_b32 s24, 0x3dd53b95
    v_mul_f32 v80, s24, v80
    v_fma_f32 v48, v48, s24, -v80
    v_fma_f32 v49, v49, s24, -v80
    v_fma_f32 v50, v50, s24, -v80
    v_fma_f32 v51, v51, s24, -v80
    v_fma_f32 v52, v52, s24, -v80
    v_fma_f32 v53, v53, s24, -v80
    v_fma_f32 v54, v54, s24, -v80
    v_fma_f32 v55, v55, s24, -v80
    v_exp_f32 v48, v48
    v_exp_f32 v49, v49
    v_exp_f32 v50, v50
    v_exp_f32 v51, v51
    v_exp_f32 v52, v52
    v_exp_f32 v53, v53
    v_exp_f32 v54, v54
    v_exp_f32 v55, v55
    v_add_f32 v80, v48, v49
    v_add_f32 v81, v50, v51
    v_add_f32 v80, v80, v52
    v_add_f32 v81, v81, v53
    v_add_f32 v80, v80, v54
    v_add_f32 v81, v81, v55
    v_add_f32 v80, v80, v81
    v_cndmask_b32 v80, 0, v80, s[50:51]
    s_nop 1
    v_add_f32 v80, v80, v80 quad_perm:[1,0,3,2] row_mask:0xf bank_mask:0xf
    s_nop 1
    v_add_f32 v80, v80, v80 quad_perm:[2,3,0,1] row_mask:0xf bank_mask:0xf
    s_nop 1
    v_add_f32 v80, v80, v80 row_half_mirror row_mask:0xf bank_mask:0xf
    v_rcp_f32 v80, v80
    s_nop 0
    v_mul_f32 v48, v48, v80
    v_mul_f32 v49, v49, v80
    v_mul_f32 v50, v50, v80
    v_mul_f32 v51, v51, v80
    v_mul_f32 v52, v52, v80
    v_mul_f32 v53, v53, v80
    v_mul_f32 v54, v54, v80
    v_mul_f32 v55, v55, v80
    v_cvt_pk_bf16_f32 v56, v48, v49
    v_cvt_pk_bf16_f32 v57, v50, v51
    v_cvt_pk_bf16_f32 v58, v52, v53
    v_cvt_pk_bf16_f32 v59, v54, v55
    v_min_u32 v56, -2, v56
    v_min_u32 v57, -2, v57
    v_min_u32 v58, -2, v58
    v_min_u32 v59, -2, v59
    buffer_store_dwordx4 v[56:59], v22, s[8:11], s42 offen sc1
    s_add_u32 s42, s42, 458752
    s_waitcnt vmcnt(1)
    v_max3_u32 v58, v84, v85, v86
    v_max3_u32 v58, v58, v87, v88
    v_max3_u32 v58, v58, v89, v90
    v_max3_u32 v58, v58, v91, v92
    v_max_u32 v58, v58, v93
    v_cmp_eq_u32 vcc, -1, v58
    s_cbranch_vccz interleave_layers__linear_attn_block__memory_aug_recurrent_mem_tr__prompt_kernel_s_pmw2_out
    s_mov_b32 s61, 0
interleave_layers__linear_attn_block__memory_aug_recurrent_mem_tr__prompt_kernel_s_pmw2:
    buffer_load_dwordx4 v[84:87], v7, s[8:11], s47 offen sc1
    buffer_load_dwordx4 v[88:91], v7, s[8:11], s46 offen sc1
    buffer_load_dwordx2 v[92:93], v8, s[8:11], s47 offen sc1
    s_waitcnt vmcnt(0)
    v_max3_u32 v58, v84, v85, v86
    v_max3_u32 v58, v58, v87, v88
    v_max3_u32 v58, v58, v89, v90
    v_max3_u32 v58, v58, v91, v92
    v_max_u32 v58, v58, v93
    v_cmp_eq_u32 vcc, -1, v58
    s_add_u32 s61, s61, 1
    s_cbranch_vccz interleave_layers__linear_attn_block__memory_aug_recurrent_mem_tr__prompt_kernel_s_pmw2_out
    s_cmp_ge_u32 s61, s60
    s_cbranch_scc1 interleave_layers__linear_attn_block__memory_aug_recurrent_mem_tr__prompt_kernel_s_pmw2_to
    s_sleep 1
    s_branch interleave_layers__linear_attn_block__memory_aug_recurrent_mem_tr__prompt_kernel_s_pmw2
interleave_layers__linear_attn_block__memory_aug_recurrent_mem_tr__prompt_kernel_s_pmw2_to:
    s_mov_b32 s60, 1
interleave_layers__linear_attn_block__memory_aug_recurrent_mem_tr__prompt_kernel_s_pmw2_out:
    ds_write_b128 v7, v[84:87]
    ds_write_b128 v7, v[88:91] offset:4096
    ds_write_b64 v8, v[92:93]
interleave_layers__linear_attn_block__memory_aug_recurrent_mem_tr__prompt_kernel_s_gow2:
    ds_read_b128 v[68:71], v6 offset:4096
    ds_read_b128 v[72:75], v6 offset:5120
    ds_read_b128 v[76:79], v6 offset:12288
    ds_read_b128 v[80:83], v6 offset:13312
    v_smfmac_f32_16x16x64_bf16 v[24:27], v[84:87], a[16:23], v4
    v_smfmac_f32_16x16x64_bf16 v[28:31], v[84:87], a[96:103], v4
    v_smfmac_f32_16x16x64_bf16 v[32:35], v[84:87], a[176:183], v4
    v_smfmac_f32_16x16x64_bf16 v[40:43], v[84:87], v[112:119], v4
    v_smfmac_f32_16x16x64_bf16 v[44:47], v[84:87], v[192:199], v4
    s_waitcnt lgkmcnt(2)
    v_smfmac_f32_16x16x64_bf16 v[36:39], v[84:87], v[68:75], v4
    ds_read_b128 v[68:71], v6 offset:0
    ds_read_b128 v[72:75], v6 offset:1024
    s_barrier
    ds_read_b128 v[48:51], v5 offset:0
    ds_read_b128 v[52:55], v5 offset:1024
    ds_read_b128 v[56:59], v5 offset:3072
    ds_read_b128 v[60:63], v5 offset:4096
    ds_read_b128 v[64:67], v5 offset:5120
    v_smfmac_f32_16x16x64_bf16 v[24:27], v[88:91], a[48:55], v4
    v_smfmac_f32_16x16x64_bf16 v[28:31], v[88:91], a[128:135], v4
    v_smfmac_f32_16x16x64_bf16 v[32:35], v[88:91], a[208:215], v4
    v_smfmac_f32_16x16x64_bf16 v[40:43], v[88:91], v[144:151], v4
    v_smfmac_f32_16x16x64_bf16 v[44:47], v[88:91], v[224:231], v4
    s_waitcnt lgkmcnt(7)
    v_smfmac_f32_16x16x64_bf16 v[36:39], v[88:91], v[76:83], v4
    ds_read_b128 v[76:79], v6 offset:2048
    ds_read_b128 v[80:83], v6 offset:3072
    s_waitcnt lgkmcnt(6)
    v_smfmac_f32_16x16x64_bf16 v[24:27], v[48:51], a[0:7], v4
    v_smfmac_f32_16x16x64_bf16 v[28:31], v[48:51], a[80:87], v4
    v_smfmac_f32_16x16x64_bf16 v[40:43], v[48:51], v[96:103], v4
    v_smfmac_f32_16x16x64_bf16 v[36:39], v[48:51], v[68:75], v4
    ds_read_b128 v[68:71], v6 offset:6144
    ds_read_b128 v[72:75], v6 offset:7168
    ds_read_b128 v[48:51], v5 offset:7168
    s_waitcnt lgkmcnt(8)
    v_smfmac_f32_16x16x64_bf16 v[24:27], v[52:55], a[8:15], v4
    v_smfmac_f32_16x16x64_bf16 v[28:31], v[52:55], a[88:95], v4
    v_smfmac_f32_16x16x64_bf16 v[40:43], v[52:55], v[104:111], v4
    s_waitcnt lgkmcnt(3)
    v_smfmac_f32_16x16x64_bf16 v[36:39], v[52:55], v[76:83], v4
    ds_read_b128 v[76:79], v6 offset:8192
    ds_read_b128 v[80:83], v6 offset:9216
    ds_read_b128 v[52:55], v5 offset:8192
    v_smfmac_f32_16x16x64_bf16 v[24:27], v[56:59], a[24:31], v4
    v_smfmac_f32_16x16x64_bf16 v[28:31], v[56:59], a[104:111], v4
    v_smfmac_f32_16x16x64_bf16 v[40:43], v[56:59], v[120:127], v4
    s_waitcnt lgkmcnt(4)
    v_smfmac_f32_16x16x64_bf16 v[36:39], v[56:59], v[68:75], v4
    ds_read_b128 v[68:71], v6 offset:10240
    ds_read_b128 v[72:75], v6 offset:11264
    ds_read_b128 v[56:59], v5 offset:9216
    v_smfmac_f32_16x16x64_bf16 v[24:27], v[60:63], a[32:39], v4
    v_smfmac_f32_16x16x64_bf16 v[28:31], v[60:63], a[112:119], v4
    v_smfmac_f32_16x16x64_bf16 v[40:43], v[60:63], v[128:135], v4
    s_waitcnt lgkmcnt(4)
    v_smfmac_f32_16x16x64_bf16 v[36:39], v[60:63], v[76:83], v4
    ds_read_b128 v[76:79], v6 offset:14336
    ds_read_b128 v[80:83], v6 offset:15360
    ds_read_b128 v[60:63], v5 offset:0
    v_smfmac_f32_16x16x64_bf16 v[24:27], v[64:67], a[40:47], v4
    v_smfmac_f32_16x16x64_bf16 v[28:31], v[64:67], a[120:127], v4
    v_smfmac_f32_16x16x64_bf16 v[40:43], v[64:67], v[136:143], v4
    s_waitcnt lgkmcnt(4)
    v_smfmac_f32_16x16x64_bf16 v[36:39], v[64:67], v[68:75], v4
    ds_read_b128 v[68:71], v6 offset:16384
    ds_read_b128 v[72:75], v6 offset:17408
    ds_read_b128 v[64:67], v5 offset:1024
    v_smfmac_f32_16x16x64_bf16 v[24:27], v[48:51], a[56:63], v4
    v_smfmac_f32_16x16x64_bf16 v[28:31], v[48:51], a[136:143], v4
    v_smfmac_f32_16x16x64_bf16 v[40:43], v[48:51], v[152:159], v4
    s_waitcnt lgkmcnt(4)
    v_smfmac_f32_16x16x64_bf16 v[36:39], v[48:51], v[76:83], v4
    ds_read_b128 v[76:79], v6 offset:18432
    ds_read_b128 v[80:83], v6 offset:19456
    ds_read_b128 v[48:51], v5 offset:3072
    v_smfmac_f32_16x16x64_bf16 v[24:27], v[52:55], a[64:71], v4
    v_smfmac_f32_16x16x64_bf16 v[28:31], v[52:55], a[144:151], v4
    v_smfmac_f32_16x16x64_bf16 v[40:43], v[52:55], v[160:167], v4
    s_waitcnt lgkmcnt(4)
    v_smfmac_f32_16x16x64_bf16 v[36:39], v[52:55], v[68:75], v4
    ds_read_b128 v[52:55], v5 offset:4096
    v_smfmac_f32_16x16x64_bf16 v[24:27], v[56:59], a[72:79], v4
    v_smfmac_f32_16x16x64_bf16 v[28:31], v[56:59], a[152:159], v4
    v_smfmac_f32_16x16x64_bf16 v[40:43], v[56:59], v[168:175], v4
    s_waitcnt lgkmcnt(2)
    v_smfmac_f32_16x16x64_bf16 v[36:39], v[56:59], v[76:83], v4
    ds_read_b128 v[56:59], v5 offset:5120
    buffer_load_dwordx4 v[80:83], v19, s[8:11], s45 offen offset:0 sc1
    buffer_load_dwordx4 v[84:87], v19, s[8:11], s45 offen offset:1024 sc1
    buffer_load_dwordx4 v[88:91], v19, s[8:11], s45 offen offset:2048 sc1
    v_smfmac_f32_16x16x64_bf16 v[32:35], v[60:63], a[160:167], v4
    v_smfmac_f32_16x16x64_bf16 v[44:47], v[60:63], v[176:183], v4
    v_permlane32_swap_b32 v28, v40
    v_permlane32_swap_b32 v29, v41
    ds_read_b128 v[60:63], v5 offset:7168
    v_smfmac_f32_16x16x64_bf16 v[32:35], v[64:67], a[168:175], v4
    v_permlane32_swap_b32 v30, v42
    v_permlane32_swap_b32 v31, v43
    v_smfmac_f32_16x16x64_bf16 v[44:47], v[64:67], v[184:191], v4
    v_add_f32 v28, v28, v40
    v_add_f32 v29, v29, v41
    ds_read_b128 v[64:67], v5 offset:8192
    s_waitcnt lgkmcnt(4)
    v_smfmac_f32_16x16x64_bf16 v[32:35], v[48:51], a[184:191], v4
    v_add_f32 v30, v30, v42
    v_add_f32 v31, v31, v43
    v_smfmac_f32_16x16x64_bf16 v[44:47], v[48:51], v[200:207], v4
    v_cvt_pk_bf16_f32 v40, v28, v29
    v_cvt_pk_bf16_f32 v41, v30, v31
    ds_read_b128 v[48:51], v5 offset:9216
    s_waitcnt lgkmcnt(4)
    v_smfmac_f32_16x16x64_bf16 v[32:35], v[52:55], a[192:199], v4
    v_mfma_f32_16x16x16_bf16 v[28:31], v[40:41], v[10:11], 0
    v_permlane32_swap_b32 v24, v36
    v_smfmac_f32_16x16x64_bf16 v[44:47], v[52:55], v[208:215], v4
    v_permlane32_swap_b32 v25, v37
    v_permlane32_swap_b32 v26, v38
    s_waitcnt lgkmcnt(3)
    v_smfmac_f32_16x16x64_bf16 v[32:35], v[56:59], a[200:207], v4
    v_permlane32_swap_b32 v27, v39
    v_add_f32 v24, v24, v36
    v_smfmac_f32_16x16x64_bf16 v[44:47], v[56:59], v[216:223], v4
    v_add_f32 v25, v25, v37
    v_add_f32 v26, v26, v38
    s_waitcnt lgkmcnt(2)
    v_smfmac_f32_16x16x64_bf16 v[32:35], v[60:63], a[216:223], v4
    v_add_f32 v27, v27, v39
    v_cvt_pk_bf16_f32 v36, v24, v25
    v_smfmac_f32_16x16x64_bf16 v[44:47], v[60:63], v[232:239], v4
    v_cvt_pk_bf16_f32 v37, v26, v27
    s_nop 1
    v_mfma_f32_16x16x16_bf16 v[24:27], v[36:37], v[10:11], 0
    s_waitcnt lgkmcnt(1)
    v_smfmac_f32_16x16x64_bf16 v[32:35], v[64:67], a[224:231], v4
    s_nop 5
    v_cvt_pk_bf16_f32 v24, v24, v25
    v_smfmac_f32_16x16x64_bf16 v[44:47], v[64:67], v[240:247], v4
    v_cvt_pk_bf16_f32 v25, v26, v27
    v_cvt_pk_bf16_f32 v26, v28, v29
    s_waitcnt lgkmcnt(0)
    v_smfmac_f32_16x16x64_bf16 v[32:35], v[48:51], a[232:239], v4
    v_cvt_pk_bf16_f32 v27, v30, v31
    s_waitcnt vmcnt(3)
    v_smfmac_f32_16x16x64_bf16 v[44:47], v[48:51], v[248:255], v4
    v_mfma_f32_16x16x32_bf16 v[28:31], a[240:243], v[24:27], 0
    v_mfma_f32_16x16x32_bf16 v[36:39], a[244:247], v[24:27], 0
    v_mfma_f32_16x16x32_bf16 v[40:43], v[24:27], v[24:27], 0
    s_nop 4
    v_permlane32_swap_b32 v32, v44
    v_permlane32_swap_b32 v33, v45
    v_permlane32_swap_b32 v34, v46
    v_permlane32_swap_b32 v35, v47
    v_add_f32 v32, v32, v44
    v_add_f32 v33, v33, v45
    v_add_f32 v34, v34, v46
    v_add_f32 v35, v35, v47
    v_cvt_pk_bf16_f32 v44, v32, v33
    v_cvt_pk_bf16_f32 v45, v34, v35
    s_nop 1
    v_mfma_f32_16x16x16_bf16 v[32:35], v[44:45], v[10:11], 0
    s_nop 7
    v_cvt_pk_bf16_f32 v32, v32, v33
    v_cvt_pk_bf16_f32 v33, v34, v35
    s_nop 1
    v_mfma_f32_16x16x16_bf16 v[28:31], a[248:249], v[32:33], v[28:31]
    v_mfma_f32_16x16x16_bf16 v[36:39], a[250:251], v[32:33], v[36:39]
    v_mfma_f32_16x16x16_bf16 v[40:43], v[32:33], v[32:33], v[40:43]
    s_nop 5
    ds_write_b128 v12, v[28:31]
    ds_write_b128 v12, v[36:39] offset:16
    ds_write_b128 v13, v[40:43]
    s_waitcnt lgkmcnt(0)
    s_barrier
    s_waitcnt vmcnt(0)
    v_mfma_f32_16x16x32_bf16 v[36:39], a[240:243], v[80:83], 0
    v_mfma_f32_16x16x32_bf16 v[44:47], a[244:247], v[80:83], 0
    v_mfma_f32_16x16x32_bf16 v[68:71], v[24:27], v[80:83], 0
    v_mfma_f32_16x16x32_bf16 v[40:43], a[240:243], v[84:87], 0
    v_mfma_f32_16x16x32_bf16 v[64:67], a[244:247], v[84:87], 0
    v_mfma_f32_16x16x32_bf16 v[72:75], v[24:27], v[84:87], 0
    s_nop 0
    v_mfma_f32_16x16x16_bf16 v[36:39], a[248:249], v[88:89], v[36:39]
    v_mfma_f32_16x16x16_bf16 v[44:47], a[250:251], v[88:89], v[44:47]
    v_mfma_f32_16x16x16_bf16 v[68:71], v[32:33], v[88:89], v[68:71]
    v_mfma_f32_16x16x16_bf16 v[40:43], a[248:249], v[90:91], v[40:43]
    v_mfma_f32_16x16x16_bf16 v[64:67], a[250:251], v[90:91], v[64:67]
    v_mfma_f32_16x16x16_bf16 v[72:75], v[32:33], v[90:91], v[72:75]
    s_nop 2
    ds_write_b128 v16, v[36:39] offset:0
    ds_write_b128 v16, v[44:47] offset:16
    ds_write_b128 v17, v[68:71]
    ds_write_b128 v16, v[40:43] offset:2816
    ds_write_b128 v16, v[64:67] offset:2832
    ds_write_b128 v18, v[72:75]
    s_add_u32 s40, s40, 1
    s_add_u32 s41, s41, 393216
    s_add_u32 s45, s45, 393216
    s_add_u32 s43, s43, 458752
    s_add_u32 s47, s47, 458752
    s_add_u32 s48, s48, 458752
    s_add_u32 s49, s49, 458752
    s_waitcnt lgkmcnt(0)
    s_barrier
    s_cmp_lt_u32 s40, 64
    s_cbranch_scc1 interleave_layers__linear_attn_block__memory_aug_recurrent_mem_tr__prompt_kernel_s_stepw2
    s_branch interleave_layers__linear_attn_block__memory_aug_recurrent_mem_tr__prompt_kernel_s_end
interleave_layers__linear_attn_block__memory_aug_recurrent_mem_tr__prompt_kernel_s_stepw3:
    v_mov_b32 v24, 0
    v_mov_b32 v25, 0
    v_mov_b32 v26, 0
    v_mov_b32 v27, 0
    v_mov_b32 v28, 0
    v_mov_b32 v29, 0
    v_mov_b32 v30, 0
    v_mov_b32 v31, 0
    v_mov_b32 v32, 0
    v_mov_b32 v33, 0
    v_mov_b32 v34, 0
    v_mov_b32 v35, 0
    v_mov_b32 v36, 0
    v_mov_b32 v37, 0
    v_mov_b32 v38, 0
    v_mov_b32 v39, 0
    v_mov_b32 v40, 0
    v_mov_b32 v41, 0
    v_mov_b32 v42, 0
    v_mov_b32 v43, 0
    v_mov_b32 v44, 0
    v_mov_b32 v45, 0
    v_mov_b32 v46, 0
    v_mov_b32 v47, 0
    s_add_u32 s46, s47, 4096
    s_lshl_b32 s95, s92, 6
    s_add_u32 s95, s95, s40
    s_add_u32 s95, s95, 1
    s_cmp_ge_i32 s59, s95
    s_cbranch_scc1 interleave_layers__linear_attn_block__memory_aug_recurrent_mem_tr__prompt_kernel_s_ecw3_ok
    s_and_b32 s24, s2, 7
    s_lshl_b32 s24, s24, 7
    s_add_u32 s24, s24, 23109632
    v_and_b32 v49, 3, v1
    v_lshl_add_u32 v49, v49, 2, s24
    s_mov_b32 s61, 0
interleave_layers__linear_attn_block__memory_aug_recurrent_mem_tr__prompt_kernel_s_ecw3:
    buffer_load_dword v48, v49, s[8:11], 0 offen sc1
    s_waitcnt vmcnt(0)
    v_readlane_b32 s59, v48, 0
    v_readlane_b32 s24, v48, 1
    s_min_i32 s59, s59, s24
    v_readlane_b32 s24, v48, 2
    s_min_i32 s59, s59, s24
    s_cmp_ge_i32 s59, s95
    s_cbranch_scc1 interleave_layers__linear_attn_block__memory_aug_recurrent_mem_tr__prompt_kernel_s_ecw3_ok
    s_add_u32 s61, s61, 1
    s_cmp_ge_u32 s61, s60
    s_cbranch_scc1 interleave_layers__linear_attn_block__memory_aug_recurrent_mem_tr__prompt_kernel_s_ecw3_to
    s_sleep 2
    s_branch interleave_layers__linear_attn_block__memory_aug_recurrent_mem_tr__prompt_kernel_s_ecw3
interleave_layers__linear_attn_block__memory_aug_recurrent_mem_tr__prompt_kernel_s_ecw3_to:
    s_mov_b32 s60, 1
interleave_layers__linear_attn_block__memory_aug_recurrent_mem_tr__prompt_kernel_s_ecw3_ok:
    s_add_u32 s63, s40, 1
    s_cmp_ge_i32 s62, s63
    s_cbranch_scc1 interleave_layers__linear_attn_block__memory_aug_recurrent_mem_tr__prompt_kernel_s_enw3_ok
    s_mov_b32 s61, 0
interleave_layers__linear_attn_block__memory_aug_recurrent_mem_tr__prompt_kernel_s_enw3:
    buffer_load_dword v48, v9, s[8:11], 0 offen sc1
    s_waitcnt vmcnt(0)
    v_readlane_b32 s62, v48, 0
    v_readlane_b32 s24, v48, 1
    s_min_i32 s62, s62, s24
    s_cmp_ge_i32 s62, s63
    s_cbranch_scc1 interleave_layers__linear_attn_block__memory_aug_recurrent_mem_tr__prompt_kernel_s_enw3_ok
    s_add_u32 s61, s61, 1
    s_cmp_ge_u32 s61, s60
    s_cbranch_scc1 interleave_layers__linear_attn_block__memory_aug_recurrent_mem_tr__prompt_kernel_s_enw3_to
    s_sleep 2
    s_branch interleave_layers__linear_attn_block__memory_aug_recurrent_mem_tr__prompt_kernel_s_enw3
interleave_layers__linear_attn_block__memory_aug_recurrent_mem_tr__prompt_kernel_s_enw3_to:
    s_mov_b32 s60, 1
interleave_layers__linear_attn_block__memory_aug_recurrent_mem_tr__prompt_kernel_s_enw3_ok:
    buffer_load_dwordx4 a[240:243], v19, s[8:11], s41 offen offset:0 sc1
    buffer_load_dwordx4 a[244:247], v19, s[8:11], s41 offen offset:1024 sc1
    buffer_load_dwordx4 a[248:251], v19, s[8:11], s41 offen offset:2048 sc1
    s_sleep 5
    s_mov_b64 exec, 1
    s_mov_b32 s61, 0
    v_mov_b32 v83, 0
    buffer_atomic_add v83, v23, s[8:11], s48 offen sc0
    s_sleep 3
    v_mov_b32 v94, 0
    buffer_atomic_add v94, v23, s[8:11], s48 offen sc0
    s_sleep 3
    v_mov_b32 v95, 0
    buffer_atomic_add v95, v23, s[8:11], s48 offen sc0
    s_sleep 3
interleave_layers__linear_attn_block__memory_aug_recurrent_mem_tr__prompt_kernel_s_prw3:
    v_mov_b32 v82, 0
    buffer_atomic_add v82, v23, s[8:11], s48 offen sc0
    s_waitcnt vmcnt(3)
    v_cmp_le_i32 vcc, 8, v83
    s_add_u32 s61, s61, 1
    s_cbranch_vccnz interleave_layers__linear_attn_block__memory_aug_recurrent_mem_tr__prompt_kernel_s_prw3_out
    s_sleep 3
    v_mov_b32 v83, 0
    buffer_atomic_add v83, v23, s[8:11], s48 offen sc0
    s_waitcnt vmcnt(3)
    v_cmp_le_i32 vcc, 8, v94
    s_add_u32 s61, s61, 1
    s_cbranch_vccnz interleave_layers__linear_attn_block__memory_aug_recurrent_mem_tr__prompt_kernel_s_prw3_out
    s_sleep 3
    v_mov_b32 v94, 0
    buffer_atomic_add v94, v23, s[8:11], s48 offen sc0
    s_waitcnt vmcnt(3)
    v_cmp_le_i32 vcc, 8, v95
    s_add_u32 s61, s61, 1
    s_cbranch_vccnz interleave_layers__linear_attn_block__memory_aug_recurrent_mem_tr__prompt_kernel_s_prw3_out
    s_sleep 3
    v_mov_b32 v95, 0
    buffer_atomic_add v95, v23, s[8:11], s48 offen sc0
    s_waitcnt vmcnt(3)
    v_cmp_le_i32 vcc, 8, v82
    s_add_u32 s61, s61, 1
    s_cbranch_vccnz interleave_layers__linear_attn_block__memory_aug_recurrent_mem_tr__prompt_kernel_s_prw3_out
    s_sleep 3
    s_cmp_ge_u32 s61, s60
    s_cbranch_scc0 interleave_layers__linear_attn_block__memory_aug_recurrent_mem_tr__prompt_kernel_s_prw3
    s_mov_b32 s60, 1
interleave_layers__linear_attn_block__memory_aug_recurrent_mem_tr__prompt_kernel_s_prw3_out:
    s_mov_b64 exec, -1
    buffer_load_dwordx4 v[84:87], v7, s[8:11], s47 offen sc1
    buffer_load_dwordx4 v[88:91], v7, s[8:11], s46 offen sc1
    buffer_load_dwordx2 v[92:93], v8, s[8:11], s47 offen sc1
    ds_read_b128 v[48:51], v21 offset:0
    ds_read_b128 v[52:55], v21 offset:16
    ds_read_b128 v[56:59], v21 offset:5632
    ds_read_b128 v[60:63], v21 offset:5648
    ds_read_b128 v[64:67], v21 offset:11264
    ds_read_b128 v[68:71], v21 offset:11280
    ds_read_b128 v[72:75], v21 offset:16896
    ds_read_b128 v[76:79], v21 offset:16912
    s_waitcnt lgkmcnt(4)
    v_pk_add_f32 v[48:49], v[48:49], v[56:57]
    v_pk_add_f32 v[50:51], v[50:51], v[58:59]
    v_pk_add_f32 v[52:53], v[52:53], v[60:61]
    v_pk_add_f32 v[54:55], v[54:55], v[62:63]
    s_waitcnt lgkmcnt(0)
    v_pk_add_f32 v[64:65], v[64:65], v[72:73]
    v_pk_add_f32 v[66:67], v[66:67], v[74:75]
    v_pk_add_f32 v[68:69], v[68:69], v[76:77]
    v_pk_add_f32 v[70:71], v[70:71], v[78:79]
    v_pk_add_f32 v[48:49], v[48:49], v[64:65]
    v_pk_add_f32 v[50:51], v[50:51], v[66:67]
    v_pk_add_f32 v[52:53], v[52:53], v[68:69]
    v_pk_add_f32 v[54:55], v[54:55], v[70:71]
    v_mov_b32 v81, 0xff800000
    v_cndmask_b32 v48, v81, v48, s[64:65]
    v_cndmask_b32 v49, v81, v49, s[66:67]
    v_cndmask_b32 v50, v81, v50, s[68:69]
    v_cndmask_b32 v51, v81, v51, s[70:71]
    v_cndmask_b32 v52, v81, v52, s[72:73]
    v_cndmask_b32 v53, v81, v53, s[74:75]
    v_cndmask_b32 v54, v81, v54, s[76:77]
    v_cndmask_b32 v55, v81, v55, s[78:79]
    v_max3_f32 v80, v48, v49, v50
    v_max3_f32 v80, v80, v51, v52
    v_max3_f32 v80, v80, v53, v54
    v_max_f32 v80, v80, v55
    v_mov_b32 v81, 0xff800000
    v_cndmask_b32 v80, v81, v80, s[50:51]
    s_nop 1
    v_max_f32 v80, v80, v80 quad_perm:[1,0,3,2] row_mask:0xf bank_mask:0xf
    s_nop 1
    v_max_f32 v80, v80, v80 quad_perm:[2,3,0,1] row_mask:0xf bank_mask:0xf
    s_nop 1
    v_max_f32 v80, v80, v80 row_half_mirror row_mask:0xf bank_mask:0xf
    s_mov_b32 s24, 0x3dd53b95
    v_mul_f32 v80, s24, v80
    v_fma_f32 v48, v48, s24, -v80
    v_fma_f32 v49, v49, s24, -v80
    v_fma_f32 v50, v50, s24, -v80
    v_fma_f32 v51, v51, s24, -v80
    v_fma_f32 v52, v52, s24, -v80
    v_fma_f32 v53, v53, s24, -v80
    v_fma_f32 v54, v54, s24, -v80
    v_fma_f32 v55, v55, s24, -v80
    v_exp_f32 v48, v48
    v_exp_f32 v49, v49
    v_exp_f32 v50, v50
    v_exp_f32 v51, v51
    v_exp_f32 v52, v52
    v_exp_f32 v53, v53
    v_exp_f32 v54, v54
    v_exp_f32 v55, v55
    v_add_f32 v80, v48, v49
    v_add_f32 v81, v50, v51
    v_add_f32 v80, v80, v52
    v_add_f32 v81, v81, v53
    v_add_f32 v80, v80, v54
    v_add_f32 v81, v81, v55
    v_add_f32 v80, v80, v81
    v_cndmask_b32 v80, 0, v80, s[50:51]
    s_nop 1
    v_add_f32 v80, v80, v80 quad_perm:[1,0,3,2] row_mask:0xf bank_mask:0xf
    s_nop 1
    v_add_f32 v80, v80, v80 quad_perm:[2,3,0,1] row_mask:0xf bank_mask:0xf
    s_nop 1
    v_add_f32 v80, v80, v80 row_half_mirror row_mask:0xf bank_mask:0xf
    v_rcp_f32 v80, v80
    s_nop 0
    v_mul_f32 v48, v48, v80
    v_mul_f32 v49, v49, v80
    v_mul_f32 v50, v50, v80
    v_mul_f32 v51, v51, v80
    v_mul_f32 v52, v52, v80
    v_mul_f32 v53, v53, v80
    v_mul_f32 v54, v54, v80
    v_mul_f32 v55, v55, v80
    v_cvt_pk_bf16_f32 v56, v48, v49
    v_cvt_pk_bf16_f32 v57, v50, v51
    v_cvt_pk_bf16_f32 v58, v52, v53
    v_cvt_pk_bf16_f32 v59, v54, v55
    v_min_u32 v56, -2, v56
    v_min_u32 v57, -2, v57
    v_min_u32 v58, -2, v58
    v_min_u32 v59, -2, v59
    buffer_store_dwordx4 v[56:59], v22, s[8:11], s42 offen sc1
    s_add_u32 s42, s42, 458752
    s_waitcnt vmcnt(1)
    v_max3_u32 v58, v84, v85, v86
    v_max3_u32 v58, v58, v87, v88
    v_max3_u32 v58, v58, v89, v90
    v_max3_u32 v58, v58, v91, v92
    v_max_u32 v58, v58, v93
    v_cmp_eq_u32 vcc, -1, v58
    s_cbranch_vccz interleave_layers__linear_attn_block__memory_aug_recurrent_mem_tr__prompt_kernel_s_pmw3_out
    s_mov_b32 s61, 0
interleave_layers__linear_attn_block__memory_aug_recurrent_mem_tr__prompt_kernel_s_pmw3:
    buffer_load_dwordx4 v[84:87], v7, s[8:11], s47 offen sc1
    buffer_load_dwordx4 v[88:91], v7, s[8:11], s46 offen sc1
    buffer_load_dwordx2 v[92:93], v8, s[8:11], s47 offen sc1
    s_waitcnt vmcnt(0)
    v_max3_u32 v58, v84, v85, v86
    v_max3_u32 v58, v58, v87, v88
    v_max3_u32 v58, v58, v89, v90
    v_max3_u32 v58, v58, v91, v92
    v_max_u32 v58, v58, v93
    v_cmp_eq_u32 vcc, -1, v58
    s_add_u32 s61, s61, 1
    s_cbranch_vccz interleave_layers__linear_attn_block__memory_aug_recurrent_mem_tr__prompt_kernel_s_pmw3_out
    s_cmp_ge_u32 s61, s60
    s_cbranch_scc1 interleave_layers__linear_attn_block__memory_aug_recurrent_mem_tr__prompt_kernel_s_pmw3_to
    s_sleep 1
    s_branch interleave_layers__linear_attn_block__memory_aug_recurrent_mem_tr__prompt_kernel_s_pmw3
interleave_layers__linear_attn_block__memory_aug_recurrent_mem_tr__prompt_kernel_s_pmw3_to:
    s_mov_b32 s60, 1
interleave_layers__linear_attn_block__memory_aug_recurrent_mem_tr__prompt_kernel_s_pmw3_out:
    ds_write_b128 v7, v[84:87]
    ds_write_b128 v7, v[88:91] offset:4096
    ds_write_b64 v8, v[92:93]
interleave_layers__linear_attn_block__memory_aug_recurrent_mem_tr__prompt_kernel_s_gow3:
    ds_read_b128 v[68:71], v6 offset:6144
    ds_read_b128 v[72:75], v6 offset:7168
    ds_read_b128 v[76:79], v6 offset:14336
    ds_read_b128 v[80:83], v6 offset:15360
    v_smfmac_f32_16x16x64_bf16 v[24:27], v[84:87], a[24:31], v4
    v_smfmac_f32_16x16x64_bf16 v[28:31], v[84:87], a[104:111], v4
    v_smfmac_f32_16x16x64_bf16 v[32:35], v[84:87], a[184:191], v4
    v_smfmac_f32_16x16x64_bf16 v[40:43], v[84:87], v[120:127], v4
    v_smfmac_f32_16x16x64_bf16 v[44:47], v[84:87], v[200:207], v4
    s_waitcnt lgkmcnt(2)
    v_smfmac_f32_16x16x64_bf16 v[36:39], v[84:87], v[68:75], v4
    ds_read_b128 v[68:71], v6 offset:0
    ds_read_b128 v[72:75], v6 offset:1024
    s_barrier
    ds_read_b128 v[48:51], v5 offset:0
    ds_read_b128 v[52:55], v5 offset:1024
    ds_read_b128 v[56:59], v5 offset:2048
    ds_read_b128 v[60:63], v5 offset:4096
    ds_read_b128 v[64:67], v5 offset:5120
    v_smfmac_f32_16x16x64_bf16 v[24:27], v[88:91], a[56:63], v4
    v_smfmac_f32_16x16x64_bf16 v[28:31], v[88:91], a[136:143], v4
    v_smfmac_f32_16x16x64_bf16 v[32:35], v[88:91], a[216:223], v4
    v_smfmac_f32_16x16x64_bf16 v[40:43], v[88:91], v[152:159], v4
    v_smfmac_f32_16x16x64_bf16 v[44:47], v[88:91], v[232:239], v4
    s_waitcnt lgkmcnt(7)
    v_smfmac_f32_16x16x64_bf16 v[36:39], v[88:91], v[76:83], v4
    ds_read_b128 v[76:79], v6 offset:2048
    ds_read_b128 v[80:83], v6 offset:3072
    s_waitcnt lgkmcnt(6)
    v_smfmac_f32_16x16x64_bf16 v[24:27], v[48:51], a[0:7], v4
    v_smfmac_f32_16x16x64_bf16 v[28:31], v[48:51], a[80:87], v4
    v_smfmac_f32_16x16x64_bf16 v[40:43], v[48:51], v[96:103], v4
    v_smfmac_f32_16x16x64_bf16 v[36:39], v[48:51], v[68:75], v4
    ds_read_b128 v[68:71], v6 offset:4096
    ds_read_b128 v[72:75], v6 offset:5120
    ds_read_b128 v[48:51], v5 offset:6144
    s_waitcnt lgkmcnt(8)
    v_smfmac_f32_16x16x64_bf16 v[24:27], v[52:55], a[8:15], v4
    v_smfmac_f32_16x16x64_bf16 v[28:31], v[52:55], a[88:95], v4
    v_smfmac_f32_16x16x64_bf16 v[40:43], v[52:55], v[104:111], v4
    s_waitcnt lgkmcnt(3)
    v_smfmac_f32_16x16x64_bf16 v[36:39], v[52:55], v[76:83], v4
    ds_read_b128 v[76:79], v6 offset:8192
    ds_read_b128 v[80:83], v6 offset:9216
    ds_read_b128 v[52:55], v5 offset:8192
    v_smfmac_f32_16x16x64_bf16 v[24:27], v[56:59], a[16:23], v4
    v_smfmac_f32_16x16x64_bf16 v[28:31], v[56:59], a[96:103], v4
    v_smfmac_f32_16x16x64_bf16 v[40:43], v[56:59], v[112:119], v4
    s_waitcnt lgkmcnt(4)
    v_smfmac_f32_16x16x64_bf16 v[36:39], v[56:59], v[68:75], v4
    ds_read_b128 v[68:71], v6 offset:10240
    ds_read_b128 v[72:75], v6 offset:11264
    ds_read_b128 v[56:59], v5 offset:9216
    v_smfmac_f32_16x16x64_bf16 v[24:27], v[60:63], a[32:39], v4
    v_smfmac_f32_16x16x64_bf16 v[28:31], v[60:63], a[112:119], v4
    v_smfmac_f32_16x16x64_bf16 v[40:43], v[60:63], v[128:135], v4
    s_waitcnt lgkmcnt(4)
    v_smfmac_f32_16x16x64_bf16 v[36:39], v[60:63], v[76:83], v4
    ds_read_b128 v[76:79], v6 offset:12288
    ds_read_b128 v[80:83], v6 offset:13312
    ds_read_b128 v[60:63], v5 offset:0
    v_smfmac_f32_16x16x64_bf16 v[24:27], v[64:67], a[40:47], v4
    v_smfmac_f32_16x16x64_bf16 v[28:31], v[64:67], a[120:127], v4
    v_smfmac_f32_16x16x64_bf16 v[40:43], v[64:67], v[136:143], v4
    s_waitcnt lgkmcnt(4)
    v_smfmac_f32_16x16x64_bf16 v[36:39], v[64:67], v[68:75], v4
    ds_read_b128 v[68:71], v6 offset:16384
    ds_read_b128 v[72:75], v6 offset:17408
    ds_read_b128 v[64:67], v5 offset:1024
    v_smfmac_f32_16x16x64_bf16 v[24:27], v[48:51], a[48:55], v4
    v_smfmac_f32_16x16x64_bf16 v[28:31], v[48:51], a[128:135], v4
    v_smfmac_f32_16x16x64_bf16 v[40:43], v[48:51], v[144:151], v4
    s_waitcnt lgkmcnt(4)
    v_smfmac_f32_16x16x64_bf16 v[36:39], v[48:51], v[76:83], v4
    ds_read_b128 v[76:79], v6 offset:18432
    ds_read_b128 v[80:83], v6 offset:19456
    ds_read_b128 v[48:51], v5 offset:2048
    v_smfmac_f32_16x16x64_bf16 v[24:27], v[52:55], a[64:71], v4
    v_smfmac_f32_16x16x64_bf16 v[28:31], v[52:55], a[144:151], v4
    v_smfmac_f32_16x16x64_bf16 v[40:43], v[52:55], v[160:167], v4
    s_waitcnt lgkmcnt(4)
    v_smfmac_f32_16x16x64_bf16 v[36:39], v[52:55], v[68:75], v4
    ds_read_b128 v[52:55], v5 offset:4096
    v_smfmac_f32_16x16x64_bf16 v[24:27], v[56:59], a[72:79], v4
    v_smfmac_f32_16x16x64_bf16 v[28:31], v[56:59], a[152:159], v4
    v_smfmac_f32_16x16x64_bf16 v[40:43], v[56:59], v[168:175], v4
    s_waitcnt lgkmcnt(2)
    v_smfmac_f32_16x16x64_bf16 v[36:39], v[56:59], v[76:83], v4
    ds_read_b128 v[56:59], v5 offset:5120
    buffer_load_dwordx4 v[80:83], v19, s[8:11], s45 offen offset:0 sc1
    buffer_load_dwordx4 v[84:87], v19, s[8:11], s45 offen offset:1024 sc1
    buffer_load_dwordx4 v[88:91], v19, s[8:11], s45 offen offset:2048 sc1
    v_smfmac_f32_16x16x64_bf16 v[32:35], v[60:63], a[160:167], v4
    v_smfmac_f32_16x16x64_bf16 v[44:47], v[60:63], v[176:183], v4
    v_permlane32_swap_b32 v28, v40
    v_permlane32_swap_b32 v29, v41
    ds_read_b128 v[60:63], v5 offset:6144
    v_smfmac_f32_16x16x64_bf16 v[32:35], v[64:67], a[168:175], v4
    v_permlane32_swap_b32 v30, v42
    v_permlane32_swap_b32 v31, v43
    v_smfmac_f32_16x16x64_bf16 v[44:47], v[64:67], v[184:191], v4
    v_add_f32 v28, v28, v40
    v_add_f32 v29, v29, v41
    ds_read_b128 v[64:67], v5 offset:8192
    s_waitcnt lgkmcnt(4)
    v_smfmac_f32_16x16x64_bf16 v[32:35], v[48:51], a[176:183], v4
    v_add_f32 v30, v30, v42
    v_add_f32 v31, v31, v43
    v_smfmac_f32_16x16x64_bf16 v[44:47], v[48:51], v[192:199], v4
    v_cvt_pk_bf16_f32 v40, v28, v29
    v_cvt_pk_bf16_f32 v41, v30, v31
    ds_read_b128 v[48:51], v5 offset:9216
    s_waitcnt lgkmcnt(4)
    v_smfmac_f32_16x16x64_bf16 v[32:35], v[52:55], a[192:199], v4
    v_mfma_f32_16x16x16_bf16 v[28:31], v[40:41], v[10:11], 0
    v_permlane32_swap_b32 v24, v36
    v_smfmac_f32_16x16x64_bf16 v[44:47], v[52:55], v[208:215], v4
    v_permlane32_swap_b32 v25, v37
    v_permlane32_swap_b32 v26, v38
    s_waitcnt lgkmcnt(3)
    v_smfmac_f32_16x16x64_bf16 v[32:35], v[56:59], a[200:207], v4
    v_permlane32_swap_b32 v27, v39
    v_add_f32 v24, v24, v36
    v_smfmac_f32_16x16x64_bf16 v[44:47], v[56:59], v[216:223], v4
    v_add_f32 v25, v25, v37
    v_add_f32 v26, v26, v38
    s_waitcnt lgkmcnt(2)
    v_smfmac_f32_16x16x64_bf16 v[32:35], v[60:63], a[208:215], v4
    v_add_f32 v27, v27, v39
    v_cvt_pk_bf16_f32 v36, v24, v25
    v_smfmac_f32_16x16x64_bf16 v[44:47], v[60:63], v[224:231], v4
    v_cvt_pk_bf16_f32 v37, v26, v27
    s_nop 1
    v_mfma_f32_16x16x16_bf16 v[24:27], v[36:37], v[10:11], 0
    s_waitcnt lgkmcnt(1)
    v_smfmac_f32_16x16x64_bf16 v[32:35], v[64:67], a[224:231], v4
    s_nop 5
    v_cvt_pk_bf16_f32 v24, v24, v25
    v_smfmac_f32_16x16x64_bf16 v[44:47], v[64:67], v[240:247], v4
    v_cvt_pk_bf16_f32 v25, v26, v27
    v_cvt_pk_bf16_f32 v26, v28, v29
    s_waitcnt lgkmcnt(0)
    v_smfmac_f32_16x16x64_bf16 v[32:35], v[48:51], a[232:239], v4
    v_cvt_pk_bf16_f32 v27, v30, v31
    s_waitcnt vmcnt(3)
    v_smfmac_f32_16x16x64_bf16 v[44:47], v[48:51], v[248:255], v4
    v_mfma_f32_16x16x32_bf16 v[28:31], a[240:243], v[24:27], 0
    v_mfma_f32_16x16x32_bf16 v[36:39], a[244:247], v[24:27], 0
    v_mfma_f32_16x16x32_bf16 v[40:43], v[24:27], v[24:27], 0
    s_nop 4
    v_permlane32_swap_b32 v32, v44
    v_permlane32_swap_b32 v33, v45
    v_permlane32_swap_b32 v34, v46
    v_permlane32_swap_b32 v35, v47
    v_add_f32 v32, v32, v44
    v_add_f32 v33, v33, v45
    v_add_f32 v34, v34, v46
    v_add_f32 v35, v35, v47
    v_cvt_pk_bf16_f32 v44, v32, v33
    v_cvt_pk_bf16_f32 v45, v34, v35
    s_nop 1
    v_mfma_f32_16x16x16_bf16 v[32:35], v[44:45], v[10:11], 0
    s_nop 7
    v_cvt_pk_bf16_f32 v32, v32, v33
    v_cvt_pk_bf16_f32 v33, v34, v35
    s_nop 1
    v_mfma_f32_16x16x16_bf16 v[28:31], a[248:249], v[32:33], v[28:31]
    v_mfma_f32_16x16x16_bf16 v[36:39], a[250:251], v[32:33], v[36:39]
    v_mfma_f32_16x16x16_bf16 v[40:43], v[32:33], v[32:33], v[40:43]
    s_nop 5
    ds_write_b128 v12, v[28:31]
    ds_write_b128 v12, v[36:39] offset:16
    ds_write_b128 v13, v[40:43]
    s_waitcnt lgkmcnt(0)
    s_barrier
    s_waitcnt vmcnt(0)
    v_mfma_f32_16x16x32_bf16 v[36:39], a[240:243], v[80:83], 0
    v_mfma_f32_16x16x32_bf16 v[44:47], a[244:247], v[80:83], 0
    v_mfma_f32_16x16x32_bf16 v[68:71], v[24:27], v[80:83], 0
    v_mfma_f32_16x16x32_bf16 v[40:43], a[240:243], v[84:87], 0
    v_mfma_f32_16x16x32_bf16 v[64:67], a[244:247], v[84:87], 0
    v_mfma_f32_16x16x32_bf16 v[72:75], v[24:27], v[84:87], 0
    s_nop 0
    v_mfma_f32_16x16x16_bf16 v[36:39], a[248:249], v[88:89], v[36:39]
    v_mfma_f32_16x16x16_bf16 v[44:47], a[250:251], v[88:89], v[44:47]
    v_mfma_f32_16x16x16_bf16 v[68:71], v[32:33], v[88:89], v[68:71]
    v_mfma_f32_16x16x16_bf16 v[40:43], a[248:249], v[90:91], v[40:43]
    v_mfma_f32_16x16x16_bf16 v[64:67], a[250:251], v[90:91], v[64:67]
    v_mfma_f32_16x16x16_bf16 v[72:75], v[32:33], v[90:91], v[72:75]
    s_nop 2
    ds_write_b128 v16, v[36:39] offset:0
    ds_write_b128 v16, v[44:47] offset:16
    ds_write_b128 v17, v[68:71]
    ds_write_b128 v16, v[40:43] offset:2816
    ds_write_b128 v16, v[64:67] offset:2832
    ds_write_b128 v18, v[72:75]
    s_add_u32 s40, s40, 1
    s_add_u32 s41, s41, 393216
    s_add_u32 s45, s45, 393216
    s_add_u32 s43, s43, 458752
    s_add_u32 s47, s47, 458752
    s_add_u32 s48, s48, 458752
    s_add_u32 s49, s49, 458752
    s_waitcnt lgkmcnt(0)
    s_barrier
    s_cmp_lt_u32 s40, 64
    s_cbranch_scc1 interleave_layers__linear_attn_block__memory_aug_recurrent_mem_tr__prompt_kernel_s_stepw3
interleave_layers__linear_attn_block__memory_aug_recurrent_mem_tr__prompt_kernel_s_end:
    ds_read_b128 v[48:51], v21 offset:0
    ds_read_b128 v[52:55], v21 offset:16
    ds_read_b128 v[56:59], v21 offset:5632
    ds_read_b128 v[60:63], v21 offset:5648
    ds_read_b128 v[64:67], v21 offset:11264
    ds_read_b128 v[68:71], v21 offset:11280
    ds_read_b128 v[72:75], v21 offset:16896
    ds_read_b128 v[76:79], v21 offset:16912
    s_waitcnt lgkmcnt(4)
    v_pk_add_f32 v[48:49], v[48:49], v[56:57]
    v_pk_add_f32 v[50:51], v[50:51], v[58:59]
    v_pk_add_f32 v[52:53], v[52:53], v[60:61]
    v_pk_add_f32 v[54:55], v[54:55], v[62:63]
    s_waitcnt lgkmcnt(0)
    v_pk_add_f32 v[64:65], v[64:65], v[72:73]
    v_pk_add_f32 v[66:67], v[66:67], v[74:75]
    v_pk_add_f32 v[68:69], v[68:69], v[76:77]
    v_pk_add_f32 v[70:71], v[70:71], v[78:79]
    v_pk_add_f32 v[48:49], v[48:49], v[64:65]
    v_pk_add_f32 v[50:51], v[50:51], v[66:67]
    v_pk_add_f32 v[52:53], v[52:53], v[68:69]
    v_pk_add_f32 v[54:55], v[54:55], v[70:71]
    v_mov_b32 v81, 0xff800000
    v_cndmask_b32 v48, v81, v48, s[64:65]
    v_cndmask_b32 v49, v81, v49, s[66:67]
    v_cndmask_b32 v50, v81, v50, s[68:69]
    v_cndmask_b32 v51, v81, v51, s[70:71]
    v_cndmask_b32 v52, v81, v52, s[72:73]
    v_cndmask_b32 v53, v81, v53, s[74:75]
    v_cndmask_b32 v54, v81, v54, s[76:77]
    v_cndmask_b32 v55, v81, v55, s[78:79]
    v_max3_f32 v80, v48, v49, v50
    v_max3_f32 v80, v80, v51, v52
    v_max3_f32 v80, v80, v53, v54
    v_max_f32 v80, v80, v55
    v_mov_b32 v81, 0xff800000
    v_cndmask_b32 v80, v81, v80, s[50:51]
    s_nop 1
    v_max_f32 v80, v80, v80 quad_perm:[1,0,3,2] row_mask:0xf bank_mask:0xf
    s_nop 1
    v_max_f32 v80, v80, v80 quad_perm:[2,3,0,1] row_mask:0xf bank_mask:0xf
    s_nop 1
    v_max_f32 v80, v80, v80 row_half_mirror row_mask:0xf bank_mask:0xf
    s_mov_b32 s24, 0x3dd53b95
    v_mul_f32 v80, s24, v80
    v_fma_f32 v48, v48, s24, -v80
    v_fma_f32 v49, v49, s24, -v80
    v_fma_f32 v50, v50, s24, -v80
    v_fma_f32 v51, v51, s24, -v80
    v_fma_f32 v52, v52, s24, -v80
    v_fma_f32 v53, v53, s24, -v80
    v_fma_f32 v54, v54, s24, -v80
    v_fma_f32 v55, v55, s24, -v80
    v_exp_f32 v48, v48
    v_exp_f32 v49, v49
    v_exp_f32 v50, v50
    v_exp_f32 v51, v51
    v_exp_f32 v52, v52
    v_exp_f32 v53, v53
    v_exp_f32 v54, v54
    v_exp_f32 v55, v55
    v_add_f32 v80, v48, v49
    v_add_f32 v81, v50, v51
    v_add_f32 v80, v80, v52
    v_add_f32 v81, v81, v53
    v_add_f32 v80, v80, v54
    v_add_f32 v81, v81, v55
    v_add_f32 v80, v80, v81
    v_cndmask_b32 v80, 0, v80, s[50:51]
    s_nop 1
    v_add_f32 v80, v80, v80 quad_perm:[1,0,3,2] row_mask:0xf bank_mask:0xf
    s_nop 1
    v_add_f32 v80, v80, v80 quad_perm:[2,3,0,1] row_mask:0xf bank_mask:0xf
    s_nop 1
    v_add_f32 v80, v80, v80 row_half_mirror row_mask:0xf bank_mask:0xf
    v_rcp_f32 v80, v80
    s_nop 0
    v_mul_f32 v48, v48, v80
    v_mul_f32 v49, v49, v80
    v_mul_f32 v50, v50, v80
    v_mul_f32 v51, v51, v80
    v_mul_f32 v52, v52, v80
    v_mul_f32 v53, v53, v80
    v_mul_f32 v54, v54, v80
    v_mul_f32 v55, v55, v80
    v_cvt_pk_bf16_f32 v56, v48, v49
    v_cvt_pk_bf16_f32 v57, v50, v51
    v_cvt_pk_bf16_f32 v58, v52, v53
    v_cvt_pk_bf16_f32 v59, v54, v55
    v_min_u32 v56, -2, v56
    v_min_u32 v57, -2, v57
    v_min_u32 v58, -2, v58
    v_min_u32 v59, -2, v59
    buffer_store_dwordx4 v[56:59], v22, s[8:11], s42 offen sc1
    s_add_u32 s42, s42, 458752
    s_cmp_eq_u32 s92, 0
    s_cbranch_scc0 interleave_layers__linear_attn_block__memory_aug_recurrent_mem_tr__prompt_kernel_end
    s_mov_b32 s92, 1
    s_branch interleave_layers__linear_attn_block__memory_aug_recurrent_mem_tr__prompt_kernel_s_layer
interleave_layers__linear_attn_block__memory_aug_recurrent_mem_tr__prompt_kernel_roleV:
    s_sub_u32 s44, s2, 32
    s_load_dwordx2 s[6:7], s[0:1], 56
    s_load_dwordx2 s[24:25], s[0:1], 64
    s_load_dwordx2 s[26:27], s[0:1], 32
    s_waitcnt lgkmcnt(0)
    s_mov_b32 s12, s6
    s_mov_b32 s13, s7
    s_mov_b32 s14, 7864320
    s_mov_b32 s15, 0x00020000
    s_mov_b32 s16, s24
    s_mov_b32 s17, s25
    s_mov_b32 s18, 7864320
    s_mov_b32 s19, 0x00020000
    s_mov_b32 s20, s26
    s_mov_b32 s21, s27
    s_mov_b32 s22, 10240
    s_mov_b32 s23, 0x00020000
    v_add_u32 v16, 0, v0
    s_mov_b32 s24, 683
    v_mul_lo_u32 v17, v16, s24
    v_lshrrev_b32 v17, 14, v17
    v_mul_u32_u24 v18, 24, v17
    v_sub_u32 v18, v16, v18
    s_mov_b32 s24, 12288
    v_mul_lo_u32 v4, v17, s24
    v_lshl_add_u32 v4, v18, 4, v4
    v_mul_u32_u24 v10, 400, v17
    v_lshl_add_u32 v10, v18, 4, v10
    v_add_u32 v10, 90112, v10
    v_add_u32 v16, 256, v0
    s_mov_b32 s24, 683
    v_mul_lo_u32 v17, v16, s24
    v_lshrrev_b32 v17, 14, v17
    v_mul_u32_u24 v18, 24, v17
    v_sub_u32 v18, v16, v18
    s_mov_b32 s24, 12288
    v_mul_lo_u32 v5, v17, s24
    v_lshl_add_u32 v5, v18, 4, v5
    v_mul_u32_u24 v11, 400, v17
    v_lshl_add_u32 v11, v18, 4, v11
    v_add_u32 v11, 90112, v11
    v_add_u32 v16, 512, v0
    s_mov_b32 s24, 683
    v_mul_lo_u32 v17, v16, s24
    v_lshrrev_b32 v17, 14, v17
    v_mul_u32_u24 v18, 24, v17
    v_sub_u32 v18, v16, v18
    s_mov_b32 s24, 12288
    v_mul_lo_u32 v6, v17, s24
    v_lshl_add_u32 v6, v18, 4, v6
    v_mul_u32_u24 v12, 400, v17
    v_lshl_add_u32 v12, v18, 4, v12
    v_add_u32 v12, 90112, v12
    v_add_u32 v16, 768, v0
    s_mov_b32 s24, 683
    v_mul_lo_u32 v17, v16, s24
    v_lshrrev_b32 v17, 14, v17
    v_mul_u32_u24 v18, 24, v17
    v_sub_u32 v18, v16, v18
    s_mov_b32 s24, 12288
    v_mul_lo_u32 v7, v17, s24
    v_lshl_add_u32 v7, v18, 4, v7
    v_mul_u32_u24 v13, 400, v17
    v_lshl_add_u32 v13, v18, 4, v13
    v_add_u32 v13, 90112, v13
    v_add_u32 v16, 1024, v0
    s_mov_b32 s24, 683
    v_mul_lo_u32 v17, v16, s24
    v_lshrrev_b32 v17, 14, v17
    v_mul_u32_u24 v18, 24, v17
    v_sub_u32 v18, v16, v18
    s_mov_b32 s24, 12288
    v_mul_lo_u32 v8, v17, s24
    v_lshl_add_u32 v8, v18, 4, v8
    v_mul_u32_u24 v14, 400, v17
    v_lshl_add_u32 v14, v18, 4, v14
    v_add_u32 v14, 90112, v14
    v_add_u32 v16, 1280, v0
    s_mov_b32 s24, 683
    v_mul_lo_u32 v17, v16, s24
    v_lshrrev_b32 v17, 14, v17
    v_mul_u32_u24 v18, 24, v17
    v_sub_u32 v18, v16, v18
    s_mov_b32 s24, 12288
    v_mul_lo_u32 v9, v17, s24
    v_lshl_add_u32 v9, v18, 4, v9
    v_mul_u32_u24 v15, 400, v17
    v_lshl_add_u32 v15, v18, 4, v15
    v_add_u32 v15, 90112, v15
    v_lshrrev_b32 v17, 1, v3
    v_lshlrev_b32 v17, 4, v17
    v_and_b32 v18, 1, v3
    v_lshl_add_u32 v17, v18, 2, v17
    v_lshrrev_b32 v18, 2, v2
    v_and_b32 v19, 1, v18
    v_add_u32 v17, v17, v19
    v_lshrrev_b32 v18, 1, v18
    v_lshl_add_u32 v17, v18, 3, v17
    v_mul_u32_u24 v16, 400, v17
    v_and_b32 v18, 3, v2
    v_lshl_add_u32 v16, v18, 3, v16
    v_add_u32 v16, 90112, v16
    s_mul_i32 s24, s3, 96
    v_add_u32 v16, s24, v16
    s_mul_i32 s45, s44, 384
    s_add_u32 s46, s45, 0
    buffer_load_dwordx4 v[24:27], v4, s[12:15], s46 offen
    buffer_load_dwordx4 v[28:31], v5, s[12:15], s46 offen
    buffer_load_dwordx4 v[32:35], v6, s[12:15], s46 offen
    buffer_load_dwordx4 v[36:39], v7, s[12:15], s46 offen
    buffer_load_dwordx4 v[40:43], v8, s[12:15], s46 offen
    buffer_load_dwordx4 v[44:47], v9, s[12:15], s46 offen
    s_add_u32 s46, s45, 786432
    buffer_load_dwordx4 v[48:51], v4, s[12:15], s46 offen
    buffer_load_dwordx4 v[52:55], v5, s[12:15], s46 offen
    buffer_load_dwordx4 v[56:59], v6, s[12:15], s46 offen
    buffer_load_dwordx4 v[60:63], v7, s[12:15], s46 offen
    buffer_load_dwordx4 v[64:67], v8, s[12:15], s46 offen
    buffer_load_dwordx4 v[68:71], v9, s[12:15], s46 offen
    s_waitcnt vmcnt(6)
    ds_write_b128 v10, v[24:27]
    ds_write_b128 v11, v[28:31]
    ds_write_b128 v12, v[32:35]
    ds_write_b128 v13, v[36:39]
    ds_write_b128 v14, v[40:43]
    ds_write_b128 v15, v[44:47]
    s_add_u32 s46, s45, 1572864
    buffer_load_dwordx4 v[72:75], v4, s[12:15], s46 offen
    buffer_load_dwordx4 v[76:79], v5, s[12:15], s46 offen
    buffer_load_dwordx4 v[80:83], v6, s[12:15], s46 offen
    buffer_load_dwordx4 v[84:87], v7, s[12:15], s46 offen
    buffer_load_dwordx4 v[88:91], v8, s[12:15], s46 offen
    buffer_load_dwordx4 v[92:95], v9, s[12:15], s46 offen
    s_waitcnt lgkmcnt(0)
    s_barrier
    ds_read_b64_tr_b16 a[0:1], v16 offset:0
    ds_read_b64_tr_b16 a[2:3], v16 offset:800
    ds_read_b64_tr_b16 a[4:5], v16 offset:12800
    ds_read_b64_tr_b16 a[6:7], v16 offset:13600
    ds_read_b64_tr_b16 a[80:81], v16 offset:32
    ds_read_b64_tr_b16 a[82:83], v16 offset:832
    ds_read_b64_tr_b16 a[84:85], v16 offset:12832
    ds_read_b64_tr_b16 a[86:87], v16 offset:13632
    ds_read_b64_tr_b16 a[160:161], v16 offset:64
    ds_read_b64_tr_b16 a[162:163], v16 offset:864
    ds_read_b64_tr_b16 a[164:165], v16 offset:12864
    ds_read_b64_tr_b16 a[166:167], v16 offset:13664
    s_waitcnt lgkmcnt(0)
    s_barrier
    s_waitcnt vmcnt(6)
    ds_write_b128 v10, v[48:51]
    ds_write_b128 v11, v[52:55]
    ds_write_b128 v12, v[56:59]
    ds_write_b128 v13, v[60:63]
    ds_write_b128 v14, v[64:67]
    ds_write_b128 v15, v[68:71]
    s_add_u32 s46, s45, 2359296
    buffer_load_dwordx4 v[24:27], v4, s[12:15], s46 offen
    buffer_load_dwordx4 v[28:31], v5, s[12:15], s46 offen
    buffer_load_dwordx4 v[32:35], v6, s[12:15], s46 offen
    buffer_load_dwordx4 v[36:39], v7, s[12:15], s46 offen
    buffer_load_dwordx4 v[40:43], v8, s[12:15], s46 offen
    buffer_load_dwordx4 v[44:47], v9, s[12:15], s46 offen
    s_waitcnt lgkmcnt(0)
    s_barrier
    ds_read_b64_tr_b16 a[8:9], v16 offset:0
    ds_read_b64_tr_b16 a[10:11], v16 offset:800
    ds_read_b64_tr_b16 a[12:13], v16 offset:12800
    ds_read_b64_tr_b16 a[14:15], v16 offset:13600
    ds_read_b64_tr_b16 a[88:89], v16 offset:32
    ds_read_b64_tr_b16 a[90:91], v16 offset:832
    ds_read_b64_tr_b16 a[92:93], v16 offset:12832
    ds_read_b64_tr_b16 a[94:95], v16 offset:13632
    ds_read_b64_tr_b16 a[168:169], v16 offset:64
    ds_read_b64_tr_b16 a[170:171], v16 offset:864
    ds_read_b64_tr_b16 a[172:173], v16 offset:12864
    ds_read_b64_tr_b16 a[174:175], v16 offset:13664
    s_waitcnt lgkmcnt(0)
    s_barrier
    s_waitcnt vmcnt(6)
    ds_write_b128 v10, v[72:75]
    ds_write_b128 v11, v[76:79]
    ds_write_b128 v12, v[80:83]
    ds_write_b128 v13, v[84:87]
    ds_write_b128 v14, v[88:91]
    ds_write_b128 v15, v[92:95]
    s_add_u32 s46, s45, 3145728
    buffer_load_dwordx4 v[48:51], v4, s[12:15], s46 offen
    buffer_load_dwordx4 v[52:55], v5, s[12:15], s46 offen
    buffer_load_dwordx4 v[56:59], v6, s[12:15], s46 offen
    buffer_load_dwordx4 v[60:63], v7, s[12:15], s46 offen
    buffer_load_dwordx4 v[64:67], v8, s[12:15], s46 offen
    buffer_load_dwordx4 v[68:71], v9, s[12:15], s46 offen
    s_waitcnt lgkmcnt(0)
    s_barrier
    ds_read_b64_tr_b16 a[16:17], v16 offset:0
    ds_read_b64_tr_b16 a[18:19], v16 offset:800
    ds_read_b64_tr_b16 a[20:21], v16 offset:12800
    ds_read_b64_tr_b16 a[22:23], v16 offset:13600
    ds_read_b64_tr_b16 a[96:97], v16 offset:32
    ds_read_b64_tr_b16 a[98:99], v16 offset:832
    ds_read_b64_tr_b16 a[100:101], v16 offset:12832
    ds_read_b64_tr_b16 a[102:103], v16 offset:13632
    ds_read_b64_tr_b16 a[176:177], v16 offset:64
    ds_read_b64_tr_b16 a[178:179], v16 offset:864
    ds_read_b64_tr_b16 a[180:181], v16 offset:12864
    ds_read_b64_tr_b16 a[182:183], v16 offset:13664
    s_waitcnt lgkmcnt(0)
    s_barrier
    s_waitcnt vmcnt(6)
    ds_write_b128 v10, v[24:27]
    ds_write_b128 v11, v[28:31]
    ds_write_b128 v12, v[32:35]
    ds_write_b128 v13, v[36:39]
    ds_write_b128 v14, v[40:43]
    ds_write_b128 v15, v[44:47]
    s_add_u32 s46, s45, 3932160
    buffer_load_dwordx4 v[72:75], v4, s[12:15], s46 offen
    buffer_load_dwordx4 v[76:79], v5, s[12:15], s46 offen
    buffer_load_dwordx4 v[80:83], v6, s[12:15], s46 offen
    buffer_load_dwordx4 v[84:87], v7, s[12:15], s46 offen
    buffer_load_dwordx4 v[88:91], v8, s[12:15], s46 offen
    buffer_load_dwordx4 v[92:95], v9, s[12:15], s46 offen
    s_waitcnt lgkmcnt(0)
    s_barrier
    ds_read_b64_tr_b16 a[24:25], v16 offset:0
    ds_read_b64_tr_b16 a[26:27], v16 offset:800
    ds_read_b64_tr_b16 a[28:29], v16 offset:12800
    ds_read_b64_tr_b16 a[30:31], v16 offset:13600
    ds_read_b64_tr_b16 a[104:105], v16 offset:32
    ds_read_b64_tr_b16 a[106:107], v16 offset:832
    ds_read_b64_tr_b16 a[108:109], v16 offset:12832
    ds_read_b64_tr_b16 a[110:111], v16 offset:13632
    ds_read_b64_tr_b16 a[184:185], v16 offset:64
    ds_read_b64_tr_b16 a[186:187], v16 offset:864
    ds_read_b64_tr_b16 a[188:189], v16 offset:12864
    ds_read_b64_tr_b16 a[190:191], v16 offset:13664
    s_waitcnt lgkmcnt(0)
    s_barrier
    s_waitcnt vmcnt(6)
    ds_write_b128 v10, v[48:51]
    ds_write_b128 v11, v[52:55]
    ds_write_b128 v12, v[56:59]
    ds_write_b128 v13, v[60:63]
    ds_write_b128 v14, v[64:67]
    ds_write_b128 v15, v[68:71]
    s_add_u32 s46, s45, 4718592
    buffer_load_dwordx4 v[24:27], v4, s[12:15], s46 offen
    buffer_load_dwordx4 v[28:31], v5, s[12:15], s46 offen
    buffer_load_dwordx4 v[32:35], v6, s[12:15], s46 offen
    buffer_load_dwordx4 v[36:39], v7, s[12:15], s46 offen
    buffer_load_dwordx4 v[40:43], v8, s[12:15], s46 offen
    buffer_load_dwordx4 v[44:47], v9, s[12:15], s46 offen
    s_waitcnt lgkmcnt(0)
    s_barrier
    ds_read_b64_tr_b16 a[32:33], v16 offset:0
    ds_read_b64_tr_b16 a[34:35], v16 offset:800
    ds_read_b64_tr_b16 a[36:37], v16 offset:12800
    ds_read_b64_tr_b16 a[38:39], v16 offset:13600
    ds_read_b64_tr_b16 a[112:113], v16 offset:32
    ds_read_b64_tr_b16 a[114:115], v16 offset:832
    ds_read_b64_tr_b16 a[116:117], v16 offset:12832
    ds_read_b64_tr_b16 a[118:119], v16 offset:13632
    ds_read_b64_tr_b16 a[192:193], v16 offset:64
    ds_read_b64_tr_b16 a[194:195], v16 offset:864
    ds_read_b64_tr_b16 a[196:197], v16 offset:12864
    ds_read_b64_tr_b16 a[198:199], v16 offset:13664
    s_waitcnt lgkmcnt(0)
    s_barrier
    s_waitcnt vmcnt(6)
    ds_write_b128 v10, v[72:75]
    ds_write_b128 v11, v[76:79]
    ds_write_b128 v12, v[80:83]
    ds_write_b128 v13, v[84:87]
    ds_write_b128 v14, v[88:91]
    ds_write_b128 v15, v[92:95]
    s_add_u32 s46, s45, 5505024
    buffer_load_dwordx4 v[48:51], v4, s[12:15], s46 offen
    buffer_load_dwordx4 v[52:55], v5, s[12:15], s46 offen
    buffer_load_dwordx4 v[56:59], v6, s[12:15], s46 offen
    buffer_load_dwordx4 v[60:63], v7, s[12:15], s46 offen
    buffer_load_dwordx4 v[64:67], v8, s[12:15], s46 offen
    buffer_load_dwordx4 v[68:71], v9, s[12:15], s46 offen
    s_waitcnt lgkmcnt(0)
    s_barrier
    ds_read_b64_tr_b16 a[40:41], v16 offset:0
    ds_read_b64_tr_b16 a[42:43], v16 offset:800
    ds_read_b64_tr_b16 a[44:45], v16 offset:12800
    ds_read_b64_tr_b16 a[46:47], v16 offset:13600
    ds_read_b64_tr_b16 a[120:121], v16 offset:32
    ds_read_b64_tr_b16 a[122:123], v16 offset:832
    ds_read_b64_tr_b16 a[124:125], v16 offset:12832
    ds_read_b64_tr_b16 a[126:127], v16 offset:13632
    ds_read_b64_tr_b16 a[200:201], v16 offset:64
    ds_read_b64_tr_b16 a[202:203], v16 offset:864
    ds_read_b64_tr_b16 a[204:205], v16 offset:12864
    ds_read_b64_tr_b16 a[206:207], v16 offset:13664
    s_waitcnt lgkmcnt(0)
    s_barrier
    s_waitcnt vmcnt(6)
    ds_write_b128 v10, v[24:27]
    ds_write_b128 v11, v[28:31]
    ds_write_b128 v12, v[32:35]
    ds_write_b128 v13, v[36:39]
    ds_write_b128 v14, v[40:43]
    ds_write_b128 v15, v[44:47]
    s_add_u32 s46, s45, 6291456
    buffer_load_dwordx4 v[72:75], v4, s[12:15], s46 offen
    buffer_load_dwordx4 v[76:79], v5, s[12:15], s46 offen
    buffer_load_dwordx4 v[80:83], v6, s[12:15], s46 offen
    buffer_load_dwordx4 v[84:87], v7, s[12:15], s46 offen
    buffer_load_dwordx4 v[88:91], v8, s[12:15], s46 offen
    buffer_load_dwordx4 v[92:95], v9, s[12:15], s46 offen
    s_waitcnt lgkmcnt(0)
    s_barrier
    ds_read_b64_tr_b16 a[48:49], v16 offset:0
    ds_read_b64_tr_b16 a[50:51], v16 offset:800
    ds_read_b64_tr_b16 a[52:53], v16 offset:12800
    ds_read_b64_tr_b16 a[54:55], v16 offset:13600
    ds_read_b64_tr_b16 a[128:129], v16 offset:32
    ds_read_b64_tr_b16 a[130:131], v16 offset:832
    ds_read_b64_tr_b16 a[132:133], v16 offset:12832
    ds_read_b64_tr_b16 a[134:135], v16 offset:13632
    ds_read_b64_tr_b16 a[208:209], v16 offset:64
    ds_read_b64_tr_b16 a[210:211], v16 offset:864
    ds_read_b64_tr_b16 a[212:213], v16 offset:12864
    ds_read_b64_tr_b16 a[214:215], v16 offset:13664
    s_waitcnt lgkmcnt(0)
    s_barrier
    s_waitcnt vmcnt(6)
    ds_write_b128 v10, v[48:51]
    ds_write_b128 v11, v[52:55]
    ds_write_b128 v12, v[56:59]
    ds_write_b128 v13, v[60:63]
    ds_write_b128 v14, v[64:67]
    ds_write_b128 v15, v[68:71]
    s_add_u32 s46, s45, 7077888
    buffer_load_dwordx4 v[24:27], v4, s[12:15], s46 offen
    buffer_load_dwordx4 v[28:31], v5, s[12:15], s46 offen
    buffer_load_dwordx4 v[32:35], v6, s[12:15], s46 offen
    buffer_load_dwordx4 v[36:39], v7, s[12:15], s46 offen
    buffer_load_dwordx4 v[40:43], v8, s[12:15], s46 offen
    buffer_load_dwordx4 v[44:47], v9, s[12:15], s46 offen
    s_waitcnt lgkmcnt(0)
    s_barrier
    ds_read_b64_tr_b16 a[56:57], v16 offset:0
    ds_read_b64_tr_b16 a[58:59], v16 offset:800
    ds_read_b64_tr_b16 a[60:61], v16 offset:12800
    ds_read_b64_tr_b16 a[62:63], v16 offset:13600
    ds_read_b64_tr_b16 a[136:137], v16 offset:32
    ds_read_b64_tr_b16 a[138:139], v16 offset:832
    ds_read_b64_tr_b16 a[140:141], v16 offset:12832
    ds_read_b64_tr_b16 a[142:143], v16 offset:13632
    ds_read_b64_tr_b16 a[216:217], v16 offset:64
    ds_read_b64_tr_b16 a[218:219], v16 offset:864
    ds_read_b64_tr_b16 a[220:221], v16 offset:12864
    ds_read_b64_tr_b16 a[222:223], v16 offset:13664
    s_waitcnt lgkmcnt(0)
    s_barrier
    s_waitcnt vmcnt(6)
    ds_write_b128 v10, v[72:75]
    ds_write_b128 v11, v[76:79]
    ds_write_b128 v12, v[80:83]
    ds_write_b128 v13, v[84:87]
    ds_write_b128 v14, v[88:91]
    ds_write_b128 v15, v[92:95]
    s_waitcnt lgkmcnt(0)
    s_barrier
    ds_read_b64_tr_b16 a[64:65], v16 offset:0
    ds_read_b64_tr_b16 a[66:67], v16 offset:800
    ds_read_b64_tr_b16 a[68:69], v16 offset:12800
    ds_read_b64_tr_b16 a[70:71], v16 offset:13600
    ds_read_b64_tr_b16 a[144:145], v16 offset:32
    ds_read_b64_tr_b16 a[146:147], v16 offset:832
    ds_read_b64_tr_b16 a[148:149], v16 offset:12832
    ds_read_b64_tr_b16 a[150:151], v16 offset:13632
    ds_read_b64_tr_b16 a[224:225], v16 offset:64
    ds_read_b64_tr_b16 a[226:227], v16 offset:864
    ds_read_b64_tr_b16 a[228:229], v16 offset:12864
    ds_read_b64_tr_b16 a[230:231], v16 offset:13664
    s_waitcnt lgkmcnt(0)
    s_barrier
    s_waitcnt vmcnt(0)
    ds_write_b128 v10, v[24:27]
    ds_write_b128 v11, v[28:31]
    ds_write_b128 v12, v[32:35]
    ds_write_b128 v13, v[36:39]
    ds_write_b128 v14, v[40:43]
    ds_write_b128 v15, v[44:47]
    s_waitcnt lgkmcnt(0)
    s_barrier
    ds_read_b64_tr_b16 a[72:73], v16 offset:0
    ds_read_b64_tr_b16 a[74:75], v16 offset:800
    ds_read_b64_tr_b16 a[76:77], v16 offset:12800
    ds_read_b64_tr_b16 a[78:79], v16 offset:13600
    ds_read_b64_tr_b16 a[152:153], v16 offset:32
    ds_read_b64_tr_b16 a[154:155], v16 offset:832
    ds_read_b64_tr_b16 a[156:157], v16 offset:12832
    ds_read_b64_tr_b16 a[158:159], v16 offset:13632
    ds_read_b64_tr_b16 a[232:233], v16 offset:64
    ds_read_b64_tr_b16 a[234:235], v16 offset:864
    ds_read_b64_tr_b16 a[236:237], v16 offset:12864
    ds_read_b64_tr_b16 a[238:239], v16 offset:13664
    s_waitcnt lgkmcnt(0)
    s_barrier
    v_add_u32 v64, 0, v0
    s_mov_b32 s24, 1639
    v_mul_lo_u32 v65, v64, s24
    v_lshrrev_b32 v65, 16, v65
    v_mul_u32_u24 v66, 40, v65
    v_sub_u32 v66, v64, v66
    s_mov_b32 s24, 1280
    v_mul_lo_u32 v4, v65, s24
    v_lshl_add_u32 v4, v66, 4, v4
    v_mul_u32_u24 v14, 656, v65
    v_lshl_add_u32 v14, v66, 4, v14
    v_add_u32 v14, 90112, v14
    v_add_u32 v64, 256, v0
    s_mov_b32 s24, 1639
    v_mul_lo_u32 v65, v64, s24
    v_lshrrev_b32 v65, 16, v65
    v_mul_u32_u24 v66, 40, v65
    v_sub_u32 v66, v64, v66
    s_mov_b32 s24, 1280
    v_mul_lo_u32 v5, v65, s24
    v_lshl_add_u32 v5, v66, 4, v5
    v_mul_u32_u24 v15, 656, v65
    v_lshl_add_u32 v15, v66, 4, v15
    v_add_u32 v15, 90112, v15
    v_add_u32 v64, 512, v0
    s_mov_b32 s24, 1639
    v_mul_lo_u32 v65, v64, s24
    v_lshrrev_b32 v65, 16, v65
    v_mul_u32_u24 v66, 40, v65
    v_sub_u32 v66, v64, v66
    s_mov_b32 s24, 1280
    v_mul_lo_u32 v6, v65, s24
    v_lshl_add_u32 v6, v66, 4, v6
    v_mul_u32_u24 v16, 656, v65
    v_lshl_add_u32 v16, v66, 4, v16
    v_add_u32 v16, 90112, v16
    v_add_u32 v64, 768, v0
    s_mov_b32 s24, 1639
    v_mul_lo_u32 v65, v64, s24
    v_lshrrev_b32 v65, 16, v65
    v_mul_u32_u24 v66, 40, v65
    v_sub_u32 v66, v64, v66
    s_mov_b32 s24, 1280
    v_mul_lo_u32 v7, v65, s24
    v_lshl_add_u32 v7, v66, 4, v7
    v_mul_u32_u24 v17, 656, v65
    v_lshl_add_u32 v17, v66, 4, v17
    v_add_u32 v17, 90112, v17
    v_add_u32 v64, 1024, v0
    s_mov_b32 s24, 1639
    v_mul_lo_u32 v65, v64, s24
    v_lshrrev_b32 v65, 16, v65
    v_mul_u32_u24 v66, 40, v65
    v_sub_u32 v66, v64, v66
    s_mov_b32 s24, 1280
    v_mul_lo_u32 v8, v65, s24
    v_lshl_add_u32 v8, v66, 4, v8
    v_mul_u32_u24 v18, 656, v65
    v_lshl_add_u32 v18, v66, 4, v18
    v_add_u32 v18, 90112, v18
    v_add_u32 v64, 1280, v0
    s_mov_b32 s24, 1639
    v_mul_lo_u32 v65, v64, s24
    v_lshrrev_b32 v65, 16, v65
    v_mul_u32_u24 v66, 40, v65
    v_sub_u32 v66, v64, v66
    s_mov_b32 s24, 1280
    v_mul_lo_u32 v9, v65, s24
    v_lshl_add_u32 v9, v66, 4, v9
    v_mul_u32_u24 v19, 656, v65
    v_lshl_add_u32 v19, v66, 4, v19
    v_add_u32 v19, 90112, v19
    v_add_u32 v64, 1536, v0
    s_mov_b32 s24, 1639
    v_mul_lo_u32 v65, v64, s24
    v_lshrrev_b32 v65, 16, v65
    v_mul_u32_u24 v66, 40, v65
    v_sub_u32 v66, v64, v66
    s_mov_b32 s24, 1280
    v_mul_lo_u32 v10, v65, s24
    v_lshl_add_u32 v10, v66, 4, v10
    v_mul_u32_u24 v20, 656, v65
    v_lshl_add_u32 v20, v66, 4, v20
    v_add_u32 v20, 90112, v20
    v_add_u32 v64, 1792, v0
    s_mov_b32 s24, 1639
    v_mul_lo_u32 v65, v64, s24
    v_lshrrev_b32 v65, 16, v65
    v_mul_u32_u24 v66, 40, v65
    v_sub_u32 v66, v64, v66
    s_mov_b32 s24, 1280
    v_mul_lo_u32 v11, v65, s24
    v_lshl_add_u32 v11, v66, 4, v11
    v_mul_u32_u24 v21, 656, v65
    v_lshl_add_u32 v21, v66, 4, v21
    v_add_u32 v21, 90112, v21
    v_add_u32 v64, 2048, v0
    s_mov_b32 s24, 1639
    v_mul_lo_u32 v65, v64, s24
    v_lshrrev_b32 v65, 16, v65
    v_mul_u32_u24 v66, 40, v65
    v_sub_u32 v66, v64, v66
    s_mov_b32 s24, 1280
    v_mul_lo_u32 v12, v65, s24
    v_lshl_add_u32 v12, v66, 4, v12
    v_mul_u32_u24 v22, 656, v65
    v_lshl_add_u32 v22, v66, 4, v22
    v_add_u32 v22, 90112, v22
    v_add_u32 v64, 2304, v0
    s_mov_b32 s24, 1639
    v_mul_lo_u32 v65, v64, s24
    v_lshrrev_b32 v65, 16, v65
    v_mul_u32_u24 v66, 40, v65
    v_sub_u32 v66, v64, v66
    s_mov_b32 s24, 1280
    v_mul_lo_u32 v13, v65, s24
    v_lshl_add_u32 v13, v66, 4, v13
    v_mul_u32_u24 v23, 656, v65
    v_lshl_add_u32 v23, v66, 4, v23
    v_add_u32 v23, 90112, v23
    v_lshrrev_b32 v64, 1, v3
    v_lshlrev_b32 v64, 4, v64
    v_and_b32 v65, 1, v3
    v_lshl_add_u32 v64, v65, 2, v64
    v_lshrrev_b32 v65, 2, v2
    v_and_b32 v66, 1, v65
    v_add_u32 v64, v64, v66
    v_lshrrev_b32 v65, 1, v65
    v_lshl_add_u32 v64, v65, 3, v64
    v_mul_u32_u24 v72, 656, v64
    v_and_b32 v65, 3, v2
    v_lshl_add_u32 v72, v65, 3, v72
    v_add_u32 v72, 90112, v72
    s_and_b32 s24, s3, 1
    s_mul_i32 s24, s24, 320
    v_add_u32 v72, s24, v72
    v_lshlrev_b32 v73, 4, v1
    s_mul_i32 s24, s3, 18432
    s_add_u32 s24, s24, 16384
    v_add_u32 v73, s24, v73
    s_mul_i32 s45, s44, 245760
    s_add_u32 s46, s45, 0
    buffer_load_dwordx4 v[24:27], v4, s[16:19], s46 offen
    buffer_load_dwordx4 v[28:31], v5, s[16:19], s46 offen
    buffer_load_dwordx4 v[32:35], v6, s[16:19], s46 offen
    buffer_load_dwordx4 v[36:39], v7, s[16:19], s46 offen
    buffer_load_dwordx4 v[40:43], v8, s[16:19], s46 offen
    buffer_load_dwordx4 v[44:47], v9, s[16:19], s46 offen
    buffer_load_dwordx4 v[48:51], v10, s[16:19], s46 offen
    buffer_load_dwordx4 v[52:55], v11, s[16:19], s46 offen
    buffer_load_dwordx4 v[56:59], v12, s[16:19], s46 offen
    buffer_load_dwordx4 v[60:63], v13, s[16:19], s46 offen
    s_waitcnt vmcnt(0)
    ds_write_b128 v14, v[24:27]
    ds_write_b128 v15, v[28:31]
    ds_write_b128 v16, v[32:35]
    ds_write_b128 v17, v[36:39]
    ds_write_b128 v18, v[40:43]
    ds_write_b128 v19, v[44:47]
    ds_write_b128 v20, v[48:51]
    ds_write_b128 v21, v[52:55]
    ds_write_b128 v22, v[56:59]
    ds_write_b128 v23, v[60:63]
    s_waitcnt lgkmcnt(0)
    s_barrier
    s_lshr_b32 s24, s3, 1
    s_cmp_eq_u32 s24, 0
    s_cbranch_scc0 interleave_layers__linear_attn_block__memory_aug_recurrent_mem_tr__prompt_kernel_wo16
    ds_read_b64_tr_b16 a[240:241], v72 offset:0
    ds_read_b64_tr_b16 a[242:243], v72 offset:1312
    ds_read_b64_tr_b16 a[244:245], v72 offset:20992
    ds_read_b64_tr_b16 a[246:247], v72 offset:22304
    ds_read_b64_tr_b16 v[112:113], v72 offset:32
    ds_read_b64_tr_b16 v[114:115], v72 offset:1344
    ds_read_b64_tr_b16 v[116:117], v72 offset:21024
    ds_read_b64_tr_b16 v[118:119], v72 offset:22336
    ds_read_b64_tr_b16 v[136:137], v72 offset:64
    ds_read_b64_tr_b16 v[138:139], v72 offset:1376
    ds_read_b64_tr_b16 v[140:141], v72 offset:21056
    ds_read_b64_tr_b16 v[142:143], v72 offset:22368
    ds_read_b64_tr_b16 v[160:161], v72 offset:96
    ds_read_b64_tr_b16 v[162:163], v72 offset:1408
    ds_read_b64_tr_b16 v[164:165], v72 offset:21088
    ds_read_b64_tr_b16 v[166:167], v72 offset:22400
    ds_read_b64_tr_b16 v[184:185], v72 offset:128
    ds_read_b64_tr_b16 v[186:187], v72 offset:1440
    ds_read_b64_tr_b16 v[188:189], v72 offset:21120
    ds_read_b64_tr_b16 v[190:191], v72 offset:22432
    ds_read_b64_tr_b16 v[208:209], v72 offset:160
    ds_read_b64_tr_b16 v[210:211], v72 offset:1472
    ds_read_b64_tr_b16 v[212:213], v72 offset:21152
    ds_read_b64_tr_b16 v[214:215], v72 offset:22464
    ds_read_b64_tr_b16 v[232:233], v72 offset:192
    ds_read_b64_tr_b16 v[234:235], v72 offset:1504
    ds_read_b64_tr_b16 v[236:237], v72 offset:21184
    ds_read_b64_tr_b16 v[238:239], v72 offset:22496
    ds_read_b64_tr_b16 v[64:65], v72 offset:224
    ds_read_b64_tr_b16 v[66:67], v72 offset:1536
    ds_read_b64_tr_b16 v[68:69], v72 offset:21216
    ds_read_b64_tr_b16 v[70:71], v72 offset:22528
    s_waitcnt lgkmcnt(0)
    ds_write_b128 v73, v[64:67] offset:0
    ds_write_b128 v73, v[68:71] offset:1024
    s_waitcnt lgkmcnt(0)
    ds_read_b64_tr_b16 v[64:65], v72 offset:256
    ds_read_b64_tr_b16 v[66:67], v72 offset:1568
    ds_read_b64_tr_b16 v[68:69], v72 offset:21248
    ds_read_b64_tr_b16 v[70:71], v72 offset:22560
    s_waitcnt lgkmcnt(0)
    ds_write_b128 v73, v[64:67] offset:6144
    ds_write_b128 v73, v[68:71] offset:7168
    s_waitcnt lgkmcnt(0)
    ds_read_b64_tr_b16 v[64:65], v72 offset:288
    ds_read_b64_tr_b16 v[66:67], v72 offset:1600
    ds_read_b64_tr_b16 v[68:69], v72 offset:21280
    ds_read_b64_tr_b16 v[70:71], v72 offset:22592
    s_waitcnt lgkmcnt(0)
    ds_write_b128 v73, v[64:67] offset:12288
    ds_write_b128 v73, v[68:71] offset:13312
    s_waitcnt lgkmcnt(0)
    s_waitcnt lgkmcnt(0)
interleave_layers__linear_attn_block__memory_aug_recurrent_mem_tr__prompt_kernel_wo16:
    s_barrier
    s_add_u32 s46, s45, 640
    buffer_load_dwordx4 v[24:27], v4, s[16:19], s46 offen
    buffer_load_dwordx4 v[28:31], v5, s[16:19], s46 offen
    buffer_load_dwordx4 v[32:35], v6, s[16:19], s46 offen
    buffer_load_dwordx4 v[36:39], v7, s[16:19], s46 offen
    buffer_load_dwordx4 v[40:43], v8, s[16:19], s46 offen
    buffer_load_dwordx4 v[44:47], v9, s[16:19], s46 offen
    buffer_load_dwordx4 v[48:51], v10, s[16:19], s46 offen
    buffer_load_dwordx4 v[52:55], v11, s[16:19], s46 offen
    buffer_load_dwordx4 v[56:59], v12, s[16:19], s46 offen
    buffer_load_dwordx4 v[60:63], v13, s[16:19], s46 offen
    s_waitcnt vmcnt(0)
    ds_write_b128 v14, v[24:27]
    ds_write_b128 v15, v[28:31]
    ds_write_b128 v16, v[32:35]
    ds_write_b128 v17, v[36:39]
    ds_write_b128 v18, v[40:43]
    ds_write_b128 v19, v[44:47]
    ds_write_b128 v20, v[48:51]
    ds_write_b128 v21, v[52:55]
    ds_write_b128 v22, v[56:59]
    ds_write_b128 v23, v[60:63]
    s_waitcnt lgkmcnt(0)
    s_barrier
    s_lshr_b32 s24, s3, 1
    s_cmp_eq_u32 s24, 1
    s_cbranch_scc0 interleave_layers__linear_attn_block__memory_aug_recurrent_mem_tr__prompt_kernel_wo17
    ds_read_b64_tr_b16 a[240:241], v72 offset:0
    ds_read_b64_tr_b16 a[242:243], v72 offset:1312
    ds_read_b64_tr_b16 a[244:245], v72 offset:20992
    ds_read_b64_tr_b16 a[246:247], v72 offset:22304
    ds_read_b64_tr_b16 v[112:113], v72 offset:32
    ds_read_b64_tr_b16 v[114:115], v72 offset:1344
    ds_read_b64_tr_b16 v[116:117], v72 offset:21024
    ds_read_b64_tr_b16 v[118:119], v72 offset:22336
    ds_read_b64_tr_b16 v[136:137], v72 offset:64
    ds_read_b64_tr_b16 v[138:139], v72 offset:1376
    ds_read_b64_tr_b16 v[140:141], v72 offset:21056
    ds_read_b64_tr_b16 v[142:143], v72 offset:22368
    ds_read_b64_tr_b16 v[160:161], v72 offset:96
    ds_read_b64_tr_b16 v[162:163], v72 offset:1408
    ds_read_b64_tr_b16 v[164:165], v72 offset:21088
    ds_read_b64_tr_b16 v[166:167], v72 offset:22400
    ds_read_b64_tr_b16 v[184:185], v72 offset:128
    ds_read_b64_tr_b16 v[186:187], v72 offset:1440
    ds_read_b64_tr_b16 v[188:189], v72 offset:21120
    ds_read_b64_tr_b16 v[190:191], v72 offset:22432
    ds_read_b64_tr_b16 v[208:209], v72 offset:160
    ds_read_b64_tr_b16 v[210:211], v72 offset:1472
    ds_read_b64_tr_b16 v[212:213], v72 offset:21152
    ds_read_b64_tr_b16 v[214:215], v72 offset:22464
    ds_read_b64_tr_b16 v[232:233], v72 offset:192
    ds_read_b64_tr_b16 v[234:235], v72 offset:1504
    ds_read_b64_tr_b16 v[236:237], v72 offset:21184
    ds_read_b64_tr_b16 v[238:239], v72 offset:22496
    ds_read_b64_tr_b16 v[64:65], v72 offset:224
    ds_read_b64_tr_b16 v[66:67], v72 offset:1536
    ds_read_b64_tr_b16 v[68:69], v72 offset:21216
    ds_read_b64_tr_b16 v[70:71], v72 offset:22528
    s_waitcnt lgkmcnt(0)
    ds_write_b128 v73, v[64:67] offset:0
    ds_write_b128 v73, v[68:71] offset:1024
    s_waitcnt lgkmcnt(0)
    ds_read_b64_tr_b16 v[64:65], v72 offset:256
    ds_read_b64_tr_b16 v[66:67], v72 offset:1568
    ds_read_b64_tr_b16 v[68:69], v72 offset:21248
    ds_read_b64_tr_b16 v[70:71], v72 offset:22560
    s_waitcnt lgkmcnt(0)
    ds_write_b128 v73, v[64:67] offset:6144
    ds_write_b128 v73, v[68:71] offset:7168
    s_waitcnt lgkmcnt(0)
    ds_read_b64_tr_b16 v[64:65], v72 offset:288
    ds_read_b64_tr_b16 v[66:67], v72 offset:1600
    ds_read_b64_tr_b16 v[68:69], v72 offset:21280
    ds_read_b64_tr_b16 v[70:71], v72 offset:22592
    s_waitcnt lgkmcnt(0)
    ds_write_b128 v73, v[64:67] offset:12288
    ds_write_b128 v73, v[68:71] offset:13312
    s_waitcnt lgkmcnt(0)
    s_waitcnt lgkmcnt(0)
interleave_layers__linear_attn_block__memory_aug_recurrent_mem_tr__prompt_kernel_wo17:
    s_barrier
    s_add_u32 s46, s45, 81920
    buffer_load_dwordx4 v[24:27], v4, s[16:19], s46 offen
    buffer_load_dwordx4 v[28:31], v5, s[16:19], s46 offen
    buffer_load_dwordx4 v[32:35], v6, s[16:19], s46 offen
    buffer_load_dwordx4 v[36:39], v7, s[16:19], s46 offen
    buffer_load_dwordx4 v[40:43], v8, s[16:19], s46 offen
    buffer_load_dwordx4 v[44:47], v9, s[16:19], s46 offen
    buffer_load_dwordx4 v[48:51], v10, s[16:19], s46 offen
    buffer_load_dwordx4 v[52:55], v11, s[16:19], s46 offen
    buffer_load_dwordx4 v[56:59], v12, s[16:19], s46 offen
    buffer_load_dwordx4 v[60:63], v13, s[16:19], s46 offen
    s_waitcnt vmcnt(0)
    ds_write_b128 v14, v[24:27]
    ds_write_b128 v15, v[28:31]
    ds_write_b128 v16, v[32:35]
    ds_write_b128 v17, v[36:39]
    ds_write_b128 v18, v[40:43]
    ds_write_b128 v19, v[44:47]
    ds_write_b128 v20, v[48:51]
    ds_write_b128 v21, v[52:55]
    ds_write_b128 v22, v[56:59]
    ds_write_b128 v23, v[60:63]
    s_waitcnt lgkmcnt(0)
    s_barrier
    s_lshr_b32 s24, s3, 1
    s_cmp_eq_u32 s24, 0
    s_cbranch_scc0 interleave_layers__linear_attn_block__memory_aug_recurrent_mem_tr__prompt_kernel_wo18
    ds_read_b64_tr_b16 a[248:249], v72 offset:0
    ds_read_b64_tr_b16 a[250:251], v72 offset:1312
    ds_read_b64_tr_b16 a[252:253], v72 offset:20992
    ds_read_b64_tr_b16 a[254:255], v72 offset:22304
    ds_read_b64_tr_b16 v[120:121], v72 offset:32
    ds_read_b64_tr_b16 v[122:123], v72 offset:1344
    ds_read_b64_tr_b16 v[124:125], v72 offset:21024
    ds_read_b64_tr_b16 v[126:127], v72 offset:22336
    ds_read_b64_tr_b16 v[144:145], v72 offset:64
    ds_read_b64_tr_b16 v[146:147], v72 offset:1376
    ds_read_b64_tr_b16 v[148:149], v72 offset:21056
    ds_read_b64_tr_b16 v[150:151], v72 offset:22368
    ds_read_b64_tr_b16 v[168:169], v72 offset:96
    ds_read_b64_tr_b16 v[170:171], v72 offset:1408
    ds_read_b64_tr_b16 v[172:173], v72 offset:21088
    ds_read_b64_tr_b16 v[174:175], v72 offset:22400
    ds_read_b64_tr_b16 v[192:193], v72 offset:128
    ds_read_b64_tr_b16 v[194:195], v72 offset:1440
    ds_read_b64_tr_b16 v[196:197], v72 offset:21120
    ds_read_b64_tr_b16 v[198:199], v72 offset:22432
    ds_read_b64_tr_b16 v[216:217], v72 offset:160
    ds_read_b64_tr_b16 v[218:219], v72 offset:1472
    ds_read_b64_tr_b16 v[220:221], v72 offset:21152
    ds_read_b64_tr_b16 v[222:223], v72 offset:22464
    ds_read_b64_tr_b16 v[240:241], v72 offset:192
    ds_read_b64_tr_b16 v[242:243], v72 offset:1504
    ds_read_b64_tr_b16 v[244:245], v72 offset:21184
    ds_read_b64_tr_b16 v[246:247], v72 offset:22496
    ds_read_b64_tr_b16 v[64:65], v72 offset:224
    ds_read_b64_tr_b16 v[66:67], v72 offset:1536
    ds_read_b64_tr_b16 v[68:69], v72 offset:21216
    ds_read_b64_tr_b16 v[70:71], v72 offset:22528
    s_waitcnt lgkmcnt(0)
    ds_write_b128 v73, v[64:67] offset:2048
    ds_write_b128 v73, v[68:71] offset:3072
    s_waitcnt lgkmcnt(0)
    ds_read_b64_tr_b16 v[64:65], v72 offset:256
    ds_read_b64_tr_b16 v[66:67], v72 offset:1568
    ds_read_b64_tr_b16 v[68:69], v72 offset:21248
    ds_read_b64_tr_b16 v[70:71], v72 offset:22560
    s_waitcnt lgkmcnt(0)
    ds_write_b128 v73, v[64:67] offset:8192
    ds_write_b128 v73, v[68:71] offset:9216
    s_waitcnt lgkmcnt(0)
    ds_read_b64_tr_b16 v[64:65], v72 offset:288
    ds_read_b64_tr_b16 v[66:67], v72 offset:1600
    ds_read_b64_tr_b16 v[68:69], v72 offset:21280
    ds_read_b64_tr_b16 v[70:71], v72 offset:22592
    s_waitcnt lgkmcnt(0)
    ds_write_b128 v73, v[64:67] offset:14336
    ds_write_b128 v73, v[68:71] offset:15360
    s_waitcnt lgkmcnt(0)
    s_waitcnt lgkmcnt(0)
interleave_layers__linear_attn_block__memory_aug_recurrent_mem_tr__prompt_kernel_wo18:
    s_barrier
    s_add_u32 s46, s45, 82560
    buffer_load_dwordx4 v[24:27], v4, s[16:19], s46 offen
    buffer_load_dwordx4 v[28:31], v5, s[16:19], s46 offen
    buffer_load_dwordx4 v[32:35], v6, s[16:19], s46 offen
    buffer_load_dwordx4 v[36:39], v7, s[16:19], s46 offen
    buffer_load_dwordx4 v[40:43], v8, s[16:19], s46 offen
    buffer_load_dwordx4 v[44:47], v9, s[16:19], s46 offen
    buffer_load_dwordx4 v[48:51], v10, s[16:19], s46 offen
    buffer_load_dwordx4 v[52:55], v11, s[16:19], s46 offen
    buffer_load_dwordx4 v[56:59], v12, s[16:19], s46 offen
    buffer_load_dwordx4 v[60:63], v13, s[16:19], s46 offen
    s_waitcnt vmcnt(0)
    ds_write_b128 v14, v[24:27]
    ds_write_b128 v15, v[28:31]
    ds_write_b128 v16, v[32:35]
    ds_write_b128 v17, v[36:39]
    ds_write_b128 v18, v[40:43]
    ds_write_b128 v19, v[44:47]
    ds_write_b128 v20, v[48:51]
    ds_write_b128 v21, v[52:55]
    ds_write_b128 v22, v[56:59]
    ds_write_b128 v23, v[60:63]
    s_waitcnt lgkmcnt(0)
    s_barrier
    s_lshr_b32 s24, s3, 1
    s_cmp_eq_u32 s24, 1
    s_cbranch_scc0 interleave_layers__linear_attn_block__memory_aug_recurrent_mem_tr__prompt_kernel_wo19
    ds_read_b64_tr_b16 a[248:249], v72 offset:0
    ds_read_b64_tr_b16 a[250:251], v72 offset:1312
    ds_read_b64_tr_b16 a[252:253], v72 offset:20992
    ds_read_b64_tr_b16 a[254:255], v72 offset:22304
    ds_read_b64_tr_b16 v[120:121], v72 offset:32
    ds_read_b64_tr_b16 v[122:123], v72 offset:1344
    ds_read_b64_tr_b16 v[124:125], v72 offset:21024
    ds_read_b64_tr_b16 v[126:127], v72 offset:22336
    ds_read_b64_tr_b16 v[144:145], v72 offset:64
    ds_read_b64_tr_b16 v[146:147], v72 offset:1376
    ds_read_b64_tr_b16 v[148:149], v72 offset:21056
    ds_read_b64_tr_b16 v[150:151], v72 offset:22368
    ds_read_b64_tr_b16 v[168:169], v72 offset:96
    ds_read_b64_tr_b16 v[170:171], v72 offset:1408
    ds_read_b64_tr_b16 v[172:173], v72 offset:21088
    ds_read_b64_tr_b16 v[174:175], v72 offset:22400
    ds_read_b64_tr_b16 v[192:193], v72 offset:128
    ds_read_b64_tr_b16 v[194:195], v72 offset:1440
    ds_read_b64_tr_b16 v[196:197], v72 offset:21120
    ds_read_b64_tr_b16 v[198:199], v72 offset:22432
    ds_read_b64_tr_b16 v[216:217], v72 offset:160
    ds_read_b64_tr_b16 v[218:219], v72 offset:1472
    ds_read_b64_tr_b16 v[220:221], v72 offset:21152
    ds_read_b64_tr_b16 v[222:223], v72 offset:22464
    ds_read_b64_tr_b16 v[240:241], v72 offset:192
    ds_read_b64_tr_b16 v[242:243], v72 offset:1504
    ds_read_b64_tr_b16 v[244:245], v72 offset:21184
    ds_read_b64_tr_b16 v[246:247], v72 offset:22496
    ds_read_b64_tr_b16 v[64:65], v72 offset:224
    ds_read_b64_tr_b16 v[66:67], v72 offset:1536
    ds_read_b64_tr_b16 v[68:69], v72 offset:21216
    ds_read_b64_tr_b16 v[70:71], v72 offset:22528
    s_waitcnt lgkmcnt(0)
    ds_write_b128 v73, v[64:67] offset:2048
    ds_write_b128 v73, v[68:71] offset:3072
    s_waitcnt lgkmcnt(0)
    ds_read_b64_tr_b16 v[64:65], v72 offset:256
    ds_read_b64_tr_b16 v[66:67], v72 offset:1568
    ds_read_b64_tr_b16 v[68:69], v72 offset:21248
    ds_read_b64_tr_b16 v[70:71], v72 offset:22560
    s_waitcnt lgkmcnt(0)
    ds_write_b128 v73, v[64:67] offset:8192
    ds_write_b128 v73, v[68:71] offset:9216
    s_waitcnt lgkmcnt(0)
    ds_read_b64_tr_b16 v[64:65], v72 offset:288
    ds_read_b64_tr_b16 v[66:67], v72 offset:1600
    ds_read_b64_tr_b16 v[68:69], v72 offset:21280
    ds_read_b64_tr_b16 v[70:71], v72 offset:22592
    s_waitcnt lgkmcnt(0)
    ds_write_b128 v73, v[64:67] offset:14336
    ds_write_b128 v73, v[68:71] offset:15360
    s_waitcnt lgkmcnt(0)
    s_waitcnt lgkmcnt(0)
interleave_layers__linear_attn_block__memory_aug_recurrent_mem_tr__prompt_kernel_wo19:
    s_barrier
    s_add_u32 s46, s45, 163840
    buffer_load_dwordx4 v[24:27], v4, s[16:19], s46 offen
    buffer_load_dwordx4 v[28:31], v5, s[16:19], s46 offen
    buffer_load_dwordx4 v[32:35], v6, s[16:19], s46 offen
    buffer_load_dwordx4 v[36:39], v7, s[16:19], s46 offen
    buffer_load_dwordx4 v[40:43], v8, s[16:19], s46 offen
    buffer_load_dwordx4 v[44:47], v9, s[16:19], s46 offen
    buffer_load_dwordx4 v[48:51], v10, s[16:19], s46 offen
    buffer_load_dwordx4 v[52:55], v11, s[16:19], s46 offen
    buffer_load_dwordx4 v[56:59], v12, s[16:19], s46 offen
    buffer_load_dwordx4 v[60:63], v13, s[16:19], s46 offen
    s_waitcnt vmcnt(0)
    ds_write_b128 v14, v[24:27]
    ds_write_b128 v15, v[28:31]
    ds_write_b128 v16, v[32:35]
    ds_write_b128 v17, v[36:39]
    ds_write_b128 v18, v[40:43]
    ds_write_b128 v19, v[44:47]
    ds_write_b128 v20, v[48:51]
    ds_write_b128 v21, v[52:55]
    ds_write_b128 v22, v[56:59]
    ds_write_b128 v23, v[60:63]
    s_waitcnt lgkmcnt(0)
    s_barrier
    s_lshr_b32 s24, s3, 1
    s_cmp_eq_u32 s24, 0
    s_cbranch_scc0 interleave_layers__linear_attn_block__memory_aug_recurrent_mem_tr__prompt_kernel_wo20
    ds_read_b64_tr_b16 v[104:105], v72 offset:0
    ds_read_b64_tr_b16 v[106:107], v72 offset:1312
    ds_read_b64_tr_b16 v[108:109], v72 offset:20992
    ds_read_b64_tr_b16 v[110:111], v72 offset:22304
    ds_read_b64_tr_b16 v[128:129], v72 offset:32
    ds_read_b64_tr_b16 v[130:131], v72 offset:1344
    ds_read_b64_tr_b16 v[132:133], v72 offset:21024
    ds_read_b64_tr_b16 v[134:135], v72 offset:22336
    ds_read_b64_tr_b16 v[152:153], v72 offset:64
    ds_read_b64_tr_b16 v[154:155], v72 offset:1376
    ds_read_b64_tr_b16 v[156:157], v72 offset:21056
    ds_read_b64_tr_b16 v[158:159], v72 offset:22368
    ds_read_b64_tr_b16 v[176:177], v72 offset:96
    ds_read_b64_tr_b16 v[178:179], v72 offset:1408
    ds_read_b64_tr_b16 v[180:181], v72 offset:21088
    ds_read_b64_tr_b16 v[182:183], v72 offset:22400
    ds_read_b64_tr_b16 v[200:201], v72 offset:128
    ds_read_b64_tr_b16 v[202:203], v72 offset:1440
    ds_read_b64_tr_b16 v[204:205], v72 offset:21120
    ds_read_b64_tr_b16 v[206:207], v72 offset:22432
    ds_read_b64_tr_b16 v[224:225], v72 offset:160
    ds_read_b64_tr_b16 v[226:227], v72 offset:1472
    ds_read_b64_tr_b16 v[228:229], v72 offset:21152
    ds_read_b64_tr_b16 v[230:231], v72 offset:22464
    ds_read_b64_tr_b16 v[248:249], v72 offset:192
    ds_read_b64_tr_b16 v[250:251], v72 offset:1504
    ds_read_b64_tr_b16 v[252:253], v72 offset:21184
    ds_read_b64_tr_b16 v[254:255], v72 offset:22496
    ds_read_b64_tr_b16 v[64:65], v72 offset:224
    ds_read_b64_tr_b16 v[66:67], v72 offset:1536
    ds_read_b64_tr_b16 v[68:69], v72 offset:21216
    ds_read_b64_tr_b16 v[70:71], v72 offset:22528
    s_waitcnt lgkmcnt(0)
    ds_write_b128 v73, v[64:67] offset:4096
    ds_write_b128 v73, v[68:71] offset:5120
    s_waitcnt lgkmcnt(0)
    ds_read_b64_tr_b16 v[64:65], v72 offset:256
    ds_read_b64_tr_b16 v[66:67], v72 offset:1568
    ds_read_b64_tr_b16 v[68:69], v72 offset:21248
    ds_read_b64_tr_b16 v[70:71], v72 offset:22560
    s_waitcnt lgkmcnt(0)
    ds_write_b128 v73, v[64:67] offset:10240
    ds_write_b128 v73, v[68:71] offset:11264
    s_waitcnt lgkmcnt(0)
    ds_read_b64_tr_b16 v[64:65], v72 offset:288
    ds_read_b64_tr_b16 v[66:67], v72 offset:1600
    ds_read_b64_tr_b16 v[68:69], v72 offset:21280
    ds_read_b64_tr_b16 v[70:71], v72 offset:22592
    s_waitcnt lgkmcnt(0)
    ds_write_b128 v73, v[64:67] offset:16384
    ds_write_b128 v73, v[68:71] offset:17408
    s_waitcnt lgkmcnt(0)
    s_waitcnt lgkmcnt(0)
interleave_layers__linear_attn_block__memory_aug_recurrent_mem_tr__prompt_kernel_wo20:
    s_barrier
    s_add_u32 s46, s45, 164480
    buffer_load_dwordx4 v[24:27], v4, s[16:19], s46 offen
    buffer_load_dwordx4 v[28:31], v5, s[16:19], s46 offen
    buffer_load_dwordx4 v[32:35], v6, s[16:19], s46 offen
    buffer_load_dwordx4 v[36:39], v7, s[16:19], s46 offen
    buffer_load_dwordx4 v[40:43], v8, s[16:19], s46 offen
    buffer_load_dwordx4 v[44:47], v9, s[16:19], s46 offen
    buffer_load_dwordx4 v[48:51], v10, s[16:19], s46 offen
    buffer_load_dwordx4 v[52:55], v11, s[16:19], s46 offen
    buffer_load_dwordx4 v[56:59], v12, s[16:19], s46 offen
    buffer_load_dwordx4 v[60:63], v13, s[16:19], s46 offen
    s_waitcnt vmcnt(0)
    ds_write_b128 v14, v[24:27]
    ds_write_b128 v15, v[28:31]
    ds_write_b128 v16, v[32:35]
    ds_write_b128 v17, v[36:39]
    ds_write_b128 v18, v[40:43]
    ds_write_b128 v19, v[44:47]
    ds_write_b128 v20, v[48:51]
    ds_write_b128 v21, v[52:55]
    ds_write_b128 v22, v[56:59]
    ds_write_b128 v23, v[60:63]
    s_waitcnt lgkmcnt(0)
    s_barrier
    s_lshr_b32 s24, s3, 1
    s_cmp_eq_u32 s24, 1
    s_cbranch_scc0 interleave_layers__linear_attn_block__memory_aug_recurrent_mem_tr__prompt_kernel_wo21
    ds_read_b64_tr_b16 v[104:105], v72 offset:0
    ds_read_b64_tr_b16 v[106:107], v72 offset:1312
    ds_read_b64_tr_b16 v[108:109], v72 offset:20992
    ds_read_b64_tr_b16 v[110:111], v72 offset:22304
    ds_read_b64_tr_b16 v[128:129], v72 offset:32
    ds_read_b64_tr_b16 v[130:131], v72 offset:1344
    ds_read_b64_tr_b16 v[132:133], v72 offset:21024
    ds_read_b64_tr_b16 v[134:135], v72 offset:22336
    ds_read_b64_tr_b16 v[152:153], v72 offset:64
    ds_read_b64_tr_b16 v[154:155], v72 offset:1376
    ds_read_b64_tr_b16 v[156:157], v72 offset:21056
    ds_read_b64_tr_b16 v[158:159], v72 offset:22368
    ds_read_b64_tr_b16 v[176:177], v72 offset:96
    ds_read_b64_tr_b16 v[178:179], v72 offset:1408
    ds_read_b64_tr_b16 v[180:181], v72 offset:21088
    ds_read_b64_tr_b16 v[182:183], v72 offset:22400
    ds_read_b64_tr_b16 v[200:201], v72 offset:128
    ds_read_b64_tr_b16 v[202:203], v72 offset:1440
    ds_read_b64_tr_b16 v[204:205], v72 offset:21120
    ds_read_b64_tr_b16 v[206:207], v72 offset:22432
    ds_read_b64_tr_b16 v[224:225], v72 offset:160
    ds_read_b64_tr_b16 v[226:227], v72 offset:1472
    ds_read_b64_tr_b16 v[228:229], v72 offset:21152
    ds_read_b64_tr_b16 v[230:231], v72 offset:22464
    ds_read_b64_tr_b16 v[248:249], v72 offset:192
    ds_read_b64_tr_b16 v[250:251], v72 offset:1504
    ds_read_b64_tr_b16 v[252:253], v72 offset:21184
    ds_read_b64_tr_b16 v[254:255], v72 offset:22496
    ds_read_b64_tr_b16 v[64:65], v72 offset:224
    ds_read_b64_tr_b16 v[66:67], v72 offset:1536
    ds_read_b64_tr_b16 v[68:69], v72 offset:21216
    ds_read_b64_tr_b16 v[70:71], v72 offset:22528
    s_waitcnt lgkmcnt(0)
    ds_write_b128 v73, v[64:67] offset:4096
    ds_write_b128 v73, v[68:71] offset:5120
    s_waitcnt lgkmcnt(0)
    ds_read_b64_tr_b16 v[64:65], v72 offset:256
    ds_read_b64_tr_b16 v[66:67], v72 offset:1568
    ds_read_b64_tr_b16 v[68:69], v72 offset:21248
    ds_read_b64_tr_b16 v[70:71], v72 offset:22560
    s_waitcnt lgkmcnt(0)
    ds_write_b128 v73, v[64:67] offset:10240
    ds_write_b128 v73, v[68:71] offset:11264
    s_waitcnt lgkmcnt(0)
    ds_read_b64_tr_b16 v[64:65], v72 offset:288
    ds_read_b64_tr_b16 v[66:67], v72 offset:1600
    ds_read_b64_tr_b16 v[68:69], v72 offset:21280
    ds_read_b64_tr_b16 v[70:71], v72 offset:22592
    s_waitcnt lgkmcnt(0)
    ds_write_b128 v73, v[64:67] offset:16384
    ds_write_b128 v73, v[68:71] offset:17408
    s_waitcnt lgkmcnt(0)
    s_waitcnt lgkmcnt(0)
interleave_layers__linear_attn_block__memory_aug_recurrent_mem_tr__prompt_kernel_wo21:
    s_barrier
    v_mov_b32 v6, v73
    v_mov_b32 v4, 0x4444
    v_mov_b32 v5, 0xeeee
    v_cmp_gt_u32 vcc, 8, v2
    s_nop 1
    v_cndmask_b32 v4, v5, v4, vcc
    v_lshlrev_b32 v5, 4, v1
    s_lshl_b32 s24, s3, 10
    v_add_u32 v7, s24, v5
    s_lshl_b32 s24, s3, 9
    s_add_u32 s24, s24, 8192
    v_lshlrev_b32 v8, 3, v1
    v_add_u32 v8, s24, v8
    v_and_b32 v64, 7, v2
    v_lshlrev_b32 v9, 5, v64
    v_lshrrev_b32 v64, 3, v2
    v_lshl_add_u32 v9, v64, 4, v9
    v_and_b32 v64, 1, v3
    v_lshl_add_u32 v9, v64, 3, v9
    s_mul_i32 s24, s3, 768
    s_add_u32 s24, s24, 10240
    v_add_u32 v9, s24, v9
    v_lshrrev_b32 v65, 1, v3
    v_lshl_add_u32 v10, v65, 8, v9
    v_lshrrev_b32 v64, 2, v2
    v_lshlrev_b32 v11, 5, v64
    v_and_b32 v64, 3, v2
    v_lshl_add_u32 v11, v64, 3, v11
    v_lshl_add_u32 v11, v3, 8, v11
    v_add_u32 v11, 10240, v11
    s_mul_i32 s24, s3, 10
    s_lshl_b32 s24, s24, 13
    s_lshl_b32 s25, s44, 8
    s_add_u32 s24, s24, s25
    v_lshlrev_b32 v14, 13, v3
    v_lshl_add_u32 v14, v2, 4, v14
    v_add_u32 v14, s24, v14
    v_lshrrev_b32 v64, 1, v3
    v_lshlrev_b32 v15, 13, v64
    v_lshl_add_u32 v15, v2, 4, v15
    v_add_u32 v15, s24, v15
    v_add_u32 v15, 65536, v15
    v_and_b32 v64, 1, v3
    v_cmp_eq_u32 vcc, 0, v64
    v_mov_b32 v64, 2146435072
    s_nop 0
    v_cndmask_b32 v15, v64, v15, vcc
    s_and_b32 s24, s2, 15
    s_mul_i32 s25, s3, 16
    s_add_u32 s24, s24, s25
    s_lshl_b32 s24, s24, 7
    v_mov_b32 v12, s24
    v_mov_b32 v0, 1
interleave_layers__linear_attn_block__memory_aug_recurrent_mem_tr__prompt_kernel_v_layer:
    s_mul_i32 s93, s92, 29360128
    s_add_u32 s93, s93, 117440512
    s_mul_i32 s94, s92, 16384
    s_add_u32 s94, s94, 23068672
    s_lshl_b32 s24, s3, 6
    s_add_u32 s24, s24, 0
    v_add_u32 v64, s24, v1
    v_and_b32 v65, 7, v64
    v_mul_u32_u24 v65, 1280, v65
    v_lshrrev_b32 v66, 3, v64
    v_lshl_add_u32 v65, v66, 4, v65
    v_cmp_gt_u32 vcc, 640, v64
    v_mov_b32 v67, 2146435072
    s_nop 0
    v_cndmask_b32 v65, v67, v65, vcc
    buffer_load_dwordx4 v[68:71], v65, s[20:23], 0 offen
    v_lshlrev_b32 v64, 4, v64
    s_waitcnt vmcnt(0)
    s_and_saveexec_b64 s[30:31], vcc
    ds_write_b128 v64, v[68:71]
    s_mov_b64 exec, s[30:31]
    s_lshl_b32 s24, s3, 6
    s_add_u32 s24, s24, 256
    v_add_u32 v64, s24, v1
    v_and_b32 v65, 7, v64
    v_mul_u32_u24 v65, 1280, v65
    v_lshrrev_b32 v66, 3, v64
    v_lshl_add_u32 v65, v66, 4, v65
    v_cmp_gt_u32 vcc, 640, v64
    v_mov_b32 v67, 2146435072
    s_nop 0
    v_cndmask_b32 v65, v67, v65, vcc
    buffer_load_dwordx4 v[68:71], v65, s[20:23], 0 offen
    v_lshlrev_b32 v64, 4, v64
    s_waitcnt vmcnt(0)
    s_and_saveexec_b64 s[30:31], vcc
    ds_write_b128 v64, v[68:71]
    s_mov_b64 exec, s[30:31]
    s_lshl_b32 s24, s3, 6
    s_add_u32 s24, s24, 512
    v_add_u32 v64, s24, v1
    v_and_b32 v65, 7, v64
    v_mul_u32_u24 v65, 1280, v65
    v_lshrrev_b32 v66, 3, v64
    v_lshl_add_u32 v65, v66, 4, v65
    v_cmp_gt_u32 vcc, 640, v64
    v_mov_b32 v67, 2146435072
    s_nop 0
    v_cndmask_b32 v65, v67, v65, vcc
    buffer_load_dwordx4 v[68:71], v65, s[20:23], 0 offen
    v_lshlrev_b32 v64, 4, v64
    s_waitcnt vmcnt(0)
    s_and_saveexec_b64 s[30:31], vcc
    ds_write_b128 v64, v[68:71]
    s_mov_b64 exec, s[30:31]
    s_mov_b32 s40, 0
    s_add_u32 s43, s93, 0
    s_add_u32 s47, s93, -28672
    s_add_u32 s45, s93, -18432
    s_lshl_b32 s95, s92, 6
    s_add_u32 s95, s95, s40
    s_add_u32 s95, s95, 1
    s_cmp_ge_i32 s59, s95
    s_cbranch_scc1 interleave_layers__linear_attn_block__memory_aug_recurrent_mem_tr__prompt_kernel_v_ec0_ok
    s_and_b32 s24, s2, 7
    s_lshl_b32 s24, s24, 7
    s_add_u32 s24, s24, 23109632
    v_and_b32 v65, 3, v1
    v_lshl_add_u32 v65, v65, 2, s24
    s_mov_b32 s61, 0
interleave_layers__linear_attn_block__memory_aug_recurrent_mem_tr__prompt_kernel_v_ec0:
    buffer_load_dword v64, v65, s[8:11], 0 offen sc1
    s_waitcnt vmcnt(0)
    v_readlane_b32 s59, v64, 0
    v_readlane_b32 s24, v64, 1
    s_min_i32 s59, s59, s24
    v_readlane_b32 s24, v64, 2
    s_min_i32 s59, s59, s24
    s_cmp_ge_i32 s59, s95
    s_cbranch_scc1 interleave_layers__linear_attn_block__memory_aug_recurrent_mem_tr__prompt_kernel_v_ec0_ok
    s_add_u32 s61, s61, 1
    s_cmp_ge_u32 s61, s60
    s_cbranch_scc1 interleave_layers__linear_attn_block__memory_aug_recurrent_mem_tr__prompt_kernel_v_ec0_to
    s_sleep 2
    s_branch interleave_layers__linear_attn_block__memory_aug_recurrent_mem_tr__prompt_kernel_v_ec0
interleave_layers__linear_attn_block__memory_aug_recurrent_mem_tr__prompt_kernel_v_ec0_to:
    s_mov_b32 s60, 1
interleave_layers__linear_attn_block__memory_aug_recurrent_mem_tr__prompt_kernel_v_ec0_ok:
    v_mov_b32 v16, 0
    v_mov_b32 v17, 0
    v_mov_b32 v18, 0
    v_mov_b32 v19, 0
    v_mov_b32 v20, 0
    v_mov_b32 v21, 0
    v_mov_b32 v22, 0
    v_mov_b32 v23, 0
    v_mov_b32 v24, 0
    v_mov_b32 v25, 0
    v_mov_b32 v26, 0
    v_mov_b32 v27, 0
    v_mov_b32 v28, 0
    v_mov_b32 v29, 0
    v_mov_b32 v30, 0
    v_mov_b32 v31, 0
    v_mov_b32 v32, 0
    v_mov_b32 v33, 0
    v_mov_b32 v34, 0
    v_mov_b32 v35, 0
    v_mov_b32 v36, 0
    v_mov_b32 v37, 0
    v_mov_b32 v38, 0
    v_mov_b32 v39, 0
    v_mov_b32 v40, 0
    v_mov_b32 v41, 0
    v_mov_b32 v42, 0
    v_mov_b32 v43, 0
    v_mov_b32 v44, 0
    v_mov_b32 v45, 0
    v_mov_b32 v46, 0
    v_mov_b32 v47, 0
    v_mov_b32 v48, 0
    v_mov_b32 v49, 0
    v_mov_b32 v50, 0
    v_mov_b32 v51, 0
    v_mov_b32 v52, 0
    v_mov_b32 v53, 0
    v_mov_b32 v54, 0
    v_mov_b32 v55, 0
    v_mov_b32 v56, 0
    v_mov_b32 v57, 0
    v_mov_b32 v58, 0
    v_mov_b32 v59, 0
    v_mov_b32 v60, 0
    v_mov_b32 v61, 0
    v_mov_b32 v62, 0
    v_mov_b32 v63, 0
    v_mov_b32 v64, 0
    v_mov_b32 v65, 0
    v_mov_b32 v66, 0
    v_mov_b32 v67, 0
    s_waitcnt lgkmcnt(0)
    s_barrier
    ds_read_b128 v[68:71], v7
    ds_read_b128 v[72:75], v7 offset:4096
    s_waitcnt lgkmcnt(0)
    s_cmp_eq_u32 s3, 0
    s_cbranch_scc1 interleave_layers__linear_attn_block__memory_aug_recurrent_mem_tr__prompt_kernel_v_gow0
    s_cmp_eq_u32 s3, 1
    s_cbranch_scc1 interleave_layers__linear_attn_block__memory_aug_recurrent_mem_tr__prompt_kernel_v_gow1
    s_cmp_eq_u32 s3, 2
    s_cbranch_scc1 interleave_layers__linear_attn_block__memory_aug_recurrent_mem_tr__prompt_kernel_v_gow2
    s_branch interleave_layers__linear_attn_block__memory_aug_recurrent_mem_tr__prompt_kernel_v_gow3
interleave_layers__linear_attn_block__memory_aug_recurrent_mem_tr__prompt_kernel_v_stepw0:
    v_mov_b32 v16, 0
    v_mov_b32 v17, 0
    v_mov_b32 v18, 0
    v_mov_b32 v19, 0
    v_mov_b32 v20, 0
    v_mov_b32 v21, 0
    v_mov_b32 v22, 0
    v_mov_b32 v23, 0
    v_mov_b32 v24, 0
    v_mov_b32 v25, 0
    v_mov_b32 v26, 0
    v_mov_b32 v27, 0
    v_mov_b32 v28, 0
    v_mov_b32 v29, 0
    v_mov_b32 v30, 0
    v_mov_b32 v31, 0
    v_mov_b32 v32, 0
    v_mov_b32 v33, 0
    v_mov_b32 v34, 0
    v_mov_b32 v35, 0
    v_mov_b32 v36, 0
    v_mov_b32 v37, 0
    v_mov_b32 v38, 0
    v_mov_b32 v39, 0
    v_mov_b32 v40, 0
    v_mov_b32 v41, 0
    v_mov_b32 v42, 0
    v_mov_b32 v43, 0
    v_mov_b32 v44, 0
    v_mov_b32 v45, 0
    v_mov_b32 v46, 0
    v_mov_b32 v47, 0
    v_mov_b32 v48, 0
    v_mov_b32 v49, 0
    v_mov_b32 v50, 0
    v_mov_b32 v51, 0
    v_mov_b32 v52, 0
    v_mov_b32 v53, 0
    v_mov_b32 v54, 0
    v_mov_b32 v55, 0
    v_mov_b32 v56, 0
    v_mov_b32 v57, 0
    v_mov_b32 v58, 0
    v_mov_b32 v59, 0
    v_mov_b32 v60, 0
    v_mov_b32 v61, 0
    v_mov_b32 v62, 0
    v_mov_b32 v63, 0
    v_mov_b32 v64, 0
    v_mov_b32 v65, 0
    v_mov_b32 v66, 0
    v_mov_b32 v67, 0
    s_add_u32 s48, s47, 4096
    s_lshl_b32 s95, s92, 6
    s_add_u32 s95, s95, s40
    s_add_u32 s95, s95, 1
    s_cmp_ge_i32 s59, s95
    s_cbranch_scc1 interleave_layers__linear_attn_block__memory_aug_recurrent_mem_tr__prompt_kernel_v_ecw0_ok
    s_and_b32 s24, s2, 7
    s_lshl_b32 s24, s24, 7
    s_add_u32 s24, s24, 23109632
    v_and_b32 v79, 3, v1
    v_lshl_add_u32 v79, v79, 2, s24
    s_mov_b32 s61, 0
interleave_layers__linear_attn_block__memory_aug_recurrent_mem_tr__prompt_kernel_v_ecw0:
    buffer_load_dword v78, v79, s[8:11], 0 offen sc1
    s_waitcnt vmcnt(0)
    v_readlane_b32 s59, v78, 0
    v_readlane_b32 s24, v78, 1
    s_min_i32 s59, s59, s24
    v_readlane_b32 s24, v78, 2
    s_min_i32 s59, s59, s24
    s_cmp_ge_i32 s59, s95
    s_cbranch_scc1 interleave_layers__linear_attn_block__memory_aug_recurrent_mem_tr__prompt_kernel_v_ecw0_ok
    s_add_u32 s61, s61, 1
    s_cmp_ge_u32 s61, s60
    s_cbranch_scc1 interleave_layers__linear_attn_block__memory_aug_recurrent_mem_tr__prompt_kernel_v_ecw0_to
    s_sleep 2
    s_branch interleave_layers__linear_attn_block__memory_aug_recurrent_mem_tr__prompt_kernel_v_ecw0
interleave_layers__linear_attn_block__memory_aug_recurrent_mem_tr__prompt_kernel_v_ecw0_to:
    s_mov_b32 s60, 1
interleave_layers__linear_attn_block__memory_aug_recurrent_mem_tr__prompt_kernel_v_ecw0_ok:
    s_sleep 20
    s_mov_b64 exec, 1
    s_mov_b32 s61, 0
    v_mov_b32 v81, 0
    buffer_atomic_add v81, v12, s[8:11], s45 offen sc0
    s_sleep 3
    v_mov_b32 v82, 0
    buffer_atomic_add v82, v12, s[8:11], s45 offen sc0
    s_sleep 3
    v_mov_b32 v83, 0
    buffer_atomic_add v83, v12, s[8:11], s45 offen sc0
    s_sleep 3
interleave_layers__linear_attn_block__memory_aug_recurrent_mem_tr__prompt_kernel_v_prw0:
    v_mov_b32 v80, 0
    buffer_atomic_add v80, v12, s[8:11], s45 offen sc0
    s_waitcnt vmcnt(3)
    v_cmp_le_i32 vcc, 8, v81
    s_add_u32 s61, s61, 1
    s_cbranch_vccnz interleave_layers__linear_attn_block__memory_aug_recurrent_mem_tr__prompt_kernel_v_prw0_out
    s_sleep 3
    v_mov_b32 v81, 0
    buffer_atomic_add v81, v12, s[8:11], s45 offen sc0
    s_waitcnt vmcnt(3)
    v_cmp_le_i32 vcc, 8, v82
    s_add_u32 s61, s61, 1
    s_cbranch_vccnz interleave_layers__linear_attn_block__memory_aug_recurrent_mem_tr__prompt_kernel_v_prw0_out
    s_sleep 3
    v_mov_b32 v82, 0
    buffer_atomic_add v82, v12, s[8:11], s45 offen sc0
    s_waitcnt vmcnt(3)
    v_cmp_le_i32 vcc, 8, v83
    s_add_u32 s61, s61, 1
    s_cbranch_vccnz interleave_layers__linear_attn_block__memory_aug_recurrent_mem_tr__prompt_kernel_v_prw0_out
    s_sleep 3
    v_mov_b32 v83, 0
    buffer_atomic_add v83, v12, s[8:11], s45 offen sc0
    s_waitcnt vmcnt(3)
    v_cmp_le_i32 vcc, 8, v80
    s_add_u32 s61, s61, 1
    s_cbranch_vccnz interleave_layers__linear_attn_block__memory_aug_recurrent_mem_tr__prompt_kernel_v_prw0_out
    s_sleep 3
    s_cmp_ge_u32 s61, s60
    s_cbranch_scc0 interleave_layers__linear_attn_block__memory_aug_recurrent_mem_tr__prompt_kernel_v_prw0
    s_mov_b32 s60, 1
interleave_layers__linear_attn_block__memory_aug_recurrent_mem_tr__prompt_kernel_v_prw0_out:
    s_mov_b64 exec, -1
    buffer_load_dwordx4 v[68:71], v7, s[8:11], s47 offen sc1
    buffer_load_dwordx4 v[72:75], v7, s[8:11], s48 offen sc1
    buffer_load_dwordx2 v[76:77], v8, s[8:11], s47 offen sc1
    s_waitcnt vmcnt(0)
    v_max3_u32 v103, v68, v69, v70
    v_max3_u32 v103, v103, v71, v72
    v_max3_u32 v103, v103, v73, v74
    v_max3_u32 v103, v103, v75, v76
    v_max_u32 v103, v103, v77
    v_cmp_eq_u32 vcc, -1, v103
    s_cbranch_vccz interleave_layers__linear_attn_block__memory_aug_recurrent_mem_tr__prompt_kernel_v_pmw0_out
    s_mov_b32 s61, 0
interleave_layers__linear_attn_block__memory_aug_recurrent_mem_tr__prompt_kernel_v_pmw0:
    buffer_load_dwordx4 v[68:71], v7, s[8:11], s47 offen sc1
    buffer_load_dwordx4 v[72:75], v7, s[8:11], s48 offen sc1
    buffer_load_dwordx2 v[76:77], v8, s[8:11], s47 offen sc1
    s_waitcnt vmcnt(0)
    v_max3_u32 v103, v68, v69, v70
    v_max3_u32 v103, v103, v71, v72
    v_max3_u32 v103, v103, v73, v74
    v_max3_u32 v103, v103, v75, v76
    v_max_u32 v103, v103, v77
    v_cmp_eq_u32 vcc, -1, v103
    s_add_u32 s61, s61, 1
    s_cbranch_vccz interleave_layers__linear_attn_block__memory_aug_recurrent_mem_tr__prompt_kernel_v_pmw0_out
    s_cmp_ge_u32 s61, s60
    s_cbranch_scc1 interleave_layers__linear_attn_block__memory_aug_recurrent_mem_tr__prompt_kernel_v_pmw0_to
    s_sleep 1
    s_branch interleave_layers__linear_attn_block__memory_aug_recurrent_mem_tr__prompt_kernel_v_pmw0
interleave_layers__linear_attn_block__memory_aug_recurrent_mem_tr__prompt_kernel_v_pmw0_to:
    s_mov_b32 s60, 1
interleave_layers__linear_attn_block__memory_aug_recurrent_mem_tr__prompt_kernel_v_pmw0_out:
    ds_write_b128 v7, v[68:71]
    ds_write_b128 v7, v[72:75] offset:4096
    ds_write_b64 v8, v[76:77]
interleave_layers__linear_attn_block__memory_aug_recurrent_mem_tr__prompt_kernel_v_gow0:
    v_smfmac_f32_16x16x64_bf16 v[56:59], v[68:71], a[0:7], v4
    v_smfmac_f32_16x16x64_bf16 v[60:63], v[68:71], a[80:87], v4
    v_smfmac_f32_16x16x64_bf16 v[64:67], v[68:71], a[160:167], v4
    s_waitcnt lgkmcnt(0)
    s_barrier
    ds_read_b128 v[80:83], v5 offset:1024
    ds_read_b128 v[84:87], v5 offset:2048
    ds_read_b128 v[88:91], v5 offset:3072
    ds_read_b128 v[92:95], v5 offset:5120
    ds_read_b128 v[96:99], v5 offset:6144
    ds_read_b128 v[100:103], v5 offset:7168
    ds_read_b128 v[76:79], v5 offset:8192
    ds_read_b128 v[68:71], v5 offset:9216
    v_smfmac_f32_16x16x64_bf16 v[64:67], v[72:75], a[192:199], v4
    v_smfmac_f32_16x16x64_bf16 v[56:59], v[72:75], a[32:39], v4
    v_smfmac_f32_16x16x64_bf16 v[60:63], v[72:75], a[112:119], v4
    s_waitcnt lgkmcnt(7)
    v_smfmac_f32_16x16x64_bf16 v[64:67], v[80:83], a[168:175], v4
    s_waitcnt lgkmcnt(6)
    v_smfmac_f32_16x16x64_bf16 v[64:67], v[84:87], a[176:183], v4
    s_waitcnt lgkmcnt(5)
    v_smfmac_f32_16x16x64_bf16 v[64:67], v[88:91], a[184:191], v4
    s_waitcnt lgkmcnt(4)
    v_smfmac_f32_16x16x64_bf16 v[64:67], v[92:95], a[200:207], v4
    s_waitcnt lgkmcnt(3)
    v_smfmac_f32_16x16x64_bf16 v[64:67], v[96:99], a[208:215], v4
    s_waitcnt lgkmcnt(2)
    v_smfmac_f32_16x16x64_bf16 v[64:67], v[100:103], a[216:223], v4
    s_waitcnt lgkmcnt(1)
    v_smfmac_f32_16x16x64_bf16 v[64:67], v[76:79], a[224:231], v4
    s_waitcnt lgkmcnt(0)
    v_smfmac_f32_16x16x64_bf16 v[64:67], v[68:71], a[232:239], v4
    v_smfmac_f32_16x16x64_bf16 v[56:59], v[80:83], a[8:15], v4
    v_smfmac_f32_16x16x64_bf16 v[60:63], v[80:83], a[88:95], v4
    v_smfmac_f32_16x16x64_bf16 v[56:59], v[84:87], a[16:23], v4
    s_nop 4
    v_mov_b32 v72, v64
    v_smfmac_f32_16x16x64_bf16 v[60:63], v[84:87], a[96:103], v4
    v_mov_b32 v73, v65
    v_mov_b32 v74, v66
    v_smfmac_f32_16x16x64_bf16 v[56:59], v[88:91], a[24:31], v4
    v_mov_b32 v75, v67
    v_smfmac_f32_16x16x64_bf16 v[60:63], v[88:91], a[104:111], v4
    v_permlane32_swap_b32 v64, v72
    v_permlane32_swap_b32 v65, v73
    v_smfmac_f32_16x16x64_bf16 v[56:59], v[92:95], a[40:47], v4
    v_permlane32_swap_b32 v66, v74
    v_permlane32_swap_b32 v67, v75
    v_smfmac_f32_16x16x64_bf16 v[60:63], v[92:95], a[120:127], v4
    v_add_f32 v64, v64, v72
    v_add_f32 v65, v65, v73
    v_smfmac_f32_16x16x64_bf16 v[56:59], v[96:99], a[48:55], v4
    v_add_f32 v66, v66, v74
    v_add_f32 v67, v67, v75
    v_smfmac_f32_16x16x64_bf16 v[60:63], v[96:99], a[128:135], v4
    v_cvt_pk_bf16_f32 v72, v64, v65
    v_cvt_pk_bf16_f32 v73, v66, v67
    v_smfmac_f32_16x16x64_bf16 v[56:59], v[100:103], a[56:63], v4
    ds_write_b64 v9, v[72:73] offset:512
    v_smfmac_f32_16x16x64_bf16 v[60:63], v[100:103], a[136:143], v4
    v_smfmac_f32_16x16x64_bf16 v[56:59], v[76:79], a[64:71], v4
    v_smfmac_f32_16x16x64_bf16 v[60:63], v[76:79], a[144:151], v4
    v_smfmac_f32_16x16x64_bf16 v[56:59], v[68:71], a[72:79], v4
    v_smfmac_f32_16x16x64_bf16 v[60:63], v[68:71], a[152:159], v4
    s_nop 7
    v_permlane32_swap_b32 v56, v60
    v_permlane32_swap_b32 v57, v61
    v_permlane32_swap_b32 v58, v62
    v_permlane32_swap_b32 v59, v63
    v_add_f32 v56, v56, v60
    v_add_f32 v57, v57, v61
    v_add_f32 v58, v58, v62
    v_add_f32 v59, v59, v63
    v_cvt_pk_bf16_f32 v68, v56, v57
    v_cvt_pk_bf16_f32 v69, v58, v59
    ds_write_b64 v10, v[68:69]
    s_waitcnt lgkmcnt(0)
    s_barrier
    ds_read_b64_tr_b16 v[68:69], v11 offset:0
    ds_read_b64_tr_b16 v[70:71], v11 offset:128
    ds_read_b64_tr_b16 v[72:73], v11 offset:1024
    ds_read_b64_tr_b16 v[74:75], v11 offset:1152
    ds_read_b64_tr_b16 v[76:77], v11 offset:2048
    ds_read_b64_tr_b16 v[78:79], v11 offset:2176
    ds_read_b128 v[80:83], v6 offset:0
    ds_read_b128 v[84:87], v6 offset:1024
    ds_read_b128 v[88:91], v6 offset:2048
    ds_read_b128 v[92:95], v6 offset:3072
    ds_read_b128 v[96:99], v6 offset:4096
    ds_read_b128 v[100:103], v6 offset:5120
    s_waitcnt lgkmcnt(10)
    v_smfmac_f32_16x16x64_bf16 v[16:19], v[68:71], a[240:247], v4
    v_smfmac_f32_16x16x64_bf16 v[20:23], v[68:71], v[112:119], v4
    v_smfmac_f32_16x16x64_bf16 v[24:27], v[68:71], v[136:143], v4
    v_smfmac_f32_16x16x64_bf16 v[28:31], v[68:71], v[160:167], v4
    s_waitcnt lgkmcnt(8)
    v_smfmac_f32_16x16x64_bf16 v[16:19], v[72:75], a[248:255], v4
    v_smfmac_f32_16x16x64_bf16 v[20:23], v[72:75], v[120:127], v4
    v_smfmac_f32_16x16x64_bf16 v[24:27], v[72:75], v[144:151], v4
    v_smfmac_f32_16x16x64_bf16 v[28:31], v[72:75], v[168:175], v4
    s_waitcnt lgkmcnt(6)
    v_smfmac_f32_16x16x64_bf16 v[16:19], v[76:79], v[104:111], v4
    v_smfmac_f32_16x16x64_bf16 v[20:23], v[76:79], v[128:135], v4
    v_smfmac_f32_16x16x64_bf16 v[24:27], v[76:79], v[152:159], v4
    v_smfmac_f32_16x16x64_bf16 v[28:31], v[76:79], v[176:183], v4
    v_smfmac_f32_16x16x64_bf16 v[32:35], v[68:71], v[184:191], v4
    v_smfmac_f32_16x16x64_bf16 v[36:39], v[68:71], v[208:215], v4
    s_nop 4
    v_permlane32_swap_b32 v16, v24
    v_permlane32_swap_b32 v17, v25
    v_smfmac_f32_16x16x64_bf16 v[40:43], v[68:71], v[232:239], v4
    v_permlane32_swap_b32 v18, v26
    v_permlane32_swap_b32 v19, v27
    s_waitcnt lgkmcnt(4)
    v_smfmac_f32_16x16x64_bf16 v[44:47], v[68:71], v[80:87], v4
    v_add_f32 v16, v16, v24
    v_add_f32 v17, v17, v25
    ds_read_b128 v[80:83], v6 offset:6144
    ds_read_b128 v[84:87], v6 offset:7168
    v_smfmac_f32_16x16x64_bf16 v[32:35], v[72:75], v[192:199], v4
    v_add_f32 v18, v18, v26
    v_add_f32 v19, v19, v27
    v_smfmac_f32_16x16x64_bf16 v[36:39], v[72:75], v[216:223], v4
    v_permlane32_swap_b32 v20, v28
    v_permlane32_swap_b32 v21, v29
    v_smfmac_f32_16x16x64_bf16 v[40:43], v[72:75], v[240:247], v4
    v_permlane32_swap_b32 v22, v30
    v_permlane32_swap_b32 v23, v31
    s_waitcnt lgkmcnt(4)
    v_smfmac_f32_16x16x64_bf16 v[44:47], v[72:75], v[88:95], v4
    v_add_f32 v20, v20, v28
    v_add_f32 v21, v21, v29
    ds_read_b128 v[88:91], v6 offset:8192
    ds_read_b128 v[92:95], v6 offset:9216
    v_smfmac_f32_16x16x64_bf16 v[32:35], v[76:79], v[200:207], v4
    v_add_f32 v22, v22, v30
    v_add_f32 v23, v23, v31
    v_smfmac_f32_16x16x64_bf16 v[36:39], v[76:79], v[224:231], v4
    v_cvt_pk_bf16_f32 v56, v16, v17
    v_cvt_pk_bf16_f32 v57, v18, v19
    v_smfmac_f32_16x16x64_bf16 v[40:43], v[76:79], v[248:255], v4
    v_cvt_pk_bf16_f32 v58, v20, v21
    v_cvt_pk_bf16_f32 v59, v22, v23
    s_waitcnt lgkmcnt(4)
    v_smfmac_f32_16x16x64_bf16 v[44:47], v[76:79], v[96:103], v4
    v_permlane16_swap_b32 v56, v58
    ds_read_b128 v[96:99], v6 offset:10240
    ds_read_b128 v[100:103], v6 offset:11264
    v_permlane16_swap_b32 v57, v59
    v_min_u32 v56, -2, v56
    v_min_u32 v57, -2, v57
    v_min_u32 v58, -2, v58
    v_min_u32 v59, -2, v59
    buffer_store_dwordx4 v[56:59], v14, s[8:11], s43 offen sc1
    s_add_u32 s49, s43, 32768
    s_waitcnt lgkmcnt(4)
    v_smfmac_f32_16x16x64_bf16 v[48:51], v[68:71], v[80:87], v4
    v_permlane32_swap_b32 v32, v40
    v_permlane32_swap_b32 v33, v41
    v_permlane32_swap_b32 v34, v42
    ds_read_b128 v[80:83], v6 offset:12288
    ds_read_b128 v[84:87], v6 offset:13312
    s_waitcnt lgkmcnt(4)
    v_smfmac_f32_16x16x64_bf16 v[48:51], v[72:75], v[88:95], v4
    v_permlane32_swap_b32 v35, v43
    v_add_f32 v32, v32, v40
    v_add_f32 v33, v33, v41
    v_add_f32 v34, v34, v42
    ds_read_b128 v[88:91], v6 offset:14336
    ds_read_b128 v[92:95], v6 offset:15360
    s_waitcnt lgkmcnt(4)
    v_smfmac_f32_16x16x64_bf16 v[48:51], v[76:79], v[96:103], v4
    v_add_f32 v35, v35, v43
    v_permlane32_swap_b32 v36, v44
    v_permlane32_swap_b32 v37, v45
    v_permlane32_swap_b32 v38, v46
    ds_read_b128 v[96:99], v6 offset:16384
    ds_read_b128 v[100:103], v6 offset:17408
    v_permlane32_swap_b32 v39, v47
    v_add_f32 v36, v36, v44
    v_add_f32 v37, v37, v45
    v_add_f32 v38, v38, v46
    s_waitcnt lgkmcnt(4)
    v_smfmac_f32_16x16x64_bf16 v[52:55], v[68:71], v[80:87], v4
    v_add_f32 v39, v39, v47
    v_cvt_pk_bf16_f32 v60, v32, v33
    v_cvt_pk_bf16_f32 v61, v34, v35
    s_waitcnt lgkmcnt(2)
    v_smfmac_f32_16x16x64_bf16 v[52:55], v[72:75], v[88:95], v4
    v_cvt_pk_bf16_f32 v62, v36, v37
    v_cvt_pk_bf16_f32 v63, v38, v39
    s_waitcnt lgkmcnt(0)
    v_smfmac_f32_16x16x64_bf16 v[52:55], v[76:79], v[96:103], v4
    v_permlane16_swap_b32 v60, v62
    v_permlane16_swap_b32 v61, v63
    v_min_u32 v60, -2, v60
    v_min_u32 v61, -2, v61
    v_min_u32 v62, -2, v62
    v_min_u32 v63, -2, v63
    buffer_store_dwordx4 v[60:63], v14, s[8:11], s49 offen sc1
    s_nop 0
    v_permlane32_swap_b32 v48, v52
    v_permlane32_swap_b32 v49, v53
    v_permlane32_swap_b32 v50, v54
    v_permlane32_swap_b32 v51, v55
    v_add_f32 v48, v48, v52
    v_add_f32 v49, v49, v53
    v_add_f32 v50, v50, v54
    v_add_f32 v51, v51, v55
    v_cvt_pk_bf16_f32 v64, v48, v49
    v_cvt_pk_bf16_f32 v65, v50, v51
    v_mov_b32 v66, v64
    v_mov_b32 v67, v65
    s_nop 0
    v_permlane16_swap_b32 v64, v66
    v_permlane16_swap_b32 v65, v67
    v_min_u32 v64, -2, v64
    v_min_u32 v65, -2, v65
    v_min_u32 v66, -2, v66
    v_min_u32 v67, -2, v67
    buffer_store_dwordx4 v[64:67], v15, s[8:11], s43 offen sc1
    s_add_u32 s40, s40, 1
    s_add_u32 s43, s43, 458752
    s_add_u32 s47, s47, 458752
    s_add_u32 s45, s45, 458752
    s_cmp_lt_u32 s40, 64
    s_cbranch_scc1 interleave_layers__linear_attn_block__memory_aug_recurrent_mem_tr__prompt_kernel_v_stepw0
    s_branch interleave_layers__linear_attn_block__memory_aug_recurrent_mem_tr__prompt_kernel_v_end
interleave_layers__linear_attn_block__memory_aug_recurrent_mem_tr__prompt_kernel_v_stepw1:
    v_mov_b32 v16, 0
    v_mov_b32 v17, 0
    v_mov_b32 v18, 0
    v_mov_b32 v19, 0
    v_mov_b32 v20, 0
    v_mov_b32 v21, 0
    v_mov_b32 v22, 0
    v_mov_b32 v23, 0
    v_mov_b32 v24, 0
    v_mov_b32 v25, 0
    v_mov_b32 v26, 0
    v_mov_b32 v27, 0
    v_mov_b32 v28, 0
    v_mov_b32 v29, 0
    v_mov_b32 v30, 0
    v_mov_b32 v31, 0
    v_mov_b32 v32, 0
    v_mov_b32 v33, 0
    v_mov_b32 v34, 0
    v_mov_b32 v35, 0
    v_mov_b32 v36, 0
    v_mov_b32 v37, 0
    v_mov_b32 v38, 0
    v_mov_b32 v39, 0
    v_mov_b32 v40, 0
    v_mov_b32 v41, 0
    v_mov_b32 v42, 0
    v_mov_b32 v43, 0
    v_mov_b32 v44, 0
    v_mov_b32 v45, 0
    v_mov_b32 v46, 0
    v_mov_b32 v47, 0
    v_mov_b32 v48, 0
    v_mov_b32 v49, 0
    v_mov_b32 v50, 0
    v_mov_b32 v51, 0
    v_mov_b32 v52, 0
    v_mov_b32 v53, 0
    v_mov_b32 v54, 0
    v_mov_b32 v55, 0
    v_mov_b32 v56, 0
    v_mov_b32 v57, 0
    v_mov_b32 v58, 0
    v_mov_b32 v59, 0
    v_mov_b32 v60, 0
    v_mov_b32 v61, 0
    v_mov_b32 v62, 0
    v_mov_b32 v63, 0
    v_mov_b32 v64, 0
    v_mov_b32 v65, 0
    v_mov_b32 v66, 0
    v_mov_b32 v67, 0
    s_add_u32 s48, s47, 4096
    s_lshl_b32 s95, s92, 6
    s_add_u32 s95, s95, s40
    s_add_u32 s95, s95, 1
    s_cmp_ge_i32 s59, s95
    s_cbranch_scc1 interleave_layers__linear_attn_block__memory_aug_recurrent_mem_tr__prompt_kernel_v_ecw1_ok
    s_and_b32 s24, s2, 7
    s_lshl_b32 s24, s24, 7
    s_add_u32 s24, s24, 23109632
    v_and_b32 v79, 3, v1
    v_lshl_add_u32 v79, v79, 2, s24
    s_mov_b32 s61, 0
interleave_layers__linear_attn_block__memory_aug_recurrent_mem_tr__prompt_kernel_v_ecw1:
    buffer_load_dword v78, v79, s[8:11], 0 offen sc1
    s_waitcnt vmcnt(0)
    v_readlane_b32 s59, v78, 0
    v_readlane_b32 s24, v78, 1
    s_min_i32 s59, s59, s24
    v_readlane_b32 s24, v78, 2
    s_min_i32 s59, s59, s24
    s_cmp_ge_i32 s59, s95
    s_cbranch_scc1 interleave_layers__linear_attn_block__memory_aug_recurrent_mem_tr__prompt_kernel_v_ecw1_ok
    s_add_u32 s61, s61, 1
    s_cmp_ge_u32 s61, s60
    s_cbranch_scc1 interleave_layers__linear_attn_block__memory_aug_recurrent_mem_tr__prompt_kernel_v_ecw1_to
    s_sleep 2
    s_branch interleave_layers__linear_attn_block__memory_aug_recurrent_mem_tr__prompt_kernel_v_ecw1
interleave_layers__linear_attn_block__memory_aug_recurrent_mem_tr__prompt_kernel_v_ecw1_to:
    s_mov_b32 s60, 1
interleave_layers__linear_attn_block__memory_aug_recurrent_mem_tr__prompt_kernel_v_ecw1_ok:
    s_sleep 20
    s_mov_b64 exec, 1
    s_mov_b32 s61, 0
    v_mov_b32 v81, 0
    buffer_atomic_add v81, v12, s[8:11], s45 offen sc0
    s_sleep 3
    v_mov_b32 v82, 0
    buffer_atomic_add v82, v12, s[8:11], s45 offen sc0
    s_sleep 3
    v_mov_b32 v83, 0
    buffer_atomic_add v83, v12, s[8:11], s45 offen sc0
    s_sleep 3
interleave_layers__linear_attn_block__memory_aug_recurrent_mem_tr__prompt_kernel_v_prw1:
    v_mov_b32 v80, 0
    buffer_atomic_add v80, v12, s[8:11], s45 offen sc0
    s_waitcnt vmcnt(3)
    v_cmp_le_i32 vcc, 8, v81
    s_add_u32 s61, s61, 1
    s_cbranch_vccnz interleave_layers__linear_attn_block__memory_aug_recurrent_mem_tr__prompt_kernel_v_prw1_out
    s_sleep 3
    v_mov_b32 v81, 0
    buffer_atomic_add v81, v12, s[8:11], s45 offen sc0
    s_waitcnt vmcnt(3)
    v_cmp_le_i32 vcc, 8, v82
    s_add_u32 s61, s61, 1
    s_cbranch_vccnz interleave_layers__linear_attn_block__memory_aug_recurrent_mem_tr__prompt_kernel_v_prw1_out
    s_sleep 3
    v_mov_b32 v82, 0
    buffer_atomic_add v82, v12, s[8:11], s45 offen sc0
    s_waitcnt vmcnt(3)
    v_cmp_le_i32 vcc, 8, v83
    s_add_u32 s61, s61, 1
    s_cbranch_vccnz interleave_layers__linear_attn_block__memory_aug_recurrent_mem_tr__prompt_kernel_v_prw1_out
    s_sleep 3
    v_mov_b32 v83, 0
    buffer_atomic_add v83, v12, s[8:11], s45 offen sc0
    s_waitcnt vmcnt(3)
    v_cmp_le_i32 vcc, 8, v80
    s_add_u32 s61, s61, 1
    s_cbranch_vccnz interleave_layers__linear_attn_block__memory_aug_recurrent_mem_tr__prompt_kernel_v_prw1_out
    s_sleep 3
    s_cmp_ge_u32 s61, s60
    s_cbranch_scc0 interleave_layers__linear_attn_block__memory_aug_recurrent_mem_tr__prompt_kernel_v_prw1
    s_mov_b32 s60, 1
interleave_layers__linear_attn_block__memory_aug_recurrent_mem_tr__prompt_kernel_v_prw1_out:
    s_mov_b64 exec, -1
    buffer_load_dwordx4 v[68:71], v7, s[8:11], s47 offen sc1
    buffer_load_dwordx4 v[72:75], v7, s[8:11], s48 offen sc1
    buffer_load_dwordx2 v[76:77], v8, s[8:11], s47 offen sc1
    s_waitcnt vmcnt(0)
    v_max3_u32 v103, v68, v69, v70
    v_max3_u32 v103, v103, v71, v72
    v_max3_u32 v103, v103, v73, v74
    v_max3_u32 v103, v103, v75, v76
    v_max_u32 v103, v103, v77
    v_cmp_eq_u32 vcc, -1, v103
    s_cbranch_vccz interleave_layers__linear_attn_block__memory_aug_recurrent_mem_tr__prompt_kernel_v_pmw1_out
    s_mov_b32 s61, 0
interleave_layers__linear_attn_block__memory_aug_recurrent_mem_tr__prompt_kernel_v_pmw1:
    buffer_load_dwordx4 v[68:71], v7, s[8:11], s47 offen sc1
    buffer_load_dwordx4 v[72:75], v7, s[8:11], s48 offen sc1
    buffer_load_dwordx2 v[76:77], v8, s[8:11], s47 offen sc1
    s_waitcnt vmcnt(0)
    v_max3_u32 v103, v68, v69, v70
    v_max3_u32 v103, v103, v71, v72
    v_max3_u32 v103, v103, v73, v74
    v_max3_u32 v103, v103, v75, v76
    v_max_u32 v103, v103, v77
    v_cmp_eq_u32 vcc, -1, v103
    s_add_u32 s61, s61, 1
    s_cbranch_vccz interleave_layers__linear_attn_block__memory_aug_recurrent_mem_tr__prompt_kernel_v_pmw1_out
    s_cmp_ge_u32 s61, s60
    s_cbranch_scc1 interleave_layers__linear_attn_block__memory_aug_recurrent_mem_tr__prompt_kernel_v_pmw1_to
    s_sleep 1
    s_branch interleave_layers__linear_attn_block__memory_aug_recurrent_mem_tr__prompt_kernel_v_pmw1
interleave_layers__linear_attn_block__memory_aug_recurrent_mem_tr__prompt_kernel_v_pmw1_to:
    s_mov_b32 s60, 1
interleave_layers__linear_attn_block__memory_aug_recurrent_mem_tr__prompt_kernel_v_pmw1_out:
    ds_write_b128 v7, v[68:71]
    ds_write_b128 v7, v[72:75] offset:4096
    ds_write_b64 v8, v[76:77]
interleave_layers__linear_attn_block__memory_aug_recurrent_mem_tr__prompt_kernel_v_gow1:
    v_smfmac_f32_16x16x64_bf16 v[56:59], v[68:71], a[8:15], v4
    v_smfmac_f32_16x16x64_bf16 v[60:63], v[68:71], a[88:95], v4
    v_smfmac_f32_16x16x64_bf16 v[64:67], v[68:71], a[168:175], v4
    s_waitcnt lgkmcnt(0)
    s_barrier
    ds_read_b128 v[80:83], v5 offset:0
    ds_read_b128 v[84:87], v5 offset:2048
    ds_read_b128 v[88:91], v5 offset:3072
    ds_read_b128 v[92:95], v5 offset:4096
    ds_read_b128 v[96:99], v5 offset:6144
    ds_read_b128 v[100:103], v5 offset:7168
    ds_read_b128 v[76:79], v5 offset:8192
    ds_read_b128 v[68:71], v5 offset:9216
    v_smfmac_f32_16x16x64_bf16 v[64:67], v[72:75], a[200:207], v4
    v_smfmac_f32_16x16x64_bf16 v[56:59], v[72:75], a[40:47], v4
    v_smfmac_f32_16x16x64_bf16 v[60:63], v[72:75], a[120:127], v4
    s_waitcnt lgkmcnt(7)
    v_smfmac_f32_16x16x64_bf16 v[64:67], v[80:83], a[160:167], v4
    s_waitcnt lgkmcnt(6)
    v_smfmac_f32_16x16x64_bf16 v[64:67], v[84:87], a[176:183], v4
    s_waitcnt lgkmcnt(5)
    v_smfmac_f32_16x16x64_bf16 v[64:67], v[88:91], a[184:191], v4
    s_waitcnt lgkmcnt(4)
    v_smfmac_f32_16x16x64_bf16 v[64:67], v[92:95], a[192:199], v4
    s_waitcnt lgkmcnt(3)
    v_smfmac_f32_16x16x64_bf16 v[64:67], v[96:99], a[208:215], v4
    s_waitcnt lgkmcnt(2)
    v_smfmac_f32_16x16x64_bf16 v[64:67], v[100:103], a[216:223], v4
    s_waitcnt lgkmcnt(1)
    v_smfmac_f32_16x16x64_bf16 v[64:67], v[76:79], a[224:231], v4
    s_waitcnt lgkmcnt(0)
    v_smfmac_f32_16x16x64_bf16 v[64:67], v[68:71], a[232:239], v4
    v_smfmac_f32_16x16x64_bf16 v[56:59], v[80:83], a[0:7], v4
    v_smfmac_f32_16x16x64_bf16 v[60:63], v[80:83], a[80:87], v4
    v_smfmac_f32_16x16x64_bf16 v[56:59], v[84:87], a[16:23], v4
    s_nop 4
    v_mov_b32 v72, v64
    v_smfmac_f32_16x16x64_bf16 v[60:63], v[84:87], a[96:103], v4
    v_mov_b32 v73, v65
    v_mov_b32 v74, v66
    v_smfmac_f32_16x16x64_bf16 v[56:59], v[88:91], a[24:31], v4
    v_mov_b32 v75, v67
    v_smfmac_f32_16x16x64_bf16 v[60:63], v[88:91], a[104:111], v4
    v_permlane32_swap_b32 v64, v72
    v_permlane32_swap_b32 v65, v73
    v_smfmac_f32_16x16x64_bf16 v[56:59], v[92:95], a[32:39], v4
    v_permlane32_swap_b32 v66, v74
    v_permlane32_swap_b32 v67, v75
    v_smfmac_f32_16x16x64_bf16 v[60:63], v[92:95], a[112:119], v4
    v_add_f32 v64, v64, v72
    v_add_f32 v65, v65, v73
    v_smfmac_f32_16x16x64_bf16 v[56:59], v[96:99], a[48:55], v4
    v_add_f32 v66, v66, v74
    v_add_f32 v67, v67, v75
    v_smfmac_f32_16x16x64_bf16 v[60:63], v[96:99], a[128:135], v4
    v_cvt_pk_bf16_f32 v72, v64, v65
    v_cvt_pk_bf16_f32 v73, v66, v67
    v_smfmac_f32_16x16x64_bf16 v[56:59], v[100:103], a[56:63], v4
    ds_write_b64 v9, v[72:73] offset:512
    v_smfmac_f32_16x16x64_bf16 v[60:63], v[100:103], a[136:143], v4
    v_smfmac_f32_16x16x64_bf16 v[56:59], v[76:79], a[64:71], v4
    v_smfmac_f32_16x16x64_bf16 v[60:63], v[76:79], a[144:151], v4
    v_smfmac_f32_16x16x64_bf16 v[56:59], v[68:71], a[72:79], v4
    v_smfmac_f32_16x16x64_bf16 v[60:63], v[68:71], a[152:159], v4
    s_nop 7
    v_permlane32_swap_b32 v56, v60
    v_permlane32_swap_b32 v57, v61
    v_permlane32_swap_b32 v58, v62
    v_permlane32_swap_b32 v59, v63
    v_add_f32 v56, v56, v60
    v_add_f32 v57, v57, v61
    v_add_f32 v58, v58, v62
    v_add_f32 v59, v59, v63
    v_cvt_pk_bf16_f32 v68, v56, v57
    v_cvt_pk_bf16_f32 v69, v58, v59
    ds_write_b64 v10, v[68:69]
    s_waitcnt lgkmcnt(0)
    s_barrier
    ds_read_b64_tr_b16 v[68:69], v11 offset:0
    ds_read_b64_tr_b16 v[70:71], v11 offset:128
    ds_read_b64_tr_b16 v[72:73], v11 offset:1024
    ds_read_b64_tr_b16 v[74:75], v11 offset:1152
    ds_read_b64_tr_b16 v[76:77], v11 offset:2048
    ds_read_b64_tr_b16 v[78:79], v11 offset:2176
    ds_read_b128 v[80:83], v6 offset:0
    ds_read_b128 v[84:87], v6 offset:1024
    ds_read_b128 v[88:91], v6 offset:2048
    ds_read_b128 v[92:95], v6 offset:3072
    ds_read_b128 v[96:99], v6 offset:4096
    ds_read_b128 v[100:103], v6 offset:5120
    s_waitcnt lgkmcnt(10)
    v_smfmac_f32_16x16x64_bf16 v[16:19], v[68:71], a[240:247], v4
    v_smfmac_f32_16x16x64_bf16 v[20:23], v[68:71], v[112:119], v4
    v_smfmac_f32_16x16x64_bf16 v[24:27], v[68:71], v[136:143], v4
    v_smfmac_f32_16x16x64_bf16 v[28:31], v[68:71], v[160:167], v4
    s_waitcnt lgkmcnt(8)
    v_smfmac_f32_16x16x64_bf16 v[16:19], v[72:75], a[248:255], v4
    v_smfmac_f32_16x16x64_bf16 v[20:23], v[72:75], v[120:127], v4
    v_smfmac_f32_16x16x64_bf16 v[24:27], v[72:75], v[144:151], v4
    v_smfmac_f32_16x16x64_bf16 v[28:31], v[72:75], v[168:175], v4
    s_waitcnt lgkmcnt(6)
    v_smfmac_f32_16x16x64_bf16 v[16:19], v[76:79], v[104:111], v4
    v_smfmac_f32_16x16x64_bf16 v[20:23], v[76:79], v[128:135], v4
    v_smfmac_f32_16x16x64_bf16 v[24:27], v[76:79], v[152:159], v4
    v_smfmac_f32_16x16x64_bf16 v[28:31], v[76:79], v[176:183], v4
    v_smfmac_f32_16x16x64_bf16 v[32:35], v[68:71], v[184:191], v4
    v_smfmac_f32_16x16x64_bf16 v[36:39], v[68:71], v[208:215], v4
    s_nop 4
    v_permlane32_swap_b32 v16, v24
    v_permlane32_swap_b32 v17, v25
    v_smfmac_f32_16x16x64_bf16 v[40:43], v[68:71], v[232:239], v4
    v_permlane32_swap_b32 v18, v26
    v_permlane32_swap_b32 v19, v27
    s_waitcnt lgkmcnt(4)
    v_smfmac_f32_16x16x64_bf16 v[44:47], v[68:71], v[80:87], v4
    v_add_f32 v16, v16, v24
    v_add_f32 v17, v17, v25
    ds_read_b128 v[80:83], v6 offset:6144
    ds_read_b128 v[84:87], v6 offset:7168
    v_smfmac_f32_16x16x64_bf16 v[32:35], v[72:75], v[192:199], v4
    v_add_f32 v18, v18, v26
    v_add_f32 v19, v19, v27
    v_smfmac_f32_16x16x64_bf16 v[36:39], v[72:75], v[216:223], v4
    v_permlane32_swap_b32 v20, v28
    v_permlane32_swap_b32 v21, v29
    v_smfmac_f32_16x16x64_bf16 v[40:43], v[72:75], v[240:247], v4
    v_permlane32_swap_b32 v22, v30
    v_permlane32_swap_b32 v23, v31
    s_waitcnt lgkmcnt(4)
    v_smfmac_f32_16x16x64_bf16 v[44:47], v[72:75], v[88:95], v4
    v_add_f32 v20, v20, v28
    v_add_f32 v21, v21, v29
    ds_read_b128 v[88:91], v6 offset:8192
    ds_read_b128 v[92:95], v6 offset:9216
    v_smfmac_f32_16x16x64_bf16 v[32:35], v[76:79], v[200:207], v4
    v_add_f32 v22, v22, v30
    v_add_f32 v23, v23, v31
    v_smfmac_f32_16x16x64_bf16 v[36:39], v[76:79], v[224:231], v4
    v_cvt_pk_bf16_f32 v56, v16, v17
    v_cvt_pk_bf16_f32 v57, v18, v19
    v_smfmac_f32_16x16x64_bf16 v[40:43], v[76:79], v[248:255], v4
    v_cvt_pk_bf16_f32 v58, v20, v21
    v_cvt_pk_bf16_f32 v59, v22, v23
    s_waitcnt lgkmcnt(4)
    v_smfmac_f32_16x16x64_bf16 v[44:47], v[76:79], v[96:103], v4
    v_permlane16_swap_b32 v56, v58
    ds_read_b128 v[96:99], v6 offset:10240
    ds_read_b128 v[100:103], v6 offset:11264
    v_permlane16_swap_b32 v57, v59
    v_min_u32 v56, -2, v56
    v_min_u32 v57, -2, v57
    v_min_u32 v58, -2, v58
    v_min_u32 v59, -2, v59
    buffer_store_dwordx4 v[56:59], v14, s[8:11], s43 offen sc1
    s_add_u32 s49, s43, 32768
    s_waitcnt lgkmcnt(4)
    v_smfmac_f32_16x16x64_bf16 v[48:51], v[68:71], v[80:87], v4
    v_permlane32_swap_b32 v32, v40
    v_permlane32_swap_b32 v33, v41
    v_permlane32_swap_b32 v34, v42
    ds_read_b128 v[80:83], v6 offset:12288
    ds_read_b128 v[84:87], v6 offset:13312
    s_waitcnt lgkmcnt(4)
    v_smfmac_f32_16x16x64_bf16 v[48:51], v[72:75], v[88:95], v4
    v_permlane32_swap_b32 v35, v43
    v_add_f32 v32, v32, v40
    v_add_f32 v33, v33, v41
    v_add_f32 v34, v34, v42
    ds_read_b128 v[88:91], v6 offset:14336
    ds_read_b128 v[92:95], v6 offset:15360
    s_waitcnt lgkmcnt(4)
    v_smfmac_f32_16x16x64_bf16 v[48:51], v[76:79], v[96:103], v4
    v_add_f32 v35, v35, v43
    v_permlane32_swap_b32 v36, v44
    v_permlane32_swap_b32 v37, v45
    v_permlane32_swap_b32 v38, v46
    ds_read_b128 v[96:99], v6 offset:16384
    ds_read_b128 v[100:103], v6 offset:17408
    v_permlane32_swap_b32 v39, v47
    v_add_f32 v36, v36, v44
    v_add_f32 v37, v37, v45
    v_add_f32 v38, v38, v46
    s_waitcnt lgkmcnt(4)
    v_smfmac_f32_16x16x64_bf16 v[52:55], v[68:71], v[80:87], v4
    v_add_f32 v39, v39, v47
    v_cvt_pk_bf16_f32 v60, v32, v33
    v_cvt_pk_bf16_f32 v61, v34, v35
    s_waitcnt lgkmcnt(2)
    v_smfmac_f32_16x16x64_bf16 v[52:55], v[72:75], v[88:95], v4
    v_cvt_pk_bf16_f32 v62, v36, v37
    v_cvt_pk_bf16_f32 v63, v38, v39
    s_waitcnt lgkmcnt(0)
    v_smfmac_f32_16x16x64_bf16 v[52:55], v[76:79], v[96:103], v4
    v_permlane16_swap_b32 v60, v62
    v_permlane16_swap_b32 v61, v63
    v_min_u32 v60, -2, v60
    v_min_u32 v61, -2, v61
    v_min_u32 v62, -2, v62
    v_min_u32 v63, -2, v63
    buffer_store_dwordx4 v[60:63], v14, s[8:11], s49 offen sc1
    s_nop 0
    v_permlane32_swap_b32 v48, v52
    v_permlane32_swap_b32 v49, v53
    v_permlane32_swap_b32 v50, v54
    v_permlane32_swap_b32 v51, v55
    v_add_f32 v48, v48, v52
    v_add_f32 v49, v49, v53
    v_add_f32 v50, v50, v54
    v_add_f32 v51, v51, v55
    v_cvt_pk_bf16_f32 v64, v48, v49
    v_cvt_pk_bf16_f32 v65, v50, v51
    v_mov_b32 v66, v64
    v_mov_b32 v67, v65
    s_nop 0
    v_permlane16_swap_b32 v64, v66
    v_permlane16_swap_b32 v65, v67
    v_min_u32 v64, -2, v64
    v_min_u32 v65, -2, v65
    v_min_u32 v66, -2, v66
    v_min_u32 v67, -2, v67
    buffer_store_dwordx4 v[64:67], v15, s[8:11], s43 offen sc1
    s_add_u32 s40, s40, 1
    s_add_u32 s43, s43, 458752
    s_add_u32 s47, s47, 458752
    s_add_u32 s45, s45, 458752
    s_cmp_lt_u32 s40, 64
    s_cbranch_scc1 interleave_layers__linear_attn_block__memory_aug_recurrent_mem_tr__prompt_kernel_v_stepw1
    s_branch interleave_layers__linear_attn_block__memory_aug_recurrent_mem_tr__prompt_kernel_v_end
interleave_layers__linear_attn_block__memory_aug_recurrent_mem_tr__prompt_kernel_v_stepw2:
    v_mov_b32 v16, 0
    v_mov_b32 v17, 0
    v_mov_b32 v18, 0
    v_mov_b32 v19, 0
    v_mov_b32 v20, 0
    v_mov_b32 v21, 0
    v_mov_b32 v22, 0
    v_mov_b32 v23, 0
    v_mov_b32 v24, 0
    v_mov_b32 v25, 0
    v_mov_b32 v26, 0
    v_mov_b32 v27, 0
    v_mov_b32 v28, 0
    v_mov_b32 v29, 0
    v_mov_b32 v30, 0
    v_mov_b32 v31, 0
    v_mov_b32 v32, 0
    v_mov_b32 v33, 0
    v_mov_b32 v34, 0
    v_mov_b32 v35, 0
    v_mov_b32 v36, 0
    v_mov_b32 v37, 0
    v_mov_b32 v38, 0
    v_mov_b32 v39, 0
    v_mov_b32 v40, 0
    v_mov_b32 v41, 0
    v_mov_b32 v42, 0
    v_mov_b32 v43, 0
    v_mov_b32 v44, 0
    v_mov_b32 v45, 0
    v_mov_b32 v46, 0
    v_mov_b32 v47, 0
    v_mov_b32 v48, 0
    v_mov_b32 v49, 0
    v_mov_b32 v50, 0
    v_mov_b32 v51, 0
    v_mov_b32 v52, 0
    v_mov_b32 v53, 0
    v_mov_b32 v54, 0
    v_mov_b32 v55, 0
    v_mov_b32 v56, 0
    v_mov_b32 v57, 0
    v_mov_b32 v58, 0
    v_mov_b32 v59, 0
    v_mov_b32 v60, 0
    v_mov_b32 v61, 0
    v_mov_b32 v62, 0
    v_mov_b32 v63, 0
    v_mov_b32 v64, 0
    v_mov_b32 v65, 0
    v_mov_b32 v66, 0
    v_mov_b32 v67, 0
    s_add_u32 s48, s47, 4096
    s_lshl_b32 s95, s92, 6
    s_add_u32 s95, s95, s40
    s_add_u32 s95, s95, 1
    s_cmp_ge_i32 s59, s95
    s_cbranch_scc1 interleave_layers__linear_attn_block__memory_aug_recurrent_mem_tr__prompt_kernel_v_ecw2_ok
    s_and_b32 s24, s2, 7
    s_lshl_b32 s24, s24, 7
    s_add_u32 s24, s24, 23109632
    v_and_b32 v79, 3, v1
    v_lshl_add_u32 v79, v79, 2, s24
    s_mov_b32 s61, 0
interleave_layers__linear_attn_block__memory_aug_recurrent_mem_tr__prompt_kernel_v_ecw2:
    buffer_load_dword v78, v79, s[8:11], 0 offen sc1
    s_waitcnt vmcnt(0)
    v_readlane_b32 s59, v78, 0
    v_readlane_b32 s24, v78, 1
    s_min_i32 s59, s59, s24
    v_readlane_b32 s24, v78, 2
    s_min_i32 s59, s59, s24
    s_cmp_ge_i32 s59, s95
    s_cbranch_scc1 interleave_layers__linear_attn_block__memory_aug_recurrent_mem_tr__prompt_kernel_v_ecw2_ok
    s_add_u32 s61, s61, 1
    s_cmp_ge_u32 s61, s60
    s_cbranch_scc1 interleave_layers__linear_attn_block__memory_aug_recurrent_mem_tr__prompt_kernel_v_ecw2_to
    s_sleep 2
    s_branch interleave_layers__linear_attn_block__memory_aug_recurrent_mem_tr__prompt_kernel_v_ecw2
interleave_layers__linear_attn_block__memory_aug_recurrent_mem_tr__prompt_kernel_v_ecw2_to:
    s_mov_b32 s60, 1
interleave_layers__linear_attn_block__memory_aug_recurrent_mem_tr__prompt_kernel_v_ecw2_ok:
    s_sleep 20
    s_mov_b64 exec, 1
    s_mov_b32 s61, 0
    v_mov_b32 v81, 0
    buffer_atomic_add v81, v12, s[8:11], s45 offen sc0
    s_sleep 3
    v_mov_b32 v82, 0
    buffer_atomic_add v82, v12, s[8:11], s45 offen sc0
    s_sleep 3
    v_mov_b32 v83, 0
    buffer_atomic_add v83, v12, s[8:11], s45 offen sc0
    s_sleep 3
interleave_layers__linear_attn_block__memory_aug_recurrent_mem_tr__prompt_kernel_v_prw2:
    v_mov_b32 v80, 0
    buffer_atomic_add v80, v12, s[8:11], s45 offen sc0
    s_waitcnt vmcnt(3)
    v_cmp_le_i32 vcc, 8, v81
    s_add_u32 s61, s61, 1
    s_cbranch_vccnz interleave_layers__linear_attn_block__memory_aug_recurrent_mem_tr__prompt_kernel_v_prw2_out
    s_sleep 3
    v_mov_b32 v81, 0
    buffer_atomic_add v81, v12, s[8:11], s45 offen sc0
    s_waitcnt vmcnt(3)
    v_cmp_le_i32 vcc, 8, v82
    s_add_u32 s61, s61, 1
    s_cbranch_vccnz interleave_layers__linear_attn_block__memory_aug_recurrent_mem_tr__prompt_kernel_v_prw2_out
    s_sleep 3
    v_mov_b32 v82, 0
    buffer_atomic_add v82, v12, s[8:11], s45 offen sc0
    s_waitcnt vmcnt(3)
    v_cmp_le_i32 vcc, 8, v83
    s_add_u32 s61, s61, 1
    s_cbranch_vccnz interleave_layers__linear_attn_block__memory_aug_recurrent_mem_tr__prompt_kernel_v_prw2_out
    s_sleep 3
    v_mov_b32 v83, 0
    buffer_atomic_add v83, v12, s[8:11], s45 offen sc0
    s_waitcnt vmcnt(3)
    v_cmp_le_i32 vcc, 8, v80
    s_add_u32 s61, s61, 1
    s_cbranch_vccnz interleave_layers__linear_attn_block__memory_aug_recurrent_mem_tr__prompt_kernel_v_prw2_out
    s_sleep 3
    s_cmp_ge_u32 s61, s60
    s_cbranch_scc0 interleave_layers__linear_attn_block__memory_aug_recurrent_mem_tr__prompt_kernel_v_prw2
    s_mov_b32 s60, 1
interleave_layers__linear_attn_block__memory_aug_recurrent_mem_tr__prompt_kernel_v_prw2_out:
    s_mov_b64 exec, -1
    buffer_load_dwordx4 v[68:71], v7, s[8:11], s47 offen sc1
    buffer_load_dwordx4 v[72:75], v7, s[8:11], s48 offen sc1
    buffer_load_dwordx2 v[76:77], v8, s[8:11], s47 offen sc1
    s_waitcnt vmcnt(0)
    v_max3_u32 v103, v68, v69, v70
    v_max3_u32 v103, v103, v71, v72
    v_max3_u32 v103, v103, v73, v74
    v_max3_u32 v103, v103, v75, v76
    v_max_u32 v103, v103, v77
    v_cmp_eq_u32 vcc, -1, v103
    s_cbranch_vccz interleave_layers__linear_attn_block__memory_aug_recurrent_mem_tr__prompt_kernel_v_pmw2_out
    s_mov_b32 s61, 0
interleave_layers__linear_attn_block__memory_aug_recurrent_mem_tr__prompt_kernel_v_pmw2:
    buffer_load_dwordx4 v[68:71], v7, s[8:11], s47 offen sc1
    buffer_load_dwordx4 v[72:75], v7, s[8:11], s48 offen sc1
    buffer_load_dwordx2 v[76:77], v8, s[8:11], s47 offen sc1
    s_waitcnt vmcnt(0)
    v_max3_u32 v103, v68, v69, v70
    v_max3_u32 v103, v103, v71, v72
    v_max3_u32 v103, v103, v73, v74
    v_max3_u32 v103, v103, v75, v76
    v_max_u32 v103, v103, v77
    v_cmp_eq_u32 vcc, -1, v103
    s_add_u32 s61, s61, 1
    s_cbranch_vccz interleave_layers__linear_attn_block__memory_aug_recurrent_mem_tr__prompt_kernel_v_pmw2_out
    s_cmp_ge_u32 s61, s60
    s_cbranch_scc1 interleave_layers__linear_attn_block__memory_aug_recurrent_mem_tr__prompt_kernel_v_pmw2_to
    s_sleep 1
    s_branch interleave_layers__linear_attn_block__memory_aug_recurrent_mem_tr__prompt_kernel_v_pmw2
interleave_layers__linear_attn_block__memory_aug_recurrent_mem_tr__prompt_kernel_v_pmw2_to:
    s_mov_b32 s60, 1
interleave_layers__linear_attn_block__memory_aug_recurrent_mem_tr__prompt_kernel_v_pmw2_out:
    ds_write_b128 v7, v[68:71]
    ds_write_b128 v7, v[72:75] offset:4096
    ds_write_b64 v8, v[76:77]
interleave_layers__linear_attn_block__memory_aug_recurrent_mem_tr__prompt_kernel_v_gow2:
    v_smfmac_f32_16x16x64_bf16 v[56:59], v[68:71], a[16:23], v4
    v_smfmac_f32_16x16x64_bf16 v[60:63], v[68:71], a[96:103], v4
    v_smfmac_f32_16x16x64_bf16 v[64:67], v[68:71], a[176:183], v4
    s_waitcnt lgkmcnt(0)
    s_barrier
    ds_read_b128 v[80:83], v5 offset:0
    ds_read_b128 v[84:87], v5 offset:1024
    ds_read_b128 v[88:91], v5 offset:3072
    ds_read_b128 v[92:95], v5 offset:4096
    ds_read_b128 v[96:99], v5 offset:5120
    ds_read_b128 v[100:103], v5 offset:7168
    ds_read_b128 v[76:79], v5 offset:8192
    ds_read_b128 v[68:71], v5 offset:9216
    v_smfmac_f32_16x16x64_bf16 v[64:67], v[72:75], a[208:215], v4
    v_smfmac_f32_16x16x64_bf16 v[56:59], v[72:75], a[48:55], v4
    v_smfmac_f32_16x16x64_bf16 v[60:63], v[72:75], a[128:135], v4
    s_waitcnt lgkmcnt(7)
    v_smfmac_f32_16x16x64_bf16 v[64:67], v[80:83], a[160:167], v4
    s_waitcnt lgkmcnt(6)
    v_smfmac_f32_16x16x64_bf16 v[64:67], v[84:87], a[168:175], v4
    s_waitcnt lgkmcnt(5)
    v_smfmac_f32_16x16x64_bf16 v[64:67], v[88:91], a[184:191], v4
    s_waitcnt lgkmcnt(4)
    v_smfmac_f32_16x16x64_bf16 v[64:67], v[92:95], a[192:199], v4
    s_waitcnt lgkmcnt(3)
    v_smfmac_f32_16x16x64_bf16 v[64:67], v[96:99], a[200:207], v4
    s_waitcnt lgkmcnt(2)
    v_smfmac_f32_16x16x64_bf16 v[64:67], v[100:103], a[216:223], v4
    s_waitcnt lgkmcnt(1)
    v_smfmac_f32_16x16x64_bf16 v[64:67], v[76:79], a[224:231], v4
    s_waitcnt lgkmcnt(0)
    v_smfmac_f32_16x16x64_bf16 v[64:67], v[68:71], a[232:239], v4
    v_smfmac_f32_16x16x64_bf16 v[56:59], v[80:83], a[0:7], v4
    v_smfmac_f32_16x16x64_bf16 v[60:63], v[80:83], a[80:87], v4
    v_smfmac_f32_16x16x64_bf16 v[56:59], v[84:87], a[8:15], v4
    s_nop 4
    v_mov_b32 v72, v64
    v_smfmac_f32_16x16x64_bf16 v[60:63], v[84:87], a[88:95], v4
    v_mov_b32 v73, v65
    v_mov_b32 v74, v66
    v_smfmac_f32_16x16x64_bf16 v[56:59], v[88:91], a[24:31], v4
    v_mov_b32 v75, v67
    v_smfmac_f32_16x16x64_bf16 v[60:63], v[88:91], a[104:111], v4
    v_permlane32_swap_b32 v64, v72
    v_permlane32_swap_b32 v65, v73
    v_smfmac_f32_16x16x64_bf16 v[56:59], v[92:95], a[32:39], v4
    v_permlane32_swap_b32 v66, v74
    v_permlane32_swap_b32 v67, v75
    v_smfmac_f32_16x16x64_bf16 v[60:63], v[92:95], a[112:119], v4
    v_add_f32 v64, v64, v72
    v_add_f32 v65, v65, v73
    v_smfmac_f32_16x16x64_bf16 v[56:59], v[96:99], a[40:47], v4
    v_add_f32 v66, v66, v74
    v_add_f32 v67, v67, v75
    v_smfmac_f32_16x16x64_bf16 v[60:63], v[96:99], a[120:127], v4
    v_cvt_pk_bf16_f32 v72, v64, v65
    v_cvt_pk_bf16_f32 v73, v66, v67
    v_smfmac_f32_16x16x64_bf16 v[56:59], v[100:103], a[56:63], v4
    ds_write_b64 v9, v[72:73] offset:512
    v_smfmac_f32_16x16x64_bf16 v[60:63], v[100:103], a[136:143], v4
    v_smfmac_f32_16x16x64_bf16 v[56:59], v[76:79], a[64:71], v4
    v_smfmac_f32_16x16x64_bf16 v[60:63], v[76:79], a[144:151], v4
    v_smfmac_f32_16x16x64_bf16 v[56:59], v[68:71], a[72:79], v4
    v_smfmac_f32_16x16x64_bf16 v[60:63], v[68:71], a[152:159], v4
    s_nop 7
    v_permlane32_swap_b32 v56, v60
    v_permlane32_swap_b32 v57, v61
    v_permlane32_swap_b32 v58, v62
    v_permlane32_swap_b32 v59, v63
    v_add_f32 v56, v56, v60
    v_add_f32 v57, v57, v61
    v_add_f32 v58, v58, v62
    v_add_f32 v59, v59, v63
    v_cvt_pk_bf16_f32 v68, v56, v57
    v_cvt_pk_bf16_f32 v69, v58, v59
    ds_write_b64 v10, v[68:69]
    s_waitcnt lgkmcnt(0)
    s_barrier
    ds_read_b64_tr_b16 v[68:69], v11 offset:0
    ds_read_b64_tr_b16 v[70:71], v11 offset:128
    ds_read_b64_tr_b16 v[72:73], v11 offset:1024
    ds_read_b64_tr_b16 v[74:75], v11 offset:1152
    ds_read_b64_tr_b16 v[76:77], v11 offset:2048
    ds_read_b64_tr_b16 v[78:79], v11 offset:2176
    ds_read_b128 v[80:83], v6 offset:0
    ds_read_b128 v[84:87], v6 offset:1024
    ds_read_b128 v[88:91], v6 offset:2048
    ds_read_b128 v[92:95], v6 offset:3072
    ds_read_b128 v[96:99], v6 offset:4096
    ds_read_b128 v[100:103], v6 offset:5120
    s_waitcnt lgkmcnt(10)
    v_smfmac_f32_16x16x64_bf16 v[16:19], v[68:71], a[240:247], v4
    v_smfmac_f32_16x16x64_bf16 v[20:23], v[68:71], v[112:119], v4
    v_smfmac_f32_16x16x64_bf16 v[24:27], v[68:71], v[136:143], v4
    v_smfmac_f32_16x16x64_bf16 v[28:31], v[68:71], v[160:167], v4
    s_waitcnt lgkmcnt(8)
    v_smfmac_f32_16x16x64_bf16 v[16:19], v[72:75], a[248:255], v4
    v_smfmac_f32_16x16x64_bf16 v[20:23], v[72:75], v[120:127], v4
    v_smfmac_f32_16x16x64_bf16 v[24:27], v[72:75], v[144:151], v4
    v_smfmac_f32_16x16x64_bf16 v[28:31], v[72:75], v[168:175], v4
    s_waitcnt lgkmcnt(6)
    v_smfmac_f32_16x16x64_bf16 v[16:19], v[76:79], v[104:111], v4
    v_smfmac_f32_16x16x64_bf16 v[20:23], v[76:79], v[128:135], v4
    v_smfmac_f32_16x16x64_bf16 v[24:27], v[76:79], v[152:159], v4
    v_smfmac_f32_16x16x64_bf16 v[28:31], v[76:79], v[176:183], v4
    v_smfmac_f32_16x16x64_bf16 v[32:35], v[68:71], v[184:191], v4
    v_smfmac_f32_16x16x64_bf16 v[36:39], v[68:71], v[208:215], v4
    s_nop 4
    v_permlane32_swap_b32 v16, v24
    v_permlane32_swap_b32 v17, v25
    v_smfmac_f32_16x16x64_bf16 v[40:43], v[68:71], v[232:239], v4
    v_permlane32_swap_b32 v18, v26
    v_permlane32_swap_b32 v19, v27
    s_waitcnt lgkmcnt(4)
    v_smfmac_f32_16x16x64_bf16 v[44:47], v[68:71], v[80:87], v4
    v_add_f32 v16, v16, v24
    v_add_f32 v17, v17, v25
    ds_read_b128 v[80:83], v6 offset:6144
    ds_read_b128 v[84:87], v6 offset:7168
    v_smfmac_f32_16x16x64_bf16 v[32:35], v[72:75], v[192:199], v4
    v_add_f32 v18, v18, v26
    v_add_f32 v19, v19, v27
    v_smfmac_f32_16x16x64_bf16 v[36:39], v[72:75], v[216:223], v4
    v_permlane32_swap_b32 v20, v28
    v_permlane32_swap_b32 v21, v29
    v_smfmac_f32_16x16x64_bf16 v[40:43], v[72:75], v[240:247], v4
    v_permlane32_swap_b32 v22, v30
    v_permlane32_swap_b32 v23, v31
    s_waitcnt lgkmcnt(4)
    v_smfmac_f32_16x16x64_bf16 v[44:47], v[72:75], v[88:95], v4
    v_add_f32 v20, v20, v28
    v_add_f32 v21, v21, v29
    ds_read_b128 v[88:91], v6 offset:8192
    ds_read_b128 v[92:95], v6 offset:9216
    v_smfmac_f32_16x16x64_bf16 v[32:35], v[76:79], v[200:207], v4
    v_add_f32 v22, v22, v30
    v_add_f32 v23, v23, v31
    v_smfmac_f32_16x16x64_bf16 v[36:39], v[76:79], v[224:231], v4
    v_cvt_pk_bf16_f32 v56, v16, v17
    v_cvt_pk_bf16_f32 v57, v18, v19
    v_smfmac_f32_16x16x64_bf16 v[40:43], v[76:79], v[248:255], v4
    v_cvt_pk_bf16_f32 v58, v20, v21
    v_cvt_pk_bf16_f32 v59, v22, v23
    s_waitcnt lgkmcnt(4)
    v_smfmac_f32_16x16x64_bf16 v[44:47], v[76:79], v[96:103], v4
    v_permlane16_swap_b32 v56, v58
    ds_read_b128 v[96:99], v6 offset:10240
    ds_read_b128 v[100:103], v6 offset:11264
    v_permlane16_swap_b32 v57, v59
    v_min_u32 v56, -2, v56
    v_min_u32 v57, -2, v57
    v_min_u32 v58, -2, v58
    v_min_u32 v59, -2, v59
    buffer_store_dwordx4 v[56:59], v14, s[8:11], s43 offen sc1
    s_add_u32 s49, s43, 32768
    s_waitcnt lgkmcnt(4)
    v_smfmac_f32_16x16x64_bf16 v[48:51], v[68:71], v[80:87], v4
    v_permlane32_swap_b32 v32, v40
    v_permlane32_swap_b32 v33, v41
    v_permlane32_swap_b32 v34, v42
    ds_read_b128 v[80:83], v6 offset:12288
    ds_read_b128 v[84:87], v6 offset:13312
    s_waitcnt lgkmcnt(4)
    v_smfmac_f32_16x16x64_bf16 v[48:51], v[72:75], v[88:95], v4
    v_permlane32_swap_b32 v35, v43
    v_add_f32 v32, v32, v40
    v_add_f32 v33, v33, v41
    v_add_f32 v34, v34, v42
    ds_read_b128 v[88:91], v6 offset:14336
    ds_read_b128 v[92:95], v6 offset:15360
    s_waitcnt lgkmcnt(4)
    v_smfmac_f32_16x16x64_bf16 v[48:51], v[76:79], v[96:103], v4
    v_add_f32 v35, v35, v43
    v_permlane32_swap_b32 v36, v44
    v_permlane32_swap_b32 v37, v45
    v_permlane32_swap_b32 v38, v46
    ds_read_b128 v[96:99], v6 offset:16384
    ds_read_b128 v[100:103], v6 offset:17408
    v_permlane32_swap_b32 v39, v47
    v_add_f32 v36, v36, v44
    v_add_f32 v37, v37, v45
    v_add_f32 v38, v38, v46
    s_waitcnt lgkmcnt(4)
    v_smfmac_f32_16x16x64_bf16 v[52:55], v[68:71], v[80:87], v4
    v_add_f32 v39, v39, v47
    v_cvt_pk_bf16_f32 v60, v32, v33
    v_cvt_pk_bf16_f32 v61, v34, v35
    s_waitcnt lgkmcnt(2)
    v_smfmac_f32_16x16x64_bf16 v[52:55], v[72:75], v[88:95], v4
    v_cvt_pk_bf16_f32 v62, v36, v37
    v_cvt_pk_bf16_f32 v63, v38, v39
    s_waitcnt lgkmcnt(0)
    v_smfmac_f32_16x16x64_bf16 v[52:55], v[76:79], v[96:103], v4
    v_permlane16_swap_b32 v60, v62
    v_permlane16_swap_b32 v61, v63
    v_min_u32 v60, -2, v60
    v_min_u32 v61, -2, v61
    v_min_u32 v62, -2, v62
    v_min_u32 v63, -2, v63
    buffer_store_dwordx4 v[60:63], v14, s[8:11], s49 offen sc1
    s_nop 0
    v_permlane32_swap_b32 v48, v52
    v_permlane32_swap_b32 v49, v53
    v_permlane32_swap_b32 v50, v54
    v_permlane32_swap_b32 v51, v55
    v_add_f32 v48, v48, v52
    v_add_f32 v49, v49, v53
    v_add_f32 v50, v50, v54
    v_add_f32 v51, v51, v55
    v_cvt_pk_bf16_f32 v64, v48, v49
    v_cvt_pk_bf16_f32 v65, v50, v51
    v_mov_b32 v66, v64
    v_mov_b32 v67, v65
    s_nop 0
    v_permlane16_swap_b32 v64, v66
    v_permlane16_swap_b32 v65, v67
    v_min_u32 v64, -2, v64
    v_min_u32 v65, -2, v65
    v_min_u32 v66, -2, v66
    v_min_u32 v67, -2, v67
    buffer_store_dwordx4 v[64:67], v15, s[8:11], s43 offen sc1
    s_add_u32 s40, s40, 1
    s_add_u32 s43, s43, 458752
    s_add_u32 s47, s47, 458752
    s_add_u32 s45, s45, 458752
    s_cmp_lt_u32 s40, 64
    s_cbranch_scc1 interleave_layers__linear_attn_block__memory_aug_recurrent_mem_tr__prompt_kernel_v_stepw2
    s_branch interleave_layers__linear_attn_block__memory_aug_recurrent_mem_tr__prompt_kernel_v_end
interleave_layers__linear_attn_block__memory_aug_recurrent_mem_tr__prompt_kernel_v_stepw3:
    v_mov_b32 v16, 0
    v_mov_b32 v17, 0
    v_mov_b32 v18, 0
    v_mov_b32 v19, 0
    v_mov_b32 v20, 0
    v_mov_b32 v21, 0
    v_mov_b32 v22, 0
    v_mov_b32 v23, 0
    v_mov_b32 v24, 0
    v_mov_b32 v25, 0
    v_mov_b32 v26, 0
    v_mov_b32 v27, 0
    v_mov_b32 v28, 0
    v_mov_b32 v29, 0
    v_mov_b32 v30, 0
    v_mov_b32 v31, 0
    v_mov_b32 v32, 0
    v_mov_b32 v33, 0
    v_mov_b32 v34, 0
    v_mov_b32 v35, 0
    v_mov_b32 v36, 0
    v_mov_b32 v37, 0
    v_mov_b32 v38, 0
    v_mov_b32 v39, 0
    v_mov_b32 v40, 0
    v_mov_b32 v41, 0
    v_mov_b32 v42, 0
    v_mov_b32 v43, 0
    v_mov_b32 v44, 0
    v_mov_b32 v45, 0
    v_mov_b32 v46, 0
    v_mov_b32 v47, 0
    v_mov_b32 v48, 0
    v_mov_b32 v49, 0
    v_mov_b32 v50, 0
    v_mov_b32 v51, 0
    v_mov_b32 v52, 0
    v_mov_b32 v53, 0
    v_mov_b32 v54, 0
    v_mov_b32 v55, 0
    v_mov_b32 v56, 0
    v_mov_b32 v57, 0
    v_mov_b32 v58, 0
    v_mov_b32 v59, 0
    v_mov_b32 v60, 0
    v_mov_b32 v61, 0
    v_mov_b32 v62, 0
    v_mov_b32 v63, 0
    v_mov_b32 v64, 0
    v_mov_b32 v65, 0
    v_mov_b32 v66, 0
    v_mov_b32 v67, 0
    s_add_u32 s48, s47, 4096
    s_lshl_b32 s95, s92, 6
    s_add_u32 s95, s95, s40
    s_add_u32 s95, s95, 1
    s_cmp_ge_i32 s59, s95
    s_cbranch_scc1 interleave_layers__linear_attn_block__memory_aug_recurrent_mem_tr__prompt_kernel_v_ecw3_ok
    s_and_b32 s24, s2, 7
    s_lshl_b32 s24, s24, 7
    s_add_u32 s24, s24, 23109632
    v_and_b32 v79, 3, v1
    v_lshl_add_u32 v79, v79, 2, s24
    s_mov_b32 s61, 0
interleave_layers__linear_attn_block__memory_aug_recurrent_mem_tr__prompt_kernel_v_ecw3:
    buffer_load_dword v78, v79, s[8:11], 0 offen sc1
    s_waitcnt vmcnt(0)
    v_readlane_b32 s59, v78, 0
    v_readlane_b32 s24, v78, 1
    s_min_i32 s59, s59, s24
    v_readlane_b32 s24, v78, 2
    s_min_i32 s59, s59, s24
    s_cmp_ge_i32 s59, s95
    s_cbranch_scc1 interleave_layers__linear_attn_block__memory_aug_recurrent_mem_tr__prompt_kernel_v_ecw3_ok
    s_add_u32 s61, s61, 1
    s_cmp_ge_u32 s61, s60
    s_cbranch_scc1 interleave_layers__linear_attn_block__memory_aug_recurrent_mem_tr__prompt_kernel_v_ecw3_to
    s_sleep 2
    s_branch interleave_layers__linear_attn_block__memory_aug_recurrent_mem_tr__prompt_kernel_v_ecw3
interleave_layers__linear_attn_block__memory_aug_recurrent_mem_tr__prompt_kernel_v_ecw3_to:
    s_mov_b32 s60, 1
interleave_layers__linear_attn_block__memory_aug_recurrent_mem_tr__prompt_kernel_v_ecw3_ok:
    s_sleep 20
    s_mov_b64 exec, 1
    s_mov_b32 s61, 0
    v_mov_b32 v81, 0
    buffer_atomic_add v81, v12, s[8:11], s45 offen sc0
    s_sleep 3
    v_mov_b32 v82, 0
    buffer_atomic_add v82, v12, s[8:11], s45 offen sc0
    s_sleep 3
    v_mov_b32 v83, 0
    buffer_atomic_add v83, v12, s[8:11], s45 offen sc0
    s_sleep 3
interleave_layers__linear_attn_block__memory_aug_recurrent_mem_tr__prompt_kernel_v_prw3:
    v_mov_b32 v80, 0
    buffer_atomic_add v80, v12, s[8:11], s45 offen sc0
    s_waitcnt vmcnt(3)
    v_cmp_le_i32 vcc, 8, v81
    s_add_u32 s61, s61, 1
    s_cbranch_vccnz interleave_layers__linear_attn_block__memory_aug_recurrent_mem_tr__prompt_kernel_v_prw3_out
    s_sleep 3
    v_mov_b32 v81, 0
    buffer_atomic_add v81, v12, s[8:11], s45 offen sc0
    s_waitcnt vmcnt(3)
    v_cmp_le_i32 vcc, 8, v82
    s_add_u32 s61, s61, 1
    s_cbranch_vccnz interleave_layers__linear_attn_block__memory_aug_recurrent_mem_tr__prompt_kernel_v_prw3_out
    s_sleep 3
    v_mov_b32 v82, 0
    buffer_atomic_add v82, v12, s[8:11], s45 offen sc0
    s_waitcnt vmcnt(3)
    v_cmp_le_i32 vcc, 8, v83
    s_add_u32 s61, s61, 1
    s_cbranch_vccnz interleave_layers__linear_attn_block__memory_aug_recurrent_mem_tr__prompt_kernel_v_prw3_out
    s_sleep 3
    v_mov_b32 v83, 0
    buffer_atomic_add v83, v12, s[8:11], s45 offen sc0
    s_waitcnt vmcnt(3)
    v_cmp_le_i32 vcc, 8, v80
    s_add_u32 s61, s61, 1
    s_cbranch_vccnz interleave_layers__linear_attn_block__memory_aug_recurrent_mem_tr__prompt_kernel_v_prw3_out
    s_sleep 3
    s_cmp_ge_u32 s61, s60
    s_cbranch_scc0 interleave_layers__linear_attn_block__memory_aug_recurrent_mem_tr__prompt_kernel_v_prw3
    s_mov_b32 s60, 1
interleave_layers__linear_attn_block__memory_aug_recurrent_mem_tr__prompt_kernel_v_prw3_out:
    s_mov_b64 exec, -1
    buffer_load_dwordx4 v[68:71], v7, s[8:11], s47 offen sc1
    buffer_load_dwordx4 v[72:75], v7, s[8:11], s48 offen sc1
    buffer_load_dwordx2 v[76:77], v8, s[8:11], s47 offen sc1
    s_waitcnt vmcnt(0)
    v_max3_u32 v103, v68, v69, v70
    v_max3_u32 v103, v103, v71, v72
    v_max3_u32 v103, v103, v73, v74
    v_max3_u32 v103, v103, v75, v76
    v_max_u32 v103, v103, v77
    v_cmp_eq_u32 vcc, -1, v103
    s_cbranch_vccz interleave_layers__linear_attn_block__memory_aug_recurrent_mem_tr__prompt_kernel_v_pmw3_out
    s_mov_b32 s61, 0
interleave_layers__linear_attn_block__memory_aug_recurrent_mem_tr__prompt_kernel_v_pmw3:
    buffer_load_dwordx4 v[68:71], v7, s[8:11], s47 offen sc1
    buffer_load_dwordx4 v[72:75], v7, s[8:11], s48 offen sc1
    buffer_load_dwordx2 v[76:77], v8, s[8:11], s47 offen sc1
    s_waitcnt vmcnt(0)
    v_max3_u32 v103, v68, v69, v70
    v_max3_u32 v103, v103, v71, v72
    v_max3_u32 v103, v103, v73, v74
    v_max3_u32 v103, v103, v75, v76
    v_max_u32 v103, v103, v77
    v_cmp_eq_u32 vcc, -1, v103
    s_add_u32 s61, s61, 1
    s_cbranch_vccz interleave_layers__linear_attn_block__memory_aug_recurrent_mem_tr__prompt_kernel_v_pmw3_out
    s_cmp_ge_u32 s61, s60
    s_cbranch_scc1 interleave_layers__linear_attn_block__memory_aug_recurrent_mem_tr__prompt_kernel_v_pmw3_to
    s_sleep 1
    s_branch interleave_layers__linear_attn_block__memory_aug_recurrent_mem_tr__prompt_kernel_v_pmw3
interleave_layers__linear_attn_block__memory_aug_recurrent_mem_tr__prompt_kernel_v_pmw3_to:
    s_mov_b32 s60, 1
interleave_layers__linear_attn_block__memory_aug_recurrent_mem_tr__prompt_kernel_v_pmw3_out:
    ds_write_b128 v7, v[68:71]
    ds_write_b128 v7, v[72:75] offset:4096
    ds_write_b64 v8, v[76:77]
interleave_layers__linear_attn_block__memory_aug_recurrent_mem_tr__prompt_kernel_v_gow3:
    v_smfmac_f32_16x16x64_bf16 v[56:59], v[68:71], a[24:31], v4
    v_smfmac_f32_16x16x64_bf16 v[60:63], v[68:71], a[104:111], v4
    v_smfmac_f32_16x16x64_bf16 v[64:67], v[68:71], a[184:191], v4
    s_waitcnt lgkmcnt(0)
    s_barrier
    ds_read_b128 v[80:83], v5 offset:0
    ds_read_b128 v[84:87], v5 offset:1024
    ds_read_b128 v[88:91], v5 offset:2048
    ds_read_b128 v[92:95], v5 offset:4096
    ds_read_b128 v[96:99], v5 offset:5120
    ds_read_b128 v[100:103], v5 offset:6144
    ds_read_b128 v[76:79], v5 offset:8192
    ds_read_b128 v[68:71], v5 offset:9216
    v_smfmac_f32_16x16x64_bf16 v[64:67], v[72:75], a[216:223], v4
    v_smfmac_f32_16x16x64_bf16 v[56:59], v[72:75], a[56:63], v4
    v_smfmac_f32_16x16x64_bf16 v[60:63], v[72:75], a[136:143], v4
    s_waitcnt lgkmcnt(7)
    v_smfmac_f32_16x16x64_bf16 v[64:67], v[80:83], a[160:167], v4
    s_waitcnt lgkmcnt(6)
    v_smfmac_f32_16x16x64_bf16 v[64:67], v[84:87], a[168:175], v4
    s_waitcnt lgkmcnt(5)
    v_smfmac_f32_16x16x64_bf16 v[64:67], v[88:91], a[176:183], v4
    s_waitcnt lgkmcnt(4)
    v_smfmac_f32_16x16x64_bf16 v[64:67], v[92:95], a[192:199], v4
    s_waitcnt lgkmcnt(3)
    v_smfmac_f32_16x16x64_bf16 v[64:67], v[96:99], a[200:207], v4
    s_waitcnt lgkmcnt(2)
    v_smfmac_f32_16x16x64_bf16 v[64:67], v[100:103], a[208:215], v4
    s_waitcnt lgkmcnt(1)
    v_smfmac_f32_16x16x64_bf16 v[64:67], v[76:79], a[224:231], v4
    s_waitcnt lgkmcnt(0)
    v_smfmac_f32_16x16x64_bf16 v[64:67], v[68:71], a[232:239], v4
    v_smfmac_f32_16x16x64_bf16 v[56:59], v[80:83], a[0:7], v4
    v_smfmac_f32_16x16x64_bf16 v[60:63], v[80:83], a[80:87], v4
    v_smfmac_f32_16x16x64_bf16 v[56:59], v[84:87], a[8:15], v4
    s_nop 4
    v_mov_b32 v72, v64
    v_smfmac_f32_16x16x64_bf16 v[60:63], v[84:87], a[88:95], v4
    v_mov_b32 v73, v65
    v_mov_b32 v74, v66
    v_smfmac_f32_16x16x64_bf16 v[56:59], v[88:91], a[16:23], v4
    v_mov_b32 v75, v67
    v_smfmac_f32_16x16x64_bf16 v[60:63], v[88:91], a[96:103], v4
    v_permlane32_swap_b32 v64, v72
    v_permlane32_swap_b32 v65, v73
    v_smfmac_f32_16x16x64_bf16 v[56:59], v[92:95], a[32:39], v4
    v_permlane32_swap_b32 v66, v74
    v_permlane32_swap_b32 v67, v75
    v_smfmac_f32_16x16x64_bf16 v[60:63], v[92:95], a[112:119], v4
    v_add_f32 v64, v64, v72
    v_add_f32 v65, v65, v73
    v_smfmac_f32_16x16x64_bf16 v[56:59], v[96:99], a[40:47], v4
    v_add_f32 v66, v66, v74
    v_add_f32 v67, v67, v75
    v_smfmac_f32_16x16x64_bf16 v[60:63], v[96:99], a[120:127], v4
    v_cvt_pk_bf16_f32 v72, v64, v65
    v_cvt_pk_bf16_f32 v73, v66, v67
    v_smfmac_f32_16x16x64_bf16 v[56:59], v[100:103], a[48:55], v4
    ds_write_b64 v9, v[72:73] offset:512
    v_smfmac_f32_16x16x64_bf16 v[60:63], v[100:103], a[128:135], v4
    v_smfmac_f32_16x16x64_bf16 v[56:59], v[76:79], a[64:71], v4
    v_smfmac_f32_16x16x64_bf16 v[60:63], v[76:79], a[144:151], v4
    v_smfmac_f32_16x16x64_bf16 v[56:59], v[68:71], a[72:79], v4
    v_smfmac_f32_16x16x64_bf16 v[60:63], v[68:71], a[152:159], v4
    s_nop 7
    v_permlane32_swap_b32 v56, v60
    v_permlane32_swap_b32 v57, v61
    v_permlane32_swap_b32 v58, v62
    v_permlane32_swap_b32 v59, v63
    v_add_f32 v56, v56, v60
    v_add_f32 v57, v57, v61
    v_add_f32 v58, v58, v62
    v_add_f32 v59, v59, v63
    v_cvt_pk_bf16_f32 v68, v56, v57
    v_cvt_pk_bf16_f32 v69, v58, v59
    ds_write_b64 v10, v[68:69]
    s_waitcnt lgkmcnt(0)
    s_barrier
    ds_read_b64_tr_b16 v[68:69], v11 offset:0
    ds_read_b64_tr_b16 v[70:71], v11 offset:128
    ds_read_b64_tr_b16 v[72:73], v11 offset:1024
    ds_read_b64_tr_b16 v[74:75], v11 offset:1152
    ds_read_b64_tr_b16 v[76:77], v11 offset:2048
    ds_read_b64_tr_b16 v[78:79], v11 offset:2176
    ds_read_b128 v[80:83], v6 offset:0
    ds_read_b128 v[84:87], v6 offset:1024
    ds_read_b128 v[88:91], v6 offset:2048
    ds_read_b128 v[92:95], v6 offset:3072
    ds_read_b128 v[96:99], v6 offset:4096
    ds_read_b128 v[100:103], v6 offset:5120
    s_waitcnt lgkmcnt(10)
    v_smfmac_f32_16x16x64_bf16 v[16:19], v[68:71], a[240:247], v4
    v_smfmac_f32_16x16x64_bf16 v[20:23], v[68:71], v[112:119], v4
    v_smfmac_f32_16x16x64_bf16 v[24:27], v[68:71], v[136:143], v4
    v_smfmac_f32_16x16x64_bf16 v[28:31], v[68:71], v[160:167], v4
    s_waitcnt lgkmcnt(8)
    v_smfmac_f32_16x16x64_bf16 v[16:19], v[72:75], a[248:255], v4
    v_smfmac_f32_16x16x64_bf16 v[20:23], v[72:75], v[120:127], v4
    v_smfmac_f32_16x16x64_bf16 v[24:27], v[72:75], v[144:151], v4
    v_smfmac_f32_16x16x64_bf16 v[28:31], v[72:75], v[168:175], v4
    s_waitcnt lgkmcnt(6)
    v_smfmac_f32_16x16x64_bf16 v[16:19], v[76:79], v[104:111], v4
    v_smfmac_f32_16x16x64_bf16 v[20:23], v[76:79], v[128:135], v4
    v_smfmac_f32_16x16x64_bf16 v[24:27], v[76:79], v[152:159], v4
    v_smfmac_f32_16x16x64_bf16 v[28:31], v[76:79], v[176:183], v4
    v_smfmac_f32_16x16x64_bf16 v[32:35], v[68:71], v[184:191], v4
    v_smfmac_f32_16x16x64_bf16 v[36:39], v[68:71], v[208:215], v4
    s_nop 4
    v_permlane32_swap_b32 v16, v24
    v_permlane32_swap_b32 v17, v25
    v_smfmac_f32_16x16x64_bf16 v[40:43], v[68:71], v[232:239], v4
    v_permlane32_swap_b32 v18, v26
    v_permlane32_swap_b32 v19, v27
    s_waitcnt lgkmcnt(4)
    v_smfmac_f32_16x16x64_bf16 v[44:47], v[68:71], v[80:87], v4
    v_add_f32 v16, v16, v24
    v_add_f32 v17, v17, v25
    ds_read_b128 v[80:83], v6 offset:6144
    ds_read_b128 v[84:87], v6 offset:7168
    v_smfmac_f32_16x16x64_bf16 v[32:35], v[72:75], v[192:199], v4
    v_add_f32 v18, v18, v26
    v_add_f32 v19, v19, v27
    v_smfmac_f32_16x16x64_bf16 v[36:39], v[72:75], v[216:223], v4
    v_permlane32_swap_b32 v20, v28
    v_permlane32_swap_b32 v21, v29
    v_smfmac_f32_16x16x64_bf16 v[40:43], v[72:75], v[240:247], v4
    v_permlane32_swap_b32 v22, v30
    v_permlane32_swap_b32 v23, v31
    s_waitcnt lgkmcnt(4)
    v_smfmac_f32_16x16x64_bf16 v[44:47], v[72:75], v[88:95], v4
    v_add_f32 v20, v20, v28
    v_add_f32 v21, v21, v29
    ds_read_b128 v[88:91], v6 offset:8192
    ds_read_b128 v[92:95], v6 offset:9216
    v_smfmac_f32_16x16x64_bf16 v[32:35], v[76:79], v[200:207], v4
    v_add_f32 v22, v22, v30
    v_add_f32 v23, v23, v31
    v_smfmac_f32_16x16x64_bf16 v[36:39], v[76:79], v[224:231], v4
    v_cvt_pk_bf16_f32 v56, v16, v17
    v_cvt_pk_bf16_f32 v57, v18, v19
    v_smfmac_f32_16x16x64_bf16 v[40:43], v[76:79], v[248:255], v4
    v_cvt_pk_bf16_f32 v58, v20, v21
    v_cvt_pk_bf16_f32 v59, v22, v23
    s_waitcnt lgkmcnt(4)
    v_smfmac_f32_16x16x64_bf16 v[44:47], v[76:79], v[96:103], v4
    v_permlane16_swap_b32 v56, v58
    ds_read_b128 v[96:99], v6 offset:10240
    ds_read_b128 v[100:103], v6 offset:11264
    v_permlane16_swap_b32 v57, v59
    v_min_u32 v56, -2, v56
    v_min_u32 v57, -2, v57
    v_min_u32 v58, -2, v58
    v_min_u32 v59, -2, v59
    buffer_store_dwordx4 v[56:59], v14, s[8:11], s43 offen sc1
    s_add_u32 s49, s43, 32768
    s_waitcnt lgkmcnt(4)
    v_smfmac_f32_16x16x64_bf16 v[48:51], v[68:71], v[80:87], v4
    v_permlane32_swap_b32 v32, v40
    v_permlane32_swap_b32 v33, v41
    v_permlane32_swap_b32 v34, v42
    ds_read_b128 v[80:83], v6 offset:12288
    ds_read_b128 v[84:87], v6 offset:13312
    s_waitcnt lgkmcnt(4)
    v_smfmac_f32_16x16x64_bf16 v[48:51], v[72:75], v[88:95], v4
    v_permlane32_swap_b32 v35, v43
    v_add_f32 v32, v32, v40
    v_add_f32 v33, v33, v41
    v_add_f32 v34, v34, v42
    ds_read_b128 v[88:91], v6 offset:14336
    ds_read_b128 v[92:95], v6 offset:15360
    s_waitcnt lgkmcnt(4)
    v_smfmac_f32_16x16x64_bf16 v[48:51], v[76:79], v[96:103], v4
    v_add_f32 v35, v35, v43
    v_permlane32_swap_b32 v36, v44
    v_permlane32_swap_b32 v37, v45
    v_permlane32_swap_b32 v38, v46
    ds_read_b128 v[96:99], v6 offset:16384
    ds_read_b128 v[100:103], v6 offset:17408
    v_permlane32_swap_b32 v39, v47
    v_add_f32 v36, v36, v44
    v_add_f32 v37, v37, v45
    v_add_f32 v38, v38, v46
    s_waitcnt lgkmcnt(4)
    v_smfmac_f32_16x16x64_bf16 v[52:55], v[68:71], v[80:87], v4
    v_add_f32 v39, v39, v47
    v_cvt_pk_bf16_f32 v60, v32, v33
    v_cvt_pk_bf16_f32 v61, v34, v35
    s_waitcnt lgkmcnt(2)
    v_smfmac_f32_16x16x64_bf16 v[52:55], v[72:75], v[88:95], v4
    v_cvt_pk_bf16_f32 v62, v36, v37
    v_cvt_pk_bf16_f32 v63, v38, v39
    s_waitcnt lgkmcnt(0)
    v_smfmac_f32_16x16x64_bf16 v[52:55], v[76:79], v[96:103], v4
    v_permlane16_swap_b32 v60, v62
    v_permlane16_swap_b32 v61, v63
    v_min_u32 v60, -2, v60
    v_min_u32 v61, -2, v61
    v_min_u32 v62, -2, v62
    v_min_u32 v63, -2, v63
    buffer_store_dwordx4 v[60:63], v14, s[8:11], s49 offen sc1
    s_nop 0
    v_permlane32_swap_b32 v48, v52
    v_permlane32_swap_b32 v49, v53
    v_permlane32_swap_b32 v50, v54
    v_permlane32_swap_b32 v51, v55
    v_add_f32 v48, v48, v52
    v_add_f32 v49, v49, v53
    v_add_f32 v50, v50, v54
    v_add_f32 v51, v51, v55
    v_cvt_pk_bf16_f32 v64, v48, v49
    v_cvt_pk_bf16_f32 v65, v50, v51
    v_mov_b32 v66, v64
    v_mov_b32 v67, v65
    s_nop 0
    v_permlane16_swap_b32 v64, v66
    v_permlane16_swap_b32 v65, v67
    v_min_u32 v64, -2, v64
    v_min_u32 v65, -2, v65
    v_min_u32 v66, -2, v66
    v_min_u32 v67, -2, v67
    buffer_store_dwordx4 v[64:67], v15, s[8:11], s43 offen sc1
    s_add_u32 s40, s40, 1
    s_add_u32 s43, s43, 458752
    s_add_u32 s47, s47, 458752
    s_add_u32 s45, s45, 458752
    s_cmp_lt_u32 s40, 64
    s_cbranch_scc1 interleave_layers__linear_attn_block__memory_aug_recurrent_mem_tr__prompt_kernel_v_stepw3
interleave_layers__linear_attn_block__memory_aug_recurrent_mem_tr__prompt_kernel_v_end:
    s_cmp_eq_u32 s92, 0
    s_cbranch_scc0 interleave_layers__linear_attn_block__memory_aug_recurrent_mem_tr__prompt_kernel_end
    s_mov_b32 s92, 1
    s_branch interleave_layers__linear_attn_block__memory_aug_recurrent_mem_tr__prompt_kernel_v_layer
interleave_layers__linear_attn_block__memory_aug_recurrent_mem_tr__prompt_kernel_roleR:
interleave_layers__linear_attn_block__memory_aug_recurrent_mem_tr__prompt_kernel_r_top:
    s_barrier
    s_sub_u32 s24, s2, 64
    s_cmp_ge_u32 s24, 24
    s_cbranch_scc1 interleave_layers__linear_attn_block__memory_aug_recurrent_mem_tr__prompt_kernel_rk22
    s_and_b32 s44, s24, 7
    s_lshr_b32 s45, s24, 3
    s_cmp_eq_u32 s92, 0
    s_cselect_b32 s46, 32, 2
    v_lshlrev_b32 v5, 4, v1
    s_mov_b32 s64, 12288
    s_cmp_eq_u32 s45, 1
    s_cselect_b32 s64, 5120, s64
    s_cmp_eq_u32 s45, 2
    s_cselect_b32 s64, 17408, s64
    s_mov_b32 s65, 1024
    s_cmp_eq_u32 s45, 1
    s_cselect_b32 s65, 7168, s65
    s_cmp_eq_u32 s45, 2
    s_cselect_b32 s65, 13312, s65
    s_mov_b32 s66, 0
    s_cmp_eq_u32 s45, 1
    s_cselect_b32 s66, 6144, s66
    s_cmp_eq_u32 s45, 2
    s_cselect_b32 s66, 14336, s66
    s_mov_b32 s67, 2048
    s_cmp_eq_u32 s45, 1
    s_cselect_b32 s67, 8192, s67
    s_cmp_eq_u32 s45, 2
    s_cselect_b32 s67, 15360, s67
    s_mov_b32 s68, 4096
    s_cmp_eq_u32 s45, 1
    s_cselect_b32 s68, 10240, s68
    s_cmp_eq_u32 s45, 2
    s_cselect_b32 s68, 16384, s68
    s_mov_b32 s69, 3072
    s_cmp_eq_u32 s45, 1
    s_cselect_b32 s69, 9216, s69
    s_cmp_eq_u32 s45, 2
    s_cselect_b32 s69, 16384, s69
    s_mov_b32 s70, 3072
    s_cmp_eq_u32 s45, 1
    s_cselect_b32 s70, 11264, s70
    s_cmp_eq_u32 s45, 2
    s_cselect_b32 s70, 16384, s70
    v_mov_b32 v16, 0
    v_mov_b32 v17, 0
    v_mov_b32 v18, 0
    v_mov_b32 v19, 0
    v_mov_b32 v20, 0
    v_mov_b32 v21, 0
    v_mov_b32 v22, 0
    v_mov_b32 v23, 0
    v_mov_b32 v24, 0
    v_mov_b32 v25, 0
    v_mov_b32 v26, 0
    v_mov_b32 v27, 0
    v_mov_b32 v28, 0
    v_mov_b32 v29, 0
    v_mov_b32 v30, 0
    v_mov_b32 v31, 0
    v_mov_b32 v32, 0
    v_mov_b32 v33, 0
    v_mov_b32 v34, 0
    v_mov_b32 v35, 0
    v_mov_b32 v36, 0
    v_mov_b32 v37, 0
    v_mov_b32 v38, 0
    v_mov_b32 v39, 0
    v_mov_b32 v40, 0
    v_mov_b32 v41, 0
    v_mov_b32 v42, 0
    v_mov_b32 v43, 0
    s_lshl_b32 s24, s92, 3
    s_add_u32 s24, s24, s44
    s_lshl_b32 s24, s24, 7
    s_add_u32 s24, s24, 23101440
    v_lshlrev_b32 v15, 2, v1
    v_add_u32 v15, s24, v15
    s_cmp_eq_u32 s92, 0
    s_cselect_b32 s26, -1, 3
    s_mov_b32 s61, 0
interleave_layers__linear_attn_block__memory_aug_recurrent_mem_tr__prompt_kernel_k2_w:
    buffer_load_dword v14, v15, s[8:11], 0 offen sc1
    s_waitcnt vmcnt(0)
    v_cmp_le_i32 vcc, 1, v14
    s_and_b32 s24, vcc_lo, s26
    s_cmp_eq_u32 s24, s26
    s_cbranch_scc1 interleave_layers__linear_attn_block__memory_aug_recurrent_mem_tr__prompt_kernel_k2_w_ok
    s_add_u32 s61, s61, 1
    s_cmp_ge_u32 s61, s60
    s_cbranch_scc1 interleave_layers__linear_attn_block__memory_aug_recurrent_mem_tr__prompt_kernel_k2_w_to
    s_sleep 2
    s_branch interleave_layers__linear_attn_block__memory_aug_recurrent_mem_tr__prompt_kernel_k2_w
interleave_layers__linear_attn_block__memory_aug_recurrent_mem_tr__prompt_kernel_k2_w_to:
    s_mov_b32 s60, 1
interleave_layers__linear_attn_block__memory_aug_recurrent_mem_tr__prompt_kernel_k2_w_ok:
    s_mov_b32 s40, s3
interleave_layers__linear_attn_block__memory_aug_recurrent_mem_tr__prompt_kernel_k2_rd:
    s_add_u32 s25, s40, 0
    s_mul_i32 s24, s25, 147456
    s_mul_i32 s26, s44, 18432
    s_add_u32 s24, s24, s26
    s_add_u32 s24, s24, 16777216
    s_cmp_lt_u32 s25, s46
    s_cselect_b32 s24, s24, 2146435072
    s_add_u32 s26, s24, s64
    buffer_load_dwordx4 v[48:51], v5, s[8:11], s26 offen sc1
    s_add_u32 s26, s24, s65
    buffer_load_dwordx4 v[52:55], v5, s[8:11], s26 offen sc1
    s_add_u32 s26, s24, s66
    buffer_load_dwordx4 v[56:59], v5, s[8:11], s26 offen sc1
    s_add_u32 s26, s24, s67
    buffer_load_dwordx4 v[60:63], v5, s[8:11], s26 offen sc1
    s_add_u32 s26, s24, s68
    buffer_load_dwordx4 v[64:67], v5, s[8:11], s26 offen sc1
    s_add_u32 s26, s24, s69
    buffer_load_dwordx4 v[68:71], v5, s[8:11], s26 offen sc1
    s_add_u32 s26, s24, s70
    buffer_load_dwordx4 v[72:75], v5, s[8:11], s26 offen sc1
    s_add_u32 s25, s40, 4
    s_mul_i32 s24, s25, 147456
    s_mul_i32 s26, s44, 18432
    s_add_u32 s24, s24, s26
    s_add_u32 s24, s24, 16777216
    s_cmp_lt_u32 s25, s46
    s_cselect_b32 s24, s24, 2146435072
    s_add_u32 s26, s24, s64
    buffer_load_dwordx4 v[76:79], v5, s[8:11], s26 offen sc1
    s_add_u32 s26, s24, s65
    buffer_load_dwordx4 v[80:83], v5, s[8:11], s26 offen sc1
    s_add_u32 s26, s24, s66
    buffer_load_dwordx4 v[84:87], v5, s[8:11], s26 offen sc1
    s_add_u32 s26, s24, s67
    buffer_load_dwordx4 v[88:91], v5, s[8:11], s26 offen sc1
    s_add_u32 s26, s24, s68
    buffer_load_dwordx4 v[92:95], v5, s[8:11], s26 offen sc1
    s_add_u32 s26, s24, s69
    buffer_load_dwordx4 v[96:99], v5, s[8:11], s26 offen sc1
    s_add_u32 s26, s24, s70
    buffer_load_dwordx4 v[100:103], v5, s[8:11], s26 offen sc1
    s_add_u32 s25, s40, 8
    s_mul_i32 s24, s25, 147456
    s_mul_i32 s26, s44, 18432
    s_add_u32 s24, s24, s26
    s_add_u32 s24, s24, 16777216
    s_cmp_lt_u32 s25, s46
    s_cselect_b32 s24, s24, 2146435072
    s_add_u32 s26, s24, s64
    buffer_load_dwordx4 v[104:107], v5, s[8:11], s26 offen sc1
    s_add_u32 s26, s24, s65
    buffer_load_dwordx4 v[108:111], v5, s[8:11], s26 offen sc1
    s_add_u32 s26, s24, s66
    buffer_load_dwordx4 v[112:115], v5, s[8:11], s26 offen sc1
    s_add_u32 s26, s24, s67
    buffer_load_dwordx4 v[116:119], v5, s[8:11], s26 offen sc1
    s_add_u32 s26, s24, s68
    buffer_load_dwordx4 v[120:123], v5, s[8:11], s26 offen sc1
    s_add_u32 s26, s24, s69
    buffer_load_dwordx4 v[124:127], v5, s[8:11], s26 offen sc1
    s_add_u32 s26, s24, s70
    buffer_load_dwordx4 v[128:131], v5, s[8:11], s26 offen sc1
    s_add_u32 s25, s40, 12
    s_mul_i32 s24, s25, 147456
    s_mul_i32 s26, s44, 18432
    s_add_u32 s24, s24, s26
    s_add_u32 s24, s24, 16777216
    s_cmp_lt_u32 s25, s46
    s_cselect_b32 s24, s24, 2146435072
    s_add_u32 s26, s24, s64
    buffer_load_dwordx4 v[132:135], v5, s[8:11], s26 offen sc1
    s_add_u32 s26, s24, s65
    buffer_load_dwordx4 v[136:139], v5, s[8:11], s26 offen sc1
    s_add_u32 s26, s24, s66
    buffer_load_dwordx4 v[140:143], v5, s[8:11], s26 offen sc1
    s_add_u32 s26, s24, s67
    buffer_load_dwordx4 v[144:147], v5, s[8:11], s26 offen sc1
    s_add_u32 s26, s24, s68
    buffer_load_dwordx4 v[148:151], v5, s[8:11], s26 offen sc1
    s_add_u32 s26, s24, s69
    buffer_load_dwordx4 v[152:155], v5, s[8:11], s26 offen sc1
    s_add_u32 s26, s24, s70
    buffer_load_dwordx4 v[156:159], v5, s[8:11], s26 offen sc1
    s_add_u32 s40, s40, 16
    s_cmp_lt_u32 s40, s46
    s_cbranch_scc0 interleave_layers__linear_attn_block__memory_aug_recurrent_mem_tr__prompt_kernel_k2m23
    s_waitcnt vmcnt(21)
    v_pk_add_f32 v[16:17], v[16:17], v[48:49]
    v_pk_add_f32 v[18:19], v[18:19], v[50:51]
    v_pk_add_f32 v[20:21], v[20:21], v[52:53]
    v_pk_add_f32 v[22:23], v[22:23], v[54:55]
    v_pk_add_f32 v[24:25], v[24:25], v[56:57]
    v_pk_add_f32 v[26:27], v[26:27], v[58:59]
    v_pk_add_f32 v[28:29], v[28:29], v[60:61]
    v_pk_add_f32 v[30:31], v[30:31], v[62:63]
    v_pk_add_f32 v[32:33], v[32:33], v[64:65]
    v_pk_add_f32 v[34:35], v[34:35], v[66:67]
    v_pk_add_f32 v[36:37], v[36:37], v[68:69]
    v_pk_add_f32 v[38:39], v[38:39], v[70:71]
    v_pk_add_f32 v[40:41], v[40:41], v[72:73]
    v_pk_add_f32 v[42:43], v[42:43], v[74:75]
    s_waitcnt vmcnt(14)
    v_pk_add_f32 v[16:17], v[16:17], v[76:77]
    v_pk_add_f32 v[18:19], v[18:19], v[78:79]
    v_pk_add_f32 v[20:21], v[20:21], v[80:81]
    v_pk_add_f32 v[22:23], v[22:23], v[82:83]
    v_pk_add_f32 v[24:25], v[24:25], v[84:85]
    v_pk_add_f32 v[26:27], v[26:27], v[86:87]
    v_pk_add_f32 v[28:29], v[28:29], v[88:89]
    v_pk_add_f32 v[30:31], v[30:31], v[90:91]
    v_pk_add_f32 v[32:33], v[32:33], v[92:93]
    v_pk_add_f32 v[34:35], v[34:35], v[94:95]
    v_pk_add_f32 v[36:37], v[36:37], v[96:97]
    v_pk_add_f32 v[38:39], v[38:39], v[98:99]
    v_pk_add_f32 v[40:41], v[40:41], v[100:101]
    v_pk_add_f32 v[42:43], v[42:43], v[102:103]
    s_waitcnt vmcnt(7)
    v_pk_add_f32 v[16:17], v[16:17], v[104:105]
    v_pk_add_f32 v[18:19], v[18:19], v[106:107]
    v_pk_add_f32 v[20:21], v[20:21], v[108:109]
    v_pk_add_f32 v[22:23], v[22:23], v[110:111]
    v_pk_add_f32 v[24:25], v[24:25], v[112:113]
    v_pk_add_f32 v[26:27], v[26:27], v[114:115]
    v_pk_add_f32 v[28:29], v[28:29], v[116:117]
    v_pk_add_f32 v[30:31], v[30:31], v[118:119]
    v_pk_add_f32 v[32:33], v[32:33], v[120:121]
    v_pk_add_f32 v[34:35], v[34:35], v[122:123]
    v_pk_add_f32 v[36:37], v[36:37], v[124:125]
    v_pk_add_f32 v[38:39], v[38:39], v[126:127]
    v_pk_add_f32 v[40:41], v[40:41], v[128:129]
    v_pk_add_f32 v[42:43], v[42:43], v[130:131]
    s_waitcnt vmcnt(0)
    v_pk_add_f32 v[16:17], v[16:17], v[132:133]
    v_pk_add_f32 v[18:19], v[18:19], v[134:135]
    v_pk_add_f32 v[20:21], v[20:21], v[136:137]
    v_pk_add_f32 v[22:23], v[22:23], v[138:139]
    v_pk_add_f32 v[24:25], v[24:25], v[140:141]
    v_pk_add_f32 v[26:27], v[26:27], v[142:143]
    v_pk_add_f32 v[28:29], v[28:29], v[144:145]
    v_pk_add_f32 v[30:31], v[30:31], v[146:147]
    v_pk_add_f32 v[32:33], v[32:33], v[148:149]
    v_pk_add_f32 v[34:35], v[34:35], v[150:151]
    v_pk_add_f32 v[36:37], v[36:37], v[152:153]
    v_pk_add_f32 v[38:39], v[38:39], v[154:155]
    v_pk_add_f32 v[40:41], v[40:41], v[156:157]
    v_pk_add_f32 v[42:43], v[42:43], v[158:159]
    s_branch interleave_layers__linear_attn_block__memory_aug_recurrent_mem_tr__prompt_kernel_k2_rd
interleave_layers__linear_attn_block__memory_aug_recurrent_mem_tr__prompt_kernel_k2m23:
    s_waitcnt vmcnt(21)
    v_pk_add_f32 v[16:17], v[16:17], v[48:49]
    v_pk_add_f32 v[18:19], v[18:19], v[50:51]
    v_pk_add_f32 v[20:21], v[20:21], v[52:53]
    v_pk_add_f32 v[22:23], v[22:23], v[54:55]
    v_pk_add_f32 v[24:25], v[24:25], v[56:57]
    v_pk_add_f32 v[26:27], v[26:27], v[58:59]
    v_pk_add_f32 v[28:29], v[28:29], v[60:61]
    v_pk_add_f32 v[30:31], v[30:31], v[62:63]
    v_pk_add_f32 v[32:33], v[32:33], v[64:65]
    v_pk_add_f32 v[34:35], v[34:35], v[66:67]
    v_pk_add_f32 v[36:37], v[36:37], v[68:69]
    v_pk_add_f32 v[38:39], v[38:39], v[70:71]
    v_pk_add_f32 v[40:41], v[40:41], v[72:73]
    v_pk_add_f32 v[42:43], v[42:43], v[74:75]
    s_waitcnt vmcnt(14)
    v_pk_add_f32 v[16:17], v[16:17], v[76:77]
    v_pk_add_f32 v[18:19], v[18:19], v[78:79]
    v_pk_add_f32 v[20:21], v[20:21], v[80:81]
    v_pk_add_f32 v[22:23], v[22:23], v[82:83]
    v_pk_add_f32 v[24:25], v[24:25], v[84:85]
    v_pk_add_f32 v[26:27], v[26:27], v[86:87]
    v_pk_add_f32 v[28:29], v[28:29], v[88:89]
    v_pk_add_f32 v[30:31], v[30:31], v[90:91]
    v_pk_add_f32 v[32:33], v[32:33], v[92:93]
    v_pk_add_f32 v[34:35], v[34:35], v[94:95]
    v_pk_add_f32 v[36:37], v[36:37], v[96:97]
    v_pk_add_f32 v[38:39], v[38:39], v[98:99]
    v_pk_add_f32 v[40:41], v[40:41], v[100:101]
    v_pk_add_f32 v[42:43], v[42:43], v[102:103]
    s_waitcnt vmcnt(7)
    v_pk_add_f32 v[16:17], v[16:17], v[104:105]
    v_pk_add_f32 v[18:19], v[18:19], v[106:107]
    v_pk_add_f32 v[20:21], v[20:21], v[108:109]
    v_pk_add_f32 v[22:23], v[22:23], v[110:111]
    v_pk_add_f32 v[24:25], v[24:25], v[112:113]
    v_pk_add_f32 v[26:27], v[26:27], v[114:115]
    v_pk_add_f32 v[28:29], v[28:29], v[116:117]
    v_pk_add_f32 v[30:31], v[30:31], v[118:119]
    v_pk_add_f32 v[32:33], v[32:33], v[120:121]
    v_pk_add_f32 v[34:35], v[34:35], v[122:123]
    v_pk_add_f32 v[36:37], v[36:37], v[124:125]
    v_pk_add_f32 v[38:39], v[38:39], v[126:127]
    v_pk_add_f32 v[40:41], v[40:41], v[128:129]
    v_pk_add_f32 v[42:43], v[42:43], v[130:131]
    s_waitcnt vmcnt(0)
    v_pk_add_f32 v[16:17], v[16:17], v[132:133]
    v_pk_add_f32 v[18:19], v[18:19], v[134:135]
    v_pk_add_f32 v[20:21], v[20:21], v[136:137]
    v_pk_add_f32 v[22:23], v[22:23], v[138:139]
    v_pk_add_f32 v[24:25], v[24:25], v[140:141]
    v_pk_add_f32 v[26:27], v[26:27], v[142:143]
    v_pk_add_f32 v[28:29], v[28:29], v[144:145]
    v_pk_add_f32 v[30:31], v[30:31], v[146:147]
    v_pk_add_f32 v[32:33], v[32:33], v[148:149]
    v_pk_add_f32 v[34:35], v[34:35], v[150:151]
    v_pk_add_f32 v[36:37], v[36:37], v[152:153]
    v_pk_add_f32 v[38:39], v[38:39], v[154:155]
    v_pk_add_f32 v[40:41], v[40:41], v[156:157]
    v_pk_add_f32 v[42:43], v[42:43], v[158:159]
    s_mul_i32 s24, s3, 7168
    v_add_u32 v6, s24, v5
    ds_write_b128 v6, v[16:19] offset:0
    ds_write_b128 v6, v[20:23] offset:1024
    ds_write_b128 v6, v[24:27] offset:2048
    ds_write_b128 v6, v[28:31] offset:3072
    ds_write_b128 v6, v[32:35] offset:4096
    ds_write_b128 v6, v[36:39] offset:5120
    ds_write_b128 v6, v[40:43] offset:6144
    s_waitcnt lgkmcnt(0)
    s_barrier
    s_mov_b32 s41, 0
    s_cmp_eq_u32 s45, 1
    s_cselect_b32 s41, 4, s41
    s_cmp_eq_u32 s45, 2
    s_cselect_b32 s41, 9, s41
    s_mov_b32 s42, 4
    s_cmp_eq_u32 s45, 1
    s_cselect_b32 s42, 5, s42
    s_cmp_eq_u32 s45, 2
    s_cselect_b32 s42, 5, s42
    s_mul_i32 s43, s92, 131072
    s_mul_i32 s24, s44, 14336
    s_add_u32 s43, s43, s24
    s_add_u32 s43, s43, 22020096
    v_and_b32 v7, 3, v2
    v_lshrrev_b32 v8, 2, v2
    s_add_u32 s40, s3, 0
    s_cmp_lt_u32 s40, s42
    s_cbranch_scc0 interleave_layers__linear_attn_block__memory_aug_recurrent_mem_tr__prompt_kernel_k2f24
    s_add_u32 s40, s40, s41
    s_mov_b32 s47, 67633672
    s_cmp_eq_u32 s40, 1
    s_cselect_b32 s47, 67699226, s47
    s_cmp_eq_u32 s40, 2
    s_cselect_b32 s47, 67702404, s47
    s_cmp_eq_u32 s40, 3
    s_cselect_b32 s47, 67765224, s47
    s_cmp_eq_u32 s40, 4
    s_cselect_b32 s47, 67765896, s47
    s_cmp_eq_u32 s40, 5
    s_cselect_b32 s47, 67831450, s47
    s_cmp_eq_u32 s40, 6
    s_cselect_b32 s47, 67833604, s47
    s_cmp_eq_u32 s40, 7
    s_cselect_b32 s47, 67897320, s47
    s_cmp_eq_u32 s40, 8
    s_cselect_b32 s47, 67899142, s47
    s_cmp_eq_u32 s40, 9
    s_cselect_b32 s47, 75497992, s47
    s_cmp_eq_u32 s40, 10
    s_cselect_b32 s47, 75499162, s47
    s_cmp_eq_u32 s40, 11
    s_cselect_b32 s47, 75501316, s47
    s_cmp_eq_u32 s40, 12
    s_cselect_b32 s47, 247768, s47
    s_cmp_eq_u32 s40, 13
    s_cselect_b32 s47, 249604, s47
    s_bfe_u32 s24, s47, 0x7000c
    s_bfe_u32 s25, s47, 0x50013
    s_bfe_u32 s26, s47, 0x30018
    v_mul_u32_u24 v9, s25, v7
    v_mul_u32_u24 v10, s26, v8
    v_add3_u32 v9, v9, v10, s24
    v_mul_u32_u24 v9, 205, v9
    v_lshrrev_b32 v9, 12, v9
    s_bfe_u32 s24, s47, 196608
    s_lshl_b32 s24, s24, 10
    v_add_u32 v10, s24, v5
    ds_read_b128 v[160:163], v10 offset:0
    ds_read_b128 v[164:167], v10 offset:7168
    ds_read_b128 v[168:171], v10 offset:14336
    ds_read_b128 v[172:175], v10 offset:21504
    s_bfe_u32 s25, s47, 196614
    s_lshl_b32 s25, s25, 4
    v_lshl_add_u32 v11, v3, 2, s25
    v_mul_u32_u24 v11, 205, v11
    v_lshrrev_b32 v11, 12, v11
    v_cmp_eq_u32 vcc, v9, v11
    s_waitcnt lgkmcnt(0)
    v_pk_add_f32 v[160:161], v[160:161], v[164:165]
    v_pk_add_f32 v[168:169], v[168:169], v[172:173]
    v_pk_add_f32 v[162:163], v[162:163], v[166:167]
    v_pk_add_f32 v[170:171], v[170:171], v[174:175]
    v_pk_add_f32 v[160:161], v[160:161], v[168:169]
    v_pk_add_f32 v[162:163], v[162:163], v[170:171]
    v_cvt_pk_bf16_f32 v176, v160, v161
    v_cvt_pk_bf16_f32 v177, v162, v163
    v_cndmask_b32 v176, 0, v176, vcc
    v_cndmask_b32 v177, 0, v177, vcc
    s_bfe_u32 s24, s47, 196611
    s_lshl_b32 s24, s24, 10
    v_add_u32 v10, s24, v5
    ds_read_b128 v[160:163], v10 offset:0
    ds_read_b128 v[164:167], v10 offset:7168
    ds_read_b128 v[168:171], v10 offset:14336
    ds_read_b128 v[172:175], v10 offset:21504
    s_bfe_u32 s25, s47, 196617
    s_lshl_b32 s25, s25, 4
    v_lshl_add_u32 v11, v3, 2, s25
    v_mul_u32_u24 v11, 205, v11
    v_lshrrev_b32 v11, 12, v11
    v_cmp_eq_u32 vcc, v9, v11
    s_waitcnt lgkmcnt(0)
    v_pk_add_f32 v[160:161], v[160:161], v[164:165]
    v_pk_add_f32 v[168:169], v[168:169], v[172:173]
    v_pk_add_f32 v[162:163], v[162:163], v[166:167]
    v_pk_add_f32 v[170:171], v[170:171], v[174:175]
    v_pk_add_f32 v[160:161], v[160:161], v[168:169]
    v_pk_add_f32 v[162:163], v[162:163], v[170:171]
    v_cvt_pk_bf16_f32 v178, v160, v161
    v_cvt_pk_bf16_f32 v179, v162, v163
    v_cndmask_b32 v178, 0, v178, vcc
    v_cndmask_b32 v179, 0, v179, vcc
    s_lshl_b32 s24, s40, 10
    s_add_u32 s24, s24, s43
    buffer_store_dwordx4 v[176:179], v5, s[8:11], s24 offen sc1
interleave_layers__linear_attn_block__memory_aug_recurrent_mem_tr__prompt_kernel_k2f24:
    s_add_u32 s40, s3, 4
    s_cmp_lt_u32 s40, s42
    s_cbranch_scc0 interleave_layers__linear_attn_block__memory_aug_recurrent_mem_tr__prompt_kernel_k2f25
    s_add_u32 s40, s40, s41
    s_mov_b32 s47, 67633672
    s_cmp_eq_u32 s40, 1
    s_cselect_b32 s47, 67699226, s47
    s_cmp_eq_u32 s40, 2
    s_cselect_b32 s47, 67702404, s47
    s_cmp_eq_u32 s40, 3
    s_cselect_b32 s47, 67765224, s47
    s_cmp_eq_u32 s40, 4
    s_cselect_b32 s47, 67765896, s47
    s_cmp_eq_u32 s40, 5
    s_cselect_b32 s47, 67831450, s47
    s_cmp_eq_u32 s40, 6
    s_cselect_b32 s47, 67833604, s47
    s_cmp_eq_u32 s40, 7
    s_cselect_b32 s47, 67897320, s47
    s_cmp_eq_u32 s40, 8
    s_cselect_b32 s47, 67899142, s47
    s_cmp_eq_u32 s40, 9
    s_cselect_b32 s47, 75497992, s47
    s_cmp_eq_u32 s40, 10
    s_cselect_b32 s47, 75499162, s47
    s_cmp_eq_u32 s40, 11
    s_cselect_b32 s47, 75501316, s47
    s_cmp_eq_u32 s40, 12
    s_cselect_b32 s47, 247768, s47
    s_cmp_eq_u32 s40, 13
    s_cselect_b32 s47, 249604, s47
    s_bfe_u32 s24, s47, 0x7000c
    s_bfe_u32 s25, s47, 0x50013
    s_bfe_u32 s26, s47, 0x30018
    v_mul_u32_u24 v9, s25, v7
    v_mul_u32_u24 v10, s26, v8
    v_add3_u32 v9, v9, v10, s24
    v_mul_u32_u24 v9, 205, v9
    v_lshrrev_b32 v9, 12, v9
    s_bfe_u32 s24, s47, 196608
    s_lshl_b32 s24, s24, 10
    v_add_u32 v10, s24, v5
    ds_read_b128 v[160:163], v10 offset:0
    ds_read_b128 v[164:167], v10 offset:7168
    ds_read_b128 v[168:171], v10 offset:14336
    ds_read_b128 v[172:175], v10 offset:21504
    s_bfe_u32 s25, s47, 196614
    s_lshl_b32 s25, s25, 4
    v_lshl_add_u32 v11, v3, 2, s25
    v_mul_u32_u24 v11, 205, v11
    v_lshrrev_b32 v11, 12, v11
    v_cmp_eq_u32 vcc, v9, v11
    s_waitcnt lgkmcnt(0)
    v_pk_add_f32 v[160:161], v[160:161], v[164:165]
    v_pk_add_f32 v[168:169], v[168:169], v[172:173]
    v_pk_add_f32 v[162:163], v[162:163], v[166:167]
    v_pk_add_f32 v[170:171], v[170:171], v[174:175]
    v_pk_add_f32 v[160:161], v[160:161], v[168:169]
    v_pk_add_f32 v[162:163], v[162:163], v[170:171]
    v_cvt_pk_bf16_f32 v176, v160, v161
    v_cvt_pk_bf16_f32 v177, v162, v163
    v_cndmask_b32 v176, 0, v176, vcc
    v_cndmask_b32 v177, 0, v177, vcc
    s_bfe_u32 s24, s47, 196611
    s_lshl_b32 s24, s24, 10
    v_add_u32 v10, s24, v5
    ds_read_b128 v[160:163], v10 offset:0
    ds_read_b128 v[164:167], v10 offset:7168
    ds_read_b128 v[168:171], v10 offset:14336
    ds_read_b128 v[172:175], v10 offset:21504
    s_bfe_u32 s25, s47, 196617
    s_lshl_b32 s25, s25, 4
    v_lshl_add_u32 v11, v3, 2, s25
    v_mul_u32_u24 v11, 205, v11
    v_lshrrev_b32 v11, 12, v11
    v_cmp_eq_u32 vcc, v9, v11
    s_waitcnt lgkmcnt(0)
    v_pk_add_f32 v[160:161], v[160:161], v[164:165]
    v_pk_add_f32 v[168:169], v[168:169], v[172:173]
    v_pk_add_f32 v[162:163], v[162:163], v[166:167]
    v_pk_add_f32 v[170:171], v[170:171], v[174:175]
    v_pk_add_f32 v[160:161], v[160:161], v[168:169]
    v_pk_add_f32 v[162:163], v[162:163], v[170:171]
    v_cvt_pk_bf16_f32 v178, v160, v161
    v_cvt_pk_bf16_f32 v179, v162, v163
    v_cndmask_b32 v178, 0, v178, vcc
    v_cndmask_b32 v179, 0, v179, vcc
    s_lshl_b32 s24, s40, 10
    s_add_u32 s24, s24, s43
    buffer_store_dwordx4 v[176:179], v5, s[8:11], s24 offen sc1
interleave_layers__linear_attn_block__memory_aug_recurrent_mem_tr__prompt_kernel_k2f25:
    s_waitcnt vmcnt(0)
    s_barrier
    s_lshl_b32 s24, s92, 7
    s_sub_u32 s25, s2, 64
    s_lshl_b32 s25, s25, 2
    s_add_u32 s24, s24, s25
    s_add_u32 s24, s24, 23103488
    s_cmp_eq_u32 s3, 0
    s_cbranch_scc0 interleave_layers__linear_attn_block__memory_aug_recurrent_mem_tr__prompt_kernel_pb26
    v_lshlrev_b32 v14, 7, v1
    v_add_u32 v14, s24, v14
    v_mov_b32 v15, 2146435072
    v_cmp_le_u32 vcc, 1, v1
    s_nop 1
    v_cndmask_b32 v14, v14, v15, vcc
    v_mov_b32 v15, 1
    buffer_store_dword v15, v14, s[8:11], 0 offen sc1
interleave_layers__linear_attn_block__memory_aug_recurrent_mem_tr__prompt_kernel_pb26:
interleave_layers__linear_attn_block__memory_aug_recurrent_mem_tr__prompt_kernel_rk22:
    s_sub_u32 s44, s2, 64
    v_lshlrev_b32 v5, 4, v1
    s_lshl_b32 s24, s44, 15
    s_lshl_b32 s25, s3, 13
    s_add_u32 s24, s24, s25
    v_add_u32 v6, s24, v5
    v_add_u32 v7, 4096, v6
    s_lshl_b32 s24, s3, 12
    v_add_u32 v8, s24, v5
    s_lshl_b32 s24, s3, 10
    s_add_u32 s24, s24, 16384
    v_add_u32 v9, s24, v5
    s_lshl_b32 s24, s44, 13
    s_lshl_b32 s25, s3, 11
    s_add_u32 s24, s24, s25
    v_add_u32 v10, s24, v5
    v_and_b32 v204, 7, v2
    v_mul_u32_u24 v11, 80, v204
    v_lshl_add_u32 v11, v3, 4, v11
    s_mul_i32 s24, s3, 640
    v_add_u32 v11, s24, v11
    v_add_u32 v204, 8192, v5
    v_cmp_gt_u32 vcc, 8, v2
    s_nop 1
    v_cndmask_b32 v11, v204, v11, vcc
    v_and_b32 v204, 7, v2
    v_mul_u32_u24 v12, 80, v204
    v_lshrrev_b32 v204, 3, v2
    v_lshl_add_u32 v12, v204, 5, v12
    v_lshlrev_b32 v13, 4, v2
    s_lshl_b32 s24, s44, 8
    v_add_u32 v13, s24, v13
    v_mov_b32 v204, 2146435072
    v_cmp_gt_u32 vcc, 1, v3
    s_nop 1
    v_cndmask_b32 v13, v204, v13, vcc
    v_cmp_le_u32 s[50:51], 8, v2
    s_and_b32 s25, s44, 15
    s_lshr_b32 s25, s25, 2
    s_sub_u32 s26, s44, 32
    s_lshr_b32 s26, s26, 1
    s_cmp_ge_u32 s44, 32
    s_cselect_b32 s25, s26, s25
    s_mul_i32 s24, s25, 16
    v_add_u32 v120, s24, v1
    v_lshlrev_b32 v120, 7, v120
    v_mov_b32 v204, 2146435072
    v_cmp_le_u32 vcc, 16, v1
    s_nop 1
    v_cndmask_b32 v120, v120, v204, vcc
    s_and_b32 s24, s44, 7
    s_mul_i32 s25, s3, 8
    s_add_u32 s24, s24, s25
    s_lshl_b32 s24, s24, 7
    v_mov_b32 v125, s24
    v_mov_b32 v122, 12288
    v_mov_b32 v123, 0
    s_barrier
    ds_write_b32 v122, v123
    v_mov_b32 v123, 1
    s_waitcnt lgkmcnt(0)
    s_barrier
    s_mul_i32 s93, s92, 29360128
    s_add_u32 s93, s93, 117440512
    s_mul_i32 s94, s92, 16384
    s_add_u32 s94, s94, 23068672
    s_mov_b32 s40, 0
    s_mov_b32 s41, 184549376
    s_add_u32 s45, s93, 448512
    s_add_u32 s46, s93, 440320
    s_add_u32 s43, s93, 409600
    s_add_u32 s42, s93, 0
    s_add_u32 s47, s93, 430080
    v_and_b32 v252, 7, v1
    v_lshlrev_b32 v252, 7, v252
    s_lshl_b32 s24, s3, 10
    s_add_u32 s24, s24, 12288
    s_add_u32 s24, s24, s94
    v_add_u32 v252, s24, v252
    s_mov_b32 s62, -1
    s_mov_b32 s63, 1
    s_cmp_ge_i32 s62, s63
    s_cbranch_scc1 interleave_layers__linear_attn_block__memory_aug_recurrent_mem_tr__prompt_kernel_r_en0_ok
    s_mov_b32 s61, 0
interleave_layers__linear_attn_block__memory_aug_recurrent_mem_tr__prompt_kernel_r_en0:
    buffer_load_dword v253, v252, s[8:11], 0 offen sc1
    s_waitcnt vmcnt(0)
    v_readlane_b32 s62, v253, 0
    v_readlane_b32 s24, v253, 1
    s_min_i32 s62, s62, s24
    v_readlane_b32 s24, v253, 2
    s_min_i32 s62, s62, s24
    v_readlane_b32 s24, v253, 3
    s_min_i32 s62, s62, s24
    v_readlane_b32 s24, v253, 4
    s_min_i32 s62, s62, s24
    v_readlane_b32 s24, v253, 5
    s_min_i32 s62, s62, s24
    v_readlane_b32 s24, v253, 6
    s_min_i32 s62, s62, s24
    v_readlane_b32 s24, v253, 7
    s_min_i32 s62, s62, s24
    s_cmp_ge_i32 s62, s63
    s_cbranch_scc1 interleave_layers__linear_attn_block__memory_aug_recurrent_mem_tr__prompt_kernel_r_en0_ok
    s_add_u32 s61, s61, 1
    s_cmp_ge_u32 s61, s60
    s_cbranch_scc1 interleave_layers__linear_attn_block__memory_aug_recurrent_mem_tr__prompt_kernel_r_en0_to
    s_sleep 2
    s_branch interleave_layers__linear_attn_block__memory_aug_recurrent_mem_tr__prompt_kernel_r_en0
interleave_layers__linear_attn_block__memory_aug_recurrent_mem_tr__prompt_kernel_r_en0_to:
    s_mov_b32 s60, 1
interleave_layers__linear_attn_block__memory_aug_recurrent_mem_tr__prompt_kernel_r_en0_ok:
    buffer_load_dwordx4 v[48:51], v6, s[8:11], s41 offen offset:0 sc1
    buffer_load_dwordx4 v[52:55], v6, s[8:11], s41 offen offset:1024 sc1
    buffer_load_dwordx4 v[56:59], v6, s[8:11], s41 offen offset:2048 sc1
    buffer_load_dwordx4 v[60:63], v6, s[8:11], s41 offen offset:3072 sc1
    buffer_load_dwordx4 v[64:67], v7, s[8:11], s41 offen offset:0 sc1
    buffer_load_dwordx4 v[68:71], v7, s[8:11], s41 offen offset:1024 sc1
    buffer_load_dwordx4 v[72:75], v7, s[8:11], s41 offen offset:2048 sc1
    buffer_load_dwordx4 v[76:79], v7, s[8:11], s41 offen offset:3072 sc1
    s_add_u32 s41, s41, 1310720
interleave_layers__linear_attn_block__memory_aug_recurrent_mem_tr__prompt_kernel_r_step:
    s_waitcnt vmcnt(0)
    v_mov_b32 v16, v48
    v_mov_b32 v17, v49
    v_mov_b32 v18, v50
    v_mov_b32 v19, v51
    v_mov_b32 v20, v52
    v_mov_b32 v21, v53
    v_mov_b32 v22, v54
    v_mov_b32 v23, v55
    v_mov_b32 v24, v56
    v_mov_b32 v25, v57
    v_mov_b32 v26, v58
    v_mov_b32 v27, v59
    v_mov_b32 v28, v60
    v_mov_b32 v29, v61
    v_mov_b32 v30, v62
    v_mov_b32 v31, v63
    v_mov_b32 v32, v64
    v_mov_b32 v33, v65
    v_mov_b32 v34, v66
    v_mov_b32 v35, v67
    v_mov_b32 v36, v68
    v_mov_b32 v37, v69
    v_mov_b32 v38, v70
    v_mov_b32 v39, v71
    v_mov_b32 v40, v72
    v_mov_b32 v41, v73
    v_mov_b32 v42, v74
    v_mov_b32 v43, v75
    v_mov_b32 v44, v76
    v_mov_b32 v45, v77
    v_mov_b32 v46, v78
    v_mov_b32 v47, v79
    s_lshl_b32 s95, s92, 6
    s_add_u32 s95, s95, s40
    s_add_u32 s95, s95, 1
    s_cmp_ge_i32 s59, s95
    s_cbranch_scc1 interleave_layers__linear_attn_block__memory_aug_recurrent_mem_tr__prompt_kernel_r_ec_ok
    s_and_b32 s24, s2, 7
    s_lshl_b32 s24, s24, 7
    s_add_u32 s24, s24, 23109632
    v_and_b32 v254, 3, v1
    v_lshl_add_u32 v254, v254, 2, s24
    s_mov_b32 s61, 0
interleave_layers__linear_attn_block__memory_aug_recurrent_mem_tr__prompt_kernel_r_ec:
    buffer_load_dword v253, v254, s[8:11], 0 offen sc1
    s_waitcnt vmcnt(0)
    v_readlane_b32 s59, v253, 0
    v_readlane_b32 s24, v253, 1
    s_min_i32 s59, s59, s24
    v_readlane_b32 s24, v253, 2
    s_min_i32 s59, s59, s24
    s_cmp_ge_i32 s59, s95
    s_cbranch_scc1 interleave_layers__linear_attn_block__memory_aug_recurrent_mem_tr__prompt_kernel_r_ec_ok
    s_add_u32 s61, s61, 1
    s_cmp_ge_u32 s61, s60
    s_cbranch_scc1 interleave_layers__linear_attn_block__memory_aug_recurrent_mem_tr__prompt_kernel_r_ec_to
    s_sleep 2
    s_branch interleave_layers__linear_attn_block__memory_aug_recurrent_mem_tr__prompt_kernel_r_ec
interleave_layers__linear_attn_block__memory_aug_recurrent_mem_tr__prompt_kernel_r_ec_to:
    s_mov_b32 s60, 1
interleave_layers__linear_attn_block__memory_aug_recurrent_mem_tr__prompt_kernel_r_ec_ok:
    s_mov_b64 exec, 1
    s_mov_b32 s61, 0
    v_mov_b32 v117, 0
    buffer_atomic_add v117, v125, s[8:11], s45 offen sc0
    s_sleep 2
    v_mov_b32 v118, 0
    buffer_atomic_add v118, v125, s[8:11], s45 offen sc0
    s_sleep 2
    v_mov_b32 v119, 0
    buffer_atomic_add v119, v125, s[8:11], s45 offen sc0
    s_sleep 2
interleave_layers__linear_attn_block__memory_aug_recurrent_mem_tr__prompt_kernel_r_pr:
    v_mov_b32 v116, 0
    buffer_atomic_add v116, v125, s[8:11], s45 offen sc0
    s_waitcnt vmcnt(3)
    v_cmp_le_i32 vcc, 7, v117
    s_add_u32 s61, s61, 1
    s_cbranch_vccnz interleave_layers__linear_attn_block__memory_aug_recurrent_mem_tr__prompt_kernel_r_pr_out
    s_sleep 2
    v_mov_b32 v117, 0
    buffer_atomic_add v117, v125, s[8:11], s45 offen sc0
    s_waitcnt vmcnt(3)
    v_cmp_le_i32 vcc, 7, v118
    s_add_u32 s61, s61, 1
    s_cbranch_vccnz interleave_layers__linear_attn_block__memory_aug_recurrent_mem_tr__prompt_kernel_r_pr_out
    s_sleep 2
    v_mov_b32 v118, 0
    buffer_atomic_add v118, v125, s[8:11], s45 offen sc0
    s_waitcnt vmcnt(3)
    v_cmp_le_i32 vcc, 7, v119
    s_add_u32 s61, s61, 1
    s_cbranch_vccnz interleave_layers__linear_attn_block__memory_aug_recurrent_mem_tr__prompt_kernel_r_pr_out
    s_sleep 2
    v_mov_b32 v119, 0
    buffer_atomic_add v119, v125, s[8:11], s45 offen sc0
    s_waitcnt vmcnt(3)
    v_cmp_le_i32 vcc, 7, v116
    s_add_u32 s61, s61, 1
    s_cbranch_vccnz interleave_layers__linear_attn_block__memory_aug_recurrent_mem_tr__prompt_kernel_r_pr_out
    s_sleep 2
    s_cmp_ge_u32 s61, s60
    s_cbranch_scc0 interleave_layers__linear_attn_block__memory_aug_recurrent_mem_tr__prompt_kernel_r_pr
    s_mov_b32 s60, 1
interleave_layers__linear_attn_block__memory_aug_recurrent_mem_tr__prompt_kernel_r_pr_out:
    s_mov_b64 exec, -1
    buffer_load_dwordx4 v[100:103], v10, s[8:11], s42 offen offset:0 sc1
    buffer_load_dwordx4 v[104:107], v10, s[8:11], s42 offen offset:1024 sc1
    buffer_load_dwordx4 v[80:83], v8, s[8:11], s43 offen offset:0 sc1
    buffer_load_dwordx4 v[84:87], v8, s[8:11], s43 offen offset:1024 sc1
    buffer_load_dwordx4 v[88:91], v8, s[8:11], s43 offen offset:2048 sc1
    buffer_load_dwordx4 v[92:95], v8, s[8:11], s43 offen offset:3072 sc1
    buffer_load_dwordx4 v[96:99], v9, s[8:11], s43 offen sc1
    s_waitcnt vmcnt(0)
    v_max3_u32 v204, v80, v81, v82
    v_max3_u32 v204, v204, v83, v84
    v_max3_u32 v204, v204, v85, v86
    v_max3_u32 v204, v204, v87, v88
    v_max3_u32 v204, v204, v89, v90
    v_max3_u32 v204, v204, v91, v92
    v_max3_u32 v204, v204, v93, v94
    v_max3_u32 v204, v204, v95, v96
    v_max3_u32 v204, v204, v97, v98
    v_max3_u32 v204, v204, v99, v100
    v_max3_u32 v204, v204, v101, v102
    v_max3_u32 v204, v204, v103, v104
    v_max3_u32 v204, v204, v105, v106
    v_max_u32 v204, v204, v107
    v_cmp_eq_u32 vcc, -1, v204
    s_cbranch_vccz interleave_layers__linear_attn_block__memory_aug_recurrent_mem_tr__prompt_kernel_r_p_out
    s_mov_b32 s61, 0
interleave_layers__linear_attn_block__memory_aug_recurrent_mem_tr__prompt_kernel_r_p:
    buffer_load_dwordx4 v[100:103], v10, s[8:11], s42 offen offset:0 sc1
    buffer_load_dwordx4 v[104:107], v10, s[8:11], s42 offen offset:1024 sc1
    buffer_load_dwordx4 v[80:83], v8, s[8:11], s43 offen offset:0 sc1
    buffer_load_dwordx4 v[84:87], v8, s[8:11], s43 offen offset:1024 sc1
    buffer_load_dwordx4 v[88:91], v8, s[8:11], s43 offen offset:2048 sc1
    buffer_load_dwordx4 v[92:95], v8, s[8:11], s43 offen offset:3072 sc1
    buffer_load_dwordx4 v[96:99], v9, s[8:11], s43 offen sc1
    s_waitcnt vmcnt(0)
    v_max3_u32 v204, v80, v81, v82
    v_max3_u32 v204, v204, v83, v84
    v_max3_u32 v204, v204, v85, v86
    v_max3_u32 v204, v204, v87, v88
    v_max3_u32 v204, v204, v89, v90
    v_max3_u32 v204, v204, v91, v92
    v_max3_u32 v204, v204, v93, v94
    v_max3_u32 v204, v204, v95, v96
    v_max3_u32 v204, v204, v97, v98
    v_max3_u32 v204, v204, v99, v100
    v_max3_u32 v204, v204, v101, v102
    v_max3_u32 v204, v204, v103, v104
    v_max3_u32 v204, v204, v105, v106
    v_max_u32 v204, v204, v107
    v_cmp_eq_u32 vcc, -1, v204
    s_add_u32 s61, s61, 1
    s_cbranch_vccz interleave_layers__linear_attn_block__memory_aug_recurrent_mem_tr__prompt_kernel_r_p_out
    s_cmp_ge_u32 s61, s60
    s_cbranch_scc1 interleave_layers__linear_attn_block__memory_aug_recurrent_mem_tr__prompt_kernel_r_p_to
    s_sleep 1
    s_branch interleave_layers__linear_attn_block__memory_aug_recurrent_mem_tr__prompt_kernel_r_p
interleave_layers__linear_attn_block__memory_aug_recurrent_mem_tr__prompt_kernel_r_p_to:
    s_mov_b32 s60, 1
interleave_layers__linear_attn_block__memory_aug_recurrent_mem_tr__prompt_kernel_r_p_out:
    s_mov_b64 exec, 1
    ds_add_rtn_u32 v124, v122, v123
    s_mov_b64 exec, -1
    v_mfma_f32_16x16x32_bf16 v[108:111], v[100:103], v[96:99], 0
    v_mfma_f32_16x16x32_bf16 v[112:115], v[104:107], v[96:99], 0
    v_mfma_f32_16x16x32_bf16 v[108:111], v[16:19], v[80:83], v[108:111]
    v_mfma_f32_16x16x32_bf16 v[112:115], v[20:23], v[80:83], v[112:115]
    s_waitcnt lgkmcnt(0)
    v_readfirstlane_b32 s24, v124
    s_and_b32 s24, s24, 3
    s_cmp_eq_u32 s24, 3
    s_cbranch_scc0 interleave_layers__linear_attn_block__memory_aug_recurrent_mem_tr__prompt_kernel_nh27
    buffer_atomic_add v123, v120, s[8:11], s46 offen
interleave_layers__linear_attn_block__memory_aug_recurrent_mem_tr__prompt_kernel_nh27:
    v_mfma_f32_16x16x32_bf16 v[108:111], v[24:27], v[84:87], v[108:111]
    v_mfma_f32_16x16x32_bf16 v[112:115], v[28:31], v[84:87], v[112:115]
    v_mfma_f32_16x16x32_bf16 v[108:111], v[32:35], v[88:91], v[108:111]
    v_mfma_f32_16x16x32_bf16 v[112:115], v[36:39], v[88:91], v[112:115]
    v_mfma_f32_16x16x32_bf16 v[108:111], v[40:43], v[92:95], v[108:111]
    v_mfma_f32_16x16x32_bf16 v[112:115], v[44:47], v[92:95], v[112:115]
    s_and_b32 s24, s40, 1
    s_mul_i32 s24, s24, 2560
    v_add_u32 v14, s24, v11
    v_add_u32 v15, s24, v12
    s_nop 3
    v_cndmask_b32 v108, v108, v112, s[50:51]
    v_cndmask_b32 v109, v109, v113, s[50:51]
    v_cndmask_b32 v110, v110, v114, s[50:51]
    v_cndmask_b32 v111, v111, v115, s[50:51]
    v_add_f32 v108, v108, v108 row_ror:8 row_mask:0xf bank_mask:0xf
    v_add_f32 v109, v109, v109 row_ror:8 row_mask:0xf bank_mask:0xf
    v_add_f32 v110, v110, v110 row_ror:8 row_mask:0xf bank_mask:0xf
    v_add_f32 v111, v111, v111 row_ror:8 row_mask:0xf bank_mask:0xf
    ds_write_b128 v14, v[108:111]
    s_waitcnt lgkmcnt(0)
    s_barrier
    s_cmp_eq_u32 s3, 0
    s_cbranch_scc0 interleave_layers__linear_attn_block__memory_aug_recurrent_mem_tr__prompt_kernel_np28
    ds_read_b128 v[220:223], v15 offset:0
    ds_read_b128 v[224:227], v15 offset:16
    ds_read_b128 v[228:231], v15 offset:640
    ds_read_b128 v[232:235], v15 offset:656
    ds_read_b128 v[236:239], v15 offset:1280
    ds_read_b128 v[240:243], v15 offset:1296
    ds_read_b128 v[244:247], v15 offset:1920
    ds_read_b128 v[248:251], v15 offset:1936
    s_waitcnt lgkmcnt(4)
    v_pk_add_f32 v[220:221], v[220:221], v[228:229]
    v_pk_add_f32 v[222:223], v[222:223], v[230:231]
    v_pk_add_f32 v[224:225], v[224:225], v[232:233]
    v_pk_add_f32 v[226:227], v[226:227], v[234:235]
    s_waitcnt lgkmcnt(0)
    v_pk_add_f32 v[236:237], v[236:237], v[244:245]
    v_pk_add_f32 v[238:239], v[238:239], v[246:247]
    v_pk_add_f32 v[240:241], v[240:241], v[248:249]
    v_pk_add_f32 v[242:243], v[242:243], v[250:251]
    v_pk_add_f32 v[220:221], v[220:221], v[236:237]
    v_pk_add_f32 v[222:223], v[222:223], v[238:239]
    v_pk_add_f32 v[224:225], v[224:225], v[240:241]
    v_pk_add_f32 v[226:227], v[226:227], v[242:243]
    v_cvt_pk_bf16_f32 v228, v220, v221
    v_cvt_pk_bf16_f32 v229, v222, v223
    v_cvt_pk_bf16_f32 v230, v224, v225
    v_cvt_pk_bf16_f32 v231, v226, v227
    v_min_u32 v228, -2, v228
    v_min_u32 v229, -2, v229
    v_min_u32 v230, -2, v230
    v_min_u32 v231, -2, v231
    buffer_store_dwordx4 v[228:231], v13, s[8:11], s47 offen sc1
interleave_layers__linear_attn_block__memory_aug_recurrent_mem_tr__prompt_kernel_np28:
    s_add_u32 s63, s40, 2
    s_min_u32 s63, s63, 64
    s_sleep 20
    s_cmp_ge_i32 s62, s63
    s_cbranch_scc1 interleave_layers__linear_attn_block__memory_aug_recurrent_mem_tr__prompt_kernel_r_en_ok
    s_mov_b32 s61, 0
interleave_layers__linear_attn_block__memory_aug_recurrent_mem_tr__prompt_kernel_r_en:
    buffer_load_dword v253, v252, s[8:11], 0 offen sc1
    s_waitcnt vmcnt(0)
    v_readlane_b32 s62, v253, 0
    v_readlane_b32 s24, v253, 1
    s_min_i32 s62, s62, s24
    v_readlane_b32 s24, v253, 2
    s_min_i32 s62, s62, s24
    v_readlane_b32 s24, v253, 3
    s_min_i32 s62, s62, s24
    v_readlane_b32 s24, v253, 4
    s_min_i32 s62, s62, s24
    v_readlane_b32 s24, v253, 5
    s_min_i32 s62, s62, s24
    v_readlane_b32 s24, v253, 6
    s_min_i32 s62, s62, s24
    v_readlane_b32 s24, v253, 7
    s_min_i32 s62, s62, s24
    s_cmp_ge_i32 s62, s63
    s_cbranch_scc1 interleave_layers__linear_attn_block__memory_aug_recurrent_mem_tr__prompt_kernel_r_en_ok
    s_add_u32 s61, s61, 1
    s_cmp_ge_u32 s61, s60
    s_cbranch_scc1 interleave_layers__linear_attn_block__memory_aug_recurrent_mem_tr__prompt_kernel_r_en_to
    s_sleep 2
    s_branch interleave_layers__linear_attn_block__memory_aug_recurrent_mem_tr__prompt_kernel_r_en
interleave_layers__linear_attn_block__memory_aug_recurrent_mem_tr__prompt_kernel_r_en_to:
    s_mov_b32 s60, 1
interleave_layers__linear_attn_block__memory_aug_recurrent_mem_tr__prompt_kernel_r_en_ok:
    buffer_load_dwordx4 v[48:51], v6, s[8:11], s41 offen offset:0 sc1
    buffer_load_dwordx4 v[52:55], v6, s[8:11], s41 offen offset:1024 sc1
    buffer_load_dwordx4 v[56:59], v6, s[8:11], s41 offen offset:2048 sc1
    buffer_load_dwordx4 v[60:63], v6, s[8:11], s41 offen offset:3072 sc1
    buffer_load_dwordx4 v[64:67], v7, s[8:11], s41 offen offset:0 sc1
    buffer_load_dwordx4 v[68:71], v7, s[8:11], s41 offen offset:1024 sc1
    buffer_load_dwordx4 v[72:75], v7, s[8:11], s41 offen offset:2048 sc1
    buffer_load_dwordx4 v[76:79], v7, s[8:11], s41 offen offset:3072 sc1
    s_add_u32 s41, s41, 1310720
    s_add_u32 s40, s40, 1
    s_add_u32 s42, s42, 458752
    s_add_u32 s43, s43, 458752
    s_add_u32 s47, s47, 458752
    s_add_u32 s45, s45, 458752
    s_add_u32 s46, s46, 458752
    s_cmp_lt_u32 s40, 64
    s_cbranch_scc1 interleave_layers__linear_attn_block__memory_aug_recurrent_mem_tr__prompt_kernel_r_step
    s_waitcnt vmcnt(0)
    s_cmp_eq_u32 s92, 0
    s_cbranch_scc0 interleave_layers__linear_attn_block__memory_aug_recurrent_mem_tr__prompt_kernel_end
    s_mov_b32 s92, 1
    s_branch interleave_layers__linear_attn_block__memory_aug_recurrent_mem_tr__prompt_kernel_r_top
interleave_layers__linear_attn_block__memory_aug_recurrent_mem_tr__prompt_kernel_roleP:
    s_sub_u32 s44, s2, 104
    s_lshr_b32 s46, s44, 5
    s_and_b32 s44, s44, 31
    s_load_dwordx2 s[6:7], s[0:1], 40
    s_load_dwordx2 s[24:25], s[0:1], 48
    s_load_dwordx2 s[26:27], s[0:1], 56
    s_waitcnt lgkmcnt(0)
    s_cmp_eq_u32 s46, 1
    s_cselect_b32 s6, s24, s6
    s_cselect_b32 s7, s25, s7
    s_cmp_eq_u32 s46, 2
    s_cselect_b32 s6, s26, s6
    s_cselect_b32 s7, s27, s7
    s_mov_b32 s12, s6
    s_mov_b32 s13, s7
    s_mov_b32 s14, 7864320
    s_mov_b32 s15, 0x00020000
    v_add_u32 v16, 0, v0
    s_mov_b32 s24, 683
    v_mul_lo_u32 v17, v16, s24
    v_lshrrev_b32 v17, 14, v17
    v_mul_u32_u24 v18, 24, v17
    v_sub_u32 v18, v16, v18
    s_mov_b32 s24, 12288
    v_mul_lo_u32 v4, v17, s24
    v_lshl_add_u32 v4, v18, 4, v4
    v_mul_u32_u24 v10, 400, v17
    v_lshl_add_u32 v10, v18, 4, v10
    v_add_u32 v10, 81920, v10
    v_add_u32 v16, 256, v0
    s_mov_b32 s24, 683
    v_mul_lo_u32 v17, v16, s24
    v_lshrrev_b32 v17, 14, v17
    v_mul_u32_u24 v18, 24, v17
    v_sub_u32 v18, v16, v18
    s_mov_b32 s24, 12288
    v_mul_lo_u32 v5, v17, s24
    v_lshl_add_u32 v5, v18, 4, v5
    v_mul_u32_u24 v11, 400, v17
    v_lshl_add_u32 v11, v18, 4, v11
    v_add_u32 v11, 81920, v11
    v_add_u32 v16, 512, v0
    s_mov_b32 s24, 683
    v_mul_lo_u32 v17, v16, s24
    v_lshrrev_b32 v17, 14, v17
    v_mul_u32_u24 v18, 24, v17
    v_sub_u32 v18, v16, v18
    s_mov_b32 s24, 12288
    v_mul_lo_u32 v6, v17, s24
    v_lshl_add_u32 v6, v18, 4, v6
    v_mul_u32_u24 v12, 400, v17
    v_lshl_add_u32 v12, v18, 4, v12
    v_add_u32 v12, 81920, v12
    v_add_u32 v16, 768, v0
    s_mov_b32 s24, 683
    v_mul_lo_u32 v17, v16, s24
    v_lshrrev_b32 v17, 14, v17
    v_mul_u32_u24 v18, 24, v17
    v_sub_u32 v18, v16, v18
    s_mov_b32 s24, 12288
    v_mul_lo_u32 v7, v17, s24
    v_lshl_add_u32 v7, v18, 4, v7
    v_mul_u32_u24 v13, 400, v17
    v_lshl_add_u32 v13, v18, 4, v13
    v_add_u32 v13, 81920, v13
    v_add_u32 v16, 1024, v0
    s_mov_b32 s24, 683
    v_mul_lo_u32 v17, v16, s24
    v_lshrrev_b32 v17, 14, v17
    v_mul_u32_u24 v18, 24, v17
    v_sub_u32 v18, v16, v18
    s_mov_b32 s24, 12288
    v_mul_lo_u32 v8, v17, s24
    v_lshl_add_u32 v8, v18, 4, v8
    v_mul_u32_u24 v14, 400, v17
    v_lshl_add_u32 v14, v18, 4, v14
    v_add_u32 v14, 81920, v14
    v_add_u32 v16, 1280, v0
    s_mov_b32 s24, 683
    v_mul_lo_u32 v17, v16, s24
    v_lshrrev_b32 v17, 14, v17
    v_mul_u32_u24 v18, 24, v17
    v_sub_u32 v18, v16, v18
    s_mov_b32 s24, 12288
    v_mul_lo_u32 v9, v17, s24
    v_lshl_add_u32 v9, v18, 4, v9
    v_mul_u32_u24 v15, 400, v17
    v_lshl_add_u32 v15, v18, 4, v15
    v_add_u32 v15, 81920, v15
    v_lshrrev_b32 v16, 2, v2
    v_lshl_add_u32 v16, v3, 2, v16
    v_mul_u32_u24 v32, 400, v16
    v_and_b32 v16, 3, v2
    v_lshl_add_u32 v32, v16, 3, v32
    s_mul_i32 s24, s3, 96
    s_add_u32 s24, s24, 81920
    v_add_u32 v32, s24, v32
    s_mul_i32 s45, s44, 384
    s_add_u32 s47, s45, 0
    buffer_load_dwordx4 v[56:59], v4, s[12:15], s47 offen
    buffer_load_dwordx4 v[60:63], v5, s[12:15], s47 offen
    buffer_load_dwordx4 v[64:67], v6, s[12:15], s47 offen
    buffer_load_dwordx4 v[68:71], v7, s[12:15], s47 offen
    buffer_load_dwordx4 v[72:75], v8, s[12:15], s47 offen
    buffer_load_dwordx4 v[76:79], v9, s[12:15], s47 offen
    s_add_u32 s47, s45, 786432
    buffer_load_dwordx4 v[80:83], v4, s[12:15], s47 offen
    buffer_load_dwordx4 v[84:87], v5, s[12:15], s47 offen
    buffer_load_dwordx4 v[88:91], v6, s[12:15], s47 offen
    buffer_load_dwordx4 v[92:95], v7, s[12:15], s47 offen
    buffer_load_dwordx4 v[96:99], v8, s[12:15], s47 offen
    buffer_load_dwordx4 v[100:103], v9, s[12:15], s47 offen
    s_add_u32 s47, s45, 1572864
    buffer_load_dwordx4 v[104:107], v4, s[12:15], s47 offen
    buffer_load_dwordx4 v[108:111], v5, s[12:15], s47 offen
    buffer_load_dwordx4 v[112:115], v6, s[12:15], s47 offen
    buffer_load_dwordx4 v[116:119], v7, s[12:15], s47 offen
    buffer_load_dwordx4 v[120:123], v8, s[12:15], s47 offen
    buffer_load_dwordx4 v[124:127], v9, s[12:15], s47 offen
    s_add_u32 s47, s45, 2359296
    buffer_load_dwordx4 v[128:131], v4, s[12:15], s47 offen
    buffer_load_dwordx4 v[132:135], v5, s[12:15], s47 offen
    buffer_load_dwordx4 v[136:139], v6, s[12:15], s47 offen
    buffer_load_dwordx4 v[140:143], v7, s[12:15], s47 offen
    buffer_load_dwordx4 v[144:147], v8, s[12:15], s47 offen
    buffer_load_dwordx4 v[148:151], v9, s[12:15], s47 offen
    s_add_u32 s47, s45, 3145728
    buffer_load_dwordx4 v[152:155], v4, s[12:15], s47 offen
    buffer_load_dwordx4 v[156:159], v5, s[12:15], s47 offen
    buffer_load_dwordx4 v[160:163], v6, s[12:15], s47 offen
    buffer_load_dwordx4 v[164:167], v7, s[12:15], s47 offen
    buffer_load_dwordx4 v[168:171], v8, s[12:15], s47 offen
    buffer_load_dwordx4 v[172:175], v9, s[12:15], s47 offen
    s_add_u32 s47, s45, 3932160
    buffer_load_dwordx4 v[176:179], v4, s[12:15], s47 offen
    buffer_load_dwordx4 v[180:183], v5, s[12:15], s47 offen
    buffer_load_dwordx4 v[184:187], v6, s[12:15], s47 offen
    buffer_load_dwordx4 v[188:191], v7, s[12:15], s47 offen
    buffer_load_dwordx4 v[192:195], v8, s[12:15], s47 offen
    buffer_load_dwordx4 v[196:199], v9, s[12:15], s47 offen
    s_add_u32 s47, s45, 4718592
    buffer_load_dwordx4 v[200:203], v4, s[12:15], s47 offen
    buffer_load_dwordx4 v[204:207], v5, s[12:15], s47 offen
    buffer_load_dwordx4 v[208:211], v6, s[12:15], s47 offen
    buffer_load_dwordx4 v[212:215], v7, s[12:15], s47 offen
    buffer_load_dwordx4 v[216:219], v8, s[12:15], s47 offen
    buffer_load_dwordx4 v[220:223], v9, s[12:15], s47 offen
    s_add_u32 s47, s45, 5505024
    buffer_load_dwordx4 v[224:227], v4, s[12:15], s47 offen
    buffer_load_dwordx4 v[228:231], v5, s[12:15], s47 offen
    buffer_load_dwordx4 v[232:235], v6, s[12:15], s47 offen
    buffer_load_dwordx4 v[236:239], v7, s[12:15], s47 offen
    buffer_load_dwordx4 v[240:243], v8, s[12:15], s47 offen
    buffer_load_dwordx4 v[244:247], v9, s[12:15], s47 offen
    v_mov_b32 v28, 0x3f803f80
    v_mov_b32 v29, 0x3f803f80
    v_mov_b32 v30, 0x3f803f80
    v_mov_b32 v31, 0x3f803f80
    s_waitcnt vmcnt(42)
    ds_write_b128 v10, v[56:59] offset:0
    ds_write_b128 v11, v[60:63] offset:0
    ds_write_b128 v12, v[64:67] offset:0
    ds_write_b128 v13, v[68:71] offset:0
    ds_write_b128 v14, v[72:75] offset:0
    ds_write_b128 v15, v[76:79] offset:0
    s_waitcnt lgkmcnt(0)
    s_add_u32 s47, s45, 6291456
    buffer_load_dwordx4 v[56:59], v4, s[12:15], s47 offen
    buffer_load_dwordx4 v[60:63], v5, s[12:15], s47 offen
    buffer_load_dwordx4 v[64:67], v6, s[12:15], s47 offen
    buffer_load_dwordx4 v[68:71], v7, s[12:15], s47 offen
    buffer_load_dwordx4 v[72:75], v8, s[12:15], s47 offen
    buffer_load_dwordx4 v[76:79], v9, s[12:15], s47 offen
    s_barrier
    ds_read_b64_tr_b16 a[0:1], v32 offset:0
    ds_read_b64_tr_b16 a[2:3], v32 offset:6400
    ds_read_b64_tr_b16 a[4:5], v32 offset:12800
    ds_read_b64_tr_b16 a[6:7], v32 offset:19200
    ds_read_b64_tr_b16 a[80:81], v32 offset:32
    ds_read_b64_tr_b16 a[82:83], v32 offset:6432
    ds_read_b64_tr_b16 a[84:85], v32 offset:12832
    ds_read_b64_tr_b16 a[86:87], v32 offset:19232
    ds_read_b64_tr_b16 a[160:161], v32 offset:64
    ds_read_b64_tr_b16 a[162:163], v32 offset:6464
    ds_read_b64_tr_b16 a[164:165], v32 offset:12864
    ds_read_b64_tr_b16 a[166:167], v32 offset:19264
    s_waitcnt vmcnt(42)
    ds_write_b128 v10, v[80:83] offset:25600
    ds_write_b128 v11, v[84:87] offset:25600
    ds_write_b128 v12, v[88:91] offset:25600
    ds_write_b128 v13, v[92:95] offset:25600
    ds_write_b128 v14, v[96:99] offset:25600
    ds_write_b128 v15, v[100:103] offset:25600
    s_waitcnt lgkmcnt(0)
    s_add_u32 s47, s45, 7077888
    buffer_load_dwordx4 v[80:83], v4, s[12:15], s47 offen
    buffer_load_dwordx4 v[84:87], v5, s[12:15], s47 offen
    buffer_load_dwordx4 v[88:91], v6, s[12:15], s47 offen
    buffer_load_dwordx4 v[92:95], v7, s[12:15], s47 offen
    buffer_load_dwordx4 v[96:99], v8, s[12:15], s47 offen
    buffer_load_dwordx4 v[100:103], v9, s[12:15], s47 offen
    v_mfma_f32_16x16x32_bf16 v[16:19], a[0:3], v[28:31], 0
    v_mfma_f32_16x16x32_bf16 v[20:23], a[80:83], v[28:31], 0
    v_mfma_f32_16x16x32_bf16 v[24:27], a[160:163], v[28:31], 0
    v_mfma_f32_16x16x32_bf16 v[16:19], a[4:7], v[28:31], v[16:19]
    v_mfma_f32_16x16x32_bf16 v[20:23], a[84:87], v[28:31], v[20:23]
    v_mfma_f32_16x16x32_bf16 v[24:27], a[164:167], v[28:31], v[24:27]
    s_barrier
    ds_read_b64_tr_b16 a[8:9], v32 offset:25600
    ds_read_b64_tr_b16 a[10:11], v32 offset:32000
    ds_read_b64_tr_b16 a[12:13], v32 offset:38400
    ds_read_b64_tr_b16 a[14:15], v32 offset:44800
    ds_read_b64_tr_b16 a[88:89], v32 offset:25632
    ds_read_b64_tr_b16 a[90:91], v32 offset:32032
    ds_read_b64_tr_b16 a[92:93], v32 offset:38432
    ds_read_b64_tr_b16 a[94:95], v32 offset:44832
    ds_read_b64_tr_b16 a[168:169], v32 offset:25664
    ds_read_b64_tr_b16 a[170:171], v32 offset:32064
    ds_read_b64_tr_b16 a[172:173], v32 offset:38464
    ds_read_b64_tr_b16 a[174:175], v32 offset:44864
    s_waitcnt vmcnt(42)
    ds_write_b128 v10, v[104:107] offset:0
    ds_write_b128 v11, v[108:111] offset:0
    ds_write_b128 v12, v[112:115] offset:0
    ds_write_b128 v13, v[116:119] offset:0
    ds_write_b128 v14, v[120:123] offset:0
    ds_write_b128 v15, v[124:127] offset:0
    s_waitcnt lgkmcnt(0)
    v_mfma_f32_16x16x32_bf16 v[16:19], a[8:11], v[28:31], v[16:19]
    v_mfma_f32_16x16x32_bf16 v[20:23], a[88:91], v[28:31], v[20:23]
    v_mfma_f32_16x16x32_bf16 v[24:27], a[168:171], v[28:31], v[24:27]
    v_mfma_f32_16x16x32_bf16 v[16:19], a[12:15], v[28:31], v[16:19]
    v_mfma_f32_16x16x32_bf16 v[20:23], a[92:95], v[28:31], v[20:23]
    v_mfma_f32_16x16x32_bf16 v[24:27], a[172:175], v[28:31], v[24:27]
    s_barrier
    ds_read_b64_tr_b16 a[16:17], v32 offset:0
    ds_read_b64_tr_b16 a[18:19], v32 offset:6400
    ds_read_b64_tr_b16 a[20:21], v32 offset:12800
    ds_read_b64_tr_b16 a[22:23], v32 offset:19200
    ds_read_b64_tr_b16 a[96:97], v32 offset:32
    ds_read_b64_tr_b16 a[98:99], v32 offset:6432
    ds_read_b64_tr_b16 a[100:101], v32 offset:12832
    ds_read_b64_tr_b16 a[102:103], v32 offset:19232
    ds_read_b64_tr_b16 a[176:177], v32 offset:64
    ds_read_b64_tr_b16 a[178:179], v32 offset:6464
    ds_read_b64_tr_b16 a[180:181], v32 offset:12864
    ds_read_b64_tr_b16 a[182:183], v32 offset:19264
    s_waitcnt vmcnt(36)
    ds_write_b128 v10, v[128:131] offset:25600
    ds_write_b128 v11, v[132:135] offset:25600
    ds_write_b128 v12, v[136:139] offset:25600
    ds_write_b128 v13, v[140:143] offset:25600
    ds_write_b128 v14, v[144:147] offset:25600
    ds_write_b128 v15, v[148:151] offset:25600
    s_waitcnt lgkmcnt(0)
    v_mfma_f32_16x16x32_bf16 v[16:19], a[16:19], v[28:31], v[16:19]
    v_mfma_f32_16x16x32_bf16 v[20:23], a[96:99], v[28:31], v[20:23]
    v_mfma_f32_16x16x32_bf16 v[24:27], a[176:179], v[28:31], v[24:27]
    v_mfma_f32_16x16x32_bf16 v[16:19], a[20:23], v[28:31], v[16:19]
    v_mfma_f32_16x16x32_bf16 v[20:23], a[100:103], v[28:31], v[20:23]
    v_mfma_f32_16x16x32_bf16 v[24:27], a[180:183], v[28:31], v[24:27]
    s_barrier
    ds_read_b64_tr_b16 a[24:25], v32 offset:25600
    ds_read_b64_tr_b16 a[26:27], v32 offset:32000
    ds_read_b64_tr_b16 a[28:29], v32 offset:38400
    ds_read_b64_tr_b16 a[30:31], v32 offset:44800
    ds_read_b64_tr_b16 a[104:105], v32 offset:25632
    ds_read_b64_tr_b16 a[106:107], v32 offset:32032
    ds_read_b64_tr_b16 a[108:109], v32 offset:38432
    ds_read_b64_tr_b16 a[110:111], v32 offset:44832
    ds_read_b64_tr_b16 a[184:185], v32 offset:25664
    ds_read_b64_tr_b16 a[186:187], v32 offset:32064
    ds_read_b64_tr_b16 a[188:189], v32 offset:38464
    ds_read_b64_tr_b16 a[190:191], v32 offset:44864
    s_waitcnt vmcnt(30)
    ds_write_b128 v10, v[152:155] offset:0
    ds_write_b128 v11, v[156:159] offset:0
    ds_write_b128 v12, v[160:163] offset:0
    ds_write_b128 v13, v[164:167] offset:0
    ds_write_b128 v14, v[168:171] offset:0
    ds_write_b128 v15, v[172:175] offset:0
    s_waitcnt lgkmcnt(0)
    v_mfma_f32_16x16x32_bf16 v[16:19], a[24:27], v[28:31], v[16:19]
    v_mfma_f32_16x16x32_bf16 v[20:23], a[104:107], v[28:31], v[20:23]
    v_mfma_f32_16x16x32_bf16 v[24:27], a[184:187], v[28:31], v[24:27]
    v_mfma_f32_16x16x32_bf16 v[16:19], a[28:31], v[28:31], v[16:19]
    v_mfma_f32_16x16x32_bf16 v[20:23], a[108:111], v[28:31], v[20:23]
    v_mfma_f32_16x16x32_bf16 v[24:27], a[188:191], v[28:31], v[24:27]
    s_barrier
    ds_read_b64_tr_b16 a[32:33], v32 offset:0
    ds_read_b64_tr_b16 a[34:35], v32 offset:6400
    ds_read_b64_tr_b16 a[36:37], v32 offset:12800
    ds_read_b64_tr_b16 a[38:39], v32 offset:19200
    ds_read_b64_tr_b16 a[112:113], v32 offset:32
    ds_read_b64_tr_b16 a[114:115], v32 offset:6432
    ds_read_b64_tr_b16 a[116:117], v32 offset:12832
    ds_read_b64_tr_b16 a[118:119], v32 offset:19232
    ds_read_b64_tr_b16 a[192:193], v32 offset:64
    ds_read_b64_tr_b16 a[194:195], v32 offset:6464
    ds_read_b64_tr_b16 a[196:197], v32 offset:12864
    ds_read_b64_tr_b16 a[198:199], v32 offset:19264
    s_waitcnt vmcnt(24)
    ds_write_b128 v10, v[176:179] offset:25600
    ds_write_b128 v11, v[180:183] offset:25600
    ds_write_b128 v12, v[184:187] offset:25600
    ds_write_b128 v13, v[188:191] offset:25600
    ds_write_b128 v14, v[192:195] offset:25600
    ds_write_b128 v15, v[196:199] offset:25600
    s_waitcnt lgkmcnt(0)
    v_mfma_f32_16x16x32_bf16 v[16:19], a[32:35], v[28:31], v[16:19]
    v_mfma_f32_16x16x32_bf16 v[20:23], a[112:115], v[28:31], v[20:23]
    v_mfma_f32_16x16x32_bf16 v[24:27], a[192:195], v[28:31], v[24:27]
    v_mfma_f32_16x16x32_bf16 v[16:19], a[36:39], v[28:31], v[16:19]
    v_mfma_f32_16x16x32_bf16 v[20:23], a[116:119], v[28:31], v[20:23]
    v_mfma_f32_16x16x32_bf16 v[24:27], a[196:199], v[28:31], v[24:27]
    s_barrier
    ds_read_b64_tr_b16 a[40:41], v32 offset:25600
    ds_read_b64_tr_b16 a[42:43], v32 offset:32000
    ds_read_b64_tr_b16 a[44:45], v32 offset:38400
    ds_read_b64_tr_b16 a[46:47], v32 offset:44800
    ds_read_b64_tr_b16 a[120:121], v32 offset:25632
    ds_read_b64_tr_b16 a[122:123], v32 offset:32032
    ds_read_b64_tr_b16 a[124:125], v32 offset:38432
    ds_read_b64_tr_b16 a[126:127], v32 offset:44832
    ds_read_b64_tr_b16 a[200:201], v32 offset:25664
    ds_read_b64_tr_b16 a[202:203], v32 offset:32064
    ds_read_b64_tr_b16 a[204:205], v32 offset:38464
    ds_read_b64_tr_b16 a[206:207], v32 offset:44864
    s_waitcnt vmcnt(18)
    ds_write_b128 v10, v[200:203] offset:0
    ds_write_b128 v11, v[204:207] offset:0
    ds_write_b128 v12, v[208:211] offset:0
    ds_write_b128 v13, v[212:215] offset:0
    ds_write_b128 v14, v[216:219] offset:0
    ds_write_b128 v15, v[220:223] offset:0
    s_waitcnt lgkmcnt(0)
    v_mfma_f32_16x16x32_bf16 v[16:19], a[40:43], v[28:31], v[16:19]
    v_mfma_f32_16x16x32_bf16 v[20:23], a[120:123], v[28:31], v[20:23]
    v_mfma_f32_16x16x32_bf16 v[24:27], a[200:203], v[28:31], v[24:27]
    v_mfma_f32_16x16x32_bf16 v[16:19], a[44:47], v[28:31], v[16:19]
    v_mfma_f32_16x16x32_bf16 v[20:23], a[124:127], v[28:31], v[20:23]
    v_mfma_f32_16x16x32_bf16 v[24:27], a[204:207], v[28:31], v[24:27]
    s_barrier
    ds_read_b64_tr_b16 a[48:49], v32 offset:0
    ds_read_b64_tr_b16 a[50:51], v32 offset:6400
    ds_read_b64_tr_b16 a[52:53], v32 offset:12800
    ds_read_b64_tr_b16 a[54:55], v32 offset:19200
    ds_read_b64_tr_b16 a[128:129], v32 offset:32
    ds_read_b64_tr_b16 a[130:131], v32 offset:6432
    ds_read_b64_tr_b16 a[132:133], v32 offset:12832
    ds_read_b64_tr_b16 a[134:135], v32 offset:19232
    ds_read_b64_tr_b16 a[208:209], v32 offset:64
    ds_read_b64_tr_b16 a[210:211], v32 offset:6464
    ds_read_b64_tr_b16 a[212:213], v32 offset:12864
    ds_read_b64_tr_b16 a[214:215], v32 offset:19264
    s_waitcnt vmcnt(12)
    ds_write_b128 v10, v[224:227] offset:25600
    ds_write_b128 v11, v[228:231] offset:25600
    ds_write_b128 v12, v[232:235] offset:25600
    ds_write_b128 v13, v[236:239] offset:25600
    ds_write_b128 v14, v[240:243] offset:25600
    ds_write_b128 v15, v[244:247] offset:25600
    s_waitcnt lgkmcnt(0)
    v_mfma_f32_16x16x32_bf16 v[16:19], a[48:51], v[28:31], v[16:19]
    v_mfma_f32_16x16x32_bf16 v[20:23], a[128:131], v[28:31], v[20:23]
    v_mfma_f32_16x16x32_bf16 v[24:27], a[208:211], v[28:31], v[24:27]
    v_mfma_f32_16x16x32_bf16 v[16:19], a[52:55], v[28:31], v[16:19]
    v_mfma_f32_16x16x32_bf16 v[20:23], a[132:135], v[28:31], v[20:23]
    v_mfma_f32_16x16x32_bf16 v[24:27], a[212:215], v[28:31], v[24:27]
    s_barrier
    ds_read_b64_tr_b16 a[56:57], v32 offset:25600
    ds_read_b64_tr_b16 a[58:59], v32 offset:32000
    ds_read_b64_tr_b16 a[60:61], v32 offset:38400
    ds_read_b64_tr_b16 a[62:63], v32 offset:44800
    ds_read_b64_tr_b16 a[136:137], v32 offset:25632
    ds_read_b64_tr_b16 a[138:139], v32 offset:32032
    ds_read_b64_tr_b16 a[140:141], v32 offset:38432
    ds_read_b64_tr_b16 a[142:143], v32 offset:44832
    ds_read_b64_tr_b16 a[216:217], v32 offset:25664
    ds_read_b64_tr_b16 a[218:219], v32 offset:32064
    ds_read_b64_tr_b16 a[220:221], v32 offset:38464
    ds_read_b64_tr_b16 a[222:223], v32 offset:44864
    s_waitcnt vmcnt(6)
    ds_write_b128 v10, v[56:59] offset:0
    ds_write_b128 v11, v[60:63] offset:0
    ds_write_b128 v12, v[64:67] offset:0
    ds_write_b128 v13, v[68:71] offset:0
    ds_write_b128 v14, v[72:75] offset:0
    ds_write_b128 v15, v[76:79] offset:0
    s_waitcnt lgkmcnt(0)
    v_mfma_f32_16x16x32_bf16 v[16:19], a[56:59], v[28:31], v[16:19]
    v_mfma_f32_16x16x32_bf16 v[20:23], a[136:139], v[28:31], v[20:23]
    v_mfma_f32_16x16x32_bf16 v[24:27], a[216:219], v[28:31], v[24:27]
    v_mfma_f32_16x16x32_bf16 v[16:19], a[60:63], v[28:31], v[16:19]
    v_mfma_f32_16x16x32_bf16 v[20:23], a[140:143], v[28:31], v[20:23]
    v_mfma_f32_16x16x32_bf16 v[24:27], a[220:223], v[28:31], v[24:27]
    s_barrier
    ds_read_b64_tr_b16 a[64:65], v32 offset:0
    ds_read_b64_tr_b16 a[66:67], v32 offset:6400
    ds_read_b64_tr_b16 a[68:69], v32 offset:12800
    ds_read_b64_tr_b16 a[70:71], v32 offset:19200
    ds_read_b64_tr_b16 a[144:145], v32 offset:32
    ds_read_b64_tr_b16 a[146:147], v32 offset:6432
    ds_read_b64_tr_b16 a[148:149], v32 offset:12832
    ds_read_b64_tr_b16 a[150:151], v32 offset:19232
    ds_read_b64_tr_b16 a[224:225], v32 offset:64
    ds_read_b64_tr_b16 a[226:227], v32 offset:6464
    ds_read_b64_tr_b16 a[228:229], v32 offset:12864
    ds_read_b64_tr_b16 a[230:231], v32 offset:19264
    s_waitcnt vmcnt(0)
    ds_write_b128 v10, v[80:83] offset:25600
    ds_write_b128 v11, v[84:87] offset:25600
    ds_write_b128 v12, v[88:91] offset:25600
    ds_write_b128 v13, v[92:95] offset:25600
    ds_write_b128 v14, v[96:99] offset:25600
    ds_write_b128 v15, v[100:103] offset:25600
    s_waitcnt lgkmcnt(0)
    v_mfma_f32_16x16x32_bf16 v[16:19], a[64:67], v[28:31], v[16:19]
    v_mfma_f32_16x16x32_bf16 v[20:23], a[144:147], v[28:31], v[20:23]
    v_mfma_f32_16x16x32_bf16 v[24:27], a[224:227], v[28:31], v[24:27]
    v_mfma_f32_16x16x32_bf16 v[16:19], a[68:71], v[28:31], v[16:19]
    v_mfma_f32_16x16x32_bf16 v[20:23], a[148:151], v[28:31], v[20:23]
    v_mfma_f32_16x16x32_bf16 v[24:27], a[228:231], v[28:31], v[24:27]
    s_barrier
    ds_read_b64_tr_b16 a[72:73], v32 offset:25600
    ds_read_b64_tr_b16 a[74:75], v32 offset:32000
    ds_read_b64_tr_b16 a[76:77], v32 offset:38400
    ds_read_b64_tr_b16 a[78:79], v32 offset:44800
    ds_read_b64_tr_b16 a[152:153], v32 offset:25632
    ds_read_b64_tr_b16 a[154:155], v32 offset:32032
    ds_read_b64_tr_b16 a[156:157], v32 offset:38432
    ds_read_b64_tr_b16 a[158:159], v32 offset:44832
    ds_read_b64_tr_b16 a[232:233], v32 offset:25664
    ds_read_b64_tr_b16 a[234:235], v32 offset:32064
    ds_read_b64_tr_b16 a[236:237], v32 offset:38464
    ds_read_b64_tr_b16 a[238:239], v32 offset:44864
    s_waitcnt lgkmcnt(0)
    v_mfma_f32_16x16x32_bf16 v[16:19], a[72:75], v[28:31], v[16:19]
    v_mfma_f32_16x16x32_bf16 v[20:23], a[152:155], v[28:31], v[20:23]
    v_mfma_f32_16x16x32_bf16 v[24:27], a[232:235], v[28:31], v[24:27]
    v_mfma_f32_16x16x32_bf16 v[16:19], a[76:79], v[28:31], v[16:19]
    v_mfma_f32_16x16x32_bf16 v[20:23], a[156:159], v[28:31], v[20:23]
    v_mfma_f32_16x16x32_bf16 v[24:27], a[236:239], v[28:31], v[24:27]
    s_nop 5
    v_mov_b32 v224, v16
    v_mov_b32 v225, v17
    v_mov_b32 v226, v18
    v_mov_b32 v227, v19
    v_mov_b32 v228, v20
    v_mov_b32 v229, v21
    v_mov_b32 v230, v22
    v_mov_b32 v231, v23
    v_mov_b32 v232, v24
    v_mov_b32 v233, v25
    v_mov_b32 v234, v26
    v_mov_b32 v235, v27
    v_mov_b32 v236, v28
    v_mov_b32 v237, v29
    v_mov_b32 v238, v30
    v_mov_b32 v239, v31
    s_barrier
interleave_layers__linear_attn_block__memory_aug_recurrent_mem_tr__prompt_kernel_p_layer:
    s_mul_i32 s93, s92, 29360128
    s_add_u32 s93, s93, 117440512
    s_mul_i32 s94, s92, 16384
    s_add_u32 s94, s94, 23068672
    s_sub_u32 s44, s2, 104
    s_lshr_b32 s46, s44, 5
    s_and_b32 s44, s44, 31
    s_mov_b32 s43, 67108864
    s_cmp_eq_u32 s46, 1
    s_cselect_b32 s43, 92274688, s43
    s_cmp_eq_u32 s46, 2
    s_cselect_b32 s43, 33554432, s43
    s_cmp_eq_u32 s92, 0
    s_cselect_b32 s73, 0, 8388608
    v_lshlrev_b32 v5, 4, v1
    s_mul_i32 s24, s3, 10240
    v_add_u32 v6, s24, v5
    v_add_u32 v7, 4096, v6
    v_add_u32 v8, 8192, v6
    s_mul_i32 s24, s44, 12288
    s_mul_i32 s25, s3, 3072
    s_add_u32 s24, s24, s25
    v_add_u32 v11, s24, v5
    s_lshr_b32 s24, s3, 1
    s_lshl_b32 s24, s24, 8
    s_and_b32 s25, s3, 1
    s_lshl_b32 s25, s25, 3
    s_add_u32 s24, s24, s25
    s_add_u32 s24, s24, 81920
    v_lshlrev_b32 v13, 4, v2
    v_add_u32 v12, s24, v13
    v_add_u32 v13, 81920, v13
    v_lshrrev_b32 v15, 2, v2
    v_cmp_eq_u32 vcc, v15, v3
    v_lshlrev_b32 v15, 3, v1
    v_add_u32 v15, 82944, v15
    v_cndmask_b32 v12, v15, v12, vcc
    v_and_b32 v15, 3, v2
    v_cmp_eq_u32 s[48:49], 1, v15
    v_cmp_eq_u32 s[50:51], 2, v15
    v_cmp_eq_u32 s[54:55], 3, v15
    s_and_b32 s24, s2, 7
    s_lshl_b32 s24, s24, 7
    s_lshl_b32 s25, s92, 10
    s_add_u32 s24, s24, s25
    s_add_u32 s24, s24, 23105536
    s_cmp_eq_u32 s92, 0
    s_cselect_b32 s25, 20, 5
    s_cselect_b32 s75, 2, 0
    s_cselect_b32 s74, 16, 64
    v_cmp_gt_u32 vcc, s25, v1
    s_nop 1
    v_cndmask_b32 v4, 0, v1, vcc
    v_lshlrev_b32 v4, 2, v4
    v_add_u32 v4, s24, v4
    s_lshl_b32 s24, s46, 12
    s_lshl_b32 s25, s44, 7
    s_add_u32 s24, s24, s25
    s_add_u32 s24, s24, s94
    v_mov_b32 v14, s24
    v_mov_b32 v15, 2146435072
    v_cmp_eq_u32 vcc, 0, v1
    s_nop 1
    v_cndmask_b32 v14, v15, v14, vcc
    s_cmp_eq_u32 s3, 0
    s_cselect_b32 s24, 0, 2146435072
    v_or_b32 v14, s24, v14
    s_sub_u32 s70, s2, 104
    s_mul_i32 s71, s70, 205
    s_lshr_b32 s71, s71, 12
    s_mul_i32 s24, s71, 20
    s_sub_u32 s70, s70, s24
    s_cmp_lt_u32 s71, 4
    s_cselect_b32 s64, s71, 64
    s_lshl_b32 s24, s70, 16
    s_lshl_b32 s25, s3, 13
    s_add_u32 s24, s24, s25
    v_add_u32 v240, s24, v5
    v_add_u32 v241, 4096, v240
    s_lshl_b32 s24, s70, 14
    s_lshl_b32 s25, s3, 11
    s_add_u32 s24, s24, s25
    v_add_u32 v242, s24, v5
    s_lshl_b32 s24, s3, 14
    v_add_u32 v193, s24, v5
    v_add_u32 v212, 0, v193
    v_add_u32 v213, 4096, v193
    v_add_u32 v214, 8192, v193
    v_add_u32 v215, 12288, v193
    s_lshl_b32 s24, s3, 12
    s_add_u32 s24, s24, 65536
    v_add_u32 v216, s24, v5
    s_lshl_b32 s24, s3, 12
    s_add_u32 s24, s24, 83968
    v_add_u32 v217, s24, v5
    s_and_b32 s24, s3, 1
    s_lshl_b32 s24, s24, 10
    s_add_u32 s24, s24, 83968
    v_add_u32 v218, s24, v5
    s_and_b32 s24, s3, 1
    s_mul_i32 s24, s24, 20480
    s_lshl_b32 s25, s70, 10
    s_add_u32 s24, s24, s25
    v_add_u32 v219, s24, v5
    s_and_b32 s24, s3, 1
    s_lshl_b32 s24, s24, 4
    v_add_u32 v243, s24, v2
    v_mul_u32_u24 v243, 1280, v243
    v_lshl_add_u32 v243, v3, 3, v243
    s_lshl_b32 s24, s70, 6
    v_add_u32 v243, s24, v243
    s_load_dwordx2 s[26:27], s[0:1], 80
    s_waitcnt lgkmcnt(0)
    s_mov_b32 s12, s26
    s_mov_b32 s13, s27
    s_mov_b32 s14, 2621440
    s_mov_b32 s15, 0x00020000
    s_mul_i32 s65, s71, 1310720
    s_add_u32 s65, s65, 184549376
    s_mul_i32 s24, s71, 458752
    s_add_u32 s24, s24, s93
    s_add_u32 s66, s24, 0
    s_add_u32 s67, s24, 327680
    s_mul_i32 s68, s71, 40960
    v_and_b32 v252, 7, v1
    v_lshlrev_b32 v252, 7, v252
    s_lshl_b32 s24, s3, 10
    s_add_u32 s24, s24, 12288
    s_add_u32 s24, s24, s94
    v_add_u32 v252, s24, v252
    s_mov_b32 s69, -1
    s_lshl_b32 s24, s71, 7
    s_lshl_b32 s25, s70, 2
    s_add_u32 s24, s24, s25
    s_add_u32 s24, s24, 23107584
    s_cmp_eq_u32 s3, 0
    s_cselect_b32 s24, s24, 2146435072
    v_mov_b32 v245, s24
    v_mov_b32 v246, 2146435072
    v_cmp_eq_u32 vcc, 0, v1
    s_nop 1
    v_cndmask_b32 v245, v246, v245, vcc
    s_mov_b32 s79, -1
    s_mov_b32 s62, -1
    s_mov_b32 s63, 1
    s_cmp_ge_i32 s62, s63
    s_cbranch_scc1 interleave_layers__linear_attn_block__memory_aug_recurrent_mem_tr__prompt_kernel_p_en0_ok
    s_mov_b32 s61, 0
interleave_layers__linear_attn_block__memory_aug_recurrent_mem_tr__prompt_kernel_p_en0:
    buffer_load_dword v16, v4, s[8:11], 0 offen sc1
    s_waitcnt vmcnt(0)
    v_readlane_b32 s62, v16, 0
    v_readlane_b32 s24, v16, 1
    s_min_i32 s62, s62, s24
    v_readlane_b32 s24, v16, 2
    s_min_i32 s62, s62, s24
    v_readlane_b32 s24, v16, 3
    s_min_i32 s62, s62, s24
    v_readlane_b32 s24, v16, 4
    s_min_i32 s62, s62, s24
    v_readlane_b32 s24, v16, 5
    s_min_i32 s62, s62, s24
    v_readlane_b32 s24, v16, 6
    s_min_i32 s62, s62, s24
    v_readlane_b32 s24, v16, 7
    s_min_i32 s62, s62, s24
    v_readlane_b32 s24, v16, 8
    s_min_i32 s62, s62, s24
    v_readlane_b32 s24, v16, 9
    s_min_i32 s62, s62, s24
    v_readlane_b32 s24, v16, 10
    s_min_i32 s62, s62, s24
    v_readlane_b32 s24, v16, 11
    s_min_i32 s62, s62, s24
    v_readlane_b32 s24, v16, 12
    s_min_i32 s62, s62, s24
    v_readlane_b32 s24, v16, 13
    s_min_i32 s62, s62, s24
    v_readlane_b32 s24, v16, 14
    s_min_i32 s62, s62, s24
    v_readlane_b32 s24, v16, 15
    s_min_i32 s62, s62, s24
    v_readlane_b32 s24, v16, 16
    s_min_i32 s62, s62, s24
    v_readlane_b32 s24, v16, 17
    s_min_i32 s62, s62, s24
    v_readlane_b32 s24, v16, 18
    s_min_i32 s62, s62, s24
    v_readlane_b32 s24, v16, 19
    s_min_i32 s62, s62, s24
    s_cmp_ge_i32 s62, s63
    s_cbranch_scc1 interleave_layers__linear_attn_block__memory_aug_recurrent_mem_tr__prompt_kernel_p_en0_ok
    s_add_u32 s61, s61, 1
    s_cmp_ge_u32 s61, s60
    s_cbranch_scc1 interleave_layers__linear_attn_block__memory_aug_recurrent_mem_tr__prompt_kernel_p_en0_to
    s_sleep 2
    s_branch interleave_layers__linear_attn_block__memory_aug_recurrent_mem_tr__prompt_kernel_p_en0
interleave_layers__linear_attn_block__memory_aug_recurrent_mem_tr__prompt_kernel_p_en0_to:
    s_mov_b32 s60, 1
interleave_layers__linear_attn_block__memory_aug_recurrent_mem_tr__prompt_kernel_p_en0_ok:
    s_mov_b32 s41, s73
    buffer_load_dwordx4 v[16:19], v6, s[8:11], s41 offen offset:0
    buffer_load_dwordx4 v[20:23], v6, s[8:11], s41 offen offset:1024
    buffer_load_dwordx4 v[24:27], v6, s[8:11], s41 offen offset:2048
    buffer_load_dwordx4 v[28:31], v6, s[8:11], s41 offen offset:3072
    buffer_load_dwordx4 v[32:35], v7, s[8:11], s41 offen offset:0
    buffer_load_dwordx4 v[36:39], v7, s[8:11], s41 offen offset:1024
    buffer_load_dwordx4 v[40:43], v7, s[8:11], s41 offen offset:2048
    buffer_load_dwordx4 v[44:47], v7, s[8:11], s41 offen offset:3072
    buffer_load_dwordx4 v[48:51], v8, s[8:11], s41 offen offset:0
    buffer_load_dwordx4 v[52:55], v8, s[8:11], s41 offen offset:1024
    s_mov_b32 s40, 0
    s_mov_b32 s42, 0
    s_waitcnt vmcnt(0)
    v_mfma_f32_16x16x32_bf16 v[148:151], v[16:19], v[16:19], 0
    v_mfma_f32_16x16x32_bf16 v[144:147], v[236:239], v[16:19], 0
    v_mfma_f32_16x16x32_bf16 v[148:151], v[20:23], v[20:23], v[148:151]
    v_mfma_f32_16x16x32_bf16 v[144:147], v[236:239], v[20:23], v[144:147]
    v_mfma_f32_16x16x32_bf16 v[148:151], v[24:27], v[24:27], v[148:151]
    v_mfma_f32_16x16x32_bf16 v[144:147], v[236:239], v[24:27], v[144:147]
    v_mfma_f32_16x16x32_bf16 v[148:151], v[28:31], v[28:31], v[148:151]
    v_mfma_f32_16x16x32_bf16 v[144:147], v[236:239], v[28:31], v[144:147]
    v_mfma_f32_16x16x32_bf16 v[148:151], v[32:35], v[32:35], v[148:151]
    v_mfma_f32_16x16x32_bf16 v[144:147], v[236:239], v[32:35], v[144:147]
    v_mfma_f32_16x16x32_bf16 v[148:151], v[36:39], v[36:39], v[148:151]
    v_mfma_f32_16x16x32_bf16 v[144:147], v[236:239], v[36:39], v[144:147]
    v_mfma_f32_16x16x32_bf16 v[148:151], v[40:43], v[40:43], v[148:151]
    v_mfma_f32_16x16x32_bf16 v[144:147], v[236:239], v[40:43], v[144:147]
    v_mfma_f32_16x16x32_bf16 v[148:151], v[44:47], v[44:47], v[148:151]
    v_mfma_f32_16x16x32_bf16 v[144:147], v[236:239], v[44:47], v[144:147]
    v_mfma_f32_16x16x32_bf16 v[148:151], v[48:51], v[48:51], v[148:151]
    v_mfma_f32_16x16x32_bf16 v[144:147], v[236:239], v[48:51], v[144:147]
    v_mfma_f32_16x16x32_bf16 v[148:151], v[52:55], v[52:55], v[148:151]
    v_mfma_f32_16x16x32_bf16 v[144:147], v[236:239], v[52:55], v[144:147]
    ds_write_b128 v6, v[16:19] offset:0
    ds_write_b128 v6, v[20:23] offset:1024
    ds_write_b128 v6, v[24:27] offset:2048
    ds_write_b128 v6, v[28:31] offset:3072
    ds_write_b128 v6, v[32:35] offset:4096
    ds_write_b128 v6, v[36:39] offset:5120
    ds_write_b128 v6, v[40:43] offset:6144
    ds_write_b128 v6, v[44:47] offset:7168
    ds_write_b128 v6, v[48:51] offset:8192
    ds_write_b128 v6, v[52:55] offset:9216
    v_cndmask_b32 v145, v148, v149, s[48:49]
    v_cndmask_b32 v145, v145, v150, s[50:51]
    v_cndmask_b32 v145, v145, v151, s[54:55]
    ds_write_b64 v12, v[144:145]
    s_waitcnt lgkmcnt(0)
    s_barrier
interleave_layers__linear_attn_block__memory_aug_recurrent_mem_tr__prompt_kernel_p_segA:
    v_add_u32 v9, s42, v5
    s_xor_b32 s42, s42, 40960
    v_add_u32 v10, s42, v6
    s_and_b32 s24, s40, 1
    s_lshl_b32 s24, s24, 9
    v_add_u32 v124, s24, v13
    s_xor_b32 s24, s24, 512
    v_add_u32 v140, s24, v12
    ds_read_b128 v[112:115], v124
    ds_read_b128 v[116:119], v124 offset:256
    ds_read_b128 v[56:59], v9 offset:0
    ds_read_b128 v[60:63], v9 offset:20480
    ds_read_b128 v[64:67], v9 offset:1024
    ds_read_b128 v[68:71], v9 offset:21504
    ds_read_b128 v[72:75], v9 offset:2048
    ds_read_b128 v[76:79], v9 offset:22528
    ds_read_b128 v[80:83], v9 offset:3072
    ds_read_b128 v[84:87], v9 offset:23552
    s_waitcnt lgkmcnt(6)
    v_mfma_f32_16x16x32_bf16 v[88:91], a[0:3], v[56:59], 0
    v_add_f32 v112, v112, v114
    v_mfma_f32_16x16x32_bf16 v[92:95], a[80:83], v[56:59], 0
    v_add_f32 v113, v113, v115
    v_mfma_f32_16x16x32_bf16 v[96:99], a[160:163], v[56:59], 0
    v_mul_f32 v112, 0x3acccccd, v112
    v_mfma_f32_16x16x32_bf16 v[100:103], a[0:3], v[60:63], 0
    v_mul_f32 v114, v112, v112
    v_mfma_f32_16x16x32_bf16 v[104:107], a[80:83], v[60:63], 0
    v_mov_b32 v115, 0x3acccccd
    v_mfma_f32_16x16x32_bf16 v[108:111], a[160:163], v[60:63], 0
    v_fma_f32 v113, v113, v115, -v114
    ds_read_b128 v[56:59], v9 offset:4096
    ds_read_b128 v[60:63], v9 offset:24576
    s_waitcnt lgkmcnt(6)
    v_mfma_f32_16x16x32_bf16 v[88:91], a[4:7], v[64:67], v[88:91]
    v_max_f32 v113, 0, v113
    v_mfma_f32_16x16x32_bf16 v[92:95], a[84:87], v[64:67], v[92:95]
    v_add_f32 v113, 0x3727c5ac, v113
    v_mfma_f32_16x16x32_bf16 v[96:99], a[164:167], v[64:67], v[96:99]
    v_rsq_f32 v132, v113
    v_mfma_f32_16x16x32_bf16 v[100:103], a[4:7], v[68:71], v[100:103]
    v_mul_f32 v133, v112, v132
    v_mfma_f32_16x16x32_bf16 v[104:107], a[84:87], v[68:71], v[104:107]
    v_sub_f32 v133, 0, v133
    v_mfma_f32_16x16x32_bf16 v[108:111], a[164:167], v[68:71], v[108:111]
    v_add_f32 v116, v116, v118
    ds_read_b128 v[64:67], v9 offset:5120
    ds_read_b128 v[68:71], v9 offset:25600
    s_waitcnt lgkmcnt(6)
    v_mfma_f32_16x16x32_bf16 v[88:91], a[8:11], v[72:75], v[88:91]
    v_add_f32 v117, v117, v119
    v_mfma_f32_16x16x32_bf16 v[92:95], a[88:91], v[72:75], v[92:95]
    v_mul_f32 v116, 0x3acccccd, v116
    v_mfma_f32_16x16x32_bf16 v[96:99], a[168:171], v[72:75], v[96:99]
    v_mul_f32 v118, v116, v116
    v_mfma_f32_16x16x32_bf16 v[100:103], a[8:11], v[76:79], v[100:103]
    v_mov_b32 v119, 0x3acccccd
    v_mfma_f32_16x16x32_bf16 v[104:107], a[88:91], v[76:79], v[104:107]
    v_fma_f32 v117, v117, v119, -v118
    v_mfma_f32_16x16x32_bf16 v[108:111], a[168:171], v[76:79], v[108:111]
    v_max_f32 v117, 0, v117
    ds_read_b128 v[72:75], v9 offset:6144
    ds_read_b128 v[76:79], v9 offset:26624
    s_waitcnt lgkmcnt(6)
    v_mfma_f32_16x16x32_bf16 v[88:91], a[12:15], v[80:83], v[88:91]
    v_add_f32 v117, 0x3727c5ac, v117
    v_mfma_f32_16x16x32_bf16 v[92:95], a[92:95], v[80:83], v[92:95]
    v_rsq_f32 v134, v117
    v_mfma_f32_16x16x32_bf16 v[96:99], a[172:175], v[80:83], v[96:99]
    v_mul_f32 v135, v116, v134
    v_mfma_f32_16x16x32_bf16 v[100:103], a[12:15], v[84:87], v[100:103]
    v_sub_f32 v135, 0, v135
    v_mfma_f32_16x16x32_bf16 v[104:107], a[92:95], v[84:87], v[104:107]
    v_mfma_f32_16x16x32_bf16 v[108:111], a[172:175], v[84:87], v[108:111]
    ds_read_b128 v[80:83], v9 offset:7168
    ds_read_b128 v[84:87], v9 offset:27648
    s_waitcnt lgkmcnt(6)
    v_mfma_f32_16x16x32_bf16 v[88:91], a[16:19], v[56:59], v[88:91]
    v_mfma_f32_16x16x32_bf16 v[92:95], a[96:99], v[56:59], v[92:95]
    v_mfma_f32_16x16x32_bf16 v[96:99], a[176:179], v[56:59], v[96:99]
    v_mfma_f32_16x16x32_bf16 v[100:103], a[16:19], v[60:63], v[100:103]
    v_mfma_f32_16x16x32_bf16 v[104:107], a[96:99], v[60:63], v[104:107]
    v_mfma_f32_16x16x32_bf16 v[108:111], a[176:179], v[60:63], v[108:111]
    ds_read_b128 v[56:59], v9 offset:8192
    ds_read_b128 v[60:63], v9 offset:28672
    s_waitcnt lgkmcnt(6)
    v_mfma_f32_16x16x32_bf16 v[88:91], a[20:23], v[64:67], v[88:91]
    v_mfma_f32_16x16x32_bf16 v[92:95], a[100:103], v[64:67], v[92:95]
    v_mfma_f32_16x16x32_bf16 v[96:99], a[180:183], v[64:67], v[96:99]
    v_mfma_f32_16x16x32_bf16 v[100:103], a[20:23], v[68:71], v[100:103]
    v_mfma_f32_16x16x32_bf16 v[104:107], a[100:103], v[68:71], v[104:107]
    v_mfma_f32_16x16x32_bf16 v[108:111], a[180:183], v[68:71], v[108:111]
    ds_read_b128 v[64:67], v9 offset:9216
    ds_read_b128 v[68:71], v9 offset:29696
    s_waitcnt lgkmcnt(6)
    v_mfma_f32_16x16x32_bf16 v[88:91], a[24:27], v[72:75], v[88:91]
    v_mfma_f32_16x16x32_bf16 v[92:95], a[104:107], v[72:75], v[92:95]
    v_mfma_f32_16x16x32_bf16 v[96:99], a[184:187], v[72:75], v[96:99]
    v_mfma_f32_16x16x32_bf16 v[100:103], a[24:27], v[76:79], v[100:103]
    v_mfma_f32_16x16x32_bf16 v[104:107], a[104:107], v[76:79], v[104:107]
    v_mfma_f32_16x16x32_bf16 v[108:111], a[184:187], v[76:79], v[108:111]
    ds_read_b128 v[72:75], v9 offset:10240
    ds_read_b128 v[76:79], v9 offset:30720
    s_waitcnt lgkmcnt(6)
    v_mfma_f32_16x16x32_bf16 v[88:91], a[28:31], v[80:83], v[88:91]
    v_mfma_f32_16x16x32_bf16 v[92:95], a[108:111], v[80:83], v[92:95]
    v_mfma_f32_16x16x32_bf16 v[96:99], a[188:191], v[80:83], v[96:99]
    v_mfma_f32_16x16x32_bf16 v[100:103], a[28:31], v[84:87], v[100:103]
    v_mfma_f32_16x16x32_bf16 v[104:107], a[108:111], v[84:87], v[104:107]
    v_mfma_f32_16x16x32_bf16 v[108:111], a[188:191], v[84:87], v[108:111]
    ds_read_b128 v[80:83], v9 offset:11264
    ds_read_b128 v[84:87], v9 offset:31744
    s_waitcnt lgkmcnt(6)
    v_mfma_f32_16x16x32_bf16 v[88:91], a[32:35], v[56:59], v[88:91]
    v_mfma_f32_16x16x32_bf16 v[92:95], a[112:115], v[56:59], v[92:95]
    v_mfma_f32_16x16x32_bf16 v[96:99], a[192:195], v[56:59], v[96:99]
    v_mfma_f32_16x16x32_bf16 v[100:103], a[32:35], v[60:63], v[100:103]
    v_mfma_f32_16x16x32_bf16 v[104:107], a[112:115], v[60:63], v[104:107]
    v_mfma_f32_16x16x32_bf16 v[108:111], a[192:195], v[60:63], v[108:111]
    ds_read_b128 v[56:59], v9 offset:12288
    ds_read_b128 v[60:63], v9 offset:32768
    s_waitcnt lgkmcnt(6)
    v_mfma_f32_16x16x32_bf16 v[88:91], a[36:39], v[64:67], v[88:91]
    v_mfma_f32_16x16x32_bf16 v[92:95], a[116:119], v[64:67], v[92:95]
    v_mfma_f32_16x16x32_bf16 v[96:99], a[196:199], v[64:67], v[96:99]
    v_mfma_f32_16x16x32_bf16 v[100:103], a[36:39], v[68:71], v[100:103]
    v_mfma_f32_16x16x32_bf16 v[104:107], a[116:119], v[68:71], v[104:107]
    v_mfma_f32_16x16x32_bf16 v[108:111], a[196:199], v[68:71], v[108:111]
    ds_read_b128 v[64:67], v9 offset:13312
    ds_read_b128 v[68:71], v9 offset:33792
    s_waitcnt lgkmcnt(6)
    v_mfma_f32_16x16x32_bf16 v[88:91], a[40:43], v[72:75], v[88:91]
    v_mfma_f32_16x16x32_bf16 v[92:95], a[120:123], v[72:75], v[92:95]
    v_mfma_f32_16x16x32_bf16 v[96:99], a[200:203], v[72:75], v[96:99]
    v_mfma_f32_16x16x32_bf16 v[100:103], a[40:43], v[76:79], v[100:103]
    v_mfma_f32_16x16x32_bf16 v[104:107], a[120:123], v[76:79], v[104:107]
    v_mfma_f32_16x16x32_bf16 v[108:111], a[200:203], v[76:79], v[108:111]
    ds_read_b128 v[72:75], v9 offset:14336
    ds_read_b128 v[76:79], v9 offset:34816
    s_waitcnt lgkmcnt(6)
    v_mfma_f32_16x16x32_bf16 v[88:91], a[44:47], v[80:83], v[88:91]
    v_mfma_f32_16x16x32_bf16 v[92:95], a[124:127], v[80:83], v[92:95]
    v_mfma_f32_16x16x32_bf16 v[96:99], a[204:207], v[80:83], v[96:99]
    v_mfma_f32_16x16x32_bf16 v[100:103], a[44:47], v[84:87], v[100:103]
    v_mfma_f32_16x16x32_bf16 v[104:107], a[124:127], v[84:87], v[104:107]
    v_mfma_f32_16x16x32_bf16 v[108:111], a[204:207], v[84:87], v[108:111]
    ds_read_b128 v[80:83], v9 offset:15360
    ds_read_b128 v[84:87], v9 offset:35840
    s_waitcnt lgkmcnt(6)
    v_mfma_f32_16x16x32_bf16 v[88:91], a[48:51], v[56:59], v[88:91]
    v_mfma_f32_16x16x32_bf16 v[92:95], a[128:131], v[56:59], v[92:95]
    v_mfma_f32_16x16x32_bf16 v[96:99], a[208:211], v[56:59], v[96:99]
    v_mfma_f32_16x16x32_bf16 v[100:103], a[48:51], v[60:63], v[100:103]
    v_mfma_f32_16x16x32_bf16 v[104:107], a[128:131], v[60:63], v[104:107]
    v_mfma_f32_16x16x32_bf16 v[108:111], a[208:211], v[60:63], v[108:111]
    ds_read_b128 v[56:59], v9 offset:16384
    ds_read_b128 v[60:63], v9 offset:36864
    s_waitcnt lgkmcnt(6)
    v_mfma_f32_16x16x32_bf16 v[88:91], a[52:55], v[64:67], v[88:91]
    v_mfma_f32_16x16x32_bf16 v[92:95], a[132:135], v[64:67], v[92:95]
    v_mfma_f32_16x16x32_bf16 v[96:99], a[212:215], v[64:67], v[96:99]
    v_mfma_f32_16x16x32_bf16 v[100:103], a[52:55], v[68:71], v[100:103]
    v_mfma_f32_16x16x32_bf16 v[104:107], a[132:135], v[68:71], v[104:107]
    v_mfma_f32_16x16x32_bf16 v[108:111], a[212:215], v[68:71], v[108:111]
    ds_read_b128 v[64:67], v9 offset:17408
    ds_read_b128 v[68:71], v9 offset:37888
    s_waitcnt lgkmcnt(6)
    v_mfma_f32_16x16x32_bf16 v[88:91], a[56:59], v[72:75], v[88:91]
    v_mfma_f32_16x16x32_bf16 v[92:95], a[136:139], v[72:75], v[92:95]
    v_mfma_f32_16x16x32_bf16 v[96:99], a[216:219], v[72:75], v[96:99]
    v_mfma_f32_16x16x32_bf16 v[100:103], a[56:59], v[76:79], v[100:103]
    v_mfma_f32_16x16x32_bf16 v[104:107], a[136:139], v[76:79], v[104:107]
    v_mfma_f32_16x16x32_bf16 v[108:111], a[216:219], v[76:79], v[108:111]
    ds_read_b128 v[72:75], v9 offset:18432
    ds_read_b128 v[76:79], v9 offset:38912
    s_waitcnt lgkmcnt(6)
    v_mfma_f32_16x16x32_bf16 v[88:91], a[60:63], v[80:83], v[88:91]
    v_mfma_f32_16x16x32_bf16 v[92:95], a[140:143], v[80:83], v[92:95]
    v_mfma_f32_16x16x32_bf16 v[96:99], a[220:223], v[80:83], v[96:99]
    v_mfma_f32_16x16x32_bf16 v[100:103], a[60:63], v[84:87], v[100:103]
    v_mfma_f32_16x16x32_bf16 v[104:107], a[140:143], v[84:87], v[104:107]
    v_mfma_f32_16x16x32_bf16 v[108:111], a[220:223], v[84:87], v[108:111]
    ds_read_b128 v[80:83], v9 offset:19456
    ds_read_b128 v[84:87], v9 offset:39936
    s_waitcnt lgkmcnt(6)
    v_mfma_f32_16x16x32_bf16 v[88:91], a[64:67], v[56:59], v[88:91]
    v_mfma_f32_16x16x32_bf16 v[92:95], a[144:147], v[56:59], v[92:95]
    v_mfma_f32_16x16x32_bf16 v[96:99], a[224:227], v[56:59], v[96:99]
    v_mfma_f32_16x16x32_bf16 v[100:103], a[64:67], v[60:63], v[100:103]
    v_mfma_f32_16x16x32_bf16 v[104:107], a[144:147], v[60:63], v[104:107]
    v_mfma_f32_16x16x32_bf16 v[108:111], a[224:227], v[60:63], v[108:111]
    s_waitcnt lgkmcnt(4)
    v_mfma_f32_16x16x32_bf16 v[88:91], a[68:71], v[64:67], v[88:91]
    v_mfma_f32_16x16x32_bf16 v[92:95], a[148:151], v[64:67], v[92:95]
    v_mfma_f32_16x16x32_bf16 v[96:99], a[228:231], v[64:67], v[96:99]
    v_mfma_f32_16x16x32_bf16 v[100:103], a[68:71], v[68:71], v[100:103]
    v_mfma_f32_16x16x32_bf16 v[104:107], a[148:151], v[68:71], v[104:107]
    v_mfma_f32_16x16x32_bf16 v[108:111], a[228:231], v[68:71], v[108:111]
    s_waitcnt lgkmcnt(2)
    v_mfma_f32_16x16x32_bf16 v[88:91], a[72:75], v[72:75], v[88:91]
    v_mfma_f32_16x16x32_bf16 v[92:95], a[152:155], v[72:75], v[92:95]
    v_mfma_f32_16x16x32_bf16 v[96:99], a[232:235], v[72:75], v[96:99]
    v_mfma_f32_16x16x32_bf16 v[100:103], a[72:75], v[76:79], v[100:103]
    v_mfma_f32_16x16x32_bf16 v[104:107], a[152:155], v[76:79], v[104:107]
    v_mfma_f32_16x16x32_bf16 v[108:111], a[232:235], v[76:79], v[108:111]
    s_waitcnt lgkmcnt(0)
    v_mfma_f32_16x16x32_bf16 v[88:91], a[76:79], v[80:83], v[88:91]
    v_mfma_f32_16x16x32_bf16 v[92:95], a[156:159], v[80:83], v[92:95]
    v_mfma_f32_16x16x32_bf16 v[96:99], a[236:239], v[80:83], v[96:99]
    v_mfma_f32_16x16x32_bf16 v[100:103], a[76:79], v[84:87], v[100:103]
    v_mfma_f32_16x16x32_bf16 v[104:107], a[156:159], v[84:87], v[104:107]
    v_mfma_f32_16x16x32_bf16 v[108:111], a[236:239], v[84:87], v[108:111]
    v_pk_mul_f32 v[124:125], v[224:225], v[132:133] op_sel:[0,1] op_sel_hi:[1,1]
    v_pk_mul_f32 v[126:127], v[226:227], v[132:133] op_sel:[0,1] op_sel_hi:[1,1]
    s_nop 0
    v_pk_fma_f32 v[88:89], v[88:89], v[132:133], v[124:125] op_sel:[0,0,0] op_sel_hi:[1,0,1]
    v_pk_fma_f32 v[90:91], v[90:91], v[132:133], v[126:127] op_sel:[0,0,0] op_sel_hi:[1,0,1]
    v_pk_mul_f32 v[124:125], v[228:229], v[132:133] op_sel:[0,1] op_sel_hi:[1,1]
    v_pk_mul_f32 v[126:127], v[230:231], v[132:133] op_sel:[0,1] op_sel_hi:[1,1]
    v_pk_fma_f32 v[92:93], v[92:93], v[132:133], v[124:125] op_sel:[0,0,0] op_sel_hi:[1,0,1]
    v_pk_fma_f32 v[94:95], v[94:95], v[132:133], v[126:127] op_sel:[0,0,0] op_sel_hi:[1,0,1]
    v_pk_mul_f32 v[124:125], v[232:233], v[132:133] op_sel:[0,1] op_sel_hi:[1,1]
    v_pk_mul_f32 v[126:127], v[234:235], v[132:133] op_sel:[0,1] op_sel_hi:[1,1]
    v_pk_fma_f32 v[96:97], v[96:97], v[132:133], v[124:125] op_sel:[0,0,0] op_sel_hi:[1,0,1]
    v_pk_fma_f32 v[98:99], v[98:99], v[132:133], v[126:127] op_sel:[0,0,0] op_sel_hi:[1,0,1]
    v_pk_mul_f32 v[124:125], v[224:225], v[134:135] op_sel:[0,1] op_sel_hi:[1,1]
    v_pk_mul_f32 v[126:127], v[226:227], v[134:135] op_sel:[0,1] op_sel_hi:[1,1]
    v_pk_fma_f32 v[100:101], v[100:101], v[134:135], v[124:125] op_sel:[0,0,0] op_sel_hi:[1,0,1]
    v_pk_fma_f32 v[102:103], v[102:103], v[134:135], v[126:127] op_sel:[0,0,0] op_sel_hi:[1,0,1]
    v_pk_mul_f32 v[124:125], v[228:229], v[134:135] op_sel:[0,1] op_sel_hi:[1,1]
    v_pk_mul_f32 v[126:127], v[230:231], v[134:135] op_sel:[0,1] op_sel_hi:[1,1]
    v_pk_fma_f32 v[104:105], v[104:105], v[134:135], v[124:125] op_sel:[0,0,0] op_sel_hi:[1,0,1]
    v_pk_fma_f32 v[106:107], v[106:107], v[134:135], v[126:127] op_sel:[0,0,0] op_sel_hi:[1,0,1]
    v_pk_mul_f32 v[124:125], v[232:233], v[134:135] op_sel:[0,1] op_sel_hi:[1,1]
    v_pk_mul_f32 v[126:127], v[234:235], v[134:135] op_sel:[0,1] op_sel_hi:[1,1]
    v_pk_fma_f32 v[108:109], v[108:109], v[134:135], v[124:125] op_sel:[0,0,0] op_sel_hi:[1,0,1]
    v_pk_fma_f32 v[110:111], v[110:111], v[134:135], v[126:127] op_sel:[0,0,0] op_sel_hi:[1,0,1]
    v_cvt_pk_bf16_f32 v112, v88, v89
    v_cvt_pk_bf16_f32 v113, v90, v91
    v_cvt_pk_bf16_f32 v114, v92, v93
    v_cvt_pk_bf16_f32 v115, v94, v95
    v_cvt_pk_bf16_f32 v116, v100, v101
    v_cvt_pk_bf16_f32 v117, v102, v103
    v_cvt_pk_bf16_f32 v118, v104, v105
    v_cvt_pk_bf16_f32 v119, v106, v107
    v_cvt_pk_bf16_f32 v120, v96, v97
    v_cvt_pk_bf16_f32 v121, v98, v99
    v_cvt_pk_bf16_f32 v122, v108, v109
    v_cvt_pk_bf16_f32 v123, v110, v111
    buffer_store_dwordx4 v[112:115], v11, s[8:11], s43 offen offset:0 sc1
    buffer_store_dwordx4 v[116:119], v11, s[8:11], s43 offen offset:1024 sc1
    buffer_store_dwordx4 v[120:123], v11, s[8:11], s43 offen offset:2048 sc1
    s_add_u32 s43, s43, 393216
    s_waitcnt vmcnt(0)
    s_barrier
    s_add_u32 s24, s40, 1
    v_mov_b32 v15, s24
    buffer_store_dword v15, v14, s[8:11], 0 offen sc1
    s_add_u32 s63, s40, 1
    s_lshr_b32 s63, s63, s75
    s_add_u32 s63, s63, 1
    s_min_u32 s63, s63, s74
    s_cmp_ge_i32 s62, s63
    s_cbranch_scc1 interleave_layers__linear_attn_block__memory_aug_recurrent_mem_tr__prompt_kernel_p_enA_ok
    s_mov_b32 s61, 0
interleave_layers__linear_attn_block__memory_aug_recurrent_mem_tr__prompt_kernel_p_enA:
    buffer_load_dword v16, v4, s[8:11], 0 offen sc1
    s_waitcnt vmcnt(0)
    v_readlane_b32 s62, v16, 0
    v_readlane_b32 s24, v16, 1
    s_min_i32 s62, s62, s24
    v_readlane_b32 s24, v16, 2
    s_min_i32 s62, s62, s24
    v_readlane_b32 s24, v16, 3
    s_min_i32 s62, s62, s24
    v_readlane_b32 s24, v16, 4
    s_min_i32 s62, s62, s24
    v_readlane_b32 s24, v16, 5
    s_min_i32 s62, s62, s24
    v_readlane_b32 s24, v16, 6
    s_min_i32 s62, s62, s24
    v_readlane_b32 s24, v16, 7
    s_min_i32 s62, s62, s24
    v_readlane_b32 s24, v16, 8
    s_min_i32 s62, s62, s24
    v_readlane_b32 s24, v16, 9
    s_min_i32 s62, s62, s24
    v_readlane_b32 s24, v16, 10
    s_min_i32 s62, s62, s24
    v_readlane_b32 s24, v16, 11
    s_min_i32 s62, s62, s24
    v_readlane_b32 s24, v16, 12
    s_min_i32 s62, s62, s24
    v_readlane_b32 s24, v16, 13
    s_min_i32 s62, s62, s24
    v_readlane_b32 s24, v16, 14
    s_min_i32 s62, s62, s24
    v_readlane_b32 s24, v16, 15
    s_min_i32 s62, s62, s24
    v_readlane_b32 s24, v16, 16
    s_min_i32 s62, s62, s24
    v_readlane_b32 s24, v16, 17
    s_min_i32 s62, s62, s24
    v_readlane_b32 s24, v16, 18
    s_min_i32 s62, s62, s24
    v_readlane_b32 s24, v16, 19
    s_min_i32 s62, s62, s24
    s_cmp_ge_i32 s62, s63
    s_cbranch_scc1 interleave_layers__linear_attn_block__memory_aug_recurrent_mem_tr__prompt_kernel_p_enA_ok
    s_add_u32 s61, s61, 1
    s_cmp_ge_u32 s61, s60
    s_cbranch_scc1 interleave_layers__linear_attn_block__memory_aug_recurrent_mem_tr__prompt_kernel_p_enA_to
    s_sleep 2
    s_branch interleave_layers__linear_attn_block__memory_aug_recurrent_mem_tr__prompt_kernel_p_enA
interleave_layers__linear_attn_block__memory_aug_recurrent_mem_tr__prompt_kernel_p_enA_to:
    s_mov_b32 s60, 1
interleave_layers__linear_attn_block__memory_aug_recurrent_mem_tr__prompt_kernel_p_enA_ok:
    s_add_u32 s41, s41, 40960
    buffer_load_dwordx4 v[16:19], v6, s[8:11], s41 offen offset:0
    buffer_load_dwordx4 v[20:23], v6, s[8:11], s41 offen offset:1024
    buffer_load_dwordx4 v[24:27], v6, s[8:11], s41 offen offset:2048
    buffer_load_dwordx4 v[28:31], v6, s[8:11], s41 offen offset:3072
    buffer_load_dwordx4 v[32:35], v7, s[8:11], s41 offen offset:0
    buffer_load_dwordx4 v[36:39], v7, s[8:11], s41 offen offset:1024
    buffer_load_dwordx4 v[40:43], v7, s[8:11], s41 offen offset:2048
    buffer_load_dwordx4 v[44:47], v7, s[8:11], s41 offen offset:3072
    buffer_load_dwordx4 v[48:51], v8, s[8:11], s41 offen offset:0
    buffer_load_dwordx4 v[52:55], v8, s[8:11], s41 offen offset:1024
    s_waitcnt vmcnt(0)
    v_mfma_f32_16x16x32_bf16 v[148:151], v[16:19], v[16:19], 0
    v_mfma_f32_16x16x32_bf16 v[144:147], v[236:239], v[16:19], 0
    v_mfma_f32_16x16x32_bf16 v[148:151], v[20:23], v[20:23], v[148:151]
    v_mfma_f32_16x16x32_bf16 v[144:147], v[236:239], v[20:23], v[144:147]
    v_mfma_f32_16x16x32_bf16 v[148:151], v[24:27], v[24:27], v[148:151]
    v_mfma_f32_16x16x32_bf16 v[144:147], v[236:239], v[24:27], v[144:147]
    v_mfma_f32_16x16x32_bf16 v[148:151], v[28:31], v[28:31], v[148:151]
    v_mfma_f32_16x16x32_bf16 v[144:147], v[236:239], v[28:31], v[144:147]
    v_mfma_f32_16x16x32_bf16 v[148:151], v[32:35], v[32:35], v[148:151]
    v_mfma_f32_16x16x32_bf16 v[144:147], v[236:239], v[32:35], v[144:147]
    v_mfma_f32_16x16x32_bf16 v[148:151], v[36:39], v[36:39], v[148:151]
    v_mfma_f32_16x16x32_bf16 v[144:147], v[236:239], v[36:39], v[144:147]
    v_mfma_f32_16x16x32_bf16 v[148:151], v[40:43], v[40:43], v[148:151]
    v_mfma_f32_16x16x32_bf16 v[144:147], v[236:239], v[40:43], v[144:147]
    v_mfma_f32_16x16x32_bf16 v[148:151], v[44:47], v[44:47], v[148:151]
    v_mfma_f32_16x16x32_bf16 v[144:147], v[236:239], v[44:47], v[144:147]
    v_mfma_f32_16x16x32_bf16 v[148:151], v[48:51], v[48:51], v[148:151]
    v_mfma_f32_16x16x32_bf16 v[144:147], v[236:239], v[48:51], v[144:147]
    v_mfma_f32_16x16x32_bf16 v[148:151], v[52:55], v[52:55], v[148:151]
    v_mfma_f32_16x16x32_bf16 v[144:147], v[236:239], v[52:55], v[144:147]
    ds_write_b128 v10, v[16:19] offset:0
    ds_write_b128 v10, v[20:23] offset:1024
    ds_write_b128 v10, v[24:27] offset:2048
    ds_write_b128 v10, v[28:31] offset:3072
    ds_write_b128 v10, v[32:35] offset:4096
    ds_write_b128 v10, v[36:39] offset:5120
    ds_write_b128 v10, v[40:43] offset:6144
    ds_write_b128 v10, v[44:47] offset:7168
    ds_write_b128 v10, v[48:51] offset:8192
    ds_write_b128 v10, v[52:55] offset:9216
    v_cndmask_b32 v145, v148, v149, s[48:49]
    v_cndmask_b32 v145, v145, v150, s[50:51]
    v_cndmask_b32 v145, v145, v151, s[54:55]
    ds_write_b64 v140, v[144:145]
    s_add_u32 s40, s40, 1
    s_waitcnt lgkmcnt(0)
    s_barrier
    s_cmp_lt_u32 s40, 2
    s_cbranch_scc1 interleave_layers__linear_attn_block__memory_aug_recurrent_mem_tr__prompt_kernel_p_segA
    s_branch interleave_layers__linear_attn_block__memory_aug_recurrent_mem_tr__prompt_kernel_p_next
interleave_layers__linear_attn_block__memory_aug_recurrent_mem_tr__prompt_kernel_p_seg:
    v_add_u32 v9, s42, v5
    s_xor_b32 s42, s42, 40960
    v_add_u32 v10, s42, v6
    s_add_u32 s63, s40, 1
    s_lshr_b32 s63, s63, s75
    s_add_u32 s63, s63, 1
    s_min_u32 s63, s63, s74
    s_cmp_ge_i32 s62, s63
    s_cbranch_scc1 interleave_layers__linear_attn_block__memory_aug_recurrent_mem_tr__prompt_kernel_p_en_ok
    s_mov_b32 s61, 0
interleave_layers__linear_attn_block__memory_aug_recurrent_mem_tr__prompt_kernel_p_en:
    buffer_load_dword v16, v4, s[8:11], 0 offen sc1
    s_waitcnt vmcnt(0)
    v_readlane_b32 s62, v16, 0
    v_readlane_b32 s24, v16, 1
    s_min_i32 s62, s62, s24
    v_readlane_b32 s24, v16, 2
    s_min_i32 s62, s62, s24
    v_readlane_b32 s24, v16, 3
    s_min_i32 s62, s62, s24
    v_readlane_b32 s24, v16, 4
    s_min_i32 s62, s62, s24
    v_readlane_b32 s24, v16, 5
    s_min_i32 s62, s62, s24
    v_readlane_b32 s24, v16, 6
    s_min_i32 s62, s62, s24
    v_readlane_b32 s24, v16, 7
    s_min_i32 s62, s62, s24
    v_readlane_b32 s24, v16, 8
    s_min_i32 s62, s62, s24
    v_readlane_b32 s24, v16, 9
    s_min_i32 s62, s62, s24
    v_readlane_b32 s24, v16, 10
    s_min_i32 s62, s62, s24
    v_readlane_b32 s24, v16, 11
    s_min_i32 s62, s62, s24
    v_readlane_b32 s24, v16, 12
    s_min_i32 s62, s62, s24
    v_readlane_b32 s24, v16, 13
    s_min_i32 s62, s62, s24
    v_readlane_b32 s24, v16, 14
    s_min_i32 s62, s62, s24
    v_readlane_b32 s24, v16, 15
    s_min_i32 s62, s62, s24
    v_readlane_b32 s24, v16, 16
    s_min_i32 s62, s62, s24
    v_readlane_b32 s24, v16, 17
    s_min_i32 s62, s62, s24
    v_readlane_b32 s24, v16, 18
    s_min_i32 s62, s62, s24
    v_readlane_b32 s24, v16, 19
    s_min_i32 s62, s62, s24
    s_cmp_ge_i32 s62, s63
    s_cbranch_scc1 interleave_layers__linear_attn_block__memory_aug_recurrent_mem_tr__prompt_kernel_p_en_ok
    s_add_u32 s61, s61, 1
    s_cmp_ge_u32 s61, s60
    s_cbranch_scc1 interleave_layers__linear_attn_block__memory_aug_recurrent_mem_tr__prompt_kernel_p_en_to
    s_sleep 2
    s_branch interleave_layers__linear_attn_block__memory_aug_recurrent_mem_tr__prompt_kernel_p_en
interleave_layers__linear_attn_block__memory_aug_recurrent_mem_tr__prompt_kernel_p_en_to:
    s_mov_b32 s60, 1
interleave_layers__linear_attn_block__memory_aug_recurrent_mem_tr__prompt_kernel_p_en_ok:
    s_add_u32 s41, s41, 40960
    buffer_load_dwordx4 v[16:19], v6, s[8:11], s41 offen offset:0
    buffer_load_dwordx4 v[20:23], v6, s[8:11], s41 offen offset:1024
    buffer_load_dwordx4 v[24:27], v6, s[8:11], s41 offen offset:2048
    buffer_load_dwordx4 v[28:31], v6, s[8:11], s41 offen offset:3072
    buffer_load_dwordx4 v[32:35], v7, s[8:11], s41 offen offset:0
    buffer_load_dwordx4 v[36:39], v7, s[8:11], s41 offen offset:1024
    buffer_load_dwordx4 v[40:43], v7, s[8:11], s41 offen offset:2048
    buffer_load_dwordx4 v[44:47], v7, s[8:11], s41 offen offset:3072
    buffer_load_dwordx4 v[48:51], v8, s[8:11], s41 offen offset:0
    buffer_load_dwordx4 v[52:55], v8, s[8:11], s41 offen offset:1024
    s_and_b32 s24, s40, 1
    s_lshl_b32 s24, s24, 9
    v_add_u32 v124, s24, v13
    s_xor_b32 s24, s24, 512
    v_add_u32 v140, s24, v12
    ds_read_b128 v[112:115], v124
    ds_read_b128 v[116:119], v124 offset:256
    ds_read_b128 v[56:59], v9 offset:0
    ds_read_b128 v[60:63], v9 offset:20480
    ds_read_b128 v[64:67], v9 offset:1024
    ds_read_b128 v[68:71], v9 offset:21504
    ds_read_b128 v[72:75], v9 offset:2048
    ds_read_b128 v[76:79], v9 offset:22528
    ds_read_b128 v[80:83], v9 offset:3072
    ds_read_b128 v[84:87], v9 offset:23552
    s_waitcnt lgkmcnt(6)
    v_mfma_f32_16x16x32_bf16 v[88:91], a[0:3], v[56:59], 0
    v_add_f32 v112, v112, v114
    v_mfma_f32_16x16x32_bf16 v[92:95], a[80:83], v[56:59], 0
    v_add_f32 v113, v113, v115
    v_mfma_f32_16x16x32_bf16 v[96:99], a[160:163], v[56:59], 0
    v_mul_f32 v112, 0x3acccccd, v112
    v_mfma_f32_16x16x32_bf16 v[100:103], a[0:3], v[60:63], 0
    v_mul_f32 v114, v112, v112
    v_mfma_f32_16x16x32_bf16 v[104:107], a[80:83], v[60:63], 0
    v_mov_b32 v115, 0x3acccccd
    v_mfma_f32_16x16x32_bf16 v[108:111], a[160:163], v[60:63], 0
    v_fma_f32 v113, v113, v115, -v114
    ds_read_b128 v[56:59], v9 offset:4096
    ds_read_b128 v[60:63], v9 offset:24576
    s_waitcnt lgkmcnt(6)
    v_mfma_f32_16x16x32_bf16 v[88:91], a[4:7], v[64:67], v[88:91]
    v_max_f32 v113, 0, v113
    v_mfma_f32_16x16x32_bf16 v[92:95], a[84:87], v[64:67], v[92:95]
    v_add_f32 v113, 0x3727c5ac, v113
    v_mfma_f32_16x16x32_bf16 v[96:99], a[164:167], v[64:67], v[96:99]
    v_rsq_f32 v132, v113
    v_mfma_f32_16x16x32_bf16 v[100:103], a[4:7], v[68:71], v[100:103]
    v_mul_f32 v133, v112, v132
    v_mfma_f32_16x16x32_bf16 v[104:107], a[84:87], v[68:71], v[104:107]
    v_sub_f32 v133, 0, v133
    v_mfma_f32_16x16x32_bf16 v[108:111], a[164:167], v[68:71], v[108:111]
    v_add_f32 v116, v116, v118
    ds_read_b128 v[64:67], v9 offset:5120
    ds_read_b128 v[68:71], v9 offset:25600
    s_waitcnt lgkmcnt(6)
    v_mfma_f32_16x16x32_bf16 v[88:91], a[8:11], v[72:75], v[88:91]
    v_add_f32 v117, v117, v119
    v_mfma_f32_16x16x32_bf16 v[92:95], a[88:91], v[72:75], v[92:95]
    v_mul_f32 v116, 0x3acccccd, v116
    v_mfma_f32_16x16x32_bf16 v[96:99], a[168:171], v[72:75], v[96:99]
    v_mul_f32 v118, v116, v116
    v_mfma_f32_16x16x32_bf16 v[100:103], a[8:11], v[76:79], v[100:103]
    v_mov_b32 v119, 0x3acccccd
    v_mfma_f32_16x16x32_bf16 v[104:107], a[88:91], v[76:79], v[104:107]
    v_fma_f32 v117, v117, v119, -v118
    v_mfma_f32_16x16x32_bf16 v[108:111], a[168:171], v[76:79], v[108:111]
    v_max_f32 v117, 0, v117
    ds_read_b128 v[72:75], v9 offset:6144
    ds_read_b128 v[76:79], v9 offset:26624
    s_waitcnt lgkmcnt(6)
    v_mfma_f32_16x16x32_bf16 v[88:91], a[12:15], v[80:83], v[88:91]
    v_add_f32 v117, 0x3727c5ac, v117
    v_mfma_f32_16x16x32_bf16 v[92:95], a[92:95], v[80:83], v[92:95]
    v_rsq_f32 v134, v117
    v_mfma_f32_16x16x32_bf16 v[96:99], a[172:175], v[80:83], v[96:99]
    v_mul_f32 v135, v116, v134
    v_mfma_f32_16x16x32_bf16 v[100:103], a[12:15], v[84:87], v[100:103]
    v_sub_f32 v135, 0, v135
    v_mfma_f32_16x16x32_bf16 v[104:107], a[92:95], v[84:87], v[104:107]
    v_mfma_f32_16x16x32_bf16 v[108:111], a[172:175], v[84:87], v[108:111]
    ds_read_b128 v[80:83], v9 offset:7168
    ds_read_b128 v[84:87], v9 offset:27648
    s_waitcnt lgkmcnt(6)
    v_mfma_f32_16x16x32_bf16 v[88:91], a[16:19], v[56:59], v[88:91]
    v_mfma_f32_16x16x32_bf16 v[92:95], a[96:99], v[56:59], v[92:95]
    v_mfma_f32_16x16x32_bf16 v[96:99], a[176:179], v[56:59], v[96:99]
    v_mfma_f32_16x16x32_bf16 v[100:103], a[16:19], v[60:63], v[100:103]
    v_mfma_f32_16x16x32_bf16 v[104:107], a[96:99], v[60:63], v[104:107]
    v_mfma_f32_16x16x32_bf16 v[108:111], a[176:179], v[60:63], v[108:111]
    ds_read_b128 v[56:59], v9 offset:8192
    ds_read_b128 v[60:63], v9 offset:28672
    s_waitcnt lgkmcnt(6)
    v_mfma_f32_16x16x32_bf16 v[88:91], a[20:23], v[64:67], v[88:91]
    v_mfma_f32_16x16x32_bf16 v[92:95], a[100:103], v[64:67], v[92:95]
    v_mfma_f32_16x16x32_bf16 v[96:99], a[180:183], v[64:67], v[96:99]
    v_mfma_f32_16x16x32_bf16 v[100:103], a[20:23], v[68:71], v[100:103]
    v_mfma_f32_16x16x32_bf16 v[104:107], a[100:103], v[68:71], v[104:107]
    v_mfma_f32_16x16x32_bf16 v[108:111], a[180:183], v[68:71], v[108:111]
    ds_read_b128 v[64:67], v9 offset:9216
    ds_read_b128 v[68:71], v9 offset:29696
    s_waitcnt lgkmcnt(6)
    v_mfma_f32_16x16x32_bf16 v[88:91], a[24:27], v[72:75], v[88:91]
    v_mfma_f32_16x16x32_bf16 v[92:95], a[104:107], v[72:75], v[92:95]
    v_mfma_f32_16x16x32_bf16 v[96:99], a[184:187], v[72:75], v[96:99]
    v_mfma_f32_16x16x32_bf16 v[100:103], a[24:27], v[76:79], v[100:103]
    v_mfma_f32_16x16x32_bf16 v[104:107], a[104:107], v[76:79], v[104:107]
    v_mfma_f32_16x16x32_bf16 v[108:111], a[184:187], v[76:79], v[108:111]
    ds_read_b128 v[72:75], v9 offset:10240
    ds_read_b128 v[76:79], v9 offset:30720
    s_waitcnt lgkmcnt(6)
    v_mfma_f32_16x16x32_bf16 v[88:91], a[28:31], v[80:83], v[88:91]
    v_mfma_f32_16x16x32_bf16 v[92:95], a[108:111], v[80:83], v[92:95]
    v_mfma_f32_16x16x32_bf16 v[96:99], a[188:191], v[80:83], v[96:99]
    v_mfma_f32_16x16x32_bf16 v[100:103], a[28:31], v[84:87], v[100:103]
    v_mfma_f32_16x16x32_bf16 v[104:107], a[108:111], v[84:87], v[104:107]
    v_mfma_f32_16x16x32_bf16 v[108:111], a[188:191], v[84:87], v[108:111]
    ds_read_b128 v[80:83], v9 offset:11264
    ds_read_b128 v[84:87], v9 offset:31744
    s_waitcnt lgkmcnt(6)
    v_mfma_f32_16x16x32_bf16 v[88:91], a[32:35], v[56:59], v[88:91]
    v_mfma_f32_16x16x32_bf16 v[92:95], a[112:115], v[56:59], v[92:95]
    v_mfma_f32_16x16x32_bf16 v[96:99], a[192:195], v[56:59], v[96:99]
    v_mfma_f32_16x16x32_bf16 v[100:103], a[32:35], v[60:63], v[100:103]
    v_mfma_f32_16x16x32_bf16 v[104:107], a[112:115], v[60:63], v[104:107]
    v_mfma_f32_16x16x32_bf16 v[108:111], a[192:195], v[60:63], v[108:111]
    ds_read_b128 v[56:59], v9 offset:12288
    ds_read_b128 v[60:63], v9 offset:32768
    s_waitcnt lgkmcnt(6)
    v_mfma_f32_16x16x32_bf16 v[88:91], a[36:39], v[64:67], v[88:91]
    v_mfma_f32_16x16x32_bf16 v[92:95], a[116:119], v[64:67], v[92:95]
    v_mfma_f32_16x16x32_bf16 v[96:99], a[196:199], v[64:67], v[96:99]
    v_mfma_f32_16x16x32_bf16 v[100:103], a[36:39], v[68:71], v[100:103]
    v_mfma_f32_16x16x32_bf16 v[104:107], a[116:119], v[68:71], v[104:107]
    v_mfma_f32_16x16x32_bf16 v[108:111], a[196:199], v[68:71], v[108:111]
    s_waitcnt vmcnt(10)
    s_barrier
    v_mov_b32 v15, s40
    buffer_store_dword v15, v14, s[8:11], 0 offen sc1
    s_cmp_ge_i32 s79, 0
    s_cselect_b32 s24, 0, 2146435072
    v_or_b32 v246, s24, v245
    v_mov_b32 v247, s79
    buffer_store_dword v247, v246, s[8:11], 0 offen sc1
    s_mov_b32 s79, -1
    ds_read_b128 v[64:67], v9 offset:13312
    ds_read_b128 v[68:71], v9 offset:33792
    s_waitcnt lgkmcnt(6)
    v_mfma_f32_16x16x32_bf16 v[88:91], a[40:43], v[72:75], v[88:91]
    v_mfma_f32_16x16x32_bf16 v[92:95], a[120:123], v[72:75], v[92:95]
    v_mfma_f32_16x16x32_bf16 v[96:99], a[200:203], v[72:75], v[96:99]
    v_mfma_f32_16x16x32_bf16 v[100:103], a[40:43], v[76:79], v[100:103]
    v_mfma_f32_16x16x32_bf16 v[104:107], a[120:123], v[76:79], v[104:107]
    v_mfma_f32_16x16x32_bf16 v[108:111], a[200:203], v[76:79], v[108:111]
    ds_read_b128 v[72:75], v9 offset:14336
    ds_read_b128 v[76:79], v9 offset:34816
    s_waitcnt lgkmcnt(6)
    s_waitcnt vmcnt(2)
    v_mfma_f32_16x16x32_bf16 v[88:91], a[44:47], v[80:83], v[88:91]
    v_mfma_f32_16x16x32_bf16 v[92:95], a[124:127], v[80:83], v[92:95]
    ds_write_b128 v10, v[16:19] offset:0
    v_mfma_f32_16x16x32_bf16 v[96:99], a[204:207], v[80:83], v[96:99]
    v_mfma_f32_16x16x32_bf16 v[100:103], a[44:47], v[84:87], v[100:103]
    v_mfma_f32_16x16x32_bf16 v[104:107], a[124:127], v[84:87], v[104:107]
    v_mfma_f32_16x16x32_bf16 v[108:111], a[204:207], v[84:87], v[108:111]
    v_mfma_f32_16x16x32_bf16 v[148:151], v[16:19], v[16:19], 0
    v_mfma_f32_16x16x32_bf16 v[144:147], v[236:239], v[16:19], 0
    v_mfma_f32_16x16x32_bf16 v[148:151], v[20:23], v[20:23], v[148:151]
    ds_read_b128 v[80:83], v9 offset:15360
    ds_read_b128 v[84:87], v9 offset:35840
    s_waitcnt lgkmcnt(7)
    v_mfma_f32_16x16x32_bf16 v[88:91], a[48:51], v[56:59], v[88:91]
    v_mfma_f32_16x16x32_bf16 v[92:95], a[128:131], v[56:59], v[92:95]
    ds_write_b128 v10, v[20:23] offset:1024
    v_mfma_f32_16x16x32_bf16 v[96:99], a[208:211], v[56:59], v[96:99]
    v_mfma_f32_16x16x32_bf16 v[100:103], a[48:51], v[60:63], v[100:103]
    v_mfma_f32_16x16x32_bf16 v[104:107], a[128:131], v[60:63], v[104:107]
    v_mfma_f32_16x16x32_bf16 v[108:111], a[208:211], v[60:63], v[108:111]
    v_mfma_f32_16x16x32_bf16 v[144:147], v[236:239], v[20:23], v[144:147]
    v_mfma_f32_16x16x32_bf16 v[148:151], v[24:27], v[24:27], v[148:151]
    v_mfma_f32_16x16x32_bf16 v[144:147], v[236:239], v[24:27], v[144:147]
    ds_read_b128 v[56:59], v9 offset:16384
    ds_read_b128 v[60:63], v9 offset:36864
    s_waitcnt lgkmcnt(8)
    v_mfma_f32_16x16x32_bf16 v[88:91], a[52:55], v[64:67], v[88:91]
    v_mfma_f32_16x16x32_bf16 v[92:95], a[132:135], v[64:67], v[92:95]
    ds_write_b128 v10, v[24:27] offset:2048
    v_mfma_f32_16x16x32_bf16 v[96:99], a[212:215], v[64:67], v[96:99]
    v_mfma_f32_16x16x32_bf16 v[100:103], a[52:55], v[68:71], v[100:103]
    v_mfma_f32_16x16x32_bf16 v[104:107], a[132:135], v[68:71], v[104:107]
    v_mfma_f32_16x16x32_bf16 v[108:111], a[212:215], v[68:71], v[108:111]
    v_mfma_f32_16x16x32_bf16 v[148:151], v[28:31], v[28:31], v[148:151]
    v_mfma_f32_16x16x32_bf16 v[144:147], v[236:239], v[28:31], v[144:147]
    v_mfma_f32_16x16x32_bf16 v[148:151], v[32:35], v[32:35], v[148:151]
    ds_read_b128 v[64:67], v9 offset:17408
    ds_read_b128 v[68:71], v9 offset:37888
    s_waitcnt lgkmcnt(9)
    v_mfma_f32_16x16x32_bf16 v[88:91], a[56:59], v[72:75], v[88:91]
    v_mfma_f32_16x16x32_bf16 v[92:95], a[136:139], v[72:75], v[92:95]
    ds_write_b128 v10, v[28:31] offset:3072
    v_mfma_f32_16x16x32_bf16 v[96:99], a[216:219], v[72:75], v[96:99]
    v_mfma_f32_16x16x32_bf16 v[100:103], a[56:59], v[76:79], v[100:103]
    v_mfma_f32_16x16x32_bf16 v[104:107], a[136:139], v[76:79], v[104:107]
    v_mfma_f32_16x16x32_bf16 v[108:111], a[216:219], v[76:79], v[108:111]
    v_mfma_f32_16x16x32_bf16 v[144:147], v[236:239], v[32:35], v[144:147]
    v_mfma_f32_16x16x32_bf16 v[148:151], v[36:39], v[36:39], v[148:151]
    v_mfma_f32_16x16x32_bf16 v[144:147], v[236:239], v[36:39], v[144:147]
    ds_read_b128 v[72:75], v9 offset:18432
    ds_read_b128 v[76:79], v9 offset:38912
    s_waitcnt lgkmcnt(9)
    v_mfma_f32_16x16x32_bf16 v[88:91], a[60:63], v[80:83], v[88:91]
    v_mfma_f32_16x16x32_bf16 v[92:95], a[140:143], v[80:83], v[92:95]
    ds_write_b128 v10, v[32:35] offset:4096
    v_mfma_f32_16x16x32_bf16 v[96:99], a[220:223], v[80:83], v[96:99]
    v_mfma_f32_16x16x32_bf16 v[100:103], a[60:63], v[84:87], v[100:103]
    v_mfma_f32_16x16x32_bf16 v[104:107], a[140:143], v[84:87], v[104:107]
    v_mfma_f32_16x16x32_bf16 v[108:111], a[220:223], v[84:87], v[108:111]
    v_mfma_f32_16x16x32_bf16 v[148:151], v[40:43], v[40:43], v[148:151]
    v_mfma_f32_16x16x32_bf16 v[144:147], v[236:239], v[40:43], v[144:147]
    v_mfma_f32_16x16x32_bf16 v[148:151], v[44:47], v[44:47], v[148:151]
    ds_read_b128 v[80:83], v9 offset:19456
    ds_read_b128 v[84:87], v9 offset:39936
    s_waitcnt lgkmcnt(9)
    v_mfma_f32_16x16x32_bf16 v[88:91], a[64:67], v[56:59], v[88:91]
    v_mfma_f32_16x16x32_bf16 v[92:95], a[144:147], v[56:59], v[92:95]
    ds_write_b128 v10, v[36:39] offset:5120
    v_mfma_f32_16x16x32_bf16 v[96:99], a[224:227], v[56:59], v[96:99]
    v_mfma_f32_16x16x32_bf16 v[100:103], a[64:67], v[60:63], v[100:103]
    v_mfma_f32_16x16x32_bf16 v[104:107], a[144:147], v[60:63], v[104:107]
    v_mfma_f32_16x16x32_bf16 v[108:111], a[224:227], v[60:63], v[108:111]
    v_mfma_f32_16x16x32_bf16 v[144:147], v[236:239], v[44:47], v[144:147]
    v_mfma_f32_16x16x32_bf16 v[148:151], v[48:51], v[48:51], v[148:151]
    v_mfma_f32_16x16x32_bf16 v[144:147], v[236:239], v[48:51], v[144:147]
    s_waitcnt lgkmcnt(7)
    v_mfma_f32_16x16x32_bf16 v[88:91], a[68:71], v[64:67], v[88:91]
    v_mfma_f32_16x16x32_bf16 v[92:95], a[148:151], v[64:67], v[92:95]
    ds_write_b128 v10, v[40:43] offset:6144
    v_mfma_f32_16x16x32_bf16 v[96:99], a[228:231], v[64:67], v[96:99]
    v_mfma_f32_16x16x32_bf16 v[100:103], a[68:71], v[68:71], v[100:103]
    v_mfma_f32_16x16x32_bf16 v[104:107], a[148:151], v[68:71], v[104:107]
    v_mfma_f32_16x16x32_bf16 v[108:111], a[228:231], v[68:71], v[108:111]
    v_mfma_f32_16x16x32_bf16 v[148:151], v[52:55], v[52:55], v[148:151]
    v_mfma_f32_16x16x32_bf16 v[144:147], v[236:239], v[52:55], v[144:147]
    s_waitcnt lgkmcnt(5)
    v_mfma_f32_16x16x32_bf16 v[88:91], a[72:75], v[72:75], v[88:91]
    v_mfma_f32_16x16x32_bf16 v[92:95], a[152:155], v[72:75], v[92:95]
    ds_write_b128 v10, v[44:47] offset:7168
    v_mfma_f32_16x16x32_bf16 v[96:99], a[232:235], v[72:75], v[96:99]
    v_mfma_f32_16x16x32_bf16 v[100:103], a[72:75], v[76:79], v[100:103]
    v_mfma_f32_16x16x32_bf16 v[104:107], a[152:155], v[76:79], v[104:107]
    v_mfma_f32_16x16x32_bf16 v[108:111], a[232:235], v[76:79], v[108:111]
    s_waitcnt lgkmcnt(3)
    v_mfma_f32_16x16x32_bf16 v[88:91], a[76:79], v[80:83], v[88:91]
    v_mfma_f32_16x16x32_bf16 v[92:95], a[156:159], v[80:83], v[92:95]
    ds_write_b128 v10, v[48:51] offset:8192
    v_mfma_f32_16x16x32_bf16 v[96:99], a[236:239], v[80:83], v[96:99]
    v_mfma_f32_16x16x32_bf16 v[100:103], a[76:79], v[84:87], v[100:103]
    v_mfma_f32_16x16x32_bf16 v[104:107], a[156:159], v[84:87], v[104:107]
    v_mfma_f32_16x16x32_bf16 v[108:111], a[236:239], v[84:87], v[108:111]
    v_cndmask_b32 v145, v148, v149, s[48:49]
    v_cndmask_b32 v145, v145, v150, s[50:51]
    v_cndmask_b32 v145, v145, v151, s[54:55]
    ds_write_b128 v10, v[52:55] offset:9216
    ds_write_b64 v140, v[144:145]
    v_pk_mul_f32 v[124:125], v[224:225], v[132:133] op_sel:[0,1] op_sel_hi:[1,1]
    v_pk_mul_f32 v[126:127], v[226:227], v[132:133] op_sel:[0,1] op_sel_hi:[1,1]
    v_pk_fma_f32 v[88:89], v[88:89], v[132:133], v[124:125] op_sel:[0,0,0] op_sel_hi:[1,0,1]
    v_pk_fma_f32 v[90:91], v[90:91], v[132:133], v[126:127] op_sel:[0,0,0] op_sel_hi:[1,0,1]
    v_pk_mul_f32 v[124:125], v[228:229], v[132:133] op_sel:[0,1] op_sel_hi:[1,1]
    v_pk_mul_f32 v[126:127], v[230:231], v[132:133] op_sel:[0,1] op_sel_hi:[1,1]
    v_pk_fma_f32 v[92:93], v[92:93], v[132:133], v[124:125] op_sel:[0,0,0] op_sel_hi:[1,0,1]
    v_pk_fma_f32 v[94:95], v[94:95], v[132:133], v[126:127] op_sel:[0,0,0] op_sel_hi:[1,0,1]
    v_pk_mul_f32 v[124:125], v[232:233], v[132:133] op_sel:[0,1] op_sel_hi:[1,1]
    v_pk_mul_f32 v[126:127], v[234:235], v[132:133] op_sel:[0,1] op_sel_hi:[1,1]
    v_pk_fma_f32 v[96:97], v[96:97], v[132:133], v[124:125] op_sel:[0,0,0] op_sel_hi:[1,0,1]
    v_pk_fma_f32 v[98:99], v[98:99], v[132:133], v[126:127] op_sel:[0,0,0] op_sel_hi:[1,0,1]
    v_pk_mul_f32 v[124:125], v[224:225], v[134:135] op_sel:[0,1] op_sel_hi:[1,1]
    v_pk_mul_f32 v[126:127], v[226:227], v[134:135] op_sel:[0,1] op_sel_hi:[1,1]
    v_pk_fma_f32 v[100:101], v[100:101], v[134:135], v[124:125] op_sel:[0,0,0] op_sel_hi:[1,0,1]
    v_pk_fma_f32 v[102:103], v[102:103], v[134:135], v[126:127] op_sel:[0,0,0] op_sel_hi:[1,0,1]
    v_pk_mul_f32 v[124:125], v[228:229], v[134:135] op_sel:[0,1] op_sel_hi:[1,1]
    v_pk_mul_f32 v[126:127], v[230:231], v[134:135] op_sel:[0,1] op_sel_hi:[1,1]
    v_pk_fma_f32 v[104:105], v[104:105], v[134:135], v[124:125] op_sel:[0,0,0] op_sel_hi:[1,0,1]
    v_pk_fma_f32 v[106:107], v[106:107], v[134:135], v[126:127] op_sel:[0,0,0] op_sel_hi:[1,0,1]
    v_pk_mul_f32 v[124:125], v[232:233], v[134:135] op_sel:[0,1] op_sel_hi:[1,1]
    v_pk_mul_f32 v[126:127], v[234:235], v[134:135] op_sel:[0,1] op_sel_hi:[1,1]
    v_pk_fma_f32 v[108:109], v[108:109], v[134:135], v[124:125] op_sel:[0,0,0] op_sel_hi:[1,0,1]
    v_pk_fma_f32 v[110:111], v[110:111], v[134:135], v[126:127] op_sel:[0,0,0] op_sel_hi:[1,0,1]
    v_cvt_pk_bf16_f32 v112, v88, v89
    v_cvt_pk_bf16_f32 v113, v90, v91
    v_cvt_pk_bf16_f32 v114, v92, v93
    v_cvt_pk_bf16_f32 v115, v94, v95
    v_cvt_pk_bf16_f32 v116, v100, v101
    v_cvt_pk_bf16_f32 v117, v102, v103
    v_cvt_pk_bf16_f32 v118, v104, v105
    v_cvt_pk_bf16_f32 v119, v106, v107
    v_cvt_pk_bf16_f32 v120, v96, v97
    v_cvt_pk_bf16_f32 v121, v98, v99
    v_cvt_pk_bf16_f32 v122, v108, v109
    v_cvt_pk_bf16_f32 v123, v110, v111
    buffer_store_dwordx4 v[112:115], v11, s[8:11], s43 offen offset:0 sc1
    buffer_store_dwordx4 v[116:119], v11, s[8:11], s43 offen offset:1024 sc1
    buffer_store_dwordx4 v[120:123], v11, s[8:11], s43 offen offset:2048 sc1
    s_add_u32 s43, s43, 393216
    s_add_u32 s40, s40, 1
    s_waitcnt lgkmcnt(0)
    s_barrier
interleave_layers__linear_attn_block__memory_aug_recurrent_mem_tr__prompt_kernel_p_next:
    s_add_u32 s24, s64, 24
    s_cmp_le_u32 s24, s40
    s_cbranch_scc1 interleave_layers__linear_attn_block__memory_aug_recurrent_mem_tr__prompt_kernel_p_pub
    s_cmp_lt_u32 s40, 64
    s_cbranch_scc1 interleave_layers__linear_attn_block__memory_aug_recurrent_mem_tr__prompt_kernel_p_seg
interleave_layers__linear_attn_block__memory_aug_recurrent_mem_tr__prompt_kernel_p_pub:
    s_waitcnt vmcnt(0)
    s_barrier
    s_cmp_eq_u32 s3, 0
    s_cbranch_scc0 interleave_layers__linear_attn_block__memory_aug_recurrent_mem_tr__prompt_kernel_fp29
    v_mov_b32 v15, s40
    buffer_store_dword v15, v14, s[8:11], 0 offen sc1
interleave_layers__linear_attn_block__memory_aug_recurrent_mem_tr__prompt_kernel_fp29:
    s_add_u32 s24, s64, 24
    s_cmp_le_u32 s24, s40
    s_cbranch_scc1 interleave_layers__linear_attn_block__memory_aug_recurrent_mem_tr__prompt_kernel_p_x
    s_cmp_lt_u32 s40, 64
    s_cbranch_scc1 interleave_layers__linear_attn_block__memory_aug_recurrent_mem_tr__prompt_kernel_p_seg
    s_cmp_ge_u32 s64, 64
    s_cbranch_scc1 interleave_layers__linear_attn_block__memory_aug_recurrent_mem_tr__prompt_kernel_p_done
interleave_layers__linear_attn_block__memory_aug_recurrent_mem_tr__prompt_kernel_p_x:
    s_add_u32 s63, s64, 1
    s_cmp_ge_i32 s69, s63
    s_cbranch_scc1 interleave_layers__linear_attn_block__memory_aug_recurrent_mem_tr__prompt_kernel_x_en_ok
    s_mov_b32 s61, 0
interleave_layers__linear_attn_block__memory_aug_recurrent_mem_tr__prompt_kernel_x_en:
    buffer_load_dword v253, v252, s[8:11], 0 offen sc1
    s_waitcnt vmcnt(0)
    v_readlane_b32 s69, v253, 0
    v_readlane_b32 s24, v253, 1
    s_min_i32 s69, s69, s24
    v_readlane_b32 s24, v253, 2
    s_min_i32 s69, s69, s24
    v_readlane_b32 s24, v253, 3
    s_min_i32 s69, s69, s24
    v_readlane_b32 s24, v253, 4
    s_min_i32 s69, s69, s24
    v_readlane_b32 s24, v253, 5
    s_min_i32 s69, s69, s24
    v_readlane_b32 s24, v253, 6
    s_min_i32 s69, s69, s24
    v_readlane_b32 s24, v253, 7
    s_min_i32 s69, s69, s24
    s_cmp_ge_i32 s69, s63
    s_cbranch_scc1 interleave_layers__linear_attn_block__memory_aug_recurrent_mem_tr__prompt_kernel_x_en_ok
    s_add_u32 s61, s61, 1
    s_cmp_ge_u32 s61, s60
    s_cbranch_scc1 interleave_layers__linear_attn_block__memory_aug_recurrent_mem_tr__prompt_kernel_x_en_to
    s_sleep 2
    s_branch interleave_layers__linear_attn_block__memory_aug_recurrent_mem_tr__prompt_kernel_x_en
interleave_layers__linear_attn_block__memory_aug_recurrent_mem_tr__prompt_kernel_x_en_to:
    s_mov_b32 s60, 1
interleave_layers__linear_attn_block__memory_aug_recurrent_mem_tr__prompt_kernel_x_en_ok:
    s_lshl_b32 s95, s92, 6
    s_add_u32 s95, s95, s64
    s_add_u32 s95, s95, 1
    s_cmp_ge_i32 s59, s95
    s_cbranch_scc1 interleave_layers__linear_attn_block__memory_aug_recurrent_mem_tr__prompt_kernel_x_ec_ok
    s_and_b32 s24, s2, 7
    s_lshl_b32 s24, s24, 7
    s_add_u32 s24, s24, 23109632
    v_and_b32 v254, 3, v1
    v_lshl_add_u32 v254, v254, 2, s24
    s_mov_b32 s61, 0
interleave_layers__linear_attn_block__memory_aug_recurrent_mem_tr__prompt_kernel_x_ec:
    buffer_load_dword v253, v254, s[8:11], 0 offen sc1
    s_waitcnt vmcnt(0)
    v_readlane_b32 s59, v253, 0
    v_readlane_b32 s24, v253, 1
    s_min_i32 s59, s59, s24
    v_readlane_b32 s24, v253, 2
    s_min_i32 s59, s59, s24
    s_cmp_ge_i32 s59, s95
    s_cbranch_scc1 interleave_layers__linear_attn_block__memory_aug_recurrent_mem_tr__prompt_kernel_x_ec_ok
    s_add_u32 s61, s61, 1
    s_cmp_ge_u32 s61, s60
    s_cbranch_scc1 interleave_layers__linear_attn_block__memory_aug_recurrent_mem_tr__prompt_kernel_x_ec_to
    s_sleep 2
    s_branch interleave_layers__linear_attn_block__memory_aug_recurrent_mem_tr__prompt_kernel_x_ec
interleave_layers__linear_attn_block__memory_aug_recurrent_mem_tr__prompt_kernel_x_ec_to:
    s_mov_b32 s60, 1
interleave_layers__linear_attn_block__memory_aug_recurrent_mem_tr__prompt_kernel_x_ec_ok:
    s_add_u32 s52, s65, 32768
    buffer_load_dwordx4 v[16:19], v240, s[8:11], s65 offen offset:0 sc1
    buffer_load_dwordx4 v[20:23], v240, s[8:11], s65 offen offset:1024 sc1
    buffer_load_dwordx4 v[24:27], v240, s[8:11], s65 offen offset:2048 sc1
    buffer_load_dwordx4 v[28:31], v240, s[8:11], s65 offen offset:3072 sc1
    buffer_load_dwordx4 v[32:35], v241, s[8:11], s65 offen offset:0 sc1
    buffer_load_dwordx4 v[36:39], v241, s[8:11], s65 offen offset:1024 sc1
    buffer_load_dwordx4 v[40:43], v241, s[8:11], s65 offen offset:2048 sc1
    buffer_load_dwordx4 v[44:47], v241, s[8:11], s65 offen offset:3072 sc1
    buffer_load_dwordx4 v[48:51], v240, s[8:11], s52 offen offset:0 sc1
    buffer_load_dwordx4 v[52:55], v240, s[8:11], s52 offen offset:1024 sc1
    buffer_load_dwordx4 v[56:59], v240, s[8:11], s52 offen offset:2048 sc1
    buffer_load_dwordx4 v[60:63], v240, s[8:11], s52 offen offset:3072 sc1
    buffer_load_dwordx4 v[64:67], v241, s[8:11], s52 offen offset:0 sc1
    buffer_load_dwordx4 v[68:71], v241, s[8:11], s52 offen offset:1024 sc1
    buffer_load_dwordx4 v[72:75], v241, s[8:11], s52 offen offset:2048 sc1
    buffer_load_dwordx4 v[76:79], v241, s[8:11], s52 offen offset:3072 sc1
    s_add_u32 s24, s68, s73
    buffer_load_dwordx4 v[196:199], v219, s[8:11], s24 offen sc1
    s_mov_b32 s61, 0
interleave_layers__linear_attn_block__memory_aug_recurrent_mem_tr__prompt_kernel_x_p0:
    buffer_load_dwordx4 v[140:143], v215, s[8:11], s67 offen offset:3072 sc1
    s_waitcnt vmcnt(0)
    v_max3_u32 v192, v140, v141, v142
    v_max_u32 v192, v192, v143
    v_cmp_eq_u32 vcc, -1, v192
    s_add_u32 s61, s61, 1
    s_cbranch_vccz interleave_layers__linear_attn_block__memory_aug_recurrent_mem_tr__prompt_kernel_x_p0_out
    s_cmp_ge_u32 s61, s60
    s_cbranch_scc1 interleave_layers__linear_attn_block__memory_aug_recurrent_mem_tr__prompt_kernel_x_p0_to
    s_sleep 8
    s_branch interleave_layers__linear_attn_block__memory_aug_recurrent_mem_tr__prompt_kernel_x_p0
interleave_layers__linear_attn_block__memory_aug_recurrent_mem_tr__prompt_kernel_x_p0_to:
    s_mov_b32 s60, 1
interleave_layers__linear_attn_block__memory_aug_recurrent_mem_tr__prompt_kernel_x_p0_out:
    s_add_u32 s53, s66, 8192
    s_mov_b32 s61, 0
interleave_layers__linear_attn_block__memory_aug_recurrent_mem_tr__prompt_kernel_x_p1:
    buffer_load_dwordx4 v[80:83], v212, s[8:11], s67 offen offset:0 sc1
    buffer_load_dwordx4 v[84:87], v212, s[8:11], s67 offen offset:1024 sc1
    buffer_load_dwordx4 v[88:91], v212, s[8:11], s67 offen offset:2048 sc1
    buffer_load_dwordx4 v[92:95], v212, s[8:11], s67 offen offset:3072 sc1
    buffer_load_dwordx4 v[96:99], v213, s[8:11], s67 offen offset:0 sc1
    buffer_load_dwordx4 v[100:103], v213, s[8:11], s67 offen offset:1024 sc1
    buffer_load_dwordx4 v[104:107], v213, s[8:11], s67 offen offset:2048 sc1
    buffer_load_dwordx4 v[108:111], v213, s[8:11], s67 offen offset:3072 sc1
    buffer_load_dwordx4 v[112:115], v214, s[8:11], s67 offen offset:0 sc1
    buffer_load_dwordx4 v[116:119], v214, s[8:11], s67 offen offset:1024 sc1
    buffer_load_dwordx4 v[120:123], v214, s[8:11], s67 offen offset:2048 sc1
    buffer_load_dwordx4 v[124:127], v214, s[8:11], s67 offen offset:3072 sc1
    buffer_load_dwordx4 v[128:131], v215, s[8:11], s67 offen offset:0 sc1
    buffer_load_dwordx4 v[132:135], v215, s[8:11], s67 offen offset:1024 sc1
    buffer_load_dwordx4 v[136:139], v215, s[8:11], s67 offen offset:2048 sc1
    buffer_load_dwordx4 v[140:143], v215, s[8:11], s67 offen offset:3072 sc1
    buffer_load_dwordx4 v[144:147], v216, s[8:11], s67 offen offset:0 sc1
    buffer_load_dwordx4 v[148:151], v216, s[8:11], s67 offen offset:1024 sc1
    buffer_load_dwordx4 v[152:155], v216, s[8:11], s67 offen offset:2048 sc1
    buffer_load_dwordx4 v[156:159], v216, s[8:11], s67 offen offset:3072 sc1
    buffer_load_dwordx4 v[160:163], v242, s[8:11], s66 offen offset:0 sc1
    buffer_load_dwordx4 v[164:167], v242, s[8:11], s66 offen offset:1024 sc1
    buffer_load_dwordx4 v[168:171], v242, s[8:11], s53 offen offset:0 sc1
    buffer_load_dwordx4 v[172:175], v242, s[8:11], s53 offen offset:1024 sc1
    s_waitcnt vmcnt(0)
    v_max3_u32 v192, v80, v81, v82
    v_max3_u32 v192, v192, v83, v84
    v_max3_u32 v192, v192, v85, v86
    v_max3_u32 v192, v192, v87, v88
    v_max3_u32 v192, v192, v89, v90
    v_max3_u32 v192, v192, v91, v92
    v_max3_u32 v192, v192, v93, v94
    v_max3_u32 v192, v192, v95, v96
    v_max3_u32 v192, v192, v97, v98
    v_max3_u32 v192, v192, v99, v100
    v_max3_u32 v192, v192, v101, v102
    v_max3_u32 v192, v192, v103, v104
    v_max3_u32 v192, v192, v105, v106
    v_max3_u32 v192, v192, v107, v108
    v_max3_u32 v192, v192, v109, v110
    v_max3_u32 v192, v192, v111, v112
    v_max3_u32 v192, v192, v113, v114
    v_max3_u32 v192, v192, v115, v116
    v_max3_u32 v192, v192, v117, v118
    v_max3_u32 v192, v192, v119, v120
    v_max3_u32 v192, v192, v121, v122
    v_max3_u32 v192, v192, v123, v124
    v_max3_u32 v192, v192, v125, v126
    v_max3_u32 v192, v192, v127, v128
    v_max3_u32 v192, v192, v129, v130
    v_max3_u32 v192, v192, v131, v132
    v_max3_u32 v192, v192, v133, v134
    v_max3_u32 v192, v192, v135, v136
    v_max3_u32 v192, v192, v137, v138
    v_max3_u32 v192, v192, v139, v140
    v_max3_u32 v192, v192, v141, v142
    v_max3_u32 v192, v192, v143, v144
    v_max3_u32 v192, v192, v145, v146
    v_max3_u32 v192, v192, v147, v148
    v_max3_u32 v192, v192, v149, v150
    v_max3_u32 v192, v192, v151, v152
    v_max3_u32 v192, v192, v153, v154
    v_max3_u32 v192, v192, v155, v156
    v_max3_u32 v192, v192, v157, v158
    v_max3_u32 v192, v192, v159, v160
    v_max3_u32 v192, v192, v161, v162
    v_max3_u32 v192, v192, v163, v164
    v_max3_u32 v192, v192, v165, v166
    v_max3_u32 v192, v192, v167, v168
    v_max3_u32 v192, v192, v169, v170
    v_max3_u32 v192, v192, v171, v172
    v_max3_u32 v192, v192, v173, v174
    v_max_u32 v192, v192, v175
    v_cmp_eq_u32 vcc, -1, v192
    s_add_u32 s61, s61, 1
    s_cbranch_vccz interleave_layers__linear_attn_block__memory_aug_recurrent_mem_tr__prompt_kernel_x_p1_out
    s_cmp_ge_u32 s61, s60
    s_cbranch_scc1 interleave_layers__linear_attn_block__memory_aug_recurrent_mem_tr__prompt_kernel_x_p1_to
    s_sleep 2
    s_branch interleave_layers__linear_attn_block__memory_aug_recurrent_mem_tr__prompt_kernel_x_p1
interleave_layers__linear_attn_block__memory_aug_recurrent_mem_tr__prompt_kernel_x_p1_to:
    s_mov_b32 s60, 1
interleave_layers__linear_attn_block__memory_aug_recurrent_mem_tr__prompt_kernel_x_p1_out:
    v_mfma_f32_16x16x32_bf16 v[176:179], v[16:19], v[80:83], 0
    v_mfma_f32_16x16x32_bf16 v[180:183], v[16:19], v[84:87], 0
    v_mfma_f32_16x16x32_bf16 v[184:187], v[48:51], v[80:83], 0
    v_mfma_f32_16x16x32_bf16 v[188:191], v[48:51], v[84:87], 0
    v_mfma_f32_16x16x32_bf16 v[176:179], v[20:23], v[88:91], v[176:179]
    v_mfma_f32_16x16x32_bf16 v[180:183], v[20:23], v[92:95], v[180:183]
    v_mfma_f32_16x16x32_bf16 v[184:187], v[52:55], v[88:91], v[184:187]
    v_mfma_f32_16x16x32_bf16 v[188:191], v[52:55], v[92:95], v[188:191]
    v_mfma_f32_16x16x32_bf16 v[176:179], v[24:27], v[96:99], v[176:179]
    v_mfma_f32_16x16x32_bf16 v[180:183], v[24:27], v[100:103], v[180:183]
    v_mfma_f32_16x16x32_bf16 v[184:187], v[56:59], v[96:99], v[184:187]
    v_mfma_f32_16x16x32_bf16 v[188:191], v[56:59], v[100:103], v[188:191]
    v_mfma_f32_16x16x32_bf16 v[176:179], v[28:31], v[104:107], v[176:179]
    v_mfma_f32_16x16x32_bf16 v[180:183], v[28:31], v[108:111], v[180:183]
    v_mfma_f32_16x16x32_bf16 v[184:187], v[60:63], v[104:107], v[184:187]
    v_mfma_f32_16x16x32_bf16 v[188:191], v[60:63], v[108:111], v[188:191]
    v_mfma_f32_16x16x32_bf16 v[176:179], v[32:35], v[112:115], v[176:179]
    v_mfma_f32_16x16x32_bf16 v[180:183], v[32:35], v[116:119], v[180:183]
    v_mfma_f32_16x16x32_bf16 v[184:187], v[64:67], v[112:115], v[184:187]
    v_mfma_f32_16x16x32_bf16 v[188:191], v[64:67], v[116:119], v[188:191]
    v_mfma_f32_16x16x32_bf16 v[176:179], v[36:39], v[120:123], v[176:179]
    v_mfma_f32_16x16x32_bf16 v[180:183], v[36:39], v[124:127], v[180:183]
    v_mfma_f32_16x16x32_bf16 v[184:187], v[68:71], v[120:123], v[184:187]
    v_mfma_f32_16x16x32_bf16 v[188:191], v[68:71], v[124:127], v[188:191]
    v_mfma_f32_16x16x32_bf16 v[176:179], v[40:43], v[128:131], v[176:179]
    v_mfma_f32_16x16x32_bf16 v[180:183], v[40:43], v[132:135], v[180:183]
    v_mfma_f32_16x16x32_bf16 v[184:187], v[72:75], v[128:131], v[184:187]
    v_mfma_f32_16x16x32_bf16 v[188:191], v[72:75], v[132:135], v[188:191]
    v_mfma_f32_16x16x32_bf16 v[176:179], v[44:47], v[136:139], v[176:179]
    v_mfma_f32_16x16x32_bf16 v[180:183], v[44:47], v[140:143], v[180:183]
    v_mfma_f32_16x16x32_bf16 v[184:187], v[76:79], v[136:139], v[184:187]
    v_mfma_f32_16x16x32_bf16 v[188:191], v[76:79], v[140:143], v[188:191]
    v_mfma_f32_16x16x32_bf16 v[176:179], v[160:163], v[144:147], v[176:179]
    v_mfma_f32_16x16x32_bf16 v[180:183], v[160:163], v[148:151], v[180:183]
    v_mfma_f32_16x16x32_bf16 v[184:187], v[168:171], v[144:147], v[184:187]
    v_mfma_f32_16x16x32_bf16 v[188:191], v[168:171], v[148:151], v[188:191]
    v_mfma_f32_16x16x32_bf16 v[176:179], v[164:167], v[152:155], v[176:179]
    v_mfma_f32_16x16x32_bf16 v[180:183], v[164:167], v[156:159], v[180:183]
    v_mfma_f32_16x16x32_bf16 v[184:187], v[172:175], v[152:155], v[184:187]
    v_mfma_f32_16x16x32_bf16 v[188:191], v[172:175], v[156:159], v[188:191]
    s_nop 4
    ds_write_b128 v217, v[176:179] offset:0
    ds_write_b128 v217, v[180:183] offset:1024
    ds_write_b128 v217, v[184:187] offset:2048
    ds_write_b128 v217, v[188:191] offset:3072
    s_waitcnt lgkmcnt(0)
    s_barrier
    s_cmp_ge_u32 s3, 2
    s_cbranch_scc1 interleave_layers__linear_attn_block__memory_aug_recurrent_mem_tr__prompt_kernel_xs30
    ds_read_b128 v[16:19], v218 offset:0
    ds_read_b128 v[20:23], v218 offset:4096
    ds_read_b128 v[24:27], v218 offset:8192
    ds_read_b128 v[28:31], v218 offset:12288
    ds_read_b128 v[32:35], v218 offset:2048
    ds_read_b128 v[36:39], v218 offset:6144
    ds_read_b128 v[40:43], v218 offset:10240
    ds_read_b128 v[44:47], v218 offset:14336
    s_waitcnt lgkmcnt(4)
    v_pk_add_f32 v[16:17], v[16:17], v[20:21]
    v_pk_add_f32 v[24:25], v[24:25], v[28:29]
    v_pk_add_f32 v[18:19], v[18:19], v[22:23]
    v_pk_add_f32 v[26:27], v[26:27], v[30:31]
    v_pk_add_f32 v[16:17], v[16:17], v[24:25]
    v_pk_add_f32 v[18:19], v[18:19], v[26:27]
    v_cvt_pk_bf16_f32 v20, v16, v17
    v_cvt_pk_bf16_f32 v21, v18, v19
    v_lshlrev_b32 v16, 16, v20
    v_and_b32 v17, 0xffff0000, v20
    v_lshlrev_b32 v22, 16, v196
    v_and_b32 v23, 0xffff0000, v196
    v_pk_add_f32 v[16:17], v[16:17], v[22:23]
    v_cvt_pk_bf16_f32 v48, v16, v17
    v_lshlrev_b32 v16, 16, v21
    v_and_b32 v17, 0xffff0000, v21
    v_lshlrev_b32 v22, 16, v197
    v_and_b32 v23, 0xffff0000, v197
    v_pk_add_f32 v[16:17], v[16:17], v[22:23]
    v_cvt_pk_bf16_f32 v49, v16, v17
    s_waitcnt lgkmcnt(0)
    v_pk_add_f32 v[32:33], v[32:33], v[36:37]
    v_pk_add_f32 v[40:41], v[40:41], v[44:45]
    v_pk_add_f32 v[34:35], v[34:35], v[38:39]
    v_pk_add_f32 v[42:43], v[42:43], v[46:47]
    v_pk_add_f32 v[32:33], v[32:33], v[40:41]
    v_pk_add_f32 v[34:35], v[34:35], v[42:43]
    v_cvt_pk_bf16_f32 v36, v32, v33
    v_cvt_pk_bf16_f32 v37, v34, v35
    v_lshlrev_b32 v32, 16, v36
    v_and_b32 v33, 0xffff0000, v36
    v_lshlrev_b32 v38, 16, v198
    v_and_b32 v39, 0xffff0000, v198
    v_pk_add_f32 v[32:33], v[32:33], v[38:39]
    v_cvt_pk_bf16_f32 v50, v32, v33
    v_lshlrev_b32 v32, 16, v37
    v_and_b32 v33, 0xffff0000, v37
    v_lshlrev_b32 v38, 16, v199
    v_and_b32 v39, 0xffff0000, v199
    v_pk_add_f32 v[32:33], v[32:33], v[38:39]
    v_cvt_pk_bf16_f32 v51, v32, v33
    s_cmp_eq_u32 s92, 0
    s_cbranch_scc0 interleave_layers__linear_attn_block__memory_aug_recurrent_mem_tr__prompt_kernel_xo31
    s_add_u32 s24, s68, 4194304
    buffer_store_dwordx4 v[48:51], v219, s[8:11], s24 offen sc1
    s_branch interleave_layers__linear_attn_block__memory_aug_recurrent_mem_tr__prompt_kernel_xs30
interleave_layers__linear_attn_block__memory_aug_recurrent_mem_tr__prompt_kernel_xo31:
    buffer_store_dwordx2 v[48:49], v243, s[12:15], s68 offen
    buffer_store_dwordx2 v[50:51], v243, s[12:15], s68 offen offset:32
interleave_layers__linear_attn_block__memory_aug_recurrent_mem_tr__prompt_kernel_xs30:
    s_lshr_b32 s25, s64, 2
    s_add_u32 s25, s25, 1
    s_cmp_eq_u32 s92, 0
    s_cselect_b32 s79, s25, -1
    s_cmp_lt_u32 s40, 64
    s_cbranch_scc1 interleave_layers__linear_attn_block__memory_aug_recurrent_mem_tr__prompt_kernel_xp32
    s_waitcnt vmcnt(0)
    s_barrier
    s_cmp_ge_i32 s79, 0
    s_cselect_b32 s24, 0, 2146435072
    v_or_b32 v246, s24, v245
    v_mov_b32 v247, s79
    buffer_store_dword v247, v246, s[8:11], 0 offen sc1
    s_mov_b32 s79, -1
interleave_layers__linear_attn_block__memory_aug_recurrent_mem_tr__prompt_kernel_xp32:
    s_add_u32 s64, s64, 4
    s_add_u32 s65, s65, 5242880
    s_add_u32 s66, s66, 1835008
    s_add_u32 s67, s67, 1835008
    s_add_u32 s68, s68, 163840
    s_branch interleave_layers__linear_attn_block__memory_aug_recurrent_mem_tr__prompt_kernel_p_next
interleave_layers__linear_attn_block__memory_aug_recurrent_mem_tr__prompt_kernel_p_done:
    s_cmp_eq_u32 s92, 0
    s_cbranch_scc0 interleave_layers__linear_attn_block__memory_aug_recurrent_mem_tr__prompt_kernel_end
    s_mov_b32 s92, 1
    s_branch interleave_layers__linear_attn_block__memory_aug_recurrent_mem_tr__prompt_kernel_p_layer
interleave_layers__linear_attn_block__memory_aug_recurrent_mem_tr__prompt_kernel_roleO:
    s_sub_u32 s44, s2, 200
    s_load_dwordx2 s[6:7], s[0:1], 64
    s_waitcnt lgkmcnt(0)
    s_mov_b32 s12, s6
    s_mov_b32 s13, s7
    s_mov_b32 s14, 7864320
    s_mov_b32 s15, 0x00020000
    v_add_u32 v8, 0, v0
    s_mov_b32 s24, 3277
    v_mul_lo_u32 v9, v8, s24
    v_lshrrev_b32 v9, 18, v9
    v_mul_u32_u24 v10, 80, v9
    v_sub_u32 v10, v8, v10
    v_mul_u32_u24 v16, 1312, v9
    v_lshl_add_u32 v16, v10, 4, v16
    v_add_u32 v8, 256, v0
    s_mov_b32 s24, 3277
    v_mul_lo_u32 v9, v8, s24
    v_lshrrev_b32 v9, 18, v9
    v_mul_u32_u24 v10, 80, v9
    v_sub_u32 v10, v8, v10
    v_mul_u32_u24 v17, 1312, v9
    v_lshl_add_u32 v17, v10, 4, v17
    v_add_u32 v8, 512, v0
    s_mov_b32 s24, 3277
    v_mul_lo_u32 v9, v8, s24
    v_lshrrev_b32 v9, 18, v9
    v_mul_u32_u24 v10, 80, v9
    v_sub_u32 v10, v8, v10
    v_mul_u32_u24 v18, 1312, v9
    v_lshl_add_u32 v18, v10, 4, v18
    v_add_u32 v8, 768, v0
    s_mov_b32 s24, 3277
    v_mul_lo_u32 v9, v8, s24
    v_lshrrev_b32 v9, 18, v9
    v_mul_u32_u24 v10, 80, v9
    v_sub_u32 v10, v8, v10
    v_mul_u32_u24 v19, 1312, v9
    v_lshl_add_u32 v19, v10, 4, v19
    v_add_u32 v8, 1024, v0
    s_mov_b32 s24, 3277
    v_mul_lo_u32 v9, v8, s24
    v_lshrrev_b32 v9, 18, v9
    v_mul_u32_u24 v10, 80, v9
    v_sub_u32 v10, v8, v10
    v_mul_u32_u24 v20, 1312, v9
    v_lshl_add_u32 v20, v10, 4, v20
    v_add_u32 v8, 1280, v0
    s_mov_b32 s24, 3277
    v_mul_lo_u32 v9, v8, s24
    v_lshrrev_b32 v9, 18, v9
    v_mul_u32_u24 v10, 80, v9
    v_sub_u32 v10, v8, v10
    v_mul_u32_u24 v21, 1312, v9
    v_lshl_add_u32 v21, v10, 4, v21
    v_add_u32 v8, 1536, v0
    s_mov_b32 s24, 3277
    v_mul_lo_u32 v9, v8, s24
    v_lshrrev_b32 v9, 18, v9
    v_mul_u32_u24 v10, 80, v9
    v_sub_u32 v10, v8, v10
    v_mul_u32_u24 v22, 1312, v9
    v_lshl_add_u32 v22, v10, 4, v22
    v_add_u32 v8, 1792, v0
    s_mov_b32 s24, 3277
    v_mul_lo_u32 v9, v8, s24
    v_lshrrev_b32 v9, 18, v9
    v_mul_u32_u24 v10, 80, v9
    v_sub_u32 v10, v8, v10
    v_mul_u32_u24 v23, 1312, v9
    v_lshl_add_u32 v23, v10, 4, v23
    v_add_u32 v8, 2048, v0
    s_mov_b32 s24, 3277
    v_mul_lo_u32 v9, v8, s24
    v_lshrrev_b32 v9, 18, v9
    v_mul_u32_u24 v10, 80, v9
    v_sub_u32 v10, v8, v10
    v_mul_u32_u24 v24, 1312, v9
    v_lshl_add_u32 v24, v10, 4, v24
    v_add_u32 v8, 2304, v0
    s_mov_b32 s24, 3277
    v_mul_lo_u32 v9, v8, s24
    v_lshrrev_b32 v9, 18, v9
    v_mul_u32_u24 v10, 80, v9
    v_sub_u32 v10, v8, v10
    v_mul_u32_u24 v25, 1312, v9
    v_lshl_add_u32 v25, v10, 4, v25
    v_add_u32 v8, 2560, v0
    s_mov_b32 s24, 3277
    v_mul_lo_u32 v9, v8, s24
    v_lshrrev_b32 v9, 18, v9
    v_mul_u32_u24 v10, 80, v9
    v_sub_u32 v10, v8, v10
    v_mul_u32_u24 v26, 1312, v9
    v_lshl_add_u32 v26, v10, 4, v26
    v_add_u32 v8, 2816, v0
    s_mov_b32 s24, 3277
    v_mul_lo_u32 v9, v8, s24
    v_lshrrev_b32 v9, 18, v9
    v_mul_u32_u24 v10, 80, v9
    v_sub_u32 v10, v8, v10
    v_mul_u32_u24 v27, 1312, v9
    v_lshl_add_u32 v27, v10, 4, v27
    v_add_u32 v8, 3072, v0
    s_mov_b32 s24, 3277
    v_mul_lo_u32 v9, v8, s24
    v_lshrrev_b32 v9, 18, v9
    v_mul_u32_u24 v10, 80, v9
    v_sub_u32 v10, v8, v10
    v_mul_u32_u24 v28, 1312, v9
    v_lshl_add_u32 v28, v10, 4, v28
    v_add_u32 v8, 3328, v0
    s_mov_b32 s24, 3277
    v_mul_lo_u32 v9, v8, s24
    v_lshrrev_b32 v9, 18, v9
    v_mul_u32_u24 v10, 80, v9
    v_sub_u32 v10, v8, v10
    v_mul_u32_u24 v29, 1312, v9
    v_lshl_add_u32 v29, v10, 4, v29
    v_add_u32 v8, 3584, v0
    s_mov_b32 s24, 3277
    v_mul_lo_u32 v9, v8, s24
    v_lshrrev_b32 v9, 18, v9
    v_mul_u32_u24 v10, 80, v9
    v_sub_u32 v10, v8, v10
    v_mul_u32_u24 v30, 1312, v9
    v_lshl_add_u32 v30, v10, 4, v30
    v_add_u32 v8, 3840, v0
    s_mov_b32 s24, 3277
    v_mul_lo_u32 v9, v8, s24
    v_lshrrev_b32 v9, 18, v9
    v_mul_u32_u24 v10, 80, v9
    v_sub_u32 v10, v8, v10
    v_mul_u32_u24 v31, 1312, v9
    v_lshl_add_u32 v31, v10, 4, v31
    v_add_u32 v8, 4096, v0
    s_mov_b32 s24, 3277
    v_mul_lo_u32 v9, v8, s24
    v_lshrrev_b32 v9, 18, v9
    v_mul_u32_u24 v10, 80, v9
    v_sub_u32 v10, v8, v10
    v_mul_u32_u24 v32, 1312, v9
    v_lshl_add_u32 v32, v10, 4, v32
    v_add_u32 v8, 4352, v0
    s_mov_b32 s24, 3277
    v_mul_lo_u32 v9, v8, s24
    v_lshrrev_b32 v9, 18, v9
    v_mul_u32_u24 v10, 80, v9
    v_sub_u32 v10, v8, v10
    v_mul_u32_u24 v33, 1312, v9
    v_lshl_add_u32 v33, v10, 4, v33
    v_add_u32 v8, 4608, v0
    s_mov_b32 s24, 3277
    v_mul_lo_u32 v9, v8, s24
    v_lshrrev_b32 v9, 18, v9
    v_mul_u32_u24 v10, 80, v9
    v_sub_u32 v10, v8, v10
    v_mul_u32_u24 v34, 1312, v9
    v_lshl_add_u32 v34, v10, 4, v34
    v_add_u32 v8, 4864, v0
    s_mov_b32 s24, 3277
    v_mul_lo_u32 v9, v8, s24
    v_lshrrev_b32 v9, 18, v9
    v_mul_u32_u24 v10, 80, v9
    v_sub_u32 v10, v8, v10
    v_mul_u32_u24 v35, 1312, v9
    v_lshl_add_u32 v35, v10, 4, v35
    v_add_u32 v8, 5120, v0
    s_mov_b32 s24, 3277
    v_mul_lo_u32 v9, v8, s24
    v_lshrrev_b32 v9, 18, v9
    v_mul_u32_u24 v10, 80, v9
    v_sub_u32 v10, v8, v10
    v_mul_u32_u24 v36, 1312, v9
    v_lshl_add_u32 v36, v10, 4, v36
    v_add_u32 v8, 5376, v0
    s_mov_b32 s24, 3277
    v_mul_lo_u32 v9, v8, s24
    v_lshrrev_b32 v9, 18, v9
    v_mul_u32_u24 v10, 80, v9
    v_sub_u32 v10, v8, v10
    v_mul_u32_u24 v37, 1312, v9
    v_lshl_add_u32 v37, v10, 4, v37
    v_add_u32 v8, 5632, v0
    s_mov_b32 s24, 3277
    v_mul_lo_u32 v9, v8, s24
    v_lshrrev_b32 v9, 18, v9
    v_mul_u32_u24 v10, 80, v9
    v_sub_u32 v10, v8, v10
    v_mul_u32_u24 v38, 1312, v9
    v_lshl_add_u32 v38, v10, 4, v38
    v_add_u32 v8, 5888, v0
    s_mov_b32 s24, 3277
    v_mul_lo_u32 v9, v8, s24
    v_lshrrev_b32 v9, 18, v9
    v_mul_u32_u24 v10, 80, v9
    v_sub_u32 v10, v8, v10
    v_mul_u32_u24 v39, 1312, v9
    v_lshl_add_u32 v39, v10, 4, v39
    v_add_u32 v8, 6144, v0
    s_mov_b32 s24, 3277
    v_mul_lo_u32 v9, v8, s24
    v_lshrrev_b32 v9, 18, v9
    v_mul_u32_u24 v10, 80, v9
    v_sub_u32 v10, v8, v10
    v_mul_u32_u24 v40, 1312, v9
    v_lshl_add_u32 v40, v10, 4, v40
    v_add_u32 v8, 6400, v0
    s_mov_b32 s24, 3277
    v_mul_lo_u32 v9, v8, s24
    v_lshrrev_b32 v9, 18, v9
    v_mul_u32_u24 v10, 80, v9
    v_sub_u32 v10, v8, v10
    v_mul_u32_u24 v41, 1312, v9
    v_lshl_add_u32 v41, v10, 4, v41
    v_add_u32 v8, 6656, v0
    s_mov_b32 s24, 3277
    v_mul_lo_u32 v9, v8, s24
    v_lshrrev_b32 v9, 18, v9
    v_mul_u32_u24 v10, 80, v9
    v_sub_u32 v10, v8, v10
    v_mul_u32_u24 v42, 1312, v9
    v_lshl_add_u32 v42, v10, 4, v42
    v_add_u32 v8, 6912, v0
    s_mov_b32 s24, 3277
    v_mul_lo_u32 v9, v8, s24
    v_lshrrev_b32 v9, 18, v9
    v_mul_u32_u24 v10, 80, v9
    v_sub_u32 v10, v8, v10
    v_mul_u32_u24 v43, 1312, v9
    v_lshl_add_u32 v43, v10, 4, v43
    v_add_u32 v8, 7168, v0
    s_mov_b32 s24, 3277
    v_mul_lo_u32 v9, v8, s24
    v_lshrrev_b32 v9, 18, v9
    v_mul_u32_u24 v10, 80, v9
    v_sub_u32 v10, v8, v10
    v_mul_u32_u24 v44, 1312, v9
    v_lshl_add_u32 v44, v10, 4, v44
    v_add_u32 v8, 7424, v0
    s_mov_b32 s24, 3277
    v_mul_lo_u32 v9, v8, s24
    v_lshrrev_b32 v9, 18, v9
    v_mul_u32_u24 v10, 80, v9
    v_sub_u32 v10, v8, v10
    v_mul_u32_u24 v45, 1312, v9
    v_lshl_add_u32 v45, v10, 4, v45
    v_lshlrev_b32 v4, 4, v0
    s_mul_i32 s45, s44, 245760
    s_add_u32 s46, s45, 0
    buffer_load_dwordx4 v[48:51], v4, s[12:15], s46 offen
    s_add_u32 s46, s45, 4096
    buffer_load_dwordx4 v[52:55], v4, s[12:15], s46 offen
    s_add_u32 s46, s45, 8192
    buffer_load_dwordx4 v[56:59], v4, s[12:15], s46 offen
    s_add_u32 s46, s45, 12288
    buffer_load_dwordx4 v[60:63], v4, s[12:15], s46 offen
    s_add_u32 s46, s45, 16384
    buffer_load_dwordx4 v[64:67], v4, s[12:15], s46 offen
    s_add_u32 s46, s45, 20480
    buffer_load_dwordx4 v[68:71], v4, s[12:15], s46 offen
    s_add_u32 s46, s45, 24576
    buffer_load_dwordx4 v[72:75], v4, s[12:15], s46 offen
    s_add_u32 s46, s45, 28672
    buffer_load_dwordx4 v[76:79], v4, s[12:15], s46 offen
    s_add_u32 s46, s45, 32768
    buffer_load_dwordx4 v[80:83], v4, s[12:15], s46 offen
    s_add_u32 s46, s45, 36864
    buffer_load_dwordx4 v[84:87], v4, s[12:15], s46 offen
    s_add_u32 s46, s45, 40960
    buffer_load_dwordx4 v[88:91], v4, s[12:15], s46 offen
    s_add_u32 s46, s45, 45056
    buffer_load_dwordx4 v[92:95], v4, s[12:15], s46 offen
    s_add_u32 s46, s45, 49152
    buffer_load_dwordx4 v[96:99], v4, s[12:15], s46 offen
    s_add_u32 s46, s45, 53248
    buffer_load_dwordx4 v[100:103], v4, s[12:15], s46 offen
    s_add_u32 s46, s45, 57344
    buffer_load_dwordx4 v[104:107], v4, s[12:15], s46 offen
    s_add_u32 s46, s45, 61440
    buffer_load_dwordx4 v[108:111], v4, s[12:15], s46 offen
    s_add_u32 s46, s45, 65536
    buffer_load_dwordx4 v[112:115], v4, s[12:15], s46 offen
    s_add_u32 s46, s45, 69632
    buffer_load_dwordx4 v[116:119], v4, s[12:15], s46 offen
    s_add_u32 s46, s45, 73728
    buffer_load_dwordx4 v[120:123], v4, s[12:15], s46 offen
    s_add_u32 s46, s45, 77824
    buffer_load_dwordx4 v[124:127], v4, s[12:15], s46 offen
    s_add_u32 s46, s45, 81920
    buffer_load_dwordx4 v[128:131], v4, s[12:15], s46 offen
    s_add_u32 s46, s45, 86016
    buffer_load_dwordx4 v[132:135], v4, s[12:15], s46 offen
    s_add_u32 s46, s45, 90112
    buffer_load_dwordx4 v[136:139], v4, s[12:15], s46 offen
    s_add_u32 s46, s45, 94208
    buffer_load_dwordx4 v[140:143], v4, s[12:15], s46 offen
    s_add_u32 s46, s45, 98304
    buffer_load_dwordx4 v[144:147], v4, s[12:15], s46 offen
    s_add_u32 s46, s45, 102400
    buffer_load_dwordx4 v[148:151], v4, s[12:15], s46 offen
    s_add_u32 s46, s45, 106496
    buffer_load_dwordx4 v[152:155], v4, s[12:15], s46 offen
    s_add_u32 s46, s45, 110592
    buffer_load_dwordx4 v[156:159], v4, s[12:15], s46 offen
    s_add_u32 s46, s45, 114688
    buffer_load_dwordx4 v[160:163], v4, s[12:15], s46 offen
    s_add_u32 s46, s45, 118784
    buffer_load_dwordx4 v[164:167], v4, s[12:15], s46 offen
    s_add_u32 s46, s45, 122880
    buffer_load_dwordx4 v[168:171], v4, s[12:15], s46 offen
    s_add_u32 s46, s45, 126976
    buffer_load_dwordx4 v[172:175], v4, s[12:15], s46 offen
    s_add_u32 s46, s45, 131072
    buffer_load_dwordx4 v[176:179], v4, s[12:15], s46 offen
    s_add_u32 s46, s45, 135168
    buffer_load_dwordx4 v[180:183], v4, s[12:15], s46 offen
    s_add_u32 s46, s45, 139264
    buffer_load_dwordx4 v[184:187], v4, s[12:15], s46 offen
    s_add_u32 s46, s45, 143360
    buffer_load_dwordx4 v[188:191], v4, s[12:15], s46 offen
    s_add_u32 s46, s45, 147456
    buffer_load_dwordx4 v[192:195], v4, s[12:15], s46 offen
    s_add_u32 s46, s45, 151552
    buffer_load_dwordx4 v[196:199], v4, s[12:15], s46 offen
    s_add_u32 s46, s45, 155648
    buffer_load_dwordx4 v[200:203], v4, s[12:15], s46 offen
    s_add_u32 s46, s45, 159744
    buffer_load_dwordx4 v[204:207], v4, s[12:15], s46 offen
    s_add_u32 s46, s45, 163840
    buffer_load_dwordx4 v[208:211], v4, s[12:15], s46 offen
    s_add_u32 s46, s45, 167936
    buffer_load_dwordx4 v[212:215], v4, s[12:15], s46 offen
    s_add_u32 s46, s45, 172032
    buffer_load_dwordx4 v[216:219], v4, s[12:15], s46 offen
    s_add_u32 s46, s45, 176128
    buffer_load_dwordx4 v[220:223], v4, s[12:15], s46 offen
    s_add_u32 s46, s45, 180224
    buffer_load_dwordx4 v[224:227], v4, s[12:15], s46 offen
    s_add_u32 s46, s45, 184320
    buffer_load_dwordx4 v[228:231], v4, s[12:15], s46 offen
    s_add_u32 s46, s45, 188416
    buffer_load_dwordx4 v[232:235], v4, s[12:15], s46 offen
    s_add_u32 s46, s45, 192512
    buffer_load_dwordx4 v[236:239], v4, s[12:15], s46 offen
    s_add_u32 s46, s45, 196608
    buffer_load_dwordx4 v[240:243], v4, s[12:15], s46 offen
    s_add_u32 s46, s45, 200704
    buffer_load_dwordx4 v[244:247], v4, s[12:15], s46 offen
    s_add_u32 s46, s45, 204800
    buffer_load_dwordx4 v[248:251], v4, s[12:15], s46 offen
    s_add_u32 s46, s45, 208896
    buffer_load_dwordx4 v[252:255], v4, s[12:15], s46 offen
    v_lshrrev_b32 v8, 2, v2
    v_lshl_add_u32 v8, v3, 2, v8
    v_mul_u32_u24 v5, 1312, v8
    v_and_b32 v8, 3, v2
    v_lshl_add_u32 v5, v8, 3, v5
    s_mul_i32 s24, s3, 320
    v_add_u32 v5, s24, v5
    v_add_u32 v6, 62976, v5
    s_waitcnt vmcnt(22)
    ds_write_b128 v16, v[48:51]
    ds_write_b128 v17, v[52:55]
    ds_write_b128 v18, v[56:59]
    ds_write_b128 v19, v[60:63]
    ds_write_b128 v20, v[64:67]
    ds_write_b128 v21, v[68:71]
    ds_write_b128 v22, v[72:75]
    ds_write_b128 v23, v[76:79]
    ds_write_b128 v24, v[80:83]
    ds_write_b128 v25, v[84:87]
    ds_write_b128 v26, v[88:91]
    ds_write_b128 v27, v[92:95]
    ds_write_b128 v28, v[96:99]
    ds_write_b128 v29, v[100:103]
    ds_write_b128 v30, v[104:107]
    ds_write_b128 v31, v[108:111]
    ds_write_b128 v32, v[112:115]
    ds_write_b128 v33, v[116:119]
    ds_write_b128 v34, v[120:123]
    ds_write_b128 v35, v[124:127]
    ds_write_b128 v36, v[128:131]
    ds_write_b128 v37, v[132:135]
    ds_write_b128 v38, v[136:139]
    ds_write_b128 v39, v[140:143]
    ds_write_b128 v40, v[144:147]
    ds_write_b128 v41, v[148:151]
    ds_write_b128 v42, v[152:155]
    ds_write_b128 v43, v[156:159]
    ds_write_b128 v44, v[160:163]
    ds_write_b128 v45, v[164:167]
    s_waitcnt lgkmcnt(0)
    s_add_u32 s46, s45, 212992
    buffer_load_dwordx4 v[48:51], v4, s[12:15], s46 offen
    s_add_u32 s46, s45, 217088
    buffer_load_dwordx4 v[52:55], v4, s[12:15], s46 offen
    s_add_u32 s46, s45, 221184
    buffer_load_dwordx4 v[56:59], v4, s[12:15], s46 offen
    s_add_u32 s46, s45, 225280
    buffer_load_dwordx4 v[60:63], v4, s[12:15], s46 offen
    s_add_u32 s46, s45, 229376
    buffer_load_dwordx4 v[64:67], v4, s[12:15], s46 offen
    s_add_u32 s46, s45, 233472
    buffer_load_dwordx4 v[68:71], v4, s[12:15], s46 offen
    s_add_u32 s46, s45, 237568
    buffer_load_dwordx4 v[72:75], v4, s[12:15], s46 offen
    s_add_u32 s46, s45, 241664
    buffer_load_dwordx4 v[76:79], v4, s[12:15], s46 offen
    s_barrier
    ds_read_b64_tr_b16 a[0:1], v5 offset:0
    ds_read_b64_tr_b16 a[2:3], v5 offset:20992
    ds_read_b64_tr_b16 a[4:5], v6 offset:0
    ds_read_b64_tr_b16 a[6:7], v6 offset:20992
    ds_read_b64_tr_b16 a[16:17], v5 offset:41984
    ds_read_b64_tr_b16 a[18:19], v6 offset:41984
    ds_read_b64_tr_b16 a[24:25], v5 offset:32
    ds_read_b64_tr_b16 a[26:27], v5 offset:21024
    ds_read_b64_tr_b16 a[28:29], v6 offset:32
    ds_read_b64_tr_b16 a[30:31], v6 offset:21024
    ds_read_b64_tr_b16 a[40:41], v5 offset:42016
    ds_read_b64_tr_b16 a[42:43], v6 offset:42016
    ds_read_b64_tr_b16 a[48:49], v5 offset:64
    ds_read_b64_tr_b16 a[50:51], v5 offset:21056
    ds_read_b64_tr_b16 a[52:53], v6 offset:64
    ds_read_b64_tr_b16 a[54:55], v6 offset:21056
    ds_read_b64_tr_b16 a[64:65], v5 offset:42048
    ds_read_b64_tr_b16 a[66:67], v6 offset:42048
    ds_read_b64_tr_b16 a[72:73], v5 offset:96
    ds_read_b64_tr_b16 a[74:75], v5 offset:21088
    ds_read_b64_tr_b16 a[76:77], v6 offset:96
    ds_read_b64_tr_b16 a[78:79], v6 offset:21088
    ds_read_b64_tr_b16 a[88:89], v5 offset:42080
    ds_read_b64_tr_b16 a[90:91], v6 offset:42080
    ds_read_b64_tr_b16 a[96:97], v5 offset:128
    ds_read_b64_tr_b16 a[98:99], v5 offset:21120
    ds_read_b64_tr_b16 a[100:101], v6 offset:128
    ds_read_b64_tr_b16 a[102:103], v6 offset:21120
    ds_read_b64_tr_b16 a[112:113], v5 offset:42112
    ds_read_b64_tr_b16 a[114:115], v6 offset:42112
    ds_read_b64_tr_b16 a[120:121], v5 offset:160
    ds_read_b64_tr_b16 a[122:123], v5 offset:21152
    ds_read_b64_tr_b16 a[124:125], v6 offset:160
    ds_read_b64_tr_b16 a[126:127], v6 offset:21152
    ds_read_b64_tr_b16 a[136:137], v5 offset:42144
    ds_read_b64_tr_b16 a[138:139], v6 offset:42144
    ds_read_b64_tr_b16 a[144:145], v5 offset:192
    ds_read_b64_tr_b16 a[146:147], v5 offset:21184
    ds_read_b64_tr_b16 a[148:149], v6 offset:192
    ds_read_b64_tr_b16 a[150:151], v6 offset:21184
    ds_read_b64_tr_b16 a[160:161], v5 offset:42176
    ds_read_b64_tr_b16 a[162:163], v6 offset:42176
    ds_read_b64_tr_b16 a[168:169], v5 offset:224
    ds_read_b64_tr_b16 a[170:171], v5 offset:21216
    ds_read_b64_tr_b16 a[172:173], v6 offset:224
    ds_read_b64_tr_b16 a[174:175], v6 offset:21216
    ds_read_b64_tr_b16 a[184:185], v5 offset:42208
    ds_read_b64_tr_b16 a[186:187], v6 offset:42208
    ds_read_b64_tr_b16 a[192:193], v5 offset:256
    ds_read_b64_tr_b16 a[194:195], v5 offset:21248
    ds_read_b64_tr_b16 a[196:197], v6 offset:256
    ds_read_b64_tr_b16 a[198:199], v6 offset:21248
    ds_read_b64_tr_b16 a[208:209], v5 offset:42240
    ds_read_b64_tr_b16 a[210:211], v6 offset:42240
    ds_read_b64_tr_b16 a[216:217], v5 offset:288
    ds_read_b64_tr_b16 a[218:219], v5 offset:21280
    ds_read_b64_tr_b16 a[220:221], v6 offset:288
    ds_read_b64_tr_b16 a[222:223], v6 offset:21280
    ds_read_b64_tr_b16 a[232:233], v5 offset:42272
    ds_read_b64_tr_b16 a[234:235], v6 offset:42272
    s_waitcnt lgkmcnt(0)
    s_barrier
    s_waitcnt vmcnt(0)
    ds_write_b128 v16, v[168:171]
    ds_write_b128 v17, v[172:175]
    ds_write_b128 v18, v[176:179]
    ds_write_b128 v19, v[180:183]
    ds_write_b128 v20, v[184:187]
    ds_write_b128 v21, v[188:191]
    ds_write_b128 v22, v[192:195]
    ds_write_b128 v23, v[196:199]
    ds_write_b128 v24, v[200:203]
    ds_write_b128 v25, v[204:207]
    ds_write_b128 v26, v[208:211]
    ds_write_b128 v27, v[212:215]
    ds_write_b128 v28, v[216:219]
    ds_write_b128 v29, v[220:223]
    ds_write_b128 v30, v[224:227]
    ds_write_b128 v31, v[228:231]
    ds_write_b128 v32, v[232:235]
    ds_write_b128 v33, v[236:239]
    ds_write_b128 v34, v[240:243]
    ds_write_b128 v35, v[244:247]
    ds_write_b128 v36, v[248:251]
    ds_write_b128 v37, v[252:255]
    ds_write_b128 v38, v[48:51]
    ds_write_b128 v39, v[52:55]
    ds_write_b128 v40, v[56:59]
    ds_write_b128 v41, v[60:63]
    ds_write_b128 v42, v[64:67]
    ds_write_b128 v43, v[68:71]
    ds_write_b128 v44, v[72:75]
    ds_write_b128 v45, v[76:79]
    s_waitcnt lgkmcnt(0)
    s_barrier
    ds_read_b64_tr_b16 a[8:9], v5 offset:0
    ds_read_b64_tr_b16 a[10:11], v5 offset:20992
    ds_read_b64_tr_b16 a[12:13], v6 offset:0
    ds_read_b64_tr_b16 a[14:15], v6 offset:20992
    ds_read_b64_tr_b16 a[20:21], v5 offset:41984
    ds_read_b64_tr_b16 a[22:23], v6 offset:41984
    ds_read_b64_tr_b16 a[32:33], v5 offset:32
    ds_read_b64_tr_b16 a[34:35], v5 offset:21024
    ds_read_b64_tr_b16 a[36:37], v6 offset:32
    ds_read_b64_tr_b16 a[38:39], v6 offset:21024
    ds_read_b64_tr_b16 a[44:45], v5 offset:42016
    ds_read_b64_tr_b16 a[46:47], v6 offset:42016
    ds_read_b64_tr_b16 a[56:57], v5 offset:64
    ds_read_b64_tr_b16 a[58:59], v5 offset:21056
    ds_read_b64_tr_b16 a[60:61], v6 offset:64
    ds_read_b64_tr_b16 a[62:63], v6 offset:21056
    ds_read_b64_tr_b16 a[68:69], v5 offset:42048
    ds_read_b64_tr_b16 a[70:71], v6 offset:42048
    ds_read_b64_tr_b16 a[80:81], v5 offset:96
    ds_read_b64_tr_b16 a[82:83], v5 offset:21088
    ds_read_b64_tr_b16 a[84:85], v6 offset:96
    ds_read_b64_tr_b16 a[86:87], v6 offset:21088
    ds_read_b64_tr_b16 a[92:93], v5 offset:42080
    ds_read_b64_tr_b16 a[94:95], v6 offset:42080
    ds_read_b64_tr_b16 a[104:105], v5 offset:128
    ds_read_b64_tr_b16 a[106:107], v5 offset:21120
    ds_read_b64_tr_b16 a[108:109], v6 offset:128
    ds_read_b64_tr_b16 a[110:111], v6 offset:21120
    ds_read_b64_tr_b16 a[116:117], v5 offset:42112
    ds_read_b64_tr_b16 a[118:119], v6 offset:42112
    ds_read_b64_tr_b16 a[128:129], v5 offset:160
    ds_read_b64_tr_b16 a[130:131], v5 offset:21152
    ds_read_b64_tr_b16 a[132:133], v6 offset:160
    ds_read_b64_tr_b16 a[134:135], v6 offset:21152
    ds_read_b64_tr_b16 a[140:141], v5 offset:42144
    ds_read_b64_tr_b16 a[142:143], v6 offset:42144
    ds_read_b64_tr_b16 a[152:153], v5 offset:192
    ds_read_b64_tr_b16 a[154:155], v5 offset:21184
    ds_read_b64_tr_b16 a[156:157], v6 offset:192
    ds_read_b64_tr_b16 a[158:159], v6 offset:21184
    ds_read_b64_tr_b16 a[164:165], v5 offset:42176
    ds_read_b64_tr_b16 a[166:167], v6 offset:42176
    ds_read_b64_tr_b16 a[176:177], v5 offset:224
    ds_read_b64_tr_b16 a[178:179], v5 offset:21216
    ds_read_b64_tr_b16 a[180:181], v6 offset:224
    ds_read_b64_tr_b16 a[182:183], v6 offset:21216
    ds_read_b64_tr_b16 a[188:189], v5 offset:42208
    ds_read_b64_tr_b16 a[190:191], v6 offset:42208
    ds_read_b64_tr_b16 a[200:201], v5 offset:256
    ds_read_b64_tr_b16 a[202:203], v5 offset:21248
    ds_read_b64_tr_b16 a[204:205], v6 offset:256
    ds_read_b64_tr_b16 a[206:207], v6 offset:21248
    ds_read_b64_tr_b16 a[212:213], v5 offset:42240
    ds_read_b64_tr_b16 a[214:215], v6 offset:42240
    ds_read_b64_tr_b16 a[224:225], v5 offset:288
    ds_read_b64_tr_b16 a[226:227], v5 offset:21280
    ds_read_b64_tr_b16 a[228:229], v6 offset:288
    ds_read_b64_tr_b16 a[230:231], v6 offset:21280
    ds_read_b64_tr_b16 a[236:237], v5 offset:42272
    ds_read_b64_tr_b16 a[238:239], v6 offset:42272
    s_waitcnt lgkmcnt(0)
    s_barrier
    v_lshlrev_b32 v5, 4, v1
    s_mul_i32 s24, s44, 12288
    v_add_u32 v6, s24, v5
    v_add_u32 v7, 4096, v6
    v_add_u32 v8, 8192, v6
    s_mul_i32 s24, s3, 327680
    s_lshl_b32 s25, s44, 10
    s_add_u32 s24, s24, s25
    v_add_u32 v9, s24, v5
interleave_layers__linear_attn_block__memory_aug_recurrent_mem_tr__prompt_kernel_o_layer:
    s_mul_i32 s93, s92, 29360128
    s_add_u32 s93, s93, 117440512
    s_mul_i32 s94, s92, 16384
    s_add_u32 s94, s94, 23068672
    s_mov_b32 s24, 12288
    s_lshl_b32 s25, s44, 7
    s_add_u32 s24, s24, s25
    s_add_u32 s24, s24, s94
    v_mov_b32 v14, s24
    v_mov_b32 v15, 2146435072
    v_cmp_eq_u32 vcc, 0, v1
    s_nop 1
    v_cndmask_b32 v14, v15, v14, vcc
    s_lshl_b32 s24, s44, 7
    s_add_u32 s24, s24, 8192
    s_add_u32 s24, s24, s94
    v_mov_b32 v10, s24
    s_mov_b32 s41, 33554432
    s_mov_b32 s43, 184549376
    s_mov_b32 s40, 0
    s_mov_b32 s62, -1
    s_mov_b32 s63, 1
    s_cmp_ge_i32 s62, s63
    s_cbranch_scc1 interleave_layers__linear_attn_block__memory_aug_recurrent_mem_tr__prompt_kernel_o_en0_ok
    s_mov_b32 s61, 0
interleave_layers__linear_attn_block__memory_aug_recurrent_mem_tr__prompt_kernel_o_en0:
    buffer_load_dword v11, v10, s[8:11], 0 offen sc1
    s_waitcnt vmcnt(0)
    v_readlane_b32 s62, v11, 0
    s_cmp_ge_i32 s62, s63
    s_cbranch_scc1 interleave_layers__linear_attn_block__memory_aug_recurrent_mem_tr__prompt_kernel_o_en0_ok
    s_add_u32 s61, s61, 1
    s_cmp_ge_u32 s61, s60
    s_cbranch_scc1 interleave_layers__linear_attn_block__memory_aug_recurrent_mem_tr__prompt_kernel_o_en0_to
    s_sleep 2
    s_branch interleave_layers__linear_attn_block__memory_aug_recurrent_mem_tr__prompt_kernel_o_en0
interleave_layers__linear_attn_block__memory_aug_recurrent_mem_tr__prompt_kernel_o_en0_to:
    s_mov_b32 s60, 1
interleave_layers__linear_attn_block__memory_aug_recurrent_mem_tr__prompt_kernel_o_en0_ok:
    buffer_load_dwordx4 v[16:19], v6, s[8:11], s41 offen offset:0 sc1
    buffer_load_dwordx4 v[20:23], v6, s[8:11], s41 offen offset:1024 sc1
    buffer_load_dwordx4 v[24:27], v6, s[8:11], s41 offen offset:2048 sc1
    buffer_load_dwordx4 v[28:31], v6, s[8:11], s41 offen offset:3072 sc1
    buffer_load_dwordx4 v[32:35], v7, s[8:11], s41 offen offset:0 sc1
    buffer_load_dwordx4 v[36:39], v7, s[8:11], s41 offen offset:1024 sc1
    buffer_load_dwordx4 v[40:43], v7, s[8:11], s41 offen offset:2048 sc1
    buffer_load_dwordx4 v[44:47], v7, s[8:11], s41 offen offset:3072 sc1
    buffer_load_dwordx4 v[48:51], v8, s[8:11], s41 offen offset:0 sc1
    buffer_load_dwordx4 v[52:55], v8, s[8:11], s41 offen offset:1024 sc1
    buffer_load_dwordx4 v[56:59], v8, s[8:11], s41 offen offset:2048 sc1
    buffer_load_dwordx4 v[60:63], v8, s[8:11], s41 offen offset:3072 sc1
    s_add_u32 s41, s41, 393216
    s_waitcnt vmcnt(0)
interleave_layers__linear_attn_block__memory_aug_recurrent_mem_tr__prompt_kernel_o_seg:
    v_swap_b32 v26, v36
    v_swap_b32 v27, v37
    v_swap_b32 v50, v60
    v_swap_b32 v51, v61
    v_mfma_f32_16x16x32_bf16 v[112:115], v[16:19], a[0:3], 0
    v_mfma_f32_16x16x32_bf16 v[116:119], v[20:23], a[0:3], 0
    v_mfma_f32_16x16x32_bf16 v[120:123], v[16:19], a[24:27], 0
    v_mfma_f32_16x16x32_bf16 v[124:127], v[20:23], a[24:27], 0
    v_mfma_f32_16x16x32_bf16 v[128:131], v[16:19], a[48:51], 0
    v_mfma_f32_16x16x32_bf16 v[132:135], v[20:23], a[48:51], 0
    v_mfma_f32_16x16x32_bf16 v[136:139], v[16:19], a[72:75], 0
    v_mfma_f32_16x16x32_bf16 v[140:143], v[20:23], a[72:75], 0
    v_mfma_f32_16x16x32_bf16 v[144:147], v[16:19], a[96:99], 0
    v_mfma_f32_16x16x32_bf16 v[148:151], v[20:23], a[96:99], 0
    v_mfma_f32_16x16x32_bf16 v[152:155], v[16:19], a[120:123], 0
    v_mfma_f32_16x16x32_bf16 v[156:159], v[20:23], a[120:123], 0
    v_mfma_f32_16x16x32_bf16 v[160:163], v[16:19], a[144:147], 0
    v_mfma_f32_16x16x32_bf16 v[164:167], v[20:23], a[144:147], 0
    v_mfma_f32_16x16x32_bf16 v[168:171], v[16:19], a[168:171], 0
    v_mfma_f32_16x16x32_bf16 v[172:175], v[20:23], a[168:171], 0
    v_mfma_f32_16x16x32_bf16 v[176:179], v[16:19], a[192:195], 0
    v_mfma_f32_16x16x32_bf16 v[180:183], v[20:23], a[192:195], 0
    v_mfma_f32_16x16x32_bf16 v[184:187], v[16:19], a[216:219], 0
    v_mfma_f32_16x16x32_bf16 v[188:191], v[20:23], a[216:219], 0
    v_mfma_f32_16x16x32_bf16 v[112:115], v[28:31], a[4:7], v[112:115]
    v_mfma_f32_16x16x32_bf16 v[116:119], v[32:35], a[4:7], v[116:119]
    v_mfma_f32_16x16x32_bf16 v[120:123], v[28:31], a[28:31], v[120:123]
    v_mfma_f32_16x16x32_bf16 v[124:127], v[32:35], a[28:31], v[124:127]
    v_mfma_f32_16x16x32_bf16 v[128:131], v[28:31], a[52:55], v[128:131]
    v_mfma_f32_16x16x32_bf16 v[132:135], v[32:35], a[52:55], v[132:135]
    v_mfma_f32_16x16x32_bf16 v[136:139], v[28:31], a[76:79], v[136:139]
    v_mfma_f32_16x16x32_bf16 v[140:143], v[32:35], a[76:79], v[140:143]
    v_mfma_f32_16x16x32_bf16 v[144:147], v[28:31], a[100:103], v[144:147]
    v_mfma_f32_16x16x32_bf16 v[148:151], v[32:35], a[100:103], v[148:151]
    v_mfma_f32_16x16x32_bf16 v[152:155], v[28:31], a[124:127], v[152:155]
    v_mfma_f32_16x16x32_bf16 v[156:159], v[32:35], a[124:127], v[156:159]
    v_mfma_f32_16x16x32_bf16 v[160:163], v[28:31], a[148:151], v[160:163]
    v_mfma_f32_16x16x32_bf16 v[164:167], v[32:35], a[148:151], v[164:167]
    v_mfma_f32_16x16x32_bf16 v[168:171], v[28:31], a[172:175], v[168:171]
    v_mfma_f32_16x16x32_bf16 v[172:175], v[32:35], a[172:175], v[172:175]
    v_mfma_f32_16x16x32_bf16 v[176:179], v[28:31], a[196:199], v[176:179]
    v_mfma_f32_16x16x32_bf16 v[180:183], v[32:35], a[196:199], v[180:183]
    v_mfma_f32_16x16x32_bf16 v[184:187], v[28:31], a[220:223], v[184:187]
    v_mfma_f32_16x16x32_bf16 v[188:191], v[32:35], a[220:223], v[188:191]
    v_mfma_f32_16x16x32_bf16 v[112:115], v[40:43], a[8:11], v[112:115]
    v_mfma_f32_16x16x32_bf16 v[116:119], v[44:47], a[8:11], v[116:119]
    v_mfma_f32_16x16x32_bf16 v[120:123], v[40:43], a[32:35], v[120:123]
    v_mfma_f32_16x16x32_bf16 v[124:127], v[44:47], a[32:35], v[124:127]
    v_mfma_f32_16x16x32_bf16 v[128:131], v[40:43], a[56:59], v[128:131]
    v_mfma_f32_16x16x32_bf16 v[132:135], v[44:47], a[56:59], v[132:135]
    v_mfma_f32_16x16x32_bf16 v[136:139], v[40:43], a[80:83], v[136:139]
    v_mfma_f32_16x16x32_bf16 v[140:143], v[44:47], a[80:83], v[140:143]
    v_mfma_f32_16x16x32_bf16 v[144:147], v[40:43], a[104:107], v[144:147]
    v_mfma_f32_16x16x32_bf16 v[148:151], v[44:47], a[104:107], v[148:151]
    v_mfma_f32_16x16x32_bf16 v[152:155], v[40:43], a[128:131], v[152:155]
    v_mfma_f32_16x16x32_bf16 v[156:159], v[44:47], a[128:131], v[156:159]
    v_mfma_f32_16x16x32_bf16 v[160:163], v[40:43], a[152:155], v[160:163]
    v_mfma_f32_16x16x32_bf16 v[164:167], v[44:47], a[152:155], v[164:167]
    v_mfma_f32_16x16x32_bf16 v[168:171], v[40:43], a[176:179], v[168:171]
    v_mfma_f32_16x16x32_bf16 v[172:175], v[44:47], a[176:179], v[172:175]
    v_mfma_f32_16x16x32_bf16 v[176:179], v[40:43], a[200:203], v[176:179]
    v_mfma_f32_16x16x32_bf16 v[180:183], v[44:47], a[200:203], v[180:183]
    v_mfma_f32_16x16x32_bf16 v[184:187], v[40:43], a[224:227], v[184:187]
    v_mfma_f32_16x16x32_bf16 v[188:191], v[44:47], a[224:227], v[188:191]
    s_cmp_eq_u32 s40, 0
    s_cbranch_scc1 interleave_layers__linear_attn_block__memory_aug_recurrent_mem_tr__prompt_kernel_of33
    s_waitcnt vmcnt(0)
    s_barrier
    s_cmp_eq_u32 s3, 0
    s_cbranch_scc0 interleave_layers__linear_attn_block__memory_aug_recurrent_mem_tr__prompt_kernel_fp34
    v_mov_b32 v15, s40
    buffer_store_dword v15, v14, s[8:11], 0 offen sc1
interleave_layers__linear_attn_block__memory_aug_recurrent_mem_tr__prompt_kernel_fp34:
    s_add_u32 s63, s40, 2
    s_min_u32 s63, s63, 64
    s_cmp_ge_i32 s62, s63
    s_cbranch_scc1 interleave_layers__linear_attn_block__memory_aug_recurrent_mem_tr__prompt_kernel_o_en1_ok
    s_mov_b32 s61, 0
interleave_layers__linear_attn_block__memory_aug_recurrent_mem_tr__prompt_kernel_o_en1:
    buffer_load_dword v11, v10, s[8:11], 0 offen sc1
    s_waitcnt vmcnt(0)
    v_readlane_b32 s62, v11, 0
    s_cmp_ge_i32 s62, s63
    s_cbranch_scc1 interleave_layers__linear_attn_block__memory_aug_recurrent_mem_tr__prompt_kernel_o_en1_ok
    s_add_u32 s61, s61, 1
    s_cmp_ge_u32 s61, s60
    s_cbranch_scc1 interleave_layers__linear_attn_block__memory_aug_recurrent_mem_tr__prompt_kernel_o_en1_to
    s_sleep 2
    s_branch interleave_layers__linear_attn_block__memory_aug_recurrent_mem_tr__prompt_kernel_o_en1
interleave_layers__linear_attn_block__memory_aug_recurrent_mem_tr__prompt_kernel_o_en1_to:
    s_mov_b32 s60, 1
interleave_layers__linear_attn_block__memory_aug_recurrent_mem_tr__prompt_kernel_o_en1_ok:
    buffer_load_dwordx4 v[64:67], v6, s[8:11], s41 offen offset:0 sc1
    buffer_load_dwordx4 v[68:71], v6, s[8:11], s41 offen offset:1024 sc1
    buffer_load_dwordx4 v[72:75], v6, s[8:11], s41 offen offset:2048 sc1
    buffer_load_dwordx4 v[76:79], v6, s[8:11], s41 offen offset:3072 sc1
    buffer_load_dwordx4 v[80:83], v7, s[8:11], s41 offen offset:0 sc1
    buffer_load_dwordx4 v[84:87], v7, s[8:11], s41 offen offset:1024 sc1
    buffer_load_dwordx4 v[88:91], v7, s[8:11], s41 offen offset:2048 sc1
    buffer_load_dwordx4 v[92:95], v7, s[8:11], s41 offen offset:3072 sc1
    buffer_load_dwordx4 v[96:99], v8, s[8:11], s41 offen offset:0 sc1
    buffer_load_dwordx4 v[100:103], v8, s[8:11], s41 offen offset:1024 sc1
    buffer_load_dwordx4 v[104:107], v8, s[8:11], s41 offen offset:2048 sc1
    buffer_load_dwordx4 v[108:111], v8, s[8:11], s41 offen offset:3072 sc1
    s_add_u32 s41, s41, 393216
interleave_layers__linear_attn_block__memory_aug_recurrent_mem_tr__prompt_kernel_of33:
    v_mfma_f32_16x16x32_bf16 v[112:115], v[52:55], a[12:15], v[112:115]
    v_mfma_f32_16x16x32_bf16 v[116:119], v[56:59], a[12:15], v[116:119]
    v_mfma_f32_16x16x32_bf16 v[120:123], v[52:55], a[36:39], v[120:123]
    v_mfma_f32_16x16x32_bf16 v[124:127], v[56:59], a[36:39], v[124:127]
    v_mfma_f32_16x16x32_bf16 v[128:131], v[52:55], a[60:63], v[128:131]
    v_mfma_f32_16x16x32_bf16 v[132:135], v[56:59], a[60:63], v[132:135]
    v_mfma_f32_16x16x32_bf16 v[136:139], v[52:55], a[84:87], v[136:139]
    v_mfma_f32_16x16x32_bf16 v[140:143], v[56:59], a[84:87], v[140:143]
    v_mfma_f32_16x16x32_bf16 v[144:147], v[52:55], a[108:111], v[144:147]
    v_mfma_f32_16x16x32_bf16 v[148:151], v[56:59], a[108:111], v[148:151]
    v_mfma_f32_16x16x32_bf16 v[152:155], v[52:55], a[132:135], v[152:155]
    v_mfma_f32_16x16x32_bf16 v[156:159], v[56:59], a[132:135], v[156:159]
    v_mfma_f32_16x16x32_bf16 v[160:163], v[52:55], a[156:159], v[160:163]
    v_mfma_f32_16x16x32_bf16 v[164:167], v[56:59], a[156:159], v[164:167]
    v_mfma_f32_16x16x32_bf16 v[168:171], v[52:55], a[180:183], v[168:171]
    v_mfma_f32_16x16x32_bf16 v[172:175], v[56:59], a[180:183], v[172:175]
    v_mfma_f32_16x16x32_bf16 v[176:179], v[52:55], a[204:207], v[176:179]
    v_mfma_f32_16x16x32_bf16 v[180:183], v[56:59], a[204:207], v[180:183]
    v_mfma_f32_16x16x32_bf16 v[184:187], v[52:55], a[228:231], v[184:187]
    v_mfma_f32_16x16x32_bf16 v[188:191], v[56:59], a[228:231], v[188:191]
    v_mfma_f32_16x16x32_bf16 v[112:115], v[24:27], a[16:19], v[112:115]
    v_mfma_f32_16x16x32_bf16 v[116:119], v[36:39], a[16:19], v[116:119]
    v_mfma_f32_16x16x32_bf16 v[120:123], v[24:27], a[40:43], v[120:123]
    v_mfma_f32_16x16x32_bf16 v[124:127], v[36:39], a[40:43], v[124:127]
    v_mfma_f32_16x16x32_bf16 v[128:131], v[24:27], a[64:67], v[128:131]
    v_mfma_f32_16x16x32_bf16 v[132:135], v[36:39], a[64:67], v[132:135]
    v_mfma_f32_16x16x32_bf16 v[136:139], v[24:27], a[88:91], v[136:139]
    v_mfma_f32_16x16x32_bf16 v[140:143], v[36:39], a[88:91], v[140:143]
    v_mfma_f32_16x16x32_bf16 v[144:147], v[24:27], a[112:115], v[144:147]
    v_mfma_f32_16x16x32_bf16 v[148:151], v[36:39], a[112:115], v[148:151]
    v_mfma_f32_16x16x32_bf16 v[152:155], v[24:27], a[136:139], v[152:155]
    v_mfma_f32_16x16x32_bf16 v[156:159], v[36:39], a[136:139], v[156:159]
    v_mfma_f32_16x16x32_bf16 v[160:163], v[24:27], a[160:163], v[160:163]
    v_mfma_f32_16x16x32_bf16 v[164:167], v[36:39], a[160:163], v[164:167]
    v_mfma_f32_16x16x32_bf16 v[168:171], v[24:27], a[184:187], v[168:171]
    v_mfma_f32_16x16x32_bf16 v[172:175], v[36:39], a[184:187], v[172:175]
    v_mfma_f32_16x16x32_bf16 v[176:179], v[24:27], a[208:211], v[176:179]
    v_mfma_f32_16x16x32_bf16 v[180:183], v[36:39], a[208:211], v[180:183]
    v_mfma_f32_16x16x32_bf16 v[184:187], v[24:27], a[232:235], v[184:187]
    v_mfma_f32_16x16x32_bf16 v[188:191], v[36:39], a[232:235], v[188:191]
    v_mfma_f32_16x16x32_bf16 v[112:115], v[48:51], a[20:23], v[112:115]
    v_mfma_f32_16x16x32_bf16 v[116:119], v[60:63], a[20:23], v[116:119]
    v_mfma_f32_16x16x32_bf16 v[120:123], v[48:51], a[44:47], v[120:123]
    v_mfma_f32_16x16x32_bf16 v[124:127], v[60:63], a[44:47], v[124:127]
    v_mfma_f32_16x16x32_bf16 v[128:131], v[48:51], a[68:71], v[128:131]
    v_mfma_f32_16x16x32_bf16 v[132:135], v[60:63], a[68:71], v[132:135]
    v_mfma_f32_16x16x32_bf16 v[136:139], v[48:51], a[92:95], v[136:139]
    v_mfma_f32_16x16x32_bf16 v[140:143], v[60:63], a[92:95], v[140:143]
    v_mfma_f32_16x16x32_bf16 v[144:147], v[48:51], a[116:119], v[144:147]
    v_mfma_f32_16x16x32_bf16 v[148:151], v[60:63], a[116:119], v[148:151]
    v_mfma_f32_16x16x32_bf16 v[152:155], v[48:51], a[140:143], v[152:155]
    v_mfma_f32_16x16x32_bf16 v[156:159], v[60:63], a[140:143], v[156:159]
    v_mfma_f32_16x16x32_bf16 v[160:163], v[48:51], a[164:167], v[160:163]
    v_mfma_f32_16x16x32_bf16 v[164:167], v[60:63], a[164:167], v[164:167]
    v_mfma_f32_16x16x32_bf16 v[168:171], v[48:51], a[188:191], v[168:171]
    v_mfma_f32_16x16x32_bf16 v[172:175], v[60:63], a[188:191], v[172:175]
    v_mfma_f32_16x16x32_bf16 v[176:179], v[48:51], a[212:215], v[176:179]
    v_mfma_f32_16x16x32_bf16 v[180:183], v[60:63], a[212:215], v[180:183]
    v_mfma_f32_16x16x32_bf16 v[184:187], v[48:51], a[236:239], v[184:187]
    v_mfma_f32_16x16x32_bf16 v[188:191], v[60:63], a[236:239], v[188:191]
    s_mov_b32 s46, s43
    v_cvt_pk_bf16_f32 v192, v112, v113
    v_cvt_pk_bf16_f32 v193, v114, v115
    v_cvt_pk_bf16_f32 v194, v116, v117
    v_cvt_pk_bf16_f32 v195, v118, v119
    buffer_store_dwordx4 v[192:195], v9, s[8:11], s46 offen sc1
    s_add_u32 s46, s46, 32768
    v_cvt_pk_bf16_f32 v196, v120, v121
    v_cvt_pk_bf16_f32 v197, v122, v123
    v_cvt_pk_bf16_f32 v198, v124, v125
    v_cvt_pk_bf16_f32 v199, v126, v127
    buffer_store_dwordx4 v[196:199], v9, s[8:11], s46 offen sc1
    s_add_u32 s46, s46, 32768
    v_cvt_pk_bf16_f32 v200, v128, v129
    v_cvt_pk_bf16_f32 v201, v130, v131
    v_cvt_pk_bf16_f32 v202, v132, v133
    v_cvt_pk_bf16_f32 v203, v134, v135
    buffer_store_dwordx4 v[200:203], v9, s[8:11], s46 offen sc1
    s_add_u32 s46, s46, 32768
    v_cvt_pk_bf16_f32 v204, v136, v137
    v_cvt_pk_bf16_f32 v205, v138, v139
    v_cvt_pk_bf16_f32 v206, v140, v141
    v_cvt_pk_bf16_f32 v207, v142, v143
    buffer_store_dwordx4 v[204:207], v9, s[8:11], s46 offen sc1
    s_add_u32 s46, s46, 32768
    v_cvt_pk_bf16_f32 v208, v144, v145
    v_cvt_pk_bf16_f32 v209, v146, v147
    v_cvt_pk_bf16_f32 v210, v148, v149
    v_cvt_pk_bf16_f32 v211, v150, v151
    buffer_store_dwordx4 v[208:211], v9, s[8:11], s46 offen sc1
    s_add_u32 s46, s46, 32768
    v_cvt_pk_bf16_f32 v212, v152, v153
    v_cvt_pk_bf16_f32 v213, v154, v155
    v_cvt_pk_bf16_f32 v214, v156, v157
    v_cvt_pk_bf16_f32 v215, v158, v159
    buffer_store_dwordx4 v[212:215], v9, s[8:11], s46 offen sc1
    s_add_u32 s46, s46, 32768
    v_cvt_pk_bf16_f32 v216, v160, v161
    v_cvt_pk_bf16_f32 v217, v162, v163
    v_cvt_pk_bf16_f32 v218, v164, v165
    v_cvt_pk_bf16_f32 v219, v166, v167
    buffer_store_dwordx4 v[216:219], v9, s[8:11], s46 offen sc1
    s_add_u32 s46, s46, 32768
    v_cvt_pk_bf16_f32 v220, v168, v169
    v_cvt_pk_bf16_f32 v221, v170, v171
    v_cvt_pk_bf16_f32 v222, v172, v173
    v_cvt_pk_bf16_f32 v223, v174, v175
    buffer_store_dwordx4 v[220:223], v9, s[8:11], s46 offen sc1
    s_add_u32 s46, s46, 32768
    v_cvt_pk_bf16_f32 v224, v176, v177
    v_cvt_pk_bf16_f32 v225, v178, v179
    v_cvt_pk_bf16_f32 v226, v180, v181
    v_cvt_pk_bf16_f32 v227, v182, v183
    buffer_store_dwordx4 v[224:227], v9, s[8:11], s46 offen sc1
    s_add_u32 s46, s46, 32768
    v_cvt_pk_bf16_f32 v228, v184, v185
    v_cvt_pk_bf16_f32 v229, v186, v187
    v_cvt_pk_bf16_f32 v230, v188, v189
    v_cvt_pk_bf16_f32 v231, v190, v191
    buffer_store_dwordx4 v[228:231], v9, s[8:11], s46 offen sc1
    s_cmp_eq_u32 s40, 0
    s_cbranch_scc0 interleave_layers__linear_attn_block__memory_aug_recurrent_mem_tr__prompt_kernel_of35
    s_waitcnt vmcnt(0)
    s_barrier
    s_cmp_eq_u32 s3, 0
    s_cbranch_scc0 interleave_layers__linear_attn_block__memory_aug_recurrent_mem_tr__prompt_kernel_fp36
    v_mov_b32 v15, 1
    buffer_store_dword v15, v14, s[8:11], 0 offen sc1
interleave_layers__linear_attn_block__memory_aug_recurrent_mem_tr__prompt_kernel_fp36:
    s_add_u32 s63, s40, 2
    s_min_u32 s63, s63, 64
    s_cmp_ge_i32 s62, s63
    s_cbranch_scc1 interleave_layers__linear_attn_block__memory_aug_recurrent_mem_tr__prompt_kernel_o_en3_ok
    s_mov_b32 s61, 0
interleave_layers__linear_attn_block__memory_aug_recurrent_mem_tr__prompt_kernel_o_en3:
    buffer_load_dword v11, v10, s[8:11], 0 offen sc1
    s_waitcnt vmcnt(0)
    v_readlane_b32 s62, v11, 0
    s_cmp_ge_i32 s62, s63
    s_cbranch_scc1 interleave_layers__linear_attn_block__memory_aug_recurrent_mem_tr__prompt_kernel_o_en3_ok
    s_add_u32 s61, s61, 1
    s_cmp_ge_u32 s61, s60
    s_cbranch_scc1 interleave_layers__linear_attn_block__memory_aug_recurrent_mem_tr__prompt_kernel_o_en3_to
    s_sleep 2
    s_branch interleave_layers__linear_attn_block__memory_aug_recurrent_mem_tr__prompt_kernel_o_en3
interleave_layers__linear_attn_block__memory_aug_recurrent_mem_tr__prompt_kernel_o_en3_to:
    s_mov_b32 s60, 1
interleave_layers__linear_attn_block__memory_aug_recurrent_mem_tr__prompt_kernel_o_en3_ok:
    buffer_load_dwordx4 v[64:67], v6, s[8:11], s41 offen offset:0 sc1
    buffer_load_dwordx4 v[68:71], v6, s[8:11], s41 offen offset:1024 sc1
    buffer_load_dwordx4 v[72:75], v6, s[8:11], s41 offen offset:2048 sc1
    buffer_load_dwordx4 v[76:79], v6, s[8:11], s41 offen offset:3072 sc1
    buffer_load_dwordx4 v[80:83], v7, s[8:11], s41 offen offset:0 sc1
    buffer_load_dwordx4 v[84:87], v7, s[8:11], s41 offen offset:1024 sc1
    buffer_load_dwordx4 v[88:91], v7, s[8:11], s41 offen offset:2048 sc1
    buffer_load_dwordx4 v[92:95], v7, s[8:11], s41 offen offset:3072 sc1
    buffer_load_dwordx4 v[96:99], v8, s[8:11], s41 offen offset:0 sc1
    buffer_load_dwordx4 v[100:103], v8, s[8:11], s41 offen offset:1024 sc1
    buffer_load_dwordx4 v[104:107], v8, s[8:11], s41 offen offset:2048 sc1
    buffer_load_dwordx4 v[108:111], v8, s[8:11], s41 offen offset:3072 sc1
    s_add_u32 s41, s41, 393216
    s_waitcnt vmcnt(0)
interleave_layers__linear_attn_block__memory_aug_recurrent_mem_tr__prompt_kernel_of35:
    s_waitcnt vmcnt(10)
    s_add_u32 s40, s40, 1
    s_add_u32 s43, s43, 1310720
    v_swap_b32 v74, v84
    v_swap_b32 v75, v85
    v_swap_b32 v98, v108
    v_swap_b32 v99, v109
    v_mfma_f32_16x16x32_bf16 v[112:115], v[64:67], a[0:3], 0
    v_mfma_f32_16x16x32_bf16 v[116:119], v[68:71], a[0:3], 0
    v_mfma_f32_16x16x32_bf16 v[120:123], v[64:67], a[24:27], 0
    v_mfma_f32_16x16x32_bf16 v[124:127], v[68:71], a[24:27], 0
    v_mfma_f32_16x16x32_bf16 v[128:131], v[64:67], a[48:51], 0
    v_mfma_f32_16x16x32_bf16 v[132:135], v[68:71], a[48:51], 0
    v_mfma_f32_16x16x32_bf16 v[136:139], v[64:67], a[72:75], 0
    v_mfma_f32_16x16x32_bf16 v[140:143], v[68:71], a[72:75], 0
    v_mfma_f32_16x16x32_bf16 v[144:147], v[64:67], a[96:99], 0
    v_mfma_f32_16x16x32_bf16 v[148:151], v[68:71], a[96:99], 0
    v_mfma_f32_16x16x32_bf16 v[152:155], v[64:67], a[120:123], 0
    v_mfma_f32_16x16x32_bf16 v[156:159], v[68:71], a[120:123], 0
    v_mfma_f32_16x16x32_bf16 v[160:163], v[64:67], a[144:147], 0
    v_mfma_f32_16x16x32_bf16 v[164:167], v[68:71], a[144:147], 0
    v_mfma_f32_16x16x32_bf16 v[168:171], v[64:67], a[168:171], 0
    v_mfma_f32_16x16x32_bf16 v[172:175], v[68:71], a[168:171], 0
    v_mfma_f32_16x16x32_bf16 v[176:179], v[64:67], a[192:195], 0
    v_mfma_f32_16x16x32_bf16 v[180:183], v[68:71], a[192:195], 0
    v_mfma_f32_16x16x32_bf16 v[184:187], v[64:67], a[216:219], 0
    v_mfma_f32_16x16x32_bf16 v[188:191], v[68:71], a[216:219], 0
    v_mfma_f32_16x16x32_bf16 v[112:115], v[76:79], a[4:7], v[112:115]
    v_mfma_f32_16x16x32_bf16 v[116:119], v[80:83], a[4:7], v[116:119]
    v_mfma_f32_16x16x32_bf16 v[120:123], v[76:79], a[28:31], v[120:123]
    v_mfma_f32_16x16x32_bf16 v[124:127], v[80:83], a[28:31], v[124:127]
    v_mfma_f32_16x16x32_bf16 v[128:131], v[76:79], a[52:55], v[128:131]
    v_mfma_f32_16x16x32_bf16 v[132:135], v[80:83], a[52:55], v[132:135]
    v_mfma_f32_16x16x32_bf16 v[136:139], v[76:79], a[76:79], v[136:139]
    v_mfma_f32_16x16x32_bf16 v[140:143], v[80:83], a[76:79], v[140:143]
    v_mfma_f32_16x16x32_bf16 v[144:147], v[76:79], a[100:103], v[144:147]
    v_mfma_f32_16x16x32_bf16 v[148:151], v[80:83], a[100:103], v[148:151]
    v_mfma_f32_16x16x32_bf16 v[152:155], v[76:79], a[124:127], v[152:155]
    v_mfma_f32_16x16x32_bf16 v[156:159], v[80:83], a[124:127], v[156:159]
    v_mfma_f32_16x16x32_bf16 v[160:163], v[76:79], a[148:151], v[160:163]
    v_mfma_f32_16x16x32_bf16 v[164:167], v[80:83], a[148:151], v[164:167]
    v_mfma_f32_16x16x32_bf16 v[168:171], v[76:79], a[172:175], v[168:171]
    v_mfma_f32_16x16x32_bf16 v[172:175], v[80:83], a[172:175], v[172:175]
    v_mfma_f32_16x16x32_bf16 v[176:179], v[76:79], a[196:199], v[176:179]
    v_mfma_f32_16x16x32_bf16 v[180:183], v[80:83], a[196:199], v[180:183]
    v_mfma_f32_16x16x32_bf16 v[184:187], v[76:79], a[220:223], v[184:187]
    v_mfma_f32_16x16x32_bf16 v[188:191], v[80:83], a[220:223], v[188:191]
    v_mfma_f32_16x16x32_bf16 v[112:115], v[88:91], a[8:11], v[112:115]
    v_mfma_f32_16x16x32_bf16 v[116:119], v[92:95], a[8:11], v[116:119]
    v_mfma_f32_16x16x32_bf16 v[120:123], v[88:91], a[32:35], v[120:123]
    v_mfma_f32_16x16x32_bf16 v[124:127], v[92:95], a[32:35], v[124:127]
    v_mfma_f32_16x16x32_bf16 v[128:131], v[88:91], a[56:59], v[128:131]
    v_mfma_f32_16x16x32_bf16 v[132:135], v[92:95], a[56:59], v[132:135]
    v_mfma_f32_16x16x32_bf16 v[136:139], v[88:91], a[80:83], v[136:139]
    v_mfma_f32_16x16x32_bf16 v[140:143], v[92:95], a[80:83], v[140:143]
    v_mfma_f32_16x16x32_bf16 v[144:147], v[88:91], a[104:107], v[144:147]
    v_mfma_f32_16x16x32_bf16 v[148:151], v[92:95], a[104:107], v[148:151]
    v_mfma_f32_16x16x32_bf16 v[152:155], v[88:91], a[128:131], v[152:155]
    v_mfma_f32_16x16x32_bf16 v[156:159], v[92:95], a[128:131], v[156:159]
    v_mfma_f32_16x16x32_bf16 v[160:163], v[88:91], a[152:155], v[160:163]
    v_mfma_f32_16x16x32_bf16 v[164:167], v[92:95], a[152:155], v[164:167]
    v_mfma_f32_16x16x32_bf16 v[168:171], v[88:91], a[176:179], v[168:171]
    v_mfma_f32_16x16x32_bf16 v[172:175], v[92:95], a[176:179], v[172:175]
    v_mfma_f32_16x16x32_bf16 v[176:179], v[88:91], a[200:203], v[176:179]
    v_mfma_f32_16x16x32_bf16 v[180:183], v[92:95], a[200:203], v[180:183]
    v_mfma_f32_16x16x32_bf16 v[184:187], v[88:91], a[224:227], v[184:187]
    v_mfma_f32_16x16x32_bf16 v[188:191], v[92:95], a[224:227], v[188:191]
    s_waitcnt vmcnt(0)
    s_barrier
    s_cmp_eq_u32 s3, 0
    s_cbranch_scc0 interleave_layers__linear_attn_block__memory_aug_recurrent_mem_tr__prompt_kernel_fp38
    v_mov_b32 v15, s40
    buffer_store_dword v15, v14, s[8:11], 0 offen sc1
interleave_layers__linear_attn_block__memory_aug_recurrent_mem_tr__prompt_kernel_fp38:
    s_add_u32 s63, s40, 2
    s_min_u32 s63, s63, 64
    s_cmp_ge_i32 s62, s63
    s_cbranch_scc1 interleave_layers__linear_attn_block__memory_aug_recurrent_mem_tr__prompt_kernel_o_en2_ok
    s_mov_b32 s61, 0
interleave_layers__linear_attn_block__memory_aug_recurrent_mem_tr__prompt_kernel_o_en2:
    buffer_load_dword v11, v10, s[8:11], 0 offen sc1
    s_waitcnt vmcnt(0)
    v_readlane_b32 s62, v11, 0
    s_cmp_ge_i32 s62, s63
    s_cbranch_scc1 interleave_layers__linear_attn_block__memory_aug_recurrent_mem_tr__prompt_kernel_o_en2_ok
    s_add_u32 s61, s61, 1
    s_cmp_ge_u32 s61, s60
    s_cbranch_scc1 interleave_layers__linear_attn_block__memory_aug_recurrent_mem_tr__prompt_kernel_o_en2_to
    s_sleep 2
    s_branch interleave_layers__linear_attn_block__memory_aug_recurrent_mem_tr__prompt_kernel_o_en2
interleave_layers__linear_attn_block__memory_aug_recurrent_mem_tr__prompt_kernel_o_en2_to:
    s_mov_b32 s60, 1
interleave_layers__linear_attn_block__memory_aug_recurrent_mem_tr__prompt_kernel_o_en2_ok:
    buffer_load_dwordx4 v[16:19], v6, s[8:11], s41 offen offset:0 sc1
    buffer_load_dwordx4 v[20:23], v6, s[8:11], s41 offen offset:1024 sc1
    buffer_load_dwordx4 v[24:27], v6, s[8:11], s41 offen offset:2048 sc1
    buffer_load_dwordx4 v[28:31], v6, s[8:11], s41 offen offset:3072 sc1
    buffer_load_dwordx4 v[32:35], v7, s[8:11], s41 offen offset:0 sc1
    buffer_load_dwordx4 v[36:39], v7, s[8:11], s41 offen offset:1024 sc1
    buffer_load_dwordx4 v[40:43], v7, s[8:11], s41 offen offset:2048 sc1
    buffer_load_dwordx4 v[44:47], v7, s[8:11], s41 offen offset:3072 sc1
    buffer_load_dwordx4 v[48:51], v8, s[8:11], s41 offen offset:0 sc1
    buffer_load_dwordx4 v[52:55], v8, s[8:11], s41 offen offset:1024 sc1
    buffer_load_dwordx4 v[56:59], v8, s[8:11], s41 offen offset:2048 sc1
    buffer_load_dwordx4 v[60:63], v8, s[8:11], s41 offen offset:3072 sc1
    s_add_u32 s41, s41, 393216
interleave_layers__linear_attn_block__memory_aug_recurrent_mem_tr__prompt_kernel_of37:
    v_mfma_f32_16x16x32_bf16 v[112:115], v[100:103], a[12:15], v[112:115]
    v_mfma_f32_16x16x32_bf16 v[116:119], v[104:107], a[12:15], v[116:119]
    v_mfma_f32_16x16x32_bf16 v[120:123], v[100:103], a[36:39], v[120:123]
    v_mfma_f32_16x16x32_bf16 v[124:127], v[104:107], a[36:39], v[124:127]
    v_mfma_f32_16x16x32_bf16 v[128:131], v[100:103], a[60:63], v[128:131]
    v_mfma_f32_16x16x32_bf16 v[132:135], v[104:107], a[60:63], v[132:135]
    v_mfma_f32_16x16x32_bf16 v[136:139], v[100:103], a[84:87], v[136:139]
    v_mfma_f32_16x16x32_bf16 v[140:143], v[104:107], a[84:87], v[140:143]
    v_mfma_f32_16x16x32_bf16 v[144:147], v[100:103], a[108:111], v[144:147]
    v_mfma_f32_16x16x32_bf16 v[148:151], v[104:107], a[108:111], v[148:151]
    v_mfma_f32_16x16x32_bf16 v[152:155], v[100:103], a[132:135], v[152:155]
    v_mfma_f32_16x16x32_bf16 v[156:159], v[104:107], a[132:135], v[156:159]
    v_mfma_f32_16x16x32_bf16 v[160:163], v[100:103], a[156:159], v[160:163]
    v_mfma_f32_16x16x32_bf16 v[164:167], v[104:107], a[156:159], v[164:167]
    v_mfma_f32_16x16x32_bf16 v[168:171], v[100:103], a[180:183], v[168:171]
    v_mfma_f32_16x16x32_bf16 v[172:175], v[104:107], a[180:183], v[172:175]
    v_mfma_f32_16x16x32_bf16 v[176:179], v[100:103], a[204:207], v[176:179]
    v_mfma_f32_16x16x32_bf16 v[180:183], v[104:107], a[204:207], v[180:183]
    v_mfma_f32_16x16x32_bf16 v[184:187], v[100:103], a[228:231], v[184:187]
    v_mfma_f32_16x16x32_bf16 v[188:191], v[104:107], a[228:231], v[188:191]
    v_mfma_f32_16x16x32_bf16 v[112:115], v[72:75], a[16:19], v[112:115]
    v_mfma_f32_16x16x32_bf16 v[116:119], v[84:87], a[16:19], v[116:119]
    v_mfma_f32_16x16x32_bf16 v[120:123], v[72:75], a[40:43], v[120:123]
    v_mfma_f32_16x16x32_bf16 v[124:127], v[84:87], a[40:43], v[124:127]
    v_mfma_f32_16x16x32_bf16 v[128:131], v[72:75], a[64:67], v[128:131]
    v_mfma_f32_16x16x32_bf16 v[132:135], v[84:87], a[64:67], v[132:135]
    v_mfma_f32_16x16x32_bf16 v[136:139], v[72:75], a[88:91], v[136:139]
    v_mfma_f32_16x16x32_bf16 v[140:143], v[84:87], a[88:91], v[140:143]
    v_mfma_f32_16x16x32_bf16 v[144:147], v[72:75], a[112:115], v[144:147]
    v_mfma_f32_16x16x32_bf16 v[148:151], v[84:87], a[112:115], v[148:151]
    v_mfma_f32_16x16x32_bf16 v[152:155], v[72:75], a[136:139], v[152:155]
    v_mfma_f32_16x16x32_bf16 v[156:159], v[84:87], a[136:139], v[156:159]
    v_mfma_f32_16x16x32_bf16 v[160:163], v[72:75], a[160:163], v[160:163]
    v_mfma_f32_16x16x32_bf16 v[164:167], v[84:87], a[160:163], v[164:167]
    v_mfma_f32_16x16x32_bf16 v[168:171], v[72:75], a[184:187], v[168:171]
    v_mfma_f32_16x16x32_bf16 v[172:175], v[84:87], a[184:187], v[172:175]
    v_mfma_f32_16x16x32_bf16 v[176:179], v[72:75], a[208:211], v[176:179]
    v_mfma_f32_16x16x32_bf16 v[180:183], v[84:87], a[208:211], v[180:183]
    v_mfma_f32_16x16x32_bf16 v[184:187], v[72:75], a[232:235], v[184:187]
    v_mfma_f32_16x16x32_bf16 v[188:191], v[84:87], a[232:235], v[188:191]
    v_mfma_f32_16x16x32_bf16 v[112:115], v[96:99], a[20:23], v[112:115]
    v_mfma_f32_16x16x32_bf16 v[116:119], v[108:111], a[20:23], v[116:119]
    v_mfma_f32_16x16x32_bf16 v[120:123], v[96:99], a[44:47], v[120:123]
    v_mfma_f32_16x16x32_bf16 v[124:127], v[108:111], a[44:47], v[124:127]
    v_mfma_f32_16x16x32_bf16 v[128:131], v[96:99], a[68:71], v[128:131]
    v_mfma_f32_16x16x32_bf16 v[132:135], v[108:111], a[68:71], v[132:135]
    v_mfma_f32_16x16x32_bf16 v[136:139], v[96:99], a[92:95], v[136:139]
    v_mfma_f32_16x16x32_bf16 v[140:143], v[108:111], a[92:95], v[140:143]
    v_mfma_f32_16x16x32_bf16 v[144:147], v[96:99], a[116:119], v[144:147]
    v_mfma_f32_16x16x32_bf16 v[148:151], v[108:111], a[116:119], v[148:151]
    v_mfma_f32_16x16x32_bf16 v[152:155], v[96:99], a[140:143], v[152:155]
    v_mfma_f32_16x16x32_bf16 v[156:159], v[108:111], a[140:143], v[156:159]
    v_mfma_f32_16x16x32_bf16 v[160:163], v[96:99], a[164:167], v[160:163]
    v_mfma_f32_16x16x32_bf16 v[164:167], v[108:111], a[164:167], v[164:167]
    v_mfma_f32_16x16x32_bf16 v[168:171], v[96:99], a[188:191], v[168:171]
    v_mfma_f32_16x16x32_bf16 v[172:175], v[108:111], a[188:191], v[172:175]
    v_mfma_f32_16x16x32_bf16 v[176:179], v[96:99], a[212:215], v[176:179]
    v_mfma_f32_16x16x32_bf16 v[180:183], v[108:111], a[212:215], v[180:183]
    v_mfma_f32_16x16x32_bf16 v[184:187], v[96:99], a[236:239], v[184:187]
    v_mfma_f32_16x16x32_bf16 v[188:191], v[108:111], a[236:239], v[188:191]
    s_mov_b32 s46, s43
    v_cvt_pk_bf16_f32 v192, v112, v113
    v_cvt_pk_bf16_f32 v193, v114, v115
    v_cvt_pk_bf16_f32 v194, v116, v117
    v_cvt_pk_bf16_f32 v195, v118, v119
    buffer_store_dwordx4 v[192:195], v9, s[8:11], s46 offen sc1
    s_add_u32 s46, s46, 32768
    v_cvt_pk_bf16_f32 v196, v120, v121
    v_cvt_pk_bf16_f32 v197, v122, v123
    v_cvt_pk_bf16_f32 v198, v124, v125
    v_cvt_pk_bf16_f32 v199, v126, v127
    buffer_store_dwordx4 v[196:199], v9, s[8:11], s46 offen sc1
    s_add_u32 s46, s46, 32768
    v_cvt_pk_bf16_f32 v200, v128, v129
    v_cvt_pk_bf16_f32 v201, v130, v131
    v_cvt_pk_bf16_f32 v202, v132, v133
    v_cvt_pk_bf16_f32 v203, v134, v135
    buffer_store_dwordx4 v[200:203], v9, s[8:11], s46 offen sc1
    s_add_u32 s46, s46, 32768
    v_cvt_pk_bf16_f32 v204, v136, v137
    v_cvt_pk_bf16_f32 v205, v138, v139
    v_cvt_pk_bf16_f32 v206, v140, v141
    v_cvt_pk_bf16_f32 v207, v142, v143
    buffer_store_dwordx4 v[204:207], v9, s[8:11], s46 offen sc1
    s_add_u32 s46, s46, 32768
    v_cvt_pk_bf16_f32 v208, v144, v145
    v_cvt_pk_bf16_f32 v209, v146, v147
    v_cvt_pk_bf16_f32 v210, v148, v149
    v_cvt_pk_bf16_f32 v211, v150, v151
    buffer_store_dwordx4 v[208:211], v9, s[8:11], s46 offen sc1
    s_add_u32 s46, s46, 32768
    v_cvt_pk_bf16_f32 v212, v152, v153
    v_cvt_pk_bf16_f32 v213, v154, v155
    v_cvt_pk_bf16_f32 v214, v156, v157
    v_cvt_pk_bf16_f32 v215, v158, v159
    buffer_store_dwordx4 v[212:215], v9, s[8:11], s46 offen sc1
    s_add_u32 s46, s46, 32768
    v_cvt_pk_bf16_f32 v216, v160, v161
    v_cvt_pk_bf16_f32 v217, v162, v163
    v_cvt_pk_bf16_f32 v218, v164, v165
    v_cvt_pk_bf16_f32 v219, v166, v167
    buffer_store_dwordx4 v[216:219], v9, s[8:11], s46 offen sc1
    s_add_u32 s46, s46, 32768
    v_cvt_pk_bf16_f32 v220, v168, v169
    v_cvt_pk_bf16_f32 v221, v170, v171
    v_cvt_pk_bf16_f32 v222, v172, v173
    v_cvt_pk_bf16_f32 v223, v174, v175
    buffer_store_dwordx4 v[220:223], v9, s[8:11], s46 offen sc1
    s_add_u32 s46, s46, 32768
    v_cvt_pk_bf16_f32 v224, v176, v177
    v_cvt_pk_bf16_f32 v225, v178, v179
    v_cvt_pk_bf16_f32 v226, v180, v181
    v_cvt_pk_bf16_f32 v227, v182, v183
    buffer_store_dwordx4 v[224:227], v9, s[8:11], s46 offen sc1
    s_add_u32 s46, s46, 32768
    v_cvt_pk_bf16_f32 v228, v184, v185
    v_cvt_pk_bf16_f32 v229, v186, v187
    v_cvt_pk_bf16_f32 v230, v188, v189
    v_cvt_pk_bf16_f32 v231, v190, v191
    buffer_store_dwordx4 v[228:231], v9, s[8:11], s46 offen sc1
    s_waitcnt vmcnt(10)
    s_add_u32 s40, s40, 1
    s_add_u32 s43, s43, 1310720
    s_cmp_lt_u32 s40, 64
    s_cbranch_scc1 interleave_layers__linear_attn_block__memory_aug_recurrent_mem_tr__prompt_kernel_o_seg
    s_waitcnt vmcnt(0)
    s_barrier
    s_cmp_eq_u32 s3, 0
    s_cbranch_scc0 interleave_layers__linear_attn_block__memory_aug_recurrent_mem_tr__prompt_kernel_fp39
    v_mov_b32 v15, s40
    buffer_store_dword v15, v14, s[8:11], 0 offen sc1
interleave_layers__linear_attn_block__memory_aug_recurrent_mem_tr__prompt_kernel_fp39:
    s_cmp_eq_u32 s92, 0
    s_cbranch_scc0 interleave_layers__linear_attn_block__memory_aug_recurrent_mem_tr__prompt_kernel_end
    s_mov_b32 s92, 1
    s_branch interleave_layers__linear_attn_block__memory_aug_recurrent_mem_tr__prompt_kernel_o_layer
interleave_layers__linear_attn_block__memory_aug_recurrent_mem_tr__prompt_kernel_end:
    s_endpgm
.section .rodata,"a"
.p2align 6
.amdhsa_kernel interleave_layers__linear_attn_block__memory_aug_recurrent_mem_tr__prompt_kernel
  .amdhsa_next_free_vgpr 512
  .amdhsa_next_free_sgpr 100
  .amdhsa_accum_offset 256
  .amdhsa_group_segment_fixed_size 0
  .amdhsa_kernarg_size 104
  .amdhsa_user_sgpr_count 2
  .amdhsa_user_sgpr_kernarg_segment_ptr 1
  .amdhsa_system_sgpr_workgroup_id_x 1
.end_amdhsa_kernel
```

```asm
; @launch kernel=interleave_layers__linear_attn_block__memory_aug_recurrent_mem_tr__prompt_kernel grid=(256,1,1) block=(256,1,1) lds=135168
.amdgcn_target "amdgcn-amd-amdhsa--gfx950"
.text
.globl interleave_layers__linear_attn_block__memory_aug_recurrent_mem_tr__prompt_kernel
.p2align 8
.type interleave_layers__linear_attn_block__memory_aug_recurrent_mem_tr__prompt_kernel,@function
interleave_layers__linear_attn_block__memory_aug_recurrent_mem_tr__prompt_kernel:
    s_cmp_ge_u32 s2, 256
    s_cbranch_scc1 interleave_layers__linear_attn_block__memory_aug_recurrent_mem_tr__prompt_kernel_end
    s_load_dwordx2 s[4:5], s[0:1], 96
    s_load_dwordx2 s[6:7], s[0:1], 88
    s_load_dwordx2 s[24:25], s[0:1], 0
    s_load_dwordx2 s[98:99], s[0:1], 8
    s_and_b32 s44, s2, 7
    s_lshr_b32 s45, s2, 3
    s_and_b32 s26, s44, 3
    s_lshl_b32 s27, s45, 2
    s_add_u32 s26, s26, s27
    s_add_u32 s27, s26, 128
    s_cmp_lt_u32 s26, 104
    s_cselect_b32 s27, s26, s27
    s_add_u32 s26, s26, 104
    s_cmp_lt_u32 s44, 4
    s_cselect_b32 s2, s27, s26
    v_and_b32 v1, 63, v0
    v_lshrrev_b32 v4, 6, v0
    v_and_b32 v2, 15, v1
    v_lshrrev_b32 v3, 4, v1
    v_readfirstlane_b32 s3, v4
    s_mov_b32 s60, 131072
    s_mov_b32 s59, -1
    s_mov_b32 s92, 0
    s_waitcnt lgkmcnt(0)
    s_mov_b32 s8, s4
    s_mov_b32 s9, s5
    s_mov_b32 s10, 268435456
    s_mov_b32 s11, 0x00020000
    s_mov_b32 s72, s6
    s_mov_b32 s73, s7
    s_mov_b32 s74, 256
    s_mov_b32 s75, 0x00020000
    s_mov_b32 s16, s24
    s_mov_b32 s17, s25
    s_mov_b32 s18, 2621440
    s_mov_b32 s19, 0x00020000
    s_cmp_eq_u32 s2, 255
    s_cbranch_scc0 interleave_layers__linear_attn_block__memory_aug_recurrent_mem_tr__prompt_kernel_cf1
    v_lshlrev_b32 v5, 4, v0
    v_mov_b32 v8, -1
    v_mov_b32 v9, -1
    v_mov_b32 v10, -1
    v_mov_b32 v11, -1
    s_mov_b32 s24, 23068672
    buffer_store_dwordx4 v[8:11], v5, s[8:11], s24 offen sc1
    s_add_u32 s24, s24, 4096
    buffer_store_dwordx4 v[8:11], v5, s[8:11], s24 offen sc1
    s_add_u32 s24, s24, 4096
    buffer_store_dwordx4 v[8:11], v5, s[8:11], s24 offen sc1
    s_add_u32 s24, s24, 4096
    buffer_store_dwordx4 v[8:11], v5, s[8:11], s24 offen sc1
    s_add_u32 s24, s24, 4096
    buffer_store_dwordx4 v[8:11], v5, s[8:11], s24 offen sc1
    s_add_u32 s24, s24, 4096
    buffer_store_dwordx4 v[8:11], v5, s[8:11], s24 offen sc1
    s_add_u32 s24, s24, 4096
    buffer_store_dwordx4 v[8:11], v5, s[8:11], s24 offen sc1
    s_add_u32 s24, s24, 4096
    buffer_store_dwordx4 v[8:11], v5, s[8:11], s24 offen sc1
    s_add_u32 s24, s24, 4096
    buffer_store_dwordx4 v[8:11], v5, s[8:11], s24 offen sc1
    s_add_u32 s24, s24, 4096
    buffer_store_dwordx4 v[8:11], v5, s[8:11], s24 offen sc1
    s_add_u32 s24, s24, 4096
    buffer_store_dwordx4 v[8:11], v5, s[8:11], s24 offen sc1
    s_add_u32 s24, s24, 4096
    buffer_store_dwordx4 v[8:11], v5, s[8:11], s24 offen sc1
    s_add_u32 s24, s24, 4096
    buffer_store_dwordx4 v[8:11], v5, s[8:11], s24 offen sc1
    s_add_u32 s24, s24, 4096
    buffer_store_dwordx4 v[8:11], v5, s[8:11], s24 offen sc1
    s_add_u32 s24, s24, 4096
    buffer_store_dwordx4 v[8:11], v5, s[8:11], s24 offen sc1
    s_add_u32 s24, s24, 4096
    buffer_store_dwordx4 v[8:11], v5, s[8:11], s24 offen sc1
    s_add_u32 s24, s24, 4096
interleave_layers__linear_attn_block__memory_aug_recurrent_mem_tr__prompt_kernel_cf1:
    s_mov_b32 s46, 64
    s_mov_b32 s47, 32
    s_mov_b32 s50, 0
    s_lshl_b32 s48, s45, 1
    s_mov_b32 s49, 1
    s_mov_b32 s40, 2
interleave_layers__linear_attn_block__memory_aug_recurrent_mem_tr__prompt_kernel_k1_entry:
    v_and_b32 v7, 31, v0
    v_lshrrev_b32 v8, 5, v0
    v_mul_u32_u24 v152, 3840, v8
    v_lshlrev_b32 v9, 4, v7
    v_add_u32 v152, v152, v9
    v_cmp_le_u32 vcc, 10, v7
    s_nop 1
    v_cndmask_b32 v10, 0, 1, vcc
    v_cmp_le_u32 vcc, 20, v7
    s_nop 1
    v_cndmask_b32 v11, 0, 1, vcc
    v_add_u32 v10, v10, v11
    v_mul_u32_u24 v10, 1120, v10
    v_add_u32 v152, v152, v10
    v_mov_b32 v10, 2146435072
    v_cmp_le_u32 vcc, 30, v7
    s_nop 1
    v_cndmask_b32 v152, v152, v10, vcc
    v_mul_u32_u24 v153, 544, v8
    v_add_u32 v153, v153, v9
    v_add_u32 v153, 40960, v153
    s_mov_b32 s12, s98
    s_mov_b32 s13, s99
    s_mov_b32 s14, 2457600
    s_mov_b32 s15, 0x00020000
    s_mul_i32 s52, s44, 160
    v_lshrrev_b32 v10, 2, v0
    v_mul_u32_u24 v10, 3840, v10
    v_and_b32 v11, 3, v0
    v_lshlrev_b32 v11, 6, v11
    v_min_u32 v11, 156, v11
    v_add_u32 v10, v10, v11
    s_mul_i32 s24, s45, 205
    s_lshr_b32 s24, s24, 11
    s_mul_i32 s24, s24, 10
    s_sub_u32 s24, s45, s24
    s_mul_i32 s24, s24, 245760
    s_add_u32 s24, s24, s52
    buffer_load_dword a254, v10, s[12:15], s24 offen
    s_add_u32 s24, s24, 1280
    buffer_load_dword a254, v10, s[12:15], s24 offen
    s_add_u32 s24, s24, 1280
    buffer_load_dword a254, v10, s[12:15], s24 offen
    s_add_u32 s24, s52, 0
    buffer_load_dwordx4 v[56:59], v152, s[12:15], s24 offen
    s_add_u32 s24, s24, 30720
    buffer_load_dwordx4 v[60:63], v152, s[12:15], s24 offen
    s_add_u32 s24, s24, 30720
    buffer_load_dwordx4 v[64:67], v152, s[12:15], s24 offen
    s_add_u32 s24, s24, 30720
    buffer_load_dwordx4 v[68:71], v152, s[12:15], s24 offen
    s_add_u32 s24, s24, 30720
    buffer_load_dwordx4 v[72:75], v152, s[12:15], s24 offen
    s_add_u32 s24, s24, 30720
    buffer_load_dwordx4 v[76:79], v152, s[12:15], s24 offen
    s_add_u32 s24, s24, 30720
    buffer_load_dwordx4 v[80:83], v152, s[12:15], s24 offen
    s_add_u32 s24, s24, 30720
    buffer_load_dwordx4 v[84:87], v152, s[12:15], s24 offen
    s_add_u32 s24, s52, 245760
    buffer_load_dwordx4 v[88:91], v152, s[12:15], s24 offen
    s_add_u32 s24, s24, 30720
    buffer_load_dwordx4 v[92:95], v152, s[12:15], s24 offen
    s_add_u32 s24, s24, 30720
    buffer_load_dwordx4 v[96:99], v152, s[12:15], s24 offen
    s_add_u32 s24, s24, 30720
    buffer_load_dwordx4 v[100:103], v152, s[12:15], s24 offen
    s_add_u32 s24, s24, 30720
    buffer_load_dwordx4 v[104:107], v152, s[12:15], s24 offen
    s_add_u32 s24, s24, 30720
    buffer_load_dwordx4 v[108:111], v152, s[12:15], s24 offen
    s_add_u32 s24, s24, 30720
    buffer_load_dwordx4 v[112:115], v152, s[12:15], s24 offen
    s_add_u32 s24, s24, 30720
    buffer_load_dwordx4 v[116:119], v152, s[12:15], s24 offen
    s_add_u32 s24, s52, 491520
    buffer_load_dwordx4 v[120:123], v152, s[12:15], s24 offen
    s_add_u32 s24, s24, 30720
    buffer_load_dwordx4 v[124:127], v152, s[12:15], s24 offen
    s_add_u32 s24, s24, 30720
    buffer_load_dwordx4 v[128:131], v152, s[12:15], s24 offen
    s_add_u32 s24, s24, 30720
    buffer_load_dwordx4 v[132:135], v152, s[12:15], s24 offen
    s_add_u32 s24, s24, 30720
    buffer_load_dwordx4 v[136:139], v152, s[12:15], s24 offen
    s_add_u32 s24, s24, 30720
    buffer_load_dwordx4 v[140:143], v152, s[12:15], s24 offen
    s_add_u32 s24, s24, 30720
    buffer_load_dwordx4 v[144:147], v152, s[12:15], s24 offen
    s_add_u32 s24, s24, 30720
    buffer_load_dwordx4 v[148:151], v152, s[12:15], s24 offen
    s_lshr_b32 s24, s3, 1
    s_mul_i32 s24, s24, 20480
    s_and_b32 s25, s3, 1
    s_mul_i32 s25, s25, 10
    s_mul_i32 s25, s25, s46
    s_add_u32 s24, s24, s25
    s_cmp_eq_u32 s50, 1
    s_cselect_b32 s25, 16, 1280
    s_cselect_b32 s26, 256, 8
    v_mul_u32_u24 v4, s25, v2
    v_mul_u32_u24 v5, s26, v3
    v_add3_u32 v4, v4, v5, s24
    v_add_u32 v5, s47, v4
    s_mul_i32 s43, s48, 40960
    s_mul_i32 s42, s49, 40960
    s_cmp_eq_u32 s92, 0
    s_cselect_b32 s51, 1, 0
    s_cselect_b32 s41, s43, 2146435072
    s_mov_b32 s24, s41
    buffer_load_dwordx2 v[16:17], v4, s[16:19], s24 offen
    buffer_load_dwordx2 v[18:19], v5, s[16:19], s24 offen
    s_add_u32 s24, s24, s46
    buffer_load_dwordx2 v[20:21], v4, s[16:19], s24 offen
    buffer_load_dwordx2 v[22:23], v5, s[16:19], s24 offen
    s_add_u32 s24, s24, s46
    buffer_load_dwordx2 v[24:25], v4, s[16:19], s24 offen
    buffer_load_dwordx2 v[26:27], v5, s[16:19], s24 offen
    s_add_u32 s24, s24, s46
    buffer_load_dwordx2 v[28:29], v4, s[16:19], s24 offen
    buffer_load_dwordx2 v[30:31], v5, s[16:19], s24 offen
    s_add_u32 s24, s24, s46
    buffer_load_dwordx2 v[32:33], v4, s[16:19], s24 offen
    buffer_load_dwordx2 v[34:35], v5, s[16:19], s24 offen
    s_add_u32 s24, s24, s46
    buffer_load_dwordx2 v[36:37], v4, s[16:19], s24 offen
    buffer_load_dwordx2 v[38:39], v5, s[16:19], s24 offen
    s_add_u32 s24, s24, s46
    buffer_load_dwordx2 v[40:41], v4, s[16:19], s24 offen
    buffer_load_dwordx2 v[42:43], v5, s[16:19], s24 offen
    s_add_u32 s24, s24, s46
    buffer_load_dwordx2 v[44:45], v4, s[16:19], s24 offen
    buffer_load_dwordx2 v[46:47], v5, s[16:19], s24 offen
    s_add_u32 s24, s24, s46
    buffer_load_dwordx2 v[48:49], v4, s[16:19], s24 offen
    buffer_load_dwordx2 v[50:51], v5, s[16:19], s24 offen
    s_add_u32 s24, s24, s46
    buffer_load_dwordx2 v[52:53], v4, s[16:19], s24 offen
    buffer_load_dwordx2 v[54:55], v5, s[16:19], s24 offen
    v_lshrrev_b32 v6, 2, v2
    v_lshl_add_u32 v6, v3, 2, v6
    v_mul_u32_u24 v6, 544, v6
    v_and_b32 v7, 3, v2
    v_lshl_add_u32 v6, v7, 3, v6
    v_add_u32 v6, 40960, v6
    s_mov_b32 s24, 0
    s_cmp_eq_u32 s3, 1
    s_cselect_b32 s24, 64, s24
    s_cmp_eq_u32 s3, 2
    s_cselect_b32 s24, 128, s24
    s_cmp_eq_u32 s3, 3
    s_cselect_b32 s24, 224, s24
    v_add_u32 v12, s24, v6
    s_mov_b32 s24, 32
    s_cmp_eq_u32 s3, 1
    s_cselect_b32 s24, 96, s24
    s_cmp_eq_u32 s3, 2
    s_cselect_b32 s24, 160, s24
    s_cmp_eq_u32 s3, 3
    s_cselect_b32 s24, 256, s24
    v_add_u32 v13, s24, v6
    s_mov_b32 s24, 320
    s_cmp_eq_u32 s3, 1
    s_cselect_b32 s24, 384, s24
    s_cmp_eq_u32 s3, 2
    s_cselect_b32 s24, 192, s24
    s_cmp_eq_u32 s3, 3
    s_cselect_b32 s24, 288, s24
    v_add_u32 v14, s24, v6
    s_mov_b32 s24, 352
    s_cmp_eq_u32 s3, 1
    s_cselect_b32 s24, 416, s24
    s_cmp_eq_u32 s3, 2
    s_cselect_b32 s24, 448, s24
    s_cmp_eq_u32 s3, 3
    s_cselect_b32 s24, 288, s24
    v_add_u32 v15, s24, v6
    v_mov_b32 v172, 0x3f803f80
    v_mov_b32 v173, 0x3f803f80
    v_mov_b32 v174, 0x3f803f80
    v_mov_b32 v175, 0x3f803f80
    s_waitcnt vmcnt(36)
    ds_write_b128 v153, v[56:59] offset:0
    ds_write_b128 v153, v[60:63] offset:4352
    ds_write_b128 v153, v[64:67] offset:8704
    ds_write_b128 v153, v[68:71] offset:13056
    ds_write_b128 v153, v[72:75] offset:17408
    ds_write_b128 v153, v[76:79] offset:21760
    ds_write_b128 v153, v[80:83] offset:26112
    ds_write_b128 v153, v[84:87] offset:30464
    s_waitcnt lgkmcnt(0)
    s_add_u32 s24, s52, 737280
    buffer_load_dwordx4 v[56:59], v152, s[12:15], s24 offen
    s_add_u32 s24, s24, 30720
    buffer_load_dwordx4 v[60:63], v152, s[12:15], s24 offen
    s_add_u32 s24, s24, 30720
    buffer_load_dwordx4 v[64:67], v152, s[12:15], s24 offen
    s_add_u32 s24, s24, 30720
    buffer_load_dwordx4 v[68:71], v152, s[12:15], s24 offen
    s_add_u32 s24, s24, 30720
    buffer_load_dwordx4 v[72:75], v152, s[12:15], s24 offen
    s_add_u32 s24, s24, 30720
    buffer_load_dwordx4 v[76:79], v152, s[12:15], s24 offen
    s_add_u32 s24, s24, 30720
    buffer_load_dwordx4 v[80:83], v152, s[12:15], s24 offen
    s_add_u32 s24, s24, 30720
    buffer_load_dwordx4 v[84:87], v152, s[12:15], s24 offen
    s_barrier
    s_cmp_eq_u32 s2, 255
    s_cbranch_scc0 interleave_layers__linear_attn_block__memory_aug_recurrent_mem_tr__prompt_kernel_fb2
    s_cmp_eq_u32 s92, 0
    s_cbranch_scc0 interleave_layers__linear_attn_block__memory_aug_recurrent_mem_tr__prompt_kernel_fb2
    s_cmp_eq_u32 s3, 0
    s_cbranch_scc0 interleave_layers__linear_attn_block__memory_aug_recurrent_mem_tr__prompt_kernel_fb2
    v_mov_b32 v154, 2146435072
    v_cmp_eq_u32 vcc, 0, v1
    s_nop 1
    v_cndmask_b32 v154, v154, 0, vcc
    v_mov_b32 v155, 1
    buffer_store_dword v155, v154, s[72:75], 0 offen sc1
interleave_layers__linear_attn_block__memory_aug_recurrent_mem_tr__prompt_kernel_fb2:
    ds_read_b64_tr_b16 a[0:1], v12 offset:0
    ds_read_b64_tr_b16 a[2:3], v12 offset:8704
    ds_read_b64_tr_b16 a[4:5], v12 offset:17408
    ds_read_b64_tr_b16 a[6:7], v12 offset:26112
    ds_read_b64_tr_b16 a[80:81], v13 offset:0
    ds_read_b64_tr_b16 a[82:83], v13 offset:8704
    ds_read_b64_tr_b16 a[84:85], v13 offset:17408
    ds_read_b64_tr_b16 a[86:87], v13 offset:26112
    ds_read_b64_tr_b16 a[160:161], v14 offset:0
    ds_read_b64_tr_b16 a[162:163], v14 offset:8704
    ds_read_b64_tr_b16 a[164:165], v14 offset:17408
    ds_read_b64_tr_b16 a[166:167], v14 offset:26112
    ds_read_b64_tr_b16 v[176:177], v15 offset:0
    ds_read_b64_tr_b16 v[178:179], v15 offset:8704
    ds_read_b64_tr_b16 v[180:181], v15 offset:17408
    ds_read_b64_tr_b16 v[182:183], v15 offset:26112
    s_waitcnt vmcnt(36)
    ds_write_b128 v153, v[88:91] offset:34816
    ds_write_b128 v153, v[92:95] offset:39168
    ds_write_b128 v153, v[96:99] offset:43520
    ds_write_b128 v153, v[100:103] offset:47872
    ds_write_b128 v153, v[104:107] offset:52224
    ds_write_b128 v153, v[108:111] offset:56576
    ds_write_b128 v153, v[112:115] offset:60928
    ds_write_b128 v153, v[116:119] offset:65280
    s_waitcnt lgkmcnt(0)
    s_add_u32 s24, s52, 983040
    buffer_load_dwordx4 v[88:91], v152, s[12:15], s24 offen
    s_add_u32 s24, s24, 30720
    buffer_load_dwordx4 v[92:95], v152, s[12:15], s24 offen
    s_add_u32 s24, s24, 30720
    buffer_load_dwordx4 v[96:99], v152, s[12:15], s24 offen
    s_add_u32 s24, s24, 30720
    buffer_load_dwordx4 v[100:103], v152, s[12:15], s24 offen
    s_add_u32 s24, s24, 30720
    buffer_load_dwordx4 v[104:107], v152, s[12:15], s24 offen
    s_add_u32 s24, s24, 30720
    buffer_load_dwordx4 v[108:111], v152, s[12:15], s24 offen
    s_add_u32 s24, s24, 30720
    buffer_load_dwordx4 v[112:115], v152, s[12:15], s24 offen
    s_add_u32 s24, s24, 30720
    buffer_load_dwordx4 v[116:119], v152, s[12:15], s24 offen
    v_mfma_f32_16x16x32_bf16 v[156:159], a[0:3], v[172:175], 0
    v_mfma_f32_16x16x32_bf16 v[160:163], a[80:83], v[172:175], 0
    v_mfma_f32_16x16x32_bf16 v[164:167], a[160:163], v[172:175], 0
    v_mfma_f32_16x16x32_bf16 v[168:171], v[176:179], v[172:175], 0
    v_mfma_f32_16x16x32_bf16 v[156:159], a[4:7], v[172:175], v[156:159]
    v_mfma_f32_16x16x32_bf16 v[160:163], a[84:87], v[172:175], v[160:163]
    v_mfma_f32_16x16x32_bf16 v[164:167], a[164:167], v[172:175], v[164:167]
    v_mfma_f32_16x16x32_bf16 v[168:171], v[180:183], v[172:175], v[168:171]
    s_barrier
    ds_read_b64_tr_b16 a[8:9], v12 offset:34816
    ds_read_b64_tr_b16 a[10:11], v12 offset:43520
    ds_read_b64_tr_b16 a[12:13], v12 offset:52224
    ds_read_b64_tr_b16 a[14:15], v12 offset:60928
    ds_read_b64_tr_b16 a[88:89], v13 offset:34816
    ds_read_b64_tr_b16 a[90:91], v13 offset:43520
    ds_read_b64_tr_b16 a[92:93], v13 offset:52224
    ds_read_b64_tr_b16 a[94:95], v13 offset:60928
    ds_read_b64_tr_b16 a[168:169], v14 offset:34816
    ds_read_b64_tr_b16 a[170:171], v14 offset:43520
    ds_read_b64_tr_b16 a[172:173], v14 offset:52224
    ds_read_b64_tr_b16 a[174:175], v14 offset:60928
    ds_read_b64_tr_b16 v[184:185], v15 offset:34816
    ds_read_b64_tr_b16 v[186:187], v15 offset:43520
    ds_read_b64_tr_b16 v[188:189], v15 offset:52224
    ds_read_b64_tr_b16 v[190:191], v15 offset:60928
    s_waitcnt vmcnt(36)
    ds_write_b128 v153, v[120:123] offset:0
    ds_write_b128 v153, v[124:127] offset:4352
    ds_write_b128 v153, v[128:131] offset:8704
    ds_write_b128 v153, v[132:135] offset:13056
    ds_write_b128 v153, v[136:139] offset:17408
    ds_write_b128 v153, v[140:143] offset:21760
    ds_write_b128 v153, v[144:147] offset:26112
    ds_write_b128 v153, v[148:151] offset:30464
    s_waitcnt lgkmcnt(0)
    s_add_u32 s24, s52, 1228800
    buffer_load_dwordx4 v[120:123], v152, s[12:15], s24 offen
    s_add_u32 s24, s24, 30720
    buffer_load_dwordx4 v[124:127], v152, s[12:15], s24 offen
    s_add_u32 s24, s24, 30720
    buffer_load_dwordx4 v[128:131], v152, s[12:15], s24 offen
    s_add_u32 s24, s24, 30720
    buffer_load_dwordx4 v[132:135], v152, s[12:15], s24 offen
    s_add_u32 s24, s24, 30720
    buffer_load_dwordx4 v[136:139], v152, s[12:15], s24 offen
    s_add_u32 s24, s24, 30720
    buffer_load_dwordx4 v[140:143], v152, s[12:15], s24 offen
    s_add_u32 s24, s24, 30720
    buffer_load_dwordx4 v[144:147], v152, s[12:15], s24 offen
    s_add_u32 s24, s24, 30720
    buffer_load_dwordx4 v[148:151], v152, s[12:15], s24 offen
    v_mfma_f32_16x16x32_bf16 v[156:159], a[8:11], v[172:175], v[156:159]
    v_mfma_f32_16x16x32_bf16 v[160:163], a[88:91], v[172:175], v[160:163]
    v_mfma_f32_16x16x32_bf16 v[164:167], a[168:171], v[172:175], v[164:167]
    v_mfma_f32_16x16x32_bf16 v[168:171], v[184:187], v[172:175], v[168:171]
    v_mfma_f32_16x16x32_bf16 v[156:159], a[12:15], v[172:175], v[156:159]
    v_mfma_f32_16x16x32_bf16 v[160:163], a[92:95], v[172:175], v[160:163]
    v_mfma_f32_16x16x32_bf16 v[164:167], a[172:175], v[172:175], v[164:167]
    v_mfma_f32_16x16x32_bf16 v[168:171], v[188:191], v[172:175], v[168:171]
    s_barrier
    ds_read_b64_tr_b16 a[16:17], v12 offset:0
    ds_read_b64_tr_b16 a[18:19], v12 offset:8704
    ds_read_b64_tr_b16 a[20:21], v12 offset:17408
    ds_read_b64_tr_b16 a[22:23], v12 offset:26112
    ds_read_b64_tr_b16 a[96:97], v13 offset:0
    ds_read_b64_tr_b16 a[98:99], v13 offset:8704
    ds_read_b64_tr_b16 a[100:101], v13 offset:17408
    ds_read_b64_tr_b16 a[102:103], v13 offset:26112
    ds_read_b64_tr_b16 a[176:177], v14 offset:0
    ds_read_b64_tr_b16 a[178:179], v14 offset:8704
    ds_read_b64_tr_b16 a[180:181], v14 offset:17408
    ds_read_b64_tr_b16 a[182:183], v14 offset:26112
    ds_read_b64_tr_b16 v[192:193], v15 offset:0
    ds_read_b64_tr_b16 v[194:195], v15 offset:8704
    ds_read_b64_tr_b16 v[196:197], v15 offset:17408
    ds_read_b64_tr_b16 v[198:199], v15 offset:26112
    s_waitcnt vmcnt(16)
    ds_write_b128 v153, v[56:59] offset:34816
    ds_write_b128 v153, v[60:63] offset:39168
    ds_write_b128 v153, v[64:67] offset:43520
    ds_write_b128 v153, v[68:71] offset:47872
    ds_write_b128 v153, v[72:75] offset:52224
    ds_write_b128 v153, v[76:79] offset:56576
    ds_write_b128 v153, v[80:83] offset:60928
    ds_write_b128 v153, v[84:87] offset:65280
    s_waitcnt lgkmcnt(0)
    s_add_u32 s24, s52, 1474560
    buffer_load_dwordx4 v[56:59], v152, s[12:15], s24 offen
    s_add_u32 s24, s24, 30720
    buffer_load_dwordx4 v[60:63], v152, s[12:15], s24 offen
    s_add_u32 s24, s24, 30720
    buffer_load_dwordx4 v[64:67], v152, s[12:15], s24 offen
    s_add_u32 s24, s24, 30720
    buffer_load_dwordx4 v[68:71], v152, s[12:15], s24 offen
    s_add_u32 s24, s24, 30720
    buffer_load_dwordx4 v[72:75], v152, s[12:15], s24 offen
    s_add_u32 s24, s24, 30720
    buffer_load_dwordx4 v[76:79], v152, s[12:15], s24 offen
    s_add_u32 s24, s24, 30720
    buffer_load_dwordx4 v[80:83], v152, s[12:15], s24 offen
    s_add_u32 s24, s24, 30720
    buffer_load_dwordx4 v[84:87], v152, s[12:15], s24 offen
    v_mfma_f32_16x16x32_bf16 v[156:159], a[16:19], v[172:175], v[156:159]
    v_mfma_f32_16x16x32_bf16 v[160:163], a[96:99], v[172:175], v[160:163]
    v_mfma_f32_16x16x32_bf16 v[164:167], a[176:179], v[172:175], v[164:167]
    v_mfma_f32_16x16x32_bf16 v[168:171], v[192:195], v[172:175], v[168:171]
    v_mfma_f32_16x16x32_bf16 v[156:159], a[20:23], v[172:175], v[156:159]
    v_mfma_f32_16x16x32_bf16 v[160:163], a[100:103], v[172:175], v[160:163]
    v_mfma_f32_16x16x32_bf16 v[164:167], a[180:183], v[172:175], v[164:167]
    v_mfma_f32_16x16x32_bf16 v[168:171], v[196:199], v[172:175], v[168:171]
    s_barrier
    ds_read_b64_tr_b16 a[24:25], v12 offset:34816
    ds_read_b64_tr_b16 a[26:27], v12 offset:43520
    ds_read_b64_tr_b16 a[28:29], v12 offset:52224
    ds_read_b64_tr_b16 a[30:31], v12 offset:60928
    ds_read_b64_tr_b16 a[104:105], v13 offset:34816
    ds_read_b64_tr_b16 a[106:107], v13 offset:43520
    ds_read_b64_tr_b16 a[108:109], v13 offset:52224
    ds_read_b64_tr_b16 a[110:111], v13 offset:60928
    ds_read_b64_tr_b16 a[184:185], v14 offset:34816
    ds_read_b64_tr_b16 a[186:187], v14 offset:43520
    ds_read_b64_tr_b16 a[188:189], v14 offset:52224
    ds_read_b64_tr_b16 a[190:191], v14 offset:60928
    ds_read_b64_tr_b16 v[200:201], v15 offset:34816
    ds_read_b64_tr_b16 v[202:203], v15 offset:43520
    ds_read_b64_tr_b16 v[204:205], v15 offset:52224
    ds_read_b64_tr_b16 v[206:207], v15 offset:60928
    s_waitcnt vmcnt(16)
    ds_write_b128 v153, v[88:91] offset:0
    ds_write_b128 v153, v[92:95] offset:4352
    ds_write_b128 v153, v[96:99] offset:8704
    ds_write_b128 v153, v[100:103] offset:13056
    ds_write_b128 v153, v[104:107] offset:17408
    ds_write_b128 v153, v[108:111] offset:21760
    ds_write_b128 v153, v[112:115] offset:26112
    ds_write_b128 v153, v[116:119] offset:30464
    s_waitcnt lgkmcnt(0)
    s_add_u32 s24, s52, 1720320
    buffer_load_dwordx4 v[88:91], v152, s[12:15], s24 offen
    s_add_u32 s24, s24, 30720
    buffer_load_dwordx4 v[92:95], v152, s[12:15], s24 offen
    s_add_u32 s24, s24, 30720
    buffer_load_dwordx4 v[96:99], v152, s[12:15], s24 offen
    s_add_u32 s24, s24, 30720
    buffer_load_dwordx4 v[100:103], v152, s[12:15], s24 offen
    s_add_u32 s24, s24, 30720
    buffer_load_dwordx4 v[104:107], v152, s[12:15], s24 offen
    s_add_u32 s24, s24, 30720
    buffer_load_dwordx4 v[108:111], v152, s[12:15], s24 offen
    s_add_u32 s24, s24, 30720
    buffer_load_dwordx4 v[112:115], v152, s[12:15], s24 offen
    s_add_u32 s24, s24, 30720
    buffer_load_dwordx4 v[116:119], v152, s[12:15], s24 offen
    v_mfma_f32_16x16x32_bf16 v[156:159], a[24:27], v[172:175], v[156:159]
    v_mfma_f32_16x16x32_bf16 v[160:163], a[104:107], v[172:175], v[160:163]
    v_mfma_f32_16x16x32_bf16 v[164:167], a[184:187], v[172:175], v[164:167]
    v_mfma_f32_16x16x32_bf16 v[168:171], v[200:203], v[172:175], v[168:171]
    v_mfma_f32_16x16x32_bf16 v[156:159], a[28:31], v[172:175], v[156:159]
    v_mfma_f32_16x16x32_bf16 v[160:163], a[108:111], v[172:175], v[160:163]
    v_mfma_f32_16x16x32_bf16 v[164:167], a[188:191], v[172:175], v[164:167]
    v_mfma_f32_16x16x32_bf16 v[168:171], v[204:207], v[172:175], v[168:171]
    s_barrier
    ds_read_b64_tr_b16 a[32:33], v12 offset:0
    ds_read_b64_tr_b16 a[34:35], v12 offset:8704
    ds_read_b64_tr_b16 a[36:37], v12 offset:17408
    ds_read_b64_tr_b16 a[38:39], v12 offset:26112
    ds_read_b64_tr_b16 a[112:113], v13 offset:0
    ds_read_b64_tr_b16 a[114:115], v13 offset:8704
    ds_read_b64_tr_b16 a[116:117], v13 offset:17408
    ds_read_b64_tr_b16 a[118:119], v13 offset:26112
    ds_read_b64_tr_b16 a[192:193], v14 offset:0
    ds_read_b64_tr_b16 a[194:195], v14 offset:8704
    ds_read_b64_tr_b16 a[196:197], v14 offset:17408
    ds_read_b64_tr_b16 a[198:199], v14 offset:26112
    ds_read_b64_tr_b16 v[208:209], v15 offset:0
    ds_read_b64_tr_b16 v[210:211], v15 offset:8704
    ds_read_b64_tr_b16 v[212:213], v15 offset:17408
    ds_read_b64_tr_b16 v[214:215], v15 offset:26112
    s_waitcnt vmcnt(16)
    ds_write_b128 v153, v[120:123] offset:34816
    ds_write_b128 v153, v[124:127] offset:39168
    ds_write_b128 v153, v[128:131] offset:43520
    ds_write_b128 v153, v[132:135] offset:47872
    ds_write_b128 v153, v[136:139] offset:52224
    ds_write_b128 v153, v[140:143] offset:56576
    ds_write_b128 v153, v[144:147] offset:60928
    ds_write_b128 v153, v[148:151] offset:65280
    s_waitcnt lgkmcnt(0)
    s_add_u32 s24, s52, 1966080
    buffer_load_dwordx4 v[120:123], v152, s[12:15], s24 offen
    s_add_u32 s24, s24, 30720
    buffer_load_dwordx4 v[124:127], v152, s[12:15], s24 offen
    s_add_u32 s24, s24, 30720
    buffer_load_dwordx4 v[128:131], v152, s[12:15], s24 offen
    s_add_u32 s24, s24, 30720
    buffer_load_dwordx4 v[132:135], v152, s[12:15], s24 offen
    s_add_u32 s24, s24, 30720
    buffer_load_dwordx4 v[136:139], v152, s[12:15], s24 offen
    s_add_u32 s24, s24, 30720
    buffer_load_dwordx4 v[140:143], v152, s[12:15], s24 offen
    s_add_u32 s24, s24, 30720
    buffer_load_dwordx4 v[144:147], v152, s[12:15], s24 offen
    s_add_u32 s24, s24, 30720
    buffer_load_dwordx4 v[148:151], v152, s[12:15], s24 offen
    v_mfma_f32_16x16x32_bf16 v[156:159], a[32:35], v[172:175], v[156:159]
    v_mfma_f32_16x16x32_bf16 v[160:163], a[112:115], v[172:175], v[160:163]
    v_mfma_f32_16x16x32_bf16 v[164:167], a[192:195], v[172:175], v[164:167]
    v_mfma_f32_16x16x32_bf16 v[168:171], v[208:211], v[172:175], v[168:171]
    v_mfma_f32_16x16x32_bf16 v[156:159], a[36:39], v[172:175], v[156:159]
    v_mfma_f32_16x16x32_bf16 v[160:163], a[116:119], v[172:175], v[160:163]
    v_mfma_f32_16x16x32_bf16 v[164:167], a[196:199], v[172:175], v[164:167]
    v_mfma_f32_16x16x32_bf16 v[168:171], v[212:215], v[172:175], v[168:171]
    s_barrier
    ds_read_b64_tr_b16 a[40:41], v12 offset:34816
    ds_read_b64_tr_b16 a[42:43], v12 offset:43520
    ds_read_b64_tr_b16 a[44:45], v12 offset:52224
    ds_read_b64_tr_b16 a[46:47], v12 offset:60928
    ds_read_b64_tr_b16 a[120:121], v13 offset:34816
    ds_read_b64_tr_b16 a[122:123], v13 offset:43520
    ds_read_b64_tr_b16 a[124:125], v13 offset:52224
    ds_read_b64_tr_b16 a[126:127], v13 offset:60928
    ds_read_b64_tr_b16 a[200:201], v14 offset:34816
    ds_read_b64_tr_b16 a[202:203], v14 offset:43520
    ds_read_b64_tr_b16 a[204:205], v14 offset:52224
    ds_read_b64_tr_b16 a[206:207], v14 offset:60928
    ds_read_b64_tr_b16 v[216:217], v15 offset:34816
    ds_read_b64_tr_b16 v[218:219], v15 offset:43520
    ds_read_b64_tr_b16 v[220:221], v15 offset:52224
    ds_read_b64_tr_b16 v[222:223], v15 offset:60928
    s_waitcnt vmcnt(16)
    ds_write_b128 v153, v[56:59] offset:0
    ds_write_b128 v153, v[60:63] offset:4352
    ds_write_b128 v153, v[64:67] offset:8704
    ds_write_b128 v153, v[68:71] offset:13056
    ds_write_b128 v153, v[72:75] offset:17408
    ds_write_b128 v153, v[76:79] offset:21760
    ds_write_b128 v153, v[80:83] offset:26112
    ds_write_b128 v153, v[84:87] offset:30464
    s_waitcnt lgkmcnt(0)
    s_add_u32 s24, s52, 2211840
    buffer_load_dwordx4 v[56:59], v152, s[12:15], s24 offen
    s_add_u32 s24, s24, 30720
    buffer_load_dwordx4 v[60:63], v152, s[12:15], s24 offen
    s_add_u32 s24, s24, 30720
    buffer_load_dwordx4 v[64:67], v152, s[12:15], s24 offen
    s_add_u32 s24, s24, 30720
    buffer_load_dwordx4 v[68:71], v152, s[12:15], s24 offen
    s_add_u32 s24, s24, 30720
    buffer_load_dwordx4 v[72:75], v152, s[12:15], s24 offen
    s_add_u32 s24, s24, 30720
    buffer_load_dwordx4 v[76:79], v152, s[12:15], s24 offen
    s_add_u32 s24, s24, 30720
    buffer_load_dwordx4 v[80:83], v152, s[12:15], s24 offen
    s_add_u32 s24, s24, 30720
    buffer_load_dwordx4 v[84:87], v152, s[12:15], s24 offen
    v_mfma_f32_16x16x32_bf16 v[156:159], a[40:43], v[172:175], v[156:159]
    v_mfma_f32_16x16x32_bf16 v[160:163], a[120:123], v[172:175], v[160:163]
    v_mfma_f32_16x16x32_bf16 v[164:167], a[200:203], v[172:175], v[164:167]
    v_mfma_f32_16x16x32_bf16 v[168:171], v[216:219], v[172:175], v[168:171]
    v_mfma_f32_16x16x32_bf16 v[156:159], a[44:47], v[172:175], v[156:159]
    v_mfma_f32_16x16x32_bf16 v[160:163], a[124:127], v[172:175], v[160:163]
    v_mfma_f32_16x16x32_bf16 v[164:167], a[204:207], v[172:175], v[164:167]
    v_mfma_f32_16x16x32_bf16 v[168:171], v[220:223], v[172:175], v[168:171]
    s_barrier
    ds_read_b64_tr_b16 a[48:49], v12 offset:0
    ds_read_b64_tr_b16 a[50:51], v12 offset:8704
    ds_read_b64_tr_b16 a[52:53], v12 offset:17408
    ds_read_b64_tr_b16 a[54:55], v12 offset:26112
    ds_read_b64_tr_b16 a[128:129], v13 offset:0
    ds_read_b64_tr_b16 a[130:131], v13 offset:8704
    ds_read_b64_tr_b16 a[132:133], v13 offset:17408
    ds_read_b64_tr_b16 a[134:135], v13 offset:26112
    ds_read_b64_tr_b16 a[208:209], v14 offset:0
    ds_read_b64_tr_b16 a[210:211], v14 offset:8704
    ds_read_b64_tr_b16 a[212:213], v14 offset:17408
    ds_read_b64_tr_b16 a[214:215], v14 offset:26112
    ds_read_b64_tr_b16 v[224:225], v15 offset:0
    ds_read_b64_tr_b16 v[226:227], v15 offset:8704
    ds_read_b64_tr_b16 v[228:229], v15 offset:17408
    ds_read_b64_tr_b16 v[230:231], v15 offset:26112
    s_waitcnt vmcnt(16)
    ds_write_b128 v153, v[88:91] offset:34816
    ds_write_b128 v153, v[92:95] offset:39168
    ds_write_b128 v153, v[96:99] offset:43520
    ds_write_b128 v153, v[100:103] offset:47872
    ds_write_b128 v153, v[104:107] offset:52224
    ds_write_b128 v153, v[108:111] offset:56576
    ds_write_b128 v153, v[112:115] offset:60928
    ds_write_b128 v153, v[116:119] offset:65280
    s_waitcnt lgkmcnt(0)
    v_mfma_f32_16x16x32_bf16 v[156:159], a[48:51], v[172:175], v[156:159]
    v_mfma_f32_16x16x32_bf16 v[160:163], a[128:131], v[172:175], v[160:163]
    v_mfma_f32_16x16x32_bf16 v[164:167], a[208:211], v[172:175], v[164:167]
    v_mfma_f32_16x16x32_bf16 v[168:171], v[224:227], v[172:175], v[168:171]
    v_mfma_f32_16x16x32_bf16 v[156:159], a[52:55], v[172:175], v[156:159]
    v_mfma_f32_16x16x32_bf16 v[160:163], a[132:135], v[172:175], v[160:163]
    v_mfma_f32_16x16x32_bf16 v[164:167], a[212:215], v[172:175], v[164:167]
    v_mfma_f32_16x16x32_bf16 v[168:171], v[228:231], v[172:175], v[168:171]
    s_barrier
    ds_read_b64_tr_b16 a[56:57], v12 offset:34816
    ds_read_b64_tr_b16 a[58:59], v12 offset:43520
    ds_read_b64_tr_b16 a[60:61], v12 offset:52224
    ds_read_b64_tr_b16 a[62:63], v12 offset:60928
    ds_read_b64_tr_b16 a[136:137], v13 offset:34816
    ds_read_b64_tr_b16 a[138:139], v13 offset:43520
    ds_read_b64_tr_b16 a[140:141], v13 offset:52224
    ds_read_b64_tr_b16 a[142:143], v13 offset:60928
    ds_read_b64_tr_b16 a[216:217], v14 offset:34816
    ds_read_b64_tr_b16 a[218:219], v14 offset:43520
    ds_read_b64_tr_b16 a[220:221], v14 offset:52224
    ds_read_b64_tr_b16 a[222:223], v14 offset:60928
    ds_read_b64_tr_b16 v[232:233], v15 offset:34816
    ds_read_b64_tr_b16 v[234:235], v15 offset:43520
    ds_read_b64_tr_b16 v[236:237], v15 offset:52224
    ds_read_b64_tr_b16 v[238:239], v15 offset:60928
    s_waitcnt vmcnt(8)
    ds_write_b128 v153, v[120:123] offset:0
    ds_write_b128 v153, v[124:127] offset:4352
    ds_write_b128 v153, v[128:131] offset:8704
    ds_write_b128 v153, v[132:135] offset:13056
    ds_write_b128 v153, v[136:139] offset:17408
    ds_write_b128 v153, v[140:143] offset:21760
    ds_write_b128 v153, v[144:147] offset:26112
    ds_write_b128 v153, v[148:151] offset:30464
    s_waitcnt lgkmcnt(0)
    v_mfma_f32_16x16x32_bf16 v[156:159], a[56:59], v[172:175], v[156:159]
    v_mfma_f32_16x16x32_bf16 v[160:163], a[136:139], v[172:175], v[160:163]
    v_mfma_f32_16x16x32_bf16 v[164:167], a[216:219], v[172:175], v[164:167]
    v_mfma_f32_16x16x32_bf16 v[168:171], v[232:235], v[172:175], v[168:171]
    v_mfma_f32_16x16x32_bf16 v[156:159], a[60:63], v[172:175], v[156:159]
    v_mfma_f32_16x16x32_bf16 v[160:163], a[140:143], v[172:175], v[160:163]
    v_mfma_f32_16x16x32_bf16 v[164:167], a[220:223], v[172:175], v[164:167]
    v_mfma_f32_16x16x32_bf16 v[168:171], v[236:239], v[172:175], v[168:171]
    s_barrier
    ds_read_b64_tr_b16 a[64:65], v12 offset:0
    ds_read_b64_tr_b16 a[66:67], v12 offset:8704
    ds_read_b64_tr_b16 a[68:69], v12 offset:17408
    ds_read_b64_tr_b16 a[70:71], v12 offset:26112
    ds_read_b64_tr_b16 a[144:145], v13 offset:0
    ds_read_b64_tr_b16 a[146:147], v13 offset:8704
    ds_read_b64_tr_b16 a[148:149], v13 offset:17408
    ds_read_b64_tr_b16 a[150:151], v13 offset:26112
    ds_read_b64_tr_b16 a[224:225], v14 offset:0
    ds_read_b64_tr_b16 a[226:227], v14 offset:8704
    ds_read_b64_tr_b16 a[228:229], v14 offset:17408
    ds_read_b64_tr_b16 a[230:231], v14 offset:26112
    ds_read_b64_tr_b16 v[240:241], v15 offset:0
    ds_read_b64_tr_b16 v[242:243], v15 offset:8704
    ds_read_b64_tr_b16 v[244:245], v15 offset:17408
    ds_read_b64_tr_b16 v[246:247], v15 offset:26112
    s_waitcnt vmcnt(0)
    ds_write_b128 v153, v[56:59] offset:34816
    ds_write_b128 v153, v[60:63] offset:39168
    ds_write_b128 v153, v[64:67] offset:43520
    ds_write_b128 v153, v[68:71] offset:47872
    ds_write_b128 v153, v[72:75] offset:52224
    ds_write_b128 v153, v[76:79] offset:56576
    ds_write_b128 v153, v[80:83] offset:60928
    ds_write_b128 v153, v[84:87] offset:65280
    s_waitcnt lgkmcnt(0)
    v_mfma_f32_16x16x32_bf16 v[156:159], a[64:67], v[172:175], v[156:159]
    v_mfma_f32_16x16x32_bf16 v[160:163], a[144:147], v[172:175], v[160:163]
    v_mfma_f32_16x16x32_bf16 v[164:167], a[224:227], v[172:175], v[164:167]
    v_mfma_f32_16x16x32_bf16 v[168:171], v[240:243], v[172:175], v[168:171]
    v_mfma_f32_16x16x32_bf16 v[156:159], a[68:71], v[172:175], v[156:159]
    v_mfma_f32_16x16x32_bf16 v[160:163], a[148:151], v[172:175], v[160:163]
    v_mfma_f32_16x16x32_bf16 v[164:167], a[228:231], v[172:175], v[164:167]
    v_mfma_f32_16x16x32_bf16 v[168:171], v[244:247], v[172:175], v[168:171]
    s_barrier
    ds_read_b64_tr_b16 a[72:73], v12 offset:34816
    ds_read_b64_tr_b16 a[74:75], v12 offset:43520
    ds_read_b64_tr_b16 a[76:77], v12 offset:52224
    ds_read_b64_tr_b16 a[78:79], v12 offset:60928
    ds_read_b64_tr_b16 a[152:153], v13 offset:34816
    ds_read_b64_tr_b16 a[154:155], v13 offset:43520
    ds_read_b64_tr_b16 a[156:157], v13 offset:52224
    ds_read_b64_tr_b16 a[158:159], v13 offset:60928
    ds_read_b64_tr_b16 a[232:233], v14 offset:34816
    ds_read_b64_tr_b16 a[234:235], v14 offset:43520
    ds_read_b64_tr_b16 a[236:237], v14 offset:52224
    ds_read_b64_tr_b16 a[238:239], v14 offset:60928
    ds_read_b64_tr_b16 v[248:249], v15 offset:34816
    ds_read_b64_tr_b16 v[250:251], v15 offset:43520
    ds_read_b64_tr_b16 v[252:253], v15 offset:52224
    ds_read_b64_tr_b16 v[254:255], v15 offset:60928
    v_lshlrev_b32 v7, 4, v1
    s_lshr_b32 s24, s3, 1
    s_mul_i32 s24, s24, 20
    s_and_b32 s25, s3, 1
    s_mul_i32 s25, s25, 10
    s_add_u32 s24, s24, s25
    s_lshl_b32 s24, s24, 10
    v_add_u32 v6, s24, v7
    s_lshr_b32 s24, s3, 1
    s_lshl_b32 s24, s24, 8
    s_and_b32 s25, s3, 1
    s_lshl_b32 s25, s25, 3
    s_add_u32 s24, s24, s25
    s_add_u32 s24, s24, 51712
    v_lshlrev_b32 v9, 4, v2
    v_add_u32 v8, s24, v9
    v_add_u32 v9, 51712, v9
    v_mul_u32_u24 v10, 336, v2
    v_lshl_add_u32 v10, v3, 3, v10
    v_add_u32 v10, 40960, v10
    v_lshrrev_b32 v11, 2, v2
    v_lshl_add_u32 v11, v3, 3, v11
    v_mul_u32_u24 v11, 336, v11
    v_and_b32 v15, 3, v2
    v_lshl_add_u32 v11, v15, 3, v11
    s_lshl_b32 s24, s3, 5
    s_add_u32 s24, s24, 40960
    v_add_u32 v11, s24, v11
    s_lshl_b32 s24, s3, 10
    v_add_u32 v12, s24, v7
    v_lshlrev_b32 v15, 3, v1
    v_add_u32 v15, 2048, v15
    s_cmp_eq_u32 s3, 2
    s_cselect_b64 vcc, -1, 0
    v_cndmask_b32 v12, v12, v15, vcc
    s_mul_i32 s24, s44, 2560
    s_add_u32 s24, s24, 12582912
    v_add_u32 v12, s24, v12
    s_mov_b32 s52, 0x3fb8aa3b
    s_mov_b32 s53, s52
    s_mov_b32 s54, 0x358637bd
    s_mov_b32 s55, s54
    v_mov_b32 v120, 0
    v_mov_b32 v121, 0
    v_mov_b32 v122, 0
    v_mov_b32 v123, 0
    v_mov_b32 v124, 0
    v_mov_b32 v125, 0
    v_mov_b32 v126, 0
    v_mov_b32 v127, 0
    v_mov_b32 v128, 0
    v_mov_b32 v129, 0
    v_mov_b32 v130, 0
    v_mov_b32 v131, 0
    v_mov_b32 v132, 0
    v_mov_b32 v133, 0
    v_mov_b32 v134, 0
    v_mov_b32 v135, 0
    v_mov_b32 v136, 0
    v_mov_b32 v137, 0
    v_mov_b32 v138, 0
    v_mov_b32 v139, 0
    v_mov_b32 v140, 0
    v_mov_b32 v141, 0
    v_mov_b32 v142, 0
    v_mov_b32 v143, 0
    s_waitcnt lgkmcnt(0)
    v_mfma_f32_16x16x32_bf16 v[156:159], a[72:75], v[172:175], v[156:159]
    v_mfma_f32_16x16x32_bf16 v[160:163], a[152:155], v[172:175], v[160:163]
    v_mfma_f32_16x16x32_bf16 v[164:167], a[232:235], v[172:175], v[164:167]
    v_mfma_f32_16x16x32_bf16 v[168:171], v[248:251], v[172:175], v[168:171]
    v_mfma_f32_16x16x32_bf16 v[156:159], a[76:79], v[172:175], v[156:159]
    v_mfma_f32_16x16x32_bf16 v[160:163], a[156:159], v[172:175], v[160:163]
    v_mfma_f32_16x16x32_bf16 v[164:167], a[236:239], v[172:175], v[164:167]
    v_mfma_f32_16x16x32_bf16 v[168:171], v[252:255], v[172:175], v[168:171]
    s_mov_b32 s56, 1
interleave_layers__linear_attn_block__memory_aug_recurrent_mem_tr__prompt_kernel_k1_seg:
    s_cmp_eq_u32 s51, 1
    s_cbranch_scc1 interleave_layers__linear_attn_block__memory_aug_recurrent_mem_tr__prompt_kernel_k13
    s_and_b32 s24, s48, 3
    s_lshl_b32 s24, s24, 7
    s_add_u32 s24, s24, 23107584
    v_lshlrev_b32 v15, 2, v1
    v_add_u32 v15, s24, v15
    s_lshr_b32 s95, s48, 2
    s_add_u32 s95, s95, 1
    s_mov_b32 s61, 0
interleave_layers__linear_attn_block__memory_aug_recurrent_mem_tr__prompt_kernel_k1_wx:
    buffer_load_dword v14, v15, s[8:11], 0 offen sc1
    s_waitcnt vmcnt(0)
    v_cmp_le_i32 vcc, s95, v14
    s_mov_b32 s25, 0xfffff
    s_and_b32 s24, vcc_lo, s25
    s_cmp_eq_u32 s24, s25
    s_cbranch_scc1 interleave_layers__linear_attn_block__memory_aug_recurrent_mem_tr__prompt_kernel_k1_wx_ok
    s_add_u32 s61, s61, 1
    s_cmp_ge_u32 s61, s60
    s_cbranch_scc1 interleave_layers__linear_attn_block__memory_aug_recurrent_mem_tr__prompt_kernel_k1_wx_to
    s_sleep 4
    s_branch interleave_layers__linear_attn_block__memory_aug_recurrent_mem_tr__prompt_kernel_k1_wx
interleave_layers__linear_attn_block__memory_aug_recurrent_mem_tr__prompt_kernel_k1_wx_to:
    s_mov_b32 s60, 1
interleave_layers__linear_attn_block__memory_aug_recurrent_mem_tr__prompt_kernel_k1_wx_ok:
    s_mov_b32 s41, s43
    s_mov_b32 s24, s41
    buffer_load_dwordx4 v[16:19], v4, s[16:19], s24 offen sc1
    s_add_u32 s24, s24, s46
    buffer_load_dwordx4 v[20:23], v4, s[16:19], s24 offen sc1
    s_add_u32 s24, s24, s46
    buffer_load_dwordx4 v[24:27], v4, s[16:19], s24 offen sc1
    s_add_u32 s24, s24, s46
    buffer_load_dwordx4 v[28:31], v4, s[16:19], s24 offen sc1
    s_add_u32 s24, s24, s46
    buffer_load_dwordx4 v[32:35], v4, s[16:19], s24 offen sc1
    s_add_u32 s24, s24, s46
    buffer_load_dwordx4 v[36:39], v4, s[16:19], s24 offen sc1
    s_add_u32 s24, s24, s46
    buffer_load_dwordx4 v[40:43], v4, s[16:19], s24 offen sc1
    s_add_u32 s24, s24, s46
    buffer_load_dwordx4 v[44:47], v4, s[16:19], s24 offen sc1
    s_add_u32 s24, s24, s46
    buffer_load_dwordx4 v[48:51], v4, s[16:19], s24 offen sc1
    s_add_u32 s24, s24, s46
    buffer_load_dwordx4 v[52:55], v4, s[16:19], s24 offen sc1
    s_mul_i32 s24, s49, 1
    s_add_u32 s24, s24, s48
    s_and_b32 s24, s24, 3
    s_lshl_b32 s24, s24, 7
    s_add_u32 s24, s24, 23107584
    v_lshlrev_b32 v15, 2, v1
    v_add_u32 v15, s24, v15
    buffer_load_dword v13, v15, s[8:11], 0 offen sc1
interleave_layers__linear_attn_block__memory_aug_recurrent_mem_tr__prompt_kernel_k13:
    s_cmp_eq_u32 s92, 0
    s_cselect_b32 s24, s56, 0
    s_cmp_eq_u32 s24, 1
    s_cbranch_scc1 interleave_layers__linear_attn_block__memory_aug_recurrent_mem_tr__prompt_kernel_k1w4
    s_waitcnt vmcnt(0)
interleave_layers__linear_attn_block__memory_aug_recurrent_mem_tr__prompt_kernel_k1w4:
    s_mov_b32 s56, 0
    v_mov_b32 v148, 0
    v_mov_b32 v149, 0
    v_mov_b32 v150, 0
    v_mov_b32 v151, 0
    v_dot2c_f32_bf16 v148, v16, v172
    v_dot2c_f32_bf16 v149, v16, v16
    v_dot2c_f32_bf16 v150, v17, v172
    v_dot2c_f32_bf16 v151, v17, v17
    v_dot2c_f32_bf16 v148, v18, v172
    v_dot2c_f32_bf16 v149, v18, v18
    v_dot2c_f32_bf16 v150, v19, v172
    v_dot2c_f32_bf16 v151, v19, v19
    v_dot2c_f32_bf16 v148, v20, v172
    v_dot2c_f32_bf16 v149, v20, v20
    v_dot2c_f32_bf16 v150, v21, v172
    v_dot2c_f32_bf16 v151, v21, v21
    v_dot2c_f32_bf16 v148, v22, v172
    v_dot2c_f32_bf16 v149, v22, v22
    v_dot2c_f32_bf16 v150, v23, v172
    v_dot2c_f32_bf16 v151, v23, v23
    v_dot2c_f32_bf16 v148, v24, v172
    v_dot2c_f32_bf16 v149, v24, v24
    v_dot2c_f32_bf16 v150, v25, v172
    v_dot2c_f32_bf16 v151, v25, v25
    v_dot2c_f32_bf16 v148, v26, v172
    v_dot2c_f32_bf16 v149, v26, v26
    v_dot2c_f32_bf16 v150, v27, v172
    v_dot2c_f32_bf16 v151, v27, v27
    v_dot2c_f32_bf16 v148, v28, v172
    v_dot2c_f32_bf16 v149, v28, v28
    v_dot2c_f32_bf16 v150, v29, v172
    v_dot2c_f32_bf16 v151, v29, v29
    v_dot2c_f32_bf16 v148, v30, v172
    v_dot2c_f32_bf16 v149, v30, v30
    v_dot2c_f32_bf16 v150, v31, v172
    v_dot2c_f32_bf16 v151, v31, v31
    v_dot2c_f32_bf16 v148, v32, v172
    v_dot2c_f32_bf16 v149, v32, v32
    v_dot2c_f32_bf16 v150, v33, v172
    v_dot2c_f32_bf16 v151, v33, v33
    v_dot2c_f32_bf16 v148, v34, v172
    v_dot2c_f32_bf16 v149, v34, v34
    v_dot2c_f32_bf16 v150, v35, v172
    v_dot2c_f32_bf16 v151, v35, v35
    v_dot2c_f32_bf16 v148, v36, v172
    v_dot2c_f32_bf16 v149, v36, v36
    v_dot2c_f32_bf16 v150, v37, v172
    v_dot2c_f32_bf16 v151, v37, v37
    v_dot2c_f32_bf16 v148, v38, v172
    v_dot2c_f32_bf16 v149, v38, v38
    v_dot2c_f32_bf16 v150, v39, v172
    v_dot2c_f32_bf16 v151, v39, v39
    v_dot2c_f32_bf16 v148, v40, v172
    v_dot2c_f32_bf16 v149, v40, v40
    v_dot2c_f32_bf16 v150, v41, v172
    v_dot2c_f32_bf16 v151, v41, v41
    v_dot2c_f32_bf16 v148, v42, v172
    v_dot2c_f32_bf16 v149, v42, v42
    v_dot2c_f32_bf16 v150, v43, v172
    v_dot2c_f32_bf16 v151, v43, v43
    v_dot2c_f32_bf16 v148, v44, v172
    v_dot2c_f32_bf16 v149, v44, v44
    v_dot2c_f32_bf16 v150, v45, v172
    v_dot2c_f32_bf16 v151, v45, v45
    v_dot2c_f32_bf16 v148, v46, v172
    v_dot2c_f32_bf16 v149, v46, v46
    v_dot2c_f32_bf16 v150, v47, v172
    v_dot2c_f32_bf16 v151, v47, v47
    v_dot2c_f32_bf16 v148, v48, v172
    v_dot2c_f32_bf16 v149, v48, v48
    v_dot2c_f32_bf16 v150, v49, v172
    v_dot2c_f32_bf16 v151, v49, v49
    v_dot2c_f32_bf16 v148, v50, v172
    v_dot2c_f32_bf16 v149, v50, v50
    v_dot2c_f32_bf16 v150, v51, v172
    v_dot2c_f32_bf16 v151, v51, v51
    v_dot2c_f32_bf16 v148, v52, v172
    v_dot2c_f32_bf16 v149, v52, v52
    v_dot2c_f32_bf16 v150, v53, v172
    v_dot2c_f32_bf16 v151, v53, v53
    v_dot2c_f32_bf16 v148, v54, v172
    v_dot2c_f32_bf16 v149, v54, v54
    v_dot2c_f32_bf16 v150, v55, v172
    v_dot2c_f32_bf16 v151, v55, v55
    s_nop 1
    v_add_f32 v148, v148, v150
    v_add_f32 v149, v149, v151
    v_mov_b32 v150, v148
    v_mov_b32 v151, v149
    s_nop 0
    v_permlane16_swap_b32 v148, v150
    v_permlane16_swap_b32 v149, v151
    v_add_f32 v148, v148, v150
    v_add_f32 v149, v149, v151
    v_mov_b32 v150, v148
    v_mov_b32 v151, v149
    s_nop 0
    v_permlane32_swap_b32 v148, v150
    v_permlane32_swap_b32 v149, v151
    v_add_f32 v148, v148, v150
    v_add_f32 v149, v149, v151
    ds_write_b128 v6, v[16:19] offset:0
    ds_write_b128 v6, v[20:23] offset:1024
    ds_write_b128 v6, v[24:27] offset:2048
    ds_write_b128 v6, v[28:31] offset:3072
    ds_write_b128 v6, v[32:35] offset:4096
    ds_write_b128 v6, v[36:39] offset:5120
    ds_write_b128 v6, v[40:43] offset:6144
    ds_write_b128 v6, v[44:47] offset:7168
    ds_write_b128 v6, v[48:51] offset:8192
    ds_write_b128 v6, v[52:55] offset:9216
    ds_write_b64 v8, v[148:149]
    s_mov_b32 s51, 0
    s_waitcnt lgkmcnt(0)
    s_cmp_gt_u32 s40, 1
    s_cbranch_scc0 interleave_layers__linear_attn_block__memory_aug_recurrent_mem_tr__prompt_kernel_k15
    s_cmp_eq_u32 s92, 0
    s_cbranch_scc1 interleave_layers__linear_attn_block__memory_aug_recurrent_mem_tr__prompt_kernel_k16
    s_add_u32 s24, s48, s49
    s_lshr_b32 s24, s24, 2
    s_add_u32 s24, s24, 1
    v_cmp_le_i32 vcc, s24, v13
    s_and_b32 s24, vcc_lo, 0xfffff
    s_cmp_eq_u32 s24, 0xfffff
    s_cbranch_scc0 interleave_layers__linear_attn_block__memory_aug_recurrent_mem_tr__prompt_kernel_k15
    s_add_u32 s41, s43, s42
    s_mov_b32 s24, s41
    buffer_load_dwordx4 v[16:19], v4, s[16:19], s24 offen sc1
    s_add_u32 s24, s24, s46
    buffer_load_dwordx4 v[20:23], v4, s[16:19], s24 offen sc1
    s_add_u32 s24, s24, s46
    buffer_load_dwordx4 v[24:27], v4, s[16:19], s24 offen sc1
    s_add_u32 s24, s24, s46
    buffer_load_dwordx4 v[28:31], v4, s[16:19], s24 offen sc1
    s_add_u32 s24, s24, s46
    buffer_load_dwordx4 v[32:35], v4, s[16:19], s24 offen sc1
    s_add_u32 s24, s24, s46
    buffer_load_dwordx4 v[36:39], v4, s[16:19], s24 offen sc1
    s_add_u32 s24, s24, s46
    buffer_load_dwordx4 v[40:43], v4, s[16:19], s24 offen sc1
    s_add_u32 s24, s24, s46
    buffer_load_dwordx4 v[44:47], v4, s[16:19], s24 offen sc1
    s_add_u32 s24, s24, s46
    buffer_load_dwordx4 v[48:51], v4, s[16:19], s24 offen sc1
    s_add_u32 s24, s24, s46
    buffer_load_dwordx4 v[52:55], v4, s[16:19], s24 offen sc1
    s_mov_b32 s51, 1
    s_mul_i32 s24, s49, 2
    s_add_u32 s24, s24, s48
    s_and_b32 s24, s24, 3
    s_lshl_b32 s24, s24, 7
    s_add_u32 s24, s24, 23107584
    v_lshlrev_b32 v15, 2, v1
    v_add_u32 v15, s24, v15
    buffer_load_dword v13, v15, s[8:11], 0 offen sc1
    s_branch interleave_layers__linear_attn_block__memory_aug_recurrent_mem_tr__prompt_kernel_k15
interleave_layers__linear_attn_block__memory_aug_recurrent_mem_tr__prompt_kernel_k16:
    s_add_u32 s41, s43, s42
    s_mov_b32 s24, s41
    buffer_load_dwordx2 v[16:17], v4, s[16:19], s24 offen
    buffer_load_dwordx2 v[18:19], v5, s[16:19], s24 offen
    s_add_u32 s24, s24, s46
    buffer_load_dwordx2 v[20:21], v4, s[16:19], s24 offen
    buffer_load_dwordx2 v[22:23], v5, s[16:19], s24 offen
    s_add_u32 s24, s24, s46
    buffer_load_dwordx2 v[24:25], v4, s[16:19], s24 offen
    buffer_load_dwordx2 v[26:27], v5, s[16:19], s24 offen
    s_add_u32 s24, s24, s46
    buffer_load_dwordx2 v[28:29], v4, s[16:19], s24 offen
    buffer_load_dwordx2 v[30:31], v5, s[16:19], s24 offen
    s_add_u32 s24, s24, s46
    buffer_load_dwordx2 v[32:33], v4, s[16:19], s24 offen
    buffer_load_dwordx2 v[34:35], v5, s[16:19], s24 offen
    s_add_u32 s24, s24, s46
    buffer_load_dwordx2 v[36:37], v4, s[16:19], s24 offen
    buffer_load_dwordx2 v[38:39], v5, s[16:19], s24 offen
    s_add_u32 s24, s24, s46
    buffer_load_dwordx2 v[40:41], v4, s[16:19], s24 offen
    buffer_load_dwordx2 v[42:43], v5, s[16:19], s24 offen
    s_add_u32 s24, s24, s46
    buffer_load_dwordx2 v[44:45], v4, s[16:19], s24 offen
    buffer_load_dwordx2 v[46:47], v5, s[16:19], s24 offen
    s_add_u32 s24, s24, s46
    buffer_load_dwordx2 v[48:49], v4, s[16:19], s24 offen
    buffer_load_dwordx2 v[50:51], v5, s[16:19], s24 offen
    s_add_u32 s24, s24, s46
    buffer_load_dwordx2 v[52:53], v4, s[16:19], s24 offen
    buffer_load_dwordx2 v[54:55], v5, s[16:19], s24 offen
    s_mov_b32 s51, 1
interleave_layers__linear_attn_block__memory_aug_recurrent_mem_tr__prompt_kernel_k15:
    s_barrier
    ds_read_b128 v[148:151], v9
    ds_read_b128 v[152:155], v9 offset:256
    ds_read_b128 v[56:59], v7 offset:0
    ds_read_b128 v[60:63], v7 offset:20480
    ds_read_b128 v[64:67], v7 offset:1024
    ds_read_b128 v[68:71], v7 offset:21504
    ds_read_b128 v[72:75], v7 offset:2048
    ds_read_b128 v[76:79], v7 offset:22528
    s_waitcnt lgkmcnt(6)
    v_add_f32 v148, v148, v150
    v_add_f32 v149, v149, v151
    v_mul_f32 v148, 0x3acccccd, v148
    v_mul_f32 v150, v148, v148
    v_mov_b32 v151, 0x3acccccd
    v_fma_f32 v149, v149, v151, -v150
    v_max_f32 v149, 0, v149
    v_add_f32 v149, 0x3727c5ac, v149
    v_rsq_f32 v144, v149
    s_nop 0
    v_mul_f32 v145, v148, v144
    v_sub_f32 v145, 0, v145
    v_add_f32 v152, v152, v154
    v_add_f32 v153, v153, v155
    v_mul_f32 v152, 0x3acccccd, v152
    v_mul_f32 v154, v152, v152
    v_mov_b32 v155, 0x3acccccd
    v_fma_f32 v153, v153, v155, -v154
    v_max_f32 v153, 0, v153
    v_add_f32 v153, 0x3727c5ac, v153
    v_rsq_f32 v146, v153
    s_nop 0
    v_mul_f32 v147, v152, v146
    v_sub_f32 v147, 0, v147
    ds_read_b128 v[80:83], v7 offset:3072
    ds_read_b128 v[84:87], v7 offset:23552
    s_waitcnt lgkmcnt(6)
    v_mfma_f32_16x16x32_bf16 v[88:91], a[0:3], v[56:59], 0
    v_mfma_f32_16x16x32_bf16 v[96:99], a[80:83], v[56:59], 0
    v_mfma_f32_16x16x32_bf16 v[104:107], a[160:163], v[56:59], 0
    v_mfma_f32_16x16x32_bf16 v[112:115], v[176:179], v[56:59], 0
    v_mfma_f32_16x16x32_bf16 v[92:95], a[0:3], v[60:63], 0
    v_mfma_f32_16x16x32_bf16 v[100:103], a[80:83], v[60:63], 0
    v_mfma_f32_16x16x32_bf16 v[108:111], a[160:163], v[60:63], 0
    v_mfma_f32_16x16x32_bf16 v[116:119], v[176:179], v[60:63], 0
    ds_read_b128 v[56:59], v7 offset:4096
    ds_read_b128 v[60:63], v7 offset:24576
    s_waitcnt lgkmcnt(6)
    v_mfma_f32_16x16x32_bf16 v[88:91], a[4:7], v[64:67], v[88:91]
    v_mfma_f32_16x16x32_bf16 v[96:99], a[84:87], v[64:67], v[96:99]
    v_mfma_f32_16x16x32_bf16 v[104:107], a[164:167], v[64:67], v[104:107]
    v_mfma_f32_16x16x32_bf16 v[112:115], v[180:183], v[64:67], v[112:115]
    v_mfma_f32_16x16x32_bf16 v[92:95], a[4:7], v[68:71], v[92:95]
    v_mfma_f32_16x16x32_bf16 v[100:103], a[84:87], v[68:71], v[100:103]
    v_mfma_f32_16x16x32_bf16 v[108:111], a[164:167], v[68:71], v[108:111]
    v_mfma_f32_16x16x32_bf16 v[116:119], v[180:183], v[68:71], v[116:119]
    ds_read_b128 v[64:67], v7 offset:5120
    ds_read_b128 v[68:71], v7 offset:25600
    s_waitcnt lgkmcnt(6)
    v_mfma_f32_16x16x32_bf16 v[88:91], a[8:11], v[72:75], v[88:91]
    v_mfma_f32_16x16x32_bf16 v[96:99], a[88:91], v[72:75], v[96:99]
    v_mfma_f32_16x16x32_bf16 v[104:107], a[168:171], v[72:75], v[104:107]
    v_mfma_f32_16x16x32_bf16 v[112:115], v[184:187], v[72:75], v[112:115]
    v_mfma_f32_16x16x32_bf16 v[92:95], a[8:11], v[76:79], v[92:95]
    v_mfma_f32_16x16x32_bf16 v[100:103], a[88:91], v[76:79], v[100:103]
    v_mfma_f32_16x16x32_bf16 v[108:111], a[168:171], v[76:79], v[108:111]
    v_mfma_f32_16x16x32_bf16 v[116:119], v[184:187], v[76:79], v[116:119]
    ds_read_b128 v[72:75], v7 offset:6144
    ds_read_b128 v[76:79], v7 offset:26624
    s_waitcnt lgkmcnt(6)
    v_mfma_f32_16x16x32_bf16 v[88:91], a[12:15], v[80:83], v[88:91]
    v_mfma_f32_16x16x32_bf16 v[96:99], a[92:95], v[80:83], v[96:99]
    v_mfma_f32_16x16x32_bf16 v[104:107], a[172:175], v[80:83], v[104:107]
    v_mfma_f32_16x16x32_bf16 v[112:115], v[188:191], v[80:83], v[112:115]
    v_mfma_f32_16x16x32_bf16 v[92:95], a[12:15], v[84:87], v[92:95]
    v_mfma_f32_16x16x32_bf16 v[100:103], a[92:95], v[84:87], v[100:103]
    v_mfma_f32_16x16x32_bf16 v[108:111], a[172:175], v[84:87], v[108:111]
    v_mfma_f32_16x16x32_bf16 v[116:119], v[188:191], v[84:87], v[116:119]
    ds_read_b128 v[80:83], v7 offset:7168
    ds_read_b128 v[84:87], v7 offset:27648
    s_waitcnt lgkmcnt(6)
    v_mfma_f32_16x16x32_bf16 v[88:91], a[16:19], v[56:59], v[88:91]
    v_mfma_f32_16x16x32_bf16 v[96:99], a[96:99], v[56:59], v[96:99]
    v_mfma_f32_16x16x32_bf16 v[104:107], a[176:179], v[56:59], v[104:107]
    v_mfma_f32_16x16x32_bf16 v[112:115], v[192:195], v[56:59], v[112:115]
    v_mfma_f32_16x16x32_bf16 v[92:95], a[16:19], v[60:63], v[92:95]
    v_mfma_f32_16x16x32_bf16 v[100:103], a[96:99], v[60:63], v[100:103]
    v_mfma_f32_16x16x32_bf16 v[108:111], a[176:179], v[60:63], v[108:111]
    v_mfma_f32_16x16x32_bf16 v[116:119], v[192:195], v[60:63], v[116:119]
    ds_read_b128 v[56:59], v7 offset:8192
    ds_read_b128 v[60:63], v7 offset:28672
    s_waitcnt lgkmcnt(6)
    v_mfma_f32_16x16x32_bf16 v[88:91], a[20:23], v[64:67], v[88:91]
    v_mfma_f32_16x16x32_bf16 v[96:99], a[100:103], v[64:67], v[96:99]
    v_mfma_f32_16x16x32_bf16 v[104:107], a[180:183], v[64:67], v[104:107]
    v_mfma_f32_16x16x32_bf16 v[112:115], v[196:199], v[64:67], v[112:115]
    v_mfma_f32_16x16x32_bf16 v[92:95], a[20:23], v[68:71], v[92:95]
    v_mfma_f32_16x16x32_bf16 v[100:103], a[100:103], v[68:71], v[100:103]
    v_mfma_f32_16x16x32_bf16 v[108:111], a[180:183], v[68:71], v[108:111]
    v_mfma_f32_16x16x32_bf16 v[116:119], v[196:199], v[68:71], v[116:119]
    ds_read_b128 v[64:67], v7 offset:9216
    ds_read_b128 v[68:71], v7 offset:29696
    s_waitcnt lgkmcnt(6)
    v_mfma_f32_16x16x32_bf16 v[88:91], a[24:27], v[72:75], v[88:91]
    v_mfma_f32_16x16x32_bf16 v[96:99], a[104:107], v[72:75], v[96:99]
    v_mfma_f32_16x16x32_bf16 v[104:107], a[184:187], v[72:75], v[104:107]
    v_mfma_f32_16x16x32_bf16 v[112:115], v[200:203], v[72:75], v[112:115]
    v_mfma_f32_16x16x32_bf16 v[92:95], a[24:27], v[76:79], v[92:95]
    v_mfma_f32_16x16x32_bf16 v[100:103], a[104:107], v[76:79], v[100:103]
    v_mfma_f32_16x16x32_bf16 v[108:111], a[184:187], v[76:79], v[108:111]
    v_mfma_f32_16x16x32_bf16 v[116:119], v[200:203], v[76:79], v[116:119]
    ds_read_b128 v[72:75], v7 offset:10240
    ds_read_b128 v[76:79], v7 offset:30720
    s_waitcnt lgkmcnt(6)
    v_mfma_f32_16x16x32_bf16 v[88:91], a[28:31], v[80:83], v[88:91]
    v_mfma_f32_16x16x32_bf16 v[96:99], a[108:111], v[80:83], v[96:99]
    v_mfma_f32_16x16x32_bf16 v[104:107], a[188:191], v[80:83], v[104:107]
    v_mfma_f32_16x16x32_bf16 v[112:115], v[204:207], v[80:83], v[112:115]
    v_mfma_f32_16x16x32_bf16 v[92:95], a[28:31], v[84:87], v[92:95]
    v_mfma_f32_16x16x32_bf16 v[100:103], a[108:111], v[84:87], v[100:103]
    v_mfma_f32_16x16x32_bf16 v[108:111], a[188:191], v[84:87], v[108:111]
    v_mfma_f32_16x16x32_bf16 v[116:119], v[204:207], v[84:87], v[116:119]
    ds_read_b128 v[80:83], v7 offset:11264
    ds_read_b128 v[84:87], v7 offset:31744
    s_waitcnt lgkmcnt(6)
    v_mfma_f32_16x16x32_bf16 v[88:91], a[32:35], v[56:59], v[88:91]
    v_mfma_f32_16x16x32_bf16 v[96:99], a[112:115], v[56:59], v[96:99]
    v_mfma_f32_16x16x32_bf16 v[104:107], a[192:195], v[56:59], v[104:107]
    v_mfma_f32_16x16x32_bf16 v[112:115], v[208:211], v[56:59], v[112:115]
    v_mfma_f32_16x16x32_bf16 v[92:95], a[32:35], v[60:63], v[92:95]
    v_mfma_f32_16x16x32_bf16 v[100:103], a[112:115], v[60:63], v[100:103]
    v_mfma_f32_16x16x32_bf16 v[108:111], a[192:195], v[60:63], v[108:111]
    v_mfma_f32_16x16x32_bf16 v[116:119], v[208:211], v[60:63], v[116:119]
    ds_read_b128 v[56:59], v7 offset:12288
    ds_read_b128 v[60:63], v7 offset:32768
    s_waitcnt lgkmcnt(6)
    v_mfma_f32_16x16x32_bf16 v[88:91], a[36:39], v[64:67], v[88:91]
    v_mfma_f32_16x16x32_bf16 v[96:99], a[116:119], v[64:67], v[96:99]
    v_mfma_f32_16x16x32_bf16 v[104:107], a[196:199], v[64:67], v[104:107]
    v_mfma_f32_16x16x32_bf16 v[112:115], v[212:215], v[64:67], v[112:115]
    v_mfma_f32_16x16x32_bf16 v[92:95], a[36:39], v[68:71], v[92:95]
    v_mfma_f32_16x16x32_bf16 v[100:103], a[116:119], v[68:71], v[100:103]
    v_mfma_f32_16x16x32_bf16 v[108:111], a[196:199], v[68:71], v[108:111]
    v_mfma_f32_16x16x32_bf16 v[116:119], v[212:215], v[68:71], v[116:119]
    ds_read_b128 v[64:67], v7 offset:13312
    ds_read_b128 v[68:71], v7 offset:33792
    s_waitcnt lgkmcnt(6)
    v_mfma_f32_16x16x32_bf16 v[88:91], a[40:43], v[72:75], v[88:91]
    v_mfma_f32_16x16x32_bf16 v[96:99], a[120:123], v[72:75], v[96:99]
    v_mfma_f32_16x16x32_bf16 v[104:107], a[200:203], v[72:75], v[104:107]
    v_mfma_f32_16x16x32_bf16 v[112:115], v[216:219], v[72:75], v[112:115]
    v_mfma_f32_16x16x32_bf16 v[92:95], a[40:43], v[76:79], v[92:95]
    v_mfma_f32_16x16x32_bf16 v[100:103], a[120:123], v[76:79], v[100:103]
    v_mfma_f32_16x16x32_bf16 v[108:111], a[200:203], v[76:79], v[108:111]
    v_mfma_f32_16x16x32_bf16 v[116:119], v[216:219], v[76:79], v[116:119]
    ds_read_b128 v[72:75], v7 offset:14336
    ds_read_b128 v[76:79], v7 offset:34816
    s_waitcnt lgkmcnt(6)
    v_mfma_f32_16x16x32_bf16 v[88:91], a[44:47], v[80:83], v[88:91]
    v_mfma_f32_16x16x32_bf16 v[96:99], a[124:127], v[80:83], v[96:99]
    v_mfma_f32_16x16x32_bf16 v[104:107], a[204:207], v[80:83], v[104:107]
    v_mfma_f32_16x16x32_bf16 v[112:115], v[220:223], v[80:83], v[112:115]
    v_mfma_f32_16x16x32_bf16 v[92:95], a[44:47], v[84:87], v[92:95]
    v_mfma_f32_16x16x32_bf16 v[100:103], a[124:127], v[84:87], v[100:103]
    v_mfma_f32_16x16x32_bf16 v[108:111], a[204:207], v[84:87], v[108:111]
    v_mfma_f32_16x16x32_bf16 v[116:119], v[220:223], v[84:87], v[116:119]
    ds_read_b128 v[80:83], v7 offset:15360
    ds_read_b128 v[84:87], v7 offset:35840
    s_waitcnt lgkmcnt(6)
    v_mfma_f32_16x16x32_bf16 v[88:91], a[48:51], v[56:59], v[88:91]
    v_mfma_f32_16x16x32_bf16 v[96:99], a[128:131], v[56:59], v[96:99]
    v_mfma_f32_16x16x32_bf16 v[104:107], a[208:211], v[56:59], v[104:107]
    v_mfma_f32_16x16x32_bf16 v[112:115], v[224:227], v[56:59], v[112:115]
    v_mfma_f32_16x16x32_bf16 v[92:95], a[48:51], v[60:63], v[92:95]
    v_mfma_f32_16x16x32_bf16 v[100:103], a[128:131], v[60:63], v[100:103]
    v_mfma_f32_16x16x32_bf16 v[108:111], a[208:211], v[60:63], v[108:111]
    v_mfma_f32_16x16x32_bf16 v[116:119], v[224:227], v[60:63], v[116:119]
    ds_read_b128 v[56:59], v7 offset:16384
    ds_read_b128 v[60:63], v7 offset:36864
    s_waitcnt lgkmcnt(6)
    v_mfma_f32_16x16x32_bf16 v[88:91], a[52:55], v[64:67], v[88:91]
    v_mfma_f32_16x16x32_bf16 v[96:99], a[132:135], v[64:67], v[96:99]
    v_mfma_f32_16x16x32_bf16 v[104:107], a[212:215], v[64:67], v[104:107]
    v_mfma_f32_16x16x32_bf16 v[112:115], v[228:231], v[64:67], v[112:115]
    v_mfma_f32_16x16x32_bf16 v[92:95], a[52:55], v[68:71], v[92:95]
    v_mfma_f32_16x16x32_bf16 v[100:103], a[132:135], v[68:71], v[100:103]
    v_mfma_f32_16x16x32_bf16 v[108:111], a[212:215], v[68:71], v[108:111]
    v_mfma_f32_16x16x32_bf16 v[116:119], v[228:231], v[68:71], v[116:119]
    ds_read_b128 v[64:67], v7 offset:17408
    ds_read_b128 v[68:71], v7 offset:37888
    s_waitcnt lgkmcnt(6)
    v_mfma_f32_16x16x32_bf16 v[88:91], a[56:59], v[72:75], v[88:91]
    v_mfma_f32_16x16x32_bf16 v[96:99], a[136:139], v[72:75], v[96:99]
    v_mfma_f32_16x16x32_bf16 v[104:107], a[216:219], v[72:75], v[104:107]
    v_mfma_f32_16x16x32_bf16 v[112:115], v[232:235], v[72:75], v[112:115]
    v_mfma_f32_16x16x32_bf16 v[92:95], a[56:59], v[76:79], v[92:95]
    v_mfma_f32_16x16x32_bf16 v[100:103], a[136:139], v[76:79], v[100:103]
    v_mfma_f32_16x16x32_bf16 v[108:111], a[216:219], v[76:79], v[108:111]
    v_mfma_f32_16x16x32_bf16 v[116:119], v[232:235], v[76:79], v[116:119]
    ds_read_b128 v[72:75], v7 offset:18432
    ds_read_b128 v[76:79], v7 offset:38912
    s_waitcnt lgkmcnt(6)
    v_mfma_f32_16x16x32_bf16 v[88:91], a[60:63], v[80:83], v[88:91]
    v_mfma_f32_16x16x32_bf16 v[96:99], a[140:143], v[80:83], v[96:99]
    v_mfma_f32_16x16x32_bf16 v[104:107], a[220:223], v[80:83], v[104:107]
    v_mfma_f32_16x16x32_bf16 v[112:115], v[236:239], v[80:83], v[112:115]
    v_mfma_f32_16x16x32_bf16 v[92:95], a[60:63], v[84:87], v[92:95]
    v_mfma_f32_16x16x32_bf16 v[100:103], a[140:143], v[84:87], v[100:103]
    v_mfma_f32_16x16x32_bf16 v[108:111], a[220:223], v[84:87], v[108:111]
    v_mfma_f32_16x16x32_bf16 v[116:119], v[236:239], v[84:87], v[116:119]
    ds_read_b128 v[80:83], v7 offset:19456
    ds_read_b128 v[84:87], v7 offset:39936
    s_waitcnt lgkmcnt(6)
    v_mfma_f32_16x16x32_bf16 v[88:91], a[64:67], v[56:59], v[88:91]
    v_mfma_f32_16x16x32_bf16 v[96:99], a[144:147], v[56:59], v[96:99]
    v_mfma_f32_16x16x32_bf16 v[104:107], a[224:227], v[56:59], v[104:107]
    v_mfma_f32_16x16x32_bf16 v[112:115], v[240:243], v[56:59], v[112:115]
    v_mfma_f32_16x16x32_bf16 v[92:95], a[64:67], v[60:63], v[92:95]
    v_mfma_f32_16x16x32_bf16 v[100:103], a[144:147], v[60:63], v[100:103]
    v_mfma_f32_16x16x32_bf16 v[108:111], a[224:227], v[60:63], v[108:111]
    v_mfma_f32_16x16x32_bf16 v[116:119], v[240:243], v[60:63], v[116:119]
    s_waitcnt lgkmcnt(4)
    v_mfma_f32_16x16x32_bf16 v[88:91], a[68:71], v[64:67], v[88:91]
    v_mfma_f32_16x16x32_bf16 v[96:99], a[148:151], v[64:67], v[96:99]
    v_mfma_f32_16x16x32_bf16 v[104:107], a[228:231], v[64:67], v[104:107]
    v_mfma_f32_16x16x32_bf16 v[112:115], v[244:247], v[64:67], v[112:115]
    v_mfma_f32_16x16x32_bf16 v[92:95], a[68:71], v[68:71], v[92:95]
    v_mfma_f32_16x16x32_bf16 v[100:103], a[148:151], v[68:71], v[100:103]
    v_mfma_f32_16x16x32_bf16 v[108:111], a[228:231], v[68:71], v[108:111]
    v_mfma_f32_16x16x32_bf16 v[116:119], v[244:247], v[68:71], v[116:119]
    s_waitcnt lgkmcnt(2)
    v_mfma_f32_16x16x32_bf16 v[88:91], a[72:75], v[72:75], v[88:91]
    v_mfma_f32_16x16x32_bf16 v[96:99], a[152:155], v[72:75], v[96:99]
    v_mfma_f32_16x16x32_bf16 v[104:107], a[232:235], v[72:75], v[104:107]
    v_mfma_f32_16x16x32_bf16 v[112:115], v[248:251], v[72:75], v[112:115]
    v_mfma_f32_16x16x32_bf16 v[92:95], a[72:75], v[76:79], v[92:95]
    v_mfma_f32_16x16x32_bf16 v[100:103], a[152:155], v[76:79], v[100:103]
    v_mfma_f32_16x16x32_bf16 v[108:111], a[232:235], v[76:79], v[108:111]
    v_mfma_f32_16x16x32_bf16 v[116:119], v[248:251], v[76:79], v[116:119]
    s_waitcnt lgkmcnt(0)
    v_mfma_f32_16x16x32_bf16 v[88:91], a[76:79], v[80:83], v[88:91]
    v_mfma_f32_16x16x32_bf16 v[96:99], a[156:159], v[80:83], v[96:99]
    v_mfma_f32_16x16x32_bf16 v[104:107], a[236:239], v[80:83], v[104:107]
    v_mfma_f32_16x16x32_bf16 v[112:115], v[252:255], v[80:83], v[112:115]
    v_mfma_f32_16x16x32_bf16 v[92:95], a[76:79], v[84:87], v[92:95]
    v_mfma_f32_16x16x32_bf16 v[100:103], a[156:159], v[84:87], v[100:103]
    v_mfma_f32_16x16x32_bf16 v[108:111], a[236:239], v[84:87], v[108:111]
    v_mfma_f32_16x16x32_bf16 v[116:119], v[252:255], v[84:87], v[116:119]
    v_pk_mul_f32 v[148:149], v[156:157], v[144:145] op_sel:[0,1] op_sel_hi:[1,1]
    v_pk_mul_f32 v[150:151], v[158:159], v[144:145] op_sel:[0,1] op_sel_hi:[1,1]
    v_pk_fma_f32 v[88:89], v[88:89], v[144:145], v[148:149] op_sel:[0,0,0] op_sel_hi:[1,0,1]
    v_pk_fma_f32 v[90:91], v[90:91], v[144:145], v[150:151] op_sel:[0,0,0] op_sel_hi:[1,0,1]
    v_pk_mul_f32 v[148:149], v[156:157], v[146:147] op_sel:[0,1] op_sel_hi:[1,1]
    v_pk_mul_f32 v[150:151], v[158:159], v[146:147] op_sel:[0,1] op_sel_hi:[1,1]
    v_pk_fma_f32 v[92:93], v[92:93], v[146:147], v[148:149] op_sel:[0,0,0] op_sel_hi:[1,0,1]
    v_pk_fma_f32 v[94:95], v[94:95], v[146:147], v[150:151] op_sel:[0,0,0] op_sel_hi:[1,0,1]
    v_pk_mul_f32 v[148:149], v[160:161], v[144:145] op_sel:[0,1] op_sel_hi:[1,1]
    v_pk_mul_f32 v[150:151], v[162:163], v[144:145] op_sel:[0,1] op_sel_hi:[1,1]
    v_pk_fma_f32 v[96:97], v[96:97], v[144:145], v[148:149] op_sel:[0,0,0] op_sel_hi:[1,0,1]
    v_pk_fma_f32 v[98:99], v[98:99], v[144:145], v[150:151] op_sel:[0,0,0] op_sel_hi:[1,0,1]
    v_pk_mul_f32 v[148:149], v[160:161], v[146:147] op_sel:[0,1] op_sel_hi:[1,1]
    v_pk_mul_f32 v[150:151], v[162:163], v[146:147] op_sel:[0,1] op_sel_hi:[1,1]
    v_pk_fma_f32 v[100:101], v[100:101], v[146:147], v[148:149] op_sel:[0,0,0] op_sel_hi:[1,0,1]
    v_pk_fma_f32 v[102:103], v[102:103], v[146:147], v[150:151] op_sel:[0,0,0] op_sel_hi:[1,0,1]
    v_pk_mul_f32 v[148:149], v[164:165], v[144:145] op_sel:[0,1] op_sel_hi:[1,1]
    v_pk_mul_f32 v[150:151], v[166:167], v[144:145] op_sel:[0,1] op_sel_hi:[1,1]
    v_pk_fma_f32 v[104:105], v[104:105], v[144:145], v[148:149] op_sel:[0,0,0] op_sel_hi:[1,0,1]
    v_pk_fma_f32 v[106:107], v[106:107], v[144:145], v[150:151] op_sel:[0,0,0] op_sel_hi:[1,0,1]
    v_pk_mul_f32 v[148:149], v[164:165], v[146:147] op_sel:[0,1] op_sel_hi:[1,1]
    v_pk_mul_f32 v[150:151], v[166:167], v[146:147] op_sel:[0,1] op_sel_hi:[1,1]
    v_pk_fma_f32 v[108:109], v[108:109], v[146:147], v[148:149] op_sel:[0,0,0] op_sel_hi:[1,0,1]
    v_pk_fma_f32 v[110:111], v[110:111], v[146:147], v[150:151] op_sel:[0,0,0] op_sel_hi:[1,0,1]
    v_pk_mul_f32 v[148:149], v[168:169], v[144:145] op_sel:[0,1] op_sel_hi:[1,1]
    v_pk_mul_f32 v[150:151], v[170:171], v[144:145] op_sel:[0,1] op_sel_hi:[1,1]
    v_pk_fma_f32 v[112:113], v[112:113], v[144:145], v[148:149] op_sel:[0,0,0] op_sel_hi:[1,0,1]
    v_pk_fma_f32 v[114:115], v[114:115], v[144:145], v[150:151] op_sel:[0,0,0] op_sel_hi:[1,0,1]
    v_pk_mul_f32 v[148:149], v[168:169], v[146:147] op_sel:[0,1] op_sel_hi:[1,1]
    v_pk_mul_f32 v[150:151], v[170:171], v[146:147] op_sel:[0,1] op_sel_hi:[1,1]
    v_pk_fma_f32 v[116:117], v[116:117], v[146:147], v[148:149] op_sel:[0,0,0] op_sel_hi:[1,0,1]
    v_pk_fma_f32 v[118:119], v[118:119], v[146:147], v[150:151] op_sel:[0,0,0] op_sel_hi:[1,0,1]
    s_add_u32 s25, s43, 20480
    s_cmp_ge_u32 s3, 2
    s_cbranch_scc1 interleave_layers__linear_attn_block__memory_aug_recurrent_mem_tr__prompt_kernel_k1_e2
    s_lshl_b32 s24, s3, 6
    v_add_u32 v15, s24, v10
    v_cvt_pk_bf16_f32 v64, v104, v105
    v_cvt_pk_bf16_f32 v65, v106, v107
    ds_write_b64 v15, v[64:65] offset:160
    v_cvt_pk_bf16_f32 v66, v108, v109
    v_cvt_pk_bf16_f32 v67, v110, v111
    ds_write_b64 v15, v[66:67] offset:5536
    v_cvt_pk_bf16_f32 v68, v112, v113
    v_cvt_pk_bf16_f32 v69, v114, v115
    ds_write_b64 v15, v[68:69] offset:192
    v_cvt_pk_bf16_f32 v70, v116, v117
    v_cvt_pk_bf16_f32 v71, v118, v119
    ds_write_b64 v15, v[70:71] offset:5568
    v_min_f32 v148, 0, v88
    v_min_f32 v149, 0, v89
    v_pk_mul_f32 v[148:149], v[148:149], s[52:53]
    v_min_f32 v150, 0, v90
    v_min_f32 v151, 0, v91
    v_pk_mul_f32 v[150:151], v[150:151], s[52:53]
    v_exp_f32 v148, v148
    v_exp_f32 v149, v149
    v_exp_f32 v150, v150
    v_exp_f32 v151, v151
    v_max_f32 v88, 0, v88
    v_max_f32 v89, 0, v89
    v_max_f32 v90, 0, v90
    v_max_f32 v91, 0, v91
    v_pk_add_f32 v[88:89], v[88:89], v[148:149]
    v_pk_add_f32 v[90:91], v[90:91], v[150:151]
    v_pk_add_f32 v[88:89], v[88:89], s[54:55]
    v_pk_add_f32 v[90:91], v[90:91], s[54:55]
    v_min_f32 v148, 0, v96
    v_min_f32 v149, 0, v97
    v_pk_mul_f32 v[148:149], v[148:149], s[52:53]
    v_min_f32 v150, 0, v98
    v_min_f32 v151, 0, v99
    v_pk_mul_f32 v[150:151], v[150:151], s[52:53]
    v_exp_f32 v148, v148
    v_exp_f32 v149, v149
    v_exp_f32 v150, v150
    v_exp_f32 v151, v151
    v_max_f32 v96, 0, v96
    v_max_f32 v97, 0, v97
    v_max_f32 v98, 0, v98
    v_max_f32 v99, 0, v99
    v_pk_add_f32 v[96:97], v[96:97], v[148:149]
    v_pk_add_f32 v[98:99], v[98:99], v[150:151]
    v_pk_add_f32 v[96:97], v[96:97], s[54:55]
    v_pk_add_f32 v[98:99], v[98:99], s[54:55]
    v_cvt_pk_bf16_f32 v56, v88, v89
    v_cvt_pk_bf16_f32 v57, v90, v91
    v_cvt_pk_bf16_f32 v58, v96, v97
    v_cvt_pk_bf16_f32 v59, v98, v99
    buffer_store_dwordx4 v[56:59], v12, s[8:11], s43 offen sc1
    v_min_f32 v148, 0, v92
    v_min_f32 v149, 0, v93
    v_pk_mul_f32 v[148:149], v[148:149], s[52:53]
    v_min_f32 v150, 0, v94
    v_min_f32 v151, 0, v95
    v_pk_mul_f32 v[150:151], v[150:151], s[52:53]
    v_exp_f32 v148, v148
    v_exp_f32 v149, v149
    v_exp_f32 v150, v150
    v_exp_f32 v151, v151
    v_max_f32 v92, 0, v92
    v_max_f32 v93, 0, v93
    v_max_f32 v94, 0, v94
    v_max_f32 v95, 0, v95
    v_pk_add_f32 v[92:93], v[92:93], v[148:149]
    v_pk_add_f32 v[94:95], v[94:95], v[150:151]
    v_pk_add_f32 v[92:93], v[92:93], s[54:55]
    v_pk_add_f32 v[94:95], v[94:95], s[54:55]
    v_min_f32 v148, 0, v100
    v_min_f32 v149, 0, v101
    v_pk_mul_f32 v[148:149], v[148:149], s[52:53]
    v_min_f32 v150, 0, v102
    v_min_f32 v151, 0, v103
    v_pk_mul_f32 v[150:151], v[150:151], s[52:53]
    v_exp_f32 v148, v148
    v_exp_f32 v149, v149
    v_exp_f32 v150, v150
    v_exp_f32 v151, v151
    v_max_f32 v100, 0, v100
    v_max_f32 v101, 0, v101
    v_max_f32 v102, 0, v102
    v_max_f32 v103, 0, v103
    v_pk_add_f32 v[100:101], v[100:101], v[148:149]
    v_pk_add_f32 v[102:103], v[102:103], v[150:151]
    v_pk_add_f32 v[100:101], v[100:101], s[54:55]
    v_pk_add_f32 v[102:103], v[102:103], s[54:55]
    v_cvt_pk_bf16_f32 v60, v92, v93
    v_cvt_pk_bf16_f32 v61, v94, v95
    v_cvt_pk_bf16_f32 v62, v100, v101
    v_cvt_pk_bf16_f32 v63, v102, v103
    buffer_store_dwordx4 v[60:63], v12, s[8:11], s25 offen sc1
    s_branch interleave_layers__linear_attn_block__memory_aug_recurrent_mem_tr__prompt_kernel_k1_ej
interleave_layers__linear_attn_block__memory_aug_recurrent_mem_tr__prompt_kernel_k1_e2:
    s_cmp_eq_u32 s3, 3
    s_cbranch_scc1 interleave_layers__linear_attn_block__memory_aug_recurrent_mem_tr__prompt_kernel_k1_e3
    v_cvt_pk_bf16_f32 v68, v112, v113
    v_cvt_pk_bf16_f32 v69, v114, v115
    ds_write_b64 v10, v[68:69] offset:288
    v_cvt_pk_bf16_f32 v70, v116, v117
    v_cvt_pk_bf16_f32 v71, v118, v119
    ds_write_b64 v10, v[70:71] offset:5664
    v_min_f32 v148, 0, v96
    v_min_f32 v149, 0, v97
    v_pk_mul_f32 v[148:149], v[148:149], s[52:53]
    v_min_f32 v150, 0, v98
    v_min_f32 v151, 0, v99
    v_pk_mul_f32 v[150:151], v[150:151], s[52:53]
    v_exp_f32 v148, v148
    v_exp_f32 v149, v149
    v_exp_f32 v150, v150
    v_exp_f32 v151, v151
    v_max_f32 v96, 0, v96
    v_max_f32 v97, 0, v97
    v_max_f32 v98, 0, v98
    v_max_f32 v99, 0, v99
    v_pk_add_f32 v[96:97], v[96:97], v[148:149]
    v_pk_add_f32 v[98:99], v[98:99], v[150:151]
    v_pk_add_f32 v[96:97], v[96:97], s[54:55]
    v_pk_add_f32 v[98:99], v[98:99], s[54:55]
    v_min_f32 v148, 0, v104
    v_min_f32 v149, 0, v105
    v_pk_mul_f32 v[148:149], v[148:149], s[52:53]
    v_min_f32 v150, 0, v106
    v_min_f32 v151, 0, v107
    v_pk_mul_f32 v[150:151], v[150:151], s[52:53]
    v_exp_f32 v148, v148
    v_exp_f32 v149, v149
    v_exp_f32 v150, v150
    v_exp_f32 v151, v151
    v_max_f32 v104, 0, v104
    v_max_f32 v105, 0, v105
    v_max_f32 v106, 0, v106
    v_max_f32 v107, 0, v107
    v_pk_add_f32 v[104:105], v[104:105], v[148:149]
    v_pk_add_f32 v[106:107], v[106:107], v[150:151]
    v_pk_add_f32 v[104:105], v[104:105], s[54:55]
    v_pk_add_f32 v[106:107], v[106:107], s[54:55]
    v_min_f32 v148, 0, v100
    v_min_f32 v149, 0, v101
    v_pk_mul_f32 v[148:149], v[148:149], s[52:53]
    v_min_f32 v150, 0, v102
    v_min_f32 v151, 0, v103
    v_pk_mul_f32 v[150:151], v[150:151], s[52:53]
    v_exp_f32 v148, v148
    v_exp_f32 v149, v149
    v_exp_f32 v150, v150
    v_exp_f32 v151, v151
    v_max_f32 v100, 0, v100
    v_max_f32 v101, 0, v101
    v_max_f32 v102, 0, v102
    v_max_f32 v103, 0, v103
    v_pk_add_f32 v[100:101], v[100:101], v[148:149]
    v_pk_add_f32 v[102:103], v[102:103], v[150:151]
    v_pk_add_f32 v[100:101], v[100:101], s[54:55]
    v_pk_add_f32 v[102:103], v[102:103], s[54:55]
    v_min_f32 v148, 0, v108
    v_min_f32 v149, 0, v109
    v_pk_mul_f32 v[148:149], v[148:149], s[52:53]
    v_min_f32 v150, 0, v110
    v_min_f32 v151, 0, v111
    v_pk_mul_f32 v[150:151], v[150:151], s[52:53]
    v_exp_f32 v148, v148
    v_exp_f32 v149, v149
    v_exp_f32 v150, v150
    v_exp_f32 v151, v151
    v_max_f32 v108, 0, v108
    v_max_f32 v109, 0, v109
    v_max_f32 v110, 0, v110
    v_max_f32 v111, 0, v111
    v_pk_add_f32 v[108:109], v[108:109], v[148:149]
    v_pk_add_f32 v[110:111], v[110:111], v[150:151]
    v_pk_add_f32 v[108:109], v[108:109], s[54:55]
    v_pk_add_f32 v[110:111], v[110:111], s[54:55]
    v_cvt_pk_bf16_f32 v60, v96, v97
    v_cvt_pk_bf16_f32 v61, v98, v99
    ds_write_b64 v10, v[60:61] offset:0
    v_cvt_pk_bf16_f32 v62, v100, v101
    v_cvt_pk_bf16_f32 v63, v102, v103
    ds_write_b64 v10, v[62:63] offset:5376
    v_cvt_pk_bf16_f32 v64, v104, v105
    v_cvt_pk_bf16_f32 v65, v106, v107
    ds_write_b64 v10, v[64:65] offset:32
    v_cvt_pk_bf16_f32 v66, v108, v109
    v_cvt_pk_bf16_f32 v67, v110, v111
    ds_write_b64 v10, v[66:67] offset:5408
    v_min_f32 v148, 0, v88
    v_min_f32 v149, 0, v89
    v_pk_mul_f32 v[148:149], v[148:149], s[52:53]
    v_min_f32 v150, 0, v90
    v_min_f32 v151, 0, v91
    v_pk_mul_f32 v[150:151], v[150:151], s[52:53]
    v_exp_f32 v148, v148
    v_exp_f32 v149, v149
    v_exp_f32 v150, v150
    v_exp_f32 v151, v151
    v_max_f32 v88, 0, v88
    v_max_f32 v89, 0, v89
    v_max_f32 v90, 0, v90
    v_max_f32 v91, 0, v91
    v_pk_add_f32 v[88:89], v[88:89], v[148:149]
    v_pk_add_f32 v[90:91], v[90:91], v[150:151]
    v_pk_add_f32 v[88:89], v[88:89], s[54:55]
    v_pk_add_f32 v[90:91], v[90:91], s[54:55]
    v_cvt_pk_bf16_f32 v56, v88, v89
    v_cvt_pk_bf16_f32 v57, v90, v91
    buffer_store_dwordx2 v[56:57], v12, s[8:11], s43 offen sc1
    v_min_f32 v148, 0, v92
    v_min_f32 v149, 0, v93
    v_pk_mul_f32 v[148:149], v[148:149], s[52:53]
    v_min_f32 v150, 0, v94
    v_min_f32 v151, 0, v95
    v_pk_mul_f32 v[150:151], v[150:151], s[52:53]
    v_exp_f32 v148, v148
    v_exp_f32 v149, v149
    v_exp_f32 v150, v150
    v_exp_f32 v151, v151
    v_max_f32 v92, 0, v92
    v_max_f32 v93, 0, v93
    v_max_f32 v94, 0, v94
    v_max_f32 v95, 0, v95
    v_pk_add_f32 v[92:93], v[92:93], v[148:149]
    v_pk_add_f32 v[94:95], v[94:95], v[150:151]
    v_pk_add_f32 v[92:93], v[92:93], s[54:55]
    v_pk_add_f32 v[94:95], v[94:95], s[54:55]
    v_cvt_pk_bf16_f32 v58, v92, v93
    v_cvt_pk_bf16_f32 v59, v94, v95
    buffer_store_dwordx2 v[58:59], v12, s[8:11], s25 offen sc1
    s_branch interleave_layers__linear_attn_block__memory_aug_recurrent_mem_tr__prompt_kernel_k1_ej
interleave_layers__linear_attn_block__memory_aug_recurrent_mem_tr__prompt_kernel_k1_e3:
    v_min_f32 v148, 0, v88
    v_min_f32 v149, 0, v89
    v_pk_mul_f32 v[148:149], v[148:149], s[52:53]
    v_min_f32 v150, 0, v90
    v_min_f32 v151, 0, v91
    v_pk_mul_f32 v[150:151], v[150:151], s[52:53]
    v_exp_f32 v148, v148
    v_exp_f32 v149, v149
    v_exp_f32 v150, v150
    v_exp_f32 v151, v151
    v_max_f32 v88, 0, v88
    v_max_f32 v89, 0, v89
    v_max_f32 v90, 0, v90
    v_max_f32 v91, 0, v91
    v_pk_add_f32 v[88:89], v[88:89], v[148:149]
    v_pk_add_f32 v[90:91], v[90:91], v[150:151]
    v_pk_add_f32 v[88:89], v[88:89], s[54:55]
    v_pk_add_f32 v[90:91], v[90:91], s[54:55]
    v_min_f32 v148, 0, v92
    v_min_f32 v149, 0, v93
    v_pk_mul_f32 v[148:149], v[148:149], s[52:53]
    v_min_f32 v150, 0, v94
    v_min_f32 v151, 0, v95
    v_pk_mul_f32 v[150:151], v[150:151], s[52:53]
    v_exp_f32 v148, v148
    v_exp_f32 v149, v149
    v_exp_f32 v150, v150
    v_exp_f32 v151, v151
    v_max_f32 v92, 0, v92
    v_max_f32 v93, 0, v93
    v_max_f32 v94, 0, v94
    v_max_f32 v95, 0, v95
    v_pk_add_f32 v[92:93], v[92:93], v[148:149]
    v_pk_add_f32 v[94:95], v[94:95], v[150:151]
    v_pk_add_f32 v[92:93], v[92:93], s[54:55]
    v_pk_add_f32 v[94:95], v[94:95], s[54:55]
    v_cvt_pk_bf16_f32 v56, v88, v89
    v_cvt_pk_bf16_f32 v57, v90, v91
    ds_write_b64 v10, v[56:57] offset:64
    v_cvt_pk_bf16_f32 v58, v92, v93
    v_cvt_pk_bf16_f32 v59, v94, v95
    ds_write_b64 v10, v[58:59] offset:5440
    v_min_f32 v148, 0, v96
    v_min_f32 v149, 0, v97
    v_pk_mul_f32 v[148:149], v[148:149], s[52:53]
    v_min_f32 v150, 0, v98
    v_min_f32 v151, 0, v99
    v_pk_mul_f32 v[150:151], v[150:151], s[52:53]
    v_exp_f32 v148, v148
    v_exp_f32 v149, v149
    v_exp_f32 v150, v150
    v_exp_f32 v151, v151
    v_max_f32 v96, 0, v96
    v_max_f32 v97, 0, v97
    v_max_f32 v98, 0, v98
    v_max_f32 v99, 0, v99
    v_pk_add_f32 v[96:97], v[96:97], v[148:149]
    v_pk_add_f32 v[98:99], v[98:99], v[150:151]
    v_pk_add_f32 v[96:97], v[96:97], s[54:55]
    v_pk_add_f32 v[98:99], v[98:99], s[54:55]
    v_min_f32 v148, 0, v100
    v_min_f32 v149, 0, v101
    v_pk_mul_f32 v[148:149], v[148:149], s[52:53]
    v_min_f32 v150, 0, v102
    v_min_f32 v151, 0, v103
    v_pk_mul_f32 v[150:151], v[150:151], s[52:53]
    v_exp_f32 v148, v148
    v_exp_f32 v149, v149
    v_exp_f32 v150, v150
    v_exp_f32 v151, v151
    v_max_f32 v100, 0, v100
    v_max_f32 v101, 0, v101
    v_max_f32 v102, 0, v102
    v_max_f32 v103, 0, v103
    v_pk_add_f32 v[100:101], v[100:101], v[148:149]
    v_pk_add_f32 v[102:103], v[102:103], v[150:151]
    v_pk_add_f32 v[100:101], v[100:101], s[54:55]
    v_pk_add_f32 v[102:103], v[102:103], s[54:55]
    v_cvt_pk_bf16_f32 v60, v96, v97
    v_cvt_pk_bf16_f32 v61, v98, v99
    ds_write_b64 v10, v[60:61] offset:96
    v_cvt_pk_bf16_f32 v62, v100, v101
    v_cvt_pk_bf16_f32 v63, v102, v103
    ds_write_b64 v10, v[62:63] offset:5472
    v_min_f32 v148, 0, v104
    v_min_f32 v149, 0, v105
    v_pk_mul_f32 v[148:149], v[148:149], s[52:53]
    v_min_f32 v150, 0, v106
    v_min_f32 v151, 0, v107
    v_pk_mul_f32 v[150:151], v[150:151], s[52:53]
    v_exp_f32 v148, v148
    v_exp_f32 v149, v149
    v_exp_f32 v150, v150
    v_exp_f32 v151, v151
    v_max_f32 v104, 0, v104
    v_max_f32 v105, 0, v105
    v_max_f32 v106, 0, v106
    v_max_f32 v107, 0, v107
    v_pk_add_f32 v[104:105], v[104:105], v[148:149]
    v_pk_add_f32 v[106:107], v[106:107], v[150:151]
    v_pk_add_f32 v[104:105], v[104:105], s[54:55]
    v_pk_add_f32 v[106:107], v[106:107], s[54:55]
    v_min_f32 v148, 0, v108
    v_min_f32 v149, 0, v109
    v_pk_mul_f32 v[148:149], v[148:149], s[52:53]
    v_min_f32 v150, 0, v110
    v_min_f32 v151, 0, v111
    v_pk_mul_f32 v[150:151], v[150:151], s[52:53]
    v_exp_f32 v148, v148
    v_exp_f32 v149, v149
    v_exp_f32 v150, v150
    v_exp_f32 v151, v151
    v_max_f32 v108, 0, v108
    v_max_f32 v109, 0, v109
    v_max_f32 v110, 0, v110
    v_max_f32 v111, 0, v111
    v_pk_add_f32 v[108:109], v[108:109], v[148:149]
    v_pk_add_f32 v[110:111], v[110:111], v[150:151]
    v_pk_add_f32 v[108:109], v[108:109], s[54:55]
    v_pk_add_f32 v[110:111], v[110:111], s[54:55]
    v_cvt_pk_bf16_f32 v64, v104, v105
    v_cvt_pk_bf16_f32 v65, v106, v107
    ds_write_b64 v10, v[64:65] offset:128
    v_cvt_pk_bf16_f32 v66, v108, v109
    v_cvt_pk_bf16_f32 v67, v110, v111
    ds_write_b64 v10, v[66:67] offset:5504
interleave_layers__linear_attn_block__memory_aug_recurrent_mem_tr__prompt_kernel_k1_ej:
    s_waitcnt lgkmcnt(0)
    s_barrier
    ds_read_b64_tr_b16 v[72:73], v11 offset:0
    ds_read_b64_tr_b16 v[74:75], v11 offset:1344
    ds_read_b64_tr_b16 v[76:77], v11 offset:32
    ds_read_b64_tr_b16 v[78:79], v11 offset:1376
    ds_read_b64_tr_b16 v[80:81], v11 offset:160
    ds_read_b64_tr_b16 v[82:83], v11 offset:1504
    ds_read_b64_tr_b16 v[84:85], v11 offset:192
    ds_read_b64_tr_b16 v[86:87], v11 offset:1536
    s_waitcnt lgkmcnt(0)
    v_mfma_f32_16x16x32_bf16 v[120:123], v[72:75], v[84:87], v[120:123]
    v_mfma_f32_16x16x32_bf16 v[124:127], v[76:79], v[80:83], v[124:127]
    v_mfma_f32_16x16x32_bf16 v[128:131], v[76:79], v[84:87], v[128:131]
    v_mfma_f32_16x16x32_bf16 v[132:135], v[76:79], v[172:175], v[132:135]
    v_mfma_f32_16x16x32_bf16 v[136:139], v[72:75], v[80:83], v[136:139]
    v_mfma_f32_16x16x32_bf16 v[140:143], v[72:75], v[172:175], v[140:143]
    s_add_u32 s43, s43, s42
    s_add_u32 s48, s48, s49
    s_sub_u32 s40, s40, 1
    s_cmp_gt_u32 s40, 0
    s_cbranch_scc1 interleave_layers__linear_attn_block__memory_aug_recurrent_mem_tr__prompt_kernel_k1_seg
    s_cmp_eq_u32 s92, 0
    s_cbranch_scc0 interleave_layers__linear_attn_block__memory_aug_recurrent_mem_tr__prompt_kernel_ri7
    v_mov_b32 v15, 0
    buffer_load_dword v14, v15, s[72:75], 0 offen sc1
interleave_layers__linear_attn_block__memory_aug_recurrent_mem_tr__prompt_kernel_ri7:
    s_mul_i32 s24, s45, 147456
    s_mul_i32 s25, s44, 18432
    s_add_u32 s24, s24, s25
    s_add_u32 s24, s24, 16777216
    s_mul_i32 s25, s3, 3072
    s_add_u32 s25, s25, s24
    s_lshl_b32 s26, s3, 10
    s_add_u32 s26, s26, s24
    s_add_u32 s26, s26, 13312
    s_cmp_eq_u32 s3, 0
    s_cselect_b32 s27, 0, 2146435072
    s_add_u32 s27, s27, s24
    s_add_u32 s28, s27, 17408
    s_add_u32 s27, s27, 12288
    buffer_store_dwordx4 v[120:123], v7, s[8:11], s25 offen offset:0 sc1
    buffer_store_dwordx4 v[124:127], v7, s[8:11], s25 offen offset:1024 sc1
    buffer_store_dwordx4 v[128:131], v7, s[8:11], s25 offen offset:2048 sc1
    buffer_store_dwordx4 v[132:135], v7, s[8:11], s26 offen sc1
    buffer_store_dwordx4 v[136:139], v7, s[8:11], s27 offen sc1
    buffer_store_dwordx4 v[140:143], v7, s[8:11], s28 offen sc1
    s_waitcnt vmcnt(0)
    s_cmp_eq_u32 s92, 0
    s_cbranch_scc0 interleave_layers__linear_attn_block__memory_aug_recurrent_mem_tr__prompt_kernel_rc8_ok
    s_mov_b32 s61, 0
interleave_layers__linear_attn_block__memory_aug_recurrent_mem_tr__prompt_kernel_rc8:
    s_waitcnt vmcnt(0)
    v_readfirstlane_b32 s24, v14
    s_cmp_eq_u32 s24, 1
    s_cbranch_scc1 interleave_layers__linear_attn_block__memory_aug_recurrent_mem_tr__prompt_kernel_rc8_ok
    s_add_u32 s61, s61, 1
    s_cmp_ge_u32 s61, s60
    s_cbranch_scc1 interleave_layers__linear_attn_block__memory_aug_recurrent_mem_tr__prompt_kernel_rc8_to
    s_sleep 2
    v_mov_b32 v15, 0
    buffer_load_dword v14, v15, s[72:75], 0 offen sc1
    s_branch interleave_layers__linear_attn_block__memory_aug_recurrent_mem_tr__prompt_kernel_rc8
interleave_layers__linear_attn_block__memory_aug_recurrent_mem_tr__prompt_kernel_rc8_to:
    s_mov_b32 s60, 1
interleave_layers__linear_attn_block__memory_aug_recurrent_mem_tr__prompt_kernel_rc8_ok:
    s_barrier
    s_lshl_b32 s24, s92, 3
    s_add_u32 s24, s24, s44
    s_lshl_b32 s24, s24, 7
    s_lshl_b32 s25, s45, 2
    s_add_u32 s24, s24, s25
    s_add_u32 s24, s24, 23101440
    s_cmp_eq_u32 s3, 0
    s_cbranch_scc0 interleave_layers__linear_attn_block__memory_aug_recurrent_mem_tr__prompt_kernel_pb9
    v_lshlrev_b32 v14, 7, v1
    v_add_u32 v14, s24, v14
    v_mov_b32 v15, 2146435072
    v_cmp_le_u32 vcc, 1, v1
    s_nop 1
    v_cndmask_b32 v14, v14, v15, vcc
    v_mov_b32 v15, 1
    buffer_store_dword v15, v14, s[8:11], 0 offen sc1
interleave_layers__linear_attn_block__memory_aug_recurrent_mem_tr__prompt_kernel_pb9:
    s_cmp_eq_u32 s92, 0
    s_cbranch_scc0 interleave_layers__linear_attn_block__memory_aug_recurrent_mem_tr__prompt_kernel_end
    s_cmp_ge_u32 s2, 232
    s_cbranch_scc1 interleave_layers__linear_attn_block__memory_aug_recurrent_mem_tr__prompt_kernel_helper
    s_cmp_ge_u32 s2, 200
    s_cbranch_scc1 interleave_layers__linear_attn_block__memory_aug_recurrent_mem_tr__prompt_kernel_toO
    s_cmp_ge_u32 s2, 104
    s_cbranch_scc1 interleave_layers__linear_attn_block__memory_aug_recurrent_mem_tr__prompt_kernel_toP
    s_cmp_ge_u32 s2, 64
    s_cbranch_scc1 interleave_layers__linear_attn_block__memory_aug_recurrent_mem_tr__prompt_kernel_toR
    s_cmp_ge_u32 s2, 32
    s_cbranch_scc1 interleave_layers__linear_attn_block__memory_aug_recurrent_mem_tr__prompt_kernel_toV
    s_branch interleave_layers__linear_attn_block__memory_aug_recurrent_mem_tr__prompt_kernel_roleS
interleave_layers__linear_attn_block__memory_aug_recurrent_mem_tr__prompt_kernel_toV:
    s_branch interleave_layers__linear_attn_block__memory_aug_recurrent_mem_tr__prompt_kernel_roleV
interleave_layers__linear_attn_block__memory_aug_recurrent_mem_tr__prompt_kernel_toR:
    s_branch interleave_layers__linear_attn_block__memory_aug_recurrent_mem_tr__prompt_kernel_roleR
interleave_layers__linear_attn_block__memory_aug_recurrent_mem_tr__prompt_kernel_toP:
    s_branch interleave_layers__linear_attn_block__memory_aug_recurrent_mem_tr__prompt_kernel_roleP
interleave_layers__linear_attn_block__memory_aug_recurrent_mem_tr__prompt_kernel_toO:
    s_branch interleave_layers__linear_attn_block__memory_aug_recurrent_mem_tr__prompt_kernel_roleO
interleave_layers__linear_attn_block__memory_aug_recurrent_mem_tr__prompt_kernel_helper:
    s_sub_u32 s24, s2, 232
    s_cmp_ge_u32 s24, 21
    s_cbranch_scc1 interleave_layers__linear_attn_block__memory_aug_recurrent_mem_tr__prompt_kernel_helper_clr
    s_cmp_eq_u32 s24, 15
    s_cbranch_scc1 interleave_layers__linear_attn_block__memory_aug_recurrent_mem_tr__prompt_kernel_helper_k1
    s_mul_i32 s57, s24, 52
    s_lshr_b32 s57, s57, 8
    s_mul_i32 s56, s57, 5
    s_sub_u32 s56, s24, s56
    s_add_u32 s57, s57, 1
    s_sub_u32 s25, s24, 16
    s_cmp_ge_u32 s24, 16
    s_cselect_b32 s56, s25, s56
    s_cselect_b32 s57, 0, s57
    s_mul_i32 s78, s57, 5
    s_add_u32 s78, s78, s56
    s_load_dwordx2 s[6:7], s[0:1], 16
    v_lshrrev_b32 v12, 4, v0
    v_mul_u32_u24 v12, 1280, v12
    v_and_b32 v13, 15, v0
    v_lshl_add_u32 v12, v13, 4, v12
    s_waitcnt lgkmcnt(0)
    s_mov_b32 s12, s6
    s_mov_b32 s13, s7
    s_mov_b32 s14, 819200
    s_mov_b32 s15, 0x00020000
    s_lshl_b32 s52, s56, 8
    s_add_u32 s24, s52, 0
    buffer_load_dwordx4 a[0:3], v12, s[12:15], s24 offen
    s_add_u32 s24, s52, 20480
    buffer_load_dwordx4 a[4:7], v12, s[12:15], s24 offen
    s_add_u32 s24, s52, 40960
    buffer_load_dwordx4 a[8:11], v12, s[12:15], s24 offen
    s_add_u32 s24, s52, 61440
    buffer_load_dwordx4 a[12:15], v12, s[12:15], s24 offen
    s_add_u32 s24, s52, 81920
    buffer_load_dwordx4 a[16:19], v12, s[12:15], s24 offen
    s_add_u32 s24, s52, 102400
    buffer_load_dwordx4 a[20:23], v12, s[12:15], s24 offen
    s_add_u32 s24, s52, 122880
    buffer_load_dwordx4 a[24:27], v12, s[12:15], s24 offen
    s_add_u32 s24, s52, 143360
    buffer_load_dwordx4 a[28:31], v12, s[12:15], s24 offen
    s_add_u32 s24, s52, 163840
    buffer_load_dwordx4 a[32:35], v12, s[12:15], s24 offen
    s_add_u32 s24, s52, 184320
    buffer_load_dwordx4 a[36:39], v12, s[12:15], s24 offen
    s_add_u32 s24, s52, 204800
    buffer_load_dwordx4 a[40:43], v12, s[12:15], s24 offen
    s_add_u32 s24, s52, 225280
    buffer_load_dwordx4 a[44:47], v12, s[12:15], s24 offen
    s_add_u32 s24, s52, 245760
    buffer_load_dwordx4 a[48:51], v12, s[12:15], s24 offen
    s_add_u32 s24, s52, 266240
    buffer_load_dwordx4 a[52:55], v12, s[12:15], s24 offen
    s_add_u32 s24, s52, 286720
    buffer_load_dwordx4 a[56:59], v12, s[12:15], s24 offen
    s_add_u32 s24, s52, 307200
    buffer_load_dwordx4 a[60:63], v12, s[12:15], s24 offen
    s_add_u32 s24, s52, 327680
    buffer_load_dwordx4 a[64:67], v12, s[12:15], s24 offen
    s_add_u32 s24, s52, 348160
    buffer_load_dwordx4 a[68:71], v12, s[12:15], s24 offen
    s_add_u32 s24, s52, 368640
    buffer_load_dwordx4 a[72:75], v12, s[12:15], s24 offen
    s_add_u32 s24, s52, 389120
    buffer_load_dwordx4 a[76:79], v12, s[12:15], s24 offen
    s_add_u32 s24, s52, 409600
    buffer_load_dwordx4 a[80:83], v12, s[12:15], s24 offen
    s_add_u32 s24, s52, 430080
    buffer_load_dwordx4 a[84:87], v12, s[12:15], s24 offen
    s_add_u32 s24, s52, 450560
    buffer_load_dwordx4 a[88:91], v12, s[12:15], s24 offen
    s_add_u32 s24, s52, 471040
    buffer_load_dwordx4 a[92:95], v12, s[12:15], s24 offen
    s_add_u32 s24, s52, 491520
    buffer_load_dwordx4 a[96:99], v12, s[12:15], s24 offen
    s_add_u32 s24, s52, 512000
    buffer_load_dwordx4 a[100:103], v12, s[12:15], s24 offen
    s_add_u32 s24, s52, 532480
    buffer_load_dwordx4 a[104:107], v12, s[12:15], s24 offen
    s_add_u32 s24, s52, 552960
    buffer_load_dwordx4 a[108:111], v12, s[12:15], s24 offen
    s_add_u32 s24, s52, 573440
    buffer_load_dwordx4 a[112:115], v12, s[12:15], s24 offen
    s_add_u32 s24, s52, 593920
    buffer_load_dwordx4 a[116:119], v12, s[12:15], s24 offen
    s_add_u32 s24, s52, 614400
    buffer_load_dwordx4 a[120:123], v12, s[12:15], s24 offen
    s_add_u32 s24, s52, 634880
    buffer_load_dwordx4 a[124:127], v12, s[12:15], s24 offen
    s_add_u32 s24, s52, 655360
    buffer_load_dwordx4 a[128:131], v12, s[12:15], s24 offen
    s_add_u32 s24, s52, 675840
    buffer_load_dwordx4 a[132:135], v12, s[12:15], s24 offen
    s_add_u32 s24, s52, 696320
    buffer_load_dwordx4 a[136:139], v12, s[12:15], s24 offen
    s_add_u32 s24, s52, 716800
    buffer_load_dwordx4 a[140:143], v12, s[12:15], s24 offen
    s_add_u32 s24, s52, 737280
    buffer_load_dwordx4 a[144:147], v12, s[12:15], s24 offen
    s_add_u32 s24, s52, 757760
    buffer_load_dwordx4 a[148:151], v12, s[12:15], s24 offen
    s_add_u32 s24, s52, 778240
    buffer_load_dwordx4 a[152:155], v12, s[12:15], s24 offen
    s_add_u32 s24, s52, 798720
    buffer_load_dwordx4 a[156:159], v12, s[12:15], s24 offen
    v_lshrrev_b32 v6, 4, v0
    v_mul_u32_u24 v6, 288, v6
    v_and_b32 v7, 15, v0
    v_lshl_add_u32 v6, v7, 4, v6
    v_add_u32 v6, 81920, v6
    v_lshrrev_b32 v7, 2, v2
    v_lshl_add_u32 v7, v3, 2, v7
    v_mul_u32_u24 v7, 288, v7
    v_and_b32 v8, 3, v2
    v_lshl_add_u32 v7, v8, 3, v7
    s_lshl_b32 s24, s3, 6
    s_add_u32 s24, s24, 81920
    v_add_u32 v7, s24, v7
    s_waitcnt vmcnt(36)
    ds_write_b128 v6, a[0:3] offset:0
    ds_write_b128 v6, a[4:7] offset:4608
    ds_write_b128 v6, a[8:11] offset:9216
    ds_write_b128 v6, a[12:15] offset:13824
    s_waitcnt lgkmcnt(0)
    s_barrier
    ds_read_b64_tr_b16 a[0:1], v7 offset:0
    ds_read_b64_tr_b16 a[2:3], v7 offset:4608
    ds_read_b64_tr_b16 a[4:5], v7 offset:32
    ds_read_b64_tr_b16 a[6:7], v7 offset:4640
    ds_read_b64_tr_b16 a[8:9], v7 offset:9216
    ds_read_b64_tr_b16 a[10:11], v7 offset:13824
    ds_read_b64_tr_b16 a[12:13], v7 offset:9248
    ds_read_b64_tr_b16 a[14:15], v7 offset:13856
    s_waitcnt vmcnt(32)
    ds_write_b128 v6, a[16:19] offset:18432
    ds_write_b128 v6, a[20:23] offset:23040
    ds_write_b128 v6, a[24:27] offset:27648
    ds_write_b128 v6, a[28:31] offset:32256
    s_waitcnt lgkmcnt(0)
    s_barrier
    ds_read_b64_tr_b16 a[16:17], v7 offset:18432
    ds_read_b64_tr_b16 a[18:19], v7 offset:23040
    ds_read_b64_tr_b16 a[20:21], v7 offset:18464
    ds_read_b64_tr_b16 a[22:23], v7 offset:23072
    ds_read_b64_tr_b16 a[24:25], v7 offset:27648
    ds_read_b64_tr_b16 a[26:27], v7 offset:32256
    ds_read_b64_tr_b16 a[28:29], v7 offset:27680
    ds_read_b64_tr_b16 a[30:31], v7 offset:32288
    s_waitcnt vmcnt(28)
    ds_write_b128 v6, a[32:35] offset:0
    ds_write_b128 v6, a[36:39] offset:4608
    ds_write_b128 v6, a[40:43] offset:9216
    ds_write_b128 v6, a[44:47] offset:13824
    s_waitcnt lgkmcnt(0)
    s_barrier
    ds_read_b64_tr_b16 a[32:33], v7 offset:0
    ds_read_b64_tr_b16 a[34:35], v7 offset:4608
    ds_read_b64_tr_b16 a[36:37], v7 offset:32
    ds_read_b64_tr_b16 a[38:39], v7 offset:4640
    ds_read_b64_tr_b16 a[40:41], v7 offset:9216
    ds_read_b64_tr_b16 a[42:43], v7 offset:13824
    ds_read_b64_tr_b16 a[44:45], v7 offset:9248
    ds_read_b64_tr_b16 a[46:47], v7 offset:13856
    s_waitcnt vmcnt(24)
    ds_write_b128 v6, a[48:51] offset:18432
    ds_write_b128 v6, a[52:55] offset:23040
    ds_write_b128 v6, a[56:59] offset:27648
    ds_write_b128 v6, a[60:63] offset:32256
    s_waitcnt lgkmcnt(0)
    s_barrier
    ds_read_b64_tr_b16 a[48:49], v7 offset:18432
    ds_read_b64_tr_b16 a[50:51], v7 offset:23040
    ds_read_b64_tr_b16 a[52:53], v7 offset:18464
    ds_read_b64_tr_b16 a[54:55], v7 offset:23072
    ds_read_b64_tr_b16 a[56:57], v7 offset:27648
    ds_read_b64_tr_b16 a[58:59], v7 offset:32256
    ds_read_b64_tr_b16 a[60:61], v7 offset:27680
    ds_read_b64_tr_b16 a[62:63], v7 offset:32288
    s_waitcnt vmcnt(20)
    ds_write_b128 v6, a[64:67] offset:0
    ds_write_b128 v6, a[68:71] offset:4608
    ds_write_b128 v6, a[72:75] offset:9216
    ds_write_b128 v6, a[76:79] offset:13824
    s_waitcnt lgkmcnt(0)
    s_barrier
    ds_read_b64_tr_b16 a[64:65], v7 offset:0
    ds_read_b64_tr_b16 a[66:67], v7 offset:4608
    ds_read_b64_tr_b16 a[68:69], v7 offset:32
    ds_read_b64_tr_b16 a[70:71], v7 offset:4640
    ds_read_b64_tr_b16 a[72:73], v7 offset:9216
    ds_read_b64_tr_b16 a[74:75], v7 offset:13824
    ds_read_b64_tr_b16 a[76:77], v7 offset:9248
    ds_read_b64_tr_b16 a[78:79], v7 offset:13856
    s_waitcnt vmcnt(16)
    ds_write_b128 v6, a[80:83] offset:18432
    ds_write_b128 v6, a[84:87] offset:23040
    ds_write_b128 v6, a[88:91] offset:27648
    ds_write_b128 v6, a[92:95] offset:32256
    s_waitcnt lgkmcnt(0)
    s_barrier
    ds_read_b64_tr_b16 a[80:81], v7 offset:18432
    ds_read_b64_tr_b16 a[82:83], v7 offset:23040
    ds_read_b64_tr_b16 a[84:85], v7 offset:18464
    ds_read_b64_tr_b16 a[86:87], v7 offset:23072
    ds_read_b64_tr_b16 a[88:89], v7 offset:27648
    ds_read_b64_tr_b16 a[90:91], v7 offset:32256
    ds_read_b64_tr_b16 a[92:93], v7 offset:27680
    ds_read_b64_tr_b16 a[94:95], v7 offset:32288
    s_waitcnt vmcnt(12)
    ds_write_b128 v6, a[96:99] offset:0
    ds_write_b128 v6, a[100:103] offset:4608
    ds_write_b128 v6, a[104:107] offset:9216
    ds_write_b128 v6, a[108:111] offset:13824
    s_waitcnt lgkmcnt(0)
    s_barrier
    ds_read_b64_tr_b16 a[96:97], v7 offset:0
    ds_read_b64_tr_b16 a[98:99], v7 offset:4608
    ds_read_b64_tr_b16 a[100:101], v7 offset:32
    ds_read_b64_tr_b16 a[102:103], v7 offset:4640
    ds_read_b64_tr_b16 a[104:105], v7 offset:9216
    ds_read_b64_tr_b16 a[106:107], v7 offset:13824
    ds_read_b64_tr_b16 a[108:109], v7 offset:9248
    ds_read_b64_tr_b16 a[110:111], v7 offset:13856
    s_waitcnt vmcnt(8)
    ds_write_b128 v6, a[112:115] offset:18432
    ds_write_b128 v6, a[116:119] offset:23040
    ds_write_b128 v6, a[120:123] offset:27648
    ds_write_b128 v6, a[124:127] offset:32256
    s_waitcnt lgkmcnt(0)
    s_barrier
    ds_read_b64_tr_b16 a[112:113], v7 offset:18432
    ds_read_b64_tr_b16 a[114:115], v7 offset:23040
    ds_read_b64_tr_b16 a[116:117], v7 offset:18464
    ds_read_b64_tr_b16 a[118:119], v7 offset:23072
    ds_read_b64_tr_b16 a[120:121], v7 offset:27648
    ds_read_b64_tr_b16 a[122:123], v7 offset:32256
    ds_read_b64_tr_b16 a[124:125], v7 offset:27680
    ds_read_b64_tr_b16 a[126:127], v7 offset:32288
    s_waitcnt vmcnt(4)
    ds_write_b128 v6, a[128:131] offset:0
    ds_write_b128 v6, a[132:135] offset:4608
    ds_write_b128 v6, a[136:139] offset:9216
    ds_write_b128 v6, a[140:143] offset:13824
    s_waitcnt lgkmcnt(0)
    s_barrier
    ds_read_b64_tr_b16 a[128:129], v7 offset:0
    ds_read_b64_tr_b16 a[130:131], v7 offset:4608
    ds_read_b64_tr_b16 a[132:133], v7 offset:32
    ds_read_b64_tr_b16 a[134:135], v7 offset:4640
    ds_read_b64_tr_b16 a[136:137], v7 offset:9216
    ds_read_b64_tr_b16 a[138:139], v7 offset:13824
    ds_read_b64_tr_b16 a[140:141], v7 offset:9248
    ds_read_b64_tr_b16 a[142:143], v7 offset:13856
    s_waitcnt vmcnt(0)
    ds_write_b128 v6, a[144:147] offset:18432
    ds_write_b128 v6, a[148:151] offset:23040
    ds_write_b128 v6, a[152:155] offset:27648
    ds_write_b128 v6, a[156:159] offset:32256
    s_waitcnt lgkmcnt(0)
    s_barrier
    ds_read_b64_tr_b16 a[144:145], v7 offset:18432
    ds_read_b64_tr_b16 a[146:147], v7 offset:23040
    ds_read_b64_tr_b16 a[148:149], v7 offset:18464
    ds_read_b64_tr_b16 a[150:151], v7 offset:23072
    ds_read_b64_tr_b16 a[152:153], v7 offset:27648
    ds_read_b64_tr_b16 a[154:155], v7 offset:32256
    ds_read_b64_tr_b16 a[156:157], v7 offset:27680
    ds_read_b64_tr_b16 a[158:159], v7 offset:32288
    s_waitcnt lgkmcnt(0)
    s_load_dwordx2 s[6:7], s[0:1], 0
    s_waitcnt lgkmcnt(0)
    s_mov_b32 s16, s6
    s_mov_b32 s17, s7
    s_mov_b32 s18, 2621440
    s_mov_b32 s19, 0x00020000
    s_mov_b32 s46, 64
    s_mov_b32 s47, 32
    s_mov_b32 s50, 0
    s_mov_b32 s58, 0
    s_mov_b32 s76, 16
    s_mov_b32 s77, 163840
interleave_layers__linear_attn_block__memory_aug_recurrent_mem_tr__prompt_kernel_k3_entry:
    v_lshlrev_b32 v5, 4, v1
    s_mul_i32 s24, s3, 5120
    s_add_u32 s24, s24, 12582912
    v_add_u32 v8, s24, v5
    v_lshlrev_b32 v9, 3, v1
    s_add_u32 s24, s24, 2048
    v_add_u32 v9, s24, v9
    s_cmp_eq_u32 s50, 1
    s_cselect_b32 s25, 16, 1280
    s_cselect_b32 s26, 256, 8
    v_mul_u32_u24 v10, s25, v2
    v_mul_u32_u24 v11, s26, v3
    s_lshl_b32 s24, s56, 2
    s_add_u32 s24, s24, s3
    s_mul_i32 s25, s24, s46
    v_add3_u32 v10, v10, v11, s25
    v_add_u32 v11, s47, v10
    s_lshl_b32 s24, s24, 10
    s_add_u32 s24, s24, s58
    v_add_u32 v12, s24, v5
    s_mul_i32 s24, s3, 5120
    s_add_u32 s24, s24, 0
    v_add_u32 v13, s24, v5
    s_mov_b32 s54, 0x358637bd
    s_mul_i32 s43, s57, 40960
    s_mov_b32 s40, 0
    s_mov_b32 s42, 0
    s_cmp_eq_u32 s92, 0
    s_cselect_b32 s26, 32, 0
    s_cselect_b32 s27, 7, 1
    s_lshl_b32 s24, s92, 10
    s_add_u32 s24, s24, 23101440
    v_and_b32 v15, 7, v1
    v_lshlrev_b32 v15, 7, v15
    v_lshrrev_b32 v14, 3, v1
    v_and_b32 v14, s27, v14
    v_lshl_add_u32 v15, v14, 2, v15
    v_add_u32 v15, s24, v15
    s_lshl_b32 s27, s26, 1
    s_add_u32 s28, s27, s26
    s_mov_b32 s61, 0
interleave_layers__linear_attn_block__memory_aug_recurrent_mem_tr__prompt_kernel_k3_w0:
    buffer_load_dword v16, v15, s[8:11], 0 offen sc1
    buffer_load_dword v17, v15, s[8:11], s26 offen sc1
    buffer_load_dword v18, v15, s[8:11], s27 offen sc1
    buffer_load_dword v19, v15, s[8:11], s28 offen sc1
    s_waitcnt vmcnt(0)
    v_min_i32 v16, v16, v17
    v_min3_i32 v16, v16, v18, v19
    v_cmp_le_i32 vcc, 1, v16
    s_cmp_eq_u64 vcc, -1
    s_cbranch_scc1 interleave_layers__linear_attn_block__memory_aug_recurrent_mem_tr__prompt_kernel_k3_w0_ok
    s_add_u32 s61, s61, 1
    s_cmp_ge_u32 s61, s60
    s_cbranch_scc1 interleave_layers__linear_attn_block__memory_aug_recurrent_mem_tr__prompt_kernel_k3_w0_to
    s_sleep 4
    s_branch interleave_layers__linear_attn_block__memory_aug_recurrent_mem_tr__prompt_kernel_k3_w0
interleave_layers__linear_attn_block__memory_aug_recurrent_mem_tr__prompt_kernel_k3_w0_to:
    s_mov_b32 s60, 1
interleave_layers__linear_attn_block__memory_aug_recurrent_mem_tr__prompt_kernel_k3_w0_ok:
    s_mov_b32 s41, s43
    s_add_u32 s25, s41, 20480
    buffer_load_dwordx4 v[16:19], v8, s[8:11], s41 offen offset:0 sc1
    buffer_load_dwordx4 v[20:23], v8, s[8:11], s41 offen offset:1024 sc1
    buffer_load_dwordx2 v[24:25], v9, s[8:11], s41 offen offset:0 sc1
    buffer_load_dwordx4 v[26:29], v8, s[8:11], s41 offen offset:2560 sc1
    buffer_load_dwordx4 v[30:33], v8, s[8:11], s41 offen offset:3584 sc1
    buffer_load_dwordx2 v[34:35], v9, s[8:11], s41 offen offset:2560 sc1
    buffer_load_dwordx4 v[36:39], v8, s[8:11], s25 offen offset:0 sc1
    buffer_load_dwordx4 v[40:43], v8, s[8:11], s25 offen offset:1024 sc1
    buffer_load_dwordx2 v[44:45], v9, s[8:11], s25 offen offset:0 sc1
    buffer_load_dwordx4 v[46:49], v8, s[8:11], s25 offen offset:2560 sc1
    buffer_load_dwordx4 v[50:53], v8, s[8:11], s25 offen offset:3584 sc1
    buffer_load_dwordx2 v[54:55], v9, s[8:11], s25 offen offset:2560 sc1
    buffer_load_dwordx2 v[96:97], v10, s[16:19], s41 offen sc1
    buffer_load_dwordx2 v[98:99], v11, s[16:19], s41 offen sc1
    buffer_load_dwordx2 v[100:101], v10, s[16:19], s25 offen sc1
    buffer_load_dwordx2 v[102:103], v11, s[16:19], s25 offen sc1
    s_add_u32 s41, s43, s77
    s_add_u32 s25, s41, 20480
    buffer_load_dwordx4 v[56:59], v8, s[8:11], s41 offen offset:0 sc1
    buffer_load_dwordx4 v[60:63], v8, s[8:11], s41 offen offset:1024 sc1
    buffer_load_dwordx2 v[64:65], v9, s[8:11], s41 offen offset:0 sc1
    buffer_load_dwordx4 v[66:69], v8, s[8:11], s41 offen offset:2560 sc1
    buffer_load_dwordx4 v[70:73], v8, s[8:11], s41 offen offset:3584 sc1
    buffer_load_dwordx2 v[74:75], v9, s[8:11], s41 offen offset:2560 sc1
    buffer_load_dwordx4 v[76:79], v8, s[8:11], s25 offen offset:0 sc1
    buffer_load_dwordx4 v[80:83], v8, s[8:11], s25 offen offset:1024 sc1
    buffer_load_dwordx2 v[84:85], v9, s[8:11], s25 offen offset:0 sc1
    buffer_load_dwordx4 v[86:89], v8, s[8:11], s25 offen offset:2560 sc1
    buffer_load_dwordx4 v[90:93], v8, s[8:11], s25 offen offset:3584 sc1
    buffer_load_dwordx2 v[94:95], v9, s[8:11], s25 offen offset:2560 sc1
    buffer_load_dwordx2 v[104:105], v10, s[16:19], s41 offen sc1
    buffer_load_dwordx2 v[106:107], v11, s[16:19], s41 offen sc1
    buffer_load_dwordx2 v[108:109], v10, s[16:19], s25 offen sc1
    buffer_load_dwordx2 v[110:111], v11, s[16:19], s25 offen sc1
    s_lshl_b32 s24, s92, 7
    s_add_u32 s24, s24, 23103488
    v_lshlrev_b32 v15, 2, v1
    v_add_u32 v15, s24, v15
    s_mov_b32 s61, 0
interleave_layers__linear_attn_block__memory_aug_recurrent_mem_tr__prompt_kernel_k3_w:
    buffer_load_dword v14, v15, s[8:11], 0 offen sc1
    s_waitcnt vmcnt(0)
    v_cmp_le_i32 vcc, 1, v14
    s_mov_b32 s25, 0xffffff
    s_and_b32 s24, vcc_lo, s25
    s_cmp_eq_u32 s24, s25
    s_cbranch_scc1 interleave_layers__linear_attn_block__memory_aug_recurrent_mem_tr__prompt_kernel_k3_w_ok
    s_add_u32 s61, s61, 1
    s_cmp_ge_u32 s61, s60
    s_cbranch_scc1 interleave_layers__linear_attn_block__memory_aug_recurrent_mem_tr__prompt_kernel_k3_w_to
    s_sleep 2
    s_branch interleave_layers__linear_attn_block__memory_aug_recurrent_mem_tr__prompt_kernel_k3_w
interleave_layers__linear_attn_block__memory_aug_recurrent_mem_tr__prompt_kernel_k3_w_to:
    s_mov_b32 s60, 1
interleave_layers__linear_attn_block__memory_aug_recurrent_mem_tr__prompt_kernel_k3_w_ok:
    s_mul_i32 s24, s92, 131072
    s_mul_i32 s25, s3, 28672
    s_add_u32 s24, s24, s25
    s_add_u32 s24, s24, 22020096
    s_add_u32 s25, s24, 0
    buffer_load_dwordx4 a[160:163], v5, s[8:11], s25 offen sc1
    s_add_u32 s25, s24, 1024
    buffer_load_dwordx4 a[164:167], v5, s[8:11], s25 offen sc1
    s_add_u32 s25, s24, 2048
    buffer_load_dwordx4 a[168:171], v5, s[8:11], s25 offen sc1
    s_add_u32 s25, s24, 3072
    buffer_load_dwordx4 a[172:175], v5, s[8:11], s25 offen sc1
    s_add_u32 s25, s24, 4096
    buffer_load_dwordx4 a[176:179], v5, s[8:11], s25 offen sc1
    s_add_u32 s25, s24, 5120
    buffer_load_dwordx4 a[180:183], v5, s[8:11], s25 offen sc1
    s_add_u32 s25, s24, 6144
    buffer_load_dwordx2 a[184:185], v5, s[8:11], s25 offen sc1
    s_add_u32 s25, s24, 7168
    buffer_load_dwordx4 a[186:189], v5, s[8:11], s25 offen sc1
    s_add_u32 s25, s24, 8192
    buffer_load_dwordx2 a[190:191], v5, s[8:11], s25 offen sc1
    s_add_u32 s25, s24, 9216
    buffer_load_dwordx4 a[192:195], v5, s[8:11], s25 offen sc1
    s_add_u32 s25, s24, 10240
    buffer_load_dwordx4 a[196:199], v5, s[8:11], s25 offen sc1
    s_add_u32 s25, s24, 11264
    buffer_load_dwordx2 a[200:201], v5, s[8:11], s25 offen sc1
    s_add_u32 s25, s24, 12288
    buffer_load_dwordx4 a[202:205], v5, s[8:11], s25 offen sc1
    s_add_u32 s25, s24, 13312
    buffer_load_dwordx2 a[206:207], v5, s[8:11], s25 offen sc1
    s_add_u32 s25, s24, 14336
    buffer_load_dwordx4 a[208:211], v5, s[8:11], s25 offen sc1
    s_add_u32 s25, s24, 15360
    buffer_load_dwordx4 a[212:215], v5, s[8:11], s25 offen sc1
    s_add_u32 s25, s24, 16384
    buffer_load_dwordx4 a[216:219], v5, s[8:11], s25 offen sc1
    s_add_u32 s25, s24, 17408
    buffer_load_dwordx4 a[220:223], v5, s[8:11], s25 offen sc1
    s_add_u32 s25, s24, 18432
    buffer_load_dwordx4 a[224:227], v5, s[8:11], s25 offen sc1
    s_add_u32 s25, s24, 19456
    buffer_load_dwordx4 a[228:231], v5, s[8:11], s25 offen sc1
    s_add_u32 s25, s24, 20480
    buffer_load_dwordx2 a[232:233], v5, s[8:11], s25 offen sc1
    s_add_u32 s25, s24, 21504
    buffer_load_dwordx4 a[234:237], v5, s[8:11], s25 offen sc1
    s_add_u32 s25, s24, 22528
    buffer_load_dwordx2 a[238:239], v5, s[8:11], s25 offen sc1
    s_add_u32 s25, s24, 23552
    buffer_load_dwordx4 a[240:243], v5, s[8:11], s25 offen sc1
    s_add_u32 s25, s24, 24576
    buffer_load_dwordx4 a[244:247], v5, s[8:11], s25 offen sc1
    s_add_u32 s25, s24, 25600
    buffer_load_dwordx2 a[248:249], v5, s[8:11], s25 offen sc1
    s_add_u32 s25, s24, 26624
    buffer_load_dwordx4 a[250:253], v5, s[8:11], s25 offen sc1
    s_add_u32 s25, s24, 27648
    buffer_load_dwordx2 a[254:255], v5, s[8:11], s25 offen sc1
    s_waitcnt vmcnt(0)
    v_mfma_f32_16x16x32_bf16 v[132:135], a[192:195], v[16:19], 0
    v_mfma_f32_16x16x32_bf16 v[136:139], a[202:205], v[20:23], 0
    v_mfma_f32_16x16x32_bf16 v[112:115], a[160:163], v[16:19], 0
    v_mfma_f32_16x16x32_bf16 v[116:119], a[164:167], v[16:19], 0
    v_mfma_f32_16x16x32_bf16 v[120:123], a[172:175], v[16:19], 0
    v_mfma_f32_16x16x32_bf16 v[124:127], a[180:183], v[20:23], 0
    v_mfma_f32_16x16x32_bf16 v[128:131], a[186:189], v[20:23], 0
    v_mfma_f32_16x16x32_bf16 v[132:135], a[196:199], v[20:23], v[132:135]
    v_mfma_f32_16x16x32_bf16 v[116:119], a[168:171], v[20:23], v[116:119]
    v_mfma_f32_16x16x32_bf16 v[120:123], a[176:179], v[20:23], v[120:123]
    v_mfma_f32_16x16x16_bf16 v[136:139], a[206:207], v[24:25], v[136:139]
    s_nop 0
    v_mfma_f32_16x16x16_bf16 v[124:127], a[184:185], v[24:25], v[124:127]
    v_mfma_f32_16x16x16_bf16 v[128:131], a[190:191], v[24:25], v[128:131]
    v_mfma_f32_16x16x16_bf16 v[132:135], a[200:201], v[24:25], v[132:135]
    v_mfma_f32_16x16x32_bf16 v[160:163], a[240:243], v[26:29], 0
    v_mfma_f32_16x16x32_bf16 v[164:167], a[250:253], v[30:33], 0
    v_mfma_f32_16x16x32_bf16 v[140:143], a[208:211], v[26:29], 0
    v_mfma_f32_16x16x32_bf16 v[144:147], a[212:215], v[26:29], 0
    v_mfma_f32_16x16x32_bf16 v[148:151], a[220:223], v[26:29], 0
    v_mfma_f32_16x16x32_bf16 v[152:155], a[228:231], v[30:33], 0
    v_mfma_f32_16x16x32_bf16 v[156:159], a[234:237], v[30:33], 0
    v_mfma_f32_16x16x32_bf16 v[160:163], a[244:247], v[30:33], v[160:163]
    v_mfma_f32_16x16x32_bf16 v[144:147], a[216:219], v[30:33], v[144:147]
    v_mfma_f32_16x16x32_bf16 v[148:151], a[224:227], v[30:33], v[148:151]
    v_mfma_f32_16x16x16_bf16 v[164:167], a[254:255], v[34:35], v[164:167]
    s_nop 0
    v_mfma_f32_16x16x16_bf16 v[152:155], a[232:233], v[34:35], v[152:155]
    v_mfma_f32_16x16x16_bf16 v[156:159], a[238:239], v[34:35], v[156:159]
    v_mfma_f32_16x16x16_bf16 v[160:163], a[248:249], v[34:35], v[160:163]
    v_add_f32 v132, s54, v132
    v_add_f32 v133, s54, v133
    v_add_f32 v134, s54, v134
    v_add_f32 v135, s54, v135
    v_add_f32 v136, s54, v136
    v_rcp_f32 v132, v132
    v_rcp_f32 v133, v133
    v_rcp_f32 v134, v134
    v_rcp_f32 v135, v135
    v_rcp_f32 v136, v136
    v_mul_f32 v112, v112, v132
    v_mul_f32 v113, v113, v132
    v_mul_f32 v114, v114, v132
    v_mul_f32 v115, v115, v132
    v_cvt_pk_bf16_f32 v168, v112, v113
    v_cvt_pk_bf16_f32 v169, v114, v115
    v_mul_f32 v116, v116, v133
    v_mul_f32 v117, v117, v133
    v_mul_f32 v118, v118, v133
    v_mul_f32 v119, v119, v133
    v_cvt_pk_bf16_f32 v170, v116, v117
    v_cvt_pk_bf16_f32 v171, v118, v119
    v_mul_f32 v120, v120, v134
    v_mul_f32 v121, v121, v134
    v_mul_f32 v122, v122, v134
    v_mul_f32 v123, v123, v134
    v_cvt_pk_bf16_f32 v172, v120, v121
    v_cvt_pk_bf16_f32 v173, v122, v123
    v_mul_f32 v124, v124, v135
    v_mul_f32 v125, v125, v135
    v_mul_f32 v126, v126, v135
    v_mul_f32 v127, v127, v135
    v_cvt_pk_bf16_f32 v174, v124, v125
    v_cvt_pk_bf16_f32 v175, v126, v127
    v_mul_f32 v128, v128, v136
    v_mul_f32 v129, v129, v136
    v_mul_f32 v130, v130, v136
    v_mul_f32 v131, v131, v136
    v_cvt_pk_bf16_f32 v176, v128, v129
    v_cvt_pk_bf16_f32 v177, v130, v131
    v_add_f32 v160, s54, v160
    v_add_f32 v161, s54, v161
    v_add_f32 v162, s54, v162
    v_add_f32 v163, s54, v163
    v_add_f32 v164, s54, v164
    v_rcp_f32 v160, v160
    v_rcp_f32 v161, v161
    v_rcp_f32 v162, v162
    v_rcp_f32 v163, v163
    v_rcp_f32 v164, v164
    v_mul_f32 v140, v140, v160
    v_mul_f32 v141, v141, v160
    v_mul_f32 v142, v142, v160
    v_mul_f32 v143, v143, v160
    v_cvt_pk_bf16_f32 v178, v140, v141
    v_cvt_pk_bf16_f32 v179, v142, v143
    v_mul_f32 v144, v144, v161
    v_mul_f32 v145, v145, v161
    v_mul_f32 v146, v146, v161
    v_mul_f32 v147, v147, v161
    v_cvt_pk_bf16_f32 v180, v144, v145
    v_cvt_pk_bf16_f32 v181, v146, v147
    v_mul_f32 v148, v148, v162
    v_mul_f32 v149, v149, v162
    v_mul_f32 v150, v150, v162
    v_mul_f32 v151, v151, v162
    v_cvt_pk_bf16_f32 v182, v148, v149
    v_cvt_pk_bf16_f32 v183, v150, v151
    v_mul_f32 v152, v152, v163
    v_mul_f32 v153, v153, v163
    v_mul_f32 v154, v154, v163
    v_mul_f32 v155, v155, v163
    v_cvt_pk_bf16_f32 v184, v152, v153
    v_cvt_pk_bf16_f32 v185, v154, v155
    v_mul_f32 v156, v156, v164
    v_mul_f32 v157, v157, v164
    v_mul_f32 v158, v158, v164
    v_mul_f32 v159, v159, v164
    v_cvt_pk_bf16_f32 v186, v156, v157
    v_cvt_pk_bf16_f32 v187, v158, v159
    v_mfma_f32_16x16x32_bf16 v[132:135], a[192:195], v[36:39], 0
    v_mfma_f32_16x16x32_bf16 v[136:139], a[202:205], v[40:43], 0
    v_mfma_f32_16x16x32_bf16 v[112:115], a[160:163], v[36:39], 0
    v_mfma_f32_16x16x32_bf16 v[116:119], a[164:167], v[36:39], 0
    v_mfma_f32_16x16x32_bf16 v[120:123], a[172:175], v[36:39], 0
    v_mfma_f32_16x16x32_bf16 v[124:127], a[180:183], v[40:43], 0
    v_mfma_f32_16x16x32_bf16 v[128:131], a[186:189], v[40:43], 0
    v_mfma_f32_16x16x32_bf16 v[132:135], a[196:199], v[40:43], v[132:135]
    v_mfma_f32_16x16x32_bf16 v[116:119], a[168:171], v[40:43], v[116:119]
    v_mfma_f32_16x16x32_bf16 v[120:123], a[176:179], v[40:43], v[120:123]
    v_mfma_f32_16x16x16_bf16 v[136:139], a[206:207], v[44:45], v[136:139]
    s_nop 0
    v_mfma_f32_16x16x16_bf16 v[124:127], a[184:185], v[44:45], v[124:127]
    v_mfma_f32_16x16x16_bf16 v[128:131], a[190:191], v[44:45], v[128:131]
    v_mfma_f32_16x16x16_bf16 v[132:135], a[200:201], v[44:45], v[132:135]
    v_mfma_f32_16x16x32_bf16 v[160:163], a[240:243], v[46:49], 0
    v_mfma_f32_16x16x32_bf16 v[164:167], a[250:253], v[50:53], 0
    v_mfma_f32_16x16x32_bf16 v[140:143], a[208:211], v[46:49], 0
    v_mfma_f32_16x16x32_bf16 v[144:147], a[212:215], v[46:49], 0
    v_mfma_f32_16x16x32_bf16 v[148:151], a[220:223], v[46:49], 0
    v_mfma_f32_16x16x32_bf16 v[152:155], a[228:231], v[50:53], 0
    v_mfma_f32_16x16x32_bf16 v[156:159], a[234:237], v[50:53], 0
    v_mfma_f32_16x16x32_bf16 v[160:163], a[244:247], v[50:53], v[160:163]
    v_mfma_f32_16x16x32_bf16 v[144:147], a[216:219], v[50:53], v[144:147]
    v_mfma_f32_16x16x32_bf16 v[148:151], a[224:227], v[50:53], v[148:151]
    v_mfma_f32_16x16x16_bf16 v[164:167], a[254:255], v[54:55], v[164:167]
    s_nop 0
    v_mfma_f32_16x16x16_bf16 v[152:155], a[232:233], v[54:55], v[152:155]
    v_mfma_f32_16x16x16_bf16 v[156:159], a[238:239], v[54:55], v[156:159]
    v_mfma_f32_16x16x16_bf16 v[160:163], a[248:249], v[54:55], v[160:163]
    v_add_f32 v132, s54, v132
    v_add_f32 v133, s54, v133
    v_add_f32 v134, s54, v134
    v_add_f32 v135, s54, v135
    v_add_f32 v136, s54, v136
    v_rcp_f32 v132, v132
    v_rcp_f32 v133, v133
    v_rcp_f32 v134, v134
    v_rcp_f32 v135, v135
    v_rcp_f32 v136, v136
    v_mul_f32 v112, v112, v132
    v_mul_f32 v113, v113, v132
    v_mul_f32 v114, v114, v132
    v_mul_f32 v115, v115, v132
    v_cvt_pk_bf16_f32 v188, v112, v113
    v_cvt_pk_bf16_f32 v189, v114, v115
    v_mul_f32 v116, v116, v133
    v_mul_f32 v117, v117, v133
    v_mul_f32 v118, v118, v133
    v_mul_f32 v119, v119, v133
    v_cvt_pk_bf16_f32 v190, v116, v117
    v_cvt_pk_bf16_f32 v191, v118, v119
    v_mul_f32 v120, v120, v134
    v_mul_f32 v121, v121, v134
    v_mul_f32 v122, v122, v134
    v_mul_f32 v123, v123, v134
    v_cvt_pk_bf16_f32 v192, v120, v121
    v_cvt_pk_bf16_f32 v193, v122, v123
    v_mul_f32 v124, v124, v135
    v_mul_f32 v125, v125, v135
    v_mul_f32 v126, v126, v135
    v_mul_f32 v127, v127, v135
    v_cvt_pk_bf16_f32 v194, v124, v125
    v_cvt_pk_bf16_f32 v195, v126, v127
    v_mul_f32 v128, v128, v136
    v_mul_f32 v129, v129, v136
    v_mul_f32 v130, v130, v136
    v_mul_f32 v131, v131, v136
    v_cvt_pk_bf16_f32 v196, v128, v129
    v_cvt_pk_bf16_f32 v197, v130, v131
    v_add_f32 v160, s54, v160
    v_add_f32 v161, s54, v161
    v_add_f32 v162, s54, v162
    v_add_f32 v163, s54, v163
    v_add_f32 v164, s54, v164
    v_rcp_f32 v160, v160
    v_rcp_f32 v161, v161
    v_rcp_f32 v162, v162
    v_rcp_f32 v163, v163
    v_rcp_f32 v164, v164
    v_mul_f32 v140, v140, v160
    v_mul_f32 v141, v141, v160
    v_mul_f32 v142, v142, v160
    v_mul_f32 v143, v143, v160
    v_cvt_pk_bf16_f32 v198, v140, v141
    v_cvt_pk_bf16_f32 v199, v142, v143
    v_mul_f32 v144, v144, v161
    v_mul_f32 v145, v145, v161
    v_mul_f32 v146, v146, v161
    v_mul_f32 v147, v147, v161
    v_cvt_pk_bf16_f32 v200, v144, v145
    v_cvt_pk_bf16_f32 v201, v146, v147
    v_mul_f32 v148, v148, v162
    v_mul_f32 v149, v149, v162
    v_mul_f32 v150, v150, v162
    v_mul_f32 v151, v151, v162
    v_cvt_pk_bf16_f32 v202, v148, v149
    v_cvt_pk_bf16_f32 v203, v150, v151
    v_mul_f32 v152, v152, v163
    v_mul_f32 v153, v153, v163
    v_mul_f32 v154, v154, v163
    v_mul_f32 v155, v155, v163
    v_cvt_pk_bf16_f32 v204, v152, v153
    v_cvt_pk_bf16_f32 v205, v154, v155
    v_mul_f32 v156, v156, v164
    v_mul_f32 v157, v157, v164
    v_mul_f32 v158, v158, v164
    v_mul_f32 v159, v159, v164
    v_cvt_pk_bf16_f32 v206, v156, v157
    v_cvt_pk_bf16_f32 v207, v158, v159
    v_add_u32 v14, s42, v13
    ds_write_b128 v14, v[168:171] offset:0
    ds_write_b128 v14, v[172:175] offset:1024
    ds_write_b128 v14, v[176:179] offset:2048
    ds_write_b128 v14, v[180:183] offset:3072
    ds_write_b128 v14, v[184:187] offset:4096
    ds_write_b128 v14, v[188:191] offset:20480
    ds_write_b128 v14, v[192:195] offset:21504
    ds_write_b128 v14, v[196:199] offset:22528
    ds_write_b128 v14, v[200:203] offset:23552
    ds_write_b128 v14, v[204:207] offset:24576
    s_waitcnt lgkmcnt(0)
    s_barrier
interleave_layers__linear_attn_block__memory_aug_recurrent_mem_tr__prompt_kernel_k3_seg:
    v_add_u32 v15, s42, v5
    ds_read_b128 v[208:211], v15 offset:0
    ds_read_b128 v[212:215], v15 offset:20480
    ds_read_b128 v[216:219], v15 offset:1024
    ds_read_b128 v[220:223], v15 offset:21504
    ds_read_b128 v[224:227], v15 offset:2048
    ds_read_b128 v[228:231], v15 offset:22528
    ds_read_b128 v[232:235], v15 offset:3072
    ds_read_b128 v[236:239], v15 offset:23552
    s_waitcnt lgkmcnt(6)
    v_mfma_f32_16x16x32_bf16 v[240:243], a[0:3], v[208:211], 0
    v_mfma_f32_16x16x32_bf16 v[244:247], a[4:7], v[208:211], 0
    v_mfma_f32_16x16x32_bf16 v[248:251], a[0:3], v[212:215], 0
    v_mfma_f32_16x16x32_bf16 v[252:255], a[4:7], v[212:215], 0
    ds_read_b128 v[208:211], v15 offset:4096
    ds_read_b128 v[212:215], v15 offset:24576
    s_waitcnt lgkmcnt(6)
    v_mfma_f32_16x16x32_bf16 v[240:243], a[8:11], v[216:219], v[240:243]
    v_mfma_f32_16x16x32_bf16 v[244:247], a[12:15], v[216:219], v[244:247]
    v_mfma_f32_16x16x32_bf16 v[248:251], a[8:11], v[220:223], v[248:251]
    v_mfma_f32_16x16x32_bf16 v[252:255], a[12:15], v[220:223], v[252:255]
    ds_read_b128 v[216:219], v15 offset:5120
    ds_read_b128 v[220:223], v15 offset:25600
    s_waitcnt lgkmcnt(6)
    v_mfma_f32_16x16x32_bf16 v[240:243], a[16:19], v[224:227], v[240:243]
    v_mfma_f32_16x16x32_bf16 v[244:247], a[20:23], v[224:227], v[244:247]
    v_mfma_f32_16x16x32_bf16 v[248:251], a[16:19], v[228:231], v[248:251]
    v_mfma_f32_16x16x32_bf16 v[252:255], a[20:23], v[228:231], v[252:255]
    ds_read_b128 v[224:227], v15 offset:6144
    ds_read_b128 v[228:231], v15 offset:26624
    s_waitcnt lgkmcnt(6)
    v_mfma_f32_16x16x32_bf16 v[240:243], a[24:27], v[232:235], v[240:243]
    v_mfma_f32_16x16x32_bf16 v[244:247], a[28:31], v[232:235], v[244:247]
    v_mfma_f32_16x16x32_bf16 v[248:251], a[24:27], v[236:239], v[248:251]
    v_mfma_f32_16x16x32_bf16 v[252:255], a[28:31], v[236:239], v[252:255]
    ds_read_b128 v[232:235], v15 offset:7168
    ds_read_b128 v[236:239], v15 offset:27648
    s_waitcnt lgkmcnt(6)
    v_mfma_f32_16x16x32_bf16 v[240:243], a[32:35], v[208:211], v[240:243]
    v_mfma_f32_16x16x32_bf16 v[244:247], a[36:39], v[208:211], v[244:247]
    v_mfma_f32_16x16x32_bf16 v[248:251], a[32:35], v[212:215], v[248:251]
    v_mfma_f32_16x16x32_bf16 v[252:255], a[36:39], v[212:215], v[252:255]
    ds_read_b128 v[208:211], v15 offset:8192
    ds_read_b128 v[212:215], v15 offset:28672
    s_waitcnt lgkmcnt(6)
    v_mfma_f32_16x16x32_bf16 v[240:243], a[40:43], v[216:219], v[240:243]
    v_mfma_f32_16x16x32_bf16 v[244:247], a[44:47], v[216:219], v[244:247]
    v_mfma_f32_16x16x32_bf16 v[248:251], a[40:43], v[220:223], v[248:251]
    v_mfma_f32_16x16x32_bf16 v[252:255], a[44:47], v[220:223], v[252:255]
    ds_read_b128 v[216:219], v15 offset:9216
    ds_read_b128 v[220:223], v15 offset:29696
    s_waitcnt lgkmcnt(6)
    v_mfma_f32_16x16x32_bf16 v[240:243], a[48:51], v[224:227], v[240:243]
    v_mfma_f32_16x16x32_bf16 v[244:247], a[52:55], v[224:227], v[244:247]
    v_mfma_f32_16x16x32_bf16 v[248:251], a[48:51], v[228:231], v[248:251]
    v_mfma_f32_16x16x32_bf16 v[252:255], a[52:55], v[228:231], v[252:255]
    ds_read_b128 v[224:227], v15 offset:10240
    ds_read_b128 v[228:231], v15 offset:30720
    s_waitcnt lgkmcnt(6)
    v_mfma_f32_16x16x32_bf16 v[240:243], a[56:59], v[232:235], v[240:243]
    v_mfma_f32_16x16x32_bf16 v[244:247], a[60:63], v[232:235], v[244:247]
    v_mfma_f32_16x16x32_bf16 v[248:251], a[56:59], v[236:239], v[248:251]
    v_mfma_f32_16x16x32_bf16 v[252:255], a[60:63], v[236:239], v[252:255]
    ds_read_b128 v[232:235], v15 offset:11264
    ds_read_b128 v[236:239], v15 offset:31744
    s_waitcnt lgkmcnt(6)
    v_mfma_f32_16x16x32_bf16 v[240:243], a[64:67], v[208:211], v[240:243]
    v_mfma_f32_16x16x32_bf16 v[244:247], a[68:71], v[208:211], v[244:247]
    v_mfma_f32_16x16x32_bf16 v[248:251], a[64:67], v[212:215], v[248:251]
    v_mfma_f32_16x16x32_bf16 v[252:255], a[68:71], v[212:215], v[252:255]
    ds_read_b128 v[208:211], v15 offset:12288
    ds_read_b128 v[212:215], v15 offset:32768
    s_waitcnt lgkmcnt(6)
    v_mfma_f32_16x16x32_bf16 v[240:243], a[72:75], v[216:219], v[240:243]
    v_mfma_f32_16x16x32_bf16 v[244:247], a[76:79], v[216:219], v[244:247]
    v_mfma_f32_16x16x32_bf16 v[248:251], a[72:75], v[220:223], v[248:251]
    v_mfma_f32_16x16x32_bf16 v[252:255], a[76:79], v[220:223], v[252:255]
    ds_read_b128 v[216:219], v15 offset:13312
    ds_read_b128 v[220:223], v15 offset:33792
    s_waitcnt lgkmcnt(6)
    v_mfma_f32_16x16x32_bf16 v[240:243], a[80:83], v[224:227], v[240:243]
    v_mfma_f32_16x16x32_bf16 v[244:247], a[84:87], v[224:227], v[244:247]
    v_mfma_f32_16x16x32_bf16 v[248:251], a[80:83], v[228:231], v[248:251]
    v_mfma_f32_16x16x32_bf16 v[252:255], a[84:87], v[228:231], v[252:255]
    ds_read_b128 v[224:227], v15 offset:14336
    ds_read_b128 v[228:231], v15 offset:34816
    s_waitcnt lgkmcnt(6)
    v_mfma_f32_16x16x32_bf16 v[240:243], a[88:91], v[232:235], v[240:243]
    v_mfma_f32_16x16x32_bf16 v[244:247], a[92:95], v[232:235], v[244:247]
    v_mfma_f32_16x16x32_bf16 v[248:251], a[88:91], v[236:239], v[248:251]
    v_mfma_f32_16x16x32_bf16 v[252:255], a[92:95], v[236:239], v[252:255]
    ds_read_b128 v[232:235], v15 offset:15360
    ds_read_b128 v[236:239], v15 offset:35840
    s_waitcnt lgkmcnt(6)
    v_mfma_f32_16x16x32_bf16 v[240:243], a[96:99], v[208:211], v[240:243]
    v_mfma_f32_16x16x32_bf16 v[244:247], a[100:103], v[208:211], v[244:247]
    v_mfma_f32_16x16x32_bf16 v[248:251], a[96:99], v[212:215], v[248:251]
    v_mfma_f32_16x16x32_bf16 v[252:255], a[100:103], v[212:215], v[252:255]
    ds_read_b128 v[208:211], v15 offset:16384
    ds_read_b128 v[212:215], v15 offset:36864
    s_waitcnt lgkmcnt(6)
    v_mfma_f32_16x16x32_bf16 v[240:243], a[104:107], v[216:219], v[240:243]
    v_mfma_f32_16x16x32_bf16 v[244:247], a[108:111], v[216:219], v[244:247]
    v_mfma_f32_16x16x32_bf16 v[248:251], a[104:107], v[220:223], v[248:251]
    v_mfma_f32_16x16x32_bf16 v[252:255], a[108:111], v[220:223], v[252:255]
    ds_read_b128 v[216:219], v15 offset:17408
    ds_read_b128 v[220:223], v15 offset:37888
    s_waitcnt lgkmcnt(6)
    v_mfma_f32_16x16x32_bf16 v[240:243], a[112:115], v[224:227], v[240:243]
    v_mfma_f32_16x16x32_bf16 v[244:247], a[116:119], v[224:227], v[244:247]
    v_mfma_f32_16x16x32_bf16 v[248:251], a[112:115], v[228:231], v[248:251]
    v_mfma_f32_16x16x32_bf16 v[252:255], a[116:119], v[228:231], v[252:255]
    ds_read_b128 v[224:227], v15 offset:18432
    ds_read_b128 v[228:231], v15 offset:38912
    s_waitcnt lgkmcnt(6)
    v_mfma_f32_16x16x32_bf16 v[240:243], a[120:123], v[232:235], v[240:243]
    v_mfma_f32_16x16x32_bf16 v[244:247], a[124:127], v[232:235], v[244:247]
    v_mfma_f32_16x16x32_bf16 v[248:251], a[120:123], v[236:239], v[248:251]
    v_mfma_f32_16x16x32_bf16 v[252:255], a[124:127], v[236:239], v[252:255]
    ds_read_b128 v[232:235], v15 offset:19456
    ds_read_b128 v[236:239], v15 offset:39936
    s_waitcnt lgkmcnt(6)
    v_mfma_f32_16x16x32_bf16 v[240:243], a[128:131], v[208:211], v[240:243]
    v_mfma_f32_16x16x32_bf16 v[244:247], a[132:135], v[208:211], v[244:247]
    v_mfma_f32_16x16x32_bf16 v[248:251], a[128:131], v[212:215], v[248:251]
    v_mfma_f32_16x16x32_bf16 v[252:255], a[132:135], v[212:215], v[252:255]
    s_waitcnt lgkmcnt(4)
    v_mfma_f32_16x16x32_bf16 v[240:243], a[136:139], v[216:219], v[240:243]
    v_mfma_f32_16x16x32_bf16 v[244:247], a[140:143], v[216:219], v[244:247]
    v_mfma_f32_16x16x32_bf16 v[248:251], a[136:139], v[220:223], v[248:251]
    v_mfma_f32_16x16x32_bf16 v[252:255], a[140:143], v[220:223], v[252:255]
    s_waitcnt lgkmcnt(2)
    v_mfma_f32_16x16x32_bf16 v[240:243], a[144:147], v[224:227], v[240:243]
    v_mfma_f32_16x16x32_bf16 v[244:247], a[148:151], v[224:227], v[244:247]
    v_mfma_f32_16x16x32_bf16 v[248:251], a[144:147], v[228:231], v[248:251]
    v_mfma_f32_16x16x32_bf16 v[252:255], a[148:151], v[228:231], v[252:255]
    s_waitcnt lgkmcnt(0)
    v_mfma_f32_16x16x32_bf16 v[240:243], a[152:155], v[232:235], v[240:243]
    v_mfma_f32_16x16x32_bf16 v[244:247], a[156:159], v[232:235], v[244:247]
    v_mfma_f32_16x16x32_bf16 v[248:251], a[152:155], v[236:239], v[248:251]
    v_mfma_f32_16x16x32_bf16 v[252:255], a[156:159], v[236:239], v[252:255]
    s_nop 4
    v_cvt_pk_bf16_f32 v208, v240, v241
    v_cvt_pk_bf16_f32 v209, v242, v243
    v_lshlrev_b32 v210, 16, v208
    v_and_b32 v211, 0xffff0000, v208
    v_lshlrev_b32 v212, 16, v96
    v_and_b32 v213, 0xffff0000, v96
    v_pk_add_f32 v[210:211], v[210:211], v[212:213]
    v_cvt_pk_bf16_f32 v216, v210, v211
    v_lshlrev_b32 v210, 16, v209
    v_and_b32 v211, 0xffff0000, v209
    v_lshlrev_b32 v212, 16, v97
    v_and_b32 v213, 0xffff0000, v97
    v_pk_add_f32 v[210:211], v[210:211], v[212:213]
    v_cvt_pk_bf16_f32 v217, v210, v211
    v_cvt_pk_bf16_f32 v208, v244, v245
    v_cvt_pk_bf16_f32 v209, v246, v247
    v_lshlrev_b32 v210, 16, v208
    v_and_b32 v211, 0xffff0000, v208
    v_lshlrev_b32 v212, 16, v98
    v_and_b32 v213, 0xffff0000, v98
    v_pk_add_f32 v[210:211], v[210:211], v[212:213]
    v_cvt_pk_bf16_f32 v218, v210, v211
    v_lshlrev_b32 v210, 16, v209
    v_and_b32 v211, 0xffff0000, v209
    v_lshlrev_b32 v212, 16, v99
    v_and_b32 v213, 0xffff0000, v99
    v_pk_add_f32 v[210:211], v[210:211], v[212:213]
    v_cvt_pk_bf16_f32 v219, v210, v211
    v_cvt_pk_bf16_f32 v208, v248, v249
    v_cvt_pk_bf16_f32 v209, v250, v251
    v_lshlrev_b32 v210, 16, v208
    v_and_b32 v211, 0xffff0000, v208
    v_lshlrev_b32 v212, 16, v100
    v_and_b32 v213, 0xffff0000, v100
    v_pk_add_f32 v[210:211], v[210:211], v[212:213]
    v_cvt_pk_bf16_f32 v220, v210, v211
    v_lshlrev_b32 v210, 16, v209
    v_and_b32 v211, 0xffff0000, v209
    v_lshlrev_b32 v212, 16, v101
    v_and_b32 v213, 0xffff0000, v101
    v_pk_add_f32 v[210:211], v[210:211], v[212:213]
    v_cvt_pk_bf16_f32 v221, v210, v211
    v_cvt_pk_bf16_f32 v208, v252, v253
    v_cvt_pk_bf16_f32 v209, v254, v255
    v_lshlrev_b32 v210, 16, v208
    v_and_b32 v211, 0xffff0000, v208
    v_lshlrev_b32 v212, 16, v102
    v_and_b32 v213, 0xffff0000, v102
    v_pk_add_f32 v[210:211], v[210:211], v[212:213]
    v_cvt_pk_bf16_f32 v222, v210, v211
    v_lshlrev_b32 v210, 16, v209
    v_and_b32 v211, 0xffff0000, v209
    v_lshlrev_b32 v212, 16, v103
    v_and_b32 v213, 0xffff0000, v103
    v_pk_add_f32 v[210:211], v[210:211], v[212:213]
    v_cvt_pk_bf16_f32 v223, v210, v211
    s_add_u32 s25, s43, 20480
    buffer_store_dwordx4 v[216:219], v12, s[8:11], s43 offen sc1
    buffer_store_dwordx4 v[220:223], v12, s[8:11], s25 offen sc1
    s_add_u32 s40, s40, 1
    s_add_u32 s43, s43, s77
    s_cmp_ge_u32 s40, s76
    s_cbranch_scc1 interleave_layers__linear_attn_block__memory_aug_recurrent_mem_tr__prompt_kernel_k3_done
    s_cmp_eq_u32 s40, 1
    s_cbranch_scc0 interleave_layers__linear_attn_block__memory_aug_recurrent_mem_tr__prompt_kernel_k3q10
    s_waitcnt vmcnt(0)
    s_barrier
    s_lshl_b32 s24, s92, 10
    s_lshl_b32 s25, s78, 2
    s_add_u32 s24, s24, s25
    s_add_u32 s24, s24, 23105536
    s_cmp_eq_u32 s3, 0
    s_cbranch_scc0 interleave_layers__linear_attn_block__memory_aug_recurrent_mem_tr__prompt_kernel_pb11
    v_lshlrev_b32 v14, 7, v1
    v_add_u32 v14, s24, v14
    v_mov_b32 v15, 2146435072
    v_cmp_le_u32 vcc, 8, v1
    s_nop 1
    v_cndmask_b32 v14, v14, v15, vcc
    v_mov_b32 v15, s40
    buffer_store_dword v15, v14, s[8:11], 0 offen sc1
interleave_layers__linear_attn_block__memory_aug_recurrent_mem_tr__prompt_kernel_pb11:
interleave_layers__linear_attn_block__memory_aug_recurrent_mem_tr__prompt_kernel_k3q10:
    s_xor_b32 s42, s42, 40960
    s_waitcnt vmcnt(2)
    v_mfma_f32_16x16x32_bf16 v[132:135], a[192:195], v[56:59], 0
    v_mfma_f32_16x16x32_bf16 v[136:139], a[202:205], v[60:63], 0
    v_mfma_f32_16x16x32_bf16 v[112:115], a[160:163], v[56:59], 0
    v_mfma_f32_16x16x32_bf16 v[116:119], a[164:167], v[56:59], 0
    v_mfma_f32_16x16x32_bf16 v[120:123], a[172:175], v[56:59], 0
    v_mfma_f32_16x16x32_bf16 v[124:127], a[180:183], v[60:63], 0
    v_mfma_f32_16x16x32_bf16 v[128:131], a[186:189], v[60:63], 0
    v_mfma_f32_16x16x32_bf16 v[132:135], a[196:199], v[60:63], v[132:135]
    v_mfma_f32_16x16x32_bf16 v[116:119], a[168:171], v[60:63], v[116:119]
    v_mfma_f32_16x16x32_bf16 v[120:123], a[176:179], v[60:63], v[120:123]
    v_mfma_f32_16x16x16_bf16 v[136:139], a[206:207], v[64:65], v[136:139]
    s_nop 0
    v_mfma_f32_16x16x16_bf16 v[124:127], a[184:185], v[64:65], v[124:127]
    v_mfma_f32_16x16x16_bf16 v[128:131], a[190:191], v[64:65], v[128:131]
    v_mfma_f32_16x16x16_bf16 v[132:135], a[200:201], v[64:65], v[132:135]
    v_mfma_f32_16x16x32_bf16 v[160:163], a[240:243], v[66:69], 0
    v_mfma_f32_16x16x32_bf16 v[164:167], a[250:253], v[70:73], 0
    v_mfma_f32_16x16x32_bf16 v[140:143], a[208:211], v[66:69], 0
    v_mfma_f32_16x16x32_bf16 v[144:147], a[212:215], v[66:69], 0
    v_mfma_f32_16x16x32_bf16 v[148:151], a[220:223], v[66:69], 0
    v_mfma_f32_16x16x32_bf16 v[152:155], a[228:231], v[70:73], 0
    v_mfma_f32_16x16x32_bf16 v[156:159], a[234:237], v[70:73], 0
    v_mfma_f32_16x16x32_bf16 v[160:163], a[244:247], v[70:73], v[160:163]
    v_mfma_f32_16x16x32_bf16 v[144:147], a[216:219], v[70:73], v[144:147]
    v_mfma_f32_16x16x32_bf16 v[148:151], a[224:227], v[70:73], v[148:151]
    v_mfma_f32_16x16x16_bf16 v[164:167], a[254:255], v[74:75], v[164:167]
    s_nop 0
    v_mfma_f32_16x16x16_bf16 v[152:155], a[232:233], v[74:75], v[152:155]
    v_mfma_f32_16x16x16_bf16 v[156:159], a[238:239], v[74:75], v[156:159]
    v_mfma_f32_16x16x16_bf16 v[160:163], a[248:249], v[74:75], v[160:163]
    v_add_f32 v132, s54, v132
    v_add_f32 v133, s54, v133
    v_add_f32 v134, s54, v134
    v_add_f32 v135, s54, v135
    v_add_f32 v136, s54, v136
    v_rcp_f32 v132, v132
    v_rcp_f32 v133, v133
    v_rcp_f32 v134, v134
    v_rcp_f32 v135, v135
    v_rcp_f32 v136, v136
    v_mul_f32 v112, v112, v132
    v_mul_f32 v113, v113, v132
    v_mul_f32 v114, v114, v132
    v_mul_f32 v115, v115, v132
    v_cvt_pk_bf16_f32 v168, v112, v113
    v_cvt_pk_bf16_f32 v169, v114, v115
    v_mul_f32 v116, v116, v133
    v_mul_f32 v117, v117, v133
    v_mul_f32 v118, v118, v133
    v_mul_f32 v119, v119, v133
    v_cvt_pk_bf16_f32 v170, v116, v117
    v_cvt_pk_bf16_f32 v171, v118, v119
    v_mul_f32 v120, v120, v134
    v_mul_f32 v121, v121, v134
    v_mul_f32 v122, v122, v134
    v_mul_f32 v123, v123, v134
    v_cvt_pk_bf16_f32 v172, v120, v121
    v_cvt_pk_bf16_f32 v173, v122, v123
    v_mul_f32 v124, v124, v135
    v_mul_f32 v125, v125, v135
    v_mul_f32 v126, v126, v135
    v_mul_f32 v127, v127, v135
    v_cvt_pk_bf16_f32 v174, v124, v125
    v_cvt_pk_bf16_f32 v175, v126, v127
    v_mul_f32 v128, v128, v136
    v_mul_f32 v129, v129, v136
    v_mul_f32 v130, v130, v136
    v_mul_f32 v131, v131, v136
    v_cvt_pk_bf16_f32 v176, v128, v129
    v_cvt_pk_bf16_f32 v177, v130, v131
    v_add_f32 v160, s54, v160
    v_add_f32 v161, s54, v161
    v_add_f32 v162, s54, v162
    v_add_f32 v163, s54, v163
    v_add_f32 v164, s54, v164
    v_rcp_f32 v160, v160
    v_rcp_f32 v161, v161
    v_rcp_f32 v162, v162
    v_rcp_f32 v163, v163
    v_rcp_f32 v164, v164
    v_mul_f32 v140, v140, v160
    v_mul_f32 v141, v141, v160
    v_mul_f32 v142, v142, v160
    v_mul_f32 v143, v143, v160
    v_cvt_pk_bf16_f32 v178, v140, v141
    v_cvt_pk_bf16_f32 v179, v142, v143
    v_mul_f32 v144, v144, v161
    v_mul_f32 v145, v145, v161
    v_mul_f32 v146, v146, v161
    v_mul_f32 v147, v147, v161
    v_cvt_pk_bf16_f32 v180, v144, v145
    v_cvt_pk_bf16_f32 v181, v146, v147
    v_mul_f32 v148, v148, v162
    v_mul_f32 v149, v149, v162
    v_mul_f32 v150, v150, v162
    v_mul_f32 v151, v151, v162
    v_cvt_pk_bf16_f32 v182, v148, v149
    v_cvt_pk_bf16_f32 v183, v150, v151
    v_mul_f32 v152, v152, v163
    v_mul_f32 v153, v153, v163
    v_mul_f32 v154, v154, v163
    v_mul_f32 v155, v155, v163
    v_cvt_pk_bf16_f32 v184, v152, v153
    v_cvt_pk_bf16_f32 v185, v154, v155
    v_mul_f32 v156, v156, v164
    v_mul_f32 v157, v157, v164
    v_mul_f32 v158, v158, v164
    v_mul_f32 v159, v159, v164
    v_cvt_pk_bf16_f32 v186, v156, v157
    v_cvt_pk_bf16_f32 v187, v158, v159
    v_mfma_f32_16x16x32_bf16 v[132:135], a[192:195], v[76:79], 0
    v_mfma_f32_16x16x32_bf16 v[136:139], a[202:205], v[80:83], 0
    v_mfma_f32_16x16x32_bf16 v[112:115], a[160:163], v[76:79], 0
    v_mfma_f32_16x16x32_bf16 v[116:119], a[164:167], v[76:79], 0
    v_mfma_f32_16x16x32_bf16 v[120:123], a[172:175], v[76:79], 0
    v_mfma_f32_16x16x32_bf16 v[124:127], a[180:183], v[80:83], 0
    v_mfma_f32_16x16x32_bf16 v[128:131], a[186:189], v[80:83], 0
    v_mfma_f32_16x16x32_bf16 v[132:135], a[196:199], v[80:83], v[132:135]
    v_mfma_f32_16x16x32_bf16 v[116:119], a[168:171], v[80:83], v[116:119]
    v_mfma_f32_16x16x32_bf16 v[120:123], a[176:179], v[80:83], v[120:123]
    v_mfma_f32_16x16x16_bf16 v[136:139], a[206:207], v[84:85], v[136:139]
    s_nop 0
    v_mfma_f32_16x16x16_bf16 v[124:127], a[184:185], v[84:85], v[124:127]
    v_mfma_f32_16x16x16_bf16 v[128:131], a[190:191], v[84:85], v[128:131]
    v_mfma_f32_16x16x16_bf16 v[132:135], a[200:201], v[84:85], v[132:135]
    v_mfma_f32_16x16x32_bf16 v[160:163], a[240:243], v[86:89], 0
    v_mfma_f32_16x16x32_bf16 v[164:167], a[250:253], v[90:93], 0
    v_mfma_f32_16x16x32_bf16 v[140:143], a[208:211], v[86:89], 0
    v_mfma_f32_16x16x32_bf16 v[144:147], a[212:215], v[86:89], 0
    v_mfma_f32_16x16x32_bf16 v[148:151], a[220:223], v[86:89], 0
    v_mfma_f32_16x16x32_bf16 v[152:155], a[228:231], v[90:93], 0
    v_mfma_f32_16x16x32_bf16 v[156:159], a[234:237], v[90:93], 0
    v_mfma_f32_16x16x32_bf16 v[160:163], a[244:247], v[90:93], v[160:163]
    v_mfma_f32_16x16x32_bf16 v[144:147], a[216:219], v[90:93], v[144:147]
    v_mfma_f32_16x16x32_bf16 v[148:151], a[224:227], v[90:93], v[148:151]
    v_mfma_f32_16x16x16_bf16 v[164:167], a[254:255], v[94:95], v[164:167]
    s_nop 0
    v_mfma_f32_16x16x16_bf16 v[152:155], a[232:233], v[94:95], v[152:155]
    v_mfma_f32_16x16x16_bf16 v[156:159], a[238:239], v[94:95], v[156:159]
    v_mfma_f32_16x16x16_bf16 v[160:163], a[248:249], v[94:95], v[160:163]
    v_add_f32 v132, s54, v132
    v_add_f32 v133, s54, v133
    v_add_f32 v134, s54, v134
    v_add_f32 v135, s54, v135
    v_add_f32 v136, s54, v136
    v_rcp_f32 v132, v132
    v_rcp_f32 v133, v133
    v_rcp_f32 v134, v134
    v_rcp_f32 v135, v135
    v_rcp_f32 v136, v136
    v_mul_f32 v112, v112, v132
    v_mul_f32 v113, v113, v132
    v_mul_f32 v114, v114, v132
    v_mul_f32 v115, v115, v132
    v_cvt_pk_bf16_f32 v188, v112, v113
    v_cvt_pk_bf16_f32 v189, v114, v115
    v_mul_f32 v116, v116, v133
    v_mul_f32 v117, v117, v133
    v_mul_f32 v118, v118, v133
    v_mul_f32 v119, v119, v133
    v_cvt_pk_bf16_f32 v190, v116, v117
    v_cvt_pk_bf16_f32 v191, v118, v119
    v_mul_f32 v120, v120, v134
    v_mul_f32 v121, v121, v134
    v_mul_f32 v122, v122, v134
    v_mul_f32 v123, v123, v134
    v_cvt_pk_bf16_f32 v192, v120, v121
    v_cvt_pk_bf16_f32 v193, v122, v123
    v_mul_f32 v124, v124, v135
    v_mul_f32 v125, v125, v135
    v_mul_f32 v126, v126, v135
    v_mul_f32 v127, v127, v135
    v_cvt_pk_bf16_f32 v194, v124, v125
    v_cvt_pk_bf16_f32 v195, v126, v127
    v_mul_f32 v128, v128, v136
    v_mul_f32 v129, v129, v136
    v_mul_f32 v130, v130, v136
    v_mul_f32 v131, v131, v136
    v_cvt_pk_bf16_f32 v196, v128, v129
    v_cvt_pk_bf16_f32 v197, v130, v131
    v_add_f32 v160, s54, v160
    v_add_f32 v161, s54, v161
    v_add_f32 v162, s54, v162
    v_add_f32 v163, s54, v163
    v_add_f32 v164, s54, v164
    v_rcp_f32 v160, v160
    v_rcp_f32 v161, v161
    v_rcp_f32 v162, v162
    v_rcp_f32 v163, v163
    v_rcp_f32 v164, v164
    v_mul_f32 v140, v140, v160
    v_mul_f32 v141, v141, v160
    v_mul_f32 v142, v142, v160
    v_mul_f32 v143, v143, v160
    v_cvt_pk_bf16_f32 v198, v140, v141
    v_cvt_pk_bf16_f32 v199, v142, v143
    v_mul_f32 v144, v144, v161
    v_mul_f32 v145, v145, v161
    v_mul_f32 v146, v146, v161
    v_mul_f32 v147, v147, v161
    v_cvt_pk_bf16_f32 v200, v144, v145
    v_cvt_pk_bf16_f32 v201, v146, v147
    v_mul_f32 v148, v148, v162
    v_mul_f32 v149, v149, v162
    v_mul_f32 v150, v150, v162
    v_mul_f32 v151, v151, v162
    v_cvt_pk_bf16_f32 v202, v148, v149
    v_cvt_pk_bf16_f32 v203, v150, v151
    v_mul_f32 v152, v152, v163
    v_mul_f32 v153, v153, v163
    v_mul_f32 v154, v154, v163
    v_mul_f32 v155, v155, v163
    v_cvt_pk_bf16_f32 v204, v152, v153
    v_cvt_pk_bf16_f32 v205, v154, v155
    v_mul_f32 v156, v156, v164
    v_mul_f32 v157, v157, v164
    v_mul_f32 v158, v158, v164
    v_mul_f32 v159, v159, v164
    v_cvt_pk_bf16_f32 v206, v156, v157
    v_cvt_pk_bf16_f32 v207, v158, v159
    v_add_u32 v14, s42, v13
    ds_write_b128 v14, v[168:171] offset:0
    ds_write_b128 v14, v[172:175] offset:1024
    ds_write_b128 v14, v[176:179] offset:2048
    ds_write_b128 v14, v[180:183] offset:3072
    ds_write_b128 v14, v[184:187] offset:4096
    ds_write_b128 v14, v[188:191] offset:20480
    ds_write_b128 v14, v[192:195] offset:21504
    ds_write_b128 v14, v[196:199] offset:22528
    ds_write_b128 v14, v[200:203] offset:23552
    ds_write_b128 v14, v[204:207] offset:24576
    s_add_u32 s41, s43, s77
    s_add_u32 s24, s40, 1
    s_cmp_lt_u32 s24, s76
    s_cselect_b32 s41, s41, 2146435072
    s_waitcnt vmcnt(0)
    s_add_u32 s25, s41, 20480
    buffer_load_dwordx4 v[16:19], v8, s[8:11], s41 offen offset:0 sc1
    buffer_load_dwordx4 v[20:23], v8, s[8:11], s41 offen offset:1024 sc1
    buffer_load_dwordx2 v[24:25], v9, s[8:11], s41 offen offset:0 sc1
    buffer_load_dwordx4 v[26:29], v8, s[8:11], s41 offen offset:2560 sc1
    buffer_load_dwordx4 v[30:33], v8, s[8:11], s41 offen offset:3584 sc1
    buffer_load_dwordx2 v[34:35], v9, s[8:11], s41 offen offset:2560 sc1
    buffer_load_dwordx4 v[36:39], v8, s[8:11], s25 offen offset:0 sc1
    buffer_load_dwordx4 v[40:43], v8, s[8:11], s25 offen offset:1024 sc1
    buffer_load_dwordx2 v[44:45], v9, s[8:11], s25 offen offset:0 sc1
    buffer_load_dwordx4 v[46:49], v8, s[8:11], s25 offen offset:2560 sc1
    buffer_load_dwordx4 v[50:53], v8, s[8:11], s25 offen offset:3584 sc1
    buffer_load_dwordx2 v[54:55], v9, s[8:11], s25 offen offset:2560 sc1
    buffer_load_dwordx2 v[96:97], v10, s[16:19], s41 offen sc1
    buffer_load_dwordx2 v[98:99], v11, s[16:19], s41 offen sc1
    buffer_load_dwordx2 v[100:101], v10, s[16:19], s25 offen sc1
    buffer_load_dwordx2 v[102:103], v11, s[16:19], s25 offen sc1
    s_waitcnt lgkmcnt(0)
    s_barrier
    s_lshl_b32 s24, s92, 10
    s_lshl_b32 s25, s78, 2
    s_add_u32 s24, s24, s25
    s_add_u32 s24, s24, 23105536
    s_cmp_eq_u32 s3, 0
    s_cbranch_scc0 interleave_layers__linear_attn_block__memory_aug_recurrent_mem_tr__prompt_kernel_pb12
    v_lshlrev_b32 v14, 7, v1
    v_add_u32 v14, s24, v14
    v_mov_b32 v15, 2146435072
    v_cmp_le_u32 vcc, 8, v1
    s_nop 1
    v_cndmask_b32 v14, v14, v15, vcc
    v_mov_b32 v15, s40
    buffer_store_dword v15, v14, s[8:11], 0 offen sc1
interleave_layers__linear_attn_block__memory_aug_recurrent_mem_tr__prompt_kernel_pb12:
    v_add_u32 v15, s42, v5
    ds_read_b128 v[208:211], v15 offset:0
    ds_read_b128 v[212:215], v15 offset:20480
    ds_read_b128 v[216:219], v15 offset:1024
    ds_read_b128 v[220:223], v15 offset:21504
    ds_read_b128 v[224:227], v15 offset:2048
    ds_read_b128 v[228:231], v15 offset:22528
    ds_read_b128 v[232:235], v15 offset:3072
    ds_read_b128 v[236:239], v15 offset:23552
    s_waitcnt lgkmcnt(6)
    v_mfma_f32_16x16x32_bf16 v[240:243], a[0:3], v[208:211], 0
    v_mfma_f32_16x16x32_bf16 v[244:247], a[4:7], v[208:211], 0
    v_mfma_f32_16x16x32_bf16 v[248:251], a[0:3], v[212:215], 0
    v_mfma_f32_16x16x32_bf16 v[252:255], a[4:7], v[212:215], 0
    ds_read_b128 v[208:211], v15 offset:4096
    ds_read_b128 v[212:215], v15 offset:24576
    s_waitcnt lgkmcnt(6)
    v_mfma_f32_16x16x32_bf16 v[240:243], a[8:11], v[216:219], v[240:243]
    v_mfma_f32_16x16x32_bf16 v[244:247], a[12:15], v[216:219], v[244:247]
    v_mfma_f32_16x16x32_bf16 v[248:251], a[8:11], v[220:223], v[248:251]
    v_mfma_f32_16x16x32_bf16 v[252:255], a[12:15], v[220:223], v[252:255]
    ds_read_b128 v[216:219], v15 offset:5120
    ds_read_b128 v[220:223], v15 offset:25600
    s_waitcnt lgkmcnt(6)
    v_mfma_f32_16x16x32_bf16 v[240:243], a[16:19], v[224:227], v[240:243]
    v_mfma_f32_16x16x32_bf16 v[244:247], a[20:23], v[224:227], v[244:247]
    v_mfma_f32_16x16x32_bf16 v[248:251], a[16:19], v[228:231], v[248:251]
    v_mfma_f32_16x16x32_bf16 v[252:255], a[20:23], v[228:231], v[252:255]
    ds_read_b128 v[224:227], v15 offset:6144
    ds_read_b128 v[228:231], v15 offset:26624
    s_waitcnt lgkmcnt(6)
    v_mfma_f32_16x16x32_bf16 v[240:243], a[24:27], v[232:235], v[240:243]
    v_mfma_f32_16x16x32_bf16 v[244:247], a[28:31], v[232:235], v[244:247]
    v_mfma_f32_16x16x32_bf16 v[248:251], a[24:27], v[236:239], v[248:251]
    v_mfma_f32_16x16x32_bf16 v[252:255], a[28:31], v[236:239], v[252:255]
    ds_read_b128 v[232:235], v15 offset:7168
    ds_read_b128 v[236:239], v15 offset:27648
    s_waitcnt lgkmcnt(6)
    v_mfma_f32_16x16x32_bf16 v[240:243], a[32:35], v[208:211], v[240:243]
    v_mfma_f32_16x16x32_bf16 v[244:247], a[36:39], v[208:211], v[244:247]
    v_mfma_f32_16x16x32_bf16 v[248:251], a[32:35], v[212:215], v[248:251]
    v_mfma_f32_16x16x32_bf16 v[252:255], a[36:39], v[212:215], v[252:255]
    ds_read_b128 v[208:211], v15 offset:8192
    ds_read_b128 v[212:215], v15 offset:28672
    s_waitcnt lgkmcnt(6)
    v_mfma_f32_16x16x32_bf16 v[240:243], a[40:43], v[216:219], v[240:243]
    v_mfma_f32_16x16x32_bf16 v[244:247], a[44:47], v[216:219], v[244:247]
    v_mfma_f32_16x16x32_bf16 v[248:251], a[40:43], v[220:223], v[248:251]
    v_mfma_f32_16x16x32_bf16 v[252:255], a[44:47], v[220:223], v[252:255]
    ds_read_b128 v[216:219], v15 offset:9216
    ds_read_b128 v[220:223], v15 offset:29696
    s_waitcnt lgkmcnt(6)
    v_mfma_f32_16x16x32_bf16 v[240:243], a[48:51], v[224:227], v[240:243]
    v_mfma_f32_16x16x32_bf16 v[244:247], a[52:55], v[224:227], v[244:247]
    v_mfma_f32_16x16x32_bf16 v[248:251], a[48:51], v[228:231], v[248:251]
    v_mfma_f32_16x16x32_bf16 v[252:255], a[52:55], v[228:231], v[252:255]
    ds_read_b128 v[224:227], v15 offset:10240
    ds_read_b128 v[228:231], v15 offset:30720
    s_waitcnt lgkmcnt(6)
    v_mfma_f32_16x16x32_bf16 v[240:243], a[56:59], v[232:235], v[240:243]
    v_mfma_f32_16x16x32_bf16 v[244:247], a[60:63], v[232:235], v[244:247]
    v_mfma_f32_16x16x32_bf16 v[248:251], a[56:59], v[236:239], v[248:251]
    v_mfma_f32_16x16x32_bf16 v[252:255], a[60:63], v[236:239], v[252:255]
    ds_read_b128 v[232:235], v15 offset:11264
    ds_read_b128 v[236:239], v15 offset:31744
    s_waitcnt lgkmcnt(6)
    v_mfma_f32_16x16x32_bf16 v[240:243], a[64:67], v[208:211], v[240:243]
    v_mfma_f32_16x16x32_bf16 v[244:247], a[68:71], v[208:211], v[244:247]
    v_mfma_f32_16x16x32_bf16 v[248:251], a[64:67], v[212:215], v[248:251]
    v_mfma_f32_16x16x32_bf16 v[252:255], a[68:71], v[212:215], v[252:255]
    ds_read_b128 v[208:211], v15 offset:12288
    ds_read_b128 v[212:215], v15 offset:32768
    s_waitcnt lgkmcnt(6)
    v_mfma_f32_16x16x32_bf16 v[240:243], a[72:75], v[216:219], v[240:243]
    v_mfma_f32_16x16x32_bf16 v[244:247], a[76:79], v[216:219], v[244:247]
    v_mfma_f32_16x16x32_bf16 v[248:251], a[72:75], v[220:223], v[248:251]
    v_mfma_f32_16x16x32_bf16 v[252:255], a[76:79], v[220:223], v[252:255]
    ds_read_b128 v[216:219], v15 offset:13312
    ds_read_b128 v[220:223], v15 offset:33792
    s_waitcnt lgkmcnt(6)
    v_mfma_f32_16x16x32_bf16 v[240:243], a[80:83], v[224:227], v[240:243]
    v_mfma_f32_16x16x32_bf16 v[244:247], a[84:87], v[224:227], v[244:247]
    v_mfma_f32_16x16x32_bf16 v[248:251], a[80:83], v[228:231], v[248:251]
    v_mfma_f32_16x16x32_bf16 v[252:255], a[84:87], v[228:231], v[252:255]
    ds_read_b128 v[224:227], v15 offset:14336
    ds_read_b128 v[228:231], v15 offset:34816
    s_waitcnt lgkmcnt(6)
    v_mfma_f32_16x16x32_bf16 v[240:243], a[88:91], v[232:235], v[240:243]
    v_mfma_f32_16x16x32_bf16 v[244:247], a[92:95], v[232:235], v[244:247]
    v_mfma_f32_16x16x32_bf16 v[248:251], a[88:91], v[236:239], v[248:251]
    v_mfma_f32_16x16x32_bf16 v[252:255], a[92:95], v[236:239], v[252:255]
    ds_read_b128 v[232:235], v15 offset:15360
    ds_read_b128 v[236:239], v15 offset:35840
    s_waitcnt lgkmcnt(6)
    v_mfma_f32_16x16x32_bf16 v[240:243], a[96:99], v[208:211], v[240:243]
    v_mfma_f32_16x16x32_bf16 v[244:247], a[100:103], v[208:211], v[244:247]
    v_mfma_f32_16x16x32_bf16 v[248:251], a[96:99], v[212:215], v[248:251]
    v_mfma_f32_16x16x32_bf16 v[252:255], a[100:103], v[212:215], v[252:255]
    ds_read_b128 v[208:211], v15 offset:16384
    ds_read_b128 v[212:215], v15 offset:36864
    s_waitcnt lgkmcnt(6)
    v_mfma_f32_16x16x32_bf16 v[240:243], a[104:107], v[216:219], v[240:243]
    v_mfma_f32_16x16x32_bf16 v[244:247], a[108:111], v[216:219], v[244:247]
    v_mfma_f32_16x16x32_bf16 v[248:251], a[104:107], v[220:223], v[248:251]
    v_mfma_f32_16x16x32_bf16 v[252:255], a[108:111], v[220:223], v[252:255]
    ds_read_b128 v[216:219], v15 offset:17408
    ds_read_b128 v[220:223], v15 offset:37888
    s_waitcnt lgkmcnt(6)
    v_mfma_f32_16x16x32_bf16 v[240:243], a[112:115], v[224:227], v[240:243]
    v_mfma_f32_16x16x32_bf16 v[244:247], a[116:119], v[224:227], v[244:247]
    v_mfma_f32_16x16x32_bf16 v[248:251], a[112:115], v[228:231], v[248:251]
    v_mfma_f32_16x16x32_bf16 v[252:255], a[116:119], v[228:231], v[252:255]
    ds_read_b128 v[224:227], v15 offset:18432
    ds_read_b128 v[228:231], v15 offset:38912
    s_waitcnt lgkmcnt(6)
    v_mfma_f32_16x16x32_bf16 v[240:243], a[120:123], v[232:235], v[240:243]
    v_mfma_f32_16x16x32_bf16 v[244:247], a[124:127], v[232:235], v[244:247]
    v_mfma_f32_16x16x32_bf16 v[248:251], a[120:123], v[236:239], v[248:251]
    v_mfma_f32_16x16x32_bf16 v[252:255], a[124:127], v[236:239], v[252:255]
    ds_read_b128 v[232:235], v15 offset:19456
    ds_read_b128 v[236:239], v15 offset:39936
    s_waitcnt lgkmcnt(6)
    v_mfma_f32_16x16x32_bf16 v[240:243], a[128:131], v[208:211], v[240:243]
    v_mfma_f32_16x16x32_bf16 v[244:247], a[132:135], v[208:211], v[244:247]
    v_mfma_f32_16x16x32_bf16 v[248:251], a[128:131], v[212:215], v[248:251]
    v_mfma_f32_16x16x32_bf16 v[252:255], a[132:135], v[212:215], v[252:255]
    s_waitcnt lgkmcnt(4)
    v_mfma_f32_16x16x32_bf16 v[240:243], a[136:139], v[216:219], v[240:243]
    v_mfma_f32_16x16x32_bf16 v[244:247], a[140:143], v[216:219], v[244:247]
    v_mfma_f32_16x16x32_bf16 v[248:251], a[136:139], v[220:223], v[248:251]
    v_mfma_f32_16x16x32_bf16 v[252:255], a[140:143], v[220:223], v[252:255]
    s_waitcnt lgkmcnt(2)
    v_mfma_f32_16x16x32_bf16 v[240:243], a[144:147], v[224:227], v[240:243]
    v_mfma_f32_16x16x32_bf16 v[244:247], a[148:151], v[224:227], v[244:247]
    v_mfma_f32_16x16x32_bf16 v[248:251], a[144:147], v[228:231], v[248:251]
    v_mfma_f32_16x16x32_bf16 v[252:255], a[148:151], v[228:231], v[252:255]
    s_waitcnt lgkmcnt(0)
    v_mfma_f32_16x16x32_bf16 v[240:243], a[152:155], v[232:235], v[240:243]
    v_mfma_f32_16x16x32_bf16 v[244:247], a[156:159], v[232:235], v[244:247]
    v_mfma_f32_16x16x32_bf16 v[248:251], a[152:155], v[236:239], v[248:251]
    v_mfma_f32_16x16x32_bf16 v[252:255], a[156:159], v[236:239], v[252:255]
    s_nop 4
    v_cvt_pk_bf16_f32 v208, v240, v241
    v_cvt_pk_bf16_f32 v209, v242, v243
    v_lshlrev_b32 v210, 16, v208
    v_and_b32 v211, 0xffff0000, v208
    v_lshlrev_b32 v212, 16, v104
    v_and_b32 v213, 0xffff0000, v104
    v_pk_add_f32 v[210:211], v[210:211], v[212:213]
    v_cvt_pk_bf16_f32 v216, v210, v211
    v_lshlrev_b32 v210, 16, v209
    v_and_b32 v211, 0xffff0000, v209
    v_lshlrev_b32 v212, 16, v105
    v_and_b32 v213, 0xffff0000, v105
    v_pk_add_f32 v[210:211], v[210:211], v[212:213]
    v_cvt_pk_bf16_f32 v217, v210, v211
    v_cvt_pk_bf16_f32 v208, v244, v245
    v_cvt_pk_bf16_f32 v209, v246, v247
    v_lshlrev_b32 v210, 16, v208
    v_and_b32 v211, 0xffff0000, v208
    v_lshlrev_b32 v212, 16, v106
    v_and_b32 v213, 0xffff0000, v106
    v_pk_add_f32 v[210:211], v[210:211], v[212:213]
    v_cvt_pk_bf16_f32 v218, v210, v211
    v_lshlrev_b32 v210, 16, v209
    v_and_b32 v211, 0xffff0000, v209
    v_lshlrev_b32 v212, 16, v107
    v_and_b32 v213, 0xffff0000, v107
    v_pk_add_f32 v[210:211], v[210:211], v[212:213]
    v_cvt_pk_bf16_f32 v219, v210, v211
    v_cvt_pk_bf16_f32 v208, v248, v249
    v_cvt_pk_bf16_f32 v209, v250, v251
    v_lshlrev_b32 v210, 16, v208
    v_and_b32 v211, 0xffff0000, v208
    v_lshlrev_b32 v212, 16, v108
    v_and_b32 v213, 0xffff0000, v108
    v_pk_add_f32 v[210:211], v[210:211], v[212:213]
    v_cvt_pk_bf16_f32 v220, v210, v211
    v_lshlrev_b32 v210, 16, v209
    v_and_b32 v211, 0xffff0000, v209
    v_lshlrev_b32 v212, 16, v109
    v_and_b32 v213, 0xffff0000, v109
    v_pk_add_f32 v[210:211], v[210:211], v[212:213]
    v_cvt_pk_bf16_f32 v221, v210, v211
    v_cvt_pk_bf16_f32 v208, v252, v253
    v_cvt_pk_bf16_f32 v209, v254, v255
    v_lshlrev_b32 v210, 16, v208
    v_and_b32 v211, 0xffff0000, v208
    v_lshlrev_b32 v212, 16, v110
    v_and_b32 v213, 0xffff0000, v110
    v_pk_add_f32 v[210:211], v[210:211], v[212:213]
    v_cvt_pk_bf16_f32 v222, v210, v211
    v_lshlrev_b32 v210, 16, v209
    v_and_b32 v211, 0xffff0000, v209
    v_lshlrev_b32 v212, 16, v111
    v_and_b32 v213, 0xffff0000, v111
    v_pk_add_f32 v[210:211], v[210:211], v[212:213]
    v_cvt_pk_bf16_f32 v223, v210, v211
    s_add_u32 s25, s43, 20480
    buffer_store_dwordx4 v[216:219], v12, s[8:11], s43 offen sc1
    buffer_store_dwordx4 v[220:223], v12, s[8:11], s25 offen sc1
    s_add_u32 s40, s40, 1
    s_add_u32 s43, s43, s77
    s_cmp_ge_u32 s40, s76
    s_cbranch_scc1 interleave_layers__linear_attn_block__memory_aug_recurrent_mem_tr__prompt_kernel_k3_done
    s_xor_b32 s42, s42, 40960
    s_waitcnt vmcnt(2)
    v_mfma_f32_16x16x32_bf16 v[132:135], a[192:195], v[16:19], 0
    v_mfma_f32_16x16x32_bf16 v[136:139], a[202:205], v[20:23], 0
    v_mfma_f32_16x16x32_bf16 v[112:115], a[160:163], v[16:19], 0
    v_mfma_f32_16x16x32_bf16 v[116:119], a[164:167], v[16:19], 0
    v_mfma_f32_16x16x32_bf16 v[120:123], a[172:175], v[16:19], 0
    v_mfma_f32_16x16x32_bf16 v[124:127], a[180:183], v[20:23], 0
    v_mfma_f32_16x16x32_bf16 v[128:131], a[186:189], v[20:23], 0
    v_mfma_f32_16x16x32_bf16 v[132:135], a[196:199], v[20:23], v[132:135]
    v_mfma_f32_16x16x32_bf16 v[116:119], a[168:171], v[20:23], v[116:119]
    v_mfma_f32_16x16x32_bf16 v[120:123], a[176:179], v[20:23], v[120:123]
    v_mfma_f32_16x16x16_bf16 v[136:139], a[206:207], v[24:25], v[136:139]
    s_nop 0
    v_mfma_f32_16x16x16_bf16 v[124:127], a[184:185], v[24:25], v[124:127]
    v_mfma_f32_16x16x16_bf16 v[128:131], a[190:191], v[24:25], v[128:131]
    v_mfma_f32_16x16x16_bf16 v[132:135], a[200:201], v[24:25], v[132:135]
    v_mfma_f32_16x16x32_bf16 v[160:163], a[240:243], v[26:29], 0
    v_mfma_f32_16x16x32_bf16 v[164:167], a[250:253], v[30:33], 0
    v_mfma_f32_16x16x32_bf16 v[140:143], a[208:211], v[26:29], 0
    v_mfma_f32_16x16x32_bf16 v[144:147], a[212:215], v[26:29], 0
    v_mfma_f32_16x16x32_bf16 v[148:151], a[220:223], v[26:29], 0
    v_mfma_f32_16x16x32_bf16 v[152:155], a[228:231], v[30:33], 0
    v_mfma_f32_16x16x32_bf16 v[156:159], a[234:237], v[30:33], 0
    v_mfma_f32_16x16x32_bf16 v[160:163], a[244:247], v[30:33], v[160:163]
    v_mfma_f32_16x16x32_bf16 v[144:147], a[216:219], v[30:33], v[144:147]
    v_mfma_f32_16x16x32_bf16 v[148:151], a[224:227], v[30:33], v[148:151]
    v_mfma_f32_16x16x16_bf16 v[164:167], a[254:255], v[34:35], v[164:167]
    s_nop 0
    v_mfma_f32_16x16x16_bf16 v[152:155], a[232:233], v[34:35], v[152:155]
    v_mfma_f32_16x16x16_bf16 v[156:159], a[238:239], v[34:35], v[156:159]
    v_mfma_f32_16x16x16_bf16 v[160:163], a[248:249], v[34:35], v[160:163]
    v_add_f32 v132, s54, v132
    v_add_f32 v133, s54, v133
    v_add_f32 v134, s54, v134
    v_add_f32 v135, s54, v135
    v_add_f32 v136, s54, v136
    v_rcp_f32 v132, v132
    v_rcp_f32 v133, v133
    v_rcp_f32 v134, v134
    v_rcp_f32 v135, v135
    v_rcp_f32 v136, v136
    v_mul_f32 v112, v112, v132
    v_mul_f32 v113, v113, v132
    v_mul_f32 v114, v114, v132
    v_mul_f32 v115, v115, v132
    v_cvt_pk_bf16_f32 v168, v112, v113
    v_cvt_pk_bf16_f32 v169, v114, v115
    v_mul_f32 v116, v116, v133
    v_mul_f32 v117, v117, v133
    v_mul_f32 v118, v118, v133
    v_mul_f32 v119, v119, v133
    v_cvt_pk_bf16_f32 v170, v116, v117
    v_cvt_pk_bf16_f32 v171, v118, v119
    v_mul_f32 v120, v120, v134
    v_mul_f32 v121, v121, v134
    v_mul_f32 v122, v122, v134
    v_mul_f32 v123, v123, v134
    v_cvt_pk_bf16_f32 v172, v120, v121
    v_cvt_pk_bf16_f32 v173, v122, v123
    v_mul_f32 v124, v124, v135
    v_mul_f32 v125, v125, v135
    v_mul_f32 v126, v126, v135
    v_mul_f32 v127, v127, v135
    v_cvt_pk_bf16_f32 v174, v124, v125
    v_cvt_pk_bf16_f32 v175, v126, v127
    v_mul_f32 v128, v128, v136
    v_mul_f32 v129, v129, v136
    v_mul_f32 v130, v130, v136
    v_mul_f32 v131, v131, v136
    v_cvt_pk_bf16_f32 v176, v128, v129
    v_cvt_pk_bf16_f32 v177, v130, v131
    v_add_f32 v160, s54, v160
    v_add_f32 v161, s54, v161
    v_add_f32 v162, s54, v162
    v_add_f32 v163, s54, v163
    v_add_f32 v164, s54, v164
    v_rcp_f32 v160, v160
    v_rcp_f32 v161, v161
    v_rcp_f32 v162, v162
    v_rcp_f32 v163, v163
    v_rcp_f32 v164, v164
    v_mul_f32 v140, v140, v160
    v_mul_f32 v141, v141, v160
    v_mul_f32 v142, v142, v160
    v_mul_f32 v143, v143, v160
    v_cvt_pk_bf16_f32 v178, v140, v141
    v_cvt_pk_bf16_f32 v179, v142, v143
    v_mul_f32 v144, v144, v161
    v_mul_f32 v145, v145, v161
    v_mul_f32 v146, v146, v161
    v_mul_f32 v147, v147, v161
    v_cvt_pk_bf16_f32 v180, v144, v145
    v_cvt_pk_bf16_f32 v181, v146, v147
    v_mul_f32 v148, v148, v162
    v_mul_f32 v149, v149, v162
    v_mul_f32 v150, v150, v162
    v_mul_f32 v151, v151, v162
    v_cvt_pk_bf16_f32 v182, v148, v149
    v_cvt_pk_bf16_f32 v183, v150, v151
    v_mul_f32 v152, v152, v163
    v_mul_f32 v153, v153, v163
    v_mul_f32 v154, v154, v163
    v_mul_f32 v155, v155, v163
    v_cvt_pk_bf16_f32 v184, v152, v153
    v_cvt_pk_bf16_f32 v185, v154, v155
    v_mul_f32 v156, v156, v164
    v_mul_f32 v157, v157, v164
    v_mul_f32 v158, v158, v164
    v_mul_f32 v159, v159, v164
    v_cvt_pk_bf16_f32 v186, v156, v157
    v_cvt_pk_bf16_f32 v187, v158, v159
    v_mfma_f32_16x16x32_bf16 v[132:135], a[192:195], v[36:39], 0
    v_mfma_f32_16x16x32_bf16 v[136:139], a[202:205], v[40:43], 0
    v_mfma_f32_16x16x32_bf16 v[112:115], a[160:163], v[36:39], 0
    v_mfma_f32_16x16x32_bf16 v[116:119], a[164:167], v[36:39], 0
    v_mfma_f32_16x16x32_bf16 v[120:123], a[172:175], v[36:39], 0
    v_mfma_f32_16x16x32_bf16 v[124:127], a[180:183], v[40:43], 0
    v_mfma_f32_16x16x32_bf16 v[128:131], a[186:189], v[40:43], 0
    v_mfma_f32_16x16x32_bf16 v[132:135], a[196:199], v[40:43], v[132:135]
    v_mfma_f32_16x16x32_bf16 v[116:119], a[168:171], v[40:43], v[116:119]
    v_mfma_f32_16x16x32_bf16 v[120:123], a[176:179], v[40:43], v[120:123]
    v_mfma_f32_16x16x16_bf16 v[136:139], a[206:207], v[44:45], v[136:139]
    s_nop 0
    v_mfma_f32_16x16x16_bf16 v[124:127], a[184:185], v[44:45], v[124:127]
    v_mfma_f32_16x16x16_bf16 v[128:131], a[190:191], v[44:45], v[128:131]
    v_mfma_f32_16x16x16_bf16 v[132:135], a[200:201], v[44:45], v[132:135]
    v_mfma_f32_16x16x32_bf16 v[160:163], a[240:243], v[46:49], 0
    v_mfma_f32_16x16x32_bf16 v[164:167], a[250:253], v[50:53], 0
    v_mfma_f32_16x16x32_bf16 v[140:143], a[208:211], v[46:49], 0
    v_mfma_f32_16x16x32_bf16 v[144:147], a[212:215], v[46:49], 0
    v_mfma_f32_16x16x32_bf16 v[148:151], a[220:223], v[46:49], 0
    v_mfma_f32_16x16x32_bf16 v[152:155], a[228:231], v[50:53], 0
    v_mfma_f32_16x16x32_bf16 v[156:159], a[234:237], v[50:53], 0
    v_mfma_f32_16x16x32_bf16 v[160:163], a[244:247], v[50:53], v[160:163]
    v_mfma_f32_16x16x32_bf16 v[144:147], a[216:219], v[50:53], v[144:147]
    v_mfma_f32_16x16x32_bf16 v[148:151], a[224:227], v[50:53], v[148:151]
    v_mfma_f32_16x16x16_bf16 v[164:167], a[254:255], v[54:55], v[164:167]
    s_nop 0
    v_mfma_f32_16x16x16_bf16 v[152:155], a[232:233], v[54:55], v[152:155]
    v_mfma_f32_16x16x16_bf16 v[156:159], a[238:239], v[54:55], v[156:159]
    v_mfma_f32_16x16x16_bf16 v[160:163], a[248:249], v[54:55], v[160:163]
    v_add_f32 v132, s54, v132
    v_add_f32 v133, s54, v133
    v_add_f32 v134, s54, v134
    v_add_f32 v135, s54, v135
    v_add_f32 v136, s54, v136
    v_rcp_f32 v132, v132
    v_rcp_f32 v133, v133
    v_rcp_f32 v134, v134
    v_rcp_f32 v135, v135
    v_rcp_f32 v136, v136
    v_mul_f32 v112, v112, v132
    v_mul_f32 v113, v113, v132
    v_mul_f32 v114, v114, v132
    v_mul_f32 v115, v115, v132
    v_cvt_pk_bf16_f32 v188, v112, v113
    v_cvt_pk_bf16_f32 v189, v114, v115
    v_mul_f32 v116, v116, v133
    v_mul_f32 v117, v117, v133
    v_mul_f32 v118, v118, v133
    v_mul_f32 v119, v119, v133
    v_cvt_pk_bf16_f32 v190, v116, v117
    v_cvt_pk_bf16_f32 v191, v118, v119
    v_mul_f32 v120, v120, v134
    v_mul_f32 v121, v121, v134
    v_mul_f32 v122, v122, v134
    v_mul_f32 v123, v123, v134
    v_cvt_pk_bf16_f32 v192, v120, v121
    v_cvt_pk_bf16_f32 v193, v122, v123
    v_mul_f32 v124, v124, v135
    v_mul_f32 v125, v125, v135
    v_mul_f32 v126, v126, v135
    v_mul_f32 v127, v127, v135
    v_cvt_pk_bf16_f32 v194, v124, v125
    v_cvt_pk_bf16_f32 v195, v126, v127
    v_mul_f32 v128, v128, v136
    v_mul_f32 v129, v129, v136
    v_mul_f32 v130, v130, v136
    v_mul_f32 v131, v131, v136
    v_cvt_pk_bf16_f32 v196, v128, v129
    v_cvt_pk_bf16_f32 v197, v130, v131
    v_add_f32 v160, s54, v160
    v_add_f32 v161, s54, v161
    v_add_f32 v162, s54, v162
    v_add_f32 v163, s54, v163
    v_add_f32 v164, s54, v164
    v_rcp_f32 v160, v160
    v_rcp_f32 v161, v161
    v_rcp_f32 v162, v162
    v_rcp_f32 v163, v163
    v_rcp_f32 v164, v164
    v_mul_f32 v140, v140, v160
    v_mul_f32 v141, v141, v160
    v_mul_f32 v142, v142, v160
    v_mul_f32 v143, v143, v160
    v_cvt_pk_bf16_f32 v198, v140, v141
    v_cvt_pk_bf16_f32 v199, v142, v143
    v_mul_f32 v144, v144, v161
    v_mul_f32 v145, v145, v161
    v_mul_f32 v146, v146, v161
    v_mul_f32 v147, v147, v161
    v_cvt_pk_bf16_f32 v200, v144, v145
    v_cvt_pk_bf16_f32 v201, v146, v147
    v_mul_f32 v148, v148, v162
    v_mul_f32 v149, v149, v162
    v_mul_f32 v150, v150, v162
    v_mul_f32 v151, v151, v162
    v_cvt_pk_bf16_f32 v202, v148, v149
    v_cvt_pk_bf16_f32 v203, v150, v151
    v_mul_f32 v152, v152, v163
    v_mul_f32 v153, v153, v163
    v_mul_f32 v154, v154, v163
    v_mul_f32 v155, v155, v163
    v_cvt_pk_bf16_f32 v204, v152, v153
    v_cvt_pk_bf16_f32 v205, v154, v155
    v_mul_f32 v156, v156, v164
    v_mul_f32 v157, v157, v164
    v_mul_f32 v158, v158, v164
    v_mul_f32 v159, v159, v164
    v_cvt_pk_bf16_f32 v206, v156, v157
    v_cvt_pk_bf16_f32 v207, v158, v159
    v_add_u32 v14, s42, v13
    ds_write_b128 v14, v[168:171] offset:0
    ds_write_b128 v14, v[172:175] offset:1024
    ds_write_b128 v14, v[176:179] offset:2048
    ds_write_b128 v14, v[180:183] offset:3072
    ds_write_b128 v14, v[184:187] offset:4096
    ds_write_b128 v14, v[188:191] offset:20480
    ds_write_b128 v14, v[192:195] offset:21504
    ds_write_b128 v14, v[196:199] offset:22528
    ds_write_b128 v14, v[200:203] offset:23552
    ds_write_b128 v14, v[204:207] offset:24576
    s_add_u32 s41, s43, s77
    s_add_u32 s24, s40, 1
    s_cmp_lt_u32 s24, s76
    s_cselect_b32 s41, s41, 2146435072
    s_waitcnt vmcnt(0)
    s_add_u32 s25, s41, 20480
    buffer_load_dwordx4 v[56:59], v8, s[8:11], s41 offen offset:0 sc1
    buffer_load_dwordx4 v[60:63], v8, s[8:11], s41 offen offset:1024 sc1
    buffer_load_dwordx2 v[64:65], v9, s[8:11], s41 offen offset:0 sc1
    buffer_load_dwordx4 v[66:69], v8, s[8:11], s41 offen offset:2560 sc1
    buffer_load_dwordx4 v[70:73], v8, s[8:11], s41 offen offset:3584 sc1
    buffer_load_dwordx2 v[74:75], v9, s[8:11], s41 offen offset:2560 sc1
    buffer_load_dwordx4 v[76:79], v8, s[8:11], s25 offen offset:0 sc1
    buffer_load_dwordx4 v[80:83], v8, s[8:11], s25 offen offset:1024 sc1
    buffer_load_dwordx2 v[84:85], v9, s[8:11], s25 offen offset:0 sc1
    buffer_load_dwordx4 v[86:89], v8, s[8:11], s25 offen offset:2560 sc1
    buffer_load_dwordx4 v[90:93], v8, s[8:11], s25 offen offset:3584 sc1
    buffer_load_dwordx2 v[94:95], v9, s[8:11], s25 offen offset:2560 sc1
    buffer_load_dwordx2 v[104:105], v10, s[16:19], s41 offen sc1
    buffer_load_dwordx2 v[106:107], v11, s[16:19], s41 offen sc1
    buffer_load_dwordx2 v[108:109], v10, s[16:19], s25 offen sc1
    buffer_load_dwordx2 v[110:111], v11, s[16:19], s25 offen sc1
    s_waitcnt lgkmcnt(0)
    s_barrier
    s_lshl_b32 s24, s92, 10
    s_lshl_b32 s25, s78, 2
    s_add_u32 s24, s24, s25
    s_add_u32 s24, s24, 23105536
    s_cmp_eq_u32 s3, 0
    s_cbranch_scc0 interleave_layers__linear_attn_block__memory_aug_recurrent_mem_tr__prompt_kernel_pb13
    v_lshlrev_b32 v14, 7, v1
    v_add_u32 v14, s24, v14
    v_mov_b32 v15, 2146435072
    v_cmp_le_u32 vcc, 8, v1
    s_nop 1
    v_cndmask_b32 v14, v14, v15, vcc
    v_mov_b32 v15, s40
    buffer_store_dword v15, v14, s[8:11], 0 offen sc1
interleave_layers__linear_attn_block__memory_aug_recurrent_mem_tr__prompt_kernel_pb13:
    s_branch interleave_layers__linear_attn_block__memory_aug_recurrent_mem_tr__prompt_kernel_k3_seg
interleave_layers__linear_attn_block__memory_aug_recurrent_mem_tr__prompt_kernel_k3_done:
    s_waitcnt vmcnt(0)
    s_barrier
    s_lshl_b32 s24, s92, 10
    s_lshl_b32 s25, s78, 2
    s_add_u32 s24, s24, s25
    s_add_u32 s24, s24, 23105536
    s_cmp_eq_u32 s3, 0
    s_cbranch_scc0 interleave_layers__linear_attn_block__memory_aug_recurrent_mem_tr__prompt_kernel_pb14
    v_lshlrev_b32 v14, 7, v1
    v_add_u32 v14, s24, v14
    v_mov_b32 v15, 2146435072
    v_cmp_le_u32 vcc, 8, v1
    s_nop 1
    v_cndmask_b32 v14, v14, v15, vcc
    v_mov_b32 v15, s40
    buffer_store_dword v15, v14, s[8:11], 0 offen sc1
interleave_layers__linear_attn_block__memory_aug_recurrent_mem_tr__prompt_kernel_pb14:
    s_cmp_eq_u32 s92, 0
    s_cbranch_scc0 interleave_layers__linear_attn_block__memory_aug_recurrent_mem_tr__prompt_kernel_end
    s_mov_b32 s92, 1
    s_cmp_lt_u32 s2, 248
    s_cbranch_scc1 interleave_layers__linear_attn_block__memory_aug_recurrent_mem_tr__prompt_kernel_helper_k1
    s_add_u32 s16, s4, 4194304
    s_addc_u32 s17, s5, 0
    s_mov_b32 s18, 2621440
    s_mov_b32 s19, 0x00020000
    s_mov_b32 s46, 1024
    s_mov_b32 s47, 8
    s_mov_b32 s50, 1
    s_mov_b32 s58, 8388608
    s_mov_b32 s76, 64
    s_mov_b32 s77, 40960
    s_branch interleave_layers__linear_attn_block__memory_aug_recurrent_mem_tr__prompt_kernel_k3_entry
interleave_layers__linear_attn_block__memory_aug_recurrent_mem_tr__prompt_kernel_helper_k1:
    s_mov_b32 s92, 1
    s_sub_u32 s24, s2, 232
    s_add_u32 s16, s4, 4194304
    s_addc_u32 s17, s5, 0
    s_mov_b32 s18, 2621440
    s_mov_b32 s19, 0x00020000
    s_mov_b32 s46, 1024
    s_mov_b32 s47, 8
    s_mov_b32 s50, 1
    s_and_b32 s44, s24, 7
    s_lshr_b32 s45, s24, 3
    s_mov_b32 s48, s45
    s_mov_b32 s49, 2
    s_mov_b32 s40, 32
    s_branch interleave_layers__linear_attn_block__memory_aug_recurrent_mem_tr__prompt_kernel_k1_entry
interleave_layers__linear_attn_block__memory_aug_recurrent_mem_tr__prompt_kernel_helper_clr:
    s_sub_u32 s44, s2, 253
    s_lshl_b32 s24, s44, 2
    s_add_u32 s24, s24, s3
    s_mul_i32 s24, s24, 38912
    s_add_u32 s41, s24, 117440512
    v_lshlrev_b32 v5, 4, v1
    v_mov_b32 v8, -1
    v_mov_b32 v9, -1
    v_mov_b32 v10, -1
    v_mov_b32 v11, -1
    s_lshl_b32 s24, s44, 2
    s_add_u32 s42, s24, 23109632
    s_mov_b32 s40, 0
interleave_layers__linear_attn_block__memory_aug_recurrent_mem_tr__prompt_kernel_clr_blk:
    s_mov_b32 s43, s41
    buffer_store_dwordx4 v[8:11], v5, s[8:11], s43 offen offset:0 sc1
    buffer_store_dwordx4 v[8:11], v5, s[8:11], s43 offen offset:1024 sc1
    buffer_store_dwordx4 v[8:11], v5, s[8:11], s43 offen offset:2048 sc1
    buffer_store_dwordx4 v[8:11], v5, s[8:11], s43 offen offset:3072 sc1
    s_add_u32 s43, s43, 4096
    buffer_store_dwordx4 v[8:11], v5, s[8:11], s43 offen offset:0 sc1
    buffer_store_dwordx4 v[8:11], v5, s[8:11], s43 offen offset:1024 sc1
    buffer_store_dwordx4 v[8:11], v5, s[8:11], s43 offen offset:2048 sc1
    buffer_store_dwordx4 v[8:11], v5, s[8:11], s43 offen offset:3072 sc1
    s_add_u32 s43, s43, 4096
    buffer_store_dwordx4 v[8:11], v5, s[8:11], s43 offen offset:0 sc1
    buffer_store_dwordx4 v[8:11], v5, s[8:11], s43 offen offset:1024 sc1
    buffer_store_dwordx4 v[8:11], v5, s[8:11], s43 offen offset:2048 sc1
    buffer_store_dwordx4 v[8:11], v5, s[8:11], s43 offen offset:3072 sc1
    s_add_u32 s43, s43, 4096
    buffer_store_dwordx4 v[8:11], v5, s[8:11], s43 offen offset:0 sc1
    buffer_store_dwordx4 v[8:11], v5, s[8:11], s43 offen offset:1024 sc1
    buffer_store_dwordx4 v[8:11], v5, s[8:11], s43 offen offset:2048 sc1
    buffer_store_dwordx4 v[8:11], v5, s[8:11], s43 offen offset:3072 sc1
    s_add_u32 s43, s43, 4096
    buffer_store_dwordx4 v[8:11], v5, s[8:11], s43 offen offset:0 sc1
    buffer_store_dwordx4 v[8:11], v5, s[8:11], s43 offen offset:1024 sc1
    buffer_store_dwordx4 v[8:11], v5, s[8:11], s43 offen offset:2048 sc1
    buffer_store_dwordx4 v[8:11], v5, s[8:11], s43 offen offset:3072 sc1
    s_add_u32 s43, s43, 4096
    buffer_store_dwordx4 v[8:11], v5, s[8:11], s43 offen offset:0 sc1
    buffer_store_dwordx4 v[8:11], v5, s[8:11], s43 offen offset:1024 sc1
    buffer_store_dwordx4 v[8:11], v5, s[8:11], s43 offen offset:2048 sc1
    buffer_store_dwordx4 v[8:11], v5, s[8:11], s43 offen offset:3072 sc1
    s_add_u32 s43, s43, 4096
    buffer_store_dwordx4 v[8:11], v5, s[8:11], s43 offen offset:0 sc1
    buffer_store_dwordx4 v[8:11], v5, s[8:11], s43 offen offset:1024 sc1
    buffer_store_dwordx4 v[8:11], v5, s[8:11], s43 offen offset:2048 sc1
    buffer_store_dwordx4 v[8:11], v5, s[8:11], s43 offen offset:3072 sc1
    s_add_u32 s43, s43, 4096
    buffer_store_dwordx4 v[8:11], v5, s[8:11], s43 offen offset:0 sc1
    buffer_store_dwordx4 v[8:11], v5, s[8:11], s43 offen offset:1024 sc1
    buffer_store_dwordx4 v[8:11], v5, s[8:11], s43 offen offset:2048 sc1
    buffer_store_dwordx4 v[8:11], v5, s[8:11], s43 offen offset:3072 sc1
    s_add_u32 s43, s43, 4096
    buffer_store_dwordx4 v[8:11], v5, s[8:11], s43 offen offset:0 sc1
    buffer_store_dwordx4 v[8:11], v5, s[8:11], s43 offen offset:1024 sc1
    buffer_store_dwordx4 v[8:11], v5, s[8:11], s43 offen offset:2048 sc1
    buffer_store_dwordx4 v[8:11], v5, s[8:11], s43 offen offset:3072 sc1
    s_add_u32 s43, s43, 4096
    buffer_store_dwordx4 v[8:11], v5, s[8:11], s43 offen offset:0 sc1
    buffer_store_dwordx4 v[8:11], v5, s[8:11], s43 offen offset:1024 sc1
    s_waitcnt vmcnt(38)
    s_barrier
    s_cmp_eq_u32 s3, 0
    s_cbranch_scc0 interleave_layers__linear_attn_block__memory_aug_recurrent_mem_tr__prompt_kernel_pb15
    v_lshlrev_b32 v14, 7, v1
    v_add_u32 v14, s42, v14
    v_mov_b32 v15, 2146435072
    v_cmp_le_u32 vcc, 8, v1
    s_nop 1
    v_cndmask_b32 v14, v14, v15, vcc
    v_mov_b32 v15, s40
    buffer_store_dword v15, v14, s[8:11], 0 offen sc1
interleave_layers__linear_attn_block__memory_aug_recurrent_mem_tr__prompt_kernel_pb15:
    s_add_u32 s40, s40, 1
    s_add_u32 s41, s41, 458752
    s_cmp_lt_u32 s40, 128
    s_cbranch_scc1 interleave_layers__linear_attn_block__memory_aug_recurrent_mem_tr__prompt_kernel_clr_blk
    s_waitcnt vmcnt(0)
    s_barrier
    s_cmp_eq_u32 s3, 0
    s_cbranch_scc0 interleave_layers__linear_attn_block__memory_aug_recurrent_mem_tr__prompt_kernel_pb16
    v_lshlrev_b32 v14, 7, v1
    v_add_u32 v14, s42, v14
    v_mov_b32 v15, 2146435072
    v_cmp_le_u32 vcc, 8, v1
    s_nop 1
    v_cndmask_b32 v14, v14, v15, vcc
    v_mov_b32 v15, s40
    buffer_store_dword v15, v14, s[8:11], 0 offen sc1
interleave_layers__linear_attn_block__memory_aug_recurrent_mem_tr__prompt_kernel_pb16:
    s_branch interleave_layers__linear_attn_block__memory_aug_recurrent_mem_tr__prompt_kernel_end
interleave_layers__linear_attn_block__memory_aug_recurrent_mem_tr__prompt_kernel_roleS:
    s_mov_b32 s44, s2
    s_load_dwordx2 s[6:7], s[0:1], 40
    s_load_dwordx2 s[24:25], s[0:1], 48
    s_load_dwordx2 s[26:27], s[0:1], 32
    s_waitcnt lgkmcnt(0)
    s_mov_b32 s12, s6
    s_mov_b32 s13, s7
    s_mov_b32 s14, 7864320
    s_mov_b32 s15, 0x00020000
    s_mov_b32 s16, s24
    s_mov_b32 s17, s25
    s_mov_b32 s18, 7864320
    s_mov_b32 s19, 0x00020000
    s_mov_b32 s20, s26
    s_mov_b32 s21, s27
    s_mov_b32 s22, 10240
    s_mov_b32 s23, 0x00020000
    v_add_u32 v16, 0, v0
    s_mov_b32 s24, 683
    v_mul_lo_u32 v17, v16, s24
    v_lshrrev_b32 v17, 14, v17
    v_mul_u32_u24 v18, 24, v17
    v_sub_u32 v18, v16, v18
    s_mov_b32 s24, 12288
    v_mul_lo_u32 v4, v17, s24
    v_lshl_add_u32 v4, v18, 4, v4
    v_mul_u32_u24 v10, 400, v17
    v_lshl_add_u32 v10, v18, 4, v10
    v_add_u32 v10, 106496, v10
    v_add_u32 v16, 256, v0
    s_mov_b32 s24, 683
    v_mul_lo_u32 v17, v16, s24
    v_lshrrev_b32 v17, 14, v17
    v_mul_u32_u24 v18, 24, v17
    v_sub_u32 v18, v16, v18
    s_mov_b32 s24, 12288
    v_mul_lo_u32 v5, v17, s24
    v_lshl_add_u32 v5, v18, 4, v5
    v_mul_u32_u24 v11, 400, v17
    v_lshl_add_u32 v11, v18, 4, v11
    v_add_u32 v11, 106496, v11
    v_add_u32 v16, 512, v0
    s_mov_b32 s24, 683
    v_mul_lo_u32 v17, v16, s24
    v_lshrrev_b32 v17, 14, v17
    v_mul_u32_u24 v18, 24, v17
    v_sub_u32 v18, v16, v18
    s_mov_b32 s24, 12288
    v_mul_lo_u32 v6, v17, s24
    v_lshl_add_u32 v6, v18, 4, v6
    v_mul_u32_u24 v12, 400, v17
    v_lshl_add_u32 v12, v18, 4, v12
    v_add_u32 v12, 106496, v12
    v_add_u32 v16, 768, v0
    s_mov_b32 s24, 683
    v_mul_lo_u32 v17, v16, s24
    v_lshrrev_b32 v17, 14, v17
    v_mul_u32_u24 v18, 24, v17
    v_sub_u32 v18, v16, v18
    s_mov_b32 s24, 12288
    v_mul_lo_u32 v7, v17, s24
    v_lshl_add_u32 v7, v18, 4, v7
    v_mul_u32_u24 v13, 400, v17
    v_lshl_add_u32 v13, v18, 4, v13
    v_add_u32 v13, 106496, v13
    v_add_u32 v16, 1024, v0
    s_mov_b32 s24, 683
    v_mul_lo_u32 v17, v16, s24
    v_lshrrev_b32 v17, 14, v17
    v_mul_u32_u24 v18, 24, v17
    v_sub_u32 v18, v16, v18
    s_mov_b32 s24, 12288
    v_mul_lo_u32 v8, v17, s24
    v_lshl_add_u32 v8, v18, 4, v8
    v_mul_u32_u24 v14, 400, v17
    v_lshl_add_u32 v14, v18, 4, v14
    v_add_u32 v14, 106496, v14
    v_add_u32 v16, 1280, v0
    s_mov_b32 s24, 683
    v_mul_lo_u32 v17, v16, s24
    v_lshrrev_b32 v17, 14, v17
    v_mul_u32_u24 v18, 24, v17
    v_sub_u32 v18, v16, v18
    s_mov_b32 s24, 12288
    v_mul_lo_u32 v9, v17, s24
    v_lshl_add_u32 v9, v18, 4, v9
    v_mul_u32_u24 v15, 400, v17
    v_lshl_add_u32 v15, v18, 4, v15
    v_add_u32 v15, 106496, v15
    v_lshrrev_b32 v17, 1, v3
    v_lshlrev_b32 v17, 4, v17
    v_and_b32 v18, 1, v3
    v_lshl_add_u32 v17, v18, 2, v17
    v_lshrrev_b32 v18, 2, v2
    v_and_b32 v19, 1, v18
    v_add_u32 v17, v17, v19
    v_lshrrev_b32 v18, 1, v18
    v_lshl_add_u32 v17, v18, 3, v17
    v_mul_u32_u24 v16, 400, v17
    v_and_b32 v18, 3, v2
    v_lshl_add_u32 v16, v18, 3, v16
    v_add_u32 v16, 106496, v16
    s_mul_i32 s24, s3, 96
    v_add_u32 v16, s24, v16
    v_lshlrev_b32 v17, 4, v1
    s_mul_i32 s24, s3, 20480
    s_add_u32 s24, s24, 24576
    v_add_u32 v17, s24, v17
    s_mul_i32 s45, s44, 384
    s_add_u32 s46, s45, 0
    buffer_load_dwordx4 v[24:27], v4, s[12:15], s46 offen
    buffer_load_dwordx4 v[28:31], v5, s[12:15], s46 offen
    buffer_load_dwordx4 v[32:35], v6, s[12:15], s46 offen
    buffer_load_dwordx4 v[36:39], v7, s[12:15], s46 offen
    buffer_load_dwordx4 v[40:43], v8, s[12:15], s46 offen
    buffer_load_dwordx4 v[44:47], v9, s[12:15], s46 offen
    s_add_u32 s46, s45, 0
    buffer_load_dwordx4 v[48:51], v4, s[16:19], s46 offen
    buffer_load_dwordx4 v[52:55], v5, s[16:19], s46 offen
    buffer_load_dwordx4 v[56:59], v6, s[16:19], s46 offen
    buffer_load_dwordx4 v[60:63], v7, s[16:19], s46 offen
    buffer_load_dwordx4 v[64:67], v8, s[16:19], s46 offen
    buffer_load_dwordx4 v[68:71], v9, s[16:19], s46 offen
    s_waitcnt vmcnt(6)
    ds_write_b128 v10, v[24:27]
    ds_write_b128 v11, v[28:31]
    ds_write_b128 v12, v[32:35]
    ds_write_b128 v13, v[36:39]
    ds_write_b128 v14, v[40:43]
    ds_write_b128 v15, v[44:47]
    s_add_u32 s46, s45, 786432
    buffer_load_dwordx4 v[72:75], v4, s[12:15], s46 offen
    buffer_load_dwordx4 v[76:79], v5, s[12:15], s46 offen
    buffer_load_dwordx4 v[80:83], v6, s[12:15], s46 offen
    buffer_load_dwordx4 v[84:87], v7, s[12:15], s46 offen
    buffer_load_dwordx4 v[88:91], v8, s[12:15], s46 offen
    buffer_load_dwordx4 v[92:95], v9, s[12:15], s46 offen
    s_waitcnt lgkmcnt(0)
    s_barrier
    ds_read_b64_tr_b16 a[0:1], v16 offset:0
    ds_read_b64_tr_b16 a[2:3], v16 offset:800
    ds_read_b64_tr_b16 a[4:5], v16 offset:12800
    ds_read_b64_tr_b16 a[6:7], v16 offset:13600
    ds_read_b64_tr_b16 a[80:81], v16 offset:32
    ds_read_b64_tr_b16 a[82:83], v16 offset:832
    ds_read_b64_tr_b16 a[84:85], v16 offset:12832
    ds_read_b64_tr_b16 a[86:87], v16 offset:13632
    ds_read_b64_tr_b16 a[160:161], v16 offset:64
    ds_read_b64_tr_b16 a[162:163], v16 offset:864
    ds_read_b64_tr_b16 a[164:165], v16 offset:12864
    ds_read_b64_tr_b16 a[166:167], v16 offset:13664
    s_waitcnt lgkmcnt(0)
    s_barrier
    s_waitcnt vmcnt(6)
    ds_write_b128 v10, v[48:51]
    ds_write_b128 v11, v[52:55]
    ds_write_b128 v12, v[56:59]
    ds_write_b128 v13, v[60:63]
    ds_write_b128 v14, v[64:67]
    ds_write_b128 v15, v[68:71]
    s_add_u32 s46, s45, 786432
    buffer_load_dwordx4 v[24:27], v4, s[16:19], s46 offen
    buffer_load_dwordx4 v[28:31], v5, s[16:19], s46 offen
    buffer_load_dwordx4 v[32:35], v6, s[16:19], s46 offen
    buffer_load_dwordx4 v[36:39], v7, s[16:19], s46 offen
    buffer_load_dwordx4 v[40:43], v8, s[16:19], s46 offen
    buffer_load_dwordx4 v[44:47], v9, s[16:19], s46 offen
    s_waitcnt lgkmcnt(0)
    s_barrier
    ds_read_b64_tr_b16 v[96:97], v16 offset:32
    ds_read_b64_tr_b16 v[98:99], v16 offset:832
    ds_read_b64_tr_b16 v[100:101], v16 offset:12832
    ds_read_b64_tr_b16 v[102:103], v16 offset:13632
    ds_read_b64_tr_b16 v[176:177], v16 offset:64
    ds_read_b64_tr_b16 v[178:179], v16 offset:864
    ds_read_b64_tr_b16 v[180:181], v16 offset:12864
    ds_read_b64_tr_b16 v[182:183], v16 offset:13664
    ds_read_b64_tr_b16 v[48:49], v16 offset:0
    ds_read_b64_tr_b16 v[50:51], v16 offset:800
    ds_read_b64_tr_b16 v[52:53], v16 offset:12800
    ds_read_b64_tr_b16 v[54:55], v16 offset:13600
    s_waitcnt lgkmcnt(0)
    ds_write_b128 v17, v[48:51] offset:0
    ds_write_b128 v17, v[52:55] offset:1024
    s_waitcnt lgkmcnt(0)
    s_barrier
    s_waitcnt vmcnt(6)
    ds_write_b128 v10, v[72:75]
    ds_write_b128 v11, v[76:79]
    ds_write_b128 v12, v[80:83]
    ds_write_b128 v13, v[84:87]
    ds_write_b128 v14, v[88:91]
    ds_write_b128 v15, v[92:95]
    s_add_u32 s46, s45, 1572864
    buffer_load_dwordx4 v[48:51], v4, s[12:15], s46 offen
    buffer_load_dwordx4 v[52:55], v5, s[12:15], s46 offen
    buffer_load_dwordx4 v[56:59], v6, s[12:15], s46 offen
    buffer_load_dwordx4 v[60:63], v7, s[12:15], s46 offen
    buffer_load_dwordx4 v[64:67], v8, s[12:15], s46 offen
    buffer_load_dwordx4 v[68:71], v9, s[12:15], s46 offen
    s_waitcnt lgkmcnt(0)
    s_barrier
    ds_read_b64_tr_b16 a[8:9], v16 offset:0
    ds_read_b64_tr_b16 a[10:11], v16 offset:800
    ds_read_b64_tr_b16 a[12:13], v16 offset:12800
    ds_read_b64_tr_b16 a[14:15], v16 offset:13600
    ds_read_b64_tr_b16 a[88:89], v16 offset:32
    ds_read_b64_tr_b16 a[90:91], v16 offset:832
    ds_read_b64_tr_b16 a[92:93], v16 offset:12832
    ds_read_b64_tr_b16 a[94:95], v16 offset:13632
    ds_read_b64_tr_b16 a[168:169], v16 offset:64
    ds_read_b64_tr_b16 a[170:171], v16 offset:864
    ds_read_b64_tr_b16 a[172:173], v16 offset:12864
    ds_read_b64_tr_b16 a[174:175], v16 offset:13664
    s_waitcnt lgkmcnt(0)
    s_barrier
    s_waitcnt vmcnt(6)
    ds_write_b128 v10, v[24:27]
    ds_write_b128 v11, v[28:31]
    ds_write_b128 v12, v[32:35]
    ds_write_b128 v13, v[36:39]
    ds_write_b128 v14, v[40:43]
    ds_write_b128 v15, v[44:47]
    s_add_u32 s46, s45, 1572864
    buffer_load_dwordx4 v[72:75], v4, s[16:19], s46 offen
    buffer_load_dwordx4 v[76:79], v5, s[16:19], s46 offen
    buffer_load_dwordx4 v[80:83], v6, s[16:19], s46 offen
    buffer_load_dwordx4 v[84:87], v7, s[16:19], s46 offen
    buffer_load_dwordx4 v[88:91], v8, s[16:19], s46 offen
    buffer_load_dwordx4 v[92:95], v9, s[16:19], s46 offen
    s_waitcnt lgkmcnt(0)
    s_barrier
    ds_read_b64_tr_b16 v[104:105], v16 offset:32
    ds_read_b64_tr_b16 v[106:107], v16 offset:832
    ds_read_b64_tr_b16 v[108:109], v16 offset:12832
    ds_read_b64_tr_b16 v[110:111], v16 offset:13632
    ds_read_b64_tr_b16 v[184:185], v16 offset:64
    ds_read_b64_tr_b16 v[186:187], v16 offset:864
    ds_read_b64_tr_b16 v[188:189], v16 offset:12864
    ds_read_b64_tr_b16 v[190:191], v16 offset:13664
    ds_read_b64_tr_b16 v[24:25], v16 offset:0
    ds_read_b64_tr_b16 v[26:27], v16 offset:800
    ds_read_b64_tr_b16 v[28:29], v16 offset:12800
    ds_read_b64_tr_b16 v[30:31], v16 offset:13600
    s_waitcnt lgkmcnt(0)
    ds_write_b128 v17, v[24:27] offset:2048
    ds_write_b128 v17, v[28:31] offset:3072
    s_waitcnt lgkmcnt(0)
    s_barrier
    s_waitcnt vmcnt(6)
    ds_write_b128 v10, v[48:51]
    ds_write_b128 v11, v[52:55]
    ds_write_b128 v12, v[56:59]
    ds_write_b128 v13, v[60:63]
    ds_write_b128 v14, v[64:67]
    ds_write_b128 v15, v[68:71]
    s_add_u32 s46, s45, 2359296
    buffer_load_dwordx4 v[24:27], v4, s[12:15], s46 offen
    buffer_load_dwordx4 v[28:31], v5, s[12:15], s46 offen
    buffer_load_dwordx4 v[32:35], v6, s[12:15], s46 offen
    buffer_load_dwordx4 v[36:39], v7, s[12:15], s46 offen
    buffer_load_dwordx4 v[40:43], v8, s[12:15], s46 offen
    buffer_load_dwordx4 v[44:47], v9, s[12:15], s46 offen
    s_waitcnt lgkmcnt(0)
    s_barrier
    ds_read_b64_tr_b16 a[16:17], v16 offset:0
    ds_read_b64_tr_b16 a[18:19], v16 offset:800
    ds_read_b64_tr_b16 a[20:21], v16 offset:12800
    ds_read_b64_tr_b16 a[22:23], v16 offset:13600
    ds_read_b64_tr_b16 a[96:97], v16 offset:32
    ds_read_b64_tr_b16 a[98:99], v16 offset:832
    ds_read_b64_tr_b16 a[100:101], v16 offset:12832
    ds_read_b64_tr_b16 a[102:103], v16 offset:13632
    ds_read_b64_tr_b16 a[176:177], v16 offset:64
    ds_read_b64_tr_b16 a[178:179], v16 offset:864
    ds_read_b64_tr_b16 a[180:181], v16 offset:12864
    ds_read_b64_tr_b16 a[182:183], v16 offset:13664
    s_waitcnt lgkmcnt(0)
    s_barrier
    s_waitcnt vmcnt(6)
    ds_write_b128 v10, v[72:75]
    ds_write_b128 v11, v[76:79]
    ds_write_b128 v12, v[80:83]
    ds_write_b128 v13, v[84:87]
    ds_write_b128 v14, v[88:91]
    ds_write_b128 v15, v[92:95]
    s_add_u32 s46, s45, 2359296
    buffer_load_dwordx4 v[48:51], v4, s[16:19], s46 offen
    buffer_load_dwordx4 v[52:55], v5, s[16:19], s46 offen
    buffer_load_dwordx4 v[56:59], v6, s[16:19], s46 offen
    buffer_load_dwordx4 v[60:63], v7, s[16:19], s46 offen
    buffer_load_dwordx4 v[64:67], v8, s[16:19], s46 offen
    buffer_load_dwordx4 v[68:71], v9, s[16:19], s46 offen
    s_waitcnt lgkmcnt(0)
    s_barrier
    ds_read_b64_tr_b16 v[112:113], v16 offset:32
    ds_read_b64_tr_b16 v[114:115], v16 offset:832
    ds_read_b64_tr_b16 v[116:117], v16 offset:12832
    ds_read_b64_tr_b16 v[118:119], v16 offset:13632
    ds_read_b64_tr_b16 v[192:193], v16 offset:64
    ds_read_b64_tr_b16 v[194:195], v16 offset:864
    ds_read_b64_tr_b16 v[196:197], v16 offset:12864
    ds_read_b64_tr_b16 v[198:199], v16 offset:13664
    ds_read_b64_tr_b16 v[72:73], v16 offset:0
    ds_read_b64_tr_b16 v[74:75], v16 offset:800
    ds_read_b64_tr_b16 v[76:77], v16 offset:12800
    ds_read_b64_tr_b16 v[78:79], v16 offset:13600
    s_waitcnt lgkmcnt(0)
    ds_write_b128 v17, v[72:75] offset:4096
    ds_write_b128 v17, v[76:79] offset:5120
    s_waitcnt lgkmcnt(0)
    s_barrier
    s_waitcnt vmcnt(6)
    ds_write_b128 v10, v[24:27]
    ds_write_b128 v11, v[28:31]
    ds_write_b128 v12, v[32:35]
    ds_write_b128 v13, v[36:39]
    ds_write_b128 v14, v[40:43]
    ds_write_b128 v15, v[44:47]
    s_add_u32 s46, s45, 3145728
    buffer_load_dwordx4 v[72:75], v4, s[12:15], s46 offen
    buffer_load_dwordx4 v[76:79], v5, s[12:15], s46 offen
    buffer_load_dwordx4 v[80:83], v6, s[12:15], s46 offen
    buffer_load_dwordx4 v[84:87], v7, s[12:15], s46 offen
    buffer_load_dwordx4 v[88:91], v8, s[12:15], s46 offen
    buffer_load_dwordx4 v[92:95], v9, s[12:15], s46 offen
    s_waitcnt lgkmcnt(0)
    s_barrier
    ds_read_b64_tr_b16 a[24:25], v16 offset:0
    ds_read_b64_tr_b16 a[26:27], v16 offset:800
    ds_read_b64_tr_b16 a[28:29], v16 offset:12800
    ds_read_b64_tr_b16 a[30:31], v16 offset:13600
    ds_read_b64_tr_b16 a[104:105], v16 offset:32
    ds_read_b64_tr_b16 a[106:107], v16 offset:832
    ds_read_b64_tr_b16 a[108:109], v16 offset:12832
    ds_read_b64_tr_b16 a[110:111], v16 offset:13632
    ds_read_b64_tr_b16 a[184:185], v16 offset:64
    ds_read_b64_tr_b16 a[186:187], v16 offset:864
    ds_read_b64_tr_b16 a[188:189], v16 offset:12864
    ds_read_b64_tr_b16 a[190:191], v16 offset:13664
    s_waitcnt lgkmcnt(0)
    s_barrier
    s_waitcnt vmcnt(6)
    ds_write_b128 v10, v[48:51]
    ds_write_b128 v11, v[52:55]
    ds_write_b128 v12, v[56:59]
    ds_write_b128 v13, v[60:63]
    ds_write_b128 v14, v[64:67]
    ds_write_b128 v15, v[68:71]
    s_add_u32 s46, s45, 3145728
    buffer_load_dwordx4 v[24:27], v4, s[16:19], s46 offen
    buffer_load_dwordx4 v[28:31], v5, s[16:19], s46 offen
    buffer_load_dwordx4 v[32:35], v6, s[16:19], s46 offen
    buffer_load_dwordx4 v[36:39], v7, s[16:19], s46 offen
    buffer_load_dwordx4 v[40:43], v8, s[16:19], s46 offen
    buffer_load_dwordx4 v[44:47], v9, s[16:19], s46 offen
    s_waitcnt lgkmcnt(0)
    s_barrier
    ds_read_b64_tr_b16 v[120:121], v16 offset:32
    ds_read_b64_tr_b16 v[122:123], v16 offset:832
    ds_read_b64_tr_b16 v[124:125], v16 offset:12832
    ds_read_b64_tr_b16 v[126:127], v16 offset:13632
    ds_read_b64_tr_b16 v[200:201], v16 offset:64
    ds_read_b64_tr_b16 v[202:203], v16 offset:864
    ds_read_b64_tr_b16 v[204:205], v16 offset:12864
    ds_read_b64_tr_b16 v[206:207], v16 offset:13664
    ds_read_b64_tr_b16 v[48:49], v16 offset:0
    ds_read_b64_tr_b16 v[50:51], v16 offset:800
    ds_read_b64_tr_b16 v[52:53], v16 offset:12800
    ds_read_b64_tr_b16 v[54:55], v16 offset:13600
    s_waitcnt lgkmcnt(0)
    ds_write_b128 v17, v[48:51] offset:6144
    ds_write_b128 v17, v[52:55] offset:7168
    s_waitcnt lgkmcnt(0)
    s_barrier
    s_waitcnt vmcnt(6)
    ds_write_b128 v10, v[72:75]
    ds_write_b128 v11, v[76:79]
    ds_write_b128 v12, v[80:83]
    ds_write_b128 v13, v[84:87]
    ds_write_b128 v14, v[88:91]
    ds_write_b128 v15, v[92:95]
    s_add_u32 s46, s45, 3932160
    buffer_load_dwordx4 v[48:51], v4, s[12:15], s46 offen
    buffer_load_dwordx4 v[52:55], v5, s[12:15], s46 offen
    buffer_load_dwordx4 v[56:59], v6, s[12:15], s46 offen
    buffer_load_dwordx4 v[60:63], v7, s[12:15], s46 offen
    buffer_load_dwordx4 v[64:67], v8, s[12:15], s46 offen
    buffer_load_dwordx4 v[68:71], v9, s[12:15], s46 offen
    s_waitcnt lgkmcnt(0)
    s_barrier
    ds_read_b64_tr_b16 a[32:33], v16 offset:0
    ds_read_b64_tr_b16 a[34:35], v16 offset:800
    ds_read_b64_tr_b16 a[36:37], v16 offset:12800
    ds_read_b64_tr_b16 a[38:39], v16 offset:13600
    ds_read_b64_tr_b16 a[112:113], v16 offset:32
    ds_read_b64_tr_b16 a[114:115], v16 offset:832
    ds_read_b64_tr_b16 a[116:117], v16 offset:12832
    ds_read_b64_tr_b16 a[118:119], v16 offset:13632
    ds_read_b64_tr_b16 a[192:193], v16 offset:64
    ds_read_b64_tr_b16 a[194:195], v16 offset:864
    ds_read_b64_tr_b16 a[196:197], v16 offset:12864
    ds_read_b64_tr_b16 a[198:199], v16 offset:13664
    s_waitcnt lgkmcnt(0)
    s_barrier
    s_waitcnt vmcnt(6)
    ds_write_b128 v10, v[24:27]
    ds_write_b128 v11, v[28:31]
    ds_write_b128 v12, v[32:35]
    ds_write_b128 v13, v[36:39]
    ds_write_b128 v14, v[40:43]
    ds_write_b128 v15, v[44:47]
    s_add_u32 s46, s45, 3932160
    buffer_load_dwordx4 v[72:75], v4, s[16:19], s46 offen
    buffer_load_dwordx4 v[76:79], v5, s[16:19], s46 offen
    buffer_load_dwordx4 v[80:83], v6, s[16:19], s46 offen
    buffer_load_dwordx4 v[84:87], v7, s[16:19], s46 offen
    buffer_load_dwordx4 v[88:91], v8, s[16:19], s46 offen
    buffer_load_dwordx4 v[92:95], v9, s[16:19], s46 offen
    s_waitcnt lgkmcnt(0)
    s_barrier
    ds_read_b64_tr_b16 v[128:129], v16 offset:32
    ds_read_b64_tr_b16 v[130:131], v16 offset:832
    ds_read_b64_tr_b16 v[132:133], v16 offset:12832
    ds_read_b64_tr_b16 v[134:135], v16 offset:13632
    ds_read_b64_tr_b16 v[208:209], v16 offset:64
    ds_read_b64_tr_b16 v[210:211], v16 offset:864
    ds_read_b64_tr_b16 v[212:213], v16 offset:12864
    ds_read_b64_tr_b16 v[214:215], v16 offset:13664
    ds_read_b64_tr_b16 v[24:25], v16 offset:0
    ds_read_b64_tr_b16 v[26:27], v16 offset:800
    ds_read_b64_tr_b16 v[28:29], v16 offset:12800
    ds_read_b64_tr_b16 v[30:31], v16 offset:13600
    s_waitcnt lgkmcnt(0)
    ds_write_b128 v17, v[24:27] offset:8192
    ds_write_b128 v17, v[28:31] offset:9216
    s_waitcnt lgkmcnt(0)
    s_barrier
    s_waitcnt vmcnt(6)
    ds_write_b128 v10, v[48:51]
    ds_write_b128 v11, v[52:55]
    ds_write_b128 v12, v[56:59]
    ds_write_b128 v13, v[60:63]
    ds_write_b128 v14, v[64:67]
    ds_write_b128 v15, v[68:71]
    s_add_u32 s46, s45, 4718592
    buffer_load_dwordx4 v[24:27], v4, s[12:15], s46 offen
    buffer_load_dwordx4 v[28:31], v5, s[12:15], s46 offen
    buffer_load_dwordx4 v[32:35], v6, s[12:15], s46 offen
    buffer_load_dwordx4 v[36:39], v7, s[12:15], s46 offen
    buffer_load_dwordx4 v[40:43], v8, s[12:15], s46 offen
    buffer_load_dwordx4 v[44:47], v9, s[12:15], s46 offen
    s_waitcnt lgkmcnt(0)
    s_barrier
    ds_read_b64_tr_b16 a[40:41], v16 offset:0
    ds_read_b64_tr_b16 a[42:43], v16 offset:800
    ds_read_b64_tr_b16 a[44:45], v16 offset:12800
    ds_read_b64_tr_b16 a[46:47], v16 offset:13600
    ds_read_b64_tr_b16 a[120:121], v16 offset:32
    ds_read_b64_tr_b16 a[122:123], v16 offset:832
    ds_read_b64_tr_b16 a[124:125], v16 offset:12832
    ds_read_b64_tr_b16 a[126:127], v16 offset:13632
    ds_read_b64_tr_b16 a[200:201], v16 offset:64
    ds_read_b64_tr_b16 a[202:203], v16 offset:864
    ds_read_b64_tr_b16 a[204:205], v16 offset:12864
    ds_read_b64_tr_b16 a[206:207], v16 offset:13664
    s_waitcnt lgkmcnt(0)
    s_barrier
    s_waitcnt vmcnt(6)
    ds_write_b128 v10, v[72:75]
    ds_write_b128 v11, v[76:79]
    ds_write_b128 v12, v[80:83]
    ds_write_b128 v13, v[84:87]
    ds_write_b128 v14, v[88:91]
    ds_write_b128 v15, v[92:95]
    s_add_u32 s46, s45, 4718592
    buffer_load_dwordx4 v[48:51], v4, s[16:19], s46 offen
    buffer_load_dwordx4 v[52:55], v5, s[16:19], s46 offen
    buffer_load_dwordx4 v[56:59], v6, s[16:19], s46 offen
    buffer_load_dwordx4 v[60:63], v7, s[16:19], s46 offen
    buffer_load_dwordx4 v[64:67], v8, s[16:19], s46 offen
    buffer_load_dwordx4 v[68:71], v9, s[16:19], s46 offen
    s_waitcnt lgkmcnt(0)
    s_barrier
    ds_read_b64_tr_b16 v[136:137], v16 offset:32
    ds_read_b64_tr_b16 v[138:139], v16 offset:832
    ds_read_b64_tr_b16 v[140:141], v16 offset:12832
    ds_read_b64_tr_b16 v[142:143], v16 offset:13632
    ds_read_b64_tr_b16 v[216:217], v16 offset:64
    ds_read_b64_tr_b16 v[218:219], v16 offset:864
    ds_read_b64_tr_b16 v[220:221], v16 offset:12864
    ds_read_b64_tr_b16 v[222:223], v16 offset:13664
    ds_read_b64_tr_b16 v[72:73], v16 offset:0
    ds_read_b64_tr_b16 v[74:75], v16 offset:800
    ds_read_b64_tr_b16 v[76:77], v16 offset:12800
    ds_read_b64_tr_b16 v[78:79], v16 offset:13600
    s_waitcnt lgkmcnt(0)
    ds_write_b128 v17, v[72:75] offset:10240
    ds_write_b128 v17, v[76:79] offset:11264
    s_waitcnt lgkmcnt(0)
    s_barrier
    s_waitcnt vmcnt(6)
    ds_write_b128 v10, v[24:27]
    ds_write_b128 v11, v[28:31]
    ds_write_b128 v12, v[32:35]
    ds_write_b128 v13, v[36:39]
    ds_write_b128 v14, v[40:43]
    ds_write_b128 v15, v[44:47]
    s_add_u32 s46, s45, 5505024
    buffer_load_dwordx4 v[72:75], v4, s[12:15], s46 offen
    buffer_load_dwordx4 v[76:79], v5, s[12:15], s46 offen
    buffer_load_dwordx4 v[80:83], v6, s[12:15], s46 offen
    buffer_load_dwordx4 v[84:87], v7, s[12:15], s46 offen
    buffer_load_dwordx4 v[88:91], v8, s[12:15], s46 offen
    buffer_load_dwordx4 v[92:95], v9, s[12:15], s46 offen
    s_waitcnt lgkmcnt(0)
    s_barrier
    ds_read_b64_tr_b16 a[48:49], v16 offset:0
    ds_read_b64_tr_b16 a[50:51], v16 offset:800
    ds_read_b64_tr_b16 a[52:53], v16 offset:12800
    ds_read_b64_tr_b16 a[54:55], v16 offset:13600
    ds_read_b64_tr_b16 a[128:129], v16 offset:32
    ds_read_b64_tr_b16 a[130:131], v16 offset:832
    ds_read_b64_tr_b16 a[132:133], v16 offset:12832
    ds_read_b64_tr_b16 a[134:135], v16 offset:13632
    ds_read_b64_tr_b16 a[208:209], v16 offset:64
    ds_read_b64_tr_b16 a[210:211], v16 offset:864
    ds_read_b64_tr_b16 a[212:213], v16 offset:12864
    ds_read_b64_tr_b16 a[214:215], v16 offset:13664
    s_waitcnt lgkmcnt(0)
    s_barrier
    s_waitcnt vmcnt(6)
    ds_write_b128 v10, v[48:51]
    ds_write_b128 v11, v[52:55]
    ds_write_b128 v12, v[56:59]
    ds_write_b128 v13, v[60:63]
    ds_write_b128 v14, v[64:67]
    ds_write_b128 v15, v[68:71]
    s_add_u32 s46, s45, 5505024
    buffer_load_dwordx4 v[24:27], v4, s[16:19], s46 offen
    buffer_load_dwordx4 v[28:31], v5, s[16:19], s46 offen
    buffer_load_dwordx4 v[32:35], v6, s[16:19], s46 offen
    buffer_load_dwordx4 v[36:39], v7, s[16:19], s46 offen
    buffer_load_dwordx4 v[40:43], v8, s[16:19], s46 offen
    buffer_load_dwordx4 v[44:47], v9, s[16:19], s46 offen
    s_waitcnt lgkmcnt(0)
    s_barrier
    ds_read_b64_tr_b16 v[144:145], v16 offset:32
    ds_read_b64_tr_b16 v[146:147], v16 offset:832
    ds_read_b64_tr_b16 v[148:149], v16 offset:12832
    ds_read_b64_tr_b16 v[150:151], v16 offset:13632
    ds_read_b64_tr_b16 v[224:225], v16 offset:64
    ds_read_b64_tr_b16 v[226:227], v16 offset:864
    ds_read_b64_tr_b16 v[228:229], v16 offset:12864
    ds_read_b64_tr_b16 v[230:231], v16 offset:13664
    ds_read_b64_tr_b16 v[48:49], v16 offset:0
    ds_read_b64_tr_b16 v[50:51], v16 offset:800
    ds_read_b64_tr_b16 v[52:53], v16 offset:12800
    ds_read_b64_tr_b16 v[54:55], v16 offset:13600
    s_waitcnt lgkmcnt(0)
    ds_write_b128 v17, v[48:51] offset:12288
    ds_write_b128 v17, v[52:55] offset:13312
    s_waitcnt lgkmcnt(0)
    s_barrier
    s_waitcnt vmcnt(6)
    ds_write_b128 v10, v[72:75]
    ds_write_b128 v11, v[76:79]
    ds_write_b128 v12, v[80:83]
    ds_write_b128 v13, v[84:87]
    ds_write_b128 v14, v[88:91]
    ds_write_b128 v15, v[92:95]
    s_add_u32 s46, s45, 6291456
    buffer_load_dwordx4 v[48:51], v4, s[12:15], s46 offen
    buffer_load_dwordx4 v[52:55], v5, s[12:15], s46 offen
    buffer_load_dwordx4 v[56:59], v6, s[12:15], s46 offen
    buffer_load_dwordx4 v[60:63], v7, s[12:15], s46 offen
    buffer_load_dwordx4 v[64:67], v8, s[12:15], s46 offen
    buffer_load_dwordx4 v[68:71], v9, s[12:15], s46 offen
    s_waitcnt lgkmcnt(0)
    s_barrier
    ds_read_b64_tr_b16 a[56:57], v16 offset:0
    ds_read_b64_tr_b16 a[58:59], v16 offset:800
    ds_read_b64_tr_b16 a[60:61], v16 offset:12800
    ds_read_b64_tr_b16 a[62:63], v16 offset:13600
    ds_read_b64_tr_b16 a[136:137], v16 offset:32
    ds_read_b64_tr_b16 a[138:139], v16 offset:832
    ds_read_b64_tr_b16 a[140:141], v16 offset:12832
    ds_read_b64_tr_b16 a[142:143], v16 offset:13632
    ds_read_b64_tr_b16 a[216:217], v16 offset:64
    ds_read_b64_tr_b16 a[218:219], v16 offset:864
    ds_read_b64_tr_b16 a[220:221], v16 offset:12864
    ds_read_b64_tr_b16 a[222:223], v16 offset:13664
    s_waitcnt lgkmcnt(0)
    s_barrier
    s_waitcnt vmcnt(6)
    ds_write_b128 v10, v[24:27]
    ds_write_b128 v11, v[28:31]
    ds_write_b128 v12, v[32:35]
    ds_write_b128 v13, v[36:39]
    ds_write_b128 v14, v[40:43]
    ds_write_b128 v15, v[44:47]
    s_add_u32 s46, s45, 6291456
    buffer_load_dwordx4 v[72:75], v4, s[16:19], s46 offen
    buffer_load_dwordx4 v[76:79], v5, s[16:19], s46 offen
    buffer_load_dwordx4 v[80:83], v6, s[16:19], s46 offen
    buffer_load_dwordx4 v[84:87], v7, s[16:19], s46 offen
    buffer_load_dwordx4 v[88:91], v8, s[16:19], s46 offen
    buffer_load_dwordx4 v[92:95], v9, s[16:19], s46 offen
    s_waitcnt lgkmcnt(0)
    s_barrier
    ds_read_b64_tr_b16 v[152:153], v16 offset:32
    ds_read_b64_tr_b16 v[154:155], v16 offset:832
    ds_read_b64_tr_b16 v[156:157], v16 offset:12832
    ds_read_b64_tr_b16 v[158:159], v16 offset:13632
    ds_read_b64_tr_b16 v[232:233], v16 offset:64
    ds_read_b64_tr_b16 v[234:235], v16 offset:864
    ds_read_b64_tr_b16 v[236:237], v16 offset:12864
    ds_read_b64_tr_b16 v[238:239], v16 offset:13664
    ds_read_b64_tr_b16 v[24:25], v16 offset:0
    ds_read_b64_tr_b16 v[26:27], v16 offset:800
    ds_read_b64_tr_b16 v[28:29], v16 offset:12800
    ds_read_b64_tr_b16 v[30:31], v16 offset:13600
    s_waitcnt lgkmcnt(0)
    ds_write_b128 v17, v[24:27] offset:14336
    ds_write_b128 v17, v[28:31] offset:15360
    s_waitcnt lgkmcnt(0)
    s_barrier
    s_waitcnt vmcnt(6)
    ds_write_b128 v10, v[48:51]
    ds_write_b128 v11, v[52:55]
    ds_write_b128 v12, v[56:59]
    ds_write_b128 v13, v[60:63]
    ds_write_b128 v14, v[64:67]
    ds_write_b128 v15, v[68:71]
    s_add_u32 s46, s45, 7077888
    buffer_load_dwordx4 v[24:27], v4, s[12:15], s46 offen
    buffer_load_dwordx4 v[28:31], v5, s[12:15], s46 offen
    buffer_load_dwordx4 v[32:35], v6, s[12:15], s46 offen
    buffer_load_dwordx4 v[36:39], v7, s[12:15], s46 offen
    buffer_load_dwordx4 v[40:43], v8, s[12:15], s46 offen
    buffer_load_dwordx4 v[44:47], v9, s[12:15], s46 offen
    s_waitcnt lgkmcnt(0)
    s_barrier
    ds_read_b64_tr_b16 a[64:65], v16 offset:0
    ds_read_b64_tr_b16 a[66:67], v16 offset:800
    ds_read_b64_tr_b16 a[68:69], v16 offset:12800
    ds_read_b64_tr_b16 a[70:71], v16 offset:13600
    ds_read_b64_tr_b16 a[144:145], v16 offset:32
    ds_read_b64_tr_b16 a[146:147], v16 offset:832
    ds_read_b64_tr_b16 a[148:149], v16 offset:12832
    ds_read_b64_tr_b16 a[150:151], v16 offset:13632
    ds_read_b64_tr_b16 a[224:225], v16 offset:64
    ds_read_b64_tr_b16 a[226:227], v16 offset:864
    ds_read_b64_tr_b16 a[228:229], v16 offset:12864
    ds_read_b64_tr_b16 a[230:231], v16 offset:13664
    s_waitcnt lgkmcnt(0)
    s_barrier
    s_waitcnt vmcnt(6)
    ds_write_b128 v10, v[72:75]
    ds_write_b128 v11, v[76:79]
    ds_write_b128 v12, v[80:83]
    ds_write_b128 v13, v[84:87]
    ds_write_b128 v14, v[88:91]
    ds_write_b128 v15, v[92:95]
    s_add_u32 s46, s45, 7077888
    buffer_load_dwordx4 v[48:51], v4, s[16:19], s46 offen
    buffer_load_dwordx4 v[52:55], v5, s[16:19], s46 offen
    buffer_load_dwordx4 v[56:59], v6, s[16:19], s46 offen
    buffer_load_dwordx4 v[60:63], v7, s[16:19], s46 offen
    buffer_load_dwordx4 v[64:67], v8, s[16:19], s46 offen
    buffer_load_dwordx4 v[68:71], v9, s[16:19], s46 offen
    s_waitcnt lgkmcnt(0)
    s_barrier
    ds_read_b64_tr_b16 v[160:161], v16 offset:32
    ds_read_b64_tr_b16 v[162:163], v16 offset:832
    ds_read_b64_tr_b16 v[164:165], v16 offset:12832
    ds_read_b64_tr_b16 v[166:167], v16 offset:13632
    ds_read_b64_tr_b16 v[240:241], v16 offset:64
    ds_read_b64_tr_b16 v[242:243], v16 offset:864
    ds_read_b64_tr_b16 v[244:245], v16 offset:12864
    ds_read_b64_tr_b16 v[246:247], v16 offset:13664
    ds_read_b64_tr_b16 v[72:73], v16 offset:0
    ds_read_b64_tr_b16 v[74:75], v16 offset:800
    ds_read_b64_tr_b16 v[76:77], v16 offset:12800
    ds_read_b64_tr_b16 v[78:79], v16 offset:13600
    s_waitcnt lgkmcnt(0)
    ds_write_b128 v17, v[72:75] offset:16384
    ds_write_b128 v17, v[76:79] offset:17408
    s_waitcnt lgkmcnt(0)
    s_barrier
    s_waitcnt vmcnt(6)
    ds_write_b128 v10, v[24:27]
    ds_write_b128 v11, v[28:31]
    ds_write_b128 v12, v[32:35]
    ds_write_b128 v13, v[36:39]
    ds_write_b128 v14, v[40:43]
    ds_write_b128 v15, v[44:47]
    s_waitcnt lgkmcnt(0)
    s_barrier
    ds_read_b64_tr_b16 a[72:73], v16 offset:0
    ds_read_b64_tr_b16 a[74:75], v16 offset:800
    ds_read_b64_tr_b16 a[76:77], v16 offset:12800
    ds_read_b64_tr_b16 a[78:79], v16 offset:13600
    ds_read_b64_tr_b16 a[152:153], v16 offset:32
    ds_read_b64_tr_b16 a[154:155], v16 offset:832
    ds_read_b64_tr_b16 a[156:157], v16 offset:12832
    ds_read_b64_tr_b16 a[158:159], v16 offset:13632
    ds_read_b64_tr_b16 a[232:233], v16 offset:64
    ds_read_b64_tr_b16 a[234:235], v16 offset:864
    ds_read_b64_tr_b16 a[236:237], v16 offset:12864
    ds_read_b64_tr_b16 a[238:239], v16 offset:13664
    s_waitcnt lgkmcnt(0)
    s_barrier
    s_waitcnt vmcnt(0)
    ds_write_b128 v10, v[48:51]
    ds_write_b128 v11, v[52:55]
    ds_write_b128 v12, v[56:59]
    ds_write_b128 v13, v[60:63]
    ds_write_b128 v14, v[64:67]
    ds_write_b128 v15, v[68:71]
    s_waitcnt lgkmcnt(0)
    s_barrier
    ds_read_b64_tr_b16 v[168:169], v16 offset:32
    ds_read_b64_tr_b16 v[170:171], v16 offset:832
    ds_read_b64_tr_b16 v[172:173], v16 offset:12832
    ds_read_b64_tr_b16 v[174:175], v16 offset:13632
    ds_read_b64_tr_b16 v[248:249], v16 offset:64
    ds_read_b64_tr_b16 v[250:251], v16 offset:864
    ds_read_b64_tr_b16 v[252:253], v16 offset:12864
    ds_read_b64_tr_b16 v[254:255], v16 offset:13664
    ds_read_b64_tr_b16 v[48:49], v16 offset:0
    ds_read_b64_tr_b16 v[50:51], v16 offset:800
    ds_read_b64_tr_b16 v[52:53], v16 offset:12800
    ds_read_b64_tr_b16 v[54:55], v16 offset:13600
    s_waitcnt lgkmcnt(0)
    ds_write_b128 v17, v[48:51] offset:18432
    ds_write_b128 v17, v[52:55] offset:19456
    s_waitcnt lgkmcnt(0)
    s_barrier
    v_mov_b32 v6, v17
    v_mov_b32 v30, 0xeeee
    v_mov_b32 v4, 0x4444
    v_cmp_gt_u32 vcc, 8, v2
    s_nop 1
    v_cndmask_b32 v4, v30, v4, vcc
    v_lshlrev_b32 v5, 4, v1
    s_lshl_b32 s24, s3, 10
    v_add_u32 v7, s24, v5
    s_lshl_b32 s24, s3, 9
    s_add_u32 s24, s24, 8192
    v_lshlrev_b32 v8, 3, v1
    v_add_u32 v8, s24, v8
    v_and_b32 v30, 1, v2
    v_lshlrev_b32 v30, 4, v30
    v_mov_b32 v31, 0x3f80
    v_lshlrev_b32 v31, v30, v31
    v_lshrrev_b32 v30, 2, v2
    v_cmp_eq_u32 vcc, v30, v3
    s_nop 1
    v_cndmask_b32 v31, 0, v31, vcc
    v_and_b32 v30, 2, v2
    v_cmp_eq_u32 vcc, 0, v30
    s_nop 1
    v_cndmask_b32 v10, 0, v31, vcc
    v_cndmask_b32 v11, v31, 0, vcc
    v_add_u32 v33, 22528, v5
    s_mul_i32 s24, s3, 1408
    s_add_u32 s24, s24, 16384
    v_mul_u32_u24 v30, 176, v2
    v_add_u32 v30, s24, v30
    v_lshl_add_u32 v12, v3, 5, v30
    v_cmp_gt_u32 vcc, 8, v2
    s_nop 1
    v_cndmask_b32 v12, v33, v12, vcc
    v_lshl_add_u32 v13, v3, 4, v30
    v_add_u32 v13, 96, v13
    v_cmp_le_u32 s[24:25], 2, v3
    s_and_b64 vcc, vcc, s[24:25]
    v_cndmask_b32 v13, v33, v13, vcc
    s_mul_i32 s24, s3, 5632
    s_add_u32 s24, s24, 106496
    v_mul_u32_u24 v30, 176, v2
    v_add_u32 v30, s24, v30
    v_lshl_add_u32 v16, v3, 5, v30
    v_lshl_add_u32 v17, v3, 4, v30
    v_add_u32 v17, 96, v17
    v_add_u32 v18, 2816, v17
    v_cmp_le_u32 vcc, 2, v3
    s_nop 1
    v_cndmask_b32 v17, v33, v17, vcc
    v_cndmask_b32 v18, v33, v18, vcc
    v_lshrrev_b32 v30, 3, v1
    v_and_b32 v31, 7, v1
    v_min_u32 v32, 4, v31
    v_mul_u32_u24 v14, 176, v30
    v_lshl_add_u32 v14, v32, 5, v14
    s_mul_i32 s24, s3, 1408
    s_add_u32 s24, s24, 106496
    v_add_u32 v21, s24, v14
    v_add_u32 v14, 16384, v14
    v_cmp_gt_u32 s[50:51], 5, v31
    s_lshl_b32 s24, s3, 3
    v_add_u32 v32, s24, v30
    v_lshlrev_b32 v33, 2, v31
    v_sub_u32 v32, v32, v33
    v_mov_b32 v33, 100
    v_cmp_gt_u32 vcc, 4, v31
    s_nop 1
    v_cndmask_b32 v32, v33, v32, vcc
    v_cmp_le_i32 s[64:65], 0, v32
    v_cmp_le_i32 s[66:67], 1, v32
    v_cmp_le_i32 s[68:69], 2, v32
    v_cmp_le_i32 s[70:71], 3, v32
    v_cmp_le_i32 s[72:73], 16, v32
    v_cmp_le_i32 s[74:75], 17, v32
    v_cmp_le_i32 s[76:77], 18, v32
    v_cmp_le_i32 s[78:79], 19, v32
    s_lshr_b32 s24, s44, 1
    s_lshl_b32 s24, s24, 10
    s_and_b32 s25, s44, 1
    s_lshl_b32 s25, s25, 7
    s_add_u32 s24, s24, s25
    v_lshlrev_b32 v15, 8, v31
    v_lshl_add_u32 v15, v30, 4, v15
    v_add_u32 v15, s24, v15
    s_lshr_b32 s24, s44, 3
    s_lshl_b32 s24, s24, 10
    s_and_b32 s25, s44, 3
    s_lshl_b32 s25, s25, 8
    s_add_u32 s24, s24, s25
    s_lshr_b32 s25, s44, 2
    s_and_b32 s25, s25, 1
    s_lshl_b32 s25, s25, 7
    s_add_u32 s24, s24, s25
    s_add_u32 s24, s24, 16384
    v_lshlrev_b32 v32, 4, v30
    v_add_u32 v32, s24, v32
    v_cmp_eq_u32 vcc, 4, v31
    s_nop 1
    v_cndmask_b32 v15, v15, v32, vcc
    v_mov_b32 v32, 2146435072
    v_cndmask_b32 v15, v32, v15, s[50:51]
    s_cmp_lt_u32 s3, 1
    s_cselect_b32 s24, 0, 2146435072
    v_or_b32 v15, s24, v15
    s_and_b32 s24, s3, 1
    s_lshl_b32 s24, s24, 7
    s_lshr_b32 s25, s3, 1
    s_lshl_b32 s25, s25, 10
    s_add_u32 s24, s24, s25
    s_lshl_b32 s25, s44, 11
    s_add_u32 s25, s25, s24
    v_lshlrev_b32 v22, 8, v31
    v_lshl_add_u32 v22, v30, 4, v22
    v_add_u32 v22, s25, v22
    s_lshr_b32 s25, s44, 2
    s_lshl_b32 s25, s25, 11
    s_add_u32 s25, s25, s24
    s_and_b32 s26, s44, 3
    s_lshl_b32 s26, s26, 8
    s_add_u32 s25, s25, s26
    s_add_u32 s25, s25, 65536
    v_lshlrev_b32 v32, 4, v30
    v_add_u32 v32, s25, v32
    v_cmp_eq_u32 vcc, 4, v31
    s_nop 1
    v_cndmask_b32 v22, v22, v32, vcc
    v_mov_b32 v32, 2146435072
    v_cndmask_b32 v22, v32, v22, s[50:51]
    s_mul_i32 s24, s44, 12288
    s_mul_i32 s25, s3, 3072
    s_add_u32 s24, s24, s25
    v_add_u32 v19, s24, v5
    s_and_b32 s24, s2, 15
    s_mul_i32 s25, s3, 16
    s_add_u32 s24, s24, s25
    s_lshl_b32 s24, s24, 7
    v_mov_b32 v23, s24
    s_lshr_b32 s25, s44, 3
    s_mul_i32 s24, s25, 8
    v_add_u32 v20, s24, v1
    v_lshlrev_b32 v20, 7, v20
    v_mov_b32 v30, 2146435072
    v_cmp_le_u32 vcc, 8, v1
    s_nop 1
    v_cndmask_b32 v20, v20, v30, vcc
    s_cmp_eq_u32 s3, 0
    s_cselect_b32 s24, 0, 2146435072
    v_or_b32 v20, s24, v20
    v_mov_b32 v0, 1
interleave_layers__linear_attn_block__memory_aug_recurrent_mem_tr__prompt_kernel_s_layer:
    s_mul_i32 s93, s92, 29360128
    s_add_u32 s93, s93, 117440512
    s_mul_i32 s94, s92, 16384
    s_add_u32 s94, s94, 23068672
    v_and_b32 v9, 1, v1
    v_lshlrev_b32 v9, 12, v9
    s_lshl_b32 s24, s44, 7
    s_add_u32 s24, s24, s94
    v_add_u32 v9, s24, v9
    s_lshl_b32 s24, s3, 6
    s_add_u32 s24, s24, 0
    v_add_u32 v48, s24, v1
    v_and_b32 v49, 7, v48
    v_mul_u32_u24 v49, 1280, v49
    v_lshrrev_b32 v50, 3, v48
    v_lshl_add_u32 v49, v50, 4, v49
    v_cmp_gt_u32 vcc, 640, v48
    v_mov_b32 v51, 2146435072
    s_nop 0
    v_cndmask_b32 v49, v51, v49, vcc
    buffer_load_dwordx4 v[52:55], v49, s[20:23], 0 offen
    v_lshlrev_b32 v48, 4, v48
    s_waitcnt vmcnt(0)
    s_and_saveexec_b64 s[30:31], vcc
    ds_write_b128 v48, v[52:55]
    s_mov_b64 exec, s[30:31]
    s_lshl_b32 s24, s3, 6
    s_add_u32 s24, s24, 256
    v_add_u32 v48, s24, v1
    v_and_b32 v49, 7, v48
    v_mul_u32_u24 v49, 1280, v49
    v_lshrrev_b32 v50, 3, v48
    v_lshl_add_u32 v49, v50, 4, v49
    v_cmp_gt_u32 vcc, 640, v48
    v_mov_b32 v51, 2146435072
    s_nop 0
    v_cndmask_b32 v49, v51, v49, vcc
    buffer_load_dwordx4 v[52:55], v49, s[20:23], 0 offen
    v_lshlrev_b32 v48, 4, v48
    s_waitcnt vmcnt(0)
    s_and_saveexec_b64 s[30:31], vcc
    ds_write_b128 v48, v[52:55]
    s_mov_b64 exec, s[30:31]
    s_lshl_b32 s24, s3, 6
    s_add_u32 s24, s24, 512
    v_add_u32 v48, s24, v1
    v_and_b32 v49, 7, v48
    v_mul_u32_u24 v49, 1280, v49
    v_lshrrev_b32 v50, 3, v48
    v_lshl_add_u32 v49, v50, 4, v49
    v_cmp_gt_u32 vcc, 640, v48
    v_mov_b32 v51, 2146435072
    s_nop 0
    v_cndmask_b32 v49, v51, v49, vcc
    buffer_load_dwordx4 v[52:55], v49, s[20:23], 0 offen
    v_lshlrev_b32 v48, 4, v48
    s_waitcnt vmcnt(0)
    s_and_saveexec_b64 s[30:31], vcc
    ds_write_b128 v48, v[52:55]
    s_mov_b64 exec, s[30:31]
    s_mov_b32 s40, 0
    s_mov_b32 s41, 92274688
    s_add_u32 s42, s93, 327680
    s_add_u32 s43, s93, 409600
    s_mov_b32 s45, 67108864
    s_add_u32 s47, s93, -28672
    s_add_u32 s48, s93, -18432
    s_add_u32 s49, s93, 448512
    s_lshl_b32 s95, s92, 6
    s_add_u32 s95, s95, s40
    s_add_u32 s95, s95, 1
    s_cmp_ge_i32 s59, s95
    s_cbranch_scc1 interleave_layers__linear_attn_block__memory_aug_recurrent_mem_tr__prompt_kernel_s_ec0_ok
    s_and_b32 s24, s2, 7
    s_lshl_b32 s24, s24, 7
    s_add_u32 s24, s24, 23109632
    v_and_b32 v49, 3, v1
    v_lshl_add_u32 v49, v49, 2, s24
    s_mov_b32 s61, 0
interleave_layers__linear_attn_block__memory_aug_recurrent_mem_tr__prompt_kernel_s_ec0:
    buffer_load_dword v48, v49, s[8:11], 0 offen sc1
    s_waitcnt vmcnt(0)
    v_readlane_b32 s59, v48, 0
    v_readlane_b32 s24, v48, 1
    s_min_i32 s59, s59, s24
    v_readlane_b32 s24, v48, 2
    s_min_i32 s59, s59, s24
    s_cmp_ge_i32 s59, s95
    s_cbranch_scc1 interleave_layers__linear_attn_block__memory_aug_recurrent_mem_tr__prompt_kernel_s_ec0_ok
    s_add_u32 s61, s61, 1
    s_cmp_ge_u32 s61, s60
    s_cbranch_scc1 interleave_layers__linear_attn_block__memory_aug_recurrent_mem_tr__prompt_kernel_s_ec0_to
    s_sleep 2
    s_branch interleave_layers__linear_attn_block__memory_aug_recurrent_mem_tr__prompt_kernel_s_ec0
interleave_layers__linear_attn_block__memory_aug_recurrent_mem_tr__prompt_kernel_s_ec0_to:
    s_mov_b32 s60, 1
interleave_layers__linear_attn_block__memory_aug_recurrent_mem_tr__prompt_kernel_s_ec0_ok:
    s_mov_b32 s62, -1
    s_mov_b32 s63, 1
    s_cmp_ge_i32 s62, s63
    s_cbranch_scc1 interleave_layers__linear_attn_block__memory_aug_recurrent_mem_tr__prompt_kernel_s_en0_ok
    s_mov_b32 s61, 0
interleave_layers__linear_attn_block__memory_aug_recurrent_mem_tr__prompt_kernel_s_en0:
    buffer_load_dword v48, v9, s[8:11], 0 offen sc1
    s_waitcnt vmcnt(0)
    v_readlane_b32 s62, v48, 0
    v_readlane_b32 s24, v48, 1
    s_min_i32 s62, s62, s24
    s_cmp_ge_i32 s62, s63
    s_cbranch_scc1 interleave_layers__linear_attn_block__memory_aug_recurrent_mem_tr__prompt_kernel_s_en0_ok
    s_add_u32 s61, s61, 1
    s_cmp_ge_u32 s61, s60
    s_cbranch_scc1 interleave_layers__linear_attn_block__memory_aug_recurrent_mem_tr__prompt_kernel_s_en0_to
    s_sleep 2
    s_branch interleave_layers__linear_attn_block__memory_aug_recurrent_mem_tr__prompt_kernel_s_en0
interleave_layers__linear_attn_block__memory_aug_recurrent_mem_tr__prompt_kernel_s_en0_to:
    s_mov_b32 s60, 1
interleave_layers__linear_attn_block__memory_aug_recurrent_mem_tr__prompt_kernel_s_en0_ok:
    buffer_load_dwordx4 a[240:243], v19, s[8:11], s41 offen offset:0 sc1
    buffer_load_dwordx4 a[244:247], v19, s[8:11], s41 offen offset:1024 sc1
    buffer_load_dwordx4 a[248:251], v19, s[8:11], s41 offen offset:2048 sc1
    s_waitcnt lgkmcnt(0)
    v_mov_b32 v24, 0
    v_mov_b32 v25, 0
    v_mov_b32 v26, 0
    v_mov_b32 v27, 0
    v_mov_b32 v28, 0
    v_mov_b32 v29, 0
    v_mov_b32 v30, 0
    v_mov_b32 v31, 0
    v_mov_b32 v32, 0
    v_mov_b32 v33, 0
    v_mov_b32 v34, 0
    v_mov_b32 v35, 0
    v_mov_b32 v36, 0
    v_mov_b32 v37, 0
    v_mov_b32 v38, 0
    v_mov_b32 v39, 0
    v_mov_b32 v40, 0
    v_mov_b32 v41, 0
    v_mov_b32 v42, 0
    v_mov_b32 v43, 0
    v_mov_b32 v44, 0
    v_mov_b32 v45, 0
    v_mov_b32 v46, 0
    v_mov_b32 v47, 0
    s_barrier
    ds_read_b128 v[84:87], v7
    ds_read_b128 v[88:91], v7 offset:4096
    s_waitcnt vmcnt(0) lgkmcnt(0)
    s_cmp_eq_u32 s3, 0
    s_cbranch_scc1 interleave_layers__linear_attn_block__memory_aug_recurrent_mem_tr__prompt_kernel_s_gow0
    s_cmp_eq_u32 s3, 1
    s_cbranch_scc1 interleave_layers__linear_attn_block__memory_aug_recurrent_mem_tr__prompt_kernel_s_gow1
    s_cmp_eq_u32 s3, 2
    s_cbranch_scc1 interleave_layers__linear_attn_block__memory_aug_recurrent_mem_tr__prompt_kernel_s_gow2
    s_branch interleave_layers__linear_attn_block__memory_aug_recurrent_mem_tr__prompt_kernel_s_gow3
interleave_layers__linear_attn_block__memory_aug_recurrent_mem_tr__prompt_kernel_s_stepw0:
    v_mov_b32 v24, 0
    v_mov_b32 v25, 0
    v_mov_b32 v26, 0
    v_mov_b32 v27, 0
    v_mov_b32 v28, 0
    v_mov_b32 v29, 0
    v_mov_b32 v30, 0
    v_mov_b32 v31, 0
    v_mov_b32 v32, 0
    v_mov_b32 v33, 0
    v_mov_b32 v34, 0
    v_mov_b32 v35, 0
    v_mov_b32 v36, 0
    v_mov_b32 v37, 0
    v_mov_b32 v38, 0
    v_mov_b32 v39, 0
    v_mov_b32 v40, 0
    v_mov_b32 v41, 0
    v_mov_b32 v42, 0
    v_mov_b32 v43, 0
    v_mov_b32 v44, 0
    v_mov_b32 v45, 0
    v_mov_b32 v46, 0
    v_mov_b32 v47, 0
    s_add_u32 s46, s47, 4096
    s_lshl_b32 s95, s92, 6
    s_add_u32 s95, s95, s40
    s_add_u32 s95, s95, 1
    s_cmp_ge_i32 s59, s95
    s_cbranch_scc1 interleave_layers__linear_attn_block__memory_aug_recurrent_mem_tr__prompt_kernel_s_ecw0_ok
    s_and_b32 s24, s2, 7
    s_lshl_b32 s24, s24, 7
    s_add_u32 s24, s24, 23109632
    v_and_b32 v49, 3, v1
    v_lshl_add_u32 v49, v49, 2, s24
    s_mov_b32 s61, 0
interleave_layers__linear_attn_block__memory_aug_recurrent_mem_tr__prompt_kernel_s_ecw0:
    buffer_load_dword v48, v49, s[8:11], 0 offen sc1
    s_waitcnt vmcnt(0)
    v_readlane_b32 s59, v48, 0
    v_readlane_b32 s24, v48, 1
    s_min_i32 s59, s59, s24
    v_readlane_b32 s24, v48, 2
    s_min_i32 s59, s59, s24
    s_cmp_ge_i32 s59, s95
    s_cbranch_scc1 interleave_layers__linear_attn_block__memory_aug_recurrent_mem_tr__prompt_kernel_s_ecw0_ok
    s_add_u32 s61, s61, 1
    s_cmp_ge_u32 s61, s60
    s_cbranch_scc1 interleave_layers__linear_attn_block__memory_aug_recurrent_mem_tr__prompt_kernel_s_ecw0_to
    s_sleep 2
    s_branch interleave_layers__linear_attn_block__memory_aug_recurrent_mem_tr__prompt_kernel_s_ecw0
interleave_layers__linear_attn_block__memory_aug_recurrent_mem_tr__prompt_kernel_s_ecw0_to:
    s_mov_b32 s60, 1
interleave_layers__linear_attn_block__memory_aug_recurrent_mem_tr__prompt_kernel_s_ecw0_ok:
    s_add_u32 s63, s40, 1
    s_cmp_ge_i32 s62, s63
    s_cbranch_scc1 interleave_layers__linear_attn_block__memory_aug_recurrent_mem_tr__prompt_kernel_s_enw0_ok
    s_mov_b32 s61, 0
interleave_layers__linear_attn_block__memory_aug_recurrent_mem_tr__prompt_kernel_s_enw0:
    buffer_load_dword v48, v9, s[8:11], 0 offen sc1
    s_waitcnt vmcnt(0)
    v_readlane_b32 s62, v48, 0
    v_readlane_b32 s24, v48, 1
    s_min_i32 s62, s62, s24
    s_cmp_ge_i32 s62, s63
    s_cbranch_scc1 interleave_layers__linear_attn_block__memory_aug_recurrent_mem_tr__prompt_kernel_s_enw0_ok
    s_add_u32 s61, s61, 1
    s_cmp_ge_u32 s61, s60
    s_cbranch_scc1 interleave_layers__linear_attn_block__memory_aug_recurrent_mem_tr__prompt_kernel_s_enw0_to
    s_sleep 2
    s_branch interleave_layers__linear_attn_block__memory_aug_recurrent_mem_tr__prompt_kernel_s_enw0
interleave_layers__linear_attn_block__memory_aug_recurrent_mem_tr__prompt_kernel_s_enw0_to:
    s_mov_b32 s60, 1
interleave_layers__linear_attn_block__memory_aug_recurrent_mem_tr__prompt_kernel_s_enw0_ok:
    buffer_load_dwordx4 a[240:243], v19, s[8:11], s41 offen offset:0 sc1
    buffer_load_dwordx4 a[244:247], v19, s[8:11], s41 offen offset:1024 sc1
    buffer_load_dwordx4 a[248:251], v19, s[8:11], s41 offen offset:2048 sc1
    s_sleep 5
    s_mov_b64 exec, 1
    s_mov_b32 s61, 0
    v_mov_b32 v83, 0
    buffer_atomic_add v83, v23, s[8:11], s48 offen sc0
    s_sleep 3
    v_mov_b32 v94, 0
    buffer_atomic_add v94, v23, s[8:11], s48 offen sc0
    s_sleep 3
    v_mov_b32 v95, 0
    buffer_atomic_add v95, v23, s[8:11], s48 offen sc0
    s_sleep 3
interleave_layers__linear_attn_block__memory_aug_recurrent_mem_tr__prompt_kernel_s_prw0:
    v_mov_b32 v82, 0
    buffer_atomic_add v82, v23, s[8:11], s48 offen sc0
    s_waitcnt vmcnt(3)
    v_cmp_le_i32 vcc, 8, v83
    s_add_u32 s61, s61, 1
    s_cbranch_vccnz interleave_layers__linear_attn_block__memory_aug_recurrent_mem_tr__prompt_kernel_s_prw0_out
    s_sleep 3
    v_mov_b32 v83, 0
    buffer_atomic_add v83, v23, s[8:11], s48 offen sc0
    s_waitcnt vmcnt(3)
    v_cmp_le_i32 vcc, 8, v94
    s_add_u32 s61, s61, 1
    s_cbranch_vccnz interleave_layers__linear_attn_block__memory_aug_recurrent_mem_tr__prompt_kernel_s_prw0_out
    s_sleep 3
    v_mov_b32 v94, 0
    buffer_atomic_add v94, v23, s[8:11], s48 offen sc0
    s_waitcnt vmcnt(3)
    v_cmp_le_i32 vcc, 8, v95
    s_add_u32 s61, s61, 1
    s_cbranch_vccnz interleave_layers__linear_attn_block__memory_aug_recurrent_mem_tr__prompt_kernel_s_prw0_out
    s_sleep 3
    v_mov_b32 v95, 0
    buffer_atomic_add v95, v23, s[8:11], s48 offen sc0
    s_waitcnt vmcnt(3)
    v_cmp_le_i32 vcc, 8, v82
    s_add_u32 s61, s61, 1
    s_cbranch_vccnz interleave_layers__linear_attn_block__memory_aug_recurrent_mem_tr__prompt_kernel_s_prw0_out
    s_sleep 3
    s_cmp_ge_u32 s61, s60
    s_cbranch_scc0 interleave_layers__linear_attn_block__memory_aug_recurrent_mem_tr__prompt_kernel_s_prw0
    s_mov_b32 s60, 1
interleave_layers__linear_attn_block__memory_aug_recurrent_mem_tr__prompt_kernel_s_prw0_out:
    s_mov_b64 exec, -1
    buffer_load_dwordx4 v[84:87], v7, s[8:11], s47 offen sc1
    buffer_load_dwordx4 v[88:91], v7, s[8:11], s46 offen sc1
    buffer_load_dwordx2 v[92:93], v8, s[8:11], s47 offen sc1
    ds_read_b128 v[48:51], v21 offset:0
    ds_read_b128 v[52:55], v21 offset:16
    ds_read_b128 v[56:59], v21 offset:5632
    ds_read_b128 v[60:63], v21 offset:5648
    ds_read_b128 v[64:67], v21 offset:11264
    ds_read_b128 v[68:71], v21 offset:11280
    ds_read_b128 v[72:75], v21 offset:16896
    ds_read_b128 v[76:79], v21 offset:16912
    s_waitcnt lgkmcnt(4)
    v_pk_add_f32 v[48:49], v[48:49], v[56:57]
    v_pk_add_f32 v[50:51], v[50:51], v[58:59]
    v_pk_add_f32 v[52:53], v[52:53], v[60:61]
    v_pk_add_f32 v[54:55], v[54:55], v[62:63]
    s_waitcnt lgkmcnt(0)
    v_pk_add_f32 v[64:65], v[64:65], v[72:73]
    v_pk_add_f32 v[66:67], v[66:67], v[74:75]
    v_pk_add_f32 v[68:69], v[68:69], v[76:77]
    v_pk_add_f32 v[70:71], v[70:71], v[78:79]
    v_pk_add_f32 v[48:49], v[48:49], v[64:65]
    v_pk_add_f32 v[50:51], v[50:51], v[66:67]
    v_pk_add_f32 v[52:53], v[52:53], v[68:69]
    v_pk_add_f32 v[54:55], v[54:55], v[70:71]
    v_mov_b32 v81, 0xff800000
    v_cndmask_b32 v48, v81, v48, s[64:65]
    v_cndmask_b32 v49, v81, v49, s[66:67]
    v_cndmask_b32 v50, v81, v50, s[68:69]
    v_cndmask_b32 v51, v81, v51, s[70:71]
    v_cndmask_b32 v52, v81, v52, s[72:73]
    v_cndmask_b32 v53, v81, v53, s[74:75]
    v_cndmask_b32 v54, v81, v54, s[76:77]
    v_cndmask_b32 v55, v81, v55, s[78:79]
    v_max3_f32 v80, v48, v49, v50
    v_max3_f32 v80, v80, v51, v52
    v_max3_f32 v80, v80, v53, v54
    v_max_f32 v80, v80, v55
    v_mov_b32 v81, 0xff800000
    v_cndmask_b32 v80, v81, v80, s[50:51]
    s_nop 1
    v_max_f32 v80, v80, v80 quad_perm:[1,0,3,2] row_mask:0xf bank_mask:0xf
    s_nop 1
    v_max_f32 v80, v80, v80 quad_perm:[2,3,0,1] row_mask:0xf bank_mask:0xf
    s_nop 1
    v_max_f32 v80, v80, v80 row_half_mirror row_mask:0xf bank_mask:0xf
    s_mov_b32 s24, 0x3dd53b95
    v_mul_f32 v80, s24, v80
    v_fma_f32 v48, v48, s24, -v80
    v_fma_f32 v49, v49, s24, -v80
    v_fma_f32 v50, v50, s24, -v80
    v_fma_f32 v51, v51, s24, -v80
    v_fma_f32 v52, v52, s24, -v80
    v_fma_f32 v53, v53, s24, -v80
    v_fma_f32 v54, v54, s24, -v80
    v_fma_f32 v55, v55, s24, -v80
    v_exp_f32 v48, v48
    v_exp_f32 v49, v49
    v_exp_f32 v50, v50
    v_exp_f32 v51, v51
    v_exp_f32 v52, v52
    v_exp_f32 v53, v53
    v_exp_f32 v54, v54
    v_exp_f32 v55, v55
    v_add_f32 v80, v48, v49
    v_add_f32 v81, v50, v51
    v_add_f32 v80, v80, v52
    v_add_f32 v81, v81, v53
    v_add_f32 v80, v80, v54
    v_add_f32 v81, v81, v55
    v_add_f32 v80, v80, v81
    v_cndmask_b32 v80, 0, v80, s[50:51]
    s_nop 1
    v_add_f32 v80, v80, v80 quad_perm:[1,0,3,2] row_mask:0xf bank_mask:0xf
    s_nop 1
    v_add_f32 v80, v80, v80 quad_perm:[2,3,0,1] row_mask:0xf bank_mask:0xf
    s_nop 1
    v_add_f32 v80, v80, v80 row_half_mirror row_mask:0xf bank_mask:0xf
    v_rcp_f32 v80, v80
    s_nop 0
    v_mul_f32 v48, v48, v80
    v_mul_f32 v49, v49, v80
    v_mul_f32 v50, v50, v80
    v_mul_f32 v51, v51, v80
    v_mul_f32 v52, v52, v80
    v_mul_f32 v53, v53, v80
    v_mul_f32 v54, v54, v80
    v_mul_f32 v55, v55, v80
    v_cvt_pk_bf16_f32 v56, v48, v49
    v_cvt_pk_bf16_f32 v57, v50, v51
    v_cvt_pk_bf16_f32 v58, v52, v53
    v_cvt_pk_bf16_f32 v59, v54, v55
    v_min_u32 v56, -2, v56
    v_min_u32 v57, -2, v57
    v_min_u32 v58, -2, v58
    v_min_u32 v59, -2, v59
    buffer_store_dwordx4 v[56:59], v22, s[8:11], s42 offen sc1
    s_add_u32 s42, s42, 458752
    s_waitcnt vmcnt(1)
    v_max3_u32 v58, v84, v85, v86
    v_max3_u32 v58, v58, v87, v88
    v_max3_u32 v58, v58, v89, v90
    v_max3_u32 v58, v58, v91, v92
    v_max_u32 v58, v58, v93
    v_cmp_eq_u32 vcc, -1, v58
    s_cbranch_vccz interleave_layers__linear_attn_block__memory_aug_recurrent_mem_tr__prompt_kernel_s_pmw0_out
    s_mov_b32 s61, 0
interleave_layers__linear_attn_block__memory_aug_recurrent_mem_tr__prompt_kernel_s_pmw0:
    buffer_load_dwordx4 v[84:87], v7, s[8:11], s47 offen sc1
    buffer_load_dwordx4 v[88:91], v7, s[8:11], s46 offen sc1
    buffer_load_dwordx2 v[92:93], v8, s[8:11], s47 offen sc1
    s_waitcnt vmcnt(0)
    v_max3_u32 v58, v84, v85, v86
    v_max3_u32 v58, v58, v87, v88
    v_max3_u32 v58, v58, v89, v90
    v_max3_u32 v58, v58, v91, v92
    v_max_u32 v58, v58, v93
    v_cmp_eq_u32 vcc, -1, v58
    s_add_u32 s61, s61, 1
    s_cbranch_vccz interleave_layers__linear_attn_block__memory_aug_recurrent_mem_tr__prompt_kernel_s_pmw0_out
    s_cmp_ge_u32 s61, s60
    s_cbranch_scc1 interleave_layers__linear_attn_block__memory_aug_recurrent_mem_tr__prompt_kernel_s_pmw0_to
    s_sleep 1
    s_branch interleave_layers__linear_attn_block__memory_aug_recurrent_mem_tr__prompt_kernel_s_pmw0
interleave_layers__linear_attn_block__memory_aug_recurrent_mem_tr__prompt_kernel_s_pmw0_to:
    s_mov_b32 s60, 1
interleave_layers__linear_attn_block__memory_aug_recurrent_mem_tr__prompt_kernel_s_pmw0_out:
    ds_write_b128 v7, v[84:87]
    ds_write_b128 v7, v[88:91] offset:4096
    ds_write_b64 v8, v[92:93]
interleave_layers__linear_attn_block__memory_aug_recurrent_mem_tr__prompt_kernel_s_gow0:
    ds_read_b128 v[68:71], v6 offset:0
    ds_read_b128 v[72:75], v6 offset:1024
    ds_read_b128 v[76:79], v6 offset:8192
    ds_read_b128 v[80:83], v6 offset:9216
    v_smfmac_f32_16x16x64_bf16 v[24:27], v[84:87], a[0:7], v4
    v_smfmac_f32_16x16x64_bf16 v[28:31], v[84:87], a[80:87], v4
    v_smfmac_f32_16x16x64_bf16 v[32:35], v[84:87], a[160:167], v4
    v_smfmac_f32_16x16x64_bf16 v[40:43], v[84:87], v[96:103], v4
    v_smfmac_f32_16x16x64_bf16 v[44:47], v[84:87], v[176:183], v4
    s_waitcnt lgkmcnt(2)
    v_smfmac_f32_16x16x64_bf16 v[36:39], v[84:87], v[68:75], v4
    ds_read_b128 v[68:71], v6 offset:2048
    ds_read_b128 v[72:75], v6 offset:3072
    s_barrier
    ds_read_b128 v[48:51], v5 offset:1024
    ds_read_b128 v[52:55], v5 offset:2048
    ds_read_b128 v[56:59], v5 offset:3072
    ds_read_b128 v[60:63], v5 offset:5120
    ds_read_b128 v[64:67], v5 offset:6144
    v_smfmac_f32_16x16x64_bf16 v[24:27], v[88:91], a[32:39], v4
    v_smfmac_f32_16x16x64_bf16 v[28:31], v[88:91], a[112:119], v4
    v_smfmac_f32_16x16x64_bf16 v[32:35], v[88:91], a[192:199], v4
    v_smfmac_f32_16x16x64_bf16 v[40:43], v[88:91], v[128:135], v4
    v_smfmac_f32_16x16x64_bf16 v[44:47], v[88:91], v[208:215], v4
    s_waitcnt lgkmcnt(7)
    v_smfmac_f32_16x16x64_bf16 v[36:39], v[88:91], v[76:83], v4
    ds_read_b128 v[76:79], v6 offset:4096
    ds_read_b128 v[80:83], v6 offset:5120
    s_waitcnt lgkmcnt(6)
    v_smfmac_f32_16x16x64_bf16 v[24:27], v[48:51], a[8:15], v4
    v_smfmac_f32_16x16x64_bf16 v[28:31], v[48:51], a[88:95], v4
    v_smfmac_f32_16x16x64_bf16 v[40:43], v[48:51], v[104:111], v4
    v_smfmac_f32_16x16x64_bf16 v[36:39], v[48:51], v[68:75], v4
    ds_read_b128 v[68:71], v6 offset:6144
    ds_read_b128 v[72:75], v6 offset:7168
    ds_read_b128 v[48:51], v5 offset:7168
    s_waitcnt lgkmcnt(8)
    v_smfmac_f32_16x16x64_bf16 v[24:27], v[52:55], a[16:23], v4
    v_smfmac_f32_16x16x64_bf16 v[28:31], v[52:55], a[96:103], v4
    v_smfmac_f32_16x16x64_bf16 v[40:43], v[52:55], v[112:119], v4
    s_waitcnt lgkmcnt(3)
    v_smfmac_f32_16x16x64_bf16 v[36:39], v[52:55], v[76:83], v4
    ds_read_b128 v[76:79], v6 offset:10240
    ds_read_b128 v[80:83], v6 offset:11264
    ds_read_b128 v[52:55], v5 offset:8192
    v_smfmac_f32_16x16x64_bf16 v[24:27], v[56:59], a[24:31], v4
    v_smfmac_f32_16x16x64_bf16 v[28:31], v[56:59], a[104:111], v4
    v_smfmac_f32_16x16x64_bf16 v[40:43], v[56:59], v[120:127], v4
    s_waitcnt lgkmcnt(4)
    v_smfmac_f32_16x16x64_bf16 v[36:39], v[56:59], v[68:75], v4
    ds_read_b128 v[68:71], v6 offset:12288
    ds_read_b128 v[72:75], v6 offset:13312
    ds_read_b128 v[56:59], v5 offset:9216
    v_smfmac_f32_16x16x64_bf16 v[24:27], v[60:63], a[40:47], v4
    v_smfmac_f32_16x16x64_bf16 v[28:31], v[60:63], a[120:127], v4
    v_smfmac_f32_16x16x64_bf16 v[40:43], v[60:63], v[136:143], v4
    s_waitcnt lgkmcnt(4)
    v_smfmac_f32_16x16x64_bf16 v[36:39], v[60:63], v[76:83], v4
    ds_read_b128 v[76:79], v6 offset:14336
    ds_read_b128 v[80:83], v6 offset:15360
    ds_read_b128 v[60:63], v5 offset:1024
    v_smfmac_f32_16x16x64_bf16 v[24:27], v[64:67], a[48:55], v4
    v_smfmac_f32_16x16x64_bf16 v[28:31], v[64:67], a[128:135], v4
    v_smfmac_f32_16x16x64_bf16 v[40:43], v[64:67], v[144:151], v4
    s_waitcnt lgkmcnt(4)
    v_smfmac_f32_16x16x64_bf16 v[36:39], v[64:67], v[68:75], v4
    ds_read_b128 v[68:71], v6 offset:16384
    ds_read_b128 v[72:75], v6 offset:17408
    ds_read_b128 v[64:67], v5 offset:2048
    v_smfmac_f32_16x16x64_bf16 v[24:27], v[48:51], a[56:63], v4
    v_smfmac_f32_16x16x64_bf16 v[28:31], v[48:51], a[136:143], v4
    v_smfmac_f32_16x16x64_bf16 v[40:43], v[48:51], v[152:159], v4
    s_waitcnt lgkmcnt(4)
    v_smfmac_f32_16x16x64_bf16 v[36:39], v[48:51], v[76:83], v4
    ds_read_b128 v[76:79], v6 offset:18432
    ds_read_b128 v[80:83], v6 offset:19456
    ds_read_b128 v[48:51], v5 offset:3072
    v_smfmac_f32_16x16x64_bf16 v[24:27], v[52:55], a[64:71], v4
    v_smfmac_f32_16x16x64_bf16 v[28:31], v[52:55], a[144:151], v4
    v_smfmac_f32_16x16x64_bf16 v[40:43], v[52:55], v[160:167], v4
    s_waitcnt lgkmcnt(4)
    v_smfmac_f32_16x16x64_bf16 v[36:39], v[52:55], v[68:75], v4
    ds_read_b128 v[52:55], v5 offset:5120
    v_smfmac_f32_16x16x64_bf16 v[24:27], v[56:59], a[72:79], v4
    v_smfmac_f32_16x16x64_bf16 v[28:31], v[56:59], a[152:159], v4
    v_smfmac_f32_16x16x64_bf16 v[40:43], v[56:59], v[168:175], v4
    s_waitcnt lgkmcnt(2)
    v_smfmac_f32_16x16x64_bf16 v[36:39], v[56:59], v[76:83], v4
    ds_read_b128 v[56:59], v5 offset:6144
    buffer_load_dwordx4 v[80:83], v19, s[8:11], s45 offen offset:0 sc1
    buffer_load_dwordx4 v[84:87], v19, s[8:11], s45 offen offset:1024 sc1
    buffer_load_dwordx4 v[88:91], v19, s[8:11], s45 offen offset:2048 sc1
    v_smfmac_f32_16x16x64_bf16 v[32:35], v[60:63], a[168:175], v4
    v_smfmac_f32_16x16x64_bf16 v[44:47], v[60:63], v[184:191], v4
    v_permlane32_swap_b32 v28, v40
    v_permlane32_swap_b32 v29, v41
    ds_read_b128 v[60:63], v5 offset:7168
    v_smfmac_f32_16x16x64_bf16 v[32:35], v[64:67], a[176:183], v4
    v_permlane32_swap_b32 v30, v42
    v_permlane32_swap_b32 v31, v43
    v_smfmac_f32_16x16x64_bf16 v[44:47], v[64:67], v[192:199], v4
    v_add_f32 v28, v28, v40
    v_add_f32 v29, v29, v41
    ds_read_b128 v[64:67], v5 offset:8192
    s_waitcnt lgkmcnt(4)
    v_smfmac_f32_16x16x64_bf16 v[32:35], v[48:51], a[184:191], v4
    v_add_f32 v30, v30, v42
    v_add_f32 v31, v31, v43
    v_smfmac_f32_16x16x64_bf16 v[44:47], v[48:51], v[200:207], v4
    v_cvt_pk_bf16_f32 v40, v28, v29
    v_cvt_pk_bf16_f32 v41, v30, v31
    ds_read_b128 v[48:51], v5 offset:9216
    s_waitcnt lgkmcnt(4)
    v_smfmac_f32_16x16x64_bf16 v[32:35], v[52:55], a[200:207], v4
    v_mfma_f32_16x16x16_bf16 v[28:31], v[40:41], v[10:11], 0
    v_permlane32_swap_b32 v24, v36
    v_smfmac_f32_16x16x64_bf16 v[44:47], v[52:55], v[216:223], v4
    v_permlane32_swap_b32 v25, v37
    v_permlane32_swap_b32 v26, v38
    s_waitcnt lgkmcnt(3)
    v_smfmac_f32_16x16x64_bf16 v[32:35], v[56:59], a[208:215], v4
    v_permlane32_swap_b32 v27, v39
    v_add_f32 v24, v24, v36
    v_smfmac_f32_16x16x64_bf16 v[44:47], v[56:59], v[224:231], v4
    v_add_f32 v25, v25, v37
    v_add_f32 v26, v26, v38
    s_waitcnt lgkmcnt(2)
    v_smfmac_f32_16x16x64_bf16 v[32:35], v[60:63], a[216:223], v4
    v_add_f32 v27, v27, v39
    v_cvt_pk_bf16_f32 v36, v24, v25
    v_smfmac_f32_16x16x64_bf16 v[44:47], v[60:63], v[232:239], v4
    v_cvt_pk_bf16_f32 v37, v26, v27
    s_nop 1
    v_mfma_f32_16x16x16_bf16 v[24:27], v[36:37], v[10:11], 0
    s_waitcnt lgkmcnt(1)
    v_smfmac_f32_16x16x64_bf16 v[32:35], v[64:67], a[224:231], v4
    s_nop 5
    v_cvt_pk_bf16_f32 v24, v24, v25
    v_smfmac_f32_16x16x64_bf16 v[44:47], v[64:67], v[240:247], v4
    v_cvt_pk_bf16_f32 v25, v26, v27
    v_cvt_pk_bf16_f32 v26, v28, v29
    s_waitcnt lgkmcnt(0)
    v_smfmac_f32_16x16x64_bf16 v[32:35], v[48:51], a[232:239], v4
    v_cvt_pk_bf16_f32 v27, v30, v31
    s_waitcnt vmcnt(3)
    v_smfmac_f32_16x16x64_bf16 v[44:47], v[48:51], v[248:255], v4
    v_mfma_f32_16x16x32_bf16 v[28:31], a[240:243], v[24:27], 0
    v_mfma_f32_16x16x32_bf16 v[36:39], a[244:247], v[24:27], 0
    v_mfma_f32_16x16x32_bf16 v[40:43], v[24:27], v[24:27], 0
    s_nop 4
    v_permlane32_swap_b32 v32, v44
    v_permlane32_swap_b32 v33, v45
    v_permlane32_swap_b32 v34, v46
    v_permlane32_swap_b32 v35, v47
    v_add_f32 v32, v32, v44
    v_add_f32 v33, v33, v45
    v_add_f32 v34, v34, v46
    v_add_f32 v35, v35, v47
    v_cvt_pk_bf16_f32 v44, v32, v33
    v_cvt_pk_bf16_f32 v45, v34, v35
    s_nop 1
    v_mfma_f32_16x16x16_bf16 v[32:35], v[44:45], v[10:11], 0
    s_nop 7
    v_cvt_pk_bf16_f32 v32, v32, v33
    v_cvt_pk_bf16_f32 v33, v34, v35
    s_nop 1
    v_mfma_f32_16x16x16_bf16 v[28:31], a[248:249], v[32:33], v[28:31]
    v_mfma_f32_16x16x16_bf16 v[36:39], a[250:251], v[32:33], v[36:39]
    v_mfma_f32_16x16x16_bf16 v[40:43], v[32:33], v[32:33], v[40:43]
    buffer_atomic_add v0, v20, s[8:11], s49 offen
    s_nop 4
    ds_write_b128 v12, v[28:31]
    ds_write_b128 v12, v[36:39] offset:16
    ds_write_b128 v13, v[40:43]
    s_waitcnt lgkmcnt(0)
    s_barrier
    ds_read_b128 v[48:51], v14 offset:0
    ds_read_b128 v[52:55], v14 offset:16
    ds_read_b128 v[56:59], v14 offset:1408
    ds_read_b128 v[60:63], v14 offset:1424
    ds_read_b128 v[64:67], v14 offset:2816
    ds_read_b128 v[68:71], v14 offset:2832
    ds_read_b128 v[72:75], v14 offset:4224
    ds_read_b128 v[76:79], v14 offset:4240
    s_waitcnt lgkmcnt(4)
    v_pk_add_f32 v[48:49], v[48:49], v[56:57]
    v_pk_add_f32 v[50:51], v[50:51], v[58:59]
    v_pk_add_f32 v[52:53], v[52:53], v[60:61]
    v_pk_add_f32 v[54:55], v[54:55], v[62:63]
    s_waitcnt lgkmcnt(0)
    v_pk_add_f32 v[64:65], v[64:65], v[72:73]
    v_pk_add_f32 v[66:67], v[66:67], v[74:75]
    v_pk_add_f32 v[68:69], v[68:69], v[76:77]
    v_pk_add_f32 v[70:71], v[70:71], v[78:79]
    v_pk_add_f32 v[48:49], v[48:49], v[64:65]
    v_pk_add_f32 v[50:51], v[50:51], v[66:67]
    v_pk_add_f32 v[52:53], v[52:53], v[68:69]
    v_pk_add_f32 v[54:55], v[54:55], v[70:71]
    v_max3_f32 v92, v48, v49, v50
    v_max3_f32 v92, v92, v51, v52
    v_max3_f32 v92, v92, v53, v54
    v_max_f32 v92, v92, v55
    v_mov_b32 v93, 0xff800000
    v_cndmask_b32 v92, v93, v92, s[50:51]
    s_nop 1
    v_max_f32 v92, v92, v92 quad_perm:[1,0,3,2] row_mask:0xf bank_mask:0xf
    s_nop 1
    v_max_f32 v92, v92, v92 quad_perm:[2,3,0,1] row_mask:0xf bank_mask:0xf
    s_nop 1
    v_max_f32 v92, v92, v92 row_half_mirror row_mask:0xf bank_mask:0xf
    s_mov_b32 s24, 0x3dd53b95
    v_mul_f32 v92, s24, v92
    v_fma_f32 v48, v48, s24, -v92
    v_fma_f32 v49, v49, s24, -v92
    v_fma_f32 v50, v50, s24, -v92
    v_fma_f32 v51, v51, s24, -v92
    v_fma_f32 v52, v52, s24, -v92
    v_fma_f32 v53, v53, s24, -v92
    v_fma_f32 v54, v54, s24, -v92
    v_fma_f32 v55, v55, s24, -v92
    v_exp_f32 v48, v48
    v_exp_f32 v49, v49
    v_exp_f32 v50, v50
    v_exp_f32 v51, v51
    v_exp_f32 v52, v52
    v_exp_f32 v53, v53
    v_exp_f32 v54, v54
    v_exp_f32 v55, v55
    v_add_f32 v92, v48, v49
    v_add_f32 v93, v50, v51
    v_add_f32 v92, v92, v52
    v_add_f32 v93, v93, v53
    v_add_f32 v92, v92, v54
    v_add_f32 v93, v93, v55
    v_add_f32 v92, v92, v93
    v_cndmask_b32 v92, 0, v92, s[50:51]
    s_nop 1
    v_add_f32 v92, v92, v92 quad_perm:[1,0,3,2] row_mask:0xf bank_mask:0xf
    s_nop 1
    v_add_f32 v92, v92, v92 quad_perm:[2,3,0,1] row_mask:0xf bank_mask:0xf
    s_nop 1
    v_add_f32 v92, v92, v92 row_half_mirror row_mask:0xf bank_mask:0xf
    v_rcp_f32 v92, v92
    s_nop 0
    v_mul_f32 v48, v48, v92
    v_mul_f32 v49, v49, v92
    v_mul_f32 v50, v50, v92
    v_mul_f32 v51, v51, v92
    v_mul_f32 v52, v52, v92
    v_mul_f32 v53, v53, v92
    v_mul_f32 v54, v54, v92
    v_mul_f32 v55, v55, v92
    v_cvt_pk_bf16_f32 v56, v48, v49
    v_cvt_pk_bf16_f32 v57, v50, v51
    v_cvt_pk_bf16_f32 v58, v52, v53
    v_cvt_pk_bf16_f32 v59, v54, v55
    v_min_u32 v56, -2, v56
    v_min_u32 v57, -2, v57
    v_min_u32 v58, -2, v58
    v_min_u32 v59, -2, v59
    buffer_store_dwordx4 v[56:59], v15, s[8:11], s43 offen sc1
    s_waitcnt vmcnt(2)
    v_mfma_f32_16x16x32_bf16 v[36:39], a[240:243], v[80:83], 0
    v_mfma_f32_16x16x32_bf16 v[44:47], a[244:247], v[80:83], 0
    v_mfma_f32_16x16x32_bf16 v[68:71], v[24:27], v[80:83], 0
    v_mfma_f32_16x16x32_bf16 v[40:43], a[240:243], v[84:87], 0
    v_mfma_f32_16x16x32_bf16 v[64:67], a[244:247], v[84:87], 0
    v_mfma_f32_16x16x32_bf16 v[72:75], v[24:27], v[84:87], 0
    s_nop 0
    v_mfma_f32_16x16x16_bf16 v[36:39], a[248:249], v[88:89], v[36:39]
    v_mfma_f32_16x16x16_bf16 v[44:47], a[250:251], v[88:89], v[44:47]
    v_mfma_f32_16x16x16_bf16 v[68:71], v[32:33], v[88:89], v[68:71]
    v_mfma_f32_16x16x16_bf16 v[40:43], a[248:249], v[90:91], v[40:43]
    v_mfma_f32_16x16x16_bf16 v[64:67], a[250:251], v[90:91], v[64:67]
    v_mfma_f32_16x16x16_bf16 v[72:75], v[32:33], v[90:91], v[72:75]
    s_nop 2
    ds_write_b128 v16, v[36:39] offset:0
    ds_write_b128 v16, v[44:47] offset:16
    ds_write_b128 v17, v[68:71]
    ds_write_b128 v16, v[40:43] offset:2816
    ds_write_b128 v16, v[64:67] offset:2832
    ds_write_b128 v18, v[72:75]
    s_add_u32 s40, s40, 1
    s_add_u32 s41, s41, 393216
    s_add_u32 s45, s45, 393216
    s_add_u32 s43, s43, 458752
    s_add_u32 s47, s47, 458752
    s_add_u32 s48, s48, 458752
    s_add_u32 s49, s49, 458752
    s_waitcnt lgkmcnt(0)
    s_barrier
    s_cmp_lt_u32 s40, 64
    s_cbranch_scc1 interleave_layers__linear_attn_block__memory_aug_recurrent_mem_tr__prompt_kernel_s_stepw0
    s_branch interleave_layers__linear_attn_block__memory_aug_recurrent_mem_tr__prompt_kernel_s_end
interleave_layers__linear_attn_block__memory_aug_recurrent_mem_tr__prompt_kernel_s_stepw1:
    v_mov_b32 v24, 0
    v_mov_b32 v25, 0
    v_mov_b32 v26, 0
    v_mov_b32 v27, 0
    v_mov_b32 v28, 0
    v_mov_b32 v29, 0
    v_mov_b32 v30, 0
    v_mov_b32 v31, 0
    v_mov_b32 v32, 0
    v_mov_b32 v33, 0
    v_mov_b32 v34, 0
    v_mov_b32 v35, 0
    v_mov_b32 v36, 0
    v_mov_b32 v37, 0
    v_mov_b32 v38, 0
    v_mov_b32 v39, 0
    v_mov_b32 v40, 0
    v_mov_b32 v41, 0
    v_mov_b32 v42, 0
    v_mov_b32 v43, 0
    v_mov_b32 v44, 0
    v_mov_b32 v45, 0
    v_mov_b32 v46, 0
    v_mov_b32 v47, 0
    s_add_u32 s46, s47, 4096
    s_lshl_b32 s95, s92, 6
    s_add_u32 s95, s95, s40
    s_add_u32 s95, s95, 1
    s_cmp_ge_i32 s59, s95
    s_cbranch_scc1 interleave_layers__linear_attn_block__memory_aug_recurrent_mem_tr__prompt_kernel_s_ecw1_ok
    s_and_b32 s24, s2, 7
    s_lshl_b32 s24, s24, 7
    s_add_u32 s24, s24, 23109632
    v_and_b32 v49, 3, v1
    v_lshl_add_u32 v49, v49, 2, s24
    s_mov_b32 s61, 0
interleave_layers__linear_attn_block__memory_aug_recurrent_mem_tr__prompt_kernel_s_ecw1:
    buffer_load_dword v48, v49, s[8:11], 0 offen sc1
    s_waitcnt vmcnt(0)
    v_readlane_b32 s59, v48, 0
    v_readlane_b32 s24, v48, 1
    s_min_i32 s59, s59, s24
    v_readlane_b32 s24, v48, 2
    s_min_i32 s59, s59, s24
    s_cmp_ge_i32 s59, s95
    s_cbranch_scc1 interleave_layers__linear_attn_block__memory_aug_recurrent_mem_tr__prompt_kernel_s_ecw1_ok
    s_add_u32 s61, s61, 1
    s_cmp_ge_u32 s61, s60
    s_cbranch_scc1 interleave_layers__linear_attn_block__memory_aug_recurrent_mem_tr__prompt_kernel_s_ecw1_to
    s_sleep 2
    s_branch interleave_layers__linear_attn_block__memory_aug_recurrent_mem_tr__prompt_kernel_s_ecw1
interleave_layers__linear_attn_block__memory_aug_recurrent_mem_tr__prompt_kernel_s_ecw1_to:
    s_mov_b32 s60, 1
interleave_layers__linear_attn_block__memory_aug_recurrent_mem_tr__prompt_kernel_s_ecw1_ok:
    s_add_u32 s63, s40, 1
    s_cmp_ge_i32 s62, s63
    s_cbranch_scc1 interleave_layers__linear_attn_block__memory_aug_recurrent_mem_tr__prompt_kernel_s_enw1_ok
    s_mov_b32 s61, 0
interleave_layers__linear_attn_block__memory_aug_recurrent_mem_tr__prompt_kernel_s_enw1:
    buffer_load_dword v48, v9, s[8:11], 0 offen sc1
    s_waitcnt vmcnt(0)
    v_readlane_b32 s62, v48, 0
    v_readlane_b32 s24, v48, 1
    s_min_i32 s62, s62, s24
    s_cmp_ge_i32 s62, s63
    s_cbranch_scc1 interleave_layers__linear_attn_block__memory_aug_recurrent_mem_tr__prompt_kernel_s_enw1_ok
    s_add_u32 s61, s61, 1
    s_cmp_ge_u32 s61, s60
    s_cbranch_scc1 interleave_layers__linear_attn_block__memory_aug_recurrent_mem_tr__prompt_kernel_s_enw1_to
    s_sleep 2
    s_branch interleave_layers__linear_attn_block__memory_aug_recurrent_mem_tr__prompt_kernel_s_enw1
interleave_layers__linear_attn_block__memory_aug_recurrent_mem_tr__prompt_kernel_s_enw1_to:
    s_mov_b32 s60, 1
interleave_layers__linear_attn_block__memory_aug_recurrent_mem_tr__prompt_kernel_s_enw1_ok:
    buffer_load_dwordx4 a[240:243], v19, s[8:11], s41 offen offset:0 sc1
    buffer_load_dwordx4 a[244:247], v19, s[8:11], s41 offen offset:1024 sc1
    buffer_load_dwordx4 a[248:251], v19, s[8:11], s41 offen offset:2048 sc1
    s_sleep 5
    s_mov_b64 exec, 1
    s_mov_b32 s61, 0
    v_mov_b32 v83, 0
    buffer_atomic_add v83, v23, s[8:11], s48 offen sc0
    s_sleep 3
    v_mov_b32 v94, 0
    buffer_atomic_add v94, v23, s[8:11], s48 offen sc0
    s_sleep 3
    v_mov_b32 v95, 0
    buffer_atomic_add v95, v23, s[8:11], s48 offen sc0
    s_sleep 3
interleave_layers__linear_attn_block__memory_aug_recurrent_mem_tr__prompt_kernel_s_prw1:
    v_mov_b32 v82, 0
    buffer_atomic_add v82, v23, s[8:11], s48 offen sc0
    s_waitcnt vmcnt(3)
    v_cmp_le_i32 vcc, 8, v83
    s_add_u32 s61, s61, 1
    s_cbranch_vccnz interleave_layers__linear_attn_block__memory_aug_recurrent_mem_tr__prompt_kernel_s_prw1_out
    s_sleep 3
    v_mov_b32 v83, 0
    buffer_atomic_add v83, v23, s[8:11], s48 offen sc0
    s_waitcnt vmcnt(3)
    v_cmp_le_i32 vcc, 8, v94
    s_add_u32 s61, s61, 1
    s_cbranch_vccnz interleave_layers__linear_attn_block__memory_aug_recurrent_mem_tr__prompt_kernel_s_prw1_out
    s_sleep 3
    v_mov_b32 v94, 0
    buffer_atomic_add v94, v23, s[8:11], s48 offen sc0
    s_waitcnt vmcnt(3)
    v_cmp_le_i32 vcc, 8, v95
    s_add_u32 s61, s61, 1
    s_cbranch_vccnz interleave_layers__linear_attn_block__memory_aug_recurrent_mem_tr__prompt_kernel_s_prw1_out
    s_sleep 3
    v_mov_b32 v95, 0
    buffer_atomic_add v95, v23, s[8:11], s48 offen sc0
    s_waitcnt vmcnt(3)
    v_cmp_le_i32 vcc, 8, v82
    s_add_u32 s61, s61, 1
    s_cbranch_vccnz interleave_layers__linear_attn_block__memory_aug_recurrent_mem_tr__prompt_kernel_s_prw1_out
    s_sleep 3
    s_cmp_ge_u32 s61, s60
    s_cbranch_scc0 interleave_layers__linear_attn_block__memory_aug_recurrent_mem_tr__prompt_kernel_s_prw1
    s_mov_b32 s60, 1
interleave_layers__linear_attn_block__memory_aug_recurrent_mem_tr__prompt_kernel_s_prw1_out:
    s_mov_b64 exec, -1
    buffer_load_dwordx4 v[84:87], v7, s[8:11], s47 offen sc1
    buffer_load_dwordx4 v[88:91], v7, s[8:11], s46 offen sc1
    buffer_load_dwordx2 v[92:93], v8, s[8:11], s47 offen sc1
    ds_read_b128 v[48:51], v21 offset:0
    ds_read_b128 v[52:55], v21 offset:16
    ds_read_b128 v[56:59], v21 offset:5632
    ds_read_b128 v[60:63], v21 offset:5648
    ds_read_b128 v[64:67], v21 offset:11264
    ds_read_b128 v[68:71], v21 offset:11280
    ds_read_b128 v[72:75], v21 offset:16896
    ds_read_b128 v[76:79], v21 offset:16912
    s_waitcnt lgkmcnt(4)
    v_pk_add_f32 v[48:49], v[48:49], v[56:57]
    v_pk_add_f32 v[50:51], v[50:51], v[58:59]
    v_pk_add_f32 v[52:53], v[52:53], v[60:61]
    v_pk_add_f32 v[54:55], v[54:55], v[62:63]
    s_waitcnt lgkmcnt(0)
    v_pk_add_f32 v[64:65], v[64:65], v[72:73]
    v_pk_add_f32 v[66:67], v[66:67], v[74:75]
    v_pk_add_f32 v[68:69], v[68:69], v[76:77]
    v_pk_add_f32 v[70:71], v[70:71], v[78:79]
    v_pk_add_f32 v[48:49], v[48:49], v[64:65]
    v_pk_add_f32 v[50:51], v[50:51], v[66:67]
    v_pk_add_f32 v[52:53], v[52:53], v[68:69]
    v_pk_add_f32 v[54:55], v[54:55], v[70:71]
    v_mov_b32 v81, 0xff800000
    v_cndmask_b32 v48, v81, v48, s[64:65]
    v_cndmask_b32 v49, v81, v49, s[66:67]
    v_cndmask_b32 v50, v81, v50, s[68:69]
    v_cndmask_b32 v51, v81, v51, s[70:71]
    v_cndmask_b32 v52, v81, v52, s[72:73]
    v_cndmask_b32 v53, v81, v53, s[74:75]
    v_cndmask_b32 v54, v81, v54, s[76:77]
    v_cndmask_b32 v55, v81, v55, s[78:79]
    v_max3_f32 v80, v48, v49, v50
    v_max3_f32 v80, v80, v51, v52
    v_max3_f32 v80, v80, v53, v54
    v_max_f32 v80, v80, v55
    v_mov_b32 v81, 0xff800000
    v_cndmask_b32 v80, v81, v80, s[50:51]
    s_nop 1
    v_max_f32 v80, v80, v80 quad_perm:[1,0,3,2] row_mask:0xf bank_mask:0xf
    s_nop 1
    v_max_f32 v80, v80, v80 quad_perm:[2,3,0,1] row_mask:0xf bank_mask:0xf
    s_nop 1
    v_max_f32 v80, v80, v80 row_half_mirror row_mask:0xf bank_mask:0xf
    s_mov_b32 s24, 0x3dd53b95
    v_mul_f32 v80, s24, v80
    v_fma_f32 v48, v48, s24, -v80
    v_fma_f32 v49, v49, s24, -v80
    v_fma_f32 v50, v50, s24, -v80
    v_fma_f32 v51, v51, s24, -v80
    v_fma_f32 v52, v52, s24, -v80
    v_fma_f32 v53, v53, s24, -v80
    v_fma_f32 v54, v54, s24, -v80
    v_fma_f32 v55, v55, s24, -v80
    v_exp_f32 v48, v48
    v_exp_f32 v49, v49
    v_exp_f32 v50, v50
    v_exp_f32 v51, v51
    v_exp_f32 v52, v52
    v_exp_f32 v53, v53
    v_exp_f32 v54, v54
    v_exp_f32 v55, v55
    v_add_f32 v80, v48, v49
    v_add_f32 v81, v50, v51
    v_add_f32 v80, v80, v52
    v_add_f32 v81, v81, v53
    v_add_f32 v80, v80, v54
    v_add_f32 v81, v81, v55
    v_add_f32 v80, v80, v81
    v_cndmask_b32 v80, 0, v80, s[50:51]
    s_nop 1
    v_add_f32 v80, v80, v80 quad_perm:[1,0,3,2] row_mask:0xf bank_mask:0xf
    s_nop 1
    v_add_f32 v80, v80, v80 quad_perm:[2,3,0,1] row_mask:0xf bank_mask:0xf
    s_nop 1
    v_add_f32 v80, v80, v80 row_half_mirror row_mask:0xf bank_mask:0xf
    v_rcp_f32 v80, v80
    s_nop 0
    v_mul_f32 v48, v48, v80
    v_mul_f32 v49, v49, v80
    v_mul_f32 v50, v50, v80
    v_mul_f32 v51, v51, v80
    v_mul_f32 v52, v52, v80
    v_mul_f32 v53, v53, v80
    v_mul_f32 v54, v54, v80
    v_mul_f32 v55, v55, v80
    v_cvt_pk_bf16_f32 v56, v48, v49
    v_cvt_pk_bf16_f32 v57, v50, v51
    v_cvt_pk_bf16_f32 v58, v52, v53
    v_cvt_pk_bf16_f32 v59, v54, v55
    v_min_u32 v56, -2, v56
    v_min_u32 v57, -2, v57
    v_min_u32 v58, -2, v58
    v_min_u32 v59, -2, v59
    buffer_store_dwordx4 v[56:59], v22, s[8:11], s42 offen sc1
    s_add_u32 s42, s42, 458752
    s_waitcnt vmcnt(1)
    v_max3_u32 v58, v84, v85, v86
    v_max3_u32 v58, v58, v87, v88
    v_max3_u32 v58, v58, v89, v90
    v_max3_u32 v58, v58, v91, v92
    v_max_u32 v58, v58, v93
    v_cmp_eq_u32 vcc, -1, v58
    s_cbranch_vccz interleave_layers__linear_attn_block__memory_aug_recurrent_mem_tr__prompt_kernel_s_pmw1_out
    s_mov_b32 s61, 0
interleave_layers__linear_attn_block__memory_aug_recurrent_mem_tr__prompt_kernel_s_pmw1:
    buffer_load_dwordx4 v[84:87], v7, s[8:11], s47 offen sc1
    buffer_load_dwordx4 v[88:91], v7, s[8:11], s46 offen sc1
    buffer_load_dwordx2 v[92:93], v8, s[8:11], s47 offen sc1
    s_waitcnt vmcnt(0)
    v_max3_u32 v58, v84, v85, v86
    v_max3_u32 v58, v58, v87, v88
    v_max3_u32 v58, v58, v89, v90
    v_max3_u32 v58, v58, v91, v92
    v_max_u32 v58, v58, v93
    v_cmp_eq_u32 vcc, -1, v58
    s_add_u32 s61, s61, 1
    s_cbranch_vccz interleave_layers__linear_attn_block__memory_aug_recurrent_mem_tr__prompt_kernel_s_pmw1_out
    s_cmp_ge_u32 s61, s60
    s_cbranch_scc1 interleave_layers__linear_attn_block__memory_aug_recurrent_mem_tr__prompt_kernel_s_pmw1_to
    s_sleep 1
    s_branch interleave_layers__linear_attn_block__memory_aug_recurrent_mem_tr__prompt_kernel_s_pmw1
interleave_layers__linear_attn_block__memory_aug_recurrent_mem_tr__prompt_kernel_s_pmw1_to:
    s_mov_b32 s60, 1
interleave_layers__linear_attn_block__memory_aug_recurrent_mem_tr__prompt_kernel_s_pmw1_out:
    ds_write_b128 v7, v[84:87]
    ds_write_b128 v7, v[88:91] offset:4096
    ds_write_b64 v8, v[92:93]
interleave_layers__linear_attn_block__memory_aug_recurrent_mem_tr__prompt_kernel_s_gow1:
    ds_read_b128 v[68:71], v6 offset:2048
    ds_read_b128 v[72:75], v6 offset:3072
    ds_read_b128 v[76:79], v6 offset:10240
    ds_read_b128 v[80:83], v6 offset:11264
    v_smfmac_f32_16x16x64_bf16 v[24:27], v[84:87], a[8:15], v4
    v_smfmac_f32_16x16x64_bf16 v[28:31], v[84:87], a[88:95], v4
    v_smfmac_f32_16x16x64_bf16 v[32:35], v[84:87], a[168:175], v4
    v_smfmac_f32_16x16x64_bf16 v[40:43], v[84:87], v[104:111], v4
    v_smfmac_f32_16x16x64_bf16 v[44:47], v[84:87], v[184:191], v4
    s_waitcnt lgkmcnt(2)
    v_smfmac_f32_16x16x64_bf16 v[36:39], v[84:87], v[68:75], v4
    ds_read_b128 v[68:71], v6 offset:0
    ds_read_b128 v[72:75], v6 offset:1024
    s_barrier
    ds_read_b128 v[48:51], v5 offset:0
    ds_read_b128 v[52:55], v5 offset:2048
    ds_read_b128 v[56:59], v5 offset:3072
    ds_read_b128 v[60:63], v5 offset:4096
    ds_read_b128 v[64:67], v5 offset:6144
    v_smfmac_f32_16x16x64_bf16 v[24:27], v[88:91], a[40:47], v4
    v_smfmac_f32_16x16x64_bf16 v[28:31], v[88:91], a[120:127], v4
    v_smfmac_f32_16x16x64_bf16 v[32:35], v[88:91], a[200:207], v4
    v_smfmac_f32_16x16x64_bf16 v[40:43], v[88:91], v[136:143], v4
    v_smfmac_f32_16x16x64_bf16 v[44:47], v[88:91], v[216:223], v4
    s_waitcnt lgkmcnt(7)
    v_smfmac_f32_16x16x64_bf16 v[36:39], v[88:91], v[76:83], v4
    ds_read_b128 v[76:79], v6 offset:4096
    ds_read_b128 v[80:83], v6 offset:5120
    s_waitcnt lgkmcnt(6)
    v_smfmac_f32_16x16x64_bf16 v[24:27], v[48:51], a[0:7], v4
    v_smfmac_f32_16x16x64_bf16 v[28:31], v[48:51], a[80:87], v4
    v_smfmac_f32_16x16x64_bf16 v[40:43], v[48:51], v[96:103], v4
    v_smfmac_f32_16x16x64_bf16 v[36:39], v[48:51], v[68:75], v4
    ds_read_b128 v[68:71], v6 offset:6144
    ds_read_b128 v[72:75], v6 offset:7168
    ds_read_b128 v[48:51], v5 offset:7168
    s_waitcnt lgkmcnt(8)
    v_smfmac_f32_16x16x64_bf16 v[24:27], v[52:55], a[16:23], v4
    v_smfmac_f32_16x16x64_bf16 v[28:31], v[52:55], a[96:103], v4
    v_smfmac_f32_16x16x64_bf16 v[40:43], v[52:55], v[112:119], v4
    s_waitcnt lgkmcnt(3)
    v_smfmac_f32_16x16x64_bf16 v[36:39], v[52:55], v[76:83], v4
    ds_read_b128 v[76:79], v6 offset:8192
    ds_read_b128 v[80:83], v6 offset:9216
    ds_read_b128 v[52:55], v5 offset:8192
    v_smfmac_f32_16x16x64_bf16 v[24:27], v[56:59], a[24:31], v4
    v_smfmac_f32_16x16x64_bf16 v[28:31], v[56:59], a[104:111], v4
    v_smfmac_f32_16x16x64_bf16 v[40:43], v[56:59], v[120:127], v4
    s_waitcnt lgkmcnt(4)
    v_smfmac_f32_16x16x64_bf16 v[36:39], v[56:59], v[68:75], v4
    ds_read_b128 v[68:71], v6 offset:12288
    ds_read_b128 v[72:75], v6 offset:13312
    ds_read_b128 v[56:59], v5 offset:9216
    v_smfmac_f32_16x16x64_bf16 v[24:27], v[60:63], a[32:39], v4
    v_smfmac_f32_16x16x64_bf16 v[28:31], v[60:63], a[112:119], v4
    v_smfmac_f32_16x16x64_bf16 v[40:43], v[60:63], v[128:135], v4
    s_waitcnt lgkmcnt(4)
    v_smfmac_f32_16x16x64_bf16 v[36:39], v[60:63], v[76:83], v4
    ds_read_b128 v[76:79], v6 offset:14336
    ds_read_b128 v[80:83], v6 offset:15360
    ds_read_b128 v[60:63], v5 offset:0
    v_smfmac_f32_16x16x64_bf16 v[24:27], v[64:67], a[48:55], v4
    v_smfmac_f32_16x16x64_bf16 v[28:31], v[64:67], a[128:135], v4
    v_smfmac_f32_16x16x64_bf16 v[40:43], v[64:67], v[144:151], v4
    s_waitcnt lgkmcnt(4)
    v_smfmac_f32_16x16x64_bf16 v[36:39], v[64:67], v[68:75], v4
    ds_read_b128 v[68:71], v6 offset:16384
    ds_read_b128 v[72:75], v6 offset:17408
    ds_read_b128 v[64:67], v5 offset:2048
    v_smfmac_f32_16x16x64_bf16 v[24:27], v[48:51], a[56:63], v4
    v_smfmac_f32_16x16x64_bf16 v[28:31], v[48:51], a[136:143], v4
    v_smfmac_f32_16x16x64_bf16 v[40:43], v[48:51], v[152:159], v4
    s_waitcnt lgkmcnt(4)
    v_smfmac_f32_16x16x64_bf16 v[36:39], v[48:51], v[76:83], v4
    ds_read_b128 v[76:79], v6 offset:18432
    ds_read_b128 v[80:83], v6 offset:19456
    ds_read_b128 v[48:51], v5 offset:3072
    v_smfmac_f32_16x16x64_bf16 v[24:27], v[52:55], a[64:71], v4
    v_smfmac_f32_16x16x64_bf16 v[28:31], v[52:55], a[144:151], v4
    v_smfmac_f32_16x16x64_bf16 v[40:43], v[52:55], v[160:167], v4
    s_waitcnt lgkmcnt(4)
    v_smfmac_f32_16x16x64_bf16 v[36:39], v[52:55], v[68:75], v4
    ds_read_b128 v[52:55], v5 offset:4096
    v_smfmac_f32_16x16x64_bf16 v[24:27], v[56:59], a[72:79], v4
    v_smfmac_f32_16x16x64_bf16 v[28:31], v[56:59], a[152:159], v4
    v_smfmac_f32_16x16x64_bf16 v[40:43], v[56:59], v[168:175], v4
    s_waitcnt lgkmcnt(2)
    v_smfmac_f32_16x16x64_bf16 v[36:39], v[56:59], v[76:83], v4
    ds_read_b128 v[56:59], v5 offset:6144
    buffer_load_dwordx4 v[80:83], v19, s[8:11], s45 offen offset:0 sc1
    buffer_load_dwordx4 v[84:87], v19, s[8:11], s45 offen offset:1024 sc1
    buffer_load_dwordx4 v[88:91], v19, s[8:11], s45 offen offset:2048 sc1
    v_smfmac_f32_16x16x64_bf16 v[32:35], v[60:63], a[160:167], v4
    v_smfmac_f32_16x16x64_bf16 v[44:47], v[60:63], v[176:183], v4
    v_permlane32_swap_b32 v28, v40
    v_permlane32_swap_b32 v29, v41
    ds_read_b128 v[60:63], v5 offset:7168
    v_smfmac_f32_16x16x64_bf16 v[32:35], v[64:67], a[176:183], v4
    v_permlane32_swap_b32 v30, v42
    v_permlane32_swap_b32 v31, v43
    v_smfmac_f32_16x16x64_bf16 v[44:47], v[64:67], v[192:199], v4
    v_add_f32 v28, v28, v40
    v_add_f32 v29, v29, v41
    ds_read_b128 v[64:67], v5 offset:8192
    s_waitcnt lgkmcnt(4)
    v_smfmac_f32_16x16x64_bf16 v[32:35], v[48:51], a[184:191], v4
    v_add_f32 v30, v30, v42
    v_add_f32 v31, v31, v43
    v_smfmac_f32_16x16x64_bf16 v[44:47], v[48:51], v[200:207], v4
    v_cvt_pk_bf16_f32 v40, v28, v29
    v_cvt_pk_bf16_f32 v41, v30, v31
    ds_read_b128 v[48:51], v5 offset:9216
    s_waitcnt lgkmcnt(4)
    v_smfmac_f32_16x16x64_bf16 v[32:35], v[52:55], a[192:199], v4
    v_mfma_f32_16x16x16_bf16 v[28:31], v[40:41], v[10:11], 0
    v_permlane32_swap_b32 v24, v36
    v_smfmac_f32_16x16x64_bf16 v[44:47], v[52:55], v[208:215], v4
    v_permlane32_swap_b32 v25, v37
    v_permlane32_swap_b32 v26, v38
    s_waitcnt lgkmcnt(3)
    v_smfmac_f32_16x16x64_bf16 v[32:35], v[56:59], a[208:215], v4
    v_permlane32_swap_b32 v27, v39
    v_add_f32 v24, v24, v36
    v_smfmac_f32_16x16x64_bf16 v[44:47], v[56:59], v[224:231], v4
    v_add_f32 v25, v25, v37
    v_add_f32 v26, v26, v38
    s_waitcnt lgkmcnt(2)
    v_smfmac_f32_16x16x64_bf16 v[32:35], v[60:63], a[216:223], v4
    v_add_f32 v27, v27, v39
    v_cvt_pk_bf16_f32 v36, v24, v25
    v_smfmac_f32_16x16x64_bf16 v[44:47], v[60:63], v[232:239], v4
    v_cvt_pk_bf16_f32 v37, v26, v27
    s_nop 1
    v_mfma_f32_16x16x16_bf16 v[24:27], v[36:37], v[10:11], 0
    s_waitcnt lgkmcnt(1)
    v_smfmac_f32_16x16x64_bf16 v[32:35], v[64:67], a[224:231], v4
    s_nop 5
    v_cvt_pk_bf16_f32 v24, v24, v25
    v_smfmac_f32_16x16x64_bf16 v[44:47], v[64:67], v[240:247], v4
    v_cvt_pk_bf16_f32 v25, v26, v27
    v_cvt_pk_bf16_f32 v26, v28, v29
    s_waitcnt lgkmcnt(0)
    v_smfmac_f32_16x16x64_bf16 v[32:35], v[48:51], a[232:239], v4
    v_cvt_pk_bf16_f32 v27, v30, v31
    s_waitcnt vmcnt(3)
    v_smfmac_f32_16x16x64_bf16 v[44:47], v[48:51], v[248:255], v4
    v_mfma_f32_16x16x32_bf16 v[28:31], a[240:243], v[24:27], 0
    v_mfma_f32_16x16x32_bf16 v[36:39], a[244:247], v[24:27], 0
    v_mfma_f32_16x16x32_bf16 v[40:43], v[24:27], v[24:27], 0
    s_nop 4
    v_permlane32_swap_b32 v32, v44
    v_permlane32_swap_b32 v33, v45
    v_permlane32_swap_b32 v34, v46
    v_permlane32_swap_b32 v35, v47
    v_add_f32 v32, v32, v44
    v_add_f32 v33, v33, v45
    v_add_f32 v34, v34, v46
    v_add_f32 v35, v35, v47
    v_cvt_pk_bf16_f32 v44, v32, v33
    v_cvt_pk_bf16_f32 v45, v34, v35
    s_nop 1
    v_mfma_f32_16x16x16_bf16 v[32:35], v[44:45], v[10:11], 0
    s_nop 7
    v_cvt_pk_bf16_f32 v32, v32, v33
    v_cvt_pk_bf16_f32 v33, v34, v35
    s_nop 1
    v_mfma_f32_16x16x16_bf16 v[28:31], a[248:249], v[32:33], v[28:31]
    v_mfma_f32_16x16x16_bf16 v[36:39], a[250:251], v[32:33], v[36:39]
    v_mfma_f32_16x16x16_bf16 v[40:43], v[32:33], v[32:33], v[40:43]
    s_nop 5
    ds_write_b128 v12, v[28:31]
    ds_write_b128 v12, v[36:39] offset:16
    ds_write_b128 v13, v[40:43]
    s_waitcnt lgkmcnt(0)
    s_barrier
    s_waitcnt vmcnt(0)
    v_mfma_f32_16x16x32_bf16 v[36:39], a[240:243], v[80:83], 0
    v_mfma_f32_16x16x32_bf16 v[44:47], a[244:247], v[80:83], 0
    v_mfma_f32_16x16x32_bf16 v[68:71], v[24:27], v[80:83], 0
    v_mfma_f32_16x16x32_bf16 v[40:43], a[240:243], v[84:87], 0
    v_mfma_f32_16x16x32_bf16 v[64:67], a[244:247], v[84:87], 0
    v_mfma_f32_16x16x32_bf16 v[72:75], v[24:27], v[84:87], 0
    s_nop 0
    v_mfma_f32_16x16x16_bf16 v[36:39], a[248:249], v[88:89], v[36:39]
    v_mfma_f32_16x16x16_bf16 v[44:47], a[250:251], v[88:89], v[44:47]
    v_mfma_f32_16x16x16_bf16 v[68:71], v[32:33], v[88:89], v[68:71]
    v_mfma_f32_16x16x16_bf16 v[40:43], a[248:249], v[90:91], v[40:43]
    v_mfma_f32_16x16x16_bf16 v[64:67], a[250:251], v[90:91], v[64:67]
    v_mfma_f32_16x16x16_bf16 v[72:75], v[32:33], v[90:91], v[72:75]
    s_nop 2
    ds_write_b128 v16, v[36:39] offset:0
    ds_write_b128 v16, v[44:47] offset:16
    ds_write_b128 v17, v[68:71]
    ds_write_b128 v16, v[40:43] offset:2816
    ds_write_b128 v16, v[64:67] offset:2832
    ds_write_b128 v18, v[72:75]
    s_add_u32 s40, s40, 1
    s_add_u32 s41, s41, 393216
    s_add_u32 s45, s45, 393216
    s_add_u32 s43, s43, 458752
    s_add_u32 s47, s47, 458752
    s_add_u32 s48, s48, 458752
    s_add_u32 s49, s49, 458752
    s_waitcnt lgkmcnt(0)
    s_barrier
    s_cmp_lt_u32 s40, 64
    s_cbranch_scc1 interleave_layers__linear_attn_block__memory_aug_recurrent_mem_tr__prompt_kernel_s_stepw1
    s_branch interleave_layers__linear_attn_block__memory_aug_recurrent_mem_tr__prompt_kernel_s_end
interleave_layers__linear_attn_block__memory_aug_recurrent_mem_tr__prompt_kernel_s_stepw2:
    v_mov_b32 v24, 0
    v_mov_b32 v25, 0
    v_mov_b32 v26, 0
    v_mov_b32 v27, 0
    v_mov_b32 v28, 0
    v_mov_b32 v29, 0
    v_mov_b32 v30, 0
    v_mov_b32 v31, 0
    v_mov_b32 v32, 0
    v_mov_b32 v33, 0
    v_mov_b32 v34, 0
    v_mov_b32 v35, 0
    v_mov_b32 v36, 0
    v_mov_b32 v37, 0
    v_mov_b32 v38, 0
    v_mov_b32 v39, 0
    v_mov_b32 v40, 0
    v_mov_b32 v41, 0
    v_mov_b32 v42, 0
    v_mov_b32 v43, 0
    v_mov_b32 v44, 0
    v_mov_b32 v45, 0
    v_mov_b32 v46, 0
    v_mov_b32 v47, 0
    s_add_u32 s46, s47, 4096
    s_lshl_b32 s95, s92, 6
    s_add_u32 s95, s95, s40
    s_add_u32 s95, s95, 1
    s_cmp_ge_i32 s59, s95
    s_cbranch_scc1 interleave_layers__linear_attn_block__memory_aug_recurrent_mem_tr__prompt_kernel_s_ecw2_ok
    s_and_b32 s24, s2, 7
    s_lshl_b32 s24, s24, 7
    s_add_u32 s24, s24, 23109632
    v_and_b32 v49, 3, v1
    v_lshl_add_u32 v49, v49, 2, s24
    s_mov_b32 s61, 0
interleave_layers__linear_attn_block__memory_aug_recurrent_mem_tr__prompt_kernel_s_ecw2:
    buffer_load_dword v48, v49, s[8:11], 0 offen sc1
    s_waitcnt vmcnt(0)
    v_readlane_b32 s59, v48, 0
    v_readlane_b32 s24, v48, 1
    s_min_i32 s59, s59, s24
    v_readlane_b32 s24, v48, 2
    s_min_i32 s59, s59, s24
    s_cmp_ge_i32 s59, s95
    s_cbranch_scc1 interleave_layers__linear_attn_block__memory_aug_recurrent_mem_tr__prompt_kernel_s_ecw2_ok
    s_add_u32 s61, s61, 1
    s_cmp_ge_u32 s61, s60
    s_cbranch_scc1 interleave_layers__linear_attn_block__memory_aug_recurrent_mem_tr__prompt_kernel_s_ecw2_to
    s_sleep 2
    s_branch interleave_layers__linear_attn_block__memory_aug_recurrent_mem_tr__prompt_kernel_s_ecw2
interleave_layers__linear_attn_block__memory_aug_recurrent_mem_tr__prompt_kernel_s_ecw2_to:
    s_mov_b32 s60, 1
interleave_layers__linear_attn_block__memory_aug_recurrent_mem_tr__prompt_kernel_s_ecw2_ok:
    s_add_u32 s63, s40, 1
    s_cmp_ge_i32 s62, s63
    s_cbranch_scc1 interleave_layers__linear_attn_block__memory_aug_recurrent_mem_tr__prompt_kernel_s_enw2_ok
    s_mov_b32 s61, 0
interleave_layers__linear_attn_block__memory_aug_recurrent_mem_tr__prompt_kernel_s_enw2:
    buffer_load_dword v48, v9, s[8:11], 0 offen sc1
    s_waitcnt vmcnt(0)
    v_readlane_b32 s62, v48, 0
    v_readlane_b32 s24, v48, 1
    s_min_i32 s62, s62, s24
    s_cmp_ge_i32 s62, s63
    s_cbranch_scc1 interleave_layers__linear_attn_block__memory_aug_recurrent_mem_tr__prompt_kernel_s_enw2_ok
    s_add_u32 s61, s61, 1
    s_cmp_ge_u32 s61, s60
    s_cbranch_scc1 interleave_layers__linear_attn_block__memory_aug_recurrent_mem_tr__prompt_kernel_s_enw2_to
    s_sleep 2
    s_branch interleave_layers__linear_attn_block__memory_aug_recurrent_mem_tr__prompt_kernel_s_enw2
interleave_layers__linear_attn_block__memory_aug_recurrent_mem_tr__prompt_kernel_s_enw2_to:
    s_mov_b32 s60, 1
interleave_layers__linear_attn_block__memory_aug_recurrent_mem_tr__prompt_kernel_s_enw2_ok:
    buffer_load_dwordx4 a[240:243], v19, s[8:11], s41 offen offset:0 sc1
    buffer_load_dwordx4 a[244:247], v19, s[8:11], s41 offen offset:1024 sc1
    buffer_load_dwordx4 a[248:251], v19, s[8:11], s41 offen offset:2048 sc1
    s_sleep 5
    s_mov_b64 exec, 1
    s_mov_b32 s61, 0
    v_mov_b32 v83, 0
    buffer_atomic_add v83, v23, s[8:11], s48 offen sc0
    s_sleep 3
    v_mov_b32 v94, 0
    buffer_atomic_add v94, v23, s[8:11], s48 offen sc0
    s_sleep 3
    v_mov_b32 v95, 0
    buffer_atomic_add v95, v23, s[8:11], s48 offen sc0
    s_sleep 3
interleave_layers__linear_attn_block__memory_aug_recurrent_mem_tr__prompt_kernel_s_prw2:
    v_mov_b32 v82, 0
    buffer_atomic_add v82, v23, s[8:11], s48 offen sc0
    s_waitcnt vmcnt(3)
    v_cmp_le_i32 vcc, 8, v83
    s_add_u32 s61, s61, 1
    s_cbranch_vccnz interleave_layers__linear_attn_block__memory_aug_recurrent_mem_tr__prompt_kernel_s_prw2_out
    s_sleep 3
    v_mov_b32 v83, 0
    buffer_atomic_add v83, v23, s[8:11], s48 offen sc0
    s_waitcnt vmcnt(3)
    v_cmp_le_i32 vcc, 8, v94
    s_add_u32 s61, s61, 1
    s_cbranch_vccnz interleave_layers__linear_attn_block__memory_aug_recurrent_mem_tr__prompt_kernel_s_prw2_out
    s_sleep 3
    v_mov_b32 v94, 0
    buffer_atomic_add v94, v23, s[8:11], s48 offen sc0
    s_waitcnt vmcnt(3)
    v_cmp_le_i32 vcc, 8, v95
    s_add_u32 s61, s61, 1
    s_cbranch_vccnz interleave_layers__linear_attn_block__memory_aug_recurrent_mem_tr__prompt_kernel_s_prw2_out
    s_sleep 3
    v_mov_b32 v95, 0
    buffer_atomic_add v95, v23, s[8:11], s48 offen sc0
    s_waitcnt vmcnt(3)
    v_cmp_le_i32 vcc, 8, v82
    s_add_u32 s61, s61, 1
    s_cbranch_vccnz interleave_layers__linear_attn_block__memory_aug_recurrent_mem_tr__prompt_kernel_s_prw2_out
    s_sleep 3
    s_cmp_ge_u32 s61, s60
    s_cbranch_scc0 interleave_layers__linear_attn_block__memory_aug_recurrent_mem_tr__prompt_kernel_s_prw2
    s_mov_b32 s60, 1
interleave_layers__linear_attn_block__memory_aug_recurrent_mem_tr__prompt_kernel_s_prw2_out:
    s_mov_b64 exec, -1
    buffer_load_dwordx4 v[84:87], v7, s[8:11], s47 offen sc1
    buffer_load_dwordx4 v[88:91], v7, s[8:11], s46 offen sc1
    buffer_load_dwordx2 v[92:93], v8, s[8:11], s47 offen sc1
    ds_read_b128 v[48:51], v21 offset:0
    ds_read_b128 v[52:55], v21 offset:16
    ds_read_b128 v[56:59], v21 offset:5632
    ds_read_b128 v[60:63], v21 offset:5648
    ds_read_b128 v[64:67], v21 offset:11264
    ds_read_b128 v[68:71], v21 offset:11280
    ds_read_b128 v[72:75], v21 offset:16896
    ds_read_b128 v[76:79], v21 offset:16912
    s_waitcnt lgkmcnt(4)
    v_pk_add_f32 v[48:49], v[48:49], v[56:57]
    v_pk_add_f32 v[50:51], v[50:51], v[58:59]
    v_pk_add_f32 v[52:53], v[52:53], v[60:61]
    v_pk_add_f32 v[54:55], v[54:55], v[62:63]
    s_waitcnt lgkmcnt(0)
    v_pk_add_f32 v[64:65], v[64:65], v[72:73]
    v_pk_add_f32 v[66:67], v[66:67], v[74:75]
    v_pk_add_f32 v[68:69], v[68:69], v[76:77]
    v_pk_add_f32 v[70:71], v[70:71], v[78:79]
    v_pk_add_f32 v[48:49], v[48:49], v[64:65]
    v_pk_add_f32 v[50:51], v[50:51], v[66:67]
    v_pk_add_f32 v[52:53], v[52:53], v[68:69]
    v_pk_add_f32 v[54:55], v[54:55], v[70:71]
    v_mov_b32 v81, 0xff800000
    v_cndmask_b32 v48, v81, v48, s[64:65]
    v_cndmask_b32 v49, v81, v49, s[66:67]
    v_cndmask_b32 v50, v81, v50, s[68:69]
    v_cndmask_b32 v51, v81, v51, s[70:71]
    v_cndmask_b32 v52, v81, v52, s[72:73]
    v_cndmask_b32 v53, v81, v53, s[74:75]
    v_cndmask_b32 v54, v81, v54, s[76:77]
    v_cndmask_b32 v55, v81, v55, s[78:79]
    v_max3_f32 v80, v48, v49, v50
    v_max3_f32 v80, v80, v51, v52
    v_max3_f32 v80, v80, v53, v54
    v_max_f32 v80, v80, v55
    v_mov_b32 v81, 0xff800000
    v_cndmask_b32 v80, v81, v80, s[50:51]
    s_nop 1
    v_max_f32 v80, v80, v80 quad_perm:[1,0,3,2] row_mask:0xf bank_mask:0xf
    s_nop 1
    v_max_f32 v80, v80, v80 quad_perm:[2,3,0,1] row_mask:0xf bank_mask:0xf
    s_nop 1
    v_max_f32 v80, v80, v80 row_half_mirror row_mask:0xf bank_mask:0xf
    s_mov_b32 s24, 0x3dd53b95
    v_mul_f32 v80, s24, v80
    v_fma_f32 v48, v48, s24, -v80
    v_fma_f32 v49, v49, s24, -v80
    v_fma_f32 v50, v50, s24, -v80
    v_fma_f32 v51, v51, s24, -v80
    v_fma_f32 v52, v52, s24, -v80
    v_fma_f32 v53, v53, s24, -v80
    v_fma_f32 v54, v54, s24, -v80
    v_fma_f32 v55, v55, s24, -v80
    v_exp_f32 v48, v48
    v_exp_f32 v49, v49
    v_exp_f32 v50, v50
    v_exp_f32 v51, v51
    v_exp_f32 v52, v52
    v_exp_f32 v53, v53
    v_exp_f32 v54, v54
    v_exp_f32 v55, v55
    v_add_f32 v80, v48, v49
    v_add_f32 v81, v50, v51
    v_add_f32 v80, v80, v52
    v_add_f32 v81, v81, v53
    v_add_f32 v80, v80, v54
    v_add_f32 v81, v81, v55
    v_add_f32 v80, v80, v81
    v_cndmask_b32 v80, 0, v80, s[50:51]
    s_nop 1
    v_add_f32 v80, v80, v80 quad_perm:[1,0,3,2] row_mask:0xf bank_mask:0xf
    s_nop 1
    v_add_f32 v80, v80, v80 quad_perm:[2,3,0,1] row_mask:0xf bank_mask:0xf
    s_nop 1
    v_add_f32 v80, v80, v80 row_half_mirror row_mask:0xf bank_mask:0xf
    v_rcp_f32 v80, v80
    s_nop 0
    v_mul_f32 v48, v48, v80
    v_mul_f32 v49, v49, v80
    v_mul_f32 v50, v50, v80
    v_mul_f32 v51, v51, v80
    v_mul_f32 v52, v52, v80
    v_mul_f32 v53, v53, v80
    v_mul_f32 v54, v54, v80
    v_mul_f32 v55, v55, v80
    v_cvt_pk_bf16_f32 v56, v48, v49
    v_cvt_pk_bf16_f32 v57, v50, v51
    v_cvt_pk_bf16_f32 v58, v52, v53
    v_cvt_pk_bf16_f32 v59, v54, v55
    v_min_u32 v56, -2, v56
    v_min_u32 v57, -2, v57
    v_min_u32 v58, -2, v58
    v_min_u32 v59, -2, v59
    buffer_store_dwordx4 v[56:59], v22, s[8:11], s42 offen sc1
    s_add_u32 s42, s42, 458752
    s_waitcnt vmcnt(1)
    v_max3_u32 v58, v84, v85, v86
    v_max3_u32 v58, v58, v87, v88
    v_max3_u32 v58, v58, v89, v90
    v_max3_u32 v58, v58, v91, v92
    v_max_u32 v58, v58, v93
    v_cmp_eq_u32 vcc, -1, v58
    s_cbranch_vccz interleave_layers__linear_attn_block__memory_aug_recurrent_mem_tr__prompt_kernel_s_pmw2_out
    s_mov_b32 s61, 0
interleave_layers__linear_attn_block__memory_aug_recurrent_mem_tr__prompt_kernel_s_pmw2:
    buffer_load_dwordx4 v[84:87], v7, s[8:11], s47 offen sc1
    buffer_load_dwordx4 v[88:91], v7, s[8:11], s46 offen sc1
    buffer_load_dwordx2 v[92:93], v8, s[8:11], s47 offen sc1
    s_waitcnt vmcnt(0)
    v_max3_u32 v58, v84, v85, v86
    v_max3_u32 v58, v58, v87, v88
    v_max3_u32 v58, v58, v89, v90
    v_max3_u32 v58, v58, v91, v92
    v_max_u32 v58, v58, v93
    v_cmp_eq_u32 vcc, -1, v58
    s_add_u32 s61, s61, 1
    s_cbranch_vccz interleave_layers__linear_attn_block__memory_aug_recurrent_mem_tr__prompt_kernel_s_pmw2_out
    s_cmp_ge_u32 s61, s60
    s_cbranch_scc1 interleave_layers__linear_attn_block__memory_aug_recurrent_mem_tr__prompt_kernel_s_pmw2_to
    s_sleep 1
    s_branch interleave_layers__linear_attn_block__memory_aug_recurrent_mem_tr__prompt_kernel_s_pmw2
interleave_layers__linear_attn_block__memory_aug_recurrent_mem_tr__prompt_kernel_s_pmw2_to:
    s_mov_b32 s60, 1
interleave_layers__linear_attn_block__memory_aug_recurrent_mem_tr__prompt_kernel_s_pmw2_out:
    ds_write_b128 v7, v[84:87]
    ds_write_b128 v7, v[88:91] offset:4096
    ds_write_b64 v8, v[92:93]
interleave_layers__linear_attn_block__memory_aug_recurrent_mem_tr__prompt_kernel_s_gow2:
    ds_read_b128 v[68:71], v6 offset:4096
    ds_read_b128 v[72:75], v6 offset:5120
    ds_read_b128 v[76:79], v6 offset:12288
    ds_read_b128 v[80:83], v6 offset:13312
    v_smfmac_f32_16x16x64_bf16 v[24:27], v[84:87], a[16:23], v4
    v_smfmac_f32_16x16x64_bf16 v[28:31], v[84:87], a[96:103], v4
    v_smfmac_f32_16x16x64_bf16 v[32:35], v[84:87], a[176:183], v4
    v_smfmac_f32_16x16x64_bf16 v[40:43], v[84:87], v[112:119], v4
    v_smfmac_f32_16x16x64_bf16 v[44:47], v[84:87], v[192:199], v4
    s_waitcnt lgkmcnt(2)
    v_smfmac_f32_16x16x64_bf16 v[36:39], v[84:87], v[68:75], v4
    ds_read_b128 v[68:71], v6 offset:0
    ds_read_b128 v[72:75], v6 offset:1024
    s_barrier
    ds_read_b128 v[48:51], v5 offset:0
    ds_read_b128 v[52:55], v5 offset:1024
    ds_read_b128 v[56:59], v5 offset:3072
    ds_read_b128 v[60:63], v5 offset:4096
    ds_read_b128 v[64:67], v5 offset:5120
    v_smfmac_f32_16x16x64_bf16 v[24:27], v[88:91], a[48:55], v4
    v_smfmac_f32_16x16x64_bf16 v[28:31], v[88:91], a[128:135], v4
    v_smfmac_f32_16x16x64_bf16 v[32:35], v[88:91], a[208:215], v4
    v_smfmac_f32_16x16x64_bf16 v[40:43], v[88:91], v[144:151], v4
    v_smfmac_f32_16x16x64_bf16 v[44:47], v[88:91], v[224:231], v4
    s_waitcnt lgkmcnt(7)
    v_smfmac_f32_16x16x64_bf16 v[36:39], v[88:91], v[76:83], v4
    ds_read_b128 v[76:79], v6 offset:2048
    ds_read_b128 v[80:83], v6 offset:3072
    s_waitcnt lgkmcnt(6)
    v_smfmac_f32_16x16x64_bf16 v[24:27], v[48:51], a[0:7], v4
    v_smfmac_f32_16x16x64_bf16 v[28:31], v[48:51], a[80:87], v4
    v_smfmac_f32_16x16x64_bf16 v[40:43], v[48:51], v[96:103], v4
    v_smfmac_f32_16x16x64_bf16 v[36:39], v[48:51], v[68:75], v4
    ds_read_b128 v[68:71], v6 offset:6144
    ds_read_b128 v[72:75], v6 offset:7168
    ds_read_b128 v[48:51], v5 offset:7168
    s_waitcnt lgkmcnt(8)
    v_smfmac_f32_16x16x64_bf16 v[24:27], v[52:55], a[8:15], v4
    v_smfmac_f32_16x16x64_bf16 v[28:31], v[52:55], a[88:95], v4
    v_smfmac_f32_16x16x64_bf16 v[40:43], v[52:55], v[104:111], v4
    s_waitcnt lgkmcnt(3)
    v_smfmac_f32_16x16x64_bf16 v[36:39], v[52:55], v[76:83], v4
    ds_read_b128 v[76:79], v6 offset:8192
    ds_read_b128 v[80:83], v6 offset:9216
    ds_read_b128 v[52:55], v5 offset:8192
    v_smfmac_f32_16x16x64_bf16 v[24:27], v[56:59], a[24:31], v4
    v_smfmac_f32_16x16x64_bf16 v[28:31], v[56:59], a[104:111], v4
    v_smfmac_f32_16x16x64_bf16 v[40:43], v[56:59], v[120:127], v4
    s_waitcnt lgkmcnt(4)
    v_smfmac_f32_16x16x64_bf16 v[36:39], v[56:59], v[68:75], v4
    ds_read_b128 v[68:71], v6 offset:10240
    ds_read_b128 v[72:75], v6 offset:11264
    ds_read_b128 v[56:59], v5 offset:9216
    v_smfmac_f32_16x16x64_bf16 v[24:27], v[60:63], a[32:39], v4
    v_smfmac_f32_16x16x64_bf16 v[28:31], v[60:63], a[112:119], v4
    v_smfmac_f32_16x16x64_bf16 v[40:43], v[60:63], v[128:135], v4
    s_waitcnt lgkmcnt(4)
    v_smfmac_f32_16x16x64_bf16 v[36:39], v[60:63], v[76:83], v4
    ds_read_b128 v[76:79], v6 offset:14336
    ds_read_b128 v[80:83], v6 offset:15360
    ds_read_b128 v[60:63], v5 offset:0
    v_smfmac_f32_16x16x64_bf16 v[24:27], v[64:67], a[40:47], v4
    v_smfmac_f32_16x16x64_bf16 v[28:31], v[64:67], a[120:127], v4
    v_smfmac_f32_16x16x64_bf16 v[40:43], v[64:67], v[136:143], v4
    s_waitcnt lgkmcnt(4)
    v_smfmac_f32_16x16x64_bf16 v[36:39], v[64:67], v[68:75], v4
    ds_read_b128 v[68:71], v6 offset:16384
    ds_read_b128 v[72:75], v6 offset:17408
    ds_read_b128 v[64:67], v5 offset:1024
    v_smfmac_f32_16x16x64_bf16 v[24:27], v[48:51], a[56:63], v4
    v_smfmac_f32_16x16x64_bf16 v[28:31], v[48:51], a[136:143], v4
    v_smfmac_f32_16x16x64_bf16 v[40:43], v[48:51], v[152:159], v4
    s_waitcnt lgkmcnt(4)
    v_smfmac_f32_16x16x64_bf16 v[36:39], v[48:51], v[76:83], v4
    ds_read_b128 v[76:79], v6 offset:18432
    ds_read_b128 v[80:83], v6 offset:19456
    ds_read_b128 v[48:51], v5 offset:3072
    v_smfmac_f32_16x16x64_bf16 v[24:27], v[52:55], a[64:71], v4
    v_smfmac_f32_16x16x64_bf16 v[28:31], v[52:55], a[144:151], v4
    v_smfmac_f32_16x16x64_bf16 v[40:43], v[52:55], v[160:167], v4
    s_waitcnt lgkmcnt(4)
    v_smfmac_f32_16x16x64_bf16 v[36:39], v[52:55], v[68:75], v4
    ds_read_b128 v[52:55], v5 offset:4096
    v_smfmac_f32_16x16x64_bf16 v[24:27], v[56:59], a[72:79], v4
    v_smfmac_f32_16x16x64_bf16 v[28:31], v[56:59], a[152:159], v4
    v_smfmac_f32_16x16x64_bf16 v[40:43], v[56:59], v[168:175], v4
    s_waitcnt lgkmcnt(2)
    v_smfmac_f32_16x16x64_bf16 v[36:39], v[56:59], v[76:83], v4
    ds_read_b128 v[56:59], v5 offset:5120
    buffer_load_dwordx4 v[80:83], v19, s[8:11], s45 offen offset:0 sc1
    buffer_load_dwordx4 v[84:87], v19, s[8:11], s45 offen offset:1024 sc1
    buffer_load_dwordx4 v[88:91], v19, s[8:11], s45 offen offset:2048 sc1
    v_smfmac_f32_16x16x64_bf16 v[32:35], v[60:63], a[160:167], v4
    v_smfmac_f32_16x16x64_bf16 v[44:47], v[60:63], v[176:183], v4
    v_permlane32_swap_b32 v28, v40
    v_permlane32_swap_b32 v29, v41
    ds_read_b128 v[60:63], v5 offset:7168
    v_smfmac_f32_16x16x64_bf16 v[32:35], v[64:67], a[168:175], v4
    v_permlane32_swap_b32 v30, v42
    v_permlane32_swap_b32 v31, v43
    v_smfmac_f32_16x16x64_bf16 v[44:47], v[64:67], v[184:191], v4
    v_add_f32 v28, v28, v40
    v_add_f32 v29, v29, v41
    ds_read_b128 v[64:67], v5 offset:8192
    s_waitcnt lgkmcnt(4)
    v_smfmac_f32_16x16x64_bf16 v[32:35], v[48:51], a[184:191], v4
    v_add_f32 v30, v30, v42
    v_add_f32 v31, v31, v43
    v_smfmac_f32_16x16x64_bf16 v[44:47], v[48:51], v[200:207], v4
    v_cvt_pk_bf16_f32 v40, v28, v29
    v_cvt_pk_bf16_f32 v41, v30, v31
    ds_read_b128 v[48:51], v5 offset:9216
    s_waitcnt lgkmcnt(4)
    v_smfmac_f32_16x16x64_bf16 v[32:35], v[52:55], a[192:199], v4
    v_mfma_f32_16x16x16_bf16 v[28:31], v[40:41], v[10:11], 0
    v_permlane32_swap_b32 v24, v36
    v_smfmac_f32_16x16x64_bf16 v[44:47], v[52:55], v[208:215], v4
    v_permlane32_swap_b32 v25, v37
    v_permlane32_swap_b32 v26, v38
    s_waitcnt lgkmcnt(3)
    v_smfmac_f32_16x16x64_bf16 v[32:35], v[56:59], a[200:207], v4
    v_permlane32_swap_b32 v27, v39
    v_add_f32 v24, v24, v36
    v_smfmac_f32_16x16x64_bf16 v[44:47], v[56:59], v[216:223], v4
    v_add_f32 v25, v25, v37
    v_add_f32 v26, v26, v38
    s_waitcnt lgkmcnt(2)
    v_smfmac_f32_16x16x64_bf16 v[32:35], v[60:63], a[216:223], v4
    v_add_f32 v27, v27, v39
    v_cvt_pk_bf16_f32 v36, v24, v25
    v_smfmac_f32_16x16x64_bf16 v[44:47], v[60:63], v[232:239], v4
    v_cvt_pk_bf16_f32 v37, v26, v27
    s_nop 1
    v_mfma_f32_16x16x16_bf16 v[24:27], v[36:37], v[10:11], 0
    s_waitcnt lgkmcnt(1)
    v_smfmac_f32_16x16x64_bf16 v[32:35], v[64:67], a[224:231], v4
    s_nop 5
    v_cvt_pk_bf16_f32 v24, v24, v25
    v_smfmac_f32_16x16x64_bf16 v[44:47], v[64:67], v[240:247], v4
    v_cvt_pk_bf16_f32 v25, v26, v27
    v_cvt_pk_bf16_f32 v26, v28, v29
    s_waitcnt lgkmcnt(0)
    v_smfmac_f32_16x16x64_bf16 v[32:35], v[48:51], a[232:239], v4
    v_cvt_pk_bf16_f32 v27, v30, v31
    s_waitcnt vmcnt(3)
    v_smfmac_f32_16x16x64_bf16 v[44:47], v[48:51], v[248:255], v4
    v_mfma_f32_16x16x32_bf16 v[28:31], a[240:243], v[24:27], 0
    v_mfma_f32_16x16x32_bf16 v[36:39], a[244:247], v[24:27], 0
    v_mfma_f32_16x16x32_bf16 v[40:43], v[24:27], v[24:27], 0
    s_nop 4
    v_permlane32_swap_b32 v32, v44
    v_permlane32_swap_b32 v33, v45
    v_permlane32_swap_b32 v34, v46
    v_permlane32_swap_b32 v35, v47
    v_add_f32 v32, v32, v44
    v_add_f32 v33, v33, v45
    v_add_f32 v34, v34, v46
    v_add_f32 v35, v35, v47
    v_cvt_pk_bf16_f32 v44, v32, v33
    v_cvt_pk_bf16_f32 v45, v34, v35
    s_nop 1
    v_mfma_f32_16x16x16_bf16 v[32:35], v[44:45], v[10:11], 0
    s_nop 7
    v_cvt_pk_bf16_f32 v32, v32, v33
    v_cvt_pk_bf16_f32 v33, v34, v35
    s_nop 1
    v_mfma_f32_16x16x16_bf16 v[28:31], a[248:249], v[32:33], v[28:31]
    v_mfma_f32_16x16x16_bf16 v[36:39], a[250:251], v[32:33], v[36:39]
    v_mfma_f32_16x16x16_bf16 v[40:43], v[32:33], v[32:33], v[40:43]
    s_nop 5
    ds_write_b128 v12, v[28:31]
    ds_write_b128 v12, v[36:39] offset:16
    ds_write_b128 v13, v[40:43]
    s_waitcnt lgkmcnt(0)
    s_barrier
    s_waitcnt vmcnt(0)
    v_mfma_f32_16x16x32_bf16 v[36:39], a[240:243], v[80:83], 0
    v_mfma_f32_16x16x32_bf16 v[44:47], a[244:247], v[80:83], 0
    v_mfma_f32_16x16x32_bf16 v[68:71], v[24:27], v[80:83], 0
    v_mfma_f32_16x16x32_bf16 v[40:43], a[240:243], v[84:87], 0
    v_mfma_f32_16x16x32_bf16 v[64:67], a[244:247], v[84:87], 0
    v_mfma_f32_16x16x32_bf16 v[72:75], v[24:27], v[84:87], 0
    s_nop 0
    v_mfma_f32_16x16x16_bf16 v[36:39], a[248:249], v[88:89], v[36:39]
    v_mfma_f32_16x16x16_bf16 v[44:47], a[250:251], v[88:89], v[44:47]
    v_mfma_f32_16x16x16_bf16 v[68:71], v[32:33], v[88:89], v[68:71]
    v_mfma_f32_16x16x16_bf16 v[40:43], a[248:249], v[90:91], v[40:43]
    v_mfma_f32_16x16x16_bf16 v[64:67], a[250:251], v[90:91], v[64:67]
    v_mfma_f32_16x16x16_bf16 v[72:75], v[32:33], v[90:91], v[72:75]
    s_nop 2
    ds_write_b128 v16, v[36:39] offset:0
    ds_write_b128 v16, v[44:47] offset:16
    ds_write_b128 v17, v[68:71]
    ds_write_b128 v16, v[40:43] offset:2816
    ds_write_b128 v16, v[64:67] offset:2832
    ds_write_b128 v18, v[72:75]
    s_add_u32 s40, s40, 1
    s_add_u32 s41, s41, 393216
    s_add_u32 s45, s45, 393216
    s_add_u32 s43, s43, 458752
    s_add_u32 s47, s47, 458752
    s_add_u32 s48, s48, 458752
    s_add_u32 s49, s49, 458752
    s_waitcnt lgkmcnt(0)
    s_barrier
    s_cmp_lt_u32 s40, 64
    s_cbranch_scc1 interleave_layers__linear_attn_block__memory_aug_recurrent_mem_tr__prompt_kernel_s_stepw2
    s_branch interleave_layers__linear_attn_block__memory_aug_recurrent_mem_tr__prompt_kernel_s_end
interleave_layers__linear_attn_block__memory_aug_recurrent_mem_tr__prompt_kernel_s_stepw3:
    v_mov_b32 v24, 0
    v_mov_b32 v25, 0
    v_mov_b32 v26, 0
    v_mov_b32 v27, 0
    v_mov_b32 v28, 0
    v_mov_b32 v29, 0
    v_mov_b32 v30, 0
    v_mov_b32 v31, 0
    v_mov_b32 v32, 0
    v_mov_b32 v33, 0
    v_mov_b32 v34, 0
    v_mov_b32 v35, 0
    v_mov_b32 v36, 0
    v_mov_b32 v37, 0
    v_mov_b32 v38, 0
    v_mov_b32 v39, 0
    v_mov_b32 v40, 0
    v_mov_b32 v41, 0
    v_mov_b32 v42, 0
    v_mov_b32 v43, 0
    v_mov_b32 v44, 0
    v_mov_b32 v45, 0
    v_mov_b32 v46, 0
    v_mov_b32 v47, 0
    s_add_u32 s46, s47, 4096
    s_lshl_b32 s95, s92, 6
    s_add_u32 s95, s95, s40
    s_add_u32 s95, s95, 1
    s_cmp_ge_i32 s59, s95
    s_cbranch_scc1 interleave_layers__linear_attn_block__memory_aug_recurrent_mem_tr__prompt_kernel_s_ecw3_ok
    s_and_b32 s24, s2, 7
    s_lshl_b32 s24, s24, 7
    s_add_u32 s24, s24, 23109632
    v_and_b32 v49, 3, v1
    v_lshl_add_u32 v49, v49, 2, s24
    s_mov_b32 s61, 0
interleave_layers__linear_attn_block__memory_aug_recurrent_mem_tr__prompt_kernel_s_ecw3:
    buffer_load_dword v48, v49, s[8:11], 0 offen sc1
    s_waitcnt vmcnt(0)
    v_readlane_b32 s59, v48, 0
    v_readlane_b32 s24, v48, 1
    s_min_i32 s59, s59, s24
    v_readlane_b32 s24, v48, 2
    s_min_i32 s59, s59, s24
    s_cmp_ge_i32 s59, s95
    s_cbranch_scc1 interleave_layers__linear_attn_block__memory_aug_recurrent_mem_tr__prompt_kernel_s_ecw3_ok
    s_add_u32 s61, s61, 1
    s_cmp_ge_u32 s61, s60
    s_cbranch_scc1 interleave_layers__linear_attn_block__memory_aug_recurrent_mem_tr__prompt_kernel_s_ecw3_to
    s_sleep 2
    s_branch interleave_layers__linear_attn_block__memory_aug_recurrent_mem_tr__prompt_kernel_s_ecw3
interleave_layers__linear_attn_block__memory_aug_recurrent_mem_tr__prompt_kernel_s_ecw3_to:
    s_mov_b32 s60, 1
interleave_layers__linear_attn_block__memory_aug_recurrent_mem_tr__prompt_kernel_s_ecw3_ok:
    s_add_u32 s63, s40, 1
    s_cmp_ge_i32 s62, s63
    s_cbranch_scc1 interleave_layers__linear_attn_block__memory_aug_recurrent_mem_tr__prompt_kernel_s_enw3_ok
    s_mov_b32 s61, 0
interleave_layers__linear_attn_block__memory_aug_recurrent_mem_tr__prompt_kernel_s_enw3:
    buffer_load_dword v48, v9, s[8:11], 0 offen sc1
    s_waitcnt vmcnt(0)
    v_readlane_b32 s62, v48, 0
    v_readlane_b32 s24, v48, 1
    s_min_i32 s62, s62, s24
    s_cmp_ge_i32 s62, s63
    s_cbranch_scc1 interleave_layers__linear_attn_block__memory_aug_recurrent_mem_tr__prompt_kernel_s_enw3_ok
    s_add_u32 s61, s61, 1
    s_cmp_ge_u32 s61, s60
    s_cbranch_scc1 interleave_layers__linear_attn_block__memory_aug_recurrent_mem_tr__prompt_kernel_s_enw3_to
    s_sleep 2
    s_branch interleave_layers__linear_attn_block__memory_aug_recurrent_mem_tr__prompt_kernel_s_enw3
interleave_layers__linear_attn_block__memory_aug_recurrent_mem_tr__prompt_kernel_s_enw3_to:
    s_mov_b32 s60, 1
interleave_layers__linear_attn_block__memory_aug_recurrent_mem_tr__prompt_kernel_s_enw3_ok:
    buffer_load_dwordx4 a[240:243], v19, s[8:11], s41 offen offset:0 sc1
    buffer_load_dwordx4 a[244:247], v19, s[8:11], s41 offen offset:1024 sc1
    buffer_load_dwordx4 a[248:251], v19, s[8:11], s41 offen offset:2048 sc1
    s_sleep 5
    s_mov_b64 exec, 1
    s_mov_b32 s61, 0
    v_mov_b32 v83, 0
    buffer_atomic_add v83, v23, s[8:11], s48 offen sc0
    s_sleep 3
    v_mov_b32 v94, 0
    buffer_atomic_add v94, v23, s[8:11], s48 offen sc0
    s_sleep 3
    v_mov_b32 v95, 0
    buffer_atomic_add v95, v23, s[8:11], s48 offen sc0
    s_sleep 3
interleave_layers__linear_attn_block__memory_aug_recurrent_mem_tr__prompt_kernel_s_prw3:
    v_mov_b32 v82, 0
    buffer_atomic_add v82, v23, s[8:11], s48 offen sc0
    s_waitcnt vmcnt(3)
    v_cmp_le_i32 vcc, 8, v83
    s_add_u32 s61, s61, 1
    s_cbranch_vccnz interleave_layers__linear_attn_block__memory_aug_recurrent_mem_tr__prompt_kernel_s_prw3_out
    s_sleep 3
    v_mov_b32 v83, 0
    buffer_atomic_add v83, v23, s[8:11], s48 offen sc0
    s_waitcnt vmcnt(3)
    v_cmp_le_i32 vcc, 8, v94
    s_add_u32 s61, s61, 1
    s_cbranch_vccnz interleave_layers__linear_attn_block__memory_aug_recurrent_mem_tr__prompt_kernel_s_prw3_out
    s_sleep 3
    v_mov_b32 v94, 0
    buffer_atomic_add v94, v23, s[8:11], s48 offen sc0
    s_waitcnt vmcnt(3)
    v_cmp_le_i32 vcc, 8, v95
    s_add_u32 s61, s61, 1
    s_cbranch_vccnz interleave_layers__linear_attn_block__memory_aug_recurrent_mem_tr__prompt_kernel_s_prw3_out
    s_sleep 3
    v_mov_b32 v95, 0
    buffer_atomic_add v95, v23, s[8:11], s48 offen sc0
    s_waitcnt vmcnt(3)
    v_cmp_le_i32 vcc, 8, v82
    s_add_u32 s61, s61, 1
    s_cbranch_vccnz interleave_layers__linear_attn_block__memory_aug_recurrent_mem_tr__prompt_kernel_s_prw3_out
    s_sleep 3
    s_cmp_ge_u32 s61, s60
    s_cbranch_scc0 interleave_layers__linear_attn_block__memory_aug_recurrent_mem_tr__prompt_kernel_s_prw3
    s_mov_b32 s60, 1
interleave_layers__linear_attn_block__memory_aug_recurrent_mem_tr__prompt_kernel_s_prw3_out:
    s_mov_b64 exec, -1
    buffer_load_dwordx4 v[84:87], v7, s[8:11], s47 offen sc1
    buffer_load_dwordx4 v[88:91], v7, s[8:11], s46 offen sc1
    buffer_load_dwordx2 v[92:93], v8, s[8:11], s47 offen sc1
    ds_read_b128 v[48:51], v21 offset:0
    ds_read_b128 v[52:55], v21 offset:16
    ds_read_b128 v[56:59], v21 offset:5632
    ds_read_b128 v[60:63], v21 offset:5648
    ds_read_b128 v[64:67], v21 offset:11264
    ds_read_b128 v[68:71], v21 offset:11280
    ds_read_b128 v[72:75], v21 offset:16896
    ds_read_b128 v[76:79], v21 offset:16912
    s_waitcnt lgkmcnt(4)
    v_pk_add_f32 v[48:49], v[48:49], v[56:57]
    v_pk_add_f32 v[50:51], v[50:51], v[58:59]
    v_pk_add_f32 v[52:53], v[52:53], v[60:61]
    v_pk_add_f32 v[54:55], v[54:55], v[62:63]
    s_waitcnt lgkmcnt(0)
    v_pk_add_f32 v[64:65], v[64:65], v[72:73]
    v_pk_add_f32 v[66:67], v[66:67], v[74:75]
    v_pk_add_f32 v[68:69], v[68:69], v[76:77]
    v_pk_add_f32 v[70:71], v[70:71], v[78:79]
    v_pk_add_f32 v[48:49], v[48:49], v[64:65]
    v_pk_add_f32 v[50:51], v[50:51], v[66:67]
    v_pk_add_f32 v[52:53], v[52:53], v[68:69]
    v_pk_add_f32 v[54:55], v[54:55], v[70:71]
    v_mov_b32 v81, 0xff800000
    v_cndmask_b32 v48, v81, v48, s[64:65]
    v_cndmask_b32 v49, v81, v49, s[66:67]
    v_cndmask_b32 v50, v81, v50, s[68:69]
    v_cndmask_b32 v51, v81, v51, s[70:71]
    v_cndmask_b32 v52, v81, v52, s[72:73]
    v_cndmask_b32 v53, v81, v53, s[74:75]
    v_cndmask_b32 v54, v81, v54, s[76:77]
    v_cndmask_b32 v55, v81, v55, s[78:79]
    v_max3_f32 v80, v48, v49, v50
    v_max3_f32 v80, v80, v51, v52
    v_max3_f32 v80, v80, v53, v54
    v_max_f32 v80, v80, v55
    v_mov_b32 v81, 0xff800000
    v_cndmask_b32 v80, v81, v80, s[50:51]
    s_nop 1
    v_max_f32 v80, v80, v80 quad_perm:[1,0,3,2] row_mask:0xf bank_mask:0xf
    s_nop 1
    v_max_f32 v80, v80, v80 quad_perm:[2,3,0,1] row_mask:0xf bank_mask:0xf
    s_nop 1
    v_max_f32 v80, v80, v80 row_half_mirror row_mask:0xf bank_mask:0xf
    s_mov_b32 s24, 0x3dd53b95
    v_mul_f32 v80, s24, v80
    v_fma_f32 v48, v48, s24, -v80
    v_fma_f32 v49, v49, s24, -v80
    v_fma_f32 v50, v50, s24, -v80
    v_fma_f32 v51, v51, s24, -v80
    v_fma_f32 v52, v52, s24, -v80
    v_fma_f32 v53, v53, s24, -v80
    v_fma_f32 v54, v54, s24, -v80
    v_fma_f32 v55, v55, s24, -v80
    v_exp_f32 v48, v48
    v_exp_f32 v49, v49
    v_exp_f32 v50, v50
    v_exp_f32 v51, v51
    v_exp_f32 v52, v52
    v_exp_f32 v53, v53
    v_exp_f32 v54, v54
    v_exp_f32 v55, v55
    v_add_f32 v80, v48, v49
    v_add_f32 v81, v50, v51
    v_add_f32 v80, v80, v52
    v_add_f32 v81, v81, v53
    v_add_f32 v80, v80, v54
    v_add_f32 v81, v81, v55
    v_add_f32 v80, v80, v81
    v_cndmask_b32 v80, 0, v80, s[50:51]
    s_nop 1
    v_add_f32 v80, v80, v80 quad_perm:[1,0,3,2] row_mask:0xf bank_mask:0xf
    s_nop 1
    v_add_f32 v80, v80, v80 quad_perm:[2,3,0,1] row_mask:0xf bank_mask:0xf
    s_nop 1
    v_add_f32 v80, v80, v80 row_half_mirror row_mask:0xf bank_mask:0xf
    v_rcp_f32 v80, v80
    s_nop 0
    v_mul_f32 v48, v48, v80
    v_mul_f32 v49, v49, v80
    v_mul_f32 v50, v50, v80
    v_mul_f32 v51, v51, v80
    v_mul_f32 v52, v52, v80
    v_mul_f32 v53, v53, v80
    v_mul_f32 v54, v54, v80
    v_mul_f32 v55, v55, v80
    v_cvt_pk_bf16_f32 v56, v48, v49
    v_cvt_pk_bf16_f32 v57, v50, v51
    v_cvt_pk_bf16_f32 v58, v52, v53
    v_cvt_pk_bf16_f32 v59, v54, v55
    v_min_u32 v56, -2, v56
    v_min_u32 v57, -2, v57
    v_min_u32 v58, -2, v58
    v_min_u32 v59, -2, v59
    buffer_store_dwordx4 v[56:59], v22, s[8:11], s42 offen sc1
    s_add_u32 s42, s42, 458752
    s_waitcnt vmcnt(1)
    v_max3_u32 v58, v84, v85, v86
    v_max3_u32 v58, v58, v87, v88
    v_max3_u32 v58, v58, v89, v90
    v_max3_u32 v58, v58, v91, v92
    v_max_u32 v58, v58, v93
    v_cmp_eq_u32 vcc, -1, v58
    s_cbranch_vccz interleave_layers__linear_attn_block__memory_aug_recurrent_mem_tr__prompt_kernel_s_pmw3_out
    s_mov_b32 s61, 0
interleave_layers__linear_attn_block__memory_aug_recurrent_mem_tr__prompt_kernel_s_pmw3:
    buffer_load_dwordx4 v[84:87], v7, s[8:11], s47 offen sc1
    buffer_load_dwordx4 v[88:91], v7, s[8:11], s46 offen sc1
    buffer_load_dwordx2 v[92:93], v8, s[8:11], s47 offen sc1
    s_waitcnt vmcnt(0)
    v_max3_u32 v58, v84, v85, v86
    v_max3_u32 v58, v58, v87, v88
    v_max3_u32 v58, v58, v89, v90
    v_max3_u32 v58, v58, v91, v92
    v_max_u32 v58, v58, v93
    v_cmp_eq_u32 vcc, -1, v58
    s_add_u32 s61, s61, 1
    s_cbranch_vccz interleave_layers__linear_attn_block__memory_aug_recurrent_mem_tr__prompt_kernel_s_pmw3_out
    s_cmp_ge_u32 s61, s60
    s_cbranch_scc1 interleave_layers__linear_attn_block__memory_aug_recurrent_mem_tr__prompt_kernel_s_pmw3_to
    s_sleep 1
    s_branch interleave_layers__linear_attn_block__memory_aug_recurrent_mem_tr__prompt_kernel_s_pmw3
interleave_layers__linear_attn_block__memory_aug_recurrent_mem_tr__prompt_kernel_s_pmw3_to:
    s_mov_b32 s60, 1
interleave_layers__linear_attn_block__memory_aug_recurrent_mem_tr__prompt_kernel_s_pmw3_out:
    ds_write_b128 v7, v[84:87]
    ds_write_b128 v7, v[88:91] offset:4096
    ds_write_b64 v8, v[92:93]
interleave_layers__linear_attn_block__memory_aug_recurrent_mem_tr__prompt_kernel_s_gow3:
    ds_read_b128 v[68:71], v6 offset:6144
    ds_read_b128 v[72:75], v6 offset:7168
    ds_read_b128 v[76:79], v6 offset:14336
    ds_read_b128 v[80:83], v6 offset:15360
    v_smfmac_f32_16x16x64_bf16 v[24:27], v[84:87], a[24:31], v4
    v_smfmac_f32_16x16x64_bf16 v[28:31], v[84:87], a[104:111], v4
    v_smfmac_f32_16x16x64_bf16 v[32:35], v[84:87], a[184:191], v4
    v_smfmac_f32_16x16x64_bf16 v[40:43], v[84:87], v[120:127], v4
    v_smfmac_f32_16x16x64_bf16 v[44:47], v[84:87], v[200:207], v4
    s_waitcnt lgkmcnt(2)
    v_smfmac_f32_16x16x64_bf16 v[36:39], v[84:87], v[68:75], v4
    ds_read_b128 v[68:71], v6 offset:0
    ds_read_b128 v[72:75], v6 offset:1024
    s_barrier
    ds_read_b128 v[48:51], v5 offset:0
    ds_read_b128 v[52:55], v5 offset:1024
    ds_read_b128 v[56:59], v5 offset:2048
    ds_read_b128 v[60:63], v5 offset:4096
    ds_read_b128 v[64:67], v5 offset:5120
    v_smfmac_f32_16x16x64_bf16 v[24:27], v[88:91], a[56:63], v4
    v_smfmac_f32_16x16x64_bf16 v[28:31], v[88:91], a[136:143], v4
    v_smfmac_f32_16x16x64_bf16 v[32:35], v[88:91], a[216:223], v4
    v_smfmac_f32_16x16x64_bf16 v[40:43], v[88:91], v[152:159], v4
    v_smfmac_f32_16x16x64_bf16 v[44:47], v[88:91], v[232:239], v4
    s_waitcnt lgkmcnt(7)
    v_smfmac_f32_16x16x64_bf16 v[36:39], v[88:91], v[76:83], v4
    ds_read_b128 v[76:79], v6 offset:2048
    ds_read_b128 v[80:83], v6 offset:3072
    s_waitcnt lgkmcnt(6)
    v_smfmac_f32_16x16x64_bf16 v[24:27], v[48:51], a[0:7], v4
    v_smfmac_f32_16x16x64_bf16 v[28:31], v[48:51], a[80:87], v4
    v_smfmac_f32_16x16x64_bf16 v[40:43], v[48:51], v[96:103], v4
    v_smfmac_f32_16x16x64_bf16 v[36:39], v[48:51], v[68:75], v4
    ds_read_b128 v[68:71], v6 offset:4096
    ds_read_b128 v[72:75], v6 offset:5120
    ds_read_b128 v[48:51], v5 offset:6144
    s_waitcnt lgkmcnt(8)
    v_smfmac_f32_16x16x64_bf16 v[24:27], v[52:55], a[8:15], v4
    v_smfmac_f32_16x16x64_bf16 v[28:31], v[52:55], a[88:95], v4
    v_smfmac_f32_16x16x64_bf16 v[40:43], v[52:55], v[104:111], v4
    s_waitcnt lgkmcnt(3)
    v_smfmac_f32_16x16x64_bf16 v[36:39], v[52:55], v[76:83], v4
    ds_read_b128 v[76:79], v6 offset:8192
    ds_read_b128 v[80:83], v6 offset:9216
    ds_read_b128 v[52:55], v5 offset:8192
    v_smfmac_f32_16x16x64_bf16 v[24:27], v[56:59], a[16:23], v4
    v_smfmac_f32_16x16x64_bf16 v[28:31], v[56:59], a[96:103], v4
    v_smfmac_f32_16x16x64_bf16 v[40:43], v[56:59], v[112:119], v4
    s_waitcnt lgkmcnt(4)
    v_smfmac_f32_16x16x64_bf16 v[36:39], v[56:59], v[68:75], v4
    ds_read_b128 v[68:71], v6 offset:10240
    ds_read_b128 v[72:75], v6 offset:11264
    ds_read_b128 v[56:59], v5 offset:9216
    v_smfmac_f32_16x16x64_bf16 v[24:27], v[60:63], a[32:39], v4
    v_smfmac_f32_16x16x64_bf16 v[28:31], v[60:63], a[112:119], v4
    v_smfmac_f32_16x16x64_bf16 v[40:43], v[60:63], v[128:135], v4
    s_waitcnt lgkmcnt(4)
    v_smfmac_f32_16x16x64_bf16 v[36:39], v[60:63], v[76:83], v4
    ds_read_b128 v[76:79], v6 offset:12288
    ds_read_b128 v[80:83], v6 offset:13312
    ds_read_b128 v[60:63], v5 offset:0
    v_smfmac_f32_16x16x64_bf16 v[24:27], v[64:67], a[40:47], v4
    v_smfmac_f32_16x16x64_bf16 v[28:31], v[64:67], a[120:127], v4
    v_smfmac_f32_16x16x64_bf16 v[40:43], v[64:67], v[136:143], v4
    s_waitcnt lgkmcnt(4)
    v_smfmac_f32_16x16x64_bf16 v[36:39], v[64:67], v[68:75], v4
    ds_read_b128 v[68:71], v6 offset:16384
    ds_read_b128 v[72:75], v6 offset:17408
    ds_read_b128 v[64:67], v5 offset:1024
    v_smfmac_f32_16x16x64_bf16 v[24:27], v[48:51], a[48:55], v4
    v_smfmac_f32_16x16x64_bf16 v[28:31], v[48:51], a[128:135], v4
    v_smfmac_f32_16x16x64_bf16 v[40:43], v[48:51], v[144:151], v4
    s_waitcnt lgkmcnt(4)
    v_smfmac_f32_16x16x64_bf16 v[36:39], v[48:51], v[76:83], v4
    ds_read_b128 v[76:79], v6 offset:18432
    ds_read_b128 v[80:83], v6 offset:19456
    ds_read_b128 v[48:51], v5 offset:2048
    v_smfmac_f32_16x16x64_bf16 v[24:27], v[52:55], a[64:71], v4
    v_smfmac_f32_16x16x64_bf16 v[28:31], v[52:55], a[144:151], v4
    v_smfmac_f32_16x16x64_bf16 v[40:43], v[52:55], v[160:167], v4
    s_waitcnt lgkmcnt(4)
    v_smfmac_f32_16x16x64_bf16 v[36:39], v[52:55], v[68:75], v4
    ds_read_b128 v[52:55], v5 offset:4096
    v_smfmac_f32_16x16x64_bf16 v[24:27], v[56:59], a[72:79], v4
    v_smfmac_f32_16x16x64_bf16 v[28:31], v[56:59], a[152:159], v4
    v_smfmac_f32_16x16x64_bf16 v[40:43], v[56:59], v[168:175], v4
    s_waitcnt lgkmcnt(2)
    v_smfmac_f32_16x16x64_bf16 v[36:39], v[56:59], v[76:83], v4
    ds_read_b128 v[56:59], v5 offset:5120
    buffer_load_dwordx4 v[80:83], v19, s[8:11], s45 offen offset:0 sc1
    buffer_load_dwordx4 v[84:87], v19, s[8:11], s45 offen offset:1024 sc1
    buffer_load_dwordx4 v[88:91], v19, s[8:11], s45 offen offset:2048 sc1
    v_smfmac_f32_16x16x64_bf16 v[32:35], v[60:63], a[160:167], v4
    v_smfmac_f32_16x16x64_bf16 v[44:47], v[60:63], v[176:183], v4
    v_permlane32_swap_b32 v28, v40
    v_permlane32_swap_b32 v29, v41
    ds_read_b128 v[60:63], v5 offset:6144
    v_smfmac_f32_16x16x64_bf16 v[32:35], v[64:67], a[168:175], v4
    v_permlane32_swap_b32 v30, v42
    v_permlane32_swap_b32 v31, v43
    v_smfmac_f32_16x16x64_bf16 v[44:47], v[64:67], v[184:191], v4
    v_add_f32 v28, v28, v40
    v_add_f32 v29, v29, v41
    ds_read_b128 v[64:67], v5 offset:8192
    s_waitcnt lgkmcnt(4)
    v_smfmac_f32_16x16x64_bf16 v[32:35], v[48:51], a[176:183], v4
    v_add_f32 v30, v30, v42
    v_add_f32 v31, v31, v43
    v_smfmac_f32_16x16x64_bf16 v[44:47], v[48:51], v[192:199], v4
    v_cvt_pk_bf16_f32 v40, v28, v29
    v_cvt_pk_bf16_f32 v41, v30, v31
    ds_read_b128 v[48:51], v5 offset:9216
    s_waitcnt lgkmcnt(4)
    v_smfmac_f32_16x16x64_bf16 v[32:35], v[52:55], a[192:199], v4
    v_mfma_f32_16x16x16_bf16 v[28:31], v[40:41], v[10:11], 0
    v_permlane32_swap_b32 v24, v36
    v_smfmac_f32_16x16x64_bf16 v[44:47], v[52:55], v[208:215], v4
    v_permlane32_swap_b32 v25, v37
    v_permlane32_swap_b32 v26, v38
    s_waitcnt lgkmcnt(3)
    v_smfmac_f32_16x16x64_bf16 v[32:35], v[56:59], a[200:207], v4
    v_permlane32_swap_b32 v27, v39
    v_add_f32 v24, v24, v36
    v_smfmac_f32_16x16x64_bf16 v[44:47], v[56:59], v[216:223], v4
    v_add_f32 v25, v25, v37
    v_add_f32 v26, v26, v38
    s_waitcnt lgkmcnt(2)
    v_smfmac_f32_16x16x64_bf16 v[32:35], v[60:63], a[208:215], v4
    v_add_f32 v27, v27, v39
    v_cvt_pk_bf16_f32 v36, v24, v25
    v_smfmac_f32_16x16x64_bf16 v[44:47], v[60:63], v[224:231], v4
    v_cvt_pk_bf16_f32 v37, v26, v27
    s_nop 1
    v_mfma_f32_16x16x16_bf16 v[24:27], v[36:37], v[10:11], 0
    s_waitcnt lgkmcnt(1)
    v_smfmac_f32_16x16x64_bf16 v[32:35], v[64:67], a[224:231], v4
    s_nop 5
    v_cvt_pk_bf16_f32 v24, v24, v25
    v_smfmac_f32_16x16x64_bf16 v[44:47], v[64:67], v[240:247], v4
    v_cvt_pk_bf16_f32 v25, v26, v27
    v_cvt_pk_bf16_f32 v26, v28, v29
    s_waitcnt lgkmcnt(0)
    v_smfmac_f32_16x16x64_bf16 v[32:35], v[48:51], a[232:239], v4
    v_cvt_pk_bf16_f32 v27, v30, v31
    s_waitcnt vmcnt(3)
    v_smfmac_f32_16x16x64_bf16 v[44:47], v[48:51], v[248:255], v4
    v_mfma_f32_16x16x32_bf16 v[28:31], a[240:243], v[24:27], 0
    v_mfma_f32_16x16x32_bf16 v[36:39], a[244:247], v[24:27], 0
    v_mfma_f32_16x16x32_bf16 v[40:43], v[24:27], v[24:27], 0
    s_nop 4
    v_permlane32_swap_b32 v32, v44
    v_permlane32_swap_b32 v33, v45
    v_permlane32_swap_b32 v34, v46
    v_permlane32_swap_b32 v35, v47
    v_add_f32 v32, v32, v44
    v_add_f32 v33, v33, v45
    v_add_f32 v34, v34, v46
    v_add_f32 v35, v35, v47
    v_cvt_pk_bf16_f32 v44, v32, v33
    v_cvt_pk_bf16_f32 v45, v34, v35
    s_nop 1
    v_mfma_f32_16x16x16_bf16 v[32:35], v[44:45], v[10:11], 0
    s_nop 7
    v_cvt_pk_bf16_f32 v32, v32, v33
    v_cvt_pk_bf16_f32 v33, v34, v35
    s_nop 1
    v_mfma_f32_16x16x16_bf16 v[28:31], a[248:249], v[32:33], v[28:31]
    v_mfma_f32_16x16x16_bf16 v[36:39], a[250:251], v[32:33], v[36:39]
    v_mfma_f32_16x16x16_bf16 v[40:43], v[32:33], v[32:33], v[40:43]
    s_nop 5
    ds_write_b128 v12, v[28:31]
    ds_write_b128 v12, v[36:39] offset:16
    ds_write_b128 v13, v[40:43]
    s_waitcnt lgkmcnt(0)
    s_barrier
    s_waitcnt vmcnt(0)
    v_mfma_f32_16x16x32_bf16 v[36:39], a[240:243], v[80:83], 0
    v_mfma_f32_16x16x32_bf16 v[44:47], a[244:247], v[80:83], 0
    v_mfma_f32_16x16x32_bf16 v[68:71], v[24:27], v[80:83], 0
    v_mfma_f32_16x16x32_bf16 v[40:43], a[240:243], v[84:87], 0
    v_mfma_f32_16x16x32_bf16 v[64:67], a[244:247], v[84:87], 0
    v_mfma_f32_16x16x32_bf16 v[72:75], v[24:27], v[84:87], 0
    s_nop 0
    v_mfma_f32_16x16x16_bf16 v[36:39], a[248:249], v[88:89], v[36:39]
    v_mfma_f32_16x16x16_bf16 v[44:47], a[250:251], v[88:89], v[44:47]
    v_mfma_f32_16x16x16_bf16 v[68:71], v[32:33], v[88:89], v[68:71]
    v_mfma_f32_16x16x16_bf16 v[40:43], a[248:249], v[90:91], v[40:43]
    v_mfma_f32_16x16x16_bf16 v[64:67], a[250:251], v[90:91], v[64:67]
    v_mfma_f32_16x16x16_bf16 v[72:75], v[32:33], v[90:91], v[72:75]
    s_nop 2
    ds_write_b128 v16, v[36:39] offset:0
    ds_write_b128 v16, v[44:47] offset:16
    ds_write_b128 v17, v[68:71]
    ds_write_b128 v16, v[40:43] offset:2816
    ds_write_b128 v16, v[64:67] offset:2832
    ds_write_b128 v18, v[72:75]
    s_add_u32 s40, s40, 1
    s_add_u32 s41, s41, 393216
    s_add_u32 s45, s45, 393216
    s_add_u32 s43, s43, 458752
    s_add_u32 s47, s47, 458752
    s_add_u32 s48, s48, 458752
    s_add_u32 s49, s49, 458752
    s_waitcnt lgkmcnt(0)
    s_barrier
    s_cmp_lt_u32 s40, 64
    s_cbranch_scc1 interleave_layers__linear_attn_block__memory_aug_recurrent_mem_tr__prompt_kernel_s_stepw3
interleave_layers__linear_attn_block__memory_aug_recurrent_mem_tr__prompt_kernel_s_end:
    ds_read_b128 v[48:51], v21 offset:0
    ds_read_b128 v[52:55], v21 offset:16
    ds_read_b128 v[56:59], v21 offset:5632
    ds_read_b128 v[60:63], v21 offset:5648
    ds_read_b128 v[64:67], v21 offset:11264
    ds_read_b128 v[68:71], v21 offset:11280
    ds_read_b128 v[72:75], v21 offset:16896
    ds_read_b128 v[76:79], v21 offset:16912
    s_waitcnt lgkmcnt(4)
    v_pk_add_f32 v[48:49], v[48:49], v[56:57]
    v_pk_add_f32 v[50:51], v[50:51], v[58:59]
    v_pk_add_f32 v[52:53], v[52:53], v[60:61]
    v_pk_add_f32 v[54:55], v[54:55], v[62:63]
    s_waitcnt lgkmcnt(0)
    v_pk_add_f32 v[64:65], v[64:65], v[72:73]
    v_pk_add_f32 v[66:67], v[66:67], v[74:75]
    v_pk_add_f32 v[68:69], v[68:69], v[76:77]
    v_pk_add_f32 v[70:71], v[70:71], v[78:79]
    v_pk_add_f32 v[48:49], v[48:49], v[64:65]
    v_pk_add_f32 v[50:51], v[50:51], v[66:67]
    v_pk_add_f32 v[52:53], v[52:53], v[68:69]
    v_pk_add_f32 v[54:55], v[54:55], v[70:71]
    v_mov_b32 v81, 0xff800000
    v_cndmask_b32 v48, v81, v48, s[64:65]
    v_cndmask_b32 v49, v81, v49, s[66:67]
    v_cndmask_b32 v50, v81, v50, s[68:69]
    v_cndmask_b32 v51, v81, v51, s[70:71]
    v_cndmask_b32 v52, v81, v52, s[72:73]
    v_cndmask_b32 v53, v81, v53, s[74:75]
    v_cndmask_b32 v54, v81, v54, s[76:77]
    v_cndmask_b32 v55, v81, v55, s[78:79]
    v_max3_f32 v80, v48, v49, v50
    v_max3_f32 v80, v80, v51, v52
    v_max3_f32 v80, v80, v53, v54
    v_max_f32 v80, v80, v55
    v_mov_b32 v81, 0xff800000
    v_cndmask_b32 v80, v81, v80, s[50:51]
    s_nop 1
    v_max_f32 v80, v80, v80 quad_perm:[1,0,3,2] row_mask:0xf bank_mask:0xf
    s_nop 1
    v_max_f32 v80, v80, v80 quad_perm:[2,3,0,1] row_mask:0xf bank_mask:0xf
    s_nop 1
    v_max_f32 v80, v80, v80 row_half_mirror row_mask:0xf bank_mask:0xf
    s_mov_b32 s24, 0x3dd53b95
    v_mul_f32 v80, s24, v80
    v_fma_f32 v48, v48, s24, -v80
    v_fma_f32 v49, v49, s24, -v80
    v_fma_f32 v50, v50, s24, -v80
    v_fma_f32 v51, v51, s24, -v80
    v_fma_f32 v52, v52, s24, -v80
    v_fma_f32 v53, v53, s24, -v80
    v_fma_f32 v54, v54, s24, -v80
    v_fma_f32 v55, v55, s24, -v80
    v_exp_f32 v48, v48
    v_exp_f32 v49, v49
    v_exp_f32 v50, v50
    v_exp_f32 v51, v51
    v_exp_f32 v52, v52
    v_exp_f32 v53, v53
    v_exp_f32 v54, v54
    v_exp_f32 v55, v55
    v_add_f32 v80, v48, v49
    v_add_f32 v81, v50, v51
    v_add_f32 v80, v80, v52
    v_add_f32 v81, v81, v53
    v_add_f32 v80, v80, v54
    v_add_f32 v81, v81, v55
    v_add_f32 v80, v80, v81
    v_cndmask_b32 v80, 0, v80, s[50:51]
    s_nop 1
    v_add_f32 v80, v80, v80 quad_perm:[1,0,3,2] row_mask:0xf bank_mask:0xf
    s_nop 1
    v_add_f32 v80, v80, v80 quad_perm:[2,3,0,1] row_mask:0xf bank_mask:0xf
    s_nop 1
    v_add_f32 v80, v80, v80 row_half_mirror row_mask:0xf bank_mask:0xf
    v_rcp_f32 v80, v80
    s_nop 0
    v_mul_f32 v48, v48, v80
    v_mul_f32 v49, v49, v80
    v_mul_f32 v50, v50, v80
    v_mul_f32 v51, v51, v80
    v_mul_f32 v52, v52, v80
    v_mul_f32 v53, v53, v80
    v_mul_f32 v54, v54, v80
    v_mul_f32 v55, v55, v80
    v_cvt_pk_bf16_f32 v56, v48, v49
    v_cvt_pk_bf16_f32 v57, v50, v51
    v_cvt_pk_bf16_f32 v58, v52, v53
    v_cvt_pk_bf16_f32 v59, v54, v55
    v_min_u32 v56, -2, v56
    v_min_u32 v57, -2, v57
    v_min_u32 v58, -2, v58
    v_min_u32 v59, -2, v59
    buffer_store_dwordx4 v[56:59], v22, s[8:11], s42 offen sc1
    s_add_u32 s42, s42, 458752
    s_cmp_eq_u32 s92, 0
    s_cbranch_scc0 interleave_layers__linear_attn_block__memory_aug_recurrent_mem_tr__prompt_kernel_end
    s_mov_b32 s92, 1
    s_branch interleave_layers__linear_attn_block__memory_aug_recurrent_mem_tr__prompt_kernel_s_layer
interleave_layers__linear_attn_block__memory_aug_recurrent_mem_tr__prompt_kernel_roleV:
    s_sub_u32 s44, s2, 32
    s_load_dwordx2 s[6:7], s[0:1], 56
    s_load_dwordx2 s[24:25], s[0:1], 64
    s_load_dwordx2 s[26:27], s[0:1], 32
    s_waitcnt lgkmcnt(0)
    s_mov_b32 s12, s6
    s_mov_b32 s13, s7
    s_mov_b32 s14, 7864320
    s_mov_b32 s15, 0x00020000
    s_mov_b32 s16, s24
    s_mov_b32 s17, s25
    s_mov_b32 s18, 7864320
    s_mov_b32 s19, 0x00020000
    s_mov_b32 s20, s26
    s_mov_b32 s21, s27
    s_mov_b32 s22, 10240
    s_mov_b32 s23, 0x00020000
    v_add_u32 v16, 0, v0
    s_mov_b32 s24, 683
    v_mul_lo_u32 v17, v16, s24
    v_lshrrev_b32 v17, 14, v17
    v_mul_u32_u24 v18, 24, v17
    v_sub_u32 v18, v16, v18
    s_mov_b32 s24, 12288
    v_mul_lo_u32 v4, v17, s24
    v_lshl_add_u32 v4, v18, 4, v4
    v_mul_u32_u24 v10, 400, v17
    v_lshl_add_u32 v10, v18, 4, v10
    v_add_u32 v10, 90112, v10
    v_add_u32 v16, 256, v0
    s_mov_b32 s24, 683
    v_mul_lo_u32 v17, v16, s24
    v_lshrrev_b32 v17, 14, v17
    v_mul_u32_u24 v18, 24, v17
    v_sub_u32 v18, v16, v18
    s_mov_b32 s24, 12288
    v_mul_lo_u32 v5, v17, s24
    v_lshl_add_u32 v5, v18, 4, v5
    v_mul_u32_u24 v11, 400, v17
    v_lshl_add_u32 v11, v18, 4, v11
    v_add_u32 v11, 90112, v11
    v_add_u32 v16, 512, v0
    s_mov_b32 s24, 683
    v_mul_lo_u32 v17, v16, s24
    v_lshrrev_b32 v17, 14, v17
    v_mul_u32_u24 v18, 24, v17
    v_sub_u32 v18, v16, v18
    s_mov_b32 s24, 12288
    v_mul_lo_u32 v6, v17, s24
    v_lshl_add_u32 v6, v18, 4, v6
    v_mul_u32_u24 v12, 400, v17
    v_lshl_add_u32 v12, v18, 4, v12
    v_add_u32 v12, 90112, v12
    v_add_u32 v16, 768, v0
    s_mov_b32 s24, 683
    v_mul_lo_u32 v17, v16, s24
    v_lshrrev_b32 v17, 14, v17
    v_mul_u32_u24 v18, 24, v17
    v_sub_u32 v18, v16, v18
    s_mov_b32 s24, 12288
    v_mul_lo_u32 v7, v17, s24
    v_lshl_add_u32 v7, v18, 4, v7
    v_mul_u32_u24 v13, 400, v17
    v_lshl_add_u32 v13, v18, 4, v13
    v_add_u32 v13, 90112, v13
    v_add_u32 v16, 1024, v0
    s_mov_b32 s24, 683
    v_mul_lo_u32 v17, v16, s24
    v_lshrrev_b32 v17, 14, v17
    v_mul_u32_u24 v18, 24, v17
    v_sub_u32 v18, v16, v18
    s_mov_b32 s24, 12288
    v_mul_lo_u32 v8, v17, s24
    v_lshl_add_u32 v8, v18, 4, v8
    v_mul_u32_u24 v14, 400, v17
    v_lshl_add_u32 v14, v18, 4, v14
    v_add_u32 v14, 90112, v14
    v_add_u32 v16, 1280, v0
    s_mov_b32 s24, 683
    v_mul_lo_u32 v17, v16, s24
    v_lshrrev_b32 v17, 14, v17
    v_mul_u32_u24 v18, 24, v17
    v_sub_u32 v18, v16, v18
    s_mov_b32 s24, 12288
    v_mul_lo_u32 v9, v17, s24
    v_lshl_add_u32 v9, v18, 4, v9
    v_mul_u32_u24 v15, 400, v17
    v_lshl_add_u32 v15, v18, 4, v15
    v_add_u32 v15, 90112, v15
    v_lshrrev_b32 v17, 1, v3
    v_lshlrev_b32 v17, 4, v17
    v_and_b32 v18, 1, v3
    v_lshl_add_u32 v17, v18, 2, v17
    v_lshrrev_b32 v18, 2, v2
    v_and_b32 v19, 1, v18
    v_add_u32 v17, v17, v19
    v_lshrrev_b32 v18, 1, v18
    v_lshl_add_u32 v17, v18, 3, v17
    v_mul_u32_u24 v16, 400, v17
    v_and_b32 v18, 3, v2
    v_lshl_add_u32 v16, v18, 3, v16
    v_add_u32 v16, 90112, v16
    s_mul_i32 s24, s3, 96
    v_add_u32 v16, s24, v16
    s_mul_i32 s45, s44, 384
    s_add_u32 s46, s45, 0
    buffer_load_dwordx4 v[24:27], v4, s[12:15], s46 offen
    buffer_load_dwordx4 v[28:31], v5, s[12:15], s46 offen
    buffer_load_dwordx4 v[32:35], v6, s[12:15], s46 offen
    buffer_load_dwordx4 v[36:39], v7, s[12:15], s46 offen
    buffer_load_dwordx4 v[40:43], v8, s[12:15], s46 offen
    buffer_load_dwordx4 v[44:47], v9, s[12:15], s46 offen
    s_add_u32 s46, s45, 786432
    buffer_load_dwordx4 v[48:51], v4, s[12:15], s46 offen
    buffer_load_dwordx4 v[52:55], v5, s[12:15], s46 offen
    buffer_load_dwordx4 v[56:59], v6, s[12:15], s46 offen
    buffer_load_dwordx4 v[60:63], v7, s[12:15], s46 offen
    buffer_load_dwordx4 v[64:67], v8, s[12:15], s46 offen
    buffer_load_dwordx4 v[68:71], v9, s[12:15], s46 offen
    s_waitcnt vmcnt(6)
    ds_write_b128 v10, v[24:27]
    ds_write_b128 v11, v[28:31]
    ds_write_b128 v12, v[32:35]
    ds_write_b128 v13, v[36:39]
    ds_write_b128 v14, v[40:43]
    ds_write_b128 v15, v[44:47]
    s_add_u32 s46, s45, 1572864
    buffer_load_dwordx4 v[72:75], v4, s[12:15], s46 offen
    buffer_load_dwordx4 v[76:79], v5, s[12:15], s46 offen
    buffer_load_dwordx4 v[80:83], v6, s[12:15], s46 offen
    buffer_load_dwordx4 v[84:87], v7, s[12:15], s46 offen
    buffer_load_dwordx4 v[88:91], v8, s[12:15], s46 offen
    buffer_load_dwordx4 v[92:95], v9, s[12:15], s46 offen
    s_waitcnt lgkmcnt(0)
    s_barrier
    ds_read_b64_tr_b16 a[0:1], v16 offset:0
    ds_read_b64_tr_b16 a[2:3], v16 offset:800
    ds_read_b64_tr_b16 a[4:5], v16 offset:12800
    ds_read_b64_tr_b16 a[6:7], v16 offset:13600
    ds_read_b64_tr_b16 a[80:81], v16 offset:32
    ds_read_b64_tr_b16 a[82:83], v16 offset:832
    ds_read_b64_tr_b16 a[84:85], v16 offset:12832
    ds_read_b64_tr_b16 a[86:87], v16 offset:13632
    ds_read_b64_tr_b16 a[160:161], v16 offset:64
    ds_read_b64_tr_b16 a[162:163], v16 offset:864
    ds_read_b64_tr_b16 a[164:165], v16 offset:12864
    ds_read_b64_tr_b16 a[166:167], v16 offset:13664
    s_waitcnt lgkmcnt(0)
    s_barrier
    s_waitcnt vmcnt(6)
    ds_write_b128 v10, v[48:51]
    ds_write_b128 v11, v[52:55]
    ds_write_b128 v12, v[56:59]
    ds_write_b128 v13, v[60:63]
    ds_write_b128 v14, v[64:67]
    ds_write_b128 v15, v[68:71]
    s_add_u32 s46, s45, 2359296
    buffer_load_dwordx4 v[24:27], v4, s[12:15], s46 offen
    buffer_load_dwordx4 v[28:31], v5, s[12:15], s46 offen
    buffer_load_dwordx4 v[32:35], v6, s[12:15], s46 offen
    buffer_load_dwordx4 v[36:39], v7, s[12:15], s46 offen
    buffer_load_dwordx4 v[40:43], v8, s[12:15], s46 offen
    buffer_load_dwordx4 v[44:47], v9, s[12:15], s46 offen
    s_waitcnt lgkmcnt(0)
    s_barrier
    ds_read_b64_tr_b16 a[8:9], v16 offset:0
    ds_read_b64_tr_b16 a[10:11], v16 offset:800
    ds_read_b64_tr_b16 a[12:13], v16 offset:12800
    ds_read_b64_tr_b16 a[14:15], v16 offset:13600
    ds_read_b64_tr_b16 a[88:89], v16 offset:32
    ds_read_b64_tr_b16 a[90:91], v16 offset:832
    ds_read_b64_tr_b16 a[92:93], v16 offset:12832
    ds_read_b64_tr_b16 a[94:95], v16 offset:13632
    ds_read_b64_tr_b16 a[168:169], v16 offset:64
    ds_read_b64_tr_b16 a[170:171], v16 offset:864
    ds_read_b64_tr_b16 a[172:173], v16 offset:12864
    ds_read_b64_tr_b16 a[174:175], v16 offset:13664
    s_waitcnt lgkmcnt(0)
    s_barrier
    s_waitcnt vmcnt(6)
    ds_write_b128 v10, v[72:75]
    ds_write_b128 v11, v[76:79]
    ds_write_b128 v12, v[80:83]
    ds_write_b128 v13, v[84:87]
    ds_write_b128 v14, v[88:91]
    ds_write_b128 v15, v[92:95]
    s_add_u32 s46, s45, 3145728
    buffer_load_dwordx4 v[48:51], v4, s[12:15], s46 offen
    buffer_load_dwordx4 v[52:55], v5, s[12:15], s46 offen
    buffer_load_dwordx4 v[56:59], v6, s[12:15], s46 offen
    buffer_load_dwordx4 v[60:63], v7, s[12:15], s46 offen
    buffer_load_dwordx4 v[64:67], v8, s[12:15], s46 offen
    buffer_load_dwordx4 v[68:71], v9, s[12:15], s46 offen
    s_waitcnt lgkmcnt(0)
    s_barrier
    ds_read_b64_tr_b16 a[16:17], v16 offset:0
    ds_read_b64_tr_b16 a[18:19], v16 offset:800
    ds_read_b64_tr_b16 a[20:21], v16 offset:12800
    ds_read_b64_tr_b16 a[22:23], v16 offset:13600
    ds_read_b64_tr_b16 a[96:97], v16 offset:32
    ds_read_b64_tr_b16 a[98:99], v16 offset:832
    ds_read_b64_tr_b16 a[100:101], v16 offset:12832
    ds_read_b64_tr_b16 a[102:103], v16 offset:13632
    ds_read_b64_tr_b16 a[176:177], v16 offset:64
    ds_read_b64_tr_b16 a[178:179], v16 offset:864
    ds_read_b64_tr_b16 a[180:181], v16 offset:12864
    ds_read_b64_tr_b16 a[182:183], v16 offset:13664
    s_waitcnt lgkmcnt(0)
    s_barrier
    s_waitcnt vmcnt(6)
    ds_write_b128 v10, v[24:27]
    ds_write_b128 v11, v[28:31]
    ds_write_b128 v12, v[32:35]
    ds_write_b128 v13, v[36:39]
    ds_write_b128 v14, v[40:43]
    ds_write_b128 v15, v[44:47]
    s_add_u32 s46, s45, 3932160
    buffer_load_dwordx4 v[72:75], v4, s[12:15], s46 offen
    buffer_load_dwordx4 v[76:79], v5, s[12:15], s46 offen
    buffer_load_dwordx4 v[80:83], v6, s[12:15], s46 offen
    buffer_load_dwordx4 v[84:87], v7, s[12:15], s46 offen
    buffer_load_dwordx4 v[88:91], v8, s[12:15], s46 offen
    buffer_load_dwordx4 v[92:95], v9, s[12:15], s46 offen
    s_waitcnt lgkmcnt(0)
    s_barrier
    ds_read_b64_tr_b16 a[24:25], v16 offset:0
    ds_read_b64_tr_b16 a[26:27], v16 offset:800
    ds_read_b64_tr_b16 a[28:29], v16 offset:12800
    ds_read_b64_tr_b16 a[30:31], v16 offset:13600
    ds_read_b64_tr_b16 a[104:105], v16 offset:32
    ds_read_b64_tr_b16 a[106:107], v16 offset:832
    ds_read_b64_tr_b16 a[108:109], v16 offset:12832
    ds_read_b64_tr_b16 a[110:111], v16 offset:13632
    ds_read_b64_tr_b16 a[184:185], v16 offset:64
    ds_read_b64_tr_b16 a[186:187], v16 offset:864
    ds_read_b64_tr_b16 a[188:189], v16 offset:12864
    ds_read_b64_tr_b16 a[190:191], v16 offset:13664
    s_waitcnt lgkmcnt(0)
    s_barrier
    s_waitcnt vmcnt(6)
    ds_write_b128 v10, v[48:51]
    ds_write_b128 v11, v[52:55]
    ds_write_b128 v12, v[56:59]
    ds_write_b128 v13, v[60:63]
    ds_write_b128 v14, v[64:67]
    ds_write_b128 v15, v[68:71]
    s_add_u32 s46, s45, 4718592
    buffer_load_dwordx4 v[24:27], v4, s[12:15], s46 offen
    buffer_load_dwordx4 v[28:31], v5, s[12:15], s46 offen
    buffer_load_dwordx4 v[32:35], v6, s[12:15], s46 offen
    buffer_load_dwordx4 v[36:39], v7, s[12:15], s46 offen
    buffer_load_dwordx4 v[40:43], v8, s[12:15], s46 offen
    buffer_load_dwordx4 v[44:47], v9, s[12:15], s46 offen
    s_waitcnt lgkmcnt(0)
    s_barrier
    ds_read_b64_tr_b16 a[32:33], v16 offset:0
    ds_read_b64_tr_b16 a[34:35], v16 offset:800
    ds_read_b64_tr_b16 a[36:37], v16 offset:12800
    ds_read_b64_tr_b16 a[38:39], v16 offset:13600
    ds_read_b64_tr_b16 a[112:113], v16 offset:32
    ds_read_b64_tr_b16 a[114:115], v16 offset:832
    ds_read_b64_tr_b16 a[116:117], v16 offset:12832
    ds_read_b64_tr_b16 a[118:119], v16 offset:13632
    ds_read_b64_tr_b16 a[192:193], v16 offset:64
    ds_read_b64_tr_b16 a[194:195], v16 offset:864
    ds_read_b64_tr_b16 a[196:197], v16 offset:12864
    ds_read_b64_tr_b16 a[198:199], v16 offset:13664
    s_waitcnt lgkmcnt(0)
    s_barrier
    s_waitcnt vmcnt(6)
    ds_write_b128 v10, v[72:75]
    ds_write_b128 v11, v[76:79]
    ds_write_b128 v12, v[80:83]
    ds_write_b128 v13, v[84:87]
    ds_write_b128 v14, v[88:91]
    ds_write_b128 v15, v[92:95]
    s_add_u32 s46, s45, 5505024
    buffer_load_dwordx4 v[48:51], v4, s[12:15], s46 offen
    buffer_load_dwordx4 v[52:55], v5, s[12:15], s46 offen
    buffer_load_dwordx4 v[56:59], v6, s[12:15], s46 offen
    buffer_load_dwordx4 v[60:63], v7, s[12:15], s46 offen
    buffer_load_dwordx4 v[64:67], v8, s[12:15], s46 offen
    buffer_load_dwordx4 v[68:71], v9, s[12:15], s46 offen
    s_waitcnt lgkmcnt(0)
    s_barrier
    ds_read_b64_tr_b16 a[40:41], v16 offset:0
    ds_read_b64_tr_b16 a[42:43], v16 offset:800
    ds_read_b64_tr_b16 a[44:45], v16 offset:12800
    ds_read_b64_tr_b16 a[46:47], v16 offset:13600
    ds_read_b64_tr_b16 a[120:121], v16 offset:32
    ds_read_b64_tr_b16 a[122:123], v16 offset:832
    ds_read_b64_tr_b16 a[124:125], v16 offset:12832
    ds_read_b64_tr_b16 a[126:127], v16 offset:13632
    ds_read_b64_tr_b16 a[200:201], v16 offset:64
    ds_read_b64_tr_b16 a[202:203], v16 offset:864
    ds_read_b64_tr_b16 a[204:205], v16 offset:12864
    ds_read_b64_tr_b16 a[206:207], v16 offset:13664
    s_waitcnt lgkmcnt(0)
    s_barrier
    s_waitcnt vmcnt(6)
    ds_write_b128 v10, v[24:27]
    ds_write_b128 v11, v[28:31]
    ds_write_b128 v12, v[32:35]
    ds_write_b128 v13, v[36:39]
    ds_write_b128 v14, v[40:43]
    ds_write_b128 v15, v[44:47]
    s_add_u32 s46, s45, 6291456
    buffer_load_dwordx4 v[72:75], v4, s[12:15], s46 offen
    buffer_load_dwordx4 v[76:79], v5, s[12:15], s46 offen
    buffer_load_dwordx4 v[80:83], v6, s[12:15], s46 offen
    buffer_load_dwordx4 v[84:87], v7, s[12:15], s46 offen
    buffer_load_dwordx4 v[88:91], v8, s[12:15], s46 offen
    buffer_load_dwordx4 v[92:95], v9, s[12:15], s46 offen
    s_waitcnt lgkmcnt(0)
    s_barrier
    ds_read_b64_tr_b16 a[48:49], v16 offset:0
    ds_read_b64_tr_b16 a[50:51], v16 offset:800
    ds_read_b64_tr_b16 a[52:53], v16 offset:12800
    ds_read_b64_tr_b16 a[54:55], v16 offset:13600
    ds_read_b64_tr_b16 a[128:129], v16 offset:32
    ds_read_b64_tr_b16 a[130:131], v16 offset:832
    ds_read_b64_tr_b16 a[132:133], v16 offset:12832
    ds_read_b64_tr_b16 a[134:135], v16 offset:13632
    ds_read_b64_tr_b16 a[208:209], v16 offset:64
    ds_read_b64_tr_b16 a[210:211], v16 offset:864
    ds_read_b64_tr_b16 a[212:213], v16 offset:12864
    ds_read_b64_tr_b16 a[214:215], v16 offset:13664
    s_waitcnt lgkmcnt(0)
    s_barrier
    s_waitcnt vmcnt(6)
    ds_write_b128 v10, v[48:51]
    ds_write_b128 v11, v[52:55]
    ds_write_b128 v12, v[56:59]
    ds_write_b128 v13, v[60:63]
    ds_write_b128 v14, v[64:67]
    ds_write_b128 v15, v[68:71]
    s_add_u32 s46, s45, 7077888
    buffer_load_dwordx4 v[24:27], v4, s[12:15], s46 offen
    buffer_load_dwordx4 v[28:31], v5, s[12:15], s46 offen
    buffer_load_dwordx4 v[32:35], v6, s[12:15], s46 offen
    buffer_load_dwordx4 v[36:39], v7, s[12:15], s46 offen
    buffer_load_dwordx4 v[40:43], v8, s[12:15], s46 offen
    buffer_load_dwordx4 v[44:47], v9, s[12:15], s46 offen
    s_waitcnt lgkmcnt(0)
    s_barrier
    ds_read_b64_tr_b16 a[56:57], v16 offset:0
    ds_read_b64_tr_b16 a[58:59], v16 offset:800
    ds_read_b64_tr_b16 a[60:61], v16 offset:12800
    ds_read_b64_tr_b16 a[62:63], v16 offset:13600
    ds_read_b64_tr_b16 a[136:137], v16 offset:32
    ds_read_b64_tr_b16 a[138:139], v16 offset:832
    ds_read_b64_tr_b16 a[140:141], v16 offset:12832
    ds_read_b64_tr_b16 a[142:143], v16 offset:13632
    ds_read_b64_tr_b16 a[216:217], v16 offset:64
    ds_read_b64_tr_b16 a[218:219], v16 offset:864
    ds_read_b64_tr_b16 a[220:221], v16 offset:12864
    ds_read_b64_tr_b16 a[222:223], v16 offset:13664
    s_waitcnt lgkmcnt(0)
    s_barrier
    s_waitcnt vmcnt(6)
    ds_write_b128 v10, v[72:75]
    ds_write_b128 v11, v[76:79]
    ds_write_b128 v12, v[80:83]
    ds_write_b128 v13, v[84:87]
    ds_write_b128 v14, v[88:91]
    ds_write_b128 v15, v[92:95]
    s_waitcnt lgkmcnt(0)
    s_barrier
    ds_read_b64_tr_b16 a[64:65], v16 offset:0
    ds_read_b64_tr_b16 a[66:67], v16 offset:800
    ds_read_b64_tr_b16 a[68:69], v16 offset:12800
    ds_read_b64_tr_b16 a[70:71], v16 offset:13600
    ds_read_b64_tr_b16 a[144:145], v16 offset:32
    ds_read_b64_tr_b16 a[146:147], v16 offset:832
    ds_read_b64_tr_b16 a[148:149], v16 offset:12832
    ds_read_b64_tr_b16 a[150:151], v16 offset:13632
    ds_read_b64_tr_b16 a[224:225], v16 offset:64
    ds_read_b64_tr_b16 a[226:227], v16 offset:864
    ds_read_b64_tr_b16 a[228:229], v16 offset:12864
    ds_read_b64_tr_b16 a[230:231], v16 offset:13664
    s_waitcnt lgkmcnt(0)
    s_barrier
    s_waitcnt vmcnt(0)
    ds_write_b128 v10, v[24:27]
    ds_write_b128 v11, v[28:31]
    ds_write_b128 v12, v[32:35]
    ds_write_b128 v13, v[36:39]
    ds_write_b128 v14, v[40:43]
    ds_write_b128 v15, v[44:47]
    s_waitcnt lgkmcnt(0)
    s_barrier
    ds_read_b64_tr_b16 a[72:73], v16 offset:0
    ds_read_b64_tr_b16 a[74:75], v16 offset:800
    ds_read_b64_tr_b16 a[76:77], v16 offset:12800
    ds_read_b64_tr_b16 a[78:79], v16 offset:13600
    ds_read_b64_tr_b16 a[152:153], v16 offset:32
    ds_read_b64_tr_b16 a[154:155], v16 offset:832
    ds_read_b64_tr_b16 a[156:157], v16 offset:12832
    ds_read_b64_tr_b16 a[158:159], v16 offset:13632
    ds_read_b64_tr_b16 a[232:233], v16 offset:64
    ds_read_b64_tr_b16 a[234:235], v16 offset:864
    ds_read_b64_tr_b16 a[236:237], v16 offset:12864
    ds_read_b64_tr_b16 a[238:239], v16 offset:13664
    s_waitcnt lgkmcnt(0)
    s_barrier
    v_add_u32 v64, 0, v0
    s_mov_b32 s24, 1639
    v_mul_lo_u32 v65, v64, s24
    v_lshrrev_b32 v65, 16, v65
    v_mul_u32_u24 v66, 40, v65
    v_sub_u32 v66, v64, v66
    s_mov_b32 s24, 1280
    v_mul_lo_u32 v4, v65, s24
    v_lshl_add_u32 v4, v66, 4, v4
    v_mul_u32_u24 v14, 656, v65
    v_lshl_add_u32 v14, v66, 4, v14
    v_add_u32 v14, 90112, v14
    v_add_u32 v64, 256, v0
    s_mov_b32 s24, 1639
    v_mul_lo_u32 v65, v64, s24
    v_lshrrev_b32 v65, 16, v65
    v_mul_u32_u24 v66, 40, v65
    v_sub_u32 v66, v64, v66
    s_mov_b32 s24, 1280
    v_mul_lo_u32 v5, v65, s24
    v_lshl_add_u32 v5, v66, 4, v5
    v_mul_u32_u24 v15, 656, v65
    v_lshl_add_u32 v15, v66, 4, v15
    v_add_u32 v15, 90112, v15
    v_add_u32 v64, 512, v0
    s_mov_b32 s24, 1639
    v_mul_lo_u32 v65, v64, s24
    v_lshrrev_b32 v65, 16, v65
    v_mul_u32_u24 v66, 40, v65
    v_sub_u32 v66, v64, v66
    s_mov_b32 s24, 1280
    v_mul_lo_u32 v6, v65, s24
    v_lshl_add_u32 v6, v66, 4, v6
    v_mul_u32_u24 v16, 656, v65
    v_lshl_add_u32 v16, v66, 4, v16
    v_add_u32 v16, 90112, v16
    v_add_u32 v64, 768, v0
    s_mov_b32 s24, 1639
    v_mul_lo_u32 v65, v64, s24
    v_lshrrev_b32 v65, 16, v65
    v_mul_u32_u24 v66, 40, v65
    v_sub_u32 v66, v64, v66
    s_mov_b32 s24, 1280
    v_mul_lo_u32 v7, v65, s24
    v_lshl_add_u32 v7, v66, 4, v7
    v_mul_u32_u24 v17, 656, v65
    v_lshl_add_u32 v17, v66, 4, v17
    v_add_u32 v17, 90112, v17
    v_add_u32 v64, 1024, v0
    s_mov_b32 s24, 1639
    v_mul_lo_u32 v65, v64, s24
    v_lshrrev_b32 v65, 16, v65
    v_mul_u32_u24 v66, 40, v65
    v_sub_u32 v66, v64, v66
    s_mov_b32 s24, 1280
    v_mul_lo_u32 v8, v65, s24
    v_lshl_add_u32 v8, v66, 4, v8
    v_mul_u32_u24 v18, 656, v65
    v_lshl_add_u32 v18, v66, 4, v18
    v_add_u32 v18, 90112, v18
    v_add_u32 v64, 1280, v0
    s_mov_b32 s24, 1639
    v_mul_lo_u32 v65, v64, s24
    v_lshrrev_b32 v65, 16, v65
    v_mul_u32_u24 v66, 40, v65
    v_sub_u32 v66, v64, v66
    s_mov_b32 s24, 1280
    v_mul_lo_u32 v9, v65, s24
    v_lshl_add_u32 v9, v66, 4, v9
    v_mul_u32_u24 v19, 656, v65
    v_lshl_add_u32 v19, v66, 4, v19
    v_add_u32 v19, 90112, v19
    v_add_u32 v64, 1536, v0
    s_mov_b32 s24, 1639
    v_mul_lo_u32 v65, v64, s24
    v_lshrrev_b32 v65, 16, v65
    v_mul_u32_u24 v66, 40, v65
    v_sub_u32 v66, v64, v66
    s_mov_b32 s24, 1280
    v_mul_lo_u32 v10, v65, s24
    v_lshl_add_u32 v10, v66, 4, v10
    v_mul_u32_u24 v20, 656, v65
    v_lshl_add_u32 v20, v66, 4, v20
    v_add_u32 v20, 90112, v20
    v_add_u32 v64, 1792, v0
    s_mov_b32 s24, 1639
    v_mul_lo_u32 v65, v64, s24
    v_lshrrev_b32 v65, 16, v65
    v_mul_u32_u24 v66, 40, v65
    v_sub_u32 v66, v64, v66
    s_mov_b32 s24, 1280
    v_mul_lo_u32 v11, v65, s24
    v_lshl_add_u32 v11, v66, 4, v11
    v_mul_u32_u24 v21, 656, v65
    v_lshl_add_u32 v21, v66, 4, v21
    v_add_u32 v21, 90112, v21
    v_add_u32 v64, 2048, v0
    s_mov_b32 s24, 1639
    v_mul_lo_u32 v65, v64, s24
    v_lshrrev_b32 v65, 16, v65
    v_mul_u32_u24 v66, 40, v65
    v_sub_u32 v66, v64, v66
    s_mov_b32 s24, 1280
    v_mul_lo_u32 v12, v65, s24
    v_lshl_add_u32 v12, v66, 4, v12
    v_mul_u32_u24 v22, 656, v65
    v_lshl_add_u32 v22, v66, 4, v22
    v_add_u32 v22, 90112, v22
    v_add_u32 v64, 2304, v0
    s_mov_b32 s24, 1639
    v_mul_lo_u32 v65, v64, s24
    v_lshrrev_b32 v65, 16, v65
    v_mul_u32_u24 v66, 40, v65
    v_sub_u32 v66, v64, v66
    s_mov_b32 s24, 1280
    v_mul_lo_u32 v13, v65, s24
    v_lshl_add_u32 v13, v66, 4, v13
    v_mul_u32_u24 v23, 656, v65
    v_lshl_add_u32 v23, v66, 4, v23
    v_add_u32 v23, 90112, v23
    v_lshrrev_b32 v64, 1, v3
    v_lshlrev_b32 v64, 4, v64
    v_and_b32 v65, 1, v3
    v_lshl_add_u32 v64, v65, 2, v64
    v_lshrrev_b32 v65, 2, v2
    v_and_b32 v66, 1, v65
    v_add_u32 v64, v64, v66
    v_lshrrev_b32 v65, 1, v65
    v_lshl_add_u32 v64, v65, 3, v64
    v_mul_u32_u24 v72, 656, v64
    v_and_b32 v65, 3, v2
    v_lshl_add_u32 v72, v65, 3, v72
    v_add_u32 v72, 90112, v72
    s_and_b32 s24, s3, 1
    s_mul_i32 s24, s24, 320
    v_add_u32 v72, s24, v72
    v_lshlrev_b32 v73, 4, v1
    s_mul_i32 s24, s3, 18432
    s_add_u32 s24, s24, 16384
    v_add_u32 v73, s24, v73
    s_mul_i32 s45, s44, 245760
    s_add_u32 s46, s45, 0
    buffer_load_dwordx4 v[24:27], v4, s[16:19], s46 offen
    buffer_load_dwordx4 v[28:31], v5, s[16:19], s46 offen
    buffer_load_dwordx4 v[32:35], v6, s[16:19], s46 offen
    buffer_load_dwordx4 v[36:39], v7, s[16:19], s46 offen
    buffer_load_dwordx4 v[40:43], v8, s[16:19], s46 offen
    buffer_load_dwordx4 v[44:47], v9, s[16:19], s46 offen
    buffer_load_dwordx4 v[48:51], v10, s[16:19], s46 offen
    buffer_load_dwordx4 v[52:55], v11, s[16:19], s46 offen
    buffer_load_dwordx4 v[56:59], v12, s[16:19], s46 offen
    buffer_load_dwordx4 v[60:63], v13, s[16:19], s46 offen
    s_waitcnt vmcnt(0)
    ds_write_b128 v14, v[24:27]
    ds_write_b128 v15, v[28:31]
    ds_write_b128 v16, v[32:35]
    ds_write_b128 v17, v[36:39]
    ds_write_b128 v18, v[40:43]
    ds_write_b128 v19, v[44:47]
    ds_write_b128 v20, v[48:51]
    ds_write_b128 v21, v[52:55]
    ds_write_b128 v22, v[56:59]
    ds_write_b128 v23, v[60:63]
    s_waitcnt lgkmcnt(0)
    s_barrier
    s_lshr_b32 s24, s3, 1
    s_cmp_eq_u32 s24, 0
    s_cbranch_scc0 interleave_layers__linear_attn_block__memory_aug_recurrent_mem_tr__prompt_kernel_wo17
    ds_read_b64_tr_b16 a[240:241], v72 offset:0
    ds_read_b64_tr_b16 a[242:243], v72 offset:1312
    ds_read_b64_tr_b16 a[244:245], v72 offset:20992
    ds_read_b64_tr_b16 a[246:247], v72 offset:22304
    ds_read_b64_tr_b16 v[112:113], v72 offset:32
    ds_read_b64_tr_b16 v[114:115], v72 offset:1344
    ds_read_b64_tr_b16 v[116:117], v72 offset:21024
    ds_read_b64_tr_b16 v[118:119], v72 offset:22336
    ds_read_b64_tr_b16 v[136:137], v72 offset:64
    ds_read_b64_tr_b16 v[138:139], v72 offset:1376
    ds_read_b64_tr_b16 v[140:141], v72 offset:21056
    ds_read_b64_tr_b16 v[142:143], v72 offset:22368
    ds_read_b64_tr_b16 v[160:161], v72 offset:96
    ds_read_b64_tr_b16 v[162:163], v72 offset:1408
    ds_read_b64_tr_b16 v[164:165], v72 offset:21088
    ds_read_b64_tr_b16 v[166:167], v72 offset:22400
    ds_read_b64_tr_b16 v[184:185], v72 offset:128
    ds_read_b64_tr_b16 v[186:187], v72 offset:1440
    ds_read_b64_tr_b16 v[188:189], v72 offset:21120
    ds_read_b64_tr_b16 v[190:191], v72 offset:22432
    ds_read_b64_tr_b16 v[208:209], v72 offset:160
    ds_read_b64_tr_b16 v[210:211], v72 offset:1472
    ds_read_b64_tr_b16 v[212:213], v72 offset:21152
    ds_read_b64_tr_b16 v[214:215], v72 offset:22464
    ds_read_b64_tr_b16 v[232:233], v72 offset:192
    ds_read_b64_tr_b16 v[234:235], v72 offset:1504
    ds_read_b64_tr_b16 v[236:237], v72 offset:21184
    ds_read_b64_tr_b16 v[238:239], v72 offset:22496
    ds_read_b64_tr_b16 v[64:65], v72 offset:224
    ds_read_b64_tr_b16 v[66:67], v72 offset:1536
    ds_read_b64_tr_b16 v[68:69], v72 offset:21216
    ds_read_b64_tr_b16 v[70:71], v72 offset:22528
    s_waitcnt lgkmcnt(0)
    ds_write_b128 v73, v[64:67] offset:0
    ds_write_b128 v73, v[68:71] offset:1024
    s_waitcnt lgkmcnt(0)
    ds_read_b64_tr_b16 v[64:65], v72 offset:256
    ds_read_b64_tr_b16 v[66:67], v72 offset:1568
    ds_read_b64_tr_b16 v[68:69], v72 offset:21248
    ds_read_b64_tr_b16 v[70:71], v72 offset:22560
    s_waitcnt lgkmcnt(0)
    ds_write_b128 v73, v[64:67] offset:6144
    ds_write_b128 v73, v[68:71] offset:7168
    s_waitcnt lgkmcnt(0)
    ds_read_b64_tr_b16 v[64:65], v72 offset:288
    ds_read_b64_tr_b16 v[66:67], v72 offset:1600
    ds_read_b64_tr_b16 v[68:69], v72 offset:21280
    ds_read_b64_tr_b16 v[70:71], v72 offset:22592
    s_waitcnt lgkmcnt(0)
    ds_write_b128 v73, v[64:67] offset:12288
    ds_write_b128 v73, v[68:71] offset:13312
    s_waitcnt lgkmcnt(0)
    s_waitcnt lgkmcnt(0)
interleave_layers__linear_attn_block__memory_aug_recurrent_mem_tr__prompt_kernel_wo17:
    s_barrier
    s_add_u32 s46, s45, 640
    buffer_load_dwordx4 v[24:27], v4, s[16:19], s46 offen
    buffer_load_dwordx4 v[28:31], v5, s[16:19], s46 offen
    buffer_load_dwordx4 v[32:35], v6, s[16:19], s46 offen
    buffer_load_dwordx4 v[36:39], v7, s[16:19], s46 offen
    buffer_load_dwordx4 v[40:43], v8, s[16:19], s46 offen
    buffer_load_dwordx4 v[44:47], v9, s[16:19], s46 offen
    buffer_load_dwordx4 v[48:51], v10, s[16:19], s46 offen
    buffer_load_dwordx4 v[52:55], v11, s[16:19], s46 offen
    buffer_load_dwordx4 v[56:59], v12, s[16:19], s46 offen
    buffer_load_dwordx4 v[60:63], v13, s[16:19], s46 offen
    s_waitcnt vmcnt(0)
    ds_write_b128 v14, v[24:27]
    ds_write_b128 v15, v[28:31]
    ds_write_b128 v16, v[32:35]
    ds_write_b128 v17, v[36:39]
    ds_write_b128 v18, v[40:43]
    ds_write_b128 v19, v[44:47]
    ds_write_b128 v20, v[48:51]
    ds_write_b128 v21, v[52:55]
    ds_write_b128 v22, v[56:59]
    ds_write_b128 v23, v[60:63]
    s_waitcnt lgkmcnt(0)
    s_barrier
    s_lshr_b32 s24, s3, 1
    s_cmp_eq_u32 s24, 1
    s_cbranch_scc0 interleave_layers__linear_attn_block__memory_aug_recurrent_mem_tr__prompt_kernel_wo18
    ds_read_b64_tr_b16 a[240:241], v72 offset:0
    ds_read_b64_tr_b16 a[242:243], v72 offset:1312
    ds_read_b64_tr_b16 a[244:245], v72 offset:20992
    ds_read_b64_tr_b16 a[246:247], v72 offset:22304
    ds_read_b64_tr_b16 v[112:113], v72 offset:32
    ds_read_b64_tr_b16 v[114:115], v72 offset:1344
    ds_read_b64_tr_b16 v[116:117], v72 offset:21024
    ds_read_b64_tr_b16 v[118:119], v72 offset:22336
    ds_read_b64_tr_b16 v[136:137], v72 offset:64
    ds_read_b64_tr_b16 v[138:139], v72 offset:1376
    ds_read_b64_tr_b16 v[140:141], v72 offset:21056
    ds_read_b64_tr_b16 v[142:143], v72 offset:22368
    ds_read_b64_tr_b16 v[160:161], v72 offset:96
    ds_read_b64_tr_b16 v[162:163], v72 offset:1408
    ds_read_b64_tr_b16 v[164:165], v72 offset:21088
    ds_read_b64_tr_b16 v[166:167], v72 offset:22400
    ds_read_b64_tr_b16 v[184:185], v72 offset:128
    ds_read_b64_tr_b16 v[186:187], v72 offset:1440
    ds_read_b64_tr_b16 v[188:189], v72 offset:21120
    ds_read_b64_tr_b16 v[190:191], v72 offset:22432
    ds_read_b64_tr_b16 v[208:209], v72 offset:160
    ds_read_b64_tr_b16 v[210:211], v72 offset:1472
    ds_read_b64_tr_b16 v[212:213], v72 offset:21152
    ds_read_b64_tr_b16 v[214:215], v72 offset:22464
    ds_read_b64_tr_b16 v[232:233], v72 offset:192
    ds_read_b64_tr_b16 v[234:235], v72 offset:1504
    ds_read_b64_tr_b16 v[236:237], v72 offset:21184
    ds_read_b64_tr_b16 v[238:239], v72 offset:22496
    ds_read_b64_tr_b16 v[64:65], v72 offset:224
    ds_read_b64_tr_b16 v[66:67], v72 offset:1536
    ds_read_b64_tr_b16 v[68:69], v72 offset:21216
    ds_read_b64_tr_b16 v[70:71], v72 offset:22528
    s_waitcnt lgkmcnt(0)
    ds_write_b128 v73, v[64:67] offset:0
    ds_write_b128 v73, v[68:71] offset:1024
    s_waitcnt lgkmcnt(0)
    ds_read_b64_tr_b16 v[64:65], v72 offset:256
    ds_read_b64_tr_b16 v[66:67], v72 offset:1568
    ds_read_b64_tr_b16 v[68:69], v72 offset:21248
    ds_read_b64_tr_b16 v[70:71], v72 offset:22560
    s_waitcnt lgkmcnt(0)
    ds_write_b128 v73, v[64:67] offset:6144
    ds_write_b128 v73, v[68:71] offset:7168
    s_waitcnt lgkmcnt(0)
    ds_read_b64_tr_b16 v[64:65], v72 offset:288
    ds_read_b64_tr_b16 v[66:67], v72 offset:1600
    ds_read_b64_tr_b16 v[68:69], v72 offset:21280
    ds_read_b64_tr_b16 v[70:71], v72 offset:22592
    s_waitcnt lgkmcnt(0)
    ds_write_b128 v73, v[64:67] offset:12288
    ds_write_b128 v73, v[68:71] offset:13312
    s_waitcnt lgkmcnt(0)
    s_waitcnt lgkmcnt(0)
interleave_layers__linear_attn_block__memory_aug_recurrent_mem_tr__prompt_kernel_wo18:
    s_barrier
    s_add_u32 s46, s45, 81920
    buffer_load_dwordx4 v[24:27], v4, s[16:19], s46 offen
    buffer_load_dwordx4 v[28:31], v5, s[16:19], s46 offen
    buffer_load_dwordx4 v[32:35], v6, s[16:19], s46 offen
    buffer_load_dwordx4 v[36:39], v7, s[16:19], s46 offen
    buffer_load_dwordx4 v[40:43], v8, s[16:19], s46 offen
    buffer_load_dwordx4 v[44:47], v9, s[16:19], s46 offen
    buffer_load_dwordx4 v[48:51], v10, s[16:19], s46 offen
    buffer_load_dwordx4 v[52:55], v11, s[16:19], s46 offen
    buffer_load_dwordx4 v[56:59], v12, s[16:19], s46 offen
    buffer_load_dwordx4 v[60:63], v13, s[16:19], s46 offen
    s_waitcnt vmcnt(0)
    ds_write_b128 v14, v[24:27]
    ds_write_b128 v15, v[28:31]
    ds_write_b128 v16, v[32:35]
    ds_write_b128 v17, v[36:39]
    ds_write_b128 v18, v[40:43]
    ds_write_b128 v19, v[44:47]
    ds_write_b128 v20, v[48:51]
    ds_write_b128 v21, v[52:55]
    ds_write_b128 v22, v[56:59]
    ds_write_b128 v23, v[60:63]
    s_waitcnt lgkmcnt(0)
    s_barrier
    s_lshr_b32 s24, s3, 1
    s_cmp_eq_u32 s24, 0
    s_cbranch_scc0 interleave_layers__linear_attn_block__memory_aug_recurrent_mem_tr__prompt_kernel_wo19
    ds_read_b64_tr_b16 a[248:249], v72 offset:0
    ds_read_b64_tr_b16 a[250:251], v72 offset:1312
    ds_read_b64_tr_b16 a[252:253], v72 offset:20992
    ds_read_b64_tr_b16 a[254:255], v72 offset:22304
    ds_read_b64_tr_b16 v[120:121], v72 offset:32
    ds_read_b64_tr_b16 v[122:123], v72 offset:1344
    ds_read_b64_tr_b16 v[124:125], v72 offset:21024
    ds_read_b64_tr_b16 v[126:127], v72 offset:22336
    ds_read_b64_tr_b16 v[144:145], v72 offset:64
    ds_read_b64_tr_b16 v[146:147], v72 offset:1376
    ds_read_b64_tr_b16 v[148:149], v72 offset:21056
    ds_read_b64_tr_b16 v[150:151], v72 offset:22368
    ds_read_b64_tr_b16 v[168:169], v72 offset:96
    ds_read_b64_tr_b16 v[170:171], v72 offset:1408
    ds_read_b64_tr_b16 v[172:173], v72 offset:21088
    ds_read_b64_tr_b16 v[174:175], v72 offset:22400
    ds_read_b64_tr_b16 v[192:193], v72 offset:128
    ds_read_b64_tr_b16 v[194:195], v72 offset:1440
    ds_read_b64_tr_b16 v[196:197], v72 offset:21120
    ds_read_b64_tr_b16 v[198:199], v72 offset:22432
    ds_read_b64_tr_b16 v[216:217], v72 offset:160
    ds_read_b64_tr_b16 v[218:219], v72 offset:1472
    ds_read_b64_tr_b16 v[220:221], v72 offset:21152
    ds_read_b64_tr_b16 v[222:223], v72 offset:22464
    ds_read_b64_tr_b16 v[240:241], v72 offset:192
    ds_read_b64_tr_b16 v[242:243], v72 offset:1504
    ds_read_b64_tr_b16 v[244:245], v72 offset:21184
    ds_read_b64_tr_b16 v[246:247], v72 offset:22496
    ds_read_b64_tr_b16 v[64:65], v72 offset:224
    ds_read_b64_tr_b16 v[66:67], v72 offset:1536
    ds_read_b64_tr_b16 v[68:69], v72 offset:21216
    ds_read_b64_tr_b16 v[70:71], v72 offset:22528
    s_waitcnt lgkmcnt(0)
    ds_write_b128 v73, v[64:67] offset:2048
    ds_write_b128 v73, v[68:71] offset:3072
    s_waitcnt lgkmcnt(0)
    ds_read_b64_tr_b16 v[64:65], v72 offset:256
    ds_read_b64_tr_b16 v[66:67], v72 offset:1568
    ds_read_b64_tr_b16 v[68:69], v72 offset:21248
    ds_read_b64_tr_b16 v[70:71], v72 offset:22560
    s_waitcnt lgkmcnt(0)
    ds_write_b128 v73, v[64:67] offset:8192
    ds_write_b128 v73, v[68:71] offset:9216
    s_waitcnt lgkmcnt(0)
    ds_read_b64_tr_b16 v[64:65], v72 offset:288
    ds_read_b64_tr_b16 v[66:67], v72 offset:1600
    ds_read_b64_tr_b16 v[68:69], v72 offset:21280
    ds_read_b64_tr_b16 v[70:71], v72 offset:22592
    s_waitcnt lgkmcnt(0)
    ds_write_b128 v73, v[64:67] offset:14336
    ds_write_b128 v73, v[68:71] offset:15360
    s_waitcnt lgkmcnt(0)
    s_waitcnt lgkmcnt(0)
interleave_layers__linear_attn_block__memory_aug_recurrent_mem_tr__prompt_kernel_wo19:
    s_barrier
    s_add_u32 s46, s45, 82560
    buffer_load_dwordx4 v[24:27], v4, s[16:19], s46 offen
    buffer_load_dwordx4 v[28:31], v5, s[16:19], s46 offen
    buffer_load_dwordx4 v[32:35], v6, s[16:19], s46 offen
    buffer_load_dwordx4 v[36:39], v7, s[16:19], s46 offen
    buffer_load_dwordx4 v[40:43], v8, s[16:19], s46 offen
    buffer_load_dwordx4 v[44:47], v9, s[16:19], s46 offen
    buffer_load_dwordx4 v[48:51], v10, s[16:19], s46 offen
    buffer_load_dwordx4 v[52:55], v11, s[16:19], s46 offen
    buffer_load_dwordx4 v[56:59], v12, s[16:19], s46 offen
    buffer_load_dwordx4 v[60:63], v13, s[16:19], s46 offen
    s_waitcnt vmcnt(0)
    ds_write_b128 v14, v[24:27]
    ds_write_b128 v15, v[28:31]
    ds_write_b128 v16, v[32:35]
    ds_write_b128 v17, v[36:39]
    ds_write_b128 v18, v[40:43]
    ds_write_b128 v19, v[44:47]
    ds_write_b128 v20, v[48:51]
    ds_write_b128 v21, v[52:55]
    ds_write_b128 v22, v[56:59]
    ds_write_b128 v23, v[60:63]
    s_waitcnt lgkmcnt(0)
    s_barrier
    s_lshr_b32 s24, s3, 1
    s_cmp_eq_u32 s24, 1
    s_cbranch_scc0 interleave_layers__linear_attn_block__memory_aug_recurrent_mem_tr__prompt_kernel_wo20
    ds_read_b64_tr_b16 a[248:249], v72 offset:0
    ds_read_b64_tr_b16 a[250:251], v72 offset:1312
    ds_read_b64_tr_b16 a[252:253], v72 offset:20992
    ds_read_b64_tr_b16 a[254:255], v72 offset:22304
    ds_read_b64_tr_b16 v[120:121], v72 offset:32
    ds_read_b64_tr_b16 v[122:123], v72 offset:1344
    ds_read_b64_tr_b16 v[124:125], v72 offset:21024
    ds_read_b64_tr_b16 v[126:127], v72 offset:22336
    ds_read_b64_tr_b16 v[144:145], v72 offset:64
    ds_read_b64_tr_b16 v[146:147], v72 offset:1376
    ds_read_b64_tr_b16 v[148:149], v72 offset:21056
    ds_read_b64_tr_b16 v[150:151], v72 offset:22368
    ds_read_b64_tr_b16 v[168:169], v72 offset:96
    ds_read_b64_tr_b16 v[170:171], v72 offset:1408
    ds_read_b64_tr_b16 v[172:173], v72 offset:21088
    ds_read_b64_tr_b16 v[174:175], v72 offset:22400
    ds_read_b64_tr_b16 v[192:193], v72 offset:128
    ds_read_b64_tr_b16 v[194:195], v72 offset:1440
    ds_read_b64_tr_b16 v[196:197], v72 offset:21120
    ds_read_b64_tr_b16 v[198:199], v72 offset:22432
    ds_read_b64_tr_b16 v[216:217], v72 offset:160
    ds_read_b64_tr_b16 v[218:219], v72 offset:1472
    ds_read_b64_tr_b16 v[220:221], v72 offset:21152
    ds_read_b64_tr_b16 v[222:223], v72 offset:22464
    ds_read_b64_tr_b16 v[240:241], v72 offset:192
    ds_read_b64_tr_b16 v[242:243], v72 offset:1504
    ds_read_b64_tr_b16 v[244:245], v72 offset:21184
    ds_read_b64_tr_b16 v[246:247], v72 offset:22496
    ds_read_b64_tr_b16 v[64:65], v72 offset:224
    ds_read_b64_tr_b16 v[66:67], v72 offset:1536
    ds_read_b64_tr_b16 v[68:69], v72 offset:21216
    ds_read_b64_tr_b16 v[70:71], v72 offset:22528
    s_waitcnt lgkmcnt(0)
    ds_write_b128 v73, v[64:67] offset:2048
    ds_write_b128 v73, v[68:71] offset:3072
    s_waitcnt lgkmcnt(0)
    ds_read_b64_tr_b16 v[64:65], v72 offset:256
    ds_read_b64_tr_b16 v[66:67], v72 offset:1568
    ds_read_b64_tr_b16 v[68:69], v72 offset:21248
    ds_read_b64_tr_b16 v[70:71], v72 offset:22560
    s_waitcnt lgkmcnt(0)
    ds_write_b128 v73, v[64:67] offset:8192
    ds_write_b128 v73, v[68:71] offset:9216
    s_waitcnt lgkmcnt(0)
    ds_read_b64_tr_b16 v[64:65], v72 offset:288
    ds_read_b64_tr_b16 v[66:67], v72 offset:1600
    ds_read_b64_tr_b16 v[68:69], v72 offset:21280
    ds_read_b64_tr_b16 v[70:71], v72 offset:22592
    s_waitcnt lgkmcnt(0)
    ds_write_b128 v73, v[64:67] offset:14336
    ds_write_b128 v73, v[68:71] offset:15360
    s_waitcnt lgkmcnt(0)
    s_waitcnt lgkmcnt(0)
interleave_layers__linear_attn_block__memory_aug_recurrent_mem_tr__prompt_kernel_wo20:
    s_barrier
    s_add_u32 s46, s45, 163840
    buffer_load_dwordx4 v[24:27], v4, s[16:19], s46 offen
    buffer_load_dwordx4 v[28:31], v5, s[16:19], s46 offen
    buffer_load_dwordx4 v[32:35], v6, s[16:19], s46 offen
    buffer_load_dwordx4 v[36:39], v7, s[16:19], s46 offen
    buffer_load_dwordx4 v[40:43], v8, s[16:19], s46 offen
    buffer_load_dwordx4 v[44:47], v9, s[16:19], s46 offen
    buffer_load_dwordx4 v[48:51], v10, s[16:19], s46 offen
    buffer_load_dwordx4 v[52:55], v11, s[16:19], s46 offen
    buffer_load_dwordx4 v[56:59], v12, s[16:19], s46 offen
    buffer_load_dwordx4 v[60:63], v13, s[16:19], s46 offen
    s_waitcnt vmcnt(0)
    ds_write_b128 v14, v[24:27]
    ds_write_b128 v15, v[28:31]
    ds_write_b128 v16, v[32:35]
    ds_write_b128 v17, v[36:39]
    ds_write_b128 v18, v[40:43]
    ds_write_b128 v19, v[44:47]
    ds_write_b128 v20, v[48:51]
    ds_write_b128 v21, v[52:55]
    ds_write_b128 v22, v[56:59]
    ds_write_b128 v23, v[60:63]
    s_waitcnt lgkmcnt(0)
    s_barrier
    s_lshr_b32 s24, s3, 1
    s_cmp_eq_u32 s24, 0
    s_cbranch_scc0 interleave_layers__linear_attn_block__memory_aug_recurrent_mem_tr__prompt_kernel_wo21
    ds_read_b64_tr_b16 v[104:105], v72 offset:0
    ds_read_b64_tr_b16 v[106:107], v72 offset:1312
    ds_read_b64_tr_b16 v[108:109], v72 offset:20992
    ds_read_b64_tr_b16 v[110:111], v72 offset:22304
    ds_read_b64_tr_b16 v[128:129], v72 offset:32
    ds_read_b64_tr_b16 v[130:131], v72 offset:1344
    ds_read_b64_tr_b16 v[132:133], v72 offset:21024
    ds_read_b64_tr_b16 v[134:135], v72 offset:22336
    ds_read_b64_tr_b16 v[152:153], v72 offset:64
    ds_read_b64_tr_b16 v[154:155], v72 offset:1376
    ds_read_b64_tr_b16 v[156:157], v72 offset:21056
    ds_read_b64_tr_b16 v[158:159], v72 offset:22368
    ds_read_b64_tr_b16 v[176:177], v72 offset:96
    ds_read_b64_tr_b16 v[178:179], v72 offset:1408
    ds_read_b64_tr_b16 v[180:181], v72 offset:21088
    ds_read_b64_tr_b16 v[182:183], v72 offset:22400
    ds_read_b64_tr_b16 v[200:201], v72 offset:128
    ds_read_b64_tr_b16 v[202:203], v72 offset:1440
    ds_read_b64_tr_b16 v[204:205], v72 offset:21120
    ds_read_b64_tr_b16 v[206:207], v72 offset:22432
    ds_read_b64_tr_b16 v[224:225], v72 offset:160
    ds_read_b64_tr_b16 v[226:227], v72 offset:1472
    ds_read_b64_tr_b16 v[228:229], v72 offset:21152
    ds_read_b64_tr_b16 v[230:231], v72 offset:22464
    ds_read_b64_tr_b16 v[248:249], v72 offset:192
    ds_read_b64_tr_b16 v[250:251], v72 offset:1504
    ds_read_b64_tr_b16 v[252:253], v72 offset:21184
    ds_read_b64_tr_b16 v[254:255], v72 offset:22496
    ds_read_b64_tr_b16 v[64:65], v72 offset:224
    ds_read_b64_tr_b16 v[66:67], v72 offset:1536
    ds_read_b64_tr_b16 v[68:69], v72 offset:21216
    ds_read_b64_tr_b16 v[70:71], v72 offset:22528
    s_waitcnt lgkmcnt(0)
    ds_write_b128 v73, v[64:67] offset:4096
    ds_write_b128 v73, v[68:71] offset:5120
    s_waitcnt lgkmcnt(0)
    ds_read_b64_tr_b16 v[64:65], v72 offset:256
    ds_read_b64_tr_b16 v[66:67], v72 offset:1568
    ds_read_b64_tr_b16 v[68:69], v72 offset:21248
    ds_read_b64_tr_b16 v[70:71], v72 offset:22560
    s_waitcnt lgkmcnt(0)
    ds_write_b128 v73, v[64:67] offset:10240
    ds_write_b128 v73, v[68:71] offset:11264
    s_waitcnt lgkmcnt(0)
    ds_read_b64_tr_b16 v[64:65], v72 offset:288
    ds_read_b64_tr_b16 v[66:67], v72 offset:1600
    ds_read_b64_tr_b16 v[68:69], v72 offset:21280
    ds_read_b64_tr_b16 v[70:71], v72 offset:22592
    s_waitcnt lgkmcnt(0)
    ds_write_b128 v73, v[64:67] offset:16384
    ds_write_b128 v73, v[68:71] offset:17408
    s_waitcnt lgkmcnt(0)
    s_waitcnt lgkmcnt(0)
interleave_layers__linear_attn_block__memory_aug_recurrent_mem_tr__prompt_kernel_wo21:
    s_barrier
    s_add_u32 s46, s45, 164480
    buffer_load_dwordx4 v[24:27], v4, s[16:19], s46 offen
    buffer_load_dwordx4 v[28:31], v5, s[16:19], s46 offen
    buffer_load_dwordx4 v[32:35], v6, s[16:19], s46 offen
    buffer_load_dwordx4 v[36:39], v7, s[16:19], s46 offen
    buffer_load_dwordx4 v[40:43], v8, s[16:19], s46 offen
    buffer_load_dwordx4 v[44:47], v9, s[16:19], s46 offen
    buffer_load_dwordx4 v[48:51], v10, s[16:19], s46 offen
    buffer_load_dwordx4 v[52:55], v11, s[16:19], s46 offen
    buffer_load_dwordx4 v[56:59], v12, s[16:19], s46 offen
    buffer_load_dwordx4 v[60:63], v13, s[16:19], s46 offen
    s_waitcnt vmcnt(0)
    ds_write_b128 v14, v[24:27]
    ds_write_b128 v15, v[28:31]
    ds_write_b128 v16, v[32:35]
    ds_write_b128 v17, v[36:39]
    ds_write_b128 v18, v[40:43]
    ds_write_b128 v19, v[44:47]
    ds_write_b128 v20, v[48:51]
    ds_write_b128 v21, v[52:55]
    ds_write_b128 v22, v[56:59]
    ds_write_b128 v23, v[60:63]
    s_waitcnt lgkmcnt(0)
    s_barrier
    s_lshr_b32 s24, s3, 1
    s_cmp_eq_u32 s24, 1
    s_cbranch_scc0 interleave_layers__linear_attn_block__memory_aug_recurrent_mem_tr__prompt_kernel_wo22
    ds_read_b64_tr_b16 v[104:105], v72 offset:0
    ds_read_b64_tr_b16 v[106:107], v72 offset:1312
    ds_read_b64_tr_b16 v[108:109], v72 offset:20992
    ds_read_b64_tr_b16 v[110:111], v72 offset:22304
    ds_read_b64_tr_b16 v[128:129], v72 offset:32
    ds_read_b64_tr_b16 v[130:131], v72 offset:1344
    ds_read_b64_tr_b16 v[132:133], v72 offset:21024
    ds_read_b64_tr_b16 v[134:135], v72 offset:22336
    ds_read_b64_tr_b16 v[152:153], v72 offset:64
    ds_read_b64_tr_b16 v[154:155], v72 offset:1376
    ds_read_b64_tr_b16 v[156:157], v72 offset:21056
    ds_read_b64_tr_b16 v[158:159], v72 offset:22368
    ds_read_b64_tr_b16 v[176:177], v72 offset:96
    ds_read_b64_tr_b16 v[178:179], v72 offset:1408
    ds_read_b64_tr_b16 v[180:181], v72 offset:21088
    ds_read_b64_tr_b16 v[182:183], v72 offset:22400
    ds_read_b64_tr_b16 v[200:201], v72 offset:128
    ds_read_b64_tr_b16 v[202:203], v72 offset:1440
    ds_read_b64_tr_b16 v[204:205], v72 offset:21120
    ds_read_b64_tr_b16 v[206:207], v72 offset:22432
    ds_read_b64_tr_b16 v[224:225], v72 offset:160
    ds_read_b64_tr_b16 v[226:227], v72 offset:1472
    ds_read_b64_tr_b16 v[228:229], v72 offset:21152
    ds_read_b64_tr_b16 v[230:231], v72 offset:22464
    ds_read_b64_tr_b16 v[248:249], v72 offset:192
    ds_read_b64_tr_b16 v[250:251], v72 offset:1504
    ds_read_b64_tr_b16 v[252:253], v72 offset:21184
    ds_read_b64_tr_b16 v[254:255], v72 offset:22496
    ds_read_b64_tr_b16 v[64:65], v72 offset:224
    ds_read_b64_tr_b16 v[66:67], v72 offset:1536
    ds_read_b64_tr_b16 v[68:69], v72 offset:21216
    ds_read_b64_tr_b16 v[70:71], v72 offset:22528
    s_waitcnt lgkmcnt(0)
    ds_write_b128 v73, v[64:67] offset:4096
    ds_write_b128 v73, v[68:71] offset:5120
    s_waitcnt lgkmcnt(0)
    ds_read_b64_tr_b16 v[64:65], v72 offset:256
    ds_read_b64_tr_b16 v[66:67], v72 offset:1568
    ds_read_b64_tr_b16 v[68:69], v72 offset:21248
    ds_read_b64_tr_b16 v[70:71], v72 offset:22560
    s_waitcnt lgkmcnt(0)
    ds_write_b128 v73, v[64:67] offset:10240
    ds_write_b128 v73, v[68:71] offset:11264
    s_waitcnt lgkmcnt(0)
    ds_read_b64_tr_b16 v[64:65], v72 offset:288
    ds_read_b64_tr_b16 v[66:67], v72 offset:1600
    ds_read_b64_tr_b16 v[68:69], v72 offset:21280
    ds_read_b64_tr_b16 v[70:71], v72 offset:22592
    s_waitcnt lgkmcnt(0)
    ds_write_b128 v73, v[64:67] offset:16384
    ds_write_b128 v73, v[68:71] offset:17408
    s_waitcnt lgkmcnt(0)
    s_waitcnt lgkmcnt(0)
interleave_layers__linear_attn_block__memory_aug_recurrent_mem_tr__prompt_kernel_wo22:
    s_barrier
    v_mov_b32 v6, v73
    v_mov_b32 v4, 0x4444
    v_mov_b32 v5, 0xeeee
    v_cmp_gt_u32 vcc, 8, v2
    s_nop 1
    v_cndmask_b32 v4, v5, v4, vcc
    v_lshlrev_b32 v5, 4, v1
    s_lshl_b32 s24, s3, 10
    v_add_u32 v7, s24, v5
    s_lshl_b32 s24, s3, 9
    s_add_u32 s24, s24, 8192
    v_lshlrev_b32 v8, 3, v1
    v_add_u32 v8, s24, v8
    v_and_b32 v64, 7, v2
    v_lshlrev_b32 v9, 5, v64
    v_lshrrev_b32 v64, 3, v2
    v_lshl_add_u32 v9, v64, 4, v9
    v_and_b32 v64, 1, v3
    v_lshl_add_u32 v9, v64, 3, v9
    s_mul_i32 s24, s3, 768
    s_add_u32 s24, s24, 10240
    v_add_u32 v9, s24, v9
    v_lshrrev_b32 v65, 1, v3
    v_lshl_add_u32 v10, v65, 8, v9
    v_lshrrev_b32 v64, 2, v2
    v_lshlrev_b32 v11, 5, v64
    v_and_b32 v64, 3, v2
    v_lshl_add_u32 v11, v64, 3, v11
    v_lshl_add_u32 v11, v3, 8, v11
    v_add_u32 v11, 10240, v11
    s_mul_i32 s24, s3, 10
    s_lshl_b32 s24, s24, 13
    s_lshl_b32 s25, s44, 8
    s_add_u32 s24, s24, s25
    v_lshlrev_b32 v14, 13, v3
    v_lshl_add_u32 v14, v2, 4, v14
    v_add_u32 v14, s24, v14
    v_lshrrev_b32 v64, 1, v3
    v_lshlrev_b32 v15, 13, v64
    v_lshl_add_u32 v15, v2, 4, v15
    v_add_u32 v15, s24, v15
    v_add_u32 v15, 65536, v15
    v_and_b32 v64, 1, v3
    v_cmp_eq_u32 vcc, 0, v64
    v_mov_b32 v64, 2146435072
    s_nop 0
    v_cndmask_b32 v15, v64, v15, vcc
    s_and_b32 s24, s2, 15
    s_mul_i32 s25, s3, 16
    s_add_u32 s24, s24, s25
    s_lshl_b32 s24, s24, 7
    v_mov_b32 v12, s24
    v_mov_b32 v0, 1
interleave_layers__linear_attn_block__memory_aug_recurrent_mem_tr__prompt_kernel_v_layer:
    s_mul_i32 s93, s92, 29360128
    s_add_u32 s93, s93, 117440512
    s_mul_i32 s94, s92, 16384
    s_add_u32 s94, s94, 23068672
    s_lshl_b32 s24, s3, 6
    s_add_u32 s24, s24, 0
    v_add_u32 v64, s24, v1
    v_and_b32 v65, 7, v64
    v_mul_u32_u24 v65, 1280, v65
    v_lshrrev_b32 v66, 3, v64
    v_lshl_add_u32 v65, v66, 4, v65
    v_cmp_gt_u32 vcc, 640, v64
    v_mov_b32 v67, 2146435072
    s_nop 0
    v_cndmask_b32 v65, v67, v65, vcc
    buffer_load_dwordx4 v[68:71], v65, s[20:23], 0 offen
    v_lshlrev_b32 v64, 4, v64
    s_waitcnt vmcnt(0)
    s_and_saveexec_b64 s[30:31], vcc
    ds_write_b128 v64, v[68:71]
    s_mov_b64 exec, s[30:31]
    s_lshl_b32 s24, s3, 6
    s_add_u32 s24, s24, 256
    v_add_u32 v64, s24, v1
    v_and_b32 v65, 7, v64
    v_mul_u32_u24 v65, 1280, v65
    v_lshrrev_b32 v66, 3, v64
    v_lshl_add_u32 v65, v66, 4, v65
    v_cmp_gt_u32 vcc, 640, v64
    v_mov_b32 v67, 2146435072
    s_nop 0
    v_cndmask_b32 v65, v67, v65, vcc
    buffer_load_dwordx4 v[68:71], v65, s[20:23], 0 offen
    v_lshlrev_b32 v64, 4, v64
    s_waitcnt vmcnt(0)
    s_and_saveexec_b64 s[30:31], vcc
    ds_write_b128 v64, v[68:71]
    s_mov_b64 exec, s[30:31]
    s_lshl_b32 s24, s3, 6
    s_add_u32 s24, s24, 512
    v_add_u32 v64, s24, v1
    v_and_b32 v65, 7, v64
    v_mul_u32_u24 v65, 1280, v65
    v_lshrrev_b32 v66, 3, v64
    v_lshl_add_u32 v65, v66, 4, v65
    v_cmp_gt_u32 vcc, 640, v64
    v_mov_b32 v67, 2146435072
    s_nop 0
    v_cndmask_b32 v65, v67, v65, vcc
    buffer_load_dwordx4 v[68:71], v65, s[20:23], 0 offen
    v_lshlrev_b32 v64, 4, v64
    s_waitcnt vmcnt(0)
    s_and_saveexec_b64 s[30:31], vcc
    ds_write_b128 v64, v[68:71]
    s_mov_b64 exec, s[30:31]
    s_mov_b32 s40, 0
    s_add_u32 s43, s93, 0
    s_add_u32 s47, s93, -28672
    s_add_u32 s45, s93, -18432
    s_lshl_b32 s95, s92, 6
    s_add_u32 s95, s95, s40
    s_add_u32 s95, s95, 1
    s_cmp_ge_i32 s59, s95
    s_cbranch_scc1 interleave_layers__linear_attn_block__memory_aug_recurrent_mem_tr__prompt_kernel_v_ec0_ok
    s_and_b32 s24, s2, 7
    s_lshl_b32 s24, s24, 7
    s_add_u32 s24, s24, 23109632
    v_and_b32 v65, 3, v1
    v_lshl_add_u32 v65, v65, 2, s24
    s_mov_b32 s61, 0
interleave_layers__linear_attn_block__memory_aug_recurrent_mem_tr__prompt_kernel_v_ec0:
    buffer_load_dword v64, v65, s[8:11], 0 offen sc1
    s_waitcnt vmcnt(0)
    v_readlane_b32 s59, v64, 0
    v_readlane_b32 s24, v64, 1
    s_min_i32 s59, s59, s24
    v_readlane_b32 s24, v64, 2
    s_min_i32 s59, s59, s24
    s_cmp_ge_i32 s59, s95
    s_cbranch_scc1 interleave_layers__linear_attn_block__memory_aug_recurrent_mem_tr__prompt_kernel_v_ec0_ok
    s_add_u32 s61, s61, 1
    s_cmp_ge_u32 s61, s60
    s_cbranch_scc1 interleave_layers__linear_attn_block__memory_aug_recurrent_mem_tr__prompt_kernel_v_ec0_to
    s_sleep 2
    s_branch interleave_layers__linear_attn_block__memory_aug_recurrent_mem_tr__prompt_kernel_v_ec0
interleave_layers__linear_attn_block__memory_aug_recurrent_mem_tr__prompt_kernel_v_ec0_to:
    s_mov_b32 s60, 1
interleave_layers__linear_attn_block__memory_aug_recurrent_mem_tr__prompt_kernel_v_ec0_ok:
    v_mov_b32 v16, 0
    v_mov_b32 v17, 0
    v_mov_b32 v18, 0
    v_mov_b32 v19, 0
    v_mov_b32 v20, 0
    v_mov_b32 v21, 0
    v_mov_b32 v22, 0
    v_mov_b32 v23, 0
    v_mov_b32 v24, 0
    v_mov_b32 v25, 0
    v_mov_b32 v26, 0
    v_mov_b32 v27, 0
    v_mov_b32 v28, 0
    v_mov_b32 v29, 0
    v_mov_b32 v30, 0
    v_mov_b32 v31, 0
    v_mov_b32 v32, 0
    v_mov_b32 v33, 0
    v_mov_b32 v34, 0
    v_mov_b32 v35, 0
    v_mov_b32 v36, 0
    v_mov_b32 v37, 0
    v_mov_b32 v38, 0
    v_mov_b32 v39, 0
    v_mov_b32 v40, 0
    v_mov_b32 v41, 0
    v_mov_b32 v42, 0
    v_mov_b32 v43, 0
    v_mov_b32 v44, 0
    v_mov_b32 v45, 0
    v_mov_b32 v46, 0
    v_mov_b32 v47, 0
    v_mov_b32 v48, 0
    v_mov_b32 v49, 0
    v_mov_b32 v50, 0
    v_mov_b32 v51, 0
    v_mov_b32 v52, 0
    v_mov_b32 v53, 0
    v_mov_b32 v54, 0
    v_mov_b32 v55, 0
    v_mov_b32 v56, 0
    v_mov_b32 v57, 0
    v_mov_b32 v58, 0
    v_mov_b32 v59, 0
    v_mov_b32 v60, 0
    v_mov_b32 v61, 0
    v_mov_b32 v62, 0
    v_mov_b32 v63, 0
    v_mov_b32 v64, 0
    v_mov_b32 v65, 0
    v_mov_b32 v66, 0
    v_mov_b32 v67, 0
    s_waitcnt lgkmcnt(0)
    s_barrier
    ds_read_b128 v[68:71], v7
    ds_read_b128 v[72:75], v7 offset:4096
    s_waitcnt lgkmcnt(0)
    s_cmp_eq_u32 s3, 0
    s_cbranch_scc1 interleave_layers__linear_attn_block__memory_aug_recurrent_mem_tr__prompt_kernel_v_gow0
    s_cmp_eq_u32 s3, 1
    s_cbranch_scc1 interleave_layers__linear_attn_block__memory_aug_recurrent_mem_tr__prompt_kernel_v_gow1
    s_cmp_eq_u32 s3, 2
    s_cbranch_scc1 interleave_layers__linear_attn_block__memory_aug_recurrent_mem_tr__prompt_kernel_v_gow2
    s_branch interleave_layers__linear_attn_block__memory_aug_recurrent_mem_tr__prompt_kernel_v_gow3
interleave_layers__linear_attn_block__memory_aug_recurrent_mem_tr__prompt_kernel_v_stepw0:
    v_mov_b32 v16, 0
    v_mov_b32 v17, 0
    v_mov_b32 v18, 0
    v_mov_b32 v19, 0
    v_mov_b32 v20, 0
    v_mov_b32 v21, 0
    v_mov_b32 v22, 0
    v_mov_b32 v23, 0
    v_mov_b32 v24, 0
    v_mov_b32 v25, 0
    v_mov_b32 v26, 0
    v_mov_b32 v27, 0
    v_mov_b32 v28, 0
    v_mov_b32 v29, 0
    v_mov_b32 v30, 0
    v_mov_b32 v31, 0
    v_mov_b32 v32, 0
    v_mov_b32 v33, 0
    v_mov_b32 v34, 0
    v_mov_b32 v35, 0
    v_mov_b32 v36, 0
    v_mov_b32 v37, 0
    v_mov_b32 v38, 0
    v_mov_b32 v39, 0
    v_mov_b32 v40, 0
    v_mov_b32 v41, 0
    v_mov_b32 v42, 0
    v_mov_b32 v43, 0
    v_mov_b32 v44, 0
    v_mov_b32 v45, 0
    v_mov_b32 v46, 0
    v_mov_b32 v47, 0
    v_mov_b32 v48, 0
    v_mov_b32 v49, 0
    v_mov_b32 v50, 0
    v_mov_b32 v51, 0
    v_mov_b32 v52, 0
    v_mov_b32 v53, 0
    v_mov_b32 v54, 0
    v_mov_b32 v55, 0
    v_mov_b32 v56, 0
    v_mov_b32 v57, 0
    v_mov_b32 v58, 0
    v_mov_b32 v59, 0
    v_mov_b32 v60, 0
    v_mov_b32 v61, 0
    v_mov_b32 v62, 0
    v_mov_b32 v63, 0
    v_mov_b32 v64, 0
    v_mov_b32 v65, 0
    v_mov_b32 v66, 0
    v_mov_b32 v67, 0
    s_add_u32 s48, s47, 4096
    s_lshl_b32 s95, s92, 6
    s_add_u32 s95, s95, s40
    s_add_u32 s95, s95, 1
    s_cmp_ge_i32 s59, s95
    s_cbranch_scc1 interleave_layers__linear_attn_block__memory_aug_recurrent_mem_tr__prompt_kernel_v_ecw0_ok
    s_and_b32 s24, s2, 7
    s_lshl_b32 s24, s24, 7
    s_add_u32 s24, s24, 23109632
    v_and_b32 v79, 3, v1
    v_lshl_add_u32 v79, v79, 2, s24
    s_mov_b32 s61, 0
interleave_layers__linear_attn_block__memory_aug_recurrent_mem_tr__prompt_kernel_v_ecw0:
    buffer_load_dword v78, v79, s[8:11], 0 offen sc1
    s_waitcnt vmcnt(0)
    v_readlane_b32 s59, v78, 0
    v_readlane_b32 s24, v78, 1
    s_min_i32 s59, s59, s24
    v_readlane_b32 s24, v78, 2
    s_min_i32 s59, s59, s24
    s_cmp_ge_i32 s59, s95
    s_cbranch_scc1 interleave_layers__linear_attn_block__memory_aug_recurrent_mem_tr__prompt_kernel_v_ecw0_ok
    s_add_u32 s61, s61, 1
    s_cmp_ge_u32 s61, s60
    s_cbranch_scc1 interleave_layers__linear_attn_block__memory_aug_recurrent_mem_tr__prompt_kernel_v_ecw0_to
    s_sleep 2
    s_branch interleave_layers__linear_attn_block__memory_aug_recurrent_mem_tr__prompt_kernel_v_ecw0
interleave_layers__linear_attn_block__memory_aug_recurrent_mem_tr__prompt_kernel_v_ecw0_to:
    s_mov_b32 s60, 1
interleave_layers__linear_attn_block__memory_aug_recurrent_mem_tr__prompt_kernel_v_ecw0_ok:
    s_sleep 20
    s_mov_b64 exec, 1
    s_mov_b32 s61, 0
    v_mov_b32 v81, 0
    buffer_atomic_add v81, v12, s[8:11], s45 offen sc0
    s_sleep 3
    v_mov_b32 v82, 0
    buffer_atomic_add v82, v12, s[8:11], s45 offen sc0
    s_sleep 3
    v_mov_b32 v83, 0
    buffer_atomic_add v83, v12, s[8:11], s45 offen sc0
    s_sleep 3
interleave_layers__linear_attn_block__memory_aug_recurrent_mem_tr__prompt_kernel_v_prw0:
    v_mov_b32 v80, 0
    buffer_atomic_add v80, v12, s[8:11], s45 offen sc0
    s_waitcnt vmcnt(3)
    v_cmp_le_i32 vcc, 8, v81
    s_add_u32 s61, s61, 1
    s_cbranch_vccnz interleave_layers__linear_attn_block__memory_aug_recurrent_mem_tr__prompt_kernel_v_prw0_out
    s_sleep 3
    v_mov_b32 v81, 0
    buffer_atomic_add v81, v12, s[8:11], s45 offen sc0
    s_waitcnt vmcnt(3)
    v_cmp_le_i32 vcc, 8, v82
    s_add_u32 s61, s61, 1
    s_cbranch_vccnz interleave_layers__linear_attn_block__memory_aug_recurrent_mem_tr__prompt_kernel_v_prw0_out
    s_sleep 3
    v_mov_b32 v82, 0
    buffer_atomic_add v82, v12, s[8:11], s45 offen sc0
    s_waitcnt vmcnt(3)
    v_cmp_le_i32 vcc, 8, v83
    s_add_u32 s61, s61, 1
    s_cbranch_vccnz interleave_layers__linear_attn_block__memory_aug_recurrent_mem_tr__prompt_kernel_v_prw0_out
    s_sleep 3
    v_mov_b32 v83, 0
    buffer_atomic_add v83, v12, s[8:11], s45 offen sc0
    s_waitcnt vmcnt(3)
    v_cmp_le_i32 vcc, 8, v80
    s_add_u32 s61, s61, 1
    s_cbranch_vccnz interleave_layers__linear_attn_block__memory_aug_recurrent_mem_tr__prompt_kernel_v_prw0_out
    s_sleep 3
    s_cmp_ge_u32 s61, s60
    s_cbranch_scc0 interleave_layers__linear_attn_block__memory_aug_recurrent_mem_tr__prompt_kernel_v_prw0
    s_mov_b32 s60, 1
interleave_layers__linear_attn_block__memory_aug_recurrent_mem_tr__prompt_kernel_v_prw0_out:
    s_mov_b64 exec, -1
    buffer_load_dwordx4 v[68:71], v7, s[8:11], s47 offen sc1
    buffer_load_dwordx4 v[72:75], v7, s[8:11], s48 offen sc1
    buffer_load_dwordx2 v[76:77], v8, s[8:11], s47 offen sc1
    s_waitcnt vmcnt(0)
    v_max3_u32 v103, v68, v69, v70
    v_max3_u32 v103, v103, v71, v72
    v_max3_u32 v103, v103, v73, v74
    v_max3_u32 v103, v103, v75, v76
    v_max_u32 v103, v103, v77
    v_cmp_eq_u32 vcc, -1, v103
    s_cbranch_vccz interleave_layers__linear_attn_block__memory_aug_recurrent_mem_tr__prompt_kernel_v_pmw0_out
    s_mov_b32 s61, 0
interleave_layers__linear_attn_block__memory_aug_recurrent_mem_tr__prompt_kernel_v_pmw0:
    buffer_load_dwordx4 v[68:71], v7, s[8:11], s47 offen sc1
    buffer_load_dwordx4 v[72:75], v7, s[8:11], s48 offen sc1
    buffer_load_dwordx2 v[76:77], v8, s[8:11], s47 offen sc1
    s_waitcnt vmcnt(0)
    v_max3_u32 v103, v68, v69, v70
    v_max3_u32 v103, v103, v71, v72
    v_max3_u32 v103, v103, v73, v74
    v_max3_u32 v103, v103, v75, v76
    v_max_u32 v103, v103, v77
    v_cmp_eq_u32 vcc, -1, v103
    s_add_u32 s61, s61, 1
    s_cbranch_vccz interleave_layers__linear_attn_block__memory_aug_recurrent_mem_tr__prompt_kernel_v_pmw0_out
    s_cmp_ge_u32 s61, s60
    s_cbranch_scc1 interleave_layers__linear_attn_block__memory_aug_recurrent_mem_tr__prompt_kernel_v_pmw0_to
    s_sleep 1
    s_branch interleave_layers__linear_attn_block__memory_aug_recurrent_mem_tr__prompt_kernel_v_pmw0
interleave_layers__linear_attn_block__memory_aug_recurrent_mem_tr__prompt_kernel_v_pmw0_to:
    s_mov_b32 s60, 1
interleave_layers__linear_attn_block__memory_aug_recurrent_mem_tr__prompt_kernel_v_pmw0_out:
    ds_write_b128 v7, v[68:71]
    ds_write_b128 v7, v[72:75] offset:4096
    ds_write_b64 v8, v[76:77]
interleave_layers__linear_attn_block__memory_aug_recurrent_mem_tr__prompt_kernel_v_gow0:
    v_smfmac_f32_16x16x64_bf16 v[56:59], v[68:71], a[0:7], v4
    v_smfmac_f32_16x16x64_bf16 v[60:63], v[68:71], a[80:87], v4
    v_smfmac_f32_16x16x64_bf16 v[64:67], v[68:71], a[160:167], v4
    s_waitcnt lgkmcnt(0)
    s_barrier
    ds_read_b128 v[80:83], v5 offset:1024
    ds_read_b128 v[84:87], v5 offset:2048
    ds_read_b128 v[88:91], v5 offset:3072
    ds_read_b128 v[92:95], v5 offset:5120
    ds_read_b128 v[96:99], v5 offset:6144
    ds_read_b128 v[100:103], v5 offset:7168
    ds_read_b128 v[76:79], v5 offset:8192
    ds_read_b128 v[68:71], v5 offset:9216
    v_smfmac_f32_16x16x64_bf16 v[64:67], v[72:75], a[192:199], v4
    v_smfmac_f32_16x16x64_bf16 v[56:59], v[72:75], a[32:39], v4
    v_smfmac_f32_16x16x64_bf16 v[60:63], v[72:75], a[112:119], v4
    s_waitcnt lgkmcnt(7)
    v_smfmac_f32_16x16x64_bf16 v[64:67], v[80:83], a[168:175], v4
    s_waitcnt lgkmcnt(6)
    v_smfmac_f32_16x16x64_bf16 v[64:67], v[84:87], a[176:183], v4
    s_waitcnt lgkmcnt(5)
    v_smfmac_f32_16x16x64_bf16 v[64:67], v[88:91], a[184:191], v4
    s_waitcnt lgkmcnt(4)
    v_smfmac_f32_16x16x64_bf16 v[64:67], v[92:95], a[200:207], v4
    s_waitcnt lgkmcnt(3)
    v_smfmac_f32_16x16x64_bf16 v[64:67], v[96:99], a[208:215], v4
    s_waitcnt lgkmcnt(2)
    v_smfmac_f32_16x16x64_bf16 v[64:67], v[100:103], a[216:223], v4
    s_waitcnt lgkmcnt(1)
    v_smfmac_f32_16x16x64_bf16 v[64:67], v[76:79], a[224:231], v4
    s_waitcnt lgkmcnt(0)
    v_smfmac_f32_16x16x64_bf16 v[64:67], v[68:71], a[232:239], v4
    v_smfmac_f32_16x16x64_bf16 v[56:59], v[80:83], a[8:15], v4
    v_smfmac_f32_16x16x64_bf16 v[60:63], v[80:83], a[88:95], v4
    v_smfmac_f32_16x16x64_bf16 v[56:59], v[84:87], a[16:23], v4
    s_nop 4
    v_mov_b32 v72, v64
    v_smfmac_f32_16x16x64_bf16 v[60:63], v[84:87], a[96:103], v4
    v_mov_b32 v73, v65
    v_mov_b32 v74, v66
    v_smfmac_f32_16x16x64_bf16 v[56:59], v[88:91], a[24:31], v4
    v_mov_b32 v75, v67
    v_smfmac_f32_16x16x64_bf16 v[60:63], v[88:91], a[104:111], v4
    v_permlane32_swap_b32 v64, v72
    v_permlane32_swap_b32 v65, v73
    v_smfmac_f32_16x16x64_bf16 v[56:59], v[92:95], a[40:47], v4
    v_permlane32_swap_b32 v66, v74
    v_permlane32_swap_b32 v67, v75
    v_smfmac_f32_16x16x64_bf16 v[60:63], v[92:95], a[120:127], v4
    v_add_f32 v64, v64, v72
    v_add_f32 v65, v65, v73
    v_smfmac_f32_16x16x64_bf16 v[56:59], v[96:99], a[48:55], v4
    v_add_f32 v66, v66, v74
    v_add_f32 v67, v67, v75
    v_smfmac_f32_16x16x64_bf16 v[60:63], v[96:99], a[128:135], v4
    v_cvt_pk_bf16_f32 v72, v64, v65
    v_cvt_pk_bf16_f32 v73, v66, v67
    v_smfmac_f32_16x16x64_bf16 v[56:59], v[100:103], a[56:63], v4
    ds_write_b64 v9, v[72:73] offset:512
    v_smfmac_f32_16x16x64_bf16 v[60:63], v[100:103], a[136:143], v4
    v_smfmac_f32_16x16x64_bf16 v[56:59], v[76:79], a[64:71], v4
    v_smfmac_f32_16x16x64_bf16 v[60:63], v[76:79], a[144:151], v4
    v_smfmac_f32_16x16x64_bf16 v[56:59], v[68:71], a[72:79], v4
    v_smfmac_f32_16x16x64_bf16 v[60:63], v[68:71], a[152:159], v4
    s_nop 7
    v_permlane32_swap_b32 v56, v60
    v_permlane32_swap_b32 v57, v61
    v_permlane32_swap_b32 v58, v62
    v_permlane32_swap_b32 v59, v63
    v_add_f32 v56, v56, v60
    v_add_f32 v57, v57, v61
    v_add_f32 v58, v58, v62
    v_add_f32 v59, v59, v63
    v_cvt_pk_bf16_f32 v68, v56, v57
    v_cvt_pk_bf16_f32 v69, v58, v59
    ds_write_b64 v10, v[68:69]
    s_waitcnt lgkmcnt(0)
    s_barrier
    ds_read_b64_tr_b16 v[68:69], v11 offset:0
    ds_read_b64_tr_b16 v[70:71], v11 offset:128
    ds_read_b64_tr_b16 v[72:73], v11 offset:1024
    ds_read_b64_tr_b16 v[74:75], v11 offset:1152
    ds_read_b64_tr_b16 v[76:77], v11 offset:2048
    ds_read_b64_tr_b16 v[78:79], v11 offset:2176
    ds_read_b128 v[80:83], v6 offset:0
    ds_read_b128 v[84:87], v6 offset:1024
    ds_read_b128 v[88:91], v6 offset:2048
    ds_read_b128 v[92:95], v6 offset:3072
    ds_read_b128 v[96:99], v6 offset:4096
    ds_read_b128 v[100:103], v6 offset:5120
    s_waitcnt lgkmcnt(10)
    v_smfmac_f32_16x16x64_bf16 v[16:19], v[68:71], a[240:247], v4
    v_smfmac_f32_16x16x64_bf16 v[20:23], v[68:71], v[112:119], v4
    v_smfmac_f32_16x16x64_bf16 v[24:27], v[68:71], v[136:143], v4
    v_smfmac_f32_16x16x64_bf16 v[28:31], v[68:71], v[160:167], v4
    s_waitcnt lgkmcnt(8)
    v_smfmac_f32_16x16x64_bf16 v[16:19], v[72:75], a[248:255], v4
    v_smfmac_f32_16x16x64_bf16 v[20:23], v[72:75], v[120:127], v4
    v_smfmac_f32_16x16x64_bf16 v[24:27], v[72:75], v[144:151], v4
    v_smfmac_f32_16x16x64_bf16 v[28:31], v[72:75], v[168:175], v4
    s_waitcnt lgkmcnt(6)
    v_smfmac_f32_16x16x64_bf16 v[16:19], v[76:79], v[104:111], v4
    v_smfmac_f32_16x16x64_bf16 v[20:23], v[76:79], v[128:135], v4
    v_smfmac_f32_16x16x64_bf16 v[24:27], v[76:79], v[152:159], v4
    v_smfmac_f32_16x16x64_bf16 v[28:31], v[76:79], v[176:183], v4
    v_smfmac_f32_16x16x64_bf16 v[32:35], v[68:71], v[184:191], v4
    v_smfmac_f32_16x16x64_bf16 v[36:39], v[68:71], v[208:215], v4
    s_nop 4
    v_permlane32_swap_b32 v16, v24
    v_permlane32_swap_b32 v17, v25
    v_smfmac_f32_16x16x64_bf16 v[40:43], v[68:71], v[232:239], v4
    v_permlane32_swap_b32 v18, v26
    v_permlane32_swap_b32 v19, v27
    s_waitcnt lgkmcnt(4)
    v_smfmac_f32_16x16x64_bf16 v[44:47], v[68:71], v[80:87], v4
    v_add_f32 v16, v16, v24
    v_add_f32 v17, v17, v25
    ds_read_b128 v[80:83], v6 offset:6144
    ds_read_b128 v[84:87], v6 offset:7168
    v_smfmac_f32_16x16x64_bf16 v[32:35], v[72:75], v[192:199], v4
    v_add_f32 v18, v18, v26
    v_add_f32 v19, v19, v27
    v_smfmac_f32_16x16x64_bf16 v[36:39], v[72:75], v[216:223], v4
    v_permlane32_swap_b32 v20, v28
    v_permlane32_swap_b32 v21, v29
    v_smfmac_f32_16x16x64_bf16 v[40:43], v[72:75], v[240:247], v4
    v_permlane32_swap_b32 v22, v30
    v_permlane32_swap_b32 v23, v31
    s_waitcnt lgkmcnt(4)
    v_smfmac_f32_16x16x64_bf16 v[44:47], v[72:75], v[88:95], v4
    v_add_f32 v20, v20, v28
    v_add_f32 v21, v21, v29
    ds_read_b128 v[88:91], v6 offset:8192
    ds_read_b128 v[92:95], v6 offset:9216
    v_smfmac_f32_16x16x64_bf16 v[32:35], v[76:79], v[200:207], v4
    v_add_f32 v22, v22, v30
    v_add_f32 v23, v23, v31
    v_smfmac_f32_16x16x64_bf16 v[36:39], v[76:79], v[224:231], v4
    v_cvt_pk_bf16_f32 v56, v16, v17
    v_cvt_pk_bf16_f32 v57, v18, v19
    v_smfmac_f32_16x16x64_bf16 v[40:43], v[76:79], v[248:255], v4
    v_cvt_pk_bf16_f32 v58, v20, v21
    v_cvt_pk_bf16_f32 v59, v22, v23
    s_waitcnt lgkmcnt(4)
    v_smfmac_f32_16x16x64_bf16 v[44:47], v[76:79], v[96:103], v4
    v_permlane16_swap_b32 v56, v58
    ds_read_b128 v[96:99], v6 offset:10240
    ds_read_b128 v[100:103], v6 offset:11264
    v_permlane16_swap_b32 v57, v59
    v_min_u32 v56, -2, v56
    v_min_u32 v57, -2, v57
    v_min_u32 v58, -2, v58
    v_min_u32 v59, -2, v59
    buffer_store_dwordx4 v[56:59], v14, s[8:11], s43 offen sc1
    s_add_u32 s49, s43, 32768
    s_waitcnt lgkmcnt(4)
    v_smfmac_f32_16x16x64_bf16 v[48:51], v[68:71], v[80:87], v4
    v_permlane32_swap_b32 v32, v40
    v_permlane32_swap_b32 v33, v41
    v_permlane32_swap_b32 v34, v42
    ds_read_b128 v[80:83], v6 offset:12288
    ds_read_b128 v[84:87], v6 offset:13312
    s_waitcnt lgkmcnt(4)
    v_smfmac_f32_16x16x64_bf16 v[48:51], v[72:75], v[88:95], v4
    v_permlane32_swap_b32 v35, v43
    v_add_f32 v32, v32, v40
    v_add_f32 v33, v33, v41
    v_add_f32 v34, v34, v42
    ds_read_b128 v[88:91], v6 offset:14336
    ds_read_b128 v[92:95], v6 offset:15360
    s_waitcnt lgkmcnt(4)
    v_smfmac_f32_16x16x64_bf16 v[48:51], v[76:79], v[96:103], v4
    v_add_f32 v35, v35, v43
    v_permlane32_swap_b32 v36, v44
    v_permlane32_swap_b32 v37, v45
    v_permlane32_swap_b32 v38, v46
    ds_read_b128 v[96:99], v6 offset:16384
    ds_read_b128 v[100:103], v6 offset:17408
    v_permlane32_swap_b32 v39, v47
    v_add_f32 v36, v36, v44
    v_add_f32 v37, v37, v45
    v_add_f32 v38, v38, v46
    s_waitcnt lgkmcnt(4)
    v_smfmac_f32_16x16x64_bf16 v[52:55], v[68:71], v[80:87], v4
    v_add_f32 v39, v39, v47
    v_cvt_pk_bf16_f32 v60, v32, v33
    v_cvt_pk_bf16_f32 v61, v34, v35
    s_waitcnt lgkmcnt(2)
    v_smfmac_f32_16x16x64_bf16 v[52:55], v[72:75], v[88:95], v4
    v_cvt_pk_bf16_f32 v62, v36, v37
    v_cvt_pk_bf16_f32 v63, v38, v39
    s_waitcnt lgkmcnt(0)
    v_smfmac_f32_16x16x64_bf16 v[52:55], v[76:79], v[96:103], v4
    v_permlane16_swap_b32 v60, v62
    v_permlane16_swap_b32 v61, v63
    v_min_u32 v60, -2, v60
    v_min_u32 v61, -2, v61
    v_min_u32 v62, -2, v62
    v_min_u32 v63, -2, v63
    buffer_store_dwordx4 v[60:63], v14, s[8:11], s49 offen sc1
    s_nop 0
    v_permlane32_swap_b32 v48, v52
    v_permlane32_swap_b32 v49, v53
    v_permlane32_swap_b32 v50, v54
    v_permlane32_swap_b32 v51, v55
    v_add_f32 v48, v48, v52
    v_add_f32 v49, v49, v53
    v_add_f32 v50, v50, v54
    v_add_f32 v51, v51, v55
    v_cvt_pk_bf16_f32 v64, v48, v49
    v_cvt_pk_bf16_f32 v65, v50, v51
    v_mov_b32 v66, v64
    v_mov_b32 v67, v65
    s_nop 0
    v_permlane16_swap_b32 v64, v66
    v_permlane16_swap_b32 v65, v67
    v_min_u32 v64, -2, v64
    v_min_u32 v65, -2, v65
    v_min_u32 v66, -2, v66
    v_min_u32 v67, -2, v67
    buffer_store_dwordx4 v[64:67], v15, s[8:11], s43 offen sc1
    s_add_u32 s40, s40, 1
    s_add_u32 s43, s43, 458752
    s_add_u32 s47, s47, 458752
    s_add_u32 s45, s45, 458752
    s_cmp_lt_u32 s40, 64
    s_cbranch_scc1 interleave_layers__linear_attn_block__memory_aug_recurrent_mem_tr__prompt_kernel_v_stepw0
    s_branch interleave_layers__linear_attn_block__memory_aug_recurrent_mem_tr__prompt_kernel_v_end
interleave_layers__linear_attn_block__memory_aug_recurrent_mem_tr__prompt_kernel_v_stepw1:
    v_mov_b32 v16, 0
    v_mov_b32 v17, 0
    v_mov_b32 v18, 0
    v_mov_b32 v19, 0
    v_mov_b32 v20, 0
    v_mov_b32 v21, 0
    v_mov_b32 v22, 0
    v_mov_b32 v23, 0
    v_mov_b32 v24, 0
    v_mov_b32 v25, 0
    v_mov_b32 v26, 0
    v_mov_b32 v27, 0
    v_mov_b32 v28, 0
    v_mov_b32 v29, 0
    v_mov_b32 v30, 0
    v_mov_b32 v31, 0
    v_mov_b32 v32, 0
    v_mov_b32 v33, 0
    v_mov_b32 v34, 0
    v_mov_b32 v35, 0
    v_mov_b32 v36, 0
    v_mov_b32 v37, 0
    v_mov_b32 v38, 0
    v_mov_b32 v39, 0
    v_mov_b32 v40, 0
    v_mov_b32 v41, 0
    v_mov_b32 v42, 0
    v_mov_b32 v43, 0
    v_mov_b32 v44, 0
    v_mov_b32 v45, 0
    v_mov_b32 v46, 0
    v_mov_b32 v47, 0
    v_mov_b32 v48, 0
    v_mov_b32 v49, 0
    v_mov_b32 v50, 0
    v_mov_b32 v51, 0
    v_mov_b32 v52, 0
    v_mov_b32 v53, 0
    v_mov_b32 v54, 0
    v_mov_b32 v55, 0
    v_mov_b32 v56, 0
    v_mov_b32 v57, 0
    v_mov_b32 v58, 0
    v_mov_b32 v59, 0
    v_mov_b32 v60, 0
    v_mov_b32 v61, 0
    v_mov_b32 v62, 0
    v_mov_b32 v63, 0
    v_mov_b32 v64, 0
    v_mov_b32 v65, 0
    v_mov_b32 v66, 0
    v_mov_b32 v67, 0
    s_add_u32 s48, s47, 4096
    s_lshl_b32 s95, s92, 6
    s_add_u32 s95, s95, s40
    s_add_u32 s95, s95, 1
    s_cmp_ge_i32 s59, s95
    s_cbranch_scc1 interleave_layers__linear_attn_block__memory_aug_recurrent_mem_tr__prompt_kernel_v_ecw1_ok
    s_and_b32 s24, s2, 7
    s_lshl_b32 s24, s24, 7
    s_add_u32 s24, s24, 23109632
    v_and_b32 v79, 3, v1
    v_lshl_add_u32 v79, v79, 2, s24
    s_mov_b32 s61, 0
interleave_layers__linear_attn_block__memory_aug_recurrent_mem_tr__prompt_kernel_v_ecw1:
    buffer_load_dword v78, v79, s[8:11], 0 offen sc1
    s_waitcnt vmcnt(0)
    v_readlane_b32 s59, v78, 0
    v_readlane_b32 s24, v78, 1
    s_min_i32 s59, s59, s24
    v_readlane_b32 s24, v78, 2
    s_min_i32 s59, s59, s24
    s_cmp_ge_i32 s59, s95
    s_cbranch_scc1 interleave_layers__linear_attn_block__memory_aug_recurrent_mem_tr__prompt_kernel_v_ecw1_ok
    s_add_u32 s61, s61, 1
    s_cmp_ge_u32 s61, s60
    s_cbranch_scc1 interleave_layers__linear_attn_block__memory_aug_recurrent_mem_tr__prompt_kernel_v_ecw1_to
    s_sleep 2
    s_branch interleave_layers__linear_attn_block__memory_aug_recurrent_mem_tr__prompt_kernel_v_ecw1
interleave_layers__linear_attn_block__memory_aug_recurrent_mem_tr__prompt_kernel_v_ecw1_to:
    s_mov_b32 s60, 1
interleave_layers__linear_attn_block__memory_aug_recurrent_mem_tr__prompt_kernel_v_ecw1_ok:
    s_sleep 20
    s_mov_b64 exec, 1
    s_mov_b32 s61, 0
    v_mov_b32 v81, 0
    buffer_atomic_add v81, v12, s[8:11], s45 offen sc0
    s_sleep 3
    v_mov_b32 v82, 0
    buffer_atomic_add v82, v12, s[8:11], s45 offen sc0
    s_sleep 3
    v_mov_b32 v83, 0
    buffer_atomic_add v83, v12, s[8:11], s45 offen sc0
    s_sleep 3
interleave_layers__linear_attn_block__memory_aug_recurrent_mem_tr__prompt_kernel_v_prw1:
    v_mov_b32 v80, 0
    buffer_atomic_add v80, v12, s[8:11], s45 offen sc0
    s_waitcnt vmcnt(3)
    v_cmp_le_i32 vcc, 8, v81
    s_add_u32 s61, s61, 1
    s_cbranch_vccnz interleave_layers__linear_attn_block__memory_aug_recurrent_mem_tr__prompt_kernel_v_prw1_out
    s_sleep 3
    v_mov_b32 v81, 0
    buffer_atomic_add v81, v12, s[8:11], s45 offen sc0
    s_waitcnt vmcnt(3)
    v_cmp_le_i32 vcc, 8, v82
    s_add_u32 s61, s61, 1
    s_cbranch_vccnz interleave_layers__linear_attn_block__memory_aug_recurrent_mem_tr__prompt_kernel_v_prw1_out
    s_sleep 3
    v_mov_b32 v82, 0
    buffer_atomic_add v82, v12, s[8:11], s45 offen sc0
    s_waitcnt vmcnt(3)
    v_cmp_le_i32 vcc, 8, v83
    s_add_u32 s61, s61, 1
    s_cbranch_vccnz interleave_layers__linear_attn_block__memory_aug_recurrent_mem_tr__prompt_kernel_v_prw1_out
    s_sleep 3
    v_mov_b32 v83, 0
    buffer_atomic_add v83, v12, s[8:11], s45 offen sc0
    s_waitcnt vmcnt(3)
    v_cmp_le_i32 vcc, 8, v80
    s_add_u32 s61, s61, 1
    s_cbranch_vccnz interleave_layers__linear_attn_block__memory_aug_recurrent_mem_tr__prompt_kernel_v_prw1_out
    s_sleep 3
    s_cmp_ge_u32 s61, s60
    s_cbranch_scc0 interleave_layers__linear_attn_block__memory_aug_recurrent_mem_tr__prompt_kernel_v_prw1
    s_mov_b32 s60, 1
interleave_layers__linear_attn_block__memory_aug_recurrent_mem_tr__prompt_kernel_v_prw1_out:
    s_mov_b64 exec, -1
    buffer_load_dwordx4 v[68:71], v7, s[8:11], s47 offen sc1
    buffer_load_dwordx4 v[72:75], v7, s[8:11], s48 offen sc1
    buffer_load_dwordx2 v[76:77], v8, s[8:11], s47 offen sc1
    s_waitcnt vmcnt(0)
    v_max3_u32 v103, v68, v69, v70
    v_max3_u32 v103, v103, v71, v72
    v_max3_u32 v103, v103, v73, v74
    v_max3_u32 v103, v103, v75, v76
    v_max_u32 v103, v103, v77
    v_cmp_eq_u32 vcc, -1, v103
    s_cbranch_vccz interleave_layers__linear_attn_block__memory_aug_recurrent_mem_tr__prompt_kernel_v_pmw1_out
    s_mov_b32 s61, 0
interleave_layers__linear_attn_block__memory_aug_recurrent_mem_tr__prompt_kernel_v_pmw1:
    buffer_load_dwordx4 v[68:71], v7, s[8:11], s47 offen sc1
    buffer_load_dwordx4 v[72:75], v7, s[8:11], s48 offen sc1
    buffer_load_dwordx2 v[76:77], v8, s[8:11], s47 offen sc1
    s_waitcnt vmcnt(0)
    v_max3_u32 v103, v68, v69, v70
    v_max3_u32 v103, v103, v71, v72
    v_max3_u32 v103, v103, v73, v74
    v_max3_u32 v103, v103, v75, v76
    v_max_u32 v103, v103, v77
    v_cmp_eq_u32 vcc, -1, v103
    s_add_u32 s61, s61, 1
    s_cbranch_vccz interleave_layers__linear_attn_block__memory_aug_recurrent_mem_tr__prompt_kernel_v_pmw1_out
    s_cmp_ge_u32 s61, s60
    s_cbranch_scc1 interleave_layers__linear_attn_block__memory_aug_recurrent_mem_tr__prompt_kernel_v_pmw1_to
    s_sleep 1
    s_branch interleave_layers__linear_attn_block__memory_aug_recurrent_mem_tr__prompt_kernel_v_pmw1
interleave_layers__linear_attn_block__memory_aug_recurrent_mem_tr__prompt_kernel_v_pmw1_to:
    s_mov_b32 s60, 1
interleave_layers__linear_attn_block__memory_aug_recurrent_mem_tr__prompt_kernel_v_pmw1_out:
    ds_write_b128 v7, v[68:71]
    ds_write_b128 v7, v[72:75] offset:4096
    ds_write_b64 v8, v[76:77]
interleave_layers__linear_attn_block__memory_aug_recurrent_mem_tr__prompt_kernel_v_gow1:
    v_smfmac_f32_16x16x64_bf16 v[56:59], v[68:71], a[8:15], v4
    v_smfmac_f32_16x16x64_bf16 v[60:63], v[68:71], a[88:95], v4
    v_smfmac_f32_16x16x64_bf16 v[64:67], v[68:71], a[168:175], v4
    s_waitcnt lgkmcnt(0)
    s_barrier
    ds_read_b128 v[80:83], v5 offset:0
    ds_read_b128 v[84:87], v5 offset:2048
    ds_read_b128 v[88:91], v5 offset:3072
    ds_read_b128 v[92:95], v5 offset:4096
    ds_read_b128 v[96:99], v5 offset:6144
    ds_read_b128 v[100:103], v5 offset:7168
    ds_read_b128 v[76:79], v5 offset:8192
    ds_read_b128 v[68:71], v5 offset:9216
    v_smfmac_f32_16x16x64_bf16 v[64:67], v[72:75], a[200:207], v4
    v_smfmac_f32_16x16x64_bf16 v[56:59], v[72:75], a[40:47], v4
    v_smfmac_f32_16x16x64_bf16 v[60:63], v[72:75], a[120:127], v4
    s_waitcnt lgkmcnt(7)
    v_smfmac_f32_16x16x64_bf16 v[64:67], v[80:83], a[160:167], v4
    s_waitcnt lgkmcnt(6)
    v_smfmac_f32_16x16x64_bf16 v[64:67], v[84:87], a[176:183], v4
    s_waitcnt lgkmcnt(5)
    v_smfmac_f32_16x16x64_bf16 v[64:67], v[88:91], a[184:191], v4
    s_waitcnt lgkmcnt(4)
    v_smfmac_f32_16x16x64_bf16 v[64:67], v[92:95], a[192:199], v4
    s_waitcnt lgkmcnt(3)
    v_smfmac_f32_16x16x64_bf16 v[64:67], v[96:99], a[208:215], v4
    s_waitcnt lgkmcnt(2)
    v_smfmac_f32_16x16x64_bf16 v[64:67], v[100:103], a[216:223], v4
    s_waitcnt lgkmcnt(1)
    v_smfmac_f32_16x16x64_bf16 v[64:67], v[76:79], a[224:231], v4
    s_waitcnt lgkmcnt(0)
    v_smfmac_f32_16x16x64_bf16 v[64:67], v[68:71], a[232:239], v4
    v_smfmac_f32_16x16x64_bf16 v[56:59], v[80:83], a[0:7], v4
    v_smfmac_f32_16x16x64_bf16 v[60:63], v[80:83], a[80:87], v4
    v_smfmac_f32_16x16x64_bf16 v[56:59], v[84:87], a[16:23], v4
    s_nop 4
    v_mov_b32 v72, v64
    v_smfmac_f32_16x16x64_bf16 v[60:63], v[84:87], a[96:103], v4
    v_mov_b32 v73, v65
    v_mov_b32 v74, v66
    v_smfmac_f32_16x16x64_bf16 v[56:59], v[88:91], a[24:31], v4
    v_mov_b32 v75, v67
    v_smfmac_f32_16x16x64_bf16 v[60:63], v[88:91], a[104:111], v4
    v_permlane32_swap_b32 v64, v72
    v_permlane32_swap_b32 v65, v73
    v_smfmac_f32_16x16x64_bf16 v[56:59], v[92:95], a[32:39], v4
    v_permlane32_swap_b32 v66, v74
    v_permlane32_swap_b32 v67, v75
    v_smfmac_f32_16x16x64_bf16 v[60:63], v[92:95], a[112:119], v4
    v_add_f32 v64, v64, v72
    v_add_f32 v65, v65, v73
    v_smfmac_f32_16x16x64_bf16 v[56:59], v[96:99], a[48:55], v4
    v_add_f32 v66, v66, v74
    v_add_f32 v67, v67, v75
    v_smfmac_f32_16x16x64_bf16 v[60:63], v[96:99], a[128:135], v4
    v_cvt_pk_bf16_f32 v72, v64, v65
    v_cvt_pk_bf16_f32 v73, v66, v67
    v_smfmac_f32_16x16x64_bf16 v[56:59], v[100:103], a[56:63], v4
    ds_write_b64 v9, v[72:73] offset:512
    v_smfmac_f32_16x16x64_bf16 v[60:63], v[100:103], a[136:143], v4
    v_smfmac_f32_16x16x64_bf16 v[56:59], v[76:79], a[64:71], v4
    v_smfmac_f32_16x16x64_bf16 v[60:63], v[76:79], a[144:151], v4
    v_smfmac_f32_16x16x64_bf16 v[56:59], v[68:71], a[72:79], v4
    v_smfmac_f32_16x16x64_bf16 v[60:63], v[68:71], a[152:159], v4
    s_nop 7
    v_permlane32_swap_b32 v56, v60
    v_permlane32_swap_b32 v57, v61
    v_permlane32_swap_b32 v58, v62
    v_permlane32_swap_b32 v59, v63
    v_add_f32 v56, v56, v60
    v_add_f32 v57, v57, v61
    v_add_f32 v58, v58, v62
    v_add_f32 v59, v59, v63
    v_cvt_pk_bf16_f32 v68, v56, v57
    v_cvt_pk_bf16_f32 v69, v58, v59
    ds_write_b64 v10, v[68:69]
    s_waitcnt lgkmcnt(0)
    s_barrier
    ds_read_b64_tr_b16 v[68:69], v11 offset:0
    ds_read_b64_tr_b16 v[70:71], v11 offset:128
    ds_read_b64_tr_b16 v[72:73], v11 offset:1024
    ds_read_b64_tr_b16 v[74:75], v11 offset:1152
    ds_read_b64_tr_b16 v[76:77], v11 offset:2048
    ds_read_b64_tr_b16 v[78:79], v11 offset:2176
    ds_read_b128 v[80:83], v6 offset:0
    ds_read_b128 v[84:87], v6 offset:1024
    ds_read_b128 v[88:91], v6 offset:2048
    ds_read_b128 v[92:95], v6 offset:3072
    ds_read_b128 v[96:99], v6 offset:4096
    ds_read_b128 v[100:103], v6 offset:5120
    s_waitcnt lgkmcnt(10)
    v_smfmac_f32_16x16x64_bf16 v[16:19], v[68:71], a[240:247], v4
    v_smfmac_f32_16x16x64_bf16 v[20:23], v[68:71], v[112:119], v4
    v_smfmac_f32_16x16x64_bf16 v[24:27], v[68:71], v[136:143], v4
    v_smfmac_f32_16x16x64_bf16 v[28:31], v[68:71], v[160:167], v4
    s_waitcnt lgkmcnt(8)
    v_smfmac_f32_16x16x64_bf16 v[16:19], v[72:75], a[248:255], v4
    v_smfmac_f32_16x16x64_bf16 v[20:23], v[72:75], v[120:127], v4
    v_smfmac_f32_16x16x64_bf16 v[24:27], v[72:75], v[144:151], v4
    v_smfmac_f32_16x16x64_bf16 v[28:31], v[72:75], v[168:175], v4
    s_waitcnt lgkmcnt(6)
    v_smfmac_f32_16x16x64_bf16 v[16:19], v[76:79], v[104:111], v4
    v_smfmac_f32_16x16x64_bf16 v[20:23], v[76:79], v[128:135], v4
    v_smfmac_f32_16x16x64_bf16 v[24:27], v[76:79], v[152:159], v4
    v_smfmac_f32_16x16x64_bf16 v[28:31], v[76:79], v[176:183], v4
    v_smfmac_f32_16x16x64_bf16 v[32:35], v[68:71], v[184:191], v4
    v_smfmac_f32_16x16x64_bf16 v[36:39], v[68:71], v[208:215], v4
    s_nop 4
    v_permlane32_swap_b32 v16, v24
    v_permlane32_swap_b32 v17, v25
    v_smfmac_f32_16x16x64_bf16 v[40:43], v[68:71], v[232:239], v4
    v_permlane32_swap_b32 v18, v26
    v_permlane32_swap_b32 v19, v27
    s_waitcnt lgkmcnt(4)
    v_smfmac_f32_16x16x64_bf16 v[44:47], v[68:71], v[80:87], v4
    v_add_f32 v16, v16, v24
    v_add_f32 v17, v17, v25
    ds_read_b128 v[80:83], v6 offset:6144
    ds_read_b128 v[84:87], v6 offset:7168
    v_smfmac_f32_16x16x64_bf16 v[32:35], v[72:75], v[192:199], v4
    v_add_f32 v18, v18, v26
    v_add_f32 v19, v19, v27
    v_smfmac_f32_16x16x64_bf16 v[36:39], v[72:75], v[216:223], v4
    v_permlane32_swap_b32 v20, v28
    v_permlane32_swap_b32 v21, v29
    v_smfmac_f32_16x16x64_bf16 v[40:43], v[72:75], v[240:247], v4
    v_permlane32_swap_b32 v22, v30
    v_permlane32_swap_b32 v23, v31
    s_waitcnt lgkmcnt(4)
    v_smfmac_f32_16x16x64_bf16 v[44:47], v[72:75], v[88:95], v4
    v_add_f32 v20, v20, v28
    v_add_f32 v21, v21, v29
    ds_read_b128 v[88:91], v6 offset:8192
    ds_read_b128 v[92:95], v6 offset:9216
    v_smfmac_f32_16x16x64_bf16 v[32:35], v[76:79], v[200:207], v4
    v_add_f32 v22, v22, v30
    v_add_f32 v23, v23, v31
    v_smfmac_f32_16x16x64_bf16 v[36:39], v[76:79], v[224:231], v4
    v_cvt_pk_bf16_f32 v56, v16, v17
    v_cvt_pk_bf16_f32 v57, v18, v19
    v_smfmac_f32_16x16x64_bf16 v[40:43], v[76:79], v[248:255], v4
    v_cvt_pk_bf16_f32 v58, v20, v21
    v_cvt_pk_bf16_f32 v59, v22, v23
    s_waitcnt lgkmcnt(4)
    v_smfmac_f32_16x16x64_bf16 v[44:47], v[76:79], v[96:103], v4
    v_permlane16_swap_b32 v56, v58
    ds_read_b128 v[96:99], v6 offset:10240
    ds_read_b128 v[100:103], v6 offset:11264
    v_permlane16_swap_b32 v57, v59
    v_min_u32 v56, -2, v56
    v_min_u32 v57, -2, v57
    v_min_u32 v58, -2, v58
    v_min_u32 v59, -2, v59
    buffer_store_dwordx4 v[56:59], v14, s[8:11], s43 offen sc1
    s_add_u32 s49, s43, 32768
    s_waitcnt lgkmcnt(4)
    v_smfmac_f32_16x16x64_bf16 v[48:51], v[68:71], v[80:87], v4
    v_permlane32_swap_b32 v32, v40
    v_permlane32_swap_b32 v33, v41
    v_permlane32_swap_b32 v34, v42
    ds_read_b128 v[80:83], v6 offset:12288
    ds_read_b128 v[84:87], v6 offset:13312
    s_waitcnt lgkmcnt(4)
    v_smfmac_f32_16x16x64_bf16 v[48:51], v[72:75], v[88:95], v4
    v_permlane32_swap_b32 v35, v43
    v_add_f32 v32, v32, v40
    v_add_f32 v33, v33, v41
    v_add_f32 v34, v34, v42
    ds_read_b128 v[88:91], v6 offset:14336
    ds_read_b128 v[92:95], v6 offset:15360
    s_waitcnt lgkmcnt(4)
    v_smfmac_f32_16x16x64_bf16 v[48:51], v[76:79], v[96:103], v4
    v_add_f32 v35, v35, v43
    v_permlane32_swap_b32 v36, v44
    v_permlane32_swap_b32 v37, v45
    v_permlane32_swap_b32 v38, v46
    ds_read_b128 v[96:99], v6 offset:16384
    ds_read_b128 v[100:103], v6 offset:17408
    v_permlane32_swap_b32 v39, v47
    v_add_f32 v36, v36, v44
    v_add_f32 v37, v37, v45
    v_add_f32 v38, v38, v46
    s_waitcnt lgkmcnt(4)
    v_smfmac_f32_16x16x64_bf16 v[52:55], v[68:71], v[80:87], v4
    v_add_f32 v39, v39, v47
    v_cvt_pk_bf16_f32 v60, v32, v33
    v_cvt_pk_bf16_f32 v61, v34, v35
    s_waitcnt lgkmcnt(2)
    v_smfmac_f32_16x16x64_bf16 v[52:55], v[72:75], v[88:95], v4
    v_cvt_pk_bf16_f32 v62, v36, v37
    v_cvt_pk_bf16_f32 v63, v38, v39
    s_waitcnt lgkmcnt(0)
    v_smfmac_f32_16x16x64_bf16 v[52:55], v[76:79], v[96:103], v4
    v_permlane16_swap_b32 v60, v62
    v_permlane16_swap_b32 v61, v63
    v_min_u32 v60, -2, v60
    v_min_u32 v61, -2, v61
    v_min_u32 v62, -2, v62
    v_min_u32 v63, -2, v63
    buffer_store_dwordx4 v[60:63], v14, s[8:11], s49 offen sc1
    s_nop 0
    v_permlane32_swap_b32 v48, v52
    v_permlane32_swap_b32 v49, v53
    v_permlane32_swap_b32 v50, v54
    v_permlane32_swap_b32 v51, v55
    v_add_f32 v48, v48, v52
    v_add_f32 v49, v49, v53
    v_add_f32 v50, v50, v54
    v_add_f32 v51, v51, v55
    v_cvt_pk_bf16_f32 v64, v48, v49
    v_cvt_pk_bf16_f32 v65, v50, v51
    v_mov_b32 v66, v64
    v_mov_b32 v67, v65
    s_nop 0
    v_permlane16_swap_b32 v64, v66
    v_permlane16_swap_b32 v65, v67
    v_min_u32 v64, -2, v64
    v_min_u32 v65, -2, v65
    v_min_u32 v66, -2, v66
    v_min_u32 v67, -2, v67
    buffer_store_dwordx4 v[64:67], v15, s[8:11], s43 offen sc1
    s_add_u32 s40, s40, 1
    s_add_u32 s43, s43, 458752
    s_add_u32 s47, s47, 458752
    s_add_u32 s45, s45, 458752
    s_cmp_lt_u32 s40, 64
    s_cbranch_scc1 interleave_layers__linear_attn_block__memory_aug_recurrent_mem_tr__prompt_kernel_v_stepw1
    s_branch interleave_layers__linear_attn_block__memory_aug_recurrent_mem_tr__prompt_kernel_v_end
interleave_layers__linear_attn_block__memory_aug_recurrent_mem_tr__prompt_kernel_v_stepw2:
    v_mov_b32 v16, 0
    v_mov_b32 v17, 0
    v_mov_b32 v18, 0
    v_mov_b32 v19, 0
    v_mov_b32 v20, 0
    v_mov_b32 v21, 0
    v_mov_b32 v22, 0
    v_mov_b32 v23, 0
    v_mov_b32 v24, 0
    v_mov_b32 v25, 0
    v_mov_b32 v26, 0
    v_mov_b32 v27, 0
    v_mov_b32 v28, 0
    v_mov_b32 v29, 0
    v_mov_b32 v30, 0
    v_mov_b32 v31, 0
    v_mov_b32 v32, 0
    v_mov_b32 v33, 0
    v_mov_b32 v34, 0
    v_mov_b32 v35, 0
    v_mov_b32 v36, 0
    v_mov_b32 v37, 0
    v_mov_b32 v38, 0
    v_mov_b32 v39, 0
    v_mov_b32 v40, 0
    v_mov_b32 v41, 0
    v_mov_b32 v42, 0
    v_mov_b32 v43, 0
    v_mov_b32 v44, 0
    v_mov_b32 v45, 0
    v_mov_b32 v46, 0
    v_mov_b32 v47, 0
    v_mov_b32 v48, 0
    v_mov_b32 v49, 0
    v_mov_b32 v50, 0
    v_mov_b32 v51, 0
    v_mov_b32 v52, 0
    v_mov_b32 v53, 0
    v_mov_b32 v54, 0
    v_mov_b32 v55, 0
    v_mov_b32 v56, 0
    v_mov_b32 v57, 0
    v_mov_b32 v58, 0
    v_mov_b32 v59, 0
    v_mov_b32 v60, 0
    v_mov_b32 v61, 0
    v_mov_b32 v62, 0
    v_mov_b32 v63, 0
    v_mov_b32 v64, 0
    v_mov_b32 v65, 0
    v_mov_b32 v66, 0
    v_mov_b32 v67, 0
    s_add_u32 s48, s47, 4096
    s_lshl_b32 s95, s92, 6
    s_add_u32 s95, s95, s40
    s_add_u32 s95, s95, 1
    s_cmp_ge_i32 s59, s95
    s_cbranch_scc1 interleave_layers__linear_attn_block__memory_aug_recurrent_mem_tr__prompt_kernel_v_ecw2_ok
    s_and_b32 s24, s2, 7
    s_lshl_b32 s24, s24, 7
    s_add_u32 s24, s24, 23109632
    v_and_b32 v79, 3, v1
    v_lshl_add_u32 v79, v79, 2, s24
    s_mov_b32 s61, 0
interleave_layers__linear_attn_block__memory_aug_recurrent_mem_tr__prompt_kernel_v_ecw2:
    buffer_load_dword v78, v79, s[8:11], 0 offen sc1
    s_waitcnt vmcnt(0)
    v_readlane_b32 s59, v78, 0
    v_readlane_b32 s24, v78, 1
    s_min_i32 s59, s59, s24
    v_readlane_b32 s24, v78, 2
    s_min_i32 s59, s59, s24
    s_cmp_ge_i32 s59, s95
    s_cbranch_scc1 interleave_layers__linear_attn_block__memory_aug_recurrent_mem_tr__prompt_kernel_v_ecw2_ok
    s_add_u32 s61, s61, 1
    s_cmp_ge_u32 s61, s60
    s_cbranch_scc1 interleave_layers__linear_attn_block__memory_aug_recurrent_mem_tr__prompt_kernel_v_ecw2_to
    s_sleep 2
    s_branch interleave_layers__linear_attn_block__memory_aug_recurrent_mem_tr__prompt_kernel_v_ecw2
interleave_layers__linear_attn_block__memory_aug_recurrent_mem_tr__prompt_kernel_v_ecw2_to:
    s_mov_b32 s60, 1
interleave_layers__linear_attn_block__memory_aug_recurrent_mem_tr__prompt_kernel_v_ecw2_ok:
    s_sleep 20
    s_mov_b64 exec, 1
    s_mov_b32 s61, 0
    v_mov_b32 v81, 0
    buffer_atomic_add v81, v12, s[8:11], s45 offen sc0
    s_sleep 3
    v_mov_b32 v82, 0
    buffer_atomic_add v82, v12, s[8:11], s45 offen sc0
    s_sleep 3
    v_mov_b32 v83, 0
    buffer_atomic_add v83, v12, s[8:11], s45 offen sc0
    s_sleep 3
interleave_layers__linear_attn_block__memory_aug_recurrent_mem_tr__prompt_kernel_v_prw2:
    v_mov_b32 v80, 0
    buffer_atomic_add v80, v12, s[8:11], s45 offen sc0
    s_waitcnt vmcnt(3)
    v_cmp_le_i32 vcc, 8, v81
    s_add_u32 s61, s61, 1
    s_cbranch_vccnz interleave_layers__linear_attn_block__memory_aug_recurrent_mem_tr__prompt_kernel_v_prw2_out
    s_sleep 3
    v_mov_b32 v81, 0
    buffer_atomic_add v81, v12, s[8:11], s45 offen sc0
    s_waitcnt vmcnt(3)
    v_cmp_le_i32 vcc, 8, v82
    s_add_u32 s61, s61, 1
    s_cbranch_vccnz interleave_layers__linear_attn_block__memory_aug_recurrent_mem_tr__prompt_kernel_v_prw2_out
    s_sleep 3
    v_mov_b32 v82, 0
    buffer_atomic_add v82, v12, s[8:11], s45 offen sc0
    s_waitcnt vmcnt(3)
    v_cmp_le_i32 vcc, 8, v83
    s_add_u32 s61, s61, 1
    s_cbranch_vccnz interleave_layers__linear_attn_block__memory_aug_recurrent_mem_tr__prompt_kernel_v_prw2_out
    s_sleep 3
    v_mov_b32 v83, 0
    buffer_atomic_add v83, v12, s[8:11], s45 offen sc0
    s_waitcnt vmcnt(3)
    v_cmp_le_i32 vcc, 8, v80
    s_add_u32 s61, s61, 1
    s_cbranch_vccnz interleave_layers__linear_attn_block__memory_aug_recurrent_mem_tr__prompt_kernel_v_prw2_out
    s_sleep 3
    s_cmp_ge_u32 s61, s60
    s_cbranch_scc0 interleave_layers__linear_attn_block__memory_aug_recurrent_mem_tr__prompt_kernel_v_prw2
    s_mov_b32 s60, 1
interleave_layers__linear_attn_block__memory_aug_recurrent_mem_tr__prompt_kernel_v_prw2_out:
    s_mov_b64 exec, -1
    buffer_load_dwordx4 v[68:71], v7, s[8:11], s47 offen sc1
    buffer_load_dwordx4 v[72:75], v7, s[8:11], s48 offen sc1
    buffer_load_dwordx2 v[76:77], v8, s[8:11], s47 offen sc1
    s_waitcnt vmcnt(0)
    v_max3_u32 v103, v68, v69, v70
    v_max3_u32 v103, v103, v71, v72
    v_max3_u32 v103, v103, v73, v74
    v_max3_u32 v103, v103, v75, v76
    v_max_u32 v103, v103, v77
    v_cmp_eq_u32 vcc, -1, v103
    s_cbranch_vccz interleave_layers__linear_attn_block__memory_aug_recurrent_mem_tr__prompt_kernel_v_pmw2_out
    s_mov_b32 s61, 0
interleave_layers__linear_attn_block__memory_aug_recurrent_mem_tr__prompt_kernel_v_pmw2:
    buffer_load_dwordx4 v[68:71], v7, s[8:11], s47 offen sc1
    buffer_load_dwordx4 v[72:75], v7, s[8:11], s48 offen sc1
    buffer_load_dwordx2 v[76:77], v8, s[8:11], s47 offen sc1
    s_waitcnt vmcnt(0)
    v_max3_u32 v103, v68, v69, v70
    v_max3_u32 v103, v103, v71, v72
    v_max3_u32 v103, v103, v73, v74
    v_max3_u32 v103, v103, v75, v76
    v_max_u32 v103, v103, v77
    v_cmp_eq_u32 vcc, -1, v103
    s_add_u32 s61, s61, 1
    s_cbranch_vccz interleave_layers__linear_attn_block__memory_aug_recurrent_mem_tr__prompt_kernel_v_pmw2_out
    s_cmp_ge_u32 s61, s60
    s_cbranch_scc1 interleave_layers__linear_attn_block__memory_aug_recurrent_mem_tr__prompt_kernel_v_pmw2_to
    s_sleep 1
    s_branch interleave_layers__linear_attn_block__memory_aug_recurrent_mem_tr__prompt_kernel_v_pmw2
interleave_layers__linear_attn_block__memory_aug_recurrent_mem_tr__prompt_kernel_v_pmw2_to:
    s_mov_b32 s60, 1
interleave_layers__linear_attn_block__memory_aug_recurrent_mem_tr__prompt_kernel_v_pmw2_out:
    ds_write_b128 v7, v[68:71]
    ds_write_b128 v7, v[72:75] offset:4096
    ds_write_b64 v8, v[76:77]
interleave_layers__linear_attn_block__memory_aug_recurrent_mem_tr__prompt_kernel_v_gow2:
    v_smfmac_f32_16x16x64_bf16 v[56:59], v[68:71], a[16:23], v4
    v_smfmac_f32_16x16x64_bf16 v[60:63], v[68:71], a[96:103], v4
    v_smfmac_f32_16x16x64_bf16 v[64:67], v[68:71], a[176:183], v4
    s_waitcnt lgkmcnt(0)
    s_barrier
    ds_read_b128 v[80:83], v5 offset:0
    ds_read_b128 v[84:87], v5 offset:1024
    ds_read_b128 v[88:91], v5 offset:3072
    ds_read_b128 v[92:95], v5 offset:4096
    ds_read_b128 v[96:99], v5 offset:5120
    ds_read_b128 v[100:103], v5 offset:7168
    ds_read_b128 v[76:79], v5 offset:8192
    ds_read_b128 v[68:71], v5 offset:9216
    v_smfmac_f32_16x16x64_bf16 v[64:67], v[72:75], a[208:215], v4
    v_smfmac_f32_16x16x64_bf16 v[56:59], v[72:75], a[48:55], v4
    v_smfmac_f32_16x16x64_bf16 v[60:63], v[72:75], a[128:135], v4
    s_waitcnt lgkmcnt(7)
    v_smfmac_f32_16x16x64_bf16 v[64:67], v[80:83], a[160:167], v4
    s_waitcnt lgkmcnt(6)
    v_smfmac_f32_16x16x64_bf16 v[64:67], v[84:87], a[168:175], v4
    s_waitcnt lgkmcnt(5)
    v_smfmac_f32_16x16x64_bf16 v[64:67], v[88:91], a[184:191], v4
    s_waitcnt lgkmcnt(4)
    v_smfmac_f32_16x16x64_bf16 v[64:67], v[92:95], a[192:199], v4
    s_waitcnt lgkmcnt(3)
    v_smfmac_f32_16x16x64_bf16 v[64:67], v[96:99], a[200:207], v4
    s_waitcnt lgkmcnt(2)
    v_smfmac_f32_16x16x64_bf16 v[64:67], v[100:103], a[216:223], v4
    s_waitcnt lgkmcnt(1)
    v_smfmac_f32_16x16x64_bf16 v[64:67], v[76:79], a[224:231], v4
    s_waitcnt lgkmcnt(0)
    v_smfmac_f32_16x16x64_bf16 v[64:67], v[68:71], a[232:239], v4
    v_smfmac_f32_16x16x64_bf16 v[56:59], v[80:83], a[0:7], v4
    v_smfmac_f32_16x16x64_bf16 v[60:63], v[80:83], a[80:87], v4
    v_smfmac_f32_16x16x64_bf16 v[56:59], v[84:87], a[8:15], v4
    s_nop 4
    v_mov_b32 v72, v64
    v_smfmac_f32_16x16x64_bf16 v[60:63], v[84:87], a[88:95], v4
    v_mov_b32 v73, v65
    v_mov_b32 v74, v66
    v_smfmac_f32_16x16x64_bf16 v[56:59], v[88:91], a[24:31], v4
    v_mov_b32 v75, v67
    v_smfmac_f32_16x16x64_bf16 v[60:63], v[88:91], a[104:111], v4
    v_permlane32_swap_b32 v64, v72
    v_permlane32_swap_b32 v65, v73
    v_smfmac_f32_16x16x64_bf16 v[56:59], v[92:95], a[32:39], v4
    v_permlane32_swap_b32 v66, v74
    v_permlane32_swap_b32 v67, v75
    v_smfmac_f32_16x16x64_bf16 v[60:63], v[92:95], a[112:119], v4
    v_add_f32 v64, v64, v72
    v_add_f32 v65, v65, v73
    v_smfmac_f32_16x16x64_bf16 v[56:59], v[96:99], a[40:47], v4
    v_add_f32 v66, v66, v74
    v_add_f32 v67, v67, v75
    v_smfmac_f32_16x16x64_bf16 v[60:63], v[96:99], a[120:127], v4
    v_cvt_pk_bf16_f32 v72, v64, v65
    v_cvt_pk_bf16_f32 v73, v66, v67
    v_smfmac_f32_16x16x64_bf16 v[56:59], v[100:103], a[56:63], v4
    ds_write_b64 v9, v[72:73] offset:512
    v_smfmac_f32_16x16x64_bf16 v[60:63], v[100:103], a[136:143], v4
    v_smfmac_f32_16x16x64_bf16 v[56:59], v[76:79], a[64:71], v4
    v_smfmac_f32_16x16x64_bf16 v[60:63], v[76:79], a[144:151], v4
    v_smfmac_f32_16x16x64_bf16 v[56:59], v[68:71], a[72:79], v4
    v_smfmac_f32_16x16x64_bf16 v[60:63], v[68:71], a[152:159], v4
    s_nop 7
    v_permlane32_swap_b32 v56, v60
    v_permlane32_swap_b32 v57, v61
    v_permlane32_swap_b32 v58, v62
    v_permlane32_swap_b32 v59, v63
    v_add_f32 v56, v56, v60
    v_add_f32 v57, v57, v61
    v_add_f32 v58, v58, v62
    v_add_f32 v59, v59, v63
    v_cvt_pk_bf16_f32 v68, v56, v57
    v_cvt_pk_bf16_f32 v69, v58, v59
    ds_write_b64 v10, v[68:69]
    s_waitcnt lgkmcnt(0)
    s_barrier
    ds_read_b64_tr_b16 v[68:69], v11 offset:0
    ds_read_b64_tr_b16 v[70:71], v11 offset:128
    ds_read_b64_tr_b16 v[72:73], v11 offset:1024
    ds_read_b64_tr_b16 v[74:75], v11 offset:1152
    ds_read_b64_tr_b16 v[76:77], v11 offset:2048
    ds_read_b64_tr_b16 v[78:79], v11 offset:2176
    ds_read_b128 v[80:83], v6 offset:0
    ds_read_b128 v[84:87], v6 offset:1024
    ds_read_b128 v[88:91], v6 offset:2048
    ds_read_b128 v[92:95], v6 offset:3072
    ds_read_b128 v[96:99], v6 offset:4096
    ds_read_b128 v[100:103], v6 offset:5120
    s_waitcnt lgkmcnt(10)
    v_smfmac_f32_16x16x64_bf16 v[16:19], v[68:71], a[240:247], v4
    v_smfmac_f32_16x16x64_bf16 v[20:23], v[68:71], v[112:119], v4
    v_smfmac_f32_16x16x64_bf16 v[24:27], v[68:71], v[136:143], v4
    v_smfmac_f32_16x16x64_bf16 v[28:31], v[68:71], v[160:167], v4
    s_waitcnt lgkmcnt(8)
    v_smfmac_f32_16x16x64_bf16 v[16:19], v[72:75], a[248:255], v4
    v_smfmac_f32_16x16x64_bf16 v[20:23], v[72:75], v[120:127], v4
    v_smfmac_f32_16x16x64_bf16 v[24:27], v[72:75], v[144:151], v4
    v_smfmac_f32_16x16x64_bf16 v[28:31], v[72:75], v[168:175], v4
    s_waitcnt lgkmcnt(6)
    v_smfmac_f32_16x16x64_bf16 v[16:19], v[76:79], v[104:111], v4
    v_smfmac_f32_16x16x64_bf16 v[20:23], v[76:79], v[128:135], v4
    v_smfmac_f32_16x16x64_bf16 v[24:27], v[76:79], v[152:159], v4
    v_smfmac_f32_16x16x64_bf16 v[28:31], v[76:79], v[176:183], v4
    v_smfmac_f32_16x16x64_bf16 v[32:35], v[68:71], v[184:191], v4
    v_smfmac_f32_16x16x64_bf16 v[36:39], v[68:71], v[208:215], v4
    s_nop 4
    v_permlane32_swap_b32 v16, v24
    v_permlane32_swap_b32 v17, v25
    v_smfmac_f32_16x16x64_bf16 v[40:43], v[68:71], v[232:239], v4
    v_permlane32_swap_b32 v18, v26
    v_permlane32_swap_b32 v19, v27
    s_waitcnt lgkmcnt(4)
    v_smfmac_f32_16x16x64_bf16 v[44:47], v[68:71], v[80:87], v4
    v_add_f32 v16, v16, v24
    v_add_f32 v17, v17, v25
    ds_read_b128 v[80:83], v6 offset:6144
    ds_read_b128 v[84:87], v6 offset:7168
    v_smfmac_f32_16x16x64_bf16 v[32:35], v[72:75], v[192:199], v4
    v_add_f32 v18, v18, v26
    v_add_f32 v19, v19, v27
    v_smfmac_f32_16x16x64_bf16 v[36:39], v[72:75], v[216:223], v4
    v_permlane32_swap_b32 v20, v28
    v_permlane32_swap_b32 v21, v29
    v_smfmac_f32_16x16x64_bf16 v[40:43], v[72:75], v[240:247], v4
    v_permlane32_swap_b32 v22, v30
    v_permlane32_swap_b32 v23, v31
    s_waitcnt lgkmcnt(4)
    v_smfmac_f32_16x16x64_bf16 v[44:47], v[72:75], v[88:95], v4
    v_add_f32 v20, v20, v28
    v_add_f32 v21, v21, v29
    ds_read_b128 v[88:91], v6 offset:8192
    ds_read_b128 v[92:95], v6 offset:9216
    v_smfmac_f32_16x16x64_bf16 v[32:35], v[76:79], v[200:207], v4
    v_add_f32 v22, v22, v30
    v_add_f32 v23, v23, v31
    v_smfmac_f32_16x16x64_bf16 v[36:39], v[76:79], v[224:231], v4
    v_cvt_pk_bf16_f32 v56, v16, v17
    v_cvt_pk_bf16_f32 v57, v18, v19
    v_smfmac_f32_16x16x64_bf16 v[40:43], v[76:79], v[248:255], v4
    v_cvt_pk_bf16_f32 v58, v20, v21
    v_cvt_pk_bf16_f32 v59, v22, v23
    s_waitcnt lgkmcnt(4)
    v_smfmac_f32_16x16x64_bf16 v[44:47], v[76:79], v[96:103], v4
    v_permlane16_swap_b32 v56, v58
    ds_read_b128 v[96:99], v6 offset:10240
    ds_read_b128 v[100:103], v6 offset:11264
    v_permlane16_swap_b32 v57, v59
    v_min_u32 v56, -2, v56
    v_min_u32 v57, -2, v57
    v_min_u32 v58, -2, v58
    v_min_u32 v59, -2, v59
    buffer_store_dwordx4 v[56:59], v14, s[8:11], s43 offen sc1
    s_add_u32 s49, s43, 32768
    s_waitcnt lgkmcnt(4)
    v_smfmac_f32_16x16x64_bf16 v[48:51], v[68:71], v[80:87], v4
    v_permlane32_swap_b32 v32, v40
    v_permlane32_swap_b32 v33, v41
    v_permlane32_swap_b32 v34, v42
    ds_read_b128 v[80:83], v6 offset:12288
    ds_read_b128 v[84:87], v6 offset:13312
    s_waitcnt lgkmcnt(4)
    v_smfmac_f32_16x16x64_bf16 v[48:51], v[72:75], v[88:95], v4
    v_permlane32_swap_b32 v35, v43
    v_add_f32 v32, v32, v40
    v_add_f32 v33, v33, v41
    v_add_f32 v34, v34, v42
    ds_read_b128 v[88:91], v6 offset:14336
    ds_read_b128 v[92:95], v6 offset:15360
    s_waitcnt lgkmcnt(4)
    v_smfmac_f32_16x16x64_bf16 v[48:51], v[76:79], v[96:103], v4
    v_add_f32 v35, v35, v43
    v_permlane32_swap_b32 v36, v44
    v_permlane32_swap_b32 v37, v45
    v_permlane32_swap_b32 v38, v46
    ds_read_b128 v[96:99], v6 offset:16384
    ds_read_b128 v[100:103], v6 offset:17408
    v_permlane32_swap_b32 v39, v47
    v_add_f32 v36, v36, v44
    v_add_f32 v37, v37, v45
    v_add_f32 v38, v38, v46
    s_waitcnt lgkmcnt(4)
    v_smfmac_f32_16x16x64_bf16 v[52:55], v[68:71], v[80:87], v4
    v_add_f32 v39, v39, v47
    v_cvt_pk_bf16_f32 v60, v32, v33
    v_cvt_pk_bf16_f32 v61, v34, v35
    s_waitcnt lgkmcnt(2)
    v_smfmac_f32_16x16x64_bf16 v[52:55], v[72:75], v[88:95], v4
    v_cvt_pk_bf16_f32 v62, v36, v37
    v_cvt_pk_bf16_f32 v63, v38, v39
    s_waitcnt lgkmcnt(0)
    v_smfmac_f32_16x16x64_bf16 v[52:55], v[76:79], v[96:103], v4
    v_permlane16_swap_b32 v60, v62
    v_permlane16_swap_b32 v61, v63
    v_min_u32 v60, -2, v60
    v_min_u32 v61, -2, v61
    v_min_u32 v62, -2, v62
    v_min_u32 v63, -2, v63
    buffer_store_dwordx4 v[60:63], v14, s[8:11], s49 offen sc1
    s_nop 0
    v_permlane32_swap_b32 v48, v52
    v_permlane32_swap_b32 v49, v53
    v_permlane32_swap_b32 v50, v54
    v_permlane32_swap_b32 v51, v55
    v_add_f32 v48, v48, v52
    v_add_f32 v49, v49, v53
    v_add_f32 v50, v50, v54
    v_add_f32 v51, v51, v55
    v_cvt_pk_bf16_f32 v64, v48, v49
    v_cvt_pk_bf16_f32 v65, v50, v51
    v_mov_b32 v66, v64
    v_mov_b32 v67, v65
    s_nop 0
    v_permlane16_swap_b32 v64, v66
    v_permlane16_swap_b32 v65, v67
    v_min_u32 v64, -2, v64
    v_min_u32 v65, -2, v65
    v_min_u32 v66, -2, v66
    v_min_u32 v67, -2, v67
    buffer_store_dwordx4 v[64:67], v15, s[8:11], s43 offen sc1
    s_add_u32 s40, s40, 1
    s_add_u32 s43, s43, 458752
    s_add_u32 s47, s47, 458752
    s_add_u32 s45, s45, 458752
    s_cmp_lt_u32 s40, 64
    s_cbranch_scc1 interleave_layers__linear_attn_block__memory_aug_recurrent_mem_tr__prompt_kernel_v_stepw2
    s_branch interleave_layers__linear_attn_block__memory_aug_recurrent_mem_tr__prompt_kernel_v_end
interleave_layers__linear_attn_block__memory_aug_recurrent_mem_tr__prompt_kernel_v_stepw3:
    v_mov_b32 v16, 0
    v_mov_b32 v17, 0
    v_mov_b32 v18, 0
    v_mov_b32 v19, 0
    v_mov_b32 v20, 0
    v_mov_b32 v21, 0
    v_mov_b32 v22, 0
    v_mov_b32 v23, 0
    v_mov_b32 v24, 0
    v_mov_b32 v25, 0
    v_mov_b32 v26, 0
    v_mov_b32 v27, 0
    v_mov_b32 v28, 0
    v_mov_b32 v29, 0
    v_mov_b32 v30, 0
    v_mov_b32 v31, 0
    v_mov_b32 v32, 0
    v_mov_b32 v33, 0
    v_mov_b32 v34, 0
    v_mov_b32 v35, 0
    v_mov_b32 v36, 0
    v_mov_b32 v37, 0
    v_mov_b32 v38, 0
    v_mov_b32 v39, 0
    v_mov_b32 v40, 0
    v_mov_b32 v41, 0
    v_mov_b32 v42, 0
    v_mov_b32 v43, 0
    v_mov_b32 v44, 0
    v_mov_b32 v45, 0
    v_mov_b32 v46, 0
    v_mov_b32 v47, 0
    v_mov_b32 v48, 0
    v_mov_b32 v49, 0
    v_mov_b32 v50, 0
    v_mov_b32 v51, 0
    v_mov_b32 v52, 0
    v_mov_b32 v53, 0
    v_mov_b32 v54, 0
    v_mov_b32 v55, 0
    v_mov_b32 v56, 0
    v_mov_b32 v57, 0
    v_mov_b32 v58, 0
    v_mov_b32 v59, 0
    v_mov_b32 v60, 0
    v_mov_b32 v61, 0
    v_mov_b32 v62, 0
    v_mov_b32 v63, 0
    v_mov_b32 v64, 0
    v_mov_b32 v65, 0
    v_mov_b32 v66, 0
    v_mov_b32 v67, 0
    s_add_u32 s48, s47, 4096
    s_lshl_b32 s95, s92, 6
    s_add_u32 s95, s95, s40
    s_add_u32 s95, s95, 1
    s_cmp_ge_i32 s59, s95
    s_cbranch_scc1 interleave_layers__linear_attn_block__memory_aug_recurrent_mem_tr__prompt_kernel_v_ecw3_ok
    s_and_b32 s24, s2, 7
    s_lshl_b32 s24, s24, 7
    s_add_u32 s24, s24, 23109632
    v_and_b32 v79, 3, v1
    v_lshl_add_u32 v79, v79, 2, s24
    s_mov_b32 s61, 0
interleave_layers__linear_attn_block__memory_aug_recurrent_mem_tr__prompt_kernel_v_ecw3:
    buffer_load_dword v78, v79, s[8:11], 0 offen sc1
    s_waitcnt vmcnt(0)
    v_readlane_b32 s59, v78, 0
    v_readlane_b32 s24, v78, 1
    s_min_i32 s59, s59, s24
    v_readlane_b32 s24, v78, 2
    s_min_i32 s59, s59, s24
    s_cmp_ge_i32 s59, s95
    s_cbranch_scc1 interleave_layers__linear_attn_block__memory_aug_recurrent_mem_tr__prompt_kernel_v_ecw3_ok
    s_add_u32 s61, s61, 1
    s_cmp_ge_u32 s61, s60
    s_cbranch_scc1 interleave_layers__linear_attn_block__memory_aug_recurrent_mem_tr__prompt_kernel_v_ecw3_to
    s_sleep 2
    s_branch interleave_layers__linear_attn_block__memory_aug_recurrent_mem_tr__prompt_kernel_v_ecw3
interleave_layers__linear_attn_block__memory_aug_recurrent_mem_tr__prompt_kernel_v_ecw3_to:
    s_mov_b32 s60, 1
interleave_layers__linear_attn_block__memory_aug_recurrent_mem_tr__prompt_kernel_v_ecw3_ok:
    s_sleep 20
    s_mov_b64 exec, 1
    s_mov_b32 s61, 0
    v_mov_b32 v81, 0
    buffer_atomic_add v81, v12, s[8:11], s45 offen sc0
    s_sleep 3
    v_mov_b32 v82, 0
    buffer_atomic_add v82, v12, s[8:11], s45 offen sc0
    s_sleep 3
    v_mov_b32 v83, 0
    buffer_atomic_add v83, v12, s[8:11], s45 offen sc0
    s_sleep 3
interleave_layers__linear_attn_block__memory_aug_recurrent_mem_tr__prompt_kernel_v_prw3:
    v_mov_b32 v80, 0
    buffer_atomic_add v80, v12, s[8:11], s45 offen sc0
    s_waitcnt vmcnt(3)
    v_cmp_le_i32 vcc, 8, v81
    s_add_u32 s61, s61, 1
    s_cbranch_vccnz interleave_layers__linear_attn_block__memory_aug_recurrent_mem_tr__prompt_kernel_v_prw3_out
    s_sleep 3
    v_mov_b32 v81, 0
    buffer_atomic_add v81, v12, s[8:11], s45 offen sc0
    s_waitcnt vmcnt(3)
    v_cmp_le_i32 vcc, 8, v82
    s_add_u32 s61, s61, 1
    s_cbranch_vccnz interleave_layers__linear_attn_block__memory_aug_recurrent_mem_tr__prompt_kernel_v_prw3_out
    s_sleep 3
    v_mov_b32 v82, 0
    buffer_atomic_add v82, v12, s[8:11], s45 offen sc0
    s_waitcnt vmcnt(3)
    v_cmp_le_i32 vcc, 8, v83
    s_add_u32 s61, s61, 1
    s_cbranch_vccnz interleave_layers__linear_attn_block__memory_aug_recurrent_mem_tr__prompt_kernel_v_prw3_out
    s_sleep 3
    v_mov_b32 v83, 0
    buffer_atomic_add v83, v12, s[8:11], s45 offen sc0
    s_waitcnt vmcnt(3)
    v_cmp_le_i32 vcc, 8, v80
    s_add_u32 s61, s61, 1
    s_cbranch_vccnz interleave_layers__linear_attn_block__memory_aug_recurrent_mem_tr__prompt_kernel_v_prw3_out
    s_sleep 3
    s_cmp_ge_u32 s61, s60
    s_cbranch_scc0 interleave_layers__linear_attn_block__memory_aug_recurrent_mem_tr__prompt_kernel_v_prw3
    s_mov_b32 s60, 1
interleave_layers__linear_attn_block__memory_aug_recurrent_mem_tr__prompt_kernel_v_prw3_out:
    s_mov_b64 exec, -1
    buffer_load_dwordx4 v[68:71], v7, s[8:11], s47 offen sc1
    buffer_load_dwordx4 v[72:75], v7, s[8:11], s48 offen sc1
    buffer_load_dwordx2 v[76:77], v8, s[8:11], s47 offen sc1
    s_waitcnt vmcnt(0)
    v_max3_u32 v103, v68, v69, v70
    v_max3_u32 v103, v103, v71, v72
    v_max3_u32 v103, v103, v73, v74
    v_max3_u32 v103, v103, v75, v76
    v_max_u32 v103, v103, v77
    v_cmp_eq_u32 vcc, -1, v103
    s_cbranch_vccz interleave_layers__linear_attn_block__memory_aug_recurrent_mem_tr__prompt_kernel_v_pmw3_out
    s_mov_b32 s61, 0
interleave_layers__linear_attn_block__memory_aug_recurrent_mem_tr__prompt_kernel_v_pmw3:
    buffer_load_dwordx4 v[68:71], v7, s[8:11], s47 offen sc1
    buffer_load_dwordx4 v[72:75], v7, s[8:11], s48 offen sc1
    buffer_load_dwordx2 v[76:77], v8, s[8:11], s47 offen sc1
    s_waitcnt vmcnt(0)
    v_max3_u32 v103, v68, v69, v70
    v_max3_u32 v103, v103, v71, v72
    v_max3_u32 v103, v103, v73, v74
    v_max3_u32 v103, v103, v75, v76
    v_max_u32 v103, v103, v77
    v_cmp_eq_u32 vcc, -1, v103
    s_add_u32 s61, s61, 1
    s_cbranch_vccz interleave_layers__linear_attn_block__memory_aug_recurrent_mem_tr__prompt_kernel_v_pmw3_out
    s_cmp_ge_u32 s61, s60
    s_cbranch_scc1 interleave_layers__linear_attn_block__memory_aug_recurrent_mem_tr__prompt_kernel_v_pmw3_to
    s_sleep 1
    s_branch interleave_layers__linear_attn_block__memory_aug_recurrent_mem_tr__prompt_kernel_v_pmw3
interleave_layers__linear_attn_block__memory_aug_recurrent_mem_tr__prompt_kernel_v_pmw3_to:
    s_mov_b32 s60, 1
interleave_layers__linear_attn_block__memory_aug_recurrent_mem_tr__prompt_kernel_v_pmw3_out:
    ds_write_b128 v7, v[68:71]
    ds_write_b128 v7, v[72:75] offset:4096
    ds_write_b64 v8, v[76:77]
interleave_layers__linear_attn_block__memory_aug_recurrent_mem_tr__prompt_kernel_v_gow3:
    v_smfmac_f32_16x16x64_bf16 v[56:59], v[68:71], a[24:31], v4
    v_smfmac_f32_16x16x64_bf16 v[60:63], v[68:71], a[104:111], v4
    v_smfmac_f32_16x16x64_bf16 v[64:67], v[68:71], a[184:191], v4
    s_waitcnt lgkmcnt(0)
    s_barrier
    ds_read_b128 v[80:83], v5 offset:0
    ds_read_b128 v[84:87], v5 offset:1024
    ds_read_b128 v[88:91], v5 offset:2048
    ds_read_b128 v[92:95], v5 offset:4096
    ds_read_b128 v[96:99], v5 offset:5120
    ds_read_b128 v[100:103], v5 offset:6144
    ds_read_b128 v[76:79], v5 offset:8192
    ds_read_b128 v[68:71], v5 offset:9216
    v_smfmac_f32_16x16x64_bf16 v[64:67], v[72:75], a[216:223], v4
    v_smfmac_f32_16x16x64_bf16 v[56:59], v[72:75], a[56:63], v4
    v_smfmac_f32_16x16x64_bf16 v[60:63], v[72:75], a[136:143], v4
    s_waitcnt lgkmcnt(7)
    v_smfmac_f32_16x16x64_bf16 v[64:67], v[80:83], a[160:167], v4
    s_waitcnt lgkmcnt(6)
    v_smfmac_f32_16x16x64_bf16 v[64:67], v[84:87], a[168:175], v4
    s_waitcnt lgkmcnt(5)
    v_smfmac_f32_16x16x64_bf16 v[64:67], v[88:91], a[176:183], v4
    s_waitcnt lgkmcnt(4)
    v_smfmac_f32_16x16x64_bf16 v[64:67], v[92:95], a[192:199], v4
    s_waitcnt lgkmcnt(3)
    v_smfmac_f32_16x16x64_bf16 v[64:67], v[96:99], a[200:207], v4
    s_waitcnt lgkmcnt(2)
    v_smfmac_f32_16x16x64_bf16 v[64:67], v[100:103], a[208:215], v4
    s_waitcnt lgkmcnt(1)
    v_smfmac_f32_16x16x64_bf16 v[64:67], v[76:79], a[224:231], v4
    s_waitcnt lgkmcnt(0)
    v_smfmac_f32_16x16x64_bf16 v[64:67], v[68:71], a[232:239], v4
    v_smfmac_f32_16x16x64_bf16 v[56:59], v[80:83], a[0:7], v4
    v_smfmac_f32_16x16x64_bf16 v[60:63], v[80:83], a[80:87], v4
    v_smfmac_f32_16x16x64_bf16 v[56:59], v[84:87], a[8:15], v4
    s_nop 4
    v_mov_b32 v72, v64
    v_smfmac_f32_16x16x64_bf16 v[60:63], v[84:87], a[88:95], v4
    v_mov_b32 v73, v65
    v_mov_b32 v74, v66
    v_smfmac_f32_16x16x64_bf16 v[56:59], v[88:91], a[16:23], v4
    v_mov_b32 v75, v67
    v_smfmac_f32_16x16x64_bf16 v[60:63], v[88:91], a[96:103], v4
    v_permlane32_swap_b32 v64, v72
    v_permlane32_swap_b32 v65, v73
    v_smfmac_f32_16x16x64_bf16 v[56:59], v[92:95], a[32:39], v4
    v_permlane32_swap_b32 v66, v74
    v_permlane32_swap_b32 v67, v75
    v_smfmac_f32_16x16x64_bf16 v[60:63], v[92:95], a[112:119], v4
    v_add_f32 v64, v64, v72
    v_add_f32 v65, v65, v73
    v_smfmac_f32_16x16x64_bf16 v[56:59], v[96:99], a[40:47], v4
    v_add_f32 v66, v66, v74
    v_add_f32 v67, v67, v75
    v_smfmac_f32_16x16x64_bf16 v[60:63], v[96:99], a[120:127], v4
    v_cvt_pk_bf16_f32 v72, v64, v65
    v_cvt_pk_bf16_f32 v73, v66, v67
    v_smfmac_f32_16x16x64_bf16 v[56:59], v[100:103], a[48:55], v4
    ds_write_b64 v9, v[72:73] offset:512
    v_smfmac_f32_16x16x64_bf16 v[60:63], v[100:103], a[128:135], v4
    v_smfmac_f32_16x16x64_bf16 v[56:59], v[76:79], a[64:71], v4
    v_smfmac_f32_16x16x64_bf16 v[60:63], v[76:79], a[144:151], v4
    v_smfmac_f32_16x16x64_bf16 v[56:59], v[68:71], a[72:79], v4
    v_smfmac_f32_16x16x64_bf16 v[60:63], v[68:71], a[152:159], v4
    s_nop 7
    v_permlane32_swap_b32 v56, v60
    v_permlane32_swap_b32 v57, v61
    v_permlane32_swap_b32 v58, v62
    v_permlane32_swap_b32 v59, v63
    v_add_f32 v56, v56, v60
    v_add_f32 v57, v57, v61
    v_add_f32 v58, v58, v62
    v_add_f32 v59, v59, v63
    v_cvt_pk_bf16_f32 v68, v56, v57
    v_cvt_pk_bf16_f32 v69, v58, v59
    ds_write_b64 v10, v[68:69]
    s_waitcnt lgkmcnt(0)
    s_barrier
    ds_read_b64_tr_b16 v[68:69], v11 offset:0
    ds_read_b64_tr_b16 v[70:71], v11 offset:128
    ds_read_b64_tr_b16 v[72:73], v11 offset:1024
    ds_read_b64_tr_b16 v[74:75], v11 offset:1152
    ds_read_b64_tr_b16 v[76:77], v11 offset:2048
    ds_read_b64_tr_b16 v[78:79], v11 offset:2176
    ds_read_b128 v[80:83], v6 offset:0
    ds_read_b128 v[84:87], v6 offset:1024
    ds_read_b128 v[88:91], v6 offset:2048
    ds_read_b128 v[92:95], v6 offset:3072
    ds_read_b128 v[96:99], v6 offset:4096
    ds_read_b128 v[100:103], v6 offset:5120
    s_waitcnt lgkmcnt(10)
    v_smfmac_f32_16x16x64_bf16 v[16:19], v[68:71], a[240:247], v4
    v_smfmac_f32_16x16x64_bf16 v[20:23], v[68:71], v[112:119], v4
    v_smfmac_f32_16x16x64_bf16 v[24:27], v[68:71], v[136:143], v4
    v_smfmac_f32_16x16x64_bf16 v[28:31], v[68:71], v[160:167], v4
    s_waitcnt lgkmcnt(8)
    v_smfmac_f32_16x16x64_bf16 v[16:19], v[72:75], a[248:255], v4
    v_smfmac_f32_16x16x64_bf16 v[20:23], v[72:75], v[120:127], v4
    v_smfmac_f32_16x16x64_bf16 v[24:27], v[72:75], v[144:151], v4
    v_smfmac_f32_16x16x64_bf16 v[28:31], v[72:75], v[168:175], v4
    s_waitcnt lgkmcnt(6)
    v_smfmac_f32_16x16x64_bf16 v[16:19], v[76:79], v[104:111], v4
    v_smfmac_f32_16x16x64_bf16 v[20:23], v[76:79], v[128:135], v4
    v_smfmac_f32_16x16x64_bf16 v[24:27], v[76:79], v[152:159], v4
    v_smfmac_f32_16x16x64_bf16 v[28:31], v[76:79], v[176:183], v4
    v_smfmac_f32_16x16x64_bf16 v[32:35], v[68:71], v[184:191], v4
    v_smfmac_f32_16x16x64_bf16 v[36:39], v[68:71], v[208:215], v4
    s_nop 4
    v_permlane32_swap_b32 v16, v24
    v_permlane32_swap_b32 v17, v25
    v_smfmac_f32_16x16x64_bf16 v[40:43], v[68:71], v[232:239], v4
    v_permlane32_swap_b32 v18, v26
    v_permlane32_swap_b32 v19, v27
    s_waitcnt lgkmcnt(4)
    v_smfmac_f32_16x16x64_bf16 v[44:47], v[68:71], v[80:87], v4
    v_add_f32 v16, v16, v24
    v_add_f32 v17, v17, v25
    ds_read_b128 v[80:83], v6 offset:6144
    ds_read_b128 v[84:87], v6 offset:7168
    v_smfmac_f32_16x16x64_bf16 v[32:35], v[72:75], v[192:199], v4
    v_add_f32 v18, v18, v26
    v_add_f32 v19, v19, v27
    v_smfmac_f32_16x16x64_bf16 v[36:39], v[72:75], v[216:223], v4
    v_permlane32_swap_b32 v20, v28
    v_permlane32_swap_b32 v21, v29
    v_smfmac_f32_16x16x64_bf16 v[40:43], v[72:75], v[240:247], v4
    v_permlane32_swap_b32 v22, v30
    v_permlane32_swap_b32 v23, v31
    s_waitcnt lgkmcnt(4)
    v_smfmac_f32_16x16x64_bf16 v[44:47], v[72:75], v[88:95], v4
    v_add_f32 v20, v20, v28
    v_add_f32 v21, v21, v29
    ds_read_b128 v[88:91], v6 offset:8192
    ds_read_b128 v[92:95], v6 offset:9216
    v_smfmac_f32_16x16x64_bf16 v[32:35], v[76:79], v[200:207], v4
    v_add_f32 v22, v22, v30
    v_add_f32 v23, v23, v31
    v_smfmac_f32_16x16x64_bf16 v[36:39], v[76:79], v[224:231], v4
    v_cvt_pk_bf16_f32 v56, v16, v17
    v_cvt_pk_bf16_f32 v57, v18, v19
    v_smfmac_f32_16x16x64_bf16 v[40:43], v[76:79], v[248:255], v4
    v_cvt_pk_bf16_f32 v58, v20, v21
    v_cvt_pk_bf16_f32 v59, v22, v23
    s_waitcnt lgkmcnt(4)
    v_smfmac_f32_16x16x64_bf16 v[44:47], v[76:79], v[96:103], v4
    v_permlane16_swap_b32 v56, v58
    ds_read_b128 v[96:99], v6 offset:10240
    ds_read_b128 v[100:103], v6 offset:11264
    v_permlane16_swap_b32 v57, v59
    v_min_u32 v56, -2, v56
    v_min_u32 v57, -2, v57
    v_min_u32 v58, -2, v58
    v_min_u32 v59, -2, v59
    buffer_store_dwordx4 v[56:59], v14, s[8:11], s43 offen sc1
    s_add_u32 s49, s43, 32768
    s_waitcnt lgkmcnt(4)
    v_smfmac_f32_16x16x64_bf16 v[48:51], v[68:71], v[80:87], v4
    v_permlane32_swap_b32 v32, v40
    v_permlane32_swap_b32 v33, v41
    v_permlane32_swap_b32 v34, v42
    ds_read_b128 v[80:83], v6 offset:12288
    ds_read_b128 v[84:87], v6 offset:13312
    s_waitcnt lgkmcnt(4)
    v_smfmac_f32_16x16x64_bf16 v[48:51], v[72:75], v[88:95], v4
    v_permlane32_swap_b32 v35, v43
    v_add_f32 v32, v32, v40
    v_add_f32 v33, v33, v41
    v_add_f32 v34, v34, v42
    ds_read_b128 v[88:91], v6 offset:14336
    ds_read_b128 v[92:95], v6 offset:15360
    s_waitcnt lgkmcnt(4)
    v_smfmac_f32_16x16x64_bf16 v[48:51], v[76:79], v[96:103], v4
    v_add_f32 v35, v35, v43
    v_permlane32_swap_b32 v36, v44
    v_permlane32_swap_b32 v37, v45
    v_permlane32_swap_b32 v38, v46
    ds_read_b128 v[96:99], v6 offset:16384
    ds_read_b128 v[100:103], v6 offset:17408
    v_permlane32_swap_b32 v39, v47
    v_add_f32 v36, v36, v44
    v_add_f32 v37, v37, v45
    v_add_f32 v38, v38, v46
    s_waitcnt lgkmcnt(4)
    v_smfmac_f32_16x16x64_bf16 v[52:55], v[68:71], v[80:87], v4
    v_add_f32 v39, v39, v47
    v_cvt_pk_bf16_f32 v60, v32, v33
    v_cvt_pk_bf16_f32 v61, v34, v35
    s_waitcnt lgkmcnt(2)
    v_smfmac_f32_16x16x64_bf16 v[52:55], v[72:75], v[88:95], v4
    v_cvt_pk_bf16_f32 v62, v36, v37
    v_cvt_pk_bf16_f32 v63, v38, v39
    s_waitcnt lgkmcnt(0)
    v_smfmac_f32_16x16x64_bf16 v[52:55], v[76:79], v[96:103], v4
    v_permlane16_swap_b32 v60, v62
    v_permlane16_swap_b32 v61, v63
    v_min_u32 v60, -2, v60
    v_min_u32 v61, -2, v61
    v_min_u32 v62, -2, v62
    v_min_u32 v63, -2, v63
    buffer_store_dwordx4 v[60:63], v14, s[8:11], s49 offen sc1
    s_nop 0
    v_permlane32_swap_b32 v48, v52
    v_permlane32_swap_b32 v49, v53
    v_permlane32_swap_b32 v50, v54
    v_permlane32_swap_b32 v51, v55
    v_add_f32 v48, v48, v52
    v_add_f32 v49, v49, v53
    v_add_f32 v50, v50, v54
    v_add_f32 v51, v51, v55
    v_cvt_pk_bf16_f32 v64, v48, v49
    v_cvt_pk_bf16_f32 v65, v50, v51
    v_mov_b32 v66, v64
    v_mov_b32 v67, v65
    s_nop 0
    v_permlane16_swap_b32 v64, v66
    v_permlane16_swap_b32 v65, v67
    v_min_u32 v64, -2, v64
    v_min_u32 v65, -2, v65
    v_min_u32 v66, -2, v66
    v_min_u32 v67, -2, v67
    buffer_store_dwordx4 v[64:67], v15, s[8:11], s43 offen sc1
    s_add_u32 s40, s40, 1
    s_add_u32 s43, s43, 458752
    s_add_u32 s47, s47, 458752
    s_add_u32 s45, s45, 458752
    s_cmp_lt_u32 s40, 64
    s_cbranch_scc1 interleave_layers__linear_attn_block__memory_aug_recurrent_mem_tr__prompt_kernel_v_stepw3
interleave_layers__linear_attn_block__memory_aug_recurrent_mem_tr__prompt_kernel_v_end:
    s_cmp_eq_u32 s92, 0
    s_cbranch_scc0 interleave_layers__linear_attn_block__memory_aug_recurrent_mem_tr__prompt_kernel_end
    s_mov_b32 s92, 1
    s_branch interleave_layers__linear_attn_block__memory_aug_recurrent_mem_tr__prompt_kernel_v_layer
interleave_layers__linear_attn_block__memory_aug_recurrent_mem_tr__prompt_kernel_roleR:
interleave_layers__linear_attn_block__memory_aug_recurrent_mem_tr__prompt_kernel_r_top:
    s_barrier
    s_sub_u32 s24, s2, 64
    s_cmp_ge_u32 s24, 24
    s_cbranch_scc1 interleave_layers__linear_attn_block__memory_aug_recurrent_mem_tr__prompt_kernel_rk23
    s_and_b32 s44, s24, 7
    s_lshr_b32 s45, s24, 3
    s_cmp_eq_u32 s92, 0
    s_cselect_b32 s46, 32, 2
    v_lshlrev_b32 v5, 4, v1
    s_mov_b32 s64, 12288
    s_cmp_eq_u32 s45, 1
    s_cselect_b32 s64, 5120, s64
    s_cmp_eq_u32 s45, 2
    s_cselect_b32 s64, 17408, s64
    s_mov_b32 s65, 1024
    s_cmp_eq_u32 s45, 1
    s_cselect_b32 s65, 7168, s65
    s_cmp_eq_u32 s45, 2
    s_cselect_b32 s65, 13312, s65
    s_mov_b32 s66, 0
    s_cmp_eq_u32 s45, 1
    s_cselect_b32 s66, 6144, s66
    s_cmp_eq_u32 s45, 2
    s_cselect_b32 s66, 14336, s66
    s_mov_b32 s67, 2048
    s_cmp_eq_u32 s45, 1
    s_cselect_b32 s67, 8192, s67
    s_cmp_eq_u32 s45, 2
    s_cselect_b32 s67, 15360, s67
    s_mov_b32 s68, 4096
    s_cmp_eq_u32 s45, 1
    s_cselect_b32 s68, 10240, s68
    s_cmp_eq_u32 s45, 2
    s_cselect_b32 s68, 16384, s68
    s_mov_b32 s69, 3072
    s_cmp_eq_u32 s45, 1
    s_cselect_b32 s69, 9216, s69
    s_cmp_eq_u32 s45, 2
    s_cselect_b32 s69, 16384, s69
    s_mov_b32 s70, 3072
    s_cmp_eq_u32 s45, 1
    s_cselect_b32 s70, 11264, s70
    s_cmp_eq_u32 s45, 2
    s_cselect_b32 s70, 16384, s70
    s_lshl_b32 s24, s92, 3
    s_add_u32 s24, s24, s44
    s_lshl_b32 s24, s24, 7
    s_add_u32 s24, s24, 23101440
    v_lshlrev_b32 v15, 2, v1
    v_add_u32 v15, s24, v15
    s_cmp_eq_u32 s92, 0
    s_cselect_b32 s26, -1, 3
    s_mov_b32 s61, 0
interleave_layers__linear_attn_block__memory_aug_recurrent_mem_tr__prompt_kernel_k2_w:
    buffer_load_dword v14, v15, s[8:11], 0 offen sc1
    s_waitcnt vmcnt(0)
    v_cmp_le_i32 vcc, 1, v14
    s_and_b32 s24, vcc_lo, s26
    s_cmp_eq_u32 s24, s26
    s_cbranch_scc1 interleave_layers__linear_attn_block__memory_aug_recurrent_mem_tr__prompt_kernel_k2_w_ok
    s_add_u32 s61, s61, 1
    s_cmp_ge_u32 s61, s60
    s_cbranch_scc1 interleave_layers__linear_attn_block__memory_aug_recurrent_mem_tr__prompt_kernel_k2_w_to
    s_sleep 2
    s_branch interleave_layers__linear_attn_block__memory_aug_recurrent_mem_tr__prompt_kernel_k2_w
interleave_layers__linear_attn_block__memory_aug_recurrent_mem_tr__prompt_kernel_k2_w_to:
    s_mov_b32 s60, 1
interleave_layers__linear_attn_block__memory_aug_recurrent_mem_tr__prompt_kernel_k2_w_ok:
    s_add_u32 s25, s3, 0
    s_mul_i32 s24, s25, 147456
    s_mul_i32 s26, s44, 18432
    s_add_u32 s24, s24, s26
    s_add_u32 s24, s24, 16777216
    s_cmp_lt_u32 s25, s46
    s_cselect_b32 s24, s24, 2146435072
    s_add_u32 s26, s24, s64
    buffer_load_dwordx4 v[16:19], v5, s[8:11], s26 offen sc1
    s_add_u32 s26, s24, s65
    buffer_load_dwordx4 v[20:23], v5, s[8:11], s26 offen sc1
    s_add_u32 s26, s24, s66
    buffer_load_dwordx4 v[24:27], v5, s[8:11], s26 offen sc1
    s_add_u32 s26, s24, s67
    buffer_load_dwordx4 v[28:31], v5, s[8:11], s26 offen sc1
    s_add_u32 s26, s24, s68
    buffer_load_dwordx4 v[32:35], v5, s[8:11], s26 offen sc1
    s_add_u32 s26, s24, s69
    buffer_load_dwordx4 v[36:39], v5, s[8:11], s26 offen sc1
    s_add_u32 s26, s24, s70
    buffer_load_dwordx4 v[40:43], v5, s[8:11], s26 offen sc1
    s_add_u32 s25, s3, 4
    s_mul_i32 s24, s25, 147456
    s_mul_i32 s26, s44, 18432
    s_add_u32 s24, s24, s26
    s_add_u32 s24, s24, 16777216
    s_cmp_lt_u32 s25, s46
    s_cselect_b32 s24, s24, 2146435072
    s_add_u32 s26, s24, s64
    buffer_load_dwordx4 v[44:47], v5, s[8:11], s26 offen sc1
    s_add_u32 s26, s24, s65
    buffer_load_dwordx4 v[48:51], v5, s[8:11], s26 offen sc1
    s_add_u32 s26, s24, s66
    buffer_load_dwordx4 v[52:55], v5, s[8:11], s26 offen sc1
    s_add_u32 s26, s24, s67
    buffer_load_dwordx4 v[56:59], v5, s[8:11], s26 offen sc1
    s_add_u32 s26, s24, s68
    buffer_load_dwordx4 v[60:63], v5, s[8:11], s26 offen sc1
    s_add_u32 s26, s24, s69
    buffer_load_dwordx4 v[64:67], v5, s[8:11], s26 offen sc1
    s_add_u32 s26, s24, s70
    buffer_load_dwordx4 v[68:71], v5, s[8:11], s26 offen sc1
    s_add_u32 s25, s3, 8
    s_mul_i32 s24, s25, 147456
    s_mul_i32 s26, s44, 18432
    s_add_u32 s24, s24, s26
    s_add_u32 s24, s24, 16777216
    s_cmp_lt_u32 s25, s46
    s_cselect_b32 s24, s24, 2146435072
    s_add_u32 s26, s24, s64
    buffer_load_dwordx4 v[72:75], v5, s[8:11], s26 offen sc1
    s_add_u32 s26, s24, s65
    buffer_load_dwordx4 v[76:79], v5, s[8:11], s26 offen sc1
    s_add_u32 s26, s24, s66
    buffer_load_dwordx4 v[80:83], v5, s[8:11], s26 offen sc1
    s_add_u32 s26, s24, s67
    buffer_load_dwordx4 v[84:87], v5, s[8:11], s26 offen sc1
    s_add_u32 s26, s24, s68
    buffer_load_dwordx4 v[88:91], v5, s[8:11], s26 offen sc1
    s_add_u32 s26, s24, s69
    buffer_load_dwordx4 v[92:95], v5, s[8:11], s26 offen sc1
    s_add_u32 s26, s24, s70
    buffer_load_dwordx4 v[96:99], v5, s[8:11], s26 offen sc1
    s_add_u32 s25, s3, 12
    s_mul_i32 s24, s25, 147456
    s_mul_i32 s26, s44, 18432
    s_add_u32 s24, s24, s26
    s_add_u32 s24, s24, 16777216
    s_cmp_lt_u32 s25, s46
    s_cselect_b32 s24, s24, 2146435072
    s_add_u32 s26, s24, s64
    buffer_load_dwordx4 v[100:103], v5, s[8:11], s26 offen sc1
    s_add_u32 s26, s24, s65
    buffer_load_dwordx4 v[104:107], v5, s[8:11], s26 offen sc1
    s_add_u32 s26, s24, s66
    buffer_load_dwordx4 v[108:111], v5, s[8:11], s26 offen sc1
    s_add_u32 s26, s24, s67
    buffer_load_dwordx4 v[112:115], v5, s[8:11], s26 offen sc1
    s_add_u32 s26, s24, s68
    buffer_load_dwordx4 v[116:119], v5, s[8:11], s26 offen sc1
    s_add_u32 s26, s24, s69
    buffer_load_dwordx4 v[120:123], v5, s[8:11], s26 offen sc1
    s_add_u32 s26, s24, s70
    buffer_load_dwordx4 v[124:127], v5, s[8:11], s26 offen sc1
    s_add_u32 s25, s3, 16
    s_mul_i32 s24, s25, 147456
    s_mul_i32 s26, s44, 18432
    s_add_u32 s24, s24, s26
    s_add_u32 s24, s24, 16777216
    s_cmp_lt_u32 s25, s46
    s_cselect_b32 s24, s24, 2146435072
    s_add_u32 s26, s24, s64
    buffer_load_dwordx4 v[128:131], v5, s[8:11], s26 offen sc1
    s_add_u32 s26, s24, s65
    buffer_load_dwordx4 v[132:135], v5, s[8:11], s26 offen sc1
    s_add_u32 s26, s24, s66
    buffer_load_dwordx4 v[136:139], v5, s[8:11], s26 offen sc1
    s_add_u32 s26, s24, s67
    buffer_load_dwordx4 v[140:143], v5, s[8:11], s26 offen sc1
    s_add_u32 s26, s24, s68
    buffer_load_dwordx4 v[144:147], v5, s[8:11], s26 offen sc1
    s_add_u32 s26, s24, s69
    buffer_load_dwordx4 v[148:151], v5, s[8:11], s26 offen sc1
    s_add_u32 s26, s24, s70
    buffer_load_dwordx4 v[152:155], v5, s[8:11], s26 offen sc1
    s_add_u32 s25, s3, 20
    s_mul_i32 s24, s25, 147456
    s_mul_i32 s26, s44, 18432
    s_add_u32 s24, s24, s26
    s_add_u32 s24, s24, 16777216
    s_cmp_lt_u32 s25, s46
    s_cselect_b32 s24, s24, 2146435072
    s_add_u32 s26, s24, s64
    buffer_load_dwordx4 v[156:159], v5, s[8:11], s26 offen sc1
    s_add_u32 s26, s24, s65
    buffer_load_dwordx4 v[160:163], v5, s[8:11], s26 offen sc1
    s_add_u32 s26, s24, s66
    buffer_load_dwordx4 v[164:167], v5, s[8:11], s26 offen sc1
    s_add_u32 s26, s24, s67
    buffer_load_dwordx4 v[168:171], v5, s[8:11], s26 offen sc1
    s_add_u32 s26, s24, s68
    buffer_load_dwordx4 v[172:175], v5, s[8:11], s26 offen sc1
    s_add_u32 s26, s24, s69
    buffer_load_dwordx4 v[176:179], v5, s[8:11], s26 offen sc1
    s_add_u32 s26, s24, s70
    buffer_load_dwordx4 v[180:183], v5, s[8:11], s26 offen sc1
    s_add_u32 s25, s3, 24
    s_mul_i32 s24, s25, 147456
    s_mul_i32 s26, s44, 18432
    s_add_u32 s24, s24, s26
    s_add_u32 s24, s24, 16777216
    s_cmp_lt_u32 s25, s46
    s_cselect_b32 s24, s24, 2146435072
    s_add_u32 s26, s24, s64
    buffer_load_dwordx4 v[184:187], v5, s[8:11], s26 offen sc1
    s_add_u32 s26, s24, s65
    buffer_load_dwordx4 v[188:191], v5, s[8:11], s26 offen sc1
    s_add_u32 s26, s24, s66
    buffer_load_dwordx4 v[192:195], v5, s[8:11], s26 offen sc1
    s_add_u32 s26, s24, s67
    buffer_load_dwordx4 v[196:199], v5, s[8:11], s26 offen sc1
    s_add_u32 s26, s24, s68
    buffer_load_dwordx4 v[200:203], v5, s[8:11], s26 offen sc1
    s_add_u32 s26, s24, s69
    buffer_load_dwordx4 v[204:207], v5, s[8:11], s26 offen sc1
    s_add_u32 s26, s24, s70
    buffer_load_dwordx4 v[208:211], v5, s[8:11], s26 offen sc1
    s_add_u32 s25, s3, 28
    s_mul_i32 s24, s25, 147456
    s_mul_i32 s26, s44, 18432
    s_add_u32 s24, s24, s26
    s_add_u32 s24, s24, 16777216
    s_cmp_lt_u32 s25, s46
    s_cselect_b32 s24, s24, 2146435072
    s_add_u32 s26, s24, s64
    buffer_load_dwordx4 v[212:215], v5, s[8:11], s26 offen sc1
    s_add_u32 s26, s24, s65
    buffer_load_dwordx4 v[216:219], v5, s[8:11], s26 offen sc1
    s_add_u32 s26, s24, s66
    buffer_load_dwordx4 v[220:223], v5, s[8:11], s26 offen sc1
    s_add_u32 s26, s24, s67
    buffer_load_dwordx4 v[224:227], v5, s[8:11], s26 offen sc1
    s_add_u32 s26, s24, s68
    buffer_load_dwordx4 v[228:231], v5, s[8:11], s26 offen sc1
    s_add_u32 s26, s24, s69
    buffer_load_dwordx4 v[232:235], v5, s[8:11], s26 offen sc1
    s_add_u32 s26, s24, s70
    buffer_load_dwordx4 v[236:239], v5, s[8:11], s26 offen sc1
    s_waitcnt vmcnt(42)
    v_pk_add_f32 v[16:17], v[16:17], v[44:45]
    v_pk_add_f32 v[18:19], v[18:19], v[46:47]
    v_pk_add_f32 v[20:21], v[20:21], v[48:49]
    v_pk_add_f32 v[22:23], v[22:23], v[50:51]
    v_pk_add_f32 v[24:25], v[24:25], v[52:53]
    v_pk_add_f32 v[26:27], v[26:27], v[54:55]
    v_pk_add_f32 v[28:29], v[28:29], v[56:57]
    v_pk_add_f32 v[30:31], v[30:31], v[58:59]
    v_pk_add_f32 v[32:33], v[32:33], v[60:61]
    v_pk_add_f32 v[34:35], v[34:35], v[62:63]
    v_pk_add_f32 v[36:37], v[36:37], v[64:65]
    v_pk_add_f32 v[38:39], v[38:39], v[66:67]
    v_pk_add_f32 v[40:41], v[40:41], v[68:69]
    v_pk_add_f32 v[42:43], v[42:43], v[70:71]
    s_waitcnt vmcnt(35)
    v_pk_add_f32 v[16:17], v[16:17], v[72:73]
    v_pk_add_f32 v[18:19], v[18:19], v[74:75]
    v_pk_add_f32 v[20:21], v[20:21], v[76:77]
    v_pk_add_f32 v[22:23], v[22:23], v[78:79]
    v_pk_add_f32 v[24:25], v[24:25], v[80:81]
    v_pk_add_f32 v[26:27], v[26:27], v[82:83]
    v_pk_add_f32 v[28:29], v[28:29], v[84:85]
    v_pk_add_f32 v[30:31], v[30:31], v[86:87]
    v_pk_add_f32 v[32:33], v[32:33], v[88:89]
    v_pk_add_f32 v[34:35], v[34:35], v[90:91]
    v_pk_add_f32 v[36:37], v[36:37], v[92:93]
    v_pk_add_f32 v[38:39], v[38:39], v[94:95]
    v_pk_add_f32 v[40:41], v[40:41], v[96:97]
    v_pk_add_f32 v[42:43], v[42:43], v[98:99]
    s_waitcnt vmcnt(28)
    v_pk_add_f32 v[16:17], v[16:17], v[100:101]
    v_pk_add_f32 v[18:19], v[18:19], v[102:103]
    v_pk_add_f32 v[20:21], v[20:21], v[104:105]
    v_pk_add_f32 v[22:23], v[22:23], v[106:107]
    v_pk_add_f32 v[24:25], v[24:25], v[108:109]
    v_pk_add_f32 v[26:27], v[26:27], v[110:111]
    v_pk_add_f32 v[28:29], v[28:29], v[112:113]
    v_pk_add_f32 v[30:31], v[30:31], v[114:115]
    v_pk_add_f32 v[32:33], v[32:33], v[116:117]
    v_pk_add_f32 v[34:35], v[34:35], v[118:119]
    v_pk_add_f32 v[36:37], v[36:37], v[120:121]
    v_pk_add_f32 v[38:39], v[38:39], v[122:123]
    v_pk_add_f32 v[40:41], v[40:41], v[124:125]
    v_pk_add_f32 v[42:43], v[42:43], v[126:127]
    s_waitcnt vmcnt(21)
    v_pk_add_f32 v[16:17], v[16:17], v[128:129]
    v_pk_add_f32 v[18:19], v[18:19], v[130:131]
    v_pk_add_f32 v[20:21], v[20:21], v[132:133]
    v_pk_add_f32 v[22:23], v[22:23], v[134:135]
    v_pk_add_f32 v[24:25], v[24:25], v[136:137]
    v_pk_add_f32 v[26:27], v[26:27], v[138:139]
    v_pk_add_f32 v[28:29], v[28:29], v[140:141]
    v_pk_add_f32 v[30:31], v[30:31], v[142:143]
    v_pk_add_f32 v[32:33], v[32:33], v[144:145]
    v_pk_add_f32 v[34:35], v[34:35], v[146:147]
    v_pk_add_f32 v[36:37], v[36:37], v[148:149]
    v_pk_add_f32 v[38:39], v[38:39], v[150:151]
    v_pk_add_f32 v[40:41], v[40:41], v[152:153]
    v_pk_add_f32 v[42:43], v[42:43], v[154:155]
    s_waitcnt vmcnt(14)
    v_pk_add_f32 v[16:17], v[16:17], v[156:157]
    v_pk_add_f32 v[18:19], v[18:19], v[158:159]
    v_pk_add_f32 v[20:21], v[20:21], v[160:161]
    v_pk_add_f32 v[22:23], v[22:23], v[162:163]
    v_pk_add_f32 v[24:25], v[24:25], v[164:165]
    v_pk_add_f32 v[26:27], v[26:27], v[166:167]
    v_pk_add_f32 v[28:29], v[28:29], v[168:169]
    v_pk_add_f32 v[30:31], v[30:31], v[170:171]
    v_pk_add_f32 v[32:33], v[32:33], v[172:173]
    v_pk_add_f32 v[34:35], v[34:35], v[174:175]
    v_pk_add_f32 v[36:37], v[36:37], v[176:177]
    v_pk_add_f32 v[38:39], v[38:39], v[178:179]
    v_pk_add_f32 v[40:41], v[40:41], v[180:181]
    v_pk_add_f32 v[42:43], v[42:43], v[182:183]
    s_waitcnt vmcnt(7)
    v_pk_add_f32 v[16:17], v[16:17], v[184:185]
    v_pk_add_f32 v[18:19], v[18:19], v[186:187]
    v_pk_add_f32 v[20:21], v[20:21], v[188:189]
    v_pk_add_f32 v[22:23], v[22:23], v[190:191]
    v_pk_add_f32 v[24:25], v[24:25], v[192:193]
    v_pk_add_f32 v[26:27], v[26:27], v[194:195]
    v_pk_add_f32 v[28:29], v[28:29], v[196:197]
    v_pk_add_f32 v[30:31], v[30:31], v[198:199]
    v_pk_add_f32 v[32:33], v[32:33], v[200:201]
    v_pk_add_f32 v[34:35], v[34:35], v[202:203]
    v_pk_add_f32 v[36:37], v[36:37], v[204:205]
    v_pk_add_f32 v[38:39], v[38:39], v[206:207]
    v_pk_add_f32 v[40:41], v[40:41], v[208:209]
    v_pk_add_f32 v[42:43], v[42:43], v[210:211]
    s_waitcnt vmcnt(0)
    v_pk_add_f32 v[16:17], v[16:17], v[212:213]
    v_pk_add_f32 v[18:19], v[18:19], v[214:215]
    v_pk_add_f32 v[20:21], v[20:21], v[216:217]
    v_pk_add_f32 v[22:23], v[22:23], v[218:219]
    v_pk_add_f32 v[24:25], v[24:25], v[220:221]
    v_pk_add_f32 v[26:27], v[26:27], v[222:223]
    v_pk_add_f32 v[28:29], v[28:29], v[224:225]
    v_pk_add_f32 v[30:31], v[30:31], v[226:227]
    v_pk_add_f32 v[32:33], v[32:33], v[228:229]
    v_pk_add_f32 v[34:35], v[34:35], v[230:231]
    v_pk_add_f32 v[36:37], v[36:37], v[232:233]
    v_pk_add_f32 v[38:39], v[38:39], v[234:235]
    v_pk_add_f32 v[40:41], v[40:41], v[236:237]
    v_pk_add_f32 v[42:43], v[42:43], v[238:239]
    s_mul_i32 s24, s3, 7168
    v_add_u32 v6, s24, v5
    ds_write_b128 v6, v[16:19] offset:0
    ds_write_b128 v6, v[20:23] offset:1024
    ds_write_b128 v6, v[24:27] offset:2048
    ds_write_b128 v6, v[28:31] offset:3072
    ds_write_b128 v6, v[32:35] offset:4096
    ds_write_b128 v6, v[36:39] offset:5120
    ds_write_b128 v6, v[40:43] offset:6144
    s_waitcnt lgkmcnt(0)
    s_barrier
    s_mov_b32 s41, 0
    s_cmp_eq_u32 s45, 1
    s_cselect_b32 s41, 4, s41
    s_cmp_eq_u32 s45, 2
    s_cselect_b32 s41, 9, s41
    s_mov_b32 s42, 4
    s_cmp_eq_u32 s45, 1
    s_cselect_b32 s42, 5, s42
    s_cmp_eq_u32 s45, 2
    s_cselect_b32 s42, 5, s42
    s_mul_i32 s43, s92, 131072
    s_mul_i32 s24, s44, 14336
    s_add_u32 s43, s43, s24
    s_add_u32 s43, s43, 22020096
    v_and_b32 v7, 3, v2
    v_lshrrev_b32 v8, 2, v2
    s_add_u32 s40, s3, 0
    s_cmp_lt_u32 s40, s42
    s_cbranch_scc0 interleave_layers__linear_attn_block__memory_aug_recurrent_mem_tr__prompt_kernel_k2f24
    s_add_u32 s40, s40, s41
    s_mov_b32 s47, 67633672
    s_cmp_eq_u32 s40, 1
    s_cselect_b32 s47, 67699226, s47
    s_cmp_eq_u32 s40, 2
    s_cselect_b32 s47, 67702404, s47
    s_cmp_eq_u32 s40, 3
    s_cselect_b32 s47, 67765224, s47
    s_cmp_eq_u32 s40, 4
    s_cselect_b32 s47, 67765896, s47
    s_cmp_eq_u32 s40, 5
    s_cselect_b32 s47, 67831450, s47
    s_cmp_eq_u32 s40, 6
    s_cselect_b32 s47, 67833604, s47
    s_cmp_eq_u32 s40, 7
    s_cselect_b32 s47, 67897320, s47
    s_cmp_eq_u32 s40, 8
    s_cselect_b32 s47, 67899142, s47
    s_cmp_eq_u32 s40, 9
    s_cselect_b32 s47, 75497992, s47
    s_cmp_eq_u32 s40, 10
    s_cselect_b32 s47, 75499162, s47
    s_cmp_eq_u32 s40, 11
    s_cselect_b32 s47, 75501316, s47
    s_cmp_eq_u32 s40, 12
    s_cselect_b32 s47, 247768, s47
    s_cmp_eq_u32 s40, 13
    s_cselect_b32 s47, 249604, s47
    s_bfe_u32 s24, s47, 0x7000c
    s_bfe_u32 s25, s47, 0x50013
    s_bfe_u32 s26, s47, 0x30018
    v_mul_u32_u24 v9, s25, v7
    v_mul_u32_u24 v10, s26, v8
    v_add3_u32 v9, v9, v10, s24
    v_mul_u32_u24 v9, 205, v9
    v_lshrrev_b32 v9, 12, v9
    s_bfe_u32 s24, s47, 196608
    s_lshl_b32 s24, s24, 10
    v_add_u32 v10, s24, v5
    ds_read_b128 v[160:163], v10 offset:0
    ds_read_b128 v[164:167], v10 offset:7168
    ds_read_b128 v[168:171], v10 offset:14336
    ds_read_b128 v[172:175], v10 offset:21504
    s_bfe_u32 s25, s47, 196614
    s_lshl_b32 s25, s25, 4
    v_lshl_add_u32 v11, v3, 2, s25
    v_mul_u32_u24 v11, 205, v11
    v_lshrrev_b32 v11, 12, v11
    v_cmp_eq_u32 vcc, v9, v11
    s_waitcnt lgkmcnt(0)
    v_pk_add_f32 v[160:161], v[160:161], v[164:165]
    v_pk_add_f32 v[168:169], v[168:169], v[172:173]
    v_pk_add_f32 v[162:163], v[162:163], v[166:167]
    v_pk_add_f32 v[170:171], v[170:171], v[174:175]
    v_pk_add_f32 v[160:161], v[160:161], v[168:169]
    v_pk_add_f32 v[162:163], v[162:163], v[170:171]
    v_cvt_pk_bf16_f32 v176, v160, v161
    v_cvt_pk_bf16_f32 v177, v162, v163
    v_cndmask_b32 v176, 0, v176, vcc
    v_cndmask_b32 v177, 0, v177, vcc
    s_bfe_u32 s24, s47, 196611
    s_lshl_b32 s24, s24, 10
    v_add_u32 v10, s24, v5
    ds_read_b128 v[160:163], v10 offset:0
    ds_read_b128 v[164:167], v10 offset:7168
    ds_read_b128 v[168:171], v10 offset:14336
    ds_read_b128 v[172:175], v10 offset:21504
    s_bfe_u32 s25, s47, 196617
    s_lshl_b32 s25, s25, 4
    v_lshl_add_u32 v11, v3, 2, s25
    v_mul_u32_u24 v11, 205, v11
    v_lshrrev_b32 v11, 12, v11
    v_cmp_eq_u32 vcc, v9, v11
    s_waitcnt lgkmcnt(0)
    v_pk_add_f32 v[160:161], v[160:161], v[164:165]
    v_pk_add_f32 v[168:169], v[168:169], v[172:173]
    v_pk_add_f32 v[162:163], v[162:163], v[166:167]
    v_pk_add_f32 v[170:171], v[170:171], v[174:175]
    v_pk_add_f32 v[160:161], v[160:161], v[168:169]
    v_pk_add_f32 v[162:163], v[162:163], v[170:171]
    v_cvt_pk_bf16_f32 v178, v160, v161
    v_cvt_pk_bf16_f32 v179, v162, v163
    v_cndmask_b32 v178, 0, v178, vcc
    v_cndmask_b32 v179, 0, v179, vcc
    s_lshl_b32 s24, s40, 10
    s_add_u32 s24, s24, s43
    buffer_store_dwordx4 v[176:179], v5, s[8:11], s24 offen sc1
interleave_layers__linear_attn_block__memory_aug_recurrent_mem_tr__prompt_kernel_k2f24:
    s_add_u32 s40, s3, 4
    s_cmp_lt_u32 s40, s42
    s_cbranch_scc0 interleave_layers__linear_attn_block__memory_aug_recurrent_mem_tr__prompt_kernel_k2f25
    s_add_u32 s40, s40, s41
    s_mov_b32 s47, 67633672
    s_cmp_eq_u32 s40, 1
    s_cselect_b32 s47, 67699226, s47
    s_cmp_eq_u32 s40, 2
    s_cselect_b32 s47, 67702404, s47
    s_cmp_eq_u32 s40, 3
    s_cselect_b32 s47, 67765224, s47
    s_cmp_eq_u32 s40, 4
    s_cselect_b32 s47, 67765896, s47
    s_cmp_eq_u32 s40, 5
    s_cselect_b32 s47, 67831450, s47
    s_cmp_eq_u32 s40, 6
    s_cselect_b32 s47, 67833604, s47
    s_cmp_eq_u32 s40, 7
    s_cselect_b32 s47, 67897320, s47
    s_cmp_eq_u32 s40, 8
    s_cselect_b32 s47, 67899142, s47
    s_cmp_eq_u32 s40, 9
    s_cselect_b32 s47, 75497992, s47
    s_cmp_eq_u32 s40, 10
    s_cselect_b32 s47, 75499162, s47
    s_cmp_eq_u32 s40, 11
    s_cselect_b32 s47, 75501316, s47
    s_cmp_eq_u32 s40, 12
    s_cselect_b32 s47, 247768, s47
    s_cmp_eq_u32 s40, 13
    s_cselect_b32 s47, 249604, s47
    s_bfe_u32 s24, s47, 0x7000c
    s_bfe_u32 s25, s47, 0x50013
    s_bfe_u32 s26, s47, 0x30018
    v_mul_u32_u24 v9, s25, v7
    v_mul_u32_u24 v10, s26, v8
    v_add3_u32 v9, v9, v10, s24
    v_mul_u32_u24 v9, 205, v9
    v_lshrrev_b32 v9, 12, v9
    s_bfe_u32 s24, s47, 196608
    s_lshl_b32 s24, s24, 10
    v_add_u32 v10, s24, v5
    ds_read_b128 v[160:163], v10 offset:0
    ds_read_b128 v[164:167], v10 offset:7168
    ds_read_b128 v[168:171], v10 offset:14336
    ds_read_b128 v[172:175], v10 offset:21504
    s_bfe_u32 s25, s47, 196614
    s_lshl_b32 s25, s25, 4
    v_lshl_add_u32 v11, v3, 2, s25
    v_mul_u32_u24 v11, 205, v11
    v_lshrrev_b32 v11, 12, v11
    v_cmp_eq_u32 vcc, v9, v11
    s_waitcnt lgkmcnt(0)
    v_pk_add_f32 v[160:161], v[160:161], v[164:165]
    v_pk_add_f32 v[168:169], v[168:169], v[172:173]
    v_pk_add_f32 v[162:163], v[162:163], v[166:167]
    v_pk_add_f32 v[170:171], v[170:171], v[174:175]
    v_pk_add_f32 v[160:161], v[160:161], v[168:169]
    v_pk_add_f32 v[162:163], v[162:163], v[170:171]
    v_cvt_pk_bf16_f32 v176, v160, v161
    v_cvt_pk_bf16_f32 v177, v162, v163
    v_cndmask_b32 v176, 0, v176, vcc
    v_cndmask_b32 v177, 0, v177, vcc
    s_bfe_u32 s24, s47, 196611
    s_lshl_b32 s24, s24, 10
    v_add_u32 v10, s24, v5
    ds_read_b128 v[160:163], v10 offset:0
    ds_read_b128 v[164:167], v10 offset:7168
    ds_read_b128 v[168:171], v10 offset:14336
    ds_read_b128 v[172:175], v10 offset:21504
    s_bfe_u32 s25, s47, 196617
    s_lshl_b32 s25, s25, 4
    v_lshl_add_u32 v11, v3, 2, s25
    v_mul_u32_u24 v11, 205, v11
    v_lshrrev_b32 v11, 12, v11
    v_cmp_eq_u32 vcc, v9, v11
    s_waitcnt lgkmcnt(0)
    v_pk_add_f32 v[160:161], v[160:161], v[164:165]
    v_pk_add_f32 v[168:169], v[168:169], v[172:173]
    v_pk_add_f32 v[162:163], v[162:163], v[166:167]
    v_pk_add_f32 v[170:171], v[170:171], v[174:175]
    v_pk_add_f32 v[160:161], v[160:161], v[168:169]
    v_pk_add_f32 v[162:163], v[162:163], v[170:171]
    v_cvt_pk_bf16_f32 v178, v160, v161
    v_cvt_pk_bf16_f32 v179, v162, v163
    v_cndmask_b32 v178, 0, v178, vcc
    v_cndmask_b32 v179, 0, v179, vcc
    s_lshl_b32 s24, s40, 10
    s_add_u32 s24, s24, s43
    buffer_store_dwordx4 v[176:179], v5, s[8:11], s24 offen sc1
interleave_layers__linear_attn_block__memory_aug_recurrent_mem_tr__prompt_kernel_k2f25:
    s_waitcnt vmcnt(0)
    s_barrier
    s_lshl_b32 s24, s92, 7
    s_sub_u32 s25, s2, 64
    s_lshl_b32 s25, s25, 2
    s_add_u32 s24, s24, s25
    s_add_u32 s24, s24, 23103488
    s_cmp_eq_u32 s3, 0
    s_cbranch_scc0 interleave_layers__linear_attn_block__memory_aug_recurrent_mem_tr__prompt_kernel_pb26
    v_lshlrev_b32 v14, 7, v1
    v_add_u32 v14, s24, v14
    v_mov_b32 v15, 2146435072
    v_cmp_le_u32 vcc, 1, v1
    s_nop 1
    v_cndmask_b32 v14, v14, v15, vcc
    v_mov_b32 v15, 1
    buffer_store_dword v15, v14, s[8:11], 0 offen sc1
interleave_layers__linear_attn_block__memory_aug_recurrent_mem_tr__prompt_kernel_pb26:
interleave_layers__linear_attn_block__memory_aug_recurrent_mem_tr__prompt_kernel_rk23:
    s_sub_u32 s44, s2, 64
    v_lshlrev_b32 v5, 4, v1
    s_lshl_b32 s24, s44, 15
    s_lshl_b32 s25, s3, 13
    s_add_u32 s24, s24, s25
    v_add_u32 v6, s24, v5
    v_add_u32 v7, 4096, v6
    s_lshl_b32 s24, s3, 12
    v_add_u32 v8, s24, v5
    s_lshl_b32 s24, s3, 10
    s_add_u32 s24, s24, 16384
    v_add_u32 v9, s24, v5
    s_lshl_b32 s24, s44, 13
    s_lshl_b32 s25, s3, 11
    s_add_u32 s24, s24, s25
    v_add_u32 v10, s24, v5
    v_and_b32 v204, 7, v2
    v_mul_u32_u24 v11, 80, v204
    v_lshl_add_u32 v11, v3, 4, v11
    s_mul_i32 s24, s3, 640
    v_add_u32 v11, s24, v11
    v_add_u32 v204, 8192, v5
    v_cmp_gt_u32 vcc, 8, v2
    s_nop 1
    v_cndmask_b32 v11, v204, v11, vcc
    v_and_b32 v204, 7, v2
    v_mul_u32_u24 v12, 80, v204
    v_lshrrev_b32 v204, 3, v2
    v_lshl_add_u32 v12, v204, 5, v12
    v_lshlrev_b32 v13, 4, v2
    s_lshl_b32 s24, s44, 8
    v_add_u32 v13, s24, v13
    v_mov_b32 v204, 2146435072
    v_cmp_gt_u32 vcc, 1, v3
    s_nop 1
    v_cndmask_b32 v13, v204, v13, vcc
    v_cmp_le_u32 s[50:51], 8, v2
    s_and_b32 s25, s44, 15
    s_lshr_b32 s25, s25, 2
    s_sub_u32 s26, s44, 32
    s_lshr_b32 s26, s26, 1
    s_cmp_ge_u32 s44, 32
    s_cselect_b32 s25, s26, s25
    s_mul_i32 s24, s25, 16
    v_add_u32 v120, s24, v1
    v_lshlrev_b32 v120, 7, v120
    v_mov_b32 v204, 2146435072
    v_cmp_le_u32 vcc, 16, v1
    s_nop 1
    v_cndmask_b32 v120, v120, v204, vcc
    s_and_b32 s24, s44, 7
    s_mul_i32 s25, s3, 8
    s_add_u32 s24, s24, s25
    s_lshl_b32 s24, s24, 7
    v_mov_b32 v125, s24
    v_mov_b32 v122, 12288
    v_mov_b32 v123, 0
    s_barrier
    ds_write_b32 v122, v123
    v_mov_b32 v123, 1
    s_waitcnt lgkmcnt(0)
    s_barrier
    s_mul_i32 s93, s92, 29360128
    s_add_u32 s93, s93, 117440512
    s_mul_i32 s94, s92, 16384
    s_add_u32 s94, s94, 23068672
    s_mov_b32 s40, 0
    s_mov_b32 s41, 184549376
    s_add_u32 s45, s93, 448512
    s_add_u32 s46, s93, 440320
    s_add_u32 s43, s93, 409600
    s_add_u32 s42, s93, 0
    s_add_u32 s47, s93, 430080
    v_and_b32 v252, 7, v1
    v_lshlrev_b32 v252, 7, v252
    s_lshl_b32 s24, s3, 10
    s_add_u32 s24, s24, 12288
    s_add_u32 s24, s24, s94
    v_add_u32 v252, s24, v252
    s_mov_b32 s62, -1
    s_mov_b32 s63, 1
    s_cmp_ge_i32 s62, s63
    s_cbranch_scc1 interleave_layers__linear_attn_block__memory_aug_recurrent_mem_tr__prompt_kernel_r_en0_ok
    s_mov_b32 s61, 0
interleave_layers__linear_attn_block__memory_aug_recurrent_mem_tr__prompt_kernel_r_en0:
    buffer_load_dword v253, v252, s[8:11], 0 offen sc1
    s_waitcnt vmcnt(0)
    v_readlane_b32 s62, v253, 0
    v_readlane_b32 s24, v253, 1
    s_min_i32 s62, s62, s24
    v_readlane_b32 s24, v253, 2
    s_min_i32 s62, s62, s24
    v_readlane_b32 s24, v253, 3
    s_min_i32 s62, s62, s24
    v_readlane_b32 s24, v253, 4
    s_min_i32 s62, s62, s24
    v_readlane_b32 s24, v253, 5
    s_min_i32 s62, s62, s24
    v_readlane_b32 s24, v253, 6
    s_min_i32 s62, s62, s24
    v_readlane_b32 s24, v253, 7
    s_min_i32 s62, s62, s24
    s_cmp_ge_i32 s62, s63
    s_cbranch_scc1 interleave_layers__linear_attn_block__memory_aug_recurrent_mem_tr__prompt_kernel_r_en0_ok
    s_add_u32 s61, s61, 1
    s_cmp_ge_u32 s61, s60
    s_cbranch_scc1 interleave_layers__linear_attn_block__memory_aug_recurrent_mem_tr__prompt_kernel_r_en0_to
    s_sleep 2
    s_branch interleave_layers__linear_attn_block__memory_aug_recurrent_mem_tr__prompt_kernel_r_en0
interleave_layers__linear_attn_block__memory_aug_recurrent_mem_tr__prompt_kernel_r_en0_to:
    s_mov_b32 s60, 1
interleave_layers__linear_attn_block__memory_aug_recurrent_mem_tr__prompt_kernel_r_en0_ok:
    buffer_load_dwordx4 v[48:51], v6, s[8:11], s41 offen offset:0 sc1
    buffer_load_dwordx4 v[52:55], v6, s[8:11], s41 offen offset:1024 sc1
    buffer_load_dwordx4 v[56:59], v6, s[8:11], s41 offen offset:2048 sc1
    buffer_load_dwordx4 v[60:63], v6, s[8:11], s41 offen offset:3072 sc1
    buffer_load_dwordx4 v[64:67], v7, s[8:11], s41 offen offset:0 sc1
    buffer_load_dwordx4 v[68:71], v7, s[8:11], s41 offen offset:1024 sc1
    buffer_load_dwordx4 v[72:75], v7, s[8:11], s41 offen offset:2048 sc1
    buffer_load_dwordx4 v[76:79], v7, s[8:11], s41 offen offset:3072 sc1
    s_add_u32 s41, s41, 1310720
interleave_layers__linear_attn_block__memory_aug_recurrent_mem_tr__prompt_kernel_r_step:
    s_waitcnt vmcnt(0)
    v_mov_b32 v16, v48
    v_mov_b32 v17, v49
    v_mov_b32 v18, v50
    v_mov_b32 v19, v51
    v_mov_b32 v20, v52
    v_mov_b32 v21, v53
    v_mov_b32 v22, v54
    v_mov_b32 v23, v55
    v_mov_b32 v24, v56
    v_mov_b32 v25, v57
    v_mov_b32 v26, v58
    v_mov_b32 v27, v59
    v_mov_b32 v28, v60
    v_mov_b32 v29, v61
    v_mov_b32 v30, v62
    v_mov_b32 v31, v63
    v_mov_b32 v32, v64
    v_mov_b32 v33, v65
    v_mov_b32 v34, v66
    v_mov_b32 v35, v67
    v_mov_b32 v36, v68
    v_mov_b32 v37, v69
    v_mov_b32 v38, v70
    v_mov_b32 v39, v71
    v_mov_b32 v40, v72
    v_mov_b32 v41, v73
    v_mov_b32 v42, v74
    v_mov_b32 v43, v75
    v_mov_b32 v44, v76
    v_mov_b32 v45, v77
    v_mov_b32 v46, v78
    v_mov_b32 v47, v79
    s_lshl_b32 s95, s92, 6
    s_add_u32 s95, s95, s40
    s_add_u32 s95, s95, 1
    s_cmp_ge_i32 s59, s95
    s_cbranch_scc1 interleave_layers__linear_attn_block__memory_aug_recurrent_mem_tr__prompt_kernel_r_ec_ok
    s_and_b32 s24, s2, 7
    s_lshl_b32 s24, s24, 7
    s_add_u32 s24, s24, 23109632
    v_and_b32 v254, 3, v1
    v_lshl_add_u32 v254, v254, 2, s24
    s_mov_b32 s61, 0
interleave_layers__linear_attn_block__memory_aug_recurrent_mem_tr__prompt_kernel_r_ec:
    buffer_load_dword v253, v254, s[8:11], 0 offen sc1
    s_waitcnt vmcnt(0)
    v_readlane_b32 s59, v253, 0
    v_readlane_b32 s24, v253, 1
    s_min_i32 s59, s59, s24
    v_readlane_b32 s24, v253, 2
    s_min_i32 s59, s59, s24
    s_cmp_ge_i32 s59, s95
    s_cbranch_scc1 interleave_layers__linear_attn_block__memory_aug_recurrent_mem_tr__prompt_kernel_r_ec_ok
    s_add_u32 s61, s61, 1
    s_cmp_ge_u32 s61, s60
    s_cbranch_scc1 interleave_layers__linear_attn_block__memory_aug_recurrent_mem_tr__prompt_kernel_r_ec_to
    s_sleep 2
    s_branch interleave_layers__linear_attn_block__memory_aug_recurrent_mem_tr__prompt_kernel_r_ec
interleave_layers__linear_attn_block__memory_aug_recurrent_mem_tr__prompt_kernel_r_ec_to:
    s_mov_b32 s60, 1
interleave_layers__linear_attn_block__memory_aug_recurrent_mem_tr__prompt_kernel_r_ec_ok:
    s_mov_b64 exec, 1
    s_mov_b32 s61, 0
    v_mov_b32 v117, 0
    buffer_atomic_add v117, v125, s[8:11], s45 offen sc0
    s_sleep 2
    v_mov_b32 v118, 0
    buffer_atomic_add v118, v125, s[8:11], s45 offen sc0
    s_sleep 2
    v_mov_b32 v119, 0
    buffer_atomic_add v119, v125, s[8:11], s45 offen sc0
    s_sleep 2
interleave_layers__linear_attn_block__memory_aug_recurrent_mem_tr__prompt_kernel_r_pr:
    v_mov_b32 v116, 0
    buffer_atomic_add v116, v125, s[8:11], s45 offen sc0
    s_waitcnt vmcnt(3)
    v_cmp_le_i32 vcc, 7, v117
    s_add_u32 s61, s61, 1
    s_cbranch_vccnz interleave_layers__linear_attn_block__memory_aug_recurrent_mem_tr__prompt_kernel_r_pr_out
    s_sleep 2
    v_mov_b32 v117, 0
    buffer_atomic_add v117, v125, s[8:11], s45 offen sc0
    s_waitcnt vmcnt(3)
    v_cmp_le_i32 vcc, 7, v118
    s_add_u32 s61, s61, 1
    s_cbranch_vccnz interleave_layers__linear_attn_block__memory_aug_recurrent_mem_tr__prompt_kernel_r_pr_out
    s_sleep 2
    v_mov_b32 v118, 0
    buffer_atomic_add v118, v125, s[8:11], s45 offen sc0
    s_waitcnt vmcnt(3)
    v_cmp_le_i32 vcc, 7, v119
    s_add_u32 s61, s61, 1
    s_cbranch_vccnz interleave_layers__linear_attn_block__memory_aug_recurrent_mem_tr__prompt_kernel_r_pr_out
    s_sleep 2
    v_mov_b32 v119, 0
    buffer_atomic_add v119, v125, s[8:11], s45 offen sc0
    s_waitcnt vmcnt(3)
    v_cmp_le_i32 vcc, 7, v116
    s_add_u32 s61, s61, 1
    s_cbranch_vccnz interleave_layers__linear_attn_block__memory_aug_recurrent_mem_tr__prompt_kernel_r_pr_out
    s_sleep 2
    s_cmp_ge_u32 s61, s60
    s_cbranch_scc0 interleave_layers__linear_attn_block__memory_aug_recurrent_mem_tr__prompt_kernel_r_pr
    s_mov_b32 s60, 1
interleave_layers__linear_attn_block__memory_aug_recurrent_mem_tr__prompt_kernel_r_pr_out:
    s_mov_b64 exec, -1
    buffer_load_dwordx4 v[100:103], v10, s[8:11], s42 offen offset:0 sc1
    buffer_load_dwordx4 v[104:107], v10, s[8:11], s42 offen offset:1024 sc1
    buffer_load_dwordx4 v[80:83], v8, s[8:11], s43 offen offset:0 sc1
    buffer_load_dwordx4 v[84:87], v8, s[8:11], s43 offen offset:1024 sc1
    buffer_load_dwordx4 v[88:91], v8, s[8:11], s43 offen offset:2048 sc1
    buffer_load_dwordx4 v[92:95], v8, s[8:11], s43 offen offset:3072 sc1
    buffer_load_dwordx4 v[96:99], v9, s[8:11], s43 offen sc1
    s_waitcnt vmcnt(0)
    v_max3_u32 v204, v80, v81, v82
    v_max3_u32 v204, v204, v83, v84
    v_max3_u32 v204, v204, v85, v86
    v_max3_u32 v204, v204, v87, v88
    v_max3_u32 v204, v204, v89, v90
    v_max3_u32 v204, v204, v91, v92
    v_max3_u32 v204, v204, v93, v94
    v_max3_u32 v204, v204, v95, v96
    v_max3_u32 v204, v204, v97, v98
    v_max3_u32 v204, v204, v99, v100
    v_max3_u32 v204, v204, v101, v102
    v_max3_u32 v204, v204, v103, v104
    v_max3_u32 v204, v204, v105, v106
    v_max_u32 v204, v204, v107
    v_cmp_eq_u32 vcc, -1, v204
    s_cbranch_vccz interleave_layers__linear_attn_block__memory_aug_recurrent_mem_tr__prompt_kernel_r_p_out
    s_mov_b32 s61, 0
interleave_layers__linear_attn_block__memory_aug_recurrent_mem_tr__prompt_kernel_r_p:
    buffer_load_dwordx4 v[100:103], v10, s[8:11], s42 offen offset:0 sc1
    buffer_load_dwordx4 v[104:107], v10, s[8:11], s42 offen offset:1024 sc1
    buffer_load_dwordx4 v[80:83], v8, s[8:11], s43 offen offset:0 sc1
    buffer_load_dwordx4 v[84:87], v8, s[8:11], s43 offen offset:1024 sc1
    buffer_load_dwordx4 v[88:91], v8, s[8:11], s43 offen offset:2048 sc1
    buffer_load_dwordx4 v[92:95], v8, s[8:11], s43 offen offset:3072 sc1
    buffer_load_dwordx4 v[96:99], v9, s[8:11], s43 offen sc1
    s_waitcnt vmcnt(0)
    v_max3_u32 v204, v80, v81, v82
    v_max3_u32 v204, v204, v83, v84
    v_max3_u32 v204, v204, v85, v86
    v_max3_u32 v204, v204, v87, v88
    v_max3_u32 v204, v204, v89, v90
    v_max3_u32 v204, v204, v91, v92
    v_max3_u32 v204, v204, v93, v94
    v_max3_u32 v204, v204, v95, v96
    v_max3_u32 v204, v204, v97, v98
    v_max3_u32 v204, v204, v99, v100
    v_max3_u32 v204, v204, v101, v102
    v_max3_u32 v204, v204, v103, v104
    v_max3_u32 v204, v204, v105, v106
    v_max_u32 v204, v204, v107
    v_cmp_eq_u32 vcc, -1, v204
    s_add_u32 s61, s61, 1
    s_cbranch_vccz interleave_layers__linear_attn_block__memory_aug_recurrent_mem_tr__prompt_kernel_r_p_out
    s_cmp_ge_u32 s61, s60
    s_cbranch_scc1 interleave_layers__linear_attn_block__memory_aug_recurrent_mem_tr__prompt_kernel_r_p_to
    s_sleep 1
    s_branch interleave_layers__linear_attn_block__memory_aug_recurrent_mem_tr__prompt_kernel_r_p
interleave_layers__linear_attn_block__memory_aug_recurrent_mem_tr__prompt_kernel_r_p_to:
    s_mov_b32 s60, 1
interleave_layers__linear_attn_block__memory_aug_recurrent_mem_tr__prompt_kernel_r_p_out:
    s_mov_b64 exec, 1
    ds_add_rtn_u32 v124, v122, v123
    s_mov_b64 exec, -1
    v_mfma_f32_16x16x32_bf16 v[108:111], v[100:103], v[96:99], 0
    v_mfma_f32_16x16x32_bf16 v[112:115], v[104:107], v[96:99], 0
    v_mfma_f32_16x16x32_bf16 v[108:111], v[16:19], v[80:83], v[108:111]
    v_mfma_f32_16x16x32_bf16 v[112:115], v[20:23], v[80:83], v[112:115]
    s_waitcnt lgkmcnt(0)
    v_readfirstlane_b32 s24, v124
    s_and_b32 s24, s24, 3
    s_cmp_eq_u32 s24, 3
    s_cbranch_scc0 interleave_layers__linear_attn_block__memory_aug_recurrent_mem_tr__prompt_kernel_nh27
    buffer_atomic_add v123, v120, s[8:11], s46 offen
interleave_layers__linear_attn_block__memory_aug_recurrent_mem_tr__prompt_kernel_nh27:
    v_mfma_f32_16x16x32_bf16 v[108:111], v[24:27], v[84:87], v[108:111]
    v_mfma_f32_16x16x32_bf16 v[112:115], v[28:31], v[84:87], v[112:115]
    v_mfma_f32_16x16x32_bf16 v[108:111], v[32:35], v[88:91], v[108:111]
    v_mfma_f32_16x16x32_bf16 v[112:115], v[36:39], v[88:91], v[112:115]
    v_mfma_f32_16x16x32_bf16 v[108:111], v[40:43], v[92:95], v[108:111]
    v_mfma_f32_16x16x32_bf16 v[112:115], v[44:47], v[92:95], v[112:115]
    s_and_b32 s24, s40, 1
    s_mul_i32 s24, s24, 2560
    v_add_u32 v14, s24, v11
    v_add_u32 v15, s24, v12
    s_nop 3
    v_cndmask_b32 v108, v108, v112, s[50:51]
    v_cndmask_b32 v109, v109, v113, s[50:51]
    v_cndmask_b32 v110, v110, v114, s[50:51]
    v_cndmask_b32 v111, v111, v115, s[50:51]
    v_add_f32 v108, v108, v108 row_ror:8 row_mask:0xf bank_mask:0xf
    v_add_f32 v109, v109, v109 row_ror:8 row_mask:0xf bank_mask:0xf
    v_add_f32 v110, v110, v110 row_ror:8 row_mask:0xf bank_mask:0xf
    v_add_f32 v111, v111, v111 row_ror:8 row_mask:0xf bank_mask:0xf
    ds_write_b128 v14, v[108:111]
    s_waitcnt lgkmcnt(0)
    s_barrier
    s_cmp_eq_u32 s3, 0
    s_cbranch_scc0 interleave_layers__linear_attn_block__memory_aug_recurrent_mem_tr__prompt_kernel_np28
    ds_read_b128 v[220:223], v15 offset:0
    ds_read_b128 v[224:227], v15 offset:16
    ds_read_b128 v[228:231], v15 offset:640
    ds_read_b128 v[232:235], v15 offset:656
    ds_read_b128 v[236:239], v15 offset:1280
    ds_read_b128 v[240:243], v15 offset:1296
    ds_read_b128 v[244:247], v15 offset:1920
    ds_read_b128 v[248:251], v15 offset:1936
    s_waitcnt lgkmcnt(4)
    v_pk_add_f32 v[220:221], v[220:221], v[228:229]
    v_pk_add_f32 v[222:223], v[222:223], v[230:231]
    v_pk_add_f32 v[224:225], v[224:225], v[232:233]
    v_pk_add_f32 v[226:227], v[226:227], v[234:235]
    s_waitcnt lgkmcnt(0)
    v_pk_add_f32 v[236:237], v[236:237], v[244:245]
    v_pk_add_f32 v[238:239], v[238:239], v[246:247]
    v_pk_add_f32 v[240:241], v[240:241], v[248:249]
    v_pk_add_f32 v[242:243], v[242:243], v[250:251]
    v_pk_add_f32 v[220:221], v[220:221], v[236:237]
    v_pk_add_f32 v[222:223], v[222:223], v[238:239]
    v_pk_add_f32 v[224:225], v[224:225], v[240:241]
    v_pk_add_f32 v[226:227], v[226:227], v[242:243]
    v_cvt_pk_bf16_f32 v228, v220, v221
    v_cvt_pk_bf16_f32 v229, v222, v223
    v_cvt_pk_bf16_f32 v230, v224, v225
    v_cvt_pk_bf16_f32 v231, v226, v227
    v_min_u32 v228, -2, v228
    v_min_u32 v229, -2, v229
    v_min_u32 v230, -2, v230
    v_min_u32 v231, -2, v231
    buffer_store_dwordx4 v[228:231], v13, s[8:11], s47 offen sc1
interleave_layers__linear_attn_block__memory_aug_recurrent_mem_tr__prompt_kernel_np28:
    s_cmp_eq_u32 s3, 1
    s_cbranch_scc0 interleave_layers__linear_attn_block__memory_aug_recurrent_mem_tr__prompt_kernel_xf29
    s_cmp_eq_u32 s44, 39
    s_cbranch_scc0 interleave_layers__linear_attn_block__memory_aug_recurrent_mem_tr__prompt_kernel_xf29
    s_lshl_b32 s24, s92, 6
    s_add_u32 s24, s24, s40
    s_add_u32 s24, s24, 1
    v_lshlrev_b32 v204, 7, v1
    v_add_u32 v204, 23111680, v204
    v_mov_b32 v205, 2146435072
    v_cmp_le_u32 vcc, 8, v1
    s_nop 1
    v_cndmask_b32 v204, v204, v205, vcc
    v_mov_b32 v205, s24
    buffer_store_dword v205, v204, s[8:11], 0 offen sc1
interleave_layers__linear_attn_block__memory_aug_recurrent_mem_tr__prompt_kernel_xf29:
    s_add_u32 s63, s40, 2
    s_min_u32 s63, s63, 64
    s_sleep 20
    s_cmp_ge_i32 s62, s63
    s_cbranch_scc1 interleave_layers__linear_attn_block__memory_aug_recurrent_mem_tr__prompt_kernel_r_en_ok
    s_mov_b32 s61, 0
interleave_layers__linear_attn_block__memory_aug_recurrent_mem_tr__prompt_kernel_r_en:
    buffer_load_dword v253, v252, s[8:11], 0 offen sc1
    s_waitcnt vmcnt(0)
    v_readlane_b32 s62, v253, 0
    v_readlane_b32 s24, v253, 1
    s_min_i32 s62, s62, s24
    v_readlane_b32 s24, v253, 2
    s_min_i32 s62, s62, s24
    v_readlane_b32 s24, v253, 3
    s_min_i32 s62, s62, s24
    v_readlane_b32 s24, v253, 4
    s_min_i32 s62, s62, s24
    v_readlane_b32 s24, v253, 5
    s_min_i32 s62, s62, s24
    v_readlane_b32 s24, v253, 6
    s_min_i32 s62, s62, s24
    v_readlane_b32 s24, v253, 7
    s_min_i32 s62, s62, s24
    s_cmp_ge_i32 s62, s63
    s_cbranch_scc1 interleave_layers__linear_attn_block__memory_aug_recurrent_mem_tr__prompt_kernel_r_en_ok
    s_add_u32 s61, s61, 1
    s_cmp_ge_u32 s61, s60
    s_cbranch_scc1 interleave_layers__linear_attn_block__memory_aug_recurrent_mem_tr__prompt_kernel_r_en_to
    s_sleep 2
    s_branch interleave_layers__linear_attn_block__memory_aug_recurrent_mem_tr__prompt_kernel_r_en
interleave_layers__linear_attn_block__memory_aug_recurrent_mem_tr__prompt_kernel_r_en_to:
    s_mov_b32 s60, 1
interleave_layers__linear_attn_block__memory_aug_recurrent_mem_tr__prompt_kernel_r_en_ok:
    buffer_load_dwordx4 v[48:51], v6, s[8:11], s41 offen offset:0 sc1
    buffer_load_dwordx4 v[52:55], v6, s[8:11], s41 offen offset:1024 sc1
    buffer_load_dwordx4 v[56:59], v6, s[8:11], s41 offen offset:2048 sc1
    buffer_load_dwordx4 v[60:63], v6, s[8:11], s41 offen offset:3072 sc1
    buffer_load_dwordx4 v[64:67], v7, s[8:11], s41 offen offset:0 sc1
    buffer_load_dwordx4 v[68:71], v7, s[8:11], s41 offen offset:1024 sc1
    buffer_load_dwordx4 v[72:75], v7, s[8:11], s41 offen offset:2048 sc1
    buffer_load_dwordx4 v[76:79], v7, s[8:11], s41 offen offset:3072 sc1
    s_add_u32 s41, s41, 1310720
    s_add_u32 s40, s40, 1
    s_add_u32 s42, s42, 458752
    s_add_u32 s43, s43, 458752
    s_add_u32 s47, s47, 458752
    s_add_u32 s45, s45, 458752
    s_add_u32 s46, s46, 458752
    s_cmp_lt_u32 s40, 64
    s_cbranch_scc1 interleave_layers__linear_attn_block__memory_aug_recurrent_mem_tr__prompt_kernel_r_step
    s_waitcnt vmcnt(0)
    s_cmp_eq_u32 s92, 0
    s_cbranch_scc0 interleave_layers__linear_attn_block__memory_aug_recurrent_mem_tr__prompt_kernel_end
    s_mov_b32 s92, 1
    s_branch interleave_layers__linear_attn_block__memory_aug_recurrent_mem_tr__prompt_kernel_r_top
interleave_layers__linear_attn_block__memory_aug_recurrent_mem_tr__prompt_kernel_roleP:
    s_sub_u32 s44, s2, 104
    s_lshr_b32 s46, s44, 5
    s_and_b32 s44, s44, 31
    s_load_dwordx2 s[6:7], s[0:1], 40
    s_load_dwordx2 s[24:25], s[0:1], 48
    s_load_dwordx2 s[26:27], s[0:1], 56
    s_waitcnt lgkmcnt(0)
    s_cmp_eq_u32 s46, 1
    s_cselect_b32 s6, s24, s6
    s_cselect_b32 s7, s25, s7
    s_cmp_eq_u32 s46, 2
    s_cselect_b32 s6, s26, s6
    s_cselect_b32 s7, s27, s7
    s_mov_b32 s12, s6
    s_mov_b32 s13, s7
    s_mov_b32 s14, 7864320
    s_mov_b32 s15, 0x00020000
    v_add_u32 v16, 0, v0
    s_mov_b32 s24, 683
    v_mul_lo_u32 v17, v16, s24
    v_lshrrev_b32 v17, 14, v17
    v_mul_u32_u24 v18, 24, v17
    v_sub_u32 v18, v16, v18
    s_mov_b32 s24, 12288
    v_mul_lo_u32 v4, v17, s24
    v_lshl_add_u32 v4, v18, 4, v4
    v_mul_u32_u24 v10, 400, v17
    v_lshl_add_u32 v10, v18, 4, v10
    v_add_u32 v10, 81920, v10
    v_add_u32 v16, 256, v0
    s_mov_b32 s24, 683
    v_mul_lo_u32 v17, v16, s24
    v_lshrrev_b32 v17, 14, v17
    v_mul_u32_u24 v18, 24, v17
    v_sub_u32 v18, v16, v18
    s_mov_b32 s24, 12288
    v_mul_lo_u32 v5, v17, s24
    v_lshl_add_u32 v5, v18, 4, v5
    v_mul_u32_u24 v11, 400, v17
    v_lshl_add_u32 v11, v18, 4, v11
    v_add_u32 v11, 81920, v11
    v_add_u32 v16, 512, v0
    s_mov_b32 s24, 683
    v_mul_lo_u32 v17, v16, s24
    v_lshrrev_b32 v17, 14, v17
    v_mul_u32_u24 v18, 24, v17
    v_sub_u32 v18, v16, v18
    s_mov_b32 s24, 12288
    v_mul_lo_u32 v6, v17, s24
    v_lshl_add_u32 v6, v18, 4, v6
    v_mul_u32_u24 v12, 400, v17
    v_lshl_add_u32 v12, v18, 4, v12
    v_add_u32 v12, 81920, v12
    v_add_u32 v16, 768, v0
    s_mov_b32 s24, 683
    v_mul_lo_u32 v17, v16, s24
    v_lshrrev_b32 v17, 14, v17
    v_mul_u32_u24 v18, 24, v17
    v_sub_u32 v18, v16, v18
    s_mov_b32 s24, 12288
    v_mul_lo_u32 v7, v17, s24
    v_lshl_add_u32 v7, v18, 4, v7
    v_mul_u32_u24 v13, 400, v17
    v_lshl_add_u32 v13, v18, 4, v13
    v_add_u32 v13, 81920, v13
    v_add_u32 v16, 1024, v0
    s_mov_b32 s24, 683
    v_mul_lo_u32 v17, v16, s24
    v_lshrrev_b32 v17, 14, v17
    v_mul_u32_u24 v18, 24, v17
    v_sub_u32 v18, v16, v18
    s_mov_b32 s24, 12288
    v_mul_lo_u32 v8, v17, s24
    v_lshl_add_u32 v8, v18, 4, v8
    v_mul_u32_u24 v14, 400, v17
    v_lshl_add_u32 v14, v18, 4, v14
    v_add_u32 v14, 81920, v14
    v_add_u32 v16, 1280, v0
    s_mov_b32 s24, 683
    v_mul_lo_u32 v17, v16, s24
    v_lshrrev_b32 v17, 14, v17
    v_mul_u32_u24 v18, 24, v17
    v_sub_u32 v18, v16, v18
    s_mov_b32 s24, 12288
    v_mul_lo_u32 v9, v17, s24
    v_lshl_add_u32 v9, v18, 4, v9
    v_mul_u32_u24 v15, 400, v17
    v_lshl_add_u32 v15, v18, 4, v15
    v_add_u32 v15, 81920, v15
    v_lshrrev_b32 v16, 2, v2
    v_lshl_add_u32 v16, v3, 2, v16
    v_mul_u32_u24 v32, 400, v16
    v_and_b32 v16, 3, v2
    v_lshl_add_u32 v32, v16, 3, v32
    s_mul_i32 s24, s3, 96
    s_add_u32 s24, s24, 81920
    v_add_u32 v32, s24, v32
    s_mul_i32 s45, s44, 384
    s_add_u32 s47, s45, 0
    buffer_load_dwordx4 v[56:59], v4, s[12:15], s47 offen
    buffer_load_dwordx4 v[60:63], v5, s[12:15], s47 offen
    buffer_load_dwordx4 v[64:67], v6, s[12:15], s47 offen
    buffer_load_dwordx4 v[68:71], v7, s[12:15], s47 offen
    buffer_load_dwordx4 v[72:75], v8, s[12:15], s47 offen
    buffer_load_dwordx4 v[76:79], v9, s[12:15], s47 offen
    s_add_u32 s47, s45, 786432
    buffer_load_dwordx4 v[80:83], v4, s[12:15], s47 offen
    buffer_load_dwordx4 v[84:87], v5, s[12:15], s47 offen
    buffer_load_dwordx4 v[88:91], v6, s[12:15], s47 offen
    buffer_load_dwordx4 v[92:95], v7, s[12:15], s47 offen
    buffer_load_dwordx4 v[96:99], v8, s[12:15], s47 offen
    buffer_load_dwordx4 v[100:103], v9, s[12:15], s47 offen
    s_add_u32 s47, s45, 1572864
    buffer_load_dwordx4 v[104:107], v4, s[12:15], s47 offen
    buffer_load_dwordx4 v[108:111], v5, s[12:15], s47 offen
    buffer_load_dwordx4 v[112:115], v6, s[12:15], s47 offen
    buffer_load_dwordx4 v[116:119], v7, s[12:15], s47 offen
    buffer_load_dwordx4 v[120:123], v8, s[12:15], s47 offen
    buffer_load_dwordx4 v[124:127], v9, s[12:15], s47 offen
    s_add_u32 s47, s45, 2359296
    buffer_load_dwordx4 v[128:131], v4, s[12:15], s47 offen
    buffer_load_dwordx4 v[132:135], v5, s[12:15], s47 offen
    buffer_load_dwordx4 v[136:139], v6, s[12:15], s47 offen
    buffer_load_dwordx4 v[140:143], v7, s[12:15], s47 offen
    buffer_load_dwordx4 v[144:147], v8, s[12:15], s47 offen
    buffer_load_dwordx4 v[148:151], v9, s[12:15], s47 offen
    s_add_u32 s47, s45, 3145728
    buffer_load_dwordx4 v[152:155], v4, s[12:15], s47 offen
    buffer_load_dwordx4 v[156:159], v5, s[12:15], s47 offen
    buffer_load_dwordx4 v[160:163], v6, s[12:15], s47 offen
    buffer_load_dwordx4 v[164:167], v7, s[12:15], s47 offen
    buffer_load_dwordx4 v[168:171], v8, s[12:15], s47 offen
    buffer_load_dwordx4 v[172:175], v9, s[12:15], s47 offen
    s_add_u32 s47, s45, 3932160
    buffer_load_dwordx4 v[176:179], v4, s[12:15], s47 offen
    buffer_load_dwordx4 v[180:183], v5, s[12:15], s47 offen
    buffer_load_dwordx4 v[184:187], v6, s[12:15], s47 offen
    buffer_load_dwordx4 v[188:191], v7, s[12:15], s47 offen
    buffer_load_dwordx4 v[192:195], v8, s[12:15], s47 offen
    buffer_load_dwordx4 v[196:199], v9, s[12:15], s47 offen
    s_add_u32 s47, s45, 4718592
    buffer_load_dwordx4 v[200:203], v4, s[12:15], s47 offen
    buffer_load_dwordx4 v[204:207], v5, s[12:15], s47 offen
    buffer_load_dwordx4 v[208:211], v6, s[12:15], s47 offen
    buffer_load_dwordx4 v[212:215], v7, s[12:15], s47 offen
    buffer_load_dwordx4 v[216:219], v8, s[12:15], s47 offen
    buffer_load_dwordx4 v[220:223], v9, s[12:15], s47 offen
    s_add_u32 s47, s45, 5505024
    buffer_load_dwordx4 v[224:227], v4, s[12:15], s47 offen
    buffer_load_dwordx4 v[228:231], v5, s[12:15], s47 offen
    buffer_load_dwordx4 v[232:235], v6, s[12:15], s47 offen
    buffer_load_dwordx4 v[236:239], v7, s[12:15], s47 offen
    buffer_load_dwordx4 v[240:243], v8, s[12:15], s47 offen
    buffer_load_dwordx4 v[244:247], v9, s[12:15], s47 offen
    v_mov_b32 v28, 0x3f803f80
    v_mov_b32 v29, 0x3f803f80
    v_mov_b32 v30, 0x3f803f80
    v_mov_b32 v31, 0x3f803f80
    s_waitcnt vmcnt(42)
    ds_write_b128 v10, v[56:59] offset:0
    ds_write_b128 v11, v[60:63] offset:0
    ds_write_b128 v12, v[64:67] offset:0
    ds_write_b128 v13, v[68:71] offset:0
    ds_write_b128 v14, v[72:75] offset:0
    ds_write_b128 v15, v[76:79] offset:0
    s_waitcnt lgkmcnt(0)
    s_add_u32 s47, s45, 6291456
    buffer_load_dwordx4 v[56:59], v4, s[12:15], s47 offen
    buffer_load_dwordx4 v[60:63], v5, s[12:15], s47 offen
    buffer_load_dwordx4 v[64:67], v6, s[12:15], s47 offen
    buffer_load_dwordx4 v[68:71], v7, s[12:15], s47 offen
    buffer_load_dwordx4 v[72:75], v8, s[12:15], s47 offen
    buffer_load_dwordx4 v[76:79], v9, s[12:15], s47 offen
    s_barrier
    ds_read_b64_tr_b16 a[0:1], v32 offset:0
    ds_read_b64_tr_b16 a[2:3], v32 offset:6400
    ds_read_b64_tr_b16 a[4:5], v32 offset:12800
    ds_read_b64_tr_b16 a[6:7], v32 offset:19200
    ds_read_b64_tr_b16 a[80:81], v32 offset:32
    ds_read_b64_tr_b16 a[82:83], v32 offset:6432
    ds_read_b64_tr_b16 a[84:85], v32 offset:12832
    ds_read_b64_tr_b16 a[86:87], v32 offset:19232
    ds_read_b64_tr_b16 a[160:161], v32 offset:64
    ds_read_b64_tr_b16 a[162:163], v32 offset:6464
    ds_read_b64_tr_b16 a[164:165], v32 offset:12864
    ds_read_b64_tr_b16 a[166:167], v32 offset:19264
    s_waitcnt vmcnt(42)
    ds_write_b128 v10, v[80:83] offset:25600
    ds_write_b128 v11, v[84:87] offset:25600
    ds_write_b128 v12, v[88:91] offset:25600
    ds_write_b128 v13, v[92:95] offset:25600
    ds_write_b128 v14, v[96:99] offset:25600
    ds_write_b128 v15, v[100:103] offset:25600
    s_waitcnt lgkmcnt(0)
    s_add_u32 s47, s45, 7077888
    buffer_load_dwordx4 v[80:83], v4, s[12:15], s47 offen
    buffer_load_dwordx4 v[84:87], v5, s[12:15], s47 offen
    buffer_load_dwordx4 v[88:91], v6, s[12:15], s47 offen
    buffer_load_dwordx4 v[92:95], v7, s[12:15], s47 offen
    buffer_load_dwordx4 v[96:99], v8, s[12:15], s47 offen
    buffer_load_dwordx4 v[100:103], v9, s[12:15], s47 offen
    v_mfma_f32_16x16x32_bf16 v[16:19], a[0:3], v[28:31], 0
    v_mfma_f32_16x16x32_bf16 v[20:23], a[80:83], v[28:31], 0
    v_mfma_f32_16x16x32_bf16 v[24:27], a[160:163], v[28:31], 0
    v_mfma_f32_16x16x32_bf16 v[16:19], a[4:7], v[28:31], v[16:19]
    v_mfma_f32_16x16x32_bf16 v[20:23], a[84:87], v[28:31], v[20:23]
    v_mfma_f32_16x16x32_bf16 v[24:27], a[164:167], v[28:31], v[24:27]
    s_barrier
    ds_read_b64_tr_b16 a[8:9], v32 offset:25600
    ds_read_b64_tr_b16 a[10:11], v32 offset:32000
    ds_read_b64_tr_b16 a[12:13], v32 offset:38400
    ds_read_b64_tr_b16 a[14:15], v32 offset:44800
    ds_read_b64_tr_b16 a[88:89], v32 offset:25632
    ds_read_b64_tr_b16 a[90:91], v32 offset:32032
    ds_read_b64_tr_b16 a[92:93], v32 offset:38432
    ds_read_b64_tr_b16 a[94:95], v32 offset:44832
    ds_read_b64_tr_b16 a[168:169], v32 offset:25664
    ds_read_b64_tr_b16 a[170:171], v32 offset:32064
    ds_read_b64_tr_b16 a[172:173], v32 offset:38464
    ds_read_b64_tr_b16 a[174:175], v32 offset:44864
    s_waitcnt vmcnt(42)
    ds_write_b128 v10, v[104:107] offset:0
    ds_write_b128 v11, v[108:111] offset:0
    ds_write_b128 v12, v[112:115] offset:0
    ds_write_b128 v13, v[116:119] offset:0
    ds_write_b128 v14, v[120:123] offset:0
    ds_write_b128 v15, v[124:127] offset:0
    s_waitcnt lgkmcnt(0)
    v_mfma_f32_16x16x32_bf16 v[16:19], a[8:11], v[28:31], v[16:19]
    v_mfma_f32_16x16x32_bf16 v[20:23], a[88:91], v[28:31], v[20:23]
    v_mfma_f32_16x16x32_bf16 v[24:27], a[168:171], v[28:31], v[24:27]
    v_mfma_f32_16x16x32_bf16 v[16:19], a[12:15], v[28:31], v[16:19]
    v_mfma_f32_16x16x32_bf16 v[20:23], a[92:95], v[28:31], v[20:23]
    v_mfma_f32_16x16x32_bf16 v[24:27], a[172:175], v[28:31], v[24:27]
    s_barrier
    ds_read_b64_tr_b16 a[16:17], v32 offset:0
    ds_read_b64_tr_b16 a[18:19], v32 offset:6400
    ds_read_b64_tr_b16 a[20:21], v32 offset:12800
    ds_read_b64_tr_b16 a[22:23], v32 offset:19200
    ds_read_b64_tr_b16 a[96:97], v32 offset:32
    ds_read_b64_tr_b16 a[98:99], v32 offset:6432
    ds_read_b64_tr_b16 a[100:101], v32 offset:12832
    ds_read_b64_tr_b16 a[102:103], v32 offset:19232
    ds_read_b64_tr_b16 a[176:177], v32 offset:64
    ds_read_b64_tr_b16 a[178:179], v32 offset:6464
    ds_read_b64_tr_b16 a[180:181], v32 offset:12864
    ds_read_b64_tr_b16 a[182:183], v32 offset:19264
    s_waitcnt vmcnt(36)
    ds_write_b128 v10, v[128:131] offset:25600
    ds_write_b128 v11, v[132:135] offset:25600
    ds_write_b128 v12, v[136:139] offset:25600
    ds_write_b128 v13, v[140:143] offset:25600
    ds_write_b128 v14, v[144:147] offset:25600
    ds_write_b128 v15, v[148:151] offset:25600
    s_waitcnt lgkmcnt(0)
    v_mfma_f32_16x16x32_bf16 v[16:19], a[16:19], v[28:31], v[16:19]
    v_mfma_f32_16x16x32_bf16 v[20:23], a[96:99], v[28:31], v[20:23]
    v_mfma_f32_16x16x32_bf16 v[24:27], a[176:179], v[28:31], v[24:27]
    v_mfma_f32_16x16x32_bf16 v[16:19], a[20:23], v[28:31], v[16:19]
    v_mfma_f32_16x16x32_bf16 v[20:23], a[100:103], v[28:31], v[20:23]
    v_mfma_f32_16x16x32_bf16 v[24:27], a[180:183], v[28:31], v[24:27]
    s_barrier
    ds_read_b64_tr_b16 a[24:25], v32 offset:25600
    ds_read_b64_tr_b16 a[26:27], v32 offset:32000
    ds_read_b64_tr_b16 a[28:29], v32 offset:38400
    ds_read_b64_tr_b16 a[30:31], v32 offset:44800
    ds_read_b64_tr_b16 a[104:105], v32 offset:25632
    ds_read_b64_tr_b16 a[106:107], v32 offset:32032
    ds_read_b64_tr_b16 a[108:109], v32 offset:38432
    ds_read_b64_tr_b16 a[110:111], v32 offset:44832
    ds_read_b64_tr_b16 a[184:185], v32 offset:25664
    ds_read_b64_tr_b16 a[186:187], v32 offset:32064
    ds_read_b64_tr_b16 a[188:189], v32 offset:38464
    ds_read_b64_tr_b16 a[190:191], v32 offset:44864
    s_waitcnt vmcnt(30)
    ds_write_b128 v10, v[152:155] offset:0
    ds_write_b128 v11, v[156:159] offset:0
    ds_write_b128 v12, v[160:163] offset:0
    ds_write_b128 v13, v[164:167] offset:0
    ds_write_b128 v14, v[168:171] offset:0
    ds_write_b128 v15, v[172:175] offset:0
    s_waitcnt lgkmcnt(0)
    v_mfma_f32_16x16x32_bf16 v[16:19], a[24:27], v[28:31], v[16:19]
    v_mfma_f32_16x16x32_bf16 v[20:23], a[104:107], v[28:31], v[20:23]
    v_mfma_f32_16x16x32_bf16 v[24:27], a[184:187], v[28:31], v[24:27]
    v_mfma_f32_16x16x32_bf16 v[16:19], a[28:31], v[28:31], v[16:19]
    v_mfma_f32_16x16x32_bf16 v[20:23], a[108:111], v[28:31], v[20:23]
    v_mfma_f32_16x16x32_bf16 v[24:27], a[188:191], v[28:31], v[24:27]
    s_barrier
    ds_read_b64_tr_b16 a[32:33], v32 offset:0
    ds_read_b64_tr_b16 a[34:35], v32 offset:6400
    ds_read_b64_tr_b16 a[36:37], v32 offset:12800
    ds_read_b64_tr_b16 a[38:39], v32 offset:19200
    ds_read_b64_tr_b16 a[112:113], v32 offset:32
    ds_read_b64_tr_b16 a[114:115], v32 offset:6432
    ds_read_b64_tr_b16 a[116:117], v32 offset:12832
    ds_read_b64_tr_b16 a[118:119], v32 offset:19232
    ds_read_b64_tr_b16 a[192:193], v32 offset:64
    ds_read_b64_tr_b16 a[194:195], v32 offset:6464
    ds_read_b64_tr_b16 a[196:197], v32 offset:12864
    ds_read_b64_tr_b16 a[198:199], v32 offset:19264
    s_waitcnt vmcnt(24)
    ds_write_b128 v10, v[176:179] offset:25600
    ds_write_b128 v11, v[180:183] offset:25600
    ds_write_b128 v12, v[184:187] offset:25600
    ds_write_b128 v13, v[188:191] offset:25600
    ds_write_b128 v14, v[192:195] offset:25600
    ds_write_b128 v15, v[196:199] offset:25600
    s_waitcnt lgkmcnt(0)
    v_mfma_f32_16x16x32_bf16 v[16:19], a[32:35], v[28:31], v[16:19]
    v_mfma_f32_16x16x32_bf16 v[20:23], a[112:115], v[28:31], v[20:23]
    v_mfma_f32_16x16x32_bf16 v[24:27], a[192:195], v[28:31], v[24:27]
    v_mfma_f32_16x16x32_bf16 v[16:19], a[36:39], v[28:31], v[16:19]
    v_mfma_f32_16x16x32_bf16 v[20:23], a[116:119], v[28:31], v[20:23]
    v_mfma_f32_16x16x32_bf16 v[24:27], a[196:199], v[28:31], v[24:27]
    s_barrier
    ds_read_b64_tr_b16 a[40:41], v32 offset:25600
    ds_read_b64_tr_b16 a[42:43], v32 offset:32000
    ds_read_b64_tr_b16 a[44:45], v32 offset:38400
    ds_read_b64_tr_b16 a[46:47], v32 offset:44800
    ds_read_b64_tr_b16 a[120:121], v32 offset:25632
    ds_read_b64_tr_b16 a[122:123], v32 offset:32032
    ds_read_b64_tr_b16 a[124:125], v32 offset:38432
    ds_read_b64_tr_b16 a[126:127], v32 offset:44832
    ds_read_b64_tr_b16 a[200:201], v32 offset:25664
    ds_read_b64_tr_b16 a[202:203], v32 offset:32064
    ds_read_b64_tr_b16 a[204:205], v32 offset:38464
    ds_read_b64_tr_b16 a[206:207], v32 offset:44864
    s_waitcnt vmcnt(18)
    ds_write_b128 v10, v[200:203] offset:0
    ds_write_b128 v11, v[204:207] offset:0
    ds_write_b128 v12, v[208:211] offset:0
    ds_write_b128 v13, v[212:215] offset:0
    ds_write_b128 v14, v[216:219] offset:0
    ds_write_b128 v15, v[220:223] offset:0
    s_waitcnt lgkmcnt(0)
    v_mfma_f32_16x16x32_bf16 v[16:19], a[40:43], v[28:31], v[16:19]
    v_mfma_f32_16x16x32_bf16 v[20:23], a[120:123], v[28:31], v[20:23]
    v_mfma_f32_16x16x32_bf16 v[24:27], a[200:203], v[28:31], v[24:27]
    v_mfma_f32_16x16x32_bf16 v[16:19], a[44:47], v[28:31], v[16:19]
    v_mfma_f32_16x16x32_bf16 v[20:23], a[124:127], v[28:31], v[20:23]
    v_mfma_f32_16x16x32_bf16 v[24:27], a[204:207], v[28:31], v[24:27]
    s_barrier
    ds_read_b64_tr_b16 a[48:49], v32 offset:0
    ds_read_b64_tr_b16 a[50:51], v32 offset:6400
    ds_read_b64_tr_b16 a[52:53], v32 offset:12800
    ds_read_b64_tr_b16 a[54:55], v32 offset:19200
    ds_read_b64_tr_b16 a[128:129], v32 offset:32
    ds_read_b64_tr_b16 a[130:131], v32 offset:6432
    ds_read_b64_tr_b16 a[132:133], v32 offset:12832
    ds_read_b64_tr_b16 a[134:135], v32 offset:19232
    ds_read_b64_tr_b16 a[208:209], v32 offset:64
    ds_read_b64_tr_b16 a[210:211], v32 offset:6464
    ds_read_b64_tr_b16 a[212:213], v32 offset:12864
    ds_read_b64_tr_b16 a[214:215], v32 offset:19264
    s_waitcnt vmcnt(12)
    ds_write_b128 v10, v[224:227] offset:25600
    ds_write_b128 v11, v[228:231] offset:25600
    ds_write_b128 v12, v[232:235] offset:25600
    ds_write_b128 v13, v[236:239] offset:25600
    ds_write_b128 v14, v[240:243] offset:25600
    ds_write_b128 v15, v[244:247] offset:25600
    s_waitcnt lgkmcnt(0)
    v_mfma_f32_16x16x32_bf16 v[16:19], a[48:51], v[28:31], v[16:19]
    v_mfma_f32_16x16x32_bf16 v[20:23], a[128:131], v[28:31], v[20:23]
    v_mfma_f32_16x16x32_bf16 v[24:27], a[208:211], v[28:31], v[24:27]
    v_mfma_f32_16x16x32_bf16 v[16:19], a[52:55], v[28:31], v[16:19]
    v_mfma_f32_16x16x32_bf16 v[20:23], a[132:135], v[28:31], v[20:23]
    v_mfma_f32_16x16x32_bf16 v[24:27], a[212:215], v[28:31], v[24:27]
    s_barrier
    ds_read_b64_tr_b16 a[56:57], v32 offset:25600
    ds_read_b64_tr_b16 a[58:59], v32 offset:32000
    ds_read_b64_tr_b16 a[60:61], v32 offset:38400
    ds_read_b64_tr_b16 a[62:63], v32 offset:44800
    ds_read_b64_tr_b16 a[136:137], v32 offset:25632
    ds_read_b64_tr_b16 a[138:139], v32 offset:32032
    ds_read_b64_tr_b16 a[140:141], v32 offset:38432
    ds_read_b64_tr_b16 a[142:143], v32 offset:44832
    ds_read_b64_tr_b16 a[216:217], v32 offset:25664
    ds_read_b64_tr_b16 a[218:219], v32 offset:32064
    ds_read_b64_tr_b16 a[220:221], v32 offset:38464
    ds_read_b64_tr_b16 a[222:223], v32 offset:44864
    s_waitcnt vmcnt(6)
    ds_write_b128 v10, v[56:59] offset:0
    ds_write_b128 v11, v[60:63] offset:0
    ds_write_b128 v12, v[64:67] offset:0
    ds_write_b128 v13, v[68:71] offset:0
    ds_write_b128 v14, v[72:75] offset:0
    ds_write_b128 v15, v[76:79] offset:0
    s_waitcnt lgkmcnt(0)
    v_mfma_f32_16x16x32_bf16 v[16:19], a[56:59], v[28:31], v[16:19]
    v_mfma_f32_16x16x32_bf16 v[20:23], a[136:139], v[28:31], v[20:23]
    v_mfma_f32_16x16x32_bf16 v[24:27], a[216:219], v[28:31], v[24:27]
    v_mfma_f32_16x16x32_bf16 v[16:19], a[60:63], v[28:31], v[16:19]
    v_mfma_f32_16x16x32_bf16 v[20:23], a[140:143], v[28:31], v[20:23]
    v_mfma_f32_16x16x32_bf16 v[24:27], a[220:223], v[28:31], v[24:27]
    s_barrier
    ds_read_b64_tr_b16 a[64:65], v32 offset:0
    ds_read_b64_tr_b16 a[66:67], v32 offset:6400
    ds_read_b64_tr_b16 a[68:69], v32 offset:12800
    ds_read_b64_tr_b16 a[70:71], v32 offset:19200
    ds_read_b64_tr_b16 a[144:145], v32 offset:32
    ds_read_b64_tr_b16 a[146:147], v32 offset:6432
    ds_read_b64_tr_b16 a[148:149], v32 offset:12832
    ds_read_b64_tr_b16 a[150:151], v32 offset:19232
    ds_read_b64_tr_b16 a[224:225], v32 offset:64
    ds_read_b64_tr_b16 a[226:227], v32 offset:6464
    ds_read_b64_tr_b16 a[228:229], v32 offset:12864
    ds_read_b64_tr_b16 a[230:231], v32 offset:19264
    s_waitcnt vmcnt(0)
    ds_write_b128 v10, v[80:83] offset:25600
    ds_write_b128 v11, v[84:87] offset:25600
    ds_write_b128 v12, v[88:91] offset:25600
    ds_write_b128 v13, v[92:95] offset:25600
    ds_write_b128 v14, v[96:99] offset:25600
    ds_write_b128 v15, v[100:103] offset:25600
    s_waitcnt lgkmcnt(0)
    v_mfma_f32_16x16x32_bf16 v[16:19], a[64:67], v[28:31], v[16:19]
    v_mfma_f32_16x16x32_bf16 v[20:23], a[144:147], v[28:31], v[20:23]
    v_mfma_f32_16x16x32_bf16 v[24:27], a[224:227], v[28:31], v[24:27]
    v_mfma_f32_16x16x32_bf16 v[16:19], a[68:71], v[28:31], v[16:19]
    v_mfma_f32_16x16x32_bf16 v[20:23], a[148:151], v[28:31], v[20:23]
    v_mfma_f32_16x16x32_bf16 v[24:27], a[228:231], v[28:31], v[24:27]
    s_barrier
    ds_read_b64_tr_b16 a[72:73], v32 offset:25600
    ds_read_b64_tr_b16 a[74:75], v32 offset:32000
    ds_read_b64_tr_b16 a[76:77], v32 offset:38400
    ds_read_b64_tr_b16 a[78:79], v32 offset:44800
    ds_read_b64_tr_b16 a[152:153], v32 offset:25632
    ds_read_b64_tr_b16 a[154:155], v32 offset:32032
    ds_read_b64_tr_b16 a[156:157], v32 offset:38432
    ds_read_b64_tr_b16 a[158:159], v32 offset:44832
    ds_read_b64_tr_b16 a[232:233], v32 offset:25664
    ds_read_b64_tr_b16 a[234:235], v32 offset:32064
    ds_read_b64_tr_b16 a[236:237], v32 offset:38464
    ds_read_b64_tr_b16 a[238:239], v32 offset:44864
    s_waitcnt lgkmcnt(0)
    v_mfma_f32_16x16x32_bf16 v[16:19], a[72:75], v[28:31], v[16:19]
    v_mfma_f32_16x16x32_bf16 v[20:23], a[152:155], v[28:31], v[20:23]
    v_mfma_f32_16x16x32_bf16 v[24:27], a[232:235], v[28:31], v[24:27]
    v_mfma_f32_16x16x32_bf16 v[16:19], a[76:79], v[28:31], v[16:19]
    v_mfma_f32_16x16x32_bf16 v[20:23], a[156:159], v[28:31], v[20:23]
    v_mfma_f32_16x16x32_bf16 v[24:27], a[236:239], v[28:31], v[24:27]
    s_nop 5
    v_mov_b32 v224, v16
    v_mov_b32 v225, v17
    v_mov_b32 v226, v18
    v_mov_b32 v227, v19
    v_mov_b32 v228, v20
    v_mov_b32 v229, v21
    v_mov_b32 v230, v22
    v_mov_b32 v231, v23
    v_mov_b32 v232, v24
    v_mov_b32 v233, v25
    v_mov_b32 v234, v26
    v_mov_b32 v235, v27
    v_mov_b32 v236, v28
    v_mov_b32 v237, v29
    v_mov_b32 v238, v30
    v_mov_b32 v239, v31
    s_barrier
interleave_layers__linear_attn_block__memory_aug_recurrent_mem_tr__prompt_kernel_p_layer:
    s_mul_i32 s93, s92, 29360128
    s_add_u32 s93, s93, 117440512
    s_mul_i32 s94, s92, 16384
    s_add_u32 s94, s94, 23068672
    s_sub_u32 s44, s2, 104
    s_lshr_b32 s46, s44, 5
    s_and_b32 s44, s44, 31
    s_mov_b32 s43, 67108864
    s_cmp_eq_u32 s46, 1
    s_cselect_b32 s43, 92274688, s43
    s_cmp_eq_u32 s46, 2
    s_cselect_b32 s43, 33554432, s43
    s_cmp_eq_u32 s92, 0
    s_cselect_b32 s73, 0, 8388608
    v_lshlrev_b32 v5, 4, v1
    s_mul_i32 s24, s3, 10240
    v_add_u32 v6, s24, v5
    v_add_u32 v7, 4096, v6
    v_add_u32 v8, 8192, v6
    s_mul_i32 s24, s44, 12288
    s_mul_i32 s25, s3, 3072
    s_add_u32 s24, s24, s25
    v_add_u32 v11, s24, v5
    s_lshr_b32 s24, s3, 1
    s_lshl_b32 s24, s24, 8
    s_and_b32 s25, s3, 1
    s_lshl_b32 s25, s25, 3
    s_add_u32 s24, s24, s25
    s_add_u32 s24, s24, 81920
    v_lshlrev_b32 v13, 4, v2
    v_add_u32 v12, s24, v13
    v_add_u32 v13, 81920, v13
    v_lshrrev_b32 v15, 2, v2
    v_cmp_eq_u32 vcc, v15, v3
    v_lshlrev_b32 v15, 3, v1
    v_add_u32 v15, 82944, v15
    v_cndmask_b32 v12, v15, v12, vcc
    v_and_b32 v15, 3, v2
    v_cmp_eq_u32 s[48:49], 1, v15
    v_cmp_eq_u32 s[50:51], 2, v15
    v_cmp_eq_u32 s[54:55], 3, v15
    s_and_b32 s24, s2, 7
    s_lshl_b32 s24, s24, 7
    s_lshl_b32 s25, s92, 10
    s_add_u32 s24, s24, s25
    s_add_u32 s24, s24, 23105536
    s_cmp_eq_u32 s92, 0
    s_cselect_b32 s25, 20, 5
    s_cselect_b32 s75, 2, 0
    s_cselect_b32 s74, 16, 64
    v_cmp_gt_u32 vcc, s25, v1
    s_nop 1
    v_cndmask_b32 v4, 0, v1, vcc
    v_lshlrev_b32 v4, 2, v4
    v_add_u32 v4, s24, v4
    s_lshl_b32 s24, s46, 12
    s_lshl_b32 s25, s44, 7
    s_add_u32 s24, s24, s25
    s_add_u32 s24, s24, s94
    v_mov_b32 v14, s24
    v_mov_b32 v15, 2146435072
    v_cmp_eq_u32 vcc, 0, v1
    s_nop 1
    v_cndmask_b32 v14, v15, v14, vcc
    s_cmp_eq_u32 s3, 0
    s_cselect_b32 s24, 0, 2146435072
    v_or_b32 v14, s24, v14
    s_sub_u32 s70, s2, 104
    s_mul_i32 s71, s70, 205
    s_lshr_b32 s71, s71, 12
    s_mul_i32 s24, s71, 20
    s_sub_u32 s70, s70, s24
    s_cmp_lt_u32 s71, 4
    s_cselect_b32 s64, s71, 64
    s_lshl_b32 s24, s70, 16
    s_lshl_b32 s25, s3, 13
    s_add_u32 s24, s24, s25
    v_add_u32 v240, s24, v5
    v_add_u32 v241, 4096, v240
    s_lshl_b32 s24, s70, 14
    s_lshl_b32 s25, s3, 11
    s_add_u32 s24, s24, s25
    v_add_u32 v242, s24, v5
    s_lshl_b32 s24, s3, 14
    v_add_u32 v193, s24, v5
    v_add_u32 v212, 0, v193
    v_add_u32 v213, 4096, v193
    v_add_u32 v214, 8192, v193
    v_add_u32 v215, 12288, v193
    s_lshl_b32 s24, s3, 12
    s_add_u32 s24, s24, 65536
    v_add_u32 v216, s24, v5
    s_lshl_b32 s24, s3, 12
    s_add_u32 s24, s24, 83968
    v_add_u32 v217, s24, v5
    s_and_b32 s24, s3, 1
    s_lshl_b32 s24, s24, 10
    s_add_u32 s24, s24, 83968
    v_add_u32 v218, s24, v5
    s_and_b32 s24, s3, 1
    s_mul_i32 s24, s24, 20480
    s_lshl_b32 s25, s70, 10
    s_add_u32 s24, s24, s25
    v_add_u32 v219, s24, v5
    s_and_b32 s24, s3, 1
    s_lshl_b32 s24, s24, 4
    v_add_u32 v243, s24, v2
    v_mul_u32_u24 v243, 1280, v243
    v_lshl_add_u32 v243, v3, 3, v243
    s_lshl_b32 s24, s70, 6
    v_add_u32 v243, s24, v243
    s_load_dwordx2 s[26:27], s[0:1], 80
    s_waitcnt lgkmcnt(0)
    s_mov_b32 s12, s26
    s_mov_b32 s13, s27
    s_mov_b32 s14, 2621440
    s_mov_b32 s15, 0x00020000
    s_mul_i32 s65, s71, 1310720
    s_add_u32 s65, s65, 184549376
    s_mul_i32 s24, s71, 458752
    s_add_u32 s24, s24, s93
    s_add_u32 s66, s24, 0
    s_add_u32 s67, s24, 327680
    s_mul_i32 s68, s71, 40960
    v_and_b32 v252, 7, v1
    v_lshlrev_b32 v252, 7, v252
    s_lshl_b32 s24, s3, 10
    s_add_u32 s24, s24, 12288
    s_add_u32 s24, s24, s94
    v_add_u32 v252, s24, v252
    s_mov_b32 s69, -1
    s_lshl_b32 s24, s71, 7
    s_lshl_b32 s25, s70, 2
    s_add_u32 s24, s24, s25
    s_add_u32 s24, s24, 23107584
    s_cmp_eq_u32 s3, 0
    s_cselect_b32 s24, s24, 2146435072
    v_mov_b32 v245, s24
    v_mov_b32 v246, 2146435072
    v_cmp_eq_u32 vcc, 0, v1
    s_nop 1
    v_cndmask_b32 v245, v246, v245, vcc
    s_mov_b32 s79, -1
    s_mov_b32 s76, -1
    s_mov_b32 s62, -1
    s_mov_b32 s63, 1
    s_cmp_ge_i32 s62, s63
    s_cbranch_scc1 interleave_layers__linear_attn_block__memory_aug_recurrent_mem_tr__prompt_kernel_p_en0_ok
    s_mov_b32 s61, 0
interleave_layers__linear_attn_block__memory_aug_recurrent_mem_tr__prompt_kernel_p_en0:
    buffer_load_dword v16, v4, s[8:11], 0 offen sc1
    s_waitcnt vmcnt(0)
    v_readlane_b32 s62, v16, 0
    v_readlane_b32 s24, v16, 1
    s_min_i32 s62, s62, s24
    v_readlane_b32 s24, v16, 2
    s_min_i32 s62, s62, s24
    v_readlane_b32 s24, v16, 3
    s_min_i32 s62, s62, s24
    v_readlane_b32 s24, v16, 4
    s_min_i32 s62, s62, s24
    v_readlane_b32 s24, v16, 5
    s_min_i32 s62, s62, s24
    v_readlane_b32 s24, v16, 6
    s_min_i32 s62, s62, s24
    v_readlane_b32 s24, v16, 7
    s_min_i32 s62, s62, s24
    v_readlane_b32 s24, v16, 8
    s_min_i32 s62, s62, s24
    v_readlane_b32 s24, v16, 9
    s_min_i32 s62, s62, s24
    v_readlane_b32 s24, v16, 10
    s_min_i32 s62, s62, s24
    v_readlane_b32 s24, v16, 11
    s_min_i32 s62, s62, s24
    v_readlane_b32 s24, v16, 12
    s_min_i32 s62, s62, s24
    v_readlane_b32 s24, v16, 13
    s_min_i32 s62, s62, s24
    v_readlane_b32 s24, v16, 14
    s_min_i32 s62, s62, s24
    v_readlane_b32 s24, v16, 15
    s_min_i32 s62, s62, s24
    v_readlane_b32 s24, v16, 16
    s_min_i32 s62, s62, s24
    v_readlane_b32 s24, v16, 17
    s_min_i32 s62, s62, s24
    v_readlane_b32 s24, v16, 18
    s_min_i32 s62, s62, s24
    v_readlane_b32 s24, v16, 19
    s_min_i32 s62, s62, s24
    s_cmp_ge_i32 s62, s63
    s_cbranch_scc1 interleave_layers__linear_attn_block__memory_aug_recurrent_mem_tr__prompt_kernel_p_en0_ok
    s_add_u32 s61, s61, 1
    s_cmp_ge_u32 s61, s60
    s_cbranch_scc1 interleave_layers__linear_attn_block__memory_aug_recurrent_mem_tr__prompt_kernel_p_en0_to
    s_sleep 2
    s_branch interleave_layers__linear_attn_block__memory_aug_recurrent_mem_tr__prompt_kernel_p_en0
interleave_layers__linear_attn_block__memory_aug_recurrent_mem_tr__prompt_kernel_p_en0_to:
    s_mov_b32 s60, 1
interleave_layers__linear_attn_block__memory_aug_recurrent_mem_tr__prompt_kernel_p_en0_ok:
    s_mov_b32 s41, s73
    buffer_load_dwordx4 v[16:19], v6, s[8:11], s41 offen offset:0
    buffer_load_dwordx4 v[20:23], v6, s[8:11], s41 offen offset:1024
    buffer_load_dwordx4 v[24:27], v6, s[8:11], s41 offen offset:2048
    buffer_load_dwordx4 v[28:31], v6, s[8:11], s41 offen offset:3072
    buffer_load_dwordx4 v[32:35], v7, s[8:11], s41 offen offset:0
    buffer_load_dwordx4 v[36:39], v7, s[8:11], s41 offen offset:1024
    buffer_load_dwordx4 v[40:43], v7, s[8:11], s41 offen offset:2048
    buffer_load_dwordx4 v[44:47], v7, s[8:11], s41 offen offset:3072
    buffer_load_dwordx4 v[48:51], v8, s[8:11], s41 offen offset:0
    buffer_load_dwordx4 v[52:55], v8, s[8:11], s41 offen offset:1024
    s_mov_b32 s40, 0
    s_mov_b32 s42, 0
    s_waitcnt vmcnt(0)
    v_mfma_f32_16x16x32_bf16 v[148:151], v[16:19], v[16:19], 0
    v_mfma_f32_16x16x32_bf16 v[144:147], v[236:239], v[16:19], 0
    v_mfma_f32_16x16x32_bf16 v[148:151], v[20:23], v[20:23], v[148:151]
    v_mfma_f32_16x16x32_bf16 v[144:147], v[236:239], v[20:23], v[144:147]
    v_mfma_f32_16x16x32_bf16 v[148:151], v[24:27], v[24:27], v[148:151]
    v_mfma_f32_16x16x32_bf16 v[144:147], v[236:239], v[24:27], v[144:147]
    v_mfma_f32_16x16x32_bf16 v[148:151], v[28:31], v[28:31], v[148:151]
    v_mfma_f32_16x16x32_bf16 v[144:147], v[236:239], v[28:31], v[144:147]
    v_mfma_f32_16x16x32_bf16 v[148:151], v[32:35], v[32:35], v[148:151]
    v_mfma_f32_16x16x32_bf16 v[144:147], v[236:239], v[32:35], v[144:147]
    v_mfma_f32_16x16x32_bf16 v[148:151], v[36:39], v[36:39], v[148:151]
    v_mfma_f32_16x16x32_bf16 v[144:147], v[236:239], v[36:39], v[144:147]
    v_mfma_f32_16x16x32_bf16 v[148:151], v[40:43], v[40:43], v[148:151]
    v_mfma_f32_16x16x32_bf16 v[144:147], v[236:239], v[40:43], v[144:147]
    v_mfma_f32_16x16x32_bf16 v[148:151], v[44:47], v[44:47], v[148:151]
    v_mfma_f32_16x16x32_bf16 v[144:147], v[236:239], v[44:47], v[144:147]
    v_mfma_f32_16x16x32_bf16 v[148:151], v[48:51], v[48:51], v[148:151]
    v_mfma_f32_16x16x32_bf16 v[144:147], v[236:239], v[48:51], v[144:147]
    v_mfma_f32_16x16x32_bf16 v[148:151], v[52:55], v[52:55], v[148:151]
    v_mfma_f32_16x16x32_bf16 v[144:147], v[236:239], v[52:55], v[144:147]
    ds_write_b128 v6, v[16:19] offset:0
    ds_write_b128 v6, v[20:23] offset:1024
    ds_write_b128 v6, v[24:27] offset:2048
    ds_write_b128 v6, v[28:31] offset:3072
    ds_write_b128 v6, v[32:35] offset:4096
    ds_write_b128 v6, v[36:39] offset:5120
    ds_write_b128 v6, v[40:43] offset:6144
    ds_write_b128 v6, v[44:47] offset:7168
    ds_write_b128 v6, v[48:51] offset:8192
    ds_write_b128 v6, v[52:55] offset:9216
    v_cndmask_b32 v145, v148, v149, s[48:49]
    v_cndmask_b32 v145, v145, v150, s[50:51]
    v_cndmask_b32 v145, v145, v151, s[54:55]
    ds_write_b64 v12, v[144:145]
    s_waitcnt lgkmcnt(0)
    s_barrier
    s_branch interleave_layers__linear_attn_block__memory_aug_recurrent_mem_tr__prompt_kernel_p_segA
interleave_layers__linear_attn_block__memory_aug_recurrent_mem_tr__prompt_kernel_p_pubA:
    s_waitcnt vmcnt(0)
    s_barrier
    s_cmp_eq_u32 s3, 0
    s_cbranch_scc0 interleave_layers__linear_attn_block__memory_aug_recurrent_mem_tr__prompt_kernel_fp30
    v_mov_b32 v15, s40
    buffer_store_dword v15, v14, s[8:11], 0 offen sc1
interleave_layers__linear_attn_block__memory_aug_recurrent_mem_tr__prompt_kernel_fp30:
interleave_layers__linear_attn_block__memory_aug_recurrent_mem_tr__prompt_kernel_p_segA:
    v_add_u32 v9, s42, v5
    s_xor_b32 s42, s42, 40960
    v_add_u32 v10, s42, v6
    s_and_b32 s24, s40, 1
    s_lshl_b32 s24, s24, 9
    v_add_u32 v124, s24, v13
    s_xor_b32 s24, s24, 512
    v_add_u32 v140, s24, v12
    ds_read_b128 v[112:115], v124
    ds_read_b128 v[116:119], v124 offset:256
    ds_read_b128 v[56:59], v9 offset:0
    ds_read_b128 v[60:63], v9 offset:20480
    ds_read_b128 v[64:67], v9 offset:1024
    ds_read_b128 v[68:71], v9 offset:21504
    ds_read_b128 v[72:75], v9 offset:2048
    ds_read_b128 v[76:79], v9 offset:22528
    ds_read_b128 v[80:83], v9 offset:3072
    ds_read_b128 v[84:87], v9 offset:23552
    s_waitcnt lgkmcnt(6)
    v_mfma_f32_16x16x32_bf16 v[88:91], a[0:3], v[56:59], 0
    v_add_f32 v112, v112, v114
    v_mfma_f32_16x16x32_bf16 v[92:95], a[80:83], v[56:59], 0
    v_add_f32 v113, v113, v115
    v_mfma_f32_16x16x32_bf16 v[96:99], a[160:163], v[56:59], 0
    v_mul_f32 v112, 0x3acccccd, v112
    v_mfma_f32_16x16x32_bf16 v[100:103], a[0:3], v[60:63], 0
    v_mul_f32 v114, v112, v112
    v_mfma_f32_16x16x32_bf16 v[104:107], a[80:83], v[60:63], 0
    v_mov_b32 v115, 0x3acccccd
    v_mfma_f32_16x16x32_bf16 v[108:111], a[160:163], v[60:63], 0
    v_fma_f32 v113, v113, v115, -v114
    ds_read_b128 v[56:59], v9 offset:4096
    ds_read_b128 v[60:63], v9 offset:24576
    s_waitcnt lgkmcnt(6)
    v_mfma_f32_16x16x32_bf16 v[88:91], a[4:7], v[64:67], v[88:91]
    v_max_f32 v113, 0, v113
    v_mfma_f32_16x16x32_bf16 v[92:95], a[84:87], v[64:67], v[92:95]
    v_add_f32 v113, 0x3727c5ac, v113
    v_mfma_f32_16x16x32_bf16 v[96:99], a[164:167], v[64:67], v[96:99]
    v_rsq_f32 v132, v113
    v_mfma_f32_16x16x32_bf16 v[100:103], a[4:7], v[68:71], v[100:103]
    v_mul_f32 v133, v112, v132
    v_mfma_f32_16x16x32_bf16 v[104:107], a[84:87], v[68:71], v[104:107]
    v_sub_f32 v133, 0, v133
    v_mfma_f32_16x16x32_bf16 v[108:111], a[164:167], v[68:71], v[108:111]
    v_add_f32 v116, v116, v118
    ds_read_b128 v[64:67], v9 offset:5120
    ds_read_b128 v[68:71], v9 offset:25600
    s_waitcnt lgkmcnt(6)
    v_mfma_f32_16x16x32_bf16 v[88:91], a[8:11], v[72:75], v[88:91]
    v_add_f32 v117, v117, v119
    v_mfma_f32_16x16x32_bf16 v[92:95], a[88:91], v[72:75], v[92:95]
    v_mul_f32 v116, 0x3acccccd, v116
    v_mfma_f32_16x16x32_bf16 v[96:99], a[168:171], v[72:75], v[96:99]
    v_mul_f32 v118, v116, v116
    v_mfma_f32_16x16x32_bf16 v[100:103], a[8:11], v[76:79], v[100:103]
    v_mov_b32 v119, 0x3acccccd
    v_mfma_f32_16x16x32_bf16 v[104:107], a[88:91], v[76:79], v[104:107]
    v_fma_f32 v117, v117, v119, -v118
    v_mfma_f32_16x16x32_bf16 v[108:111], a[168:171], v[76:79], v[108:111]
    v_max_f32 v117, 0, v117
    ds_read_b128 v[72:75], v9 offset:6144
    ds_read_b128 v[76:79], v9 offset:26624
    s_waitcnt lgkmcnt(6)
    v_mfma_f32_16x16x32_bf16 v[88:91], a[12:15], v[80:83], v[88:91]
    v_add_f32 v117, 0x3727c5ac, v117
    v_mfma_f32_16x16x32_bf16 v[92:95], a[92:95], v[80:83], v[92:95]
    v_rsq_f32 v134, v117
    v_mfma_f32_16x16x32_bf16 v[96:99], a[172:175], v[80:83], v[96:99]
    v_mul_f32 v135, v116, v134
    v_mfma_f32_16x16x32_bf16 v[100:103], a[12:15], v[84:87], v[100:103]
    v_sub_f32 v135, 0, v135
    v_mfma_f32_16x16x32_bf16 v[104:107], a[92:95], v[84:87], v[104:107]
    v_mfma_f32_16x16x32_bf16 v[108:111], a[172:175], v[84:87], v[108:111]
    ds_read_b128 v[80:83], v9 offset:7168
    ds_read_b128 v[84:87], v9 offset:27648
    s_waitcnt lgkmcnt(6)
    v_mfma_f32_16x16x32_bf16 v[88:91], a[16:19], v[56:59], v[88:91]
    v_mfma_f32_16x16x32_bf16 v[92:95], a[96:99], v[56:59], v[92:95]
    v_mfma_f32_16x16x32_bf16 v[96:99], a[176:179], v[56:59], v[96:99]
    v_mfma_f32_16x16x32_bf16 v[100:103], a[16:19], v[60:63], v[100:103]
    v_mfma_f32_16x16x32_bf16 v[104:107], a[96:99], v[60:63], v[104:107]
    v_mfma_f32_16x16x32_bf16 v[108:111], a[176:179], v[60:63], v[108:111]
    ds_read_b128 v[56:59], v9 offset:8192
    ds_read_b128 v[60:63], v9 offset:28672
    s_waitcnt lgkmcnt(6)
    v_mfma_f32_16x16x32_bf16 v[88:91], a[20:23], v[64:67], v[88:91]
    v_mfma_f32_16x16x32_bf16 v[92:95], a[100:103], v[64:67], v[92:95]
    v_mfma_f32_16x16x32_bf16 v[96:99], a[180:183], v[64:67], v[96:99]
    v_mfma_f32_16x16x32_bf16 v[100:103], a[20:23], v[68:71], v[100:103]
    v_mfma_f32_16x16x32_bf16 v[104:107], a[100:103], v[68:71], v[104:107]
    v_mfma_f32_16x16x32_bf16 v[108:111], a[180:183], v[68:71], v[108:111]
    ds_read_b128 v[64:67], v9 offset:9216
    ds_read_b128 v[68:71], v9 offset:29696
    s_waitcnt lgkmcnt(6)
    v_mfma_f32_16x16x32_bf16 v[88:91], a[24:27], v[72:75], v[88:91]
    v_mfma_f32_16x16x32_bf16 v[92:95], a[104:107], v[72:75], v[92:95]
    v_mfma_f32_16x16x32_bf16 v[96:99], a[184:187], v[72:75], v[96:99]
    v_mfma_f32_16x16x32_bf16 v[100:103], a[24:27], v[76:79], v[100:103]
    v_mfma_f32_16x16x32_bf16 v[104:107], a[104:107], v[76:79], v[104:107]
    v_mfma_f32_16x16x32_bf16 v[108:111], a[184:187], v[76:79], v[108:111]
    ds_read_b128 v[72:75], v9 offset:10240
    ds_read_b128 v[76:79], v9 offset:30720
    s_waitcnt lgkmcnt(6)
    v_mfma_f32_16x16x32_bf16 v[88:91], a[28:31], v[80:83], v[88:91]
    v_mfma_f32_16x16x32_bf16 v[92:95], a[108:111], v[80:83], v[92:95]
    v_mfma_f32_16x16x32_bf16 v[96:99], a[188:191], v[80:83], v[96:99]
    v_mfma_f32_16x16x32_bf16 v[100:103], a[28:31], v[84:87], v[100:103]
    v_mfma_f32_16x16x32_bf16 v[104:107], a[108:111], v[84:87], v[104:107]
    v_mfma_f32_16x16x32_bf16 v[108:111], a[188:191], v[84:87], v[108:111]
    ds_read_b128 v[80:83], v9 offset:11264
    ds_read_b128 v[84:87], v9 offset:31744
    s_waitcnt lgkmcnt(6)
    v_mfma_f32_16x16x32_bf16 v[88:91], a[32:35], v[56:59], v[88:91]
    v_mfma_f32_16x16x32_bf16 v[92:95], a[112:115], v[56:59], v[92:95]
    v_mfma_f32_16x16x32_bf16 v[96:99], a[192:195], v[56:59], v[96:99]
    v_mfma_f32_16x16x32_bf16 v[100:103], a[32:35], v[60:63], v[100:103]
    v_mfma_f32_16x16x32_bf16 v[104:107], a[112:115], v[60:63], v[104:107]
    v_mfma_f32_16x16x32_bf16 v[108:111], a[192:195], v[60:63], v[108:111]
    ds_read_b128 v[56:59], v9 offset:12288
    ds_read_b128 v[60:63], v9 offset:32768
    s_waitcnt lgkmcnt(6)
    v_mfma_f32_16x16x32_bf16 v[88:91], a[36:39], v[64:67], v[88:91]
    v_mfma_f32_16x16x32_bf16 v[92:95], a[116:119], v[64:67], v[92:95]
    v_mfma_f32_16x16x32_bf16 v[96:99], a[196:199], v[64:67], v[96:99]
    v_mfma_f32_16x16x32_bf16 v[100:103], a[36:39], v[68:71], v[100:103]
    v_mfma_f32_16x16x32_bf16 v[104:107], a[116:119], v[68:71], v[104:107]
    v_mfma_f32_16x16x32_bf16 v[108:111], a[196:199], v[68:71], v[108:111]
    ds_read_b128 v[64:67], v9 offset:13312
    ds_read_b128 v[68:71], v9 offset:33792
    s_waitcnt lgkmcnt(6)
    v_mfma_f32_16x16x32_bf16 v[88:91], a[40:43], v[72:75], v[88:91]
    v_mfma_f32_16x16x32_bf16 v[92:95], a[120:123], v[72:75], v[92:95]
    v_mfma_f32_16x16x32_bf16 v[96:99], a[200:203], v[72:75], v[96:99]
    v_mfma_f32_16x16x32_bf16 v[100:103], a[40:43], v[76:79], v[100:103]
    v_mfma_f32_16x16x32_bf16 v[104:107], a[120:123], v[76:79], v[104:107]
    v_mfma_f32_16x16x32_bf16 v[108:111], a[200:203], v[76:79], v[108:111]
    ds_read_b128 v[72:75], v9 offset:14336
    ds_read_b128 v[76:79], v9 offset:34816
    s_waitcnt lgkmcnt(6)
    v_mfma_f32_16x16x32_bf16 v[88:91], a[44:47], v[80:83], v[88:91]
    v_mfma_f32_16x16x32_bf16 v[92:95], a[124:127], v[80:83], v[92:95]
    v_mfma_f32_16x16x32_bf16 v[96:99], a[204:207], v[80:83], v[96:99]
    v_mfma_f32_16x16x32_bf16 v[100:103], a[44:47], v[84:87], v[100:103]
    v_mfma_f32_16x16x32_bf16 v[104:107], a[124:127], v[84:87], v[104:107]
    v_mfma_f32_16x16x32_bf16 v[108:111], a[204:207], v[84:87], v[108:111]
    ds_read_b128 v[80:83], v9 offset:15360
    ds_read_b128 v[84:87], v9 offset:35840
    s_waitcnt lgkmcnt(6)
    v_mfma_f32_16x16x32_bf16 v[88:91], a[48:51], v[56:59], v[88:91]
    v_mfma_f32_16x16x32_bf16 v[92:95], a[128:131], v[56:59], v[92:95]
    v_mfma_f32_16x16x32_bf16 v[96:99], a[208:211], v[56:59], v[96:99]
    v_mfma_f32_16x16x32_bf16 v[100:103], a[48:51], v[60:63], v[100:103]
    v_mfma_f32_16x16x32_bf16 v[104:107], a[128:131], v[60:63], v[104:107]
    v_mfma_f32_16x16x32_bf16 v[108:111], a[208:211], v[60:63], v[108:111]
    ds_read_b128 v[56:59], v9 offset:16384
    ds_read_b128 v[60:63], v9 offset:36864
    s_waitcnt lgkmcnt(6)
    v_mfma_f32_16x16x32_bf16 v[88:91], a[52:55], v[64:67], v[88:91]
    v_mfma_f32_16x16x32_bf16 v[92:95], a[132:135], v[64:67], v[92:95]
    v_mfma_f32_16x16x32_bf16 v[96:99], a[212:215], v[64:67], v[96:99]
    v_mfma_f32_16x16x32_bf16 v[100:103], a[52:55], v[68:71], v[100:103]
    v_mfma_f32_16x16x32_bf16 v[104:107], a[132:135], v[68:71], v[104:107]
    v_mfma_f32_16x16x32_bf16 v[108:111], a[212:215], v[68:71], v[108:111]
    ds_read_b128 v[64:67], v9 offset:17408
    ds_read_b128 v[68:71], v9 offset:37888
    s_waitcnt lgkmcnt(6)
    v_mfma_f32_16x16x32_bf16 v[88:91], a[56:59], v[72:75], v[88:91]
    v_mfma_f32_16x16x32_bf16 v[92:95], a[136:139], v[72:75], v[92:95]
    v_mfma_f32_16x16x32_bf16 v[96:99], a[216:219], v[72:75], v[96:99]
    v_mfma_f32_16x16x32_bf16 v[100:103], a[56:59], v[76:79], v[100:103]
    v_mfma_f32_16x16x32_bf16 v[104:107], a[136:139], v[76:79], v[104:107]
    v_mfma_f32_16x16x32_bf16 v[108:111], a[216:219], v[76:79], v[108:111]
    ds_read_b128 v[72:75], v9 offset:18432
    ds_read_b128 v[76:79], v9 offset:38912
    s_waitcnt lgkmcnt(6)
    v_mfma_f32_16x16x32_bf16 v[88:91], a[60:63], v[80:83], v[88:91]
    v_mfma_f32_16x16x32_bf16 v[92:95], a[140:143], v[80:83], v[92:95]
    v_mfma_f32_16x16x32_bf16 v[96:99], a[220:223], v[80:83], v[96:99]
    v_mfma_f32_16x16x32_bf16 v[100:103], a[60:63], v[84:87], v[100:103]
    v_mfma_f32_16x16x32_bf16 v[104:107], a[140:143], v[84:87], v[104:107]
    v_mfma_f32_16x16x32_bf16 v[108:111], a[220:223], v[84:87], v[108:111]
    ds_read_b128 v[80:83], v9 offset:19456
    ds_read_b128 v[84:87], v9 offset:39936
    s_waitcnt lgkmcnt(6)
    v_mfma_f32_16x16x32_bf16 v[88:91], a[64:67], v[56:59], v[88:91]
    v_mfma_f32_16x16x32_bf16 v[92:95], a[144:147], v[56:59], v[92:95]
    v_mfma_f32_16x16x32_bf16 v[96:99], a[224:227], v[56:59], v[96:99]
    v_mfma_f32_16x16x32_bf16 v[100:103], a[64:67], v[60:63], v[100:103]
    v_mfma_f32_16x16x32_bf16 v[104:107], a[144:147], v[60:63], v[104:107]
    v_mfma_f32_16x16x32_bf16 v[108:111], a[224:227], v[60:63], v[108:111]
    s_waitcnt lgkmcnt(4)
    v_mfma_f32_16x16x32_bf16 v[88:91], a[68:71], v[64:67], v[88:91]
    v_mfma_f32_16x16x32_bf16 v[92:95], a[148:151], v[64:67], v[92:95]
    v_mfma_f32_16x16x32_bf16 v[96:99], a[228:231], v[64:67], v[96:99]
    v_mfma_f32_16x16x32_bf16 v[100:103], a[68:71], v[68:71], v[100:103]
    v_mfma_f32_16x16x32_bf16 v[104:107], a[148:151], v[68:71], v[104:107]
    v_mfma_f32_16x16x32_bf16 v[108:111], a[228:231], v[68:71], v[108:111]
    s_waitcnt lgkmcnt(2)
    v_mfma_f32_16x16x32_bf16 v[88:91], a[72:75], v[72:75], v[88:91]
    v_mfma_f32_16x16x32_bf16 v[92:95], a[152:155], v[72:75], v[92:95]
    v_mfma_f32_16x16x32_bf16 v[96:99], a[232:235], v[72:75], v[96:99]
    v_mfma_f32_16x16x32_bf16 v[100:103], a[72:75], v[76:79], v[100:103]
    v_mfma_f32_16x16x32_bf16 v[104:107], a[152:155], v[76:79], v[104:107]
    v_mfma_f32_16x16x32_bf16 v[108:111], a[232:235], v[76:79], v[108:111]
    s_waitcnt lgkmcnt(0)
    v_mfma_f32_16x16x32_bf16 v[88:91], a[76:79], v[80:83], v[88:91]
    v_mfma_f32_16x16x32_bf16 v[92:95], a[156:159], v[80:83], v[92:95]
    v_mfma_f32_16x16x32_bf16 v[96:99], a[236:239], v[80:83], v[96:99]
    v_mfma_f32_16x16x32_bf16 v[100:103], a[76:79], v[84:87], v[100:103]
    v_mfma_f32_16x16x32_bf16 v[104:107], a[156:159], v[84:87], v[104:107]
    v_mfma_f32_16x16x32_bf16 v[108:111], a[236:239], v[84:87], v[108:111]
    v_pk_mul_f32 v[124:125], v[224:225], v[132:133] op_sel:[0,1] op_sel_hi:[1,1]
    v_pk_mul_f32 v[126:127], v[226:227], v[132:133] op_sel:[0,1] op_sel_hi:[1,1]
    s_nop 0
    v_pk_fma_f32 v[88:89], v[88:89], v[132:133], v[124:125] op_sel:[0,0,0] op_sel_hi:[1,0,1]
    v_pk_fma_f32 v[90:91], v[90:91], v[132:133], v[126:127] op_sel:[0,0,0] op_sel_hi:[1,0,1]
    v_pk_mul_f32 v[124:125], v[228:229], v[132:133] op_sel:[0,1] op_sel_hi:[1,1]
    v_pk_mul_f32 v[126:127], v[230:231], v[132:133] op_sel:[0,1] op_sel_hi:[1,1]
    v_pk_fma_f32 v[92:93], v[92:93], v[132:133], v[124:125] op_sel:[0,0,0] op_sel_hi:[1,0,1]
    v_pk_fma_f32 v[94:95], v[94:95], v[132:133], v[126:127] op_sel:[0,0,0] op_sel_hi:[1,0,1]
    v_pk_mul_f32 v[124:125], v[232:233], v[132:133] op_sel:[0,1] op_sel_hi:[1,1]
    v_pk_mul_f32 v[126:127], v[234:235], v[132:133] op_sel:[0,1] op_sel_hi:[1,1]
    v_pk_fma_f32 v[96:97], v[96:97], v[132:133], v[124:125] op_sel:[0,0,0] op_sel_hi:[1,0,1]
    v_pk_fma_f32 v[98:99], v[98:99], v[132:133], v[126:127] op_sel:[0,0,0] op_sel_hi:[1,0,1]
    v_pk_mul_f32 v[124:125], v[224:225], v[134:135] op_sel:[0,1] op_sel_hi:[1,1]
    v_pk_mul_f32 v[126:127], v[226:227], v[134:135] op_sel:[0,1] op_sel_hi:[1,1]
    v_pk_fma_f32 v[100:101], v[100:101], v[134:135], v[124:125] op_sel:[0,0,0] op_sel_hi:[1,0,1]
    v_pk_fma_f32 v[102:103], v[102:103], v[134:135], v[126:127] op_sel:[0,0,0] op_sel_hi:[1,0,1]
    v_pk_mul_f32 v[124:125], v[228:229], v[134:135] op_sel:[0,1] op_sel_hi:[1,1]
    v_pk_mul_f32 v[126:127], v[230:231], v[134:135] op_sel:[0,1] op_sel_hi:[1,1]
    v_pk_fma_f32 v[104:105], v[104:105], v[134:135], v[124:125] op_sel:[0,0,0] op_sel_hi:[1,0,1]
    v_pk_fma_f32 v[106:107], v[106:107], v[134:135], v[126:127] op_sel:[0,0,0] op_sel_hi:[1,0,1]
    v_pk_mul_f32 v[124:125], v[232:233], v[134:135] op_sel:[0,1] op_sel_hi:[1,1]
    v_pk_mul_f32 v[126:127], v[234:235], v[134:135] op_sel:[0,1] op_sel_hi:[1,1]
    v_pk_fma_f32 v[108:109], v[108:109], v[134:135], v[124:125] op_sel:[0,0,0] op_sel_hi:[1,0,1]
    v_pk_fma_f32 v[110:111], v[110:111], v[134:135], v[126:127] op_sel:[0,0,0] op_sel_hi:[1,0,1]
    v_cvt_pk_bf16_f32 v112, v88, v89
    v_cvt_pk_bf16_f32 v113, v90, v91
    v_cvt_pk_bf16_f32 v114, v92, v93
    v_cvt_pk_bf16_f32 v115, v94, v95
    v_cvt_pk_bf16_f32 v116, v100, v101
    v_cvt_pk_bf16_f32 v117, v102, v103
    v_cvt_pk_bf16_f32 v118, v104, v105
    v_cvt_pk_bf16_f32 v119, v106, v107
    v_cvt_pk_bf16_f32 v120, v96, v97
    v_cvt_pk_bf16_f32 v121, v98, v99
    v_cvt_pk_bf16_f32 v122, v108, v109
    v_cvt_pk_bf16_f32 v123, v110, v111
    buffer_store_dwordx4 v[112:115], v11, s[8:11], s43 offen offset:0 sc1
    buffer_store_dwordx4 v[116:119], v11, s[8:11], s43 offen offset:1024 sc1
    buffer_store_dwordx4 v[120:123], v11, s[8:11], s43 offen offset:2048 sc1
    s_add_u32 s43, s43, 393216
    s_waitcnt vmcnt(0)
    s_barrier
    s_add_u32 s24, s40, 1
    v_mov_b32 v15, s24
    buffer_store_dword v15, v14, s[8:11], 0 offen sc1
    s_add_u32 s63, s40, 1
    s_lshr_b32 s63, s63, s75
    s_add_u32 s63, s63, 1
    s_min_u32 s63, s63, s74
    s_cmp_ge_i32 s62, s63
    s_cbranch_scc1 interleave_layers__linear_attn_block__memory_aug_recurrent_mem_tr__prompt_kernel_p_enA_ok
    s_mov_b32 s61, 0
interleave_layers__linear_attn_block__memory_aug_recurrent_mem_tr__prompt_kernel_p_enA:
    buffer_load_dword v16, v4, s[8:11], 0 offen sc1
    s_waitcnt vmcnt(0)
    v_readlane_b32 s62, v16, 0
    v_readlane_b32 s24, v16, 1
    s_min_i32 s62, s62, s24
    v_readlane_b32 s24, v16, 2
    s_min_i32 s62, s62, s24
    v_readlane_b32 s24, v16, 3
    s_min_i32 s62, s62, s24
    v_readlane_b32 s24, v16, 4
    s_min_i32 s62, s62, s24
    v_readlane_b32 s24, v16, 5
    s_min_i32 s62, s62, s24
    v_readlane_b32 s24, v16, 6
    s_min_i32 s62, s62, s24
    v_readlane_b32 s24, v16, 7
    s_min_i32 s62, s62, s24
    v_readlane_b32 s24, v16, 8
    s_min_i32 s62, s62, s24
    v_readlane_b32 s24, v16, 9
    s_min_i32 s62, s62, s24
    v_readlane_b32 s24, v16, 10
    s_min_i32 s62, s62, s24
    v_readlane_b32 s24, v16, 11
    s_min_i32 s62, s62, s24
    v_readlane_b32 s24, v16, 12
    s_min_i32 s62, s62, s24
    v_readlane_b32 s24, v16, 13
    s_min_i32 s62, s62, s24
    v_readlane_b32 s24, v16, 14
    s_min_i32 s62, s62, s24
    v_readlane_b32 s24, v16, 15
    s_min_i32 s62, s62, s24
    v_readlane_b32 s24, v16, 16
    s_min_i32 s62, s62, s24
    v_readlane_b32 s24, v16, 17
    s_min_i32 s62, s62, s24
    v_readlane_b32 s24, v16, 18
    s_min_i32 s62, s62, s24
    v_readlane_b32 s24, v16, 19
    s_min_i32 s62, s62, s24
    s_cmp_ge_i32 s62, s63
    s_cbranch_scc1 interleave_layers__linear_attn_block__memory_aug_recurrent_mem_tr__prompt_kernel_p_enA_ok
    s_add_u32 s61, s61, 1
    s_cmp_ge_u32 s61, s60
    s_cbranch_scc1 interleave_layers__linear_attn_block__memory_aug_recurrent_mem_tr__prompt_kernel_p_enA_to
    s_sleep 2
    s_branch interleave_layers__linear_attn_block__memory_aug_recurrent_mem_tr__prompt_kernel_p_enA
interleave_layers__linear_attn_block__memory_aug_recurrent_mem_tr__prompt_kernel_p_enA_to:
    s_mov_b32 s60, 1
interleave_layers__linear_attn_block__memory_aug_recurrent_mem_tr__prompt_kernel_p_enA_ok:
    s_add_u32 s41, s41, 40960
    buffer_load_dwordx4 v[16:19], v6, s[8:11], s41 offen offset:0
    buffer_load_dwordx4 v[20:23], v6, s[8:11], s41 offen offset:1024
    buffer_load_dwordx4 v[24:27], v6, s[8:11], s41 offen offset:2048
    buffer_load_dwordx4 v[28:31], v6, s[8:11], s41 offen offset:3072
    buffer_load_dwordx4 v[32:35], v7, s[8:11], s41 offen offset:0
    buffer_load_dwordx4 v[36:39], v7, s[8:11], s41 offen offset:1024
    buffer_load_dwordx4 v[40:43], v7, s[8:11], s41 offen offset:2048
    buffer_load_dwordx4 v[44:47], v7, s[8:11], s41 offen offset:3072
    buffer_load_dwordx4 v[48:51], v8, s[8:11], s41 offen offset:0
    buffer_load_dwordx4 v[52:55], v8, s[8:11], s41 offen offset:1024
    buffer_load_dword v152, v4, s[8:11], 0 offen sc1
    s_waitcnt vmcnt(0)
    v_mfma_f32_16x16x32_bf16 v[148:151], v[16:19], v[16:19], 0
    v_mfma_f32_16x16x32_bf16 v[144:147], v[236:239], v[16:19], 0
    v_mfma_f32_16x16x32_bf16 v[148:151], v[20:23], v[20:23], v[148:151]
    v_mfma_f32_16x16x32_bf16 v[144:147], v[236:239], v[20:23], v[144:147]
    v_mfma_f32_16x16x32_bf16 v[148:151], v[24:27], v[24:27], v[148:151]
    v_mfma_f32_16x16x32_bf16 v[144:147], v[236:239], v[24:27], v[144:147]
    v_mfma_f32_16x16x32_bf16 v[148:151], v[28:31], v[28:31], v[148:151]
    v_mfma_f32_16x16x32_bf16 v[144:147], v[236:239], v[28:31], v[144:147]
    v_mfma_f32_16x16x32_bf16 v[148:151], v[32:35], v[32:35], v[148:151]
    v_mfma_f32_16x16x32_bf16 v[144:147], v[236:239], v[32:35], v[144:147]
    v_mfma_f32_16x16x32_bf16 v[148:151], v[36:39], v[36:39], v[148:151]
    v_mfma_f32_16x16x32_bf16 v[144:147], v[236:239], v[36:39], v[144:147]
    v_mfma_f32_16x16x32_bf16 v[148:151], v[40:43], v[40:43], v[148:151]
    v_mfma_f32_16x16x32_bf16 v[144:147], v[236:239], v[40:43], v[144:147]
    v_mfma_f32_16x16x32_bf16 v[148:151], v[44:47], v[44:47], v[148:151]
    v_mfma_f32_16x16x32_bf16 v[144:147], v[236:239], v[44:47], v[144:147]
    v_mfma_f32_16x16x32_bf16 v[148:151], v[48:51], v[48:51], v[148:151]
    v_mfma_f32_16x16x32_bf16 v[144:147], v[236:239], v[48:51], v[144:147]
    v_mfma_f32_16x16x32_bf16 v[148:151], v[52:55], v[52:55], v[148:151]
    v_mfma_f32_16x16x32_bf16 v[144:147], v[236:239], v[52:55], v[144:147]
    ds_write_b128 v10, v[16:19] offset:0
    ds_write_b128 v10, v[20:23] offset:1024
    ds_write_b128 v10, v[24:27] offset:2048
    ds_write_b128 v10, v[28:31] offset:3072
    ds_write_b128 v10, v[32:35] offset:4096
    ds_write_b128 v10, v[36:39] offset:5120
    ds_write_b128 v10, v[40:43] offset:6144
    ds_write_b128 v10, v[44:47] offset:7168
    ds_write_b128 v10, v[48:51] offset:8192
    ds_write_b128 v10, v[52:55] offset:9216
    v_cndmask_b32 v145, v148, v149, s[48:49]
    v_cndmask_b32 v145, v145, v150, s[50:51]
    v_cndmask_b32 v145, v145, v151, s[54:55]
    ds_write_b64 v140, v[144:145]
    s_add_u32 s40, s40, 1
    s_add_u32 s63, s40, 1
    s_lshr_b32 s63, s63, s75
    s_add_u32 s63, s63, 1
    s_min_u32 s63, s63, s74
    v_cmp_le_i32 vcc, s63, v152
    s_cmp_eq_u64 vcc, -1
    s_cselect_b32 s58, 1, 0
    s_cmp_ge_i32 s62, s63
    s_cselect_b32 s58, 1, s58
    s_and_b32 s24, s40, 1
    s_lshl_b32 s24, s24, 2
    s_add_u32 s24, s24, 83456
    s_lshl_b32 s25, s3, 4
    s_add_u32 s25, s25, s24
    v_mov_b32 v15, s25
    v_mov_b32 v152, s58
    ds_write_b32 v15, v152
    v_mov_b32 v15, s24
    s_waitcnt lgkmcnt(0)
    s_barrier
    ds_read_b32 v152, v15
    s_waitcnt lgkmcnt(0)
    v_readfirstlane_b32 s58, v152
    s_cmp_eq_u32 s58, 1
    s_cselect_b32 s24, s63, s62
    s_max_i32 s62, s62, s24
    s_branch interleave_layers__linear_attn_block__memory_aug_recurrent_mem_tr__prompt_kernel_p_next
interleave_layers__linear_attn_block__memory_aug_recurrent_mem_tr__prompt_kernel_p_seg:
    v_add_u32 v9, s42, v5
    s_xor_b32 s42, s42, 40960
    v_add_u32 v10, s42, v6
    s_add_u32 s63, s40, 1
    s_lshr_b32 s63, s63, s75
    s_add_u32 s63, s63, 1
    s_min_u32 s63, s63, s74
    s_cmp_ge_i32 s62, s63
    s_cbranch_scc1 interleave_layers__linear_attn_block__memory_aug_recurrent_mem_tr__prompt_kernel_p_en_ok
    s_mov_b32 s61, 0
interleave_layers__linear_attn_block__memory_aug_recurrent_mem_tr__prompt_kernel_p_en:
    buffer_load_dword v16, v4, s[8:11], 0 offen sc1
    s_waitcnt vmcnt(0)
    v_readlane_b32 s62, v16, 0
    v_readlane_b32 s24, v16, 1
    s_min_i32 s62, s62, s24
    v_readlane_b32 s24, v16, 2
    s_min_i32 s62, s62, s24
    v_readlane_b32 s24, v16, 3
    s_min_i32 s62, s62, s24
    v_readlane_b32 s24, v16, 4
    s_min_i32 s62, s62, s24
    v_readlane_b32 s24, v16, 5
    s_min_i32 s62, s62, s24
    v_readlane_b32 s24, v16, 6
    s_min_i32 s62, s62, s24
    v_readlane_b32 s24, v16, 7
    s_min_i32 s62, s62, s24
    v_readlane_b32 s24, v16, 8
    s_min_i32 s62, s62, s24
    v_readlane_b32 s24, v16, 9
    s_min_i32 s62, s62, s24
    v_readlane_b32 s24, v16, 10
    s_min_i32 s62, s62, s24
    v_readlane_b32 s24, v16, 11
    s_min_i32 s62, s62, s24
    v_readlane_b32 s24, v16, 12
    s_min_i32 s62, s62, s24
    v_readlane_b32 s24, v16, 13
    s_min_i32 s62, s62, s24
    v_readlane_b32 s24, v16, 14
    s_min_i32 s62, s62, s24
    v_readlane_b32 s24, v16, 15
    s_min_i32 s62, s62, s24
    v_readlane_b32 s24, v16, 16
    s_min_i32 s62, s62, s24
    v_readlane_b32 s24, v16, 17
    s_min_i32 s62, s62, s24
    v_readlane_b32 s24, v16, 18
    s_min_i32 s62, s62, s24
    v_readlane_b32 s24, v16, 19
    s_min_i32 s62, s62, s24
    s_cmp_ge_i32 s62, s63
    s_cbranch_scc1 interleave_layers__linear_attn_block__memory_aug_recurrent_mem_tr__prompt_kernel_p_en_ok
    s_add_u32 s61, s61, 1
    s_cmp_ge_u32 s61, s60
    s_cbranch_scc1 interleave_layers__linear_attn_block__memory_aug_recurrent_mem_tr__prompt_kernel_p_en_to
    s_sleep 2
    s_branch interleave_layers__linear_attn_block__memory_aug_recurrent_mem_tr__prompt_kernel_p_en
interleave_layers__linear_attn_block__memory_aug_recurrent_mem_tr__prompt_kernel_p_en_to:
    s_mov_b32 s60, 1
interleave_layers__linear_attn_block__memory_aug_recurrent_mem_tr__prompt_kernel_p_en_ok:
    s_add_u32 s41, s41, 40960
    buffer_load_dwordx4 v[16:19], v6, s[8:11], s41 offen offset:0
    buffer_load_dwordx4 v[20:23], v6, s[8:11], s41 offen offset:1024
    buffer_load_dwordx4 v[24:27], v6, s[8:11], s41 offen offset:2048
    buffer_load_dwordx4 v[28:31], v6, s[8:11], s41 offen offset:3072
    buffer_load_dwordx4 v[32:35], v7, s[8:11], s41 offen offset:0
    buffer_load_dwordx4 v[36:39], v7, s[8:11], s41 offen offset:1024
    buffer_load_dwordx4 v[40:43], v7, s[8:11], s41 offen offset:2048
    buffer_load_dwordx4 v[44:47], v7, s[8:11], s41 offen offset:3072
    buffer_load_dwordx4 v[48:51], v8, s[8:11], s41 offen offset:0
    buffer_load_dwordx4 v[52:55], v8, s[8:11], s41 offen offset:1024
    s_and_b32 s24, s40, 1
    s_lshl_b32 s24, s24, 9
    v_add_u32 v124, s24, v13
    s_xor_b32 s24, s24, 512
    v_add_u32 v140, s24, v12
    ds_read_b128 v[112:115], v124
    ds_read_b128 v[116:119], v124 offset:256
    ds_read_b128 v[56:59], v9 offset:0
    ds_read_b128 v[60:63], v9 offset:20480
    ds_read_b128 v[64:67], v9 offset:1024
    ds_read_b128 v[68:71], v9 offset:21504
    ds_read_b128 v[72:75], v9 offset:2048
    ds_read_b128 v[76:79], v9 offset:22528
    ds_read_b128 v[80:83], v9 offset:3072
    ds_read_b128 v[84:87], v9 offset:23552
    s_waitcnt lgkmcnt(6)
    v_mfma_f32_16x16x32_bf16 v[88:91], a[0:3], v[56:59], 0
    v_add_f32 v112, v112, v114
    v_mfma_f32_16x16x32_bf16 v[92:95], a[80:83], v[56:59], 0
    v_add_f32 v113, v113, v115
    v_mfma_f32_16x16x32_bf16 v[96:99], a[160:163], v[56:59], 0
    v_mul_f32 v112, 0x3acccccd, v112
    v_mfma_f32_16x16x32_bf16 v[100:103], a[0:3], v[60:63], 0
    v_mul_f32 v114, v112, v112
    v_mfma_f32_16x16x32_bf16 v[104:107], a[80:83], v[60:63], 0
    v_mov_b32 v115, 0x3acccccd
    v_mfma_f32_16x16x32_bf16 v[108:111], a[160:163], v[60:63], 0
    v_fma_f32 v113, v113, v115, -v114
    ds_read_b128 v[56:59], v9 offset:4096
    ds_read_b128 v[60:63], v9 offset:24576
    s_waitcnt lgkmcnt(6)
    v_mfma_f32_16x16x32_bf16 v[88:91], a[4:7], v[64:67], v[88:91]
    v_max_f32 v113, 0, v113
    v_mfma_f32_16x16x32_bf16 v[92:95], a[84:87], v[64:67], v[92:95]
    v_add_f32 v113, 0x3727c5ac, v113
    v_mfma_f32_16x16x32_bf16 v[96:99], a[164:167], v[64:67], v[96:99]
    v_rsq_f32 v132, v113
    v_mfma_f32_16x16x32_bf16 v[100:103], a[4:7], v[68:71], v[100:103]
    v_mul_f32 v133, v112, v132
    v_mfma_f32_16x16x32_bf16 v[104:107], a[84:87], v[68:71], v[104:107]
    v_sub_f32 v133, 0, v133
    v_mfma_f32_16x16x32_bf16 v[108:111], a[164:167], v[68:71], v[108:111]
    v_add_f32 v116, v116, v118
    ds_read_b128 v[64:67], v9 offset:5120
    ds_read_b128 v[68:71], v9 offset:25600
    s_waitcnt lgkmcnt(6)
    v_mfma_f32_16x16x32_bf16 v[88:91], a[8:11], v[72:75], v[88:91]
    v_add_f32 v117, v117, v119
    v_mfma_f32_16x16x32_bf16 v[92:95], a[88:91], v[72:75], v[92:95]
    v_mul_f32 v116, 0x3acccccd, v116
    v_mfma_f32_16x16x32_bf16 v[96:99], a[168:171], v[72:75], v[96:99]
    v_mul_f32 v118, v116, v116
    v_mfma_f32_16x16x32_bf16 v[100:103], a[8:11], v[76:79], v[100:103]
    v_mov_b32 v119, 0x3acccccd
    v_mfma_f32_16x16x32_bf16 v[104:107], a[88:91], v[76:79], v[104:107]
    v_fma_f32 v117, v117, v119, -v118
    v_mfma_f32_16x16x32_bf16 v[108:111], a[168:171], v[76:79], v[108:111]
    v_max_f32 v117, 0, v117
    ds_read_b128 v[72:75], v9 offset:6144
    ds_read_b128 v[76:79], v9 offset:26624
    s_waitcnt lgkmcnt(6)
    v_mfma_f32_16x16x32_bf16 v[88:91], a[12:15], v[80:83], v[88:91]
    v_add_f32 v117, 0x3727c5ac, v117
    v_mfma_f32_16x16x32_bf16 v[92:95], a[92:95], v[80:83], v[92:95]
    v_rsq_f32 v134, v117
    v_mfma_f32_16x16x32_bf16 v[96:99], a[172:175], v[80:83], v[96:99]
    v_mul_f32 v135, v116, v134
    v_mfma_f32_16x16x32_bf16 v[100:103], a[12:15], v[84:87], v[100:103]
    v_sub_f32 v135, 0, v135
    v_mfma_f32_16x16x32_bf16 v[104:107], a[92:95], v[84:87], v[104:107]
    v_mfma_f32_16x16x32_bf16 v[108:111], a[172:175], v[84:87], v[108:111]
    ds_read_b128 v[80:83], v9 offset:7168
    ds_read_b128 v[84:87], v9 offset:27648
    s_waitcnt lgkmcnt(6)
    v_mfma_f32_16x16x32_bf16 v[88:91], a[16:19], v[56:59], v[88:91]
    v_mfma_f32_16x16x32_bf16 v[92:95], a[96:99], v[56:59], v[92:95]
    v_mfma_f32_16x16x32_bf16 v[96:99], a[176:179], v[56:59], v[96:99]
    v_mfma_f32_16x16x32_bf16 v[100:103], a[16:19], v[60:63], v[100:103]
    v_mfma_f32_16x16x32_bf16 v[104:107], a[96:99], v[60:63], v[104:107]
    v_mfma_f32_16x16x32_bf16 v[108:111], a[176:179], v[60:63], v[108:111]
    ds_read_b128 v[56:59], v9 offset:8192
    ds_read_b128 v[60:63], v9 offset:28672
    s_waitcnt lgkmcnt(6)
    v_mfma_f32_16x16x32_bf16 v[88:91], a[20:23], v[64:67], v[88:91]
    v_mfma_f32_16x16x32_bf16 v[92:95], a[100:103], v[64:67], v[92:95]
    v_mfma_f32_16x16x32_bf16 v[96:99], a[180:183], v[64:67], v[96:99]
    v_mfma_f32_16x16x32_bf16 v[100:103], a[20:23], v[68:71], v[100:103]
    v_mfma_f32_16x16x32_bf16 v[104:107], a[100:103], v[68:71], v[104:107]
    v_mfma_f32_16x16x32_bf16 v[108:111], a[180:183], v[68:71], v[108:111]
    ds_read_b128 v[64:67], v9 offset:9216
    ds_read_b128 v[68:71], v9 offset:29696
    s_waitcnt lgkmcnt(6)
    v_mfma_f32_16x16x32_bf16 v[88:91], a[24:27], v[72:75], v[88:91]
    v_mfma_f32_16x16x32_bf16 v[92:95], a[104:107], v[72:75], v[92:95]
    v_mfma_f32_16x16x32_bf16 v[96:99], a[184:187], v[72:75], v[96:99]
    v_mfma_f32_16x16x32_bf16 v[100:103], a[24:27], v[76:79], v[100:103]
    v_mfma_f32_16x16x32_bf16 v[104:107], a[104:107], v[76:79], v[104:107]
    v_mfma_f32_16x16x32_bf16 v[108:111], a[184:187], v[76:79], v[108:111]
    ds_read_b128 v[72:75], v9 offset:10240
    ds_read_b128 v[76:79], v9 offset:30720
    s_waitcnt lgkmcnt(6)
    v_mfma_f32_16x16x32_bf16 v[88:91], a[28:31], v[80:83], v[88:91]
    v_mfma_f32_16x16x32_bf16 v[92:95], a[108:111], v[80:83], v[92:95]
    v_mfma_f32_16x16x32_bf16 v[96:99], a[188:191], v[80:83], v[96:99]
    v_mfma_f32_16x16x32_bf16 v[100:103], a[28:31], v[84:87], v[100:103]
    v_mfma_f32_16x16x32_bf16 v[104:107], a[108:111], v[84:87], v[104:107]
    v_mfma_f32_16x16x32_bf16 v[108:111], a[188:191], v[84:87], v[108:111]
    ds_read_b128 v[80:83], v9 offset:11264
    ds_read_b128 v[84:87], v9 offset:31744
    s_waitcnt lgkmcnt(6)
    v_mfma_f32_16x16x32_bf16 v[88:91], a[32:35], v[56:59], v[88:91]
    v_mfma_f32_16x16x32_bf16 v[92:95], a[112:115], v[56:59], v[92:95]
    v_mfma_f32_16x16x32_bf16 v[96:99], a[192:195], v[56:59], v[96:99]
    v_mfma_f32_16x16x32_bf16 v[100:103], a[32:35], v[60:63], v[100:103]
    v_mfma_f32_16x16x32_bf16 v[104:107], a[112:115], v[60:63], v[104:107]
    v_mfma_f32_16x16x32_bf16 v[108:111], a[192:195], v[60:63], v[108:111]
    ds_read_b128 v[56:59], v9 offset:12288
    ds_read_b128 v[60:63], v9 offset:32768
    s_waitcnt lgkmcnt(6)
    v_mfma_f32_16x16x32_bf16 v[88:91], a[36:39], v[64:67], v[88:91]
    v_mfma_f32_16x16x32_bf16 v[92:95], a[116:119], v[64:67], v[92:95]
    v_mfma_f32_16x16x32_bf16 v[96:99], a[196:199], v[64:67], v[96:99]
    v_mfma_f32_16x16x32_bf16 v[100:103], a[36:39], v[68:71], v[100:103]
    v_mfma_f32_16x16x32_bf16 v[104:107], a[116:119], v[68:71], v[104:107]
    v_mfma_f32_16x16x32_bf16 v[108:111], a[196:199], v[68:71], v[108:111]
    s_waitcnt vmcnt(10)
    s_barrier
    v_mov_b32 v15, s40
    buffer_store_dword v15, v14, s[8:11], 0 offen sc1
    s_cmp_ge_i32 s79, 0
    s_cselect_b32 s24, 0, 2146435072
    v_or_b32 v246, s24, v245
    v_mov_b32 v247, s79
    buffer_store_dword v247, v246, s[8:11], 0 offen sc1
    s_mov_b32 s79, -1
    buffer_load_dword v152, v4, s[8:11], 0 offen sc1
    ds_read_b128 v[64:67], v9 offset:13312
    ds_read_b128 v[68:71], v9 offset:33792
    s_waitcnt lgkmcnt(6)
    v_mfma_f32_16x16x32_bf16 v[88:91], a[40:43], v[72:75], v[88:91]
    v_mfma_f32_16x16x32_bf16 v[92:95], a[120:123], v[72:75], v[92:95]
    v_mfma_f32_16x16x32_bf16 v[96:99], a[200:203], v[72:75], v[96:99]
    v_mfma_f32_16x16x32_bf16 v[100:103], a[40:43], v[76:79], v[100:103]
    v_mfma_f32_16x16x32_bf16 v[104:107], a[120:123], v[76:79], v[104:107]
    v_mfma_f32_16x16x32_bf16 v[108:111], a[200:203], v[76:79], v[108:111]
    ds_read_b128 v[72:75], v9 offset:14336
    ds_read_b128 v[76:79], v9 offset:34816
    s_waitcnt lgkmcnt(6)
    s_waitcnt vmcnt(3)
    v_mfma_f32_16x16x32_bf16 v[88:91], a[44:47], v[80:83], v[88:91]
    v_mfma_f32_16x16x32_bf16 v[92:95], a[124:127], v[80:83], v[92:95]
    ds_write_b128 v10, v[16:19] offset:0
    v_mfma_f32_16x16x32_bf16 v[96:99], a[204:207], v[80:83], v[96:99]
    v_mfma_f32_16x16x32_bf16 v[100:103], a[44:47], v[84:87], v[100:103]
    v_mfma_f32_16x16x32_bf16 v[104:107], a[124:127], v[84:87], v[104:107]
    v_mfma_f32_16x16x32_bf16 v[108:111], a[204:207], v[84:87], v[108:111]
    v_mfma_f32_16x16x32_bf16 v[148:151], v[16:19], v[16:19], 0
    v_mfma_f32_16x16x32_bf16 v[144:147], v[236:239], v[16:19], 0
    v_mfma_f32_16x16x32_bf16 v[148:151], v[20:23], v[20:23], v[148:151]
    ds_read_b128 v[80:83], v9 offset:15360
    ds_read_b128 v[84:87], v9 offset:35840
    s_waitcnt lgkmcnt(7)
    v_mfma_f32_16x16x32_bf16 v[88:91], a[48:51], v[56:59], v[88:91]
    v_mfma_f32_16x16x32_bf16 v[92:95], a[128:131], v[56:59], v[92:95]
    ds_write_b128 v10, v[20:23] offset:1024
    v_mfma_f32_16x16x32_bf16 v[96:99], a[208:211], v[56:59], v[96:99]
    v_mfma_f32_16x16x32_bf16 v[100:103], a[48:51], v[60:63], v[100:103]
    v_mfma_f32_16x16x32_bf16 v[104:107], a[128:131], v[60:63], v[104:107]
    v_mfma_f32_16x16x32_bf16 v[108:111], a[208:211], v[60:63], v[108:111]
    v_mfma_f32_16x16x32_bf16 v[144:147], v[236:239], v[20:23], v[144:147]
    v_mfma_f32_16x16x32_bf16 v[148:151], v[24:27], v[24:27], v[148:151]
    v_mfma_f32_16x16x32_bf16 v[144:147], v[236:239], v[24:27], v[144:147]
    ds_read_b128 v[56:59], v9 offset:16384
    ds_read_b128 v[60:63], v9 offset:36864
    s_waitcnt lgkmcnt(8)
    v_mfma_f32_16x16x32_bf16 v[88:91], a[52:55], v[64:67], v[88:91]
    v_mfma_f32_16x16x32_bf16 v[92:95], a[132:135], v[64:67], v[92:95]
    ds_write_b128 v10, v[24:27] offset:2048
    v_mfma_f32_16x16x32_bf16 v[96:99], a[212:215], v[64:67], v[96:99]
    v_mfma_f32_16x16x32_bf16 v[100:103], a[52:55], v[68:71], v[100:103]
    v_mfma_f32_16x16x32_bf16 v[104:107], a[132:135], v[68:71], v[104:107]
    v_mfma_f32_16x16x32_bf16 v[108:111], a[212:215], v[68:71], v[108:111]
    v_mfma_f32_16x16x32_bf16 v[148:151], v[28:31], v[28:31], v[148:151]
    v_mfma_f32_16x16x32_bf16 v[144:147], v[236:239], v[28:31], v[144:147]
    v_mfma_f32_16x16x32_bf16 v[148:151], v[32:35], v[32:35], v[148:151]
    ds_read_b128 v[64:67], v9 offset:17408
    ds_read_b128 v[68:71], v9 offset:37888
    s_waitcnt lgkmcnt(9)
    v_mfma_f32_16x16x32_bf16 v[88:91], a[56:59], v[72:75], v[88:91]
    v_mfma_f32_16x16x32_bf16 v[92:95], a[136:139], v[72:75], v[92:95]
    ds_write_b128 v10, v[28:31] offset:3072
    v_mfma_f32_16x16x32_bf16 v[96:99], a[216:219], v[72:75], v[96:99]
    v_mfma_f32_16x16x32_bf16 v[100:103], a[56:59], v[76:79], v[100:103]
    v_mfma_f32_16x16x32_bf16 v[104:107], a[136:139], v[76:79], v[104:107]
    v_mfma_f32_16x16x32_bf16 v[108:111], a[216:219], v[76:79], v[108:111]
    v_mfma_f32_16x16x32_bf16 v[144:147], v[236:239], v[32:35], v[144:147]
    v_mfma_f32_16x16x32_bf16 v[148:151], v[36:39], v[36:39], v[148:151]
    v_mfma_f32_16x16x32_bf16 v[144:147], v[236:239], v[36:39], v[144:147]
    ds_read_b128 v[72:75], v9 offset:18432
    ds_read_b128 v[76:79], v9 offset:38912
    s_waitcnt lgkmcnt(9)
    v_mfma_f32_16x16x32_bf16 v[88:91], a[60:63], v[80:83], v[88:91]
    v_mfma_f32_16x16x32_bf16 v[92:95], a[140:143], v[80:83], v[92:95]
    ds_write_b128 v10, v[32:35] offset:4096
    v_mfma_f32_16x16x32_bf16 v[96:99], a[220:223], v[80:83], v[96:99]
    v_mfma_f32_16x16x32_bf16 v[100:103], a[60:63], v[84:87], v[100:103]
    v_mfma_f32_16x16x32_bf16 v[104:107], a[140:143], v[84:87], v[104:107]
    v_mfma_f32_16x16x32_bf16 v[108:111], a[220:223], v[84:87], v[108:111]
    v_mfma_f32_16x16x32_bf16 v[148:151], v[40:43], v[40:43], v[148:151]
    v_mfma_f32_16x16x32_bf16 v[144:147], v[236:239], v[40:43], v[144:147]
    v_mfma_f32_16x16x32_bf16 v[148:151], v[44:47], v[44:47], v[148:151]
    ds_read_b128 v[80:83], v9 offset:19456
    ds_read_b128 v[84:87], v9 offset:39936
    s_waitcnt lgkmcnt(9)
    v_mfma_f32_16x16x32_bf16 v[88:91], a[64:67], v[56:59], v[88:91]
    v_mfma_f32_16x16x32_bf16 v[92:95], a[144:147], v[56:59], v[92:95]
    ds_write_b128 v10, v[36:39] offset:5120
    v_mfma_f32_16x16x32_bf16 v[96:99], a[224:227], v[56:59], v[96:99]
    v_mfma_f32_16x16x32_bf16 v[100:103], a[64:67], v[60:63], v[100:103]
    v_mfma_f32_16x16x32_bf16 v[104:107], a[144:147], v[60:63], v[104:107]
    v_mfma_f32_16x16x32_bf16 v[108:111], a[224:227], v[60:63], v[108:111]
    v_mfma_f32_16x16x32_bf16 v[144:147], v[236:239], v[44:47], v[144:147]
    v_mfma_f32_16x16x32_bf16 v[148:151], v[48:51], v[48:51], v[148:151]
    v_mfma_f32_16x16x32_bf16 v[144:147], v[236:239], v[48:51], v[144:147]
    s_waitcnt lgkmcnt(7)
    v_mfma_f32_16x16x32_bf16 v[88:91], a[68:71], v[64:67], v[88:91]
    v_mfma_f32_16x16x32_bf16 v[92:95], a[148:151], v[64:67], v[92:95]
    ds_write_b128 v10, v[40:43] offset:6144
    v_mfma_f32_16x16x32_bf16 v[96:99], a[228:231], v[64:67], v[96:99]
    v_mfma_f32_16x16x32_bf16 v[100:103], a[68:71], v[68:71], v[100:103]
    v_mfma_f32_16x16x32_bf16 v[104:107], a[148:151], v[68:71], v[104:107]
    v_mfma_f32_16x16x32_bf16 v[108:111], a[228:231], v[68:71], v[108:111]
    v_mfma_f32_16x16x32_bf16 v[148:151], v[52:55], v[52:55], v[148:151]
    v_mfma_f32_16x16x32_bf16 v[144:147], v[236:239], v[52:55], v[144:147]
    s_waitcnt lgkmcnt(5)
    v_mfma_f32_16x16x32_bf16 v[88:91], a[72:75], v[72:75], v[88:91]
    v_mfma_f32_16x16x32_bf16 v[92:95], a[152:155], v[72:75], v[92:95]
    ds_write_b128 v10, v[44:47] offset:7168
    v_mfma_f32_16x16x32_bf16 v[96:99], a[232:235], v[72:75], v[96:99]
    v_mfma_f32_16x16x32_bf16 v[100:103], a[72:75], v[76:79], v[100:103]
    v_mfma_f32_16x16x32_bf16 v[104:107], a[152:155], v[76:79], v[104:107]
    v_mfma_f32_16x16x32_bf16 v[108:111], a[232:235], v[76:79], v[108:111]
    s_waitcnt lgkmcnt(3)
    v_mfma_f32_16x16x32_bf16 v[88:91], a[76:79], v[80:83], v[88:91]
    v_mfma_f32_16x16x32_bf16 v[92:95], a[156:159], v[80:83], v[92:95]
    ds_write_b128 v10, v[48:51] offset:8192
    v_mfma_f32_16x16x32_bf16 v[96:99], a[236:239], v[80:83], v[96:99]
    v_mfma_f32_16x16x32_bf16 v[100:103], a[76:79], v[84:87], v[100:103]
    v_mfma_f32_16x16x32_bf16 v[104:107], a[156:159], v[84:87], v[104:107]
    v_mfma_f32_16x16x32_bf16 v[108:111], a[236:239], v[84:87], v[108:111]
    v_cndmask_b32 v145, v148, v149, s[48:49]
    v_cndmask_b32 v145, v145, v150, s[50:51]
    v_cndmask_b32 v145, v145, v151, s[54:55]
    ds_write_b128 v10, v[52:55] offset:9216
    ds_write_b64 v140, v[144:145]
    v_pk_mul_f32 v[124:125], v[224:225], v[132:133] op_sel:[0,1] op_sel_hi:[1,1]
    v_pk_mul_f32 v[126:127], v[226:227], v[132:133] op_sel:[0,1] op_sel_hi:[1,1]
    v_pk_fma_f32 v[88:89], v[88:89], v[132:133], v[124:125] op_sel:[0,0,0] op_sel_hi:[1,0,1]
    v_pk_fma_f32 v[90:91], v[90:91], v[132:133], v[126:127] op_sel:[0,0,0] op_sel_hi:[1,0,1]
    v_pk_mul_f32 v[124:125], v[228:229], v[132:133] op_sel:[0,1] op_sel_hi:[1,1]
    v_pk_mul_f32 v[126:127], v[230:231], v[132:133] op_sel:[0,1] op_sel_hi:[1,1]
    v_pk_fma_f32 v[92:93], v[92:93], v[132:133], v[124:125] op_sel:[0,0,0] op_sel_hi:[1,0,1]
    v_pk_fma_f32 v[94:95], v[94:95], v[132:133], v[126:127] op_sel:[0,0,0] op_sel_hi:[1,0,1]
    v_pk_mul_f32 v[124:125], v[232:233], v[132:133] op_sel:[0,1] op_sel_hi:[1,1]
    v_pk_mul_f32 v[126:127], v[234:235], v[132:133] op_sel:[0,1] op_sel_hi:[1,1]
    v_pk_fma_f32 v[96:97], v[96:97], v[132:133], v[124:125] op_sel:[0,0,0] op_sel_hi:[1,0,1]
    v_pk_fma_f32 v[98:99], v[98:99], v[132:133], v[126:127] op_sel:[0,0,0] op_sel_hi:[1,0,1]
    v_pk_mul_f32 v[124:125], v[224:225], v[134:135] op_sel:[0,1] op_sel_hi:[1,1]
    v_pk_mul_f32 v[126:127], v[226:227], v[134:135] op_sel:[0,1] op_sel_hi:[1,1]
    v_pk_fma_f32 v[100:101], v[100:101], v[134:135], v[124:125] op_sel:[0,0,0] op_sel_hi:[1,0,1]
    v_pk_fma_f32 v[102:103], v[102:103], v[134:135], v[126:127] op_sel:[0,0,0] op_sel_hi:[1,0,1]
    v_pk_mul_f32 v[124:125], v[228:229], v[134:135] op_sel:[0,1] op_sel_hi:[1,1]
    v_pk_mul_f32 v[126:127], v[230:231], v[134:135] op_sel:[0,1] op_sel_hi:[1,1]
    v_pk_fma_f32 v[104:105], v[104:105], v[134:135], v[124:125] op_sel:[0,0,0] op_sel_hi:[1,0,1]
    v_pk_fma_f32 v[106:107], v[106:107], v[134:135], v[126:127] op_sel:[0,0,0] op_sel_hi:[1,0,1]
    v_pk_mul_f32 v[124:125], v[232:233], v[134:135] op_sel:[0,1] op_sel_hi:[1,1]
    v_pk_mul_f32 v[126:127], v[234:235], v[134:135] op_sel:[0,1] op_sel_hi:[1,1]
    v_pk_fma_f32 v[108:109], v[108:109], v[134:135], v[124:125] op_sel:[0,0,0] op_sel_hi:[1,0,1]
    v_pk_fma_f32 v[110:111], v[110:111], v[134:135], v[126:127] op_sel:[0,0,0] op_sel_hi:[1,0,1]
    v_cvt_pk_bf16_f32 v112, v88, v89
    v_cvt_pk_bf16_f32 v113, v90, v91
    v_cvt_pk_bf16_f32 v114, v92, v93
    v_cvt_pk_bf16_f32 v115, v94, v95
    v_cvt_pk_bf16_f32 v116, v100, v101
    v_cvt_pk_bf16_f32 v117, v102, v103
    v_cvt_pk_bf16_f32 v118, v104, v105
    v_cvt_pk_bf16_f32 v119, v106, v107
    v_cvt_pk_bf16_f32 v120, v96, v97
    v_cvt_pk_bf16_f32 v121, v98, v99
    v_cvt_pk_bf16_f32 v122, v108, v109
    v_cvt_pk_bf16_f32 v123, v110, v111
    buffer_store_dwordx4 v[112:115], v11, s[8:11], s43 offen offset:0 sc1
    buffer_store_dwordx4 v[116:119], v11, s[8:11], s43 offen offset:1024 sc1
    buffer_store_dwordx4 v[120:123], v11, s[8:11], s43 offen offset:2048 sc1
    s_add_u32 s43, s43, 393216
    s_waitcnt vmcnt(3)
    s_add_u32 s40, s40, 1
    s_add_u32 s63, s40, 1
    s_lshr_b32 s63, s63, s75
    s_add_u32 s63, s63, 1
    s_min_u32 s63, s63, s74
    v_cmp_le_i32 vcc, s63, v152
    s_cmp_eq_u64 vcc, -1
    s_cselect_b32 s58, 1, 0
    s_cmp_ge_i32 s62, s63
    s_cselect_b32 s58, 1, s58
    s_and_b32 s24, s40, 1
    s_lshl_b32 s24, s24, 2
    s_add_u32 s24, s24, 83456
    s_lshl_b32 s25, s3, 4
    s_add_u32 s25, s25, s24
    v_mov_b32 v15, s25
    v_mov_b32 v152, s58
    ds_write_b32 v15, v152
    v_mov_b32 v15, s24
    s_waitcnt lgkmcnt(0)
    s_barrier
    ds_read_b32 v152, v15
    s_waitcnt lgkmcnt(0)
    v_readfirstlane_b32 s58, v152
    s_cmp_eq_u32 s58, 1
    s_cselect_b32 s24, s63, s62
    s_max_i32 s62, s62, s24
interleave_layers__linear_attn_block__memory_aug_recurrent_mem_tr__prompt_kernel_p_next:
    s_add_u32 s24, s64, 8
    s_cmp_le_u32 s24, s40
    s_cbranch_scc1 interleave_layers__linear_attn_block__memory_aug_recurrent_mem_tr__prompt_kernel_p_pub
    s_cmp_lt_u32 s40, 64
    s_cbranch_scc0 interleave_layers__linear_attn_block__memory_aug_recurrent_mem_tr__prompt_kernel_pg31
    s_cmp_eq_u32 s58, 1
    s_cbranch_scc1 interleave_layers__linear_attn_block__memory_aug_recurrent_mem_tr__prompt_kernel_p_seg
    s_branch interleave_layers__linear_attn_block__memory_aug_recurrent_mem_tr__prompt_kernel_p_pubA
interleave_layers__linear_attn_block__memory_aug_recurrent_mem_tr__prompt_kernel_pg31:
interleave_layers__linear_attn_block__memory_aug_recurrent_mem_tr__prompt_kernel_p_pub:
    s_waitcnt vmcnt(0)
    s_barrier
    s_cmp_eq_u32 s3, 0
    s_cbranch_scc0 interleave_layers__linear_attn_block__memory_aug_recurrent_mem_tr__prompt_kernel_fp32
    v_mov_b32 v15, s40
    buffer_store_dword v15, v14, s[8:11], 0 offen sc1
interleave_layers__linear_attn_block__memory_aug_recurrent_mem_tr__prompt_kernel_fp32:
    s_add_u32 s24, s64, 8
    s_cmp_le_u32 s24, s40
    s_cbranch_scc1 interleave_layers__linear_attn_block__memory_aug_recurrent_mem_tr__prompt_kernel_p_x
    s_cmp_lt_u32 s40, 64
    s_cbranch_scc0 interleave_layers__linear_attn_block__memory_aug_recurrent_mem_tr__prompt_kernel_pg33
    s_cmp_eq_u32 s58, 1
    s_cbranch_scc1 interleave_layers__linear_attn_block__memory_aug_recurrent_mem_tr__prompt_kernel_p_seg
    s_branch interleave_layers__linear_attn_block__memory_aug_recurrent_mem_tr__prompt_kernel_p_pubA
interleave_layers__linear_attn_block__memory_aug_recurrent_mem_tr__prompt_kernel_pg33:
    s_cmp_ge_u32 s64, 64
    s_cbranch_scc1 interleave_layers__linear_attn_block__memory_aug_recurrent_mem_tr__prompt_kernel_p_done
interleave_layers__linear_attn_block__memory_aug_recurrent_mem_tr__prompt_kernel_p_x:
    s_add_u32 s63, s64, 1
    s_cmp_ge_i32 s69, s63
    s_cbranch_scc1 interleave_layers__linear_attn_block__memory_aug_recurrent_mem_tr__prompt_kernel_x_en_ok
    s_mov_b32 s61, 0
interleave_layers__linear_attn_block__memory_aug_recurrent_mem_tr__prompt_kernel_x_en:
    buffer_load_dword v253, v252, s[8:11], 0 offen sc1
    s_waitcnt vmcnt(0)
    v_readlane_b32 s69, v253, 0
    v_readlane_b32 s24, v253, 1
    s_min_i32 s69, s69, s24
    v_readlane_b32 s24, v253, 2
    s_min_i32 s69, s69, s24
    v_readlane_b32 s24, v253, 3
    s_min_i32 s69, s69, s24
    v_readlane_b32 s24, v253, 4
    s_min_i32 s69, s69, s24
    v_readlane_b32 s24, v253, 5
    s_min_i32 s69, s69, s24
    v_readlane_b32 s24, v253, 6
    s_min_i32 s69, s69, s24
    v_readlane_b32 s24, v253, 7
    s_min_i32 s69, s69, s24
    s_cmp_ge_i32 s69, s63
    s_cbranch_scc1 interleave_layers__linear_attn_block__memory_aug_recurrent_mem_tr__prompt_kernel_x_en_ok
    s_add_u32 s61, s61, 1
    s_cmp_ge_u32 s61, s60
    s_cbranch_scc1 interleave_layers__linear_attn_block__memory_aug_recurrent_mem_tr__prompt_kernel_x_en_to
    s_sleep 2
    s_branch interleave_layers__linear_attn_block__memory_aug_recurrent_mem_tr__prompt_kernel_x_en
interleave_layers__linear_attn_block__memory_aug_recurrent_mem_tr__prompt_kernel_x_en_to:
    s_mov_b32 s60, 1
interleave_layers__linear_attn_block__memory_aug_recurrent_mem_tr__prompt_kernel_x_en_ok:
    s_lshl_b32 s95, s92, 6
    s_add_u32 s95, s95, s64
    s_add_u32 s95, s95, 1
    s_cmp_ge_i32 s59, s95
    s_cbranch_scc1 interleave_layers__linear_attn_block__memory_aug_recurrent_mem_tr__prompt_kernel_x_ec_ok
    s_and_b32 s24, s2, 7
    s_lshl_b32 s24, s24, 7
    s_add_u32 s24, s24, 23109632
    v_and_b32 v254, 3, v1
    v_lshl_add_u32 v254, v254, 2, s24
    s_mov_b32 s61, 0
interleave_layers__linear_attn_block__memory_aug_recurrent_mem_tr__prompt_kernel_x_ec:
    buffer_load_dword v253, v254, s[8:11], 0 offen sc1
    s_waitcnt vmcnt(0)
    v_readlane_b32 s59, v253, 0
    v_readlane_b32 s24, v253, 1
    s_min_i32 s59, s59, s24
    v_readlane_b32 s24, v253, 2
    s_min_i32 s59, s59, s24
    s_cmp_ge_i32 s59, s95
    s_cbranch_scc1 interleave_layers__linear_attn_block__memory_aug_recurrent_mem_tr__prompt_kernel_x_ec_ok
    s_add_u32 s61, s61, 1
    s_cmp_ge_u32 s61, s60
    s_cbranch_scc1 interleave_layers__linear_attn_block__memory_aug_recurrent_mem_tr__prompt_kernel_x_ec_to
    s_sleep 2
    s_branch interleave_layers__linear_attn_block__memory_aug_recurrent_mem_tr__prompt_kernel_x_ec
interleave_layers__linear_attn_block__memory_aug_recurrent_mem_tr__prompt_kernel_x_ec_to:
    s_mov_b32 s60, 1
interleave_layers__linear_attn_block__memory_aug_recurrent_mem_tr__prompt_kernel_x_ec_ok:
    s_add_u32 s52, s65, 32768
    buffer_load_dwordx4 v[16:19], v240, s[8:11], s65 offen offset:0 sc1
    buffer_load_dwordx4 v[20:23], v240, s[8:11], s65 offen offset:1024 sc1
    buffer_load_dwordx4 v[24:27], v240, s[8:11], s65 offen offset:2048 sc1
    buffer_load_dwordx4 v[28:31], v240, s[8:11], s65 offen offset:3072 sc1
    buffer_load_dwordx4 v[32:35], v241, s[8:11], s65 offen offset:0 sc1
    buffer_load_dwordx4 v[36:39], v241, s[8:11], s65 offen offset:1024 sc1
    buffer_load_dwordx4 v[40:43], v241, s[8:11], s65 offen offset:2048 sc1
    buffer_load_dwordx4 v[44:47], v241, s[8:11], s65 offen offset:3072 sc1
    buffer_load_dwordx4 v[48:51], v240, s[8:11], s52 offen offset:0 sc1
    buffer_load_dwordx4 v[52:55], v240, s[8:11], s52 offen offset:1024 sc1
    buffer_load_dwordx4 v[56:59], v240, s[8:11], s52 offen offset:2048 sc1
    buffer_load_dwordx4 v[60:63], v240, s[8:11], s52 offen offset:3072 sc1
    buffer_load_dwordx4 v[64:67], v241, s[8:11], s52 offen offset:0 sc1
    buffer_load_dwordx4 v[68:71], v241, s[8:11], s52 offen offset:1024 sc1
    buffer_load_dwordx4 v[72:75], v241, s[8:11], s52 offen offset:2048 sc1
    buffer_load_dwordx4 v[76:79], v241, s[8:11], s52 offen offset:3072 sc1
    s_add_u32 s24, s68, s73
    buffer_load_dwordx4 v[196:199], v219, s[8:11], s24 offen sc1
    s_lshl_b32 s77, s92, 6
    s_add_u32 s77, s77, s64
    s_add_u32 s77, s77, 1
    s_cmp_ge_i32 s76, s77
    s_cbranch_scc1 interleave_layers__linear_attn_block__memory_aug_recurrent_mem_tr__prompt_kernel_x_cs_ok
    s_and_b32 s24, s2, 7
    s_lshl_b32 s24, s24, 7
    s_add_u32 s24, s24, 23111680
    v_mov_b32 v254, s24
    s_mov_b32 s61, 0
interleave_layers__linear_attn_block__memory_aug_recurrent_mem_tr__prompt_kernel_x_cs:
    buffer_load_dword v253, v254, s[8:11], 0 offen sc1
    s_waitcnt vmcnt(0)
    v_readlane_b32 s76, v253, 0
    s_cmp_ge_i32 s76, s77
    s_cbranch_scc1 interleave_layers__linear_attn_block__memory_aug_recurrent_mem_tr__prompt_kernel_x_cs_ok
    s_add_u32 s61, s61, 1
    s_cmp_ge_u32 s61, s60
    s_cbranch_scc1 interleave_layers__linear_attn_block__memory_aug_recurrent_mem_tr__prompt_kernel_x_cs_to
    s_sleep 16
    s_branch interleave_layers__linear_attn_block__memory_aug_recurrent_mem_tr__prompt_kernel_x_cs
interleave_layers__linear_attn_block__memory_aug_recurrent_mem_tr__prompt_kernel_x_cs_to:
    s_mov_b32 s60, 1
interleave_layers__linear_attn_block__memory_aug_recurrent_mem_tr__prompt_kernel_x_cs_ok:
    s_add_u32 s53, s66, 8192
    s_mov_b32 s61, 0
interleave_layers__linear_attn_block__memory_aug_recurrent_mem_tr__prompt_kernel_x_p1:
    buffer_load_dwordx4 v[80:83], v212, s[8:11], s67 offen offset:0 sc1
    buffer_load_dwordx4 v[84:87], v212, s[8:11], s67 offen offset:1024 sc1
    buffer_load_dwordx4 v[88:91], v212, s[8:11], s67 offen offset:2048 sc1
    buffer_load_dwordx4 v[92:95], v212, s[8:11], s67 offen offset:3072 sc1
    buffer_load_dwordx4 v[96:99], v213, s[8:11], s67 offen offset:0 sc1
    buffer_load_dwordx4 v[100:103], v213, s[8:11], s67 offen offset:1024 sc1
    buffer_load_dwordx4 v[104:107], v213, s[8:11], s67 offen offset:2048 sc1
    buffer_load_dwordx4 v[108:111], v213, s[8:11], s67 offen offset:3072 sc1
    buffer_load_dwordx4 v[112:115], v214, s[8:11], s67 offen offset:0 sc1
    buffer_load_dwordx4 v[116:119], v214, s[8:11], s67 offen offset:1024 sc1
    buffer_load_dwordx4 v[120:123], v214, s[8:11], s67 offen offset:2048 sc1
    buffer_load_dwordx4 v[124:127], v214, s[8:11], s67 offen offset:3072 sc1
    buffer_load_dwordx4 v[128:131], v215, s[8:11], s67 offen offset:0 sc1
    buffer_load_dwordx4 v[132:135], v215, s[8:11], s67 offen offset:1024 sc1
    buffer_load_dwordx4 v[136:139], v215, s[8:11], s67 offen offset:2048 sc1
    buffer_load_dwordx4 v[140:143], v215, s[8:11], s67 offen offset:3072 sc1
    buffer_load_dwordx4 v[144:147], v216, s[8:11], s67 offen offset:0 sc1
    buffer_load_dwordx4 v[148:151], v216, s[8:11], s67 offen offset:1024 sc1
    buffer_load_dwordx4 v[152:155], v216, s[8:11], s67 offen offset:2048 sc1
    buffer_load_dwordx4 v[156:159], v216, s[8:11], s67 offen offset:3072 sc1
    buffer_load_dwordx4 v[160:163], v242, s[8:11], s66 offen offset:0 sc1
    buffer_load_dwordx4 v[164:167], v242, s[8:11], s66 offen offset:1024 sc1
    buffer_load_dwordx4 v[168:171], v242, s[8:11], s53 offen offset:0 sc1
    buffer_load_dwordx4 v[172:175], v242, s[8:11], s53 offen offset:1024 sc1
    s_waitcnt vmcnt(0)
    v_max3_u32 v192, v80, v81, v82
    v_max3_u32 v192, v192, v83, v84
    v_max3_u32 v192, v192, v85, v86
    v_max3_u32 v192, v192, v87, v88
    v_max3_u32 v192, v192, v89, v90
    v_max3_u32 v192, v192, v91, v92
    v_max3_u32 v192, v192, v93, v94
    v_max3_u32 v192, v192, v95, v96
    v_max3_u32 v192, v192, v97, v98
    v_max3_u32 v192, v192, v99, v100
    v_max3_u32 v192, v192, v101, v102
    v_max3_u32 v192, v192, v103, v104
    v_max3_u32 v192, v192, v105, v106
    v_max3_u32 v192, v192, v107, v108
    v_max3_u32 v192, v192, v109, v110
    v_max3_u32 v192, v192, v111, v112
    v_max3_u32 v192, v192, v113, v114
    v_max3_u32 v192, v192, v115, v116
    v_max3_u32 v192, v192, v117, v118
    v_max3_u32 v192, v192, v119, v120
    v_max3_u32 v192, v192, v121, v122
    v_max3_u32 v192, v192, v123, v124
    v_max3_u32 v192, v192, v125, v126
    v_max3_u32 v192, v192, v127, v128
    v_max3_u32 v192, v192, v129, v130
    v_max3_u32 v192, v192, v131, v132
    v_max3_u32 v192, v192, v133, v134
    v_max3_u32 v192, v192, v135, v136
    v_max3_u32 v192, v192, v137, v138
    v_max3_u32 v192, v192, v139, v140
    v_max3_u32 v192, v192, v141, v142
    v_max3_u32 v192, v192, v143, v144
    v_max3_u32 v192, v192, v145, v146
    v_max3_u32 v192, v192, v147, v148
    v_max3_u32 v192, v192, v149, v150
    v_max3_u32 v192, v192, v151, v152
    v_max3_u32 v192, v192, v153, v154
    v_max3_u32 v192, v192, v155, v156
    v_max3_u32 v192, v192, v157, v158
    v_max3_u32 v192, v192, v159, v160
    v_max3_u32 v192, v192, v161, v162
    v_max3_u32 v192, v192, v163, v164
    v_max3_u32 v192, v192, v165, v166
    v_max3_u32 v192, v192, v167, v168
    v_max3_u32 v192, v192, v169, v170
    v_max3_u32 v192, v192, v171, v172
    v_max3_u32 v192, v192, v173, v174
    v_max_u32 v192, v192, v175
    v_cmp_eq_u32 vcc, -1, v192
    s_add_u32 s61, s61, 1
    s_cbranch_vccz interleave_layers__linear_attn_block__memory_aug_recurrent_mem_tr__prompt_kernel_x_p1_out
    s_cmp_ge_u32 s61, s60
    s_cbranch_scc1 interleave_layers__linear_attn_block__memory_aug_recurrent_mem_tr__prompt_kernel_x_p1_to
    s_sleep 2
    s_branch interleave_layers__linear_attn_block__memory_aug_recurrent_mem_tr__prompt_kernel_x_p1
interleave_layers__linear_attn_block__memory_aug_recurrent_mem_tr__prompt_kernel_x_p1_to:
    s_mov_b32 s60, 1
interleave_layers__linear_attn_block__memory_aug_recurrent_mem_tr__prompt_kernel_x_p1_out:
    v_mfma_f32_16x16x32_bf16 v[176:179], v[16:19], v[80:83], 0
    v_mfma_f32_16x16x32_bf16 v[180:183], v[16:19], v[84:87], 0
    v_mfma_f32_16x16x32_bf16 v[184:187], v[48:51], v[80:83], 0
    v_mfma_f32_16x16x32_bf16 v[188:191], v[48:51], v[84:87], 0
    v_mfma_f32_16x16x32_bf16 v[176:179], v[20:23], v[88:91], v[176:179]
    v_mfma_f32_16x16x32_bf16 v[180:183], v[20:23], v[92:95], v[180:183]
    v_mfma_f32_16x16x32_bf16 v[184:187], v[52:55], v[88:91], v[184:187]
    v_mfma_f32_16x16x32_bf16 v[188:191], v[52:55], v[92:95], v[188:191]
    v_mfma_f32_16x16x32_bf16 v[176:179], v[24:27], v[96:99], v[176:179]
    v_mfma_f32_16x16x32_bf16 v[180:183], v[24:27], v[100:103], v[180:183]
    v_mfma_f32_16x16x32_bf16 v[184:187], v[56:59], v[96:99], v[184:187]
    v_mfma_f32_16x16x32_bf16 v[188:191], v[56:59], v[100:103], v[188:191]
    v_mfma_f32_16x16x32_bf16 v[176:179], v[28:31], v[104:107], v[176:179]
    v_mfma_f32_16x16x32_bf16 v[180:183], v[28:31], v[108:111], v[180:183]
    v_mfma_f32_16x16x32_bf16 v[184:187], v[60:63], v[104:107], v[184:187]
    v_mfma_f32_16x16x32_bf16 v[188:191], v[60:63], v[108:111], v[188:191]
    v_mfma_f32_16x16x32_bf16 v[176:179], v[32:35], v[112:115], v[176:179]
    v_mfma_f32_16x16x32_bf16 v[180:183], v[32:35], v[116:119], v[180:183]
    v_mfma_f32_16x16x32_bf16 v[184:187], v[64:67], v[112:115], v[184:187]
    v_mfma_f32_16x16x32_bf16 v[188:191], v[64:67], v[116:119], v[188:191]
    v_mfma_f32_16x16x32_bf16 v[176:179], v[36:39], v[120:123], v[176:179]
    v_mfma_f32_16x16x32_bf16 v[180:183], v[36:39], v[124:127], v[180:183]
    v_mfma_f32_16x16x32_bf16 v[184:187], v[68:71], v[120:123], v[184:187]
    v_mfma_f32_16x16x32_bf16 v[188:191], v[68:71], v[124:127], v[188:191]
    v_mfma_f32_16x16x32_bf16 v[176:179], v[40:43], v[128:131], v[176:179]
    v_mfma_f32_16x16x32_bf16 v[180:183], v[40:43], v[132:135], v[180:183]
    v_mfma_f32_16x16x32_bf16 v[184:187], v[72:75], v[128:131], v[184:187]
    v_mfma_f32_16x16x32_bf16 v[188:191], v[72:75], v[132:135], v[188:191]
    v_mfma_f32_16x16x32_bf16 v[176:179], v[44:47], v[136:139], v[176:179]
    v_mfma_f32_16x16x32_bf16 v[180:183], v[44:47], v[140:143], v[180:183]
    v_mfma_f32_16x16x32_bf16 v[184:187], v[76:79], v[136:139], v[184:187]
    v_mfma_f32_16x16x32_bf16 v[188:191], v[76:79], v[140:143], v[188:191]
    v_mfma_f32_16x16x32_bf16 v[176:179], v[160:163], v[144:147], v[176:179]
    v_mfma_f32_16x16x32_bf16 v[180:183], v[160:163], v[148:151], v[180:183]
    v_mfma_f32_16x16x32_bf16 v[184:187], v[168:171], v[144:147], v[184:187]
    v_mfma_f32_16x16x32_bf16 v[188:191], v[168:171], v[148:151], v[188:191]
    v_mfma_f32_16x16x32_bf16 v[176:179], v[164:167], v[152:155], v[176:179]
    v_mfma_f32_16x16x32_bf16 v[180:183], v[164:167], v[156:159], v[180:183]
    v_mfma_f32_16x16x32_bf16 v[184:187], v[172:175], v[152:155], v[184:187]
    v_mfma_f32_16x16x32_bf16 v[188:191], v[172:175], v[156:159], v[188:191]
    s_nop 4
    ds_write_b128 v217, v[176:179] offset:0
    ds_write_b128 v217, v[180:183] offset:1024
    ds_write_b128 v217, v[184:187] offset:2048
    ds_write_b128 v217, v[188:191] offset:3072
    s_waitcnt lgkmcnt(0)
    s_barrier
    s_cmp_ge_u32 s3, 2
    s_cbranch_scc1 interleave_layers__linear_attn_block__memory_aug_recurrent_mem_tr__prompt_kernel_xs34
    ds_read_b128 v[16:19], v218 offset:0
    ds_read_b128 v[20:23], v218 offset:4096
    ds_read_b128 v[24:27], v218 offset:8192
    ds_read_b128 v[28:31], v218 offset:12288
    ds_read_b128 v[32:35], v218 offset:2048
    ds_read_b128 v[36:39], v218 offset:6144
    ds_read_b128 v[40:43], v218 offset:10240
    ds_read_b128 v[44:47], v218 offset:14336
    s_waitcnt lgkmcnt(4)
    v_pk_add_f32 v[16:17], v[16:17], v[20:21]
    v_pk_add_f32 v[24:25], v[24:25], v[28:29]
    v_pk_add_f32 v[18:19], v[18:19], v[22:23]
    v_pk_add_f32 v[26:27], v[26:27], v[30:31]
    v_pk_add_f32 v[16:17], v[16:17], v[24:25]
    v_pk_add_f32 v[18:19], v[18:19], v[26:27]
    v_cvt_pk_bf16_f32 v20, v16, v17
    v_cvt_pk_bf16_f32 v21, v18, v19
    v_lshlrev_b32 v16, 16, v20
    v_and_b32 v17, 0xffff0000, v20
    v_lshlrev_b32 v22, 16, v196
    v_and_b32 v23, 0xffff0000, v196
    v_pk_add_f32 v[16:17], v[16:17], v[22:23]
    v_cvt_pk_bf16_f32 v48, v16, v17
    v_lshlrev_b32 v16, 16, v21
    v_and_b32 v17, 0xffff0000, v21
    v_lshlrev_b32 v22, 16, v197
    v_and_b32 v23, 0xffff0000, v197
    v_pk_add_f32 v[16:17], v[16:17], v[22:23]
    v_cvt_pk_bf16_f32 v49, v16, v17
    s_waitcnt lgkmcnt(0)
    v_pk_add_f32 v[32:33], v[32:33], v[36:37]
    v_pk_add_f32 v[40:41], v[40:41], v[44:45]
    v_pk_add_f32 v[34:35], v[34:35], v[38:39]
    v_pk_add_f32 v[42:43], v[42:43], v[46:47]
    v_pk_add_f32 v[32:33], v[32:33], v[40:41]
    v_pk_add_f32 v[34:35], v[34:35], v[42:43]
    v_cvt_pk_bf16_f32 v36, v32, v33
    v_cvt_pk_bf16_f32 v37, v34, v35
    v_lshlrev_b32 v32, 16, v36
    v_and_b32 v33, 0xffff0000, v36
    v_lshlrev_b32 v38, 16, v198
    v_and_b32 v39, 0xffff0000, v198
    v_pk_add_f32 v[32:33], v[32:33], v[38:39]
    v_cvt_pk_bf16_f32 v50, v32, v33
    v_lshlrev_b32 v32, 16, v37
    v_and_b32 v33, 0xffff0000, v37
    v_lshlrev_b32 v38, 16, v199
    v_and_b32 v39, 0xffff0000, v199
    v_pk_add_f32 v[32:33], v[32:33], v[38:39]
    v_cvt_pk_bf16_f32 v51, v32, v33
    s_cmp_eq_u32 s92, 0
    s_cbranch_scc0 interleave_layers__linear_attn_block__memory_aug_recurrent_mem_tr__prompt_kernel_xo35
    s_add_u32 s24, s68, 4194304
    buffer_store_dwordx4 v[48:51], v219, s[8:11], s24 offen sc1
    s_branch interleave_layers__linear_attn_block__memory_aug_recurrent_mem_tr__prompt_kernel_xs34
interleave_layers__linear_attn_block__memory_aug_recurrent_mem_tr__prompt_kernel_xo35:
    buffer_store_dwordx2 v[48:49], v243, s[12:15], s68 offen
    buffer_store_dwordx2 v[50:51], v243, s[12:15], s68 offen offset:32
interleave_layers__linear_attn_block__memory_aug_recurrent_mem_tr__prompt_kernel_xs34:
    s_lshr_b32 s25, s64, 2
    s_add_u32 s25, s25, 1
    s_cmp_eq_u32 s92, 0
    s_cselect_b32 s79, s25, -1
    s_cmp_lt_u32 s40, 64
    s_cbranch_scc1 interleave_layers__linear_attn_block__memory_aug_recurrent_mem_tr__prompt_kernel_xp36
    s_waitcnt vmcnt(0)
    s_barrier
    s_cmp_ge_i32 s79, 0
    s_cselect_b32 s24, 0, 2146435072
    v_or_b32 v246, s24, v245
    v_mov_b32 v247, s79
    buffer_store_dword v247, v246, s[8:11], 0 offen sc1
    s_mov_b32 s79, -1
interleave_layers__linear_attn_block__memory_aug_recurrent_mem_tr__prompt_kernel_xp36:
    s_add_u32 s64, s64, 4
    s_add_u32 s65, s65, 5242880
    s_add_u32 s66, s66, 1835008
    s_add_u32 s67, s67, 1835008
    s_add_u32 s68, s68, 163840
    s_branch interleave_layers__linear_attn_block__memory_aug_recurrent_mem_tr__prompt_kernel_p_next
interleave_layers__linear_attn_block__memory_aug_recurrent_mem_tr__prompt_kernel_p_done:
    s_cmp_eq_u32 s92, 0
    s_cbranch_scc0 interleave_layers__linear_attn_block__memory_aug_recurrent_mem_tr__prompt_kernel_end
    s_mov_b32 s92, 1
    s_branch interleave_layers__linear_attn_block__memory_aug_recurrent_mem_tr__prompt_kernel_p_layer
interleave_layers__linear_attn_block__memory_aug_recurrent_mem_tr__prompt_kernel_roleO:
    s_sub_u32 s44, s2, 200
    s_load_dwordx2 s[6:7], s[0:1], 64
    s_waitcnt lgkmcnt(0)
    s_mov_b32 s12, s6
    s_mov_b32 s13, s7
    s_mov_b32 s14, 7864320
    s_mov_b32 s15, 0x00020000
    v_add_u32 v8, 0, v0
    s_mov_b32 s24, 3277
    v_mul_lo_u32 v9, v8, s24
    v_lshrrev_b32 v9, 18, v9
    v_mul_u32_u24 v10, 80, v9
    v_sub_u32 v10, v8, v10
    v_mul_u32_u24 v16, 1312, v9
    v_lshl_add_u32 v16, v10, 4, v16
    v_add_u32 v8, 256, v0
    s_mov_b32 s24, 3277
    v_mul_lo_u32 v9, v8, s24
    v_lshrrev_b32 v9, 18, v9
    v_mul_u32_u24 v10, 80, v9
    v_sub_u32 v10, v8, v10
    v_mul_u32_u24 v17, 1312, v9
    v_lshl_add_u32 v17, v10, 4, v17
    v_add_u32 v8, 512, v0
    s_mov_b32 s24, 3277
    v_mul_lo_u32 v9, v8, s24
    v_lshrrev_b32 v9, 18, v9
    v_mul_u32_u24 v10, 80, v9
    v_sub_u32 v10, v8, v10
    v_mul_u32_u24 v18, 1312, v9
    v_lshl_add_u32 v18, v10, 4, v18
    v_add_u32 v8, 768, v0
    s_mov_b32 s24, 3277
    v_mul_lo_u32 v9, v8, s24
    v_lshrrev_b32 v9, 18, v9
    v_mul_u32_u24 v10, 80, v9
    v_sub_u32 v10, v8, v10
    v_mul_u32_u24 v19, 1312, v9
    v_lshl_add_u32 v19, v10, 4, v19
    v_add_u32 v8, 1024, v0
    s_mov_b32 s24, 3277
    v_mul_lo_u32 v9, v8, s24
    v_lshrrev_b32 v9, 18, v9
    v_mul_u32_u24 v10, 80, v9
    v_sub_u32 v10, v8, v10
    v_mul_u32_u24 v20, 1312, v9
    v_lshl_add_u32 v20, v10, 4, v20
    v_add_u32 v8, 1280, v0
    s_mov_b32 s24, 3277
    v_mul_lo_u32 v9, v8, s24
    v_lshrrev_b32 v9, 18, v9
    v_mul_u32_u24 v10, 80, v9
    v_sub_u32 v10, v8, v10
    v_mul_u32_u24 v21, 1312, v9
    v_lshl_add_u32 v21, v10, 4, v21
    v_add_u32 v8, 1536, v0
    s_mov_b32 s24, 3277
    v_mul_lo_u32 v9, v8, s24
    v_lshrrev_b32 v9, 18, v9
    v_mul_u32_u24 v10, 80, v9
    v_sub_u32 v10, v8, v10
    v_mul_u32_u24 v22, 1312, v9
    v_lshl_add_u32 v22, v10, 4, v22
    v_add_u32 v8, 1792, v0
    s_mov_b32 s24, 3277
    v_mul_lo_u32 v9, v8, s24
    v_lshrrev_b32 v9, 18, v9
    v_mul_u32_u24 v10, 80, v9
    v_sub_u32 v10, v8, v10
    v_mul_u32_u24 v23, 1312, v9
    v_lshl_add_u32 v23, v10, 4, v23
    v_add_u32 v8, 2048, v0
    s_mov_b32 s24, 3277
    v_mul_lo_u32 v9, v8, s24
    v_lshrrev_b32 v9, 18, v9
    v_mul_u32_u24 v10, 80, v9
    v_sub_u32 v10, v8, v10
    v_mul_u32_u24 v24, 1312, v9
    v_lshl_add_u32 v24, v10, 4, v24
    v_add_u32 v8, 2304, v0
    s_mov_b32 s24, 3277
    v_mul_lo_u32 v9, v8, s24
    v_lshrrev_b32 v9, 18, v9
    v_mul_u32_u24 v10, 80, v9
    v_sub_u32 v10, v8, v10
    v_mul_u32_u24 v25, 1312, v9
    v_lshl_add_u32 v25, v10, 4, v25
    v_add_u32 v8, 2560, v0
    s_mov_b32 s24, 3277
    v_mul_lo_u32 v9, v8, s24
    v_lshrrev_b32 v9, 18, v9
    v_mul_u32_u24 v10, 80, v9
    v_sub_u32 v10, v8, v10
    v_mul_u32_u24 v26, 1312, v9
    v_lshl_add_u32 v26, v10, 4, v26
    v_add_u32 v8, 2816, v0
    s_mov_b32 s24, 3277
    v_mul_lo_u32 v9, v8, s24
    v_lshrrev_b32 v9, 18, v9
    v_mul_u32_u24 v10, 80, v9
    v_sub_u32 v10, v8, v10
    v_mul_u32_u24 v27, 1312, v9
    v_lshl_add_u32 v27, v10, 4, v27
    v_add_u32 v8, 3072, v0
    s_mov_b32 s24, 3277
    v_mul_lo_u32 v9, v8, s24
    v_lshrrev_b32 v9, 18, v9
    v_mul_u32_u24 v10, 80, v9
    v_sub_u32 v10, v8, v10
    v_mul_u32_u24 v28, 1312, v9
    v_lshl_add_u32 v28, v10, 4, v28
    v_add_u32 v8, 3328, v0
    s_mov_b32 s24, 3277
    v_mul_lo_u32 v9, v8, s24
    v_lshrrev_b32 v9, 18, v9
    v_mul_u32_u24 v10, 80, v9
    v_sub_u32 v10, v8, v10
    v_mul_u32_u24 v29, 1312, v9
    v_lshl_add_u32 v29, v10, 4, v29
    v_add_u32 v8, 3584, v0
    s_mov_b32 s24, 3277
    v_mul_lo_u32 v9, v8, s24
    v_lshrrev_b32 v9, 18, v9
    v_mul_u32_u24 v10, 80, v9
    v_sub_u32 v10, v8, v10
    v_mul_u32_u24 v30, 1312, v9
    v_lshl_add_u32 v30, v10, 4, v30
    v_add_u32 v8, 3840, v0
    s_mov_b32 s24, 3277
    v_mul_lo_u32 v9, v8, s24
    v_lshrrev_b32 v9, 18, v9
    v_mul_u32_u24 v10, 80, v9
    v_sub_u32 v10, v8, v10
    v_mul_u32_u24 v31, 1312, v9
    v_lshl_add_u32 v31, v10, 4, v31
    v_add_u32 v8, 4096, v0
    s_mov_b32 s24, 3277
    v_mul_lo_u32 v9, v8, s24
    v_lshrrev_b32 v9, 18, v9
    v_mul_u32_u24 v10, 80, v9
    v_sub_u32 v10, v8, v10
    v_mul_u32_u24 v32, 1312, v9
    v_lshl_add_u32 v32, v10, 4, v32
    v_add_u32 v8, 4352, v0
    s_mov_b32 s24, 3277
    v_mul_lo_u32 v9, v8, s24
    v_lshrrev_b32 v9, 18, v9
    v_mul_u32_u24 v10, 80, v9
    v_sub_u32 v10, v8, v10
    v_mul_u32_u24 v33, 1312, v9
    v_lshl_add_u32 v33, v10, 4, v33
    v_add_u32 v8, 4608, v0
    s_mov_b32 s24, 3277
    v_mul_lo_u32 v9, v8, s24
    v_lshrrev_b32 v9, 18, v9
    v_mul_u32_u24 v10, 80, v9
    v_sub_u32 v10, v8, v10
    v_mul_u32_u24 v34, 1312, v9
    v_lshl_add_u32 v34, v10, 4, v34
    v_add_u32 v8, 4864, v0
    s_mov_b32 s24, 3277
    v_mul_lo_u32 v9, v8, s24
    v_lshrrev_b32 v9, 18, v9
    v_mul_u32_u24 v10, 80, v9
    v_sub_u32 v10, v8, v10
    v_mul_u32_u24 v35, 1312, v9
    v_lshl_add_u32 v35, v10, 4, v35
    v_add_u32 v8, 5120, v0
    s_mov_b32 s24, 3277
    v_mul_lo_u32 v9, v8, s24
    v_lshrrev_b32 v9, 18, v9
    v_mul_u32_u24 v10, 80, v9
    v_sub_u32 v10, v8, v10
    v_mul_u32_u24 v36, 1312, v9
    v_lshl_add_u32 v36, v10, 4, v36
    v_add_u32 v8, 5376, v0
    s_mov_b32 s24, 3277
    v_mul_lo_u32 v9, v8, s24
    v_lshrrev_b32 v9, 18, v9
    v_mul_u32_u24 v10, 80, v9
    v_sub_u32 v10, v8, v10
    v_mul_u32_u24 v37, 1312, v9
    v_lshl_add_u32 v37, v10, 4, v37
    v_add_u32 v8, 5632, v0
    s_mov_b32 s24, 3277
    v_mul_lo_u32 v9, v8, s24
    v_lshrrev_b32 v9, 18, v9
    v_mul_u32_u24 v10, 80, v9
    v_sub_u32 v10, v8, v10
    v_mul_u32_u24 v38, 1312, v9
    v_lshl_add_u32 v38, v10, 4, v38
    v_add_u32 v8, 5888, v0
    s_mov_b32 s24, 3277
    v_mul_lo_u32 v9, v8, s24
    v_lshrrev_b32 v9, 18, v9
    v_mul_u32_u24 v10, 80, v9
    v_sub_u32 v10, v8, v10
    v_mul_u32_u24 v39, 1312, v9
    v_lshl_add_u32 v39, v10, 4, v39
    v_add_u32 v8, 6144, v0
    s_mov_b32 s24, 3277
    v_mul_lo_u32 v9, v8, s24
    v_lshrrev_b32 v9, 18, v9
    v_mul_u32_u24 v10, 80, v9
    v_sub_u32 v10, v8, v10
    v_mul_u32_u24 v40, 1312, v9
    v_lshl_add_u32 v40, v10, 4, v40
    v_add_u32 v8, 6400, v0
    s_mov_b32 s24, 3277
    v_mul_lo_u32 v9, v8, s24
    v_lshrrev_b32 v9, 18, v9
    v_mul_u32_u24 v10, 80, v9
    v_sub_u32 v10, v8, v10
    v_mul_u32_u24 v41, 1312, v9
    v_lshl_add_u32 v41, v10, 4, v41
    v_add_u32 v8, 6656, v0
    s_mov_b32 s24, 3277
    v_mul_lo_u32 v9, v8, s24
    v_lshrrev_b32 v9, 18, v9
    v_mul_u32_u24 v10, 80, v9
    v_sub_u32 v10, v8, v10
    v_mul_u32_u24 v42, 1312, v9
    v_lshl_add_u32 v42, v10, 4, v42
    v_add_u32 v8, 6912, v0
    s_mov_b32 s24, 3277
    v_mul_lo_u32 v9, v8, s24
    v_lshrrev_b32 v9, 18, v9
    v_mul_u32_u24 v10, 80, v9
    v_sub_u32 v10, v8, v10
    v_mul_u32_u24 v43, 1312, v9
    v_lshl_add_u32 v43, v10, 4, v43
    v_add_u32 v8, 7168, v0
    s_mov_b32 s24, 3277
    v_mul_lo_u32 v9, v8, s24
    v_lshrrev_b32 v9, 18, v9
    v_mul_u32_u24 v10, 80, v9
    v_sub_u32 v10, v8, v10
    v_mul_u32_u24 v44, 1312, v9
    v_lshl_add_u32 v44, v10, 4, v44
    v_add_u32 v8, 7424, v0
    s_mov_b32 s24, 3277
    v_mul_lo_u32 v9, v8, s24
    v_lshrrev_b32 v9, 18, v9
    v_mul_u32_u24 v10, 80, v9
    v_sub_u32 v10, v8, v10
    v_mul_u32_u24 v45, 1312, v9
    v_lshl_add_u32 v45, v10, 4, v45
    v_lshlrev_b32 v4, 4, v0
    s_mul_i32 s45, s44, 245760
    s_add_u32 s46, s45, 0
    buffer_load_dwordx4 v[48:51], v4, s[12:15], s46 offen
    s_add_u32 s46, s45, 4096
    buffer_load_dwordx4 v[52:55], v4, s[12:15], s46 offen
    s_add_u32 s46, s45, 8192
    buffer_load_dwordx4 v[56:59], v4, s[12:15], s46 offen
    s_add_u32 s46, s45, 12288
    buffer_load_dwordx4 v[60:63], v4, s[12:15], s46 offen
    s_add_u32 s46, s45, 16384
    buffer_load_dwordx4 v[64:67], v4, s[12:15], s46 offen
    s_add_u32 s46, s45, 20480
    buffer_load_dwordx4 v[68:71], v4, s[12:15], s46 offen
    s_add_u32 s46, s45, 24576
    buffer_load_dwordx4 v[72:75], v4, s[12:15], s46 offen
    s_add_u32 s46, s45, 28672
    buffer_load_dwordx4 v[76:79], v4, s[12:15], s46 offen
    s_add_u32 s46, s45, 32768
    buffer_load_dwordx4 v[80:83], v4, s[12:15], s46 offen
    s_add_u32 s46, s45, 36864
    buffer_load_dwordx4 v[84:87], v4, s[12:15], s46 offen
    s_add_u32 s46, s45, 40960
    buffer_load_dwordx4 v[88:91], v4, s[12:15], s46 offen
    s_add_u32 s46, s45, 45056
    buffer_load_dwordx4 v[92:95], v4, s[12:15], s46 offen
    s_add_u32 s46, s45, 49152
    buffer_load_dwordx4 v[96:99], v4, s[12:15], s46 offen
    s_add_u32 s46, s45, 53248
    buffer_load_dwordx4 v[100:103], v4, s[12:15], s46 offen
    s_add_u32 s46, s45, 57344
    buffer_load_dwordx4 v[104:107], v4, s[12:15], s46 offen
    s_add_u32 s46, s45, 61440
    buffer_load_dwordx4 v[108:111], v4, s[12:15], s46 offen
    s_add_u32 s46, s45, 65536
    buffer_load_dwordx4 v[112:115], v4, s[12:15], s46 offen
    s_add_u32 s46, s45, 69632
    buffer_load_dwordx4 v[116:119], v4, s[12:15], s46 offen
    s_add_u32 s46, s45, 73728
    buffer_load_dwordx4 v[120:123], v4, s[12:15], s46 offen
    s_add_u32 s46, s45, 77824
    buffer_load_dwordx4 v[124:127], v4, s[12:15], s46 offen
    s_add_u32 s46, s45, 81920
    buffer_load_dwordx4 v[128:131], v4, s[12:15], s46 offen
    s_add_u32 s46, s45, 86016
    buffer_load_dwordx4 v[132:135], v4, s[12:15], s46 offen
    s_add_u32 s46, s45, 90112
    buffer_load_dwordx4 v[136:139], v4, s[12:15], s46 offen
    s_add_u32 s46, s45, 94208
    buffer_load_dwordx4 v[140:143], v4, s[12:15], s46 offen
    s_add_u32 s46, s45, 98304
    buffer_load_dwordx4 v[144:147], v4, s[12:15], s46 offen
    s_add_u32 s46, s45, 102400
    buffer_load_dwordx4 v[148:151], v4, s[12:15], s46 offen
    s_add_u32 s46, s45, 106496
    buffer_load_dwordx4 v[152:155], v4, s[12:15], s46 offen
    s_add_u32 s46, s45, 110592
    buffer_load_dwordx4 v[156:159], v4, s[12:15], s46 offen
    s_add_u32 s46, s45, 114688
    buffer_load_dwordx4 v[160:163], v4, s[12:15], s46 offen
    s_add_u32 s46, s45, 118784
    buffer_load_dwordx4 v[164:167], v4, s[12:15], s46 offen
    s_add_u32 s46, s45, 122880
    buffer_load_dwordx4 v[168:171], v4, s[12:15], s46 offen
    s_add_u32 s46, s45, 126976
    buffer_load_dwordx4 v[172:175], v4, s[12:15], s46 offen
    s_add_u32 s46, s45, 131072
    buffer_load_dwordx4 v[176:179], v4, s[12:15], s46 offen
    s_add_u32 s46, s45, 135168
    buffer_load_dwordx4 v[180:183], v4, s[12:15], s46 offen
    s_add_u32 s46, s45, 139264
    buffer_load_dwordx4 v[184:187], v4, s[12:15], s46 offen
    s_add_u32 s46, s45, 143360
    buffer_load_dwordx4 v[188:191], v4, s[12:15], s46 offen
    s_add_u32 s46, s45, 147456
    buffer_load_dwordx4 v[192:195], v4, s[12:15], s46 offen
    s_add_u32 s46, s45, 151552
    buffer_load_dwordx4 v[196:199], v4, s[12:15], s46 offen
    s_add_u32 s46, s45, 155648
    buffer_load_dwordx4 v[200:203], v4, s[12:15], s46 offen
    s_add_u32 s46, s45, 159744
    buffer_load_dwordx4 v[204:207], v4, s[12:15], s46 offen
    s_add_u32 s46, s45, 163840
    buffer_load_dwordx4 v[208:211], v4, s[12:15], s46 offen
    s_add_u32 s46, s45, 167936
    buffer_load_dwordx4 v[212:215], v4, s[12:15], s46 offen
    s_add_u32 s46, s45, 172032
    buffer_load_dwordx4 v[216:219], v4, s[12:15], s46 offen
    s_add_u32 s46, s45, 176128
    buffer_load_dwordx4 v[220:223], v4, s[12:15], s46 offen
    s_add_u32 s46, s45, 180224
    buffer_load_dwordx4 v[224:227], v4, s[12:15], s46 offen
    s_add_u32 s46, s45, 184320
    buffer_load_dwordx4 v[228:231], v4, s[12:15], s46 offen
    s_add_u32 s46, s45, 188416
    buffer_load_dwordx4 v[232:235], v4, s[12:15], s46 offen
    s_add_u32 s46, s45, 192512
    buffer_load_dwordx4 v[236:239], v4, s[12:15], s46 offen
    s_add_u32 s46, s45, 196608
    buffer_load_dwordx4 v[240:243], v4, s[12:15], s46 offen
    s_add_u32 s46, s45, 200704
    buffer_load_dwordx4 v[244:247], v4, s[12:15], s46 offen
    s_add_u32 s46, s45, 204800
    buffer_load_dwordx4 v[248:251], v4, s[12:15], s46 offen
    s_add_u32 s46, s45, 208896
    buffer_load_dwordx4 v[252:255], v4, s[12:15], s46 offen
    v_lshrrev_b32 v8, 2, v2
    v_lshl_add_u32 v8, v3, 2, v8
    v_mul_u32_u24 v5, 1312, v8
    v_and_b32 v8, 3, v2
    v_lshl_add_u32 v5, v8, 3, v5
    s_mul_i32 s24, s3, 320
    v_add_u32 v5, s24, v5
    v_add_u32 v6, 62976, v5
    s_waitcnt vmcnt(22)
    ds_write_b128 v16, v[48:51]
    ds_write_b128 v17, v[52:55]
    ds_write_b128 v18, v[56:59]
    ds_write_b128 v19, v[60:63]
    ds_write_b128 v20, v[64:67]
    ds_write_b128 v21, v[68:71]
    ds_write_b128 v22, v[72:75]
    ds_write_b128 v23, v[76:79]
    ds_write_b128 v24, v[80:83]
    ds_write_b128 v25, v[84:87]
    ds_write_b128 v26, v[88:91]
    ds_write_b128 v27, v[92:95]
    ds_write_b128 v28, v[96:99]
    ds_write_b128 v29, v[100:103]
    ds_write_b128 v30, v[104:107]
    ds_write_b128 v31, v[108:111]
    ds_write_b128 v32, v[112:115]
    ds_write_b128 v33, v[116:119]
    ds_write_b128 v34, v[120:123]
    ds_write_b128 v35, v[124:127]
    ds_write_b128 v36, v[128:131]
    ds_write_b128 v37, v[132:135]
    ds_write_b128 v38, v[136:139]
    ds_write_b128 v39, v[140:143]
    ds_write_b128 v40, v[144:147]
    ds_write_b128 v41, v[148:151]
    ds_write_b128 v42, v[152:155]
    ds_write_b128 v43, v[156:159]
    ds_write_b128 v44, v[160:163]
    ds_write_b128 v45, v[164:167]
    s_waitcnt lgkmcnt(0)
    s_add_u32 s46, s45, 212992
    buffer_load_dwordx4 v[48:51], v4, s[12:15], s46 offen
    s_add_u32 s46, s45, 217088
    buffer_load_dwordx4 v[52:55], v4, s[12:15], s46 offen
    s_add_u32 s46, s45, 221184
    buffer_load_dwordx4 v[56:59], v4, s[12:15], s46 offen
    s_add_u32 s46, s45, 225280
    buffer_load_dwordx4 v[60:63], v4, s[12:15], s46 offen
    s_add_u32 s46, s45, 229376
    buffer_load_dwordx4 v[64:67], v4, s[12:15], s46 offen
    s_add_u32 s46, s45, 233472
    buffer_load_dwordx4 v[68:71], v4, s[12:15], s46 offen
    s_add_u32 s46, s45, 237568
    buffer_load_dwordx4 v[72:75], v4, s[12:15], s46 offen
    s_add_u32 s46, s45, 241664
    buffer_load_dwordx4 v[76:79], v4, s[12:15], s46 offen
    s_barrier
    ds_read_b64_tr_b16 a[0:1], v5 offset:0
    ds_read_b64_tr_b16 a[2:3], v5 offset:20992
    ds_read_b64_tr_b16 a[4:5], v6 offset:0
    ds_read_b64_tr_b16 a[6:7], v6 offset:20992
    ds_read_b64_tr_b16 a[16:17], v5 offset:41984
    ds_read_b64_tr_b16 a[18:19], v6 offset:41984
    ds_read_b64_tr_b16 a[24:25], v5 offset:32
    ds_read_b64_tr_b16 a[26:27], v5 offset:21024
    ds_read_b64_tr_b16 a[28:29], v6 offset:32
    ds_read_b64_tr_b16 a[30:31], v6 offset:21024
    ds_read_b64_tr_b16 a[40:41], v5 offset:42016
    ds_read_b64_tr_b16 a[42:43], v6 offset:42016
    ds_read_b64_tr_b16 a[48:49], v5 offset:64
    ds_read_b64_tr_b16 a[50:51], v5 offset:21056
    ds_read_b64_tr_b16 a[52:53], v6 offset:64
    ds_read_b64_tr_b16 a[54:55], v6 offset:21056
    ds_read_b64_tr_b16 a[64:65], v5 offset:42048
    ds_read_b64_tr_b16 a[66:67], v6 offset:42048
    ds_read_b64_tr_b16 a[72:73], v5 offset:96
    ds_read_b64_tr_b16 a[74:75], v5 offset:21088
    ds_read_b64_tr_b16 a[76:77], v6 offset:96
    ds_read_b64_tr_b16 a[78:79], v6 offset:21088
    ds_read_b64_tr_b16 a[88:89], v5 offset:42080
    ds_read_b64_tr_b16 a[90:91], v6 offset:42080
    ds_read_b64_tr_b16 a[96:97], v5 offset:128
    ds_read_b64_tr_b16 a[98:99], v5 offset:21120
    ds_read_b64_tr_b16 a[100:101], v6 offset:128
    ds_read_b64_tr_b16 a[102:103], v6 offset:21120
    ds_read_b64_tr_b16 a[112:113], v5 offset:42112
    ds_read_b64_tr_b16 a[114:115], v6 offset:42112
    ds_read_b64_tr_b16 a[120:121], v5 offset:160
    ds_read_b64_tr_b16 a[122:123], v5 offset:21152
    ds_read_b64_tr_b16 a[124:125], v6 offset:160
    ds_read_b64_tr_b16 a[126:127], v6 offset:21152
    ds_read_b64_tr_b16 a[136:137], v5 offset:42144
    ds_read_b64_tr_b16 a[138:139], v6 offset:42144
    ds_read_b64_tr_b16 a[144:145], v5 offset:192
    ds_read_b64_tr_b16 a[146:147], v5 offset:21184
    ds_read_b64_tr_b16 a[148:149], v6 offset:192
    ds_read_b64_tr_b16 a[150:151], v6 offset:21184
    ds_read_b64_tr_b16 a[160:161], v5 offset:42176
    ds_read_b64_tr_b16 a[162:163], v6 offset:42176
    ds_read_b64_tr_b16 a[168:169], v5 offset:224
    ds_read_b64_tr_b16 a[170:171], v5 offset:21216
    ds_read_b64_tr_b16 a[172:173], v6 offset:224
    ds_read_b64_tr_b16 a[174:175], v6 offset:21216
    ds_read_b64_tr_b16 a[184:185], v5 offset:42208
    ds_read_b64_tr_b16 a[186:187], v6 offset:42208
    ds_read_b64_tr_b16 a[192:193], v5 offset:256
    ds_read_b64_tr_b16 a[194:195], v5 offset:21248
    ds_read_b64_tr_b16 a[196:197], v6 offset:256
    ds_read_b64_tr_b16 a[198:199], v6 offset:21248
    ds_read_b64_tr_b16 a[208:209], v5 offset:42240
    ds_read_b64_tr_b16 a[210:211], v6 offset:42240
    ds_read_b64_tr_b16 a[216:217], v5 offset:288
    ds_read_b64_tr_b16 a[218:219], v5 offset:21280
    ds_read_b64_tr_b16 a[220:221], v6 offset:288
    ds_read_b64_tr_b16 a[222:223], v6 offset:21280
    ds_read_b64_tr_b16 a[232:233], v5 offset:42272
    ds_read_b64_tr_b16 a[234:235], v6 offset:42272
    s_waitcnt lgkmcnt(0)
    s_barrier
    s_waitcnt vmcnt(0)
    ds_write_b128 v16, v[168:171]
    ds_write_b128 v17, v[172:175]
    ds_write_b128 v18, v[176:179]
    ds_write_b128 v19, v[180:183]
    ds_write_b128 v20, v[184:187]
    ds_write_b128 v21, v[188:191]
    ds_write_b128 v22, v[192:195]
    ds_write_b128 v23, v[196:199]
    ds_write_b128 v24, v[200:203]
    ds_write_b128 v25, v[204:207]
    ds_write_b128 v26, v[208:211]
    ds_write_b128 v27, v[212:215]
    ds_write_b128 v28, v[216:219]
    ds_write_b128 v29, v[220:223]
    ds_write_b128 v30, v[224:227]
    ds_write_b128 v31, v[228:231]
    ds_write_b128 v32, v[232:235]
    ds_write_b128 v33, v[236:239]
    ds_write_b128 v34, v[240:243]
    ds_write_b128 v35, v[244:247]
    ds_write_b128 v36, v[248:251]
    ds_write_b128 v37, v[252:255]
    ds_write_b128 v38, v[48:51]
    ds_write_b128 v39, v[52:55]
    ds_write_b128 v40, v[56:59]
    ds_write_b128 v41, v[60:63]
    ds_write_b128 v42, v[64:67]
    ds_write_b128 v43, v[68:71]
    ds_write_b128 v44, v[72:75]
    ds_write_b128 v45, v[76:79]
    s_waitcnt lgkmcnt(0)
    s_barrier
    ds_read_b64_tr_b16 a[8:9], v5 offset:0
    ds_read_b64_tr_b16 a[10:11], v5 offset:20992
    ds_read_b64_tr_b16 a[12:13], v6 offset:0
    ds_read_b64_tr_b16 a[14:15], v6 offset:20992
    ds_read_b64_tr_b16 a[20:21], v5 offset:41984
    ds_read_b64_tr_b16 a[22:23], v6 offset:41984
    ds_read_b64_tr_b16 a[32:33], v5 offset:32
    ds_read_b64_tr_b16 a[34:35], v5 offset:21024
    ds_read_b64_tr_b16 a[36:37], v6 offset:32
    ds_read_b64_tr_b16 a[38:39], v6 offset:21024
    ds_read_b64_tr_b16 a[44:45], v5 offset:42016
    ds_read_b64_tr_b16 a[46:47], v6 offset:42016
    ds_read_b64_tr_b16 a[56:57], v5 offset:64
    ds_read_b64_tr_b16 a[58:59], v5 offset:21056
    ds_read_b64_tr_b16 a[60:61], v6 offset:64
    ds_read_b64_tr_b16 a[62:63], v6 offset:21056
    ds_read_b64_tr_b16 a[68:69], v5 offset:42048
    ds_read_b64_tr_b16 a[70:71], v6 offset:42048
    ds_read_b64_tr_b16 a[80:81], v5 offset:96
    ds_read_b64_tr_b16 a[82:83], v5 offset:21088
    ds_read_b64_tr_b16 a[84:85], v6 offset:96
    ds_read_b64_tr_b16 a[86:87], v6 offset:21088
    ds_read_b64_tr_b16 a[92:93], v5 offset:42080
    ds_read_b64_tr_b16 a[94:95], v6 offset:42080
    ds_read_b64_tr_b16 a[104:105], v5 offset:128
    ds_read_b64_tr_b16 a[106:107], v5 offset:21120
    ds_read_b64_tr_b16 a[108:109], v6 offset:128
    ds_read_b64_tr_b16 a[110:111], v6 offset:21120
    ds_read_b64_tr_b16 a[116:117], v5 offset:42112
    ds_read_b64_tr_b16 a[118:119], v6 offset:42112
    ds_read_b64_tr_b16 a[128:129], v5 offset:160
    ds_read_b64_tr_b16 a[130:131], v5 offset:21152
    ds_read_b64_tr_b16 a[132:133], v6 offset:160
    ds_read_b64_tr_b16 a[134:135], v6 offset:21152
    ds_read_b64_tr_b16 a[140:141], v5 offset:42144
    ds_read_b64_tr_b16 a[142:143], v6 offset:42144
    ds_read_b64_tr_b16 a[152:153], v5 offset:192
    ds_read_b64_tr_b16 a[154:155], v5 offset:21184
    ds_read_b64_tr_b16 a[156:157], v6 offset:192
    ds_read_b64_tr_b16 a[158:159], v6 offset:21184
    ds_read_b64_tr_b16 a[164:165], v5 offset:42176
    ds_read_b64_tr_b16 a[166:167], v6 offset:42176
    ds_read_b64_tr_b16 a[176:177], v5 offset:224
    ds_read_b64_tr_b16 a[178:179], v5 offset:21216
    ds_read_b64_tr_b16 a[180:181], v6 offset:224
    ds_read_b64_tr_b16 a[182:183], v6 offset:21216
    ds_read_b64_tr_b16 a[188:189], v5 offset:42208
    ds_read_b64_tr_b16 a[190:191], v6 offset:42208
    ds_read_b64_tr_b16 a[200:201], v5 offset:256
    ds_read_b64_tr_b16 a[202:203], v5 offset:21248
    ds_read_b64_tr_b16 a[204:205], v6 offset:256
    ds_read_b64_tr_b16 a[206:207], v6 offset:21248
    ds_read_b64_tr_b16 a[212:213], v5 offset:42240
    ds_read_b64_tr_b16 a[214:215], v6 offset:42240
    ds_read_b64_tr_b16 a[224:225], v5 offset:288
    ds_read_b64_tr_b16 a[226:227], v5 offset:21280
    ds_read_b64_tr_b16 a[228:229], v6 offset:288
    ds_read_b64_tr_b16 a[230:231], v6 offset:21280
    ds_read_b64_tr_b16 a[236:237], v5 offset:42272
    ds_read_b64_tr_b16 a[238:239], v6 offset:42272
    s_waitcnt lgkmcnt(0)
    s_barrier
    v_lshlrev_b32 v5, 4, v1
    s_mul_i32 s24, s44, 12288
    v_add_u32 v6, s24, v5
    v_add_u32 v7, 4096, v6
    v_add_u32 v8, 8192, v6
    s_mul_i32 s24, s3, 327680
    s_lshl_b32 s25, s44, 10
    s_add_u32 s24, s24, s25
    v_add_u32 v9, s24, v5
interleave_layers__linear_attn_block__memory_aug_recurrent_mem_tr__prompt_kernel_o_layer:
    s_mul_i32 s93, s92, 29360128
    s_add_u32 s93, s93, 117440512
    s_mul_i32 s94, s92, 16384
    s_add_u32 s94, s94, 23068672
    s_mov_b32 s24, 12288
    s_lshl_b32 s25, s44, 7
    s_add_u32 s24, s24, s25
    s_add_u32 s24, s24, s94
    v_mov_b32 v14, s24
    v_mov_b32 v15, 2146435072
    v_cmp_eq_u32 vcc, 0, v1
    s_nop 1
    v_cndmask_b32 v14, v15, v14, vcc
    s_lshl_b32 s24, s44, 7
    s_add_u32 s24, s24, 8192
    s_add_u32 s24, s24, s94
    v_mov_b32 v10, s24
    s_mov_b32 s41, 33554432
    s_mov_b32 s43, 184549376
    s_mov_b32 s40, 0
    s_mov_b32 s62, -1
    s_mov_b32 s63, 1
    s_cmp_ge_i32 s62, s63
    s_cbranch_scc1 interleave_layers__linear_attn_block__memory_aug_recurrent_mem_tr__prompt_kernel_o_en0_ok
    s_mov_b32 s61, 0
interleave_layers__linear_attn_block__memory_aug_recurrent_mem_tr__prompt_kernel_o_en0:
    buffer_load_dword v11, v10, s[8:11], 0 offen sc1
    s_waitcnt vmcnt(0)
    v_readlane_b32 s62, v11, 0
    s_cmp_ge_i32 s62, s63
    s_cbranch_scc1 interleave_layers__linear_attn_block__memory_aug_recurrent_mem_tr__prompt_kernel_o_en0_ok
    s_add_u32 s61, s61, 1
    s_cmp_ge_u32 s61, s60
    s_cbranch_scc1 interleave_layers__linear_attn_block__memory_aug_recurrent_mem_tr__prompt_kernel_o_en0_to
    s_sleep 2
    s_branch interleave_layers__linear_attn_block__memory_aug_recurrent_mem_tr__prompt_kernel_o_en0
interleave_layers__linear_attn_block__memory_aug_recurrent_mem_tr__prompt_kernel_o_en0_to:
    s_mov_b32 s60, 1
interleave_layers__linear_attn_block__memory_aug_recurrent_mem_tr__prompt_kernel_o_en0_ok:
    buffer_load_dwordx4 v[16:19], v6, s[8:11], s41 offen offset:0 sc1
    buffer_load_dwordx4 v[20:23], v6, s[8:11], s41 offen offset:1024 sc1
    buffer_load_dwordx4 v[24:27], v6, s[8:11], s41 offen offset:2048 sc1
    buffer_load_dwordx4 v[28:31], v6, s[8:11], s41 offen offset:3072 sc1
    buffer_load_dwordx4 v[32:35], v7, s[8:11], s41 offen offset:0 sc1
    buffer_load_dwordx4 v[36:39], v7, s[8:11], s41 offen offset:1024 sc1
    buffer_load_dwordx4 v[40:43], v7, s[8:11], s41 offen offset:2048 sc1
    buffer_load_dwordx4 v[44:47], v7, s[8:11], s41 offen offset:3072 sc1
    buffer_load_dwordx4 v[48:51], v8, s[8:11], s41 offen offset:0 sc1
    buffer_load_dwordx4 v[52:55], v8, s[8:11], s41 offen offset:1024 sc1
    buffer_load_dwordx4 v[56:59], v8, s[8:11], s41 offen offset:2048 sc1
    buffer_load_dwordx4 v[60:63], v8, s[8:11], s41 offen offset:3072 sc1
    s_add_u32 s41, s41, 393216
    s_waitcnt vmcnt(0)
interleave_layers__linear_attn_block__memory_aug_recurrent_mem_tr__prompt_kernel_o_seg:
    v_swap_b32 v26, v36
    v_swap_b32 v27, v37
    v_swap_b32 v50, v60
    v_swap_b32 v51, v61
    buffer_load_dword v232, v10, s[8:11], 0 offen sc1
    v_mfma_f32_16x16x32_bf16 v[112:115], v[16:19], a[0:3], 0
    v_mfma_f32_16x16x32_bf16 v[116:119], v[20:23], a[0:3], 0
    v_mfma_f32_16x16x32_bf16 v[120:123], v[16:19], a[24:27], 0
    v_mfma_f32_16x16x32_bf16 v[124:127], v[20:23], a[24:27], 0
    v_mfma_f32_16x16x32_bf16 v[128:131], v[16:19], a[48:51], 0
    v_mfma_f32_16x16x32_bf16 v[132:135], v[20:23], a[48:51], 0
    v_mfma_f32_16x16x32_bf16 v[136:139], v[16:19], a[72:75], 0
    v_mfma_f32_16x16x32_bf16 v[140:143], v[20:23], a[72:75], 0
    v_mfma_f32_16x16x32_bf16 v[144:147], v[16:19], a[96:99], 0
    v_mfma_f32_16x16x32_bf16 v[148:151], v[20:23], a[96:99], 0
    v_mfma_f32_16x16x32_bf16 v[152:155], v[16:19], a[120:123], 0
    v_mfma_f32_16x16x32_bf16 v[156:159], v[20:23], a[120:123], 0
    v_mfma_f32_16x16x32_bf16 v[160:163], v[16:19], a[144:147], 0
    v_mfma_f32_16x16x32_bf16 v[164:167], v[20:23], a[144:147], 0
    v_mfma_f32_16x16x32_bf16 v[168:171], v[16:19], a[168:171], 0
    v_mfma_f32_16x16x32_bf16 v[172:175], v[20:23], a[168:171], 0
    v_mfma_f32_16x16x32_bf16 v[176:179], v[16:19], a[192:195], 0
    v_mfma_f32_16x16x32_bf16 v[180:183], v[20:23], a[192:195], 0
    v_mfma_f32_16x16x32_bf16 v[184:187], v[16:19], a[216:219], 0
    v_mfma_f32_16x16x32_bf16 v[188:191], v[20:23], a[216:219], 0
    v_mfma_f32_16x16x32_bf16 v[112:115], v[28:31], a[4:7], v[112:115]
    v_mfma_f32_16x16x32_bf16 v[116:119], v[32:35], a[4:7], v[116:119]
    v_mfma_f32_16x16x32_bf16 v[120:123], v[28:31], a[28:31], v[120:123]
    v_mfma_f32_16x16x32_bf16 v[124:127], v[32:35], a[28:31], v[124:127]
    v_mfma_f32_16x16x32_bf16 v[128:131], v[28:31], a[52:55], v[128:131]
    v_mfma_f32_16x16x32_bf16 v[132:135], v[32:35], a[52:55], v[132:135]
    v_mfma_f32_16x16x32_bf16 v[136:139], v[28:31], a[76:79], v[136:139]
    v_mfma_f32_16x16x32_bf16 v[140:143], v[32:35], a[76:79], v[140:143]
    v_mfma_f32_16x16x32_bf16 v[144:147], v[28:31], a[100:103], v[144:147]
    v_mfma_f32_16x16x32_bf16 v[148:151], v[32:35], a[100:103], v[148:151]
    v_mfma_f32_16x16x32_bf16 v[152:155], v[28:31], a[124:127], v[152:155]
    v_mfma_f32_16x16x32_bf16 v[156:159], v[32:35], a[124:127], v[156:159]
    v_mfma_f32_16x16x32_bf16 v[160:163], v[28:31], a[148:151], v[160:163]
    v_mfma_f32_16x16x32_bf16 v[164:167], v[32:35], a[148:151], v[164:167]
    v_mfma_f32_16x16x32_bf16 v[168:171], v[28:31], a[172:175], v[168:171]
    v_mfma_f32_16x16x32_bf16 v[172:175], v[32:35], a[172:175], v[172:175]
    v_mfma_f32_16x16x32_bf16 v[176:179], v[28:31], a[196:199], v[176:179]
    v_mfma_f32_16x16x32_bf16 v[180:183], v[32:35], a[196:199], v[180:183]
    v_mfma_f32_16x16x32_bf16 v[184:187], v[28:31], a[220:223], v[184:187]
    v_mfma_f32_16x16x32_bf16 v[188:191], v[32:35], a[220:223], v[188:191]
    v_mfma_f32_16x16x32_bf16 v[112:115], v[40:43], a[8:11], v[112:115]
    v_mfma_f32_16x16x32_bf16 v[116:119], v[44:47], a[8:11], v[116:119]
    v_mfma_f32_16x16x32_bf16 v[120:123], v[40:43], a[32:35], v[120:123]
    v_mfma_f32_16x16x32_bf16 v[124:127], v[44:47], a[32:35], v[124:127]
    v_mfma_f32_16x16x32_bf16 v[128:131], v[40:43], a[56:59], v[128:131]
    v_mfma_f32_16x16x32_bf16 v[132:135], v[44:47], a[56:59], v[132:135]
    v_mfma_f32_16x16x32_bf16 v[136:139], v[40:43], a[80:83], v[136:139]
    v_mfma_f32_16x16x32_bf16 v[140:143], v[44:47], a[80:83], v[140:143]
    v_mfma_f32_16x16x32_bf16 v[144:147], v[40:43], a[104:107], v[144:147]
    v_mfma_f32_16x16x32_bf16 v[148:151], v[44:47], a[104:107], v[148:151]
    v_mfma_f32_16x16x32_bf16 v[152:155], v[40:43], a[128:131], v[152:155]
    v_mfma_f32_16x16x32_bf16 v[156:159], v[44:47], a[128:131], v[156:159]
    v_mfma_f32_16x16x32_bf16 v[160:163], v[40:43], a[152:155], v[160:163]
    v_mfma_f32_16x16x32_bf16 v[164:167], v[44:47], a[152:155], v[164:167]
    v_mfma_f32_16x16x32_bf16 v[168:171], v[40:43], a[176:179], v[168:171]
    v_mfma_f32_16x16x32_bf16 v[172:175], v[44:47], a[176:179], v[172:175]
    v_mfma_f32_16x16x32_bf16 v[176:179], v[40:43], a[200:203], v[176:179]
    v_mfma_f32_16x16x32_bf16 v[180:183], v[44:47], a[200:203], v[180:183]
    v_mfma_f32_16x16x32_bf16 v[184:187], v[40:43], a[224:227], v[184:187]
    v_mfma_f32_16x16x32_bf16 v[188:191], v[44:47], a[224:227], v[188:191]
    s_waitcnt vmcnt(0)
    v_readfirstlane_b32 s24, v232
    s_max_i32 s62, s62, s24
    s_add_u32 s63, s40, 2
    s_min_u32 s63, s63, 64
    s_cmp_ge_i32 s62, s63
    s_cselect_b32 s24, 1, 0
    s_lshl_b32 s25, s3, 4
    s_add_u32 s25, s25, 0
    v_mov_b32 v12, s25
    v_mov_b32 v13, s24
    ds_write_b32 v12, v13
    v_mov_b32 v12, 0
    s_waitcnt lgkmcnt(0)
    s_barrier
    ds_read_b32 v13, v12
    s_cmp_eq_u32 s3, 0
    s_cbranch_scc0 interleave_layers__linear_attn_block__memory_aug_recurrent_mem_tr__prompt_kernel_fp38
    v_mov_b32 v15, s40
    buffer_store_dword v15, v14, s[8:11], 0 offen sc1
interleave_layers__linear_attn_block__memory_aug_recurrent_mem_tr__prompt_kernel_fp38:
    s_waitcnt lgkmcnt(0)
    v_readfirstlane_b32 s58, v13
    s_cmp_eq_u32 s58, 1
    s_cbranch_scc0 interleave_layers__linear_attn_block__memory_aug_recurrent_mem_tr__prompt_kernel_of37
    s_max_i32 s62, s62, s63
    buffer_load_dwordx4 v[64:67], v6, s[8:11], s41 offen offset:0 sc1
    buffer_load_dwordx4 v[68:71], v6, s[8:11], s41 offen offset:1024 sc1
    buffer_load_dwordx4 v[72:75], v6, s[8:11], s41 offen offset:2048 sc1
    buffer_load_dwordx4 v[76:79], v6, s[8:11], s41 offen offset:3072 sc1
    buffer_load_dwordx4 v[80:83], v7, s[8:11], s41 offen offset:0 sc1
    buffer_load_dwordx4 v[84:87], v7, s[8:11], s41 offen offset:1024 sc1
    buffer_load_dwordx4 v[88:91], v7, s[8:11], s41 offen offset:2048 sc1
    buffer_load_dwordx4 v[92:95], v7, s[8:11], s41 offen offset:3072 sc1
    buffer_load_dwordx4 v[96:99], v8, s[8:11], s41 offen offset:0 sc1
    buffer_load_dwordx4 v[100:103], v8, s[8:11], s41 offen offset:1024 sc1
    buffer_load_dwordx4 v[104:107], v8, s[8:11], s41 offen offset:2048 sc1
    buffer_load_dwordx4 v[108:111], v8, s[8:11], s41 offen offset:3072 sc1
    s_add_u32 s41, s41, 393216
interleave_layers__linear_attn_block__memory_aug_recurrent_mem_tr__prompt_kernel_of37:
    v_mfma_f32_16x16x32_bf16 v[112:115], v[52:55], a[12:15], v[112:115]
    v_mfma_f32_16x16x32_bf16 v[116:119], v[56:59], a[12:15], v[116:119]
    v_mfma_f32_16x16x32_bf16 v[120:123], v[52:55], a[36:39], v[120:123]
    v_mfma_f32_16x16x32_bf16 v[124:127], v[56:59], a[36:39], v[124:127]
    v_mfma_f32_16x16x32_bf16 v[128:131], v[52:55], a[60:63], v[128:131]
    v_mfma_f32_16x16x32_bf16 v[132:135], v[56:59], a[60:63], v[132:135]
    v_mfma_f32_16x16x32_bf16 v[136:139], v[52:55], a[84:87], v[136:139]
    v_mfma_f32_16x16x32_bf16 v[140:143], v[56:59], a[84:87], v[140:143]
    v_mfma_f32_16x16x32_bf16 v[144:147], v[52:55], a[108:111], v[144:147]
    v_mfma_f32_16x16x32_bf16 v[148:151], v[56:59], a[108:111], v[148:151]
    v_mfma_f32_16x16x32_bf16 v[152:155], v[52:55], a[132:135], v[152:155]
    v_mfma_f32_16x16x32_bf16 v[156:159], v[56:59], a[132:135], v[156:159]
    v_mfma_f32_16x16x32_bf16 v[160:163], v[52:55], a[156:159], v[160:163]
    v_mfma_f32_16x16x32_bf16 v[164:167], v[56:59], a[156:159], v[164:167]
    v_mfma_f32_16x16x32_bf16 v[168:171], v[52:55], a[180:183], v[168:171]
    v_mfma_f32_16x16x32_bf16 v[172:175], v[56:59], a[180:183], v[172:175]
    v_mfma_f32_16x16x32_bf16 v[176:179], v[52:55], a[204:207], v[176:179]
    v_mfma_f32_16x16x32_bf16 v[180:183], v[56:59], a[204:207], v[180:183]
    v_mfma_f32_16x16x32_bf16 v[184:187], v[52:55], a[228:231], v[184:187]
    v_mfma_f32_16x16x32_bf16 v[188:191], v[56:59], a[228:231], v[188:191]
    v_mfma_f32_16x16x32_bf16 v[112:115], v[24:27], a[16:19], v[112:115]
    v_mfma_f32_16x16x32_bf16 v[116:119], v[36:39], a[16:19], v[116:119]
    v_mfma_f32_16x16x32_bf16 v[120:123], v[24:27], a[40:43], v[120:123]
    v_mfma_f32_16x16x32_bf16 v[124:127], v[36:39], a[40:43], v[124:127]
    v_mfma_f32_16x16x32_bf16 v[128:131], v[24:27], a[64:67], v[128:131]
    v_mfma_f32_16x16x32_bf16 v[132:135], v[36:39], a[64:67], v[132:135]
    v_mfma_f32_16x16x32_bf16 v[136:139], v[24:27], a[88:91], v[136:139]
    v_mfma_f32_16x16x32_bf16 v[140:143], v[36:39], a[88:91], v[140:143]
    v_mfma_f32_16x16x32_bf16 v[144:147], v[24:27], a[112:115], v[144:147]
    v_mfma_f32_16x16x32_bf16 v[148:151], v[36:39], a[112:115], v[148:151]
    v_mfma_f32_16x16x32_bf16 v[152:155], v[24:27], a[136:139], v[152:155]
    v_mfma_f32_16x16x32_bf16 v[156:159], v[36:39], a[136:139], v[156:159]
    v_mfma_f32_16x16x32_bf16 v[160:163], v[24:27], a[160:163], v[160:163]
    v_mfma_f32_16x16x32_bf16 v[164:167], v[36:39], a[160:163], v[164:167]
    v_mfma_f32_16x16x32_bf16 v[168:171], v[24:27], a[184:187], v[168:171]
    v_mfma_f32_16x16x32_bf16 v[172:175], v[36:39], a[184:187], v[172:175]
    v_mfma_f32_16x16x32_bf16 v[176:179], v[24:27], a[208:211], v[176:179]
    v_mfma_f32_16x16x32_bf16 v[180:183], v[36:39], a[208:211], v[180:183]
    v_mfma_f32_16x16x32_bf16 v[184:187], v[24:27], a[232:235], v[184:187]
    v_mfma_f32_16x16x32_bf16 v[188:191], v[36:39], a[232:235], v[188:191]
    v_mfma_f32_16x16x32_bf16 v[112:115], v[48:51], a[20:23], v[112:115]
    v_mfma_f32_16x16x32_bf16 v[116:119], v[60:63], a[20:23], v[116:119]
    v_mfma_f32_16x16x32_bf16 v[120:123], v[48:51], a[44:47], v[120:123]
    v_mfma_f32_16x16x32_bf16 v[124:127], v[60:63], a[44:47], v[124:127]
    v_mfma_f32_16x16x32_bf16 v[128:131], v[48:51], a[68:71], v[128:131]
    v_mfma_f32_16x16x32_bf16 v[132:135], v[60:63], a[68:71], v[132:135]
    v_mfma_f32_16x16x32_bf16 v[136:139], v[48:51], a[92:95], v[136:139]
    v_mfma_f32_16x16x32_bf16 v[140:143], v[60:63], a[92:95], v[140:143]
    v_mfma_f32_16x16x32_bf16 v[144:147], v[48:51], a[116:119], v[144:147]
    v_mfma_f32_16x16x32_bf16 v[148:151], v[60:63], a[116:119], v[148:151]
    v_mfma_f32_16x16x32_bf16 v[152:155], v[48:51], a[140:143], v[152:155]
    v_mfma_f32_16x16x32_bf16 v[156:159], v[60:63], a[140:143], v[156:159]
    v_mfma_f32_16x16x32_bf16 v[160:163], v[48:51], a[164:167], v[160:163]
    v_mfma_f32_16x16x32_bf16 v[164:167], v[60:63], a[164:167], v[164:167]
    v_mfma_f32_16x16x32_bf16 v[168:171], v[48:51], a[188:191], v[168:171]
    v_mfma_f32_16x16x32_bf16 v[172:175], v[60:63], a[188:191], v[172:175]
    v_mfma_f32_16x16x32_bf16 v[176:179], v[48:51], a[212:215], v[176:179]
    v_mfma_f32_16x16x32_bf16 v[180:183], v[60:63], a[212:215], v[180:183]
    v_mfma_f32_16x16x32_bf16 v[184:187], v[48:51], a[236:239], v[184:187]
    v_mfma_f32_16x16x32_bf16 v[188:191], v[60:63], a[236:239], v[188:191]
    s_mov_b32 s46, s43
    v_cvt_pk_bf16_f32 v192, v112, v113
    v_cvt_pk_bf16_f32 v193, v114, v115
    v_cvt_pk_bf16_f32 v194, v116, v117
    v_cvt_pk_bf16_f32 v195, v118, v119
    buffer_store_dwordx4 v[192:195], v9, s[8:11], s46 offen sc1
    s_add_u32 s46, s46, 32768
    v_cvt_pk_bf16_f32 v196, v120, v121
    v_cvt_pk_bf16_f32 v197, v122, v123
    v_cvt_pk_bf16_f32 v198, v124, v125
    v_cvt_pk_bf16_f32 v199, v126, v127
    buffer_store_dwordx4 v[196:199], v9, s[8:11], s46 offen sc1
    s_add_u32 s46, s46, 32768
    v_cvt_pk_bf16_f32 v200, v128, v129
    v_cvt_pk_bf16_f32 v201, v130, v131
    v_cvt_pk_bf16_f32 v202, v132, v133
    v_cvt_pk_bf16_f32 v203, v134, v135
    buffer_store_dwordx4 v[200:203], v9, s[8:11], s46 offen sc1
    s_add_u32 s46, s46, 32768
    v_cvt_pk_bf16_f32 v204, v136, v137
    v_cvt_pk_bf16_f32 v205, v138, v139
    v_cvt_pk_bf16_f32 v206, v140, v141
    v_cvt_pk_bf16_f32 v207, v142, v143
    buffer_store_dwordx4 v[204:207], v9, s[8:11], s46 offen sc1
    s_add_u32 s46, s46, 32768
    v_cvt_pk_bf16_f32 v208, v144, v145
    v_cvt_pk_bf16_f32 v209, v146, v147
    v_cvt_pk_bf16_f32 v210, v148, v149
    v_cvt_pk_bf16_f32 v211, v150, v151
    buffer_store_dwordx4 v[208:211], v9, s[8:11], s46 offen sc1
    s_add_u32 s46, s46, 32768
    v_cvt_pk_bf16_f32 v212, v152, v153
    v_cvt_pk_bf16_f32 v213, v154, v155
    v_cvt_pk_bf16_f32 v214, v156, v157
    v_cvt_pk_bf16_f32 v215, v158, v159
    buffer_store_dwordx4 v[212:215], v9, s[8:11], s46 offen sc1
    s_add_u32 s46, s46, 32768
    v_cvt_pk_bf16_f32 v216, v160, v161
    v_cvt_pk_bf16_f32 v217, v162, v163
    v_cvt_pk_bf16_f32 v218, v164, v165
    v_cvt_pk_bf16_f32 v219, v166, v167
    buffer_store_dwordx4 v[216:219], v9, s[8:11], s46 offen sc1
    s_add_u32 s46, s46, 32768
    v_cvt_pk_bf16_f32 v220, v168, v169
    v_cvt_pk_bf16_f32 v221, v170, v171
    v_cvt_pk_bf16_f32 v222, v172, v173
    v_cvt_pk_bf16_f32 v223, v174, v175
    buffer_store_dwordx4 v[220:223], v9, s[8:11], s46 offen sc1
    s_add_u32 s46, s46, 32768
    v_cvt_pk_bf16_f32 v224, v176, v177
    v_cvt_pk_bf16_f32 v225, v178, v179
    v_cvt_pk_bf16_f32 v226, v180, v181
    v_cvt_pk_bf16_f32 v227, v182, v183
    buffer_store_dwordx4 v[224:227], v9, s[8:11], s46 offen sc1
    s_add_u32 s46, s46, 32768
    v_cvt_pk_bf16_f32 v228, v184, v185
    v_cvt_pk_bf16_f32 v229, v186, v187
    v_cvt_pk_bf16_f32 v230, v188, v189
    v_cvt_pk_bf16_f32 v231, v190, v191
    buffer_store_dwordx4 v[228:231], v9, s[8:11], s46 offen sc1
    s_cmp_eq_u32 s58, 1
    s_cbranch_scc1 interleave_layers__linear_attn_block__memory_aug_recurrent_mem_tr__prompt_kernel_of39
    s_waitcnt vmcnt(0)
    s_barrier
    s_add_u32 s24, s40, 1
    s_cmp_eq_u32 s3, 0
    s_cbranch_scc0 interleave_layers__linear_attn_block__memory_aug_recurrent_mem_tr__prompt_kernel_fp40
    v_mov_b32 v15, s24
    buffer_store_dword v15, v14, s[8:11], 0 offen sc1
interleave_layers__linear_attn_block__memory_aug_recurrent_mem_tr__prompt_kernel_fp40:
    s_add_u32 s63, s40, 2
    s_min_u32 s63, s63, 64
    s_cmp_ge_i32 s62, s63
    s_cbranch_scc1 interleave_layers__linear_attn_block__memory_aug_recurrent_mem_tr__prompt_kernel_o_en3_ok
    s_mov_b32 s61, 0
interleave_layers__linear_attn_block__memory_aug_recurrent_mem_tr__prompt_kernel_o_en3:
    buffer_load_dword v11, v10, s[8:11], 0 offen sc1
    s_waitcnt vmcnt(0)
    v_readlane_b32 s62, v11, 0
    s_cmp_ge_i32 s62, s63
    s_cbranch_scc1 interleave_layers__linear_attn_block__memory_aug_recurrent_mem_tr__prompt_kernel_o_en3_ok
    s_add_u32 s61, s61, 1
    s_cmp_ge_u32 s61, s60
    s_cbranch_scc1 interleave_layers__linear_attn_block__memory_aug_recurrent_mem_tr__prompt_kernel_o_en3_to
    s_sleep 2
    s_branch interleave_layers__linear_attn_block__memory_aug_recurrent_mem_tr__prompt_kernel_o_en3
interleave_layers__linear_attn_block__memory_aug_recurrent_mem_tr__prompt_kernel_o_en3_to:
    s_mov_b32 s60, 1
interleave_layers__linear_attn_block__memory_aug_recurrent_mem_tr__prompt_kernel_o_en3_ok:
    buffer_load_dwordx4 v[64:67], v6, s[8:11], s41 offen offset:0 sc1
    buffer_load_dwordx4 v[68:71], v6, s[8:11], s41 offen offset:1024 sc1
    buffer_load_dwordx4 v[72:75], v6, s[8:11], s41 offen offset:2048 sc1
    buffer_load_dwordx4 v[76:79], v6, s[8:11], s41 offen offset:3072 sc1
    buffer_load_dwordx4 v[80:83], v7, s[8:11], s41 offen offset:0 sc1
    buffer_load_dwordx4 v[84:87], v7, s[8:11], s41 offen offset:1024 sc1
    buffer_load_dwordx4 v[88:91], v7, s[8:11], s41 offen offset:2048 sc1
    buffer_load_dwordx4 v[92:95], v7, s[8:11], s41 offen offset:3072 sc1
    buffer_load_dwordx4 v[96:99], v8, s[8:11], s41 offen offset:0 sc1
    buffer_load_dwordx4 v[100:103], v8, s[8:11], s41 offen offset:1024 sc1
    buffer_load_dwordx4 v[104:107], v8, s[8:11], s41 offen offset:2048 sc1
    buffer_load_dwordx4 v[108:111], v8, s[8:11], s41 offen offset:3072 sc1
    s_add_u32 s41, s41, 393216
    s_waitcnt vmcnt(0)
interleave_layers__linear_attn_block__memory_aug_recurrent_mem_tr__prompt_kernel_of39:
    s_waitcnt vmcnt(10)
    s_add_u32 s40, s40, 1
    s_add_u32 s43, s43, 1310720
    v_swap_b32 v74, v84
    v_swap_b32 v75, v85
    v_swap_b32 v98, v108
    v_swap_b32 v99, v109
    buffer_load_dword v232, v10, s[8:11], 0 offen sc1
    v_mfma_f32_16x16x32_bf16 v[112:115], v[64:67], a[0:3], 0
    v_mfma_f32_16x16x32_bf16 v[116:119], v[68:71], a[0:3], 0
    v_mfma_f32_16x16x32_bf16 v[120:123], v[64:67], a[24:27], 0
    v_mfma_f32_16x16x32_bf16 v[124:127], v[68:71], a[24:27], 0
    v_mfma_f32_16x16x32_bf16 v[128:131], v[64:67], a[48:51], 0
    v_mfma_f32_16x16x32_bf16 v[132:135], v[68:71], a[48:51], 0
    v_mfma_f32_16x16x32_bf16 v[136:139], v[64:67], a[72:75], 0
    v_mfma_f32_16x16x32_bf16 v[140:143], v[68:71], a[72:75], 0
    v_mfma_f32_16x16x32_bf16 v[144:147], v[64:67], a[96:99], 0
    v_mfma_f32_16x16x32_bf16 v[148:151], v[68:71], a[96:99], 0
    v_mfma_f32_16x16x32_bf16 v[152:155], v[64:67], a[120:123], 0
    v_mfma_f32_16x16x32_bf16 v[156:159], v[68:71], a[120:123], 0
    v_mfma_f32_16x16x32_bf16 v[160:163], v[64:67], a[144:147], 0
    v_mfma_f32_16x16x32_bf16 v[164:167], v[68:71], a[144:147], 0
    v_mfma_f32_16x16x32_bf16 v[168:171], v[64:67], a[168:171], 0
    v_mfma_f32_16x16x32_bf16 v[172:175], v[68:71], a[168:171], 0
    v_mfma_f32_16x16x32_bf16 v[176:179], v[64:67], a[192:195], 0
    v_mfma_f32_16x16x32_bf16 v[180:183], v[68:71], a[192:195], 0
    v_mfma_f32_16x16x32_bf16 v[184:187], v[64:67], a[216:219], 0
    v_mfma_f32_16x16x32_bf16 v[188:191], v[68:71], a[216:219], 0
    v_mfma_f32_16x16x32_bf16 v[112:115], v[76:79], a[4:7], v[112:115]
    v_mfma_f32_16x16x32_bf16 v[116:119], v[80:83], a[4:7], v[116:119]
    v_mfma_f32_16x16x32_bf16 v[120:123], v[76:79], a[28:31], v[120:123]
    v_mfma_f32_16x16x32_bf16 v[124:127], v[80:83], a[28:31], v[124:127]
    v_mfma_f32_16x16x32_bf16 v[128:131], v[76:79], a[52:55], v[128:131]
    v_mfma_f32_16x16x32_bf16 v[132:135], v[80:83], a[52:55], v[132:135]
    v_mfma_f32_16x16x32_bf16 v[136:139], v[76:79], a[76:79], v[136:139]
    v_mfma_f32_16x16x32_bf16 v[140:143], v[80:83], a[76:79], v[140:143]
    v_mfma_f32_16x16x32_bf16 v[144:147], v[76:79], a[100:103], v[144:147]
    v_mfma_f32_16x16x32_bf16 v[148:151], v[80:83], a[100:103], v[148:151]
    v_mfma_f32_16x16x32_bf16 v[152:155], v[76:79], a[124:127], v[152:155]
    v_mfma_f32_16x16x32_bf16 v[156:159], v[80:83], a[124:127], v[156:159]
    v_mfma_f32_16x16x32_bf16 v[160:163], v[76:79], a[148:151], v[160:163]
    v_mfma_f32_16x16x32_bf16 v[164:167], v[80:83], a[148:151], v[164:167]
    v_mfma_f32_16x16x32_bf16 v[168:171], v[76:79], a[172:175], v[168:171]
    v_mfma_f32_16x16x32_bf16 v[172:175], v[80:83], a[172:175], v[172:175]
    v_mfma_f32_16x16x32_bf16 v[176:179], v[76:79], a[196:199], v[176:179]
    v_mfma_f32_16x16x32_bf16 v[180:183], v[80:83], a[196:199], v[180:183]
    v_mfma_f32_16x16x32_bf16 v[184:187], v[76:79], a[220:223], v[184:187]
    v_mfma_f32_16x16x32_bf16 v[188:191], v[80:83], a[220:223], v[188:191]
    v_mfma_f32_16x16x32_bf16 v[112:115], v[88:91], a[8:11], v[112:115]
    v_mfma_f32_16x16x32_bf16 v[116:119], v[92:95], a[8:11], v[116:119]
    v_mfma_f32_16x16x32_bf16 v[120:123], v[88:91], a[32:35], v[120:123]
    v_mfma_f32_16x16x32_bf16 v[124:127], v[92:95], a[32:35], v[124:127]
    v_mfma_f32_16x16x32_bf16 v[128:131], v[88:91], a[56:59], v[128:131]
    v_mfma_f32_16x16x32_bf16 v[132:135], v[92:95], a[56:59], v[132:135]
    v_mfma_f32_16x16x32_bf16 v[136:139], v[88:91], a[80:83], v[136:139]
    v_mfma_f32_16x16x32_bf16 v[140:143], v[92:95], a[80:83], v[140:143]
    v_mfma_f32_16x16x32_bf16 v[144:147], v[88:91], a[104:107], v[144:147]
    v_mfma_f32_16x16x32_bf16 v[148:151], v[92:95], a[104:107], v[148:151]
    v_mfma_f32_16x16x32_bf16 v[152:155], v[88:91], a[128:131], v[152:155]
    v_mfma_f32_16x16x32_bf16 v[156:159], v[92:95], a[128:131], v[156:159]
    v_mfma_f32_16x16x32_bf16 v[160:163], v[88:91], a[152:155], v[160:163]
    v_mfma_f32_16x16x32_bf16 v[164:167], v[92:95], a[152:155], v[164:167]
    v_mfma_f32_16x16x32_bf16 v[168:171], v[88:91], a[176:179], v[168:171]
    v_mfma_f32_16x16x32_bf16 v[172:175], v[92:95], a[176:179], v[172:175]
    v_mfma_f32_16x16x32_bf16 v[176:179], v[88:91], a[200:203], v[176:179]
    v_mfma_f32_16x16x32_bf16 v[180:183], v[92:95], a[200:203], v[180:183]
    v_mfma_f32_16x16x32_bf16 v[184:187], v[88:91], a[224:227], v[184:187]
    v_mfma_f32_16x16x32_bf16 v[188:191], v[92:95], a[224:227], v[188:191]
    s_waitcnt vmcnt(0)
    v_readfirstlane_b32 s24, v232
    s_max_i32 s62, s62, s24
    s_add_u32 s63, s40, 2
    s_min_u32 s63, s63, 64
    s_cmp_ge_i32 s62, s63
    s_cselect_b32 s24, 1, 0
    s_lshl_b32 s25, s3, 4
    s_add_u32 s25, s25, 4
    v_mov_b32 v12, s25
    v_mov_b32 v13, s24
    ds_write_b32 v12, v13
    v_mov_b32 v12, 4
    s_waitcnt lgkmcnt(0)
    s_barrier
    ds_read_b32 v13, v12
    s_cmp_eq_u32 s3, 0
    s_cbranch_scc0 interleave_layers__linear_attn_block__memory_aug_recurrent_mem_tr__prompt_kernel_fp42
    v_mov_b32 v15, s40
    buffer_store_dword v15, v14, s[8:11], 0 offen sc1
interleave_layers__linear_attn_block__memory_aug_recurrent_mem_tr__prompt_kernel_fp42:
    s_waitcnt lgkmcnt(0)
    v_readfirstlane_b32 s58, v13
    s_cmp_eq_u32 s58, 1
    s_cbranch_scc0 interleave_layers__linear_attn_block__memory_aug_recurrent_mem_tr__prompt_kernel_of41
    s_max_i32 s62, s62, s63
    buffer_load_dwordx4 v[16:19], v6, s[8:11], s41 offen offset:0 sc1
    buffer_load_dwordx4 v[20:23], v6, s[8:11], s41 offen offset:1024 sc1
    buffer_load_dwordx4 v[24:27], v6, s[8:11], s41 offen offset:2048 sc1
    buffer_load_dwordx4 v[28:31], v6, s[8:11], s41 offen offset:3072 sc1
    buffer_load_dwordx4 v[32:35], v7, s[8:11], s41 offen offset:0 sc1
    buffer_load_dwordx4 v[36:39], v7, s[8:11], s41 offen offset:1024 sc1
    buffer_load_dwordx4 v[40:43], v7, s[8:11], s41 offen offset:2048 sc1
    buffer_load_dwordx4 v[44:47], v7, s[8:11], s41 offen offset:3072 sc1
    buffer_load_dwordx4 v[48:51], v8, s[8:11], s41 offen offset:0 sc1
    buffer_load_dwordx4 v[52:55], v8, s[8:11], s41 offen offset:1024 sc1
    buffer_load_dwordx4 v[56:59], v8, s[8:11], s41 offen offset:2048 sc1
    buffer_load_dwordx4 v[60:63], v8, s[8:11], s41 offen offset:3072 sc1
    s_add_u32 s41, s41, 393216
interleave_layers__linear_attn_block__memory_aug_recurrent_mem_tr__prompt_kernel_of41:
    v_mfma_f32_16x16x32_bf16 v[112:115], v[100:103], a[12:15], v[112:115]
    v_mfma_f32_16x16x32_bf16 v[116:119], v[104:107], a[12:15], v[116:119]
    v_mfma_f32_16x16x32_bf16 v[120:123], v[100:103], a[36:39], v[120:123]
    v_mfma_f32_16x16x32_bf16 v[124:127], v[104:107], a[36:39], v[124:127]
    v_mfma_f32_16x16x32_bf16 v[128:131], v[100:103], a[60:63], v[128:131]
    v_mfma_f32_16x16x32_bf16 v[132:135], v[104:107], a[60:63], v[132:135]
    v_mfma_f32_16x16x32_bf16 v[136:139], v[100:103], a[84:87], v[136:139]
    v_mfma_f32_16x16x32_bf16 v[140:143], v[104:107], a[84:87], v[140:143]
    v_mfma_f32_16x16x32_bf16 v[144:147], v[100:103], a[108:111], v[144:147]
    v_mfma_f32_16x16x32_bf16 v[148:151], v[104:107], a[108:111], v[148:151]
    v_mfma_f32_16x16x32_bf16 v[152:155], v[100:103], a[132:135], v[152:155]
    v_mfma_f32_16x16x32_bf16 v[156:159], v[104:107], a[132:135], v[156:159]
    v_mfma_f32_16x16x32_bf16 v[160:163], v[100:103], a[156:159], v[160:163]
    v_mfma_f32_16x16x32_bf16 v[164:167], v[104:107], a[156:159], v[164:167]
    v_mfma_f32_16x16x32_bf16 v[168:171], v[100:103], a[180:183], v[168:171]
    v_mfma_f32_16x16x32_bf16 v[172:175], v[104:107], a[180:183], v[172:175]
    v_mfma_f32_16x16x32_bf16 v[176:179], v[100:103], a[204:207], v[176:179]
    v_mfma_f32_16x16x32_bf16 v[180:183], v[104:107], a[204:207], v[180:183]
    v_mfma_f32_16x16x32_bf16 v[184:187], v[100:103], a[228:231], v[184:187]
    v_mfma_f32_16x16x32_bf16 v[188:191], v[104:107], a[228:231], v[188:191]
    v_mfma_f32_16x16x32_bf16 v[112:115], v[72:75], a[16:19], v[112:115]
    v_mfma_f32_16x16x32_bf16 v[116:119], v[84:87], a[16:19], v[116:119]
    v_mfma_f32_16x16x32_bf16 v[120:123], v[72:75], a[40:43], v[120:123]
    v_mfma_f32_16x16x32_bf16 v[124:127], v[84:87], a[40:43], v[124:127]
    v_mfma_f32_16x16x32_bf16 v[128:131], v[72:75], a[64:67], v[128:131]
    v_mfma_f32_16x16x32_bf16 v[132:135], v[84:87], a[64:67], v[132:135]
    v_mfma_f32_16x16x32_bf16 v[136:139], v[72:75], a[88:91], v[136:139]
    v_mfma_f32_16x16x32_bf16 v[140:143], v[84:87], a[88:91], v[140:143]
    v_mfma_f32_16x16x32_bf16 v[144:147], v[72:75], a[112:115], v[144:147]
    v_mfma_f32_16x16x32_bf16 v[148:151], v[84:87], a[112:115], v[148:151]
    v_mfma_f32_16x16x32_bf16 v[152:155], v[72:75], a[136:139], v[152:155]
    v_mfma_f32_16x16x32_bf16 v[156:159], v[84:87], a[136:139], v[156:159]
    v_mfma_f32_16x16x32_bf16 v[160:163], v[72:75], a[160:163], v[160:163]
    v_mfma_f32_16x16x32_bf16 v[164:167], v[84:87], a[160:163], v[164:167]
    v_mfma_f32_16x16x32_bf16 v[168:171], v[72:75], a[184:187], v[168:171]
    v_mfma_f32_16x16x32_bf16 v[172:175], v[84:87], a[184:187], v[172:175]
    v_mfma_f32_16x16x32_bf16 v[176:179], v[72:75], a[208:211], v[176:179]
    v_mfma_f32_16x16x32_bf16 v[180:183], v[84:87], a[208:211], v[180:183]
    v_mfma_f32_16x16x32_bf16 v[184:187], v[72:75], a[232:235], v[184:187]
    v_mfma_f32_16x16x32_bf16 v[188:191], v[84:87], a[232:235], v[188:191]
    v_mfma_f32_16x16x32_bf16 v[112:115], v[96:99], a[20:23], v[112:115]
    v_mfma_f32_16x16x32_bf16 v[116:119], v[108:111], a[20:23], v[116:119]
    v_mfma_f32_16x16x32_bf16 v[120:123], v[96:99], a[44:47], v[120:123]
    v_mfma_f32_16x16x32_bf16 v[124:127], v[108:111], a[44:47], v[124:127]
    v_mfma_f32_16x16x32_bf16 v[128:131], v[96:99], a[68:71], v[128:131]
    v_mfma_f32_16x16x32_bf16 v[132:135], v[108:111], a[68:71], v[132:135]
    v_mfma_f32_16x16x32_bf16 v[136:139], v[96:99], a[92:95], v[136:139]
    v_mfma_f32_16x16x32_bf16 v[140:143], v[108:111], a[92:95], v[140:143]
    v_mfma_f32_16x16x32_bf16 v[144:147], v[96:99], a[116:119], v[144:147]
    v_mfma_f32_16x16x32_bf16 v[148:151], v[108:111], a[116:119], v[148:151]
    v_mfma_f32_16x16x32_bf16 v[152:155], v[96:99], a[140:143], v[152:155]
    v_mfma_f32_16x16x32_bf16 v[156:159], v[108:111], a[140:143], v[156:159]
    v_mfma_f32_16x16x32_bf16 v[160:163], v[96:99], a[164:167], v[160:163]
    v_mfma_f32_16x16x32_bf16 v[164:167], v[108:111], a[164:167], v[164:167]
    v_mfma_f32_16x16x32_bf16 v[168:171], v[96:99], a[188:191], v[168:171]
    v_mfma_f32_16x16x32_bf16 v[172:175], v[108:111], a[188:191], v[172:175]
    v_mfma_f32_16x16x32_bf16 v[176:179], v[96:99], a[212:215], v[176:179]
    v_mfma_f32_16x16x32_bf16 v[180:183], v[108:111], a[212:215], v[180:183]
    v_mfma_f32_16x16x32_bf16 v[184:187], v[96:99], a[236:239], v[184:187]
    v_mfma_f32_16x16x32_bf16 v[188:191], v[108:111], a[236:239], v[188:191]
    s_mov_b32 s46, s43
    v_cvt_pk_bf16_f32 v192, v112, v113
    v_cvt_pk_bf16_f32 v193, v114, v115
    v_cvt_pk_bf16_f32 v194, v116, v117
    v_cvt_pk_bf16_f32 v195, v118, v119
    buffer_store_dwordx4 v[192:195], v9, s[8:11], s46 offen sc1
    s_add_u32 s46, s46, 32768
    v_cvt_pk_bf16_f32 v196, v120, v121
    v_cvt_pk_bf16_f32 v197, v122, v123
    v_cvt_pk_bf16_f32 v198, v124, v125
    v_cvt_pk_bf16_f32 v199, v126, v127
    buffer_store_dwordx4 v[196:199], v9, s[8:11], s46 offen sc1
    s_add_u32 s46, s46, 32768
    v_cvt_pk_bf16_f32 v200, v128, v129
    v_cvt_pk_bf16_f32 v201, v130, v131
    v_cvt_pk_bf16_f32 v202, v132, v133
    v_cvt_pk_bf16_f32 v203, v134, v135
    buffer_store_dwordx4 v[200:203], v9, s[8:11], s46 offen sc1
    s_add_u32 s46, s46, 32768
    v_cvt_pk_bf16_f32 v204, v136, v137
    v_cvt_pk_bf16_f32 v205, v138, v139
    v_cvt_pk_bf16_f32 v206, v140, v141
    v_cvt_pk_bf16_f32 v207, v142, v143
    buffer_store_dwordx4 v[204:207], v9, s[8:11], s46 offen sc1
    s_add_u32 s46, s46, 32768
    v_cvt_pk_bf16_f32 v208, v144, v145
    v_cvt_pk_bf16_f32 v209, v146, v147
    v_cvt_pk_bf16_f32 v210, v148, v149
    v_cvt_pk_bf16_f32 v211, v150, v151
    buffer_store_dwordx4 v[208:211], v9, s[8:11], s46 offen sc1
    s_add_u32 s46, s46, 32768
    v_cvt_pk_bf16_f32 v212, v152, v153
    v_cvt_pk_bf16_f32 v213, v154, v155
    v_cvt_pk_bf16_f32 v214, v156, v157
    v_cvt_pk_bf16_f32 v215, v158, v159
    buffer_store_dwordx4 v[212:215], v9, s[8:11], s46 offen sc1
    s_add_u32 s46, s46, 32768
    v_cvt_pk_bf16_f32 v216, v160, v161
    v_cvt_pk_bf16_f32 v217, v162, v163
    v_cvt_pk_bf16_f32 v218, v164, v165
    v_cvt_pk_bf16_f32 v219, v166, v167
    buffer_store_dwordx4 v[216:219], v9, s[8:11], s46 offen sc1
    s_add_u32 s46, s46, 32768
    v_cvt_pk_bf16_f32 v220, v168, v169
    v_cvt_pk_bf16_f32 v221, v170, v171
    v_cvt_pk_bf16_f32 v222, v172, v173
    v_cvt_pk_bf16_f32 v223, v174, v175
    buffer_store_dwordx4 v[220:223], v9, s[8:11], s46 offen sc1
    s_add_u32 s46, s46, 32768
    v_cvt_pk_bf16_f32 v224, v176, v177
    v_cvt_pk_bf16_f32 v225, v178, v179
    v_cvt_pk_bf16_f32 v226, v180, v181
    v_cvt_pk_bf16_f32 v227, v182, v183
    buffer_store_dwordx4 v[224:227], v9, s[8:11], s46 offen sc1
    s_add_u32 s46, s46, 32768
    v_cvt_pk_bf16_f32 v228, v184, v185
    v_cvt_pk_bf16_f32 v229, v186, v187
    v_cvt_pk_bf16_f32 v230, v188, v189
    v_cvt_pk_bf16_f32 v231, v190, v191
    buffer_store_dwordx4 v[228:231], v9, s[8:11], s46 offen sc1
    s_cmp_eq_u32 s58, 1
    s_cbranch_scc1 interleave_layers__linear_attn_block__memory_aug_recurrent_mem_tr__prompt_kernel_of43
    s_waitcnt vmcnt(0)
    s_barrier
    s_add_u32 s24, s40, 1
    s_cmp_eq_u32 s3, 0
    s_cbranch_scc0 interleave_layers__linear_attn_block__memory_aug_recurrent_mem_tr__prompt_kernel_fp44
    v_mov_b32 v15, s24
    buffer_store_dword v15, v14, s[8:11], 0 offen sc1
interleave_layers__linear_attn_block__memory_aug_recurrent_mem_tr__prompt_kernel_fp44:
    s_add_u32 s63, s40, 2
    s_min_u32 s63, s63, 64
    s_cmp_ge_i32 s62, s63
    s_cbranch_scc1 interleave_layers__linear_attn_block__memory_aug_recurrent_mem_tr__prompt_kernel_o_en4_ok
    s_mov_b32 s61, 0
interleave_layers__linear_attn_block__memory_aug_recurrent_mem_tr__prompt_kernel_o_en4:
    buffer_load_dword v11, v10, s[8:11], 0 offen sc1
    s_waitcnt vmcnt(0)
    v_readlane_b32 s62, v11, 0
    s_cmp_ge_i32 s62, s63
    s_cbranch_scc1 interleave_layers__linear_attn_block__memory_aug_recurrent_mem_tr__prompt_kernel_o_en4_ok
    s_add_u32 s61, s61, 1
    s_cmp_ge_u32 s61, s60
    s_cbranch_scc1 interleave_layers__linear_attn_block__memory_aug_recurrent_mem_tr__prompt_kernel_o_en4_to
    s_sleep 2
    s_branch interleave_layers__linear_attn_block__memory_aug_recurrent_mem_tr__prompt_kernel_o_en4
interleave_layers__linear_attn_block__memory_aug_recurrent_mem_tr__prompt_kernel_o_en4_to:
    s_mov_b32 s60, 1
interleave_layers__linear_attn_block__memory_aug_recurrent_mem_tr__prompt_kernel_o_en4_ok:
    buffer_load_dwordx4 v[16:19], v6, s[8:11], s41 offen offset:0 sc1
    buffer_load_dwordx4 v[20:23], v6, s[8:11], s41 offen offset:1024 sc1
    buffer_load_dwordx4 v[24:27], v6, s[8:11], s41 offen offset:2048 sc1
    buffer_load_dwordx4 v[28:31], v6, s[8:11], s41 offen offset:3072 sc1
    buffer_load_dwordx4 v[32:35], v7, s[8:11], s41 offen offset:0 sc1
    buffer_load_dwordx4 v[36:39], v7, s[8:11], s41 offen offset:1024 sc1
    buffer_load_dwordx4 v[40:43], v7, s[8:11], s41 offen offset:2048 sc1
    buffer_load_dwordx4 v[44:47], v7, s[8:11], s41 offen offset:3072 sc1
    buffer_load_dwordx4 v[48:51], v8, s[8:11], s41 offen offset:0 sc1
    buffer_load_dwordx4 v[52:55], v8, s[8:11], s41 offen offset:1024 sc1
    buffer_load_dwordx4 v[56:59], v8, s[8:11], s41 offen offset:2048 sc1
    buffer_load_dwordx4 v[60:63], v8, s[8:11], s41 offen offset:3072 sc1
    s_add_u32 s41, s41, 393216
    s_waitcnt vmcnt(0)
interleave_layers__linear_attn_block__memory_aug_recurrent_mem_tr__prompt_kernel_of43:
    s_waitcnt vmcnt(10)
    s_add_u32 s40, s40, 1
    s_add_u32 s43, s43, 1310720
    s_cmp_lt_u32 s40, 64
    s_cbranch_scc1 interleave_layers__linear_attn_block__memory_aug_recurrent_mem_tr__prompt_kernel_o_seg
    s_waitcnt vmcnt(0)
    s_barrier
    s_cmp_eq_u32 s3, 0
    s_cbranch_scc0 interleave_layers__linear_attn_block__memory_aug_recurrent_mem_tr__prompt_kernel_fp45
    v_mov_b32 v15, s40
    buffer_store_dword v15, v14, s[8:11], 0 offen sc1
interleave_layers__linear_attn_block__memory_aug_recurrent_mem_tr__prompt_kernel_fp45:
    s_cmp_eq_u32 s92, 0
    s_cbranch_scc0 interleave_layers__linear_attn_block__memory_aug_recurrent_mem_tr__prompt_kernel_end
    s_mov_b32 s92, 1
    s_branch interleave_layers__linear_attn_block__memory_aug_recurrent_mem_tr__prompt_kernel_o_layer
interleave_layers__linear_attn_block__memory_aug_recurrent_mem_tr__prompt_kernel_end:
    s_endpgm
.section .rodata,"a"
.p2align 6
.amdhsa_kernel interleave_layers__linear_attn_block__memory_aug_recurrent_mem_tr__prompt_kernel
  .amdhsa_next_free_vgpr 512
  .amdhsa_next_free_sgpr 100
  .amdhsa_accum_offset 256
  .amdhsa_group_segment_fixed_size 0
  .amdhsa_kernarg_size 104
  .amdhsa_user_sgpr_count 2
  .amdhsa_user_sgpr_kernarg_segment_ptr 1
  .amdhsa_system_sgpr_workgroup_id_x 1
.end_amdhsa_kernel
```

```asm
; @launch kernel=interleave_layers__linear_attn_block__memory_aug_recurrent_mem_tr__prompt_kernel grid=(256,1,1) block=(256,1,1) lds=135168
.amdgcn_target "amdgcn-amd-amdhsa--gfx950"
.text
.globl interleave_layers__linear_attn_block__memory_aug_recurrent_mem_tr__prompt_kernel
.p2align 8
.type interleave_layers__linear_attn_block__memory_aug_recurrent_mem_tr__prompt_kernel,@function
interleave_layers__linear_attn_block__memory_aug_recurrent_mem_tr__prompt_kernel:
    s_cmp_ge_u32 s2, 256
    s_cbranch_scc1 interleave_layers__linear_attn_block__memory_aug_recurrent_mem_tr__prompt_kernel_end
    s_load_dwordx2 s[4:5], s[0:1], 96
    s_load_dwordx2 s[6:7], s[0:1], 88
    s_load_dwordx2 s[24:25], s[0:1], 0
    s_load_dwordx2 s[98:99], s[0:1], 8
    s_and_b32 s44, s2, 7
    s_lshr_b32 s45, s2, 3
    s_and_b32 s26, s44, 3
    s_lshl_b32 s27, s45, 2
    s_add_u32 s26, s26, s27
    s_add_u32 s27, s26, 128
    s_cmp_lt_u32 s26, 104
    s_cselect_b32 s27, s26, s27
    s_add_u32 s26, s26, 104
    s_cmp_lt_u32 s44, 4
    s_cselect_b32 s2, s27, s26
    v_and_b32 v1, 63, v0
    v_lshrrev_b32 v4, 6, v0
    v_and_b32 v2, 15, v1
    v_lshrrev_b32 v3, 4, v1
    v_readfirstlane_b32 s3, v4
    s_mov_b32 s60, 131072
    s_mov_b32 s59, -1
    s_mov_b32 s92, 0
    s_mov_b32 s36, 0
    s_waitcnt lgkmcnt(0)
    s_mov_b32 s8, s4
    s_mov_b32 s9, s5
    s_mov_b32 s10, 268435456
    s_mov_b32 s11, 0x00020000
    s_mov_b32 s72, s6
    s_mov_b32 s73, s7
    s_mov_b32 s74, 256
    s_mov_b32 s75, 0x00020000
    s_mov_b32 s16, s24
    s_mov_b32 s17, s25
    s_mov_b32 s18, 2621440
    s_mov_b32 s19, 0x00020000
    s_cmp_eq_u32 s2, 255
    s_cbranch_scc0 interleave_layers__linear_attn_block__memory_aug_recurrent_mem_tr__prompt_kernel_cf1
    v_lshlrev_b32 v5, 4, v0
    v_mov_b32 v8, -1
    v_mov_b32 v9, -1
    v_mov_b32 v10, -1
    v_mov_b32 v11, -1
    s_mov_b32 s24, 23068672
    buffer_store_dwordx4 v[8:11], v5, s[8:11], s24 offen sc1
    s_add_u32 s24, s24, 4096
    buffer_store_dwordx4 v[8:11], v5, s[8:11], s24 offen sc1
    s_add_u32 s24, s24, 4096
    buffer_store_dwordx4 v[8:11], v5, s[8:11], s24 offen sc1
    s_add_u32 s24, s24, 4096
    buffer_store_dwordx4 v[8:11], v5, s[8:11], s24 offen sc1
    s_add_u32 s24, s24, 4096
    buffer_store_dwordx4 v[8:11], v5, s[8:11], s24 offen sc1
    s_add_u32 s24, s24, 4096
    buffer_store_dwordx4 v[8:11], v5, s[8:11], s24 offen sc1
    s_add_u32 s24, s24, 4096
    buffer_store_dwordx4 v[8:11], v5, s[8:11], s24 offen sc1
    s_add_u32 s24, s24, 4096
    buffer_store_dwordx4 v[8:11], v5, s[8:11], s24 offen sc1
    s_add_u32 s24, s24, 4096
    buffer_store_dwordx4 v[8:11], v5, s[8:11], s24 offen sc1
    s_add_u32 s24, s24, 4096
    buffer_store_dwordx4 v[8:11], v5, s[8:11], s24 offen sc1
    s_add_u32 s24, s24, 4096
    buffer_store_dwordx4 v[8:11], v5, s[8:11], s24 offen sc1
    s_add_u32 s24, s24, 4096
    buffer_store_dwordx4 v[8:11], v5, s[8:11], s24 offen sc1
    s_add_u32 s24, s24, 4096
    buffer_store_dwordx4 v[8:11], v5, s[8:11], s24 offen sc1
    s_add_u32 s24, s24, 4096
    buffer_store_dwordx4 v[8:11], v5, s[8:11], s24 offen sc1
    s_add_u32 s24, s24, 4096
    buffer_store_dwordx4 v[8:11], v5, s[8:11], s24 offen sc1
    s_add_u32 s24, s24, 4096
    buffer_store_dwordx4 v[8:11], v5, s[8:11], s24 offen sc1
    s_add_u32 s24, s24, 4096
interleave_layers__linear_attn_block__memory_aug_recurrent_mem_tr__prompt_kernel_cf1:
    s_mov_b32 s46, 64
    s_mov_b32 s47, 32
    s_mov_b32 s50, 0
    s_lshl_b32 s48, s45, 1
    s_mov_b32 s49, 1
    s_mov_b32 s40, 2
interleave_layers__linear_attn_block__memory_aug_recurrent_mem_tr__prompt_kernel_k1_entry:
    v_and_b32 v7, 31, v0
    v_lshrrev_b32 v8, 5, v0
    v_mul_u32_u24 v152, 3840, v8
    v_lshlrev_b32 v9, 4, v7
    v_add_u32 v152, v152, v9
    v_cmp_le_u32 vcc, 10, v7
    s_nop 1
    v_cndmask_b32 v10, 0, 1, vcc
    v_cmp_le_u32 vcc, 20, v7
    s_nop 1
    v_cndmask_b32 v11, 0, 1, vcc
    v_add_u32 v10, v10, v11
    v_mul_u32_u24 v10, 1120, v10
    v_add_u32 v152, v152, v10
    v_mov_b32 v10, 2146435072
    v_cmp_le_u32 vcc, 30, v7
    s_nop 1
    v_cndmask_b32 v152, v152, v10, vcc
    v_mul_u32_u24 v153, 544, v8
    v_add_u32 v153, v153, v9
    v_add_u32 v153, 40960, v153
    s_mov_b32 s12, s98
    s_mov_b32 s13, s99
    s_mov_b32 s14, 2457600
    s_mov_b32 s15, 0x00020000
    s_mul_i32 s52, s44, 160
    v_lshrrev_b32 v10, 2, v0
    v_mul_u32_u24 v10, 3840, v10
    v_and_b32 v11, 3, v0
    v_lshlrev_b32 v11, 6, v11
    v_min_u32 v11, 156, v11
    v_add_u32 v10, v10, v11
    s_mul_i32 s24, s45, 205
    s_lshr_b32 s24, s24, 11
    s_mul_i32 s24, s24, 10
    s_sub_u32 s24, s45, s24
    s_mul_i32 s24, s24, 245760
    s_add_u32 s24, s24, s52
    buffer_load_dword a254, v10, s[12:15], s24 offen
    s_add_u32 s24, s24, 1280
    buffer_load_dword a254, v10, s[12:15], s24 offen
    s_add_u32 s24, s24, 1280
    buffer_load_dword a254, v10, s[12:15], s24 offen
    s_add_u32 s24, s52, 0
    buffer_load_dwordx4 v[56:59], v152, s[12:15], s24 offen
    s_add_u32 s24, s24, 30720
    buffer_load_dwordx4 v[60:63], v152, s[12:15], s24 offen
    s_add_u32 s24, s24, 30720
    buffer_load_dwordx4 v[64:67], v152, s[12:15], s24 offen
    s_add_u32 s24, s24, 30720
    buffer_load_dwordx4 v[68:71], v152, s[12:15], s24 offen
    s_add_u32 s24, s24, 30720
    buffer_load_dwordx4 v[72:75], v152, s[12:15], s24 offen
    s_add_u32 s24, s24, 30720
    buffer_load_dwordx4 v[76:79], v152, s[12:15], s24 offen
    s_add_u32 s24, s24, 30720
    buffer_load_dwordx4 v[80:83], v152, s[12:15], s24 offen
    s_add_u32 s24, s24, 30720
    buffer_load_dwordx4 v[84:87], v152, s[12:15], s24 offen
    s_add_u32 s24, s52, 245760
    buffer_load_dwordx4 v[88:91], v152, s[12:15], s24 offen
    s_add_u32 s24, s24, 30720
    buffer_load_dwordx4 v[92:95], v152, s[12:15], s24 offen
    s_add_u32 s24, s24, 30720
    buffer_load_dwordx4 v[96:99], v152, s[12:15], s24 offen
    s_add_u32 s24, s24, 30720
    buffer_load_dwordx4 v[100:103], v152, s[12:15], s24 offen
    s_add_u32 s24, s24, 30720
    buffer_load_dwordx4 v[104:107], v152, s[12:15], s24 offen
    s_add_u32 s24, s24, 30720
    buffer_load_dwordx4 v[108:111], v152, s[12:15], s24 offen
    s_add_u32 s24, s24, 30720
    buffer_load_dwordx4 v[112:115], v152, s[12:15], s24 offen
    s_add_u32 s24, s24, 30720
    buffer_load_dwordx4 v[116:119], v152, s[12:15], s24 offen
    s_add_u32 s24, s52, 491520
    buffer_load_dwordx4 v[120:123], v152, s[12:15], s24 offen
    s_add_u32 s24, s24, 30720
    buffer_load_dwordx4 v[124:127], v152, s[12:15], s24 offen
    s_add_u32 s24, s24, 30720
    buffer_load_dwordx4 v[128:131], v152, s[12:15], s24 offen
    s_add_u32 s24, s24, 30720
    buffer_load_dwordx4 v[132:135], v152, s[12:15], s24 offen
    s_add_u32 s24, s24, 30720
    buffer_load_dwordx4 v[136:139], v152, s[12:15], s24 offen
    s_add_u32 s24, s24, 30720
    buffer_load_dwordx4 v[140:143], v152, s[12:15], s24 offen
    s_add_u32 s24, s24, 30720
    buffer_load_dwordx4 v[144:147], v152, s[12:15], s24 offen
    s_add_u32 s24, s24, 30720
    buffer_load_dwordx4 v[148:151], v152, s[12:15], s24 offen
    s_lshr_b32 s24, s3, 1
    s_mul_i32 s24, s24, 20480
    s_and_b32 s25, s3, 1
    s_mul_i32 s25, s25, 10
    s_mul_i32 s25, s25, s46
    s_add_u32 s24, s24, s25
    s_cmp_eq_u32 s50, 1
    s_cselect_b32 s25, 16, 1280
    s_cselect_b32 s26, 256, 8
    v_mul_u32_u24 v4, s25, v2
    v_mul_u32_u24 v5, s26, v3
    v_add3_u32 v4, v4, v5, s24
    v_add_u32 v5, s47, v4
    s_mul_i32 s43, s48, 40960
    s_mul_i32 s42, s49, 40960
    s_cmp_eq_u32 s92, 0
    s_cselect_b32 s51, 1, 0
    s_cselect_b32 s41, s43, 2146435072
    s_mov_b32 s24, s41
    buffer_load_dwordx2 v[16:17], v4, s[16:19], s24 offen
    buffer_load_dwordx2 v[18:19], v5, s[16:19], s24 offen
    s_add_u32 s24, s24, s46
    buffer_load_dwordx2 v[20:21], v4, s[16:19], s24 offen
    buffer_load_dwordx2 v[22:23], v5, s[16:19], s24 offen
    s_add_u32 s24, s24, s46
    buffer_load_dwordx2 v[24:25], v4, s[16:19], s24 offen
    buffer_load_dwordx2 v[26:27], v5, s[16:19], s24 offen
    s_add_u32 s24, s24, s46
    buffer_load_dwordx2 v[28:29], v4, s[16:19], s24 offen
    buffer_load_dwordx2 v[30:31], v5, s[16:19], s24 offen
    s_add_u32 s24, s24, s46
    buffer_load_dwordx2 v[32:33], v4, s[16:19], s24 offen
    buffer_load_dwordx2 v[34:35], v5, s[16:19], s24 offen
    s_add_u32 s24, s24, s46
    buffer_load_dwordx2 v[36:37], v4, s[16:19], s24 offen
    buffer_load_dwordx2 v[38:39], v5, s[16:19], s24 offen
    s_add_u32 s24, s24, s46
    buffer_load_dwordx2 v[40:41], v4, s[16:19], s24 offen
    buffer_load_dwordx2 v[42:43], v5, s[16:19], s24 offen
    s_add_u32 s24, s24, s46
    buffer_load_dwordx2 v[44:45], v4, s[16:19], s24 offen
    buffer_load_dwordx2 v[46:47], v5, s[16:19], s24 offen
    s_add_u32 s24, s24, s46
    buffer_load_dwordx2 v[48:49], v4, s[16:19], s24 offen
    buffer_load_dwordx2 v[50:51], v5, s[16:19], s24 offen
    s_add_u32 s24, s24, s46
    buffer_load_dwordx2 v[52:53], v4, s[16:19], s24 offen
    buffer_load_dwordx2 v[54:55], v5, s[16:19], s24 offen
    v_lshrrev_b32 v6, 2, v2
    v_lshl_add_u32 v6, v3, 2, v6
    v_mul_u32_u24 v6, 544, v6
    v_and_b32 v7, 3, v2
    v_lshl_add_u32 v6, v7, 3, v6
    v_add_u32 v6, 40960, v6
    s_mov_b32 s24, 0
    s_cmp_eq_u32 s3, 1
    s_cselect_b32 s24, 64, s24
    s_cmp_eq_u32 s3, 2
    s_cselect_b32 s24, 128, s24
    s_cmp_eq_u32 s3, 3
    s_cselect_b32 s24, 224, s24
    v_add_u32 v12, s24, v6
    s_mov_b32 s24, 32
    s_cmp_eq_u32 s3, 1
    s_cselect_b32 s24, 96, s24
    s_cmp_eq_u32 s3, 2
    s_cselect_b32 s24, 160, s24
    s_cmp_eq_u32 s3, 3
    s_cselect_b32 s24, 256, s24
    v_add_u32 v13, s24, v6
    s_mov_b32 s24, 320
    s_cmp_eq_u32 s3, 1
    s_cselect_b32 s24, 384, s24
    s_cmp_eq_u32 s3, 2
    s_cselect_b32 s24, 192, s24
    s_cmp_eq_u32 s3, 3
    s_cselect_b32 s24, 288, s24
    v_add_u32 v14, s24, v6
    s_mov_b32 s24, 352
    s_cmp_eq_u32 s3, 1
    s_cselect_b32 s24, 416, s24
    s_cmp_eq_u32 s3, 2
    s_cselect_b32 s24, 448, s24
    s_cmp_eq_u32 s3, 3
    s_cselect_b32 s24, 288, s24
    v_add_u32 v15, s24, v6
    v_mov_b32 v172, 0x3f803f80
    v_mov_b32 v173, 0x3f803f80
    v_mov_b32 v174, 0x3f803f80
    v_mov_b32 v175, 0x3f803f80
    s_waitcnt vmcnt(36)
    ds_write_b128 v153, v[56:59] offset:0
    ds_write_b128 v153, v[60:63] offset:4352
    ds_write_b128 v153, v[64:67] offset:8704
    ds_write_b128 v153, v[68:71] offset:13056
    ds_write_b128 v153, v[72:75] offset:17408
    ds_write_b128 v153, v[76:79] offset:21760
    ds_write_b128 v153, v[80:83] offset:26112
    ds_write_b128 v153, v[84:87] offset:30464
    s_waitcnt lgkmcnt(0)
    s_add_u32 s24, s52, 737280
    buffer_load_dwordx4 v[56:59], v152, s[12:15], s24 offen
    s_add_u32 s24, s24, 30720
    buffer_load_dwordx4 v[60:63], v152, s[12:15], s24 offen
    s_add_u32 s24, s24, 30720
    buffer_load_dwordx4 v[64:67], v152, s[12:15], s24 offen
    s_add_u32 s24, s24, 30720
    buffer_load_dwordx4 v[68:71], v152, s[12:15], s24 offen
    s_add_u32 s24, s24, 30720
    buffer_load_dwordx4 v[72:75], v152, s[12:15], s24 offen
    s_add_u32 s24, s24, 30720
    buffer_load_dwordx4 v[76:79], v152, s[12:15], s24 offen
    s_add_u32 s24, s24, 30720
    buffer_load_dwordx4 v[80:83], v152, s[12:15], s24 offen
    s_add_u32 s24, s24, 30720
    buffer_load_dwordx4 v[84:87], v152, s[12:15], s24 offen
    s_barrier
    ds_read_b64_tr_b16 a[0:1], v12 offset:0
    ds_read_b64_tr_b16 a[2:3], v12 offset:8704
    ds_read_b64_tr_b16 a[4:5], v12 offset:17408
    ds_read_b64_tr_b16 a[6:7], v12 offset:26112
    ds_read_b64_tr_b16 a[80:81], v13 offset:0
    ds_read_b64_tr_b16 a[82:83], v13 offset:8704
    ds_read_b64_tr_b16 a[84:85], v13 offset:17408
    ds_read_b64_tr_b16 a[86:87], v13 offset:26112
    ds_read_b64_tr_b16 a[160:161], v14 offset:0
    ds_read_b64_tr_b16 a[162:163], v14 offset:8704
    ds_read_b64_tr_b16 a[164:165], v14 offset:17408
    ds_read_b64_tr_b16 a[166:167], v14 offset:26112
    ds_read_b64_tr_b16 v[176:177], v15 offset:0
    ds_read_b64_tr_b16 v[178:179], v15 offset:8704
    ds_read_b64_tr_b16 v[180:181], v15 offset:17408
    ds_read_b64_tr_b16 v[182:183], v15 offset:26112
    s_waitcnt vmcnt(36)
    ds_write_b128 v153, v[88:91] offset:34816
    ds_write_b128 v153, v[92:95] offset:39168
    ds_write_b128 v153, v[96:99] offset:43520
    ds_write_b128 v153, v[100:103] offset:47872
    ds_write_b128 v153, v[104:107] offset:52224
    ds_write_b128 v153, v[108:111] offset:56576
    ds_write_b128 v153, v[112:115] offset:60928
    ds_write_b128 v153, v[116:119] offset:65280
    s_waitcnt lgkmcnt(0)
    s_add_u32 s24, s52, 983040
    buffer_load_dwordx4 v[88:91], v152, s[12:15], s24 offen
    s_add_u32 s24, s24, 30720
    buffer_load_dwordx4 v[92:95], v152, s[12:15], s24 offen
    s_add_u32 s24, s24, 30720
    buffer_load_dwordx4 v[96:99], v152, s[12:15], s24 offen
    s_add_u32 s24, s24, 30720
    buffer_load_dwordx4 v[100:103], v152, s[12:15], s24 offen
    s_add_u32 s24, s24, 30720
    buffer_load_dwordx4 v[104:107], v152, s[12:15], s24 offen
    s_add_u32 s24, s24, 30720
    buffer_load_dwordx4 v[108:111], v152, s[12:15], s24 offen
    s_add_u32 s24, s24, 30720
    buffer_load_dwordx4 v[112:115], v152, s[12:15], s24 offen
    s_add_u32 s24, s24, 30720
    buffer_load_dwordx4 v[116:119], v152, s[12:15], s24 offen
    v_mfma_f32_16x16x32_bf16 v[156:159], a[0:3], v[172:175], 0
    v_mfma_f32_16x16x32_bf16 v[160:163], a[80:83], v[172:175], 0
    v_mfma_f32_16x16x32_bf16 v[164:167], a[160:163], v[172:175], 0
    v_mfma_f32_16x16x32_bf16 v[168:171], v[176:179], v[172:175], 0
    v_mfma_f32_16x16x32_bf16 v[156:159], a[4:7], v[172:175], v[156:159]
    v_mfma_f32_16x16x32_bf16 v[160:163], a[84:87], v[172:175], v[160:163]
    v_mfma_f32_16x16x32_bf16 v[164:167], a[164:167], v[172:175], v[164:167]
    v_mfma_f32_16x16x32_bf16 v[168:171], v[180:183], v[172:175], v[168:171]
    s_barrier
    ds_read_b64_tr_b16 a[8:9], v12 offset:34816
    ds_read_b64_tr_b16 a[10:11], v12 offset:43520
    ds_read_b64_tr_b16 a[12:13], v12 offset:52224
    ds_read_b64_tr_b16 a[14:15], v12 offset:60928
    ds_read_b64_tr_b16 a[88:89], v13 offset:34816
    ds_read_b64_tr_b16 a[90:91], v13 offset:43520
    ds_read_b64_tr_b16 a[92:93], v13 offset:52224
    ds_read_b64_tr_b16 a[94:95], v13 offset:60928
    ds_read_b64_tr_b16 a[168:169], v14 offset:34816
    ds_read_b64_tr_b16 a[170:171], v14 offset:43520
    ds_read_b64_tr_b16 a[172:173], v14 offset:52224
    ds_read_b64_tr_b16 a[174:175], v14 offset:60928
    ds_read_b64_tr_b16 v[184:185], v15 offset:34816
    ds_read_b64_tr_b16 v[186:187], v15 offset:43520
    ds_read_b64_tr_b16 v[188:189], v15 offset:52224
    ds_read_b64_tr_b16 v[190:191], v15 offset:60928
    s_waitcnt vmcnt(36)
    ds_write_b128 v153, v[120:123] offset:0
    ds_write_b128 v153, v[124:127] offset:4352
    ds_write_b128 v153, v[128:131] offset:8704
    ds_write_b128 v153, v[132:135] offset:13056
    ds_write_b128 v153, v[136:139] offset:17408
    ds_write_b128 v153, v[140:143] offset:21760
    ds_write_b128 v153, v[144:147] offset:26112
    ds_write_b128 v153, v[148:151] offset:30464
    s_waitcnt lgkmcnt(0)
    s_add_u32 s24, s52, 1228800
    buffer_load_dwordx4 v[120:123], v152, s[12:15], s24 offen
    s_add_u32 s24, s24, 30720
    buffer_load_dwordx4 v[124:127], v152, s[12:15], s24 offen
    s_add_u32 s24, s24, 30720
    buffer_load_dwordx4 v[128:131], v152, s[12:15], s24 offen
    s_add_u32 s24, s24, 30720
    buffer_load_dwordx4 v[132:135], v152, s[12:15], s24 offen
    s_add_u32 s24, s24, 30720
    buffer_load_dwordx4 v[136:139], v152, s[12:15], s24 offen
    s_add_u32 s24, s24, 30720
    buffer_load_dwordx4 v[140:143], v152, s[12:15], s24 offen
    s_add_u32 s24, s24, 30720
    buffer_load_dwordx4 v[144:147], v152, s[12:15], s24 offen
    s_add_u32 s24, s24, 30720
    buffer_load_dwordx4 v[148:151], v152, s[12:15], s24 offen
    v_mfma_f32_16x16x32_bf16 v[156:159], a[8:11], v[172:175], v[156:159]
    v_mfma_f32_16x16x32_bf16 v[160:163], a[88:91], v[172:175], v[160:163]
    v_mfma_f32_16x16x32_bf16 v[164:167], a[168:171], v[172:175], v[164:167]
    v_mfma_f32_16x16x32_bf16 v[168:171], v[184:187], v[172:175], v[168:171]
    v_mfma_f32_16x16x32_bf16 v[156:159], a[12:15], v[172:175], v[156:159]
    v_mfma_f32_16x16x32_bf16 v[160:163], a[92:95], v[172:175], v[160:163]
    v_mfma_f32_16x16x32_bf16 v[164:167], a[172:175], v[172:175], v[164:167]
    v_mfma_f32_16x16x32_bf16 v[168:171], v[188:191], v[172:175], v[168:171]
    s_barrier
    ds_read_b64_tr_b16 a[16:17], v12 offset:0
    ds_read_b64_tr_b16 a[18:19], v12 offset:8704
    ds_read_b64_tr_b16 a[20:21], v12 offset:17408
    ds_read_b64_tr_b16 a[22:23], v12 offset:26112
    ds_read_b64_tr_b16 a[96:97], v13 offset:0
    ds_read_b64_tr_b16 a[98:99], v13 offset:8704
    ds_read_b64_tr_b16 a[100:101], v13 offset:17408
    ds_read_b64_tr_b16 a[102:103], v13 offset:26112
    ds_read_b64_tr_b16 a[176:177], v14 offset:0
    ds_read_b64_tr_b16 a[178:179], v14 offset:8704
    ds_read_b64_tr_b16 a[180:181], v14 offset:17408
    ds_read_b64_tr_b16 a[182:183], v14 offset:26112
    ds_read_b64_tr_b16 v[192:193], v15 offset:0
    ds_read_b64_tr_b16 v[194:195], v15 offset:8704
    ds_read_b64_tr_b16 v[196:197], v15 offset:17408
    ds_read_b64_tr_b16 v[198:199], v15 offset:26112
    s_waitcnt vmcnt(16)
    ds_write_b128 v153, v[56:59] offset:34816
    ds_write_b128 v153, v[60:63] offset:39168
    ds_write_b128 v153, v[64:67] offset:43520
    ds_write_b128 v153, v[68:71] offset:47872
    ds_write_b128 v153, v[72:75] offset:52224
    ds_write_b128 v153, v[76:79] offset:56576
    ds_write_b128 v153, v[80:83] offset:60928
    ds_write_b128 v153, v[84:87] offset:65280
    s_waitcnt lgkmcnt(0)
    s_add_u32 s24, s52, 1474560
    buffer_load_dwordx4 v[56:59], v152, s[12:15], s24 offen
    s_add_u32 s24, s24, 30720
    buffer_load_dwordx4 v[60:63], v152, s[12:15], s24 offen
    s_add_u32 s24, s24, 30720
    buffer_load_dwordx4 v[64:67], v152, s[12:15], s24 offen
    s_add_u32 s24, s24, 30720
    buffer_load_dwordx4 v[68:71], v152, s[12:15], s24 offen
    s_add_u32 s24, s24, 30720
    buffer_load_dwordx4 v[72:75], v152, s[12:15], s24 offen
    s_add_u32 s24, s24, 30720
    buffer_load_dwordx4 v[76:79], v152, s[12:15], s24 offen
    s_add_u32 s24, s24, 30720
    buffer_load_dwordx4 v[80:83], v152, s[12:15], s24 offen
    s_add_u32 s24, s24, 30720
    buffer_load_dwordx4 v[84:87], v152, s[12:15], s24 offen
    v_mfma_f32_16x16x32_bf16 v[156:159], a[16:19], v[172:175], v[156:159]
    v_mfma_f32_16x16x32_bf16 v[160:163], a[96:99], v[172:175], v[160:163]
    v_mfma_f32_16x16x32_bf16 v[164:167], a[176:179], v[172:175], v[164:167]
    v_mfma_f32_16x16x32_bf16 v[168:171], v[192:195], v[172:175], v[168:171]
    v_mfma_f32_16x16x32_bf16 v[156:159], a[20:23], v[172:175], v[156:159]
    v_mfma_f32_16x16x32_bf16 v[160:163], a[100:103], v[172:175], v[160:163]
    v_mfma_f32_16x16x32_bf16 v[164:167], a[180:183], v[172:175], v[164:167]
    v_mfma_f32_16x16x32_bf16 v[168:171], v[196:199], v[172:175], v[168:171]
    s_barrier
    ds_read_b64_tr_b16 a[24:25], v12 offset:34816
    ds_read_b64_tr_b16 a[26:27], v12 offset:43520
    ds_read_b64_tr_b16 a[28:29], v12 offset:52224
    ds_read_b64_tr_b16 a[30:31], v12 offset:60928
    ds_read_b64_tr_b16 a[104:105], v13 offset:34816
    ds_read_b64_tr_b16 a[106:107], v13 offset:43520
    ds_read_b64_tr_b16 a[108:109], v13 offset:52224
    ds_read_b64_tr_b16 a[110:111], v13 offset:60928
    ds_read_b64_tr_b16 a[184:185], v14 offset:34816
    ds_read_b64_tr_b16 a[186:187], v14 offset:43520
    ds_read_b64_tr_b16 a[188:189], v14 offset:52224
    ds_read_b64_tr_b16 a[190:191], v14 offset:60928
    ds_read_b64_tr_b16 v[200:201], v15 offset:34816
    ds_read_b64_tr_b16 v[202:203], v15 offset:43520
    ds_read_b64_tr_b16 v[204:205], v15 offset:52224
    ds_read_b64_tr_b16 v[206:207], v15 offset:60928
    s_waitcnt vmcnt(16)
    ds_write_b128 v153, v[88:91] offset:0
    ds_write_b128 v153, v[92:95] offset:4352
    ds_write_b128 v153, v[96:99] offset:8704
    ds_write_b128 v153, v[100:103] offset:13056
    ds_write_b128 v153, v[104:107] offset:17408
    ds_write_b128 v153, v[108:111] offset:21760
    ds_write_b128 v153, v[112:115] offset:26112
    ds_write_b128 v153, v[116:119] offset:30464
    s_waitcnt lgkmcnt(0)
    s_add_u32 s24, s52, 1720320
    buffer_load_dwordx4 v[88:91], v152, s[12:15], s24 offen
    s_add_u32 s24, s24, 30720
    buffer_load_dwordx4 v[92:95], v152, s[12:15], s24 offen
    s_add_u32 s24, s24, 30720
    buffer_load_dwordx4 v[96:99], v152, s[12:15], s24 offen
    s_add_u32 s24, s24, 30720
    buffer_load_dwordx4 v[100:103], v152, s[12:15], s24 offen
    s_add_u32 s24, s24, 30720
    buffer_load_dwordx4 v[104:107], v152, s[12:15], s24 offen
    s_add_u32 s24, s24, 30720
    buffer_load_dwordx4 v[108:111], v152, s[12:15], s24 offen
    s_add_u32 s24, s24, 30720
    buffer_load_dwordx4 v[112:115], v152, s[12:15], s24 offen
    s_add_u32 s24, s24, 30720
    buffer_load_dwordx4 v[116:119], v152, s[12:15], s24 offen
    v_mfma_f32_16x16x32_bf16 v[156:159], a[24:27], v[172:175], v[156:159]
    v_mfma_f32_16x16x32_bf16 v[160:163], a[104:107], v[172:175], v[160:163]
    v_mfma_f32_16x16x32_bf16 v[164:167], a[184:187], v[172:175], v[164:167]
    v_mfma_f32_16x16x32_bf16 v[168:171], v[200:203], v[172:175], v[168:171]
    v_mfma_f32_16x16x32_bf16 v[156:159], a[28:31], v[172:175], v[156:159]
    v_mfma_f32_16x16x32_bf16 v[160:163], a[108:111], v[172:175], v[160:163]
    v_mfma_f32_16x16x32_bf16 v[164:167], a[188:191], v[172:175], v[164:167]
    v_mfma_f32_16x16x32_bf16 v[168:171], v[204:207], v[172:175], v[168:171]
    s_barrier
    ds_read_b64_tr_b16 a[32:33], v12 offset:0
    ds_read_b64_tr_b16 a[34:35], v12 offset:8704
    ds_read_b64_tr_b16 a[36:37], v12 offset:17408
    ds_read_b64_tr_b16 a[38:39], v12 offset:26112
    ds_read_b64_tr_b16 a[112:113], v13 offset:0
    ds_read_b64_tr_b16 a[114:115], v13 offset:8704
    ds_read_b64_tr_b16 a[116:117], v13 offset:17408
    ds_read_b64_tr_b16 a[118:119], v13 offset:26112
    ds_read_b64_tr_b16 a[192:193], v14 offset:0
    ds_read_b64_tr_b16 a[194:195], v14 offset:8704
    ds_read_b64_tr_b16 a[196:197], v14 offset:17408
    ds_read_b64_tr_b16 a[198:199], v14 offset:26112
    ds_read_b64_tr_b16 v[208:209], v15 offset:0
    ds_read_b64_tr_b16 v[210:211], v15 offset:8704
    ds_read_b64_tr_b16 v[212:213], v15 offset:17408
    ds_read_b64_tr_b16 v[214:215], v15 offset:26112
    s_waitcnt vmcnt(16)
    ds_write_b128 v153, v[120:123] offset:34816
    ds_write_b128 v153, v[124:127] offset:39168
    ds_write_b128 v153, v[128:131] offset:43520
    ds_write_b128 v153, v[132:135] offset:47872
    ds_write_b128 v153, v[136:139] offset:52224
    ds_write_b128 v153, v[140:143] offset:56576
    ds_write_b128 v153, v[144:147] offset:60928
    ds_write_b128 v153, v[148:151] offset:65280
    s_waitcnt lgkmcnt(0)
    s_add_u32 s24, s52, 1966080
    buffer_load_dwordx4 v[120:123], v152, s[12:15], s24 offen
    s_add_u32 s24, s24, 30720
    buffer_load_dwordx4 v[124:127], v152, s[12:15], s24 offen
    s_add_u32 s24, s24, 30720
    buffer_load_dwordx4 v[128:131], v152, s[12:15], s24 offen
    s_add_u32 s24, s24, 30720
    buffer_load_dwordx4 v[132:135], v152, s[12:15], s24 offen
    s_add_u32 s24, s24, 30720
    buffer_load_dwordx4 v[136:139], v152, s[12:15], s24 offen
    s_add_u32 s24, s24, 30720
    buffer_load_dwordx4 v[140:143], v152, s[12:15], s24 offen
    s_add_u32 s24, s24, 30720
    buffer_load_dwordx4 v[144:147], v152, s[12:15], s24 offen
    s_add_u32 s24, s24, 30720
    buffer_load_dwordx4 v[148:151], v152, s[12:15], s24 offen
    v_mfma_f32_16x16x32_bf16 v[156:159], a[32:35], v[172:175], v[156:159]
    v_mfma_f32_16x16x32_bf16 v[160:163], a[112:115], v[172:175], v[160:163]
    v_mfma_f32_16x16x32_bf16 v[164:167], a[192:195], v[172:175], v[164:167]
    v_mfma_f32_16x16x32_bf16 v[168:171], v[208:211], v[172:175], v[168:171]
    v_mfma_f32_16x16x32_bf16 v[156:159], a[36:39], v[172:175], v[156:159]
    v_mfma_f32_16x16x32_bf16 v[160:163], a[116:119], v[172:175], v[160:163]
    v_mfma_f32_16x16x32_bf16 v[164:167], a[196:199], v[172:175], v[164:167]
    v_mfma_f32_16x16x32_bf16 v[168:171], v[212:215], v[172:175], v[168:171]
    s_barrier
    ds_read_b64_tr_b16 a[40:41], v12 offset:34816
    ds_read_b64_tr_b16 a[42:43], v12 offset:43520
    ds_read_b64_tr_b16 a[44:45], v12 offset:52224
    ds_read_b64_tr_b16 a[46:47], v12 offset:60928
    ds_read_b64_tr_b16 a[120:121], v13 offset:34816
    ds_read_b64_tr_b16 a[122:123], v13 offset:43520
    ds_read_b64_tr_b16 a[124:125], v13 offset:52224
    ds_read_b64_tr_b16 a[126:127], v13 offset:60928
    ds_read_b64_tr_b16 a[200:201], v14 offset:34816
    ds_read_b64_tr_b16 a[202:203], v14 offset:43520
    ds_read_b64_tr_b16 a[204:205], v14 offset:52224
    ds_read_b64_tr_b16 a[206:207], v14 offset:60928
    ds_read_b64_tr_b16 v[216:217], v15 offset:34816
    ds_read_b64_tr_b16 v[218:219], v15 offset:43520
    ds_read_b64_tr_b16 v[220:221], v15 offset:52224
    ds_read_b64_tr_b16 v[222:223], v15 offset:60928
    s_waitcnt vmcnt(16)
    ds_write_b128 v153, v[56:59] offset:0
    ds_write_b128 v153, v[60:63] offset:4352
    ds_write_b128 v153, v[64:67] offset:8704
    ds_write_b128 v153, v[68:71] offset:13056
    ds_write_b128 v153, v[72:75] offset:17408
    ds_write_b128 v153, v[76:79] offset:21760
    ds_write_b128 v153, v[80:83] offset:26112
    ds_write_b128 v153, v[84:87] offset:30464
    s_waitcnt lgkmcnt(0)
    s_add_u32 s24, s52, 2211840
    buffer_load_dwordx4 v[56:59], v152, s[12:15], s24 offen
    s_add_u32 s24, s24, 30720
    buffer_load_dwordx4 v[60:63], v152, s[12:15], s24 offen
    s_add_u32 s24, s24, 30720
    buffer_load_dwordx4 v[64:67], v152, s[12:15], s24 offen
    s_add_u32 s24, s24, 30720
    buffer_load_dwordx4 v[68:71], v152, s[12:15], s24 offen
    s_add_u32 s24, s24, 30720
    buffer_load_dwordx4 v[72:75], v152, s[12:15], s24 offen
    s_add_u32 s24, s24, 30720
    buffer_load_dwordx4 v[76:79], v152, s[12:15], s24 offen
    s_add_u32 s24, s24, 30720
    buffer_load_dwordx4 v[80:83], v152, s[12:15], s24 offen
    s_add_u32 s24, s24, 30720
    buffer_load_dwordx4 v[84:87], v152, s[12:15], s24 offen
    v_mfma_f32_16x16x32_bf16 v[156:159], a[40:43], v[172:175], v[156:159]
    v_mfma_f32_16x16x32_bf16 v[160:163], a[120:123], v[172:175], v[160:163]
    v_mfma_f32_16x16x32_bf16 v[164:167], a[200:203], v[172:175], v[164:167]
    v_mfma_f32_16x16x32_bf16 v[168:171], v[216:219], v[172:175], v[168:171]
    v_mfma_f32_16x16x32_bf16 v[156:159], a[44:47], v[172:175], v[156:159]
    v_mfma_f32_16x16x32_bf16 v[160:163], a[124:127], v[172:175], v[160:163]
    v_mfma_f32_16x16x32_bf16 v[164:167], a[204:207], v[172:175], v[164:167]
    v_mfma_f32_16x16x32_bf16 v[168:171], v[220:223], v[172:175], v[168:171]
    s_barrier
    ds_read_b64_tr_b16 a[48:49], v12 offset:0
    ds_read_b64_tr_b16 a[50:51], v12 offset:8704
    ds_read_b64_tr_b16 a[52:53], v12 offset:17408
    ds_read_b64_tr_b16 a[54:55], v12 offset:26112
    ds_read_b64_tr_b16 a[128:129], v13 offset:0
    ds_read_b64_tr_b16 a[130:131], v13 offset:8704
    ds_read_b64_tr_b16 a[132:133], v13 offset:17408
    ds_read_b64_tr_b16 a[134:135], v13 offset:26112
    ds_read_b64_tr_b16 a[208:209], v14 offset:0
    ds_read_b64_tr_b16 a[210:211], v14 offset:8704
    ds_read_b64_tr_b16 a[212:213], v14 offset:17408
    ds_read_b64_tr_b16 a[214:215], v14 offset:26112
    ds_read_b64_tr_b16 v[224:225], v15 offset:0
    ds_read_b64_tr_b16 v[226:227], v15 offset:8704
    ds_read_b64_tr_b16 v[228:229], v15 offset:17408
    ds_read_b64_tr_b16 v[230:231], v15 offset:26112
    s_waitcnt vmcnt(16)
    ds_write_b128 v153, v[88:91] offset:34816
    ds_write_b128 v153, v[92:95] offset:39168
    ds_write_b128 v153, v[96:99] offset:43520
    ds_write_b128 v153, v[100:103] offset:47872
    ds_write_b128 v153, v[104:107] offset:52224
    ds_write_b128 v153, v[108:111] offset:56576
    ds_write_b128 v153, v[112:115] offset:60928
    ds_write_b128 v153, v[116:119] offset:65280
    s_waitcnt lgkmcnt(0)
    v_mfma_f32_16x16x32_bf16 v[156:159], a[48:51], v[172:175], v[156:159]
    v_mfma_f32_16x16x32_bf16 v[160:163], a[128:131], v[172:175], v[160:163]
    v_mfma_f32_16x16x32_bf16 v[164:167], a[208:211], v[172:175], v[164:167]
    v_mfma_f32_16x16x32_bf16 v[168:171], v[224:227], v[172:175], v[168:171]
    v_mfma_f32_16x16x32_bf16 v[156:159], a[52:55], v[172:175], v[156:159]
    v_mfma_f32_16x16x32_bf16 v[160:163], a[132:135], v[172:175], v[160:163]
    v_mfma_f32_16x16x32_bf16 v[164:167], a[212:215], v[172:175], v[164:167]
    v_mfma_f32_16x16x32_bf16 v[168:171], v[228:231], v[172:175], v[168:171]
    s_barrier
    ds_read_b64_tr_b16 a[56:57], v12 offset:34816
    ds_read_b64_tr_b16 a[58:59], v12 offset:43520
    ds_read_b64_tr_b16 a[60:61], v12 offset:52224
    ds_read_b64_tr_b16 a[62:63], v12 offset:60928
    ds_read_b64_tr_b16 a[136:137], v13 offset:34816
    ds_read_b64_tr_b16 a[138:139], v13 offset:43520
    ds_read_b64_tr_b16 a[140:141], v13 offset:52224
    ds_read_b64_tr_b16 a[142:143], v13 offset:60928
    ds_read_b64_tr_b16 a[216:217], v14 offset:34816
    ds_read_b64_tr_b16 a[218:219], v14 offset:43520
    ds_read_b64_tr_b16 a[220:221], v14 offset:52224
    ds_read_b64_tr_b16 a[222:223], v14 offset:60928
    ds_read_b64_tr_b16 v[232:233], v15 offset:34816
    ds_read_b64_tr_b16 v[234:235], v15 offset:43520
    ds_read_b64_tr_b16 v[236:237], v15 offset:52224
    ds_read_b64_tr_b16 v[238:239], v15 offset:60928
    s_waitcnt vmcnt(8)
    ds_write_b128 v153, v[120:123] offset:0
    ds_write_b128 v153, v[124:127] offset:4352
    ds_write_b128 v153, v[128:131] offset:8704
    ds_write_b128 v153, v[132:135] offset:13056
    ds_write_b128 v153, v[136:139] offset:17408
    ds_write_b128 v153, v[140:143] offset:21760
    ds_write_b128 v153, v[144:147] offset:26112
    ds_write_b128 v153, v[148:151] offset:30464
    s_waitcnt lgkmcnt(0)
    v_mfma_f32_16x16x32_bf16 v[156:159], a[56:59], v[172:175], v[156:159]
    v_mfma_f32_16x16x32_bf16 v[160:163], a[136:139], v[172:175], v[160:163]
    v_mfma_f32_16x16x32_bf16 v[164:167], a[216:219], v[172:175], v[164:167]
    v_mfma_f32_16x16x32_bf16 v[168:171], v[232:235], v[172:175], v[168:171]
    v_mfma_f32_16x16x32_bf16 v[156:159], a[60:63], v[172:175], v[156:159]
    v_mfma_f32_16x16x32_bf16 v[160:163], a[140:143], v[172:175], v[160:163]
    v_mfma_f32_16x16x32_bf16 v[164:167], a[220:223], v[172:175], v[164:167]
    v_mfma_f32_16x16x32_bf16 v[168:171], v[236:239], v[172:175], v[168:171]
    s_barrier
    ds_read_b64_tr_b16 a[64:65], v12 offset:0
    ds_read_b64_tr_b16 a[66:67], v12 offset:8704
    ds_read_b64_tr_b16 a[68:69], v12 offset:17408
    ds_read_b64_tr_b16 a[70:71], v12 offset:26112
    ds_read_b64_tr_b16 a[144:145], v13 offset:0
    ds_read_b64_tr_b16 a[146:147], v13 offset:8704
    ds_read_b64_tr_b16 a[148:149], v13 offset:17408
    ds_read_b64_tr_b16 a[150:151], v13 offset:26112
    ds_read_b64_tr_b16 a[224:225], v14 offset:0
    ds_read_b64_tr_b16 a[226:227], v14 offset:8704
    ds_read_b64_tr_b16 a[228:229], v14 offset:17408
    ds_read_b64_tr_b16 a[230:231], v14 offset:26112
    ds_read_b64_tr_b16 v[240:241], v15 offset:0
    ds_read_b64_tr_b16 v[242:243], v15 offset:8704
    ds_read_b64_tr_b16 v[244:245], v15 offset:17408
    ds_read_b64_tr_b16 v[246:247], v15 offset:26112
    s_waitcnt vmcnt(0)
    ds_write_b128 v153, v[56:59] offset:34816
    ds_write_b128 v153, v[60:63] offset:39168
    ds_write_b128 v153, v[64:67] offset:43520
    ds_write_b128 v153, v[68:71] offset:47872
    ds_write_b128 v153, v[72:75] offset:52224
    ds_write_b128 v153, v[76:79] offset:56576
    ds_write_b128 v153, v[80:83] offset:60928
    ds_write_b128 v153, v[84:87] offset:65280
    s_waitcnt lgkmcnt(0)
    v_mfma_f32_16x16x32_bf16 v[156:159], a[64:67], v[172:175], v[156:159]
    v_mfma_f32_16x16x32_bf16 v[160:163], a[144:147], v[172:175], v[160:163]
    v_mfma_f32_16x16x32_bf16 v[164:167], a[224:227], v[172:175], v[164:167]
    v_mfma_f32_16x16x32_bf16 v[168:171], v[240:243], v[172:175], v[168:171]
    v_mfma_f32_16x16x32_bf16 v[156:159], a[68:71], v[172:175], v[156:159]
    v_mfma_f32_16x16x32_bf16 v[160:163], a[148:151], v[172:175], v[160:163]
    v_mfma_f32_16x16x32_bf16 v[164:167], a[228:231], v[172:175], v[164:167]
    v_mfma_f32_16x16x32_bf16 v[168:171], v[244:247], v[172:175], v[168:171]
    s_barrier
    ds_read_b64_tr_b16 a[72:73], v12 offset:34816
    ds_read_b64_tr_b16 a[74:75], v12 offset:43520
    ds_read_b64_tr_b16 a[76:77], v12 offset:52224
    ds_read_b64_tr_b16 a[78:79], v12 offset:60928
    ds_read_b64_tr_b16 a[152:153], v13 offset:34816
    ds_read_b64_tr_b16 a[154:155], v13 offset:43520
    ds_read_b64_tr_b16 a[156:157], v13 offset:52224
    ds_read_b64_tr_b16 a[158:159], v13 offset:60928
    ds_read_b64_tr_b16 a[232:233], v14 offset:34816
    ds_read_b64_tr_b16 a[234:235], v14 offset:43520
    ds_read_b64_tr_b16 a[236:237], v14 offset:52224
    ds_read_b64_tr_b16 a[238:239], v14 offset:60928
    ds_read_b64_tr_b16 v[248:249], v15 offset:34816
    ds_read_b64_tr_b16 v[250:251], v15 offset:43520
    ds_read_b64_tr_b16 v[252:253], v15 offset:52224
    ds_read_b64_tr_b16 v[254:255], v15 offset:60928
    s_cmp_eq_u32 s2, 255
    s_cbranch_scc0 interleave_layers__linear_attn_block__memory_aug_recurrent_mem_tr__prompt_kernel_fb2
    s_cmp_eq_u32 s92, 0
    s_cbranch_scc0 interleave_layers__linear_attn_block__memory_aug_recurrent_mem_tr__prompt_kernel_fb2
    s_waitcnt vmcnt(0)
    s_lshl_b32 s24, s3, 9
    s_add_u32 s24, s24, 118423552
    v_mov_b32 v154, 0
    s_lshl_b32 s27, s3, 3
    s_add_u32 s27, s27, 131072
    s_barrier
    s_mov_b32 s25, -1
    s_mov_b64 exec, 1
    v_mov_b32 v155, 0
    s_memtime s[28:29]
    s_waitcnt lgkmcnt(0)
    buffer_atomic_add v155, v154, s[8:11], s24 offen offset:0 sc0
    s_waitcnt vmcnt(0)
    s_memtime s[30:31]
    s_waitcnt lgkmcnt(0)
    s_sub_u32 s30, s30, s28
    s_min_u32 s25, s25, s30
    v_mov_b32 v155, 0
    s_memtime s[28:29]
    s_waitcnt lgkmcnt(0)
    buffer_atomic_add v155, v154, s[8:11], s24 offen offset:128 sc0
    s_waitcnt vmcnt(0)
    s_memtime s[30:31]
    s_waitcnt lgkmcnt(0)
    s_sub_u32 s30, s30, s28
    s_min_u32 s25, s25, s30
    v_mov_b32 v155, 0
    s_memtime s[28:29]
    s_waitcnt lgkmcnt(0)
    buffer_atomic_add v155, v154, s[8:11], s24 offen offset:256 sc0
    s_waitcnt vmcnt(0)
    s_memtime s[30:31]
    s_waitcnt lgkmcnt(0)
    s_sub_u32 s30, s30, s28
    s_min_u32 s25, s25, s30
    v_mov_b32 v148, s27
    v_mov_b32 v155, s25
    ds_write_b32 v148, v155 offset:0
    s_mov_b64 exec, -1
    s_add_u32 s24, s24, 0x2000
    s_barrier
    s_mov_b32 s25, -1
    s_mov_b64 exec, 1
    v_mov_b32 v155, 0
    s_memtime s[28:29]
    s_waitcnt lgkmcnt(0)
    buffer_atomic_add v155, v154, s[8:11], s24 offen offset:0 sc0
    s_waitcnt vmcnt(0)
    s_memtime s[30:31]
    s_waitcnt lgkmcnt(0)
    s_sub_u32 s30, s30, s28
    s_min_u32 s25, s25, s30
    v_mov_b32 v155, 0
    s_memtime s[28:29]
    s_waitcnt lgkmcnt(0)
    buffer_atomic_add v155, v154, s[8:11], s24 offen offset:128 sc0
    s_waitcnt vmcnt(0)
    s_memtime s[30:31]
    s_waitcnt lgkmcnt(0)
    s_sub_u32 s30, s30, s28
    s_min_u32 s25, s25, s30
    v_mov_b32 v155, 0
    s_memtime s[28:29]
    s_waitcnt lgkmcnt(0)
    buffer_atomic_add v155, v154, s[8:11], s24 offen offset:256 sc0
    s_waitcnt vmcnt(0)
    s_memtime s[30:31]
    s_waitcnt lgkmcnt(0)
    s_sub_u32 s30, s30, s28
    s_min_u32 s25, s25, s30
    v_mov_b32 v148, s27
    v_mov_b32 v155, s25
    ds_write_b32 v148, v155 offset:4
    s_mov_b64 exec, -1
    s_add_u32 s24, s24, 0x2000
    s_waitcnt lgkmcnt(0)
    s_barrier
    v_mov_b32 v154, 131072
    ds_read_b128 v[148:151], v154
    ds_read_b128 v[152:155], v154 offset:16
    s_waitcnt lgkmcnt(0)
    v_min_u32 v148, v148, v152
    v_min_u32 v149, v149, v153
    v_min_u32 v150, v150, v154
    v_min_u32 v151, v151, v155
    v_min_u32 v148, v148, v150
    v_min_u32 v149, v149, v151
    v_cmp_lt_u32 vcc, v149, v148
    s_nop 1
    v_cndmask_b32 v155, 1, 2, vcc
    s_cmp_eq_u32 s3, 0
    s_cbranch_scc0 interleave_layers__linear_attn_block__memory_aug_recurrent_mem_tr__prompt_kernel_fb2
    v_mov_b32 v154, 2146435072
    v_cmp_eq_u32 vcc, 0, v1
    s_nop 1
    v_cndmask_b32 v154, v154, 0, vcc
    buffer_store_dword v155, v154, s[72:75], 0 offen sc1
interleave_layers__linear_attn_block__memory_aug_recurrent_mem_tr__prompt_kernel_fb2:
    v_lshlrev_b32 v7, 4, v1
    s_lshr_b32 s24, s3, 1
    s_mul_i32 s24, s24, 20
    s_and_b32 s25, s3, 1
    s_mul_i32 s25, s25, 10
    s_add_u32 s24, s24, s25
    s_lshl_b32 s24, s24, 10
    v_add_u32 v6, s24, v7
    s_lshr_b32 s24, s3, 1
    s_lshl_b32 s24, s24, 8
    s_and_b32 s25, s3, 1
    s_lshl_b32 s25, s25, 3
    s_add_u32 s24, s24, s25
    s_add_u32 s24, s24, 51712
    v_lshlrev_b32 v9, 4, v2
    v_add_u32 v8, s24, v9
    v_add_u32 v9, 51712, v9
    v_mul_u32_u24 v10, 336, v2
    v_lshl_add_u32 v10, v3, 3, v10
    v_add_u32 v10, 40960, v10
    v_lshrrev_b32 v11, 2, v2
    v_lshl_add_u32 v11, v3, 3, v11
    v_mul_u32_u24 v11, 336, v11
    v_and_b32 v15, 3, v2
    v_lshl_add_u32 v11, v15, 3, v11
    s_lshl_b32 s24, s3, 5
    s_add_u32 s24, s24, 40960
    v_add_u32 v11, s24, v11
    s_lshl_b32 s24, s3, 10
    v_add_u32 v12, s24, v7
    v_lshlrev_b32 v15, 3, v1
    v_add_u32 v15, 2048, v15
    s_cmp_eq_u32 s3, 2
    s_cselect_b64 vcc, -1, 0
    v_cndmask_b32 v12, v12, v15, vcc
    s_mul_i32 s24, s44, 2560
    s_add_u32 s24, s24, 12582912
    v_add_u32 v12, s24, v12
    s_mov_b32 s52, 0x3fb8aa3b
    s_mov_b32 s53, s52
    s_mov_b32 s54, 0x358637bd
    s_mov_b32 s55, s54
    v_mov_b32 v120, 0
    v_mov_b32 v121, 0
    v_mov_b32 v122, 0
    v_mov_b32 v123, 0
    v_mov_b32 v124, 0
    v_mov_b32 v125, 0
    v_mov_b32 v126, 0
    v_mov_b32 v127, 0
    v_mov_b32 v128, 0
    v_mov_b32 v129, 0
    v_mov_b32 v130, 0
    v_mov_b32 v131, 0
    v_mov_b32 v132, 0
    v_mov_b32 v133, 0
    v_mov_b32 v134, 0
    v_mov_b32 v135, 0
    v_mov_b32 v136, 0
    v_mov_b32 v137, 0
    v_mov_b32 v138, 0
    v_mov_b32 v139, 0
    v_mov_b32 v140, 0
    v_mov_b32 v141, 0
    v_mov_b32 v142, 0
    v_mov_b32 v143, 0
    s_waitcnt lgkmcnt(0)
    v_mfma_f32_16x16x32_bf16 v[156:159], a[72:75], v[172:175], v[156:159]
    v_mfma_f32_16x16x32_bf16 v[160:163], a[152:155], v[172:175], v[160:163]
    v_mfma_f32_16x16x32_bf16 v[164:167], a[232:235], v[172:175], v[164:167]
    v_mfma_f32_16x16x32_bf16 v[168:171], v[248:251], v[172:175], v[168:171]
    v_mfma_f32_16x16x32_bf16 v[156:159], a[76:79], v[172:175], v[156:159]
    v_mfma_f32_16x16x32_bf16 v[160:163], a[156:159], v[172:175], v[160:163]
    v_mfma_f32_16x16x32_bf16 v[164:167], a[236:239], v[172:175], v[164:167]
    v_mfma_f32_16x16x32_bf16 v[168:171], v[252:255], v[172:175], v[168:171]
    s_mov_b32 s56, 1
interleave_layers__linear_attn_block__memory_aug_recurrent_mem_tr__prompt_kernel_k1_seg:
    s_cmp_eq_u32 s51, 1
    s_cbranch_scc1 interleave_layers__linear_attn_block__memory_aug_recurrent_mem_tr__prompt_kernel_k13
    s_and_b32 s24, s48, 3
    s_lshl_b32 s24, s24, 7
    s_add_u32 s24, s24, 23107584
    v_lshlrev_b32 v15, 2, v1
    v_add_u32 v15, s24, v15
    s_lshr_b32 s95, s48, 2
    s_add_u32 s95, s95, 1
    s_mov_b32 s61, 0
interleave_layers__linear_attn_block__memory_aug_recurrent_mem_tr__prompt_kernel_k1_wx:
    buffer_load_dword v14, v15, s[8:11], 0 offen sc1
    s_waitcnt vmcnt(0)
    v_cmp_le_i32 vcc, s95, v14
    s_mov_b32 s25, 0xfffff
    s_and_b32 s24, vcc_lo, s25
    s_cmp_eq_u32 s24, s25
    s_cbranch_scc1 interleave_layers__linear_attn_block__memory_aug_recurrent_mem_tr__prompt_kernel_k1_wx_ok
    s_add_u32 s61, s61, 1
    s_cmp_ge_u32 s61, s60
    s_cbranch_scc1 interleave_layers__linear_attn_block__memory_aug_recurrent_mem_tr__prompt_kernel_k1_wx_to
    s_sleep 4
    s_branch interleave_layers__linear_attn_block__memory_aug_recurrent_mem_tr__prompt_kernel_k1_wx
interleave_layers__linear_attn_block__memory_aug_recurrent_mem_tr__prompt_kernel_k1_wx_to:
    s_mov_b32 s60, 1
interleave_layers__linear_attn_block__memory_aug_recurrent_mem_tr__prompt_kernel_k1_wx_ok:
    s_mov_b32 s41, s43
    s_mov_b32 s24, s41
    buffer_load_dwordx4 v[16:19], v4, s[16:19], s24 offen sc1
    s_add_u32 s24, s24, s46
    buffer_load_dwordx4 v[20:23], v4, s[16:19], s24 offen sc1
    s_add_u32 s24, s24, s46
    buffer_load_dwordx4 v[24:27], v4, s[16:19], s24 offen sc1
    s_add_u32 s24, s24, s46
    buffer_load_dwordx4 v[28:31], v4, s[16:19], s24 offen sc1
    s_add_u32 s24, s24, s46
    buffer_load_dwordx4 v[32:35], v4, s[16:19], s24 offen sc1
    s_add_u32 s24, s24, s46
    buffer_load_dwordx4 v[36:39], v4, s[16:19], s24 offen sc1
    s_add_u32 s24, s24, s46
    buffer_load_dwordx4 v[40:43], v4, s[16:19], s24 offen sc1
    s_add_u32 s24, s24, s46
    buffer_load_dwordx4 v[44:47], v4, s[16:19], s24 offen sc1
    s_add_u32 s24, s24, s46
    buffer_load_dwordx4 v[48:51], v4, s[16:19], s24 offen sc1
    s_add_u32 s24, s24, s46
    buffer_load_dwordx4 v[52:55], v4, s[16:19], s24 offen sc1
    s_mul_i32 s24, s49, 1
    s_add_u32 s24, s24, s48
    s_and_b32 s24, s24, 3
    s_lshl_b32 s24, s24, 7
    s_add_u32 s24, s24, 23107584
    v_lshlrev_b32 v15, 2, v1
    v_add_u32 v15, s24, v15
    buffer_load_dword v13, v15, s[8:11], 0 offen sc1
interleave_layers__linear_attn_block__memory_aug_recurrent_mem_tr__prompt_kernel_k13:
    s_cmp_eq_u32 s92, 0
    s_cselect_b32 s24, s56, 0
    s_cmp_eq_u32 s24, 1
    s_cbranch_scc1 interleave_layers__linear_attn_block__memory_aug_recurrent_mem_tr__prompt_kernel_k1w4
    s_waitcnt vmcnt(0)
interleave_layers__linear_attn_block__memory_aug_recurrent_mem_tr__prompt_kernel_k1w4:
    s_mov_b32 s56, 0
    v_mov_b32 v148, 0
    v_mov_b32 v149, 0
    v_mov_b32 v150, 0
    v_mov_b32 v151, 0
    v_dot2c_f32_bf16 v148, v16, v172
    v_dot2c_f32_bf16 v149, v16, v16
    v_dot2c_f32_bf16 v150, v17, v172
    v_dot2c_f32_bf16 v151, v17, v17
    v_dot2c_f32_bf16 v148, v18, v172
    v_dot2c_f32_bf16 v149, v18, v18
    v_dot2c_f32_bf16 v150, v19, v172
    v_dot2c_f32_bf16 v151, v19, v19
    v_dot2c_f32_bf16 v148, v20, v172
    v_dot2c_f32_bf16 v149, v20, v20
    v_dot2c_f32_bf16 v150, v21, v172
    v_dot2c_f32_bf16 v151, v21, v21
    v_dot2c_f32_bf16 v148, v22, v172
    v_dot2c_f32_bf16 v149, v22, v22
    v_dot2c_f32_bf16 v150, v23, v172
    v_dot2c_f32_bf16 v151, v23, v23
    v_dot2c_f32_bf16 v148, v24, v172
    v_dot2c_f32_bf16 v149, v24, v24
    v_dot2c_f32_bf16 v150, v25, v172
    v_dot2c_f32_bf16 v151, v25, v25
    v_dot2c_f32_bf16 v148, v26, v172
    v_dot2c_f32_bf16 v149, v26, v26
    v_dot2c_f32_bf16 v150, v27, v172
    v_dot2c_f32_bf16 v151, v27, v27
    v_dot2c_f32_bf16 v148, v28, v172
    v_dot2c_f32_bf16 v149, v28, v28
    v_dot2c_f32_bf16 v150, v29, v172
    v_dot2c_f32_bf16 v151, v29, v29
    v_dot2c_f32_bf16 v148, v30, v172
    v_dot2c_f32_bf16 v149, v30, v30
    v_dot2c_f32_bf16 v150, v31, v172
    v_dot2c_f32_bf16 v151, v31, v31
    v_dot2c_f32_bf16 v148, v32, v172
    v_dot2c_f32_bf16 v149, v32, v32
    v_dot2c_f32_bf16 v150, v33, v172
    v_dot2c_f32_bf16 v151, v33, v33
    v_dot2c_f32_bf16 v148, v34, v172
    v_dot2c_f32_bf16 v149, v34, v34
    v_dot2c_f32_bf16 v150, v35, v172
    v_dot2c_f32_bf16 v151, v35, v35
    v_dot2c_f32_bf16 v148, v36, v172
    v_dot2c_f32_bf16 v149, v36, v36
    v_dot2c_f32_bf16 v150, v37, v172
    v_dot2c_f32_bf16 v151, v37, v37
    v_dot2c_f32_bf16 v148, v38, v172
    v_dot2c_f32_bf16 v149, v38, v38
    v_dot2c_f32_bf16 v150, v39, v172
    v_dot2c_f32_bf16 v151, v39, v39
    v_dot2c_f32_bf16 v148, v40, v172
    v_dot2c_f32_bf16 v149, v40, v40
    v_dot2c_f32_bf16 v150, v41, v172
    v_dot2c_f32_bf16 v151, v41, v41
    v_dot2c_f32_bf16 v148, v42, v172
    v_dot2c_f32_bf16 v149, v42, v42
    v_dot2c_f32_bf16 v150, v43, v172
    v_dot2c_f32_bf16 v151, v43, v43
    v_dot2c_f32_bf16 v148, v44, v172
    v_dot2c_f32_bf16 v149, v44, v44
    v_dot2c_f32_bf16 v150, v45, v172
    v_dot2c_f32_bf16 v151, v45, v45
    v_dot2c_f32_bf16 v148, v46, v172
    v_dot2c_f32_bf16 v149, v46, v46
    v_dot2c_f32_bf16 v150, v47, v172
    v_dot2c_f32_bf16 v151, v47, v47
    v_dot2c_f32_bf16 v148, v48, v172
    v_dot2c_f32_bf16 v149, v48, v48
    v_dot2c_f32_bf16 v150, v49, v172
    v_dot2c_f32_bf16 v151, v49, v49
    v_dot2c_f32_bf16 v148, v50, v172
    v_dot2c_f32_bf16 v149, v50, v50
    v_dot2c_f32_bf16 v150, v51, v172
    v_dot2c_f32_bf16 v151, v51, v51
    v_dot2c_f32_bf16 v148, v52, v172
    v_dot2c_f32_bf16 v149, v52, v52
    v_dot2c_f32_bf16 v150, v53, v172
    v_dot2c_f32_bf16 v151, v53, v53
    v_dot2c_f32_bf16 v148, v54, v172
    v_dot2c_f32_bf16 v149, v54, v54
    v_dot2c_f32_bf16 v150, v55, v172
    v_dot2c_f32_bf16 v151, v55, v55
    s_nop 1
    v_add_f32 v148, v148, v150
    v_add_f32 v149, v149, v151
    v_mov_b32 v150, v148
    v_mov_b32 v151, v149
    s_nop 0
    v_permlane16_swap_b32 v148, v150
    v_permlane16_swap_b32 v149, v151
    v_add_f32 v148, v148, v150
    v_add_f32 v149, v149, v151
    v_mov_b32 v150, v148
    v_mov_b32 v151, v149
    s_nop 0
    v_permlane32_swap_b32 v148, v150
    v_permlane32_swap_b32 v149, v151
    v_add_f32 v148, v148, v150
    v_add_f32 v149, v149, v151
    ds_write_b128 v6, v[16:19] offset:0
    ds_write_b128 v6, v[20:23] offset:1024
    ds_write_b128 v6, v[24:27] offset:2048
    ds_write_b128 v6, v[28:31] offset:3072
    ds_write_b128 v6, v[32:35] offset:4096
    ds_write_b128 v6, v[36:39] offset:5120
    ds_write_b128 v6, v[40:43] offset:6144
    ds_write_b128 v6, v[44:47] offset:7168
    ds_write_b128 v6, v[48:51] offset:8192
    ds_write_b128 v6, v[52:55] offset:9216
    ds_write_b64 v8, v[148:149]
    s_mov_b32 s51, 0
    s_waitcnt lgkmcnt(0)
    s_cmp_gt_u32 s40, 1
    s_cbranch_scc0 interleave_layers__linear_attn_block__memory_aug_recurrent_mem_tr__prompt_kernel_k15
    s_cmp_eq_u32 s92, 0
    s_cbranch_scc1 interleave_layers__linear_attn_block__memory_aug_recurrent_mem_tr__prompt_kernel_k16
    s_add_u32 s24, s48, s49
    s_lshr_b32 s24, s24, 2
    s_add_u32 s24, s24, 1
    v_cmp_le_i32 vcc, s24, v13
    s_and_b32 s24, vcc_lo, 0xfffff
    s_cmp_eq_u32 s24, 0xfffff
    s_cbranch_scc0 interleave_layers__linear_attn_block__memory_aug_recurrent_mem_tr__prompt_kernel_k15
    s_add_u32 s41, s43, s42
    s_mov_b32 s24, s41
    buffer_load_dwordx4 v[16:19], v4, s[16:19], s24 offen sc1
    s_add_u32 s24, s24, s46
    buffer_load_dwordx4 v[20:23], v4, s[16:19], s24 offen sc1
    s_add_u32 s24, s24, s46
    buffer_load_dwordx4 v[24:27], v4, s[16:19], s24 offen sc1
    s_add_u32 s24, s24, s46
    buffer_load_dwordx4 v[28:31], v4, s[16:19], s24 offen sc1
    s_add_u32 s24, s24, s46
    buffer_load_dwordx4 v[32:35], v4, s[16:19], s24 offen sc1
    s_add_u32 s24, s24, s46
    buffer_load_dwordx4 v[36:39], v4, s[16:19], s24 offen sc1
    s_add_u32 s24, s24, s46
    buffer_load_dwordx4 v[40:43], v4, s[16:19], s24 offen sc1
    s_add_u32 s24, s24, s46
    buffer_load_dwordx4 v[44:47], v4, s[16:19], s24 offen sc1
    s_add_u32 s24, s24, s46
    buffer_load_dwordx4 v[48:51], v4, s[16:19], s24 offen sc1
    s_add_u32 s24, s24, s46
    buffer_load_dwordx4 v[52:55], v4, s[16:19], s24 offen sc1
    s_mov_b32 s51, 1
    s_mul_i32 s24, s49, 2
    s_add_u32 s24, s24, s48
    s_and_b32 s24, s24, 3
    s_lshl_b32 s24, s24, 7
    s_add_u32 s24, s24, 23107584
    v_lshlrev_b32 v15, 2, v1
    v_add_u32 v15, s24, v15
    buffer_load_dword v13, v15, s[8:11], 0 offen sc1
    s_branch interleave_layers__linear_attn_block__memory_aug_recurrent_mem_tr__prompt_kernel_k15
interleave_layers__linear_attn_block__memory_aug_recurrent_mem_tr__prompt_kernel_k16:
    s_add_u32 s41, s43, s42
    s_mov_b32 s24, s41
    buffer_load_dwordx2 v[16:17], v4, s[16:19], s24 offen
    buffer_load_dwordx2 v[18:19], v5, s[16:19], s24 offen
    s_add_u32 s24, s24, s46
    buffer_load_dwordx2 v[20:21], v4, s[16:19], s24 offen
    buffer_load_dwordx2 v[22:23], v5, s[16:19], s24 offen
    s_add_u32 s24, s24, s46
    buffer_load_dwordx2 v[24:25], v4, s[16:19], s24 offen
    buffer_load_dwordx2 v[26:27], v5, s[16:19], s24 offen
    s_add_u32 s24, s24, s46
    buffer_load_dwordx2 v[28:29], v4, s[16:19], s24 offen
    buffer_load_dwordx2 v[30:31], v5, s[16:19], s24 offen
    s_add_u32 s24, s24, s46
    buffer_load_dwordx2 v[32:33], v4, s[16:19], s24 offen
    buffer_load_dwordx2 v[34:35], v5, s[16:19], s24 offen
    s_add_u32 s24, s24, s46
    buffer_load_dwordx2 v[36:37], v4, s[16:19], s24 offen
    buffer_load_dwordx2 v[38:39], v5, s[16:19], s24 offen
    s_add_u32 s24, s24, s46
    buffer_load_dwordx2 v[40:41], v4, s[16:19], s24 offen
    buffer_load_dwordx2 v[42:43], v5, s[16:19], s24 offen
    s_add_u32 s24, s24, s46
    buffer_load_dwordx2 v[44:45], v4, s[16:19], s24 offen
    buffer_load_dwordx2 v[46:47], v5, s[16:19], s24 offen
    s_add_u32 s24, s24, s46
    buffer_load_dwordx2 v[48:49], v4, s[16:19], s24 offen
    buffer_load_dwordx2 v[50:51], v5, s[16:19], s24 offen
    s_add_u32 s24, s24, s46
    buffer_load_dwordx2 v[52:53], v4, s[16:19], s24 offen
    buffer_load_dwordx2 v[54:55], v5, s[16:19], s24 offen
    s_mov_b32 s51, 1
interleave_layers__linear_attn_block__memory_aug_recurrent_mem_tr__prompt_kernel_k15:
    s_barrier
    ds_read_b128 v[148:151], v9
    ds_read_b128 v[152:155], v9 offset:256
    ds_read_b128 v[56:59], v7 offset:0
    ds_read_b128 v[60:63], v7 offset:20480
    ds_read_b128 v[64:67], v7 offset:1024
    ds_read_b128 v[68:71], v7 offset:21504
    ds_read_b128 v[72:75], v7 offset:2048
    ds_read_b128 v[76:79], v7 offset:22528
    s_waitcnt lgkmcnt(6)
    v_add_f32 v148, v148, v150
    v_add_f32 v149, v149, v151
    v_mul_f32 v148, 0x3acccccd, v148
    v_mul_f32 v150, v148, v148
    v_mov_b32 v151, 0x3acccccd
    v_fma_f32 v149, v149, v151, -v150
    v_max_f32 v149, 0, v149
    v_add_f32 v149, 0x3727c5ac, v149
    v_rsq_f32 v144, v149
    s_nop 0
    v_mul_f32 v145, v148, v144
    v_sub_f32 v145, 0, v145
    v_add_f32 v152, v152, v154
    v_add_f32 v153, v153, v155
    v_mul_f32 v152, 0x3acccccd, v152
    v_mul_f32 v154, v152, v152
    v_mov_b32 v155, 0x3acccccd
    v_fma_f32 v153, v153, v155, -v154
    v_max_f32 v153, 0, v153
    v_add_f32 v153, 0x3727c5ac, v153
    v_rsq_f32 v146, v153
    s_nop 0
    v_mul_f32 v147, v152, v146
    v_sub_f32 v147, 0, v147
    ds_read_b128 v[80:83], v7 offset:3072
    ds_read_b128 v[84:87], v7 offset:23552
    s_waitcnt lgkmcnt(6)
    v_mfma_f32_16x16x32_bf16 v[88:91], a[0:3], v[56:59], 0
    v_mfma_f32_16x16x32_bf16 v[96:99], a[80:83], v[56:59], 0
    v_mfma_f32_16x16x32_bf16 v[104:107], a[160:163], v[56:59], 0
    v_mfma_f32_16x16x32_bf16 v[112:115], v[176:179], v[56:59], 0
    v_mfma_f32_16x16x32_bf16 v[92:95], a[0:3], v[60:63], 0
    v_mfma_f32_16x16x32_bf16 v[100:103], a[80:83], v[60:63], 0
    v_mfma_f32_16x16x32_bf16 v[108:111], a[160:163], v[60:63], 0
    v_mfma_f32_16x16x32_bf16 v[116:119], v[176:179], v[60:63], 0
    ds_read_b128 v[56:59], v7 offset:4096
    ds_read_b128 v[60:63], v7 offset:24576
    s_waitcnt lgkmcnt(6)
    v_mfma_f32_16x16x32_bf16 v[88:91], a[4:7], v[64:67], v[88:91]
    v_mfma_f32_16x16x32_bf16 v[96:99], a[84:87], v[64:67], v[96:99]
    v_mfma_f32_16x16x32_bf16 v[104:107], a[164:167], v[64:67], v[104:107]
    v_mfma_f32_16x16x32_bf16 v[112:115], v[180:183], v[64:67], v[112:115]
    v_mfma_f32_16x16x32_bf16 v[92:95], a[4:7], v[68:71], v[92:95]
    v_mfma_f32_16x16x32_bf16 v[100:103], a[84:87], v[68:71], v[100:103]
    v_mfma_f32_16x16x32_bf16 v[108:111], a[164:167], v[68:71], v[108:111]
    v_mfma_f32_16x16x32_bf16 v[116:119], v[180:183], v[68:71], v[116:119]
    ds_read_b128 v[64:67], v7 offset:5120
    ds_read_b128 v[68:71], v7 offset:25600
    s_waitcnt lgkmcnt(6)
    v_mfma_f32_16x16x32_bf16 v[88:91], a[8:11], v[72:75], v[88:91]
    v_mfma_f32_16x16x32_bf16 v[96:99], a[88:91], v[72:75], v[96:99]
    v_mfma_f32_16x16x32_bf16 v[104:107], a[168:171], v[72:75], v[104:107]
    v_mfma_f32_16x16x32_bf16 v[112:115], v[184:187], v[72:75], v[112:115]
    v_mfma_f32_16x16x32_bf16 v[92:95], a[8:11], v[76:79], v[92:95]
    v_mfma_f32_16x16x32_bf16 v[100:103], a[88:91], v[76:79], v[100:103]
    v_mfma_f32_16x16x32_bf16 v[108:111], a[168:171], v[76:79], v[108:111]
    v_mfma_f32_16x16x32_bf16 v[116:119], v[184:187], v[76:79], v[116:119]
    ds_read_b128 v[72:75], v7 offset:6144
    ds_read_b128 v[76:79], v7 offset:26624
    s_waitcnt lgkmcnt(6)
    v_mfma_f32_16x16x32_bf16 v[88:91], a[12:15], v[80:83], v[88:91]
    v_mfma_f32_16x16x32_bf16 v[96:99], a[92:95], v[80:83], v[96:99]
    v_mfma_f32_16x16x32_bf16 v[104:107], a[172:175], v[80:83], v[104:107]
    v_mfma_f32_16x16x32_bf16 v[112:115], v[188:191], v[80:83], v[112:115]
    v_mfma_f32_16x16x32_bf16 v[92:95], a[12:15], v[84:87], v[92:95]
    v_mfma_f32_16x16x32_bf16 v[100:103], a[92:95], v[84:87], v[100:103]
    v_mfma_f32_16x16x32_bf16 v[108:111], a[172:175], v[84:87], v[108:111]
    v_mfma_f32_16x16x32_bf16 v[116:119], v[188:191], v[84:87], v[116:119]
    ds_read_b128 v[80:83], v7 offset:7168
    ds_read_b128 v[84:87], v7 offset:27648
    s_waitcnt lgkmcnt(6)
    v_mfma_f32_16x16x32_bf16 v[88:91], a[16:19], v[56:59], v[88:91]
    v_mfma_f32_16x16x32_bf16 v[96:99], a[96:99], v[56:59], v[96:99]
    v_mfma_f32_16x16x32_bf16 v[104:107], a[176:179], v[56:59], v[104:107]
    v_mfma_f32_16x16x32_bf16 v[112:115], v[192:195], v[56:59], v[112:115]
    v_mfma_f32_16x16x32_bf16 v[92:95], a[16:19], v[60:63], v[92:95]
    v_mfma_f32_16x16x32_bf16 v[100:103], a[96:99], v[60:63], v[100:103]
    v_mfma_f32_16x16x32_bf16 v[108:111], a[176:179], v[60:63], v[108:111]
    v_mfma_f32_16x16x32_bf16 v[116:119], v[192:195], v[60:63], v[116:119]
    ds_read_b128 v[56:59], v7 offset:8192
    ds_read_b128 v[60:63], v7 offset:28672
    s_waitcnt lgkmcnt(6)
    v_mfma_f32_16x16x32_bf16 v[88:91], a[20:23], v[64:67], v[88:91]
    v_mfma_f32_16x16x32_bf16 v[96:99], a[100:103], v[64:67], v[96:99]
    v_mfma_f32_16x16x32_bf16 v[104:107], a[180:183], v[64:67], v[104:107]
    v_mfma_f32_16x16x32_bf16 v[112:115], v[196:199], v[64:67], v[112:115]
    v_mfma_f32_16x16x32_bf16 v[92:95], a[20:23], v[68:71], v[92:95]
    v_mfma_f32_16x16x32_bf16 v[100:103], a[100:103], v[68:71], v[100:103]
    v_mfma_f32_16x16x32_bf16 v[108:111], a[180:183], v[68:71], v[108:111]
    v_mfma_f32_16x16x32_bf16 v[116:119], v[196:199], v[68:71], v[116:119]
    ds_read_b128 v[64:67], v7 offset:9216
    ds_read_b128 v[68:71], v7 offset:29696
    s_waitcnt lgkmcnt(6)
    v_mfma_f32_16x16x32_bf16 v[88:91], a[24:27], v[72:75], v[88:91]
    v_mfma_f32_16x16x32_bf16 v[96:99], a[104:107], v[72:75], v[96:99]
    v_mfma_f32_16x16x32_bf16 v[104:107], a[184:187], v[72:75], v[104:107]
    v_mfma_f32_16x16x32_bf16 v[112:115], v[200:203], v[72:75], v[112:115]
    v_mfma_f32_16x16x32_bf16 v[92:95], a[24:27], v[76:79], v[92:95]
    v_mfma_f32_16x16x32_bf16 v[100:103], a[104:107], v[76:79], v[100:103]
    v_mfma_f32_16x16x32_bf16 v[108:111], a[184:187], v[76:79], v[108:111]
    v_mfma_f32_16x16x32_bf16 v[116:119], v[200:203], v[76:79], v[116:119]
    ds_read_b128 v[72:75], v7 offset:10240
    ds_read_b128 v[76:79], v7 offset:30720
    s_waitcnt lgkmcnt(6)
    v_mfma_f32_16x16x32_bf16 v[88:91], a[28:31], v[80:83], v[88:91]
    v_mfma_f32_16x16x32_bf16 v[96:99], a[108:111], v[80:83], v[96:99]
    v_mfma_f32_16x16x32_bf16 v[104:107], a[188:191], v[80:83], v[104:107]
    v_mfma_f32_16x16x32_bf16 v[112:115], v[204:207], v[80:83], v[112:115]
    v_mfma_f32_16x16x32_bf16 v[92:95], a[28:31], v[84:87], v[92:95]
    v_mfma_f32_16x16x32_bf16 v[100:103], a[108:111], v[84:87], v[100:103]
    v_mfma_f32_16x16x32_bf16 v[108:111], a[188:191], v[84:87], v[108:111]
    v_mfma_f32_16x16x32_bf16 v[116:119], v[204:207], v[84:87], v[116:119]
    ds_read_b128 v[80:83], v7 offset:11264
    ds_read_b128 v[84:87], v7 offset:31744
    s_waitcnt lgkmcnt(6)
    v_mfma_f32_16x16x32_bf16 v[88:91], a[32:35], v[56:59], v[88:91]
    v_mfma_f32_16x16x32_bf16 v[96:99], a[112:115], v[56:59], v[96:99]
    v_mfma_f32_16x16x32_bf16 v[104:107], a[192:195], v[56:59], v[104:107]
    v_mfma_f32_16x16x32_bf16 v[112:115], v[208:211], v[56:59], v[112:115]
    v_mfma_f32_16x16x32_bf16 v[92:95], a[32:35], v[60:63], v[92:95]
    v_mfma_f32_16x16x32_bf16 v[100:103], a[112:115], v[60:63], v[100:103]
    v_mfma_f32_16x16x32_bf16 v[108:111], a[192:195], v[60:63], v[108:111]
    v_mfma_f32_16x16x32_bf16 v[116:119], v[208:211], v[60:63], v[116:119]
    ds_read_b128 v[56:59], v7 offset:12288
    ds_read_b128 v[60:63], v7 offset:32768
    s_waitcnt lgkmcnt(6)
    v_mfma_f32_16x16x32_bf16 v[88:91], a[36:39], v[64:67], v[88:91]
    v_mfma_f32_16x16x32_bf16 v[96:99], a[116:119], v[64:67], v[96:99]
    v_mfma_f32_16x16x32_bf16 v[104:107], a[196:199], v[64:67], v[104:107]
    v_mfma_f32_16x16x32_bf16 v[112:115], v[212:215], v[64:67], v[112:115]
    v_mfma_f32_16x16x32_bf16 v[92:95], a[36:39], v[68:71], v[92:95]
    v_mfma_f32_16x16x32_bf16 v[100:103], a[116:119], v[68:71], v[100:103]
    v_mfma_f32_16x16x32_bf16 v[108:111], a[196:199], v[68:71], v[108:111]
    v_mfma_f32_16x16x32_bf16 v[116:119], v[212:215], v[68:71], v[116:119]
    ds_read_b128 v[64:67], v7 offset:13312
    ds_read_b128 v[68:71], v7 offset:33792
    s_waitcnt lgkmcnt(6)
    v_mfma_f32_16x16x32_bf16 v[88:91], a[40:43], v[72:75], v[88:91]
    v_mfma_f32_16x16x32_bf16 v[96:99], a[120:123], v[72:75], v[96:99]
    v_mfma_f32_16x16x32_bf16 v[104:107], a[200:203], v[72:75], v[104:107]
    v_mfma_f32_16x16x32_bf16 v[112:115], v[216:219], v[72:75], v[112:115]
    v_mfma_f32_16x16x32_bf16 v[92:95], a[40:43], v[76:79], v[92:95]
    v_mfma_f32_16x16x32_bf16 v[100:103], a[120:123], v[76:79], v[100:103]
    v_mfma_f32_16x16x32_bf16 v[108:111], a[200:203], v[76:79], v[108:111]
    v_mfma_f32_16x16x32_bf16 v[116:119], v[216:219], v[76:79], v[116:119]
    ds_read_b128 v[72:75], v7 offset:14336
    ds_read_b128 v[76:79], v7 offset:34816
    s_waitcnt lgkmcnt(6)
    v_mfma_f32_16x16x32_bf16 v[88:91], a[44:47], v[80:83], v[88:91]
    v_mfma_f32_16x16x32_bf16 v[96:99], a[124:127], v[80:83], v[96:99]
    v_mfma_f32_16x16x32_bf16 v[104:107], a[204:207], v[80:83], v[104:107]
    v_mfma_f32_16x16x32_bf16 v[112:115], v[220:223], v[80:83], v[112:115]
    v_mfma_f32_16x16x32_bf16 v[92:95], a[44:47], v[84:87], v[92:95]
    v_mfma_f32_16x16x32_bf16 v[100:103], a[124:127], v[84:87], v[100:103]
    v_mfma_f32_16x16x32_bf16 v[108:111], a[204:207], v[84:87], v[108:111]
    v_mfma_f32_16x16x32_bf16 v[116:119], v[220:223], v[84:87], v[116:119]
    ds_read_b128 v[80:83], v7 offset:15360
    ds_read_b128 v[84:87], v7 offset:35840
    s_waitcnt lgkmcnt(6)
    v_mfma_f32_16x16x32_bf16 v[88:91], a[48:51], v[56:59], v[88:91]
    v_mfma_f32_16x16x32_bf16 v[96:99], a[128:131], v[56:59], v[96:99]
    v_mfma_f32_16x16x32_bf16 v[104:107], a[208:211], v[56:59], v[104:107]
    v_mfma_f32_16x16x32_bf16 v[112:115], v[224:227], v[56:59], v[112:115]
    v_mfma_f32_16x16x32_bf16 v[92:95], a[48:51], v[60:63], v[92:95]
    v_mfma_f32_16x16x32_bf16 v[100:103], a[128:131], v[60:63], v[100:103]
    v_mfma_f32_16x16x32_bf16 v[108:111], a[208:211], v[60:63], v[108:111]
    v_mfma_f32_16x16x32_bf16 v[116:119], v[224:227], v[60:63], v[116:119]
    ds_read_b128 v[56:59], v7 offset:16384
    ds_read_b128 v[60:63], v7 offset:36864
    s_waitcnt lgkmcnt(6)
    v_mfma_f32_16x16x32_bf16 v[88:91], a[52:55], v[64:67], v[88:91]
    v_mfma_f32_16x16x32_bf16 v[96:99], a[132:135], v[64:67], v[96:99]
    v_mfma_f32_16x16x32_bf16 v[104:107], a[212:215], v[64:67], v[104:107]
    v_mfma_f32_16x16x32_bf16 v[112:115], v[228:231], v[64:67], v[112:115]
    v_mfma_f32_16x16x32_bf16 v[92:95], a[52:55], v[68:71], v[92:95]
    v_mfma_f32_16x16x32_bf16 v[100:103], a[132:135], v[68:71], v[100:103]
    v_mfma_f32_16x16x32_bf16 v[108:111], a[212:215], v[68:71], v[108:111]
    v_mfma_f32_16x16x32_bf16 v[116:119], v[228:231], v[68:71], v[116:119]
    ds_read_b128 v[64:67], v7 offset:17408
    ds_read_b128 v[68:71], v7 offset:37888
    s_waitcnt lgkmcnt(6)
    v_mfma_f32_16x16x32_bf16 v[88:91], a[56:59], v[72:75], v[88:91]
    v_mfma_f32_16x16x32_bf16 v[96:99], a[136:139], v[72:75], v[96:99]
    v_mfma_f32_16x16x32_bf16 v[104:107], a[216:219], v[72:75], v[104:107]
    v_mfma_f32_16x16x32_bf16 v[112:115], v[232:235], v[72:75], v[112:115]
    v_mfma_f32_16x16x32_bf16 v[92:95], a[56:59], v[76:79], v[92:95]
    v_mfma_f32_16x16x32_bf16 v[100:103], a[136:139], v[76:79], v[100:103]
    v_mfma_f32_16x16x32_bf16 v[108:111], a[216:219], v[76:79], v[108:111]
    v_mfma_f32_16x16x32_bf16 v[116:119], v[232:235], v[76:79], v[116:119]
    ds_read_b128 v[72:75], v7 offset:18432
    ds_read_b128 v[76:79], v7 offset:38912
    s_waitcnt lgkmcnt(6)
    v_mfma_f32_16x16x32_bf16 v[88:91], a[60:63], v[80:83], v[88:91]
    v_mfma_f32_16x16x32_bf16 v[96:99], a[140:143], v[80:83], v[96:99]
    v_mfma_f32_16x16x32_bf16 v[104:107], a[220:223], v[80:83], v[104:107]
    v_mfma_f32_16x16x32_bf16 v[112:115], v[236:239], v[80:83], v[112:115]
    v_mfma_f32_16x16x32_bf16 v[92:95], a[60:63], v[84:87], v[92:95]
    v_mfma_f32_16x16x32_bf16 v[100:103], a[140:143], v[84:87], v[100:103]
    v_mfma_f32_16x16x32_bf16 v[108:111], a[220:223], v[84:87], v[108:111]
    v_mfma_f32_16x16x32_bf16 v[116:119], v[236:239], v[84:87], v[116:119]
    ds_read_b128 v[80:83], v7 offset:19456
    ds_read_b128 v[84:87], v7 offset:39936
    s_waitcnt lgkmcnt(6)
    v_mfma_f32_16x16x32_bf16 v[88:91], a[64:67], v[56:59], v[88:91]
    v_mfma_f32_16x16x32_bf16 v[96:99], a[144:147], v[56:59], v[96:99]
    v_mfma_f32_16x16x32_bf16 v[104:107], a[224:227], v[56:59], v[104:107]
    v_mfma_f32_16x16x32_bf16 v[112:115], v[240:243], v[56:59], v[112:115]
    v_mfma_f32_16x16x32_bf16 v[92:95], a[64:67], v[60:63], v[92:95]
    v_mfma_f32_16x16x32_bf16 v[100:103], a[144:147], v[60:63], v[100:103]
    v_mfma_f32_16x16x32_bf16 v[108:111], a[224:227], v[60:63], v[108:111]
    v_mfma_f32_16x16x32_bf16 v[116:119], v[240:243], v[60:63], v[116:119]
    s_waitcnt lgkmcnt(4)
    v_mfma_f32_16x16x32_bf16 v[88:91], a[68:71], v[64:67], v[88:91]
    v_mfma_f32_16x16x32_bf16 v[96:99], a[148:151], v[64:67], v[96:99]
    v_mfma_f32_16x16x32_bf16 v[104:107], a[228:231], v[64:67], v[104:107]
    v_mfma_f32_16x16x32_bf16 v[112:115], v[244:247], v[64:67], v[112:115]
    v_mfma_f32_16x16x32_bf16 v[92:95], a[68:71], v[68:71], v[92:95]
    v_mfma_f32_16x16x32_bf16 v[100:103], a[148:151], v[68:71], v[100:103]
    v_mfma_f32_16x16x32_bf16 v[108:111], a[228:231], v[68:71], v[108:111]
    v_mfma_f32_16x16x32_bf16 v[116:119], v[244:247], v[68:71], v[116:119]
    s_waitcnt lgkmcnt(2)
    v_mfma_f32_16x16x32_bf16 v[88:91], a[72:75], v[72:75], v[88:91]
    v_mfma_f32_16x16x32_bf16 v[96:99], a[152:155], v[72:75], v[96:99]
    v_mfma_f32_16x16x32_bf16 v[104:107], a[232:235], v[72:75], v[104:107]
    v_mfma_f32_16x16x32_bf16 v[112:115], v[248:251], v[72:75], v[112:115]
    v_mfma_f32_16x16x32_bf16 v[92:95], a[72:75], v[76:79], v[92:95]
    v_mfma_f32_16x16x32_bf16 v[100:103], a[152:155], v[76:79], v[100:103]
    v_mfma_f32_16x16x32_bf16 v[108:111], a[232:235], v[76:79], v[108:111]
    v_mfma_f32_16x16x32_bf16 v[116:119], v[248:251], v[76:79], v[116:119]
    s_waitcnt lgkmcnt(0)
    v_mfma_f32_16x16x32_bf16 v[88:91], a[76:79], v[80:83], v[88:91]
    v_mfma_f32_16x16x32_bf16 v[96:99], a[156:159], v[80:83], v[96:99]
    v_mfma_f32_16x16x32_bf16 v[104:107], a[236:239], v[80:83], v[104:107]
    v_mfma_f32_16x16x32_bf16 v[112:115], v[252:255], v[80:83], v[112:115]
    v_mfma_f32_16x16x32_bf16 v[92:95], a[76:79], v[84:87], v[92:95]
    v_mfma_f32_16x16x32_bf16 v[100:103], a[156:159], v[84:87], v[100:103]
    v_mfma_f32_16x16x32_bf16 v[108:111], a[236:239], v[84:87], v[108:111]
    v_mfma_f32_16x16x32_bf16 v[116:119], v[252:255], v[84:87], v[116:119]
    v_pk_mul_f32 v[148:149], v[156:157], v[144:145] op_sel:[0,1] op_sel_hi:[1,1]
    v_pk_mul_f32 v[150:151], v[158:159], v[144:145] op_sel:[0,1] op_sel_hi:[1,1]
    v_pk_fma_f32 v[88:89], v[88:89], v[144:145], v[148:149] op_sel:[0,0,0] op_sel_hi:[1,0,1]
    v_pk_fma_f32 v[90:91], v[90:91], v[144:145], v[150:151] op_sel:[0,0,0] op_sel_hi:[1,0,1]
    v_pk_mul_f32 v[148:149], v[156:157], v[146:147] op_sel:[0,1] op_sel_hi:[1,1]
    v_pk_mul_f32 v[150:151], v[158:159], v[146:147] op_sel:[0,1] op_sel_hi:[1,1]
    v_pk_fma_f32 v[92:93], v[92:93], v[146:147], v[148:149] op_sel:[0,0,0] op_sel_hi:[1,0,1]
    v_pk_fma_f32 v[94:95], v[94:95], v[146:147], v[150:151] op_sel:[0,0,0] op_sel_hi:[1,0,1]
    v_pk_mul_f32 v[148:149], v[160:161], v[144:145] op_sel:[0,1] op_sel_hi:[1,1]
    v_pk_mul_f32 v[150:151], v[162:163], v[144:145] op_sel:[0,1] op_sel_hi:[1,1]
    v_pk_fma_f32 v[96:97], v[96:97], v[144:145], v[148:149] op_sel:[0,0,0] op_sel_hi:[1,0,1]
    v_pk_fma_f32 v[98:99], v[98:99], v[144:145], v[150:151] op_sel:[0,0,0] op_sel_hi:[1,0,1]
    v_pk_mul_f32 v[148:149], v[160:161], v[146:147] op_sel:[0,1] op_sel_hi:[1,1]
    v_pk_mul_f32 v[150:151], v[162:163], v[146:147] op_sel:[0,1] op_sel_hi:[1,1]
    v_pk_fma_f32 v[100:101], v[100:101], v[146:147], v[148:149] op_sel:[0,0,0] op_sel_hi:[1,0,1]
    v_pk_fma_f32 v[102:103], v[102:103], v[146:147], v[150:151] op_sel:[0,0,0] op_sel_hi:[1,0,1]
    v_pk_mul_f32 v[148:149], v[164:165], v[144:145] op_sel:[0,1] op_sel_hi:[1,1]
    v_pk_mul_f32 v[150:151], v[166:167], v[144:145] op_sel:[0,1] op_sel_hi:[1,1]
    v_pk_fma_f32 v[104:105], v[104:105], v[144:145], v[148:149] op_sel:[0,0,0] op_sel_hi:[1,0,1]
    v_pk_fma_f32 v[106:107], v[106:107], v[144:145], v[150:151] op_sel:[0,0,0] op_sel_hi:[1,0,1]
    v_pk_mul_f32 v[148:149], v[164:165], v[146:147] op_sel:[0,1] op_sel_hi:[1,1]
    v_pk_mul_f32 v[150:151], v[166:167], v[146:147] op_sel:[0,1] op_sel_hi:[1,1]
    v_pk_fma_f32 v[108:109], v[108:109], v[146:147], v[148:149] op_sel:[0,0,0] op_sel_hi:[1,0,1]
    v_pk_fma_f32 v[110:111], v[110:111], v[146:147], v[150:151] op_sel:[0,0,0] op_sel_hi:[1,0,1]
    v_pk_mul_f32 v[148:149], v[168:169], v[144:145] op_sel:[0,1] op_sel_hi:[1,1]
    v_pk_mul_f32 v[150:151], v[170:171], v[144:145] op_sel:[0,1] op_sel_hi:[1,1]
    v_pk_fma_f32 v[112:113], v[112:113], v[144:145], v[148:149] op_sel:[0,0,0] op_sel_hi:[1,0,1]
    v_pk_fma_f32 v[114:115], v[114:115], v[144:145], v[150:151] op_sel:[0,0,0] op_sel_hi:[1,0,1]
    v_pk_mul_f32 v[148:149], v[168:169], v[146:147] op_sel:[0,1] op_sel_hi:[1,1]
    v_pk_mul_f32 v[150:151], v[170:171], v[146:147] op_sel:[0,1] op_sel_hi:[1,1]
    v_pk_fma_f32 v[116:117], v[116:117], v[146:147], v[148:149] op_sel:[0,0,0] op_sel_hi:[1,0,1]
    v_pk_fma_f32 v[118:119], v[118:119], v[146:147], v[150:151] op_sel:[0,0,0] op_sel_hi:[1,0,1]
    s_add_u32 s25, s43, 20480
    s_cmp_ge_u32 s3, 2
    s_cbranch_scc1 interleave_layers__linear_attn_block__memory_aug_recurrent_mem_tr__prompt_kernel_k1_e2
    s_lshl_b32 s24, s3, 6
    v_add_u32 v15, s24, v10
    v_cvt_pk_bf16_f32 v64, v104, v105
    v_cvt_pk_bf16_f32 v65, v106, v107
    ds_write_b64 v15, v[64:65] offset:160
    v_cvt_pk_bf16_f32 v66, v108, v109
    v_cvt_pk_bf16_f32 v67, v110, v111
    ds_write_b64 v15, v[66:67] offset:5536
    v_cvt_pk_bf16_f32 v68, v112, v113
    v_cvt_pk_bf16_f32 v69, v114, v115
    ds_write_b64 v15, v[68:69] offset:192
    v_cvt_pk_bf16_f32 v70, v116, v117
    v_cvt_pk_bf16_f32 v71, v118, v119
    ds_write_b64 v15, v[70:71] offset:5568
    v_min_f32 v148, 0, v88
    v_min_f32 v149, 0, v89
    v_pk_mul_f32 v[148:149], v[148:149], s[52:53]
    v_min_f32 v150, 0, v90
    v_min_f32 v151, 0, v91
    v_pk_mul_f32 v[150:151], v[150:151], s[52:53]
    v_exp_f32 v148, v148
    v_exp_f32 v149, v149
    v_exp_f32 v150, v150
    v_exp_f32 v151, v151
    v_max_f32 v88, 0, v88
    v_max_f32 v89, 0, v89
    v_max_f32 v90, 0, v90
    v_max_f32 v91, 0, v91
    v_pk_add_f32 v[88:89], v[88:89], v[148:149]
    v_pk_add_f32 v[90:91], v[90:91], v[150:151]
    v_pk_add_f32 v[88:89], v[88:89], s[54:55]
    v_pk_add_f32 v[90:91], v[90:91], s[54:55]
    v_min_f32 v148, 0, v96
    v_min_f32 v149, 0, v97
    v_pk_mul_f32 v[148:149], v[148:149], s[52:53]
    v_min_f32 v150, 0, v98
    v_min_f32 v151, 0, v99
    v_pk_mul_f32 v[150:151], v[150:151], s[52:53]
    v_exp_f32 v148, v148
    v_exp_f32 v149, v149
    v_exp_f32 v150, v150
    v_exp_f32 v151, v151
    v_max_f32 v96, 0, v96
    v_max_f32 v97, 0, v97
    v_max_f32 v98, 0, v98
    v_max_f32 v99, 0, v99
    v_pk_add_f32 v[96:97], v[96:97], v[148:149]
    v_pk_add_f32 v[98:99], v[98:99], v[150:151]
    v_pk_add_f32 v[96:97], v[96:97], s[54:55]
    v_pk_add_f32 v[98:99], v[98:99], s[54:55]
    v_cvt_pk_bf16_f32 v56, v88, v89
    v_cvt_pk_bf16_f32 v57, v90, v91
    v_cvt_pk_bf16_f32 v58, v96, v97
    v_cvt_pk_bf16_f32 v59, v98, v99
    buffer_store_dwordx4 v[56:59], v12, s[8:11], s43 offen sc1
    v_min_f32 v148, 0, v92
    v_min_f32 v149, 0, v93
    v_pk_mul_f32 v[148:149], v[148:149], s[52:53]
    v_min_f32 v150, 0, v94
    v_min_f32 v151, 0, v95
    v_pk_mul_f32 v[150:151], v[150:151], s[52:53]
    v_exp_f32 v148, v148
    v_exp_f32 v149, v149
    v_exp_f32 v150, v150
    v_exp_f32 v151, v151
    v_max_f32 v92, 0, v92
    v_max_f32 v93, 0, v93
    v_max_f32 v94, 0, v94
    v_max_f32 v95, 0, v95
    v_pk_add_f32 v[92:93], v[92:93], v[148:149]
    v_pk_add_f32 v[94:95], v[94:95], v[150:151]
    v_pk_add_f32 v[92:93], v[92:93], s[54:55]
    v_pk_add_f32 v[94:95], v[94:95], s[54:55]
    v_min_f32 v148, 0, v100
    v_min_f32 v149, 0, v101
    v_pk_mul_f32 v[148:149], v[148:149], s[52:53]
    v_min_f32 v150, 0, v102
    v_min_f32 v151, 0, v103
    v_pk_mul_f32 v[150:151], v[150:151], s[52:53]
    v_exp_f32 v148, v148
    v_exp_f32 v149, v149
    v_exp_f32 v150, v150
    v_exp_f32 v151, v151
    v_max_f32 v100, 0, v100
    v_max_f32 v101, 0, v101
    v_max_f32 v102, 0, v102
    v_max_f32 v103, 0, v103
    v_pk_add_f32 v[100:101], v[100:101], v[148:149]
    v_pk_add_f32 v[102:103], v[102:103], v[150:151]
    v_pk_add_f32 v[100:101], v[100:101], s[54:55]
    v_pk_add_f32 v[102:103], v[102:103], s[54:55]
    v_cvt_pk_bf16_f32 v60, v92, v93
    v_cvt_pk_bf16_f32 v61, v94, v95
    v_cvt_pk_bf16_f32 v62, v100, v101
    v_cvt_pk_bf16_f32 v63, v102, v103
    buffer_store_dwordx4 v[60:63], v12, s[8:11], s25 offen sc1
    s_branch interleave_layers__linear_attn_block__memory_aug_recurrent_mem_tr__prompt_kernel_k1_ej
interleave_layers__linear_attn_block__memory_aug_recurrent_mem_tr__prompt_kernel_k1_e2:
    s_cmp_eq_u32 s3, 3
    s_cbranch_scc1 interleave_layers__linear_attn_block__memory_aug_recurrent_mem_tr__prompt_kernel_k1_e3
    v_cvt_pk_bf16_f32 v68, v112, v113
    v_cvt_pk_bf16_f32 v69, v114, v115
    ds_write_b64 v10, v[68:69] offset:288
    v_cvt_pk_bf16_f32 v70, v116, v117
    v_cvt_pk_bf16_f32 v71, v118, v119
    ds_write_b64 v10, v[70:71] offset:5664
    v_min_f32 v148, 0, v96
    v_min_f32 v149, 0, v97
    v_pk_mul_f32 v[148:149], v[148:149], s[52:53]
    v_min_f32 v150, 0, v98
    v_min_f32 v151, 0, v99
    v_pk_mul_f32 v[150:151], v[150:151], s[52:53]
    v_exp_f32 v148, v148
    v_exp_f32 v149, v149
    v_exp_f32 v150, v150
    v_exp_f32 v151, v151
    v_max_f32 v96, 0, v96
    v_max_f32 v97, 0, v97
    v_max_f32 v98, 0, v98
    v_max_f32 v99, 0, v99
    v_pk_add_f32 v[96:97], v[96:97], v[148:149]
    v_pk_add_f32 v[98:99], v[98:99], v[150:151]
    v_pk_add_f32 v[96:97], v[96:97], s[54:55]
    v_pk_add_f32 v[98:99], v[98:99], s[54:55]
    v_min_f32 v148, 0, v104
    v_min_f32 v149, 0, v105
    v_pk_mul_f32 v[148:149], v[148:149], s[52:53]
    v_min_f32 v150, 0, v106
    v_min_f32 v151, 0, v107
    v_pk_mul_f32 v[150:151], v[150:151], s[52:53]
    v_exp_f32 v148, v148
    v_exp_f32 v149, v149
    v_exp_f32 v150, v150
    v_exp_f32 v151, v151
    v_max_f32 v104, 0, v104
    v_max_f32 v105, 0, v105
    v_max_f32 v106, 0, v106
    v_max_f32 v107, 0, v107
    v_pk_add_f32 v[104:105], v[104:105], v[148:149]
    v_pk_add_f32 v[106:107], v[106:107], v[150:151]
    v_pk_add_f32 v[104:105], v[104:105], s[54:55]
    v_pk_add_f32 v[106:107], v[106:107], s[54:55]
    v_min_f32 v148, 0, v100
    v_min_f32 v149, 0, v101
    v_pk_mul_f32 v[148:149], v[148:149], s[52:53]
    v_min_f32 v150, 0, v102
    v_min_f32 v151, 0, v103
    v_pk_mul_f32 v[150:151], v[150:151], s[52:53]
    v_exp_f32 v148, v148
    v_exp_f32 v149, v149
    v_exp_f32 v150, v150
    v_exp_f32 v151, v151
    v_max_f32 v100, 0, v100
    v_max_f32 v101, 0, v101
    v_max_f32 v102, 0, v102
    v_max_f32 v103, 0, v103
    v_pk_add_f32 v[100:101], v[100:101], v[148:149]
    v_pk_add_f32 v[102:103], v[102:103], v[150:151]
    v_pk_add_f32 v[100:101], v[100:101], s[54:55]
    v_pk_add_f32 v[102:103], v[102:103], s[54:55]
    v_min_f32 v148, 0, v108
    v_min_f32 v149, 0, v109
    v_pk_mul_f32 v[148:149], v[148:149], s[52:53]
    v_min_f32 v150, 0, v110
    v_min_f32 v151, 0, v111
    v_pk_mul_f32 v[150:151], v[150:151], s[52:53]
    v_exp_f32 v148, v148
    v_exp_f32 v149, v149
    v_exp_f32 v150, v150
    v_exp_f32 v151, v151
    v_max_f32 v108, 0, v108
    v_max_f32 v109, 0, v109
    v_max_f32 v110, 0, v110
    v_max_f32 v111, 0, v111
    v_pk_add_f32 v[108:109], v[108:109], v[148:149]
    v_pk_add_f32 v[110:111], v[110:111], v[150:151]
    v_pk_add_f32 v[108:109], v[108:109], s[54:55]
    v_pk_add_f32 v[110:111], v[110:111], s[54:55]
    v_cvt_pk_bf16_f32 v60, v96, v97
    v_cvt_pk_bf16_f32 v61, v98, v99
    ds_write_b64 v10, v[60:61] offset:0
    v_cvt_pk_bf16_f32 v62, v100, v101
    v_cvt_pk_bf16_f32 v63, v102, v103
    ds_write_b64 v10, v[62:63] offset:5376
    v_cvt_pk_bf16_f32 v64, v104, v105
    v_cvt_pk_bf16_f32 v65, v106, v107
    ds_write_b64 v10, v[64:65] offset:32
    v_cvt_pk_bf16_f32 v66, v108, v109
    v_cvt_pk_bf16_f32 v67, v110, v111
    ds_write_b64 v10, v[66:67] offset:5408
    v_min_f32 v148, 0, v88
    v_min_f32 v149, 0, v89
    v_pk_mul_f32 v[148:149], v[148:149], s[52:53]
    v_min_f32 v150, 0, v90
    v_min_f32 v151, 0, v91
    v_pk_mul_f32 v[150:151], v[150:151], s[52:53]
    v_exp_f32 v148, v148
    v_exp_f32 v149, v149
    v_exp_f32 v150, v150
    v_exp_f32 v151, v151
    v_max_f32 v88, 0, v88
    v_max_f32 v89, 0, v89
    v_max_f32 v90, 0, v90
    v_max_f32 v91, 0, v91
    v_pk_add_f32 v[88:89], v[88:89], v[148:149]
    v_pk_add_f32 v[90:91], v[90:91], v[150:151]
    v_pk_add_f32 v[88:89], v[88:89], s[54:55]
    v_pk_add_f32 v[90:91], v[90:91], s[54:55]
    v_cvt_pk_bf16_f32 v56, v88, v89
    v_cvt_pk_bf16_f32 v57, v90, v91
    buffer_store_dwordx2 v[56:57], v12, s[8:11], s43 offen sc1
    v_min_f32 v148, 0, v92
    v_min_f32 v149, 0, v93
    v_pk_mul_f32 v[148:149], v[148:149], s[52:53]
    v_min_f32 v150, 0, v94
    v_min_f32 v151, 0, v95
    v_pk_mul_f32 v[150:151], v[150:151], s[52:53]
    v_exp_f32 v148, v148
    v_exp_f32 v149, v149
    v_exp_f32 v150, v150
    v_exp_f32 v151, v151
    v_max_f32 v92, 0, v92
    v_max_f32 v93, 0, v93
    v_max_f32 v94, 0, v94
    v_max_f32 v95, 0, v95
    v_pk_add_f32 v[92:93], v[92:93], v[148:149]
    v_pk_add_f32 v[94:95], v[94:95], v[150:151]
    v_pk_add_f32 v[92:93], v[92:93], s[54:55]
    v_pk_add_f32 v[94:95], v[94:95], s[54:55]
    v_cvt_pk_bf16_f32 v58, v92, v93
    v_cvt_pk_bf16_f32 v59, v94, v95
    buffer_store_dwordx2 v[58:59], v12, s[8:11], s25 offen sc1
    s_branch interleave_layers__linear_attn_block__memory_aug_recurrent_mem_tr__prompt_kernel_k1_ej
interleave_layers__linear_attn_block__memory_aug_recurrent_mem_tr__prompt_kernel_k1_e3:
    v_min_f32 v148, 0, v88
    v_min_f32 v149, 0, v89
    v_pk_mul_f32 v[148:149], v[148:149], s[52:53]
    v_min_f32 v150, 0, v90
    v_min_f32 v151, 0, v91
    v_pk_mul_f32 v[150:151], v[150:151], s[52:53]
    v_exp_f32 v148, v148
    v_exp_f32 v149, v149
    v_exp_f32 v150, v150
    v_exp_f32 v151, v151
    v_max_f32 v88, 0, v88
    v_max_f32 v89, 0, v89
    v_max_f32 v90, 0, v90
    v_max_f32 v91, 0, v91
    v_pk_add_f32 v[88:89], v[88:89], v[148:149]
    v_pk_add_f32 v[90:91], v[90:91], v[150:151]
    v_pk_add_f32 v[88:89], v[88:89], s[54:55]
    v_pk_add_f32 v[90:91], v[90:91], s[54:55]
    v_min_f32 v148, 0, v92
    v_min_f32 v149, 0, v93
    v_pk_mul_f32 v[148:149], v[148:149], s[52:53]
    v_min_f32 v150, 0, v94
    v_min_f32 v151, 0, v95
    v_pk_mul_f32 v[150:151], v[150:151], s[52:53]
    v_exp_f32 v148, v148
    v_exp_f32 v149, v149
    v_exp_f32 v150, v150
    v_exp_f32 v151, v151
    v_max_f32 v92, 0, v92
    v_max_f32 v93, 0, v93
    v_max_f32 v94, 0, v94
    v_max_f32 v95, 0, v95
    v_pk_add_f32 v[92:93], v[92:93], v[148:149]
    v_pk_add_f32 v[94:95], v[94:95], v[150:151]
    v_pk_add_f32 v[92:93], v[92:93], s[54:55]
    v_pk_add_f32 v[94:95], v[94:95], s[54:55]
    v_cvt_pk_bf16_f32 v56, v88, v89
    v_cvt_pk_bf16_f32 v57, v90, v91
    ds_write_b64 v10, v[56:57] offset:64
    v_cvt_pk_bf16_f32 v58, v92, v93
    v_cvt_pk_bf16_f32 v59, v94, v95
    ds_write_b64 v10, v[58:59] offset:5440
    v_min_f32 v148, 0, v96
    v_min_f32 v149, 0, v97
    v_pk_mul_f32 v[148:149], v[148:149], s[52:53]
    v_min_f32 v150, 0, v98
    v_min_f32 v151, 0, v99
    v_pk_mul_f32 v[150:151], v[150:151], s[52:53]
    v_exp_f32 v148, v148
    v_exp_f32 v149, v149
    v_exp_f32 v150, v150
    v_exp_f32 v151, v151
    v_max_f32 v96, 0, v96
    v_max_f32 v97, 0, v97
    v_max_f32 v98, 0, v98
    v_max_f32 v99, 0, v99
    v_pk_add_f32 v[96:97], v[96:97], v[148:149]
    v_pk_add_f32 v[98:99], v[98:99], v[150:151]
    v_pk_add_f32 v[96:97], v[96:97], s[54:55]
    v_pk_add_f32 v[98:99], v[98:99], s[54:55]
    v_min_f32 v148, 0, v100
    v_min_f32 v149, 0, v101
    v_pk_mul_f32 v[148:149], v[148:149], s[52:53]
    v_min_f32 v150, 0, v102
    v_min_f32 v151, 0, v103
    v_pk_mul_f32 v[150:151], v[150:151], s[52:53]
    v_exp_f32 v148, v148
    v_exp_f32 v149, v149
    v_exp_f32 v150, v150
    v_exp_f32 v151, v151
    v_max_f32 v100, 0, v100
    v_max_f32 v101, 0, v101
    v_max_f32 v102, 0, v102
    v_max_f32 v103, 0, v103
    v_pk_add_f32 v[100:101], v[100:101], v[148:149]
    v_pk_add_f32 v[102:103], v[102:103], v[150:151]
    v_pk_add_f32 v[100:101], v[100:101], s[54:55]
    v_pk_add_f32 v[102:103], v[102:103], s[54:55]
    v_cvt_pk_bf16_f32 v60, v96, v97
    v_cvt_pk_bf16_f32 v61, v98, v99
    ds_write_b64 v10, v[60:61] offset:96
    v_cvt_pk_bf16_f32 v62, v100, v101
    v_cvt_pk_bf16_f32 v63, v102, v103
    ds_write_b64 v10, v[62:63] offset:5472
    v_min_f32 v148, 0, v104
    v_min_f32 v149, 0, v105
    v_pk_mul_f32 v[148:149], v[148:149], s[52:53]
    v_min_f32 v150, 0, v106
    v_min_f32 v151, 0, v107
    v_pk_mul_f32 v[150:151], v[150:151], s[52:53]
    v_exp_f32 v148, v148
    v_exp_f32 v149, v149
    v_exp_f32 v150, v150
    v_exp_f32 v151, v151
    v_max_f32 v104, 0, v104
    v_max_f32 v105, 0, v105
    v_max_f32 v106, 0, v106
    v_max_f32 v107, 0, v107
    v_pk_add_f32 v[104:105], v[104:105], v[148:149]
    v_pk_add_f32 v[106:107], v[106:107], v[150:151]
    v_pk_add_f32 v[104:105], v[104:105], s[54:55]
    v_pk_add_f32 v[106:107], v[106:107], s[54:55]
    v_min_f32 v148, 0, v108
    v_min_f32 v149, 0, v109
    v_pk_mul_f32 v[148:149], v[148:149], s[52:53]
    v_min_f32 v150, 0, v110
    v_min_f32 v151, 0, v111
    v_pk_mul_f32 v[150:151], v[150:151], s[52:53]
    v_exp_f32 v148, v148
    v_exp_f32 v149, v149
    v_exp_f32 v150, v150
    v_exp_f32 v151, v151
    v_max_f32 v108, 0, v108
    v_max_f32 v109, 0, v109
    v_max_f32 v110, 0, v110
    v_max_f32 v111, 0, v111
    v_pk_add_f32 v[108:109], v[108:109], v[148:149]
    v_pk_add_f32 v[110:111], v[110:111], v[150:151]
    v_pk_add_f32 v[108:109], v[108:109], s[54:55]
    v_pk_add_f32 v[110:111], v[110:111], s[54:55]
    v_cvt_pk_bf16_f32 v64, v104, v105
    v_cvt_pk_bf16_f32 v65, v106, v107
    ds_write_b64 v10, v[64:65] offset:128
    v_cvt_pk_bf16_f32 v66, v108, v109
    v_cvt_pk_bf16_f32 v67, v110, v111
    ds_write_b64 v10, v[66:67] offset:5504
interleave_layers__linear_attn_block__memory_aug_recurrent_mem_tr__prompt_kernel_k1_ej:
    s_waitcnt lgkmcnt(0)
    s_barrier
    ds_read_b64_tr_b16 v[72:73], v11 offset:0
    ds_read_b64_tr_b16 v[74:75], v11 offset:1344
    ds_read_b64_tr_b16 v[76:77], v11 offset:32
    ds_read_b64_tr_b16 v[78:79], v11 offset:1376
    ds_read_b64_tr_b16 v[80:81], v11 offset:160
    ds_read_b64_tr_b16 v[82:83], v11 offset:1504
    ds_read_b64_tr_b16 v[84:85], v11 offset:192
    ds_read_b64_tr_b16 v[86:87], v11 offset:1536
    s_waitcnt lgkmcnt(0)
    v_mfma_f32_16x16x32_bf16 v[120:123], v[72:75], v[84:87], v[120:123]
    v_mfma_f32_16x16x32_bf16 v[124:127], v[76:79], v[80:83], v[124:127]
    v_mfma_f32_16x16x32_bf16 v[128:131], v[76:79], v[84:87], v[128:131]
    v_mfma_f32_16x16x32_bf16 v[132:135], v[76:79], v[172:175], v[132:135]
    v_mfma_f32_16x16x32_bf16 v[136:139], v[72:75], v[80:83], v[136:139]
    v_mfma_f32_16x16x32_bf16 v[140:143], v[72:75], v[172:175], v[140:143]
    s_add_u32 s43, s43, s42
    s_add_u32 s48, s48, s49
    s_sub_u32 s40, s40, 1
    s_cmp_gt_u32 s40, 0
    s_cbranch_scc1 interleave_layers__linear_attn_block__memory_aug_recurrent_mem_tr__prompt_kernel_k1_seg
    s_cmp_eq_u32 s92, 0
    s_cbranch_scc0 interleave_layers__linear_attn_block__memory_aug_recurrent_mem_tr__prompt_kernel_ri7
    v_mov_b32 v15, 0
    buffer_load_dword v14, v15, s[72:75], 0 offen sc1
interleave_layers__linear_attn_block__memory_aug_recurrent_mem_tr__prompt_kernel_ri7:
    s_mul_i32 s24, s45, 147456
    s_mul_i32 s25, s44, 18432
    s_add_u32 s24, s24, s25
    s_add_u32 s24, s24, 16777216
    s_mul_i32 s25, s3, 3072
    s_add_u32 s25, s25, s24
    s_lshl_b32 s26, s3, 10
    s_add_u32 s26, s26, s24
    s_add_u32 s26, s26, 13312
    s_cmp_eq_u32 s3, 0
    s_cselect_b32 s27, 0, 2146435072
    s_add_u32 s27, s27, s24
    s_add_u32 s28, s27, 17408
    s_add_u32 s27, s27, 12288
    buffer_store_dwordx4 v[120:123], v7, s[8:11], s25 offen offset:0 sc1
    buffer_store_dwordx4 v[124:127], v7, s[8:11], s25 offen offset:1024 sc1
    buffer_store_dwordx4 v[128:131], v7, s[8:11], s25 offen offset:2048 sc1
    buffer_store_dwordx4 v[132:135], v7, s[8:11], s26 offen sc1
    buffer_store_dwordx4 v[136:139], v7, s[8:11], s27 offen sc1
    buffer_store_dwordx4 v[140:143], v7, s[8:11], s28 offen sc1
    s_waitcnt vmcnt(0)
    s_cmp_eq_u32 s92, 0
    s_cbranch_scc0 interleave_layers__linear_attn_block__memory_aug_recurrent_mem_tr__prompt_kernel_rc8_ok
    s_mov_b32 s61, 0
interleave_layers__linear_attn_block__memory_aug_recurrent_mem_tr__prompt_kernel_rc8:
    s_waitcnt vmcnt(0)
    v_readfirstlane_b32 s24, v14
    s_sub_u32 s36, s24, 1
    s_and_b32 s36, s36, 1
    s_lshl_b32 s36, s36, 13
    s_cmp_ge_u32 s24, 1
    s_cbranch_scc1 interleave_layers__linear_attn_block__memory_aug_recurrent_mem_tr__prompt_kernel_rc8_ok
    s_add_u32 s61, s61, 1
    s_cmp_ge_u32 s61, s60
    s_cbranch_scc1 interleave_layers__linear_attn_block__memory_aug_recurrent_mem_tr__prompt_kernel_rc8_to
    s_sleep 2
    v_mov_b32 v15, 0
    buffer_load_dword v14, v15, s[72:75], 0 offen sc1
    s_branch interleave_layers__linear_attn_block__memory_aug_recurrent_mem_tr__prompt_kernel_rc8
interleave_layers__linear_attn_block__memory_aug_recurrent_mem_tr__prompt_kernel_rc8_to:
    s_mov_b32 s60, 1
interleave_layers__linear_attn_block__memory_aug_recurrent_mem_tr__prompt_kernel_rc8_ok:
    s_barrier
    s_lshl_b32 s24, s92, 3
    s_add_u32 s24, s24, s44
    s_lshl_b32 s24, s24, 7
    s_lshl_b32 s25, s45, 2
    s_add_u32 s24, s24, s25
    s_add_u32 s24, s24, 23101440
    s_cmp_eq_u32 s3, 0
    s_cbranch_scc0 interleave_layers__linear_attn_block__memory_aug_recurrent_mem_tr__prompt_kernel_pb9
    v_lshlrev_b32 v14, 7, v1
    v_add_u32 v14, s24, v14
    v_mov_b32 v15, 2146435072
    v_cmp_le_u32 vcc, 1, v1
    s_nop 1
    v_cndmask_b32 v14, v14, v15, vcc
    v_mov_b32 v15, 1
    buffer_store_dword v15, v14, s[8:11], 0 offen sc1
interleave_layers__linear_attn_block__memory_aug_recurrent_mem_tr__prompt_kernel_pb9:
    s_cmp_eq_u32 s92, 0
    s_cbranch_scc0 interleave_layers__linear_attn_block__memory_aug_recurrent_mem_tr__prompt_kernel_end
    s_cmp_ge_u32 s2, 232
    s_cbranch_scc1 interleave_layers__linear_attn_block__memory_aug_recurrent_mem_tr__prompt_kernel_helper
    s_cmp_ge_u32 s2, 200
    s_cbranch_scc1 interleave_layers__linear_attn_block__memory_aug_recurrent_mem_tr__prompt_kernel_toO
    s_cmp_ge_u32 s2, 104
    s_cbranch_scc1 interleave_layers__linear_attn_block__memory_aug_recurrent_mem_tr__prompt_kernel_toP
    s_cmp_ge_u32 s2, 64
    s_cbranch_scc1 interleave_layers__linear_attn_block__memory_aug_recurrent_mem_tr__prompt_kernel_toR
    s_cmp_ge_u32 s2, 32
    s_cbranch_scc1 interleave_layers__linear_attn_block__memory_aug_recurrent_mem_tr__prompt_kernel_toV
    s_branch interleave_layers__linear_attn_block__memory_aug_recurrent_mem_tr__prompt_kernel_roleS
interleave_layers__linear_attn_block__memory_aug_recurrent_mem_tr__prompt_kernel_toV:
    s_branch interleave_layers__linear_attn_block__memory_aug_recurrent_mem_tr__prompt_kernel_roleV
interleave_layers__linear_attn_block__memory_aug_recurrent_mem_tr__prompt_kernel_toR:
    s_branch interleave_layers__linear_attn_block__memory_aug_recurrent_mem_tr__prompt_kernel_roleR
interleave_layers__linear_attn_block__memory_aug_recurrent_mem_tr__prompt_kernel_toP:
    s_branch interleave_layers__linear_attn_block__memory_aug_recurrent_mem_tr__prompt_kernel_roleP
interleave_layers__linear_attn_block__memory_aug_recurrent_mem_tr__prompt_kernel_toO:
    s_branch interleave_layers__linear_attn_block__memory_aug_recurrent_mem_tr__prompt_kernel_roleO
interleave_layers__linear_attn_block__memory_aug_recurrent_mem_tr__prompt_kernel_helper:
    s_sub_u32 s24, s2, 232
    s_cmp_ge_u32 s24, 21
    s_cbranch_scc1 interleave_layers__linear_attn_block__memory_aug_recurrent_mem_tr__prompt_kernel_helper_clr
    s_cmp_eq_u32 s24, 15
    s_cbranch_scc1 interleave_layers__linear_attn_block__memory_aug_recurrent_mem_tr__prompt_kernel_helper_k1
    s_mul_i32 s57, s24, 52
    s_lshr_b32 s57, s57, 8
    s_mul_i32 s56, s57, 5
    s_sub_u32 s56, s24, s56
    s_add_u32 s57, s57, 1
    s_sub_u32 s25, s24, 16
    s_cmp_ge_u32 s24, 16
    s_cselect_b32 s56, s25, s56
    s_cselect_b32 s57, 0, s57
    s_mul_i32 s78, s57, 5
    s_add_u32 s78, s78, s56
    s_load_dwordx2 s[6:7], s[0:1], 16
    v_lshrrev_b32 v12, 4, v0
    v_mul_u32_u24 v12, 1280, v12
    v_and_b32 v13, 15, v0
    v_lshl_add_u32 v12, v13, 4, v12
    s_waitcnt lgkmcnt(0)
    s_mov_b32 s12, s6
    s_mov_b32 s13, s7
    s_mov_b32 s14, 819200
    s_mov_b32 s15, 0x00020000
    s_lshl_b32 s52, s56, 8
    s_add_u32 s24, s52, 0
    buffer_load_dwordx4 a[0:3], v12, s[12:15], s24 offen
    s_add_u32 s24, s52, 20480
    buffer_load_dwordx4 a[4:7], v12, s[12:15], s24 offen
    s_add_u32 s24, s52, 40960
    buffer_load_dwordx4 a[8:11], v12, s[12:15], s24 offen
    s_add_u32 s24, s52, 61440
    buffer_load_dwordx4 a[12:15], v12, s[12:15], s24 offen
    s_add_u32 s24, s52, 81920
    buffer_load_dwordx4 a[16:19], v12, s[12:15], s24 offen
    s_add_u32 s24, s52, 102400
    buffer_load_dwordx4 a[20:23], v12, s[12:15], s24 offen
    s_add_u32 s24, s52, 122880
    buffer_load_dwordx4 a[24:27], v12, s[12:15], s24 offen
    s_add_u32 s24, s52, 143360
    buffer_load_dwordx4 a[28:31], v12, s[12:15], s24 offen
    s_add_u32 s24, s52, 163840
    buffer_load_dwordx4 a[32:35], v12, s[12:15], s24 offen
    s_add_u32 s24, s52, 184320
    buffer_load_dwordx4 a[36:39], v12, s[12:15], s24 offen
    s_add_u32 s24, s52, 204800
    buffer_load_dwordx4 a[40:43], v12, s[12:15], s24 offen
    s_add_u32 s24, s52, 225280
    buffer_load_dwordx4 a[44:47], v12, s[12:15], s24 offen
    s_add_u32 s24, s52, 245760
    buffer_load_dwordx4 a[48:51], v12, s[12:15], s24 offen
    s_add_u32 s24, s52, 266240
    buffer_load_dwordx4 a[52:55], v12, s[12:15], s24 offen
    s_add_u32 s24, s52, 286720
    buffer_load_dwordx4 a[56:59], v12, s[12:15], s24 offen
    s_add_u32 s24, s52, 307200
    buffer_load_dwordx4 a[60:63], v12, s[12:15], s24 offen
    s_add_u32 s24, s52, 327680
    buffer_load_dwordx4 a[64:67], v12, s[12:15], s24 offen
    s_add_u32 s24, s52, 348160
    buffer_load_dwordx4 a[68:71], v12, s[12:15], s24 offen
    s_add_u32 s24, s52, 368640
    buffer_load_dwordx4 a[72:75], v12, s[12:15], s24 offen
    s_add_u32 s24, s52, 389120
    buffer_load_dwordx4 a[76:79], v12, s[12:15], s24 offen
    s_add_u32 s24, s52, 409600
    buffer_load_dwordx4 a[80:83], v12, s[12:15], s24 offen
    s_add_u32 s24, s52, 430080
    buffer_load_dwordx4 a[84:87], v12, s[12:15], s24 offen
    s_add_u32 s24, s52, 450560
    buffer_load_dwordx4 a[88:91], v12, s[12:15], s24 offen
    s_add_u32 s24, s52, 471040
    buffer_load_dwordx4 a[92:95], v12, s[12:15], s24 offen
    s_add_u32 s24, s52, 491520
    buffer_load_dwordx4 a[96:99], v12, s[12:15], s24 offen
    s_add_u32 s24, s52, 512000
    buffer_load_dwordx4 a[100:103], v12, s[12:15], s24 offen
    s_add_u32 s24, s52, 532480
    buffer_load_dwordx4 a[104:107], v12, s[12:15], s24 offen
    s_add_u32 s24, s52, 552960
    buffer_load_dwordx4 a[108:111], v12, s[12:15], s24 offen
    s_add_u32 s24, s52, 573440
    buffer_load_dwordx4 a[112:115], v12, s[12:15], s24 offen
    s_add_u32 s24, s52, 593920
    buffer_load_dwordx4 a[116:119], v12, s[12:15], s24 offen
    s_add_u32 s24, s52, 614400
    buffer_load_dwordx4 a[120:123], v12, s[12:15], s24 offen
    s_add_u32 s24, s52, 634880
    buffer_load_dwordx4 a[124:127], v12, s[12:15], s24 offen
    s_add_u32 s24, s52, 655360
    buffer_load_dwordx4 a[128:131], v12, s[12:15], s24 offen
    s_add_u32 s24, s52, 675840
    buffer_load_dwordx4 a[132:135], v12, s[12:15], s24 offen
    s_add_u32 s24, s52, 696320
    buffer_load_dwordx4 a[136:139], v12, s[12:15], s24 offen
    s_add_u32 s24, s52, 716800
    buffer_load_dwordx4 a[140:143], v12, s[12:15], s24 offen
    s_add_u32 s24, s52, 737280
    buffer_load_dwordx4 a[144:147], v12, s[12:15], s24 offen
    s_add_u32 s24, s52, 757760
    buffer_load_dwordx4 a[148:151], v12, s[12:15], s24 offen
    s_add_u32 s24, s52, 778240
    buffer_load_dwordx4 a[152:155], v12, s[12:15], s24 offen
    s_add_u32 s24, s52, 798720
    buffer_load_dwordx4 a[156:159], v12, s[12:15], s24 offen
    v_lshrrev_b32 v6, 4, v0
    v_mul_u32_u24 v6, 288, v6
    v_and_b32 v7, 15, v0
    v_lshl_add_u32 v6, v7, 4, v6
    v_add_u32 v6, 81920, v6
    v_lshrrev_b32 v7, 2, v2
    v_lshl_add_u32 v7, v3, 2, v7
    v_mul_u32_u24 v7, 288, v7
    v_and_b32 v8, 3, v2
    v_lshl_add_u32 v7, v8, 3, v7
    s_lshl_b32 s24, s3, 6
    s_add_u32 s24, s24, 81920
    v_add_u32 v7, s24, v7
    s_waitcnt vmcnt(36)
    ds_write_b128 v6, a[0:3] offset:0
    ds_write_b128 v6, a[4:7] offset:4608
    ds_write_b128 v6, a[8:11] offset:9216
    ds_write_b128 v6, a[12:15] offset:13824
    s_waitcnt lgkmcnt(0)
    s_barrier
    ds_read_b64_tr_b16 a[0:1], v7 offset:0
    ds_read_b64_tr_b16 a[2:3], v7 offset:4608
    ds_read_b64_tr_b16 a[4:5], v7 offset:32
    ds_read_b64_tr_b16 a[6:7], v7 offset:4640
    ds_read_b64_tr_b16 a[8:9], v7 offset:9216
    ds_read_b64_tr_b16 a[10:11], v7 offset:13824
    ds_read_b64_tr_b16 a[12:13], v7 offset:9248
    ds_read_b64_tr_b16 a[14:15], v7 offset:13856
    s_waitcnt vmcnt(32)
    ds_write_b128 v6, a[16:19] offset:18432
    ds_write_b128 v6, a[20:23] offset:23040
    ds_write_b128 v6, a[24:27] offset:27648
    ds_write_b128 v6, a[28:31] offset:32256
    s_waitcnt lgkmcnt(0)
    s_barrier
    ds_read_b64_tr_b16 a[16:17], v7 offset:18432
    ds_read_b64_tr_b16 a[18:19], v7 offset:23040
    ds_read_b64_tr_b16 a[20:21], v7 offset:18464
    ds_read_b64_tr_b16 a[22:23], v7 offset:23072
    ds_read_b64_tr_b16 a[24:25], v7 offset:27648
    ds_read_b64_tr_b16 a[26:27], v7 offset:32256
    ds_read_b64_tr_b16 a[28:29], v7 offset:27680
    ds_read_b64_tr_b16 a[30:31], v7 offset:32288
    s_waitcnt vmcnt(28)
    ds_write_b128 v6, a[32:35] offset:0
    ds_write_b128 v6, a[36:39] offset:4608
    ds_write_b128 v6, a[40:43] offset:9216
    ds_write_b128 v6, a[44:47] offset:13824
    s_waitcnt lgkmcnt(0)
    s_barrier
    ds_read_b64_tr_b16 a[32:33], v7 offset:0
    ds_read_b64_tr_b16 a[34:35], v7 offset:4608
    ds_read_b64_tr_b16 a[36:37], v7 offset:32
    ds_read_b64_tr_b16 a[38:39], v7 offset:4640
    ds_read_b64_tr_b16 a[40:41], v7 offset:9216
    ds_read_b64_tr_b16 a[42:43], v7 offset:13824
    ds_read_b64_tr_b16 a[44:45], v7 offset:9248
    ds_read_b64_tr_b16 a[46:47], v7 offset:13856
    s_waitcnt vmcnt(24)
    ds_write_b128 v6, a[48:51] offset:18432
    ds_write_b128 v6, a[52:55] offset:23040
    ds_write_b128 v6, a[56:59] offset:27648
    ds_write_b128 v6, a[60:63] offset:32256
    s_waitcnt lgkmcnt(0)
    s_barrier
    ds_read_b64_tr_b16 a[48:49], v7 offset:18432
    ds_read_b64_tr_b16 a[50:51], v7 offset:23040
    ds_read_b64_tr_b16 a[52:53], v7 offset:18464
    ds_read_b64_tr_b16 a[54:55], v7 offset:23072
    ds_read_b64_tr_b16 a[56:57], v7 offset:27648
    ds_read_b64_tr_b16 a[58:59], v7 offset:32256
    ds_read_b64_tr_b16 a[60:61], v7 offset:27680
    ds_read_b64_tr_b16 a[62:63], v7 offset:32288
    s_waitcnt vmcnt(20)
    ds_write_b128 v6, a[64:67] offset:0
    ds_write_b128 v6, a[68:71] offset:4608
    ds_write_b128 v6, a[72:75] offset:9216
    ds_write_b128 v6, a[76:79] offset:13824
    s_waitcnt lgkmcnt(0)
    s_barrier
    ds_read_b64_tr_b16 a[64:65], v7 offset:0
    ds_read_b64_tr_b16 a[66:67], v7 offset:4608
    ds_read_b64_tr_b16 a[68:69], v7 offset:32
    ds_read_b64_tr_b16 a[70:71], v7 offset:4640
    ds_read_b64_tr_b16 a[72:73], v7 offset:9216
    ds_read_b64_tr_b16 a[74:75], v7 offset:13824
    ds_read_b64_tr_b16 a[76:77], v7 offset:9248
    ds_read_b64_tr_b16 a[78:79], v7 offset:13856
    s_waitcnt vmcnt(16)
    ds_write_b128 v6, a[80:83] offset:18432
    ds_write_b128 v6, a[84:87] offset:23040
    ds_write_b128 v6, a[88:91] offset:27648
    ds_write_b128 v6, a[92:95] offset:32256
    s_waitcnt lgkmcnt(0)
    s_barrier
    ds_read_b64_tr_b16 a[80:81], v7 offset:18432
    ds_read_b64_tr_b16 a[82:83], v7 offset:23040
    ds_read_b64_tr_b16 a[84:85], v7 offset:18464
    ds_read_b64_tr_b16 a[86:87], v7 offset:23072
    ds_read_b64_tr_b16 a[88:89], v7 offset:27648
    ds_read_b64_tr_b16 a[90:91], v7 offset:32256
    ds_read_b64_tr_b16 a[92:93], v7 offset:27680
    ds_read_b64_tr_b16 a[94:95], v7 offset:32288
    s_waitcnt vmcnt(12)
    ds_write_b128 v6, a[96:99] offset:0
    ds_write_b128 v6, a[100:103] offset:4608
    ds_write_b128 v6, a[104:107] offset:9216
    ds_write_b128 v6, a[108:111] offset:13824
    s_waitcnt lgkmcnt(0)
    s_barrier
    ds_read_b64_tr_b16 a[96:97], v7 offset:0
    ds_read_b64_tr_b16 a[98:99], v7 offset:4608
    ds_read_b64_tr_b16 a[100:101], v7 offset:32
    ds_read_b64_tr_b16 a[102:103], v7 offset:4640
    ds_read_b64_tr_b16 a[104:105], v7 offset:9216
    ds_read_b64_tr_b16 a[106:107], v7 offset:13824
    ds_read_b64_tr_b16 a[108:109], v7 offset:9248
    ds_read_b64_tr_b16 a[110:111], v7 offset:13856
    s_waitcnt vmcnt(8)
    ds_write_b128 v6, a[112:115] offset:18432
    ds_write_b128 v6, a[116:119] offset:23040
    ds_write_b128 v6, a[120:123] offset:27648
    ds_write_b128 v6, a[124:127] offset:32256
    s_waitcnt lgkmcnt(0)
    s_barrier
    ds_read_b64_tr_b16 a[112:113], v7 offset:18432
    ds_read_b64_tr_b16 a[114:115], v7 offset:23040
    ds_read_b64_tr_b16 a[116:117], v7 offset:18464
    ds_read_b64_tr_b16 a[118:119], v7 offset:23072
    ds_read_b64_tr_b16 a[120:121], v7 offset:27648
    ds_read_b64_tr_b16 a[122:123], v7 offset:32256
    ds_read_b64_tr_b16 a[124:125], v7 offset:27680
    ds_read_b64_tr_b16 a[126:127], v7 offset:32288
    s_waitcnt vmcnt(4)
    ds_write_b128 v6, a[128:131] offset:0
    ds_write_b128 v6, a[132:135] offset:4608
    ds_write_b128 v6, a[136:139] offset:9216
    ds_write_b128 v6, a[140:143] offset:13824
    s_waitcnt lgkmcnt(0)
    s_barrier
    ds_read_b64_tr_b16 a[128:129], v7 offset:0
    ds_read_b64_tr_b16 a[130:131], v7 offset:4608
    ds_read_b64_tr_b16 a[132:133], v7 offset:32
    ds_read_b64_tr_b16 a[134:135], v7 offset:4640
    ds_read_b64_tr_b16 a[136:137], v7 offset:9216
    ds_read_b64_tr_b16 a[138:139], v7 offset:13824
    ds_read_b64_tr_b16 a[140:141], v7 offset:9248
    ds_read_b64_tr_b16 a[142:143], v7 offset:13856
    s_waitcnt vmcnt(0)
    ds_write_b128 v6, a[144:147] offset:18432
    ds_write_b128 v6, a[148:151] offset:23040
    ds_write_b128 v6, a[152:155] offset:27648
    ds_write_b128 v6, a[156:159] offset:32256
    s_waitcnt lgkmcnt(0)
    s_barrier
    ds_read_b64_tr_b16 a[144:145], v7 offset:18432
    ds_read_b64_tr_b16 a[146:147], v7 offset:23040
    ds_read_b64_tr_b16 a[148:149], v7 offset:18464
    ds_read_b64_tr_b16 a[150:151], v7 offset:23072
    ds_read_b64_tr_b16 a[152:153], v7 offset:27648
    ds_read_b64_tr_b16 a[154:155], v7 offset:32256
    ds_read_b64_tr_b16 a[156:157], v7 offset:27680
    ds_read_b64_tr_b16 a[158:159], v7 offset:32288
    s_waitcnt lgkmcnt(0)
    s_load_dwordx2 s[6:7], s[0:1], 0
    s_waitcnt lgkmcnt(0)
    s_mov_b32 s16, s6
    s_mov_b32 s17, s7
    s_mov_b32 s18, 2621440
    s_mov_b32 s19, 0x00020000
    s_mov_b32 s46, 64
    s_mov_b32 s47, 32
    s_mov_b32 s50, 0
    s_mov_b32 s58, 0
    s_mov_b32 s76, 16
    s_mov_b32 s77, 163840
interleave_layers__linear_attn_block__memory_aug_recurrent_mem_tr__prompt_kernel_k3_entry:
    v_lshlrev_b32 v5, 4, v1
    s_mul_i32 s24, s3, 5120
    s_add_u32 s24, s24, 12582912
    v_add_u32 v8, s24, v5
    v_lshlrev_b32 v9, 3, v1
    s_add_u32 s24, s24, 2048
    v_add_u32 v9, s24, v9
    s_cmp_eq_u32 s50, 1
    s_cselect_b32 s25, 16, 1280
    s_cselect_b32 s26, 256, 8
    v_mul_u32_u24 v10, s25, v2
    v_mul_u32_u24 v11, s26, v3
    s_lshl_b32 s24, s56, 2
    s_add_u32 s24, s24, s3
    s_mul_i32 s25, s24, s46
    v_add3_u32 v10, v10, v11, s25
    v_add_u32 v11, s47, v10
    s_lshl_b32 s24, s24, 10
    s_add_u32 s24, s24, s58
    v_add_u32 v12, s24, v5
    s_mul_i32 s24, s3, 5120
    s_add_u32 s24, s24, 0
    v_add_u32 v13, s24, v5
    s_mov_b32 s54, 0x358637bd
    s_mul_i32 s43, s57, 40960
    s_mov_b32 s40, 0
    s_mov_b32 s42, 0
    s_cmp_eq_u32 s92, 0
    s_cselect_b32 s26, 32, 0
    s_cselect_b32 s27, 7, 1
    s_lshl_b32 s24, s92, 10
    s_add_u32 s24, s24, 23101440
    v_and_b32 v15, 7, v1
    v_lshlrev_b32 v15, 7, v15
    v_lshrrev_b32 v14, 3, v1
    v_and_b32 v14, s27, v14
    v_lshl_add_u32 v15, v14, 2, v15
    v_add_u32 v15, s24, v15
    s_lshl_b32 s27, s26, 1
    s_add_u32 s28, s27, s26
    s_mov_b32 s61, 0
interleave_layers__linear_attn_block__memory_aug_recurrent_mem_tr__prompt_kernel_k3_w0:
    buffer_load_dword v16, v15, s[8:11], 0 offen sc1
    buffer_load_dword v17, v15, s[8:11], s26 offen sc1
    buffer_load_dword v18, v15, s[8:11], s27 offen sc1
    buffer_load_dword v19, v15, s[8:11], s28 offen sc1
    s_waitcnt vmcnt(0)
    v_min_i32 v16, v16, v17
    v_min3_i32 v16, v16, v18, v19
    v_cmp_le_i32 vcc, 1, v16
    s_cmp_eq_u64 vcc, -1
    s_cbranch_scc1 interleave_layers__linear_attn_block__memory_aug_recurrent_mem_tr__prompt_kernel_k3_w0_ok
    s_add_u32 s61, s61, 1
    s_cmp_ge_u32 s61, s60
    s_cbranch_scc1 interleave_layers__linear_attn_block__memory_aug_recurrent_mem_tr__prompt_kernel_k3_w0_to
    s_sleep 4
    s_branch interleave_layers__linear_attn_block__memory_aug_recurrent_mem_tr__prompt_kernel_k3_w0
interleave_layers__linear_attn_block__memory_aug_recurrent_mem_tr__prompt_kernel_k3_w0_to:
    s_mov_b32 s60, 1
interleave_layers__linear_attn_block__memory_aug_recurrent_mem_tr__prompt_kernel_k3_w0_ok:
    s_mov_b32 s41, s43
    s_add_u32 s25, s41, 20480
    buffer_load_dwordx4 v[16:19], v8, s[8:11], s41 offen offset:0 sc1
    buffer_load_dwordx4 v[20:23], v8, s[8:11], s41 offen offset:1024 sc1
    buffer_load_dwordx2 v[24:25], v9, s[8:11], s41 offen offset:0 sc1
    buffer_load_dwordx4 v[26:29], v8, s[8:11], s41 offen offset:2560 sc1
    buffer_load_dwordx4 v[30:33], v8, s[8:11], s41 offen offset:3584 sc1
    buffer_load_dwordx2 v[34:35], v9, s[8:11], s41 offen offset:2560 sc1
    buffer_load_dwordx4 v[36:39], v8, s[8:11], s25 offen offset:0 sc1
    buffer_load_dwordx4 v[40:43], v8, s[8:11], s25 offen offset:1024 sc1
    buffer_load_dwordx2 v[44:45], v9, s[8:11], s25 offen offset:0 sc1
    buffer_load_dwordx4 v[46:49], v8, s[8:11], s25 offen offset:2560 sc1
    buffer_load_dwordx4 v[50:53], v8, s[8:11], s25 offen offset:3584 sc1
    buffer_load_dwordx2 v[54:55], v9, s[8:11], s25 offen offset:2560 sc1
    buffer_load_dwordx2 v[96:97], v10, s[16:19], s41 offen sc1
    buffer_load_dwordx2 v[98:99], v11, s[16:19], s41 offen sc1
    buffer_load_dwordx2 v[100:101], v10, s[16:19], s25 offen sc1
    buffer_load_dwordx2 v[102:103], v11, s[16:19], s25 offen sc1
    s_add_u32 s41, s43, s77
    s_add_u32 s25, s41, 20480
    buffer_load_dwordx4 v[56:59], v8, s[8:11], s41 offen offset:0 sc1
    buffer_load_dwordx4 v[60:63], v8, s[8:11], s41 offen offset:1024 sc1
    buffer_load_dwordx2 v[64:65], v9, s[8:11], s41 offen offset:0 sc1
    buffer_load_dwordx4 v[66:69], v8, s[8:11], s41 offen offset:2560 sc1
    buffer_load_dwordx4 v[70:73], v8, s[8:11], s41 offen offset:3584 sc1
    buffer_load_dwordx2 v[74:75], v9, s[8:11], s41 offen offset:2560 sc1
    buffer_load_dwordx4 v[76:79], v8, s[8:11], s25 offen offset:0 sc1
    buffer_load_dwordx4 v[80:83], v8, s[8:11], s25 offen offset:1024 sc1
    buffer_load_dwordx2 v[84:85], v9, s[8:11], s25 offen offset:0 sc1
    buffer_load_dwordx4 v[86:89], v8, s[8:11], s25 offen offset:2560 sc1
    buffer_load_dwordx4 v[90:93], v8, s[8:11], s25 offen offset:3584 sc1
    buffer_load_dwordx2 v[94:95], v9, s[8:11], s25 offen offset:2560 sc1
    buffer_load_dwordx2 v[104:105], v10, s[16:19], s41 offen sc1
    buffer_load_dwordx2 v[106:107], v11, s[16:19], s41 offen sc1
    buffer_load_dwordx2 v[108:109], v10, s[16:19], s25 offen sc1
    buffer_load_dwordx2 v[110:111], v11, s[16:19], s25 offen sc1
    s_lshl_b32 s24, s92, 7
    s_add_u32 s24, s24, 23103488
    v_lshlrev_b32 v15, 2, v1
    v_add_u32 v15, s24, v15
    s_mov_b32 s61, 0
interleave_layers__linear_attn_block__memory_aug_recurrent_mem_tr__prompt_kernel_k3_w:
    buffer_load_dword v14, v15, s[8:11], 0 offen sc1
    s_waitcnt vmcnt(0)
    v_cmp_le_i32 vcc, 1, v14
    s_mov_b32 s25, 0xffffff
    s_and_b32 s24, vcc_lo, s25
    s_cmp_eq_u32 s24, s25
    s_cbranch_scc1 interleave_layers__linear_attn_block__memory_aug_recurrent_mem_tr__prompt_kernel_k3_w_ok
    s_add_u32 s61, s61, 1
    s_cmp_ge_u32 s61, s60
    s_cbranch_scc1 interleave_layers__linear_attn_block__memory_aug_recurrent_mem_tr__prompt_kernel_k3_w_to
    s_sleep 2
    s_branch interleave_layers__linear_attn_block__memory_aug_recurrent_mem_tr__prompt_kernel_k3_w
interleave_layers__linear_attn_block__memory_aug_recurrent_mem_tr__prompt_kernel_k3_w_to:
    s_mov_b32 s60, 1
interleave_layers__linear_attn_block__memory_aug_recurrent_mem_tr__prompt_kernel_k3_w_ok:
    s_mul_i32 s24, s92, 131072
    s_mul_i32 s25, s3, 28672
    s_add_u32 s24, s24, s25
    s_add_u32 s24, s24, 22020096
    s_add_u32 s25, s24, 0
    buffer_load_dwordx4 a[160:163], v5, s[8:11], s25 offen sc1
    s_add_u32 s25, s24, 1024
    buffer_load_dwordx4 a[164:167], v5, s[8:11], s25 offen sc1
    s_add_u32 s25, s24, 2048
    buffer_load_dwordx4 a[168:171], v5, s[8:11], s25 offen sc1
    s_add_u32 s25, s24, 3072
    buffer_load_dwordx4 a[172:175], v5, s[8:11], s25 offen sc1
    s_add_u32 s25, s24, 4096
    buffer_load_dwordx4 a[176:179], v5, s[8:11], s25 offen sc1
    s_add_u32 s25, s24, 5120
    buffer_load_dwordx4 a[180:183], v5, s[8:11], s25 offen sc1
    s_add_u32 s25, s24, 6144
    buffer_load_dwordx2 a[184:185], v5, s[8:11], s25 offen sc1
    s_add_u32 s25, s24, 7168
    buffer_load_dwordx4 a[186:189], v5, s[8:11], s25 offen sc1
    s_add_u32 s25, s24, 8192
    buffer_load_dwordx2 a[190:191], v5, s[8:11], s25 offen sc1
    s_add_u32 s25, s24, 9216
    buffer_load_dwordx4 a[192:195], v5, s[8:11], s25 offen sc1
    s_add_u32 s25, s24, 10240
    buffer_load_dwordx4 a[196:199], v5, s[8:11], s25 offen sc1
    s_add_u32 s25, s24, 11264
    buffer_load_dwordx2 a[200:201], v5, s[8:11], s25 offen sc1
    s_add_u32 s25, s24, 12288
    buffer_load_dwordx4 a[202:205], v5, s[8:11], s25 offen sc1
    s_add_u32 s25, s24, 13312
    buffer_load_dwordx2 a[206:207], v5, s[8:11], s25 offen sc1
    s_add_u32 s25, s24, 14336
    buffer_load_dwordx4 a[208:211], v5, s[8:11], s25 offen sc1
    s_add_u32 s25, s24, 15360
    buffer_load_dwordx4 a[212:215], v5, s[8:11], s25 offen sc1
    s_add_u32 s25, s24, 16384
    buffer_load_dwordx4 a[216:219], v5, s[8:11], s25 offen sc1
    s_add_u32 s25, s24, 17408
    buffer_load_dwordx4 a[220:223], v5, s[8:11], s25 offen sc1
    s_add_u32 s25, s24, 18432
    buffer_load_dwordx4 a[224:227], v5, s[8:11], s25 offen sc1
    s_add_u32 s25, s24, 19456
    buffer_load_dwordx4 a[228:231], v5, s[8:11], s25 offen sc1
    s_add_u32 s25, s24, 20480
    buffer_load_dwordx2 a[232:233], v5, s[8:11], s25 offen sc1
    s_add_u32 s25, s24, 21504
    buffer_load_dwordx4 a[234:237], v5, s[8:11], s25 offen sc1
    s_add_u32 s25, s24, 22528
    buffer_load_dwordx2 a[238:239], v5, s[8:11], s25 offen sc1
    s_add_u32 s25, s24, 23552
    buffer_load_dwordx4 a[240:243], v5, s[8:11], s25 offen sc1
    s_add_u32 s25, s24, 24576
    buffer_load_dwordx4 a[244:247], v5, s[8:11], s25 offen sc1
    s_add_u32 s25, s24, 25600
    buffer_load_dwordx2 a[248:249], v5, s[8:11], s25 offen sc1
    s_add_u32 s25, s24, 26624
    buffer_load_dwordx4 a[250:253], v5, s[8:11], s25 offen sc1
    s_add_u32 s25, s24, 27648
    buffer_load_dwordx2 a[254:255], v5, s[8:11], s25 offen sc1
    s_waitcnt vmcnt(0)
    v_mfma_f32_16x16x32_bf16 v[132:135], a[192:195], v[16:19], 0
    v_mfma_f32_16x16x32_bf16 v[136:139], a[202:205], v[20:23], 0
    v_mfma_f32_16x16x32_bf16 v[112:115], a[160:163], v[16:19], 0
    v_mfma_f32_16x16x32_bf16 v[116:119], a[164:167], v[16:19], 0
    v_mfma_f32_16x16x32_bf16 v[120:123], a[172:175], v[16:19], 0
    v_mfma_f32_16x16x32_bf16 v[124:127], a[180:183], v[20:23], 0
    v_mfma_f32_16x16x32_bf16 v[128:131], a[186:189], v[20:23], 0
    v_mfma_f32_16x16x32_bf16 v[132:135], a[196:199], v[20:23], v[132:135]
    v_mfma_f32_16x16x32_bf16 v[116:119], a[168:171], v[20:23], v[116:119]
    v_mfma_f32_16x16x32_bf16 v[120:123], a[176:179], v[20:23], v[120:123]
    v_mfma_f32_16x16x16_bf16 v[136:139], a[206:207], v[24:25], v[136:139]
    s_nop 0
    v_mfma_f32_16x16x16_bf16 v[124:127], a[184:185], v[24:25], v[124:127]
    v_mfma_f32_16x16x16_bf16 v[128:131], a[190:191], v[24:25], v[128:131]
    v_mfma_f32_16x16x16_bf16 v[132:135], a[200:201], v[24:25], v[132:135]
    v_mfma_f32_16x16x32_bf16 v[160:163], a[240:243], v[26:29], 0
    v_mfma_f32_16x16x32_bf16 v[164:167], a[250:253], v[30:33], 0
    v_mfma_f32_16x16x32_bf16 v[140:143], a[208:211], v[26:29], 0
    v_mfma_f32_16x16x32_bf16 v[144:147], a[212:215], v[26:29], 0
    v_mfma_f32_16x16x32_bf16 v[148:151], a[220:223], v[26:29], 0
    v_mfma_f32_16x16x32_bf16 v[152:155], a[228:231], v[30:33], 0
    v_mfma_f32_16x16x32_bf16 v[156:159], a[234:237], v[30:33], 0
    v_mfma_f32_16x16x32_bf16 v[160:163], a[244:247], v[30:33], v[160:163]
    v_mfma_f32_16x16x32_bf16 v[144:147], a[216:219], v[30:33], v[144:147]
    v_mfma_f32_16x16x32_bf16 v[148:151], a[224:227], v[30:33], v[148:151]
    v_mfma_f32_16x16x16_bf16 v[164:167], a[254:255], v[34:35], v[164:167]
    s_nop 0
    v_mfma_f32_16x16x16_bf16 v[152:155], a[232:233], v[34:35], v[152:155]
    v_mfma_f32_16x16x16_bf16 v[156:159], a[238:239], v[34:35], v[156:159]
    v_mfma_f32_16x16x16_bf16 v[160:163], a[248:249], v[34:35], v[160:163]
    v_add_f32 v132, s54, v132
    v_add_f32 v133, s54, v133
    v_add_f32 v134, s54, v134
    v_add_f32 v135, s54, v135
    v_add_f32 v136, s54, v136
    v_rcp_f32 v132, v132
    v_rcp_f32 v133, v133
    v_rcp_f32 v134, v134
    v_rcp_f32 v135, v135
    v_rcp_f32 v136, v136
    v_mul_f32 v112, v112, v132
    v_mul_f32 v113, v113, v132
    v_mul_f32 v114, v114, v132
    v_mul_f32 v115, v115, v132
    v_cvt_pk_bf16_f32 v168, v112, v113
    v_cvt_pk_bf16_f32 v169, v114, v115
    v_mul_f32 v116, v116, v133
    v_mul_f32 v117, v117, v133
    v_mul_f32 v118, v118, v133
    v_mul_f32 v119, v119, v133
    v_cvt_pk_bf16_f32 v170, v116, v117
    v_cvt_pk_bf16_f32 v171, v118, v119
    v_mul_f32 v120, v120, v134
    v_mul_f32 v121, v121, v134
    v_mul_f32 v122, v122, v134
    v_mul_f32 v123, v123, v134
    v_cvt_pk_bf16_f32 v172, v120, v121
    v_cvt_pk_bf16_f32 v173, v122, v123
    v_mul_f32 v124, v124, v135
    v_mul_f32 v125, v125, v135
    v_mul_f32 v126, v126, v135
    v_mul_f32 v127, v127, v135
    v_cvt_pk_bf16_f32 v174, v124, v125
    v_cvt_pk_bf16_f32 v175, v126, v127
    v_mul_f32 v128, v128, v136
    v_mul_f32 v129, v129, v136
    v_mul_f32 v130, v130, v136
    v_mul_f32 v131, v131, v136
    v_cvt_pk_bf16_f32 v176, v128, v129
    v_cvt_pk_bf16_f32 v177, v130, v131
    v_add_f32 v160, s54, v160
    v_add_f32 v161, s54, v161
    v_add_f32 v162, s54, v162
    v_add_f32 v163, s54, v163
    v_add_f32 v164, s54, v164
    v_rcp_f32 v160, v160
    v_rcp_f32 v161, v161
    v_rcp_f32 v162, v162
    v_rcp_f32 v163, v163
    v_rcp_f32 v164, v164
    v_mul_f32 v140, v140, v160
    v_mul_f32 v141, v141, v160
    v_mul_f32 v142, v142, v160
    v_mul_f32 v143, v143, v160
    v_cvt_pk_bf16_f32 v178, v140, v141
    v_cvt_pk_bf16_f32 v179, v142, v143
    v_mul_f32 v144, v144, v161
    v_mul_f32 v145, v145, v161
    v_mul_f32 v146, v146, v161
    v_mul_f32 v147, v147, v161
    v_cvt_pk_bf16_f32 v180, v144, v145
    v_cvt_pk_bf16_f32 v181, v146, v147
    v_mul_f32 v148, v148, v162
    v_mul_f32 v149, v149, v162
    v_mul_f32 v150, v150, v162
    v_mul_f32 v151, v151, v162
    v_cvt_pk_bf16_f32 v182, v148, v149
    v_cvt_pk_bf16_f32 v183, v150, v151
    v_mul_f32 v152, v152, v163
    v_mul_f32 v153, v153, v163
    v_mul_f32 v154, v154, v163
    v_mul_f32 v155, v155, v163
    v_cvt_pk_bf16_f32 v184, v152, v153
    v_cvt_pk_bf16_f32 v185, v154, v155
    v_mul_f32 v156, v156, v164
    v_mul_f32 v157, v157, v164
    v_mul_f32 v158, v158, v164
    v_mul_f32 v159, v159, v164
    v_cvt_pk_bf16_f32 v186, v156, v157
    v_cvt_pk_bf16_f32 v187, v158, v159
    v_mfma_f32_16x16x32_bf16 v[132:135], a[192:195], v[36:39], 0
    v_mfma_f32_16x16x32_bf16 v[136:139], a[202:205], v[40:43], 0
    v_mfma_f32_16x16x32_bf16 v[112:115], a[160:163], v[36:39], 0
    v_mfma_f32_16x16x32_bf16 v[116:119], a[164:167], v[36:39], 0
    v_mfma_f32_16x16x32_bf16 v[120:123], a[172:175], v[36:39], 0
    v_mfma_f32_16x16x32_bf16 v[124:127], a[180:183], v[40:43], 0
    v_mfma_f32_16x16x32_bf16 v[128:131], a[186:189], v[40:43], 0
    v_mfma_f32_16x16x32_bf16 v[132:135], a[196:199], v[40:43], v[132:135]
    v_mfma_f32_16x16x32_bf16 v[116:119], a[168:171], v[40:43], v[116:119]
    v_mfma_f32_16x16x32_bf16 v[120:123], a[176:179], v[40:43], v[120:123]
    v_mfma_f32_16x16x16_bf16 v[136:139], a[206:207], v[44:45], v[136:139]
    s_nop 0
    v_mfma_f32_16x16x16_bf16 v[124:127], a[184:185], v[44:45], v[124:127]
    v_mfma_f32_16x16x16_bf16 v[128:131], a[190:191], v[44:45], v[128:131]
    v_mfma_f32_16x16x16_bf16 v[132:135], a[200:201], v[44:45], v[132:135]
    v_mfma_f32_16x16x32_bf16 v[160:163], a[240:243], v[46:49], 0
    v_mfma_f32_16x16x32_bf16 v[164:167], a[250:253], v[50:53], 0
    v_mfma_f32_16x16x32_bf16 v[140:143], a[208:211], v[46:49], 0
    v_mfma_f32_16x16x32_bf16 v[144:147], a[212:215], v[46:49], 0
    v_mfma_f32_16x16x32_bf16 v[148:151], a[220:223], v[46:49], 0
    v_mfma_f32_16x16x32_bf16 v[152:155], a[228:231], v[50:53], 0
    v_mfma_f32_16x16x32_bf16 v[156:159], a[234:237], v[50:53], 0
    v_mfma_f32_16x16x32_bf16 v[160:163], a[244:247], v[50:53], v[160:163]
    v_mfma_f32_16x16x32_bf16 v[144:147], a[216:219], v[50:53], v[144:147]
    v_mfma_f32_16x16x32_bf16 v[148:151], a[224:227], v[50:53], v[148:151]
    v_mfma_f32_16x16x16_bf16 v[164:167], a[254:255], v[54:55], v[164:167]
    s_nop 0
    v_mfma_f32_16x16x16_bf16 v[152:155], a[232:233], v[54:55], v[152:155]
    v_mfma_f32_16x16x16_bf16 v[156:159], a[238:239], v[54:55], v[156:159]
    v_mfma_f32_16x16x16_bf16 v[160:163], a[248:249], v[54:55], v[160:163]
    v_add_f32 v132, s54, v132
    v_add_f32 v133, s54, v133
    v_add_f32 v134, s54, v134
    v_add_f32 v135, s54, v135
    v_add_f32 v136, s54, v136
    v_rcp_f32 v132, v132
    v_rcp_f32 v133, v133
    v_rcp_f32 v134, v134
    v_rcp_f32 v135, v135
    v_rcp_f32 v136, v136
    v_mul_f32 v112, v112, v132
    v_mul_f32 v113, v113, v132
    v_mul_f32 v114, v114, v132
    v_mul_f32 v115, v115, v132
    v_cvt_pk_bf16_f32 v188, v112, v113
    v_cvt_pk_bf16_f32 v189, v114, v115
    v_mul_f32 v116, v116, v133
    v_mul_f32 v117, v117, v133
    v_mul_f32 v118, v118, v133
    v_mul_f32 v119, v119, v133
    v_cvt_pk_bf16_f32 v190, v116, v117
    v_cvt_pk_bf16_f32 v191, v118, v119
    v_mul_f32 v120, v120, v134
    v_mul_f32 v121, v121, v134
    v_mul_f32 v122, v122, v134
    v_mul_f32 v123, v123, v134
    v_cvt_pk_bf16_f32 v192, v120, v121
    v_cvt_pk_bf16_f32 v193, v122, v123
    v_mul_f32 v124, v124, v135
    v_mul_f32 v125, v125, v135
    v_mul_f32 v126, v126, v135
    v_mul_f32 v127, v127, v135
    v_cvt_pk_bf16_f32 v194, v124, v125
    v_cvt_pk_bf16_f32 v195, v126, v127
    v_mul_f32 v128, v128, v136
    v_mul_f32 v129, v129, v136
    v_mul_f32 v130, v130, v136
    v_mul_f32 v131, v131, v136
    v_cvt_pk_bf16_f32 v196, v128, v129
    v_cvt_pk_bf16_f32 v197, v130, v131
    v_add_f32 v160, s54, v160
    v_add_f32 v161, s54, v161
    v_add_f32 v162, s54, v162
    v_add_f32 v163, s54, v163
    v_add_f32 v164, s54, v164
    v_rcp_f32 v160, v160
    v_rcp_f32 v161, v161
    v_rcp_f32 v162, v162
    v_rcp_f32 v163, v163
    v_rcp_f32 v164, v164
    v_mul_f32 v140, v140, v160
    v_mul_f32 v141, v141, v160
    v_mul_f32 v142, v142, v160
    v_mul_f32 v143, v143, v160
    v_cvt_pk_bf16_f32 v198, v140, v141
    v_cvt_pk_bf16_f32 v199, v142, v143
    v_mul_f32 v144, v144, v161
    v_mul_f32 v145, v145, v161
    v_mul_f32 v146, v146, v161
    v_mul_f32 v147, v147, v161
    v_cvt_pk_bf16_f32 v200, v144, v145
    v_cvt_pk_bf16_f32 v201, v146, v147
    v_mul_f32 v148, v148, v162
    v_mul_f32 v149, v149, v162
    v_mul_f32 v150, v150, v162
    v_mul_f32 v151, v151, v162
    v_cvt_pk_bf16_f32 v202, v148, v149
    v_cvt_pk_bf16_f32 v203, v150, v151
    v_mul_f32 v152, v152, v163
    v_mul_f32 v153, v153, v163
    v_mul_f32 v154, v154, v163
    v_mul_f32 v155, v155, v163
    v_cvt_pk_bf16_f32 v204, v152, v153
    v_cvt_pk_bf16_f32 v205, v154, v155
    v_mul_f32 v156, v156, v164
    v_mul_f32 v157, v157, v164
    v_mul_f32 v158, v158, v164
    v_mul_f32 v159, v159, v164
    v_cvt_pk_bf16_f32 v206, v156, v157
    v_cvt_pk_bf16_f32 v207, v158, v159
    v_add_u32 v14, s42, v13
    ds_write_b128 v14, v[168:171] offset:0
    ds_write_b128 v14, v[172:175] offset:1024
    ds_write_b128 v14, v[176:179] offset:2048
    ds_write_b128 v14, v[180:183] offset:3072
    ds_write_b128 v14, v[184:187] offset:4096
    ds_write_b128 v14, v[188:191] offset:20480
    ds_write_b128 v14, v[192:195] offset:21504
    ds_write_b128 v14, v[196:199] offset:22528
    ds_write_b128 v14, v[200:203] offset:23552
    ds_write_b128 v14, v[204:207] offset:24576
    s_waitcnt lgkmcnt(0)
    s_barrier
interleave_layers__linear_attn_block__memory_aug_recurrent_mem_tr__prompt_kernel_k3_seg:
    v_add_u32 v15, s42, v5
    ds_read_b128 v[208:211], v15 offset:0
    ds_read_b128 v[212:215], v15 offset:20480
    ds_read_b128 v[216:219], v15 offset:1024
    ds_read_b128 v[220:223], v15 offset:21504
    ds_read_b128 v[224:227], v15 offset:2048
    ds_read_b128 v[228:231], v15 offset:22528
    ds_read_b128 v[232:235], v15 offset:3072
    ds_read_b128 v[236:239], v15 offset:23552
    s_waitcnt lgkmcnt(6)
    v_mfma_f32_16x16x32_bf16 v[240:243], a[0:3], v[208:211], 0
    v_mfma_f32_16x16x32_bf16 v[244:247], a[4:7], v[208:211], 0
    v_mfma_f32_16x16x32_bf16 v[248:251], a[0:3], v[212:215], 0
    v_mfma_f32_16x16x32_bf16 v[252:255], a[4:7], v[212:215], 0
    ds_read_b128 v[208:211], v15 offset:4096
    ds_read_b128 v[212:215], v15 offset:24576
    s_waitcnt lgkmcnt(6)
    v_mfma_f32_16x16x32_bf16 v[240:243], a[8:11], v[216:219], v[240:243]
    v_mfma_f32_16x16x32_bf16 v[244:247], a[12:15], v[216:219], v[244:247]
    v_mfma_f32_16x16x32_bf16 v[248:251], a[8:11], v[220:223], v[248:251]
    v_mfma_f32_16x16x32_bf16 v[252:255], a[12:15], v[220:223], v[252:255]
    ds_read_b128 v[216:219], v15 offset:5120
    ds_read_b128 v[220:223], v15 offset:25600
    s_waitcnt lgkmcnt(6)
    v_mfma_f32_16x16x32_bf16 v[240:243], a[16:19], v[224:227], v[240:243]
    v_mfma_f32_16x16x32_bf16 v[244:247], a[20:23], v[224:227], v[244:247]
    v_mfma_f32_16x16x32_bf16 v[248:251], a[16:19], v[228:231], v[248:251]
    v_mfma_f32_16x16x32_bf16 v[252:255], a[20:23], v[228:231], v[252:255]
    ds_read_b128 v[224:227], v15 offset:6144
    ds_read_b128 v[228:231], v15 offset:26624
    s_waitcnt lgkmcnt(6)
    v_mfma_f32_16x16x32_bf16 v[240:243], a[24:27], v[232:235], v[240:243]
    v_mfma_f32_16x16x32_bf16 v[244:247], a[28:31], v[232:235], v[244:247]
    v_mfma_f32_16x16x32_bf16 v[248:251], a[24:27], v[236:239], v[248:251]
    v_mfma_f32_16x16x32_bf16 v[252:255], a[28:31], v[236:239], v[252:255]
    ds_read_b128 v[232:235], v15 offset:7168
    ds_read_b128 v[236:239], v15 offset:27648
    s_waitcnt lgkmcnt(6)
    v_mfma_f32_16x16x32_bf16 v[240:243], a[32:35], v[208:211], v[240:243]
    v_mfma_f32_16x16x32_bf16 v[244:247], a[36:39], v[208:211], v[244:247]
    v_mfma_f32_16x16x32_bf16 v[248:251], a[32:35], v[212:215], v[248:251]
    v_mfma_f32_16x16x32_bf16 v[252:255], a[36:39], v[212:215], v[252:255]
    ds_read_b128 v[208:211], v15 offset:8192
    ds_read_b128 v[212:215], v15 offset:28672
    s_waitcnt lgkmcnt(6)
    v_mfma_f32_16x16x32_bf16 v[240:243], a[40:43], v[216:219], v[240:243]
    v_mfma_f32_16x16x32_bf16 v[244:247], a[44:47], v[216:219], v[244:247]
    v_mfma_f32_16x16x32_bf16 v[248:251], a[40:43], v[220:223], v[248:251]
    v_mfma_f32_16x16x32_bf16 v[252:255], a[44:47], v[220:223], v[252:255]
    ds_read_b128 v[216:219], v15 offset:9216
    ds_read_b128 v[220:223], v15 offset:29696
    s_waitcnt lgkmcnt(6)
    v_mfma_f32_16x16x32_bf16 v[240:243], a[48:51], v[224:227], v[240:243]
    v_mfma_f32_16x16x32_bf16 v[244:247], a[52:55], v[224:227], v[244:247]
    v_mfma_f32_16x16x32_bf16 v[248:251], a[48:51], v[228:231], v[248:251]
    v_mfma_f32_16x16x32_bf16 v[252:255], a[52:55], v[228:231], v[252:255]
    ds_read_b128 v[224:227], v15 offset:10240
    ds_read_b128 v[228:231], v15 offset:30720
    s_waitcnt lgkmcnt(6)
    v_mfma_f32_16x16x32_bf16 v[240:243], a[56:59], v[232:235], v[240:243]
    v_mfma_f32_16x16x32_bf16 v[244:247], a[60:63], v[232:235], v[244:247]
    v_mfma_f32_16x16x32_bf16 v[248:251], a[56:59], v[236:239], v[248:251]
    v_mfma_f32_16x16x32_bf16 v[252:255], a[60:63], v[236:239], v[252:255]
    ds_read_b128 v[232:235], v15 offset:11264
    ds_read_b128 v[236:239], v15 offset:31744
    s_waitcnt lgkmcnt(6)
    v_mfma_f32_16x16x32_bf16 v[240:243], a[64:67], v[208:211], v[240:243]
    v_mfma_f32_16x16x32_bf16 v[244:247], a[68:71], v[208:211], v[244:247]
    v_mfma_f32_16x16x32_bf16 v[248:251], a[64:67], v[212:215], v[248:251]
    v_mfma_f32_16x16x32_bf16 v[252:255], a[68:71], v[212:215], v[252:255]
    ds_read_b128 v[208:211], v15 offset:12288
    ds_read_b128 v[212:215], v15 offset:32768
    s_waitcnt lgkmcnt(6)
    v_mfma_f32_16x16x32_bf16 v[240:243], a[72:75], v[216:219], v[240:243]
    v_mfma_f32_16x16x32_bf16 v[244:247], a[76:79], v[216:219], v[244:247]
    v_mfma_f32_16x16x32_bf16 v[248:251], a[72:75], v[220:223], v[248:251]
    v_mfma_f32_16x16x32_bf16 v[252:255], a[76:79], v[220:223], v[252:255]
    ds_read_b128 v[216:219], v15 offset:13312
    ds_read_b128 v[220:223], v15 offset:33792
    s_waitcnt lgkmcnt(6)
    v_mfma_f32_16x16x32_bf16 v[240:243], a[80:83], v[224:227], v[240:243]
    v_mfma_f32_16x16x32_bf16 v[244:247], a[84:87], v[224:227], v[244:247]
    v_mfma_f32_16x16x32_bf16 v[248:251], a[80:83], v[228:231], v[248:251]
    v_mfma_f32_16x16x32_bf16 v[252:255], a[84:87], v[228:231], v[252:255]
    ds_read_b128 v[224:227], v15 offset:14336
    ds_read_b128 v[228:231], v15 offset:34816
    s_waitcnt lgkmcnt(6)
    v_mfma_f32_16x16x32_bf16 v[240:243], a[88:91], v[232:235], v[240:243]
    v_mfma_f32_16x16x32_bf16 v[244:247], a[92:95], v[232:235], v[244:247]
    v_mfma_f32_16x16x32_bf16 v[248:251], a[88:91], v[236:239], v[248:251]
    v_mfma_f32_16x16x32_bf16 v[252:255], a[92:95], v[236:239], v[252:255]
    ds_read_b128 v[232:235], v15 offset:15360
    ds_read_b128 v[236:239], v15 offset:35840
    s_waitcnt lgkmcnt(6)
    v_mfma_f32_16x16x32_bf16 v[240:243], a[96:99], v[208:211], v[240:243]
    v_mfma_f32_16x16x32_bf16 v[244:247], a[100:103], v[208:211], v[244:247]
    v_mfma_f32_16x16x32_bf16 v[248:251], a[96:99], v[212:215], v[248:251]
    v_mfma_f32_16x16x32_bf16 v[252:255], a[100:103], v[212:215], v[252:255]
    ds_read_b128 v[208:211], v15 offset:16384
    ds_read_b128 v[212:215], v15 offset:36864
    s_waitcnt lgkmcnt(6)
    v_mfma_f32_16x16x32_bf16 v[240:243], a[104:107], v[216:219], v[240:243]
    v_mfma_f32_16x16x32_bf16 v[244:247], a[108:111], v[216:219], v[244:247]
    v_mfma_f32_16x16x32_bf16 v[248:251], a[104:107], v[220:223], v[248:251]
    v_mfma_f32_16x16x32_bf16 v[252:255], a[108:111], v[220:223], v[252:255]
    ds_read_b128 v[216:219], v15 offset:17408
    ds_read_b128 v[220:223], v15 offset:37888
    s_waitcnt lgkmcnt(6)
    v_mfma_f32_16x16x32_bf16 v[240:243], a[112:115], v[224:227], v[240:243]
    v_mfma_f32_16x16x32_bf16 v[244:247], a[116:119], v[224:227], v[244:247]
    v_mfma_f32_16x16x32_bf16 v[248:251], a[112:115], v[228:231], v[248:251]
    v_mfma_f32_16x16x32_bf16 v[252:255], a[116:119], v[228:231], v[252:255]
    ds_read_b128 v[224:227], v15 offset:18432
    ds_read_b128 v[228:231], v15 offset:38912
    s_waitcnt lgkmcnt(6)
    v_mfma_f32_16x16x32_bf16 v[240:243], a[120:123], v[232:235], v[240:243]
    v_mfma_f32_16x16x32_bf16 v[244:247], a[124:127], v[232:235], v[244:247]
    v_mfma_f32_16x16x32_bf16 v[248:251], a[120:123], v[236:239], v[248:251]
    v_mfma_f32_16x16x32_bf16 v[252:255], a[124:127], v[236:239], v[252:255]
    ds_read_b128 v[232:235], v15 offset:19456
    ds_read_b128 v[236:239], v15 offset:39936
    s_waitcnt lgkmcnt(6)
    v_mfma_f32_16x16x32_bf16 v[240:243], a[128:131], v[208:211], v[240:243]
    v_mfma_f32_16x16x32_bf16 v[244:247], a[132:135], v[208:211], v[244:247]
    v_mfma_f32_16x16x32_bf16 v[248:251], a[128:131], v[212:215], v[248:251]
    v_mfma_f32_16x16x32_bf16 v[252:255], a[132:135], v[212:215], v[252:255]
    s_waitcnt lgkmcnt(4)
    v_mfma_f32_16x16x32_bf16 v[240:243], a[136:139], v[216:219], v[240:243]
    v_mfma_f32_16x16x32_bf16 v[244:247], a[140:143], v[216:219], v[244:247]
    v_mfma_f32_16x16x32_bf16 v[248:251], a[136:139], v[220:223], v[248:251]
    v_mfma_f32_16x16x32_bf16 v[252:255], a[140:143], v[220:223], v[252:255]
    s_waitcnt lgkmcnt(2)
    v_mfma_f32_16x16x32_bf16 v[240:243], a[144:147], v[224:227], v[240:243]
    v_mfma_f32_16x16x32_bf16 v[244:247], a[148:151], v[224:227], v[244:247]
    v_mfma_f32_16x16x32_bf16 v[248:251], a[144:147], v[228:231], v[248:251]
    v_mfma_f32_16x16x32_bf16 v[252:255], a[148:151], v[228:231], v[252:255]
    s_waitcnt lgkmcnt(0)
    v_mfma_f32_16x16x32_bf16 v[240:243], a[152:155], v[232:235], v[240:243]
    v_mfma_f32_16x16x32_bf16 v[244:247], a[156:159], v[232:235], v[244:247]
    v_mfma_f32_16x16x32_bf16 v[248:251], a[152:155], v[236:239], v[248:251]
    v_mfma_f32_16x16x32_bf16 v[252:255], a[156:159], v[236:239], v[252:255]
    s_nop 4
    v_cvt_pk_bf16_f32 v208, v240, v241
    v_cvt_pk_bf16_f32 v209, v242, v243
    v_lshlrev_b32 v210, 16, v208
    v_and_b32 v211, 0xffff0000, v208
    v_lshlrev_b32 v212, 16, v96
    v_and_b32 v213, 0xffff0000, v96
    v_pk_add_f32 v[210:211], v[210:211], v[212:213]
    v_cvt_pk_bf16_f32 v216, v210, v211
    v_lshlrev_b32 v210, 16, v209
    v_and_b32 v211, 0xffff0000, v209
    v_lshlrev_b32 v212, 16, v97
    v_and_b32 v213, 0xffff0000, v97
    v_pk_add_f32 v[210:211], v[210:211], v[212:213]
    v_cvt_pk_bf16_f32 v217, v210, v211
    v_cvt_pk_bf16_f32 v208, v244, v245
    v_cvt_pk_bf16_f32 v209, v246, v247
    v_lshlrev_b32 v210, 16, v208
    v_and_b32 v211, 0xffff0000, v208
    v_lshlrev_b32 v212, 16, v98
    v_and_b32 v213, 0xffff0000, v98
    v_pk_add_f32 v[210:211], v[210:211], v[212:213]
    v_cvt_pk_bf16_f32 v218, v210, v211
    v_lshlrev_b32 v210, 16, v209
    v_and_b32 v211, 0xffff0000, v209
    v_lshlrev_b32 v212, 16, v99
    v_and_b32 v213, 0xffff0000, v99
    v_pk_add_f32 v[210:211], v[210:211], v[212:213]
    v_cvt_pk_bf16_f32 v219, v210, v211
    v_cvt_pk_bf16_f32 v208, v248, v249
    v_cvt_pk_bf16_f32 v209, v250, v251
    v_lshlrev_b32 v210, 16, v208
    v_and_b32 v211, 0xffff0000, v208
    v_lshlrev_b32 v212, 16, v100
    v_and_b32 v213, 0xffff0000, v100
    v_pk_add_f32 v[210:211], v[210:211], v[212:213]
    v_cvt_pk_bf16_f32 v220, v210, v211
    v_lshlrev_b32 v210, 16, v209
    v_and_b32 v211, 0xffff0000, v209
    v_lshlrev_b32 v212, 16, v101
    v_and_b32 v213, 0xffff0000, v101
    v_pk_add_f32 v[210:211], v[210:211], v[212:213]
    v_cvt_pk_bf16_f32 v221, v210, v211
    v_cvt_pk_bf16_f32 v208, v252, v253
    v_cvt_pk_bf16_f32 v209, v254, v255
    v_lshlrev_b32 v210, 16, v208
    v_and_b32 v211, 0xffff0000, v208
    v_lshlrev_b32 v212, 16, v102
    v_and_b32 v213, 0xffff0000, v102
    v_pk_add_f32 v[210:211], v[210:211], v[212:213]
    v_cvt_pk_bf16_f32 v222, v210, v211
    v_lshlrev_b32 v210, 16, v209
    v_and_b32 v211, 0xffff0000, v209
    v_lshlrev_b32 v212, 16, v103
    v_and_b32 v213, 0xffff0000, v103
    v_pk_add_f32 v[210:211], v[210:211], v[212:213]
    v_cvt_pk_bf16_f32 v223, v210, v211
    s_add_u32 s25, s43, 20480
    buffer_store_dwordx4 v[216:219], v12, s[8:11], s43 offen sc1
    buffer_store_dwordx4 v[220:223], v12, s[8:11], s25 offen sc1
    s_add_u32 s40, s40, 1
    s_add_u32 s43, s43, s77
    s_cmp_ge_u32 s40, s76
    s_cbranch_scc1 interleave_layers__linear_attn_block__memory_aug_recurrent_mem_tr__prompt_kernel_k3_done
    s_cmp_eq_u32 s40, 1
    s_cbranch_scc0 interleave_layers__linear_attn_block__memory_aug_recurrent_mem_tr__prompt_kernel_k3q10
    s_waitcnt vmcnt(0)
    s_barrier
    s_lshl_b32 s24, s92, 10
    s_lshl_b32 s25, s78, 2
    s_add_u32 s24, s24, s25
    s_add_u32 s24, s24, 23105536
    s_cmp_eq_u32 s3, 0
    s_cbranch_scc0 interleave_layers__linear_attn_block__memory_aug_recurrent_mem_tr__prompt_kernel_pb11
    v_lshlrev_b32 v14, 7, v1
    v_add_u32 v14, s24, v14
    v_mov_b32 v15, 2146435072
    v_cmp_le_u32 vcc, 8, v1
    s_nop 1
    v_cndmask_b32 v14, v14, v15, vcc
    v_mov_b32 v15, s40
    buffer_store_dword v15, v14, s[8:11], 0 offen sc1
interleave_layers__linear_attn_block__memory_aug_recurrent_mem_tr__prompt_kernel_pb11:
interleave_layers__linear_attn_block__memory_aug_recurrent_mem_tr__prompt_kernel_k3q10:
    s_xor_b32 s42, s42, 40960
    s_waitcnt vmcnt(2)
    v_mfma_f32_16x16x32_bf16 v[132:135], a[192:195], v[56:59], 0
    v_mfma_f32_16x16x32_bf16 v[136:139], a[202:205], v[60:63], 0
    v_mfma_f32_16x16x32_bf16 v[112:115], a[160:163], v[56:59], 0
    v_mfma_f32_16x16x32_bf16 v[116:119], a[164:167], v[56:59], 0
    v_mfma_f32_16x16x32_bf16 v[120:123], a[172:175], v[56:59], 0
    v_mfma_f32_16x16x32_bf16 v[124:127], a[180:183], v[60:63], 0
    v_mfma_f32_16x16x32_bf16 v[128:131], a[186:189], v[60:63], 0
    v_mfma_f32_16x16x32_bf16 v[132:135], a[196:199], v[60:63], v[132:135]
    v_mfma_f32_16x16x32_bf16 v[116:119], a[168:171], v[60:63], v[116:119]
    v_mfma_f32_16x16x32_bf16 v[120:123], a[176:179], v[60:63], v[120:123]
    v_mfma_f32_16x16x16_bf16 v[136:139], a[206:207], v[64:65], v[136:139]
    s_nop 0
    v_mfma_f32_16x16x16_bf16 v[124:127], a[184:185], v[64:65], v[124:127]
    v_mfma_f32_16x16x16_bf16 v[128:131], a[190:191], v[64:65], v[128:131]
    v_mfma_f32_16x16x16_bf16 v[132:135], a[200:201], v[64:65], v[132:135]
    v_mfma_f32_16x16x32_bf16 v[160:163], a[240:243], v[66:69], 0
    v_mfma_f32_16x16x32_bf16 v[164:167], a[250:253], v[70:73], 0
    v_mfma_f32_16x16x32_bf16 v[140:143], a[208:211], v[66:69], 0
    v_mfma_f32_16x16x32_bf16 v[144:147], a[212:215], v[66:69], 0
    v_mfma_f32_16x16x32_bf16 v[148:151], a[220:223], v[66:69], 0
    v_mfma_f32_16x16x32_bf16 v[152:155], a[228:231], v[70:73], 0
    v_mfma_f32_16x16x32_bf16 v[156:159], a[234:237], v[70:73], 0
    v_mfma_f32_16x16x32_bf16 v[160:163], a[244:247], v[70:73], v[160:163]
    v_mfma_f32_16x16x32_bf16 v[144:147], a[216:219], v[70:73], v[144:147]
    v_mfma_f32_16x16x32_bf16 v[148:151], a[224:227], v[70:73], v[148:151]
    v_mfma_f32_16x16x16_bf16 v[164:167], a[254:255], v[74:75], v[164:167]
    s_nop 0
    v_mfma_f32_16x16x16_bf16 v[152:155], a[232:233], v[74:75], v[152:155]
    v_mfma_f32_16x16x16_bf16 v[156:159], a[238:239], v[74:75], v[156:159]
    v_mfma_f32_16x16x16_bf16 v[160:163], a[248:249], v[74:75], v[160:163]
    v_add_f32 v132, s54, v132
    v_add_f32 v133, s54, v133
    v_add_f32 v134, s54, v134
    v_add_f32 v135, s54, v135
    v_add_f32 v136, s54, v136
    v_rcp_f32 v132, v132
    v_rcp_f32 v133, v133
    v_rcp_f32 v134, v134
    v_rcp_f32 v135, v135
    v_rcp_f32 v136, v136
    v_mul_f32 v112, v112, v132
    v_mul_f32 v113, v113, v132
    v_mul_f32 v114, v114, v132
    v_mul_f32 v115, v115, v132
    v_cvt_pk_bf16_f32 v168, v112, v113
    v_cvt_pk_bf16_f32 v169, v114, v115
    v_mul_f32 v116, v116, v133
    v_mul_f32 v117, v117, v133
    v_mul_f32 v118, v118, v133
    v_mul_f32 v119, v119, v133
    v_cvt_pk_bf16_f32 v170, v116, v117
    v_cvt_pk_bf16_f32 v171, v118, v119
    v_mul_f32 v120, v120, v134
    v_mul_f32 v121, v121, v134
    v_mul_f32 v122, v122, v134
    v_mul_f32 v123, v123, v134
    v_cvt_pk_bf16_f32 v172, v120, v121
    v_cvt_pk_bf16_f32 v173, v122, v123
    v_mul_f32 v124, v124, v135
    v_mul_f32 v125, v125, v135
    v_mul_f32 v126, v126, v135
    v_mul_f32 v127, v127, v135
    v_cvt_pk_bf16_f32 v174, v124, v125
    v_cvt_pk_bf16_f32 v175, v126, v127
    v_mul_f32 v128, v128, v136
    v_mul_f32 v129, v129, v136
    v_mul_f32 v130, v130, v136
    v_mul_f32 v131, v131, v136
    v_cvt_pk_bf16_f32 v176, v128, v129
    v_cvt_pk_bf16_f32 v177, v130, v131
    v_add_f32 v160, s54, v160
    v_add_f32 v161, s54, v161
    v_add_f32 v162, s54, v162
    v_add_f32 v163, s54, v163
    v_add_f32 v164, s54, v164
    v_rcp_f32 v160, v160
    v_rcp_f32 v161, v161
    v_rcp_f32 v162, v162
    v_rcp_f32 v163, v163
    v_rcp_f32 v164, v164
    v_mul_f32 v140, v140, v160
    v_mul_f32 v141, v141, v160
    v_mul_f32 v142, v142, v160
    v_mul_f32 v143, v143, v160
    v_cvt_pk_bf16_f32 v178, v140, v141
    v_cvt_pk_bf16_f32 v179, v142, v143
    v_mul_f32 v144, v144, v161
    v_mul_f32 v145, v145, v161
    v_mul_f32 v146, v146, v161
    v_mul_f32 v147, v147, v161
    v_cvt_pk_bf16_f32 v180, v144, v145
    v_cvt_pk_bf16_f32 v181, v146, v147
    v_mul_f32 v148, v148, v162
    v_mul_f32 v149, v149, v162
    v_mul_f32 v150, v150, v162
    v_mul_f32 v151, v151, v162
    v_cvt_pk_bf16_f32 v182, v148, v149
    v_cvt_pk_bf16_f32 v183, v150, v151
    v_mul_f32 v152, v152, v163
    v_mul_f32 v153, v153, v163
    v_mul_f32 v154, v154, v163
    v_mul_f32 v155, v155, v163
    v_cvt_pk_bf16_f32 v184, v152, v153
    v_cvt_pk_bf16_f32 v185, v154, v155
    v_mul_f32 v156, v156, v164
    v_mul_f32 v157, v157, v164
    v_mul_f32 v158, v158, v164
    v_mul_f32 v159, v159, v164
    v_cvt_pk_bf16_f32 v186, v156, v157
    v_cvt_pk_bf16_f32 v187, v158, v159
    v_mfma_f32_16x16x32_bf16 v[132:135], a[192:195], v[76:79], 0
    v_mfma_f32_16x16x32_bf16 v[136:139], a[202:205], v[80:83], 0
    v_mfma_f32_16x16x32_bf16 v[112:115], a[160:163], v[76:79], 0
    v_mfma_f32_16x16x32_bf16 v[116:119], a[164:167], v[76:79], 0
    v_mfma_f32_16x16x32_bf16 v[120:123], a[172:175], v[76:79], 0
    v_mfma_f32_16x16x32_bf16 v[124:127], a[180:183], v[80:83], 0
    v_mfma_f32_16x16x32_bf16 v[128:131], a[186:189], v[80:83], 0
    v_mfma_f32_16x16x32_bf16 v[132:135], a[196:199], v[80:83], v[132:135]
    v_mfma_f32_16x16x32_bf16 v[116:119], a[168:171], v[80:83], v[116:119]
    v_mfma_f32_16x16x32_bf16 v[120:123], a[176:179], v[80:83], v[120:123]
    v_mfma_f32_16x16x16_bf16 v[136:139], a[206:207], v[84:85], v[136:139]
    s_nop 0
    v_mfma_f32_16x16x16_bf16 v[124:127], a[184:185], v[84:85], v[124:127]
    v_mfma_f32_16x16x16_bf16 v[128:131], a[190:191], v[84:85], v[128:131]
    v_mfma_f32_16x16x16_bf16 v[132:135], a[200:201], v[84:85], v[132:135]
    v_mfma_f32_16x16x32_bf16 v[160:163], a[240:243], v[86:89], 0
    v_mfma_f32_16x16x32_bf16 v[164:167], a[250:253], v[90:93], 0
    v_mfma_f32_16x16x32_bf16 v[140:143], a[208:211], v[86:89], 0
    v_mfma_f32_16x16x32_bf16 v[144:147], a[212:215], v[86:89], 0
    v_mfma_f32_16x16x32_bf16 v[148:151], a[220:223], v[86:89], 0
    v_mfma_f32_16x16x32_bf16 v[152:155], a[228:231], v[90:93], 0
    v_mfma_f32_16x16x32_bf16 v[156:159], a[234:237], v[90:93], 0
    v_mfma_f32_16x16x32_bf16 v[160:163], a[244:247], v[90:93], v[160:163]
    v_mfma_f32_16x16x32_bf16 v[144:147], a[216:219], v[90:93], v[144:147]
    v_mfma_f32_16x16x32_bf16 v[148:151], a[224:227], v[90:93], v[148:151]
    v_mfma_f32_16x16x16_bf16 v[164:167], a[254:255], v[94:95], v[164:167]
    s_nop 0
    v_mfma_f32_16x16x16_bf16 v[152:155], a[232:233], v[94:95], v[152:155]
    v_mfma_f32_16x16x16_bf16 v[156:159], a[238:239], v[94:95], v[156:159]
    v_mfma_f32_16x16x16_bf16 v[160:163], a[248:249], v[94:95], v[160:163]
    v_add_f32 v132, s54, v132
    v_add_f32 v133, s54, v133
    v_add_f32 v134, s54, v134
    v_add_f32 v135, s54, v135
    v_add_f32 v136, s54, v136
    v_rcp_f32 v132, v132
    v_rcp_f32 v133, v133
    v_rcp_f32 v134, v134
    v_rcp_f32 v135, v135
    v_rcp_f32 v136, v136
    v_mul_f32 v112, v112, v132
    v_mul_f32 v113, v113, v132
    v_mul_f32 v114, v114, v132
    v_mul_f32 v115, v115, v132
    v_cvt_pk_bf16_f32 v188, v112, v113
    v_cvt_pk_bf16_f32 v189, v114, v115
    v_mul_f32 v116, v116, v133
    v_mul_f32 v117, v117, v133
    v_mul_f32 v118, v118, v133
    v_mul_f32 v119, v119, v133
    v_cvt_pk_bf16_f32 v190, v116, v117
    v_cvt_pk_bf16_f32 v191, v118, v119
    v_mul_f32 v120, v120, v134
    v_mul_f32 v121, v121, v134
    v_mul_f32 v122, v122, v134
    v_mul_f32 v123, v123, v134
    v_cvt_pk_bf16_f32 v192, v120, v121
    v_cvt_pk_bf16_f32 v193, v122, v123
    v_mul_f32 v124, v124, v135
    v_mul_f32 v125, v125, v135
    v_mul_f32 v126, v126, v135
    v_mul_f32 v127, v127, v135
    v_cvt_pk_bf16_f32 v194, v124, v125
    v_cvt_pk_bf16_f32 v195, v126, v127
    v_mul_f32 v128, v128, v136
    v_mul_f32 v129, v129, v136
    v_mul_f32 v130, v130, v136
    v_mul_f32 v131, v131, v136
    v_cvt_pk_bf16_f32 v196, v128, v129
    v_cvt_pk_bf16_f32 v197, v130, v131
    v_add_f32 v160, s54, v160
    v_add_f32 v161, s54, v161
    v_add_f32 v162, s54, v162
    v_add_f32 v163, s54, v163
    v_add_f32 v164, s54, v164
    v_rcp_f32 v160, v160
    v_rcp_f32 v161, v161
    v_rcp_f32 v162, v162
    v_rcp_f32 v163, v163
    v_rcp_f32 v164, v164
    v_mul_f32 v140, v140, v160
    v_mul_f32 v141, v141, v160
    v_mul_f32 v142, v142, v160
    v_mul_f32 v143, v143, v160
    v_cvt_pk_bf16_f32 v198, v140, v141
    v_cvt_pk_bf16_f32 v199, v142, v143
    v_mul_f32 v144, v144, v161
    v_mul_f32 v145, v145, v161
    v_mul_f32 v146, v146, v161
    v_mul_f32 v147, v147, v161
    v_cvt_pk_bf16_f32 v200, v144, v145
    v_cvt_pk_bf16_f32 v201, v146, v147
    v_mul_f32 v148, v148, v162
    v_mul_f32 v149, v149, v162
    v_mul_f32 v150, v150, v162
    v_mul_f32 v151, v151, v162
    v_cvt_pk_bf16_f32 v202, v148, v149
    v_cvt_pk_bf16_f32 v203, v150, v151
    v_mul_f32 v152, v152, v163
    v_mul_f32 v153, v153, v163
    v_mul_f32 v154, v154, v163
    v_mul_f32 v155, v155, v163
    v_cvt_pk_bf16_f32 v204, v152, v153
    v_cvt_pk_bf16_f32 v205, v154, v155
    v_mul_f32 v156, v156, v164
    v_mul_f32 v157, v157, v164
    v_mul_f32 v158, v158, v164
    v_mul_f32 v159, v159, v164
    v_cvt_pk_bf16_f32 v206, v156, v157
    v_cvt_pk_bf16_f32 v207, v158, v159
    v_add_u32 v14, s42, v13
    ds_write_b128 v14, v[168:171] offset:0
    ds_write_b128 v14, v[172:175] offset:1024
    ds_write_b128 v14, v[176:179] offset:2048
    ds_write_b128 v14, v[180:183] offset:3072
    ds_write_b128 v14, v[184:187] offset:4096
    ds_write_b128 v14, v[188:191] offset:20480
    ds_write_b128 v14, v[192:195] offset:21504
    ds_write_b128 v14, v[196:199] offset:22528
    ds_write_b128 v14, v[200:203] offset:23552
    ds_write_b128 v14, v[204:207] offset:24576
    s_add_u32 s41, s43, s77
    s_add_u32 s24, s40, 1
    s_cmp_lt_u32 s24, s76
    s_cselect_b32 s41, s41, 2146435072
    s_waitcnt vmcnt(0)
    s_add_u32 s25, s41, 20480
    buffer_load_dwordx4 v[16:19], v8, s[8:11], s41 offen offset:0 sc1
    buffer_load_dwordx4 v[20:23], v8, s[8:11], s41 offen offset:1024 sc1
    buffer_load_dwordx2 v[24:25], v9, s[8:11], s41 offen offset:0 sc1
    buffer_load_dwordx4 v[26:29], v8, s[8:11], s41 offen offset:2560 sc1
    buffer_load_dwordx4 v[30:33], v8, s[8:11], s41 offen offset:3584 sc1
    buffer_load_dwordx2 v[34:35], v9, s[8:11], s41 offen offset:2560 sc1
    buffer_load_dwordx4 v[36:39], v8, s[8:11], s25 offen offset:0 sc1
    buffer_load_dwordx4 v[40:43], v8, s[8:11], s25 offen offset:1024 sc1
    buffer_load_dwordx2 v[44:45], v9, s[8:11], s25 offen offset:0 sc1
    buffer_load_dwordx4 v[46:49], v8, s[8:11], s25 offen offset:2560 sc1
    buffer_load_dwordx4 v[50:53], v8, s[8:11], s25 offen offset:3584 sc1
    buffer_load_dwordx2 v[54:55], v9, s[8:11], s25 offen offset:2560 sc1
    buffer_load_dwordx2 v[96:97], v10, s[16:19], s41 offen sc1
    buffer_load_dwordx2 v[98:99], v11, s[16:19], s41 offen sc1
    buffer_load_dwordx2 v[100:101], v10, s[16:19], s25 offen sc1
    buffer_load_dwordx2 v[102:103], v11, s[16:19], s25 offen sc1
    s_waitcnt lgkmcnt(0)
    s_barrier
    s_lshl_b32 s24, s92, 10
    s_lshl_b32 s25, s78, 2
    s_add_u32 s24, s24, s25
    s_add_u32 s24, s24, 23105536
    s_cmp_eq_u32 s3, 0
    s_cbranch_scc0 interleave_layers__linear_attn_block__memory_aug_recurrent_mem_tr__prompt_kernel_pb12
    v_lshlrev_b32 v14, 7, v1
    v_add_u32 v14, s24, v14
    v_mov_b32 v15, 2146435072
    v_cmp_le_u32 vcc, 8, v1
    s_nop 1
    v_cndmask_b32 v14, v14, v15, vcc
    v_mov_b32 v15, s40
    buffer_store_dword v15, v14, s[8:11], 0 offen sc1
interleave_layers__linear_attn_block__memory_aug_recurrent_mem_tr__prompt_kernel_pb12:
    v_add_u32 v15, s42, v5
    ds_read_b128 v[208:211], v15 offset:0
    ds_read_b128 v[212:215], v15 offset:20480
    ds_read_b128 v[216:219], v15 offset:1024
    ds_read_b128 v[220:223], v15 offset:21504
    ds_read_b128 v[224:227], v15 offset:2048
    ds_read_b128 v[228:231], v15 offset:22528
    ds_read_b128 v[232:235], v15 offset:3072
    ds_read_b128 v[236:239], v15 offset:23552
    s_waitcnt lgkmcnt(6)
    v_mfma_f32_16x16x32_bf16 v[240:243], a[0:3], v[208:211], 0
    v_mfma_f32_16x16x32_bf16 v[244:247], a[4:7], v[208:211], 0
    v_mfma_f32_16x16x32_bf16 v[248:251], a[0:3], v[212:215], 0
    v_mfma_f32_16x16x32_bf16 v[252:255], a[4:7], v[212:215], 0
    ds_read_b128 v[208:211], v15 offset:4096
    ds_read_b128 v[212:215], v15 offset:24576
    s_waitcnt lgkmcnt(6)
    v_mfma_f32_16x16x32_bf16 v[240:243], a[8:11], v[216:219], v[240:243]
    v_mfma_f32_16x16x32_bf16 v[244:247], a[12:15], v[216:219], v[244:247]
    v_mfma_f32_16x16x32_bf16 v[248:251], a[8:11], v[220:223], v[248:251]
    v_mfma_f32_16x16x32_bf16 v[252:255], a[12:15], v[220:223], v[252:255]
    ds_read_b128 v[216:219], v15 offset:5120
    ds_read_b128 v[220:223], v15 offset:25600
    s_waitcnt lgkmcnt(6)
    v_mfma_f32_16x16x32_bf16 v[240:243], a[16:19], v[224:227], v[240:243]
    v_mfma_f32_16x16x32_bf16 v[244:247], a[20:23], v[224:227], v[244:247]
    v_mfma_f32_16x16x32_bf16 v[248:251], a[16:19], v[228:231], v[248:251]
    v_mfma_f32_16x16x32_bf16 v[252:255], a[20:23], v[228:231], v[252:255]
    ds_read_b128 v[224:227], v15 offset:6144
    ds_read_b128 v[228:231], v15 offset:26624
    s_waitcnt lgkmcnt(6)
    v_mfma_f32_16x16x32_bf16 v[240:243], a[24:27], v[232:235], v[240:243]
    v_mfma_f32_16x16x32_bf16 v[244:247], a[28:31], v[232:235], v[244:247]
    v_mfma_f32_16x16x32_bf16 v[248:251], a[24:27], v[236:239], v[248:251]
    v_mfma_f32_16x16x32_bf16 v[252:255], a[28:31], v[236:239], v[252:255]
    ds_read_b128 v[232:235], v15 offset:7168
    ds_read_b128 v[236:239], v15 offset:27648
    s_waitcnt lgkmcnt(6)
    v_mfma_f32_16x16x32_bf16 v[240:243], a[32:35], v[208:211], v[240:243]
    v_mfma_f32_16x16x32_bf16 v[244:247], a[36:39], v[208:211], v[244:247]
    v_mfma_f32_16x16x32_bf16 v[248:251], a[32:35], v[212:215], v[248:251]
    v_mfma_f32_16x16x32_bf16 v[252:255], a[36:39], v[212:215], v[252:255]
    ds_read_b128 v[208:211], v15 offset:8192
    ds_read_b128 v[212:215], v15 offset:28672
    s_waitcnt lgkmcnt(6)
    v_mfma_f32_16x16x32_bf16 v[240:243], a[40:43], v[216:219], v[240:243]
    v_mfma_f32_16x16x32_bf16 v[244:247], a[44:47], v[216:219], v[244:247]
    v_mfma_f32_16x16x32_bf16 v[248:251], a[40:43], v[220:223], v[248:251]
    v_mfma_f32_16x16x32_bf16 v[252:255], a[44:47], v[220:223], v[252:255]
    ds_read_b128 v[216:219], v15 offset:9216
    ds_read_b128 v[220:223], v15 offset:29696
    s_waitcnt lgkmcnt(6)
    v_mfma_f32_16x16x32_bf16 v[240:243], a[48:51], v[224:227], v[240:243]
    v_mfma_f32_16x16x32_bf16 v[244:247], a[52:55], v[224:227], v[244:247]
    v_mfma_f32_16x16x32_bf16 v[248:251], a[48:51], v[228:231], v[248:251]
    v_mfma_f32_16x16x32_bf16 v[252:255], a[52:55], v[228:231], v[252:255]
    ds_read_b128 v[224:227], v15 offset:10240
    ds_read_b128 v[228:231], v15 offset:30720
    s_waitcnt lgkmcnt(6)
    v_mfma_f32_16x16x32_bf16 v[240:243], a[56:59], v[232:235], v[240:243]
    v_mfma_f32_16x16x32_bf16 v[244:247], a[60:63], v[232:235], v[244:247]
    v_mfma_f32_16x16x32_bf16 v[248:251], a[56:59], v[236:239], v[248:251]
    v_mfma_f32_16x16x32_bf16 v[252:255], a[60:63], v[236:239], v[252:255]
    ds_read_b128 v[232:235], v15 offset:11264
    ds_read_b128 v[236:239], v15 offset:31744
    s_waitcnt lgkmcnt(6)
    v_mfma_f32_16x16x32_bf16 v[240:243], a[64:67], v[208:211], v[240:243]
    v_mfma_f32_16x16x32_bf16 v[244:247], a[68:71], v[208:211], v[244:247]
    v_mfma_f32_16x16x32_bf16 v[248:251], a[64:67], v[212:215], v[248:251]
    v_mfma_f32_16x16x32_bf16 v[252:255], a[68:71], v[212:215], v[252:255]
    ds_read_b128 v[208:211], v15 offset:12288
    ds_read_b128 v[212:215], v15 offset:32768
    s_waitcnt lgkmcnt(6)
    v_mfma_f32_16x16x32_bf16 v[240:243], a[72:75], v[216:219], v[240:243]
    v_mfma_f32_16x16x32_bf16 v[244:247], a[76:79], v[216:219], v[244:247]
    v_mfma_f32_16x16x32_bf16 v[248:251], a[72:75], v[220:223], v[248:251]
    v_mfma_f32_16x16x32_bf16 v[252:255], a[76:79], v[220:223], v[252:255]
    ds_read_b128 v[216:219], v15 offset:13312
    ds_read_b128 v[220:223], v15 offset:33792
    s_waitcnt lgkmcnt(6)
    v_mfma_f32_16x16x32_bf16 v[240:243], a[80:83], v[224:227], v[240:243]
    v_mfma_f32_16x16x32_bf16 v[244:247], a[84:87], v[224:227], v[244:247]
    v_mfma_f32_16x16x32_bf16 v[248:251], a[80:83], v[228:231], v[248:251]
    v_mfma_f32_16x16x32_bf16 v[252:255], a[84:87], v[228:231], v[252:255]
    ds_read_b128 v[224:227], v15 offset:14336
    ds_read_b128 v[228:231], v15 offset:34816
    s_waitcnt lgkmcnt(6)
    v_mfma_f32_16x16x32_bf16 v[240:243], a[88:91], v[232:235], v[240:243]
    v_mfma_f32_16x16x32_bf16 v[244:247], a[92:95], v[232:235], v[244:247]
    v_mfma_f32_16x16x32_bf16 v[248:251], a[88:91], v[236:239], v[248:251]
    v_mfma_f32_16x16x32_bf16 v[252:255], a[92:95], v[236:239], v[252:255]
    ds_read_b128 v[232:235], v15 offset:15360
    ds_read_b128 v[236:239], v15 offset:35840
    s_waitcnt lgkmcnt(6)
    v_mfma_f32_16x16x32_bf16 v[240:243], a[96:99], v[208:211], v[240:243]
    v_mfma_f32_16x16x32_bf16 v[244:247], a[100:103], v[208:211], v[244:247]
    v_mfma_f32_16x16x32_bf16 v[248:251], a[96:99], v[212:215], v[248:251]
    v_mfma_f32_16x16x32_bf16 v[252:255], a[100:103], v[212:215], v[252:255]
    ds_read_b128 v[208:211], v15 offset:16384
    ds_read_b128 v[212:215], v15 offset:36864
    s_waitcnt lgkmcnt(6)
    v_mfma_f32_16x16x32_bf16 v[240:243], a[104:107], v[216:219], v[240:243]
    v_mfma_f32_16x16x32_bf16 v[244:247], a[108:111], v[216:219], v[244:247]
    v_mfma_f32_16x16x32_bf16 v[248:251], a[104:107], v[220:223], v[248:251]
    v_mfma_f32_16x16x32_bf16 v[252:255], a[108:111], v[220:223], v[252:255]
    ds_read_b128 v[216:219], v15 offset:17408
    ds_read_b128 v[220:223], v15 offset:37888
    s_waitcnt lgkmcnt(6)
    v_mfma_f32_16x16x32_bf16 v[240:243], a[112:115], v[224:227], v[240:243]
    v_mfma_f32_16x16x32_bf16 v[244:247], a[116:119], v[224:227], v[244:247]
    v_mfma_f32_16x16x32_bf16 v[248:251], a[112:115], v[228:231], v[248:251]
    v_mfma_f32_16x16x32_bf16 v[252:255], a[116:119], v[228:231], v[252:255]
    ds_read_b128 v[224:227], v15 offset:18432
    ds_read_b128 v[228:231], v15 offset:38912
    s_waitcnt lgkmcnt(6)
    v_mfma_f32_16x16x32_bf16 v[240:243], a[120:123], v[232:235], v[240:243]
    v_mfma_f32_16x16x32_bf16 v[244:247], a[124:127], v[232:235], v[244:247]
    v_mfma_f32_16x16x32_bf16 v[248:251], a[120:123], v[236:239], v[248:251]
    v_mfma_f32_16x16x32_bf16 v[252:255], a[124:127], v[236:239], v[252:255]
    ds_read_b128 v[232:235], v15 offset:19456
    ds_read_b128 v[236:239], v15 offset:39936
    s_waitcnt lgkmcnt(6)
    v_mfma_f32_16x16x32_bf16 v[240:243], a[128:131], v[208:211], v[240:243]
    v_mfma_f32_16x16x32_bf16 v[244:247], a[132:135], v[208:211], v[244:247]
    v_mfma_f32_16x16x32_bf16 v[248:251], a[128:131], v[212:215], v[248:251]
    v_mfma_f32_16x16x32_bf16 v[252:255], a[132:135], v[212:215], v[252:255]
    s_waitcnt lgkmcnt(4)
    v_mfma_f32_16x16x32_bf16 v[240:243], a[136:139], v[216:219], v[240:243]
    v_mfma_f32_16x16x32_bf16 v[244:247], a[140:143], v[216:219], v[244:247]
    v_mfma_f32_16x16x32_bf16 v[248:251], a[136:139], v[220:223], v[248:251]
    v_mfma_f32_16x16x32_bf16 v[252:255], a[140:143], v[220:223], v[252:255]
    s_waitcnt lgkmcnt(2)
    v_mfma_f32_16x16x32_bf16 v[240:243], a[144:147], v[224:227], v[240:243]
    v_mfma_f32_16x16x32_bf16 v[244:247], a[148:151], v[224:227], v[244:247]
    v_mfma_f32_16x16x32_bf16 v[248:251], a[144:147], v[228:231], v[248:251]
    v_mfma_f32_16x16x32_bf16 v[252:255], a[148:151], v[228:231], v[252:255]
    s_waitcnt lgkmcnt(0)
    v_mfma_f32_16x16x32_bf16 v[240:243], a[152:155], v[232:235], v[240:243]
    v_mfma_f32_16x16x32_bf16 v[244:247], a[156:159], v[232:235], v[244:247]
    v_mfma_f32_16x16x32_bf16 v[248:251], a[152:155], v[236:239], v[248:251]
    v_mfma_f32_16x16x32_bf16 v[252:255], a[156:159], v[236:239], v[252:255]
    s_nop 4
    v_cvt_pk_bf16_f32 v208, v240, v241
    v_cvt_pk_bf16_f32 v209, v242, v243
    v_lshlrev_b32 v210, 16, v208
    v_and_b32 v211, 0xffff0000, v208
    v_lshlrev_b32 v212, 16, v104
    v_and_b32 v213, 0xffff0000, v104
    v_pk_add_f32 v[210:211], v[210:211], v[212:213]
    v_cvt_pk_bf16_f32 v216, v210, v211
    v_lshlrev_b32 v210, 16, v209
    v_and_b32 v211, 0xffff0000, v209
    v_lshlrev_b32 v212, 16, v105
    v_and_b32 v213, 0xffff0000, v105
    v_pk_add_f32 v[210:211], v[210:211], v[212:213]
    v_cvt_pk_bf16_f32 v217, v210, v211
    v_cvt_pk_bf16_f32 v208, v244, v245
    v_cvt_pk_bf16_f32 v209, v246, v247
    v_lshlrev_b32 v210, 16, v208
    v_and_b32 v211, 0xffff0000, v208
    v_lshlrev_b32 v212, 16, v106
    v_and_b32 v213, 0xffff0000, v106
    v_pk_add_f32 v[210:211], v[210:211], v[212:213]
    v_cvt_pk_bf16_f32 v218, v210, v211
    v_lshlrev_b32 v210, 16, v209
    v_and_b32 v211, 0xffff0000, v209
    v_lshlrev_b32 v212, 16, v107
    v_and_b32 v213, 0xffff0000, v107
    v_pk_add_f32 v[210:211], v[210:211], v[212:213]
    v_cvt_pk_bf16_f32 v219, v210, v211
    v_cvt_pk_bf16_f32 v208, v248, v249
    v_cvt_pk_bf16_f32 v209, v250, v251
    v_lshlrev_b32 v210, 16, v208
    v_and_b32 v211, 0xffff0000, v208
    v_lshlrev_b32 v212, 16, v108
    v_and_b32 v213, 0xffff0000, v108
    v_pk_add_f32 v[210:211], v[210:211], v[212:213]
    v_cvt_pk_bf16_f32 v220, v210, v211
    v_lshlrev_b32 v210, 16, v209
    v_and_b32 v211, 0xffff0000, v209
    v_lshlrev_b32 v212, 16, v109
    v_and_b32 v213, 0xffff0000, v109
    v_pk_add_f32 v[210:211], v[210:211], v[212:213]
    v_cvt_pk_bf16_f32 v221, v210, v211
    v_cvt_pk_bf16_f32 v208, v252, v253
    v_cvt_pk_bf16_f32 v209, v254, v255
    v_lshlrev_b32 v210, 16, v208
    v_and_b32 v211, 0xffff0000, v208
    v_lshlrev_b32 v212, 16, v110
    v_and_b32 v213, 0xffff0000, v110
    v_pk_add_f32 v[210:211], v[210:211], v[212:213]
    v_cvt_pk_bf16_f32 v222, v210, v211
    v_lshlrev_b32 v210, 16, v209
    v_and_b32 v211, 0xffff0000, v209
    v_lshlrev_b32 v212, 16, v111
    v_and_b32 v213, 0xffff0000, v111
    v_pk_add_f32 v[210:211], v[210:211], v[212:213]
    v_cvt_pk_bf16_f32 v223, v210, v211
    s_add_u32 s25, s43, 20480
    buffer_store_dwordx4 v[216:219], v12, s[8:11], s43 offen sc1
    buffer_store_dwordx4 v[220:223], v12, s[8:11], s25 offen sc1
    s_add_u32 s40, s40, 1
    s_add_u32 s43, s43, s77
    s_cmp_ge_u32 s40, s76
    s_cbranch_scc1 interleave_layers__linear_attn_block__memory_aug_recurrent_mem_tr__prompt_kernel_k3_done
    s_xor_b32 s42, s42, 40960
    s_waitcnt vmcnt(2)
    v_mfma_f32_16x16x32_bf16 v[132:135], a[192:195], v[16:19], 0
    v_mfma_f32_16x16x32_bf16 v[136:139], a[202:205], v[20:23], 0
    v_mfma_f32_16x16x32_bf16 v[112:115], a[160:163], v[16:19], 0
    v_mfma_f32_16x16x32_bf16 v[116:119], a[164:167], v[16:19], 0
    v_mfma_f32_16x16x32_bf16 v[120:123], a[172:175], v[16:19], 0
    v_mfma_f32_16x16x32_bf16 v[124:127], a[180:183], v[20:23], 0
    v_mfma_f32_16x16x32_bf16 v[128:131], a[186:189], v[20:23], 0
    v_mfma_f32_16x16x32_bf16 v[132:135], a[196:199], v[20:23], v[132:135]
    v_mfma_f32_16x16x32_bf16 v[116:119], a[168:171], v[20:23], v[116:119]
    v_mfma_f32_16x16x32_bf16 v[120:123], a[176:179], v[20:23], v[120:123]
    v_mfma_f32_16x16x16_bf16 v[136:139], a[206:207], v[24:25], v[136:139]
    s_nop 0
    v_mfma_f32_16x16x16_bf16 v[124:127], a[184:185], v[24:25], v[124:127]
    v_mfma_f32_16x16x16_bf16 v[128:131], a[190:191], v[24:25], v[128:131]
    v_mfma_f32_16x16x16_bf16 v[132:135], a[200:201], v[24:25], v[132:135]
    v_mfma_f32_16x16x32_bf16 v[160:163], a[240:243], v[26:29], 0
    v_mfma_f32_16x16x32_bf16 v[164:167], a[250:253], v[30:33], 0
    v_mfma_f32_16x16x32_bf16 v[140:143], a[208:211], v[26:29], 0
    v_mfma_f32_16x16x32_bf16 v[144:147], a[212:215], v[26:29], 0
    v_mfma_f32_16x16x32_bf16 v[148:151], a[220:223], v[26:29], 0
    v_mfma_f32_16x16x32_bf16 v[152:155], a[228:231], v[30:33], 0
    v_mfma_f32_16x16x32_bf16 v[156:159], a[234:237], v[30:33], 0
    v_mfma_f32_16x16x32_bf16 v[160:163], a[244:247], v[30:33], v[160:163]
    v_mfma_f32_16x16x32_bf16 v[144:147], a[216:219], v[30:33], v[144:147]
    v_mfma_f32_16x16x32_bf16 v[148:151], a[224:227], v[30:33], v[148:151]
    v_mfma_f32_16x16x16_bf16 v[164:167], a[254:255], v[34:35], v[164:167]
    s_nop 0
    v_mfma_f32_16x16x16_bf16 v[152:155], a[232:233], v[34:35], v[152:155]
    v_mfma_f32_16x16x16_bf16 v[156:159], a[238:239], v[34:35], v[156:159]
    v_mfma_f32_16x16x16_bf16 v[160:163], a[248:249], v[34:35], v[160:163]
    v_add_f32 v132, s54, v132
    v_add_f32 v133, s54, v133
    v_add_f32 v134, s54, v134
    v_add_f32 v135, s54, v135
    v_add_f32 v136, s54, v136
    v_rcp_f32 v132, v132
    v_rcp_f32 v133, v133
    v_rcp_f32 v134, v134
    v_rcp_f32 v135, v135
    v_rcp_f32 v136, v136
    v_mul_f32 v112, v112, v132
    v_mul_f32 v113, v113, v132
    v_mul_f32 v114, v114, v132
    v_mul_f32 v115, v115, v132
    v_cvt_pk_bf16_f32 v168, v112, v113
    v_cvt_pk_bf16_f32 v169, v114, v115
    v_mul_f32 v116, v116, v133
    v_mul_f32 v117, v117, v133
    v_mul_f32 v118, v118, v133
    v_mul_f32 v119, v119, v133
    v_cvt_pk_bf16_f32 v170, v116, v117
    v_cvt_pk_bf16_f32 v171, v118, v119
    v_mul_f32 v120, v120, v134
    v_mul_f32 v121, v121, v134
    v_mul_f32 v122, v122, v134
    v_mul_f32 v123, v123, v134
    v_cvt_pk_bf16_f32 v172, v120, v121
    v_cvt_pk_bf16_f32 v173, v122, v123
    v_mul_f32 v124, v124, v135
    v_mul_f32 v125, v125, v135
    v_mul_f32 v126, v126, v135
    v_mul_f32 v127, v127, v135
    v_cvt_pk_bf16_f32 v174, v124, v125
    v_cvt_pk_bf16_f32 v175, v126, v127
    v_mul_f32 v128, v128, v136
    v_mul_f32 v129, v129, v136
    v_mul_f32 v130, v130, v136
    v_mul_f32 v131, v131, v136
    v_cvt_pk_bf16_f32 v176, v128, v129
    v_cvt_pk_bf16_f32 v177, v130, v131
    v_add_f32 v160, s54, v160
    v_add_f32 v161, s54, v161
    v_add_f32 v162, s54, v162
    v_add_f32 v163, s54, v163
    v_add_f32 v164, s54, v164
    v_rcp_f32 v160, v160
    v_rcp_f32 v161, v161
    v_rcp_f32 v162, v162
    v_rcp_f32 v163, v163
    v_rcp_f32 v164, v164
    v_mul_f32 v140, v140, v160
    v_mul_f32 v141, v141, v160
    v_mul_f32 v142, v142, v160
    v_mul_f32 v143, v143, v160
    v_cvt_pk_bf16_f32 v178, v140, v141
    v_cvt_pk_bf16_f32 v179, v142, v143
    v_mul_f32 v144, v144, v161
    v_mul_f32 v145, v145, v161
    v_mul_f32 v146, v146, v161
    v_mul_f32 v147, v147, v161
    v_cvt_pk_bf16_f32 v180, v144, v145
    v_cvt_pk_bf16_f32 v181, v146, v147
    v_mul_f32 v148, v148, v162
    v_mul_f32 v149, v149, v162
    v_mul_f32 v150, v150, v162
    v_mul_f32 v151, v151, v162
    v_cvt_pk_bf16_f32 v182, v148, v149
    v_cvt_pk_bf16_f32 v183, v150, v151
    v_mul_f32 v152, v152, v163
    v_mul_f32 v153, v153, v163
    v_mul_f32 v154, v154, v163
    v_mul_f32 v155, v155, v163
    v_cvt_pk_bf16_f32 v184, v152, v153
    v_cvt_pk_bf16_f32 v185, v154, v155
    v_mul_f32 v156, v156, v164
    v_mul_f32 v157, v157, v164
    v_mul_f32 v158, v158, v164
    v_mul_f32 v159, v159, v164
    v_cvt_pk_bf16_f32 v186, v156, v157
    v_cvt_pk_bf16_f32 v187, v158, v159
    v_mfma_f32_16x16x32_bf16 v[132:135], a[192:195], v[36:39], 0
    v_mfma_f32_16x16x32_bf16 v[136:139], a[202:205], v[40:43], 0
    v_mfma_f32_16x16x32_bf16 v[112:115], a[160:163], v[36:39], 0
    v_mfma_f32_16x16x32_bf16 v[116:119], a[164:167], v[36:39], 0
    v_mfma_f32_16x16x32_bf16 v[120:123], a[172:175], v[36:39], 0
    v_mfma_f32_16x16x32_bf16 v[124:127], a[180:183], v[40:43], 0
    v_mfma_f32_16x16x32_bf16 v[128:131], a[186:189], v[40:43], 0
    v_mfma_f32_16x16x32_bf16 v[132:135], a[196:199], v[40:43], v[132:135]
    v_mfma_f32_16x16x32_bf16 v[116:119], a[168:171], v[40:43], v[116:119]
    v_mfma_f32_16x16x32_bf16 v[120:123], a[176:179], v[40:43], v[120:123]
    v_mfma_f32_16x16x16_bf16 v[136:139], a[206:207], v[44:45], v[136:139]
    s_nop 0
    v_mfma_f32_16x16x16_bf16 v[124:127], a[184:185], v[44:45], v[124:127]
    v_mfma_f32_16x16x16_bf16 v[128:131], a[190:191], v[44:45], v[128:131]
    v_mfma_f32_16x16x16_bf16 v[132:135], a[200:201], v[44:45], v[132:135]
    v_mfma_f32_16x16x32_bf16 v[160:163], a[240:243], v[46:49], 0
    v_mfma_f32_16x16x32_bf16 v[164:167], a[250:253], v[50:53], 0
    v_mfma_f32_16x16x32_bf16 v[140:143], a[208:211], v[46:49], 0
    v_mfma_f32_16x16x32_bf16 v[144:147], a[212:215], v[46:49], 0
    v_mfma_f32_16x16x32_bf16 v[148:151], a[220:223], v[46:49], 0
    v_mfma_f32_16x16x32_bf16 v[152:155], a[228:231], v[50:53], 0
    v_mfma_f32_16x16x32_bf16 v[156:159], a[234:237], v[50:53], 0
    v_mfma_f32_16x16x32_bf16 v[160:163], a[244:247], v[50:53], v[160:163]
    v_mfma_f32_16x16x32_bf16 v[144:147], a[216:219], v[50:53], v[144:147]
    v_mfma_f32_16x16x32_bf16 v[148:151], a[224:227], v[50:53], v[148:151]
    v_mfma_f32_16x16x16_bf16 v[164:167], a[254:255], v[54:55], v[164:167]
    s_nop 0
    v_mfma_f32_16x16x16_bf16 v[152:155], a[232:233], v[54:55], v[152:155]
    v_mfma_f32_16x16x16_bf16 v[156:159], a[238:239], v[54:55], v[156:159]
    v_mfma_f32_16x16x16_bf16 v[160:163], a[248:249], v[54:55], v[160:163]
    v_add_f32 v132, s54, v132
    v_add_f32 v133, s54, v133
    v_add_f32 v134, s54, v134
    v_add_f32 v135, s54, v135
    v_add_f32 v136, s54, v136
    v_rcp_f32 v132, v132
    v_rcp_f32 v133, v133
    v_rcp_f32 v134, v134
    v_rcp_f32 v135, v135
    v_rcp_f32 v136, v136
    v_mul_f32 v112, v112, v132
    v_mul_f32 v113, v113, v132
    v_mul_f32 v114, v114, v132
    v_mul_f32 v115, v115, v132
    v_cvt_pk_bf16_f32 v188, v112, v113
    v_cvt_pk_bf16_f32 v189, v114, v115
    v_mul_f32 v116, v116, v133
    v_mul_f32 v117, v117, v133
    v_mul_f32 v118, v118, v133
    v_mul_f32 v119, v119, v133
    v_cvt_pk_bf16_f32 v190, v116, v117
    v_cvt_pk_bf16_f32 v191, v118, v119
    v_mul_f32 v120, v120, v134
    v_mul_f32 v121, v121, v134
    v_mul_f32 v122, v122, v134
    v_mul_f32 v123, v123, v134
    v_cvt_pk_bf16_f32 v192, v120, v121
    v_cvt_pk_bf16_f32 v193, v122, v123
    v_mul_f32 v124, v124, v135
    v_mul_f32 v125, v125, v135
    v_mul_f32 v126, v126, v135
    v_mul_f32 v127, v127, v135
    v_cvt_pk_bf16_f32 v194, v124, v125
    v_cvt_pk_bf16_f32 v195, v126, v127
    v_mul_f32 v128, v128, v136
    v_mul_f32 v129, v129, v136
    v_mul_f32 v130, v130, v136
    v_mul_f32 v131, v131, v136
    v_cvt_pk_bf16_f32 v196, v128, v129
    v_cvt_pk_bf16_f32 v197, v130, v131
    v_add_f32 v160, s54, v160
    v_add_f32 v161, s54, v161
    v_add_f32 v162, s54, v162
    v_add_f32 v163, s54, v163
    v_add_f32 v164, s54, v164
    v_rcp_f32 v160, v160
    v_rcp_f32 v161, v161
    v_rcp_f32 v162, v162
    v_rcp_f32 v163, v163
    v_rcp_f32 v164, v164
    v_mul_f32 v140, v140, v160
    v_mul_f32 v141, v141, v160
    v_mul_f32 v142, v142, v160
    v_mul_f32 v143, v143, v160
    v_cvt_pk_bf16_f32 v198, v140, v141
    v_cvt_pk_bf16_f32 v199, v142, v143
    v_mul_f32 v144, v144, v161
    v_mul_f32 v145, v145, v161
    v_mul_f32 v146, v146, v161
    v_mul_f32 v147, v147, v161
    v_cvt_pk_bf16_f32 v200, v144, v145
    v_cvt_pk_bf16_f32 v201, v146, v147
    v_mul_f32 v148, v148, v162
    v_mul_f32 v149, v149, v162
    v_mul_f32 v150, v150, v162
    v_mul_f32 v151, v151, v162
    v_cvt_pk_bf16_f32 v202, v148, v149
    v_cvt_pk_bf16_f32 v203, v150, v151
    v_mul_f32 v152, v152, v163
    v_mul_f32 v153, v153, v163
    v_mul_f32 v154, v154, v163
    v_mul_f32 v155, v155, v163
    v_cvt_pk_bf16_f32 v204, v152, v153
    v_cvt_pk_bf16_f32 v205, v154, v155
    v_mul_f32 v156, v156, v164
    v_mul_f32 v157, v157, v164
    v_mul_f32 v158, v158, v164
    v_mul_f32 v159, v159, v164
    v_cvt_pk_bf16_f32 v206, v156, v157
    v_cvt_pk_bf16_f32 v207, v158, v159
    v_add_u32 v14, s42, v13
    ds_write_b128 v14, v[168:171] offset:0
    ds_write_b128 v14, v[172:175] offset:1024
    ds_write_b128 v14, v[176:179] offset:2048
    ds_write_b128 v14, v[180:183] offset:3072
    ds_write_b128 v14, v[184:187] offset:4096
    ds_write_b128 v14, v[188:191] offset:20480
    ds_write_b128 v14, v[192:195] offset:21504
    ds_write_b128 v14, v[196:199] offset:22528
    ds_write_b128 v14, v[200:203] offset:23552
    ds_write_b128 v14, v[204:207] offset:24576
    s_add_u32 s41, s43, s77
    s_add_u32 s24, s40, 1
    s_cmp_lt_u32 s24, s76
    s_cselect_b32 s41, s41, 2146435072
    s_waitcnt vmcnt(0)
    s_add_u32 s25, s41, 20480
    buffer_load_dwordx4 v[56:59], v8, s[8:11], s41 offen offset:0 sc1
    buffer_load_dwordx4 v[60:63], v8, s[8:11], s41 offen offset:1024 sc1
    buffer_load_dwordx2 v[64:65], v9, s[8:11], s41 offen offset:0 sc1
    buffer_load_dwordx4 v[66:69], v8, s[8:11], s41 offen offset:2560 sc1
    buffer_load_dwordx4 v[70:73], v8, s[8:11], s41 offen offset:3584 sc1
    buffer_load_dwordx2 v[74:75], v9, s[8:11], s41 offen offset:2560 sc1
    buffer_load_dwordx4 v[76:79], v8, s[8:11], s25 offen offset:0 sc1
    buffer_load_dwordx4 v[80:83], v8, s[8:11], s25 offen offset:1024 sc1
    buffer_load_dwordx2 v[84:85], v9, s[8:11], s25 offen offset:0 sc1
    buffer_load_dwordx4 v[86:89], v8, s[8:11], s25 offen offset:2560 sc1
    buffer_load_dwordx4 v[90:93], v8, s[8:11], s25 offen offset:3584 sc1
    buffer_load_dwordx2 v[94:95], v9, s[8:11], s25 offen offset:2560 sc1
    buffer_load_dwordx2 v[104:105], v10, s[16:19], s41 offen sc1
    buffer_load_dwordx2 v[106:107], v11, s[16:19], s41 offen sc1
    buffer_load_dwordx2 v[108:109], v10, s[16:19], s25 offen sc1
    buffer_load_dwordx2 v[110:111], v11, s[16:19], s25 offen sc1
    s_waitcnt lgkmcnt(0)
    s_barrier
    s_lshl_b32 s24, s92, 10
    s_lshl_b32 s25, s78, 2
    s_add_u32 s24, s24, s25
    s_add_u32 s24, s24, 23105536
    s_cmp_eq_u32 s3, 0
    s_cbranch_scc0 interleave_layers__linear_attn_block__memory_aug_recurrent_mem_tr__prompt_kernel_pb13
    v_lshlrev_b32 v14, 7, v1
    v_add_u32 v14, s24, v14
    v_mov_b32 v15, 2146435072
    v_cmp_le_u32 vcc, 8, v1
    s_nop 1
    v_cndmask_b32 v14, v14, v15, vcc
    v_mov_b32 v15, s40
    buffer_store_dword v15, v14, s[8:11], 0 offen sc1
interleave_layers__linear_attn_block__memory_aug_recurrent_mem_tr__prompt_kernel_pb13:
    s_branch interleave_layers__linear_attn_block__memory_aug_recurrent_mem_tr__prompt_kernel_k3_seg
interleave_layers__linear_attn_block__memory_aug_recurrent_mem_tr__prompt_kernel_k3_done:
    s_waitcnt vmcnt(0)
    s_barrier
    s_lshl_b32 s24, s92, 10
    s_lshl_b32 s25, s78, 2
    s_add_u32 s24, s24, s25
    s_add_u32 s24, s24, 23105536
    s_cmp_eq_u32 s3, 0
    s_cbranch_scc0 interleave_layers__linear_attn_block__memory_aug_recurrent_mem_tr__prompt_kernel_pb14
    v_lshlrev_b32 v14, 7, v1
    v_add_u32 v14, s24, v14
    v_mov_b32 v15, 2146435072
    v_cmp_le_u32 vcc, 8, v1
    s_nop 1
    v_cndmask_b32 v14, v14, v15, vcc
    v_mov_b32 v15, s40
    buffer_store_dword v15, v14, s[8:11], 0 offen sc1
interleave_layers__linear_attn_block__memory_aug_recurrent_mem_tr__prompt_kernel_pb14:
    s_cmp_eq_u32 s92, 0
    s_cbranch_scc0 interleave_layers__linear_attn_block__memory_aug_recurrent_mem_tr__prompt_kernel_end
    s_mov_b32 s92, 1
    s_cmp_lt_u32 s2, 248
    s_cbranch_scc1 interleave_layers__linear_attn_block__memory_aug_recurrent_mem_tr__prompt_kernel_helper_k1
    s_add_u32 s16, s4, 4194304
    s_addc_u32 s17, s5, 0
    s_mov_b32 s18, 2621440
    s_mov_b32 s19, 0x00020000
    s_mov_b32 s46, 1024
    s_mov_b32 s47, 8
    s_mov_b32 s50, 1
    s_mov_b32 s58, 8388608
    s_mov_b32 s76, 64
    s_mov_b32 s77, 40960
    s_branch interleave_layers__linear_attn_block__memory_aug_recurrent_mem_tr__prompt_kernel_k3_entry
interleave_layers__linear_attn_block__memory_aug_recurrent_mem_tr__prompt_kernel_helper_k1:
    s_mov_b32 s92, 1
    s_sub_u32 s24, s2, 232
    s_add_u32 s16, s4, 4194304
    s_addc_u32 s17, s5, 0
    s_mov_b32 s18, 2621440
    s_mov_b32 s19, 0x00020000
    s_mov_b32 s46, 1024
    s_mov_b32 s47, 8
    s_mov_b32 s50, 1
    s_and_b32 s44, s24, 7
    s_lshr_b32 s45, s24, 3
    s_mov_b32 s48, s45
    s_mov_b32 s49, 2
    s_mov_b32 s40, 32
    s_branch interleave_layers__linear_attn_block__memory_aug_recurrent_mem_tr__prompt_kernel_k1_entry
interleave_layers__linear_attn_block__memory_aug_recurrent_mem_tr__prompt_kernel_helper_clr:
    s_sub_u32 s44, s2, 253
    s_lshl_b32 s24, s44, 2
    s_add_u32 s24, s24, s3
    s_mul_i32 s45, s24, 5
    s_add_u32 s24, s45, 0
    s_min_u32 s24, s24, 56
    s_sub_u32 s25, s24, 47
    s_cmp_ge_u32 s24, 47
    s_cselect_b32 s24, s25, s24
    s_cselect_b32 s69, 0x2000, 0
    s_lshl_b32 s64, s24, 14
    s_add_u32 s24, s45, 1
    s_min_u32 s24, s24, 56
    s_sub_u32 s25, s24, 47
    s_cmp_ge_u32 s24, 47
    s_cselect_b32 s24, s25, s24
    s_cselect_b32 s70, 0x2000, 0
    s_lshl_b32 s65, s24, 14
    s_add_u32 s24, s45, 2
    s_min_u32 s24, s24, 56
    s_sub_u32 s25, s24, 47
    s_cmp_ge_u32 s24, 47
    s_cselect_b32 s24, s25, s24
    s_cselect_b32 s71, 0x2000, 0
    s_lshl_b32 s66, s24, 14
    s_add_u32 s24, s45, 3
    s_min_u32 s24, s24, 56
    s_sub_u32 s25, s24, 47
    s_cmp_ge_u32 s24, 47
    s_cselect_b32 s24, s25, s24
    s_cselect_b32 s72, 0x2000, 0
    s_lshl_b32 s67, s24, 14
    s_add_u32 s24, s45, 4
    s_min_u32 s24, s24, 56
    s_sub_u32 s25, s24, 47
    s_cmp_ge_u32 s24, 47
    s_cselect_b32 s24, s25, s24
    s_cselect_b32 s73, 0x2000, 0
    s_lshl_b32 s68, s24, 14
    v_lshlrev_b32 v5, 4, v1
    v_mov_b32 v8, -1
    v_mov_b32 v9, -1
    v_mov_b32 v10, -1
    v_mov_b32 v11, -1
    s_lshl_b32 s24, s44, 2
    s_add_u32 s42, s24, 23109632
    s_mov_b32 s40, 0
interleave_layers__linear_attn_block__memory_aug_recurrent_mem_tr__prompt_kernel_clr_blk:
    s_lshl_b32 s24, s40, 12
    s_and_b32 s24, s24, 0x2000
    s_xor_b32 s24, s24, s36
    s_lshl_b32 s41, s40, 20
    s_add_u32 s41, s41, s24
    s_add_u32 s41, s41, 117440512
    s_add_u32 s43, s41, s64
    s_xor_b32 s43, s43, s69
    s_add_u32 s46, s43, 4096
    buffer_store_dwordx4 v[8:11], v5, s[8:11], s43 offen offset:0 sc1
    buffer_store_dwordx4 v[8:11], v5, s[8:11], s43 offen offset:1024 sc1
    buffer_store_dwordx4 v[8:11], v5, s[8:11], s43 offen offset:2048 sc1
    buffer_store_dwordx4 v[8:11], v5, s[8:11], s43 offen offset:3072 sc1
    buffer_store_dwordx4 v[8:11], v5, s[8:11], s46 offen offset:0 sc1
    buffer_store_dwordx4 v[8:11], v5, s[8:11], s46 offen offset:1024 sc1
    buffer_store_dwordx4 v[8:11], v5, s[8:11], s46 offen offset:2048 sc1
    buffer_store_dwordx4 v[8:11], v5, s[8:11], s46 offen offset:3072 sc1
    s_add_u32 s43, s41, s65
    s_xor_b32 s43, s43, s70
    s_add_u32 s46, s43, 4096
    buffer_store_dwordx4 v[8:11], v5, s[8:11], s43 offen offset:0 sc1
    buffer_store_dwordx4 v[8:11], v5, s[8:11], s43 offen offset:1024 sc1
    buffer_store_dwordx4 v[8:11], v5, s[8:11], s43 offen offset:2048 sc1
    buffer_store_dwordx4 v[8:11], v5, s[8:11], s43 offen offset:3072 sc1
    buffer_store_dwordx4 v[8:11], v5, s[8:11], s46 offen offset:0 sc1
    buffer_store_dwordx4 v[8:11], v5, s[8:11], s46 offen offset:1024 sc1
    buffer_store_dwordx4 v[8:11], v5, s[8:11], s46 offen offset:2048 sc1
    buffer_store_dwordx4 v[8:11], v5, s[8:11], s46 offen offset:3072 sc1
    s_add_u32 s43, s41, s66
    s_xor_b32 s43, s43, s71
    s_add_u32 s46, s43, 4096
    buffer_store_dwordx4 v[8:11], v5, s[8:11], s43 offen offset:0 sc1
    buffer_store_dwordx4 v[8:11], v5, s[8:11], s43 offen offset:1024 sc1
    buffer_store_dwordx4 v[8:11], v5, s[8:11], s43 offen offset:2048 sc1
    buffer_store_dwordx4 v[8:11], v5, s[8:11], s43 offen offset:3072 sc1
    buffer_store_dwordx4 v[8:11], v5, s[8:11], s46 offen offset:0 sc1
    buffer_store_dwordx4 v[8:11], v5, s[8:11], s46 offen offset:1024 sc1
    buffer_store_dwordx4 v[8:11], v5, s[8:11], s46 offen offset:2048 sc1
    buffer_store_dwordx4 v[8:11], v5, s[8:11], s46 offen offset:3072 sc1
    s_add_u32 s43, s41, s67
    s_xor_b32 s43, s43, s72
    s_add_u32 s46, s43, 4096
    buffer_store_dwordx4 v[8:11], v5, s[8:11], s43 offen offset:0 sc1
    buffer_store_dwordx4 v[8:11], v5, s[8:11], s43 offen offset:1024 sc1
    buffer_store_dwordx4 v[8:11], v5, s[8:11], s43 offen offset:2048 sc1
    buffer_store_dwordx4 v[8:11], v5, s[8:11], s43 offen offset:3072 sc1
    buffer_store_dwordx4 v[8:11], v5, s[8:11], s46 offen offset:0 sc1
    buffer_store_dwordx4 v[8:11], v5, s[8:11], s46 offen offset:1024 sc1
    buffer_store_dwordx4 v[8:11], v5, s[8:11], s46 offen offset:2048 sc1
    buffer_store_dwordx4 v[8:11], v5, s[8:11], s46 offen offset:3072 sc1
    s_add_u32 s43, s41, s68
    s_xor_b32 s43, s43, s73
    s_add_u32 s46, s43, 4096
    buffer_store_dwordx4 v[8:11], v5, s[8:11], s43 offen offset:0 sc1
    buffer_store_dwordx4 v[8:11], v5, s[8:11], s43 offen offset:1024 sc1
    buffer_store_dwordx4 v[8:11], v5, s[8:11], s43 offen offset:2048 sc1
    buffer_store_dwordx4 v[8:11], v5, s[8:11], s43 offen offset:3072 sc1
    buffer_store_dwordx4 v[8:11], v5, s[8:11], s46 offen offset:0 sc1
    buffer_store_dwordx4 v[8:11], v5, s[8:11], s46 offen offset:1024 sc1
    buffer_store_dwordx4 v[8:11], v5, s[8:11], s46 offen offset:2048 sc1
    buffer_store_dwordx4 v[8:11], v5, s[8:11], s46 offen offset:3072 sc1
    s_waitcnt vmcnt(40)
    s_barrier
    s_cmp_eq_u32 s3, 0
    s_cbranch_scc0 interleave_layers__linear_attn_block__memory_aug_recurrent_mem_tr__prompt_kernel_pb15
    v_lshlrev_b32 v14, 7, v1
    v_add_u32 v14, s42, v14
    v_mov_b32 v15, 2146435072
    v_cmp_le_u32 vcc, 8, v1
    s_nop 1
    v_cndmask_b32 v14, v14, v15, vcc
    v_mov_b32 v15, s40
    buffer_store_dword v15, v14, s[8:11], 0 offen sc1
interleave_layers__linear_attn_block__memory_aug_recurrent_mem_tr__prompt_kernel_pb15:
    s_add_u32 s40, s40, 1
    s_cmp_lt_u32 s40, 64
    s_cbranch_scc1 interleave_layers__linear_attn_block__memory_aug_recurrent_mem_tr__prompt_kernel_clr_blk
    s_waitcnt vmcnt(0)
    s_barrier
    s_cmp_eq_u32 s3, 0
    s_cbranch_scc0 interleave_layers__linear_attn_block__memory_aug_recurrent_mem_tr__prompt_kernel_pb16
    v_lshlrev_b32 v14, 7, v1
    v_add_u32 v14, s42, v14
    v_mov_b32 v15, 2146435072
    v_cmp_le_u32 vcc, 8, v1
    s_nop 1
    v_cndmask_b32 v14, v14, v15, vcc
    v_mov_b32 v15, s40
    buffer_store_dword v15, v14, s[8:11], 0 offen sc1
interleave_layers__linear_attn_block__memory_aug_recurrent_mem_tr__prompt_kernel_pb16:
interleave_layers__linear_attn_block__memory_aug_recurrent_mem_tr__prompt_kernel_clr_blk2:
    s_sub_u32 s47, s40, 64
    s_cmp_ge_u32 s47, 60
    s_cbranch_scc1 interleave_layers__linear_attn_block__memory_aug_recurrent_mem_tr__prompt_kernel_clr_last
    s_and_b32 s24, s47, 3
    s_lshl_b32 s24, s24, 7
    s_add_u32 s24, s24, 23107584
    v_lshlrev_b32 v15, 2, v1
    v_add_u32 v15, s24, v15
    s_lshr_b32 s95, s47, 2
    s_add_u32 s95, s95, 2
    s_mov_b32 s61, 0
interleave_layers__linear_attn_block__memory_aug_recurrent_mem_tr__prompt_kernel_clr_wx:
    buffer_load_dword v14, v15, s[8:11], 0 offen sc1
    s_waitcnt vmcnt(0)
    v_cmp_le_i32 vcc, s95, v14
    s_mov_b32 s25, 0xfffff
    s_and_b32 s24, vcc_lo, s25
    s_cmp_eq_u32 s24, s25
    s_cbranch_scc1 interleave_layers__linear_attn_block__memory_aug_recurrent_mem_tr__prompt_kernel_clr_wx_ok
    s_add_u32 s61, s61, 1
    s_cmp_ge_u32 s61, s60
    s_cbranch_scc1 interleave_layers__linear_attn_block__memory_aug_recurrent_mem_tr__prompt_kernel_clr_wx_to
    s_sleep 32
    s_branch interleave_layers__linear_attn_block__memory_aug_recurrent_mem_tr__prompt_kernel_clr_wx
interleave_layers__linear_attn_block__memory_aug_recurrent_mem_tr__prompt_kernel_clr_wx_to:
    s_mov_b32 s60, 1
interleave_layers__linear_attn_block__memory_aug_recurrent_mem_tr__prompt_kernel_clr_wx_ok:
    s_branch interleave_layers__linear_attn_block__memory_aug_recurrent_mem_tr__prompt_kernel_clr_go
interleave_layers__linear_attn_block__memory_aug_recurrent_mem_tr__prompt_kernel_clr_last:
    v_mov_b32 v15, 23111680
    s_mov_b32 s95, 66
    s_mov_b32 s61, 0
interleave_layers__linear_attn_block__memory_aug_recurrent_mem_tr__prompt_kernel_clr_ws:
    buffer_load_dword v14, v15, s[8:11], 0 offen sc1
    s_waitcnt vmcnt(0)
    v_cmp_le_i32 vcc, s95, v14
    s_mov_b32 s25, 0x1
    s_and_b32 s24, vcc_lo, s25
    s_cmp_eq_u32 s24, s25
    s_cbranch_scc1 interleave_layers__linear_attn_block__memory_aug_recurrent_mem_tr__prompt_kernel_clr_ws_ok
    s_add_u32 s61, s61, 1
    s_cmp_ge_u32 s61, s60
    s_cbranch_scc1 interleave_layers__linear_attn_block__memory_aug_recurrent_mem_tr__prompt_kernel_clr_ws_to
    s_sleep 32
    s_branch interleave_layers__linear_attn_block__memory_aug_recurrent_mem_tr__prompt_kernel_clr_ws
interleave_layers__linear_attn_block__memory_aug_recurrent_mem_tr__prompt_kernel_clr_ws_to:
    s_mov_b32 s60, 1
interleave_layers__linear_attn_block__memory_aug_recurrent_mem_tr__prompt_kernel_clr_ws_ok:
interleave_layers__linear_attn_block__memory_aug_recurrent_mem_tr__prompt_kernel_clr_go:
    s_lshl_b32 s24, s47, 12
    s_and_b32 s24, s24, 0x2000
    s_xor_b32 s24, s24, s36
    s_lshl_b32 s41, s47, 20
    s_add_u32 s41, s41, s24
    s_add_u32 s41, s41, 117440512
    s_add_u32 s43, s41, s64
    s_xor_b32 s43, s43, s69
    s_add_u32 s46, s43, 4096
    buffer_store_dwordx4 v[8:11], v5, s[8:11], s43 offen offset:0 sc1
    buffer_store_dwordx4 v[8:11], v5, s[8:11], s43 offen offset:1024 sc1
    buffer_store_dwordx4 v[8:11], v5, s[8:11], s43 offen offset:2048 sc1
    buffer_store_dwordx4 v[8:11], v5, s[8:11], s43 offen offset:3072 sc1
    buffer_store_dwordx4 v[8:11], v5, s[8:11], s46 offen offset:0 sc1
    buffer_store_dwordx4 v[8:11], v5, s[8:11], s46 offen offset:1024 sc1
    buffer_store_dwordx4 v[8:11], v5, s[8:11], s46 offen offset:2048 sc1
    buffer_store_dwordx4 v[8:11], v5, s[8:11], s46 offen offset:3072 sc1
    s_add_u32 s43, s41, s65
    s_xor_b32 s43, s43, s70
    s_add_u32 s46, s43, 4096
    buffer_store_dwordx4 v[8:11], v5, s[8:11], s43 offen offset:0 sc1
    buffer_store_dwordx4 v[8:11], v5, s[8:11], s43 offen offset:1024 sc1
    buffer_store_dwordx4 v[8:11], v5, s[8:11], s43 offen offset:2048 sc1
    buffer_store_dwordx4 v[8:11], v5, s[8:11], s43 offen offset:3072 sc1
    buffer_store_dwordx4 v[8:11], v5, s[8:11], s46 offen offset:0 sc1
    buffer_store_dwordx4 v[8:11], v5, s[8:11], s46 offen offset:1024 sc1
    buffer_store_dwordx4 v[8:11], v5, s[8:11], s46 offen offset:2048 sc1
    buffer_store_dwordx4 v[8:11], v5, s[8:11], s46 offen offset:3072 sc1
    s_add_u32 s43, s41, s66
    s_xor_b32 s43, s43, s71
    s_add_u32 s46, s43, 4096
    buffer_store_dwordx4 v[8:11], v5, s[8:11], s43 offen offset:0 sc1
    buffer_store_dwordx4 v[8:11], v5, s[8:11], s43 offen offset:1024 sc1
    buffer_store_dwordx4 v[8:11], v5, s[8:11], s43 offen offset:2048 sc1
    buffer_store_dwordx4 v[8:11], v5, s[8:11], s43 offen offset:3072 sc1
    buffer_store_dwordx4 v[8:11], v5, s[8:11], s46 offen offset:0 sc1
    buffer_store_dwordx4 v[8:11], v5, s[8:11], s46 offen offset:1024 sc1
    buffer_store_dwordx4 v[8:11], v5, s[8:11], s46 offen offset:2048 sc1
    buffer_store_dwordx4 v[8:11], v5, s[8:11], s46 offen offset:3072 sc1
    s_add_u32 s43, s41, s67
    s_xor_b32 s43, s43, s72
    s_add_u32 s46, s43, 4096
    buffer_store_dwordx4 v[8:11], v5, s[8:11], s43 offen offset:0 sc1
    buffer_store_dwordx4 v[8:11], v5, s[8:11], s43 offen offset:1024 sc1
    buffer_store_dwordx4 v[8:11], v5, s[8:11], s43 offen offset:2048 sc1
    buffer_store_dwordx4 v[8:11], v5, s[8:11], s43 offen offset:3072 sc1
    buffer_store_dwordx4 v[8:11], v5, s[8:11], s46 offen offset:0 sc1
    buffer_store_dwordx4 v[8:11], v5, s[8:11], s46 offen offset:1024 sc1
    buffer_store_dwordx4 v[8:11], v5, s[8:11], s46 offen offset:2048 sc1
    buffer_store_dwordx4 v[8:11], v5, s[8:11], s46 offen offset:3072 sc1
    s_add_u32 s43, s41, s68
    s_xor_b32 s43, s43, s73
    s_add_u32 s46, s43, 4096
    buffer_store_dwordx4 v[8:11], v5, s[8:11], s43 offen offset:0 sc1
    buffer_store_dwordx4 v[8:11], v5, s[8:11], s43 offen offset:1024 sc1
    buffer_store_dwordx4 v[8:11], v5, s[8:11], s43 offen offset:2048 sc1
    buffer_store_dwordx4 v[8:11], v5, s[8:11], s43 offen offset:3072 sc1
    buffer_store_dwordx4 v[8:11], v5, s[8:11], s46 offen offset:0 sc1
    buffer_store_dwordx4 v[8:11], v5, s[8:11], s46 offen offset:1024 sc1
    buffer_store_dwordx4 v[8:11], v5, s[8:11], s46 offen offset:2048 sc1
    buffer_store_dwordx4 v[8:11], v5, s[8:11], s46 offen offset:3072 sc1
    s_waitcnt vmcnt(0)
    s_barrier
    s_add_u32 s40, s40, 1
    s_cmp_eq_u32 s3, 0
    s_cbranch_scc0 interleave_layers__linear_attn_block__memory_aug_recurrent_mem_tr__prompt_kernel_pb17
    v_lshlrev_b32 v14, 7, v1
    v_add_u32 v14, s42, v14
    v_mov_b32 v15, 2146435072
    v_cmp_le_u32 vcc, 8, v1
    s_nop 1
    v_cndmask_b32 v14, v14, v15, vcc
    v_mov_b32 v15, s40
    buffer_store_dword v15, v14, s[8:11], 0 offen sc1
interleave_layers__linear_attn_block__memory_aug_recurrent_mem_tr__prompt_kernel_pb17:
    s_cmp_lt_u32 s40, 128
    s_cbranch_scc1 interleave_layers__linear_attn_block__memory_aug_recurrent_mem_tr__prompt_kernel_clr_blk2
    s_waitcnt vmcnt(0)
    s_branch interleave_layers__linear_attn_block__memory_aug_recurrent_mem_tr__prompt_kernel_end
interleave_layers__linear_attn_block__memory_aug_recurrent_mem_tr__prompt_kernel_roleS:
    s_mov_b32 s44, s2
    s_load_dwordx2 s[6:7], s[0:1], 40
    s_load_dwordx2 s[24:25], s[0:1], 48
    s_load_dwordx2 s[26:27], s[0:1], 32
    s_waitcnt lgkmcnt(0)
    s_mov_b32 s12, s6
    s_mov_b32 s13, s7
    s_mov_b32 s14, 7864320
    s_mov_b32 s15, 0x00020000
    s_mov_b32 s16, s24
    s_mov_b32 s17, s25
    s_mov_b32 s18, 7864320
    s_mov_b32 s19, 0x00020000
    s_mov_b32 s20, s26
    s_mov_b32 s21, s27
    s_mov_b32 s22, 10240
    s_mov_b32 s23, 0x00020000
    v_add_u32 v16, 0, v0
    s_mov_b32 s24, 683
    v_mul_lo_u32 v17, v16, s24
    v_lshrrev_b32 v17, 14, v17
    v_mul_u32_u24 v18, 24, v17
    v_sub_u32 v18, v16, v18
    s_mov_b32 s24, 12288
    v_mul_lo_u32 v4, v17, s24
    v_lshl_add_u32 v4, v18, 4, v4
    v_mul_u32_u24 v10, 400, v17
    v_lshl_add_u32 v10, v18, 4, v10
    v_add_u32 v10, 106496, v10
    v_add_u32 v16, 256, v0
    s_mov_b32 s24, 683
    v_mul_lo_u32 v17, v16, s24
    v_lshrrev_b32 v17, 14, v17
    v_mul_u32_u24 v18, 24, v17
    v_sub_u32 v18, v16, v18
    s_mov_b32 s24, 12288
    v_mul_lo_u32 v5, v17, s24
    v_lshl_add_u32 v5, v18, 4, v5
    v_mul_u32_u24 v11, 400, v17
    v_lshl_add_u32 v11, v18, 4, v11
    v_add_u32 v11, 106496, v11
    v_add_u32 v16, 512, v0
    s_mov_b32 s24, 683
    v_mul_lo_u32 v17, v16, s24
    v_lshrrev_b32 v17, 14, v17
    v_mul_u32_u24 v18, 24, v17
    v_sub_u32 v18, v16, v18
    s_mov_b32 s24, 12288
    v_mul_lo_u32 v6, v17, s24
    v_lshl_add_u32 v6, v18, 4, v6
    v_mul_u32_u24 v12, 400, v17
    v_lshl_add_u32 v12, v18, 4, v12
    v_add_u32 v12, 106496, v12
    v_add_u32 v16, 768, v0
    s_mov_b32 s24, 683
    v_mul_lo_u32 v17, v16, s24
    v_lshrrev_b32 v17, 14, v17
    v_mul_u32_u24 v18, 24, v17
    v_sub_u32 v18, v16, v18
    s_mov_b32 s24, 12288
    v_mul_lo_u32 v7, v17, s24
    v_lshl_add_u32 v7, v18, 4, v7
    v_mul_u32_u24 v13, 400, v17
    v_lshl_add_u32 v13, v18, 4, v13
    v_add_u32 v13, 106496, v13
    v_add_u32 v16, 1024, v0
    s_mov_b32 s24, 683
    v_mul_lo_u32 v17, v16, s24
    v_lshrrev_b32 v17, 14, v17
    v_mul_u32_u24 v18, 24, v17
    v_sub_u32 v18, v16, v18
    s_mov_b32 s24, 12288
    v_mul_lo_u32 v8, v17, s24
    v_lshl_add_u32 v8, v18, 4, v8
    v_mul_u32_u24 v14, 400, v17
    v_lshl_add_u32 v14, v18, 4, v14
    v_add_u32 v14, 106496, v14
    v_add_u32 v16, 1280, v0
    s_mov_b32 s24, 683
    v_mul_lo_u32 v17, v16, s24
    v_lshrrev_b32 v17, 14, v17
    v_mul_u32_u24 v18, 24, v17
    v_sub_u32 v18, v16, v18
    s_mov_b32 s24, 12288
    v_mul_lo_u32 v9, v17, s24
    v_lshl_add_u32 v9, v18, 4, v9
    v_mul_u32_u24 v15, 400, v17
    v_lshl_add_u32 v15, v18, 4, v15
    v_add_u32 v15, 106496, v15
    v_lshrrev_b32 v17, 1, v3
    v_lshlrev_b32 v17, 4, v17
    v_and_b32 v18, 1, v3
    v_lshl_add_u32 v17, v18, 2, v17
    v_lshrrev_b32 v18, 2, v2
    v_and_b32 v19, 1, v18
    v_add_u32 v17, v17, v19
    v_lshrrev_b32 v18, 1, v18
    v_lshl_add_u32 v17, v18, 3, v17
    v_mul_u32_u24 v16, 400, v17
    v_and_b32 v18, 3, v2
    v_lshl_add_u32 v16, v18, 3, v16
    v_add_u32 v16, 106496, v16
    s_mul_i32 s24, s3, 96
    v_add_u32 v16, s24, v16
    v_lshlrev_b32 v17, 4, v1
    s_mul_i32 s24, s3, 20480
    s_add_u32 s24, s24, 24576
    v_add_u32 v17, s24, v17
    s_mul_i32 s45, s44, 384
    s_add_u32 s46, s45, 0
    buffer_load_dwordx4 v[24:27], v4, s[12:15], s46 offen
    buffer_load_dwordx4 v[28:31], v5, s[12:15], s46 offen
    buffer_load_dwordx4 v[32:35], v6, s[12:15], s46 offen
    buffer_load_dwordx4 v[36:39], v7, s[12:15], s46 offen
    buffer_load_dwordx4 v[40:43], v8, s[12:15], s46 offen
    buffer_load_dwordx4 v[44:47], v9, s[12:15], s46 offen
    s_add_u32 s46, s45, 0
    buffer_load_dwordx4 v[48:51], v4, s[16:19], s46 offen
    buffer_load_dwordx4 v[52:55], v5, s[16:19], s46 offen
    buffer_load_dwordx4 v[56:59], v6, s[16:19], s46 offen
    buffer_load_dwordx4 v[60:63], v7, s[16:19], s46 offen
    buffer_load_dwordx4 v[64:67], v8, s[16:19], s46 offen
    buffer_load_dwordx4 v[68:71], v9, s[16:19], s46 offen
    s_waitcnt vmcnt(6)
    ds_write_b128 v10, v[24:27]
    ds_write_b128 v11, v[28:31]
    ds_write_b128 v12, v[32:35]
    ds_write_b128 v13, v[36:39]
    ds_write_b128 v14, v[40:43]
    ds_write_b128 v15, v[44:47]
    s_add_u32 s46, s45, 786432
    buffer_load_dwordx4 v[72:75], v4, s[12:15], s46 offen
    buffer_load_dwordx4 v[76:79], v5, s[12:15], s46 offen
    buffer_load_dwordx4 v[80:83], v6, s[12:15], s46 offen
    buffer_load_dwordx4 v[84:87], v7, s[12:15], s46 offen
    buffer_load_dwordx4 v[88:91], v8, s[12:15], s46 offen
    buffer_load_dwordx4 v[92:95], v9, s[12:15], s46 offen
    s_waitcnt lgkmcnt(0)
    s_barrier
    ds_read_b64_tr_b16 a[0:1], v16 offset:0
    ds_read_b64_tr_b16 a[2:3], v16 offset:800
    ds_read_b64_tr_b16 a[4:5], v16 offset:12800
    ds_read_b64_tr_b16 a[6:7], v16 offset:13600
    ds_read_b64_tr_b16 a[80:81], v16 offset:32
    ds_read_b64_tr_b16 a[82:83], v16 offset:832
    ds_read_b64_tr_b16 a[84:85], v16 offset:12832
    ds_read_b64_tr_b16 a[86:87], v16 offset:13632
    ds_read_b64_tr_b16 a[160:161], v16 offset:64
    ds_read_b64_tr_b16 a[162:163], v16 offset:864
    ds_read_b64_tr_b16 a[164:165], v16 offset:12864
    ds_read_b64_tr_b16 a[166:167], v16 offset:13664
    s_waitcnt lgkmcnt(0)
    s_barrier
    s_waitcnt vmcnt(6)
    ds_write_b128 v10, v[48:51]
    ds_write_b128 v11, v[52:55]
    ds_write_b128 v12, v[56:59]
    ds_write_b128 v13, v[60:63]
    ds_write_b128 v14, v[64:67]
    ds_write_b128 v15, v[68:71]
    s_add_u32 s46, s45, 786432
    buffer_load_dwordx4 v[24:27], v4, s[16:19], s46 offen
    buffer_load_dwordx4 v[28:31], v5, s[16:19], s46 offen
    buffer_load_dwordx4 v[32:35], v6, s[16:19], s46 offen
    buffer_load_dwordx4 v[36:39], v7, s[16:19], s46 offen
    buffer_load_dwordx4 v[40:43], v8, s[16:19], s46 offen
    buffer_load_dwordx4 v[44:47], v9, s[16:19], s46 offen
    s_waitcnt lgkmcnt(0)
    s_barrier
    ds_read_b64_tr_b16 v[96:97], v16 offset:32
    ds_read_b64_tr_b16 v[98:99], v16 offset:832
    ds_read_b64_tr_b16 v[100:101], v16 offset:12832
    ds_read_b64_tr_b16 v[102:103], v16 offset:13632
    ds_read_b64_tr_b16 v[176:177], v16 offset:64
    ds_read_b64_tr_b16 v[178:179], v16 offset:864
    ds_read_b64_tr_b16 v[180:181], v16 offset:12864
    ds_read_b64_tr_b16 v[182:183], v16 offset:13664
    ds_read_b64_tr_b16 v[48:49], v16 offset:0
    ds_read_b64_tr_b16 v[50:51], v16 offset:800
    ds_read_b64_tr_b16 v[52:53], v16 offset:12800
    ds_read_b64_tr_b16 v[54:55], v16 offset:13600
    s_waitcnt lgkmcnt(0)
    ds_write_b128 v17, v[48:51] offset:0
    ds_write_b128 v17, v[52:55] offset:1024
    s_waitcnt lgkmcnt(0)
    s_barrier
    s_waitcnt vmcnt(6)
    ds_write_b128 v10, v[72:75]
    ds_write_b128 v11, v[76:79]
    ds_write_b128 v12, v[80:83]
    ds_write_b128 v13, v[84:87]
    ds_write_b128 v14, v[88:91]
    ds_write_b128 v15, v[92:95]
    s_add_u32 s46, s45, 1572864
    buffer_load_dwordx4 v[48:51], v4, s[12:15], s46 offen
    buffer_load_dwordx4 v[52:55], v5, s[12:15], s46 offen
    buffer_load_dwordx4 v[56:59], v6, s[12:15], s46 offen
    buffer_load_dwordx4 v[60:63], v7, s[12:15], s46 offen
    buffer_load_dwordx4 v[64:67], v8, s[12:15], s46 offen
    buffer_load_dwordx4 v[68:71], v9, s[12:15], s46 offen
    s_waitcnt lgkmcnt(0)
    s_barrier
    ds_read_b64_tr_b16 a[8:9], v16 offset:0
    ds_read_b64_tr_b16 a[10:11], v16 offset:800
    ds_read_b64_tr_b16 a[12:13], v16 offset:12800
    ds_read_b64_tr_b16 a[14:15], v16 offset:13600
    ds_read_b64_tr_b16 a[88:89], v16 offset:32
    ds_read_b64_tr_b16 a[90:91], v16 offset:832
    ds_read_b64_tr_b16 a[92:93], v16 offset:12832
    ds_read_b64_tr_b16 a[94:95], v16 offset:13632
    ds_read_b64_tr_b16 a[168:169], v16 offset:64
    ds_read_b64_tr_b16 a[170:171], v16 offset:864
    ds_read_b64_tr_b16 a[172:173], v16 offset:12864
    ds_read_b64_tr_b16 a[174:175], v16 offset:13664
    s_waitcnt lgkmcnt(0)
    s_barrier
    s_waitcnt vmcnt(6)
    ds_write_b128 v10, v[24:27]
    ds_write_b128 v11, v[28:31]
    ds_write_b128 v12, v[32:35]
    ds_write_b128 v13, v[36:39]
    ds_write_b128 v14, v[40:43]
    ds_write_b128 v15, v[44:47]
    s_add_u32 s46, s45, 1572864
    buffer_load_dwordx4 v[72:75], v4, s[16:19], s46 offen
    buffer_load_dwordx4 v[76:79], v5, s[16:19], s46 offen
    buffer_load_dwordx4 v[80:83], v6, s[16:19], s46 offen
    buffer_load_dwordx4 v[84:87], v7, s[16:19], s46 offen
    buffer_load_dwordx4 v[88:91], v8, s[16:19], s46 offen
    buffer_load_dwordx4 v[92:95], v9, s[16:19], s46 offen
    s_waitcnt lgkmcnt(0)
    s_barrier
    ds_read_b64_tr_b16 v[104:105], v16 offset:32
    ds_read_b64_tr_b16 v[106:107], v16 offset:832
    ds_read_b64_tr_b16 v[108:109], v16 offset:12832
    ds_read_b64_tr_b16 v[110:111], v16 offset:13632
    ds_read_b64_tr_b16 v[184:185], v16 offset:64
    ds_read_b64_tr_b16 v[186:187], v16 offset:864
    ds_read_b64_tr_b16 v[188:189], v16 offset:12864
    ds_read_b64_tr_b16 v[190:191], v16 offset:13664
    ds_read_b64_tr_b16 v[24:25], v16 offset:0
    ds_read_b64_tr_b16 v[26:27], v16 offset:800
    ds_read_b64_tr_b16 v[28:29], v16 offset:12800
    ds_read_b64_tr_b16 v[30:31], v16 offset:13600
    s_waitcnt lgkmcnt(0)
    ds_write_b128 v17, v[24:27] offset:2048
    ds_write_b128 v17, v[28:31] offset:3072
    s_waitcnt lgkmcnt(0)
    s_barrier
    s_waitcnt vmcnt(6)
    ds_write_b128 v10, v[48:51]
    ds_write_b128 v11, v[52:55]
    ds_write_b128 v12, v[56:59]
    ds_write_b128 v13, v[60:63]
    ds_write_b128 v14, v[64:67]
    ds_write_b128 v15, v[68:71]
    s_add_u32 s46, s45, 2359296
    buffer_load_dwordx4 v[24:27], v4, s[12:15], s46 offen
    buffer_load_dwordx4 v[28:31], v5, s[12:15], s46 offen
    buffer_load_dwordx4 v[32:35], v6, s[12:15], s46 offen
    buffer_load_dwordx4 v[36:39], v7, s[12:15], s46 offen
    buffer_load_dwordx4 v[40:43], v8, s[12:15], s46 offen
    buffer_load_dwordx4 v[44:47], v9, s[12:15], s46 offen
    s_waitcnt lgkmcnt(0)
    s_barrier
    ds_read_b64_tr_b16 a[16:17], v16 offset:0
    ds_read_b64_tr_b16 a[18:19], v16 offset:800
    ds_read_b64_tr_b16 a[20:21], v16 offset:12800
    ds_read_b64_tr_b16 a[22:23], v16 offset:13600
    ds_read_b64_tr_b16 a[96:97], v16 offset:32
    ds_read_b64_tr_b16 a[98:99], v16 offset:832
    ds_read_b64_tr_b16 a[100:101], v16 offset:12832
    ds_read_b64_tr_b16 a[102:103], v16 offset:13632
    ds_read_b64_tr_b16 a[176:177], v16 offset:64
    ds_read_b64_tr_b16 a[178:179], v16 offset:864
    ds_read_b64_tr_b16 a[180:181], v16 offset:12864
    ds_read_b64_tr_b16 a[182:183], v16 offset:13664
    s_waitcnt lgkmcnt(0)
    s_barrier
    s_waitcnt vmcnt(6)
    ds_write_b128 v10, v[72:75]
    ds_write_b128 v11, v[76:79]
    ds_write_b128 v12, v[80:83]
    ds_write_b128 v13, v[84:87]
    ds_write_b128 v14, v[88:91]
    ds_write_b128 v15, v[92:95]
    s_add_u32 s46, s45, 2359296
    buffer_load_dwordx4 v[48:51], v4, s[16:19], s46 offen
    buffer_load_dwordx4 v[52:55], v5, s[16:19], s46 offen
    buffer_load_dwordx4 v[56:59], v6, s[16:19], s46 offen
    buffer_load_dwordx4 v[60:63], v7, s[16:19], s46 offen
    buffer_load_dwordx4 v[64:67], v8, s[16:19], s46 offen
    buffer_load_dwordx4 v[68:71], v9, s[16:19], s46 offen
    s_waitcnt lgkmcnt(0)
    s_barrier
    ds_read_b64_tr_b16 v[112:113], v16 offset:32
    ds_read_b64_tr_b16 v[114:115], v16 offset:832
    ds_read_b64_tr_b16 v[116:117], v16 offset:12832
    ds_read_b64_tr_b16 v[118:119], v16 offset:13632
    ds_read_b64_tr_b16 v[192:193], v16 offset:64
    ds_read_b64_tr_b16 v[194:195], v16 offset:864
    ds_read_b64_tr_b16 v[196:197], v16 offset:12864
    ds_read_b64_tr_b16 v[198:199], v16 offset:13664
    ds_read_b64_tr_b16 v[72:73], v16 offset:0
    ds_read_b64_tr_b16 v[74:75], v16 offset:800
    ds_read_b64_tr_b16 v[76:77], v16 offset:12800
    ds_read_b64_tr_b16 v[78:79], v16 offset:13600
    s_waitcnt lgkmcnt(0)
    ds_write_b128 v17, v[72:75] offset:4096
    ds_write_b128 v17, v[76:79] offset:5120
    s_waitcnt lgkmcnt(0)
    s_barrier
    s_waitcnt vmcnt(6)
    ds_write_b128 v10, v[24:27]
    ds_write_b128 v11, v[28:31]
    ds_write_b128 v12, v[32:35]
    ds_write_b128 v13, v[36:39]
    ds_write_b128 v14, v[40:43]
    ds_write_b128 v15, v[44:47]
    s_add_u32 s46, s45, 3145728
    buffer_load_dwordx4 v[72:75], v4, s[12:15], s46 offen
    buffer_load_dwordx4 v[76:79], v5, s[12:15], s46 offen
    buffer_load_dwordx4 v[80:83], v6, s[12:15], s46 offen
    buffer_load_dwordx4 v[84:87], v7, s[12:15], s46 offen
    buffer_load_dwordx4 v[88:91], v8, s[12:15], s46 offen
    buffer_load_dwordx4 v[92:95], v9, s[12:15], s46 offen
    s_waitcnt lgkmcnt(0)
    s_barrier
    ds_read_b64_tr_b16 a[24:25], v16 offset:0
    ds_read_b64_tr_b16 a[26:27], v16 offset:800
    ds_read_b64_tr_b16 a[28:29], v16 offset:12800
    ds_read_b64_tr_b16 a[30:31], v16 offset:13600
    ds_read_b64_tr_b16 a[104:105], v16 offset:32
    ds_read_b64_tr_b16 a[106:107], v16 offset:832
    ds_read_b64_tr_b16 a[108:109], v16 offset:12832
    ds_read_b64_tr_b16 a[110:111], v16 offset:13632
    ds_read_b64_tr_b16 a[184:185], v16 offset:64
    ds_read_b64_tr_b16 a[186:187], v16 offset:864
    ds_read_b64_tr_b16 a[188:189], v16 offset:12864
    ds_read_b64_tr_b16 a[190:191], v16 offset:13664
    s_waitcnt lgkmcnt(0)
    s_barrier
    s_waitcnt vmcnt(6)
    ds_write_b128 v10, v[48:51]
    ds_write_b128 v11, v[52:55]
    ds_write_b128 v12, v[56:59]
    ds_write_b128 v13, v[60:63]
    ds_write_b128 v14, v[64:67]
    ds_write_b128 v15, v[68:71]
    s_add_u32 s46, s45, 3145728
    buffer_load_dwordx4 v[24:27], v4, s[16:19], s46 offen
    buffer_load_dwordx4 v[28:31], v5, s[16:19], s46 offen
    buffer_load_dwordx4 v[32:35], v6, s[16:19], s46 offen
    buffer_load_dwordx4 v[36:39], v7, s[16:19], s46 offen
    buffer_load_dwordx4 v[40:43], v8, s[16:19], s46 offen
    buffer_load_dwordx4 v[44:47], v9, s[16:19], s46 offen
    s_waitcnt lgkmcnt(0)
    s_barrier
    ds_read_b64_tr_b16 v[120:121], v16 offset:32
    ds_read_b64_tr_b16 v[122:123], v16 offset:832
    ds_read_b64_tr_b16 v[124:125], v16 offset:12832
    ds_read_b64_tr_b16 v[126:127], v16 offset:13632
    ds_read_b64_tr_b16 v[200:201], v16 offset:64
    ds_read_b64_tr_b16 v[202:203], v16 offset:864
    ds_read_b64_tr_b16 v[204:205], v16 offset:12864
    ds_read_b64_tr_b16 v[206:207], v16 offset:13664
    ds_read_b64_tr_b16 v[48:49], v16 offset:0
    ds_read_b64_tr_b16 v[50:51], v16 offset:800
    ds_read_b64_tr_b16 v[52:53], v16 offset:12800
    ds_read_b64_tr_b16 v[54:55], v16 offset:13600
    s_waitcnt lgkmcnt(0)
    ds_write_b128 v17, v[48:51] offset:6144
    ds_write_b128 v17, v[52:55] offset:7168
    s_waitcnt lgkmcnt(0)
    s_barrier
    s_waitcnt vmcnt(6)
    ds_write_b128 v10, v[72:75]
    ds_write_b128 v11, v[76:79]
    ds_write_b128 v12, v[80:83]
    ds_write_b128 v13, v[84:87]
    ds_write_b128 v14, v[88:91]
    ds_write_b128 v15, v[92:95]
    s_add_u32 s46, s45, 3932160
    buffer_load_dwordx4 v[48:51], v4, s[12:15], s46 offen
    buffer_load_dwordx4 v[52:55], v5, s[12:15], s46 offen
    buffer_load_dwordx4 v[56:59], v6, s[12:15], s46 offen
    buffer_load_dwordx4 v[60:63], v7, s[12:15], s46 offen
    buffer_load_dwordx4 v[64:67], v8, s[12:15], s46 offen
    buffer_load_dwordx4 v[68:71], v9, s[12:15], s46 offen
    s_waitcnt lgkmcnt(0)
    s_barrier
    ds_read_b64_tr_b16 a[32:33], v16 offset:0
    ds_read_b64_tr_b16 a[34:35], v16 offset:800
    ds_read_b64_tr_b16 a[36:37], v16 offset:12800
    ds_read_b64_tr_b16 a[38:39], v16 offset:13600
    ds_read_b64_tr_b16 a[112:113], v16 offset:32
    ds_read_b64_tr_b16 a[114:115], v16 offset:832
    ds_read_b64_tr_b16 a[116:117], v16 offset:12832
    ds_read_b64_tr_b16 a[118:119], v16 offset:13632
    ds_read_b64_tr_b16 a[192:193], v16 offset:64
    ds_read_b64_tr_b16 a[194:195], v16 offset:864
    ds_read_b64_tr_b16 a[196:197], v16 offset:12864
    ds_read_b64_tr_b16 a[198:199], v16 offset:13664
    s_waitcnt lgkmcnt(0)
    s_barrier
    s_waitcnt vmcnt(6)
    ds_write_b128 v10, v[24:27]
    ds_write_b128 v11, v[28:31]
    ds_write_b128 v12, v[32:35]
    ds_write_b128 v13, v[36:39]
    ds_write_b128 v14, v[40:43]
    ds_write_b128 v15, v[44:47]
    s_add_u32 s46, s45, 3932160
    buffer_load_dwordx4 v[72:75], v4, s[16:19], s46 offen
    buffer_load_dwordx4 v[76:79], v5, s[16:19], s46 offen
    buffer_load_dwordx4 v[80:83], v6, s[16:19], s46 offen
    buffer_load_dwordx4 v[84:87], v7, s[16:19], s46 offen
    buffer_load_dwordx4 v[88:91], v8, s[16:19], s46 offen
    buffer_load_dwordx4 v[92:95], v9, s[16:19], s46 offen
    s_waitcnt lgkmcnt(0)
    s_barrier
    ds_read_b64_tr_b16 v[128:129], v16 offset:32
    ds_read_b64_tr_b16 v[130:131], v16 offset:832
    ds_read_b64_tr_b16 v[132:133], v16 offset:12832
    ds_read_b64_tr_b16 v[134:135], v16 offset:13632
    ds_read_b64_tr_b16 v[208:209], v16 offset:64
    ds_read_b64_tr_b16 v[210:211], v16 offset:864
    ds_read_b64_tr_b16 v[212:213], v16 offset:12864
    ds_read_b64_tr_b16 v[214:215], v16 offset:13664
    ds_read_b64_tr_b16 v[24:25], v16 offset:0
    ds_read_b64_tr_b16 v[26:27], v16 offset:800
    ds_read_b64_tr_b16 v[28:29], v16 offset:12800
    ds_read_b64_tr_b16 v[30:31], v16 offset:13600
    s_waitcnt lgkmcnt(0)
    ds_write_b128 v17, v[24:27] offset:8192
    ds_write_b128 v17, v[28:31] offset:9216
    s_waitcnt lgkmcnt(0)
    s_barrier
    s_waitcnt vmcnt(6)
    ds_write_b128 v10, v[48:51]
    ds_write_b128 v11, v[52:55]
    ds_write_b128 v12, v[56:59]
    ds_write_b128 v13, v[60:63]
    ds_write_b128 v14, v[64:67]
    ds_write_b128 v15, v[68:71]
    s_add_u32 s46, s45, 4718592
    buffer_load_dwordx4 v[24:27], v4, s[12:15], s46 offen
    buffer_load_dwordx4 v[28:31], v5, s[12:15], s46 offen
    buffer_load_dwordx4 v[32:35], v6, s[12:15], s46 offen
    buffer_load_dwordx4 v[36:39], v7, s[12:15], s46 offen
    buffer_load_dwordx4 v[40:43], v8, s[12:15], s46 offen
    buffer_load_dwordx4 v[44:47], v9, s[12:15], s46 offen
    s_waitcnt lgkmcnt(0)
    s_barrier
    ds_read_b64_tr_b16 a[40:41], v16 offset:0
    ds_read_b64_tr_b16 a[42:43], v16 offset:800
    ds_read_b64_tr_b16 a[44:45], v16 offset:12800
    ds_read_b64_tr_b16 a[46:47], v16 offset:13600
    ds_read_b64_tr_b16 a[120:121], v16 offset:32
    ds_read_b64_tr_b16 a[122:123], v16 offset:832
    ds_read_b64_tr_b16 a[124:125], v16 offset:12832
    ds_read_b64_tr_b16 a[126:127], v16 offset:13632
    ds_read_b64_tr_b16 a[200:201], v16 offset:64
    ds_read_b64_tr_b16 a[202:203], v16 offset:864
    ds_read_b64_tr_b16 a[204:205], v16 offset:12864
    ds_read_b64_tr_b16 a[206:207], v16 offset:13664
    s_waitcnt lgkmcnt(0)
    s_barrier
    s_waitcnt vmcnt(6)
    ds_write_b128 v10, v[72:75]
    ds_write_b128 v11, v[76:79]
    ds_write_b128 v12, v[80:83]
    ds_write_b128 v13, v[84:87]
    ds_write_b128 v14, v[88:91]
    ds_write_b128 v15, v[92:95]
    s_add_u32 s46, s45, 4718592
    buffer_load_dwordx4 v[48:51], v4, s[16:19], s46 offen
    buffer_load_dwordx4 v[52:55], v5, s[16:19], s46 offen
    buffer_load_dwordx4 v[56:59], v6, s[16:19], s46 offen
    buffer_load_dwordx4 v[60:63], v7, s[16:19], s46 offen
    buffer_load_dwordx4 v[64:67], v8, s[16:19], s46 offen
    buffer_load_dwordx4 v[68:71], v9, s[16:19], s46 offen
    s_waitcnt lgkmcnt(0)
    s_barrier
    ds_read_b64_tr_b16 v[136:137], v16 offset:32
    ds_read_b64_tr_b16 v[138:139], v16 offset:832
    ds_read_b64_tr_b16 v[140:141], v16 offset:12832
    ds_read_b64_tr_b16 v[142:143], v16 offset:13632
    ds_read_b64_tr_b16 v[216:217], v16 offset:64
    ds_read_b64_tr_b16 v[218:219], v16 offset:864
    ds_read_b64_tr_b16 v[220:221], v16 offset:12864
    ds_read_b64_tr_b16 v[222:223], v16 offset:13664
    ds_read_b64_tr_b16 v[72:73], v16 offset:0
    ds_read_b64_tr_b16 v[74:75], v16 offset:800
    ds_read_b64_tr_b16 v[76:77], v16 offset:12800
    ds_read_b64_tr_b16 v[78:79], v16 offset:13600
    s_waitcnt lgkmcnt(0)
    ds_write_b128 v17, v[72:75] offset:10240
    ds_write_b128 v17, v[76:79] offset:11264
    s_waitcnt lgkmcnt(0)
    s_barrier
    s_waitcnt vmcnt(6)
    ds_write_b128 v10, v[24:27]
    ds_write_b128 v11, v[28:31]
    ds_write_b128 v12, v[32:35]
    ds_write_b128 v13, v[36:39]
    ds_write_b128 v14, v[40:43]
    ds_write_b128 v15, v[44:47]
    s_add_u32 s46, s45, 5505024
    buffer_load_dwordx4 v[72:75], v4, s[12:15], s46 offen
    buffer_load_dwordx4 v[76:79], v5, s[12:15], s46 offen
    buffer_load_dwordx4 v[80:83], v6, s[12:15], s46 offen
    buffer_load_dwordx4 v[84:87], v7, s[12:15], s46 offen
    buffer_load_dwordx4 v[88:91], v8, s[12:15], s46 offen
    buffer_load_dwordx4 v[92:95], v9, s[12:15], s46 offen
    s_waitcnt lgkmcnt(0)
    s_barrier
    ds_read_b64_tr_b16 a[48:49], v16 offset:0
    ds_read_b64_tr_b16 a[50:51], v16 offset:800
    ds_read_b64_tr_b16 a[52:53], v16 offset:12800
    ds_read_b64_tr_b16 a[54:55], v16 offset:13600
    ds_read_b64_tr_b16 a[128:129], v16 offset:32
    ds_read_b64_tr_b16 a[130:131], v16 offset:832
    ds_read_b64_tr_b16 a[132:133], v16 offset:12832
    ds_read_b64_tr_b16 a[134:135], v16 offset:13632
    ds_read_b64_tr_b16 a[208:209], v16 offset:64
    ds_read_b64_tr_b16 a[210:211], v16 offset:864
    ds_read_b64_tr_b16 a[212:213], v16 offset:12864
    ds_read_b64_tr_b16 a[214:215], v16 offset:13664
    s_waitcnt lgkmcnt(0)
    s_barrier
    s_waitcnt vmcnt(6)
    ds_write_b128 v10, v[48:51]
    ds_write_b128 v11, v[52:55]
    ds_write_b128 v12, v[56:59]
    ds_write_b128 v13, v[60:63]
    ds_write_b128 v14, v[64:67]
    ds_write_b128 v15, v[68:71]
    s_add_u32 s46, s45, 5505024
    buffer_load_dwordx4 v[24:27], v4, s[16:19], s46 offen
    buffer_load_dwordx4 v[28:31], v5, s[16:19], s46 offen
    buffer_load_dwordx4 v[32:35], v6, s[16:19], s46 offen
    buffer_load_dwordx4 v[36:39], v7, s[16:19], s46 offen
    buffer_load_dwordx4 v[40:43], v8, s[16:19], s46 offen
    buffer_load_dwordx4 v[44:47], v9, s[16:19], s46 offen
    s_waitcnt lgkmcnt(0)
    s_barrier
    ds_read_b64_tr_b16 v[144:145], v16 offset:32
    ds_read_b64_tr_b16 v[146:147], v16 offset:832
    ds_read_b64_tr_b16 v[148:149], v16 offset:12832
    ds_read_b64_tr_b16 v[150:151], v16 offset:13632
    ds_read_b64_tr_b16 v[224:225], v16 offset:64
    ds_read_b64_tr_b16 v[226:227], v16 offset:864
    ds_read_b64_tr_b16 v[228:229], v16 offset:12864
    ds_read_b64_tr_b16 v[230:231], v16 offset:13664
    ds_read_b64_tr_b16 v[48:49], v16 offset:0
    ds_read_b64_tr_b16 v[50:51], v16 offset:800
    ds_read_b64_tr_b16 v[52:53], v16 offset:12800
    ds_read_b64_tr_b16 v[54:55], v16 offset:13600
    s_waitcnt lgkmcnt(0)
    ds_write_b128 v17, v[48:51] offset:12288
    ds_write_b128 v17, v[52:55] offset:13312
    s_waitcnt lgkmcnt(0)
    s_barrier
    s_waitcnt vmcnt(6)
    ds_write_b128 v10, v[72:75]
    ds_write_b128 v11, v[76:79]
    ds_write_b128 v12, v[80:83]
    ds_write_b128 v13, v[84:87]
    ds_write_b128 v14, v[88:91]
    ds_write_b128 v15, v[92:95]
    s_add_u32 s46, s45, 6291456
    buffer_load_dwordx4 v[48:51], v4, s[12:15], s46 offen
    buffer_load_dwordx4 v[52:55], v5, s[12:15], s46 offen
    buffer_load_dwordx4 v[56:59], v6, s[12:15], s46 offen
    buffer_load_dwordx4 v[60:63], v7, s[12:15], s46 offen
    buffer_load_dwordx4 v[64:67], v8, s[12:15], s46 offen
    buffer_load_dwordx4 v[68:71], v9, s[12:15], s46 offen
    s_waitcnt lgkmcnt(0)
    s_barrier
    ds_read_b64_tr_b16 a[56:57], v16 offset:0
    ds_read_b64_tr_b16 a[58:59], v16 offset:800
    ds_read_b64_tr_b16 a[60:61], v16 offset:12800
    ds_read_b64_tr_b16 a[62:63], v16 offset:13600
    ds_read_b64_tr_b16 a[136:137], v16 offset:32
    ds_read_b64_tr_b16 a[138:139], v16 offset:832
    ds_read_b64_tr_b16 a[140:141], v16 offset:12832
    ds_read_b64_tr_b16 a[142:143], v16 offset:13632
    ds_read_b64_tr_b16 a[216:217], v16 offset:64
    ds_read_b64_tr_b16 a[218:219], v16 offset:864
    ds_read_b64_tr_b16 a[220:221], v16 offset:12864
    ds_read_b64_tr_b16 a[222:223], v16 offset:13664
    s_waitcnt lgkmcnt(0)
    s_barrier
    s_waitcnt vmcnt(6)
    ds_write_b128 v10, v[24:27]
    ds_write_b128 v11, v[28:31]
    ds_write_b128 v12, v[32:35]
    ds_write_b128 v13, v[36:39]
    ds_write_b128 v14, v[40:43]
    ds_write_b128 v15, v[44:47]
    s_add_u32 s46, s45, 6291456
    buffer_load_dwordx4 v[72:75], v4, s[16:19], s46 offen
    buffer_load_dwordx4 v[76:79], v5, s[16:19], s46 offen
    buffer_load_dwordx4 v[80:83], v6, s[16:19], s46 offen
    buffer_load_dwordx4 v[84:87], v7, s[16:19], s46 offen
    buffer_load_dwordx4 v[88:91], v8, s[16:19], s46 offen
    buffer_load_dwordx4 v[92:95], v9, s[16:19], s46 offen
    s_waitcnt lgkmcnt(0)
    s_barrier
    ds_read_b64_tr_b16 v[152:153], v16 offset:32
    ds_read_b64_tr_b16 v[154:155], v16 offset:832
    ds_read_b64_tr_b16 v[156:157], v16 offset:12832
    ds_read_b64_tr_b16 v[158:159], v16 offset:13632
    ds_read_b64_tr_b16 v[232:233], v16 offset:64
    ds_read_b64_tr_b16 v[234:235], v16 offset:864
    ds_read_b64_tr_b16 v[236:237], v16 offset:12864
    ds_read_b64_tr_b16 v[238:239], v16 offset:13664
    ds_read_b64_tr_b16 v[24:25], v16 offset:0
    ds_read_b64_tr_b16 v[26:27], v16 offset:800
    ds_read_b64_tr_b16 v[28:29], v16 offset:12800
    ds_read_b64_tr_b16 v[30:31], v16 offset:13600
    s_waitcnt lgkmcnt(0)
    ds_write_b128 v17, v[24:27] offset:14336
    ds_write_b128 v17, v[28:31] offset:15360
    s_waitcnt lgkmcnt(0)
    s_barrier
    s_waitcnt vmcnt(6)
    ds_write_b128 v10, v[48:51]
    ds_write_b128 v11, v[52:55]
    ds_write_b128 v12, v[56:59]
    ds_write_b128 v13, v[60:63]
    ds_write_b128 v14, v[64:67]
    ds_write_b128 v15, v[68:71]
    s_add_u32 s46, s45, 7077888
    buffer_load_dwordx4 v[24:27], v4, s[12:15], s46 offen
    buffer_load_dwordx4 v[28:31], v5, s[12:15], s46 offen
    buffer_load_dwordx4 v[32:35], v6, s[12:15], s46 offen
    buffer_load_dwordx4 v[36:39], v7, s[12:15], s46 offen
    buffer_load_dwordx4 v[40:43], v8, s[12:15], s46 offen
    buffer_load_dwordx4 v[44:47], v9, s[12:15], s46 offen
    s_waitcnt lgkmcnt(0)
    s_barrier
    ds_read_b64_tr_b16 a[64:65], v16 offset:0
    ds_read_b64_tr_b16 a[66:67], v16 offset:800
    ds_read_b64_tr_b16 a[68:69], v16 offset:12800
    ds_read_b64_tr_b16 a[70:71], v16 offset:13600
    ds_read_b64_tr_b16 a[144:145], v16 offset:32
    ds_read_b64_tr_b16 a[146:147], v16 offset:832
    ds_read_b64_tr_b16 a[148:149], v16 offset:12832
    ds_read_b64_tr_b16 a[150:151], v16 offset:13632
    ds_read_b64_tr_b16 a[224:225], v16 offset:64
    ds_read_b64_tr_b16 a[226:227], v16 offset:864
    ds_read_b64_tr_b16 a[228:229], v16 offset:12864
    ds_read_b64_tr_b16 a[230:231], v16 offset:13664
    s_waitcnt lgkmcnt(0)
    s_barrier
    s_waitcnt vmcnt(6)
    ds_write_b128 v10, v[72:75]
    ds_write_b128 v11, v[76:79]
    ds_write_b128 v12, v[80:83]
    ds_write_b128 v13, v[84:87]
    ds_write_b128 v14, v[88:91]
    ds_write_b128 v15, v[92:95]
    s_add_u32 s46, s45, 7077888
    buffer_load_dwordx4 v[48:51], v4, s[16:19], s46 offen
    buffer_load_dwordx4 v[52:55], v5, s[16:19], s46 offen
    buffer_load_dwordx4 v[56:59], v6, s[16:19], s46 offen
    buffer_load_dwordx4 v[60:63], v7, s[16:19], s46 offen
    buffer_load_dwordx4 v[64:67], v8, s[16:19], s46 offen
    buffer_load_dwordx4 v[68:71], v9, s[16:19], s46 offen
    s_waitcnt lgkmcnt(0)
    s_barrier
    ds_read_b64_tr_b16 v[160:161], v16 offset:32
    ds_read_b64_tr_b16 v[162:163], v16 offset:832
    ds_read_b64_tr_b16 v[164:165], v16 offset:12832
    ds_read_b64_tr_b16 v[166:167], v16 offset:13632
    ds_read_b64_tr_b16 v[240:241], v16 offset:64
    ds_read_b64_tr_b16 v[242:243], v16 offset:864
    ds_read_b64_tr_b16 v[244:245], v16 offset:12864
    ds_read_b64_tr_b16 v[246:247], v16 offset:13664
    ds_read_b64_tr_b16 v[72:73], v16 offset:0
    ds_read_b64_tr_b16 v[74:75], v16 offset:800
    ds_read_b64_tr_b16 v[76:77], v16 offset:12800
    ds_read_b64_tr_b16 v[78:79], v16 offset:13600
    s_waitcnt lgkmcnt(0)
    ds_write_b128 v17, v[72:75] offset:16384
    ds_write_b128 v17, v[76:79] offset:17408
    s_waitcnt lgkmcnt(0)
    s_barrier
    s_waitcnt vmcnt(6)
    ds_write_b128 v10, v[24:27]
    ds_write_b128 v11, v[28:31]
    ds_write_b128 v12, v[32:35]
    ds_write_b128 v13, v[36:39]
    ds_write_b128 v14, v[40:43]
    ds_write_b128 v15, v[44:47]
    s_waitcnt lgkmcnt(0)
    s_barrier
    ds_read_b64_tr_b16 a[72:73], v16 offset:0
    ds_read_b64_tr_b16 a[74:75], v16 offset:800
    ds_read_b64_tr_b16 a[76:77], v16 offset:12800
    ds_read_b64_tr_b16 a[78:79], v16 offset:13600
    ds_read_b64_tr_b16 a[152:153], v16 offset:32
    ds_read_b64_tr_b16 a[154:155], v16 offset:832
    ds_read_b64_tr_b16 a[156:157], v16 offset:12832
    ds_read_b64_tr_b16 a[158:159], v16 offset:13632
    ds_read_b64_tr_b16 a[232:233], v16 offset:64
    ds_read_b64_tr_b16 a[234:235], v16 offset:864
    ds_read_b64_tr_b16 a[236:237], v16 offset:12864
    ds_read_b64_tr_b16 a[238:239], v16 offset:13664
    s_waitcnt lgkmcnt(0)
    s_barrier
    s_waitcnt vmcnt(0)
    ds_write_b128 v10, v[48:51]
    ds_write_b128 v11, v[52:55]
    ds_write_b128 v12, v[56:59]
    ds_write_b128 v13, v[60:63]
    ds_write_b128 v14, v[64:67]
    ds_write_b128 v15, v[68:71]
    s_waitcnt lgkmcnt(0)
    s_barrier
    ds_read_b64_tr_b16 v[168:169], v16 offset:32
    ds_read_b64_tr_b16 v[170:171], v16 offset:832
    ds_read_b64_tr_b16 v[172:173], v16 offset:12832
    ds_read_b64_tr_b16 v[174:175], v16 offset:13632
    ds_read_b64_tr_b16 v[248:249], v16 offset:64
    ds_read_b64_tr_b16 v[250:251], v16 offset:864
    ds_read_b64_tr_b16 v[252:253], v16 offset:12864
    ds_read_b64_tr_b16 v[254:255], v16 offset:13664
    ds_read_b64_tr_b16 v[48:49], v16 offset:0
    ds_read_b64_tr_b16 v[50:51], v16 offset:800
    ds_read_b64_tr_b16 v[52:53], v16 offset:12800
    ds_read_b64_tr_b16 v[54:55], v16 offset:13600
    s_waitcnt lgkmcnt(0)
    ds_write_b128 v17, v[48:51] offset:18432
    ds_write_b128 v17, v[52:55] offset:19456
    s_waitcnt lgkmcnt(0)
    s_barrier
    v_mov_b32 v6, v17
    v_mov_b32 v30, 0xeeee
    v_mov_b32 v4, 0x4444
    v_cmp_gt_u32 vcc, 8, v2
    s_nop 1
    v_cndmask_b32 v4, v30, v4, vcc
    v_lshlrev_b32 v5, 4, v1
    s_lshl_b32 s24, s3, 10
    v_add_u32 v7, s24, v5
    s_lshl_b32 s24, s3, 9
    s_add_u32 s24, s24, 8192
    v_lshlrev_b32 v8, 3, v1
    v_add_u32 v8, s24, v8
    v_and_b32 v30, 1, v2
    v_lshlrev_b32 v30, 4, v30
    v_mov_b32 v31, 0x3f80
    v_lshlrev_b32 v31, v30, v31
    v_lshrrev_b32 v30, 2, v2
    v_cmp_eq_u32 vcc, v30, v3
    s_nop 1
    v_cndmask_b32 v31, 0, v31, vcc
    v_and_b32 v30, 2, v2
    v_cmp_eq_u32 vcc, 0, v30
    s_nop 1
    v_cndmask_b32 v10, 0, v31, vcc
    v_cndmask_b32 v11, v31, 0, vcc
    v_add_u32 v33, 22528, v5
    s_mul_i32 s24, s3, 1408
    s_add_u32 s24, s24, 16384
    v_mul_u32_u24 v30, 176, v2
    v_add_u32 v30, s24, v30
    v_lshl_add_u32 v12, v3, 5, v30
    v_cmp_gt_u32 vcc, 8, v2
    s_nop 1
    v_cndmask_b32 v12, v33, v12, vcc
    v_lshl_add_u32 v13, v3, 4, v30
    v_add_u32 v13, 96, v13
    v_cmp_le_u32 s[24:25], 2, v3
    s_and_b64 vcc, vcc, s[24:25]
    v_cndmask_b32 v13, v33, v13, vcc
    s_mul_i32 s24, s3, 5632
    s_add_u32 s24, s24, 106496
    v_mul_u32_u24 v30, 176, v2
    v_add_u32 v30, s24, v30
    v_lshl_add_u32 v16, v3, 5, v30
    v_lshl_add_u32 v17, v3, 4, v30
    v_add_u32 v17, 96, v17
    v_add_u32 v18, 2816, v17
    v_cmp_le_u32 vcc, 2, v3
    s_nop 1
    v_cndmask_b32 v17, v33, v17, vcc
    v_cndmask_b32 v18, v33, v18, vcc
    v_lshrrev_b32 v30, 3, v1
    v_and_b32 v31, 7, v1
    v_min_u32 v32, 4, v31
    v_mul_u32_u24 v14, 176, v30
    v_lshl_add_u32 v14, v32, 5, v14
    s_mul_i32 s24, s3, 1408
    s_add_u32 s24, s24, 106496
    v_add_u32 v21, s24, v14
    v_add_u32 v14, 16384, v14
    v_cmp_gt_u32 s[50:51], 5, v31
    s_lshl_b32 s24, s3, 3
    v_add_u32 v32, s24, v30
    v_lshlrev_b32 v33, 2, v31
    v_sub_u32 v32, v32, v33
    v_mov_b32 v33, 100
    v_cmp_gt_u32 vcc, 4, v31
    s_nop 1
    v_cndmask_b32 v32, v33, v32, vcc
    v_cmp_le_i32 s[64:65], 0, v32
    v_cmp_le_i32 s[66:67], 1, v32
    v_cmp_le_i32 s[68:69], 2, v32
    v_cmp_le_i32 s[70:71], 3, v32
    v_cmp_le_i32 s[72:73], 16, v32
    v_cmp_le_i32 s[74:75], 17, v32
    v_cmp_le_i32 s[76:77], 18, v32
    v_cmp_le_i32 s[78:79], 19, v32
    s_lshr_b32 s24, s44, 1
    s_lshl_b32 s24, s24, 10
    s_and_b32 s25, s44, 1
    s_lshl_b32 s25, s25, 7
    s_add_u32 s24, s24, s25
    v_lshlrev_b32 v15, 8, v31
    v_lshl_add_u32 v15, v30, 4, v15
    v_add_u32 v15, s24, v15
    s_lshr_b32 s24, s44, 3
    s_lshl_b32 s24, s24, 10
    s_and_b32 s25, s44, 3
    s_lshl_b32 s25, s25, 8
    s_add_u32 s24, s24, s25
    s_lshr_b32 s25, s44, 2
    s_and_b32 s25, s25, 1
    s_lshl_b32 s25, s25, 7
    s_add_u32 s24, s24, s25
    s_add_u32 s24, s24, 16384
    v_lshlrev_b32 v32, 4, v30
    v_add_u32 v32, s24, v32
    v_cmp_eq_u32 vcc, 4, v31
    s_nop 1
    v_cndmask_b32 v15, v15, v32, vcc
    v_and_b32 v32, 0xffffe000, v15
    v_add_u32 v15, v15, v32
    v_mov_b32 v32, 2146435072
    v_cndmask_b32 v15, v32, v15, s[50:51]
    s_cmp_lt_u32 s3, 1
    s_cselect_b32 s24, 0, 2146435072
    v_or_b32 v15, s24, v15
    s_and_b32 s24, s3, 1
    s_lshl_b32 s24, s24, 7
    s_lshr_b32 s25, s3, 1
    s_lshl_b32 s25, s25, 10
    s_add_u32 s24, s24, s25
    s_lshl_b32 s25, s44, 11
    s_add_u32 s25, s25, s24
    v_lshlrev_b32 v22, 8, v31
    v_lshl_add_u32 v22, v30, 4, v22
    v_add_u32 v22, s25, v22
    s_lshr_b32 s25, s44, 2
    s_lshl_b32 s25, s25, 11
    s_add_u32 s25, s25, s24
    s_and_b32 s26, s44, 3
    s_lshl_b32 s26, s26, 8
    s_add_u32 s25, s25, s26
    s_add_u32 s25, s25, 65536
    v_lshlrev_b32 v32, 4, v30
    v_add_u32 v32, s25, v32
    v_cmp_eq_u32 vcc, 4, v31
    s_nop 1
    v_cndmask_b32 v22, v22, v32, vcc
    v_and_b32 v32, 0xffffe000, v22
    v_add_u32 v22, v22, v32
    v_mov_b32 v32, 2146435072
    v_cndmask_b32 v22, v32, v22, s[50:51]
    s_mul_i32 s24, s44, 12288
    s_mul_i32 s25, s3, 3072
    s_add_u32 s24, s24, s25
    v_add_u32 v19, s24, v5
    s_and_b32 s24, s2, 15
    s_mul_i32 s25, s3, 16
    s_add_u32 s24, s24, s25
    s_lshl_b32 s24, s24, 7
    v_mov_b32 v23, s24
    s_lshr_b32 s25, s44, 3
    s_mul_i32 s24, s25, 8
    v_add_u32 v20, s24, v1
    v_lshlrev_b32 v20, 7, v20
    v_mov_b32 v30, 2146435072
    v_cmp_le_u32 vcc, 8, v1
    s_nop 1
    v_cndmask_b32 v20, v20, v30, vcc
    s_cmp_eq_u32 s3, 0
    s_cselect_b32 s24, 0, 2146435072
    v_or_b32 v20, s24, v20
    v_mov_b32 v0, 1
interleave_layers__linear_attn_block__memory_aug_recurrent_mem_tr__prompt_kernel_s_layer:
    s_mov_b32 s93, 0
    s_lshl_b32 s24, s93, 12
    s_and_b32 s24, s24, 0x2000
    s_xor_b32 s24, s24, s36
    s_lshl_b32 s93, s93, 20
    s_add_u32 s93, s93, s24
    s_add_u32 s93, s93, 117440512
    s_mul_i32 s94, s92, 16384
    s_add_u32 s94, s94, 23068672
    v_and_b32 v9, 1, v1
    v_lshlrev_b32 v9, 12, v9
    s_lshl_b32 s24, s44, 7
    s_add_u32 s24, s24, s94
    v_add_u32 v9, s24, v9
    s_lshl_b32 s24, s3, 6
    s_add_u32 s24, s24, 0
    v_add_u32 v48, s24, v1
    v_and_b32 v49, 7, v48
    v_mul_u32_u24 v49, 1280, v49
    v_lshrrev_b32 v50, 3, v48
    v_lshl_add_u32 v49, v50, 4, v49
    v_cmp_gt_u32 vcc, 640, v48
    v_mov_b32 v51, 2146435072
    s_nop 0
    v_cndmask_b32 v49, v51, v49, vcc
    buffer_load_dwordx4 v[52:55], v49, s[20:23], 0 offen
    v_lshlrev_b32 v48, 4, v48
    s_waitcnt vmcnt(0)
    s_and_saveexec_b64 s[30:31], vcc
    ds_write_b128 v48, v[52:55]
    s_mov_b64 exec, s[30:31]
    s_lshl_b32 s24, s3, 6
    s_add_u32 s24, s24, 256
    v_add_u32 v48, s24, v1
    v_and_b32 v49, 7, v48
    v_mul_u32_u24 v49, 1280, v49
    v_lshrrev_b32 v50, 3, v48
    v_lshl_add_u32 v49, v50, 4, v49
    v_cmp_gt_u32 vcc, 640, v48
    v_mov_b32 v51, 2146435072
    s_nop 0
    v_cndmask_b32 v49, v51, v49, vcc
    buffer_load_dwordx4 v[52:55], v49, s[20:23], 0 offen
    v_lshlrev_b32 v48, 4, v48
    s_waitcnt vmcnt(0)
    s_and_saveexec_b64 s[30:31], vcc
    ds_write_b128 v48, v[52:55]
    s_mov_b64 exec, s[30:31]
    s_lshl_b32 s24, s3, 6
    s_add_u32 s24, s24, 512
    v_add_u32 v48, s24, v1
    v_and_b32 v49, 7, v48
    v_mul_u32_u24 v49, 1280, v49
    v_lshrrev_b32 v50, 3, v48
    v_lshl_add_u32 v49, v50, 4, v49
    v_cmp_gt_u32 vcc, 640, v48
    v_mov_b32 v51, 2146435072
    s_nop 0
    v_cndmask_b32 v49, v51, v49, vcc
    buffer_load_dwordx4 v[52:55], v49, s[20:23], 0 offen
    v_lshlrev_b32 v48, 4, v48
    s_waitcnt vmcnt(0)
    s_and_saveexec_b64 s[30:31], vcc
    ds_write_b128 v48, v[52:55]
    s_mov_b64 exec, s[30:31]
    s_mov_b32 s40, 0
    s_mov_b32 s41, 92274688
    s_mov_b32 s37, s93
    s_add_u32 s43, s93, 655360
    s_mov_b32 s45, 67108864
    s_add_u32 s49, s93, 753664
    s_lshl_b32 s95, s92, 6
    s_add_u32 s95, s95, s40
    s_add_u32 s95, s95, 1
    s_cmp_ge_i32 s59, s95
    s_cbranch_scc1 interleave_layers__linear_attn_block__memory_aug_recurrent_mem_tr__prompt_kernel_s_ec0_ok
    s_and_b32 s24, s2, 7
    s_lshl_b32 s24, s24, 7
    s_add_u32 s24, s24, 23109632
    v_and_b32 v49, 3, v1
    v_lshl_add_u32 v49, v49, 2, s24
    s_mov_b32 s61, 0
interleave_layers__linear_attn_block__memory_aug_recurrent_mem_tr__prompt_kernel_s_ec0:
    buffer_load_dword v48, v49, s[8:11], 0 offen sc1
    s_waitcnt vmcnt(0)
    v_readlane_b32 s59, v48, 0
    v_readlane_b32 s24, v48, 1
    s_min_i32 s59, s59, s24
    v_readlane_b32 s24, v48, 2
    s_min_i32 s59, s59, s24
    s_cmp_ge_i32 s59, s95
    s_cbranch_scc1 interleave_layers__linear_attn_block__memory_aug_recurrent_mem_tr__prompt_kernel_s_ec0_ok
    s_add_u32 s61, s61, 1
    s_cmp_ge_u32 s61, s60
    s_cbranch_scc1 interleave_layers__linear_attn_block__memory_aug_recurrent_mem_tr__prompt_kernel_s_ec0_to
    s_sleep 2
    s_branch interleave_layers__linear_attn_block__memory_aug_recurrent_mem_tr__prompt_kernel_s_ec0
interleave_layers__linear_attn_block__memory_aug_recurrent_mem_tr__prompt_kernel_s_ec0_to:
    s_mov_b32 s60, 1
interleave_layers__linear_attn_block__memory_aug_recurrent_mem_tr__prompt_kernel_s_ec0_ok:
    s_mov_b32 s62, -1
    s_mov_b32 s63, 1
    s_cmp_ge_i32 s62, s63
    s_cbranch_scc1 interleave_layers__linear_attn_block__memory_aug_recurrent_mem_tr__prompt_kernel_s_en0_ok
    s_mov_b32 s61, 0
interleave_layers__linear_attn_block__memory_aug_recurrent_mem_tr__prompt_kernel_s_en0:
    buffer_load_dword v48, v9, s[8:11], 0 offen sc1
    s_waitcnt vmcnt(0)
    v_readlane_b32 s62, v48, 0
    v_readlane_b32 s24, v48, 1
    s_min_i32 s62, s62, s24
    s_cmp_ge_i32 s62, s63
    s_cbranch_scc1 interleave_layers__linear_attn_block__memory_aug_recurrent_mem_tr__prompt_kernel_s_en0_ok
    s_add_u32 s61, s61, 1
    s_cmp_ge_u32 s61, s60
    s_cbranch_scc1 interleave_layers__linear_attn_block__memory_aug_recurrent_mem_tr__prompt_kernel_s_en0_to
    s_sleep 2
    s_branch interleave_layers__linear_attn_block__memory_aug_recurrent_mem_tr__prompt_kernel_s_en0
interleave_layers__linear_attn_block__memory_aug_recurrent_mem_tr__prompt_kernel_s_en0_to:
    s_mov_b32 s60, 1
interleave_layers__linear_attn_block__memory_aug_recurrent_mem_tr__prompt_kernel_s_en0_ok:
    buffer_load_dwordx4 a[240:243], v19, s[8:11], s41 offen offset:0 sc1
    buffer_load_dwordx4 a[244:247], v19, s[8:11], s41 offen offset:1024 sc1
    buffer_load_dwordx4 a[248:251], v19, s[8:11], s41 offen offset:2048 sc1
    s_waitcnt lgkmcnt(0)
    v_mov_b32 v24, 0
    v_mov_b32 v25, 0
    v_mov_b32 v26, 0
    v_mov_b32 v27, 0
    v_mov_b32 v28, 0
    v_mov_b32 v29, 0
    v_mov_b32 v30, 0
    v_mov_b32 v31, 0
    v_mov_b32 v32, 0
    v_mov_b32 v33, 0
    v_mov_b32 v34, 0
    v_mov_b32 v35, 0
    v_mov_b32 v36, 0
    v_mov_b32 v37, 0
    v_mov_b32 v38, 0
    v_mov_b32 v39, 0
    v_mov_b32 v40, 0
    v_mov_b32 v41, 0
    v_mov_b32 v42, 0
    v_mov_b32 v43, 0
    v_mov_b32 v44, 0
    v_mov_b32 v45, 0
    v_mov_b32 v46, 0
    v_mov_b32 v47, 0
    s_barrier
    ds_read_b128 v[84:87], v7
    ds_read_b128 v[88:91], v7 offset:4096
    s_waitcnt vmcnt(0) lgkmcnt(0)
    s_cmp_eq_u32 s3, 0
    s_cbranch_scc1 interleave_layers__linear_attn_block__memory_aug_recurrent_mem_tr__prompt_kernel_s_gow0
    s_cmp_eq_u32 s3, 1
    s_cbranch_scc1 interleave_layers__linear_attn_block__memory_aug_recurrent_mem_tr__prompt_kernel_s_gow1
    s_cmp_eq_u32 s3, 2
    s_cbranch_scc1 interleave_layers__linear_attn_block__memory_aug_recurrent_mem_tr__prompt_kernel_s_gow2
    s_branch interleave_layers__linear_attn_block__memory_aug_recurrent_mem_tr__prompt_kernel_s_gow3
interleave_layers__linear_attn_block__memory_aug_recurrent_mem_tr__prompt_kernel_s_stepw0:
    v_mov_b32 v24, 0
    v_mov_b32 v25, 0
    v_mov_b32 v26, 0
    v_mov_b32 v27, 0
    v_mov_b32 v28, 0
    v_mov_b32 v29, 0
    v_mov_b32 v30, 0
    v_mov_b32 v31, 0
    v_mov_b32 v32, 0
    v_mov_b32 v33, 0
    v_mov_b32 v34, 0
    v_mov_b32 v35, 0
    v_mov_b32 v36, 0
    v_mov_b32 v37, 0
    v_mov_b32 v38, 0
    v_mov_b32 v39, 0
    v_mov_b32 v40, 0
    v_mov_b32 v41, 0
    v_mov_b32 v42, 0
    v_mov_b32 v43, 0
    v_mov_b32 v44, 0
    v_mov_b32 v45, 0
    v_mov_b32 v46, 0
    v_mov_b32 v47, 0
    s_add_u32 s46, s47, 4096
    s_add_u32 s52, s47, 8192
    s_lshl_b32 s95, s92, 6
    s_add_u32 s95, s95, s40
    s_add_u32 s95, s95, 1
    s_cmp_ge_i32 s59, s95
    s_cbranch_scc1 interleave_layers__linear_attn_block__memory_aug_recurrent_mem_tr__prompt_kernel_s_ecw0_ok
    s_and_b32 s24, s2, 7
    s_lshl_b32 s24, s24, 7
    s_add_u32 s24, s24, 23109632
    v_and_b32 v49, 3, v1
    v_lshl_add_u32 v49, v49, 2, s24
    s_mov_b32 s61, 0
interleave_layers__linear_attn_block__memory_aug_recurrent_mem_tr__prompt_kernel_s_ecw0:
    buffer_load_dword v48, v49, s[8:11], 0 offen sc1
    s_waitcnt vmcnt(0)
    v_readlane_b32 s59, v48, 0
    v_readlane_b32 s24, v48, 1
    s_min_i32 s59, s59, s24
    v_readlane_b32 s24, v48, 2
    s_min_i32 s59, s59, s24
    s_cmp_ge_i32 s59, s95
    s_cbranch_scc1 interleave_layers__linear_attn_block__memory_aug_recurrent_mem_tr__prompt_kernel_s_ecw0_ok
    s_add_u32 s61, s61, 1
    s_cmp_ge_u32 s61, s60
    s_cbranch_scc1 interleave_layers__linear_attn_block__memory_aug_recurrent_mem_tr__prompt_kernel_s_ecw0_to
    s_sleep 2
    s_branch interleave_layers__linear_attn_block__memory_aug_recurrent_mem_tr__prompt_kernel_s_ecw0
interleave_layers__linear_attn_block__memory_aug_recurrent_mem_tr__prompt_kernel_s_ecw0_to:
    s_mov_b32 s60, 1
interleave_layers__linear_attn_block__memory_aug_recurrent_mem_tr__prompt_kernel_s_ecw0_ok:
    s_add_u32 s63, s40, 1
    s_cmp_ge_i32 s62, s63
    s_cbranch_scc1 interleave_layers__linear_attn_block__memory_aug_recurrent_mem_tr__prompt_kernel_s_enw0_ok
    s_mov_b32 s61, 0
interleave_layers__linear_attn_block__memory_aug_recurrent_mem_tr__prompt_kernel_s_enw0:
    buffer_load_dword v48, v9, s[8:11], 0 offen sc1
    s_waitcnt vmcnt(0)
    v_readlane_b32 s62, v48, 0
    v_readlane_b32 s24, v48, 1
    s_min_i32 s62, s62, s24
    s_cmp_ge_i32 s62, s63
    s_cbranch_scc1 interleave_layers__linear_attn_block__memory_aug_recurrent_mem_tr__prompt_kernel_s_enw0_ok
    s_add_u32 s61, s61, 1
    s_cmp_ge_u32 s61, s60
    s_cbranch_scc1 interleave_layers__linear_attn_block__memory_aug_recurrent_mem_tr__prompt_kernel_s_enw0_to
    s_sleep 2
    s_branch interleave_layers__linear_attn_block__memory_aug_recurrent_mem_tr__prompt_kernel_s_enw0
interleave_layers__linear_attn_block__memory_aug_recurrent_mem_tr__prompt_kernel_s_enw0_to:
    s_mov_b32 s60, 1
interleave_layers__linear_attn_block__memory_aug_recurrent_mem_tr__prompt_kernel_s_enw0_ok:
    buffer_load_dwordx4 a[240:243], v19, s[8:11], s41 offen offset:0 sc1
    buffer_load_dwordx4 a[244:247], v19, s[8:11], s41 offen offset:1024 sc1
    buffer_load_dwordx4 a[248:251], v19, s[8:11], s41 offen offset:2048 sc1
    s_sleep 5
    s_mov_b64 exec, 1
    s_mov_b32 s61, 0
    v_mov_b32 v83, 0
    buffer_atomic_add v83, v23, s[8:11], s48 offen sc0
    s_sleep 3
    v_mov_b32 v94, 0
    buffer_atomic_add v94, v23, s[8:11], s48 offen sc0
    s_sleep 3
    v_mov_b32 v95, 0
    buffer_atomic_add v95, v23, s[8:11], s48 offen sc0
    s_sleep 3
interleave_layers__linear_attn_block__memory_aug_recurrent_mem_tr__prompt_kernel_s_prw0:
    v_mov_b32 v82, 0
    buffer_atomic_add v82, v23, s[8:11], s48 offen sc0
    s_waitcnt vmcnt(3)
    v_cmp_le_i32 vcc, 8, v83
    s_add_u32 s61, s61, 1
    s_cbranch_vccnz interleave_layers__linear_attn_block__memory_aug_recurrent_mem_tr__prompt_kernel_s_prw0_out
    s_sleep 3
    v_mov_b32 v83, 0
    buffer_atomic_add v83, v23, s[8:11], s48 offen sc0
    s_waitcnt vmcnt(3)
    v_cmp_le_i32 vcc, 8, v94
    s_add_u32 s61, s61, 1
    s_cbranch_vccnz interleave_layers__linear_attn_block__memory_aug_recurrent_mem_tr__prompt_kernel_s_prw0_out
    s_sleep 3
    v_mov_b32 v94, 0
    buffer_atomic_add v94, v23, s[8:11], s48 offen sc0
    s_waitcnt vmcnt(3)
    v_cmp_le_i32 vcc, 8, v95
    s_add_u32 s61, s61, 1
    s_cbranch_vccnz interleave_layers__linear_attn_block__memory_aug_recurrent_mem_tr__prompt_kernel_s_prw0_out
    s_sleep 3
    v_mov_b32 v95, 0
    buffer_atomic_add v95, v23, s[8:11], s48 offen sc0
    s_waitcnt vmcnt(3)
    v_cmp_le_i32 vcc, 8, v82
    s_add_u32 s61, s61, 1
    s_cbranch_vccnz interleave_layers__linear_attn_block__memory_aug_recurrent_mem_tr__prompt_kernel_s_prw0_out
    s_sleep 3
    s_cmp_ge_u32 s61, s60
    s_cbranch_scc0 interleave_layers__linear_attn_block__memory_aug_recurrent_mem_tr__prompt_kernel_s_prw0
    s_mov_b32 s60, 1
interleave_layers__linear_attn_block__memory_aug_recurrent_mem_tr__prompt_kernel_s_prw0_out:
    s_mov_b64 exec, -1
    buffer_load_dwordx4 v[84:87], v7, s[8:11], s47 offen sc1
    buffer_load_dwordx4 v[88:91], v7, s[8:11], s46 offen sc1
    buffer_load_dwordx2 v[92:93], v8, s[8:11], s52 offen sc1
    ds_read_b128 v[48:51], v21 offset:0
    ds_read_b128 v[52:55], v21 offset:16
    ds_read_b128 v[56:59], v21 offset:5632
    ds_read_b128 v[60:63], v21 offset:5648
    ds_read_b128 v[64:67], v21 offset:11264
    ds_read_b128 v[68:71], v21 offset:11280
    ds_read_b128 v[72:75], v21 offset:16896
    ds_read_b128 v[76:79], v21 offset:16912
    s_waitcnt lgkmcnt(4)
    v_pk_add_f32 v[48:49], v[48:49], v[56:57]
    v_pk_add_f32 v[50:51], v[50:51], v[58:59]
    v_pk_add_f32 v[52:53], v[52:53], v[60:61]
    v_pk_add_f32 v[54:55], v[54:55], v[62:63]
    s_waitcnt lgkmcnt(0)
    v_pk_add_f32 v[64:65], v[64:65], v[72:73]
    v_pk_add_f32 v[66:67], v[66:67], v[74:75]
    v_pk_add_f32 v[68:69], v[68:69], v[76:77]
    v_pk_add_f32 v[70:71], v[70:71], v[78:79]
    v_pk_add_f32 v[48:49], v[48:49], v[64:65]
    v_pk_add_f32 v[50:51], v[50:51], v[66:67]
    v_pk_add_f32 v[52:53], v[52:53], v[68:69]
    v_pk_add_f32 v[54:55], v[54:55], v[70:71]
    v_mov_b32 v81, 0xff800000
    v_cndmask_b32 v48, v81, v48, s[64:65]
    v_cndmask_b32 v49, v81, v49, s[66:67]
    v_cndmask_b32 v50, v81, v50, s[68:69]
    v_cndmask_b32 v51, v81, v51, s[70:71]
    v_cndmask_b32 v52, v81, v52, s[72:73]
    v_cndmask_b32 v53, v81, v53, s[74:75]
    v_cndmask_b32 v54, v81, v54, s[76:77]
    v_cndmask_b32 v55, v81, v55, s[78:79]
    v_max3_f32 v80, v48, v49, v50
    v_max3_f32 v80, v80, v51, v52
    v_max3_f32 v80, v80, v53, v54
    v_max_f32 v80, v80, v55
    v_mov_b32 v81, 0xff800000
    v_cndmask_b32 v80, v81, v80, s[50:51]
    s_nop 1
    v_max_f32 v80, v80, v80 quad_perm:[1,0,3,2] row_mask:0xf bank_mask:0xf
    s_nop 1
    v_max_f32 v80, v80, v80 quad_perm:[2,3,0,1] row_mask:0xf bank_mask:0xf
    s_nop 1
    v_max_f32 v80, v80, v80 row_half_mirror row_mask:0xf bank_mask:0xf
    s_mov_b32 s24, 0x3dd53b95
    v_mul_f32 v80, s24, v80
    v_fma_f32 v48, v48, s24, -v80
    v_fma_f32 v49, v49, s24, -v80
    v_fma_f32 v50, v50, s24, -v80
    v_fma_f32 v51, v51, s24, -v80
    v_fma_f32 v52, v52, s24, -v80
    v_fma_f32 v53, v53, s24, -v80
    v_fma_f32 v54, v54, s24, -v80
    v_fma_f32 v55, v55, s24, -v80
    v_exp_f32 v48, v48
    v_exp_f32 v49, v49
    v_exp_f32 v50, v50
    v_exp_f32 v51, v51
    v_exp_f32 v52, v52
    v_exp_f32 v53, v53
    v_exp_f32 v54, v54
    v_exp_f32 v55, v55
    v_add_f32 v80, v48, v49
    v_add_f32 v81, v50, v51
    v_add_f32 v80, v80, v52
    v_add_f32 v81, v81, v53
    v_add_f32 v80, v80, v54
    v_add_f32 v81, v81, v55
    v_add_f32 v80, v80, v81
    v_cndmask_b32 v80, 0, v80, s[50:51]
    s_nop 1
    v_add_f32 v80, v80, v80 quad_perm:[1,0,3,2] row_mask:0xf bank_mask:0xf
    s_nop 1
    v_add_f32 v80, v80, v80 quad_perm:[2,3,0,1] row_mask:0xf bank_mask:0xf
    s_nop 1
    v_add_f32 v80, v80, v80 row_half_mirror row_mask:0xf bank_mask:0xf
    v_rcp_f32 v80, v80
    s_nop 0
    v_mul_f32 v48, v48, v80
    v_mul_f32 v49, v49, v80
    v_mul_f32 v50, v50, v80
    v_mul_f32 v51, v51, v80
    v_mul_f32 v52, v52, v80
    v_mul_f32 v53, v53, v80
    v_mul_f32 v54, v54, v80
    v_mul_f32 v55, v55, v80
    v_cvt_pk_bf16_f32 v56, v48, v49
    v_cvt_pk_bf16_f32 v57, v50, v51
    v_cvt_pk_bf16_f32 v58, v52, v53
    v_cvt_pk_bf16_f32 v59, v54, v55
    v_min_u32 v56, -2, v56
    v_min_u32 v57, -2, v57
    v_min_u32 v58, -2, v58
    v_min_u32 v59, -2, v59
    buffer_store_dwordx4 v[56:59], v22, s[8:11], s42 offen sc1
    s_waitcnt vmcnt(1)
    s_nop 0
    v_max3_u32 v58, v84, v85, v86
    v_max3_u32 v58, v58, v87, v88
    v_max3_u32 v58, v58, v89, v90
    v_max3_u32 v58, v58, v91, v92
    v_max_u32 v58, v58, v93
    v_cmp_eq_u32 vcc, -1, v58
    s_cbranch_vccz interleave_layers__linear_attn_block__memory_aug_recurrent_mem_tr__prompt_kernel_s_pmw0_out
    s_mov_b32 s61, 0
interleave_layers__linear_attn_block__memory_aug_recurrent_mem_tr__prompt_kernel_s_pmw0:
    buffer_load_dwordx4 v[84:87], v7, s[8:11], s47 offen sc1
    buffer_load_dwordx4 v[88:91], v7, s[8:11], s46 offen sc1
    buffer_load_dwordx2 v[92:93], v8, s[8:11], s52 offen sc1
    s_waitcnt vmcnt(0)
    v_max3_u32 v58, v84, v85, v86
    v_max3_u32 v58, v58, v87, v88
    v_max3_u32 v58, v58, v89, v90
    v_max3_u32 v58, v58, v91, v92
    v_max_u32 v58, v58, v93
    v_cmp_eq_u32 vcc, -1, v58
    s_add_u32 s61, s61, 1
    s_cbranch_vccz interleave_layers__linear_attn_block__memory_aug_recurrent_mem_tr__prompt_kernel_s_pmw0_out
    s_cmp_ge_u32 s61, s60
    s_cbranch_scc1 interleave_layers__linear_attn_block__memory_aug_recurrent_mem_tr__prompt_kernel_s_pmw0_to
    s_sleep 1
    s_branch interleave_layers__linear_attn_block__memory_aug_recurrent_mem_tr__prompt_kernel_s_pmw0
interleave_layers__linear_attn_block__memory_aug_recurrent_mem_tr__prompt_kernel_s_pmw0_to:
    s_mov_b32 s60, 1
interleave_layers__linear_attn_block__memory_aug_recurrent_mem_tr__prompt_kernel_s_pmw0_out:
    ds_write_b128 v7, v[84:87]
    ds_write_b128 v7, v[88:91] offset:4096
    ds_write_b64 v8, v[92:93]
interleave_layers__linear_attn_block__memory_aug_recurrent_mem_tr__prompt_kernel_s_gow0:
    ds_read_b128 v[68:71], v6 offset:0
    ds_read_b128 v[72:75], v6 offset:1024
    ds_read_b128 v[76:79], v6 offset:8192
    ds_read_b128 v[80:83], v6 offset:9216
    v_smfmac_f32_16x16x64_bf16 v[24:27], v[84:87], a[0:7], v4
    v_smfmac_f32_16x16x64_bf16 v[28:31], v[84:87], a[80:87], v4
    v_smfmac_f32_16x16x64_bf16 v[32:35], v[84:87], a[160:167], v4
    v_smfmac_f32_16x16x64_bf16 v[40:43], v[84:87], v[96:103], v4
    v_smfmac_f32_16x16x64_bf16 v[44:47], v[84:87], v[176:183], v4
    s_waitcnt lgkmcnt(2)
    v_smfmac_f32_16x16x64_bf16 v[36:39], v[84:87], v[68:75], v4
    ds_read_b128 v[68:71], v6 offset:2048
    ds_read_b128 v[72:75], v6 offset:3072
    s_barrier
    ds_read_b128 v[48:51], v5 offset:1024
    ds_read_b128 v[52:55], v5 offset:2048
    ds_read_b128 v[56:59], v5 offset:3072
    ds_read_b128 v[60:63], v5 offset:5120
    ds_read_b128 v[64:67], v5 offset:6144
    v_smfmac_f32_16x16x64_bf16 v[24:27], v[88:91], a[32:39], v4
    v_smfmac_f32_16x16x64_bf16 v[28:31], v[88:91], a[112:119], v4
    v_smfmac_f32_16x16x64_bf16 v[32:35], v[88:91], a[192:199], v4
    v_smfmac_f32_16x16x64_bf16 v[40:43], v[88:91], v[128:135], v4
    v_smfmac_f32_16x16x64_bf16 v[44:47], v[88:91], v[208:215], v4
    s_waitcnt lgkmcnt(7)
    v_smfmac_f32_16x16x64_bf16 v[36:39], v[88:91], v[76:83], v4
    ds_read_b128 v[76:79], v6 offset:4096
    ds_read_b128 v[80:83], v6 offset:5120
    s_waitcnt lgkmcnt(6)
    v_smfmac_f32_16x16x64_bf16 v[24:27], v[48:51], a[8:15], v4
    v_smfmac_f32_16x16x64_bf16 v[28:31], v[48:51], a[88:95], v4
    v_smfmac_f32_16x16x64_bf16 v[40:43], v[48:51], v[104:111], v4
    v_smfmac_f32_16x16x64_bf16 v[36:39], v[48:51], v[68:75], v4
    ds_read_b128 v[68:71], v6 offset:6144
    ds_read_b128 v[72:75], v6 offset:7168
    ds_read_b128 v[48:51], v5 offset:7168
    s_waitcnt lgkmcnt(8)
    v_smfmac_f32_16x16x64_bf16 v[24:27], v[52:55], a[16:23], v4
    v_smfmac_f32_16x16x64_bf16 v[28:31], v[52:55], a[96:103], v4
    v_smfmac_f32_16x16x64_bf16 v[40:43], v[52:55], v[112:119], v4
    s_waitcnt lgkmcnt(3)
    v_smfmac_f32_16x16x64_bf16 v[36:39], v[52:55], v[76:83], v4
    ds_read_b128 v[76:79], v6 offset:10240
    ds_read_b128 v[80:83], v6 offset:11264
    ds_read_b128 v[52:55], v5 offset:8192
    v_smfmac_f32_16x16x64_bf16 v[24:27], v[56:59], a[24:31], v4
    v_smfmac_f32_16x16x64_bf16 v[28:31], v[56:59], a[104:111], v4
    v_smfmac_f32_16x16x64_bf16 v[40:43], v[56:59], v[120:127], v4
    s_waitcnt lgkmcnt(4)
    v_smfmac_f32_16x16x64_bf16 v[36:39], v[56:59], v[68:75], v4
    ds_read_b128 v[68:71], v6 offset:12288
    ds_read_b128 v[72:75], v6 offset:13312
    ds_read_b128 v[56:59], v5 offset:9216
    v_smfmac_f32_16x16x64_bf16 v[24:27], v[60:63], a[40:47], v4
    v_smfmac_f32_16x16x64_bf16 v[28:31], v[60:63], a[120:127], v4
    v_smfmac_f32_16x16x64_bf16 v[40:43], v[60:63], v[136:143], v4
    s_waitcnt lgkmcnt(4)
    v_smfmac_f32_16x16x64_bf16 v[36:39], v[60:63], v[76:83], v4
    ds_read_b128 v[76:79], v6 offset:14336
    ds_read_b128 v[80:83], v6 offset:15360
    ds_read_b128 v[60:63], v5 offset:1024
    v_smfmac_f32_16x16x64_bf16 v[24:27], v[64:67], a[48:55], v4
    v_smfmac_f32_16x16x64_bf16 v[28:31], v[64:67], a[128:135], v4
    v_smfmac_f32_16x16x64_bf16 v[40:43], v[64:67], v[144:151], v4
    s_waitcnt lgkmcnt(4)
    v_smfmac_f32_16x16x64_bf16 v[36:39], v[64:67], v[68:75], v4
    ds_read_b128 v[68:71], v6 offset:16384
    ds_read_b128 v[72:75], v6 offset:17408
    ds_read_b128 v[64:67], v5 offset:2048
    v_smfmac_f32_16x16x64_bf16 v[24:27], v[48:51], a[56:63], v4
    v_smfmac_f32_16x16x64_bf16 v[28:31], v[48:51], a[136:143], v4
    v_smfmac_f32_16x16x64_bf16 v[40:43], v[48:51], v[152:159], v4
    s_waitcnt lgkmcnt(4)
    v_smfmac_f32_16x16x64_bf16 v[36:39], v[48:51], v[76:83], v4
    ds_read_b128 v[76:79], v6 offset:18432
    ds_read_b128 v[80:83], v6 offset:19456
    ds_read_b128 v[48:51], v5 offset:3072
    v_smfmac_f32_16x16x64_bf16 v[24:27], v[52:55], a[64:71], v4
    v_smfmac_f32_16x16x64_bf16 v[28:31], v[52:55], a[144:151], v4
    v_smfmac_f32_16x16x64_bf16 v[40:43], v[52:55], v[160:167], v4
    s_waitcnt lgkmcnt(4)
    v_smfmac_f32_16x16x64_bf16 v[36:39], v[52:55], v[68:75], v4
    ds_read_b128 v[52:55], v5 offset:5120
    v_smfmac_f32_16x16x64_bf16 v[24:27], v[56:59], a[72:79], v4
    v_smfmac_f32_16x16x64_bf16 v[28:31], v[56:59], a[152:159], v4
    v_smfmac_f32_16x16x64_bf16 v[40:43], v[56:59], v[168:175], v4
    s_waitcnt lgkmcnt(2)
    v_smfmac_f32_16x16x64_bf16 v[36:39], v[56:59], v[76:83], v4
    ds_read_b128 v[56:59], v5 offset:6144
    buffer_load_dwordx4 v[80:83], v19, s[8:11], s45 offen offset:0 sc1
    buffer_load_dwordx4 v[84:87], v19, s[8:11], s45 offen offset:1024 sc1
    buffer_load_dwordx4 v[88:91], v19, s[8:11], s45 offen offset:2048 sc1
    v_smfmac_f32_16x16x64_bf16 v[32:35], v[60:63], a[168:175], v4
    v_smfmac_f32_16x16x64_bf16 v[44:47], v[60:63], v[184:191], v4
    v_permlane32_swap_b32 v28, v40
    v_permlane32_swap_b32 v29, v41
    ds_read_b128 v[60:63], v5 offset:7168
    v_smfmac_f32_16x16x64_bf16 v[32:35], v[64:67], a[176:183], v4
    v_permlane32_swap_b32 v30, v42
    v_permlane32_swap_b32 v31, v43
    v_smfmac_f32_16x16x64_bf16 v[44:47], v[64:67], v[192:199], v4
    v_add_f32 v28, v28, v40
    v_add_f32 v29, v29, v41
    ds_read_b128 v[64:67], v5 offset:8192
    s_waitcnt lgkmcnt(4)
    v_smfmac_f32_16x16x64_bf16 v[32:35], v[48:51], a[184:191], v4
    v_add_f32 v30, v30, v42
    v_add_f32 v31, v31, v43
    v_smfmac_f32_16x16x64_bf16 v[44:47], v[48:51], v[200:207], v4
    v_cvt_pk_bf16_f32 v40, v28, v29
    v_cvt_pk_bf16_f32 v41, v30, v31
    ds_read_b128 v[48:51], v5 offset:9216
    s_waitcnt lgkmcnt(4)
    v_smfmac_f32_16x16x64_bf16 v[32:35], v[52:55], a[200:207], v4
    v_mfma_f32_16x16x16_bf16 v[28:31], v[40:41], v[10:11], 0
    v_permlane32_swap_b32 v24, v36
    v_smfmac_f32_16x16x64_bf16 v[44:47], v[52:55], v[216:223], v4
    v_permlane32_swap_b32 v25, v37
    v_permlane32_swap_b32 v26, v38
    s_waitcnt lgkmcnt(3)
    v_smfmac_f32_16x16x64_bf16 v[32:35], v[56:59], a[208:215], v4
    v_permlane32_swap_b32 v27, v39
    v_add_f32 v24, v24, v36
    v_smfmac_f32_16x16x64_bf16 v[44:47], v[56:59], v[224:231], v4
    v_add_f32 v25, v25, v37
    v_add_f32 v26, v26, v38
    s_waitcnt lgkmcnt(2)
    v_smfmac_f32_16x16x64_bf16 v[32:35], v[60:63], a[216:223], v4
    v_add_f32 v27, v27, v39
    v_cvt_pk_bf16_f32 v36, v24, v25
    v_smfmac_f32_16x16x64_bf16 v[44:47], v[60:63], v[232:239], v4
    v_cvt_pk_bf16_f32 v37, v26, v27
    s_nop 1
    v_mfma_f32_16x16x16_bf16 v[24:27], v[36:37], v[10:11], 0
    s_waitcnt lgkmcnt(1)
    v_smfmac_f32_16x16x64_bf16 v[32:35], v[64:67], a[224:231], v4
    s_nop 5
    v_cvt_pk_bf16_f32 v24, v24, v25
    v_smfmac_f32_16x16x64_bf16 v[44:47], v[64:67], v[240:247], v4
    v_cvt_pk_bf16_f32 v25, v26, v27
    v_cvt_pk_bf16_f32 v26, v28, v29
    s_waitcnt lgkmcnt(0)
    v_smfmac_f32_16x16x64_bf16 v[32:35], v[48:51], a[232:239], v4
    v_cvt_pk_bf16_f32 v27, v30, v31
    s_waitcnt vmcnt(3)
    v_smfmac_f32_16x16x64_bf16 v[44:47], v[48:51], v[248:255], v4
    v_mfma_f32_16x16x32_bf16 v[28:31], a[240:243], v[24:27], 0
    v_mfma_f32_16x16x32_bf16 v[36:39], a[244:247], v[24:27], 0
    v_mfma_f32_16x16x32_bf16 v[40:43], v[24:27], v[24:27], 0
    s_nop 4
    v_permlane32_swap_b32 v32, v44
    v_permlane32_swap_b32 v33, v45
    v_permlane32_swap_b32 v34, v46
    v_permlane32_swap_b32 v35, v47
    v_add_f32 v32, v32, v44
    v_add_f32 v33, v33, v45
    v_add_f32 v34, v34, v46
    v_add_f32 v35, v35, v47
    v_cvt_pk_bf16_f32 v44, v32, v33
    v_cvt_pk_bf16_f32 v45, v34, v35
    s_nop 1
    v_mfma_f32_16x16x16_bf16 v[32:35], v[44:45], v[10:11], 0
    s_nop 7
    v_cvt_pk_bf16_f32 v32, v32, v33
    v_cvt_pk_bf16_f32 v33, v34, v35
    s_nop 1
    v_mfma_f32_16x16x16_bf16 v[28:31], a[248:249], v[32:33], v[28:31]
    v_mfma_f32_16x16x16_bf16 v[36:39], a[250:251], v[32:33], v[36:39]
    v_mfma_f32_16x16x16_bf16 v[40:43], v[32:33], v[32:33], v[40:43]
    s_nop 5
    ds_write_b128 v12, v[28:31]
    ds_write_b128 v12, v[36:39] offset:16
    ds_write_b128 v13, v[40:43]
    buffer_atomic_add v0, v20, s[8:11], s49 offen
    s_waitcnt lgkmcnt(0)
    s_barrier
    ds_read_b128 v[48:51], v14 offset:0
    ds_read_b128 v[52:55], v14 offset:16
    ds_read_b128 v[56:59], v14 offset:1408
    ds_read_b128 v[60:63], v14 offset:1424
    ds_read_b128 v[64:67], v14 offset:2816
    ds_read_b128 v[68:71], v14 offset:2832
    ds_read_b128 v[72:75], v14 offset:4224
    ds_read_b128 v[76:79], v14 offset:4240
    s_waitcnt lgkmcnt(4)
    v_pk_add_f32 v[48:49], v[48:49], v[56:57]
    v_pk_add_f32 v[50:51], v[50:51], v[58:59]
    v_pk_add_f32 v[52:53], v[52:53], v[60:61]
    v_pk_add_f32 v[54:55], v[54:55], v[62:63]
    s_waitcnt lgkmcnt(0)
    v_pk_add_f32 v[64:65], v[64:65], v[72:73]
    v_pk_add_f32 v[66:67], v[66:67], v[74:75]
    v_pk_add_f32 v[68:69], v[68:69], v[76:77]
    v_pk_add_f32 v[70:71], v[70:71], v[78:79]
    v_pk_add_f32 v[48:49], v[48:49], v[64:65]
    v_pk_add_f32 v[50:51], v[50:51], v[66:67]
    v_pk_add_f32 v[52:53], v[52:53], v[68:69]
    v_pk_add_f32 v[54:55], v[54:55], v[70:71]
    v_max3_f32 v92, v48, v49, v50
    v_max3_f32 v92, v92, v51, v52
    v_max3_f32 v92, v92, v53, v54
    v_max_f32 v92, v92, v55
    v_mov_b32 v93, 0xff800000
    v_cndmask_b32 v92, v93, v92, s[50:51]
    s_nop 1
    v_max_f32 v92, v92, v92 quad_perm:[1,0,3,2] row_mask:0xf bank_mask:0xf
    s_nop 1
    v_max_f32 v92, v92, v92 quad_perm:[2,3,0,1] row_mask:0xf bank_mask:0xf
    s_nop 1
    v_max_f32 v92, v92, v92 row_half_mirror row_mask:0xf bank_mask:0xf
    s_mov_b32 s24, 0x3dd53b95
    v_mul_f32 v92, s24, v92
    v_fma_f32 v48, v48, s24, -v92
    v_fma_f32 v49, v49, s24, -v92
    v_fma_f32 v50, v50, s24, -v92
    v_fma_f32 v51, v51, s24, -v92
    v_fma_f32 v52, v52, s24, -v92
    v_fma_f32 v53, v53, s24, -v92
    v_fma_f32 v54, v54, s24, -v92
    v_fma_f32 v55, v55, s24, -v92
    v_exp_f32 v48, v48
    v_exp_f32 v49, v49
    v_exp_f32 v50, v50
    v_exp_f32 v51, v51
    v_exp_f32 v52, v52
    v_exp_f32 v53, v53
    v_exp_f32 v54, v54
    v_exp_f32 v55, v55
    v_add_f32 v92, v48, v49
    v_add_f32 v93, v50, v51
    v_add_f32 v92, v92, v52
    v_add_f32 v93, v93, v53
    v_add_f32 v92, v92, v54
    v_add_f32 v93, v93, v55
    v_add_f32 v92, v92, v93
    v_cndmask_b32 v92, 0, v92, s[50:51]
    s_nop 1
    v_add_f32 v92, v92, v92 quad_perm:[1,0,3,2] row_mask:0xf bank_mask:0xf
    s_nop 1
    v_add_f32 v92, v92, v92 quad_perm:[2,3,0,1] row_mask:0xf bank_mask:0xf
    s_nop 1
    v_add_f32 v92, v92, v92 row_half_mirror row_mask:0xf bank_mask:0xf
    v_rcp_f32 v92, v92
    s_nop 0
    v_mul_f32 v48, v48, v92
    v_mul_f32 v49, v49, v92
    v_mul_f32 v50, v50, v92
    v_mul_f32 v51, v51, v92
    v_mul_f32 v52, v52, v92
    v_mul_f32 v53, v53, v92
    v_mul_f32 v54, v54, v92
    v_mul_f32 v55, v55, v92
    v_cvt_pk_bf16_f32 v56, v48, v49
    v_cvt_pk_bf16_f32 v57, v50, v51
    v_cvt_pk_bf16_f32 v58, v52, v53
    v_cvt_pk_bf16_f32 v59, v54, v55
    v_min_u32 v56, -2, v56
    v_min_u32 v57, -2, v57
    v_min_u32 v58, -2, v58
    v_min_u32 v59, -2, v59
    buffer_store_dwordx4 v[56:59], v15, s[8:11], s43 offen sc1
    s_waitcnt vmcnt(2)
    v_mfma_f32_16x16x32_bf16 v[36:39], a[240:243], v[80:83], 0
    v_mfma_f32_16x16x32_bf16 v[44:47], a[244:247], v[80:83], 0
    v_mfma_f32_16x16x32_bf16 v[68:71], v[24:27], v[80:83], 0
    v_mfma_f32_16x16x32_bf16 v[40:43], a[240:243], v[84:87], 0
    v_mfma_f32_16x16x32_bf16 v[64:67], a[244:247], v[84:87], 0
    v_mfma_f32_16x16x32_bf16 v[72:75], v[24:27], v[84:87], 0
    s_nop 0
    v_mfma_f32_16x16x16_bf16 v[36:39], a[248:249], v[88:89], v[36:39]
    v_mfma_f32_16x16x16_bf16 v[44:47], a[250:251], v[88:89], v[44:47]
    v_mfma_f32_16x16x16_bf16 v[68:71], v[32:33], v[88:89], v[68:71]
    v_mfma_f32_16x16x16_bf16 v[40:43], a[248:249], v[90:91], v[40:43]
    v_mfma_f32_16x16x16_bf16 v[64:67], a[250:251], v[90:91], v[64:67]
    v_mfma_f32_16x16x16_bf16 v[72:75], v[32:33], v[90:91], v[72:75]
    s_nop 2
    ds_write_b128 v16, v[36:39] offset:0
    ds_write_b128 v16, v[44:47] offset:16
    ds_write_b128 v17, v[68:71]
    ds_write_b128 v16, v[40:43] offset:2816
    ds_write_b128 v16, v[64:67] offset:2832
    ds_write_b128 v18, v[72:75]
    s_add_u32 s40, s40, 1
    s_add_u32 s41, s41, 393216
    s_add_u32 s45, s45, 393216
    s_add_u32 s47, s37, 704512
    s_add_u32 s48, s37, 737280
    s_xor_b32 s42, s37, 0x2000
    s_lshl_b32 s24, s40, 12
    s_and_b32 s24, s24, 0x2000
    s_xor_b32 s24, s24, s36
    s_lshl_b32 s37, s40, 20
    s_add_u32 s37, s37, s24
    s_add_u32 s37, s37, 117440512
    s_add_u32 s43, s37, 655360
    s_add_u32 s49, s37, 753664
    s_waitcnt lgkmcnt(0)
    s_barrier
    s_cmp_lt_u32 s40, 64
    s_cbranch_scc1 interleave_layers__linear_attn_block__memory_aug_recurrent_mem_tr__prompt_kernel_s_stepw0
    s_branch interleave_layers__linear_attn_block__memory_aug_recurrent_mem_tr__prompt_kernel_s_end
interleave_layers__linear_attn_block__memory_aug_recurrent_mem_tr__prompt_kernel_s_stepw1:
    v_mov_b32 v24, 0
    v_mov_b32 v25, 0
    v_mov_b32 v26, 0
    v_mov_b32 v27, 0
    v_mov_b32 v28, 0
    v_mov_b32 v29, 0
    v_mov_b32 v30, 0
    v_mov_b32 v31, 0
    v_mov_b32 v32, 0
    v_mov_b32 v33, 0
    v_mov_b32 v34, 0
    v_mov_b32 v35, 0
    v_mov_b32 v36, 0
    v_mov_b32 v37, 0
    v_mov_b32 v38, 0
    v_mov_b32 v39, 0
    v_mov_b32 v40, 0
    v_mov_b32 v41, 0
    v_mov_b32 v42, 0
    v_mov_b32 v43, 0
    v_mov_b32 v44, 0
    v_mov_b32 v45, 0
    v_mov_b32 v46, 0
    v_mov_b32 v47, 0
    s_add_u32 s46, s47, 4096
    s_add_u32 s52, s47, 8192
    s_lshl_b32 s95, s92, 6
    s_add_u32 s95, s95, s40
    s_add_u32 s95, s95, 1
    s_cmp_ge_i32 s59, s95
    s_cbranch_scc1 interleave_layers__linear_attn_block__memory_aug_recurrent_mem_tr__prompt_kernel_s_ecw1_ok
    s_and_b32 s24, s2, 7
    s_lshl_b32 s24, s24, 7
    s_add_u32 s24, s24, 23109632
    v_and_b32 v49, 3, v1
    v_lshl_add_u32 v49, v49, 2, s24
    s_mov_b32 s61, 0
interleave_layers__linear_attn_block__memory_aug_recurrent_mem_tr__prompt_kernel_s_ecw1:
    buffer_load_dword v48, v49, s[8:11], 0 offen sc1
    s_waitcnt vmcnt(0)
    v_readlane_b32 s59, v48, 0
    v_readlane_b32 s24, v48, 1
    s_min_i32 s59, s59, s24
    v_readlane_b32 s24, v48, 2
    s_min_i32 s59, s59, s24
    s_cmp_ge_i32 s59, s95
    s_cbranch_scc1 interleave_layers__linear_attn_block__memory_aug_recurrent_mem_tr__prompt_kernel_s_ecw1_ok
    s_add_u32 s61, s61, 1
    s_cmp_ge_u32 s61, s60
    s_cbranch_scc1 interleave_layers__linear_attn_block__memory_aug_recurrent_mem_tr__prompt_kernel_s_ecw1_to
    s_sleep 2
    s_branch interleave_layers__linear_attn_block__memory_aug_recurrent_mem_tr__prompt_kernel_s_ecw1
interleave_layers__linear_attn_block__memory_aug_recurrent_mem_tr__prompt_kernel_s_ecw1_to:
    s_mov_b32 s60, 1
interleave_layers__linear_attn_block__memory_aug_recurrent_mem_tr__prompt_kernel_s_ecw1_ok:
    s_add_u32 s63, s40, 1
    s_cmp_ge_i32 s62, s63
    s_cbranch_scc1 interleave_layers__linear_attn_block__memory_aug_recurrent_mem_tr__prompt_kernel_s_enw1_ok
    s_mov_b32 s61, 0
interleave_layers__linear_attn_block__memory_aug_recurrent_mem_tr__prompt_kernel_s_enw1:
    buffer_load_dword v48, v9, s[8:11], 0 offen sc1
    s_waitcnt vmcnt(0)
    v_readlane_b32 s62, v48, 0
    v_readlane_b32 s24, v48, 1
    s_min_i32 s62, s62, s24
    s_cmp_ge_i32 s62, s63
    s_cbranch_scc1 interleave_layers__linear_attn_block__memory_aug_recurrent_mem_tr__prompt_kernel_s_enw1_ok
    s_add_u32 s61, s61, 1
    s_cmp_ge_u32 s61, s60
    s_cbranch_scc1 interleave_layers__linear_attn_block__memory_aug_recurrent_mem_tr__prompt_kernel_s_enw1_to
    s_sleep 2
    s_branch interleave_layers__linear_attn_block__memory_aug_recurrent_mem_tr__prompt_kernel_s_enw1
interleave_layers__linear_attn_block__memory_aug_recurrent_mem_tr__prompt_kernel_s_enw1_to:
    s_mov_b32 s60, 1
interleave_layers__linear_attn_block__memory_aug_recurrent_mem_tr__prompt_kernel_s_enw1_ok:
    buffer_load_dwordx4 a[240:243], v19, s[8:11], s41 offen offset:0 sc1
    buffer_load_dwordx4 a[244:247], v19, s[8:11], s41 offen offset:1024 sc1
    buffer_load_dwordx4 a[248:251], v19, s[8:11], s41 offen offset:2048 sc1
    s_sleep 5
    s_mov_b64 exec, 1
    s_mov_b32 s61, 0
    v_mov_b32 v83, 0
    buffer_atomic_add v83, v23, s[8:11], s48 offen sc0
    s_sleep 3
    v_mov_b32 v94, 0
    buffer_atomic_add v94, v23, s[8:11], s48 offen sc0
    s_sleep 3
    v_mov_b32 v95, 0
    buffer_atomic_add v95, v23, s[8:11], s48 offen sc0
    s_sleep 3
interleave_layers__linear_attn_block__memory_aug_recurrent_mem_tr__prompt_kernel_s_prw1:
    v_mov_b32 v82, 0
    buffer_atomic_add v82, v23, s[8:11], s48 offen sc0
    s_waitcnt vmcnt(3)
    v_cmp_le_i32 vcc, 8, v83
    s_add_u32 s61, s61, 1
    s_cbranch_vccnz interleave_layers__linear_attn_block__memory_aug_recurrent_mem_tr__prompt_kernel_s_prw1_out
    s_sleep 3
    v_mov_b32 v83, 0
    buffer_atomic_add v83, v23, s[8:11], s48 offen sc0
    s_waitcnt vmcnt(3)
    v_cmp_le_i32 vcc, 8, v94
    s_add_u32 s61, s61, 1
    s_cbranch_vccnz interleave_layers__linear_attn_block__memory_aug_recurrent_mem_tr__prompt_kernel_s_prw1_out
    s_sleep 3
    v_mov_b32 v94, 0
    buffer_atomic_add v94, v23, s[8:11], s48 offen sc0
    s_waitcnt vmcnt(3)
    v_cmp_le_i32 vcc, 8, v95
    s_add_u32 s61, s61, 1
    s_cbranch_vccnz interleave_layers__linear_attn_block__memory_aug_recurrent_mem_tr__prompt_kernel_s_prw1_out
    s_sleep 3
    v_mov_b32 v95, 0
    buffer_atomic_add v95, v23, s[8:11], s48 offen sc0
    s_waitcnt vmcnt(3)
    v_cmp_le_i32 vcc, 8, v82
    s_add_u32 s61, s61, 1
    s_cbranch_vccnz interleave_layers__linear_attn_block__memory_aug_recurrent_mem_tr__prompt_kernel_s_prw1_out
    s_sleep 3
    s_cmp_ge_u32 s61, s60
    s_cbranch_scc0 interleave_layers__linear_attn_block__memory_aug_recurrent_mem_tr__prompt_kernel_s_prw1
    s_mov_b32 s60, 1
interleave_layers__linear_attn_block__memory_aug_recurrent_mem_tr__prompt_kernel_s_prw1_out:
    s_mov_b64 exec, -1
    buffer_load_dwordx4 v[84:87], v7, s[8:11], s47 offen sc1
    buffer_load_dwordx4 v[88:91], v7, s[8:11], s46 offen sc1
    buffer_load_dwordx2 v[92:93], v8, s[8:11], s52 offen sc1
    ds_read_b128 v[48:51], v21 offset:0
    ds_read_b128 v[52:55], v21 offset:16
    ds_read_b128 v[56:59], v21 offset:5632
    ds_read_b128 v[60:63], v21 offset:5648
    ds_read_b128 v[64:67], v21 offset:11264
    ds_read_b128 v[68:71], v21 offset:11280
    ds_read_b128 v[72:75], v21 offset:16896
    ds_read_b128 v[76:79], v21 offset:16912
    s_waitcnt lgkmcnt(4)
    v_pk_add_f32 v[48:49], v[48:49], v[56:57]
    v_pk_add_f32 v[50:51], v[50:51], v[58:59]
    v_pk_add_f32 v[52:53], v[52:53], v[60:61]
    v_pk_add_f32 v[54:55], v[54:55], v[62:63]
    s_waitcnt lgkmcnt(0)
    v_pk_add_f32 v[64:65], v[64:65], v[72:73]
    v_pk_add_f32 v[66:67], v[66:67], v[74:75]
    v_pk_add_f32 v[68:69], v[68:69], v[76:77]
    v_pk_add_f32 v[70:71], v[70:71], v[78:79]
    v_pk_add_f32 v[48:49], v[48:49], v[64:65]
    v_pk_add_f32 v[50:51], v[50:51], v[66:67]
    v_pk_add_f32 v[52:53], v[52:53], v[68:69]
    v_pk_add_f32 v[54:55], v[54:55], v[70:71]
    v_mov_b32 v81, 0xff800000
    v_cndmask_b32 v48, v81, v48, s[64:65]
    v_cndmask_b32 v49, v81, v49, s[66:67]
    v_cndmask_b32 v50, v81, v50, s[68:69]
    v_cndmask_b32 v51, v81, v51, s[70:71]
    v_cndmask_b32 v52, v81, v52, s[72:73]
    v_cndmask_b32 v53, v81, v53, s[74:75]
    v_cndmask_b32 v54, v81, v54, s[76:77]
    v_cndmask_b32 v55, v81, v55, s[78:79]
    v_max3_f32 v80, v48, v49, v50
    v_max3_f32 v80, v80, v51, v52
    v_max3_f32 v80, v80, v53, v54
    v_max_f32 v80, v80, v55
    v_mov_b32 v81, 0xff800000
    v_cndmask_b32 v80, v81, v80, s[50:51]
    s_nop 1
    v_max_f32 v80, v80, v80 quad_perm:[1,0,3,2] row_mask:0xf bank_mask:0xf
    s_nop 1
    v_max_f32 v80, v80, v80 quad_perm:[2,3,0,1] row_mask:0xf bank_mask:0xf
    s_nop 1
    v_max_f32 v80, v80, v80 row_half_mirror row_mask:0xf bank_mask:0xf
    s_mov_b32 s24, 0x3dd53b95
    v_mul_f32 v80, s24, v80
    v_fma_f32 v48, v48, s24, -v80
    v_fma_f32 v49, v49, s24, -v80
    v_fma_f32 v50, v50, s24, -v80
    v_fma_f32 v51, v51, s24, -v80
    v_fma_f32 v52, v52, s24, -v80
    v_fma_f32 v53, v53, s24, -v80
    v_fma_f32 v54, v54, s24, -v80
    v_fma_f32 v55, v55, s24, -v80
    v_exp_f32 v48, v48
    v_exp_f32 v49, v49
    v_exp_f32 v50, v50
    v_exp_f32 v51, v51
    v_exp_f32 v52, v52
    v_exp_f32 v53, v53
    v_exp_f32 v54, v54
    v_exp_f32 v55, v55
    v_add_f32 v80, v48, v49
    v_add_f32 v81, v50, v51
    v_add_f32 v80, v80, v52
    v_add_f32 v81, v81, v53
    v_add_f32 v80, v80, v54
    v_add_f32 v81, v81, v55
    v_add_f32 v80, v80, v81
    v_cndmask_b32 v80, 0, v80, s[50:51]
    s_nop 1
    v_add_f32 v80, v80, v80 quad_perm:[1,0,3,2] row_mask:0xf bank_mask:0xf
    s_nop 1
    v_add_f32 v80, v80, v80 quad_perm:[2,3,0,1] row_mask:0xf bank_mask:0xf
    s_nop 1
    v_add_f32 v80, v80, v80 row_half_mirror row_mask:0xf bank_mask:0xf
    v_rcp_f32 v80, v80
    s_nop 0
    v_mul_f32 v48, v48, v80
    v_mul_f32 v49, v49, v80
    v_mul_f32 v50, v50, v80
    v_mul_f32 v51, v51, v80
    v_mul_f32 v52, v52, v80
    v_mul_f32 v53, v53, v80
    v_mul_f32 v54, v54, v80
    v_mul_f32 v55, v55, v80
    v_cvt_pk_bf16_f32 v56, v48, v49
    v_cvt_pk_bf16_f32 v57, v50, v51
    v_cvt_pk_bf16_f32 v58, v52, v53
    v_cvt_pk_bf16_f32 v59, v54, v55
    v_min_u32 v56, -2, v56
    v_min_u32 v57, -2, v57
    v_min_u32 v58, -2, v58
    v_min_u32 v59, -2, v59
    buffer_store_dwordx4 v[56:59], v22, s[8:11], s42 offen sc1
    s_waitcnt vmcnt(1)
    s_nop 0
    v_max3_u32 v58, v84, v85, v86
    v_max3_u32 v58, v58, v87, v88
    v_max3_u32 v58, v58, v89, v90
    v_max3_u32 v58, v58, v91, v92
    v_max_u32 v58, v58, v93
    v_cmp_eq_u32 vcc, -1, v58
    s_cbranch_vccz interleave_layers__linear_attn_block__memory_aug_recurrent_mem_tr__prompt_kernel_s_pmw1_out
    s_mov_b32 s61, 0
interleave_layers__linear_attn_block__memory_aug_recurrent_mem_tr__prompt_kernel_s_pmw1:
    buffer_load_dwordx4 v[84:87], v7, s[8:11], s47 offen sc1
    buffer_load_dwordx4 v[88:91], v7, s[8:11], s46 offen sc1
    buffer_load_dwordx2 v[92:93], v8, s[8:11], s52 offen sc1
    s_waitcnt vmcnt(0)
    v_max3_u32 v58, v84, v85, v86
    v_max3_u32 v58, v58, v87, v88
    v_max3_u32 v58, v58, v89, v90
    v_max3_u32 v58, v58, v91, v92
    v_max_u32 v58, v58, v93
    v_cmp_eq_u32 vcc, -1, v58
    s_add_u32 s61, s61, 1
    s_cbranch_vccz interleave_layers__linear_attn_block__memory_aug_recurrent_mem_tr__prompt_kernel_s_pmw1_out
    s_cmp_ge_u32 s61, s60
    s_cbranch_scc1 interleave_layers__linear_attn_block__memory_aug_recurrent_mem_tr__prompt_kernel_s_pmw1_to
    s_sleep 1
    s_branch interleave_layers__linear_attn_block__memory_aug_recurrent_mem_tr__prompt_kernel_s_pmw1
interleave_layers__linear_attn_block__memory_aug_recurrent_mem_tr__prompt_kernel_s_pmw1_to:
    s_mov_b32 s60, 1
interleave_layers__linear_attn_block__memory_aug_recurrent_mem_tr__prompt_kernel_s_pmw1_out:
    ds_write_b128 v7, v[84:87]
    ds_write_b128 v7, v[88:91] offset:4096
    ds_write_b64 v8, v[92:93]
interleave_layers__linear_attn_block__memory_aug_recurrent_mem_tr__prompt_kernel_s_gow1:
    ds_read_b128 v[68:71], v6 offset:2048
    ds_read_b128 v[72:75], v6 offset:3072
    ds_read_b128 v[76:79], v6 offset:10240
    ds_read_b128 v[80:83], v6 offset:11264
    v_smfmac_f32_16x16x64_bf16 v[24:27], v[84:87], a[8:15], v4
    v_smfmac_f32_16x16x64_bf16 v[28:31], v[84:87], a[88:95], v4
    v_smfmac_f32_16x16x64_bf16 v[32:35], v[84:87], a[168:175], v4
    v_smfmac_f32_16x16x64_bf16 v[40:43], v[84:87], v[104:111], v4
    v_smfmac_f32_16x16x64_bf16 v[44:47], v[84:87], v[184:191], v4
    s_waitcnt lgkmcnt(2)
    v_smfmac_f32_16x16x64_bf16 v[36:39], v[84:87], v[68:75], v4
    ds_read_b128 v[68:71], v6 offset:0
    ds_read_b128 v[72:75], v6 offset:1024
    s_barrier
    ds_read_b128 v[48:51], v5 offset:0
    ds_read_b128 v[52:55], v5 offset:2048
    ds_read_b128 v[56:59], v5 offset:3072
    ds_read_b128 v[60:63], v5 offset:4096
    ds_read_b128 v[64:67], v5 offset:6144
    v_smfmac_f32_16x16x64_bf16 v[24:27], v[88:91], a[40:47], v4
    v_smfmac_f32_16x16x64_bf16 v[28:31], v[88:91], a[120:127], v4
    v_smfmac_f32_16x16x64_bf16 v[32:35], v[88:91], a[200:207], v4
    v_smfmac_f32_16x16x64_bf16 v[40:43], v[88:91], v[136:143], v4
    v_smfmac_f32_16x16x64_bf16 v[44:47], v[88:91], v[216:223], v4
    s_waitcnt lgkmcnt(7)
    v_smfmac_f32_16x16x64_bf16 v[36:39], v[88:91], v[76:83], v4
    ds_read_b128 v[76:79], v6 offset:4096
    ds_read_b128 v[80:83], v6 offset:5120
    s_waitcnt lgkmcnt(6)
    v_smfmac_f32_16x16x64_bf16 v[24:27], v[48:51], a[0:7], v4
    v_smfmac_f32_16x16x64_bf16 v[28:31], v[48:51], a[80:87], v4
    v_smfmac_f32_16x16x64_bf16 v[40:43], v[48:51], v[96:103], v4
    v_smfmac_f32_16x16x64_bf16 v[36:39], v[48:51], v[68:75], v4
    ds_read_b128 v[68:71], v6 offset:6144
    ds_read_b128 v[72:75], v6 offset:7168
    ds_read_b128 v[48:51], v5 offset:7168
    s_waitcnt lgkmcnt(8)
    v_smfmac_f32_16x16x64_bf16 v[24:27], v[52:55], a[16:23], v4
    v_smfmac_f32_16x16x64_bf16 v[28:31], v[52:55], a[96:103], v4
    v_smfmac_f32_16x16x64_bf16 v[40:43], v[52:55], v[112:119], v4
    s_waitcnt lgkmcnt(3)
    v_smfmac_f32_16x16x64_bf16 v[36:39], v[52:55], v[76:83], v4
    ds_read_b128 v[76:79], v6 offset:8192
    ds_read_b128 v[80:83], v6 offset:9216
    ds_read_b128 v[52:55], v5 offset:8192
    v_smfmac_f32_16x16x64_bf16 v[24:27], v[56:59], a[24:31], v4
    v_smfmac_f32_16x16x64_bf16 v[28:31], v[56:59], a[104:111], v4
    v_smfmac_f32_16x16x64_bf16 v[40:43], v[56:59], v[120:127], v4
    s_waitcnt lgkmcnt(4)
    v_smfmac_f32_16x16x64_bf16 v[36:39], v[56:59], v[68:75], v4
    ds_read_b128 v[68:71], v6 offset:12288
    ds_read_b128 v[72:75], v6 offset:13312
    ds_read_b128 v[56:59], v5 offset:9216
    v_smfmac_f32_16x16x64_bf16 v[24:27], v[60:63], a[32:39], v4
    v_smfmac_f32_16x16x64_bf16 v[28:31], v[60:63], a[112:119], v4
    v_smfmac_f32_16x16x64_bf16 v[40:43], v[60:63], v[128:135], v4
    s_waitcnt lgkmcnt(4)
    v_smfmac_f32_16x16x64_bf16 v[36:39], v[60:63], v[76:83], v4
    ds_read_b128 v[76:79], v6 offset:14336
    ds_read_b128 v[80:83], v6 offset:15360
    ds_read_b128 v[60:63], v5 offset:0
    v_smfmac_f32_16x16x64_bf16 v[24:27], v[64:67], a[48:55], v4
    v_smfmac_f32_16x16x64_bf16 v[28:31], v[64:67], a[128:135], v4
    v_smfmac_f32_16x16x64_bf16 v[40:43], v[64:67], v[144:151], v4
    s_waitcnt lgkmcnt(4)
    v_smfmac_f32_16x16x64_bf16 v[36:39], v[64:67], v[68:75], v4
    ds_read_b128 v[68:71], v6 offset:16384
    ds_read_b128 v[72:75], v6 offset:17408
    ds_read_b128 v[64:67], v5 offset:2048
    v_smfmac_f32_16x16x64_bf16 v[24:27], v[48:51], a[56:63], v4
    v_smfmac_f32_16x16x64_bf16 v[28:31], v[48:51], a[136:143], v4
    v_smfmac_f32_16x16x64_bf16 v[40:43], v[48:51], v[152:159], v4
    s_waitcnt lgkmcnt(4)
    v_smfmac_f32_16x16x64_bf16 v[36:39], v[48:51], v[76:83], v4
    ds_read_b128 v[76:79], v6 offset:18432
    ds_read_b128 v[80:83], v6 offset:19456
    ds_read_b128 v[48:51], v5 offset:3072
    v_smfmac_f32_16x16x64_bf16 v[24:27], v[52:55], a[64:71], v4
    v_smfmac_f32_16x16x64_bf16 v[28:31], v[52:55], a[144:151], v4
    v_smfmac_f32_16x16x64_bf16 v[40:43], v[52:55], v[160:167], v4
    s_waitcnt lgkmcnt(4)
    v_smfmac_f32_16x16x64_bf16 v[36:39], v[52:55], v[68:75], v4
    ds_read_b128 v[52:55], v5 offset:4096
    v_smfmac_f32_16x16x64_bf16 v[24:27], v[56:59], a[72:79], v4
    v_smfmac_f32_16x16x64_bf16 v[28:31], v[56:59], a[152:159], v4
    v_smfmac_f32_16x16x64_bf16 v[40:43], v[56:59], v[168:175], v4
    s_waitcnt lgkmcnt(2)
    v_smfmac_f32_16x16x64_bf16 v[36:39], v[56:59], v[76:83], v4
    ds_read_b128 v[56:59], v5 offset:6144
    buffer_load_dwordx4 v[80:83], v19, s[8:11], s45 offen offset:0 sc1
    buffer_load_dwordx4 v[84:87], v19, s[8:11], s45 offen offset:1024 sc1
    buffer_load_dwordx4 v[88:91], v19, s[8:11], s45 offen offset:2048 sc1
    v_smfmac_f32_16x16x64_bf16 v[32:35], v[60:63], a[160:167], v4
    v_smfmac_f32_16x16x64_bf16 v[44:47], v[60:63], v[176:183], v4
    v_permlane32_swap_b32 v28, v40
    v_permlane32_swap_b32 v29, v41
    ds_read_b128 v[60:63], v5 offset:7168
    v_smfmac_f32_16x16x64_bf16 v[32:35], v[64:67], a[176:183], v4
    v_permlane32_swap_b32 v30, v42
    v_permlane32_swap_b32 v31, v43
    v_smfmac_f32_16x16x64_bf16 v[44:47], v[64:67], v[192:199], v4
    v_add_f32 v28, v28, v40
    v_add_f32 v29, v29, v41
    ds_read_b128 v[64:67], v5 offset:8192
    s_waitcnt lgkmcnt(4)
    v_smfmac_f32_16x16x64_bf16 v[32:35], v[48:51], a[184:191], v4
    v_add_f32 v30, v30, v42
    v_add_f32 v31, v31, v43
    v_smfmac_f32_16x16x64_bf16 v[44:47], v[48:51], v[200:207], v4
    v_cvt_pk_bf16_f32 v40, v28, v29
    v_cvt_pk_bf16_f32 v41, v30, v31
    ds_read_b128 v[48:51], v5 offset:9216
    s_waitcnt lgkmcnt(4)
    v_smfmac_f32_16x16x64_bf16 v[32:35], v[52:55], a[192:199], v4
    v_mfma_f32_16x16x16_bf16 v[28:31], v[40:41], v[10:11], 0
    v_permlane32_swap_b32 v24, v36
    v_smfmac_f32_16x16x64_bf16 v[44:47], v[52:55], v[208:215], v4
    v_permlane32_swap_b32 v25, v37
    v_permlane32_swap_b32 v26, v38
    s_waitcnt lgkmcnt(3)
    v_smfmac_f32_16x16x64_bf16 v[32:35], v[56:59], a[208:215], v4
    v_permlane32_swap_b32 v27, v39
    v_add_f32 v24, v24, v36
    v_smfmac_f32_16x16x64_bf16 v[44:47], v[56:59], v[224:231], v4
    v_add_f32 v25, v25, v37
    v_add_f32 v26, v26, v38
    s_waitcnt lgkmcnt(2)
    v_smfmac_f32_16x16x64_bf16 v[32:35], v[60:63], a[216:223], v4
    v_add_f32 v27, v27, v39
    v_cvt_pk_bf16_f32 v36, v24, v25
    v_smfmac_f32_16x16x64_bf16 v[44:47], v[60:63], v[232:239], v4
    v_cvt_pk_bf16_f32 v37, v26, v27
    s_nop 1
    v_mfma_f32_16x16x16_bf16 v[24:27], v[36:37], v[10:11], 0
    s_waitcnt lgkmcnt(1)
    v_smfmac_f32_16x16x64_bf16 v[32:35], v[64:67], a[224:231], v4
    s_nop 5
    v_cvt_pk_bf16_f32 v24, v24, v25
    v_smfmac_f32_16x16x64_bf16 v[44:47], v[64:67], v[240:247], v4
    v_cvt_pk_bf16_f32 v25, v26, v27
    v_cvt_pk_bf16_f32 v26, v28, v29
    s_waitcnt lgkmcnt(0)
    v_smfmac_f32_16x16x64_bf16 v[32:35], v[48:51], a[232:239], v4
    v_cvt_pk_bf16_f32 v27, v30, v31
    s_waitcnt vmcnt(3)
    v_smfmac_f32_16x16x64_bf16 v[44:47], v[48:51], v[248:255], v4
    v_mfma_f32_16x16x32_bf16 v[28:31], a[240:243], v[24:27], 0
    v_mfma_f32_16x16x32_bf16 v[36:39], a[244:247], v[24:27], 0
    v_mfma_f32_16x16x32_bf16 v[40:43], v[24:27], v[24:27], 0
    s_nop 4
    v_permlane32_swap_b32 v32, v44
    v_permlane32_swap_b32 v33, v45
    v_permlane32_swap_b32 v34, v46
    v_permlane32_swap_b32 v35, v47
    v_add_f32 v32, v32, v44
    v_add_f32 v33, v33, v45
    v_add_f32 v34, v34, v46
    v_add_f32 v35, v35, v47
    v_cvt_pk_bf16_f32 v44, v32, v33
    v_cvt_pk_bf16_f32 v45, v34, v35
    s_nop 1
    v_mfma_f32_16x16x16_bf16 v[32:35], v[44:45], v[10:11], 0
    s_nop 7
    v_cvt_pk_bf16_f32 v32, v32, v33
    v_cvt_pk_bf16_f32 v33, v34, v35
    s_nop 1
    v_mfma_f32_16x16x16_bf16 v[28:31], a[248:249], v[32:33], v[28:31]
    v_mfma_f32_16x16x16_bf16 v[36:39], a[250:251], v[32:33], v[36:39]
    v_mfma_f32_16x16x16_bf16 v[40:43], v[32:33], v[32:33], v[40:43]
    s_nop 5
    ds_write_b128 v12, v[28:31]
    ds_write_b128 v12, v[36:39] offset:16
    ds_write_b128 v13, v[40:43]
    s_waitcnt lgkmcnt(0)
    s_barrier
    s_waitcnt vmcnt(0)
    v_mfma_f32_16x16x32_bf16 v[36:39], a[240:243], v[80:83], 0
    v_mfma_f32_16x16x32_bf16 v[44:47], a[244:247], v[80:83], 0
    v_mfma_f32_16x16x32_bf16 v[68:71], v[24:27], v[80:83], 0
    v_mfma_f32_16x16x32_bf16 v[40:43], a[240:243], v[84:87], 0
    v_mfma_f32_16x16x32_bf16 v[64:67], a[244:247], v[84:87], 0
    v_mfma_f32_16x16x32_bf16 v[72:75], v[24:27], v[84:87], 0
    s_nop 0
    v_mfma_f32_16x16x16_bf16 v[36:39], a[248:249], v[88:89], v[36:39]
    v_mfma_f32_16x16x16_bf16 v[44:47], a[250:251], v[88:89], v[44:47]
    v_mfma_f32_16x16x16_bf16 v[68:71], v[32:33], v[88:89], v[68:71]
    v_mfma_f32_16x16x16_bf16 v[40:43], a[248:249], v[90:91], v[40:43]
    v_mfma_f32_16x16x16_bf16 v[64:67], a[250:251], v[90:91], v[64:67]
    v_mfma_f32_16x16x16_bf16 v[72:75], v[32:33], v[90:91], v[72:75]
    s_nop 2
    ds_write_b128 v16, v[36:39] offset:0
    ds_write_b128 v16, v[44:47] offset:16
    ds_write_b128 v17, v[68:71]
    ds_write_b128 v16, v[40:43] offset:2816
    ds_write_b128 v16, v[64:67] offset:2832
    ds_write_b128 v18, v[72:75]
    s_add_u32 s40, s40, 1
    s_add_u32 s41, s41, 393216
    s_add_u32 s45, s45, 393216
    s_add_u32 s47, s37, 704512
    s_add_u32 s48, s37, 737280
    s_xor_b32 s42, s37, 0x2000
    s_lshl_b32 s24, s40, 12
    s_and_b32 s24, s24, 0x2000
    s_xor_b32 s24, s24, s36
    s_lshl_b32 s37, s40, 20
    s_add_u32 s37, s37, s24
    s_add_u32 s37, s37, 117440512
    s_add_u32 s43, s37, 655360
    s_add_u32 s49, s37, 753664
    s_waitcnt lgkmcnt(0)
    s_barrier
    s_cmp_lt_u32 s40, 64
    s_cbranch_scc1 interleave_layers__linear_attn_block__memory_aug_recurrent_mem_tr__prompt_kernel_s_stepw1
    s_branch interleave_layers__linear_attn_block__memory_aug_recurrent_mem_tr__prompt_kernel_s_end
interleave_layers__linear_attn_block__memory_aug_recurrent_mem_tr__prompt_kernel_s_stepw2:
    v_mov_b32 v24, 0
    v_mov_b32 v25, 0
    v_mov_b32 v26, 0
    v_mov_b32 v27, 0
    v_mov_b32 v28, 0
    v_mov_b32 v29, 0
    v_mov_b32 v30, 0
    v_mov_b32 v31, 0
    v_mov_b32 v32, 0
    v_mov_b32 v33, 0
    v_mov_b32 v34, 0
    v_mov_b32 v35, 0
    v_mov_b32 v36, 0
    v_mov_b32 v37, 0
    v_mov_b32 v38, 0
    v_mov_b32 v39, 0
    v_mov_b32 v40, 0
    v_mov_b32 v41, 0
    v_mov_b32 v42, 0
    v_mov_b32 v43, 0
    v_mov_b32 v44, 0
    v_mov_b32 v45, 0
    v_mov_b32 v46, 0
    v_mov_b32 v47, 0
    s_add_u32 s46, s47, 4096
    s_add_u32 s52, s47, 8192
    s_lshl_b32 s95, s92, 6
    s_add_u32 s95, s95, s40
    s_add_u32 s95, s95, 1
    s_cmp_ge_i32 s59, s95
    s_cbranch_scc1 interleave_layers__linear_attn_block__memory_aug_recurrent_mem_tr__prompt_kernel_s_ecw2_ok
    s_and_b32 s24, s2, 7
    s_lshl_b32 s24, s24, 7
    s_add_u32 s24, s24, 23109632
    v_and_b32 v49, 3, v1
    v_lshl_add_u32 v49, v49, 2, s24
    s_mov_b32 s61, 0
interleave_layers__linear_attn_block__memory_aug_recurrent_mem_tr__prompt_kernel_s_ecw2:
    buffer_load_dword v48, v49, s[8:11], 0 offen sc1
    s_waitcnt vmcnt(0)
    v_readlane_b32 s59, v48, 0
    v_readlane_b32 s24, v48, 1
    s_min_i32 s59, s59, s24
    v_readlane_b32 s24, v48, 2
    s_min_i32 s59, s59, s24
    s_cmp_ge_i32 s59, s95
    s_cbranch_scc1 interleave_layers__linear_attn_block__memory_aug_recurrent_mem_tr__prompt_kernel_s_ecw2_ok
    s_add_u32 s61, s61, 1
    s_cmp_ge_u32 s61, s60
    s_cbranch_scc1 interleave_layers__linear_attn_block__memory_aug_recurrent_mem_tr__prompt_kernel_s_ecw2_to
    s_sleep 2
    s_branch interleave_layers__linear_attn_block__memory_aug_recurrent_mem_tr__prompt_kernel_s_ecw2
interleave_layers__linear_attn_block__memory_aug_recurrent_mem_tr__prompt_kernel_s_ecw2_to:
    s_mov_b32 s60, 1
interleave_layers__linear_attn_block__memory_aug_recurrent_mem_tr__prompt_kernel_s_ecw2_ok:
    s_add_u32 s63, s40, 1
    s_cmp_ge_i32 s62, s63
    s_cbranch_scc1 interleave_layers__linear_attn_block__memory_aug_recurrent_mem_tr__prompt_kernel_s_enw2_ok
    s_mov_b32 s61, 0
interleave_layers__linear_attn_block__memory_aug_recurrent_mem_tr__prompt_kernel_s_enw2:
    buffer_load_dword v48, v9, s[8:11], 0 offen sc1
    s_waitcnt vmcnt(0)
    v_readlane_b32 s62, v48, 0
    v_readlane_b32 s24, v48, 1
    s_min_i32 s62, s62, s24
    s_cmp_ge_i32 s62, s63
    s_cbranch_scc1 interleave_layers__linear_attn_block__memory_aug_recurrent_mem_tr__prompt_kernel_s_enw2_ok
    s_add_u32 s61, s61, 1
    s_cmp_ge_u32 s61, s60
    s_cbranch_scc1 interleave_layers__linear_attn_block__memory_aug_recurrent_mem_tr__prompt_kernel_s_enw2_to
    s_sleep 2
    s_branch interleave_layers__linear_attn_block__memory_aug_recurrent_mem_tr__prompt_kernel_s_enw2
interleave_layers__linear_attn_block__memory_aug_recurrent_mem_tr__prompt_kernel_s_enw2_to:
    s_mov_b32 s60, 1
interleave_layers__linear_attn_block__memory_aug_recurrent_mem_tr__prompt_kernel_s_enw2_ok:
    buffer_load_dwordx4 a[240:243], v19, s[8:11], s41 offen offset:0 sc1
    buffer_load_dwordx4 a[244:247], v19, s[8:11], s41 offen offset:1024 sc1
    buffer_load_dwordx4 a[248:251], v19, s[8:11], s41 offen offset:2048 sc1
    s_sleep 5
    s_mov_b64 exec, 1
    s_mov_b32 s61, 0
    v_mov_b32 v83, 0
    buffer_atomic_add v83, v23, s[8:11], s48 offen sc0
    s_sleep 3
    v_mov_b32 v94, 0
    buffer_atomic_add v94, v23, s[8:11], s48 offen sc0
    s_sleep 3
    v_mov_b32 v95, 0
    buffer_atomic_add v95, v23, s[8:11], s48 offen sc0
    s_sleep 3
interleave_layers__linear_attn_block__memory_aug_recurrent_mem_tr__prompt_kernel_s_prw2:
    v_mov_b32 v82, 0
    buffer_atomic_add v82, v23, s[8:11], s48 offen sc0
    s_waitcnt vmcnt(3)
    v_cmp_le_i32 vcc, 8, v83
    s_add_u32 s61, s61, 1
    s_cbranch_vccnz interleave_layers__linear_attn_block__memory_aug_recurrent_mem_tr__prompt_kernel_s_prw2_out
    s_sleep 3
    v_mov_b32 v83, 0
    buffer_atomic_add v83, v23, s[8:11], s48 offen sc0
    s_waitcnt vmcnt(3)
    v_cmp_le_i32 vcc, 8, v94
    s_add_u32 s61, s61, 1
    s_cbranch_vccnz interleave_layers__linear_attn_block__memory_aug_recurrent_mem_tr__prompt_kernel_s_prw2_out
    s_sleep 3
    v_mov_b32 v94, 0
    buffer_atomic_add v94, v23, s[8:11], s48 offen sc0
    s_waitcnt vmcnt(3)
    v_cmp_le_i32 vcc, 8, v95
    s_add_u32 s61, s61, 1
    s_cbranch_vccnz interleave_layers__linear_attn_block__memory_aug_recurrent_mem_tr__prompt_kernel_s_prw2_out
    s_sleep 3
    v_mov_b32 v95, 0
    buffer_atomic_add v95, v23, s[8:11], s48 offen sc0
    s_waitcnt vmcnt(3)
    v_cmp_le_i32 vcc, 8, v82
    s_add_u32 s61, s61, 1
    s_cbranch_vccnz interleave_layers__linear_attn_block__memory_aug_recurrent_mem_tr__prompt_kernel_s_prw2_out
    s_sleep 3
    s_cmp_ge_u32 s61, s60
    s_cbranch_scc0 interleave_layers__linear_attn_block__memory_aug_recurrent_mem_tr__prompt_kernel_s_prw2
    s_mov_b32 s60, 1
interleave_layers__linear_attn_block__memory_aug_recurrent_mem_tr__prompt_kernel_s_prw2_out:
    s_mov_b64 exec, -1
    buffer_load_dwordx4 v[84:87], v7, s[8:11], s47 offen sc1
    buffer_load_dwordx4 v[88:91], v7, s[8:11], s46 offen sc1
    buffer_load_dwordx2 v[92:93], v8, s[8:11], s52 offen sc1
    ds_read_b128 v[48:51], v21 offset:0
    ds_read_b128 v[52:55], v21 offset:16
    ds_read_b128 v[56:59], v21 offset:5632
    ds_read_b128 v[60:63], v21 offset:5648
    ds_read_b128 v[64:67], v21 offset:11264
    ds_read_b128 v[68:71], v21 offset:11280
    ds_read_b128 v[72:75], v21 offset:16896
    ds_read_b128 v[76:79], v21 offset:16912
    s_waitcnt lgkmcnt(4)
    v_pk_add_f32 v[48:49], v[48:49], v[56:57]
    v_pk_add_f32 v[50:51], v[50:51], v[58:59]
    v_pk_add_f32 v[52:53], v[52:53], v[60:61]
    v_pk_add_f32 v[54:55], v[54:55], v[62:63]
    s_waitcnt lgkmcnt(0)
    v_pk_add_f32 v[64:65], v[64:65], v[72:73]
    v_pk_add_f32 v[66:67], v[66:67], v[74:75]
    v_pk_add_f32 v[68:69], v[68:69], v[76:77]
    v_pk_add_f32 v[70:71], v[70:71], v[78:79]
    v_pk_add_f32 v[48:49], v[48:49], v[64:65]
    v_pk_add_f32 v[50:51], v[50:51], v[66:67]
    v_pk_add_f32 v[52:53], v[52:53], v[68:69]
    v_pk_add_f32 v[54:55], v[54:55], v[70:71]
    v_mov_b32 v81, 0xff800000
    v_cndmask_b32 v48, v81, v48, s[64:65]
    v_cndmask_b32 v49, v81, v49, s[66:67]
    v_cndmask_b32 v50, v81, v50, s[68:69]
    v_cndmask_b32 v51, v81, v51, s[70:71]
    v_cndmask_b32 v52, v81, v52, s[72:73]
    v_cndmask_b32 v53, v81, v53, s[74:75]
    v_cndmask_b32 v54, v81, v54, s[76:77]
    v_cndmask_b32 v55, v81, v55, s[78:79]
    v_max3_f32 v80, v48, v49, v50
    v_max3_f32 v80, v80, v51, v52
    v_max3_f32 v80, v80, v53, v54
    v_max_f32 v80, v80, v55
    v_mov_b32 v81, 0xff800000
    v_cndmask_b32 v80, v81, v80, s[50:51]
    s_nop 1
    v_max_f32 v80, v80, v80 quad_perm:[1,0,3,2] row_mask:0xf bank_mask:0xf
    s_nop 1
    v_max_f32 v80, v80, v80 quad_perm:[2,3,0,1] row_mask:0xf bank_mask:0xf
    s_nop 1
    v_max_f32 v80, v80, v80 row_half_mirror row_mask:0xf bank_mask:0xf
    s_mov_b32 s24, 0x3dd53b95
    v_mul_f32 v80, s24, v80
    v_fma_f32 v48, v48, s24, -v80
    v_fma_f32 v49, v49, s24, -v80
    v_fma_f32 v50, v50, s24, -v80
    v_fma_f32 v51, v51, s24, -v80
    v_fma_f32 v52, v52, s24, -v80
    v_fma_f32 v53, v53, s24, -v80
    v_fma_f32 v54, v54, s24, -v80
    v_fma_f32 v55, v55, s24, -v80
    v_exp_f32 v48, v48
    v_exp_f32 v49, v49
    v_exp_f32 v50, v50
    v_exp_f32 v51, v51
    v_exp_f32 v52, v52
    v_exp_f32 v53, v53
    v_exp_f32 v54, v54
    v_exp_f32 v55, v55
    v_add_f32 v80, v48, v49
    v_add_f32 v81, v50, v51
    v_add_f32 v80, v80, v52
    v_add_f32 v81, v81, v53
    v_add_f32 v80, v80, v54
    v_add_f32 v81, v81, v55
    v_add_f32 v80, v80, v81
    v_cndmask_b32 v80, 0, v80, s[50:51]
    s_nop 1
    v_add_f32 v80, v80, v80 quad_perm:[1,0,3,2] row_mask:0xf bank_mask:0xf
    s_nop 1
    v_add_f32 v80, v80, v80 quad_perm:[2,3,0,1] row_mask:0xf bank_mask:0xf
    s_nop 1
    v_add_f32 v80, v80, v80 row_half_mirror row_mask:0xf bank_mask:0xf
    v_rcp_f32 v80, v80
    s_nop 0
    v_mul_f32 v48, v48, v80
    v_mul_f32 v49, v49, v80
    v_mul_f32 v50, v50, v80
    v_mul_f32 v51, v51, v80
    v_mul_f32 v52, v52, v80
    v_mul_f32 v53, v53, v80
    v_mul_f32 v54, v54, v80
    v_mul_f32 v55, v55, v80
    v_cvt_pk_bf16_f32 v56, v48, v49
    v_cvt_pk_bf16_f32 v57, v50, v51
    v_cvt_pk_bf16_f32 v58, v52, v53
    v_cvt_pk_bf16_f32 v59, v54, v55
    v_min_u32 v56, -2, v56
    v_min_u32 v57, -2, v57
    v_min_u32 v58, -2, v58
    v_min_u32 v59, -2, v59
    buffer_store_dwordx4 v[56:59], v22, s[8:11], s42 offen sc1
    s_waitcnt vmcnt(1)
    s_nop 0
    v_max3_u32 v58, v84, v85, v86
    v_max3_u32 v58, v58, v87, v88
    v_max3_u32 v58, v58, v89, v90
    v_max3_u32 v58, v58, v91, v92
    v_max_u32 v58, v58, v93
    v_cmp_eq_u32 vcc, -1, v58
    s_cbranch_vccz interleave_layers__linear_attn_block__memory_aug_recurrent_mem_tr__prompt_kernel_s_pmw2_out
    s_mov_b32 s61, 0
interleave_layers__linear_attn_block__memory_aug_recurrent_mem_tr__prompt_kernel_s_pmw2:
    buffer_load_dwordx4 v[84:87], v7, s[8:11], s47 offen sc1
    buffer_load_dwordx4 v[88:91], v7, s[8:11], s46 offen sc1
    buffer_load_dwordx2 v[92:93], v8, s[8:11], s52 offen sc1
    s_waitcnt vmcnt(0)
    v_max3_u32 v58, v84, v85, v86
    v_max3_u32 v58, v58, v87, v88
    v_max3_u32 v58, v58, v89, v90
    v_max3_u32 v58, v58, v91, v92
    v_max_u32 v58, v58, v93
    v_cmp_eq_u32 vcc, -1, v58
    s_add_u32 s61, s61, 1
    s_cbranch_vccz interleave_layers__linear_attn_block__memory_aug_recurrent_mem_tr__prompt_kernel_s_pmw2_out
    s_cmp_ge_u32 s61, s60
    s_cbranch_scc1 interleave_layers__linear_attn_block__memory_aug_recurrent_mem_tr__prompt_kernel_s_pmw2_to
    s_sleep 1
    s_branch interleave_layers__linear_attn_block__memory_aug_recurrent_mem_tr__prompt_kernel_s_pmw2
interleave_layers__linear_attn_block__memory_aug_recurrent_mem_tr__prompt_kernel_s_pmw2_to:
    s_mov_b32 s60, 1
interleave_layers__linear_attn_block__memory_aug_recurrent_mem_tr__prompt_kernel_s_pmw2_out:
    ds_write_b128 v7, v[84:87]
    ds_write_b128 v7, v[88:91] offset:4096
    ds_write_b64 v8, v[92:93]
interleave_layers__linear_attn_block__memory_aug_recurrent_mem_tr__prompt_kernel_s_gow2:
    ds_read_b128 v[68:71], v6 offset:4096
    ds_read_b128 v[72:75], v6 offset:5120
    ds_read_b128 v[76:79], v6 offset:12288
    ds_read_b128 v[80:83], v6 offset:13312
    v_smfmac_f32_16x16x64_bf16 v[24:27], v[84:87], a[16:23], v4
    v_smfmac_f32_16x16x64_bf16 v[28:31], v[84:87], a[96:103], v4
    v_smfmac_f32_16x16x64_bf16 v[32:35], v[84:87], a[176:183], v4
    v_smfmac_f32_16x16x64_bf16 v[40:43], v[84:87], v[112:119], v4
    v_smfmac_f32_16x16x64_bf16 v[44:47], v[84:87], v[192:199], v4
    s_waitcnt lgkmcnt(2)
    v_smfmac_f32_16x16x64_bf16 v[36:39], v[84:87], v[68:75], v4
    ds_read_b128 v[68:71], v6 offset:0
    ds_read_b128 v[72:75], v6 offset:1024
    s_barrier
    ds_read_b128 v[48:51], v5 offset:0
    ds_read_b128 v[52:55], v5 offset:1024
    ds_read_b128 v[56:59], v5 offset:3072
    ds_read_b128 v[60:63], v5 offset:4096
    ds_read_b128 v[64:67], v5 offset:5120
    v_smfmac_f32_16x16x64_bf16 v[24:27], v[88:91], a[48:55], v4
    v_smfmac_f32_16x16x64_bf16 v[28:31], v[88:91], a[128:135], v4
    v_smfmac_f32_16x16x64_bf16 v[32:35], v[88:91], a[208:215], v4
    v_smfmac_f32_16x16x64_bf16 v[40:43], v[88:91], v[144:151], v4
    v_smfmac_f32_16x16x64_bf16 v[44:47], v[88:91], v[224:231], v4
    s_waitcnt lgkmcnt(7)
    v_smfmac_f32_16x16x64_bf16 v[36:39], v[88:91], v[76:83], v4
    ds_read_b128 v[76:79], v6 offset:2048
    ds_read_b128 v[80:83], v6 offset:3072
    s_waitcnt lgkmcnt(6)
    v_smfmac_f32_16x16x64_bf16 v[24:27], v[48:51], a[0:7], v4
    v_smfmac_f32_16x16x64_bf16 v[28:31], v[48:51], a[80:87], v4
    v_smfmac_f32_16x16x64_bf16 v[40:43], v[48:51], v[96:103], v4
    v_smfmac_f32_16x16x64_bf16 v[36:39], v[48:51], v[68:75], v4
    ds_read_b128 v[68:71], v6 offset:6144
    ds_read_b128 v[72:75], v6 offset:7168
    ds_read_b128 v[48:51], v5 offset:7168
    s_waitcnt lgkmcnt(8)
    v_smfmac_f32_16x16x64_bf16 v[24:27], v[52:55], a[8:15], v4
    v_smfmac_f32_16x16x64_bf16 v[28:31], v[52:55], a[88:95], v4
    v_smfmac_f32_16x16x64_bf16 v[40:43], v[52:55], v[104:111], v4
    s_waitcnt lgkmcnt(3)
    v_smfmac_f32_16x16x64_bf16 v[36:39], v[52:55], v[76:83], v4
    ds_read_b128 v[76:79], v6 offset:8192
    ds_read_b128 v[80:83], v6 offset:9216
    ds_read_b128 v[52:55], v5 offset:8192
    v_smfmac_f32_16x16x64_bf16 v[24:27], v[56:59], a[24:31], v4
    v_smfmac_f32_16x16x64_bf16 v[28:31], v[56:59], a[104:111], v4
    v_smfmac_f32_16x16x64_bf16 v[40:43], v[56:59], v[120:127], v4
    s_waitcnt lgkmcnt(4)
    v_smfmac_f32_16x16x64_bf16 v[36:39], v[56:59], v[68:75], v4
    ds_read_b128 v[68:71], v6 offset:10240
    ds_read_b128 v[72:75], v6 offset:11264
    ds_read_b128 v[56:59], v5 offset:9216
    v_smfmac_f32_16x16x64_bf16 v[24:27], v[60:63], a[32:39], v4
    v_smfmac_f32_16x16x64_bf16 v[28:31], v[60:63], a[112:119], v4
    v_smfmac_f32_16x16x64_bf16 v[40:43], v[60:63], v[128:135], v4
    s_waitcnt lgkmcnt(4)
    v_smfmac_f32_16x16x64_bf16 v[36:39], v[60:63], v[76:83], v4
    ds_read_b128 v[76:79], v6 offset:14336
    ds_read_b128 v[80:83], v6 offset:15360
    ds_read_b128 v[60:63], v5 offset:0
    v_smfmac_f32_16x16x64_bf16 v[24:27], v[64:67], a[40:47], v4
    v_smfmac_f32_16x16x64_bf16 v[28:31], v[64:67], a[120:127], v4
    v_smfmac_f32_16x16x64_bf16 v[40:43], v[64:67], v[136:143], v4
    s_waitcnt lgkmcnt(4)
    v_smfmac_f32_16x16x64_bf16 v[36:39], v[64:67], v[68:75], v4
    ds_read_b128 v[68:71], v6 offset:16384
    ds_read_b128 v[72:75], v6 offset:17408
    ds_read_b128 v[64:67], v5 offset:1024
    v_smfmac_f32_16x16x64_bf16 v[24:27], v[48:51], a[56:63], v4
    v_smfmac_f32_16x16x64_bf16 v[28:31], v[48:51], a[136:143], v4
    v_smfmac_f32_16x16x64_bf16 v[40:43], v[48:51], v[152:159], v4
    s_waitcnt lgkmcnt(4)
    v_smfmac_f32_16x16x64_bf16 v[36:39], v[48:51], v[76:83], v4
    ds_read_b128 v[76:79], v6 offset:18432
    ds_read_b128 v[80:83], v6 offset:19456
    ds_read_b128 v[48:51], v5 offset:3072
    v_smfmac_f32_16x16x64_bf16 v[24:27], v[52:55], a[64:71], v4
    v_smfmac_f32_16x16x64_bf16 v[28:31], v[52:55], a[144:151], v4
    v_smfmac_f32_16x16x64_bf16 v[40:43], v[52:55], v[160:167], v4
    s_waitcnt lgkmcnt(4)
    v_smfmac_f32_16x16x64_bf16 v[36:39], v[52:55], v[68:75], v4
    ds_read_b128 v[52:55], v5 offset:4096
    v_smfmac_f32_16x16x64_bf16 v[24:27], v[56:59], a[72:79], v4
    v_smfmac_f32_16x16x64_bf16 v[28:31], v[56:59], a[152:159], v4
    v_smfmac_f32_16x16x64_bf16 v[40:43], v[56:59], v[168:175], v4
    s_waitcnt lgkmcnt(2)
    v_smfmac_f32_16x16x64_bf16 v[36:39], v[56:59], v[76:83], v4
    ds_read_b128 v[56:59], v5 offset:5120
    buffer_load_dwordx4 v[80:83], v19, s[8:11], s45 offen offset:0 sc1
    buffer_load_dwordx4 v[84:87], v19, s[8:11], s45 offen offset:1024 sc1
    buffer_load_dwordx4 v[88:91], v19, s[8:11], s45 offen offset:2048 sc1
    v_smfmac_f32_16x16x64_bf16 v[32:35], v[60:63], a[160:167], v4
    v_smfmac_f32_16x16x64_bf16 v[44:47], v[60:63], v[176:183], v4
    v_permlane32_swap_b32 v28, v40
    v_permlane32_swap_b32 v29, v41
    ds_read_b128 v[60:63], v5 offset:7168
    v_smfmac_f32_16x16x64_bf16 v[32:35], v[64:67], a[168:175], v4
    v_permlane32_swap_b32 v30, v42
    v_permlane32_swap_b32 v31, v43
    v_smfmac_f32_16x16x64_bf16 v[44:47], v[64:67], v[184:191], v4
    v_add_f32 v28, v28, v40
    v_add_f32 v29, v29, v41
    ds_read_b128 v[64:67], v5 offset:8192
    s_waitcnt lgkmcnt(4)
    v_smfmac_f32_16x16x64_bf16 v[32:35], v[48:51], a[184:191], v4
    v_add_f32 v30, v30, v42
    v_add_f32 v31, v31, v43
    v_smfmac_f32_16x16x64_bf16 v[44:47], v[48:51], v[200:207], v4
    v_cvt_pk_bf16_f32 v40, v28, v29
    v_cvt_pk_bf16_f32 v41, v30, v31
    ds_read_b128 v[48:51], v5 offset:9216
    s_waitcnt lgkmcnt(4)
    v_smfmac_f32_16x16x64_bf16 v[32:35], v[52:55], a[192:199], v4
    v_mfma_f32_16x16x16_bf16 v[28:31], v[40:41], v[10:11], 0
    v_permlane32_swap_b32 v24, v36
    v_smfmac_f32_16x16x64_bf16 v[44:47], v[52:55], v[208:215], v4
    v_permlane32_swap_b32 v25, v37
    v_permlane32_swap_b32 v26, v38
    s_waitcnt lgkmcnt(3)
    v_smfmac_f32_16x16x64_bf16 v[32:35], v[56:59], a[200:207], v4
    v_permlane32_swap_b32 v27, v39
    v_add_f32 v24, v24, v36
    v_smfmac_f32_16x16x64_bf16 v[44:47], v[56:59], v[216:223], v4
    v_add_f32 v25, v25, v37
    v_add_f32 v26, v26, v38
    s_waitcnt lgkmcnt(2)
    v_smfmac_f32_16x16x64_bf16 v[32:35], v[60:63], a[216:223], v4
    v_add_f32 v27, v27, v39
    v_cvt_pk_bf16_f32 v36, v24, v25
    v_smfmac_f32_16x16x64_bf16 v[44:47], v[60:63], v[232:239], v4
    v_cvt_pk_bf16_f32 v37, v26, v27
    s_nop 1
    v_mfma_f32_16x16x16_bf16 v[24:27], v[36:37], v[10:11], 0
    s_waitcnt lgkmcnt(1)
    v_smfmac_f32_16x16x64_bf16 v[32:35], v[64:67], a[224:231], v4
    s_nop 5
    v_cvt_pk_bf16_f32 v24, v24, v25
    v_smfmac_f32_16x16x64_bf16 v[44:47], v[64:67], v[240:247], v4
    v_cvt_pk_bf16_f32 v25, v26, v27
    v_cvt_pk_bf16_f32 v26, v28, v29
    s_waitcnt lgkmcnt(0)
    v_smfmac_f32_16x16x64_bf16 v[32:35], v[48:51], a[232:239], v4
    v_cvt_pk_bf16_f32 v27, v30, v31
    s_waitcnt vmcnt(3)
    v_smfmac_f32_16x16x64_bf16 v[44:47], v[48:51], v[248:255], v4
    v_mfma_f32_16x16x32_bf16 v[28:31], a[240:243], v[24:27], 0
    v_mfma_f32_16x16x32_bf16 v[36:39], a[244:247], v[24:27], 0
    v_mfma_f32_16x16x32_bf16 v[40:43], v[24:27], v[24:27], 0
    s_nop 4
    v_permlane32_swap_b32 v32, v44
    v_permlane32_swap_b32 v33, v45
    v_permlane32_swap_b32 v34, v46
    v_permlane32_swap_b32 v35, v47
    v_add_f32 v32, v32, v44
    v_add_f32 v33, v33, v45
    v_add_f32 v34, v34, v46
    v_add_f32 v35, v35, v47
    v_cvt_pk_bf16_f32 v44, v32, v33
    v_cvt_pk_bf16_f32 v45, v34, v35
    s_nop 1
    v_mfma_f32_16x16x16_bf16 v[32:35], v[44:45], v[10:11], 0
    s_nop 7
    v_cvt_pk_bf16_f32 v32, v32, v33
    v_cvt_pk_bf16_f32 v33, v34, v35
    s_nop 1
    v_mfma_f32_16x16x16_bf16 v[28:31], a[248:249], v[32:33], v[28:31]
    v_mfma_f32_16x16x16_bf16 v[36:39], a[250:251], v[32:33], v[36:39]
    v_mfma_f32_16x16x16_bf16 v[40:43], v[32:33], v[32:33], v[40:43]
    s_nop 5
    ds_write_b128 v12, v[28:31]
    ds_write_b128 v12, v[36:39] offset:16
    ds_write_b128 v13, v[40:43]
    s_waitcnt lgkmcnt(0)
    s_barrier
    s_waitcnt vmcnt(0)
    v_mfma_f32_16x16x32_bf16 v[36:39], a[240:243], v[80:83], 0
    v_mfma_f32_16x16x32_bf16 v[44:47], a[244:247], v[80:83], 0
    v_mfma_f32_16x16x32_bf16 v[68:71], v[24:27], v[80:83], 0
    v_mfma_f32_16x16x32_bf16 v[40:43], a[240:243], v[84:87], 0
    v_mfma_f32_16x16x32_bf16 v[64:67], a[244:247], v[84:87], 0
    v_mfma_f32_16x16x32_bf16 v[72:75], v[24:27], v[84:87], 0
    s_nop 0
    v_mfma_f32_16x16x16_bf16 v[36:39], a[248:249], v[88:89], v[36:39]
    v_mfma_f32_16x16x16_bf16 v[44:47], a[250:251], v[88:89], v[44:47]
    v_mfma_f32_16x16x16_bf16 v[68:71], v[32:33], v[88:89], v[68:71]
    v_mfma_f32_16x16x16_bf16 v[40:43], a[248:249], v[90:91], v[40:43]
    v_mfma_f32_16x16x16_bf16 v[64:67], a[250:251], v[90:91], v[64:67]
    v_mfma_f32_16x16x16_bf16 v[72:75], v[32:33], v[90:91], v[72:75]
    s_nop 2
    ds_write_b128 v16, v[36:39] offset:0
    ds_write_b128 v16, v[44:47] offset:16
    ds_write_b128 v17, v[68:71]
    ds_write_b128 v16, v[40:43] offset:2816
    ds_write_b128 v16, v[64:67] offset:2832
    ds_write_b128 v18, v[72:75]
    s_add_u32 s40, s40, 1
    s_add_u32 s41, s41, 393216
    s_add_u32 s45, s45, 393216
    s_add_u32 s47, s37, 704512
    s_add_u32 s48, s37, 737280
    s_xor_b32 s42, s37, 0x2000
    s_lshl_b32 s24, s40, 12
    s_and_b32 s24, s24, 0x2000
    s_xor_b32 s24, s24, s36
    s_lshl_b32 s37, s40, 20
    s_add_u32 s37, s37, s24
    s_add_u32 s37, s37, 117440512
    s_add_u32 s43, s37, 655360
    s_add_u32 s49, s37, 753664
    s_waitcnt lgkmcnt(0)
    s_barrier
    s_cmp_lt_u32 s40, 64
    s_cbranch_scc1 interleave_layers__linear_attn_block__memory_aug_recurrent_mem_tr__prompt_kernel_s_stepw2
    s_branch interleave_layers__linear_attn_block__memory_aug_recurrent_mem_tr__prompt_kernel_s_end
interleave_layers__linear_attn_block__memory_aug_recurrent_mem_tr__prompt_kernel_s_stepw3:
    v_mov_b32 v24, 0
    v_mov_b32 v25, 0
    v_mov_b32 v26, 0
    v_mov_b32 v27, 0
    v_mov_b32 v28, 0
    v_mov_b32 v29, 0
    v_mov_b32 v30, 0
    v_mov_b32 v31, 0
    v_mov_b32 v32, 0
    v_mov_b32 v33, 0
    v_mov_b32 v34, 0
    v_mov_b32 v35, 0
    v_mov_b32 v36, 0
    v_mov_b32 v37, 0
    v_mov_b32 v38, 0
    v_mov_b32 v39, 0
    v_mov_b32 v40, 0
    v_mov_b32 v41, 0
    v_mov_b32 v42, 0
    v_mov_b32 v43, 0
    v_mov_b32 v44, 0
    v_mov_b32 v45, 0
    v_mov_b32 v46, 0
    v_mov_b32 v47, 0
    s_add_u32 s46, s47, 4096
    s_add_u32 s52, s47, 8192
    s_lshl_b32 s95, s92, 6
    s_add_u32 s95, s95, s40
    s_add_u32 s95, s95, 1
    s_cmp_ge_i32 s59, s95
    s_cbranch_scc1 interleave_layers__linear_attn_block__memory_aug_recurrent_mem_tr__prompt_kernel_s_ecw3_ok
    s_and_b32 s24, s2, 7
    s_lshl_b32 s24, s24, 7
    s_add_u32 s24, s24, 23109632
    v_and_b32 v49, 3, v1
    v_lshl_add_u32 v49, v49, 2, s24
    s_mov_b32 s61, 0
interleave_layers__linear_attn_block__memory_aug_recurrent_mem_tr__prompt_kernel_s_ecw3:
    buffer_load_dword v48, v49, s[8:11], 0 offen sc1
    s_waitcnt vmcnt(0)
    v_readlane_b32 s59, v48, 0
    v_readlane_b32 s24, v48, 1
    s_min_i32 s59, s59, s24
    v_readlane_b32 s24, v48, 2
    s_min_i32 s59, s59, s24
    s_cmp_ge_i32 s59, s95
    s_cbranch_scc1 interleave_layers__linear_attn_block__memory_aug_recurrent_mem_tr__prompt_kernel_s_ecw3_ok
    s_add_u32 s61, s61, 1
    s_cmp_ge_u32 s61, s60
    s_cbranch_scc1 interleave_layers__linear_attn_block__memory_aug_recurrent_mem_tr__prompt_kernel_s_ecw3_to
    s_sleep 2
    s_branch interleave_layers__linear_attn_block__memory_aug_recurrent_mem_tr__prompt_kernel_s_ecw3
interleave_layers__linear_attn_block__memory_aug_recurrent_mem_tr__prompt_kernel_s_ecw3_to:
    s_mov_b32 s60, 1
interleave_layers__linear_attn_block__memory_aug_recurrent_mem_tr__prompt_kernel_s_ecw3_ok:
    s_add_u32 s63, s40, 1
    s_cmp_ge_i32 s62, s63
    s_cbranch_scc1 interleave_layers__linear_attn_block__memory_aug_recurrent_mem_tr__prompt_kernel_s_enw3_ok
    s_mov_b32 s61, 0
interleave_layers__linear_attn_block__memory_aug_recurrent_mem_tr__prompt_kernel_s_enw3:
    buffer_load_dword v48, v9, s[8:11], 0 offen sc1
    s_waitcnt vmcnt(0)
    v_readlane_b32 s62, v48, 0
    v_readlane_b32 s24, v48, 1
    s_min_i32 s62, s62, s24
    s_cmp_ge_i32 s62, s63
    s_cbranch_scc1 interleave_layers__linear_attn_block__memory_aug_recurrent_mem_tr__prompt_kernel_s_enw3_ok
    s_add_u32 s61, s61, 1
    s_cmp_ge_u32 s61, s60
    s_cbranch_scc1 interleave_layers__linear_attn_block__memory_aug_recurrent_mem_tr__prompt_kernel_s_enw3_to
    s_sleep 2
    s_branch interleave_layers__linear_attn_block__memory_aug_recurrent_mem_tr__prompt_kernel_s_enw3
interleave_layers__linear_attn_block__memory_aug_recurrent_mem_tr__prompt_kernel_s_enw3_to:
    s_mov_b32 s60, 1
interleave_layers__linear_attn_block__memory_aug_recurrent_mem_tr__prompt_kernel_s_enw3_ok:
    buffer_load_dwordx4 a[240:243], v19, s[8:11], s41 offen offset:0 sc1
    buffer_load_dwordx4 a[244:247], v19, s[8:11], s41 offen offset:1024 sc1
    buffer_load_dwordx4 a[248:251], v19, s[8:11], s41 offen offset:2048 sc1
    s_sleep 5
    s_mov_b64 exec, 1
    s_mov_b32 s61, 0
    v_mov_b32 v83, 0
    buffer_atomic_add v83, v23, s[8:11], s48 offen sc0
    s_sleep 3
    v_mov_b32 v94, 0
    buffer_atomic_add v94, v23, s[8:11], s48 offen sc0
    s_sleep 3
    v_mov_b32 v95, 0
    buffer_atomic_add v95, v23, s[8:11], s48 offen sc0
    s_sleep 3
interleave_layers__linear_attn_block__memory_aug_recurrent_mem_tr__prompt_kernel_s_prw3:
    v_mov_b32 v82, 0
    buffer_atomic_add v82, v23, s[8:11], s48 offen sc0
    s_waitcnt vmcnt(3)
    v_cmp_le_i32 vcc, 8, v83
    s_add_u32 s61, s61, 1
    s_cbranch_vccnz interleave_layers__linear_attn_block__memory_aug_recurrent_mem_tr__prompt_kernel_s_prw3_out
    s_sleep 3
    v_mov_b32 v83, 0
    buffer_atomic_add v83, v23, s[8:11], s48 offen sc0
    s_waitcnt vmcnt(3)
    v_cmp_le_i32 vcc, 8, v94
    s_add_u32 s61, s61, 1
    s_cbranch_vccnz interleave_layers__linear_attn_block__memory_aug_recurrent_mem_tr__prompt_kernel_s_prw3_out
    s_sleep 3
    v_mov_b32 v94, 0
    buffer_atomic_add v94, v23, s[8:11], s48 offen sc0
    s_waitcnt vmcnt(3)
    v_cmp_le_i32 vcc, 8, v95
    s_add_u32 s61, s61, 1
    s_cbranch_vccnz interleave_layers__linear_attn_block__memory_aug_recurrent_mem_tr__prompt_kernel_s_prw3_out
    s_sleep 3
    v_mov_b32 v95, 0
    buffer_atomic_add v95, v23, s[8:11], s48 offen sc0
    s_waitcnt vmcnt(3)
    v_cmp_le_i32 vcc, 8, v82
    s_add_u32 s61, s61, 1
    s_cbranch_vccnz interleave_layers__linear_attn_block__memory_aug_recurrent_mem_tr__prompt_kernel_s_prw3_out
    s_sleep 3
    s_cmp_ge_u32 s61, s60
    s_cbranch_scc0 interleave_layers__linear_attn_block__memory_aug_recurrent_mem_tr__prompt_kernel_s_prw3
    s_mov_b32 s60, 1
interleave_layers__linear_attn_block__memory_aug_recurrent_mem_tr__prompt_kernel_s_prw3_out:
    s_mov_b64 exec, -1
    buffer_load_dwordx4 v[84:87], v7, s[8:11], s47 offen sc1
    buffer_load_dwordx4 v[88:91], v7, s[8:11], s46 offen sc1
    buffer_load_dwordx2 v[92:93], v8, s[8:11], s52 offen sc1
    ds_read_b128 v[48:51], v21 offset:0
    ds_read_b128 v[52:55], v21 offset:16
    ds_read_b128 v[56:59], v21 offset:5632
    ds_read_b128 v[60:63], v21 offset:5648
    ds_read_b128 v[64:67], v21 offset:11264
    ds_read_b128 v[68:71], v21 offset:11280
    ds_read_b128 v[72:75], v21 offset:16896
    ds_read_b128 v[76:79], v21 offset:16912
    s_waitcnt lgkmcnt(4)
    v_pk_add_f32 v[48:49], v[48:49], v[56:57]
    v_pk_add_f32 v[50:51], v[50:51], v[58:59]
    v_pk_add_f32 v[52:53], v[52:53], v[60:61]
    v_pk_add_f32 v[54:55], v[54:55], v[62:63]
    s_waitcnt lgkmcnt(0)
    v_pk_add_f32 v[64:65], v[64:65], v[72:73]
    v_pk_add_f32 v[66:67], v[66:67], v[74:75]
    v_pk_add_f32 v[68:69], v[68:69], v[76:77]
    v_pk_add_f32 v[70:71], v[70:71], v[78:79]
    v_pk_add_f32 v[48:49], v[48:49], v[64:65]
    v_pk_add_f32 v[50:51], v[50:51], v[66:67]
    v_pk_add_f32 v[52:53], v[52:53], v[68:69]
    v_pk_add_f32 v[54:55], v[54:55], v[70:71]
    v_mov_b32 v81, 0xff800000
    v_cndmask_b32 v48, v81, v48, s[64:65]
    v_cndmask_b32 v49, v81, v49, s[66:67]
    v_cndmask_b32 v50, v81, v50, s[68:69]
    v_cndmask_b32 v51, v81, v51, s[70:71]
    v_cndmask_b32 v52, v81, v52, s[72:73]
    v_cndmask_b32 v53, v81, v53, s[74:75]
    v_cndmask_b32 v54, v81, v54, s[76:77]
    v_cndmask_b32 v55, v81, v55, s[78:79]
    v_max3_f32 v80, v48, v49, v50
    v_max3_f32 v80, v80, v51, v52
    v_max3_f32 v80, v80, v53, v54
    v_max_f32 v80, v80, v55
    v_mov_b32 v81, 0xff800000
    v_cndmask_b32 v80, v81, v80, s[50:51]
    s_nop 1
    v_max_f32 v80, v80, v80 quad_perm:[1,0,3,2] row_mask:0xf bank_mask:0xf
    s_nop 1
    v_max_f32 v80, v80, v80 quad_perm:[2,3,0,1] row_mask:0xf bank_mask:0xf
    s_nop 1
    v_max_f32 v80, v80, v80 row_half_mirror row_mask:0xf bank_mask:0xf
    s_mov_b32 s24, 0x3dd53b95
    v_mul_f32 v80, s24, v80
    v_fma_f32 v48, v48, s24, -v80
    v_fma_f32 v49, v49, s24, -v80
    v_fma_f32 v50, v50, s24, -v80
    v_fma_f32 v51, v51, s24, -v80
    v_fma_f32 v52, v52, s24, -v80
    v_fma_f32 v53, v53, s24, -v80
    v_fma_f32 v54, v54, s24, -v80
    v_fma_f32 v55, v55, s24, -v80
    v_exp_f32 v48, v48
    v_exp_f32 v49, v49
    v_exp_f32 v50, v50
    v_exp_f32 v51, v51
    v_exp_f32 v52, v52
    v_exp_f32 v53, v53
    v_exp_f32 v54, v54
    v_exp_f32 v55, v55
    v_add_f32 v80, v48, v49
    v_add_f32 v81, v50, v51
    v_add_f32 v80, v80, v52
    v_add_f32 v81, v81, v53
    v_add_f32 v80, v80, v54
    v_add_f32 v81, v81, v55
    v_add_f32 v80, v80, v81
    v_cndmask_b32 v80, 0, v80, s[50:51]
    s_nop 1
    v_add_f32 v80, v80, v80 quad_perm:[1,0,3,2] row_mask:0xf bank_mask:0xf
    s_nop 1
    v_add_f32 v80, v80, v80 quad_perm:[2,3,0,1] row_mask:0xf bank_mask:0xf
    s_nop 1
    v_add_f32 v80, v80, v80 row_half_mirror row_mask:0xf bank_mask:0xf
    v_rcp_f32 v80, v80
    s_nop 0
    v_mul_f32 v48, v48, v80
    v_mul_f32 v49, v49, v80
    v_mul_f32 v50, v50, v80
    v_mul_f32 v51, v51, v80
    v_mul_f32 v52, v52, v80
    v_mul_f32 v53, v53, v80
    v_mul_f32 v54, v54, v80
    v_mul_f32 v55, v55, v80
    v_cvt_pk_bf16_f32 v56, v48, v49
    v_cvt_pk_bf16_f32 v57, v50, v51
    v_cvt_pk_bf16_f32 v58, v52, v53
    v_cvt_pk_bf16_f32 v59, v54, v55
    v_min_u32 v56, -2, v56
    v_min_u32 v57, -2, v57
    v_min_u32 v58, -2, v58
    v_min_u32 v59, -2, v59
    buffer_store_dwordx4 v[56:59], v22, s[8:11], s42 offen sc1
    s_waitcnt vmcnt(1)
    s_nop 0
    v_max3_u32 v58, v84, v85, v86
    v_max3_u32 v58, v58, v87, v88
    v_max3_u32 v58, v58, v89, v90
    v_max3_u32 v58, v58, v91, v92
    v_max_u32 v58, v58, v93
    v_cmp_eq_u32 vcc, -1, v58
    s_cbranch_vccz interleave_layers__linear_attn_block__memory_aug_recurrent_mem_tr__prompt_kernel_s_pmw3_out
    s_mov_b32 s61, 0
interleave_layers__linear_attn_block__memory_aug_recurrent_mem_tr__prompt_kernel_s_pmw3:
    buffer_load_dwordx4 v[84:87], v7, s[8:11], s47 offen sc1
    buffer_load_dwordx4 v[88:91], v7, s[8:11], s46 offen sc1
    buffer_load_dwordx2 v[92:93], v8, s[8:11], s52 offen sc1
    s_waitcnt vmcnt(0)
    v_max3_u32 v58, v84, v85, v86
    v_max3_u32 v58, v58, v87, v88
    v_max3_u32 v58, v58, v89, v90
    v_max3_u32 v58, v58, v91, v92
    v_max_u32 v58, v58, v93
    v_cmp_eq_u32 vcc, -1, v58
    s_add_u32 s61, s61, 1
    s_cbranch_vccz interleave_layers__linear_attn_block__memory_aug_recurrent_mem_tr__prompt_kernel_s_pmw3_out
    s_cmp_ge_u32 s61, s60
    s_cbranch_scc1 interleave_layers__linear_attn_block__memory_aug_recurrent_mem_tr__prompt_kernel_s_pmw3_to
    s_sleep 1
    s_branch interleave_layers__linear_attn_block__memory_aug_recurrent_mem_tr__prompt_kernel_s_pmw3
interleave_layers__linear_attn_block__memory_aug_recurrent_mem_tr__prompt_kernel_s_pmw3_to:
    s_mov_b32 s60, 1
interleave_layers__linear_attn_block__memory_aug_recurrent_mem_tr__prompt_kernel_s_pmw3_out:
    ds_write_b128 v7, v[84:87]
    ds_write_b128 v7, v[88:91] offset:4096
    ds_write_b64 v8, v[92:93]
interleave_layers__linear_attn_block__memory_aug_recurrent_mem_tr__prompt_kernel_s_gow3:
    ds_read_b128 v[68:71], v6 offset:6144
    ds_read_b128 v[72:75], v6 offset:7168
    ds_read_b128 v[76:79], v6 offset:14336
    ds_read_b128 v[80:83], v6 offset:15360
    v_smfmac_f32_16x16x64_bf16 v[24:27], v[84:87], a[24:31], v4
    v_smfmac_f32_16x16x64_bf16 v[28:31], v[84:87], a[104:111], v4
    v_smfmac_f32_16x16x64_bf16 v[32:35], v[84:87], a[184:191], v4
    v_smfmac_f32_16x16x64_bf16 v[40:43], v[84:87], v[120:127], v4
    v_smfmac_f32_16x16x64_bf16 v[44:47], v[84:87], v[200:207], v4
    s_waitcnt lgkmcnt(2)
    v_smfmac_f32_16x16x64_bf16 v[36:39], v[84:87], v[68:75], v4
    ds_read_b128 v[68:71], v6 offset:0
    ds_read_b128 v[72:75], v6 offset:1024
    s_barrier
    ds_read_b128 v[48:51], v5 offset:0
    ds_read_b128 v[52:55], v5 offset:1024
    ds_read_b128 v[56:59], v5 offset:2048
    ds_read_b128 v[60:63], v5 offset:4096
    ds_read_b128 v[64:67], v5 offset:5120
    v_smfmac_f32_16x16x64_bf16 v[24:27], v[88:91], a[56:63], v4
    v_smfmac_f32_16x16x64_bf16 v[28:31], v[88:91], a[136:143], v4
    v_smfmac_f32_16x16x64_bf16 v[32:35], v[88:91], a[216:223], v4
    v_smfmac_f32_16x16x64_bf16 v[40:43], v[88:91], v[152:159], v4
    v_smfmac_f32_16x16x64_bf16 v[44:47], v[88:91], v[232:239], v4
    s_waitcnt lgkmcnt(7)
    v_smfmac_f32_16x16x64_bf16 v[36:39], v[88:91], v[76:83], v4
    ds_read_b128 v[76:79], v6 offset:2048
    ds_read_b128 v[80:83], v6 offset:3072
    s_waitcnt lgkmcnt(6)
    v_smfmac_f32_16x16x64_bf16 v[24:27], v[48:51], a[0:7], v4
    v_smfmac_f32_16x16x64_bf16 v[28:31], v[48:51], a[80:87], v4
    v_smfmac_f32_16x16x64_bf16 v[40:43], v[48:51], v[96:103], v4
    v_smfmac_f32_16x16x64_bf16 v[36:39], v[48:51], v[68:75], v4
    ds_read_b128 v[68:71], v6 offset:4096
    ds_read_b128 v[72:75], v6 offset:5120
    ds_read_b128 v[48:51], v5 offset:6144
    s_waitcnt lgkmcnt(8)
    v_smfmac_f32_16x16x64_bf16 v[24:27], v[52:55], a[8:15], v4
    v_smfmac_f32_16x16x64_bf16 v[28:31], v[52:55], a[88:95], v4
    v_smfmac_f32_16x16x64_bf16 v[40:43], v[52:55], v[104:111], v4
    s_waitcnt lgkmcnt(3)
    v_smfmac_f32_16x16x64_bf16 v[36:39], v[52:55], v[76:83], v4
    ds_read_b128 v[76:79], v6 offset:8192
    ds_read_b128 v[80:83], v6 offset:9216
    ds_read_b128 v[52:55], v5 offset:8192
    v_smfmac_f32_16x16x64_bf16 v[24:27], v[56:59], a[16:23], v4
    v_smfmac_f32_16x16x64_bf16 v[28:31], v[56:59], a[96:103], v4
    v_smfmac_f32_16x16x64_bf16 v[40:43], v[56:59], v[112:119], v4
    s_waitcnt lgkmcnt(4)
    v_smfmac_f32_16x16x64_bf16 v[36:39], v[56:59], v[68:75], v4
    ds_read_b128 v[68:71], v6 offset:10240
    ds_read_b128 v[72:75], v6 offset:11264
    ds_read_b128 v[56:59], v5 offset:9216
    v_smfmac_f32_16x16x64_bf16 v[24:27], v[60:63], a[32:39], v4
    v_smfmac_f32_16x16x64_bf16 v[28:31], v[60:63], a[112:119], v4
    v_smfmac_f32_16x16x64_bf16 v[40:43], v[60:63], v[128:135], v4
    s_waitcnt lgkmcnt(4)
    v_smfmac_f32_16x16x64_bf16 v[36:39], v[60:63], v[76:83], v4
    ds_read_b128 v[76:79], v6 offset:12288
    ds_read_b128 v[80:83], v6 offset:13312
    ds_read_b128 v[60:63], v5 offset:0
    v_smfmac_f32_16x16x64_bf16 v[24:27], v[64:67], a[40:47], v4
    v_smfmac_f32_16x16x64_bf16 v[28:31], v[64:67], a[120:127], v4
    v_smfmac_f32_16x16x64_bf16 v[40:43], v[64:67], v[136:143], v4
    s_waitcnt lgkmcnt(4)
    v_smfmac_f32_16x16x64_bf16 v[36:39], v[64:67], v[68:75], v4
    ds_read_b128 v[68:71], v6 offset:16384
    ds_read_b128 v[72:75], v6 offset:17408
    ds_read_b128 v[64:67], v5 offset:1024
    v_smfmac_f32_16x16x64_bf16 v[24:27], v[48:51], a[48:55], v4
    v_smfmac_f32_16x16x64_bf16 v[28:31], v[48:51], a[128:135], v4
    v_smfmac_f32_16x16x64_bf16 v[40:43], v[48:51], v[144:151], v4
    s_waitcnt lgkmcnt(4)
    v_smfmac_f32_16x16x64_bf16 v[36:39], v[48:51], v[76:83], v4
    ds_read_b128 v[76:79], v6 offset:18432
    ds_read_b128 v[80:83], v6 offset:19456
    ds_read_b128 v[48:51], v5 offset:2048
    v_smfmac_f32_16x16x64_bf16 v[24:27], v[52:55], a[64:71], v4
    v_smfmac_f32_16x16x64_bf16 v[28:31], v[52:55], a[144:151], v4
    v_smfmac_f32_16x16x64_bf16 v[40:43], v[52:55], v[160:167], v4
    s_waitcnt lgkmcnt(4)
    v_smfmac_f32_16x16x64_bf16 v[36:39], v[52:55], v[68:75], v4
    ds_read_b128 v[52:55], v5 offset:4096
    v_smfmac_f32_16x16x64_bf16 v[24:27], v[56:59], a[72:79], v4
    v_smfmac_f32_16x16x64_bf16 v[28:31], v[56:59], a[152:159], v4
    v_smfmac_f32_16x16x64_bf16 v[40:43], v[56:59], v[168:175], v4
    s_waitcnt lgkmcnt(2)
    v_smfmac_f32_16x16x64_bf16 v[36:39], v[56:59], v[76:83], v4
    ds_read_b128 v[56:59], v5 offset:5120
    buffer_load_dwordx4 v[80:83], v19, s[8:11], s45 offen offset:0 sc1
    buffer_load_dwordx4 v[84:87], v19, s[8:11], s45 offen offset:1024 sc1
    buffer_load_dwordx4 v[88:91], v19, s[8:11], s45 offen offset:2048 sc1
    v_smfmac_f32_16x16x64_bf16 v[32:35], v[60:63], a[160:167], v4
    v_smfmac_f32_16x16x64_bf16 v[44:47], v[60:63], v[176:183], v4
    v_permlane32_swap_b32 v28, v40
    v_permlane32_swap_b32 v29, v41
    ds_read_b128 v[60:63], v5 offset:6144
    v_smfmac_f32_16x16x64_bf16 v[32:35], v[64:67], a[168:175], v4
    v_permlane32_swap_b32 v30, v42
    v_permlane32_swap_b32 v31, v43
    v_smfmac_f32_16x16x64_bf16 v[44:47], v[64:67], v[184:191], v4
    v_add_f32 v28, v28, v40
    v_add_f32 v29, v29, v41
    ds_read_b128 v[64:67], v5 offset:8192
    s_waitcnt lgkmcnt(4)
    v_smfmac_f32_16x16x64_bf16 v[32:35], v[48:51], a[176:183], v4
    v_add_f32 v30, v30, v42
    v_add_f32 v31, v31, v43
    v_smfmac_f32_16x16x64_bf16 v[44:47], v[48:51], v[192:199], v4
    v_cvt_pk_bf16_f32 v40, v28, v29
    v_cvt_pk_bf16_f32 v41, v30, v31
    ds_read_b128 v[48:51], v5 offset:9216
    s_waitcnt lgkmcnt(4)
    v_smfmac_f32_16x16x64_bf16 v[32:35], v[52:55], a[192:199], v4
    v_mfma_f32_16x16x16_bf16 v[28:31], v[40:41], v[10:11], 0
    v_permlane32_swap_b32 v24, v36
    v_smfmac_f32_16x16x64_bf16 v[44:47], v[52:55], v[208:215], v4
    v_permlane32_swap_b32 v25, v37
    v_permlane32_swap_b32 v26, v38
    s_waitcnt lgkmcnt(3)
    v_smfmac_f32_16x16x64_bf16 v[32:35], v[56:59], a[200:207], v4
    v_permlane32_swap_b32 v27, v39
    v_add_f32 v24, v24, v36
    v_smfmac_f32_16x16x64_bf16 v[44:47], v[56:59], v[216:223], v4
    v_add_f32 v25, v25, v37
    v_add_f32 v26, v26, v38
    s_waitcnt lgkmcnt(2)
    v_smfmac_f32_16x16x64_bf16 v[32:35], v[60:63], a[208:215], v4
    v_add_f32 v27, v27, v39
    v_cvt_pk_bf16_f32 v36, v24, v25
    v_smfmac_f32_16x16x64_bf16 v[44:47], v[60:63], v[224:231], v4
    v_cvt_pk_bf16_f32 v37, v26, v27
    s_nop 1
    v_mfma_f32_16x16x16_bf16 v[24:27], v[36:37], v[10:11], 0
    s_waitcnt lgkmcnt(1)
    v_smfmac_f32_16x16x64_bf16 v[32:35], v[64:67], a[224:231], v4
    s_nop 5
    v_cvt_pk_bf16_f32 v24, v24, v25
    v_smfmac_f32_16x16x64_bf16 v[44:47], v[64:67], v[240:247], v4
    v_cvt_pk_bf16_f32 v25, v26, v27
    v_cvt_pk_bf16_f32 v26, v28, v29
    s_waitcnt lgkmcnt(0)
    v_smfmac_f32_16x16x64_bf16 v[32:35], v[48:51], a[232:239], v4
    v_cvt_pk_bf16_f32 v27, v30, v31
    s_waitcnt vmcnt(3)
    v_smfmac_f32_16x16x64_bf16 v[44:47], v[48:51], v[248:255], v4
    v_mfma_f32_16x16x32_bf16 v[28:31], a[240:243], v[24:27], 0
    v_mfma_f32_16x16x32_bf16 v[36:39], a[244:247], v[24:27], 0
    v_mfma_f32_16x16x32_bf16 v[40:43], v[24:27], v[24:27], 0
    s_nop 4
    v_permlane32_swap_b32 v32, v44
    v_permlane32_swap_b32 v33, v45
    v_permlane32_swap_b32 v34, v46
    v_permlane32_swap_b32 v35, v47
    v_add_f32 v32, v32, v44
    v_add_f32 v33, v33, v45
    v_add_f32 v34, v34, v46
    v_add_f32 v35, v35, v47
    v_cvt_pk_bf16_f32 v44, v32, v33
    v_cvt_pk_bf16_f32 v45, v34, v35
    s_nop 1
    v_mfma_f32_16x16x16_bf16 v[32:35], v[44:45], v[10:11], 0
    s_nop 7
    v_cvt_pk_bf16_f32 v32, v32, v33
    v_cvt_pk_bf16_f32 v33, v34, v35
    s_nop 1
    v_mfma_f32_16x16x16_bf16 v[28:31], a[248:249], v[32:33], v[28:31]
    v_mfma_f32_16x16x16_bf16 v[36:39], a[250:251], v[32:33], v[36:39]
    v_mfma_f32_16x16x16_bf16 v[40:43], v[32:33], v[32:33], v[40:43]
    s_nop 5
    ds_write_b128 v12, v[28:31]
    ds_write_b128 v12, v[36:39] offset:16
    ds_write_b128 v13, v[40:43]
    s_waitcnt lgkmcnt(0)
    s_barrier
    s_waitcnt vmcnt(0)
    v_mfma_f32_16x16x32_bf16 v[36:39], a[240:243], v[80:83], 0
    v_mfma_f32_16x16x32_bf16 v[44:47], a[244:247], v[80:83], 0
    v_mfma_f32_16x16x32_bf16 v[68:71], v[24:27], v[80:83], 0
    v_mfma_f32_16x16x32_bf16 v[40:43], a[240:243], v[84:87], 0
    v_mfma_f32_16x16x32_bf16 v[64:67], a[244:247], v[84:87], 0
    v_mfma_f32_16x16x32_bf16 v[72:75], v[24:27], v[84:87], 0
    s_nop 0
    v_mfma_f32_16x16x16_bf16 v[36:39], a[248:249], v[88:89], v[36:39]
    v_mfma_f32_16x16x16_bf16 v[44:47], a[250:251], v[88:89], v[44:47]
    v_mfma_f32_16x16x16_bf16 v[68:71], v[32:33], v[88:89], v[68:71]
    v_mfma_f32_16x16x16_bf16 v[40:43], a[248:249], v[90:91], v[40:43]
    v_mfma_f32_16x16x16_bf16 v[64:67], a[250:251], v[90:91], v[64:67]
    v_mfma_f32_16x16x16_bf16 v[72:75], v[32:33], v[90:91], v[72:75]
    s_nop 2
    ds_write_b128 v16, v[36:39] offset:0
    ds_write_b128 v16, v[44:47] offset:16
    ds_write_b128 v17, v[68:71]
    ds_write_b128 v16, v[40:43] offset:2816
    ds_write_b128 v16, v[64:67] offset:2832
    ds_write_b128 v18, v[72:75]
    s_add_u32 s40, s40, 1
    s_add_u32 s41, s41, 393216
    s_add_u32 s45, s45, 393216
    s_add_u32 s47, s37, 704512
    s_add_u32 s48, s37, 737280
    s_xor_b32 s42, s37, 0x2000
    s_lshl_b32 s24, s40, 12
    s_and_b32 s24, s24, 0x2000
    s_xor_b32 s24, s24, s36
    s_lshl_b32 s37, s40, 20
    s_add_u32 s37, s37, s24
    s_add_u32 s37, s37, 117440512
    s_add_u32 s43, s37, 655360
    s_add_u32 s49, s37, 753664
    s_waitcnt lgkmcnt(0)
    s_barrier
    s_cmp_lt_u32 s40, 64
    s_cbranch_scc1 interleave_layers__linear_attn_block__memory_aug_recurrent_mem_tr__prompt_kernel_s_stepw3
interleave_layers__linear_attn_block__memory_aug_recurrent_mem_tr__prompt_kernel_s_end:
    ds_read_b128 v[48:51], v21 offset:0
    ds_read_b128 v[52:55], v21 offset:16
    ds_read_b128 v[56:59], v21 offset:5632
    ds_read_b128 v[60:63], v21 offset:5648
    ds_read_b128 v[64:67], v21 offset:11264
    ds_read_b128 v[68:71], v21 offset:11280
    ds_read_b128 v[72:75], v21 offset:16896
    ds_read_b128 v[76:79], v21 offset:16912
    s_waitcnt lgkmcnt(4)
    v_pk_add_f32 v[48:49], v[48:49], v[56:57]
    v_pk_add_f32 v[50:51], v[50:51], v[58:59]
    v_pk_add_f32 v[52:53], v[52:53], v[60:61]
    v_pk_add_f32 v[54:55], v[54:55], v[62:63]
    s_waitcnt lgkmcnt(0)
    v_pk_add_f32 v[64:65], v[64:65], v[72:73]
    v_pk_add_f32 v[66:67], v[66:67], v[74:75]
    v_pk_add_f32 v[68:69], v[68:69], v[76:77]
    v_pk_add_f32 v[70:71], v[70:71], v[78:79]
    v_pk_add_f32 v[48:49], v[48:49], v[64:65]
    v_pk_add_f32 v[50:51], v[50:51], v[66:67]
    v_pk_add_f32 v[52:53], v[52:53], v[68:69]
    v_pk_add_f32 v[54:55], v[54:55], v[70:71]
    v_mov_b32 v81, 0xff800000
    v_cndmask_b32 v48, v81, v48, s[64:65]
    v_cndmask_b32 v49, v81, v49, s[66:67]
    v_cndmask_b32 v50, v81, v50, s[68:69]
    v_cndmask_b32 v51, v81, v51, s[70:71]
    v_cndmask_b32 v52, v81, v52, s[72:73]
    v_cndmask_b32 v53, v81, v53, s[74:75]
    v_cndmask_b32 v54, v81, v54, s[76:77]
    v_cndmask_b32 v55, v81, v55, s[78:79]
    v_max3_f32 v80, v48, v49, v50
    v_max3_f32 v80, v80, v51, v52
    v_max3_f32 v80, v80, v53, v54
    v_max_f32 v80, v80, v55
    v_mov_b32 v81, 0xff800000
    v_cndmask_b32 v80, v81, v80, s[50:51]
    s_nop 1
    v_max_f32 v80, v80, v80 quad_perm:[1,0,3,2] row_mask:0xf bank_mask:0xf
    s_nop 1
    v_max_f32 v80, v80, v80 quad_perm:[2,3,0,1] row_mask:0xf bank_mask:0xf
    s_nop 1
    v_max_f32 v80, v80, v80 row_half_mirror row_mask:0xf bank_mask:0xf
    s_mov_b32 s24, 0x3dd53b95
    v_mul_f32 v80, s24, v80
    v_fma_f32 v48, v48, s24, -v80
    v_fma_f32 v49, v49, s24, -v80
    v_fma_f32 v50, v50, s24, -v80
    v_fma_f32 v51, v51, s24, -v80
    v_fma_f32 v52, v52, s24, -v80
    v_fma_f32 v53, v53, s24, -v80
    v_fma_f32 v54, v54, s24, -v80
    v_fma_f32 v55, v55, s24, -v80
    v_exp_f32 v48, v48
    v_exp_f32 v49, v49
    v_exp_f32 v50, v50
    v_exp_f32 v51, v51
    v_exp_f32 v52, v52
    v_exp_f32 v53, v53
    v_exp_f32 v54, v54
    v_exp_f32 v55, v55
    v_add_f32 v80, v48, v49
    v_add_f32 v81, v50, v51
    v_add_f32 v80, v80, v52
    v_add_f32 v81, v81, v53
    v_add_f32 v80, v80, v54
    v_add_f32 v81, v81, v55
    v_add_f32 v80, v80, v81
    v_cndmask_b32 v80, 0, v80, s[50:51]
    s_nop 1
    v_add_f32 v80, v80, v80 quad_perm:[1,0,3,2] row_mask:0xf bank_mask:0xf
    s_nop 1
    v_add_f32 v80, v80, v80 quad_perm:[2,3,0,1] row_mask:0xf bank_mask:0xf
    s_nop 1
    v_add_f32 v80, v80, v80 row_half_mirror row_mask:0xf bank_mask:0xf
    v_rcp_f32 v80, v80
    s_nop 0
    v_mul_f32 v48, v48, v80
    v_mul_f32 v49, v49, v80
    v_mul_f32 v50, v50, v80
    v_mul_f32 v51, v51, v80
    v_mul_f32 v52, v52, v80
    v_mul_f32 v53, v53, v80
    v_mul_f32 v54, v54, v80
    v_mul_f32 v55, v55, v80
    v_cvt_pk_bf16_f32 v56, v48, v49
    v_cvt_pk_bf16_f32 v57, v50, v51
    v_cvt_pk_bf16_f32 v58, v52, v53
    v_cvt_pk_bf16_f32 v59, v54, v55
    v_min_u32 v56, -2, v56
    v_min_u32 v57, -2, v57
    v_min_u32 v58, -2, v58
    v_min_u32 v59, -2, v59
    buffer_store_dwordx4 v[56:59], v22, s[8:11], s42 offen sc1
    s_cmp_eq_u32 s92, 0
    s_cbranch_scc0 interleave_layers__linear_attn_block__memory_aug_recurrent_mem_tr__prompt_kernel_end
    s_mov_b32 s92, 1
    s_branch interleave_layers__linear_attn_block__memory_aug_recurrent_mem_tr__prompt_kernel_s_layer
interleave_layers__linear_attn_block__memory_aug_recurrent_mem_tr__prompt_kernel_roleV:
    s_sub_u32 s44, s2, 32
    s_load_dwordx2 s[6:7], s[0:1], 56
    s_load_dwordx2 s[24:25], s[0:1], 64
    s_load_dwordx2 s[26:27], s[0:1], 32
    s_waitcnt lgkmcnt(0)
    s_mov_b32 s12, s6
    s_mov_b32 s13, s7
    s_mov_b32 s14, 7864320
    s_mov_b32 s15, 0x00020000
    s_mov_b32 s16, s24
    s_mov_b32 s17, s25
    s_mov_b32 s18, 7864320
    s_mov_b32 s19, 0x00020000
    s_mov_b32 s20, s26
    s_mov_b32 s21, s27
    s_mov_b32 s22, 10240
    s_mov_b32 s23, 0x00020000
    v_add_u32 v16, 0, v0
    s_mov_b32 s24, 683
    v_mul_lo_u32 v17, v16, s24
    v_lshrrev_b32 v17, 14, v17
    v_mul_u32_u24 v18, 24, v17
    v_sub_u32 v18, v16, v18
    s_mov_b32 s24, 12288
    v_mul_lo_u32 v4, v17, s24
    v_lshl_add_u32 v4, v18, 4, v4
    v_mul_u32_u24 v10, 400, v17
    v_lshl_add_u32 v10, v18, 4, v10
    v_add_u32 v10, 90112, v10
    v_add_u32 v16, 256, v0
    s_mov_b32 s24, 683
    v_mul_lo_u32 v17, v16, s24
    v_lshrrev_b32 v17, 14, v17
    v_mul_u32_u24 v18, 24, v17
    v_sub_u32 v18, v16, v18
    s_mov_b32 s24, 12288
    v_mul_lo_u32 v5, v17, s24
    v_lshl_add_u32 v5, v18, 4, v5
    v_mul_u32_u24 v11, 400, v17
    v_lshl_add_u32 v11, v18, 4, v11
    v_add_u32 v11, 90112, v11
    v_add_u32 v16, 512, v0
    s_mov_b32 s24, 683
    v_mul_lo_u32 v17, v16, s24
    v_lshrrev_b32 v17, 14, v17
    v_mul_u32_u24 v18, 24, v17
    v_sub_u32 v18, v16, v18
    s_mov_b32 s24, 12288
    v_mul_lo_u32 v6, v17, s24
    v_lshl_add_u32 v6, v18, 4, v6
    v_mul_u32_u24 v12, 400, v17
    v_lshl_add_u32 v12, v18, 4, v12
    v_add_u32 v12, 90112, v12
    v_add_u32 v16, 768, v0
    s_mov_b32 s24, 683
    v_mul_lo_u32 v17, v16, s24
    v_lshrrev_b32 v17, 14, v17
    v_mul_u32_u24 v18, 24, v17
    v_sub_u32 v18, v16, v18
    s_mov_b32 s24, 12288
    v_mul_lo_u32 v7, v17, s24
    v_lshl_add_u32 v7, v18, 4, v7
    v_mul_u32_u24 v13, 400, v17
    v_lshl_add_u32 v13, v18, 4, v13
    v_add_u32 v13, 90112, v13
    v_add_u32 v16, 1024, v0
    s_mov_b32 s24, 683
    v_mul_lo_u32 v17, v16, s24
    v_lshrrev_b32 v17, 14, v17
    v_mul_u32_u24 v18, 24, v17
    v_sub_u32 v18, v16, v18
    s_mov_b32 s24, 12288
    v_mul_lo_u32 v8, v17, s24
    v_lshl_add_u32 v8, v18, 4, v8
    v_mul_u32_u24 v14, 400, v17
    v_lshl_add_u32 v14, v18, 4, v14
    v_add_u32 v14, 90112, v14
    v_add_u32 v16, 1280, v0
    s_mov_b32 s24, 683
    v_mul_lo_u32 v17, v16, s24
    v_lshrrev_b32 v17, 14, v17
    v_mul_u32_u24 v18, 24, v17
    v_sub_u32 v18, v16, v18
    s_mov_b32 s24, 12288
    v_mul_lo_u32 v9, v17, s24
    v_lshl_add_u32 v9, v18, 4, v9
    v_mul_u32_u24 v15, 400, v17
    v_lshl_add_u32 v15, v18, 4, v15
    v_add_u32 v15, 90112, v15
    v_lshrrev_b32 v17, 1, v3
    v_lshlrev_b32 v17, 4, v17
    v_and_b32 v18, 1, v3
    v_lshl_add_u32 v17, v18, 2, v17
    v_lshrrev_b32 v18, 2, v2
    v_and_b32 v19, 1, v18
    v_add_u32 v17, v17, v19
    v_lshrrev_b32 v18, 1, v18
    v_lshl_add_u32 v17, v18, 3, v17
    v_mul_u32_u24 v16, 400, v17
    v_and_b32 v18, 3, v2
    v_lshl_add_u32 v16, v18, 3, v16
    v_add_u32 v16, 90112, v16
    s_mul_i32 s24, s3, 96
    v_add_u32 v16, s24, v16
    s_mul_i32 s45, s44, 384
    s_add_u32 s46, s45, 0
    buffer_load_dwordx4 v[24:27], v4, s[12:15], s46 offen
    buffer_load_dwordx4 v[28:31], v5, s[12:15], s46 offen
    buffer_load_dwordx4 v[32:35], v6, s[12:15], s46 offen
    buffer_load_dwordx4 v[36:39], v7, s[12:15], s46 offen
    buffer_load_dwordx4 v[40:43], v8, s[12:15], s46 offen
    buffer_load_dwordx4 v[44:47], v9, s[12:15], s46 offen
    s_add_u32 s46, s45, 786432
    buffer_load_dwordx4 v[48:51], v4, s[12:15], s46 offen
    buffer_load_dwordx4 v[52:55], v5, s[12:15], s46 offen
    buffer_load_dwordx4 v[56:59], v6, s[12:15], s46 offen
    buffer_load_dwordx4 v[60:63], v7, s[12:15], s46 offen
    buffer_load_dwordx4 v[64:67], v8, s[12:15], s46 offen
    buffer_load_dwordx4 v[68:71], v9, s[12:15], s46 offen
    s_waitcnt vmcnt(6)
    ds_write_b128 v10, v[24:27]
    ds_write_b128 v11, v[28:31]
    ds_write_b128 v12, v[32:35]
    ds_write_b128 v13, v[36:39]
    ds_write_b128 v14, v[40:43]
    ds_write_b128 v15, v[44:47]
    s_add_u32 s46, s45, 1572864
    buffer_load_dwordx4 v[72:75], v4, s[12:15], s46 offen
    buffer_load_dwordx4 v[76:79], v5, s[12:15], s46 offen
    buffer_load_dwordx4 v[80:83], v6, s[12:15], s46 offen
    buffer_load_dwordx4 v[84:87], v7, s[12:15], s46 offen
    buffer_load_dwordx4 v[88:91], v8, s[12:15], s46 offen
    buffer_load_dwordx4 v[92:95], v9, s[12:15], s46 offen
    s_waitcnt lgkmcnt(0)
    s_barrier
    ds_read_b64_tr_b16 a[0:1], v16 offset:0
    ds_read_b64_tr_b16 a[2:3], v16 offset:800
    ds_read_b64_tr_b16 a[4:5], v16 offset:12800
    ds_read_b64_tr_b16 a[6:7], v16 offset:13600
    ds_read_b64_tr_b16 a[80:81], v16 offset:32
    ds_read_b64_tr_b16 a[82:83], v16 offset:832
    ds_read_b64_tr_b16 a[84:85], v16 offset:12832
    ds_read_b64_tr_b16 a[86:87], v16 offset:13632
    ds_read_b64_tr_b16 a[160:161], v16 offset:64
    ds_read_b64_tr_b16 a[162:163], v16 offset:864
    ds_read_b64_tr_b16 a[164:165], v16 offset:12864
    ds_read_b64_tr_b16 a[166:167], v16 offset:13664
    s_waitcnt lgkmcnt(0)
    s_barrier
    s_waitcnt vmcnt(6)
    ds_write_b128 v10, v[48:51]
    ds_write_b128 v11, v[52:55]
    ds_write_b128 v12, v[56:59]
    ds_write_b128 v13, v[60:63]
    ds_write_b128 v14, v[64:67]
    ds_write_b128 v15, v[68:71]
    s_add_u32 s46, s45, 2359296
    buffer_load_dwordx4 v[24:27], v4, s[12:15], s46 offen
    buffer_load_dwordx4 v[28:31], v5, s[12:15], s46 offen
    buffer_load_dwordx4 v[32:35], v6, s[12:15], s46 offen
    buffer_load_dwordx4 v[36:39], v7, s[12:15], s46 offen
    buffer_load_dwordx4 v[40:43], v8, s[12:15], s46 offen
    buffer_load_dwordx4 v[44:47], v9, s[12:15], s46 offen
    s_waitcnt lgkmcnt(0)
    s_barrier
    ds_read_b64_tr_b16 a[8:9], v16 offset:0
    ds_read_b64_tr_b16 a[10:11], v16 offset:800
    ds_read_b64_tr_b16 a[12:13], v16 offset:12800
    ds_read_b64_tr_b16 a[14:15], v16 offset:13600
    ds_read_b64_tr_b16 a[88:89], v16 offset:32
    ds_read_b64_tr_b16 a[90:91], v16 offset:832
    ds_read_b64_tr_b16 a[92:93], v16 offset:12832
    ds_read_b64_tr_b16 a[94:95], v16 offset:13632
    ds_read_b64_tr_b16 a[168:169], v16 offset:64
    ds_read_b64_tr_b16 a[170:171], v16 offset:864
    ds_read_b64_tr_b16 a[172:173], v16 offset:12864
    ds_read_b64_tr_b16 a[174:175], v16 offset:13664
    s_waitcnt lgkmcnt(0)
    s_barrier
    s_waitcnt vmcnt(6)
    ds_write_b128 v10, v[72:75]
    ds_write_b128 v11, v[76:79]
    ds_write_b128 v12, v[80:83]
    ds_write_b128 v13, v[84:87]
    ds_write_b128 v14, v[88:91]
    ds_write_b128 v15, v[92:95]
    s_add_u32 s46, s45, 3145728
    buffer_load_dwordx4 v[48:51], v4, s[12:15], s46 offen
    buffer_load_dwordx4 v[52:55], v5, s[12:15], s46 offen
    buffer_load_dwordx4 v[56:59], v6, s[12:15], s46 offen
    buffer_load_dwordx4 v[60:63], v7, s[12:15], s46 offen
    buffer_load_dwordx4 v[64:67], v8, s[12:15], s46 offen
    buffer_load_dwordx4 v[68:71], v9, s[12:15], s46 offen
    s_waitcnt lgkmcnt(0)
    s_barrier
    ds_read_b64_tr_b16 a[16:17], v16 offset:0
    ds_read_b64_tr_b16 a[18:19], v16 offset:800
    ds_read_b64_tr_b16 a[20:21], v16 offset:12800
    ds_read_b64_tr_b16 a[22:23], v16 offset:13600
    ds_read_b64_tr_b16 a[96:97], v16 offset:32
    ds_read_b64_tr_b16 a[98:99], v16 offset:832
    ds_read_b64_tr_b16 a[100:101], v16 offset:12832
    ds_read_b64_tr_b16 a[102:103], v16 offset:13632
    ds_read_b64_tr_b16 a[176:177], v16 offset:64
    ds_read_b64_tr_b16 a[178:179], v16 offset:864
    ds_read_b64_tr_b16 a[180:181], v16 offset:12864
    ds_read_b64_tr_b16 a[182:183], v16 offset:13664
    s_waitcnt lgkmcnt(0)
    s_barrier
    s_waitcnt vmcnt(6)
    ds_write_b128 v10, v[24:27]
    ds_write_b128 v11, v[28:31]
    ds_write_b128 v12, v[32:35]
    ds_write_b128 v13, v[36:39]
    ds_write_b128 v14, v[40:43]
    ds_write_b128 v15, v[44:47]
    s_add_u32 s46, s45, 3932160
    buffer_load_dwordx4 v[72:75], v4, s[12:15], s46 offen
    buffer_load_dwordx4 v[76:79], v5, s[12:15], s46 offen
    buffer_load_dwordx4 v[80:83], v6, s[12:15], s46 offen
    buffer_load_dwordx4 v[84:87], v7, s[12:15], s46 offen
    buffer_load_dwordx4 v[88:91], v8, s[12:15], s46 offen
    buffer_load_dwordx4 v[92:95], v9, s[12:15], s46 offen
    s_waitcnt lgkmcnt(0)
    s_barrier
    ds_read_b64_tr_b16 a[24:25], v16 offset:0
    ds_read_b64_tr_b16 a[26:27], v16 offset:800
    ds_read_b64_tr_b16 a[28:29], v16 offset:12800
    ds_read_b64_tr_b16 a[30:31], v16 offset:13600
    ds_read_b64_tr_b16 a[104:105], v16 offset:32
    ds_read_b64_tr_b16 a[106:107], v16 offset:832
    ds_read_b64_tr_b16 a[108:109], v16 offset:12832
    ds_read_b64_tr_b16 a[110:111], v16 offset:13632
    ds_read_b64_tr_b16 a[184:185], v16 offset:64
    ds_read_b64_tr_b16 a[186:187], v16 offset:864
    ds_read_b64_tr_b16 a[188:189], v16 offset:12864
    ds_read_b64_tr_b16 a[190:191], v16 offset:13664
    s_waitcnt lgkmcnt(0)
    s_barrier
    s_waitcnt vmcnt(6)
    ds_write_b128 v10, v[48:51]
    ds_write_b128 v11, v[52:55]
    ds_write_b128 v12, v[56:59]
    ds_write_b128 v13, v[60:63]
    ds_write_b128 v14, v[64:67]
    ds_write_b128 v15, v[68:71]
    s_add_u32 s46, s45, 4718592
    buffer_load_dwordx4 v[24:27], v4, s[12:15], s46 offen
    buffer_load_dwordx4 v[28:31], v5, s[12:15], s46 offen
    buffer_load_dwordx4 v[32:35], v6, s[12:15], s46 offen
    buffer_load_dwordx4 v[36:39], v7, s[12:15], s46 offen
    buffer_load_dwordx4 v[40:43], v8, s[12:15], s46 offen
    buffer_load_dwordx4 v[44:47], v9, s[12:15], s46 offen
    s_waitcnt lgkmcnt(0)
    s_barrier
    ds_read_b64_tr_b16 a[32:33], v16 offset:0
    ds_read_b64_tr_b16 a[34:35], v16 offset:800
    ds_read_b64_tr_b16 a[36:37], v16 offset:12800
    ds_read_b64_tr_b16 a[38:39], v16 offset:13600
    ds_read_b64_tr_b16 a[112:113], v16 offset:32
    ds_read_b64_tr_b16 a[114:115], v16 offset:832
    ds_read_b64_tr_b16 a[116:117], v16 offset:12832
    ds_read_b64_tr_b16 a[118:119], v16 offset:13632
    ds_read_b64_tr_b16 a[192:193], v16 offset:64
    ds_read_b64_tr_b16 a[194:195], v16 offset:864
    ds_read_b64_tr_b16 a[196:197], v16 offset:12864
    ds_read_b64_tr_b16 a[198:199], v16 offset:13664
    s_waitcnt lgkmcnt(0)
    s_barrier
    s_waitcnt vmcnt(6)
    ds_write_b128 v10, v[72:75]
    ds_write_b128 v11, v[76:79]
    ds_write_b128 v12, v[80:83]
    ds_write_b128 v13, v[84:87]
    ds_write_b128 v14, v[88:91]
    ds_write_b128 v15, v[92:95]
    s_add_u32 s46, s45, 5505024
    buffer_load_dwordx4 v[48:51], v4, s[12:15], s46 offen
    buffer_load_dwordx4 v[52:55], v5, s[12:15], s46 offen
    buffer_load_dwordx4 v[56:59], v6, s[12:15], s46 offen
    buffer_load_dwordx4 v[60:63], v7, s[12:15], s46 offen
    buffer_load_dwordx4 v[64:67], v8, s[12:15], s46 offen
    buffer_load_dwordx4 v[68:71], v9, s[12:15], s46 offen
    s_waitcnt lgkmcnt(0)
    s_barrier
    ds_read_b64_tr_b16 a[40:41], v16 offset:0
    ds_read_b64_tr_b16 a[42:43], v16 offset:800
    ds_read_b64_tr_b16 a[44:45], v16 offset:12800
    ds_read_b64_tr_b16 a[46:47], v16 offset:13600
    ds_read_b64_tr_b16 a[120:121], v16 offset:32
    ds_read_b64_tr_b16 a[122:123], v16 offset:832
    ds_read_b64_tr_b16 a[124:125], v16 offset:12832
    ds_read_b64_tr_b16 a[126:127], v16 offset:13632
    ds_read_b64_tr_b16 a[200:201], v16 offset:64
    ds_read_b64_tr_b16 a[202:203], v16 offset:864
    ds_read_b64_tr_b16 a[204:205], v16 offset:12864
    ds_read_b64_tr_b16 a[206:207], v16 offset:13664
    s_waitcnt lgkmcnt(0)
    s_barrier
    s_waitcnt vmcnt(6)
    ds_write_b128 v10, v[24:27]
    ds_write_b128 v11, v[28:31]
    ds_write_b128 v12, v[32:35]
    ds_write_b128 v13, v[36:39]
    ds_write_b128 v14, v[40:43]
    ds_write_b128 v15, v[44:47]
    s_add_u32 s46, s45, 6291456
    buffer_load_dwordx4 v[72:75], v4, s[12:15], s46 offen
    buffer_load_dwordx4 v[76:79], v5, s[12:15], s46 offen
    buffer_load_dwordx4 v[80:83], v6, s[12:15], s46 offen
    buffer_load_dwordx4 v[84:87], v7, s[12:15], s46 offen
    buffer_load_dwordx4 v[88:91], v8, s[12:15], s46 offen
    buffer_load_dwordx4 v[92:95], v9, s[12:15], s46 offen
    s_waitcnt lgkmcnt(0)
    s_barrier
    ds_read_b64_tr_b16 a[48:49], v16 offset:0
    ds_read_b64_tr_b16 a[50:51], v16 offset:800
    ds_read_b64_tr_b16 a[52:53], v16 offset:12800
    ds_read_b64_tr_b16 a[54:55], v16 offset:13600
    ds_read_b64_tr_b16 a[128:129], v16 offset:32
    ds_read_b64_tr_b16 a[130:131], v16 offset:832
    ds_read_b64_tr_b16 a[132:133], v16 offset:12832
    ds_read_b64_tr_b16 a[134:135], v16 offset:13632
    ds_read_b64_tr_b16 a[208:209], v16 offset:64
    ds_read_b64_tr_b16 a[210:211], v16 offset:864
    ds_read_b64_tr_b16 a[212:213], v16 offset:12864
    ds_read_b64_tr_b16 a[214:215], v16 offset:13664
    s_waitcnt lgkmcnt(0)
    s_barrier
    s_waitcnt vmcnt(6)
    ds_write_b128 v10, v[48:51]
    ds_write_b128 v11, v[52:55]
    ds_write_b128 v12, v[56:59]
    ds_write_b128 v13, v[60:63]
    ds_write_b128 v14, v[64:67]
    ds_write_b128 v15, v[68:71]
    s_add_u32 s46, s45, 7077888
    buffer_load_dwordx4 v[24:27], v4, s[12:15], s46 offen
    buffer_load_dwordx4 v[28:31], v5, s[12:15], s46 offen
    buffer_load_dwordx4 v[32:35], v6, s[12:15], s46 offen
    buffer_load_dwordx4 v[36:39], v7, s[12:15], s46 offen
    buffer_load_dwordx4 v[40:43], v8, s[12:15], s46 offen
    buffer_load_dwordx4 v[44:47], v9, s[12:15], s46 offen
    s_waitcnt lgkmcnt(0)
    s_barrier
    ds_read_b64_tr_b16 a[56:57], v16 offset:0
    ds_read_b64_tr_b16 a[58:59], v16 offset:800
    ds_read_b64_tr_b16 a[60:61], v16 offset:12800
    ds_read_b64_tr_b16 a[62:63], v16 offset:13600
    ds_read_b64_tr_b16 a[136:137], v16 offset:32
    ds_read_b64_tr_b16 a[138:139], v16 offset:832
    ds_read_b64_tr_b16 a[140:141], v16 offset:12832
    ds_read_b64_tr_b16 a[142:143], v16 offset:13632
    ds_read_b64_tr_b16 a[216:217], v16 offset:64
    ds_read_b64_tr_b16 a[218:219], v16 offset:864
    ds_read_b64_tr_b16 a[220:221], v16 offset:12864
    ds_read_b64_tr_b16 a[222:223], v16 offset:13664
    s_waitcnt lgkmcnt(0)
    s_barrier
    s_waitcnt vmcnt(6)
    ds_write_b128 v10, v[72:75]
    ds_write_b128 v11, v[76:79]
    ds_write_b128 v12, v[80:83]
    ds_write_b128 v13, v[84:87]
    ds_write_b128 v14, v[88:91]
    ds_write_b128 v15, v[92:95]
    s_waitcnt lgkmcnt(0)
    s_barrier
    ds_read_b64_tr_b16 a[64:65], v16 offset:0
    ds_read_b64_tr_b16 a[66:67], v16 offset:800
    ds_read_b64_tr_b16 a[68:69], v16 offset:12800
    ds_read_b64_tr_b16 a[70:71], v16 offset:13600
    ds_read_b64_tr_b16 a[144:145], v16 offset:32
    ds_read_b64_tr_b16 a[146:147], v16 offset:832
    ds_read_b64_tr_b16 a[148:149], v16 offset:12832
    ds_read_b64_tr_b16 a[150:151], v16 offset:13632
    ds_read_b64_tr_b16 a[224:225], v16 offset:64
    ds_read_b64_tr_b16 a[226:227], v16 offset:864
    ds_read_b64_tr_b16 a[228:229], v16 offset:12864
    ds_read_b64_tr_b16 a[230:231], v16 offset:13664
    s_waitcnt lgkmcnt(0)
    s_barrier
    s_waitcnt vmcnt(0)
    ds_write_b128 v10, v[24:27]
    ds_write_b128 v11, v[28:31]
    ds_write_b128 v12, v[32:35]
    ds_write_b128 v13, v[36:39]
    ds_write_b128 v14, v[40:43]
    ds_write_b128 v15, v[44:47]
    s_waitcnt lgkmcnt(0)
    s_barrier
    ds_read_b64_tr_b16 a[72:73], v16 offset:0
    ds_read_b64_tr_b16 a[74:75], v16 offset:800
    ds_read_b64_tr_b16 a[76:77], v16 offset:12800
    ds_read_b64_tr_b16 a[78:79], v16 offset:13600
    ds_read_b64_tr_b16 a[152:153], v16 offset:32
    ds_read_b64_tr_b16 a[154:155], v16 offset:832
    ds_read_b64_tr_b16 a[156:157], v16 offset:12832
    ds_read_b64_tr_b16 a[158:159], v16 offset:13632
    ds_read_b64_tr_b16 a[232:233], v16 offset:64
    ds_read_b64_tr_b16 a[234:235], v16 offset:864
    ds_read_b64_tr_b16 a[236:237], v16 offset:12864
    ds_read_b64_tr_b16 a[238:239], v16 offset:13664
    s_waitcnt lgkmcnt(0)
    s_barrier
    v_add_u32 v64, 0, v0
    s_mov_b32 s24, 1639
    v_mul_lo_u32 v65, v64, s24
    v_lshrrev_b32 v65, 16, v65
    v_mul_u32_u24 v66, 40, v65
    v_sub_u32 v66, v64, v66
    s_mov_b32 s24, 1280
    v_mul_lo_u32 v4, v65, s24
    v_lshl_add_u32 v4, v66, 4, v4
    v_mul_u32_u24 v14, 656, v65
    v_lshl_add_u32 v14, v66, 4, v14
    v_add_u32 v14, 90112, v14
    v_add_u32 v64, 256, v0
    s_mov_b32 s24, 1639
    v_mul_lo_u32 v65, v64, s24
    v_lshrrev_b32 v65, 16, v65
    v_mul_u32_u24 v66, 40, v65
    v_sub_u32 v66, v64, v66
    s_mov_b32 s24, 1280
    v_mul_lo_u32 v5, v65, s24
    v_lshl_add_u32 v5, v66, 4, v5
    v_mul_u32_u24 v15, 656, v65
    v_lshl_add_u32 v15, v66, 4, v15
    v_add_u32 v15, 90112, v15
    v_add_u32 v64, 512, v0
    s_mov_b32 s24, 1639
    v_mul_lo_u32 v65, v64, s24
    v_lshrrev_b32 v65, 16, v65
    v_mul_u32_u24 v66, 40, v65
    v_sub_u32 v66, v64, v66
    s_mov_b32 s24, 1280
    v_mul_lo_u32 v6, v65, s24
    v_lshl_add_u32 v6, v66, 4, v6
    v_mul_u32_u24 v16, 656, v65
    v_lshl_add_u32 v16, v66, 4, v16
    v_add_u32 v16, 90112, v16
    v_add_u32 v64, 768, v0
    s_mov_b32 s24, 1639
    v_mul_lo_u32 v65, v64, s24
    v_lshrrev_b32 v65, 16, v65
    v_mul_u32_u24 v66, 40, v65
    v_sub_u32 v66, v64, v66
    s_mov_b32 s24, 1280
    v_mul_lo_u32 v7, v65, s24
    v_lshl_add_u32 v7, v66, 4, v7
    v_mul_u32_u24 v17, 656, v65
    v_lshl_add_u32 v17, v66, 4, v17
    v_add_u32 v17, 90112, v17
    v_add_u32 v64, 1024, v0
    s_mov_b32 s24, 1639
    v_mul_lo_u32 v65, v64, s24
    v_lshrrev_b32 v65, 16, v65
    v_mul_u32_u24 v66, 40, v65
    v_sub_u32 v66, v64, v66
    s_mov_b32 s24, 1280
    v_mul_lo_u32 v8, v65, s24
    v_lshl_add_u32 v8, v66, 4, v8
    v_mul_u32_u24 v18, 656, v65
    v_lshl_add_u32 v18, v66, 4, v18
    v_add_u32 v18, 90112, v18
    v_add_u32 v64, 1280, v0
    s_mov_b32 s24, 1639
    v_mul_lo_u32 v65, v64, s24
    v_lshrrev_b32 v65, 16, v65
    v_mul_u32_u24 v66, 40, v65
    v_sub_u32 v66, v64, v66
    s_mov_b32 s24, 1280
    v_mul_lo_u32 v9, v65, s24
    v_lshl_add_u32 v9, v66, 4, v9
    v_mul_u32_u24 v19, 656, v65
    v_lshl_add_u32 v19, v66, 4, v19
    v_add_u32 v19, 90112, v19
    v_add_u32 v64, 1536, v0
    s_mov_b32 s24, 1639
    v_mul_lo_u32 v65, v64, s24
    v_lshrrev_b32 v65, 16, v65
    v_mul_u32_u24 v66, 40, v65
    v_sub_u32 v66, v64, v66
    s_mov_b32 s24, 1280
    v_mul_lo_u32 v10, v65, s24
    v_lshl_add_u32 v10, v66, 4, v10
    v_mul_u32_u24 v20, 656, v65
    v_lshl_add_u32 v20, v66, 4, v20
    v_add_u32 v20, 90112, v20
    v_add_u32 v64, 1792, v0
    s_mov_b32 s24, 1639
    v_mul_lo_u32 v65, v64, s24
    v_lshrrev_b32 v65, 16, v65
    v_mul_u32_u24 v66, 40, v65
    v_sub_u32 v66, v64, v66
    s_mov_b32 s24, 1280
    v_mul_lo_u32 v11, v65, s24
    v_lshl_add_u32 v11, v66, 4, v11
    v_mul_u32_u24 v21, 656, v65
    v_lshl_add_u32 v21, v66, 4, v21
    v_add_u32 v21, 90112, v21
    v_add_u32 v64, 2048, v0
    s_mov_b32 s24, 1639
    v_mul_lo_u32 v65, v64, s24
    v_lshrrev_b32 v65, 16, v65
    v_mul_u32_u24 v66, 40, v65
    v_sub_u32 v66, v64, v66
    s_mov_b32 s24, 1280
    v_mul_lo_u32 v12, v65, s24
    v_lshl_add_u32 v12, v66, 4, v12
    v_mul_u32_u24 v22, 656, v65
    v_lshl_add_u32 v22, v66, 4, v22
    v_add_u32 v22, 90112, v22
    v_add_u32 v64, 2304, v0
    s_mov_b32 s24, 1639
    v_mul_lo_u32 v65, v64, s24
    v_lshrrev_b32 v65, 16, v65
    v_mul_u32_u24 v66, 40, v65
    v_sub_u32 v66, v64, v66
    s_mov_b32 s24, 1280
    v_mul_lo_u32 v13, v65, s24
    v_lshl_add_u32 v13, v66, 4, v13
    v_mul_u32_u24 v23, 656, v65
    v_lshl_add_u32 v23, v66, 4, v23
    v_add_u32 v23, 90112, v23
    v_lshrrev_b32 v64, 1, v3
    v_lshlrev_b32 v64, 4, v64
    v_and_b32 v65, 1, v3
    v_lshl_add_u32 v64, v65, 2, v64
    v_lshrrev_b32 v65, 2, v2
    v_and_b32 v66, 1, v65
    v_add_u32 v64, v64, v66
    v_lshrrev_b32 v65, 1, v65
    v_lshl_add_u32 v64, v65, 3, v64
    v_mul_u32_u24 v72, 656, v64
    v_and_b32 v65, 3, v2
    v_lshl_add_u32 v72, v65, 3, v72
    v_add_u32 v72, 90112, v72
    s_and_b32 s24, s3, 1
    s_mul_i32 s24, s24, 320
    v_add_u32 v72, s24, v72
    v_lshlrev_b32 v73, 4, v1
    s_mul_i32 s24, s3, 18432
    s_add_u32 s24, s24, 16384
    v_add_u32 v73, s24, v73
    s_mul_i32 s45, s44, 245760
    s_add_u32 s46, s45, 0
    buffer_load_dwordx4 v[24:27], v4, s[16:19], s46 offen
    buffer_load_dwordx4 v[28:31], v5, s[16:19], s46 offen
    buffer_load_dwordx4 v[32:35], v6, s[16:19], s46 offen
    buffer_load_dwordx4 v[36:39], v7, s[16:19], s46 offen
    buffer_load_dwordx4 v[40:43], v8, s[16:19], s46 offen
    buffer_load_dwordx4 v[44:47], v9, s[16:19], s46 offen
    buffer_load_dwordx4 v[48:51], v10, s[16:19], s46 offen
    buffer_load_dwordx4 v[52:55], v11, s[16:19], s46 offen
    buffer_load_dwordx4 v[56:59], v12, s[16:19], s46 offen
    buffer_load_dwordx4 v[60:63], v13, s[16:19], s46 offen
    s_waitcnt vmcnt(0)
    ds_write_b128 v14, v[24:27]
    ds_write_b128 v15, v[28:31]
    ds_write_b128 v16, v[32:35]
    ds_write_b128 v17, v[36:39]
    ds_write_b128 v18, v[40:43]
    ds_write_b128 v19, v[44:47]
    ds_write_b128 v20, v[48:51]
    ds_write_b128 v21, v[52:55]
    ds_write_b128 v22, v[56:59]
    ds_write_b128 v23, v[60:63]
    s_waitcnt lgkmcnt(0)
    s_barrier
    s_lshr_b32 s24, s3, 1
    s_cmp_eq_u32 s24, 0
    s_cbranch_scc0 interleave_layers__linear_attn_block__memory_aug_recurrent_mem_tr__prompt_kernel_wo18
    ds_read_b64_tr_b16 a[240:241], v72 offset:0
    ds_read_b64_tr_b16 a[242:243], v72 offset:1312
    ds_read_b64_tr_b16 a[244:245], v72 offset:20992
    ds_read_b64_tr_b16 a[246:247], v72 offset:22304
    ds_read_b64_tr_b16 v[112:113], v72 offset:32
    ds_read_b64_tr_b16 v[114:115], v72 offset:1344
    ds_read_b64_tr_b16 v[116:117], v72 offset:21024
    ds_read_b64_tr_b16 v[118:119], v72 offset:22336
    ds_read_b64_tr_b16 v[136:137], v72 offset:64
    ds_read_b64_tr_b16 v[138:139], v72 offset:1376
    ds_read_b64_tr_b16 v[140:141], v72 offset:21056
    ds_read_b64_tr_b16 v[142:143], v72 offset:22368
    ds_read_b64_tr_b16 v[160:161], v72 offset:96
    ds_read_b64_tr_b16 v[162:163], v72 offset:1408
    ds_read_b64_tr_b16 v[164:165], v72 offset:21088
    ds_read_b64_tr_b16 v[166:167], v72 offset:22400
    ds_read_b64_tr_b16 v[184:185], v72 offset:128
    ds_read_b64_tr_b16 v[186:187], v72 offset:1440
    ds_read_b64_tr_b16 v[188:189], v72 offset:21120
    ds_read_b64_tr_b16 v[190:191], v72 offset:22432
    ds_read_b64_tr_b16 v[208:209], v72 offset:160
    ds_read_b64_tr_b16 v[210:211], v72 offset:1472
    ds_read_b64_tr_b16 v[212:213], v72 offset:21152
    ds_read_b64_tr_b16 v[214:215], v72 offset:22464
    ds_read_b64_tr_b16 v[232:233], v72 offset:192
    ds_read_b64_tr_b16 v[234:235], v72 offset:1504
    ds_read_b64_tr_b16 v[236:237], v72 offset:21184
    ds_read_b64_tr_b16 v[238:239], v72 offset:22496
    ds_read_b64_tr_b16 v[64:65], v72 offset:224
    ds_read_b64_tr_b16 v[66:67], v72 offset:1536
    ds_read_b64_tr_b16 v[68:69], v72 offset:21216
    ds_read_b64_tr_b16 v[70:71], v72 offset:22528
    s_waitcnt lgkmcnt(0)
    ds_write_b128 v73, v[64:67] offset:0
    ds_write_b128 v73, v[68:71] offset:1024
    s_waitcnt lgkmcnt(0)
    ds_read_b64_tr_b16 v[64:65], v72 offset:256
    ds_read_b64_tr_b16 v[66:67], v72 offset:1568
    ds_read_b64_tr_b16 v[68:69], v72 offset:21248
    ds_read_b64_tr_b16 v[70:71], v72 offset:22560
    s_waitcnt lgkmcnt(0)
    ds_write_b128 v73, v[64:67] offset:6144
    ds_write_b128 v73, v[68:71] offset:7168
    s_waitcnt lgkmcnt(0)
    ds_read_b64_tr_b16 v[64:65], v72 offset:288
    ds_read_b64_tr_b16 v[66:67], v72 offset:1600
    ds_read_b64_tr_b16 v[68:69], v72 offset:21280
    ds_read_b64_tr_b16 v[70:71], v72 offset:22592
    s_waitcnt lgkmcnt(0)
    ds_write_b128 v73, v[64:67] offset:12288
    ds_write_b128 v73, v[68:71] offset:13312
    s_waitcnt lgkmcnt(0)
    s_waitcnt lgkmcnt(0)
interleave_layers__linear_attn_block__memory_aug_recurrent_mem_tr__prompt_kernel_wo18:
    s_barrier
    s_add_u32 s46, s45, 640
    buffer_load_dwordx4 v[24:27], v4, s[16:19], s46 offen
    buffer_load_dwordx4 v[28:31], v5, s[16:19], s46 offen
    buffer_load_dwordx4 v[32:35], v6, s[16:19], s46 offen
    buffer_load_dwordx4 v[36:39], v7, s[16:19], s46 offen
    buffer_load_dwordx4 v[40:43], v8, s[16:19], s46 offen
    buffer_load_dwordx4 v[44:47], v9, s[16:19], s46 offen
    buffer_load_dwordx4 v[48:51], v10, s[16:19], s46 offen
    buffer_load_dwordx4 v[52:55], v11, s[16:19], s46 offen
    buffer_load_dwordx4 v[56:59], v12, s[16:19], s46 offen
    buffer_load_dwordx4 v[60:63], v13, s[16:19], s46 offen
    s_waitcnt vmcnt(0)
    ds_write_b128 v14, v[24:27]
    ds_write_b128 v15, v[28:31]
    ds_write_b128 v16, v[32:35]
    ds_write_b128 v17, v[36:39]
    ds_write_b128 v18, v[40:43]
    ds_write_b128 v19, v[44:47]
    ds_write_b128 v20, v[48:51]
    ds_write_b128 v21, v[52:55]
    ds_write_b128 v22, v[56:59]
    ds_write_b128 v23, v[60:63]
    s_waitcnt lgkmcnt(0)
    s_barrier
    s_lshr_b32 s24, s3, 1
    s_cmp_eq_u32 s24, 1
    s_cbranch_scc0 interleave_layers__linear_attn_block__memory_aug_recurrent_mem_tr__prompt_kernel_wo19
    ds_read_b64_tr_b16 a[240:241], v72 offset:0
    ds_read_b64_tr_b16 a[242:243], v72 offset:1312
    ds_read_b64_tr_b16 a[244:245], v72 offset:20992
    ds_read_b64_tr_b16 a[246:247], v72 offset:22304
    ds_read_b64_tr_b16 v[112:113], v72 offset:32
    ds_read_b64_tr_b16 v[114:115], v72 offset:1344
    ds_read_b64_tr_b16 v[116:117], v72 offset:21024
    ds_read_b64_tr_b16 v[118:119], v72 offset:22336
    ds_read_b64_tr_b16 v[136:137], v72 offset:64
    ds_read_b64_tr_b16 v[138:139], v72 offset:1376
    ds_read_b64_tr_b16 v[140:141], v72 offset:21056
    ds_read_b64_tr_b16 v[142:143], v72 offset:22368
    ds_read_b64_tr_b16 v[160:161], v72 offset:96
    ds_read_b64_tr_b16 v[162:163], v72 offset:1408
    ds_read_b64_tr_b16 v[164:165], v72 offset:21088
    ds_read_b64_tr_b16 v[166:167], v72 offset:22400
    ds_read_b64_tr_b16 v[184:185], v72 offset:128
    ds_read_b64_tr_b16 v[186:187], v72 offset:1440
    ds_read_b64_tr_b16 v[188:189], v72 offset:21120
    ds_read_b64_tr_b16 v[190:191], v72 offset:22432
    ds_read_b64_tr_b16 v[208:209], v72 offset:160
    ds_read_b64_tr_b16 v[210:211], v72 offset:1472
    ds_read_b64_tr_b16 v[212:213], v72 offset:21152
    ds_read_b64_tr_b16 v[214:215], v72 offset:22464
    ds_read_b64_tr_b16 v[232:233], v72 offset:192
    ds_read_b64_tr_b16 v[234:235], v72 offset:1504
    ds_read_b64_tr_b16 v[236:237], v72 offset:21184
    ds_read_b64_tr_b16 v[238:239], v72 offset:22496
    ds_read_b64_tr_b16 v[64:65], v72 offset:224
    ds_read_b64_tr_b16 v[66:67], v72 offset:1536
    ds_read_b64_tr_b16 v[68:69], v72 offset:21216
    ds_read_b64_tr_b16 v[70:71], v72 offset:22528
    s_waitcnt lgkmcnt(0)
    ds_write_b128 v73, v[64:67] offset:0
    ds_write_b128 v73, v[68:71] offset:1024
    s_waitcnt lgkmcnt(0)
    ds_read_b64_tr_b16 v[64:65], v72 offset:256
    ds_read_b64_tr_b16 v[66:67], v72 offset:1568
    ds_read_b64_tr_b16 v[68:69], v72 offset:21248
    ds_read_b64_tr_b16 v[70:71], v72 offset:22560
    s_waitcnt lgkmcnt(0)
    ds_write_b128 v73, v[64:67] offset:6144
    ds_write_b128 v73, v[68:71] offset:7168
    s_waitcnt lgkmcnt(0)
    ds_read_b64_tr_b16 v[64:65], v72 offset:288
    ds_read_b64_tr_b16 v[66:67], v72 offset:1600
    ds_read_b64_tr_b16 v[68:69], v72 offset:21280
    ds_read_b64_tr_b16 v[70:71], v72 offset:22592
    s_waitcnt lgkmcnt(0)
    ds_write_b128 v73, v[64:67] offset:12288
    ds_write_b128 v73, v[68:71] offset:13312
    s_waitcnt lgkmcnt(0)
    s_waitcnt lgkmcnt(0)
interleave_layers__linear_attn_block__memory_aug_recurrent_mem_tr__prompt_kernel_wo19:
    s_barrier
    s_add_u32 s46, s45, 81920
    buffer_load_dwordx4 v[24:27], v4, s[16:19], s46 offen
    buffer_load_dwordx4 v[28:31], v5, s[16:19], s46 offen
    buffer_load_dwordx4 v[32:35], v6, s[16:19], s46 offen
    buffer_load_dwordx4 v[36:39], v7, s[16:19], s46 offen
    buffer_load_dwordx4 v[40:43], v8, s[16:19], s46 offen
    buffer_load_dwordx4 v[44:47], v9, s[16:19], s46 offen
    buffer_load_dwordx4 v[48:51], v10, s[16:19], s46 offen
    buffer_load_dwordx4 v[52:55], v11, s[16:19], s46 offen
    buffer_load_dwordx4 v[56:59], v12, s[16:19], s46 offen
    buffer_load_dwordx4 v[60:63], v13, s[16:19], s46 offen
    s_waitcnt vmcnt(0)
    ds_write_b128 v14, v[24:27]
    ds_write_b128 v15, v[28:31]
    ds_write_b128 v16, v[32:35]
    ds_write_b128 v17, v[36:39]
    ds_write_b128 v18, v[40:43]
    ds_write_b128 v19, v[44:47]
    ds_write_b128 v20, v[48:51]
    ds_write_b128 v21, v[52:55]
    ds_write_b128 v22, v[56:59]
    ds_write_b128 v23, v[60:63]
    s_waitcnt lgkmcnt(0)
    s_barrier
    s_lshr_b32 s24, s3, 1
    s_cmp_eq_u32 s24, 0
    s_cbranch_scc0 interleave_layers__linear_attn_block__memory_aug_recurrent_mem_tr__prompt_kernel_wo20
    ds_read_b64_tr_b16 a[248:249], v72 offset:0
    ds_read_b64_tr_b16 a[250:251], v72 offset:1312
    ds_read_b64_tr_b16 a[252:253], v72 offset:20992
    ds_read_b64_tr_b16 a[254:255], v72 offset:22304
    ds_read_b64_tr_b16 v[120:121], v72 offset:32
    ds_read_b64_tr_b16 v[122:123], v72 offset:1344
    ds_read_b64_tr_b16 v[124:125], v72 offset:21024
    ds_read_b64_tr_b16 v[126:127], v72 offset:22336
    ds_read_b64_tr_b16 v[144:145], v72 offset:64
    ds_read_b64_tr_b16 v[146:147], v72 offset:1376
    ds_read_b64_tr_b16 v[148:149], v72 offset:21056
    ds_read_b64_tr_b16 v[150:151], v72 offset:22368
    ds_read_b64_tr_b16 v[168:169], v72 offset:96
    ds_read_b64_tr_b16 v[170:171], v72 offset:1408
    ds_read_b64_tr_b16 v[172:173], v72 offset:21088
    ds_read_b64_tr_b16 v[174:175], v72 offset:22400
    ds_read_b64_tr_b16 v[192:193], v72 offset:128
    ds_read_b64_tr_b16 v[194:195], v72 offset:1440
    ds_read_b64_tr_b16 v[196:197], v72 offset:21120
    ds_read_b64_tr_b16 v[198:199], v72 offset:22432
    ds_read_b64_tr_b16 v[216:217], v72 offset:160
    ds_read_b64_tr_b16 v[218:219], v72 offset:1472
    ds_read_b64_tr_b16 v[220:221], v72 offset:21152
    ds_read_b64_tr_b16 v[222:223], v72 offset:22464
    ds_read_b64_tr_b16 v[240:241], v72 offset:192
    ds_read_b64_tr_b16 v[242:243], v72 offset:1504
    ds_read_b64_tr_b16 v[244:245], v72 offset:21184
    ds_read_b64_tr_b16 v[246:247], v72 offset:22496
    ds_read_b64_tr_b16 v[64:65], v72 offset:224
    ds_read_b64_tr_b16 v[66:67], v72 offset:1536
    ds_read_b64_tr_b16 v[68:69], v72 offset:21216
    ds_read_b64_tr_b16 v[70:71], v72 offset:22528
    s_waitcnt lgkmcnt(0)
    ds_write_b128 v73, v[64:67] offset:2048
    ds_write_b128 v73, v[68:71] offset:3072
    s_waitcnt lgkmcnt(0)
    ds_read_b64_tr_b16 v[64:65], v72 offset:256
    ds_read_b64_tr_b16 v[66:67], v72 offset:1568
    ds_read_b64_tr_b16 v[68:69], v72 offset:21248
    ds_read_b64_tr_b16 v[70:71], v72 offset:22560
    s_waitcnt lgkmcnt(0)
    ds_write_b128 v73, v[64:67] offset:8192
    ds_write_b128 v73, v[68:71] offset:9216
    s_waitcnt lgkmcnt(0)
    ds_read_b64_tr_b16 v[64:65], v72 offset:288
    ds_read_b64_tr_b16 v[66:67], v72 offset:1600
    ds_read_b64_tr_b16 v[68:69], v72 offset:21280
    ds_read_b64_tr_b16 v[70:71], v72 offset:22592
    s_waitcnt lgkmcnt(0)
    ds_write_b128 v73, v[64:67] offset:14336
    ds_write_b128 v73, v[68:71] offset:15360
    s_waitcnt lgkmcnt(0)
    s_waitcnt lgkmcnt(0)
interleave_layers__linear_attn_block__memory_aug_recurrent_mem_tr__prompt_kernel_wo20:
    s_barrier
    s_add_u32 s46, s45, 82560
    buffer_load_dwordx4 v[24:27], v4, s[16:19], s46 offen
    buffer_load_dwordx4 v[28:31], v5, s[16:19], s46 offen
    buffer_load_dwordx4 v[32:35], v6, s[16:19], s46 offen
    buffer_load_dwordx4 v[36:39], v7, s[16:19], s46 offen
    buffer_load_dwordx4 v[40:43], v8, s[16:19], s46 offen
    buffer_load_dwordx4 v[44:47], v9, s[16:19], s46 offen
    buffer_load_dwordx4 v[48:51], v10, s[16:19], s46 offen
    buffer_load_dwordx4 v[52:55], v11, s[16:19], s46 offen
    buffer_load_dwordx4 v[56:59], v12, s[16:19], s46 offen
    buffer_load_dwordx4 v[60:63], v13, s[16:19], s46 offen
    s_waitcnt vmcnt(0)
    ds_write_b128 v14, v[24:27]
    ds_write_b128 v15, v[28:31]
    ds_write_b128 v16, v[32:35]
    ds_write_b128 v17, v[36:39]
    ds_write_b128 v18, v[40:43]
    ds_write_b128 v19, v[44:47]
    ds_write_b128 v20, v[48:51]
    ds_write_b128 v21, v[52:55]
    ds_write_b128 v22, v[56:59]
    ds_write_b128 v23, v[60:63]
    s_waitcnt lgkmcnt(0)
    s_barrier
    s_lshr_b32 s24, s3, 1
    s_cmp_eq_u32 s24, 1
    s_cbranch_scc0 interleave_layers__linear_attn_block__memory_aug_recurrent_mem_tr__prompt_kernel_wo21
    ds_read_b64_tr_b16 a[248:249], v72 offset:0
    ds_read_b64_tr_b16 a[250:251], v72 offset:1312
    ds_read_b64_tr_b16 a[252:253], v72 offset:20992
    ds_read_b64_tr_b16 a[254:255], v72 offset:22304
    ds_read_b64_tr_b16 v[120:121], v72 offset:32
    ds_read_b64_tr_b16 v[122:123], v72 offset:1344
    ds_read_b64_tr_b16 v[124:125], v72 offset:21024
    ds_read_b64_tr_b16 v[126:127], v72 offset:22336
    ds_read_b64_tr_b16 v[144:145], v72 offset:64
    ds_read_b64_tr_b16 v[146:147], v72 offset:1376
    ds_read_b64_tr_b16 v[148:149], v72 offset:21056
    ds_read_b64_tr_b16 v[150:151], v72 offset:22368
    ds_read_b64_tr_b16 v[168:169], v72 offset:96
    ds_read_b64_tr_b16 v[170:171], v72 offset:1408
    ds_read_b64_tr_b16 v[172:173], v72 offset:21088
    ds_read_b64_tr_b16 v[174:175], v72 offset:22400
    ds_read_b64_tr_b16 v[192:193], v72 offset:128
    ds_read_b64_tr_b16 v[194:195], v72 offset:1440
    ds_read_b64_tr_b16 v[196:197], v72 offset:21120
    ds_read_b64_tr_b16 v[198:199], v72 offset:22432
    ds_read_b64_tr_b16 v[216:217], v72 offset:160
    ds_read_b64_tr_b16 v[218:219], v72 offset:1472
    ds_read_b64_tr_b16 v[220:221], v72 offset:21152
    ds_read_b64_tr_b16 v[222:223], v72 offset:22464
    ds_read_b64_tr_b16 v[240:241], v72 offset:192
    ds_read_b64_tr_b16 v[242:243], v72 offset:1504
    ds_read_b64_tr_b16 v[244:245], v72 offset:21184
    ds_read_b64_tr_b16 v[246:247], v72 offset:22496
    ds_read_b64_tr_b16 v[64:65], v72 offset:224
    ds_read_b64_tr_b16 v[66:67], v72 offset:1536
    ds_read_b64_tr_b16 v[68:69], v72 offset:21216
    ds_read_b64_tr_b16 v[70:71], v72 offset:22528
    s_waitcnt lgkmcnt(0)
    ds_write_b128 v73, v[64:67] offset:2048
    ds_write_b128 v73, v[68:71] offset:3072
    s_waitcnt lgkmcnt(0)
    ds_read_b64_tr_b16 v[64:65], v72 offset:256
    ds_read_b64_tr_b16 v[66:67], v72 offset:1568
    ds_read_b64_tr_b16 v[68:69], v72 offset:21248
    ds_read_b64_tr_b16 v[70:71], v72 offset:22560
    s_waitcnt lgkmcnt(0)
    ds_write_b128 v73, v[64:67] offset:8192
    ds_write_b128 v73, v[68:71] offset:9216
    s_waitcnt lgkmcnt(0)
    ds_read_b64_tr_b16 v[64:65], v72 offset:288
    ds_read_b64_tr_b16 v[66:67], v72 offset:1600
    ds_read_b64_tr_b16 v[68:69], v72 offset:21280
    ds_read_b64_tr_b16 v[70:71], v72 offset:22592
    s_waitcnt lgkmcnt(0)
    ds_write_b128 v73, v[64:67] offset:14336
    ds_write_b128 v73, v[68:71] offset:15360
    s_waitcnt lgkmcnt(0)
    s_waitcnt lgkmcnt(0)
interleave_layers__linear_attn_block__memory_aug_recurrent_mem_tr__prompt_kernel_wo21:
    s_barrier
    s_add_u32 s46, s45, 163840
    buffer_load_dwordx4 v[24:27], v4, s[16:19], s46 offen
    buffer_load_dwordx4 v[28:31], v5, s[16:19], s46 offen
    buffer_load_dwordx4 v[32:35], v6, s[16:19], s46 offen
    buffer_load_dwordx4 v[36:39], v7, s[16:19], s46 offen
    buffer_load_dwordx4 v[40:43], v8, s[16:19], s46 offen
    buffer_load_dwordx4 v[44:47], v9, s[16:19], s46 offen
    buffer_load_dwordx4 v[48:51], v10, s[16:19], s46 offen
    buffer_load_dwordx4 v[52:55], v11, s[16:19], s46 offen
    buffer_load_dwordx4 v[56:59], v12, s[16:19], s46 offen
    buffer_load_dwordx4 v[60:63], v13, s[16:19], s46 offen
    s_waitcnt vmcnt(0)
    ds_write_b128 v14, v[24:27]
    ds_write_b128 v15, v[28:31]
    ds_write_b128 v16, v[32:35]
    ds_write_b128 v17, v[36:39]
    ds_write_b128 v18, v[40:43]
    ds_write_b128 v19, v[44:47]
    ds_write_b128 v20, v[48:51]
    ds_write_b128 v21, v[52:55]
    ds_write_b128 v22, v[56:59]
    ds_write_b128 v23, v[60:63]
    s_waitcnt lgkmcnt(0)
    s_barrier
    s_lshr_b32 s24, s3, 1
    s_cmp_eq_u32 s24, 0
    s_cbranch_scc0 interleave_layers__linear_attn_block__memory_aug_recurrent_mem_tr__prompt_kernel_wo22
    ds_read_b64_tr_b16 v[104:105], v72 offset:0
    ds_read_b64_tr_b16 v[106:107], v72 offset:1312
    ds_read_b64_tr_b16 v[108:109], v72 offset:20992
    ds_read_b64_tr_b16 v[110:111], v72 offset:22304
    ds_read_b64_tr_b16 v[128:129], v72 offset:32
    ds_read_b64_tr_b16 v[130:131], v72 offset:1344
    ds_read_b64_tr_b16 v[132:133], v72 offset:21024
    ds_read_b64_tr_b16 v[134:135], v72 offset:22336
    ds_read_b64_tr_b16 v[152:153], v72 offset:64
    ds_read_b64_tr_b16 v[154:155], v72 offset:1376
    ds_read_b64_tr_b16 v[156:157], v72 offset:21056
    ds_read_b64_tr_b16 v[158:159], v72 offset:22368
    ds_read_b64_tr_b16 v[176:177], v72 offset:96
    ds_read_b64_tr_b16 v[178:179], v72 offset:1408
    ds_read_b64_tr_b16 v[180:181], v72 offset:21088
    ds_read_b64_tr_b16 v[182:183], v72 offset:22400
    ds_read_b64_tr_b16 v[200:201], v72 offset:128
    ds_read_b64_tr_b16 v[202:203], v72 offset:1440
    ds_read_b64_tr_b16 v[204:205], v72 offset:21120
    ds_read_b64_tr_b16 v[206:207], v72 offset:22432
    ds_read_b64_tr_b16 v[224:225], v72 offset:160
    ds_read_b64_tr_b16 v[226:227], v72 offset:1472
    ds_read_b64_tr_b16 v[228:229], v72 offset:21152
    ds_read_b64_tr_b16 v[230:231], v72 offset:22464
    ds_read_b64_tr_b16 v[248:249], v72 offset:192
    ds_read_b64_tr_b16 v[250:251], v72 offset:1504
    ds_read_b64_tr_b16 v[252:253], v72 offset:21184
    ds_read_b64_tr_b16 v[254:255], v72 offset:22496
    ds_read_b64_tr_b16 v[64:65], v72 offset:224
    ds_read_b64_tr_b16 v[66:67], v72 offset:1536
    ds_read_b64_tr_b16 v[68:69], v72 offset:21216
    ds_read_b64_tr_b16 v[70:71], v72 offset:22528
    s_waitcnt lgkmcnt(0)
    ds_write_b128 v73, v[64:67] offset:4096
    ds_write_b128 v73, v[68:71] offset:5120
    s_waitcnt lgkmcnt(0)
    ds_read_b64_tr_b16 v[64:65], v72 offset:256
    ds_read_b64_tr_b16 v[66:67], v72 offset:1568
    ds_read_b64_tr_b16 v[68:69], v72 offset:21248
    ds_read_b64_tr_b16 v[70:71], v72 offset:22560
    s_waitcnt lgkmcnt(0)
    ds_write_b128 v73, v[64:67] offset:10240
    ds_write_b128 v73, v[68:71] offset:11264
    s_waitcnt lgkmcnt(0)
    ds_read_b64_tr_b16 v[64:65], v72 offset:288
    ds_read_b64_tr_b16 v[66:67], v72 offset:1600
    ds_read_b64_tr_b16 v[68:69], v72 offset:21280
    ds_read_b64_tr_b16 v[70:71], v72 offset:22592
    s_waitcnt lgkmcnt(0)
    ds_write_b128 v73, v[64:67] offset:16384
    ds_write_b128 v73, v[68:71] offset:17408
    s_waitcnt lgkmcnt(0)
    s_waitcnt lgkmcnt(0)
interleave_layers__linear_attn_block__memory_aug_recurrent_mem_tr__prompt_kernel_wo22:
    s_barrier
    s_add_u32 s46, s45, 164480
    buffer_load_dwordx4 v[24:27], v4, s[16:19], s46 offen
    buffer_load_dwordx4 v[28:31], v5, s[16:19], s46 offen
    buffer_load_dwordx4 v[32:35], v6, s[16:19], s46 offen
    buffer_load_dwordx4 v[36:39], v7, s[16:19], s46 offen
    buffer_load_dwordx4 v[40:43], v8, s[16:19], s46 offen
    buffer_load_dwordx4 v[44:47], v9, s[16:19], s46 offen
    buffer_load_dwordx4 v[48:51], v10, s[16:19], s46 offen
    buffer_load_dwordx4 v[52:55], v11, s[16:19], s46 offen
    buffer_load_dwordx4 v[56:59], v12, s[16:19], s46 offen
    buffer_load_dwordx4 v[60:63], v13, s[16:19], s46 offen
    s_waitcnt vmcnt(0)
    ds_write_b128 v14, v[24:27]
    ds_write_b128 v15, v[28:31]
    ds_write_b128 v16, v[32:35]
    ds_write_b128 v17, v[36:39]
    ds_write_b128 v18, v[40:43]
    ds_write_b128 v19, v[44:47]
    ds_write_b128 v20, v[48:51]
    ds_write_b128 v21, v[52:55]
    ds_write_b128 v22, v[56:59]
    ds_write_b128 v23, v[60:63]
    s_waitcnt lgkmcnt(0)
    s_barrier
    s_lshr_b32 s24, s3, 1
    s_cmp_eq_u32 s24, 1
    s_cbranch_scc0 interleave_layers__linear_attn_block__memory_aug_recurrent_mem_tr__prompt_kernel_wo23
    ds_read_b64_tr_b16 v[104:105], v72 offset:0
    ds_read_b64_tr_b16 v[106:107], v72 offset:1312
    ds_read_b64_tr_b16 v[108:109], v72 offset:20992
    ds_read_b64_tr_b16 v[110:111], v72 offset:22304
    ds_read_b64_tr_b16 v[128:129], v72 offset:32
    ds_read_b64_tr_b16 v[130:131], v72 offset:1344
    ds_read_b64_tr_b16 v[132:133], v72 offset:21024
    ds_read_b64_tr_b16 v[134:135], v72 offset:22336
    ds_read_b64_tr_b16 v[152:153], v72 offset:64
    ds_read_b64_tr_b16 v[154:155], v72 offset:1376
    ds_read_b64_tr_b16 v[156:157], v72 offset:21056
    ds_read_b64_tr_b16 v[158:159], v72 offset:22368
    ds_read_b64_tr_b16 v[176:177], v72 offset:96
    ds_read_b64_tr_b16 v[178:179], v72 offset:1408
    ds_read_b64_tr_b16 v[180:181], v72 offset:21088
    ds_read_b64_tr_b16 v[182:183], v72 offset:22400
    ds_read_b64_tr_b16 v[200:201], v72 offset:128
    ds_read_b64_tr_b16 v[202:203], v72 offset:1440
    ds_read_b64_tr_b16 v[204:205], v72 offset:21120
    ds_read_b64_tr_b16 v[206:207], v72 offset:22432
    ds_read_b64_tr_b16 v[224:225], v72 offset:160
    ds_read_b64_tr_b16 v[226:227], v72 offset:1472
    ds_read_b64_tr_b16 v[228:229], v72 offset:21152
    ds_read_b64_tr_b16 v[230:231], v72 offset:22464
    ds_read_b64_tr_b16 v[248:249], v72 offset:192
    ds_read_b64_tr_b16 v[250:251], v72 offset:1504
    ds_read_b64_tr_b16 v[252:253], v72 offset:21184
    ds_read_b64_tr_b16 v[254:255], v72 offset:22496
    ds_read_b64_tr_b16 v[64:65], v72 offset:224
    ds_read_b64_tr_b16 v[66:67], v72 offset:1536
    ds_read_b64_tr_b16 v[68:69], v72 offset:21216
    ds_read_b64_tr_b16 v[70:71], v72 offset:22528
    s_waitcnt lgkmcnt(0)
    ds_write_b128 v73, v[64:67] offset:4096
    ds_write_b128 v73, v[68:71] offset:5120
    s_waitcnt lgkmcnt(0)
    ds_read_b64_tr_b16 v[64:65], v72 offset:256
    ds_read_b64_tr_b16 v[66:67], v72 offset:1568
    ds_read_b64_tr_b16 v[68:69], v72 offset:21248
    ds_read_b64_tr_b16 v[70:71], v72 offset:22560
    s_waitcnt lgkmcnt(0)
    ds_write_b128 v73, v[64:67] offset:10240
    ds_write_b128 v73, v[68:71] offset:11264
    s_waitcnt lgkmcnt(0)
    ds_read_b64_tr_b16 v[64:65], v72 offset:288
    ds_read_b64_tr_b16 v[66:67], v72 offset:1600
    ds_read_b64_tr_b16 v[68:69], v72 offset:21280
    ds_read_b64_tr_b16 v[70:71], v72 offset:22592
    s_waitcnt lgkmcnt(0)
    ds_write_b128 v73, v[64:67] offset:16384
    ds_write_b128 v73, v[68:71] offset:17408
    s_waitcnt lgkmcnt(0)
    s_waitcnt lgkmcnt(0)
interleave_layers__linear_attn_block__memory_aug_recurrent_mem_tr__prompt_kernel_wo23:
    s_barrier
    v_mov_b32 v6, v73
    v_mov_b32 v4, 0x4444
    v_mov_b32 v5, 0xeeee
    v_cmp_gt_u32 vcc, 8, v2
    s_nop 1
    v_cndmask_b32 v4, v5, v4, vcc
    v_lshlrev_b32 v5, 4, v1
    s_lshl_b32 s24, s3, 10
    v_add_u32 v7, s24, v5
    s_lshl_b32 s24, s3, 9
    s_add_u32 s24, s24, 8192
    v_lshlrev_b32 v8, 3, v1
    v_add_u32 v8, s24, v8
    v_and_b32 v64, 7, v2
    v_lshlrev_b32 v9, 5, v64
    v_lshrrev_b32 v64, 3, v2
    v_lshl_add_u32 v9, v64, 4, v9
    v_and_b32 v64, 1, v3
    v_lshl_add_u32 v9, v64, 3, v9
    s_mul_i32 s24, s3, 768
    s_add_u32 s24, s24, 10240
    v_add_u32 v9, s24, v9
    v_lshrrev_b32 v65, 1, v3
    v_lshl_add_u32 v10, v65, 8, v9
    v_lshrrev_b32 v64, 2, v2
    v_lshlrev_b32 v11, 5, v64
    v_and_b32 v64, 3, v2
    v_lshl_add_u32 v11, v64, 3, v11
    v_lshl_add_u32 v11, v3, 8, v11
    v_add_u32 v11, 10240, v11
    s_mul_i32 s24, s3, 10
    s_lshl_b32 s24, s24, 14
    s_lshl_b32 s25, s44, 8
    s_add_u32 s24, s24, s25
    v_lshlrev_b32 v14, 14, v3
    v_lshl_add_u32 v14, v2, 4, v14
    v_add_u32 v14, s24, v14
    v_lshrrev_b32 v64, 1, v3
    v_lshlrev_b32 v15, 14, v64
    v_lshl_add_u32 v15, v2, 4, v15
    v_add_u32 v15, s24, v15
    v_add_u32 v15, 131072, v15
    v_and_b32 v64, 1, v3
    v_cmp_eq_u32 vcc, 0, v64
    v_mov_b32 v64, 2146435072
    s_nop 0
    v_cndmask_b32 v15, v64, v15, vcc
    s_and_b32 s24, s2, 15
    s_mul_i32 s25, s3, 16
    s_add_u32 s24, s24, s25
    s_lshl_b32 s24, s24, 7
    v_mov_b32 v12, s24
    v_mov_b32 v0, 1
interleave_layers__linear_attn_block__memory_aug_recurrent_mem_tr__prompt_kernel_v_layer:
    s_mov_b32 s93, 0
    s_lshl_b32 s24, s93, 12
    s_and_b32 s24, s24, 0x2000
    s_xor_b32 s24, s24, s36
    s_lshl_b32 s93, s93, 20
    s_add_u32 s93, s93, s24
    s_add_u32 s93, s93, 117440512
    s_mul_i32 s94, s92, 16384
    s_add_u32 s94, s94, 23068672
    s_lshl_b32 s24, s3, 6
    s_add_u32 s24, s24, 0
    v_add_u32 v64, s24, v1
    v_and_b32 v65, 7, v64
    v_mul_u32_u24 v65, 1280, v65
    v_lshrrev_b32 v66, 3, v64
    v_lshl_add_u32 v65, v66, 4, v65
    v_cmp_gt_u32 vcc, 640, v64
    v_mov_b32 v67, 2146435072
    s_nop 0
    v_cndmask_b32 v65, v67, v65, vcc
    buffer_load_dwordx4 v[68:71], v65, s[20:23], 0 offen
    v_lshlrev_b32 v64, 4, v64
    s_waitcnt vmcnt(0)
    s_and_saveexec_b64 s[30:31], vcc
    ds_write_b128 v64, v[68:71]
    s_mov_b64 exec, s[30:31]
    s_lshl_b32 s24, s3, 6
    s_add_u32 s24, s24, 256
    v_add_u32 v64, s24, v1
    v_and_b32 v65, 7, v64
    v_mul_u32_u24 v65, 1280, v65
    v_lshrrev_b32 v66, 3, v64
    v_lshl_add_u32 v65, v66, 4, v65
    v_cmp_gt_u32 vcc, 640, v64
    v_mov_b32 v67, 2146435072
    s_nop 0
    v_cndmask_b32 v65, v67, v65, vcc
    buffer_load_dwordx4 v[68:71], v65, s[20:23], 0 offen
    v_lshlrev_b32 v64, 4, v64
    s_waitcnt vmcnt(0)
    s_and_saveexec_b64 s[30:31], vcc
    ds_write_b128 v64, v[68:71]
    s_mov_b64 exec, s[30:31]
    s_lshl_b32 s24, s3, 6
    s_add_u32 s24, s24, 512
    v_add_u32 v64, s24, v1
    v_and_b32 v65, 7, v64
    v_mul_u32_u24 v65, 1280, v65
    v_lshrrev_b32 v66, 3, v64
    v_lshl_add_u32 v65, v66, 4, v65
    v_cmp_gt_u32 vcc, 640, v64
    v_mov_b32 v67, 2146435072
    s_nop 0
    v_cndmask_b32 v65, v67, v65, vcc
    buffer_load_dwordx4 v[68:71], v65, s[20:23], 0 offen
    v_lshlrev_b32 v64, 4, v64
    s_waitcnt vmcnt(0)
    s_and_saveexec_b64 s[30:31], vcc
    ds_write_b128 v64, v[68:71]
    s_mov_b64 exec, s[30:31]
    s_mov_b32 s40, 0
    s_mov_b32 s37, s93
    s_add_u32 s43, s93, 0
    s_lshl_b32 s95, s92, 6
    s_add_u32 s95, s95, s40
    s_add_u32 s95, s95, 1
    s_cmp_ge_i32 s59, s95
    s_cbranch_scc1 interleave_layers__linear_attn_block__memory_aug_recurrent_mem_tr__prompt_kernel_v_ec0_ok
    s_and_b32 s24, s2, 7
    s_lshl_b32 s24, s24, 7
    s_add_u32 s24, s24, 23109632
    v_and_b32 v65, 3, v1
    v_lshl_add_u32 v65, v65, 2, s24
    s_mov_b32 s61, 0
interleave_layers__linear_attn_block__memory_aug_recurrent_mem_tr__prompt_kernel_v_ec0:
    buffer_load_dword v64, v65, s[8:11], 0 offen sc1
    s_waitcnt vmcnt(0)
    v_readlane_b32 s59, v64, 0
    v_readlane_b32 s24, v64, 1
    s_min_i32 s59, s59, s24
    v_readlane_b32 s24, v64, 2
    s_min_i32 s59, s59, s24
    s_cmp_ge_i32 s59, s95
    s_cbranch_scc1 interleave_layers__linear_attn_block__memory_aug_recurrent_mem_tr__prompt_kernel_v_ec0_ok
    s_add_u32 s61, s61, 1
    s_cmp_ge_u32 s61, s60
    s_cbranch_scc1 interleave_layers__linear_attn_block__memory_aug_recurrent_mem_tr__prompt_kernel_v_ec0_to
    s_sleep 2
    s_branch interleave_layers__linear_attn_block__memory_aug_recurrent_mem_tr__prompt_kernel_v_ec0
interleave_layers__linear_attn_block__memory_aug_recurrent_mem_tr__prompt_kernel_v_ec0_to:
    s_mov_b32 s60, 1
interleave_layers__linear_attn_block__memory_aug_recurrent_mem_tr__prompt_kernel_v_ec0_ok:
    v_mov_b32 v16, 0
    v_mov_b32 v17, 0
    v_mov_b32 v18, 0
    v_mov_b32 v19, 0
    v_mov_b32 v20, 0
    v_mov_b32 v21, 0
    v_mov_b32 v22, 0
    v_mov_b32 v23, 0
    v_mov_b32 v24, 0
    v_mov_b32 v25, 0
    v_mov_b32 v26, 0
    v_mov_b32 v27, 0
    v_mov_b32 v28, 0
    v_mov_b32 v29, 0
    v_mov_b32 v30, 0
    v_mov_b32 v31, 0
    v_mov_b32 v32, 0
    v_mov_b32 v33, 0
    v_mov_b32 v34, 0
    v_mov_b32 v35, 0
    v_mov_b32 v36, 0
    v_mov_b32 v37, 0
    v_mov_b32 v38, 0
    v_mov_b32 v39, 0
    v_mov_b32 v40, 0
    v_mov_b32 v41, 0
    v_mov_b32 v42, 0
    v_mov_b32 v43, 0
    v_mov_b32 v44, 0
    v_mov_b32 v45, 0
    v_mov_b32 v46, 0
    v_mov_b32 v47, 0
    v_mov_b32 v48, 0
    v_mov_b32 v49, 0
    v_mov_b32 v50, 0
    v_mov_b32 v51, 0
    v_mov_b32 v52, 0
    v_mov_b32 v53, 0
    v_mov_b32 v54, 0
    v_mov_b32 v55, 0
    v_mov_b32 v56, 0
    v_mov_b32 v57, 0
    v_mov_b32 v58, 0
    v_mov_b32 v59, 0
    v_mov_b32 v60, 0
    v_mov_b32 v61, 0
    v_mov_b32 v62, 0
    v_mov_b32 v63, 0
    v_mov_b32 v64, 0
    v_mov_b32 v65, 0
    v_mov_b32 v66, 0
    v_mov_b32 v67, 0
    s_waitcnt lgkmcnt(0)
    s_barrier
    ds_read_b128 v[68:71], v7
    ds_read_b128 v[72:75], v7 offset:4096
    s_waitcnt lgkmcnt(0)
    s_cmp_eq_u32 s3, 0
    s_cbranch_scc1 interleave_layers__linear_attn_block__memory_aug_recurrent_mem_tr__prompt_kernel_v_gow0
    s_cmp_eq_u32 s3, 1
    s_cbranch_scc1 interleave_layers__linear_attn_block__memory_aug_recurrent_mem_tr__prompt_kernel_v_gow1
    s_cmp_eq_u32 s3, 2
    s_cbranch_scc1 interleave_layers__linear_attn_block__memory_aug_recurrent_mem_tr__prompt_kernel_v_gow2
    s_branch interleave_layers__linear_attn_block__memory_aug_recurrent_mem_tr__prompt_kernel_v_gow3
interleave_layers__linear_attn_block__memory_aug_recurrent_mem_tr__prompt_kernel_v_stepw0:
    v_mov_b32 v16, 0
    v_mov_b32 v17, 0
    v_mov_b32 v18, 0
    v_mov_b32 v19, 0
    v_mov_b32 v20, 0
    v_mov_b32 v21, 0
    v_mov_b32 v22, 0
    v_mov_b32 v23, 0
    v_mov_b32 v24, 0
    v_mov_b32 v25, 0
    v_mov_b32 v26, 0
    v_mov_b32 v27, 0
    v_mov_b32 v28, 0
    v_mov_b32 v29, 0
    v_mov_b32 v30, 0
    v_mov_b32 v31, 0
    v_mov_b32 v32, 0
    v_mov_b32 v33, 0
    v_mov_b32 v34, 0
    v_mov_b32 v35, 0
    v_mov_b32 v36, 0
    v_mov_b32 v37, 0
    v_mov_b32 v38, 0
    v_mov_b32 v39, 0
    v_mov_b32 v40, 0
    v_mov_b32 v41, 0
    v_mov_b32 v42, 0
    v_mov_b32 v43, 0
    v_mov_b32 v44, 0
    v_mov_b32 v45, 0
    v_mov_b32 v46, 0
    v_mov_b32 v47, 0
    v_mov_b32 v48, 0
    v_mov_b32 v49, 0
    v_mov_b32 v50, 0
    v_mov_b32 v51, 0
    v_mov_b32 v52, 0
    v_mov_b32 v53, 0
    v_mov_b32 v54, 0
    v_mov_b32 v55, 0
    v_mov_b32 v56, 0
    v_mov_b32 v57, 0
    v_mov_b32 v58, 0
    v_mov_b32 v59, 0
    v_mov_b32 v60, 0
    v_mov_b32 v61, 0
    v_mov_b32 v62, 0
    v_mov_b32 v63, 0
    v_mov_b32 v64, 0
    v_mov_b32 v65, 0
    v_mov_b32 v66, 0
    v_mov_b32 v67, 0
    s_add_u32 s48, s47, 4096
    s_add_u32 s50, s47, 8192
    s_lshl_b32 s95, s92, 6
    s_add_u32 s95, s95, s40
    s_add_u32 s95, s95, 1
    s_cmp_ge_i32 s59, s95
    s_cbranch_scc1 interleave_layers__linear_attn_block__memory_aug_recurrent_mem_tr__prompt_kernel_v_ecw0_ok
    s_and_b32 s24, s2, 7
    s_lshl_b32 s24, s24, 7
    s_add_u32 s24, s24, 23109632
    v_and_b32 v79, 3, v1
    v_lshl_add_u32 v79, v79, 2, s24
    s_mov_b32 s61, 0
interleave_layers__linear_attn_block__memory_aug_recurrent_mem_tr__prompt_kernel_v_ecw0:
    buffer_load_dword v78, v79, s[8:11], 0 offen sc1
    s_waitcnt vmcnt(0)
    v_readlane_b32 s59, v78, 0
    v_readlane_b32 s24, v78, 1
    s_min_i32 s59, s59, s24
    v_readlane_b32 s24, v78, 2
    s_min_i32 s59, s59, s24
    s_cmp_ge_i32 s59, s95
    s_cbranch_scc1 interleave_layers__linear_attn_block__memory_aug_recurrent_mem_tr__prompt_kernel_v_ecw0_ok
    s_add_u32 s61, s61, 1
    s_cmp_ge_u32 s61, s60
    s_cbranch_scc1 interleave_layers__linear_attn_block__memory_aug_recurrent_mem_tr__prompt_kernel_v_ecw0_to
    s_sleep 2
    s_branch interleave_layers__linear_attn_block__memory_aug_recurrent_mem_tr__prompt_kernel_v_ecw0
interleave_layers__linear_attn_block__memory_aug_recurrent_mem_tr__prompt_kernel_v_ecw0_to:
    s_mov_b32 s60, 1
interleave_layers__linear_attn_block__memory_aug_recurrent_mem_tr__prompt_kernel_v_ecw0_ok:
    s_sleep 20
    s_mov_b64 exec, 1
    s_mov_b32 s61, 0
    v_mov_b32 v81, 0
    buffer_atomic_add v81, v12, s[8:11], s45 offen sc0
    s_sleep 3
    v_mov_b32 v82, 0
    buffer_atomic_add v82, v12, s[8:11], s45 offen sc0
    s_sleep 3
    v_mov_b32 v83, 0
    buffer_atomic_add v83, v12, s[8:11], s45 offen sc0
    s_sleep 3
interleave_layers__linear_attn_block__memory_aug_recurrent_mem_tr__prompt_kernel_v_prw0:
    v_mov_b32 v80, 0
    buffer_atomic_add v80, v12, s[8:11], s45 offen sc0
    s_waitcnt vmcnt(3)
    v_cmp_le_i32 vcc, 8, v81
    s_add_u32 s61, s61, 1
    s_cbranch_vccnz interleave_layers__linear_attn_block__memory_aug_recurrent_mem_tr__prompt_kernel_v_prw0_out
    s_sleep 3
    v_mov_b32 v81, 0
    buffer_atomic_add v81, v12, s[8:11], s45 offen sc0
    s_waitcnt vmcnt(3)
    v_cmp_le_i32 vcc, 8, v82
    s_add_u32 s61, s61, 1
    s_cbranch_vccnz interleave_layers__linear_attn_block__memory_aug_recurrent_mem_tr__prompt_kernel_v_prw0_out
    s_sleep 3
    v_mov_b32 v82, 0
    buffer_atomic_add v82, v12, s[8:11], s45 offen sc0
    s_waitcnt vmcnt(3)
    v_cmp_le_i32 vcc, 8, v83
    s_add_u32 s61, s61, 1
    s_cbranch_vccnz interleave_layers__linear_attn_block__memory_aug_recurrent_mem_tr__prompt_kernel_v_prw0_out
    s_sleep 3
    v_mov_b32 v83, 0
    buffer_atomic_add v83, v12, s[8:11], s45 offen sc0
    s_waitcnt vmcnt(3)
    v_cmp_le_i32 vcc, 8, v80
    s_add_u32 s61, s61, 1
    s_cbranch_vccnz interleave_layers__linear_attn_block__memory_aug_recurrent_mem_tr__prompt_kernel_v_prw0_out
    s_sleep 3
    s_cmp_ge_u32 s61, s60
    s_cbranch_scc0 interleave_layers__linear_attn_block__memory_aug_recurrent_mem_tr__prompt_kernel_v_prw0
    s_mov_b32 s60, 1
interleave_layers__linear_attn_block__memory_aug_recurrent_mem_tr__prompt_kernel_v_prw0_out:
    s_mov_b64 exec, -1
    buffer_load_dwordx4 v[68:71], v7, s[8:11], s47 offen sc1
    buffer_load_dwordx4 v[72:75], v7, s[8:11], s48 offen sc1
    buffer_load_dwordx2 v[76:77], v8, s[8:11], s50 offen sc1
    s_waitcnt vmcnt(0)
    v_max3_u32 v103, v68, v69, v70
    v_max3_u32 v103, v103, v71, v72
    v_max3_u32 v103, v103, v73, v74
    v_max3_u32 v103, v103, v75, v76
    v_max_u32 v103, v103, v77
    v_cmp_eq_u32 vcc, -1, v103
    s_cbranch_vccz interleave_layers__linear_attn_block__memory_aug_recurrent_mem_tr__prompt_kernel_v_pmw0_out
    s_mov_b32 s61, 0
interleave_layers__linear_attn_block__memory_aug_recurrent_mem_tr__prompt_kernel_v_pmw0:
    buffer_load_dwordx4 v[68:71], v7, s[8:11], s47 offen sc1
    buffer_load_dwordx4 v[72:75], v7, s[8:11], s48 offen sc1
    buffer_load_dwordx2 v[76:77], v8, s[8:11], s50 offen sc1
    s_waitcnt vmcnt(0)
    v_max3_u32 v103, v68, v69, v70
    v_max3_u32 v103, v103, v71, v72
    v_max3_u32 v103, v103, v73, v74
    v_max3_u32 v103, v103, v75, v76
    v_max_u32 v103, v103, v77
    v_cmp_eq_u32 vcc, -1, v103
    s_add_u32 s61, s61, 1
    s_cbranch_vccz interleave_layers__linear_attn_block__memory_aug_recurrent_mem_tr__prompt_kernel_v_pmw0_out
    s_cmp_ge_u32 s61, s60
    s_cbranch_scc1 interleave_layers__linear_attn_block__memory_aug_recurrent_mem_tr__prompt_kernel_v_pmw0_to
    s_sleep 1
    s_branch interleave_layers__linear_attn_block__memory_aug_recurrent_mem_tr__prompt_kernel_v_pmw0
interleave_layers__linear_attn_block__memory_aug_recurrent_mem_tr__prompt_kernel_v_pmw0_to:
    s_mov_b32 s60, 1
interleave_layers__linear_attn_block__memory_aug_recurrent_mem_tr__prompt_kernel_v_pmw0_out:
    ds_write_b128 v7, v[68:71]
    ds_write_b128 v7, v[72:75] offset:4096
    ds_write_b64 v8, v[76:77]
interleave_layers__linear_attn_block__memory_aug_recurrent_mem_tr__prompt_kernel_v_gow0:
    v_smfmac_f32_16x16x64_bf16 v[56:59], v[68:71], a[0:7], v4
    v_smfmac_f32_16x16x64_bf16 v[60:63], v[68:71], a[80:87], v4
    v_smfmac_f32_16x16x64_bf16 v[64:67], v[68:71], a[160:167], v4
    s_waitcnt lgkmcnt(0)
    s_barrier
    ds_read_b128 v[80:83], v5 offset:1024
    ds_read_b128 v[84:87], v5 offset:2048
    ds_read_b128 v[88:91], v5 offset:3072
    ds_read_b128 v[92:95], v5 offset:5120
    ds_read_b128 v[96:99], v5 offset:6144
    ds_read_b128 v[100:103], v5 offset:7168
    ds_read_b128 v[76:79], v5 offset:8192
    ds_read_b128 v[68:71], v5 offset:9216
    v_smfmac_f32_16x16x64_bf16 v[64:67], v[72:75], a[192:199], v4
    v_smfmac_f32_16x16x64_bf16 v[56:59], v[72:75], a[32:39], v4
    v_smfmac_f32_16x16x64_bf16 v[60:63], v[72:75], a[112:119], v4
    s_waitcnt lgkmcnt(7)
    v_smfmac_f32_16x16x64_bf16 v[64:67], v[80:83], a[168:175], v4
    s_waitcnt lgkmcnt(6)
    v_smfmac_f32_16x16x64_bf16 v[64:67], v[84:87], a[176:183], v4
    s_waitcnt lgkmcnt(5)
    v_smfmac_f32_16x16x64_bf16 v[64:67], v[88:91], a[184:191], v4
    s_waitcnt lgkmcnt(4)
    v_smfmac_f32_16x16x64_bf16 v[64:67], v[92:95], a[200:207], v4
    s_waitcnt lgkmcnt(3)
    v_smfmac_f32_16x16x64_bf16 v[64:67], v[96:99], a[208:215], v4
    s_waitcnt lgkmcnt(2)
    v_smfmac_f32_16x16x64_bf16 v[64:67], v[100:103], a[216:223], v4
    s_waitcnt lgkmcnt(1)
    v_smfmac_f32_16x16x64_bf16 v[64:67], v[76:79], a[224:231], v4
    s_waitcnt lgkmcnt(0)
    v_smfmac_f32_16x16x64_bf16 v[64:67], v[68:71], a[232:239], v4
    v_smfmac_f32_16x16x64_bf16 v[56:59], v[80:83], a[8:15], v4
    v_smfmac_f32_16x16x64_bf16 v[60:63], v[80:83], a[88:95], v4
    v_smfmac_f32_16x16x64_bf16 v[56:59], v[84:87], a[16:23], v4
    s_nop 4
    v_mov_b32 v72, v64
    v_smfmac_f32_16x16x64_bf16 v[60:63], v[84:87], a[96:103], v4
    v_mov_b32 v73, v65
    v_mov_b32 v74, v66
    v_smfmac_f32_16x16x64_bf16 v[56:59], v[88:91], a[24:31], v4
    v_mov_b32 v75, v67
    v_smfmac_f32_16x16x64_bf16 v[60:63], v[88:91], a[104:111], v4
    v_permlane32_swap_b32 v64, v72
    v_permlane32_swap_b32 v65, v73
    v_smfmac_f32_16x16x64_bf16 v[56:59], v[92:95], a[40:47], v4
    v_permlane32_swap_b32 v66, v74
    v_permlane32_swap_b32 v67, v75
    v_smfmac_f32_16x16x64_bf16 v[60:63], v[92:95], a[120:127], v4
    v_add_f32 v64, v64, v72
    v_add_f32 v65, v65, v73
    v_smfmac_f32_16x16x64_bf16 v[56:59], v[96:99], a[48:55], v4
    v_add_f32 v66, v66, v74
    v_add_f32 v67, v67, v75
    v_smfmac_f32_16x16x64_bf16 v[60:63], v[96:99], a[128:135], v4
    v_cvt_pk_bf16_f32 v72, v64, v65
    v_cvt_pk_bf16_f32 v73, v66, v67
    v_smfmac_f32_16x16x64_bf16 v[56:59], v[100:103], a[56:63], v4
    ds_write_b64 v9, v[72:73] offset:512
    v_smfmac_f32_16x16x64_bf16 v[60:63], v[100:103], a[136:143], v4
    v_smfmac_f32_16x16x64_bf16 v[56:59], v[76:79], a[64:71], v4
    v_smfmac_f32_16x16x64_bf16 v[60:63], v[76:79], a[144:151], v4
    v_smfmac_f32_16x16x64_bf16 v[56:59], v[68:71], a[72:79], v4
    v_smfmac_f32_16x16x64_bf16 v[60:63], v[68:71], a[152:159], v4
    s_nop 7
    v_permlane32_swap_b32 v56, v60
    v_permlane32_swap_b32 v57, v61
    v_permlane32_swap_b32 v58, v62
    v_permlane32_swap_b32 v59, v63
    v_add_f32 v56, v56, v60
    v_add_f32 v57, v57, v61
    v_add_f32 v58, v58, v62
    v_add_f32 v59, v59, v63
    v_cvt_pk_bf16_f32 v68, v56, v57
    v_cvt_pk_bf16_f32 v69, v58, v59
    ds_write_b64 v10, v[68:69]
    s_waitcnt lgkmcnt(0)
    s_barrier
    ds_read_b64_tr_b16 v[68:69], v11 offset:0
    ds_read_b64_tr_b16 v[70:71], v11 offset:128
    ds_read_b64_tr_b16 v[72:73], v11 offset:1024
    ds_read_b64_tr_b16 v[74:75], v11 offset:1152
    ds_read_b64_tr_b16 v[76:77], v11 offset:2048
    ds_read_b64_tr_b16 v[78:79], v11 offset:2176
    ds_read_b128 v[80:83], v6 offset:0
    ds_read_b128 v[84:87], v6 offset:1024
    ds_read_b128 v[88:91], v6 offset:2048
    ds_read_b128 v[92:95], v6 offset:3072
    ds_read_b128 v[96:99], v6 offset:4096
    ds_read_b128 v[100:103], v6 offset:5120
    s_waitcnt lgkmcnt(10)
    v_smfmac_f32_16x16x64_bf16 v[16:19], v[68:71], a[240:247], v4
    v_smfmac_f32_16x16x64_bf16 v[20:23], v[68:71], v[112:119], v4
    v_smfmac_f32_16x16x64_bf16 v[24:27], v[68:71], v[136:143], v4
    v_smfmac_f32_16x16x64_bf16 v[28:31], v[68:71], v[160:167], v4
    s_waitcnt lgkmcnt(8)
    v_smfmac_f32_16x16x64_bf16 v[16:19], v[72:75], a[248:255], v4
    v_smfmac_f32_16x16x64_bf16 v[20:23], v[72:75], v[120:127], v4
    v_smfmac_f32_16x16x64_bf16 v[24:27], v[72:75], v[144:151], v4
    v_smfmac_f32_16x16x64_bf16 v[28:31], v[72:75], v[168:175], v4
    s_waitcnt lgkmcnt(6)
    v_smfmac_f32_16x16x64_bf16 v[16:19], v[76:79], v[104:111], v4
    v_smfmac_f32_16x16x64_bf16 v[20:23], v[76:79], v[128:135], v4
    v_smfmac_f32_16x16x64_bf16 v[24:27], v[76:79], v[152:159], v4
    v_smfmac_f32_16x16x64_bf16 v[28:31], v[76:79], v[176:183], v4
    v_smfmac_f32_16x16x64_bf16 v[32:35], v[68:71], v[184:191], v4
    v_smfmac_f32_16x16x64_bf16 v[36:39], v[68:71], v[208:215], v4
    s_nop 4
    v_permlane32_swap_b32 v16, v24
    v_permlane32_swap_b32 v17, v25
    v_smfmac_f32_16x16x64_bf16 v[40:43], v[68:71], v[232:239], v4
    v_permlane32_swap_b32 v18, v26
    v_permlane32_swap_b32 v19, v27
    s_waitcnt lgkmcnt(4)
    v_smfmac_f32_16x16x64_bf16 v[44:47], v[68:71], v[80:87], v4
    v_add_f32 v16, v16, v24
    v_add_f32 v17, v17, v25
    ds_read_b128 v[80:83], v6 offset:6144
    ds_read_b128 v[84:87], v6 offset:7168
    v_smfmac_f32_16x16x64_bf16 v[32:35], v[72:75], v[192:199], v4
    v_add_f32 v18, v18, v26
    v_add_f32 v19, v19, v27
    v_smfmac_f32_16x16x64_bf16 v[36:39], v[72:75], v[216:223], v4
    v_permlane32_swap_b32 v20, v28
    v_permlane32_swap_b32 v21, v29
    v_smfmac_f32_16x16x64_bf16 v[40:43], v[72:75], v[240:247], v4
    v_permlane32_swap_b32 v22, v30
    v_permlane32_swap_b32 v23, v31
    s_waitcnt lgkmcnt(4)
    v_smfmac_f32_16x16x64_bf16 v[44:47], v[72:75], v[88:95], v4
    v_add_f32 v20, v20, v28
    v_add_f32 v21, v21, v29
    ds_read_b128 v[88:91], v6 offset:8192
    ds_read_b128 v[92:95], v6 offset:9216
    v_smfmac_f32_16x16x64_bf16 v[32:35], v[76:79], v[200:207], v4
    v_add_f32 v22, v22, v30
    v_add_f32 v23, v23, v31
    v_smfmac_f32_16x16x64_bf16 v[36:39], v[76:79], v[224:231], v4
    v_cvt_pk_bf16_f32 v56, v16, v17
    v_cvt_pk_bf16_f32 v57, v18, v19
    v_smfmac_f32_16x16x64_bf16 v[40:43], v[76:79], v[248:255], v4
    v_cvt_pk_bf16_f32 v58, v20, v21
    v_cvt_pk_bf16_f32 v59, v22, v23
    s_waitcnt lgkmcnt(4)
    v_smfmac_f32_16x16x64_bf16 v[44:47], v[76:79], v[96:103], v4
    v_permlane16_swap_b32 v56, v58
    ds_read_b128 v[96:99], v6 offset:10240
    ds_read_b128 v[100:103], v6 offset:11264
    v_permlane16_swap_b32 v57, v59
    v_min_u32 v56, -2, v56
    v_min_u32 v57, -2, v57
    v_min_u32 v58, -2, v58
    v_min_u32 v59, -2, v59
    buffer_store_dwordx4 v[56:59], v14, s[8:11], s43 offen sc1
    s_add_u32 s49, s43, 65536
    s_waitcnt lgkmcnt(4)
    v_smfmac_f32_16x16x64_bf16 v[48:51], v[68:71], v[80:87], v4
    v_permlane32_swap_b32 v32, v40
    v_permlane32_swap_b32 v33, v41
    v_permlane32_swap_b32 v34, v42
    ds_read_b128 v[80:83], v6 offset:12288
    ds_read_b128 v[84:87], v6 offset:13312
    s_waitcnt lgkmcnt(4)
    v_smfmac_f32_16x16x64_bf16 v[48:51], v[72:75], v[88:95], v4
    v_permlane32_swap_b32 v35, v43
    v_add_f32 v32, v32, v40
    v_add_f32 v33, v33, v41
    v_add_f32 v34, v34, v42
    ds_read_b128 v[88:91], v6 offset:14336
    ds_read_b128 v[92:95], v6 offset:15360
    s_waitcnt lgkmcnt(4)
    v_smfmac_f32_16x16x64_bf16 v[48:51], v[76:79], v[96:103], v4
    v_add_f32 v35, v35, v43
    v_permlane32_swap_b32 v36, v44
    v_permlane32_swap_b32 v37, v45
    v_permlane32_swap_b32 v38, v46
    ds_read_b128 v[96:99], v6 offset:16384
    ds_read_b128 v[100:103], v6 offset:17408
    v_permlane32_swap_b32 v39, v47
    v_add_f32 v36, v36, v44
    v_add_f32 v37, v37, v45
    v_add_f32 v38, v38, v46
    s_waitcnt lgkmcnt(4)
    v_smfmac_f32_16x16x64_bf16 v[52:55], v[68:71], v[80:87], v4
    v_add_f32 v39, v39, v47
    v_cvt_pk_bf16_f32 v60, v32, v33
    v_cvt_pk_bf16_f32 v61, v34, v35
    s_waitcnt lgkmcnt(2)
    v_smfmac_f32_16x16x64_bf16 v[52:55], v[72:75], v[88:95], v4
    v_cvt_pk_bf16_f32 v62, v36, v37
    v_cvt_pk_bf16_f32 v63, v38, v39
    s_waitcnt lgkmcnt(0)
    v_smfmac_f32_16x16x64_bf16 v[52:55], v[76:79], v[96:103], v4
    v_permlane16_swap_b32 v60, v62
    v_permlane16_swap_b32 v61, v63
    v_min_u32 v60, -2, v60
    v_min_u32 v61, -2, v61
    v_min_u32 v62, -2, v62
    v_min_u32 v63, -2, v63
    buffer_store_dwordx4 v[60:63], v14, s[8:11], s49 offen sc1
    s_nop 0
    v_permlane32_swap_b32 v48, v52
    v_permlane32_swap_b32 v49, v53
    v_permlane32_swap_b32 v50, v54
    v_permlane32_swap_b32 v51, v55
    v_add_f32 v48, v48, v52
    v_add_f32 v49, v49, v53
    v_add_f32 v50, v50, v54
    v_add_f32 v51, v51, v55
    v_cvt_pk_bf16_f32 v64, v48, v49
    v_cvt_pk_bf16_f32 v65, v50, v51
    v_mov_b32 v66, v64
    v_mov_b32 v67, v65
    s_nop 0
    v_permlane16_swap_b32 v64, v66
    v_permlane16_swap_b32 v65, v67
    v_min_u32 v64, -2, v64
    v_min_u32 v65, -2, v65
    v_min_u32 v66, -2, v66
    v_min_u32 v67, -2, v67
    buffer_store_dwordx4 v[64:67], v15, s[8:11], s43 offen sc1
    s_add_u32 s40, s40, 1
    s_add_u32 s47, s37, 704512
    s_add_u32 s45, s37, 737280
    s_lshl_b32 s24, s40, 12
    s_and_b32 s24, s24, 0x2000
    s_xor_b32 s24, s24, s36
    s_lshl_b32 s37, s40, 20
    s_add_u32 s37, s37, s24
    s_add_u32 s37, s37, 117440512
    s_add_u32 s43, s37, 0
    s_cmp_lt_u32 s40, 64
    s_cbranch_scc1 interleave_layers__linear_attn_block__memory_aug_recurrent_mem_tr__prompt_kernel_v_stepw0
    s_branch interleave_layers__linear_attn_block__memory_aug_recurrent_mem_tr__prompt_kernel_v_end
interleave_layers__linear_attn_block__memory_aug_recurrent_mem_tr__prompt_kernel_v_stepw1:
    v_mov_b32 v16, 0
    v_mov_b32 v17, 0
    v_mov_b32 v18, 0
    v_mov_b32 v19, 0
    v_mov_b32 v20, 0
    v_mov_b32 v21, 0
    v_mov_b32 v22, 0
    v_mov_b32 v23, 0
    v_mov_b32 v24, 0
    v_mov_b32 v25, 0
    v_mov_b32 v26, 0
    v_mov_b32 v27, 0
    v_mov_b32 v28, 0
    v_mov_b32 v29, 0
    v_mov_b32 v30, 0
    v_mov_b32 v31, 0
    v_mov_b32 v32, 0
    v_mov_b32 v33, 0
    v_mov_b32 v34, 0
    v_mov_b32 v35, 0
    v_mov_b32 v36, 0
    v_mov_b32 v37, 0
    v_mov_b32 v38, 0
    v_mov_b32 v39, 0
    v_mov_b32 v40, 0
    v_mov_b32 v41, 0
    v_mov_b32 v42, 0
    v_mov_b32 v43, 0
    v_mov_b32 v44, 0
    v_mov_b32 v45, 0
    v_mov_b32 v46, 0
    v_mov_b32 v47, 0
    v_mov_b32 v48, 0
    v_mov_b32 v49, 0
    v_mov_b32 v50, 0
    v_mov_b32 v51, 0
    v_mov_b32 v52, 0
    v_mov_b32 v53, 0
    v_mov_b32 v54, 0
    v_mov_b32 v55, 0
    v_mov_b32 v56, 0
    v_mov_b32 v57, 0
    v_mov_b32 v58, 0
    v_mov_b32 v59, 0
    v_mov_b32 v60, 0
    v_mov_b32 v61, 0
    v_mov_b32 v62, 0
    v_mov_b32 v63, 0
    v_mov_b32 v64, 0
    v_mov_b32 v65, 0
    v_mov_b32 v66, 0
    v_mov_b32 v67, 0
    s_add_u32 s48, s47, 4096
    s_add_u32 s50, s47, 8192
    s_lshl_b32 s95, s92, 6
    s_add_u32 s95, s95, s40
    s_add_u32 s95, s95, 1
    s_cmp_ge_i32 s59, s95
    s_cbranch_scc1 interleave_layers__linear_attn_block__memory_aug_recurrent_mem_tr__prompt_kernel_v_ecw1_ok
    s_and_b32 s24, s2, 7
    s_lshl_b32 s24, s24, 7
    s_add_u32 s24, s24, 23109632
    v_and_b32 v79, 3, v1
    v_lshl_add_u32 v79, v79, 2, s24
    s_mov_b32 s61, 0
interleave_layers__linear_attn_block__memory_aug_recurrent_mem_tr__prompt_kernel_v_ecw1:
    buffer_load_dword v78, v79, s[8:11], 0 offen sc1
    s_waitcnt vmcnt(0)
    v_readlane_b32 s59, v78, 0
    v_readlane_b32 s24, v78, 1
    s_min_i32 s59, s59, s24
    v_readlane_b32 s24, v78, 2
    s_min_i32 s59, s59, s24
    s_cmp_ge_i32 s59, s95
    s_cbranch_scc1 interleave_layers__linear_attn_block__memory_aug_recurrent_mem_tr__prompt_kernel_v_ecw1_ok
    s_add_u32 s61, s61, 1
    s_cmp_ge_u32 s61, s60
    s_cbranch_scc1 interleave_layers__linear_attn_block__memory_aug_recurrent_mem_tr__prompt_kernel_v_ecw1_to
    s_sleep 2
    s_branch interleave_layers__linear_attn_block__memory_aug_recurrent_mem_tr__prompt_kernel_v_ecw1
interleave_layers__linear_attn_block__memory_aug_recurrent_mem_tr__prompt_kernel_v_ecw1_to:
    s_mov_b32 s60, 1
interleave_layers__linear_attn_block__memory_aug_recurrent_mem_tr__prompt_kernel_v_ecw1_ok:
    s_sleep 20
    s_mov_b64 exec, 1
    s_mov_b32 s61, 0
    v_mov_b32 v81, 0
    buffer_atomic_add v81, v12, s[8:11], s45 offen sc0
    s_sleep 3
    v_mov_b32 v82, 0
    buffer_atomic_add v82, v12, s[8:11], s45 offen sc0
    s_sleep 3
    v_mov_b32 v83, 0
    buffer_atomic_add v83, v12, s[8:11], s45 offen sc0
    s_sleep 3
interleave_layers__linear_attn_block__memory_aug_recurrent_mem_tr__prompt_kernel_v_prw1:
    v_mov_b32 v80, 0
    buffer_atomic_add v80, v12, s[8:11], s45 offen sc0
    s_waitcnt vmcnt(3)
    v_cmp_le_i32 vcc, 8, v81
    s_add_u32 s61, s61, 1
    s_cbranch_vccnz interleave_layers__linear_attn_block__memory_aug_recurrent_mem_tr__prompt_kernel_v_prw1_out
    s_sleep 3
    v_mov_b32 v81, 0
    buffer_atomic_add v81, v12, s[8:11], s45 offen sc0
    s_waitcnt vmcnt(3)
    v_cmp_le_i32 vcc, 8, v82
    s_add_u32 s61, s61, 1
    s_cbranch_vccnz interleave_layers__linear_attn_block__memory_aug_recurrent_mem_tr__prompt_kernel_v_prw1_out
    s_sleep 3
    v_mov_b32 v82, 0
    buffer_atomic_add v82, v12, s[8:11], s45 offen sc0
    s_waitcnt vmcnt(3)
    v_cmp_le_i32 vcc, 8, v83
    s_add_u32 s61, s61, 1
    s_cbranch_vccnz interleave_layers__linear_attn_block__memory_aug_recurrent_mem_tr__prompt_kernel_v_prw1_out
    s_sleep 3
    v_mov_b32 v83, 0
    buffer_atomic_add v83, v12, s[8:11], s45 offen sc0
    s_waitcnt vmcnt(3)
    v_cmp_le_i32 vcc, 8, v80
    s_add_u32 s61, s61, 1
    s_cbranch_vccnz interleave_layers__linear_attn_block__memory_aug_recurrent_mem_tr__prompt_kernel_v_prw1_out
    s_sleep 3
    s_cmp_ge_u32 s61, s60
    s_cbranch_scc0 interleave_layers__linear_attn_block__memory_aug_recurrent_mem_tr__prompt_kernel_v_prw1
    s_mov_b32 s60, 1
interleave_layers__linear_attn_block__memory_aug_recurrent_mem_tr__prompt_kernel_v_prw1_out:
    s_mov_b64 exec, -1
    buffer_load_dwordx4 v[68:71], v7, s[8:11], s47 offen sc1
    buffer_load_dwordx4 v[72:75], v7, s[8:11], s48 offen sc1
    buffer_load_dwordx2 v[76:77], v8, s[8:11], s50 offen sc1
    s_waitcnt vmcnt(0)
    v_max3_u32 v103, v68, v69, v70
    v_max3_u32 v103, v103, v71, v72
    v_max3_u32 v103, v103, v73, v74
    v_max3_u32 v103, v103, v75, v76
    v_max_u32 v103, v103, v77
    v_cmp_eq_u32 vcc, -1, v103
    s_cbranch_vccz interleave_layers__linear_attn_block__memory_aug_recurrent_mem_tr__prompt_kernel_v_pmw1_out
    s_mov_b32 s61, 0
interleave_layers__linear_attn_block__memory_aug_recurrent_mem_tr__prompt_kernel_v_pmw1:
    buffer_load_dwordx4 v[68:71], v7, s[8:11], s47 offen sc1
    buffer_load_dwordx4 v[72:75], v7, s[8:11], s48 offen sc1
    buffer_load_dwordx2 v[76:77], v8, s[8:11], s50 offen sc1
    s_waitcnt vmcnt(0)
    v_max3_u32 v103, v68, v69, v70
    v_max3_u32 v103, v103, v71, v72
    v_max3_u32 v103, v103, v73, v74
    v_max3_u32 v103, v103, v75, v76
    v_max_u32 v103, v103, v77
    v_cmp_eq_u32 vcc, -1, v103
    s_add_u32 s61, s61, 1
    s_cbranch_vccz interleave_layers__linear_attn_block__memory_aug_recurrent_mem_tr__prompt_kernel_v_pmw1_out
    s_cmp_ge_u32 s61, s60
    s_cbranch_scc1 interleave_layers__linear_attn_block__memory_aug_recurrent_mem_tr__prompt_kernel_v_pmw1_to
    s_sleep 1
    s_branch interleave_layers__linear_attn_block__memory_aug_recurrent_mem_tr__prompt_kernel_v_pmw1
interleave_layers__linear_attn_block__memory_aug_recurrent_mem_tr__prompt_kernel_v_pmw1_to:
    s_mov_b32 s60, 1
interleave_layers__linear_attn_block__memory_aug_recurrent_mem_tr__prompt_kernel_v_pmw1_out:
    ds_write_b128 v7, v[68:71]
    ds_write_b128 v7, v[72:75] offset:4096
    ds_write_b64 v8, v[76:77]
interleave_layers__linear_attn_block__memory_aug_recurrent_mem_tr__prompt_kernel_v_gow1:
    v_smfmac_f32_16x16x64_bf16 v[56:59], v[68:71], a[8:15], v4
    v_smfmac_f32_16x16x64_bf16 v[60:63], v[68:71], a[88:95], v4
    v_smfmac_f32_16x16x64_bf16 v[64:67], v[68:71], a[168:175], v4
    s_waitcnt lgkmcnt(0)
    s_barrier
    ds_read_b128 v[80:83], v5 offset:0
    ds_read_b128 v[84:87], v5 offset:2048
    ds_read_b128 v[88:91], v5 offset:3072
    ds_read_b128 v[92:95], v5 offset:4096
    ds_read_b128 v[96:99], v5 offset:6144
    ds_read_b128 v[100:103], v5 offset:7168
    ds_read_b128 v[76:79], v5 offset:8192
    ds_read_b128 v[68:71], v5 offset:9216
    v_smfmac_f32_16x16x64_bf16 v[64:67], v[72:75], a[200:207], v4
    v_smfmac_f32_16x16x64_bf16 v[56:59], v[72:75], a[40:47], v4
    v_smfmac_f32_16x16x64_bf16 v[60:63], v[72:75], a[120:127], v4
    s_waitcnt lgkmcnt(7)
    v_smfmac_f32_16x16x64_bf16 v[64:67], v[80:83], a[160:167], v4
    s_waitcnt lgkmcnt(6)
    v_smfmac_f32_16x16x64_bf16 v[64:67], v[84:87], a[176:183], v4
    s_waitcnt lgkmcnt(5)
    v_smfmac_f32_16x16x64_bf16 v[64:67], v[88:91], a[184:191], v4
    s_waitcnt lgkmcnt(4)
    v_smfmac_f32_16x16x64_bf16 v[64:67], v[92:95], a[192:199], v4
    s_waitcnt lgkmcnt(3)
    v_smfmac_f32_16x16x64_bf16 v[64:67], v[96:99], a[208:215], v4
    s_waitcnt lgkmcnt(2)
    v_smfmac_f32_16x16x64_bf16 v[64:67], v[100:103], a[216:223], v4
    s_waitcnt lgkmcnt(1)
    v_smfmac_f32_16x16x64_bf16 v[64:67], v[76:79], a[224:231], v4
    s_waitcnt lgkmcnt(0)
    v_smfmac_f32_16x16x64_bf16 v[64:67], v[68:71], a[232:239], v4
    v_smfmac_f32_16x16x64_bf16 v[56:59], v[80:83], a[0:7], v4
    v_smfmac_f32_16x16x64_bf16 v[60:63], v[80:83], a[80:87], v4
    v_smfmac_f32_16x16x64_bf16 v[56:59], v[84:87], a[16:23], v4
    s_nop 4
    v_mov_b32 v72, v64
    v_smfmac_f32_16x16x64_bf16 v[60:63], v[84:87], a[96:103], v4
    v_mov_b32 v73, v65
    v_mov_b32 v74, v66
    v_smfmac_f32_16x16x64_bf16 v[56:59], v[88:91], a[24:31], v4
    v_mov_b32 v75, v67
    v_smfmac_f32_16x16x64_bf16 v[60:63], v[88:91], a[104:111], v4
    v_permlane32_swap_b32 v64, v72
    v_permlane32_swap_b32 v65, v73
    v_smfmac_f32_16x16x64_bf16 v[56:59], v[92:95], a[32:39], v4
    v_permlane32_swap_b32 v66, v74
    v_permlane32_swap_b32 v67, v75
    v_smfmac_f32_16x16x64_bf16 v[60:63], v[92:95], a[112:119], v4
    v_add_f32 v64, v64, v72
    v_add_f32 v65, v65, v73
    v_smfmac_f32_16x16x64_bf16 v[56:59], v[96:99], a[48:55], v4
    v_add_f32 v66, v66, v74
    v_add_f32 v67, v67, v75
    v_smfmac_f32_16x16x64_bf16 v[60:63], v[96:99], a[128:135], v4
    v_cvt_pk_bf16_f32 v72, v64, v65
    v_cvt_pk_bf16_f32 v73, v66, v67
    v_smfmac_f32_16x16x64_bf16 v[56:59], v[100:103], a[56:63], v4
    ds_write_b64 v9, v[72:73] offset:512
    v_smfmac_f32_16x16x64_bf16 v[60:63], v[100:103], a[136:143], v4
    v_smfmac_f32_16x16x64_bf16 v[56:59], v[76:79], a[64:71], v4
    v_smfmac_f32_16x16x64_bf16 v[60:63], v[76:79], a[144:151], v4
    v_smfmac_f32_16x16x64_bf16 v[56:59], v[68:71], a[72:79], v4
    v_smfmac_f32_16x16x64_bf16 v[60:63], v[68:71], a[152:159], v4
    s_nop 7
    v_permlane32_swap_b32 v56, v60
    v_permlane32_swap_b32 v57, v61
    v_permlane32_swap_b32 v58, v62
    v_permlane32_swap_b32 v59, v63
    v_add_f32 v56, v56, v60
    v_add_f32 v57, v57, v61
    v_add_f32 v58, v58, v62
    v_add_f32 v59, v59, v63
    v_cvt_pk_bf16_f32 v68, v56, v57
    v_cvt_pk_bf16_f32 v69, v58, v59
    ds_write_b64 v10, v[68:69]
    s_waitcnt lgkmcnt(0)
    s_barrier
    ds_read_b64_tr_b16 v[68:69], v11 offset:0
    ds_read_b64_tr_b16 v[70:71], v11 offset:128
    ds_read_b64_tr_b16 v[72:73], v11 offset:1024
    ds_read_b64_tr_b16 v[74:75], v11 offset:1152
    ds_read_b64_tr_b16 v[76:77], v11 offset:2048
    ds_read_b64_tr_b16 v[78:79], v11 offset:2176
    ds_read_b128 v[80:83], v6 offset:0
    ds_read_b128 v[84:87], v6 offset:1024
    ds_read_b128 v[88:91], v6 offset:2048
    ds_read_b128 v[92:95], v6 offset:3072
    ds_read_b128 v[96:99], v6 offset:4096
    ds_read_b128 v[100:103], v6 offset:5120
    s_waitcnt lgkmcnt(10)
    v_smfmac_f32_16x16x64_bf16 v[16:19], v[68:71], a[240:247], v4
    v_smfmac_f32_16x16x64_bf16 v[20:23], v[68:71], v[112:119], v4
    v_smfmac_f32_16x16x64_bf16 v[24:27], v[68:71], v[136:143], v4
    v_smfmac_f32_16x16x64_bf16 v[28:31], v[68:71], v[160:167], v4
    s_waitcnt lgkmcnt(8)
    v_smfmac_f32_16x16x64_bf16 v[16:19], v[72:75], a[248:255], v4
    v_smfmac_f32_16x16x64_bf16 v[20:23], v[72:75], v[120:127], v4
    v_smfmac_f32_16x16x64_bf16 v[24:27], v[72:75], v[144:151], v4
    v_smfmac_f32_16x16x64_bf16 v[28:31], v[72:75], v[168:175], v4
    s_waitcnt lgkmcnt(6)
    v_smfmac_f32_16x16x64_bf16 v[16:19], v[76:79], v[104:111], v4
    v_smfmac_f32_16x16x64_bf16 v[20:23], v[76:79], v[128:135], v4
    v_smfmac_f32_16x16x64_bf16 v[24:27], v[76:79], v[152:159], v4
    v_smfmac_f32_16x16x64_bf16 v[28:31], v[76:79], v[176:183], v4
    v_smfmac_f32_16x16x64_bf16 v[32:35], v[68:71], v[184:191], v4
    v_smfmac_f32_16x16x64_bf16 v[36:39], v[68:71], v[208:215], v4
    s_nop 4
    v_permlane32_swap_b32 v16, v24
    v_permlane32_swap_b32 v17, v25
    v_smfmac_f32_16x16x64_bf16 v[40:43], v[68:71], v[232:239], v4
    v_permlane32_swap_b32 v18, v26
    v_permlane32_swap_b32 v19, v27
    s_waitcnt lgkmcnt(4)
    v_smfmac_f32_16x16x64_bf16 v[44:47], v[68:71], v[80:87], v4
    v_add_f32 v16, v16, v24
    v_add_f32 v17, v17, v25
    ds_read_b128 v[80:83], v6 offset:6144
    ds_read_b128 v[84:87], v6 offset:7168
    v_smfmac_f32_16x16x64_bf16 v[32:35], v[72:75], v[192:199], v4
    v_add_f32 v18, v18, v26
    v_add_f32 v19, v19, v27
    v_smfmac_f32_16x16x64_bf16 v[36:39], v[72:75], v[216:223], v4
    v_permlane32_swap_b32 v20, v28
    v_permlane32_swap_b32 v21, v29
    v_smfmac_f32_16x16x64_bf16 v[40:43], v[72:75], v[240:247], v4
    v_permlane32_swap_b32 v22, v30
    v_permlane32_swap_b32 v23, v31
    s_waitcnt lgkmcnt(4)
    v_smfmac_f32_16x16x64_bf16 v[44:47], v[72:75], v[88:95], v4
    v_add_f32 v20, v20, v28
    v_add_f32 v21, v21, v29
    ds_read_b128 v[88:91], v6 offset:8192
    ds_read_b128 v[92:95], v6 offset:9216
    v_smfmac_f32_16x16x64_bf16 v[32:35], v[76:79], v[200:207], v4
    v_add_f32 v22, v22, v30
    v_add_f32 v23, v23, v31
    v_smfmac_f32_16x16x64_bf16 v[36:39], v[76:79], v[224:231], v4
    v_cvt_pk_bf16_f32 v56, v16, v17
    v_cvt_pk_bf16_f32 v57, v18, v19
    v_smfmac_f32_16x16x64_bf16 v[40:43], v[76:79], v[248:255], v4
    v_cvt_pk_bf16_f32 v58, v20, v21
    v_cvt_pk_bf16_f32 v59, v22, v23
    s_waitcnt lgkmcnt(4)
    v_smfmac_f32_16x16x64_bf16 v[44:47], v[76:79], v[96:103], v4
    v_permlane16_swap_b32 v56, v58
    ds_read_b128 v[96:99], v6 offset:10240
    ds_read_b128 v[100:103], v6 offset:11264
    v_permlane16_swap_b32 v57, v59
    v_min_u32 v56, -2, v56
    v_min_u32 v57, -2, v57
    v_min_u32 v58, -2, v58
    v_min_u32 v59, -2, v59
    buffer_store_dwordx4 v[56:59], v14, s[8:11], s43 offen sc1
    s_add_u32 s49, s43, 65536
    s_waitcnt lgkmcnt(4)
    v_smfmac_f32_16x16x64_bf16 v[48:51], v[68:71], v[80:87], v4
    v_permlane32_swap_b32 v32, v40
    v_permlane32_swap_b32 v33, v41
    v_permlane32_swap_b32 v34, v42
    ds_read_b128 v[80:83], v6 offset:12288
    ds_read_b128 v[84:87], v6 offset:13312
    s_waitcnt lgkmcnt(4)
    v_smfmac_f32_16x16x64_bf16 v[48:51], v[72:75], v[88:95], v4
    v_permlane32_swap_b32 v35, v43
    v_add_f32 v32, v32, v40
    v_add_f32 v33, v33, v41
    v_add_f32 v34, v34, v42
    ds_read_b128 v[88:91], v6 offset:14336
    ds_read_b128 v[92:95], v6 offset:15360
    s_waitcnt lgkmcnt(4)
    v_smfmac_f32_16x16x64_bf16 v[48:51], v[76:79], v[96:103], v4
    v_add_f32 v35, v35, v43
    v_permlane32_swap_b32 v36, v44
    v_permlane32_swap_b32 v37, v45
    v_permlane32_swap_b32 v38, v46
    ds_read_b128 v[96:99], v6 offset:16384
    ds_read_b128 v[100:103], v6 offset:17408
    v_permlane32_swap_b32 v39, v47
    v_add_f32 v36, v36, v44
    v_add_f32 v37, v37, v45
    v_add_f32 v38, v38, v46
    s_waitcnt lgkmcnt(4)
    v_smfmac_f32_16x16x64_bf16 v[52:55], v[68:71], v[80:87], v4
    v_add_f32 v39, v39, v47
    v_cvt_pk_bf16_f32 v60, v32, v33
    v_cvt_pk_bf16_f32 v61, v34, v35
    s_waitcnt lgkmcnt(2)
    v_smfmac_f32_16x16x64_bf16 v[52:55], v[72:75], v[88:95], v4
    v_cvt_pk_bf16_f32 v62, v36, v37
    v_cvt_pk_bf16_f32 v63, v38, v39
    s_waitcnt lgkmcnt(0)
    v_smfmac_f32_16x16x64_bf16 v[52:55], v[76:79], v[96:103], v4
    v_permlane16_swap_b32 v60, v62
    v_permlane16_swap_b32 v61, v63
    v_min_u32 v60, -2, v60
    v_min_u32 v61, -2, v61
    v_min_u32 v62, -2, v62
    v_min_u32 v63, -2, v63
    buffer_store_dwordx4 v[60:63], v14, s[8:11], s49 offen sc1
    s_nop 0
    v_permlane32_swap_b32 v48, v52
    v_permlane32_swap_b32 v49, v53
    v_permlane32_swap_b32 v50, v54
    v_permlane32_swap_b32 v51, v55
    v_add_f32 v48, v48, v52
    v_add_f32 v49, v49, v53
    v_add_f32 v50, v50, v54
    v_add_f32 v51, v51, v55
    v_cvt_pk_bf16_f32 v64, v48, v49
    v_cvt_pk_bf16_f32 v65, v50, v51
    v_mov_b32 v66, v64
    v_mov_b32 v67, v65
    s_nop 0
    v_permlane16_swap_b32 v64, v66
    v_permlane16_swap_b32 v65, v67
    v_min_u32 v64, -2, v64
    v_min_u32 v65, -2, v65
    v_min_u32 v66, -2, v66
    v_min_u32 v67, -2, v67
    buffer_store_dwordx4 v[64:67], v15, s[8:11], s43 offen sc1
    s_add_u32 s40, s40, 1
    s_add_u32 s47, s37, 704512
    s_add_u32 s45, s37, 737280
    s_lshl_b32 s24, s40, 12
    s_and_b32 s24, s24, 0x2000
    s_xor_b32 s24, s24, s36
    s_lshl_b32 s37, s40, 20
    s_add_u32 s37, s37, s24
    s_add_u32 s37, s37, 117440512
    s_add_u32 s43, s37, 0
    s_cmp_lt_u32 s40, 64
    s_cbranch_scc1 interleave_layers__linear_attn_block__memory_aug_recurrent_mem_tr__prompt_kernel_v_stepw1
    s_branch interleave_layers__linear_attn_block__memory_aug_recurrent_mem_tr__prompt_kernel_v_end
interleave_layers__linear_attn_block__memory_aug_recurrent_mem_tr__prompt_kernel_v_stepw2:
    v_mov_b32 v16, 0
    v_mov_b32 v17, 0
    v_mov_b32 v18, 0
    v_mov_b32 v19, 0
    v_mov_b32 v20, 0
    v_mov_b32 v21, 0
    v_mov_b32 v22, 0
    v_mov_b32 v23, 0
    v_mov_b32 v24, 0
    v_mov_b32 v25, 0
    v_mov_b32 v26, 0
    v_mov_b32 v27, 0
    v_mov_b32 v28, 0
    v_mov_b32 v29, 0
    v_mov_b32 v30, 0
    v_mov_b32 v31, 0
    v_mov_b32 v32, 0
    v_mov_b32 v33, 0
    v_mov_b32 v34, 0
    v_mov_b32 v35, 0
    v_mov_b32 v36, 0
    v_mov_b32 v37, 0
    v_mov_b32 v38, 0
    v_mov_b32 v39, 0
    v_mov_b32 v40, 0
    v_mov_b32 v41, 0
    v_mov_b32 v42, 0
    v_mov_b32 v43, 0
    v_mov_b32 v44, 0
    v_mov_b32 v45, 0
    v_mov_b32 v46, 0
    v_mov_b32 v47, 0
    v_mov_b32 v48, 0
    v_mov_b32 v49, 0
    v_mov_b32 v50, 0
    v_mov_b32 v51, 0
    v_mov_b32 v52, 0
    v_mov_b32 v53, 0
    v_mov_b32 v54, 0
    v_mov_b32 v55, 0
    v_mov_b32 v56, 0
    v_mov_b32 v57, 0
    v_mov_b32 v58, 0
    v_mov_b32 v59, 0
    v_mov_b32 v60, 0
    v_mov_b32 v61, 0
    v_mov_b32 v62, 0
    v_mov_b32 v63, 0
    v_mov_b32 v64, 0
    v_mov_b32 v65, 0
    v_mov_b32 v66, 0
    v_mov_b32 v67, 0
    s_add_u32 s48, s47, 4096
    s_add_u32 s50, s47, 8192
    s_lshl_b32 s95, s92, 6
    s_add_u32 s95, s95, s40
    s_add_u32 s95, s95, 1
    s_cmp_ge_i32 s59, s95
    s_cbranch_scc1 interleave_layers__linear_attn_block__memory_aug_recurrent_mem_tr__prompt_kernel_v_ecw2_ok
    s_and_b32 s24, s2, 7
    s_lshl_b32 s24, s24, 7
    s_add_u32 s24, s24, 23109632
    v_and_b32 v79, 3, v1
    v_lshl_add_u32 v79, v79, 2, s24
    s_mov_b32 s61, 0
interleave_layers__linear_attn_block__memory_aug_recurrent_mem_tr__prompt_kernel_v_ecw2:
    buffer_load_dword v78, v79, s[8:11], 0 offen sc1
    s_waitcnt vmcnt(0)
    v_readlane_b32 s59, v78, 0
    v_readlane_b32 s24, v78, 1
    s_min_i32 s59, s59, s24
    v_readlane_b32 s24, v78, 2
    s_min_i32 s59, s59, s24
    s_cmp_ge_i32 s59, s95
    s_cbranch_scc1 interleave_layers__linear_attn_block__memory_aug_recurrent_mem_tr__prompt_kernel_v_ecw2_ok
    s_add_u32 s61, s61, 1
    s_cmp_ge_u32 s61, s60
    s_cbranch_scc1 interleave_layers__linear_attn_block__memory_aug_recurrent_mem_tr__prompt_kernel_v_ecw2_to
    s_sleep 2
    s_branch interleave_layers__linear_attn_block__memory_aug_recurrent_mem_tr__prompt_kernel_v_ecw2
interleave_layers__linear_attn_block__memory_aug_recurrent_mem_tr__prompt_kernel_v_ecw2_to:
    s_mov_b32 s60, 1
interleave_layers__linear_attn_block__memory_aug_recurrent_mem_tr__prompt_kernel_v_ecw2_ok:
    s_sleep 20
    s_mov_b64 exec, 1
    s_mov_b32 s61, 0
    v_mov_b32 v81, 0
    buffer_atomic_add v81, v12, s[8:11], s45 offen sc0
    s_sleep 3
    v_mov_b32 v82, 0
    buffer_atomic_add v82, v12, s[8:11], s45 offen sc0
    s_sleep 3
    v_mov_b32 v83, 0
    buffer_atomic_add v83, v12, s[8:11], s45 offen sc0
    s_sleep 3
interleave_layers__linear_attn_block__memory_aug_recurrent_mem_tr__prompt_kernel_v_prw2:
    v_mov_b32 v80, 0
    buffer_atomic_add v80, v12, s[8:11], s45 offen sc0
    s_waitcnt vmcnt(3)
    v_cmp_le_i32 vcc, 8, v81
    s_add_u32 s61, s61, 1
    s_cbranch_vccnz interleave_layers__linear_attn_block__memory_aug_recurrent_mem_tr__prompt_kernel_v_prw2_out
    s_sleep 3
    v_mov_b32 v81, 0
    buffer_atomic_add v81, v12, s[8:11], s45 offen sc0
    s_waitcnt vmcnt(3)
    v_cmp_le_i32 vcc, 8, v82
    s_add_u32 s61, s61, 1
    s_cbranch_vccnz interleave_layers__linear_attn_block__memory_aug_recurrent_mem_tr__prompt_kernel_v_prw2_out
    s_sleep 3
    v_mov_b32 v82, 0
    buffer_atomic_add v82, v12, s[8:11], s45 offen sc0
    s_waitcnt vmcnt(3)
    v_cmp_le_i32 vcc, 8, v83
    s_add_u32 s61, s61, 1
    s_cbranch_vccnz interleave_layers__linear_attn_block__memory_aug_recurrent_mem_tr__prompt_kernel_v_prw2_out
    s_sleep 3
    v_mov_b32 v83, 0
    buffer_atomic_add v83, v12, s[8:11], s45 offen sc0
    s_waitcnt vmcnt(3)
    v_cmp_le_i32 vcc, 8, v80
    s_add_u32 s61, s61, 1
    s_cbranch_vccnz interleave_layers__linear_attn_block__memory_aug_recurrent_mem_tr__prompt_kernel_v_prw2_out
    s_sleep 3
    s_cmp_ge_u32 s61, s60
    s_cbranch_scc0 interleave_layers__linear_attn_block__memory_aug_recurrent_mem_tr__prompt_kernel_v_prw2
    s_mov_b32 s60, 1
interleave_layers__linear_attn_block__memory_aug_recurrent_mem_tr__prompt_kernel_v_prw2_out:
    s_mov_b64 exec, -1
    buffer_load_dwordx4 v[68:71], v7, s[8:11], s47 offen sc1
    buffer_load_dwordx4 v[72:75], v7, s[8:11], s48 offen sc1
    buffer_load_dwordx2 v[76:77], v8, s[8:11], s50 offen sc1
    s_waitcnt vmcnt(0)
    v_max3_u32 v103, v68, v69, v70
    v_max3_u32 v103, v103, v71, v72
    v_max3_u32 v103, v103, v73, v74
    v_max3_u32 v103, v103, v75, v76
    v_max_u32 v103, v103, v77
    v_cmp_eq_u32 vcc, -1, v103
    s_cbranch_vccz interleave_layers__linear_attn_block__memory_aug_recurrent_mem_tr__prompt_kernel_v_pmw2_out
    s_mov_b32 s61, 0
interleave_layers__linear_attn_block__memory_aug_recurrent_mem_tr__prompt_kernel_v_pmw2:
    buffer_load_dwordx4 v[68:71], v7, s[8:11], s47 offen sc1
    buffer_load_dwordx4 v[72:75], v7, s[8:11], s48 offen sc1
    buffer_load_dwordx2 v[76:77], v8, s[8:11], s50 offen sc1
    s_waitcnt vmcnt(0)
    v_max3_u32 v103, v68, v69, v70
    v_max3_u32 v103, v103, v71, v72
    v_max3_u32 v103, v103, v73, v74
    v_max3_u32 v103, v103, v75, v76
    v_max_u32 v103, v103, v77
    v_cmp_eq_u32 vcc, -1, v103
    s_add_u32 s61, s61, 1
    s_cbranch_vccz interleave_layers__linear_attn_block__memory_aug_recurrent_mem_tr__prompt_kernel_v_pmw2_out
    s_cmp_ge_u32 s61, s60
    s_cbranch_scc1 interleave_layers__linear_attn_block__memory_aug_recurrent_mem_tr__prompt_kernel_v_pmw2_to
    s_sleep 1
    s_branch interleave_layers__linear_attn_block__memory_aug_recurrent_mem_tr__prompt_kernel_v_pmw2
interleave_layers__linear_attn_block__memory_aug_recurrent_mem_tr__prompt_kernel_v_pmw2_to:
    s_mov_b32 s60, 1
interleave_layers__linear_attn_block__memory_aug_recurrent_mem_tr__prompt_kernel_v_pmw2_out:
    ds_write_b128 v7, v[68:71]
    ds_write_b128 v7, v[72:75] offset:4096
    ds_write_b64 v8, v[76:77]
interleave_layers__linear_attn_block__memory_aug_recurrent_mem_tr__prompt_kernel_v_gow2:
    v_smfmac_f32_16x16x64_bf16 v[56:59], v[68:71], a[16:23], v4
    v_smfmac_f32_16x16x64_bf16 v[60:63], v[68:71], a[96:103], v4
    v_smfmac_f32_16x16x64_bf16 v[64:67], v[68:71], a[176:183], v4
    s_waitcnt lgkmcnt(0)
    s_barrier
    ds_read_b128 v[80:83], v5 offset:0
    ds_read_b128 v[84:87], v5 offset:1024
    ds_read_b128 v[88:91], v5 offset:3072
    ds_read_b128 v[92:95], v5 offset:4096
    ds_read_b128 v[96:99], v5 offset:5120
    ds_read_b128 v[100:103], v5 offset:7168
    ds_read_b128 v[76:79], v5 offset:8192
    ds_read_b128 v[68:71], v5 offset:9216
    v_smfmac_f32_16x16x64_bf16 v[64:67], v[72:75], a[208:215], v4
    v_smfmac_f32_16x16x64_bf16 v[56:59], v[72:75], a[48:55], v4
    v_smfmac_f32_16x16x64_bf16 v[60:63], v[72:75], a[128:135], v4
    s_waitcnt lgkmcnt(7)
    v_smfmac_f32_16x16x64_bf16 v[64:67], v[80:83], a[160:167], v4
    s_waitcnt lgkmcnt(6)
    v_smfmac_f32_16x16x64_bf16 v[64:67], v[84:87], a[168:175], v4
    s_waitcnt lgkmcnt(5)
    v_smfmac_f32_16x16x64_bf16 v[64:67], v[88:91], a[184:191], v4
    s_waitcnt lgkmcnt(4)
    v_smfmac_f32_16x16x64_bf16 v[64:67], v[92:95], a[192:199], v4
    s_waitcnt lgkmcnt(3)
    v_smfmac_f32_16x16x64_bf16 v[64:67], v[96:99], a[200:207], v4
    s_waitcnt lgkmcnt(2)
    v_smfmac_f32_16x16x64_bf16 v[64:67], v[100:103], a[216:223], v4
    s_waitcnt lgkmcnt(1)
    v_smfmac_f32_16x16x64_bf16 v[64:67], v[76:79], a[224:231], v4
    s_waitcnt lgkmcnt(0)
    v_smfmac_f32_16x16x64_bf16 v[64:67], v[68:71], a[232:239], v4
    v_smfmac_f32_16x16x64_bf16 v[56:59], v[80:83], a[0:7], v4
    v_smfmac_f32_16x16x64_bf16 v[60:63], v[80:83], a[80:87], v4
    v_smfmac_f32_16x16x64_bf16 v[56:59], v[84:87], a[8:15], v4
    s_nop 4
    v_mov_b32 v72, v64
    v_smfmac_f32_16x16x64_bf16 v[60:63], v[84:87], a[88:95], v4
    v_mov_b32 v73, v65
    v_mov_b32 v74, v66
    v_smfmac_f32_16x16x64_bf16 v[56:59], v[88:91], a[24:31], v4
    v_mov_b32 v75, v67
    v_smfmac_f32_16x16x64_bf16 v[60:63], v[88:91], a[104:111], v4
    v_permlane32_swap_b32 v64, v72
    v_permlane32_swap_b32 v65, v73
    v_smfmac_f32_16x16x64_bf16 v[56:59], v[92:95], a[32:39], v4
    v_permlane32_swap_b32 v66, v74
    v_permlane32_swap_b32 v67, v75
    v_smfmac_f32_16x16x64_bf16 v[60:63], v[92:95], a[112:119], v4
    v_add_f32 v64, v64, v72
    v_add_f32 v65, v65, v73
    v_smfmac_f32_16x16x64_bf16 v[56:59], v[96:99], a[40:47], v4
    v_add_f32 v66, v66, v74
    v_add_f32 v67, v67, v75
    v_smfmac_f32_16x16x64_bf16 v[60:63], v[96:99], a[120:127], v4
    v_cvt_pk_bf16_f32 v72, v64, v65
    v_cvt_pk_bf16_f32 v73, v66, v67
    v_smfmac_f32_16x16x64_bf16 v[56:59], v[100:103], a[56:63], v4
    ds_write_b64 v9, v[72:73] offset:512
    v_smfmac_f32_16x16x64_bf16 v[60:63], v[100:103], a[136:143], v4
    v_smfmac_f32_16x16x64_bf16 v[56:59], v[76:79], a[64:71], v4
    v_smfmac_f32_16x16x64_bf16 v[60:63], v[76:79], a[144:151], v4
    v_smfmac_f32_16x16x64_bf16 v[56:59], v[68:71], a[72:79], v4
    v_smfmac_f32_16x16x64_bf16 v[60:63], v[68:71], a[152:159], v4
    s_nop 7
    v_permlane32_swap_b32 v56, v60
    v_permlane32_swap_b32 v57, v61
    v_permlane32_swap_b32 v58, v62
    v_permlane32_swap_b32 v59, v63
    v_add_f32 v56, v56, v60
    v_add_f32 v57, v57, v61
    v_add_f32 v58, v58, v62
    v_add_f32 v59, v59, v63
    v_cvt_pk_bf16_f32 v68, v56, v57
    v_cvt_pk_bf16_f32 v69, v58, v59
    ds_write_b64 v10, v[68:69]
    s_waitcnt lgkmcnt(0)
    s_barrier
    ds_read_b64_tr_b16 v[68:69], v11 offset:0
    ds_read_b64_tr_b16 v[70:71], v11 offset:128
    ds_read_b64_tr_b16 v[72:73], v11 offset:1024
    ds_read_b64_tr_b16 v[74:75], v11 offset:1152
    ds_read_b64_tr_b16 v[76:77], v11 offset:2048
    ds_read_b64_tr_b16 v[78:79], v11 offset:2176
    ds_read_b128 v[80:83], v6 offset:0
    ds_read_b128 v[84:87], v6 offset:1024
    ds_read_b128 v[88:91], v6 offset:2048
    ds_read_b128 v[92:95], v6 offset:3072
    ds_read_b128 v[96:99], v6 offset:4096
    ds_read_b128 v[100:103], v6 offset:5120
    s_waitcnt lgkmcnt(10)
    v_smfmac_f32_16x16x64_bf16 v[16:19], v[68:71], a[240:247], v4
    v_smfmac_f32_16x16x64_bf16 v[20:23], v[68:71], v[112:119], v4
    v_smfmac_f32_16x16x64_bf16 v[24:27], v[68:71], v[136:143], v4
    v_smfmac_f32_16x16x64_bf16 v[28:31], v[68:71], v[160:167], v4
    s_waitcnt lgkmcnt(8)
    v_smfmac_f32_16x16x64_bf16 v[16:19], v[72:75], a[248:255], v4
    v_smfmac_f32_16x16x64_bf16 v[20:23], v[72:75], v[120:127], v4
    v_smfmac_f32_16x16x64_bf16 v[24:27], v[72:75], v[144:151], v4
    v_smfmac_f32_16x16x64_bf16 v[28:31], v[72:75], v[168:175], v4
    s_waitcnt lgkmcnt(6)
    v_smfmac_f32_16x16x64_bf16 v[16:19], v[76:79], v[104:111], v4
    v_smfmac_f32_16x16x64_bf16 v[20:23], v[76:79], v[128:135], v4
    v_smfmac_f32_16x16x64_bf16 v[24:27], v[76:79], v[152:159], v4
    v_smfmac_f32_16x16x64_bf16 v[28:31], v[76:79], v[176:183], v4
    v_smfmac_f32_16x16x64_bf16 v[32:35], v[68:71], v[184:191], v4
    v_smfmac_f32_16x16x64_bf16 v[36:39], v[68:71], v[208:215], v4
    s_nop 4
    v_permlane32_swap_b32 v16, v24
    v_permlane32_swap_b32 v17, v25
    v_smfmac_f32_16x16x64_bf16 v[40:43], v[68:71], v[232:239], v4
    v_permlane32_swap_b32 v18, v26
    v_permlane32_swap_b32 v19, v27
    s_waitcnt lgkmcnt(4)
    v_smfmac_f32_16x16x64_bf16 v[44:47], v[68:71], v[80:87], v4
    v_add_f32 v16, v16, v24
    v_add_f32 v17, v17, v25
    ds_read_b128 v[80:83], v6 offset:6144
    ds_read_b128 v[84:87], v6 offset:7168
    v_smfmac_f32_16x16x64_bf16 v[32:35], v[72:75], v[192:199], v4
    v_add_f32 v18, v18, v26
    v_add_f32 v19, v19, v27
    v_smfmac_f32_16x16x64_bf16 v[36:39], v[72:75], v[216:223], v4
    v_permlane32_swap_b32 v20, v28
    v_permlane32_swap_b32 v21, v29
    v_smfmac_f32_16x16x64_bf16 v[40:43], v[72:75], v[240:247], v4
    v_permlane32_swap_b32 v22, v30
    v_permlane32_swap_b32 v23, v31
    s_waitcnt lgkmcnt(4)
    v_smfmac_f32_16x16x64_bf16 v[44:47], v[72:75], v[88:95], v4
    v_add_f32 v20, v20, v28
    v_add_f32 v21, v21, v29
    ds_read_b128 v[88:91], v6 offset:8192
    ds_read_b128 v[92:95], v6 offset:9216
    v_smfmac_f32_16x16x64_bf16 v[32:35], v[76:79], v[200:207], v4
    v_add_f32 v22, v22, v30
    v_add_f32 v23, v23, v31
    v_smfmac_f32_16x16x64_bf16 v[36:39], v[76:79], v[224:231], v4
    v_cvt_pk_bf16_f32 v56, v16, v17
    v_cvt_pk_bf16_f32 v57, v18, v19
    v_smfmac_f32_16x16x64_bf16 v[40:43], v[76:79], v[248:255], v4
    v_cvt_pk_bf16_f32 v58, v20, v21
    v_cvt_pk_bf16_f32 v59, v22, v23
    s_waitcnt lgkmcnt(4)
    v_smfmac_f32_16x16x64_bf16 v[44:47], v[76:79], v[96:103], v4
    v_permlane16_swap_b32 v56, v58
    ds_read_b128 v[96:99], v6 offset:10240
    ds_read_b128 v[100:103], v6 offset:11264
    v_permlane16_swap_b32 v57, v59
    v_min_u32 v56, -2, v56
    v_min_u32 v57, -2, v57
    v_min_u32 v58, -2, v58
    v_min_u32 v59, -2, v59
    buffer_store_dwordx4 v[56:59], v14, s[8:11], s43 offen sc1
    s_add_u32 s49, s43, 65536
    s_waitcnt lgkmcnt(4)
    v_smfmac_f32_16x16x64_bf16 v[48:51], v[68:71], v[80:87], v4
    v_permlane32_swap_b32 v32, v40
    v_permlane32_swap_b32 v33, v41
    v_permlane32_swap_b32 v34, v42
    ds_read_b128 v[80:83], v6 offset:12288
    ds_read_b128 v[84:87], v6 offset:13312
    s_waitcnt lgkmcnt(4)
    v_smfmac_f32_16x16x64_bf16 v[48:51], v[72:75], v[88:95], v4
    v_permlane32_swap_b32 v35, v43
    v_add_f32 v32, v32, v40
    v_add_f32 v33, v33, v41
    v_add_f32 v34, v34, v42
    ds_read_b128 v[88:91], v6 offset:14336
    ds_read_b128 v[92:95], v6 offset:15360
    s_waitcnt lgkmcnt(4)
    v_smfmac_f32_16x16x64_bf16 v[48:51], v[76:79], v[96:103], v4
    v_add_f32 v35, v35, v43
    v_permlane32_swap_b32 v36, v44
    v_permlane32_swap_b32 v37, v45
    v_permlane32_swap_b32 v38, v46
    ds_read_b128 v[96:99], v6 offset:16384
    ds_read_b128 v[100:103], v6 offset:17408
    v_permlane32_swap_b32 v39, v47
    v_add_f32 v36, v36, v44
    v_add_f32 v37, v37, v45
    v_add_f32 v38, v38, v46
    s_waitcnt lgkmcnt(4)
    v_smfmac_f32_16x16x64_bf16 v[52:55], v[68:71], v[80:87], v4
    v_add_f32 v39, v39, v47
    v_cvt_pk_bf16_f32 v60, v32, v33
    v_cvt_pk_bf16_f32 v61, v34, v35
    s_waitcnt lgkmcnt(2)
    v_smfmac_f32_16x16x64_bf16 v[52:55], v[72:75], v[88:95], v4
    v_cvt_pk_bf16_f32 v62, v36, v37
    v_cvt_pk_bf16_f32 v63, v38, v39
    s_waitcnt lgkmcnt(0)
    v_smfmac_f32_16x16x64_bf16 v[52:55], v[76:79], v[96:103], v4
    v_permlane16_swap_b32 v60, v62
    v_permlane16_swap_b32 v61, v63
    v_min_u32 v60, -2, v60
    v_min_u32 v61, -2, v61
    v_min_u32 v62, -2, v62
    v_min_u32 v63, -2, v63
    buffer_store_dwordx4 v[60:63], v14, s[8:11], s49 offen sc1
    s_nop 0
    v_permlane32_swap_b32 v48, v52
    v_permlane32_swap_b32 v49, v53
    v_permlane32_swap_b32 v50, v54
    v_permlane32_swap_b32 v51, v55
    v_add_f32 v48, v48, v52
    v_add_f32 v49, v49, v53
    v_add_f32 v50, v50, v54
    v_add_f32 v51, v51, v55
    v_cvt_pk_bf16_f32 v64, v48, v49
    v_cvt_pk_bf16_f32 v65, v50, v51
    v_mov_b32 v66, v64
    v_mov_b32 v67, v65
    s_nop 0
    v_permlane16_swap_b32 v64, v66
    v_permlane16_swap_b32 v65, v67
    v_min_u32 v64, -2, v64
    v_min_u32 v65, -2, v65
    v_min_u32 v66, -2, v66
    v_min_u32 v67, -2, v67
    buffer_store_dwordx4 v[64:67], v15, s[8:11], s43 offen sc1
    s_add_u32 s40, s40, 1
    s_add_u32 s47, s37, 704512
    s_add_u32 s45, s37, 737280
    s_lshl_b32 s24, s40, 12
    s_and_b32 s24, s24, 0x2000
    s_xor_b32 s24, s24, s36
    s_lshl_b32 s37, s40, 20
    s_add_u32 s37, s37, s24
    s_add_u32 s37, s37, 117440512
    s_add_u32 s43, s37, 0
    s_cmp_lt_u32 s40, 64
    s_cbranch_scc1 interleave_layers__linear_attn_block__memory_aug_recurrent_mem_tr__prompt_kernel_v_stepw2
    s_branch interleave_layers__linear_attn_block__memory_aug_recurrent_mem_tr__prompt_kernel_v_end
interleave_layers__linear_attn_block__memory_aug_recurrent_mem_tr__prompt_kernel_v_stepw3:
    v_mov_b32 v16, 0
    v_mov_b32 v17, 0
    v_mov_b32 v18, 0
    v_mov_b32 v19, 0
    v_mov_b32 v20, 0
    v_mov_b32 v21, 0
    v_mov_b32 v22, 0
    v_mov_b32 v23, 0
    v_mov_b32 v24, 0
    v_mov_b32 v25, 0
    v_mov_b32 v26, 0
    v_mov_b32 v27, 0
    v_mov_b32 v28, 0
    v_mov_b32 v29, 0
    v_mov_b32 v30, 0
    v_mov_b32 v31, 0
    v_mov_b32 v32, 0
    v_mov_b32 v33, 0
    v_mov_b32 v34, 0
    v_mov_b32 v35, 0
    v_mov_b32 v36, 0
    v_mov_b32 v37, 0
    v_mov_b32 v38, 0
    v_mov_b32 v39, 0
    v_mov_b32 v40, 0
    v_mov_b32 v41, 0
    v_mov_b32 v42, 0
    v_mov_b32 v43, 0
    v_mov_b32 v44, 0
    v_mov_b32 v45, 0
    v_mov_b32 v46, 0
    v_mov_b32 v47, 0
    v_mov_b32 v48, 0
    v_mov_b32 v49, 0
    v_mov_b32 v50, 0
    v_mov_b32 v51, 0
    v_mov_b32 v52, 0
    v_mov_b32 v53, 0
    v_mov_b32 v54, 0
    v_mov_b32 v55, 0
    v_mov_b32 v56, 0
    v_mov_b32 v57, 0
    v_mov_b32 v58, 0
    v_mov_b32 v59, 0
    v_mov_b32 v60, 0
    v_mov_b32 v61, 0
    v_mov_b32 v62, 0
    v_mov_b32 v63, 0
    v_mov_b32 v64, 0
    v_mov_b32 v65, 0
    v_mov_b32 v66, 0
    v_mov_b32 v67, 0
    s_add_u32 s48, s47, 4096
    s_add_u32 s50, s47, 8192
    s_lshl_b32 s95, s92, 6
    s_add_u32 s95, s95, s40
    s_add_u32 s95, s95, 1
    s_cmp_ge_i32 s59, s95
    s_cbranch_scc1 interleave_layers__linear_attn_block__memory_aug_recurrent_mem_tr__prompt_kernel_v_ecw3_ok
    s_and_b32 s24, s2, 7
    s_lshl_b32 s24, s24, 7
    s_add_u32 s24, s24, 23109632
    v_and_b32 v79, 3, v1
    v_lshl_add_u32 v79, v79, 2, s24
    s_mov_b32 s61, 0
interleave_layers__linear_attn_block__memory_aug_recurrent_mem_tr__prompt_kernel_v_ecw3:
    buffer_load_dword v78, v79, s[8:11], 0 offen sc1
    s_waitcnt vmcnt(0)
    v_readlane_b32 s59, v78, 0
    v_readlane_b32 s24, v78, 1
    s_min_i32 s59, s59, s24
    v_readlane_b32 s24, v78, 2
    s_min_i32 s59, s59, s24
    s_cmp_ge_i32 s59, s95
    s_cbranch_scc1 interleave_layers__linear_attn_block__memory_aug_recurrent_mem_tr__prompt_kernel_v_ecw3_ok
    s_add_u32 s61, s61, 1
    s_cmp_ge_u32 s61, s60
    s_cbranch_scc1 interleave_layers__linear_attn_block__memory_aug_recurrent_mem_tr__prompt_kernel_v_ecw3_to
    s_sleep 2
    s_branch interleave_layers__linear_attn_block__memory_aug_recurrent_mem_tr__prompt_kernel_v_ecw3
interleave_layers__linear_attn_block__memory_aug_recurrent_mem_tr__prompt_kernel_v_ecw3_to:
    s_mov_b32 s60, 1
interleave_layers__linear_attn_block__memory_aug_recurrent_mem_tr__prompt_kernel_v_ecw3_ok:
    s_sleep 20
    s_mov_b64 exec, 1
    s_mov_b32 s61, 0
    v_mov_b32 v81, 0
    buffer_atomic_add v81, v12, s[8:11], s45 offen sc0
    s_sleep 3
    v_mov_b32 v82, 0
    buffer_atomic_add v82, v12, s[8:11], s45 offen sc0
    s_sleep 3
    v_mov_b32 v83, 0
    buffer_atomic_add v83, v12, s[8:11], s45 offen sc0
    s_sleep 3
interleave_layers__linear_attn_block__memory_aug_recurrent_mem_tr__prompt_kernel_v_prw3:
    v_mov_b32 v80, 0
    buffer_atomic_add v80, v12, s[8:11], s45 offen sc0
    s_waitcnt vmcnt(3)
    v_cmp_le_i32 vcc, 8, v81
    s_add_u32 s61, s61, 1
    s_cbranch_vccnz interleave_layers__linear_attn_block__memory_aug_recurrent_mem_tr__prompt_kernel_v_prw3_out
    s_sleep 3
    v_mov_b32 v81, 0
    buffer_atomic_add v81, v12, s[8:11], s45 offen sc0
    s_waitcnt vmcnt(3)
    v_cmp_le_i32 vcc, 8, v82
    s_add_u32 s61, s61, 1
    s_cbranch_vccnz interleave_layers__linear_attn_block__memory_aug_recurrent_mem_tr__prompt_kernel_v_prw3_out
    s_sleep 3
    v_mov_b32 v82, 0
    buffer_atomic_add v82, v12, s[8:11], s45 offen sc0
    s_waitcnt vmcnt(3)
    v_cmp_le_i32 vcc, 8, v83
    s_add_u32 s61, s61, 1
    s_cbranch_vccnz interleave_layers__linear_attn_block__memory_aug_recurrent_mem_tr__prompt_kernel_v_prw3_out
    s_sleep 3
    v_mov_b32 v83, 0
    buffer_atomic_add v83, v12, s[8:11], s45 offen sc0
    s_waitcnt vmcnt(3)
    v_cmp_le_i32 vcc, 8, v80
    s_add_u32 s61, s61, 1
    s_cbranch_vccnz interleave_layers__linear_attn_block__memory_aug_recurrent_mem_tr__prompt_kernel_v_prw3_out
    s_sleep 3
    s_cmp_ge_u32 s61, s60
    s_cbranch_scc0 interleave_layers__linear_attn_block__memory_aug_recurrent_mem_tr__prompt_kernel_v_prw3
    s_mov_b32 s60, 1
interleave_layers__linear_attn_block__memory_aug_recurrent_mem_tr__prompt_kernel_v_prw3_out:
    s_mov_b64 exec, -1
    buffer_load_dwordx4 v[68:71], v7, s[8:11], s47 offen sc1
    buffer_load_dwordx4 v[72:75], v7, s[8:11], s48 offen sc1
    buffer_load_dwordx2 v[76:77], v8, s[8:11], s50 offen sc1
    s_waitcnt vmcnt(0)
    v_max3_u32 v103, v68, v69, v70
    v_max3_u32 v103, v103, v71, v72
    v_max3_u32 v103, v103, v73, v74
    v_max3_u32 v103, v103, v75, v76
    v_max_u32 v103, v103, v77
    v_cmp_eq_u32 vcc, -1, v103
    s_cbranch_vccz interleave_layers__linear_attn_block__memory_aug_recurrent_mem_tr__prompt_kernel_v_pmw3_out
    s_mov_b32 s61, 0
interleave_layers__linear_attn_block__memory_aug_recurrent_mem_tr__prompt_kernel_v_pmw3:
    buffer_load_dwordx4 v[68:71], v7, s[8:11], s47 offen sc1
    buffer_load_dwordx4 v[72:75], v7, s[8:11], s48 offen sc1
    buffer_load_dwordx2 v[76:77], v8, s[8:11], s50 offen sc1
    s_waitcnt vmcnt(0)
    v_max3_u32 v103, v68, v69, v70
    v_max3_u32 v103, v103, v71, v72
    v_max3_u32 v103, v103, v73, v74
    v_max3_u32 v103, v103, v75, v76
    v_max_u32 v103, v103, v77
    v_cmp_eq_u32 vcc, -1, v103
    s_add_u32 s61, s61, 1
    s_cbranch_vccz interleave_layers__linear_attn_block__memory_aug_recurrent_mem_tr__prompt_kernel_v_pmw3_out
    s_cmp_ge_u32 s61, s60
    s_cbranch_scc1 interleave_layers__linear_attn_block__memory_aug_recurrent_mem_tr__prompt_kernel_v_pmw3_to
    s_sleep 1
    s_branch interleave_layers__linear_attn_block__memory_aug_recurrent_mem_tr__prompt_kernel_v_pmw3
interleave_layers__linear_attn_block__memory_aug_recurrent_mem_tr__prompt_kernel_v_pmw3_to:
    s_mov_b32 s60, 1
interleave_layers__linear_attn_block__memory_aug_recurrent_mem_tr__prompt_kernel_v_pmw3_out:
    ds_write_b128 v7, v[68:71]
    ds_write_b128 v7, v[72:75] offset:4096
    ds_write_b64 v8, v[76:77]
interleave_layers__linear_attn_block__memory_aug_recurrent_mem_tr__prompt_kernel_v_gow3:
    v_smfmac_f32_16x16x64_bf16 v[56:59], v[68:71], a[24:31], v4
    v_smfmac_f32_16x16x64_bf16 v[60:63], v[68:71], a[104:111], v4
    v_smfmac_f32_16x16x64_bf16 v[64:67], v[68:71], a[184:191], v4
    s_waitcnt lgkmcnt(0)
    s_barrier
    ds_read_b128 v[80:83], v5 offset:0
    ds_read_b128 v[84:87], v5 offset:1024
    ds_read_b128 v[88:91], v5 offset:2048
    ds_read_b128 v[92:95], v5 offset:4096
    ds_read_b128 v[96:99], v5 offset:5120
    ds_read_b128 v[100:103], v5 offset:6144
    ds_read_b128 v[76:79], v5 offset:8192
    ds_read_b128 v[68:71], v5 offset:9216
    v_smfmac_f32_16x16x64_bf16 v[64:67], v[72:75], a[216:223], v4
    v_smfmac_f32_16x16x64_bf16 v[56:59], v[72:75], a[56:63], v4
    v_smfmac_f32_16x16x64_bf16 v[60:63], v[72:75], a[136:143], v4
    s_waitcnt lgkmcnt(7)
    v_smfmac_f32_16x16x64_bf16 v[64:67], v[80:83], a[160:167], v4
    s_waitcnt lgkmcnt(6)
    v_smfmac_f32_16x16x64_bf16 v[64:67], v[84:87], a[168:175], v4
    s_waitcnt lgkmcnt(5)
    v_smfmac_f32_16x16x64_bf16 v[64:67], v[88:91], a[176:183], v4
    s_waitcnt lgkmcnt(4)
    v_smfmac_f32_16x16x64_bf16 v[64:67], v[92:95], a[192:199], v4
    s_waitcnt lgkmcnt(3)
    v_smfmac_f32_16x16x64_bf16 v[64:67], v[96:99], a[200:207], v4
    s_waitcnt lgkmcnt(2)
    v_smfmac_f32_16x16x64_bf16 v[64:67], v[100:103], a[208:215], v4
    s_waitcnt lgkmcnt(1)
    v_smfmac_f32_16x16x64_bf16 v[64:67], v[76:79], a[224:231], v4
    s_waitcnt lgkmcnt(0)
    v_smfmac_f32_16x16x64_bf16 v[64:67], v[68:71], a[232:239], v4
    v_smfmac_f32_16x16x64_bf16 v[56:59], v[80:83], a[0:7], v4
    v_smfmac_f32_16x16x64_bf16 v[60:63], v[80:83], a[80:87], v4
    v_smfmac_f32_16x16x64_bf16 v[56:59], v[84:87], a[8:15], v4
    s_nop 4
    v_mov_b32 v72, v64
    v_smfmac_f32_16x16x64_bf16 v[60:63], v[84:87], a[88:95], v4
    v_mov_b32 v73, v65
    v_mov_b32 v74, v66
    v_smfmac_f32_16x16x64_bf16 v[56:59], v[88:91], a[16:23], v4
    v_mov_b32 v75, v67
    v_smfmac_f32_16x16x64_bf16 v[60:63], v[88:91], a[96:103], v4
    v_permlane32_swap_b32 v64, v72
    v_permlane32_swap_b32 v65, v73
    v_smfmac_f32_16x16x64_bf16 v[56:59], v[92:95], a[32:39], v4
    v_permlane32_swap_b32 v66, v74
    v_permlane32_swap_b32 v67, v75
    v_smfmac_f32_16x16x64_bf16 v[60:63], v[92:95], a[112:119], v4
    v_add_f32 v64, v64, v72
    v_add_f32 v65, v65, v73
    v_smfmac_f32_16x16x64_bf16 v[56:59], v[96:99], a[40:47], v4
    v_add_f32 v66, v66, v74
    v_add_f32 v67, v67, v75
    v_smfmac_f32_16x16x64_bf16 v[60:63], v[96:99], a[120:127], v4
    v_cvt_pk_bf16_f32 v72, v64, v65
    v_cvt_pk_bf16_f32 v73, v66, v67
    v_smfmac_f32_16x16x64_bf16 v[56:59], v[100:103], a[48:55], v4
    ds_write_b64 v9, v[72:73] offset:512
    v_smfmac_f32_16x16x64_bf16 v[60:63], v[100:103], a[128:135], v4
    v_smfmac_f32_16x16x64_bf16 v[56:59], v[76:79], a[64:71], v4
    v_smfmac_f32_16x16x64_bf16 v[60:63], v[76:79], a[144:151], v4
    v_smfmac_f32_16x16x64_bf16 v[56:59], v[68:71], a[72:79], v4
    v_smfmac_f32_16x16x64_bf16 v[60:63], v[68:71], a[152:159], v4
    s_nop 7
    v_permlane32_swap_b32 v56, v60
    v_permlane32_swap_b32 v57, v61
    v_permlane32_swap_b32 v58, v62
    v_permlane32_swap_b32 v59, v63
    v_add_f32 v56, v56, v60
    v_add_f32 v57, v57, v61
    v_add_f32 v58, v58, v62
    v_add_f32 v59, v59, v63
    v_cvt_pk_bf16_f32 v68, v56, v57
    v_cvt_pk_bf16_f32 v69, v58, v59
    ds_write_b64 v10, v[68:69]
    s_waitcnt lgkmcnt(0)
    s_barrier
    ds_read_b64_tr_b16 v[68:69], v11 offset:0
    ds_read_b64_tr_b16 v[70:71], v11 offset:128
    ds_read_b64_tr_b16 v[72:73], v11 offset:1024
    ds_read_b64_tr_b16 v[74:75], v11 offset:1152
    ds_read_b64_tr_b16 v[76:77], v11 offset:2048
    ds_read_b64_tr_b16 v[78:79], v11 offset:2176
    ds_read_b128 v[80:83], v6 offset:0
    ds_read_b128 v[84:87], v6 offset:1024
    ds_read_b128 v[88:91], v6 offset:2048
    ds_read_b128 v[92:95], v6 offset:3072
    ds_read_b128 v[96:99], v6 offset:4096
    ds_read_b128 v[100:103], v6 offset:5120
    s_waitcnt lgkmcnt(10)
    v_smfmac_f32_16x16x64_bf16 v[16:19], v[68:71], a[240:247], v4
    v_smfmac_f32_16x16x64_bf16 v[20:23], v[68:71], v[112:119], v4
    v_smfmac_f32_16x16x64_bf16 v[24:27], v[68:71], v[136:143], v4
    v_smfmac_f32_16x16x64_bf16 v[28:31], v[68:71], v[160:167], v4
    s_waitcnt lgkmcnt(8)
    v_smfmac_f32_16x16x64_bf16 v[16:19], v[72:75], a[248:255], v4
    v_smfmac_f32_16x16x64_bf16 v[20:23], v[72:75], v[120:127], v4
    v_smfmac_f32_16x16x64_bf16 v[24:27], v[72:75], v[144:151], v4
    v_smfmac_f32_16x16x64_bf16 v[28:31], v[72:75], v[168:175], v4
    s_waitcnt lgkmcnt(6)
    v_smfmac_f32_16x16x64_bf16 v[16:19], v[76:79], v[104:111], v4
    v_smfmac_f32_16x16x64_bf16 v[20:23], v[76:79], v[128:135], v4
    v_smfmac_f32_16x16x64_bf16 v[24:27], v[76:79], v[152:159], v4
    v_smfmac_f32_16x16x64_bf16 v[28:31], v[76:79], v[176:183], v4
    v_smfmac_f32_16x16x64_bf16 v[32:35], v[68:71], v[184:191], v4
    v_smfmac_f32_16x16x64_bf16 v[36:39], v[68:71], v[208:215], v4
    s_nop 4
    v_permlane32_swap_b32 v16, v24
    v_permlane32_swap_b32 v17, v25
    v_smfmac_f32_16x16x64_bf16 v[40:43], v[68:71], v[232:239], v4
    v_permlane32_swap_b32 v18, v26
    v_permlane32_swap_b32 v19, v27
    s_waitcnt lgkmcnt(4)
    v_smfmac_f32_16x16x64_bf16 v[44:47], v[68:71], v[80:87], v4
    v_add_f32 v16, v16, v24
    v_add_f32 v17, v17, v25
    ds_read_b128 v[80:83], v6 offset:6144
    ds_read_b128 v[84:87], v6 offset:7168
    v_smfmac_f32_16x16x64_bf16 v[32:35], v[72:75], v[192:199], v4
    v_add_f32 v18, v18, v26
    v_add_f32 v19, v19, v27
    v_smfmac_f32_16x16x64_bf16 v[36:39], v[72:75], v[216:223], v4
    v_permlane32_swap_b32 v20, v28
    v_permlane32_swap_b32 v21, v29
    v_smfmac_f32_16x16x64_bf16 v[40:43], v[72:75], v[240:247], v4
    v_permlane32_swap_b32 v22, v30
    v_permlane32_swap_b32 v23, v31
    s_waitcnt lgkmcnt(4)
    v_smfmac_f32_16x16x64_bf16 v[44:47], v[72:75], v[88:95], v4
    v_add_f32 v20, v20, v28
    v_add_f32 v21, v21, v29
    ds_read_b128 v[88:91], v6 offset:8192
    ds_read_b128 v[92:95], v6 offset:9216
    v_smfmac_f32_16x16x64_bf16 v[32:35], v[76:79], v[200:207], v4
    v_add_f32 v22, v22, v30
    v_add_f32 v23, v23, v31
    v_smfmac_f32_16x16x64_bf16 v[36:39], v[76:79], v[224:231], v4
    v_cvt_pk_bf16_f32 v56, v16, v17
    v_cvt_pk_bf16_f32 v57, v18, v19
    v_smfmac_f32_16x16x64_bf16 v[40:43], v[76:79], v[248:255], v4
    v_cvt_pk_bf16_f32 v58, v20, v21
    v_cvt_pk_bf16_f32 v59, v22, v23
    s_waitcnt lgkmcnt(4)
    v_smfmac_f32_16x16x64_bf16 v[44:47], v[76:79], v[96:103], v4
    v_permlane16_swap_b32 v56, v58
    ds_read_b128 v[96:99], v6 offset:10240
    ds_read_b128 v[100:103], v6 offset:11264
    v_permlane16_swap_b32 v57, v59
    v_min_u32 v56, -2, v56
    v_min_u32 v57, -2, v57
    v_min_u32 v58, -2, v58
    v_min_u32 v59, -2, v59
    buffer_store_dwordx4 v[56:59], v14, s[8:11], s43 offen sc1
    s_add_u32 s49, s43, 65536
    s_waitcnt lgkmcnt(4)
    v_smfmac_f32_16x16x64_bf16 v[48:51], v[68:71], v[80:87], v4
    v_permlane32_swap_b32 v32, v40
    v_permlane32_swap_b32 v33, v41
    v_permlane32_swap_b32 v34, v42
    ds_read_b128 v[80:83], v6 offset:12288
    ds_read_b128 v[84:87], v6 offset:13312
    s_waitcnt lgkmcnt(4)
    v_smfmac_f32_16x16x64_bf16 v[48:51], v[72:75], v[88:95], v4
    v_permlane32_swap_b32 v35, v43
    v_add_f32 v32, v32, v40
    v_add_f32 v33, v33, v41
    v_add_f32 v34, v34, v42
    ds_read_b128 v[88:91], v6 offset:14336
    ds_read_b128 v[92:95], v6 offset:15360
    s_waitcnt lgkmcnt(4)
    v_smfmac_f32_16x16x64_bf16 v[48:51], v[76:79], v[96:103], v4
    v_add_f32 v35, v35, v43
    v_permlane32_swap_b32 v36, v44
    v_permlane32_swap_b32 v37, v45
    v_permlane32_swap_b32 v38, v46
    ds_read_b128 v[96:99], v6 offset:16384
    ds_read_b128 v[100:103], v6 offset:17408
    v_permlane32_swap_b32 v39, v47
    v_add_f32 v36, v36, v44
    v_add_f32 v37, v37, v45
    v_add_f32 v38, v38, v46
    s_waitcnt lgkmcnt(4)
    v_smfmac_f32_16x16x64_bf16 v[52:55], v[68:71], v[80:87], v4
    v_add_f32 v39, v39, v47
    v_cvt_pk_bf16_f32 v60, v32, v33
    v_cvt_pk_bf16_f32 v61, v34, v35
    s_waitcnt lgkmcnt(2)
    v_smfmac_f32_16x16x64_bf16 v[52:55], v[72:75], v[88:95], v4
    v_cvt_pk_bf16_f32 v62, v36, v37
    v_cvt_pk_bf16_f32 v63, v38, v39
    s_waitcnt lgkmcnt(0)
    v_smfmac_f32_16x16x64_bf16 v[52:55], v[76:79], v[96:103], v4
    v_permlane16_swap_b32 v60, v62
    v_permlane16_swap_b32 v61, v63
    v_min_u32 v60, -2, v60
    v_min_u32 v61, -2, v61
    v_min_u32 v62, -2, v62
    v_min_u32 v63, -2, v63
    buffer_store_dwordx4 v[60:63], v14, s[8:11], s49 offen sc1
    s_nop 0
    v_permlane32_swap_b32 v48, v52
    v_permlane32_swap_b32 v49, v53
    v_permlane32_swap_b32 v50, v54
    v_permlane32_swap_b32 v51, v55
    v_add_f32 v48, v48, v52
    v_add_f32 v49, v49, v53
    v_add_f32 v50, v50, v54
    v_add_f32 v51, v51, v55
    v_cvt_pk_bf16_f32 v64, v48, v49
    v_cvt_pk_bf16_f32 v65, v50, v51
    v_mov_b32 v66, v64
    v_mov_b32 v67, v65
    s_nop 0
    v_permlane16_swap_b32 v64, v66
    v_permlane16_swap_b32 v65, v67
    v_min_u32 v64, -2, v64
    v_min_u32 v65, -2, v65
    v_min_u32 v66, -2, v66
    v_min_u32 v67, -2, v67
    buffer_store_dwordx4 v[64:67], v15, s[8:11], s43 offen sc1
    s_add_u32 s40, s40, 1
    s_add_u32 s47, s37, 704512
    s_add_u32 s45, s37, 737280
    s_lshl_b32 s24, s40, 12
    s_and_b32 s24, s24, 0x2000
    s_xor_b32 s24, s24, s36
    s_lshl_b32 s37, s40, 20
    s_add_u32 s37, s37, s24
    s_add_u32 s37, s37, 117440512
    s_add_u32 s43, s37, 0
    s_cmp_lt_u32 s40, 64
    s_cbranch_scc1 interleave_layers__linear_attn_block__memory_aug_recurrent_mem_tr__prompt_kernel_v_stepw3
interleave_layers__linear_attn_block__memory_aug_recurrent_mem_tr__prompt_kernel_v_end:
    s_cmp_eq_u32 s92, 0
    s_cbranch_scc0 interleave_layers__linear_attn_block__memory_aug_recurrent_mem_tr__prompt_kernel_end
    s_mov_b32 s92, 1
    s_branch interleave_layers__linear_attn_block__memory_aug_recurrent_mem_tr__prompt_kernel_v_layer
interleave_layers__linear_attn_block__memory_aug_recurrent_mem_tr__prompt_kernel_roleR:
interleave_layers__linear_attn_block__memory_aug_recurrent_mem_tr__prompt_kernel_r_top:
    s_barrier
    s_sub_u32 s24, s2, 64
    s_cmp_ge_u32 s24, 24
    s_cbranch_scc1 interleave_layers__linear_attn_block__memory_aug_recurrent_mem_tr__prompt_kernel_rk24
    s_and_b32 s44, s24, 7
    s_lshr_b32 s45, s24, 3
    s_cmp_eq_u32 s92, 0
    s_cselect_b32 s46, 32, 2
    v_lshlrev_b32 v5, 4, v1
    s_mov_b32 s64, 12288
    s_cmp_eq_u32 s45, 1
    s_cselect_b32 s64, 5120, s64
    s_cmp_eq_u32 s45, 2
    s_cselect_b32 s64, 17408, s64
    s_mov_b32 s65, 1024
    s_cmp_eq_u32 s45, 1
    s_cselect_b32 s65, 7168, s65
    s_cmp_eq_u32 s45, 2
    s_cselect_b32 s65, 13312, s65
    s_mov_b32 s66, 0
    s_cmp_eq_u32 s45, 1
    s_cselect_b32 s66, 6144, s66
    s_cmp_eq_u32 s45, 2
    s_cselect_b32 s66, 14336, s66
    s_mov_b32 s67, 2048
    s_cmp_eq_u32 s45, 1
    s_cselect_b32 s67, 8192, s67
    s_cmp_eq_u32 s45, 2
    s_cselect_b32 s67, 15360, s67
    s_mov_b32 s68, 4096
    s_cmp_eq_u32 s45, 1
    s_cselect_b32 s68, 10240, s68
    s_cmp_eq_u32 s45, 2
    s_cselect_b32 s68, 16384, s68
    s_mov_b32 s69, 3072
    s_cmp_eq_u32 s45, 1
    s_cselect_b32 s69, 9216, s69
    s_cmp_eq_u32 s45, 2
    s_cselect_b32 s69, 16384, s69
    s_mov_b32 s70, 3072
    s_cmp_eq_u32 s45, 1
    s_cselect_b32 s70, 11264, s70
    s_cmp_eq_u32 s45, 2
    s_cselect_b32 s70, 16384, s70
    s_lshl_b32 s24, s92, 3
    s_add_u32 s24, s24, s44
    s_lshl_b32 s24, s24, 7
    s_add_u32 s24, s24, 23101440
    v_lshlrev_b32 v15, 2, v1
    v_add_u32 v15, s24, v15
    s_cmp_eq_u32 s92, 0
    s_cselect_b32 s26, -1, 3
    s_mov_b32 s61, 0
interleave_layers__linear_attn_block__memory_aug_recurrent_mem_tr__prompt_kernel_k2_w:
    buffer_load_dword v14, v15, s[8:11], 0 offen sc1
    s_waitcnt vmcnt(0)
    v_cmp_le_i32 vcc, 1, v14
    s_and_b32 s24, vcc_lo, s26
    s_cmp_eq_u32 s24, s26
    s_cbranch_scc1 interleave_layers__linear_attn_block__memory_aug_recurrent_mem_tr__prompt_kernel_k2_w_ok
    s_add_u32 s61, s61, 1
    s_cmp_ge_u32 s61, s60
    s_cbranch_scc1 interleave_layers__linear_attn_block__memory_aug_recurrent_mem_tr__prompt_kernel_k2_w_to
    s_sleep 2
    s_branch interleave_layers__linear_attn_block__memory_aug_recurrent_mem_tr__prompt_kernel_k2_w
interleave_layers__linear_attn_block__memory_aug_recurrent_mem_tr__prompt_kernel_k2_w_to:
    s_mov_b32 s60, 1
interleave_layers__linear_attn_block__memory_aug_recurrent_mem_tr__prompt_kernel_k2_w_ok:
    s_add_u32 s25, s3, 0
    s_mul_i32 s24, s25, 147456
    s_mul_i32 s26, s44, 18432
    s_add_u32 s24, s24, s26
    s_add_u32 s24, s24, 16777216
    s_cmp_lt_u32 s25, s46
    s_cselect_b32 s24, s24, 2146435072
    s_add_u32 s26, s24, s64
    buffer_load_dwordx4 v[16:19], v5, s[8:11], s26 offen sc1
    s_add_u32 s26, s24, s65
    buffer_load_dwordx4 v[20:23], v5, s[8:11], s26 offen sc1
    s_add_u32 s26, s24, s66
    buffer_load_dwordx4 v[24:27], v5, s[8:11], s26 offen sc1
    s_add_u32 s26, s24, s67
    buffer_load_dwordx4 v[28:31], v5, s[8:11], s26 offen sc1
    s_add_u32 s26, s24, s68
    buffer_load_dwordx4 v[32:35], v5, s[8:11], s26 offen sc1
    s_add_u32 s26, s24, s69
    buffer_load_dwordx4 v[36:39], v5, s[8:11], s26 offen sc1
    s_add_u32 s26, s24, s70
    buffer_load_dwordx4 v[40:43], v5, s[8:11], s26 offen sc1
    s_add_u32 s25, s3, 4
    s_mul_i32 s24, s25, 147456
    s_mul_i32 s26, s44, 18432
    s_add_u32 s24, s24, s26
    s_add_u32 s24, s24, 16777216
    s_cmp_lt_u32 s25, s46
    s_cselect_b32 s24, s24, 2146435072
    s_add_u32 s26, s24, s64
    buffer_load_dwordx4 v[44:47], v5, s[8:11], s26 offen sc1
    s_add_u32 s26, s24, s65
    buffer_load_dwordx4 v[48:51], v5, s[8:11], s26 offen sc1
    s_add_u32 s26, s24, s66
    buffer_load_dwordx4 v[52:55], v5, s[8:11], s26 offen sc1
    s_add_u32 s26, s24, s67
    buffer_load_dwordx4 v[56:59], v5, s[8:11], s26 offen sc1
    s_add_u32 s26, s24, s68
    buffer_load_dwordx4 v[60:63], v5, s[8:11], s26 offen sc1
    s_add_u32 s26, s24, s69
    buffer_load_dwordx4 v[64:67], v5, s[8:11], s26 offen sc1
    s_add_u32 s26, s24, s70
    buffer_load_dwordx4 v[68:71], v5, s[8:11], s26 offen sc1
    s_add_u32 s25, s3, 8
    s_mul_i32 s24, s25, 147456
    s_mul_i32 s26, s44, 18432
    s_add_u32 s24, s24, s26
    s_add_u32 s24, s24, 16777216
    s_cmp_lt_u32 s25, s46
    s_cselect_b32 s24, s24, 2146435072
    s_add_u32 s26, s24, s64
    buffer_load_dwordx4 v[72:75], v5, s[8:11], s26 offen sc1
    s_add_u32 s26, s24, s65
    buffer_load_dwordx4 v[76:79], v5, s[8:11], s26 offen sc1
    s_add_u32 s26, s24, s66
    buffer_load_dwordx4 v[80:83], v5, s[8:11], s26 offen sc1
    s_add_u32 s26, s24, s67
    buffer_load_dwordx4 v[84:87], v5, s[8:11], s26 offen sc1
    s_add_u32 s26, s24, s68
    buffer_load_dwordx4 v[88:91], v5, s[8:11], s26 offen sc1
    s_add_u32 s26, s24, s69
    buffer_load_dwordx4 v[92:95], v5, s[8:11], s26 offen sc1
    s_add_u32 s26, s24, s70
    buffer_load_dwordx4 v[96:99], v5, s[8:11], s26 offen sc1
    s_add_u32 s25, s3, 12
    s_mul_i32 s24, s25, 147456
    s_mul_i32 s26, s44, 18432
    s_add_u32 s24, s24, s26
    s_add_u32 s24, s24, 16777216
    s_cmp_lt_u32 s25, s46
    s_cselect_b32 s24, s24, 2146435072
    s_add_u32 s26, s24, s64
    buffer_load_dwordx4 v[100:103], v5, s[8:11], s26 offen sc1
    s_add_u32 s26, s24, s65
    buffer_load_dwordx4 v[104:107], v5, s[8:11], s26 offen sc1
    s_add_u32 s26, s24, s66
    buffer_load_dwordx4 v[108:111], v5, s[8:11], s26 offen sc1
    s_add_u32 s26, s24, s67
    buffer_load_dwordx4 v[112:115], v5, s[8:11], s26 offen sc1
    s_add_u32 s26, s24, s68
    buffer_load_dwordx4 v[116:119], v5, s[8:11], s26 offen sc1
    s_add_u32 s26, s24, s69
    buffer_load_dwordx4 v[120:123], v5, s[8:11], s26 offen sc1
    s_add_u32 s26, s24, s70
    buffer_load_dwordx4 v[124:127], v5, s[8:11], s26 offen sc1
    s_add_u32 s25, s3, 16
    s_mul_i32 s24, s25, 147456
    s_mul_i32 s26, s44, 18432
    s_add_u32 s24, s24, s26
    s_add_u32 s24, s24, 16777216
    s_cmp_lt_u32 s25, s46
    s_cselect_b32 s24, s24, 2146435072
    s_add_u32 s26, s24, s64
    buffer_load_dwordx4 v[128:131], v5, s[8:11], s26 offen sc1
    s_add_u32 s26, s24, s65
    buffer_load_dwordx4 v[132:135], v5, s[8:11], s26 offen sc1
    s_add_u32 s26, s24, s66
    buffer_load_dwordx4 v[136:139], v5, s[8:11], s26 offen sc1
    s_add_u32 s26, s24, s67
    buffer_load_dwordx4 v[140:143], v5, s[8:11], s26 offen sc1
    s_add_u32 s26, s24, s68
    buffer_load_dwordx4 v[144:147], v5, s[8:11], s26 offen sc1
    s_add_u32 s26, s24, s69
    buffer_load_dwordx4 v[148:151], v5, s[8:11], s26 offen sc1
    s_add_u32 s26, s24, s70
    buffer_load_dwordx4 v[152:155], v5, s[8:11], s26 offen sc1
    s_add_u32 s25, s3, 20
    s_mul_i32 s24, s25, 147456
    s_mul_i32 s26, s44, 18432
    s_add_u32 s24, s24, s26
    s_add_u32 s24, s24, 16777216
    s_cmp_lt_u32 s25, s46
    s_cselect_b32 s24, s24, 2146435072
    s_add_u32 s26, s24, s64
    buffer_load_dwordx4 v[156:159], v5, s[8:11], s26 offen sc1
    s_add_u32 s26, s24, s65
    buffer_load_dwordx4 v[160:163], v5, s[8:11], s26 offen sc1
    s_add_u32 s26, s24, s66
    buffer_load_dwordx4 v[164:167], v5, s[8:11], s26 offen sc1
    s_add_u32 s26, s24, s67
    buffer_load_dwordx4 v[168:171], v5, s[8:11], s26 offen sc1
    s_add_u32 s26, s24, s68
    buffer_load_dwordx4 v[172:175], v5, s[8:11], s26 offen sc1
    s_add_u32 s26, s24, s69
    buffer_load_dwordx4 v[176:179], v5, s[8:11], s26 offen sc1
    s_add_u32 s26, s24, s70
    buffer_load_dwordx4 v[180:183], v5, s[8:11], s26 offen sc1
    s_add_u32 s25, s3, 24
    s_mul_i32 s24, s25, 147456
    s_mul_i32 s26, s44, 18432
    s_add_u32 s24, s24, s26
    s_add_u32 s24, s24, 16777216
    s_cmp_lt_u32 s25, s46
    s_cselect_b32 s24, s24, 2146435072
    s_add_u32 s26, s24, s64
    buffer_load_dwordx4 v[184:187], v5, s[8:11], s26 offen sc1
    s_add_u32 s26, s24, s65
    buffer_load_dwordx4 v[188:191], v5, s[8:11], s26 offen sc1
    s_add_u32 s26, s24, s66
    buffer_load_dwordx4 v[192:195], v5, s[8:11], s26 offen sc1
    s_add_u32 s26, s24, s67
    buffer_load_dwordx4 v[196:199], v5, s[8:11], s26 offen sc1
    s_add_u32 s26, s24, s68
    buffer_load_dwordx4 v[200:203], v5, s[8:11], s26 offen sc1
    s_add_u32 s26, s24, s69
    buffer_load_dwordx4 v[204:207], v5, s[8:11], s26 offen sc1
    s_add_u32 s26, s24, s70
    buffer_load_dwordx4 v[208:211], v5, s[8:11], s26 offen sc1
    s_add_u32 s25, s3, 28
    s_mul_i32 s24, s25, 147456
    s_mul_i32 s26, s44, 18432
    s_add_u32 s24, s24, s26
    s_add_u32 s24, s24, 16777216
    s_cmp_lt_u32 s25, s46
    s_cselect_b32 s24, s24, 2146435072
    s_add_u32 s26, s24, s64
    buffer_load_dwordx4 v[212:215], v5, s[8:11], s26 offen sc1
    s_add_u32 s26, s24, s65
    buffer_load_dwordx4 v[216:219], v5, s[8:11], s26 offen sc1
    s_add_u32 s26, s24, s66
    buffer_load_dwordx4 v[220:223], v5, s[8:11], s26 offen sc1
    s_add_u32 s26, s24, s67
    buffer_load_dwordx4 v[224:227], v5, s[8:11], s26 offen sc1
    s_add_u32 s26, s24, s68
    buffer_load_dwordx4 v[228:231], v5, s[8:11], s26 offen sc1
    s_add_u32 s26, s24, s69
    buffer_load_dwordx4 v[232:235], v5, s[8:11], s26 offen sc1
    s_add_u32 s26, s24, s70
    buffer_load_dwordx4 v[236:239], v5, s[8:11], s26 offen sc1
    s_waitcnt vmcnt(42)
    v_pk_add_f32 v[16:17], v[16:17], v[44:45]
    v_pk_add_f32 v[18:19], v[18:19], v[46:47]
    v_pk_add_f32 v[20:21], v[20:21], v[48:49]
    v_pk_add_f32 v[22:23], v[22:23], v[50:51]
    v_pk_add_f32 v[24:25], v[24:25], v[52:53]
    v_pk_add_f32 v[26:27], v[26:27], v[54:55]
    v_pk_add_f32 v[28:29], v[28:29], v[56:57]
    v_pk_add_f32 v[30:31], v[30:31], v[58:59]
    v_pk_add_f32 v[32:33], v[32:33], v[60:61]
    v_pk_add_f32 v[34:35], v[34:35], v[62:63]
    v_pk_add_f32 v[36:37], v[36:37], v[64:65]
    v_pk_add_f32 v[38:39], v[38:39], v[66:67]
    v_pk_add_f32 v[40:41], v[40:41], v[68:69]
    v_pk_add_f32 v[42:43], v[42:43], v[70:71]
    s_waitcnt vmcnt(35)
    v_pk_add_f32 v[16:17], v[16:17], v[72:73]
    v_pk_add_f32 v[18:19], v[18:19], v[74:75]
    v_pk_add_f32 v[20:21], v[20:21], v[76:77]
    v_pk_add_f32 v[22:23], v[22:23], v[78:79]
    v_pk_add_f32 v[24:25], v[24:25], v[80:81]
    v_pk_add_f32 v[26:27], v[26:27], v[82:83]
    v_pk_add_f32 v[28:29], v[28:29], v[84:85]
    v_pk_add_f32 v[30:31], v[30:31], v[86:87]
    v_pk_add_f32 v[32:33], v[32:33], v[88:89]
    v_pk_add_f32 v[34:35], v[34:35], v[90:91]
    v_pk_add_f32 v[36:37], v[36:37], v[92:93]
    v_pk_add_f32 v[38:39], v[38:39], v[94:95]
    v_pk_add_f32 v[40:41], v[40:41], v[96:97]
    v_pk_add_f32 v[42:43], v[42:43], v[98:99]
    s_waitcnt vmcnt(28)
    v_pk_add_f32 v[16:17], v[16:17], v[100:101]
    v_pk_add_f32 v[18:19], v[18:19], v[102:103]
    v_pk_add_f32 v[20:21], v[20:21], v[104:105]
    v_pk_add_f32 v[22:23], v[22:23], v[106:107]
    v_pk_add_f32 v[24:25], v[24:25], v[108:109]
    v_pk_add_f32 v[26:27], v[26:27], v[110:111]
    v_pk_add_f32 v[28:29], v[28:29], v[112:113]
    v_pk_add_f32 v[30:31], v[30:31], v[114:115]
    v_pk_add_f32 v[32:33], v[32:33], v[116:117]
    v_pk_add_f32 v[34:35], v[34:35], v[118:119]
    v_pk_add_f32 v[36:37], v[36:37], v[120:121]
    v_pk_add_f32 v[38:39], v[38:39], v[122:123]
    v_pk_add_f32 v[40:41], v[40:41], v[124:125]
    v_pk_add_f32 v[42:43], v[42:43], v[126:127]
    s_waitcnt vmcnt(21)
    v_pk_add_f32 v[16:17], v[16:17], v[128:129]
    v_pk_add_f32 v[18:19], v[18:19], v[130:131]
    v_pk_add_f32 v[20:21], v[20:21], v[132:133]
    v_pk_add_f32 v[22:23], v[22:23], v[134:135]
    v_pk_add_f32 v[24:25], v[24:25], v[136:137]
    v_pk_add_f32 v[26:27], v[26:27], v[138:139]
    v_pk_add_f32 v[28:29], v[28:29], v[140:141]
    v_pk_add_f32 v[30:31], v[30:31], v[142:143]
    v_pk_add_f32 v[32:33], v[32:33], v[144:145]
    v_pk_add_f32 v[34:35], v[34:35], v[146:147]
    v_pk_add_f32 v[36:37], v[36:37], v[148:149]
    v_pk_add_f32 v[38:39], v[38:39], v[150:151]
    v_pk_add_f32 v[40:41], v[40:41], v[152:153]
    v_pk_add_f32 v[42:43], v[42:43], v[154:155]
    s_waitcnt vmcnt(14)
    v_pk_add_f32 v[16:17], v[16:17], v[156:157]
    v_pk_add_f32 v[18:19], v[18:19], v[158:159]
    v_pk_add_f32 v[20:21], v[20:21], v[160:161]
    v_pk_add_f32 v[22:23], v[22:23], v[162:163]
    v_pk_add_f32 v[24:25], v[24:25], v[164:165]
    v_pk_add_f32 v[26:27], v[26:27], v[166:167]
    v_pk_add_f32 v[28:29], v[28:29], v[168:169]
    v_pk_add_f32 v[30:31], v[30:31], v[170:171]
    v_pk_add_f32 v[32:33], v[32:33], v[172:173]
    v_pk_add_f32 v[34:35], v[34:35], v[174:175]
    v_pk_add_f32 v[36:37], v[36:37], v[176:177]
    v_pk_add_f32 v[38:39], v[38:39], v[178:179]
    v_pk_add_f32 v[40:41], v[40:41], v[180:181]
    v_pk_add_f32 v[42:43], v[42:43], v[182:183]
    s_waitcnt vmcnt(7)
    v_pk_add_f32 v[16:17], v[16:17], v[184:185]
    v_pk_add_f32 v[18:19], v[18:19], v[186:187]
    v_pk_add_f32 v[20:21], v[20:21], v[188:189]
    v_pk_add_f32 v[22:23], v[22:23], v[190:191]
    v_pk_add_f32 v[24:25], v[24:25], v[192:193]
    v_pk_add_f32 v[26:27], v[26:27], v[194:195]
    v_pk_add_f32 v[28:29], v[28:29], v[196:197]
    v_pk_add_f32 v[30:31], v[30:31], v[198:199]
    v_pk_add_f32 v[32:33], v[32:33], v[200:201]
    v_pk_add_f32 v[34:35], v[34:35], v[202:203]
    v_pk_add_f32 v[36:37], v[36:37], v[204:205]
    v_pk_add_f32 v[38:39], v[38:39], v[206:207]
    v_pk_add_f32 v[40:41], v[40:41], v[208:209]
    v_pk_add_f32 v[42:43], v[42:43], v[210:211]
    s_waitcnt vmcnt(0)
    v_pk_add_f32 v[16:17], v[16:17], v[212:213]
    v_pk_add_f32 v[18:19], v[18:19], v[214:215]
    v_pk_add_f32 v[20:21], v[20:21], v[216:217]
    v_pk_add_f32 v[22:23], v[22:23], v[218:219]
    v_pk_add_f32 v[24:25], v[24:25], v[220:221]
    v_pk_add_f32 v[26:27], v[26:27], v[222:223]
    v_pk_add_f32 v[28:29], v[28:29], v[224:225]
    v_pk_add_f32 v[30:31], v[30:31], v[226:227]
    v_pk_add_f32 v[32:33], v[32:33], v[228:229]
    v_pk_add_f32 v[34:35], v[34:35], v[230:231]
    v_pk_add_f32 v[36:37], v[36:37], v[232:233]
    v_pk_add_f32 v[38:39], v[38:39], v[234:235]
    v_pk_add_f32 v[40:41], v[40:41], v[236:237]
    v_pk_add_f32 v[42:43], v[42:43], v[238:239]
    s_mul_i32 s24, s3, 7168
    v_add_u32 v6, s24, v5
    ds_write_b128 v6, v[16:19] offset:0
    ds_write_b128 v6, v[20:23] offset:1024
    ds_write_b128 v6, v[24:27] offset:2048
    ds_write_b128 v6, v[28:31] offset:3072
    ds_write_b128 v6, v[32:35] offset:4096
    ds_write_b128 v6, v[36:39] offset:5120
    ds_write_b128 v6, v[40:43] offset:6144
    s_waitcnt lgkmcnt(0)
    s_barrier
    s_mov_b32 s41, 0
    s_cmp_eq_u32 s45, 1
    s_cselect_b32 s41, 4, s41
    s_cmp_eq_u32 s45, 2
    s_cselect_b32 s41, 9, s41
    s_mov_b32 s42, 4
    s_cmp_eq_u32 s45, 1
    s_cselect_b32 s42, 5, s42
    s_cmp_eq_u32 s45, 2
    s_cselect_b32 s42, 5, s42
    s_mul_i32 s43, s92, 131072
    s_mul_i32 s24, s44, 14336
    s_add_u32 s43, s43, s24
    s_add_u32 s43, s43, 22020096
    v_and_b32 v7, 3, v2
    v_lshrrev_b32 v8, 2, v2
    s_add_u32 s40, s3, 0
    s_cmp_lt_u32 s40, s42
    s_cbranch_scc0 interleave_layers__linear_attn_block__memory_aug_recurrent_mem_tr__prompt_kernel_k2f25
    s_add_u32 s40, s40, s41
    s_mov_b32 s47, 67633672
    s_cmp_eq_u32 s40, 1
    s_cselect_b32 s47, 67699226, s47
    s_cmp_eq_u32 s40, 2
    s_cselect_b32 s47, 67702404, s47
    s_cmp_eq_u32 s40, 3
    s_cselect_b32 s47, 67765224, s47
    s_cmp_eq_u32 s40, 4
    s_cselect_b32 s47, 67765896, s47
    s_cmp_eq_u32 s40, 5
    s_cselect_b32 s47, 67831450, s47
    s_cmp_eq_u32 s40, 6
    s_cselect_b32 s47, 67833604, s47
    s_cmp_eq_u32 s40, 7
    s_cselect_b32 s47, 67897320, s47
    s_cmp_eq_u32 s40, 8
    s_cselect_b32 s47, 67899142, s47
    s_cmp_eq_u32 s40, 9
    s_cselect_b32 s47, 75497992, s47
    s_cmp_eq_u32 s40, 10
    s_cselect_b32 s47, 75499162, s47
    s_cmp_eq_u32 s40, 11
    s_cselect_b32 s47, 75501316, s47
    s_cmp_eq_u32 s40, 12
    s_cselect_b32 s47, 247768, s47
    s_cmp_eq_u32 s40, 13
    s_cselect_b32 s47, 249604, s47
    s_bfe_u32 s24, s47, 0x7000c
    s_bfe_u32 s25, s47, 0x50013
    s_bfe_u32 s26, s47, 0x30018
    v_mul_u32_u24 v9, s25, v7
    v_mul_u32_u24 v10, s26, v8
    v_add3_u32 v9, v9, v10, s24
    v_mul_u32_u24 v9, 205, v9
    v_lshrrev_b32 v9, 12, v9
    s_bfe_u32 s24, s47, 196608
    s_lshl_b32 s24, s24, 10
    v_add_u32 v10, s24, v5
    ds_read_b128 v[160:163], v10 offset:0
    ds_read_b128 v[164:167], v10 offset:7168
    ds_read_b128 v[168:171], v10 offset:14336
    ds_read_b128 v[172:175], v10 offset:21504
    s_bfe_u32 s25, s47, 196614
    s_lshl_b32 s25, s25, 4
    v_lshl_add_u32 v11, v3, 2, s25
    v_mul_u32_u24 v11, 205, v11
    v_lshrrev_b32 v11, 12, v11
    v_cmp_eq_u32 vcc, v9, v11
    s_waitcnt lgkmcnt(0)
    v_pk_add_f32 v[160:161], v[160:161], v[164:165]
    v_pk_add_f32 v[168:169], v[168:169], v[172:173]
    v_pk_add_f32 v[162:163], v[162:163], v[166:167]
    v_pk_add_f32 v[170:171], v[170:171], v[174:175]
    v_pk_add_f32 v[160:161], v[160:161], v[168:169]
    v_pk_add_f32 v[162:163], v[162:163], v[170:171]
    v_cvt_pk_bf16_f32 v176, v160, v161
    v_cvt_pk_bf16_f32 v177, v162, v163
    v_cndmask_b32 v176, 0, v176, vcc
    v_cndmask_b32 v177, 0, v177, vcc
    s_bfe_u32 s24, s47, 196611
    s_lshl_b32 s24, s24, 10
    v_add_u32 v10, s24, v5
    ds_read_b128 v[160:163], v10 offset:0
    ds_read_b128 v[164:167], v10 offset:7168
    ds_read_b128 v[168:171], v10 offset:14336
    ds_read_b128 v[172:175], v10 offset:21504
    s_bfe_u32 s25, s47, 196617
    s_lshl_b32 s25, s25, 4
    v_lshl_add_u32 v11, v3, 2, s25
    v_mul_u32_u24 v11, 205, v11
    v_lshrrev_b32 v11, 12, v11
    v_cmp_eq_u32 vcc, v9, v11
    s_waitcnt lgkmcnt(0)
    v_pk_add_f32 v[160:161], v[160:161], v[164:165]
    v_pk_add_f32 v[168:169], v[168:169], v[172:173]
    v_pk_add_f32 v[162:163], v[162:163], v[166:167]
    v_pk_add_f32 v[170:171], v[170:171], v[174:175]
    v_pk_add_f32 v[160:161], v[160:161], v[168:169]
    v_pk_add_f32 v[162:163], v[162:163], v[170:171]
    v_cvt_pk_bf16_f32 v178, v160, v161
    v_cvt_pk_bf16_f32 v179, v162, v163
    v_cndmask_b32 v178, 0, v178, vcc
    v_cndmask_b32 v179, 0, v179, vcc
    s_lshl_b32 s24, s40, 10
    s_add_u32 s24, s24, s43
    buffer_store_dwordx4 v[176:179], v5, s[8:11], s24 offen sc1
interleave_layers__linear_attn_block__memory_aug_recurrent_mem_tr__prompt_kernel_k2f25:
    s_add_u32 s40, s3, 4
    s_cmp_lt_u32 s40, s42
    s_cbranch_scc0 interleave_layers__linear_attn_block__memory_aug_recurrent_mem_tr__prompt_kernel_k2f26
    s_add_u32 s40, s40, s41
    s_mov_b32 s47, 67633672
    s_cmp_eq_u32 s40, 1
    s_cselect_b32 s47, 67699226, s47
    s_cmp_eq_u32 s40, 2
    s_cselect_b32 s47, 67702404, s47
    s_cmp_eq_u32 s40, 3
    s_cselect_b32 s47, 67765224, s47
    s_cmp_eq_u32 s40, 4
    s_cselect_b32 s47, 67765896, s47
    s_cmp_eq_u32 s40, 5
    s_cselect_b32 s47, 67831450, s47
    s_cmp_eq_u32 s40, 6
    s_cselect_b32 s47, 67833604, s47
    s_cmp_eq_u32 s40, 7
    s_cselect_b32 s47, 67897320, s47
    s_cmp_eq_u32 s40, 8
    s_cselect_b32 s47, 67899142, s47
    s_cmp_eq_u32 s40, 9
    s_cselect_b32 s47, 75497992, s47
    s_cmp_eq_u32 s40, 10
    s_cselect_b32 s47, 75499162, s47
    s_cmp_eq_u32 s40, 11
    s_cselect_b32 s47, 75501316, s47
    s_cmp_eq_u32 s40, 12
    s_cselect_b32 s47, 247768, s47
    s_cmp_eq_u32 s40, 13
    s_cselect_b32 s47, 249604, s47
    s_bfe_u32 s24, s47, 0x7000c
    s_bfe_u32 s25, s47, 0x50013
    s_bfe_u32 s26, s47, 0x30018
    v_mul_u32_u24 v9, s25, v7
    v_mul_u32_u24 v10, s26, v8
    v_add3_u32 v9, v9, v10, s24
    v_mul_u32_u24 v9, 205, v9
    v_lshrrev_b32 v9, 12, v9
    s_bfe_u32 s24, s47, 196608
    s_lshl_b32 s24, s24, 10
    v_add_u32 v10, s24, v5
    ds_read_b128 v[160:163], v10 offset:0
    ds_read_b128 v[164:167], v10 offset:7168
    ds_read_b128 v[168:171], v10 offset:14336
    ds_read_b128 v[172:175], v10 offset:21504
    s_bfe_u32 s25, s47, 196614
    s_lshl_b32 s25, s25, 4
    v_lshl_add_u32 v11, v3, 2, s25
    v_mul_u32_u24 v11, 205, v11
    v_lshrrev_b32 v11, 12, v11
    v_cmp_eq_u32 vcc, v9, v11
    s_waitcnt lgkmcnt(0)
    v_pk_add_f32 v[160:161], v[160:161], v[164:165]
    v_pk_add_f32 v[168:169], v[168:169], v[172:173]
    v_pk_add_f32 v[162:163], v[162:163], v[166:167]
    v_pk_add_f32 v[170:171], v[170:171], v[174:175]
    v_pk_add_f32 v[160:161], v[160:161], v[168:169]
    v_pk_add_f32 v[162:163], v[162:163], v[170:171]
    v_cvt_pk_bf16_f32 v176, v160, v161
    v_cvt_pk_bf16_f32 v177, v162, v163
    v_cndmask_b32 v176, 0, v176, vcc
    v_cndmask_b32 v177, 0, v177, vcc
    s_bfe_u32 s24, s47, 196611
    s_lshl_b32 s24, s24, 10
    v_add_u32 v10, s24, v5
    ds_read_b128 v[160:163], v10 offset:0
    ds_read_b128 v[164:167], v10 offset:7168
    ds_read_b128 v[168:171], v10 offset:14336
    ds_read_b128 v[172:175], v10 offset:21504
    s_bfe_u32 s25, s47, 196617
    s_lshl_b32 s25, s25, 4
    v_lshl_add_u32 v11, v3, 2, s25
    v_mul_u32_u24 v11, 205, v11
    v_lshrrev_b32 v11, 12, v11
    v_cmp_eq_u32 vcc, v9, v11
    s_waitcnt lgkmcnt(0)
    v_pk_add_f32 v[160:161], v[160:161], v[164:165]
    v_pk_add_f32 v[168:169], v[168:169], v[172:173]
    v_pk_add_f32 v[162:163], v[162:163], v[166:167]
    v_pk_add_f32 v[170:171], v[170:171], v[174:175]
    v_pk_add_f32 v[160:161], v[160:161], v[168:169]
    v_pk_add_f32 v[162:163], v[162:163], v[170:171]
    v_cvt_pk_bf16_f32 v178, v160, v161
    v_cvt_pk_bf16_f32 v179, v162, v163
    v_cndmask_b32 v178, 0, v178, vcc
    v_cndmask_b32 v179, 0, v179, vcc
    s_lshl_b32 s24, s40, 10
    s_add_u32 s24, s24, s43
    buffer_store_dwordx4 v[176:179], v5, s[8:11], s24 offen sc1
interleave_layers__linear_attn_block__memory_aug_recurrent_mem_tr__prompt_kernel_k2f26:
    s_waitcnt vmcnt(0)
    s_barrier
    s_lshl_b32 s24, s92, 7
    s_sub_u32 s25, s2, 64
    s_lshl_b32 s25, s25, 2
    s_add_u32 s24, s24, s25
    s_add_u32 s24, s24, 23103488
    s_cmp_eq_u32 s3, 0
    s_cbranch_scc0 interleave_layers__linear_attn_block__memory_aug_recurrent_mem_tr__prompt_kernel_pb27
    v_lshlrev_b32 v14, 7, v1
    v_add_u32 v14, s24, v14
    v_mov_b32 v15, 2146435072
    v_cmp_le_u32 vcc, 1, v1
    s_nop 1
    v_cndmask_b32 v14, v14, v15, vcc
    v_mov_b32 v15, 1
    buffer_store_dword v15, v14, s[8:11], 0 offen sc1
interleave_layers__linear_attn_block__memory_aug_recurrent_mem_tr__prompt_kernel_pb27:
interleave_layers__linear_attn_block__memory_aug_recurrent_mem_tr__prompt_kernel_rk24:
    s_sub_u32 s44, s2, 64
    v_lshlrev_b32 v5, 4, v1
    s_lshl_b32 s24, s44, 15
    s_lshl_b32 s25, s3, 13
    s_add_u32 s24, s24, s25
    v_add_u32 v6, s24, v5
    v_add_u32 v7, 4096, v6
    s_lshl_b32 s24, s3, 12
    s_and_b32 s25, s24, 0x2000
    s_add_u32 s24, s24, s25
    v_add_u32 v8, s24, v5
    s_lshl_b32 s24, s3, 10
    s_add_u32 s24, s24, 32768
    v_add_u32 v9, s24, v5
    s_lshl_b32 s24, s44, 14
    s_lshl_b32 s25, s3, 11
    s_add_u32 s24, s24, s25
    v_add_u32 v10, s24, v5
    v_and_b32 v204, 7, v2
    v_mul_u32_u24 v11, 80, v204
    v_lshl_add_u32 v11, v3, 4, v11
    s_mul_i32 s24, s3, 640
    v_add_u32 v11, s24, v11
    v_add_u32 v204, 8192, v5
    v_cmp_gt_u32 vcc, 8, v2
    s_nop 1
    v_cndmask_b32 v11, v204, v11, vcc
    v_and_b32 v204, 7, v2
    v_mul_u32_u24 v12, 80, v204
    v_lshrrev_b32 v204, 3, v2
    v_lshl_add_u32 v12, v204, 5, v12
    v_lshlrev_b32 v13, 4, v2
    s_lshl_b32 s24, s44, 8
    s_and_b32 s25, s24, 0x2000
    s_add_u32 s24, s24, s25
    v_add_u32 v13, s24, v13
    v_mov_b32 v204, 2146435072
    v_cmp_gt_u32 vcc, 1, v3
    s_nop 1
    v_cndmask_b32 v13, v204, v13, vcc
    v_cmp_le_u32 s[50:51], 8, v2
    s_and_b32 s25, s44, 15
    s_lshr_b32 s25, s25, 2
    s_sub_u32 s26, s44, 32
    s_lshr_b32 s26, s26, 1
    s_cmp_ge_u32 s44, 32
    s_cselect_b32 s25, s26, s25
    s_mul_i32 s24, s25, 16
    v_add_u32 v120, s24, v1
    v_lshlrev_b32 v120, 7, v120
    v_mov_b32 v204, 2146435072
    v_cmp_le_u32 vcc, 16, v1
    s_nop 1
    v_cndmask_b32 v120, v120, v204, vcc
    s_and_b32 s24, s44, 7
    s_mul_i32 s25, s3, 8
    s_add_u32 s24, s24, s25
    s_lshl_b32 s24, s24, 7
    v_mov_b32 v125, s24
    v_mov_b32 v122, 12288
    v_mov_b32 v123, 0
    s_barrier
    ds_write_b32 v122, v123
    v_mov_b32 v123, 1
    s_waitcnt lgkmcnt(0)
    s_barrier
    s_mov_b32 s93, 0
    s_lshl_b32 s24, s93, 12
    s_and_b32 s24, s24, 0x2000
    s_xor_b32 s24, s24, s36
    s_lshl_b32 s93, s93, 20
    s_add_u32 s93, s93, s24
    s_add_u32 s93, s93, 117440512
    s_mul_i32 s94, s92, 16384
    s_add_u32 s94, s94, 23068672
    s_mov_b32 s40, 0
    s_mov_b32 s41, 184549376
    s_add_u32 s45, s93, 753664
    s_add_u32 s46, s93, 737280
    s_add_u32 s43, s93, 655360
    s_add_u32 s42, s93, 0
    s_add_u32 s47, s93, 704512
    v_and_b32 v252, 7, v1
    v_lshlrev_b32 v252, 7, v252
    s_lshl_b32 s24, s3, 10
    s_add_u32 s24, s24, 12288
    s_add_u32 s24, s24, s94
    v_add_u32 v252, s24, v252
    s_mov_b32 s62, -1
    s_mov_b32 s63, 1
    s_cmp_ge_i32 s62, s63
    s_cbranch_scc1 interleave_layers__linear_attn_block__memory_aug_recurrent_mem_tr__prompt_kernel_r_en0_ok
    s_mov_b32 s61, 0
interleave_layers__linear_attn_block__memory_aug_recurrent_mem_tr__prompt_kernel_r_en0:
    buffer_load_dword v253, v252, s[8:11], 0 offen sc1
    s_waitcnt vmcnt(0)
    v_readlane_b32 s62, v253, 0
    v_readlane_b32 s24, v253, 1
    s_min_i32 s62, s62, s24
    v_readlane_b32 s24, v253, 2
    s_min_i32 s62, s62, s24
    v_readlane_b32 s24, v253, 3
    s_min_i32 s62, s62, s24
    v_readlane_b32 s24, v253, 4
    s_min_i32 s62, s62, s24
    v_readlane_b32 s24, v253, 5
    s_min_i32 s62, s62, s24
    v_readlane_b32 s24, v253, 6
    s_min_i32 s62, s62, s24
    v_readlane_b32 s24, v253, 7
    s_min_i32 s62, s62, s24
    s_cmp_ge_i32 s62, s63
    s_cbranch_scc1 interleave_layers__linear_attn_block__memory_aug_recurrent_mem_tr__prompt_kernel_r_en0_ok
    s_add_u32 s61, s61, 1
    s_cmp_ge_u32 s61, s60
    s_cbranch_scc1 interleave_layers__linear_attn_block__memory_aug_recurrent_mem_tr__prompt_kernel_r_en0_to
    s_sleep 2
    s_branch interleave_layers__linear_attn_block__memory_aug_recurrent_mem_tr__prompt_kernel_r_en0
interleave_layers__linear_attn_block__memory_aug_recurrent_mem_tr__prompt_kernel_r_en0_to:
    s_mov_b32 s60, 1
interleave_layers__linear_attn_block__memory_aug_recurrent_mem_tr__prompt_kernel_r_en0_ok:
    buffer_load_dwordx4 v[48:51], v6, s[8:11], s41 offen offset:0 sc1
    buffer_load_dwordx4 v[52:55], v6, s[8:11], s41 offen offset:1024 sc1
    buffer_load_dwordx4 v[56:59], v6, s[8:11], s41 offen offset:2048 sc1
    buffer_load_dwordx4 v[60:63], v6, s[8:11], s41 offen offset:3072 sc1
    buffer_load_dwordx4 v[64:67], v7, s[8:11], s41 offen offset:0 sc1
    buffer_load_dwordx4 v[68:71], v7, s[8:11], s41 offen offset:1024 sc1
    buffer_load_dwordx4 v[72:75], v7, s[8:11], s41 offen offset:2048 sc1
    buffer_load_dwordx4 v[76:79], v7, s[8:11], s41 offen offset:3072 sc1
    s_add_u32 s41, s41, 1310720
interleave_layers__linear_attn_block__memory_aug_recurrent_mem_tr__prompt_kernel_r_step:
    s_waitcnt vmcnt(0)
    v_mov_b32 v16, v48
    v_mov_b32 v17, v49
    v_mov_b32 v18, v50
    v_mov_b32 v19, v51
    v_mov_b32 v20, v52
    v_mov_b32 v21, v53
    v_mov_b32 v22, v54
    v_mov_b32 v23, v55
    v_mov_b32 v24, v56
    v_mov_b32 v25, v57
    v_mov_b32 v26, v58
    v_mov_b32 v27, v59
    v_mov_b32 v28, v60
    v_mov_b32 v29, v61
    v_mov_b32 v30, v62
    v_mov_b32 v31, v63
    v_mov_b32 v32, v64
    v_mov_b32 v33, v65
    v_mov_b32 v34, v66
    v_mov_b32 v35, v67
    v_mov_b32 v36, v68
    v_mov_b32 v37, v69
    v_mov_b32 v38, v70
    v_mov_b32 v39, v71
    v_mov_b32 v40, v72
    v_mov_b32 v41, v73
    v_mov_b32 v42, v74
    v_mov_b32 v43, v75
    v_mov_b32 v44, v76
    v_mov_b32 v45, v77
    v_mov_b32 v46, v78
    v_mov_b32 v47, v79
    s_lshl_b32 s95, s92, 6
    s_add_u32 s95, s95, s40
    s_add_u32 s95, s95, 1
    s_cmp_ge_i32 s59, s95
    s_cbranch_scc1 interleave_layers__linear_attn_block__memory_aug_recurrent_mem_tr__prompt_kernel_r_ec_ok
    s_and_b32 s24, s2, 7
    s_lshl_b32 s24, s24, 7
    s_add_u32 s24, s24, 23109632
    v_and_b32 v254, 3, v1
    v_lshl_add_u32 v254, v254, 2, s24
    s_mov_b32 s61, 0
interleave_layers__linear_attn_block__memory_aug_recurrent_mem_tr__prompt_kernel_r_ec:
    buffer_load_dword v253, v254, s[8:11], 0 offen sc1
    s_waitcnt vmcnt(0)
    v_readlane_b32 s59, v253, 0
    v_readlane_b32 s24, v253, 1
    s_min_i32 s59, s59, s24
    v_readlane_b32 s24, v253, 2
    s_min_i32 s59, s59, s24
    s_cmp_ge_i32 s59, s95
    s_cbranch_scc1 interleave_layers__linear_attn_block__memory_aug_recurrent_mem_tr__prompt_kernel_r_ec_ok
    s_add_u32 s61, s61, 1
    s_cmp_ge_u32 s61, s60
    s_cbranch_scc1 interleave_layers__linear_attn_block__memory_aug_recurrent_mem_tr__prompt_kernel_r_ec_to
    s_sleep 2
    s_branch interleave_layers__linear_attn_block__memory_aug_recurrent_mem_tr__prompt_kernel_r_ec
interleave_layers__linear_attn_block__memory_aug_recurrent_mem_tr__prompt_kernel_r_ec_to:
    s_mov_b32 s60, 1
interleave_layers__linear_attn_block__memory_aug_recurrent_mem_tr__prompt_kernel_r_ec_ok:
    s_mov_b64 exec, 1
    s_mov_b32 s61, 0
    v_mov_b32 v117, 0
    buffer_atomic_add v117, v125, s[8:11], s45 offen sc0
    s_sleep 2
    v_mov_b32 v118, 0
    buffer_atomic_add v118, v125, s[8:11], s45 offen sc0
    s_sleep 2
    v_mov_b32 v119, 0
    buffer_atomic_add v119, v125, s[8:11], s45 offen sc0
    s_sleep 2
interleave_layers__linear_attn_block__memory_aug_recurrent_mem_tr__prompt_kernel_r_pr:
    v_mov_b32 v116, 0
    buffer_atomic_add v116, v125, s[8:11], s45 offen sc0
    s_waitcnt vmcnt(3)
    v_cmp_le_i32 vcc, 7, v117
    s_add_u32 s61, s61, 1
    s_cbranch_vccnz interleave_layers__linear_attn_block__memory_aug_recurrent_mem_tr__prompt_kernel_r_pr_out
    s_sleep 2
    v_mov_b32 v117, 0
    buffer_atomic_add v117, v125, s[8:11], s45 offen sc0
    s_waitcnt vmcnt(3)
    v_cmp_le_i32 vcc, 7, v118
    s_add_u32 s61, s61, 1
    s_cbranch_vccnz interleave_layers__linear_attn_block__memory_aug_recurrent_mem_tr__prompt_kernel_r_pr_out
    s_sleep 2
    v_mov_b32 v118, 0
    buffer_atomic_add v118, v125, s[8:11], s45 offen sc0
    s_waitcnt vmcnt(3)
    v_cmp_le_i32 vcc, 7, v119
    s_add_u32 s61, s61, 1
    s_cbranch_vccnz interleave_layers__linear_attn_block__memory_aug_recurrent_mem_tr__prompt_kernel_r_pr_out
    s_sleep 2
    v_mov_b32 v119, 0
    buffer_atomic_add v119, v125, s[8:11], s45 offen sc0
    s_waitcnt vmcnt(3)
    v_cmp_le_i32 vcc, 7, v116
    s_add_u32 s61, s61, 1
    s_cbranch_vccnz interleave_layers__linear_attn_block__memory_aug_recurrent_mem_tr__prompt_kernel_r_pr_out
    s_sleep 2
    s_cmp_ge_u32 s61, s60
    s_cbranch_scc0 interleave_layers__linear_attn_block__memory_aug_recurrent_mem_tr__prompt_kernel_r_pr
    s_mov_b32 s60, 1
interleave_layers__linear_attn_block__memory_aug_recurrent_mem_tr__prompt_kernel_r_pr_out:
    s_mov_b64 exec, -1
    buffer_load_dwordx4 v[100:103], v10, s[8:11], s42 offen offset:0 sc1
    buffer_load_dwordx4 v[104:107], v10, s[8:11], s42 offen offset:1024 sc1
    buffer_load_dwordx4 v[80:83], v8, s[8:11], s43 offen offset:0 sc1
    buffer_load_dwordx4 v[84:87], v8, s[8:11], s43 offen offset:1024 sc1
    buffer_load_dwordx4 v[88:91], v8, s[8:11], s43 offen offset:2048 sc1
    buffer_load_dwordx4 v[92:95], v8, s[8:11], s43 offen offset:3072 sc1
    buffer_load_dwordx4 v[96:99], v9, s[8:11], s43 offen sc1
    s_waitcnt vmcnt(0)
    v_max3_u32 v204, v80, v81, v82
    v_max3_u32 v204, v204, v83, v84
    v_max3_u32 v204, v204, v85, v86
    v_max3_u32 v204, v204, v87, v88
    v_max3_u32 v204, v204, v89, v90
    v_max3_u32 v204, v204, v91, v92
    v_max3_u32 v204, v204, v93, v94
    v_max3_u32 v204, v204, v95, v96
    v_max3_u32 v204, v204, v97, v98
    v_max3_u32 v204, v204, v99, v100
    v_max3_u32 v204, v204, v101, v102
    v_max3_u32 v204, v204, v103, v104
    v_max3_u32 v204, v204, v105, v106
    v_max_u32 v204, v204, v107
    v_cmp_eq_u32 vcc, -1, v204
    s_cbranch_vccz interleave_layers__linear_attn_block__memory_aug_recurrent_mem_tr__prompt_kernel_r_p_out
    s_mov_b32 s61, 0
interleave_layers__linear_attn_block__memory_aug_recurrent_mem_tr__prompt_kernel_r_p:
    buffer_load_dwordx4 v[100:103], v10, s[8:11], s42 offen offset:0 sc1
    buffer_load_dwordx4 v[104:107], v10, s[8:11], s42 offen offset:1024 sc1
    buffer_load_dwordx4 v[80:83], v8, s[8:11], s43 offen offset:0 sc1
    buffer_load_dwordx4 v[84:87], v8, s[8:11], s43 offen offset:1024 sc1
    buffer_load_dwordx4 v[88:91], v8, s[8:11], s43 offen offset:2048 sc1
    buffer_load_dwordx4 v[92:95], v8, s[8:11], s43 offen offset:3072 sc1
    buffer_load_dwordx4 v[96:99], v9, s[8:11], s43 offen sc1
    s_waitcnt vmcnt(0)
    v_max3_u32 v204, v80, v81, v82
    v_max3_u32 v204, v204, v83, v84
    v_max3_u32 v204, v204, v85, v86
    v_max3_u32 v204, v204, v87, v88
    v_max3_u32 v204, v204, v89, v90
    v_max3_u32 v204, v204, v91, v92
    v_max3_u32 v204, v204, v93, v94
    v_max3_u32 v204, v204, v95, v96
    v_max3_u32 v204, v204, v97, v98
    v_max3_u32 v204, v204, v99, v100
    v_max3_u32 v204, v204, v101, v102
    v_max3_u32 v204, v204, v103, v104
    v_max3_u32 v204, v204, v105, v106
    v_max_u32 v204, v204, v107
    v_cmp_eq_u32 vcc, -1, v204
    s_add_u32 s61, s61, 1
    s_cbranch_vccz interleave_layers__linear_attn_block__memory_aug_recurrent_mem_tr__prompt_kernel_r_p_out
    s_cmp_ge_u32 s61, s60
    s_cbranch_scc1 interleave_layers__linear_attn_block__memory_aug_recurrent_mem_tr__prompt_kernel_r_p_to
    s_sleep 1
    s_branch interleave_layers__linear_attn_block__memory_aug_recurrent_mem_tr__prompt_kernel_r_p
interleave_layers__linear_attn_block__memory_aug_recurrent_mem_tr__prompt_kernel_r_p_to:
    s_mov_b32 s60, 1
interleave_layers__linear_attn_block__memory_aug_recurrent_mem_tr__prompt_kernel_r_p_out:
    s_mov_b64 exec, 1
    ds_add_rtn_u32 v124, v122, v123
    s_mov_b64 exec, -1
    v_mfma_f32_16x16x32_bf16 v[108:111], v[100:103], v[96:99], 0
    v_mfma_f32_16x16x32_bf16 v[112:115], v[104:107], v[96:99], 0
    v_mfma_f32_16x16x32_bf16 v[108:111], v[16:19], v[80:83], v[108:111]
    v_mfma_f32_16x16x32_bf16 v[112:115], v[20:23], v[80:83], v[112:115]
    s_waitcnt lgkmcnt(0)
    v_readfirstlane_b32 s24, v124
    s_and_b32 s24, s24, 3
    s_cmp_eq_u32 s24, 3
    s_cbranch_scc0 interleave_layers__linear_attn_block__memory_aug_recurrent_mem_tr__prompt_kernel_nh28
    buffer_atomic_add v123, v120, s[8:11], s46 offen
interleave_layers__linear_attn_block__memory_aug_recurrent_mem_tr__prompt_kernel_nh28:
    v_mfma_f32_16x16x32_bf16 v[108:111], v[24:27], v[84:87], v[108:111]
    v_mfma_f32_16x16x32_bf16 v[112:115], v[28:31], v[84:87], v[112:115]
    v_mfma_f32_16x16x32_bf16 v[108:111], v[32:35], v[88:91], v[108:111]
    v_mfma_f32_16x16x32_bf16 v[112:115], v[36:39], v[88:91], v[112:115]
    v_mfma_f32_16x16x32_bf16 v[108:111], v[40:43], v[92:95], v[108:111]
    v_mfma_f32_16x16x32_bf16 v[112:115], v[44:47], v[92:95], v[112:115]
    s_and_b32 s24, s40, 1
    s_mul_i32 s24, s24, 2560
    v_add_u32 v14, s24, v11
    v_add_u32 v15, s24, v12
    s_nop 3
    v_cndmask_b32 v108, v108, v112, s[50:51]
    v_cndmask_b32 v109, v109, v113, s[50:51]
    v_cndmask_b32 v110, v110, v114, s[50:51]
    v_cndmask_b32 v111, v111, v115, s[50:51]
    v_add_f32 v108, v108, v108 row_ror:8 row_mask:0xf bank_mask:0xf
    v_add_f32 v109, v109, v109 row_ror:8 row_mask:0xf bank_mask:0xf
    v_add_f32 v110, v110, v110 row_ror:8 row_mask:0xf bank_mask:0xf
    v_add_f32 v111, v111, v111 row_ror:8 row_mask:0xf bank_mask:0xf
    ds_write_b128 v14, v[108:111]
    s_waitcnt lgkmcnt(0)
    s_barrier
    s_cmp_eq_u32 s3, 0
    s_cbranch_scc0 interleave_layers__linear_attn_block__memory_aug_recurrent_mem_tr__prompt_kernel_np29
    ds_read_b128 v[220:223], v15 offset:0
    ds_read_b128 v[224:227], v15 offset:16
    ds_read_b128 v[228:231], v15 offset:640
    ds_read_b128 v[232:235], v15 offset:656
    ds_read_b128 v[236:239], v15 offset:1280
    ds_read_b128 v[240:243], v15 offset:1296
    ds_read_b128 v[244:247], v15 offset:1920
    ds_read_b128 v[248:251], v15 offset:1936
    s_waitcnt lgkmcnt(4)
    v_pk_add_f32 v[220:221], v[220:221], v[228:229]
    v_pk_add_f32 v[222:223], v[222:223], v[230:231]
    v_pk_add_f32 v[224:225], v[224:225], v[232:233]
    v_pk_add_f32 v[226:227], v[226:227], v[234:235]
    s_waitcnt lgkmcnt(0)
    v_pk_add_f32 v[236:237], v[236:237], v[244:245]
    v_pk_add_f32 v[238:239], v[238:239], v[246:247]
    v_pk_add_f32 v[240:241], v[240:241], v[248:249]
    v_pk_add_f32 v[242:243], v[242:243], v[250:251]
    v_pk_add_f32 v[220:221], v[220:221], v[236:237]
    v_pk_add_f32 v[222:223], v[222:223], v[238:239]
    v_pk_add_f32 v[224:225], v[224:225], v[240:241]
    v_pk_add_f32 v[226:227], v[226:227], v[242:243]
    v_cvt_pk_bf16_f32 v228, v220, v221
    v_cvt_pk_bf16_f32 v229, v222, v223
    v_cvt_pk_bf16_f32 v230, v224, v225
    v_cvt_pk_bf16_f32 v231, v226, v227
    v_min_u32 v228, -2, v228
    v_min_u32 v229, -2, v229
    v_min_u32 v230, -2, v230
    v_min_u32 v231, -2, v231
    buffer_store_dwordx4 v[228:231], v13, s[8:11], s47 offen sc1
interleave_layers__linear_attn_block__memory_aug_recurrent_mem_tr__prompt_kernel_np29:
    s_cmp_eq_u32 s3, 1
    s_cbranch_scc0 interleave_layers__linear_attn_block__memory_aug_recurrent_mem_tr__prompt_kernel_xf30
    s_cmp_eq_u32 s44, 39
    s_cbranch_scc0 interleave_layers__linear_attn_block__memory_aug_recurrent_mem_tr__prompt_kernel_xf30
    s_lshl_b32 s24, s92, 6
    s_add_u32 s24, s24, s40
    s_add_u32 s24, s24, 1
    v_lshlrev_b32 v204, 7, v1
    v_add_u32 v204, 23111680, v204
    v_mov_b32 v205, 2146435072
    v_cmp_le_u32 vcc, 8, v1
    s_nop 1
    v_cndmask_b32 v204, v204, v205, vcc
    v_mov_b32 v205, s24
    buffer_store_dword v205, v204, s[8:11], 0 offen sc1
interleave_layers__linear_attn_block__memory_aug_recurrent_mem_tr__prompt_kernel_xf30:
    s_add_u32 s63, s40, 2
    s_min_u32 s63, s63, 64
    s_sleep 18
    s_cmp_ge_i32 s62, s63
    s_cbranch_scc1 interleave_layers__linear_attn_block__memory_aug_recurrent_mem_tr__prompt_kernel_r_en_ok
    s_mov_b32 s61, 0
interleave_layers__linear_attn_block__memory_aug_recurrent_mem_tr__prompt_kernel_r_en:
    buffer_load_dword v253, v252, s[8:11], 0 offen sc1
    s_waitcnt vmcnt(0)
    v_readlane_b32 s62, v253, 0
    v_readlane_b32 s24, v253, 1
    s_min_i32 s62, s62, s24
    v_readlane_b32 s24, v253, 2
    s_min_i32 s62, s62, s24
    v_readlane_b32 s24, v253, 3
    s_min_i32 s62, s62, s24
    v_readlane_b32 s24, v253, 4
    s_min_i32 s62, s62, s24
    v_readlane_b32 s24, v253, 5
    s_min_i32 s62, s62, s24
    v_readlane_b32 s24, v253, 6
    s_min_i32 s62, s62, s24
    v_readlane_b32 s24, v253, 7
    s_min_i32 s62, s62, s24
    s_cmp_ge_i32 s62, s63
    s_cbranch_scc1 interleave_layers__linear_attn_block__memory_aug_recurrent_mem_tr__prompt_kernel_r_en_ok
    s_add_u32 s61, s61, 1
    s_cmp_ge_u32 s61, s60
    s_cbranch_scc1 interleave_layers__linear_attn_block__memory_aug_recurrent_mem_tr__prompt_kernel_r_en_to
    s_sleep 2
    s_branch interleave_layers__linear_attn_block__memory_aug_recurrent_mem_tr__prompt_kernel_r_en
interleave_layers__linear_attn_block__memory_aug_recurrent_mem_tr__prompt_kernel_r_en_to:
    s_mov_b32 s60, 1
interleave_layers__linear_attn_block__memory_aug_recurrent_mem_tr__prompt_kernel_r_en_ok:
    buffer_load_dwordx4 v[48:51], v6, s[8:11], s41 offen offset:0 sc1
    buffer_load_dwordx4 v[52:55], v6, s[8:11], s41 offen offset:1024 sc1
    buffer_load_dwordx4 v[56:59], v6, s[8:11], s41 offen offset:2048 sc1
    buffer_load_dwordx4 v[60:63], v6, s[8:11], s41 offen offset:3072 sc1
    buffer_load_dwordx4 v[64:67], v7, s[8:11], s41 offen offset:0 sc1
    buffer_load_dwordx4 v[68:71], v7, s[8:11], s41 offen offset:1024 sc1
    buffer_load_dwordx4 v[72:75], v7, s[8:11], s41 offen offset:2048 sc1
    buffer_load_dwordx4 v[76:79], v7, s[8:11], s41 offen offset:3072 sc1
    s_add_u32 s41, s41, 1310720
    s_add_u32 s40, s40, 1
    s_lshl_b32 s24, s40, 12
    s_and_b32 s24, s24, 0x2000
    s_xor_b32 s24, s24, s36
    s_lshl_b32 s37, s40, 20
    s_add_u32 s37, s37, s24
    s_add_u32 s37, s37, 117440512
    s_add_u32 s42, s37, 0
    s_add_u32 s43, s37, 655360
    s_add_u32 s47, s37, 704512
    s_add_u32 s45, s37, 753664
    s_add_u32 s46, s37, 737280
    s_cmp_lt_u32 s40, 64
    s_cbranch_scc1 interleave_layers__linear_attn_block__memory_aug_recurrent_mem_tr__prompt_kernel_r_step
    s_waitcnt vmcnt(0)
    s_cmp_eq_u32 s92, 0
    s_cbranch_scc0 interleave_layers__linear_attn_block__memory_aug_recurrent_mem_tr__prompt_kernel_end
    s_mov_b32 s92, 1
    s_branch interleave_layers__linear_attn_block__memory_aug_recurrent_mem_tr__prompt_kernel_r_top
interleave_layers__linear_attn_block__memory_aug_recurrent_mem_tr__prompt_kernel_roleP:
    s_sub_u32 s44, s2, 104
    s_lshr_b32 s46, s44, 5
    s_and_b32 s44, s44, 31
    s_load_dwordx2 s[6:7], s[0:1], 40
    s_load_dwordx2 s[24:25], s[0:1], 48
    s_load_dwordx2 s[26:27], s[0:1], 56
    s_waitcnt lgkmcnt(0)
    s_cmp_eq_u32 s46, 1
    s_cselect_b32 s6, s24, s6
    s_cselect_b32 s7, s25, s7
    s_cmp_eq_u32 s46, 2
    s_cselect_b32 s6, s26, s6
    s_cselect_b32 s7, s27, s7
    s_mov_b32 s12, s6
    s_mov_b32 s13, s7
    s_mov_b32 s14, 7864320
    s_mov_b32 s15, 0x00020000
    v_add_u32 v16, 0, v0
    s_mov_b32 s24, 683
    v_mul_lo_u32 v17, v16, s24
    v_lshrrev_b32 v17, 14, v17
    v_mul_u32_u24 v18, 24, v17
    v_sub_u32 v18, v16, v18
    s_mov_b32 s24, 12288
    v_mul_lo_u32 v4, v17, s24
    v_lshl_add_u32 v4, v18, 4, v4
    v_mul_u32_u24 v10, 400, v17
    v_lshl_add_u32 v10, v18, 4, v10
    v_add_u32 v10, 81920, v10
    v_add_u32 v16, 256, v0
    s_mov_b32 s24, 683
    v_mul_lo_u32 v17, v16, s24
    v_lshrrev_b32 v17, 14, v17
    v_mul_u32_u24 v18, 24, v17
    v_sub_u32 v18, v16, v18
    s_mov_b32 s24, 12288
    v_mul_lo_u32 v5, v17, s24
    v_lshl_add_u32 v5, v18, 4, v5
    v_mul_u32_u24 v11, 400, v17
    v_lshl_add_u32 v11, v18, 4, v11
    v_add_u32 v11, 81920, v11
    v_add_u32 v16, 512, v0
    s_mov_b32 s24, 683
    v_mul_lo_u32 v17, v16, s24
    v_lshrrev_b32 v17, 14, v17
    v_mul_u32_u24 v18, 24, v17
    v_sub_u32 v18, v16, v18
    s_mov_b32 s24, 12288
    v_mul_lo_u32 v6, v17, s24
    v_lshl_add_u32 v6, v18, 4, v6
    v_mul_u32_u24 v12, 400, v17
    v_lshl_add_u32 v12, v18, 4, v12
    v_add_u32 v12, 81920, v12
    v_add_u32 v16, 768, v0
    s_mov_b32 s24, 683
    v_mul_lo_u32 v17, v16, s24
    v_lshrrev_b32 v17, 14, v17
    v_mul_u32_u24 v18, 24, v17
    v_sub_u32 v18, v16, v18
    s_mov_b32 s24, 12288
    v_mul_lo_u32 v7, v17, s24
    v_lshl_add_u32 v7, v18, 4, v7
    v_mul_u32_u24 v13, 400, v17
    v_lshl_add_u32 v13, v18, 4, v13
    v_add_u32 v13, 81920, v13
    v_add_u32 v16, 1024, v0
    s_mov_b32 s24, 683
    v_mul_lo_u32 v17, v16, s24
    v_lshrrev_b32 v17, 14, v17
    v_mul_u32_u24 v18, 24, v17
    v_sub_u32 v18, v16, v18
    s_mov_b32 s24, 12288
    v_mul_lo_u32 v8, v17, s24
    v_lshl_add_u32 v8, v18, 4, v8
    v_mul_u32_u24 v14, 400, v17
    v_lshl_add_u32 v14, v18, 4, v14
    v_add_u32 v14, 81920, v14
    v_add_u32 v16, 1280, v0
    s_mov_b32 s24, 683
    v_mul_lo_u32 v17, v16, s24
    v_lshrrev_b32 v17, 14, v17
    v_mul_u32_u24 v18, 24, v17
    v_sub_u32 v18, v16, v18
    s_mov_b32 s24, 12288
    v_mul_lo_u32 v9, v17, s24
    v_lshl_add_u32 v9, v18, 4, v9
    v_mul_u32_u24 v15, 400, v17
    v_lshl_add_u32 v15, v18, 4, v15
    v_add_u32 v15, 81920, v15
    v_lshrrev_b32 v16, 2, v2
    v_lshl_add_u32 v16, v3, 2, v16
    v_mul_u32_u24 v32, 400, v16
    v_and_b32 v16, 3, v2
    v_lshl_add_u32 v32, v16, 3, v32
    s_mul_i32 s24, s3, 96
    s_add_u32 s24, s24, 81920
    v_add_u32 v32, s24, v32
    s_mul_i32 s45, s44, 384
    s_add_u32 s47, s45, 0
    buffer_load_dwordx4 v[56:59], v4, s[12:15], s47 offen
    buffer_load_dwordx4 v[60:63], v5, s[12:15], s47 offen
    buffer_load_dwordx4 v[64:67], v6, s[12:15], s47 offen
    buffer_load_dwordx4 v[68:71], v7, s[12:15], s47 offen
    buffer_load_dwordx4 v[72:75], v8, s[12:15], s47 offen
    buffer_load_dwordx4 v[76:79], v9, s[12:15], s47 offen
    s_add_u32 s47, s45, 786432
    buffer_load_dwordx4 v[80:83], v4, s[12:15], s47 offen
    buffer_load_dwordx4 v[84:87], v5, s[12:15], s47 offen
    buffer_load_dwordx4 v[88:91], v6, s[12:15], s47 offen
    buffer_load_dwordx4 v[92:95], v7, s[12:15], s47 offen
    buffer_load_dwordx4 v[96:99], v8, s[12:15], s47 offen
    buffer_load_dwordx4 v[100:103], v9, s[12:15], s47 offen
    s_add_u32 s47, s45, 1572864
    buffer_load_dwordx4 v[104:107], v4, s[12:15], s47 offen
    buffer_load_dwordx4 v[108:111], v5, s[12:15], s47 offen
    buffer_load_dwordx4 v[112:115], v6, s[12:15], s47 offen
    buffer_load_dwordx4 v[116:119], v7, s[12:15], s47 offen
    buffer_load_dwordx4 v[120:123], v8, s[12:15], s47 offen
    buffer_load_dwordx4 v[124:127], v9, s[12:15], s47 offen
    s_add_u32 s47, s45, 2359296
    buffer_load_dwordx4 v[128:131], v4, s[12:15], s47 offen
    buffer_load_dwordx4 v[132:135], v5, s[12:15], s47 offen
    buffer_load_dwordx4 v[136:139], v6, s[12:15], s47 offen
    buffer_load_dwordx4 v[140:143], v7, s[12:15], s47 offen
    buffer_load_dwordx4 v[144:147], v8, s[12:15], s47 offen
    buffer_load_dwordx4 v[148:151], v9, s[12:15], s47 offen
    s_add_u32 s47, s45, 3145728
    buffer_load_dwordx4 v[152:155], v4, s[12:15], s47 offen
    buffer_load_dwordx4 v[156:159], v5, s[12:15], s47 offen
    buffer_load_dwordx4 v[160:163], v6, s[12:15], s47 offen
    buffer_load_dwordx4 v[164:167], v7, s[12:15], s47 offen
    buffer_load_dwordx4 v[168:171], v8, s[12:15], s47 offen
    buffer_load_dwordx4 v[172:175], v9, s[12:15], s47 offen
    s_add_u32 s47, s45, 3932160
    buffer_load_dwordx4 v[176:179], v4, s[12:15], s47 offen
    buffer_load_dwordx4 v[180:183], v5, s[12:15], s47 offen
    buffer_load_dwordx4 v[184:187], v6, s[12:15], s47 offen
    buffer_load_dwordx4 v[188:191], v7, s[12:15], s47 offen
    buffer_load_dwordx4 v[192:195], v8, s[12:15], s47 offen
    buffer_load_dwordx4 v[196:199], v9, s[12:15], s47 offen
    s_add_u32 s47, s45, 4718592
    buffer_load_dwordx4 v[200:203], v4, s[12:15], s47 offen
    buffer_load_dwordx4 v[204:207], v5, s[12:15], s47 offen
    buffer_load_dwordx4 v[208:211], v6, s[12:15], s47 offen
    buffer_load_dwordx4 v[212:215], v7, s[12:15], s47 offen
    buffer_load_dwordx4 v[216:219], v8, s[12:15], s47 offen
    buffer_load_dwordx4 v[220:223], v9, s[12:15], s47 offen
    s_add_u32 s47, s45, 5505024
    buffer_load_dwordx4 v[224:227], v4, s[12:15], s47 offen
    buffer_load_dwordx4 v[228:231], v5, s[12:15], s47 offen
    buffer_load_dwordx4 v[232:235], v6, s[12:15], s47 offen
    buffer_load_dwordx4 v[236:239], v7, s[12:15], s47 offen
    buffer_load_dwordx4 v[240:243], v8, s[12:15], s47 offen
    buffer_load_dwordx4 v[244:247], v9, s[12:15], s47 offen
    v_mov_b32 v28, 0x3f803f80
    v_mov_b32 v29, 0x3f803f80
    v_mov_b32 v30, 0x3f803f80
    v_mov_b32 v31, 0x3f803f80
    s_waitcnt vmcnt(42)
    ds_write_b128 v10, v[56:59] offset:0
    ds_write_b128 v11, v[60:63] offset:0
    ds_write_b128 v12, v[64:67] offset:0
    ds_write_b128 v13, v[68:71] offset:0
    ds_write_b128 v14, v[72:75] offset:0
    ds_write_b128 v15, v[76:79] offset:0
    s_waitcnt lgkmcnt(0)
    s_add_u32 s47, s45, 6291456
    buffer_load_dwordx4 v[56:59], v4, s[12:15], s47 offen
    buffer_load_dwordx4 v[60:63], v5, s[12:15], s47 offen
    buffer_load_dwordx4 v[64:67], v6, s[12:15], s47 offen
    buffer_load_dwordx4 v[68:71], v7, s[12:15], s47 offen
    buffer_load_dwordx4 v[72:75], v8, s[12:15], s47 offen
    buffer_load_dwordx4 v[76:79], v9, s[12:15], s47 offen
    s_barrier
    ds_read_b64_tr_b16 a[0:1], v32 offset:0
    ds_read_b64_tr_b16 a[2:3], v32 offset:6400
    ds_read_b64_tr_b16 a[4:5], v32 offset:12800
    ds_read_b64_tr_b16 a[6:7], v32 offset:19200
    ds_read_b64_tr_b16 a[80:81], v32 offset:32
    ds_read_b64_tr_b16 a[82:83], v32 offset:6432
    ds_read_b64_tr_b16 a[84:85], v32 offset:12832
    ds_read_b64_tr_b16 a[86:87], v32 offset:19232
    ds_read_b64_tr_b16 a[160:161], v32 offset:64
    ds_read_b64_tr_b16 a[162:163], v32 offset:6464
    ds_read_b64_tr_b16 a[164:165], v32 offset:12864
    ds_read_b64_tr_b16 a[166:167], v32 offset:19264
    s_waitcnt vmcnt(42)
    ds_write_b128 v10, v[80:83] offset:25600
    ds_write_b128 v11, v[84:87] offset:25600
    ds_write_b128 v12, v[88:91] offset:25600
    ds_write_b128 v13, v[92:95] offset:25600
    ds_write_b128 v14, v[96:99] offset:25600
    ds_write_b128 v15, v[100:103] offset:25600
    s_waitcnt lgkmcnt(0)
    s_add_u32 s47, s45, 7077888
    buffer_load_dwordx4 v[80:83], v4, s[12:15], s47 offen
    buffer_load_dwordx4 v[84:87], v5, s[12:15], s47 offen
    buffer_load_dwordx4 v[88:91], v6, s[12:15], s47 offen
    buffer_load_dwordx4 v[92:95], v7, s[12:15], s47 offen
    buffer_load_dwordx4 v[96:99], v8, s[12:15], s47 offen
    buffer_load_dwordx4 v[100:103], v9, s[12:15], s47 offen
    v_mfma_f32_16x16x32_bf16 v[16:19], a[0:3], v[28:31], 0
    v_mfma_f32_16x16x32_bf16 v[20:23], a[80:83], v[28:31], 0
    v_mfma_f32_16x16x32_bf16 v[24:27], a[160:163], v[28:31], 0
    v_mfma_f32_16x16x32_bf16 v[16:19], a[4:7], v[28:31], v[16:19]
    v_mfma_f32_16x16x32_bf16 v[20:23], a[84:87], v[28:31], v[20:23]
    v_mfma_f32_16x16x32_bf16 v[24:27], a[164:167], v[28:31], v[24:27]
    s_barrier
    ds_read_b64_tr_b16 a[8:9], v32 offset:25600
    ds_read_b64_tr_b16 a[10:11], v32 offset:32000
    ds_read_b64_tr_b16 a[12:13], v32 offset:38400
    ds_read_b64_tr_b16 a[14:15], v32 offset:44800
    ds_read_b64_tr_b16 a[88:89], v32 offset:25632
    ds_read_b64_tr_b16 a[90:91], v32 offset:32032
    ds_read_b64_tr_b16 a[92:93], v32 offset:38432
    ds_read_b64_tr_b16 a[94:95], v32 offset:44832
    ds_read_b64_tr_b16 a[168:169], v32 offset:25664
    ds_read_b64_tr_b16 a[170:171], v32 offset:32064
    ds_read_b64_tr_b16 a[172:173], v32 offset:38464
    ds_read_b64_tr_b16 a[174:175], v32 offset:44864
    s_waitcnt vmcnt(42)
    ds_write_b128 v10, v[104:107] offset:0
    ds_write_b128 v11, v[108:111] offset:0
    ds_write_b128 v12, v[112:115] offset:0
    ds_write_b128 v13, v[116:119] offset:0
    ds_write_b128 v14, v[120:123] offset:0
    ds_write_b128 v15, v[124:127] offset:0
    s_waitcnt lgkmcnt(0)
    v_mfma_f32_16x16x32_bf16 v[16:19], a[8:11], v[28:31], v[16:19]
    v_mfma_f32_16x16x32_bf16 v[20:23], a[88:91], v[28:31], v[20:23]
    v_mfma_f32_16x16x32_bf16 v[24:27], a[168:171], v[28:31], v[24:27]
    v_mfma_f32_16x16x32_bf16 v[16:19], a[12:15], v[28:31], v[16:19]
    v_mfma_f32_16x16x32_bf16 v[20:23], a[92:95], v[28:31], v[20:23]
    v_mfma_f32_16x16x32_bf16 v[24:27], a[172:175], v[28:31], v[24:27]
    s_barrier
    ds_read_b64_tr_b16 a[16:17], v32 offset:0
    ds_read_b64_tr_b16 a[18:19], v32 offset:6400
    ds_read_b64_tr_b16 a[20:21], v32 offset:12800
    ds_read_b64_tr_b16 a[22:23], v32 offset:19200
    ds_read_b64_tr_b16 a[96:97], v32 offset:32
    ds_read_b64_tr_b16 a[98:99], v32 offset:6432
    ds_read_b64_tr_b16 a[100:101], v32 offset:12832
    ds_read_b64_tr_b16 a[102:103], v32 offset:19232
    ds_read_b64_tr_b16 a[176:177], v32 offset:64
    ds_read_b64_tr_b16 a[178:179], v32 offset:6464
    ds_read_b64_tr_b16 a[180:181], v32 offset:12864
    ds_read_b64_tr_b16 a[182:183], v32 offset:19264
    s_waitcnt vmcnt(36)
    ds_write_b128 v10, v[128:131] offset:25600
    ds_write_b128 v11, v[132:135] offset:25600
    ds_write_b128 v12, v[136:139] offset:25600
    ds_write_b128 v13, v[140:143] offset:25600
    ds_write_b128 v14, v[144:147] offset:25600
    ds_write_b128 v15, v[148:151] offset:25600
    s_waitcnt lgkmcnt(0)
    v_mfma_f32_16x16x32_bf16 v[16:19], a[16:19], v[28:31], v[16:19]
    v_mfma_f32_16x16x32_bf16 v[20:23], a[96:99], v[28:31], v[20:23]
    v_mfma_f32_16x16x32_bf16 v[24:27], a[176:179], v[28:31], v[24:27]
    v_mfma_f32_16x16x32_bf16 v[16:19], a[20:23], v[28:31], v[16:19]
    v_mfma_f32_16x16x32_bf16 v[20:23], a[100:103], v[28:31], v[20:23]
    v_mfma_f32_16x16x32_bf16 v[24:27], a[180:183], v[28:31], v[24:27]
    s_barrier
    ds_read_b64_tr_b16 a[24:25], v32 offset:25600
    ds_read_b64_tr_b16 a[26:27], v32 offset:32000
    ds_read_b64_tr_b16 a[28:29], v32 offset:38400
    ds_read_b64_tr_b16 a[30:31], v32 offset:44800
    ds_read_b64_tr_b16 a[104:105], v32 offset:25632
    ds_read_b64_tr_b16 a[106:107], v32 offset:32032
    ds_read_b64_tr_b16 a[108:109], v32 offset:38432
    ds_read_b64_tr_b16 a[110:111], v32 offset:44832
    ds_read_b64_tr_b16 a[184:185], v32 offset:25664
    ds_read_b64_tr_b16 a[186:187], v32 offset:32064
    ds_read_b64_tr_b16 a[188:189], v32 offset:38464
    ds_read_b64_tr_b16 a[190:191], v32 offset:44864
    s_waitcnt vmcnt(30)
    ds_write_b128 v10, v[152:155] offset:0
    ds_write_b128 v11, v[156:159] offset:0
    ds_write_b128 v12, v[160:163] offset:0
    ds_write_b128 v13, v[164:167] offset:0
    ds_write_b128 v14, v[168:171] offset:0
    ds_write_b128 v15, v[172:175] offset:0
    s_waitcnt lgkmcnt(0)
    v_mfma_f32_16x16x32_bf16 v[16:19], a[24:27], v[28:31], v[16:19]
    v_mfma_f32_16x16x32_bf16 v[20:23], a[104:107], v[28:31], v[20:23]
    v_mfma_f32_16x16x32_bf16 v[24:27], a[184:187], v[28:31], v[24:27]
    v_mfma_f32_16x16x32_bf16 v[16:19], a[28:31], v[28:31], v[16:19]
    v_mfma_f32_16x16x32_bf16 v[20:23], a[108:111], v[28:31], v[20:23]
    v_mfma_f32_16x16x32_bf16 v[24:27], a[188:191], v[28:31], v[24:27]
    s_barrier
    ds_read_b64_tr_b16 a[32:33], v32 offset:0
    ds_read_b64_tr_b16 a[34:35], v32 offset:6400
    ds_read_b64_tr_b16 a[36:37], v32 offset:12800
    ds_read_b64_tr_b16 a[38:39], v32 offset:19200
    ds_read_b64_tr_b16 a[112:113], v32 offset:32
    ds_read_b64_tr_b16 a[114:115], v32 offset:6432
    ds_read_b64_tr_b16 a[116:117], v32 offset:12832
    ds_read_b64_tr_b16 a[118:119], v32 offset:19232
    ds_read_b64_tr_b16 a[192:193], v32 offset:64
    ds_read_b64_tr_b16 a[194:195], v32 offset:6464
    ds_read_b64_tr_b16 a[196:197], v32 offset:12864
    ds_read_b64_tr_b16 a[198:199], v32 offset:19264
    s_waitcnt vmcnt(24)
    ds_write_b128 v10, v[176:179] offset:25600
    ds_write_b128 v11, v[180:183] offset:25600
    ds_write_b128 v12, v[184:187] offset:25600
    ds_write_b128 v13, v[188:191] offset:25600
    ds_write_b128 v14, v[192:195] offset:25600
    ds_write_b128 v15, v[196:199] offset:25600
    s_waitcnt lgkmcnt(0)
    v_mfma_f32_16x16x32_bf16 v[16:19], a[32:35], v[28:31], v[16:19]
    v_mfma_f32_16x16x32_bf16 v[20:23], a[112:115], v[28:31], v[20:23]
    v_mfma_f32_16x16x32_bf16 v[24:27], a[192:195], v[28:31], v[24:27]
    v_mfma_f32_16x16x32_bf16 v[16:19], a[36:39], v[28:31], v[16:19]
    v_mfma_f32_16x16x32_bf16 v[20:23], a[116:119], v[28:31], v[20:23]
    v_mfma_f32_16x16x32_bf16 v[24:27], a[196:199], v[28:31], v[24:27]
    s_barrier
    ds_read_b64_tr_b16 a[40:41], v32 offset:25600
    ds_read_b64_tr_b16 a[42:43], v32 offset:32000
    ds_read_b64_tr_b16 a[44:45], v32 offset:38400
    ds_read_b64_tr_b16 a[46:47], v32 offset:44800
    ds_read_b64_tr_b16 a[120:121], v32 offset:25632
    ds_read_b64_tr_b16 a[122:123], v32 offset:32032
    ds_read_b64_tr_b16 a[124:125], v32 offset:38432
    ds_read_b64_tr_b16 a[126:127], v32 offset:44832
    ds_read_b64_tr_b16 a[200:201], v32 offset:25664
    ds_read_b64_tr_b16 a[202:203], v32 offset:32064
    ds_read_b64_tr_b16 a[204:205], v32 offset:38464
    ds_read_b64_tr_b16 a[206:207], v32 offset:44864
    s_waitcnt vmcnt(18)
    ds_write_b128 v10, v[200:203] offset:0
    ds_write_b128 v11, v[204:207] offset:0
    ds_write_b128 v12, v[208:211] offset:0
    ds_write_b128 v13, v[212:215] offset:0
    ds_write_b128 v14, v[216:219] offset:0
    ds_write_b128 v15, v[220:223] offset:0
    s_waitcnt lgkmcnt(0)
    v_mfma_f32_16x16x32_bf16 v[16:19], a[40:43], v[28:31], v[16:19]
    v_mfma_f32_16x16x32_bf16 v[20:23], a[120:123], v[28:31], v[20:23]
    v_mfma_f32_16x16x32_bf16 v[24:27], a[200:203], v[28:31], v[24:27]
    v_mfma_f32_16x16x32_bf16 v[16:19], a[44:47], v[28:31], v[16:19]
    v_mfma_f32_16x16x32_bf16 v[20:23], a[124:127], v[28:31], v[20:23]
    v_mfma_f32_16x16x32_bf16 v[24:27], a[204:207], v[28:31], v[24:27]
    s_barrier
    ds_read_b64_tr_b16 a[48:49], v32 offset:0
    ds_read_b64_tr_b16 a[50:51], v32 offset:6400
    ds_read_b64_tr_b16 a[52:53], v32 offset:12800
    ds_read_b64_tr_b16 a[54:55], v32 offset:19200
    ds_read_b64_tr_b16 a[128:129], v32 offset:32
    ds_read_b64_tr_b16 a[130:131], v32 offset:6432
    ds_read_b64_tr_b16 a[132:133], v32 offset:12832
    ds_read_b64_tr_b16 a[134:135], v32 offset:19232
    ds_read_b64_tr_b16 a[208:209], v32 offset:64
    ds_read_b64_tr_b16 a[210:211], v32 offset:6464
    ds_read_b64_tr_b16 a[212:213], v32 offset:12864
    ds_read_b64_tr_b16 a[214:215], v32 offset:19264
    s_waitcnt vmcnt(12)
    ds_write_b128 v10, v[224:227] offset:25600
    ds_write_b128 v11, v[228:231] offset:25600
    ds_write_b128 v12, v[232:235] offset:25600
    ds_write_b128 v13, v[236:239] offset:25600
    ds_write_b128 v14, v[240:243] offset:25600
    ds_write_b128 v15, v[244:247] offset:25600
    s_waitcnt lgkmcnt(0)
    v_mfma_f32_16x16x32_bf16 v[16:19], a[48:51], v[28:31], v[16:19]
    v_mfma_f32_16x16x32_bf16 v[20:23], a[128:131], v[28:31], v[20:23]
    v_mfma_f32_16x16x32_bf16 v[24:27], a[208:211], v[28:31], v[24:27]
    v_mfma_f32_16x16x32_bf16 v[16:19], a[52:55], v[28:31], v[16:19]
    v_mfma_f32_16x16x32_bf16 v[20:23], a[132:135], v[28:31], v[20:23]
    v_mfma_f32_16x16x32_bf16 v[24:27], a[212:215], v[28:31], v[24:27]
    s_barrier
    ds_read_b64_tr_b16 a[56:57], v32 offset:25600
    ds_read_b64_tr_b16 a[58:59], v32 offset:32000
    ds_read_b64_tr_b16 a[60:61], v32 offset:38400
    ds_read_b64_tr_b16 a[62:63], v32 offset:44800
    ds_read_b64_tr_b16 a[136:137], v32 offset:25632
    ds_read_b64_tr_b16 a[138:139], v32 offset:32032
    ds_read_b64_tr_b16 a[140:141], v32 offset:38432
    ds_read_b64_tr_b16 a[142:143], v32 offset:44832
    ds_read_b64_tr_b16 a[216:217], v32 offset:25664
    ds_read_b64_tr_b16 a[218:219], v32 offset:32064
    ds_read_b64_tr_b16 a[220:221], v32 offset:38464
    ds_read_b64_tr_b16 a[222:223], v32 offset:44864
    s_waitcnt vmcnt(6)
    ds_write_b128 v10, v[56:59] offset:0
    ds_write_b128 v11, v[60:63] offset:0
    ds_write_b128 v12, v[64:67] offset:0
    ds_write_b128 v13, v[68:71] offset:0
    ds_write_b128 v14, v[72:75] offset:0
    ds_write_b128 v15, v[76:79] offset:0
    s_waitcnt lgkmcnt(0)
    v_mfma_f32_16x16x32_bf16 v[16:19], a[56:59], v[28:31], v[16:19]
    v_mfma_f32_16x16x32_bf16 v[20:23], a[136:139], v[28:31], v[20:23]
    v_mfma_f32_16x16x32_bf16 v[24:27], a[216:219], v[28:31], v[24:27]
    v_mfma_f32_16x16x32_bf16 v[16:19], a[60:63], v[28:31], v[16:19]
    v_mfma_f32_16x16x32_bf16 v[20:23], a[140:143], v[28:31], v[20:23]
    v_mfma_f32_16x16x32_bf16 v[24:27], a[220:223], v[28:31], v[24:27]
    s_barrier
    ds_read_b64_tr_b16 a[64:65], v32 offset:0
    ds_read_b64_tr_b16 a[66:67], v32 offset:6400
    ds_read_b64_tr_b16 a[68:69], v32 offset:12800
    ds_read_b64_tr_b16 a[70:71], v32 offset:19200
    ds_read_b64_tr_b16 a[144:145], v32 offset:32
    ds_read_b64_tr_b16 a[146:147], v32 offset:6432
    ds_read_b64_tr_b16 a[148:149], v32 offset:12832
    ds_read_b64_tr_b16 a[150:151], v32 offset:19232
    ds_read_b64_tr_b16 a[224:225], v32 offset:64
    ds_read_b64_tr_b16 a[226:227], v32 offset:6464
    ds_read_b64_tr_b16 a[228:229], v32 offset:12864
    ds_read_b64_tr_b16 a[230:231], v32 offset:19264
    s_waitcnt vmcnt(0)
    ds_write_b128 v10, v[80:83] offset:25600
    ds_write_b128 v11, v[84:87] offset:25600
    ds_write_b128 v12, v[88:91] offset:25600
    ds_write_b128 v13, v[92:95] offset:25600
    ds_write_b128 v14, v[96:99] offset:25600
    ds_write_b128 v15, v[100:103] offset:25600
    s_waitcnt lgkmcnt(0)
    v_mfma_f32_16x16x32_bf16 v[16:19], a[64:67], v[28:31], v[16:19]
    v_mfma_f32_16x16x32_bf16 v[20:23], a[144:147], v[28:31], v[20:23]
    v_mfma_f32_16x16x32_bf16 v[24:27], a[224:227], v[28:31], v[24:27]
    v_mfma_f32_16x16x32_bf16 v[16:19], a[68:71], v[28:31], v[16:19]
    v_mfma_f32_16x16x32_bf16 v[20:23], a[148:151], v[28:31], v[20:23]
    v_mfma_f32_16x16x32_bf16 v[24:27], a[228:231], v[28:31], v[24:27]
    s_barrier
    ds_read_b64_tr_b16 a[72:73], v32 offset:25600
    ds_read_b64_tr_b16 a[74:75], v32 offset:32000
    ds_read_b64_tr_b16 a[76:77], v32 offset:38400
    ds_read_b64_tr_b16 a[78:79], v32 offset:44800
    ds_read_b64_tr_b16 a[152:153], v32 offset:25632
    ds_read_b64_tr_b16 a[154:155], v32 offset:32032
    ds_read_b64_tr_b16 a[156:157], v32 offset:38432
    ds_read_b64_tr_b16 a[158:159], v32 offset:44832
    ds_read_b64_tr_b16 a[232:233], v32 offset:25664
    ds_read_b64_tr_b16 a[234:235], v32 offset:32064
    ds_read_b64_tr_b16 a[236:237], v32 offset:38464
    ds_read_b64_tr_b16 a[238:239], v32 offset:44864
    s_waitcnt lgkmcnt(0)
    v_mfma_f32_16x16x32_bf16 v[16:19], a[72:75], v[28:31], v[16:19]
    v_mfma_f32_16x16x32_bf16 v[20:23], a[152:155], v[28:31], v[20:23]
    v_mfma_f32_16x16x32_bf16 v[24:27], a[232:235], v[28:31], v[24:27]
    v_mfma_f32_16x16x32_bf16 v[16:19], a[76:79], v[28:31], v[16:19]
    v_mfma_f32_16x16x32_bf16 v[20:23], a[156:159], v[28:31], v[20:23]
    v_mfma_f32_16x16x32_bf16 v[24:27], a[236:239], v[28:31], v[24:27]
    s_nop 5
    v_mov_b32 v224, v16
    v_mov_b32 v225, v17
    v_mov_b32 v226, v18
    v_mov_b32 v227, v19
    v_mov_b32 v228, v20
    v_mov_b32 v229, v21
    v_mov_b32 v230, v22
    v_mov_b32 v231, v23
    v_mov_b32 v232, v24
    v_mov_b32 v233, v25
    v_mov_b32 v234, v26
    v_mov_b32 v235, v27
    v_mov_b32 v236, v28
    v_mov_b32 v237, v29
    v_mov_b32 v238, v30
    v_mov_b32 v239, v31
    s_barrier
interleave_layers__linear_attn_block__memory_aug_recurrent_mem_tr__prompt_kernel_p_layer:
    s_mov_b32 s93, 0
    s_lshl_b32 s24, s93, 12
    s_and_b32 s24, s24, 0x2000
    s_xor_b32 s24, s24, s36
    s_lshl_b32 s93, s93, 20
    s_add_u32 s93, s93, s24
    s_add_u32 s93, s93, 117440512
    s_mul_i32 s94, s92, 16384
    s_add_u32 s94, s94, 23068672
    s_sub_u32 s44, s2, 104
    s_lshr_b32 s46, s44, 5
    s_and_b32 s44, s44, 31
    s_mov_b32 s43, 67108864
    s_cmp_eq_u32 s46, 1
    s_cselect_b32 s43, 92274688, s43
    s_cmp_eq_u32 s46, 2
    s_cselect_b32 s43, 33554432, s43
    s_cmp_eq_u32 s92, 0
    s_cselect_b32 s73, 0, 8388608
    v_lshlrev_b32 v5, 4, v1
    s_mul_i32 s24, s3, 10240
    v_add_u32 v6, s24, v5
    v_add_u32 v7, 4096, v6
    v_add_u32 v8, 8192, v6
    s_mul_i32 s24, s44, 12288
    s_mul_i32 s25, s3, 3072
    s_add_u32 s24, s24, s25
    v_add_u32 v11, s24, v5
    s_lshr_b32 s24, s3, 1
    s_lshl_b32 s24, s24, 8
    s_and_b32 s25, s3, 1
    s_lshl_b32 s25, s25, 3
    s_add_u32 s24, s24, s25
    s_add_u32 s24, s24, 81920
    v_lshlrev_b32 v13, 4, v2
    v_add_u32 v12, s24, v13
    v_add_u32 v13, 81920, v13
    v_lshrrev_b32 v15, 2, v2
    v_cmp_eq_u32 vcc, v15, v3
    v_lshlrev_b32 v15, 3, v1
    v_add_u32 v15, 82944, v15
    v_cndmask_b32 v12, v15, v12, vcc
    v_and_b32 v15, 3, v2
    v_cmp_eq_u32 s[48:49], 1, v15
    v_cmp_eq_u32 s[50:51], 2, v15
    v_cmp_eq_u32 s[54:55], 3, v15
    s_and_b32 s24, s2, 7
    s_lshl_b32 s24, s24, 7
    s_lshl_b32 s25, s92, 10
    s_add_u32 s24, s24, s25
    s_add_u32 s24, s24, 23105536
    s_cmp_eq_u32 s92, 0
    s_cselect_b32 s25, 20, 5
    s_cselect_b32 s75, 2, 0
    s_cselect_b32 s74, 16, 64
    v_cmp_gt_u32 vcc, s25, v1
    s_nop 1
    v_cndmask_b32 v4, 0, v1, vcc
    v_lshlrev_b32 v4, 2, v4
    v_add_u32 v4, s24, v4
    s_lshl_b32 s24, s46, 12
    s_lshl_b32 s25, s44, 7
    s_add_u32 s24, s24, s25
    s_add_u32 s24, s24, s94
    v_mov_b32 v14, s24
    v_mov_b32 v15, 2146435072
    v_cmp_eq_u32 vcc, 0, v1
    s_nop 1
    v_cndmask_b32 v14, v15, v14, vcc
    s_cmp_eq_u32 s3, 0
    s_cselect_b32 s24, 0, 2146435072
    v_or_b32 v14, s24, v14
    s_sub_u32 s70, s2, 104
    s_mul_i32 s71, s70, 205
    s_lshr_b32 s71, s71, 12
    s_mul_i32 s24, s71, 20
    s_sub_u32 s70, s70, s24
    s_cmp_lt_u32 s71, 4
    s_cselect_b32 s64, s71, 64
    s_lshl_b32 s24, s70, 16
    s_lshl_b32 s25, s3, 13
    s_add_u32 s24, s24, s25
    v_add_u32 v240, s24, v5
    v_add_u32 v241, 4096, v240
    s_lshl_b32 s24, s70, 15
    s_lshl_b32 s25, s3, 11
    s_add_u32 s24, s24, s25
    v_add_u32 v242, s24, v5
    s_lshl_b32 s24, s3, 15
    v_add_u32 v193, s24, v5
    v_add_u32 v212, 0, v193
    v_add_u32 v213, 4096, v193
    v_add_u32 v214, 16384, v193
    v_add_u32 v215, 20480, v193
    s_lshl_b32 s24, s3, 12
    s_and_b32 s25, s24, 0x2000
    s_add_u32 s24, s24, s25
    s_add_u32 s24, s24, 131072
    v_add_u32 v216, s24, v5
    s_lshl_b32 s24, s3, 12
    s_add_u32 s24, s24, 83968
    v_add_u32 v217, s24, v5
    s_and_b32 s24, s3, 1
    s_lshl_b32 s24, s24, 10
    s_add_u32 s24, s24, 83968
    v_add_u32 v218, s24, v5
    s_and_b32 s24, s3, 1
    s_mul_i32 s24, s24, 20480
    s_lshl_b32 s25, s70, 10
    s_add_u32 s24, s24, s25
    v_add_u32 v219, s24, v5
    s_and_b32 s24, s3, 1
    s_lshl_b32 s24, s24, 4
    v_add_u32 v243, s24, v2
    v_mul_u32_u24 v243, 1280, v243
    v_lshl_add_u32 v243, v3, 3, v243
    s_lshl_b32 s24, s70, 6
    v_add_u32 v243, s24, v243
    s_load_dwordx2 s[26:27], s[0:1], 80
    s_waitcnt lgkmcnt(0)
    s_mov_b32 s12, s26
    s_mov_b32 s13, s27
    s_mov_b32 s14, 2621440
    s_mov_b32 s15, 0x00020000
    s_mul_i32 s65, s71, 1310720
    s_add_u32 s65, s65, 184549376
    s_lshl_b32 s24, s71, 12
    s_and_b32 s24, s24, 0x2000
    s_xor_b32 s24, s24, s36
    s_lshl_b32 s66, s71, 20
    s_add_u32 s66, s66, s24
    s_add_u32 s66, s66, 117440512
    s_xor_b32 s67, s66, 0x2000
    s_mul_i32 s68, s71, 40960
    v_and_b32 v252, 7, v1
    v_lshlrev_b32 v252, 7, v252
    s_lshl_b32 s24, s3, 10
    s_add_u32 s24, s24, 12288
    s_add_u32 s24, s24, s94
    v_add_u32 v252, s24, v252
    s_mov_b32 s69, -1
    s_lshl_b32 s24, s71, 7
    s_lshl_b32 s25, s70, 2
    s_add_u32 s24, s24, s25
    s_add_u32 s24, s24, 23107584
    s_cmp_eq_u32 s3, 0
    s_cselect_b32 s24, s24, 2146435072
    v_mov_b32 v245, s24
    v_mov_b32 v246, 2146435072
    v_cmp_eq_u32 vcc, 0, v1
    s_nop 1
    v_cndmask_b32 v245, v246, v245, vcc
    s_mov_b32 s79, -1
    s_mov_b32 s76, -1
    s_mov_b32 s62, -1
    s_mov_b32 s63, 1
    s_cmp_ge_i32 s62, s63
    s_cbranch_scc1 interleave_layers__linear_attn_block__memory_aug_recurrent_mem_tr__prompt_kernel_p_en0_ok
    s_mov_b32 s61, 0
interleave_layers__linear_attn_block__memory_aug_recurrent_mem_tr__prompt_kernel_p_en0:
    buffer_load_dword v16, v4, s[8:11], 0 offen sc1
    s_waitcnt vmcnt(0)
    v_readlane_b32 s62, v16, 0
    v_readlane_b32 s24, v16, 1
    s_min_i32 s62, s62, s24
    v_readlane_b32 s24, v16, 2
    s_min_i32 s62, s62, s24
    v_readlane_b32 s24, v16, 3
    s_min_i32 s62, s62, s24
    v_readlane_b32 s24, v16, 4
    s_min_i32 s62, s62, s24
    v_readlane_b32 s24, v16, 5
    s_min_i32 s62, s62, s24
    v_readlane_b32 s24, v16, 6
    s_min_i32 s62, s62, s24
    v_readlane_b32 s24, v16, 7
    s_min_i32 s62, s62, s24
    v_readlane_b32 s24, v16, 8
    s_min_i32 s62, s62, s24
    v_readlane_b32 s24, v16, 9
    s_min_i32 s62, s62, s24
    v_readlane_b32 s24, v16, 10
    s_min_i32 s62, s62, s24
    v_readlane_b32 s24, v16, 11
    s_min_i32 s62, s62, s24
    v_readlane_b32 s24, v16, 12
    s_min_i32 s62, s62, s24
    v_readlane_b32 s24, v16, 13
    s_min_i32 s62, s62, s24
    v_readlane_b32 s24, v16, 14
    s_min_i32 s62, s62, s24
    v_readlane_b32 s24, v16, 15
    s_min_i32 s62, s62, s24
    v_readlane_b32 s24, v16, 16
    s_min_i32 s62, s62, s24
    v_readlane_b32 s24, v16, 17
    s_min_i32 s62, s62, s24
    v_readlane_b32 s24, v16, 18
    s_min_i32 s62, s62, s24
    v_readlane_b32 s24, v16, 19
    s_min_i32 s62, s62, s24
    s_cmp_ge_i32 s62, s63
    s_cbranch_scc1 interleave_layers__linear_attn_block__memory_aug_recurrent_mem_tr__prompt_kernel_p_en0_ok
    s_add_u32 s61, s61, 1
    s_cmp_ge_u32 s61, s60
    s_cbranch_scc1 interleave_layers__linear_attn_block__memory_aug_recurrent_mem_tr__prompt_kernel_p_en0_to
    s_sleep 2
    s_branch interleave_layers__linear_attn_block__memory_aug_recurrent_mem_tr__prompt_kernel_p_en0
interleave_layers__linear_attn_block__memory_aug_recurrent_mem_tr__prompt_kernel_p_en0_to:
    s_mov_b32 s60, 1
interleave_layers__linear_attn_block__memory_aug_recurrent_mem_tr__prompt_kernel_p_en0_ok:
    s_mov_b32 s41, s73
    buffer_load_dwordx4 v[16:19], v6, s[8:11], s41 offen offset:0
    buffer_load_dwordx4 v[20:23], v6, s[8:11], s41 offen offset:1024
    buffer_load_dwordx4 v[24:27], v6, s[8:11], s41 offen offset:2048
    buffer_load_dwordx4 v[28:31], v6, s[8:11], s41 offen offset:3072
    buffer_load_dwordx4 v[32:35], v7, s[8:11], s41 offen offset:0
    buffer_load_dwordx4 v[36:39], v7, s[8:11], s41 offen offset:1024
    buffer_load_dwordx4 v[40:43], v7, s[8:11], s41 offen offset:2048
    buffer_load_dwordx4 v[44:47], v7, s[8:11], s41 offen offset:3072
    buffer_load_dwordx4 v[48:51], v8, s[8:11], s41 offen offset:0
    buffer_load_dwordx4 v[52:55], v8, s[8:11], s41 offen offset:1024
    s_mov_b32 s40, 0
    s_mov_b32 s42, 0
    s_waitcnt vmcnt(0)
    v_mfma_f32_16x16x32_bf16 v[148:151], v[16:19], v[16:19], 0
    v_mfma_f32_16x16x32_bf16 v[144:147], v[236:239], v[16:19], 0
    v_mfma_f32_16x16x32_bf16 v[148:151], v[20:23], v[20:23], v[148:151]
    v_mfma_f32_16x16x32_bf16 v[144:147], v[236:239], v[20:23], v[144:147]
    v_mfma_f32_16x16x32_bf16 v[148:151], v[24:27], v[24:27], v[148:151]
    v_mfma_f32_16x16x32_bf16 v[144:147], v[236:239], v[24:27], v[144:147]
    v_mfma_f32_16x16x32_bf16 v[148:151], v[28:31], v[28:31], v[148:151]
    v_mfma_f32_16x16x32_bf16 v[144:147], v[236:239], v[28:31], v[144:147]
    v_mfma_f32_16x16x32_bf16 v[148:151], v[32:35], v[32:35], v[148:151]
    v_mfma_f32_16x16x32_bf16 v[144:147], v[236:239], v[32:35], v[144:147]
    v_mfma_f32_16x16x32_bf16 v[148:151], v[36:39], v[36:39], v[148:151]
    v_mfma_f32_16x16x32_bf16 v[144:147], v[236:239], v[36:39], v[144:147]
    v_mfma_f32_16x16x32_bf16 v[148:151], v[40:43], v[40:43], v[148:151]
    v_mfma_f32_16x16x32_bf16 v[144:147], v[236:239], v[40:43], v[144:147]
    v_mfma_f32_16x16x32_bf16 v[148:151], v[44:47], v[44:47], v[148:151]
    v_mfma_f32_16x16x32_bf16 v[144:147], v[236:239], v[44:47], v[144:147]
    v_mfma_f32_16x16x32_bf16 v[148:151], v[48:51], v[48:51], v[148:151]
    v_mfma_f32_16x16x32_bf16 v[144:147], v[236:239], v[48:51], v[144:147]
    v_mfma_f32_16x16x32_bf16 v[148:151], v[52:55], v[52:55], v[148:151]
    v_mfma_f32_16x16x32_bf16 v[144:147], v[236:239], v[52:55], v[144:147]
    ds_write_b128 v6, v[16:19] offset:0
    ds_write_b128 v6, v[20:23] offset:1024
    ds_write_b128 v6, v[24:27] offset:2048
    ds_write_b128 v6, v[28:31] offset:3072
    ds_write_b128 v6, v[32:35] offset:4096
    ds_write_b128 v6, v[36:39] offset:5120
    ds_write_b128 v6, v[40:43] offset:6144
    ds_write_b128 v6, v[44:47] offset:7168
    ds_write_b128 v6, v[48:51] offset:8192
    ds_write_b128 v6, v[52:55] offset:9216
    v_cndmask_b32 v145, v148, v149, s[48:49]
    v_cndmask_b32 v145, v145, v150, s[50:51]
    v_cndmask_b32 v145, v145, v151, s[54:55]
    ds_write_b64 v12, v[144:145]
    s_waitcnt lgkmcnt(0)
    s_barrier
    s_branch interleave_layers__linear_attn_block__memory_aug_recurrent_mem_tr__prompt_kernel_p_segA
interleave_layers__linear_attn_block__memory_aug_recurrent_mem_tr__prompt_kernel_p_pubA:
    s_waitcnt vmcnt(0)
    s_barrier
    s_cmp_eq_u32 s3, 0
    s_cbranch_scc0 interleave_layers__linear_attn_block__memory_aug_recurrent_mem_tr__prompt_kernel_fp31
    v_mov_b32 v15, s40
    buffer_store_dword v15, v14, s[8:11], 0 offen sc1
interleave_layers__linear_attn_block__memory_aug_recurrent_mem_tr__prompt_kernel_fp31:
interleave_layers__linear_attn_block__memory_aug_recurrent_mem_tr__prompt_kernel_p_segA:
    v_add_u32 v9, s42, v5
    s_xor_b32 s42, s42, 40960
    v_add_u32 v10, s42, v6
    s_and_b32 s24, s40, 1
    s_lshl_b32 s24, s24, 9
    v_add_u32 v124, s24, v13
    s_xor_b32 s24, s24, 512
    v_add_u32 v140, s24, v12
    ds_read_b128 v[112:115], v124
    ds_read_b128 v[116:119], v124 offset:256
    ds_read_b128 v[56:59], v9 offset:0
    ds_read_b128 v[60:63], v9 offset:20480
    ds_read_b128 v[64:67], v9 offset:1024
    ds_read_b128 v[68:71], v9 offset:21504
    ds_read_b128 v[72:75], v9 offset:2048
    ds_read_b128 v[76:79], v9 offset:22528
    ds_read_b128 v[80:83], v9 offset:3072
    ds_read_b128 v[84:87], v9 offset:23552
    s_waitcnt lgkmcnt(6)
    v_mfma_f32_16x16x32_bf16 v[88:91], a[0:3], v[56:59], 0
    v_add_f32 v112, v112, v114
    v_mfma_f32_16x16x32_bf16 v[92:95], a[80:83], v[56:59], 0
    v_add_f32 v113, v113, v115
    v_mfma_f32_16x16x32_bf16 v[96:99], a[160:163], v[56:59], 0
    v_mul_f32 v112, 0x3acccccd, v112
    v_mfma_f32_16x16x32_bf16 v[100:103], a[0:3], v[60:63], 0
    v_mul_f32 v114, v112, v112
    v_mfma_f32_16x16x32_bf16 v[104:107], a[80:83], v[60:63], 0
    v_mov_b32 v115, 0x3acccccd
    v_mfma_f32_16x16x32_bf16 v[108:111], a[160:163], v[60:63], 0
    v_fma_f32 v113, v113, v115, -v114
    ds_read_b128 v[56:59], v9 offset:4096
    ds_read_b128 v[60:63], v9 offset:24576
    s_waitcnt lgkmcnt(6)
    v_mfma_f32_16x16x32_bf16 v[88:91], a[4:7], v[64:67], v[88:91]
    v_max_f32 v113, 0, v113
    v_mfma_f32_16x16x32_bf16 v[92:95], a[84:87], v[64:67], v[92:95]
    v_add_f32 v113, 0x3727c5ac, v113
    v_mfma_f32_16x16x32_bf16 v[96:99], a[164:167], v[64:67], v[96:99]
    v_rsq_f32 v132, v113
    v_mfma_f32_16x16x32_bf16 v[100:103], a[4:7], v[68:71], v[100:103]
    v_mul_f32 v133, v112, v132
    v_mfma_f32_16x16x32_bf16 v[104:107], a[84:87], v[68:71], v[104:107]
    v_sub_f32 v133, 0, v133
    v_mfma_f32_16x16x32_bf16 v[108:111], a[164:167], v[68:71], v[108:111]
    v_add_f32 v116, v116, v118
    ds_read_b128 v[64:67], v9 offset:5120
    ds_read_b128 v[68:71], v9 offset:25600
    s_waitcnt lgkmcnt(6)
    v_mfma_f32_16x16x32_bf16 v[88:91], a[8:11], v[72:75], v[88:91]
    v_add_f32 v117, v117, v119
    v_mfma_f32_16x16x32_bf16 v[92:95], a[88:91], v[72:75], v[92:95]
    v_mul_f32 v116, 0x3acccccd, v116
    v_mfma_f32_16x16x32_bf16 v[96:99], a[168:171], v[72:75], v[96:99]
    v_mul_f32 v118, v116, v116
    v_mfma_f32_16x16x32_bf16 v[100:103], a[8:11], v[76:79], v[100:103]
    v_mov_b32 v119, 0x3acccccd
    v_mfma_f32_16x16x32_bf16 v[104:107], a[88:91], v[76:79], v[104:107]
    v_fma_f32 v117, v117, v119, -v118
    v_mfma_f32_16x16x32_bf16 v[108:111], a[168:171], v[76:79], v[108:111]
    v_max_f32 v117, 0, v117
    ds_read_b128 v[72:75], v9 offset:6144
    ds_read_b128 v[76:79], v9 offset:26624
    s_waitcnt lgkmcnt(6)
    v_mfma_f32_16x16x32_bf16 v[88:91], a[12:15], v[80:83], v[88:91]
    v_add_f32 v117, 0x3727c5ac, v117
    v_mfma_f32_16x16x32_bf16 v[92:95], a[92:95], v[80:83], v[92:95]
    v_rsq_f32 v134, v117
    v_mfma_f32_16x16x32_bf16 v[96:99], a[172:175], v[80:83], v[96:99]
    v_mul_f32 v135, v116, v134
    v_mfma_f32_16x16x32_bf16 v[100:103], a[12:15], v[84:87], v[100:103]
    v_sub_f32 v135, 0, v135
    v_mfma_f32_16x16x32_bf16 v[104:107], a[92:95], v[84:87], v[104:107]
    v_mfma_f32_16x16x32_bf16 v[108:111], a[172:175], v[84:87], v[108:111]
    ds_read_b128 v[80:83], v9 offset:7168
    ds_read_b128 v[84:87], v9 offset:27648
    s_waitcnt lgkmcnt(6)
    v_mfma_f32_16x16x32_bf16 v[88:91], a[16:19], v[56:59], v[88:91]
    v_mfma_f32_16x16x32_bf16 v[92:95], a[96:99], v[56:59], v[92:95]
    v_mfma_f32_16x16x32_bf16 v[96:99], a[176:179], v[56:59], v[96:99]
    v_mfma_f32_16x16x32_bf16 v[100:103], a[16:19], v[60:63], v[100:103]
    v_mfma_f32_16x16x32_bf16 v[104:107], a[96:99], v[60:63], v[104:107]
    v_mfma_f32_16x16x32_bf16 v[108:111], a[176:179], v[60:63], v[108:111]
    ds_read_b128 v[56:59], v9 offset:8192
    ds_read_b128 v[60:63], v9 offset:28672
    s_waitcnt lgkmcnt(6)
    v_mfma_f32_16x16x32_bf16 v[88:91], a[20:23], v[64:67], v[88:91]
    v_mfma_f32_16x16x32_bf16 v[92:95], a[100:103], v[64:67], v[92:95]
    v_mfma_f32_16x16x32_bf16 v[96:99], a[180:183], v[64:67], v[96:99]
    v_mfma_f32_16x16x32_bf16 v[100:103], a[20:23], v[68:71], v[100:103]
    v_mfma_f32_16x16x32_bf16 v[104:107], a[100:103], v[68:71], v[104:107]
    v_mfma_f32_16x16x32_bf16 v[108:111], a[180:183], v[68:71], v[108:111]
    ds_read_b128 v[64:67], v9 offset:9216
    ds_read_b128 v[68:71], v9 offset:29696
    s_waitcnt lgkmcnt(6)
    v_mfma_f32_16x16x32_bf16 v[88:91], a[24:27], v[72:75], v[88:91]
    v_mfma_f32_16x16x32_bf16 v[92:95], a[104:107], v[72:75], v[92:95]
    v_mfma_f32_16x16x32_bf16 v[96:99], a[184:187], v[72:75], v[96:99]
    v_mfma_f32_16x16x32_bf16 v[100:103], a[24:27], v[76:79], v[100:103]
    v_mfma_f32_16x16x32_bf16 v[104:107], a[104:107], v[76:79], v[104:107]
    v_mfma_f32_16x16x32_bf16 v[108:111], a[184:187], v[76:79], v[108:111]
    ds_read_b128 v[72:75], v9 offset:10240
    ds_read_b128 v[76:79], v9 offset:30720
    s_waitcnt lgkmcnt(6)
    v_mfma_f32_16x16x32_bf16 v[88:91], a[28:31], v[80:83], v[88:91]
    v_mfma_f32_16x16x32_bf16 v[92:95], a[108:111], v[80:83], v[92:95]
    v_mfma_f32_16x16x32_bf16 v[96:99], a[188:191], v[80:83], v[96:99]
    v_mfma_f32_16x16x32_bf16 v[100:103], a[28:31], v[84:87], v[100:103]
    v_mfma_f32_16x16x32_bf16 v[104:107], a[108:111], v[84:87], v[104:107]
    v_mfma_f32_16x16x32_bf16 v[108:111], a[188:191], v[84:87], v[108:111]
    ds_read_b128 v[80:83], v9 offset:11264
    ds_read_b128 v[84:87], v9 offset:31744
    s_waitcnt lgkmcnt(6)
    v_mfma_f32_16x16x32_bf16 v[88:91], a[32:35], v[56:59], v[88:91]
    v_mfma_f32_16x16x32_bf16 v[92:95], a[112:115], v[56:59], v[92:95]
    v_mfma_f32_16x16x32_bf16 v[96:99], a[192:195], v[56:59], v[96:99]
    v_mfma_f32_16x16x32_bf16 v[100:103], a[32:35], v[60:63], v[100:103]
    v_mfma_f32_16x16x32_bf16 v[104:107], a[112:115], v[60:63], v[104:107]
    v_mfma_f32_16x16x32_bf16 v[108:111], a[192:195], v[60:63], v[108:111]
    ds_read_b128 v[56:59], v9 offset:12288
    ds_read_b128 v[60:63], v9 offset:32768
    s_waitcnt lgkmcnt(6)
    v_mfma_f32_16x16x32_bf16 v[88:91], a[36:39], v[64:67], v[88:91]
    v_mfma_f32_16x16x32_bf16 v[92:95], a[116:119], v[64:67], v[92:95]
    v_mfma_f32_16x16x32_bf16 v[96:99], a[196:199], v[64:67], v[96:99]
    v_mfma_f32_16x16x32_bf16 v[100:103], a[36:39], v[68:71], v[100:103]
    v_mfma_f32_16x16x32_bf16 v[104:107], a[116:119], v[68:71], v[104:107]
    v_mfma_f32_16x16x32_bf16 v[108:111], a[196:199], v[68:71], v[108:111]
    ds_read_b128 v[64:67], v9 offset:13312
    ds_read_b128 v[68:71], v9 offset:33792
    s_waitcnt lgkmcnt(6)
    v_mfma_f32_16x16x32_bf16 v[88:91], a[40:43], v[72:75], v[88:91]
    v_mfma_f32_16x16x32_bf16 v[92:95], a[120:123], v[72:75], v[92:95]
    v_mfma_f32_16x16x32_bf16 v[96:99], a[200:203], v[72:75], v[96:99]
    v_mfma_f32_16x16x32_bf16 v[100:103], a[40:43], v[76:79], v[100:103]
    v_mfma_f32_16x16x32_bf16 v[104:107], a[120:123], v[76:79], v[104:107]
    v_mfma_f32_16x16x32_bf16 v[108:111], a[200:203], v[76:79], v[108:111]
    ds_read_b128 v[72:75], v9 offset:14336
    ds_read_b128 v[76:79], v9 offset:34816
    s_waitcnt lgkmcnt(6)
    v_mfma_f32_16x16x32_bf16 v[88:91], a[44:47], v[80:83], v[88:91]
    v_mfma_f32_16x16x32_bf16 v[92:95], a[124:127], v[80:83], v[92:95]
    v_mfma_f32_16x16x32_bf16 v[96:99], a[204:207], v[80:83], v[96:99]
    v_mfma_f32_16x16x32_bf16 v[100:103], a[44:47], v[84:87], v[100:103]
    v_mfma_f32_16x16x32_bf16 v[104:107], a[124:127], v[84:87], v[104:107]
    v_mfma_f32_16x16x32_bf16 v[108:111], a[204:207], v[84:87], v[108:111]
    ds_read_b128 v[80:83], v9 offset:15360
    ds_read_b128 v[84:87], v9 offset:35840
    s_waitcnt lgkmcnt(6)
    v_mfma_f32_16x16x32_bf16 v[88:91], a[48:51], v[56:59], v[88:91]
    v_mfma_f32_16x16x32_bf16 v[92:95], a[128:131], v[56:59], v[92:95]
    v_mfma_f32_16x16x32_bf16 v[96:99], a[208:211], v[56:59], v[96:99]
    v_mfma_f32_16x16x32_bf16 v[100:103], a[48:51], v[60:63], v[100:103]
    v_mfma_f32_16x16x32_bf16 v[104:107], a[128:131], v[60:63], v[104:107]
    v_mfma_f32_16x16x32_bf16 v[108:111], a[208:211], v[60:63], v[108:111]
    ds_read_b128 v[56:59], v9 offset:16384
    ds_read_b128 v[60:63], v9 offset:36864
    s_waitcnt lgkmcnt(6)
    v_mfma_f32_16x16x32_bf16 v[88:91], a[52:55], v[64:67], v[88:91]
    v_mfma_f32_16x16x32_bf16 v[92:95], a[132:135], v[64:67], v[92:95]
    v_mfma_f32_16x16x32_bf16 v[96:99], a[212:215], v[64:67], v[96:99]
    v_mfma_f32_16x16x32_bf16 v[100:103], a[52:55], v[68:71], v[100:103]
    v_mfma_f32_16x16x32_bf16 v[104:107], a[132:135], v[68:71], v[104:107]
    v_mfma_f32_16x16x32_bf16 v[108:111], a[212:215], v[68:71], v[108:111]
    ds_read_b128 v[64:67], v9 offset:17408
    ds_read_b128 v[68:71], v9 offset:37888
    s_waitcnt lgkmcnt(6)
    v_mfma_f32_16x16x32_bf16 v[88:91], a[56:59], v[72:75], v[88:91]
    v_mfma_f32_16x16x32_bf16 v[92:95], a[136:139], v[72:75], v[92:95]
    v_mfma_f32_16x16x32_bf16 v[96:99], a[216:219], v[72:75], v[96:99]
    v_mfma_f32_16x16x32_bf16 v[100:103], a[56:59], v[76:79], v[100:103]
    v_mfma_f32_16x16x32_bf16 v[104:107], a[136:139], v[76:79], v[104:107]
    v_mfma_f32_16x16x32_bf16 v[108:111], a[216:219], v[76:79], v[108:111]
    ds_read_b128 v[72:75], v9 offset:18432
    ds_read_b128 v[76:79], v9 offset:38912
    s_waitcnt lgkmcnt(6)
    v_mfma_f32_16x16x32_bf16 v[88:91], a[60:63], v[80:83], v[88:91]
    v_mfma_f32_16x16x32_bf16 v[92:95], a[140:143], v[80:83], v[92:95]
    v_mfma_f32_16x16x32_bf16 v[96:99], a[220:223], v[80:83], v[96:99]
    v_mfma_f32_16x16x32_bf16 v[100:103], a[60:63], v[84:87], v[100:103]
    v_mfma_f32_16x16x32_bf16 v[104:107], a[140:143], v[84:87], v[104:107]
    v_mfma_f32_16x16x32_bf16 v[108:111], a[220:223], v[84:87], v[108:111]
    ds_read_b128 v[80:83], v9 offset:19456
    ds_read_b128 v[84:87], v9 offset:39936
    s_waitcnt lgkmcnt(6)
    v_mfma_f32_16x16x32_bf16 v[88:91], a[64:67], v[56:59], v[88:91]
    v_mfma_f32_16x16x32_bf16 v[92:95], a[144:147], v[56:59], v[92:95]
    v_mfma_f32_16x16x32_bf16 v[96:99], a[224:227], v[56:59], v[96:99]
    v_mfma_f32_16x16x32_bf16 v[100:103], a[64:67], v[60:63], v[100:103]
    v_mfma_f32_16x16x32_bf16 v[104:107], a[144:147], v[60:63], v[104:107]
    v_mfma_f32_16x16x32_bf16 v[108:111], a[224:227], v[60:63], v[108:111]
    s_waitcnt lgkmcnt(4)
    v_mfma_f32_16x16x32_bf16 v[88:91], a[68:71], v[64:67], v[88:91]
    v_mfma_f32_16x16x32_bf16 v[92:95], a[148:151], v[64:67], v[92:95]
    v_mfma_f32_16x16x32_bf16 v[96:99], a[228:231], v[64:67], v[96:99]
    v_mfma_f32_16x16x32_bf16 v[100:103], a[68:71], v[68:71], v[100:103]
    v_mfma_f32_16x16x32_bf16 v[104:107], a[148:151], v[68:71], v[104:107]
    v_mfma_f32_16x16x32_bf16 v[108:111], a[228:231], v[68:71], v[108:111]
    s_waitcnt lgkmcnt(2)
    v_mfma_f32_16x16x32_bf16 v[88:91], a[72:75], v[72:75], v[88:91]
    v_mfma_f32_16x16x32_bf16 v[92:95], a[152:155], v[72:75], v[92:95]
    v_mfma_f32_16x16x32_bf16 v[96:99], a[232:235], v[72:75], v[96:99]
    v_mfma_f32_16x16x32_bf16 v[100:103], a[72:75], v[76:79], v[100:103]
    v_mfma_f32_16x16x32_bf16 v[104:107], a[152:155], v[76:79], v[104:107]
    v_mfma_f32_16x16x32_bf16 v[108:111], a[232:235], v[76:79], v[108:111]
    s_waitcnt lgkmcnt(0)
    v_mfma_f32_16x16x32_bf16 v[88:91], a[76:79], v[80:83], v[88:91]
    v_mfma_f32_16x16x32_bf16 v[92:95], a[156:159], v[80:83], v[92:95]
    v_mfma_f32_16x16x32_bf16 v[96:99], a[236:239], v[80:83], v[96:99]
    v_mfma_f32_16x16x32_bf16 v[100:103], a[76:79], v[84:87], v[100:103]
    v_mfma_f32_16x16x32_bf16 v[104:107], a[156:159], v[84:87], v[104:107]
    v_mfma_f32_16x16x32_bf16 v[108:111], a[236:239], v[84:87], v[108:111]
    v_pk_mul_f32 v[124:125], v[224:225], v[132:133] op_sel:[0,1] op_sel_hi:[1,1]
    v_pk_mul_f32 v[126:127], v[226:227], v[132:133] op_sel:[0,1] op_sel_hi:[1,1]
    s_nop 0
    v_pk_fma_f32 v[88:89], v[88:89], v[132:133], v[124:125] op_sel:[0,0,0] op_sel_hi:[1,0,1]
    v_pk_fma_f32 v[90:91], v[90:91], v[132:133], v[126:127] op_sel:[0,0,0] op_sel_hi:[1,0,1]
    v_pk_mul_f32 v[124:125], v[228:229], v[132:133] op_sel:[0,1] op_sel_hi:[1,1]
    v_pk_mul_f32 v[126:127], v[230:231], v[132:133] op_sel:[0,1] op_sel_hi:[1,1]
    v_pk_fma_f32 v[92:93], v[92:93], v[132:133], v[124:125] op_sel:[0,0,0] op_sel_hi:[1,0,1]
    v_pk_fma_f32 v[94:95], v[94:95], v[132:133], v[126:127] op_sel:[0,0,0] op_sel_hi:[1,0,1]
    v_pk_mul_f32 v[124:125], v[232:233], v[132:133] op_sel:[0,1] op_sel_hi:[1,1]
    v_pk_mul_f32 v[126:127], v[234:235], v[132:133] op_sel:[0,1] op_sel_hi:[1,1]
    v_pk_fma_f32 v[96:97], v[96:97], v[132:133], v[124:125] op_sel:[0,0,0] op_sel_hi:[1,0,1]
    v_pk_fma_f32 v[98:99], v[98:99], v[132:133], v[126:127] op_sel:[0,0,0] op_sel_hi:[1,0,1]
    v_pk_mul_f32 v[124:125], v[224:225], v[134:135] op_sel:[0,1] op_sel_hi:[1,1]
    v_pk_mul_f32 v[126:127], v[226:227], v[134:135] op_sel:[0,1] op_sel_hi:[1,1]
    v_pk_fma_f32 v[100:101], v[100:101], v[134:135], v[124:125] op_sel:[0,0,0] op_sel_hi:[1,0,1]
    v_pk_fma_f32 v[102:103], v[102:103], v[134:135], v[126:127] op_sel:[0,0,0] op_sel_hi:[1,0,1]
    v_pk_mul_f32 v[124:125], v[228:229], v[134:135] op_sel:[0,1] op_sel_hi:[1,1]
    v_pk_mul_f32 v[126:127], v[230:231], v[134:135] op_sel:[0,1] op_sel_hi:[1,1]
    v_pk_fma_f32 v[104:105], v[104:105], v[134:135], v[124:125] op_sel:[0,0,0] op_sel_hi:[1,0,1]
    v_pk_fma_f32 v[106:107], v[106:107], v[134:135], v[126:127] op_sel:[0,0,0] op_sel_hi:[1,0,1]
    v_pk_mul_f32 v[124:125], v[232:233], v[134:135] op_sel:[0,1] op_sel_hi:[1,1]
    v_pk_mul_f32 v[126:127], v[234:235], v[134:135] op_sel:[0,1] op_sel_hi:[1,1]
    v_pk_fma_f32 v[108:109], v[108:109], v[134:135], v[124:125] op_sel:[0,0,0] op_sel_hi:[1,0,1]
    v_pk_fma_f32 v[110:111], v[110:111], v[134:135], v[126:127] op_sel:[0,0,0] op_sel_hi:[1,0,1]
    v_cvt_pk_bf16_f32 v112, v88, v89
    v_cvt_pk_bf16_f32 v113, v90, v91
    v_cvt_pk_bf16_f32 v114, v92, v93
    v_cvt_pk_bf16_f32 v115, v94, v95
    v_cvt_pk_bf16_f32 v116, v100, v101
    v_cvt_pk_bf16_f32 v117, v102, v103
    v_cvt_pk_bf16_f32 v118, v104, v105
    v_cvt_pk_bf16_f32 v119, v106, v107
    v_cvt_pk_bf16_f32 v120, v96, v97
    v_cvt_pk_bf16_f32 v121, v98, v99
    v_cvt_pk_bf16_f32 v122, v108, v109
    v_cvt_pk_bf16_f32 v123, v110, v111
    buffer_store_dwordx4 v[112:115], v11, s[8:11], s43 offen offset:0 sc1
    buffer_store_dwordx4 v[116:119], v11, s[8:11], s43 offen offset:1024 sc1
    buffer_store_dwordx4 v[120:123], v11, s[8:11], s43 offen offset:2048 sc1
    s_add_u32 s43, s43, 393216
    s_waitcnt vmcnt(0)
    s_barrier
    s_add_u32 s24, s40, 1
    v_mov_b32 v15, s24
    buffer_store_dword v15, v14, s[8:11], 0 offen sc1
    s_add_u32 s63, s40, 1
    s_lshr_b32 s63, s63, s75
    s_add_u32 s63, s63, 1
    s_min_u32 s63, s63, s74
    s_cmp_ge_i32 s62, s63
    s_cbranch_scc1 interleave_layers__linear_attn_block__memory_aug_recurrent_mem_tr__prompt_kernel_p_enA_ok
    s_mov_b32 s61, 0
interleave_layers__linear_attn_block__memory_aug_recurrent_mem_tr__prompt_kernel_p_enA:
    buffer_load_dword v16, v4, s[8:11], 0 offen sc1
    s_waitcnt vmcnt(0)
    v_readlane_b32 s62, v16, 0
    v_readlane_b32 s24, v16, 1
    s_min_i32 s62, s62, s24
    v_readlane_b32 s24, v16, 2
    s_min_i32 s62, s62, s24
    v_readlane_b32 s24, v16, 3
    s_min_i32 s62, s62, s24
    v_readlane_b32 s24, v16, 4
    s_min_i32 s62, s62, s24
    v_readlane_b32 s24, v16, 5
    s_min_i32 s62, s62, s24
    v_readlane_b32 s24, v16, 6
    s_min_i32 s62, s62, s24
    v_readlane_b32 s24, v16, 7
    s_min_i32 s62, s62, s24
    v_readlane_b32 s24, v16, 8
    s_min_i32 s62, s62, s24
    v_readlane_b32 s24, v16, 9
    s_min_i32 s62, s62, s24
    v_readlane_b32 s24, v16, 10
    s_min_i32 s62, s62, s24
    v_readlane_b32 s24, v16, 11
    s_min_i32 s62, s62, s24
    v_readlane_b32 s24, v16, 12
    s_min_i32 s62, s62, s24
    v_readlane_b32 s24, v16, 13
    s_min_i32 s62, s62, s24
    v_readlane_b32 s24, v16, 14
    s_min_i32 s62, s62, s24
    v_readlane_b32 s24, v16, 15
    s_min_i32 s62, s62, s24
    v_readlane_b32 s24, v16, 16
    s_min_i32 s62, s62, s24
    v_readlane_b32 s24, v16, 17
    s_min_i32 s62, s62, s24
    v_readlane_b32 s24, v16, 18
    s_min_i32 s62, s62, s24
    v_readlane_b32 s24, v16, 19
    s_min_i32 s62, s62, s24
    s_cmp_ge_i32 s62, s63
    s_cbranch_scc1 interleave_layers__linear_attn_block__memory_aug_recurrent_mem_tr__prompt_kernel_p_enA_ok
    s_add_u32 s61, s61, 1
    s_cmp_ge_u32 s61, s60
    s_cbranch_scc1 interleave_layers__linear_attn_block__memory_aug_recurrent_mem_tr__prompt_kernel_p_enA_to
    s_sleep 2
    s_branch interleave_layers__linear_attn_block__memory_aug_recurrent_mem_tr__prompt_kernel_p_enA
interleave_layers__linear_attn_block__memory_aug_recurrent_mem_tr__prompt_kernel_p_enA_to:
    s_mov_b32 s60, 1
interleave_layers__linear_attn_block__memory_aug_recurrent_mem_tr__prompt_kernel_p_enA_ok:
    s_add_u32 s41, s41, 40960
    buffer_load_dwordx4 v[16:19], v6, s[8:11], s41 offen offset:0
    buffer_load_dwordx4 v[20:23], v6, s[8:11], s41 offen offset:1024
    buffer_load_dwordx4 v[24:27], v6, s[8:11], s41 offen offset:2048
    buffer_load_dwordx4 v[28:31], v6, s[8:11], s41 offen offset:3072
    buffer_load_dwordx4 v[32:35], v7, s[8:11], s41 offen offset:0
    buffer_load_dwordx4 v[36:39], v7, s[8:11], s41 offen offset:1024
    buffer_load_dwordx4 v[40:43], v7, s[8:11], s41 offen offset:2048
    buffer_load_dwordx4 v[44:47], v7, s[8:11], s41 offen offset:3072
    buffer_load_dwordx4 v[48:51], v8, s[8:11], s41 offen offset:0
    buffer_load_dwordx4 v[52:55], v8, s[8:11], s41 offen offset:1024
    buffer_load_dword v152, v4, s[8:11], 0 offen sc1
    s_waitcnt vmcnt(0)
    v_mfma_f32_16x16x32_bf16 v[148:151], v[16:19], v[16:19], 0
    v_mfma_f32_16x16x32_bf16 v[144:147], v[236:239], v[16:19], 0
    v_mfma_f32_16x16x32_bf16 v[148:151], v[20:23], v[20:23], v[148:151]
    v_mfma_f32_16x16x32_bf16 v[144:147], v[236:239], v[20:23], v[144:147]
    v_mfma_f32_16x16x32_bf16 v[148:151], v[24:27], v[24:27], v[148:151]
    v_mfma_f32_16x16x32_bf16 v[144:147], v[236:239], v[24:27], v[144:147]
    v_mfma_f32_16x16x32_bf16 v[148:151], v[28:31], v[28:31], v[148:151]
    v_mfma_f32_16x16x32_bf16 v[144:147], v[236:239], v[28:31], v[144:147]
    v_mfma_f32_16x16x32_bf16 v[148:151], v[32:35], v[32:35], v[148:151]
    v_mfma_f32_16x16x32_bf16 v[144:147], v[236:239], v[32:35], v[144:147]
    v_mfma_f32_16x16x32_bf16 v[148:151], v[36:39], v[36:39], v[148:151]
    v_mfma_f32_16x16x32_bf16 v[144:147], v[236:239], v[36:39], v[144:147]
    v_mfma_f32_16x16x32_bf16 v[148:151], v[40:43], v[40:43], v[148:151]
    v_mfma_f32_16x16x32_bf16 v[144:147], v[236:239], v[40:43], v[144:147]
    v_mfma_f32_16x16x32_bf16 v[148:151], v[44:47], v[44:47], v[148:151]
    v_mfma_f32_16x16x32_bf16 v[144:147], v[236:239], v[44:47], v[144:147]
    v_mfma_f32_16x16x32_bf16 v[148:151], v[48:51], v[48:51], v[148:151]
    v_mfma_f32_16x16x32_bf16 v[144:147], v[236:239], v[48:51], v[144:147]
    v_mfma_f32_16x16x32_bf16 v[148:151], v[52:55], v[52:55], v[148:151]
    v_mfma_f32_16x16x32_bf16 v[144:147], v[236:239], v[52:55], v[144:147]
    ds_write_b128 v10, v[16:19] offset:0
    ds_write_b128 v10, v[20:23] offset:1024
    ds_write_b128 v10, v[24:27] offset:2048
    ds_write_b128 v10, v[28:31] offset:3072
    ds_write_b128 v10, v[32:35] offset:4096
    ds_write_b128 v10, v[36:39] offset:5120
    ds_write_b128 v10, v[40:43] offset:6144
    ds_write_b128 v10, v[44:47] offset:7168
    ds_write_b128 v10, v[48:51] offset:8192
    ds_write_b128 v10, v[52:55] offset:9216
    v_cndmask_b32 v145, v148, v149, s[48:49]
    v_cndmask_b32 v145, v145, v150, s[50:51]
    v_cndmask_b32 v145, v145, v151, s[54:55]
    ds_write_b64 v140, v[144:145]
    s_add_u32 s40, s40, 1
    s_add_u32 s63, s40, 1
    s_lshr_b32 s63, s63, s75
    s_add_u32 s63, s63, 1
    s_min_u32 s63, s63, s74
    v_cmp_le_i32 vcc, s63, v152
    s_cmp_eq_u64 vcc, -1
    s_cselect_b32 s58, 1, 0
    s_cmp_ge_i32 s62, s63
    s_cselect_b32 s58, 1, s58
    s_and_b32 s24, s40, 1
    s_lshl_b32 s24, s24, 2
    s_add_u32 s24, s24, 83456
    s_lshl_b32 s25, s3, 4
    s_add_u32 s25, s25, s24
    v_mov_b32 v15, s25
    v_mov_b32 v152, s58
    ds_write_b32 v15, v152
    v_mov_b32 v15, s24
    s_waitcnt lgkmcnt(0)
    s_barrier
    ds_read_b32 v152, v15
    s_waitcnt lgkmcnt(0)
    v_readfirstlane_b32 s58, v152
    s_cmp_eq_u32 s58, 1
    s_cselect_b32 s24, s63, s62
    s_max_i32 s62, s62, s24
    s_branch interleave_layers__linear_attn_block__memory_aug_recurrent_mem_tr__prompt_kernel_p_next
interleave_layers__linear_attn_block__memory_aug_recurrent_mem_tr__prompt_kernel_p_seg:
    v_add_u32 v9, s42, v5
    s_xor_b32 s42, s42, 40960
    v_add_u32 v10, s42, v6
    s_add_u32 s63, s40, 1
    s_lshr_b32 s63, s63, s75
    s_add_u32 s63, s63, 1
    s_min_u32 s63, s63, s74
    s_cmp_ge_i32 s62, s63
    s_cbranch_scc1 interleave_layers__linear_attn_block__memory_aug_recurrent_mem_tr__prompt_kernel_p_en_ok
    s_mov_b32 s61, 0
interleave_layers__linear_attn_block__memory_aug_recurrent_mem_tr__prompt_kernel_p_en:
    buffer_load_dword v16, v4, s[8:11], 0 offen sc1
    s_waitcnt vmcnt(0)
    v_readlane_b32 s62, v16, 0
    v_readlane_b32 s24, v16, 1
    s_min_i32 s62, s62, s24
    v_readlane_b32 s24, v16, 2
    s_min_i32 s62, s62, s24
    v_readlane_b32 s24, v16, 3
    s_min_i32 s62, s62, s24
    v_readlane_b32 s24, v16, 4
    s_min_i32 s62, s62, s24
    v_readlane_b32 s24, v16, 5
    s_min_i32 s62, s62, s24
    v_readlane_b32 s24, v16, 6
    s_min_i32 s62, s62, s24
    v_readlane_b32 s24, v16, 7
    s_min_i32 s62, s62, s24
    v_readlane_b32 s24, v16, 8
    s_min_i32 s62, s62, s24
    v_readlane_b32 s24, v16, 9
    s_min_i32 s62, s62, s24
    v_readlane_b32 s24, v16, 10
    s_min_i32 s62, s62, s24
    v_readlane_b32 s24, v16, 11
    s_min_i32 s62, s62, s24
    v_readlane_b32 s24, v16, 12
    s_min_i32 s62, s62, s24
    v_readlane_b32 s24, v16, 13
    s_min_i32 s62, s62, s24
    v_readlane_b32 s24, v16, 14
    s_min_i32 s62, s62, s24
    v_readlane_b32 s24, v16, 15
    s_min_i32 s62, s62, s24
    v_readlane_b32 s24, v16, 16
    s_min_i32 s62, s62, s24
    v_readlane_b32 s24, v16, 17
    s_min_i32 s62, s62, s24
    v_readlane_b32 s24, v16, 18
    s_min_i32 s62, s62, s24
    v_readlane_b32 s24, v16, 19
    s_min_i32 s62, s62, s24
    s_cmp_ge_i32 s62, s63
    s_cbranch_scc1 interleave_layers__linear_attn_block__memory_aug_recurrent_mem_tr__prompt_kernel_p_en_ok
    s_add_u32 s61, s61, 1
    s_cmp_ge_u32 s61, s60
    s_cbranch_scc1 interleave_layers__linear_attn_block__memory_aug_recurrent_mem_tr__prompt_kernel_p_en_to
    s_sleep 2
    s_branch interleave_layers__linear_attn_block__memory_aug_recurrent_mem_tr__prompt_kernel_p_en
interleave_layers__linear_attn_block__memory_aug_recurrent_mem_tr__prompt_kernel_p_en_to:
    s_mov_b32 s60, 1
interleave_layers__linear_attn_block__memory_aug_recurrent_mem_tr__prompt_kernel_p_en_ok:
    s_add_u32 s41, s41, 40960
    buffer_load_dwordx4 v[16:19], v6, s[8:11], s41 offen offset:0
    buffer_load_dwordx4 v[20:23], v6, s[8:11], s41 offen offset:1024
    buffer_load_dwordx4 v[24:27], v6, s[8:11], s41 offen offset:2048
    buffer_load_dwordx4 v[28:31], v6, s[8:11], s41 offen offset:3072
    buffer_load_dwordx4 v[32:35], v7, s[8:11], s41 offen offset:0
    buffer_load_dwordx4 v[36:39], v7, s[8:11], s41 offen offset:1024
    buffer_load_dwordx4 v[40:43], v7, s[8:11], s41 offen offset:2048
    buffer_load_dwordx4 v[44:47], v7, s[8:11], s41 offen offset:3072
    buffer_load_dwordx4 v[48:51], v8, s[8:11], s41 offen offset:0
    buffer_load_dwordx4 v[52:55], v8, s[8:11], s41 offen offset:1024
    s_and_b32 s24, s40, 1
    s_lshl_b32 s24, s24, 9
    v_add_u32 v124, s24, v13
    s_xor_b32 s24, s24, 512
    v_add_u32 v140, s24, v12
    ds_read_b128 v[112:115], v124
    ds_read_b128 v[116:119], v124 offset:256
    ds_read_b128 v[56:59], v9 offset:0
    ds_read_b128 v[60:63], v9 offset:20480
    ds_read_b128 v[64:67], v9 offset:1024
    ds_read_b128 v[68:71], v9 offset:21504
    ds_read_b128 v[72:75], v9 offset:2048
    ds_read_b128 v[76:79], v9 offset:22528
    ds_read_b128 v[80:83], v9 offset:3072
    ds_read_b128 v[84:87], v9 offset:23552
    s_waitcnt lgkmcnt(6)
    v_mfma_f32_16x16x32_bf16 v[88:91], a[0:3], v[56:59], 0
    v_add_f32 v112, v112, v114
    v_mfma_f32_16x16x32_bf16 v[92:95], a[80:83], v[56:59], 0
    v_add_f32 v113, v113, v115
    v_mfma_f32_16x16x32_bf16 v[96:99], a[160:163], v[56:59], 0
    v_mul_f32 v112, 0x3acccccd, v112
    v_mfma_f32_16x16x32_bf16 v[100:103], a[0:3], v[60:63], 0
    v_mul_f32 v114, v112, v112
    v_mfma_f32_16x16x32_bf16 v[104:107], a[80:83], v[60:63], 0
    v_mov_b32 v115, 0x3acccccd
    v_mfma_f32_16x16x32_bf16 v[108:111], a[160:163], v[60:63], 0
    v_fma_f32 v113, v113, v115, -v114
    ds_read_b128 v[56:59], v9 offset:4096
    ds_read_b128 v[60:63], v9 offset:24576
    s_waitcnt lgkmcnt(6)
    v_mfma_f32_16x16x32_bf16 v[88:91], a[4:7], v[64:67], v[88:91]
    v_max_f32 v113, 0, v113
    v_mfma_f32_16x16x32_bf16 v[92:95], a[84:87], v[64:67], v[92:95]
    v_add_f32 v113, 0x3727c5ac, v113
    v_mfma_f32_16x16x32_bf16 v[96:99], a[164:167], v[64:67], v[96:99]
    v_rsq_f32 v132, v113
    v_mfma_f32_16x16x32_bf16 v[100:103], a[4:7], v[68:71], v[100:103]
    v_mul_f32 v133, v112, v132
    v_mfma_f32_16x16x32_bf16 v[104:107], a[84:87], v[68:71], v[104:107]
    v_sub_f32 v133, 0, v133
    v_mfma_f32_16x16x32_bf16 v[108:111], a[164:167], v[68:71], v[108:111]
    v_add_f32 v116, v116, v118
    ds_read_b128 v[64:67], v9 offset:5120
    ds_read_b128 v[68:71], v9 offset:25600
    s_waitcnt lgkmcnt(6)
    v_mfma_f32_16x16x32_bf16 v[88:91], a[8:11], v[72:75], v[88:91]
    v_add_f32 v117, v117, v119
    v_mfma_f32_16x16x32_bf16 v[92:95], a[88:91], v[72:75], v[92:95]
    v_mul_f32 v116, 0x3acccccd, v116
    v_mfma_f32_16x16x32_bf16 v[96:99], a[168:171], v[72:75], v[96:99]
    v_mul_f32 v118, v116, v116
    v_mfma_f32_16x16x32_bf16 v[100:103], a[8:11], v[76:79], v[100:103]
    v_mov_b32 v119, 0x3acccccd
    v_mfma_f32_16x16x32_bf16 v[104:107], a[88:91], v[76:79], v[104:107]
    v_fma_f32 v117, v117, v119, -v118
    v_mfma_f32_16x16x32_bf16 v[108:111], a[168:171], v[76:79], v[108:111]
    v_max_f32 v117, 0, v117
    ds_read_b128 v[72:75], v9 offset:6144
    ds_read_b128 v[76:79], v9 offset:26624
    s_waitcnt lgkmcnt(6)
    v_mfma_f32_16x16x32_bf16 v[88:91], a[12:15], v[80:83], v[88:91]
    v_add_f32 v117, 0x3727c5ac, v117
    v_mfma_f32_16x16x32_bf16 v[92:95], a[92:95], v[80:83], v[92:95]
    v_rsq_f32 v134, v117
    v_mfma_f32_16x16x32_bf16 v[96:99], a[172:175], v[80:83], v[96:99]
    v_mul_f32 v135, v116, v134
    v_mfma_f32_16x16x32_bf16 v[100:103], a[12:15], v[84:87], v[100:103]
    v_sub_f32 v135, 0, v135
    v_mfma_f32_16x16x32_bf16 v[104:107], a[92:95], v[84:87], v[104:107]
    v_mfma_f32_16x16x32_bf16 v[108:111], a[172:175], v[84:87], v[108:111]
    ds_read_b128 v[80:83], v9 offset:7168
    ds_read_b128 v[84:87], v9 offset:27648
    s_waitcnt lgkmcnt(6)
    v_mfma_f32_16x16x32_bf16 v[88:91], a[16:19], v[56:59], v[88:91]
    v_mfma_f32_16x16x32_bf16 v[92:95], a[96:99], v[56:59], v[92:95]
    v_mfma_f32_16x16x32_bf16 v[96:99], a[176:179], v[56:59], v[96:99]
    v_mfma_f32_16x16x32_bf16 v[100:103], a[16:19], v[60:63], v[100:103]
    v_mfma_f32_16x16x32_bf16 v[104:107], a[96:99], v[60:63], v[104:107]
    v_mfma_f32_16x16x32_bf16 v[108:111], a[176:179], v[60:63], v[108:111]
    ds_read_b128 v[56:59], v9 offset:8192
    ds_read_b128 v[60:63], v9 offset:28672
    s_waitcnt lgkmcnt(6)
    v_mfma_f32_16x16x32_bf16 v[88:91], a[20:23], v[64:67], v[88:91]
    v_mfma_f32_16x16x32_bf16 v[92:95], a[100:103], v[64:67], v[92:95]
    v_mfma_f32_16x16x32_bf16 v[96:99], a[180:183], v[64:67], v[96:99]
    v_mfma_f32_16x16x32_bf16 v[100:103], a[20:23], v[68:71], v[100:103]
    v_mfma_f32_16x16x32_bf16 v[104:107], a[100:103], v[68:71], v[104:107]
    v_mfma_f32_16x16x32_bf16 v[108:111], a[180:183], v[68:71], v[108:111]
    ds_read_b128 v[64:67], v9 offset:9216
    ds_read_b128 v[68:71], v9 offset:29696
    s_waitcnt lgkmcnt(6)
    v_mfma_f32_16x16x32_bf16 v[88:91], a[24:27], v[72:75], v[88:91]
    v_mfma_f32_16x16x32_bf16 v[92:95], a[104:107], v[72:75], v[92:95]
    v_mfma_f32_16x16x32_bf16 v[96:99], a[184:187], v[72:75], v[96:99]
    v_mfma_f32_16x16x32_bf16 v[100:103], a[24:27], v[76:79], v[100:103]
    v_mfma_f32_16x16x32_bf16 v[104:107], a[104:107], v[76:79], v[104:107]
    v_mfma_f32_16x16x32_bf16 v[108:111], a[184:187], v[76:79], v[108:111]
    ds_read_b128 v[72:75], v9 offset:10240
    ds_read_b128 v[76:79], v9 offset:30720
    s_waitcnt lgkmcnt(6)
    v_mfma_f32_16x16x32_bf16 v[88:91], a[28:31], v[80:83], v[88:91]
    v_mfma_f32_16x16x32_bf16 v[92:95], a[108:111], v[80:83], v[92:95]
    v_mfma_f32_16x16x32_bf16 v[96:99], a[188:191], v[80:83], v[96:99]
    v_mfma_f32_16x16x32_bf16 v[100:103], a[28:31], v[84:87], v[100:103]
    v_mfma_f32_16x16x32_bf16 v[104:107], a[108:111], v[84:87], v[104:107]
    v_mfma_f32_16x16x32_bf16 v[108:111], a[188:191], v[84:87], v[108:111]
    ds_read_b128 v[80:83], v9 offset:11264
    ds_read_b128 v[84:87], v9 offset:31744
    s_waitcnt lgkmcnt(6)
    v_mfma_f32_16x16x32_bf16 v[88:91], a[32:35], v[56:59], v[88:91]
    v_mfma_f32_16x16x32_bf16 v[92:95], a[112:115], v[56:59], v[92:95]
    v_mfma_f32_16x16x32_bf16 v[96:99], a[192:195], v[56:59], v[96:99]
    v_mfma_f32_16x16x32_bf16 v[100:103], a[32:35], v[60:63], v[100:103]
    v_mfma_f32_16x16x32_bf16 v[104:107], a[112:115], v[60:63], v[104:107]
    v_mfma_f32_16x16x32_bf16 v[108:111], a[192:195], v[60:63], v[108:111]
    ds_read_b128 v[56:59], v9 offset:12288
    ds_read_b128 v[60:63], v9 offset:32768
    s_waitcnt lgkmcnt(6)
    v_mfma_f32_16x16x32_bf16 v[88:91], a[36:39], v[64:67], v[88:91]
    v_mfma_f32_16x16x32_bf16 v[92:95], a[116:119], v[64:67], v[92:95]
    v_mfma_f32_16x16x32_bf16 v[96:99], a[196:199], v[64:67], v[96:99]
    v_mfma_f32_16x16x32_bf16 v[100:103], a[36:39], v[68:71], v[100:103]
    v_mfma_f32_16x16x32_bf16 v[104:107], a[116:119], v[68:71], v[104:107]
    v_mfma_f32_16x16x32_bf16 v[108:111], a[196:199], v[68:71], v[108:111]
    s_waitcnt vmcnt(10)
    s_barrier
    v_mov_b32 v15, s40
    buffer_store_dword v15, v14, s[8:11], 0 offen sc1
    s_cmp_ge_i32 s79, 0
    s_cselect_b32 s24, 0, 2146435072
    v_or_b32 v246, s24, v245
    v_mov_b32 v247, s79
    buffer_store_dword v247, v246, s[8:11], 0 offen sc1
    s_mov_b32 s79, -1
    buffer_load_dword v152, v4, s[8:11], 0 offen sc1
    ds_read_b128 v[64:67], v9 offset:13312
    ds_read_b128 v[68:71], v9 offset:33792
    s_waitcnt lgkmcnt(6)
    v_mfma_f32_16x16x32_bf16 v[88:91], a[40:43], v[72:75], v[88:91]
    v_mfma_f32_16x16x32_bf16 v[92:95], a[120:123], v[72:75], v[92:95]
    v_mfma_f32_16x16x32_bf16 v[96:99], a[200:203], v[72:75], v[96:99]
    v_mfma_f32_16x16x32_bf16 v[100:103], a[40:43], v[76:79], v[100:103]
    v_mfma_f32_16x16x32_bf16 v[104:107], a[120:123], v[76:79], v[104:107]
    v_mfma_f32_16x16x32_bf16 v[108:111], a[200:203], v[76:79], v[108:111]
    ds_read_b128 v[72:75], v9 offset:14336
    ds_read_b128 v[76:79], v9 offset:34816
    s_waitcnt lgkmcnt(6)
    s_waitcnt vmcnt(3)
    v_mfma_f32_16x16x32_bf16 v[88:91], a[44:47], v[80:83], v[88:91]
    v_mfma_f32_16x16x32_bf16 v[92:95], a[124:127], v[80:83], v[92:95]
    ds_write_b128 v10, v[16:19] offset:0
    v_mfma_f32_16x16x32_bf16 v[96:99], a[204:207], v[80:83], v[96:99]
    v_mfma_f32_16x16x32_bf16 v[100:103], a[44:47], v[84:87], v[100:103]
    v_mfma_f32_16x16x32_bf16 v[104:107], a[124:127], v[84:87], v[104:107]
    v_mfma_f32_16x16x32_bf16 v[108:111], a[204:207], v[84:87], v[108:111]
    v_mfma_f32_16x16x32_bf16 v[148:151], v[16:19], v[16:19], 0
    v_mfma_f32_16x16x32_bf16 v[144:147], v[236:239], v[16:19], 0
    v_mfma_f32_16x16x32_bf16 v[148:151], v[20:23], v[20:23], v[148:151]
    ds_read_b128 v[80:83], v9 offset:15360
    ds_read_b128 v[84:87], v9 offset:35840
    s_waitcnt lgkmcnt(7)
    v_mfma_f32_16x16x32_bf16 v[88:91], a[48:51], v[56:59], v[88:91]
    v_mfma_f32_16x16x32_bf16 v[92:95], a[128:131], v[56:59], v[92:95]
    ds_write_b128 v10, v[20:23] offset:1024
    v_mfma_f32_16x16x32_bf16 v[96:99], a[208:211], v[56:59], v[96:99]
    v_mfma_f32_16x16x32_bf16 v[100:103], a[48:51], v[60:63], v[100:103]
    v_mfma_f32_16x16x32_bf16 v[104:107], a[128:131], v[60:63], v[104:107]
    v_mfma_f32_16x16x32_bf16 v[108:111], a[208:211], v[60:63], v[108:111]
    v_mfma_f32_16x16x32_bf16 v[144:147], v[236:239], v[20:23], v[144:147]
    v_mfma_f32_16x16x32_bf16 v[148:151], v[24:27], v[24:27], v[148:151]
    v_mfma_f32_16x16x32_bf16 v[144:147], v[236:239], v[24:27], v[144:147]
    ds_read_b128 v[56:59], v9 offset:16384
    ds_read_b128 v[60:63], v9 offset:36864
    s_waitcnt lgkmcnt(8)
    v_mfma_f32_16x16x32_bf16 v[88:91], a[52:55], v[64:67], v[88:91]
    v_mfma_f32_16x16x32_bf16 v[92:95], a[132:135], v[64:67], v[92:95]
    ds_write_b128 v10, v[24:27] offset:2048
    v_mfma_f32_16x16x32_bf16 v[96:99], a[212:215], v[64:67], v[96:99]
    v_mfma_f32_16x16x32_bf16 v[100:103], a[52:55], v[68:71], v[100:103]
    v_mfma_f32_16x16x32_bf16 v[104:107], a[132:135], v[68:71], v[104:107]
    v_mfma_f32_16x16x32_bf16 v[108:111], a[212:215], v[68:71], v[108:111]
    v_mfma_f32_16x16x32_bf16 v[148:151], v[28:31], v[28:31], v[148:151]
    v_mfma_f32_16x16x32_bf16 v[144:147], v[236:239], v[28:31], v[144:147]
    v_mfma_f32_16x16x32_bf16 v[148:151], v[32:35], v[32:35], v[148:151]
    ds_read_b128 v[64:67], v9 offset:17408
    ds_read_b128 v[68:71], v9 offset:37888
    s_waitcnt lgkmcnt(9)
    v_mfma_f32_16x16x32_bf16 v[88:91], a[56:59], v[72:75], v[88:91]
    v_mfma_f32_16x16x32_bf16 v[92:95], a[136:139], v[72:75], v[92:95]
    ds_write_b128 v10, v[28:31] offset:3072
    v_mfma_f32_16x16x32_bf16 v[96:99], a[216:219], v[72:75], v[96:99]
    v_mfma_f32_16x16x32_bf16 v[100:103], a[56:59], v[76:79], v[100:103]
    v_mfma_f32_16x16x32_bf16 v[104:107], a[136:139], v[76:79], v[104:107]
    v_mfma_f32_16x16x32_bf16 v[108:111], a[216:219], v[76:79], v[108:111]
    v_mfma_f32_16x16x32_bf16 v[144:147], v[236:239], v[32:35], v[144:147]
    v_mfma_f32_16x16x32_bf16 v[148:151], v[36:39], v[36:39], v[148:151]
    v_mfma_f32_16x16x32_bf16 v[144:147], v[236:239], v[36:39], v[144:147]
    ds_read_b128 v[72:75], v9 offset:18432
    ds_read_b128 v[76:79], v9 offset:38912
    s_waitcnt lgkmcnt(9)
    v_mfma_f32_16x16x32_bf16 v[88:91], a[60:63], v[80:83], v[88:91]
    v_mfma_f32_16x16x32_bf16 v[92:95], a[140:143], v[80:83], v[92:95]
    ds_write_b128 v10, v[32:35] offset:4096
    v_mfma_f32_16x16x32_bf16 v[96:99], a[220:223], v[80:83], v[96:99]
    v_mfma_f32_16x16x32_bf16 v[100:103], a[60:63], v[84:87], v[100:103]
    v_mfma_f32_16x16x32_bf16 v[104:107], a[140:143], v[84:87], v[104:107]
    v_mfma_f32_16x16x32_bf16 v[108:111], a[220:223], v[84:87], v[108:111]
    v_mfma_f32_16x16x32_bf16 v[148:151], v[40:43], v[40:43], v[148:151]
    v_mfma_f32_16x16x32_bf16 v[144:147], v[236:239], v[40:43], v[144:147]
    v_mfma_f32_16x16x32_bf16 v[148:151], v[44:47], v[44:47], v[148:151]
    ds_read_b128 v[80:83], v9 offset:19456
    ds_read_b128 v[84:87], v9 offset:39936
    s_waitcnt lgkmcnt(9)
    v_mfma_f32_16x16x32_bf16 v[88:91], a[64:67], v[56:59], v[88:91]
    v_mfma_f32_16x16x32_bf16 v[92:95], a[144:147], v[56:59], v[92:95]
    ds_write_b128 v10, v[36:39] offset:5120
    v_mfma_f32_16x16x32_bf16 v[96:99], a[224:227], v[56:59], v[96:99]
    v_mfma_f32_16x16x32_bf16 v[100:103], a[64:67], v[60:63], v[100:103]
    v_mfma_f32_16x16x32_bf16 v[104:107], a[144:147], v[60:63], v[104:107]
    v_mfma_f32_16x16x32_bf16 v[108:111], a[224:227], v[60:63], v[108:111]
    v_mfma_f32_16x16x32_bf16 v[144:147], v[236:239], v[44:47], v[144:147]
    v_mfma_f32_16x16x32_bf16 v[148:151], v[48:51], v[48:51], v[148:151]
    v_mfma_f32_16x16x32_bf16 v[144:147], v[236:239], v[48:51], v[144:147]
    s_waitcnt lgkmcnt(7)
    v_mfma_f32_16x16x32_bf16 v[88:91], a[68:71], v[64:67], v[88:91]
    v_mfma_f32_16x16x32_bf16 v[92:95], a[148:151], v[64:67], v[92:95]
    ds_write_b128 v10, v[40:43] offset:6144
    v_mfma_f32_16x16x32_bf16 v[96:99], a[228:231], v[64:67], v[96:99]
    v_mfma_f32_16x16x32_bf16 v[100:103], a[68:71], v[68:71], v[100:103]
    v_mfma_f32_16x16x32_bf16 v[104:107], a[148:151], v[68:71], v[104:107]
    v_mfma_f32_16x16x32_bf16 v[108:111], a[228:231], v[68:71], v[108:111]
    v_mfma_f32_16x16x32_bf16 v[148:151], v[52:55], v[52:55], v[148:151]
    v_mfma_f32_16x16x32_bf16 v[144:147], v[236:239], v[52:55], v[144:147]
    s_waitcnt lgkmcnt(5)
    v_mfma_f32_16x16x32_bf16 v[88:91], a[72:75], v[72:75], v[88:91]
    v_mfma_f32_16x16x32_bf16 v[92:95], a[152:155], v[72:75], v[92:95]
    ds_write_b128 v10, v[44:47] offset:7168
    v_mfma_f32_16x16x32_bf16 v[96:99], a[232:235], v[72:75], v[96:99]
    v_mfma_f32_16x16x32_bf16 v[100:103], a[72:75], v[76:79], v[100:103]
    v_mfma_f32_16x16x32_bf16 v[104:107], a[152:155], v[76:79], v[104:107]
    v_mfma_f32_16x16x32_bf16 v[108:111], a[232:235], v[76:79], v[108:111]
    s_waitcnt lgkmcnt(3)
    v_mfma_f32_16x16x32_bf16 v[88:91], a[76:79], v[80:83], v[88:91]
    v_mfma_f32_16x16x32_bf16 v[92:95], a[156:159], v[80:83], v[92:95]
    ds_write_b128 v10, v[48:51] offset:8192
    v_mfma_f32_16x16x32_bf16 v[96:99], a[236:239], v[80:83], v[96:99]
    v_mfma_f32_16x16x32_bf16 v[100:103], a[76:79], v[84:87], v[100:103]
    v_mfma_f32_16x16x32_bf16 v[104:107], a[156:159], v[84:87], v[104:107]
    v_mfma_f32_16x16x32_bf16 v[108:111], a[236:239], v[84:87], v[108:111]
    v_cndmask_b32 v145, v148, v149, s[48:49]
    v_cndmask_b32 v145, v145, v150, s[50:51]
    v_cndmask_b32 v145, v145, v151, s[54:55]
    ds_write_b128 v10, v[52:55] offset:9216
    ds_write_b64 v140, v[144:145]
    v_pk_mul_f32 v[124:125], v[224:225], v[132:133] op_sel:[0,1] op_sel_hi:[1,1]
    v_pk_mul_f32 v[126:127], v[226:227], v[132:133] op_sel:[0,1] op_sel_hi:[1,1]
    v_pk_fma_f32 v[88:89], v[88:89], v[132:133], v[124:125] op_sel:[0,0,0] op_sel_hi:[1,0,1]
    v_pk_fma_f32 v[90:91], v[90:91], v[132:133], v[126:127] op_sel:[0,0,0] op_sel_hi:[1,0,1]
    v_pk_mul_f32 v[124:125], v[228:229], v[132:133] op_sel:[0,1] op_sel_hi:[1,1]
    v_pk_mul_f32 v[126:127], v[230:231], v[132:133] op_sel:[0,1] op_sel_hi:[1,1]
    v_pk_fma_f32 v[92:93], v[92:93], v[132:133], v[124:125] op_sel:[0,0,0] op_sel_hi:[1,0,1]
    v_pk_fma_f32 v[94:95], v[94:95], v[132:133], v[126:127] op_sel:[0,0,0] op_sel_hi:[1,0,1]
    v_pk_mul_f32 v[124:125], v[232:233], v[132:133] op_sel:[0,1] op_sel_hi:[1,1]
    v_pk_mul_f32 v[126:127], v[234:235], v[132:133] op_sel:[0,1] op_sel_hi:[1,1]
    v_pk_fma_f32 v[96:97], v[96:97], v[132:133], v[124:125] op_sel:[0,0,0] op_sel_hi:[1,0,1]
    v_pk_fma_f32 v[98:99], v[98:99], v[132:133], v[126:127] op_sel:[0,0,0] op_sel_hi:[1,0,1]
    v_pk_mul_f32 v[124:125], v[224:225], v[134:135] op_sel:[0,1] op_sel_hi:[1,1]
    v_pk_mul_f32 v[126:127], v[226:227], v[134:135] op_sel:[0,1] op_sel_hi:[1,1]
    v_pk_fma_f32 v[100:101], v[100:101], v[134:135], v[124:125] op_sel:[0,0,0] op_sel_hi:[1,0,1]
    v_pk_fma_f32 v[102:103], v[102:103], v[134:135], v[126:127] op_sel:[0,0,0] op_sel_hi:[1,0,1]
    v_pk_mul_f32 v[124:125], v[228:229], v[134:135] op_sel:[0,1] op_sel_hi:[1,1]
    v_pk_mul_f32 v[126:127], v[230:231], v[134:135] op_sel:[0,1] op_sel_hi:[1,1]
    v_pk_fma_f32 v[104:105], v[104:105], v[134:135], v[124:125] op_sel:[0,0,0] op_sel_hi:[1,0,1]
    v_pk_fma_f32 v[106:107], v[106:107], v[134:135], v[126:127] op_sel:[0,0,0] op_sel_hi:[1,0,1]
    v_pk_mul_f32 v[124:125], v[232:233], v[134:135] op_sel:[0,1] op_sel_hi:[1,1]
    v_pk_mul_f32 v[126:127], v[234:235], v[134:135] op_sel:[0,1] op_sel_hi:[1,1]
    v_pk_fma_f32 v[108:109], v[108:109], v[134:135], v[124:125] op_sel:[0,0,0] op_sel_hi:[1,0,1]
    v_pk_fma_f32 v[110:111], v[110:111], v[134:135], v[126:127] op_sel:[0,0,0] op_sel_hi:[1,0,1]
    v_cvt_pk_bf16_f32 v112, v88, v89
    v_cvt_pk_bf16_f32 v113, v90, v91
    v_cvt_pk_bf16_f32 v114, v92, v93
    v_cvt_pk_bf16_f32 v115, v94, v95
    v_cvt_pk_bf16_f32 v116, v100, v101
    v_cvt_pk_bf16_f32 v117, v102, v103
    v_cvt_pk_bf16_f32 v118, v104, v105
    v_cvt_pk_bf16_f32 v119, v106, v107
    v_cvt_pk_bf16_f32 v120, v96, v97
    v_cvt_pk_bf16_f32 v121, v98, v99
    v_cvt_pk_bf16_f32 v122, v108, v109
    v_cvt_pk_bf16_f32 v123, v110, v111
    buffer_store_dwordx4 v[112:115], v11, s[8:11], s43 offen offset:0 sc1
    buffer_store_dwordx4 v[116:119], v11, s[8:11], s43 offen offset:1024 sc1
    buffer_store_dwordx4 v[120:123], v11, s[8:11], s43 offen offset:2048 sc1
    s_add_u32 s43, s43, 393216
    s_waitcnt vmcnt(3)
    s_add_u32 s40, s40, 1
    s_add_u32 s63, s40, 1
    s_lshr_b32 s63, s63, s75
    s_add_u32 s63, s63, 1
    s_min_u32 s63, s63, s74
    v_cmp_le_i32 vcc, s63, v152
    s_cmp_eq_u64 vcc, -1
    s_cselect_b32 s58, 1, 0
    s_cmp_ge_i32 s62, s63
    s_cselect_b32 s58, 1, s58
    s_and_b32 s24, s40, 1
    s_lshl_b32 s24, s24, 2
    s_add_u32 s24, s24, 83456
    s_lshl_b32 s25, s3, 4
    s_add_u32 s25, s25, s24
    v_mov_b32 v15, s25
    v_mov_b32 v152, s58
    ds_write_b32 v15, v152
    v_mov_b32 v15, s24
    s_waitcnt lgkmcnt(0)
    s_barrier
    ds_read_b32 v152, v15
    s_waitcnt lgkmcnt(0)
    v_readfirstlane_b32 s58, v152
    s_cmp_eq_u32 s58, 1
    s_cselect_b32 s24, s63, s62
    s_max_i32 s62, s62, s24
interleave_layers__linear_attn_block__memory_aug_recurrent_mem_tr__prompt_kernel_p_next:
    s_add_u32 s24, s64, 8
    s_cmp_le_u32 s24, s40
    s_cbranch_scc1 interleave_layers__linear_attn_block__memory_aug_recurrent_mem_tr__prompt_kernel_p_pub
    s_cmp_lt_u32 s40, 64
    s_cbranch_scc0 interleave_layers__linear_attn_block__memory_aug_recurrent_mem_tr__prompt_kernel_pg32
    s_cmp_eq_u32 s58, 1
    s_cbranch_scc1 interleave_layers__linear_attn_block__memory_aug_recurrent_mem_tr__prompt_kernel_p_seg
    s_branch interleave_layers__linear_attn_block__memory_aug_recurrent_mem_tr__prompt_kernel_p_pubA
interleave_layers__linear_attn_block__memory_aug_recurrent_mem_tr__prompt_kernel_pg32:
interleave_layers__linear_attn_block__memory_aug_recurrent_mem_tr__prompt_kernel_p_pub:
    s_waitcnt vmcnt(0)
    s_barrier
    s_cmp_eq_u32 s3, 0
    s_cbranch_scc0 interleave_layers__linear_attn_block__memory_aug_recurrent_mem_tr__prompt_kernel_fp33
    v_mov_b32 v15, s40
    buffer_store_dword v15, v14, s[8:11], 0 offen sc1
interleave_layers__linear_attn_block__memory_aug_recurrent_mem_tr__prompt_kernel_fp33:
    s_add_u32 s24, s64, 8
    s_cmp_le_u32 s24, s40
    s_cbranch_scc1 interleave_layers__linear_attn_block__memory_aug_recurrent_mem_tr__prompt_kernel_p_x
    s_cmp_lt_u32 s40, 64
    s_cbranch_scc0 interleave_layers__linear_attn_block__memory_aug_recurrent_mem_tr__prompt_kernel_pg34
    s_cmp_eq_u32 s58, 1
    s_cbranch_scc1 interleave_layers__linear_attn_block__memory_aug_recurrent_mem_tr__prompt_kernel_p_seg
    s_branch interleave_layers__linear_attn_block__memory_aug_recurrent_mem_tr__prompt_kernel_p_pubA
interleave_layers__linear_attn_block__memory_aug_recurrent_mem_tr__prompt_kernel_pg34:
    s_cmp_ge_u32 s64, 64
    s_cbranch_scc1 interleave_layers__linear_attn_block__memory_aug_recurrent_mem_tr__prompt_kernel_p_done
interleave_layers__linear_attn_block__memory_aug_recurrent_mem_tr__prompt_kernel_p_x:
    s_add_u32 s63, s64, 1
    s_cmp_ge_i32 s69, s63
    s_cbranch_scc1 interleave_layers__linear_attn_block__memory_aug_recurrent_mem_tr__prompt_kernel_x_en_ok
    s_mov_b32 s61, 0
interleave_layers__linear_attn_block__memory_aug_recurrent_mem_tr__prompt_kernel_x_en:
    buffer_load_dword v253, v252, s[8:11], 0 offen sc1
    s_waitcnt vmcnt(0)
    v_readlane_b32 s69, v253, 0
    v_readlane_b32 s24, v253, 1
    s_min_i32 s69, s69, s24
    v_readlane_b32 s24, v253, 2
    s_min_i32 s69, s69, s24
    v_readlane_b32 s24, v253, 3
    s_min_i32 s69, s69, s24
    v_readlane_b32 s24, v253, 4
    s_min_i32 s69, s69, s24
    v_readlane_b32 s24, v253, 5
    s_min_i32 s69, s69, s24
    v_readlane_b32 s24, v253, 6
    s_min_i32 s69, s69, s24
    v_readlane_b32 s24, v253, 7
    s_min_i32 s69, s69, s24
    s_cmp_ge_i32 s69, s63
    s_cbranch_scc1 interleave_layers__linear_attn_block__memory_aug_recurrent_mem_tr__prompt_kernel_x_en_ok
    s_add_u32 s61, s61, 1
    s_cmp_ge_u32 s61, s60
    s_cbranch_scc1 interleave_layers__linear_attn_block__memory_aug_recurrent_mem_tr__prompt_kernel_x_en_to
    s_sleep 2
    s_branch interleave_layers__linear_attn_block__memory_aug_recurrent_mem_tr__prompt_kernel_x_en
interleave_layers__linear_attn_block__memory_aug_recurrent_mem_tr__prompt_kernel_x_en_to:
    s_mov_b32 s60, 1
interleave_layers__linear_attn_block__memory_aug_recurrent_mem_tr__prompt_kernel_x_en_ok:
    s_lshl_b32 s95, s92, 6
    s_add_u32 s95, s95, s64
    s_add_u32 s95, s95, 1
    s_cmp_ge_i32 s59, s95
    s_cbranch_scc1 interleave_layers__linear_attn_block__memory_aug_recurrent_mem_tr__prompt_kernel_x_ec_ok
    s_and_b32 s24, s2, 7
    s_lshl_b32 s24, s24, 7
    s_add_u32 s24, s24, 23109632
    v_and_b32 v254, 3, v1
    v_lshl_add_u32 v254, v254, 2, s24
    s_mov_b32 s61, 0
interleave_layers__linear_attn_block__memory_aug_recurrent_mem_tr__prompt_kernel_x_ec:
    buffer_load_dword v253, v254, s[8:11], 0 offen sc1
    s_waitcnt vmcnt(0)
    v_readlane_b32 s59, v253, 0
    v_readlane_b32 s24, v253, 1
    s_min_i32 s59, s59, s24
    v_readlane_b32 s24, v253, 2
    s_min_i32 s59, s59, s24
    s_cmp_ge_i32 s59, s95
    s_cbranch_scc1 interleave_layers__linear_attn_block__memory_aug_recurrent_mem_tr__prompt_kernel_x_ec_ok
    s_add_u32 s61, s61, 1
    s_cmp_ge_u32 s61, s60
    s_cbranch_scc1 interleave_layers__linear_attn_block__memory_aug_recurrent_mem_tr__prompt_kernel_x_ec_to
    s_sleep 2
    s_branch interleave_layers__linear_attn_block__memory_aug_recurrent_mem_tr__prompt_kernel_x_ec
interleave_layers__linear_attn_block__memory_aug_recurrent_mem_tr__prompt_kernel_x_ec_to:
    s_mov_b32 s60, 1
interleave_layers__linear_attn_block__memory_aug_recurrent_mem_tr__prompt_kernel_x_ec_ok:
    s_add_u32 s52, s65, 32768
    buffer_load_dwordx4 v[16:19], v240, s[8:11], s65 offen offset:0 sc1
    buffer_load_dwordx4 v[20:23], v240, s[8:11], s65 offen offset:1024 sc1
    buffer_load_dwordx4 v[24:27], v240, s[8:11], s65 offen offset:2048 sc1
    buffer_load_dwordx4 v[28:31], v240, s[8:11], s65 offen offset:3072 sc1
    buffer_load_dwordx4 v[32:35], v241, s[8:11], s65 offen offset:0 sc1
    buffer_load_dwordx4 v[36:39], v241, s[8:11], s65 offen offset:1024 sc1
    buffer_load_dwordx4 v[40:43], v241, s[8:11], s65 offen offset:2048 sc1
    buffer_load_dwordx4 v[44:47], v241, s[8:11], s65 offen offset:3072 sc1
    buffer_load_dwordx4 v[48:51], v240, s[8:11], s52 offen offset:0 sc1
    buffer_load_dwordx4 v[52:55], v240, s[8:11], s52 offen offset:1024 sc1
    buffer_load_dwordx4 v[56:59], v240, s[8:11], s52 offen offset:2048 sc1
    buffer_load_dwordx4 v[60:63], v240, s[8:11], s52 offen offset:3072 sc1
    buffer_load_dwordx4 v[64:67], v241, s[8:11], s52 offen offset:0 sc1
    buffer_load_dwordx4 v[68:71], v241, s[8:11], s52 offen offset:1024 sc1
    buffer_load_dwordx4 v[72:75], v241, s[8:11], s52 offen offset:2048 sc1
    buffer_load_dwordx4 v[76:79], v241, s[8:11], s52 offen offset:3072 sc1
    s_add_u32 s24, s68, s73
    buffer_load_dwordx4 v[196:199], v219, s[8:11], s24 offen sc1
    s_lshl_b32 s77, s92, 6
    s_add_u32 s77, s77, s64
    s_add_u32 s77, s77, 1
    s_cmp_ge_i32 s76, s77
    s_cbranch_scc1 interleave_layers__linear_attn_block__memory_aug_recurrent_mem_tr__prompt_kernel_x_cs_ok
    s_and_b32 s24, s2, 7
    s_lshl_b32 s24, s24, 7
    s_add_u32 s24, s24, 23111680
    v_mov_b32 v254, s24
    s_mov_b32 s61, 0
interleave_layers__linear_attn_block__memory_aug_recurrent_mem_tr__prompt_kernel_x_cs:
    buffer_load_dword v253, v254, s[8:11], 0 offen sc1
    s_waitcnt vmcnt(0)
    v_readlane_b32 s76, v253, 0
    s_cmp_ge_i32 s76, s77
    s_cbranch_scc1 interleave_layers__linear_attn_block__memory_aug_recurrent_mem_tr__prompt_kernel_x_cs_ok
    s_add_u32 s61, s61, 1
    s_cmp_ge_u32 s61, s60
    s_cbranch_scc1 interleave_layers__linear_attn_block__memory_aug_recurrent_mem_tr__prompt_kernel_x_cs_to
    s_sleep 16
    s_branch interleave_layers__linear_attn_block__memory_aug_recurrent_mem_tr__prompt_kernel_x_cs
interleave_layers__linear_attn_block__memory_aug_recurrent_mem_tr__prompt_kernel_x_cs_to:
    s_mov_b32 s60, 1
interleave_layers__linear_attn_block__memory_aug_recurrent_mem_tr__prompt_kernel_x_cs_ok:
    s_add_u32 s53, s66, 16384
    s_mov_b32 s61, 0
interleave_layers__linear_attn_block__memory_aug_recurrent_mem_tr__prompt_kernel_x_p1:
    buffer_load_dwordx4 v[80:83], v212, s[8:11], s67 offen offset:0 sc1
    buffer_load_dwordx4 v[84:87], v212, s[8:11], s67 offen offset:1024 sc1
    buffer_load_dwordx4 v[88:91], v212, s[8:11], s67 offen offset:2048 sc1
    buffer_load_dwordx4 v[92:95], v212, s[8:11], s67 offen offset:3072 sc1
    buffer_load_dwordx4 v[96:99], v213, s[8:11], s67 offen offset:0 sc1
    buffer_load_dwordx4 v[100:103], v213, s[8:11], s67 offen offset:1024 sc1
    buffer_load_dwordx4 v[104:107], v213, s[8:11], s67 offen offset:2048 sc1
    buffer_load_dwordx4 v[108:111], v213, s[8:11], s67 offen offset:3072 sc1
    buffer_load_dwordx4 v[112:115], v214, s[8:11], s67 offen offset:0 sc1
    buffer_load_dwordx4 v[116:119], v214, s[8:11], s67 offen offset:1024 sc1
    buffer_load_dwordx4 v[120:123], v214, s[8:11], s67 offen offset:2048 sc1
    buffer_load_dwordx4 v[124:127], v214, s[8:11], s67 offen offset:3072 sc1
    buffer_load_dwordx4 v[128:131], v215, s[8:11], s67 offen offset:0 sc1
    buffer_load_dwordx4 v[132:135], v215, s[8:11], s67 offen offset:1024 sc1
    buffer_load_dwordx4 v[136:139], v215, s[8:11], s67 offen offset:2048 sc1
    buffer_load_dwordx4 v[140:143], v215, s[8:11], s67 offen offset:3072 sc1
    buffer_load_dwordx4 v[144:147], v216, s[8:11], s67 offen offset:0 sc1
    buffer_load_dwordx4 v[148:151], v216, s[8:11], s67 offen offset:1024 sc1
    buffer_load_dwordx4 v[152:155], v216, s[8:11], s67 offen offset:2048 sc1
    buffer_load_dwordx4 v[156:159], v216, s[8:11], s67 offen offset:3072 sc1
    buffer_load_dwordx4 v[160:163], v242, s[8:11], s66 offen offset:0 sc1
    buffer_load_dwordx4 v[164:167], v242, s[8:11], s66 offen offset:1024 sc1
    buffer_load_dwordx4 v[168:171], v242, s[8:11], s53 offen offset:0 sc1
    buffer_load_dwordx4 v[172:175], v242, s[8:11], s53 offen offset:1024 sc1
    s_waitcnt vmcnt(0)
    v_max3_u32 v192, v80, v81, v82
    v_max3_u32 v192, v192, v83, v84
    v_max3_u32 v192, v192, v85, v86
    v_max3_u32 v192, v192, v87, v88
    v_max3_u32 v192, v192, v89, v90
    v_max3_u32 v192, v192, v91, v92
    v_max3_u32 v192, v192, v93, v94
    v_max3_u32 v192, v192, v95, v96
    v_max3_u32 v192, v192, v97, v98
    v_max3_u32 v192, v192, v99, v100
    v_max3_u32 v192, v192, v101, v102
    v_max3_u32 v192, v192, v103, v104
    v_max3_u32 v192, v192, v105, v106
    v_max3_u32 v192, v192, v107, v108
    v_max3_u32 v192, v192, v109, v110
    v_max3_u32 v192, v192, v111, v112
    v_max3_u32 v192, v192, v113, v114
    v_max3_u32 v192, v192, v115, v116
    v_max3_u32 v192, v192, v117, v118
    v_max3_u32 v192, v192, v119, v120
    v_max3_u32 v192, v192, v121, v122
    v_max3_u32 v192, v192, v123, v124
    v_max3_u32 v192, v192, v125, v126
    v_max3_u32 v192, v192, v127, v128
    v_max3_u32 v192, v192, v129, v130
    v_max3_u32 v192, v192, v131, v132
    v_max3_u32 v192, v192, v133, v134
    v_max3_u32 v192, v192, v135, v136
    v_max3_u32 v192, v192, v137, v138
    v_max3_u32 v192, v192, v139, v140
    v_max3_u32 v192, v192, v141, v142
    v_max3_u32 v192, v192, v143, v144
    v_max3_u32 v192, v192, v145, v146
    v_max3_u32 v192, v192, v147, v148
    v_max3_u32 v192, v192, v149, v150
    v_max3_u32 v192, v192, v151, v152
    v_max3_u32 v192, v192, v153, v154
    v_max3_u32 v192, v192, v155, v156
    v_max3_u32 v192, v192, v157, v158
    v_max3_u32 v192, v192, v159, v160
    v_max3_u32 v192, v192, v161, v162
    v_max3_u32 v192, v192, v163, v164
    v_max3_u32 v192, v192, v165, v166
    v_max3_u32 v192, v192, v167, v168
    v_max3_u32 v192, v192, v169, v170
    v_max3_u32 v192, v192, v171, v172
    v_max3_u32 v192, v192, v173, v174
    v_max_u32 v192, v192, v175
    v_cmp_eq_u32 vcc, -1, v192
    s_add_u32 s61, s61, 1
    s_cbranch_vccz interleave_layers__linear_attn_block__memory_aug_recurrent_mem_tr__prompt_kernel_x_p1_out
    s_cmp_ge_u32 s61, s60
    s_cbranch_scc1 interleave_layers__linear_attn_block__memory_aug_recurrent_mem_tr__prompt_kernel_x_p1_to
    s_sleep 2
    s_branch interleave_layers__linear_attn_block__memory_aug_recurrent_mem_tr__prompt_kernel_x_p1
interleave_layers__linear_attn_block__memory_aug_recurrent_mem_tr__prompt_kernel_x_p1_to:
    s_mov_b32 s60, 1
interleave_layers__linear_attn_block__memory_aug_recurrent_mem_tr__prompt_kernel_x_p1_out:
    v_mfma_f32_16x16x32_bf16 v[176:179], v[16:19], v[80:83], 0
    v_mfma_f32_16x16x32_bf16 v[180:183], v[16:19], v[84:87], 0
    v_mfma_f32_16x16x32_bf16 v[184:187], v[48:51], v[80:83], 0
    v_mfma_f32_16x16x32_bf16 v[188:191], v[48:51], v[84:87], 0
    v_mfma_f32_16x16x32_bf16 v[176:179], v[20:23], v[88:91], v[176:179]
    v_mfma_f32_16x16x32_bf16 v[180:183], v[20:23], v[92:95], v[180:183]
    v_mfma_f32_16x16x32_bf16 v[184:187], v[52:55], v[88:91], v[184:187]
    v_mfma_f32_16x16x32_bf16 v[188:191], v[52:55], v[92:95], v[188:191]
    v_mfma_f32_16x16x32_bf16 v[176:179], v[24:27], v[96:99], v[176:179]
    v_mfma_f32_16x16x32_bf16 v[180:183], v[24:27], v[100:103], v[180:183]
    v_mfma_f32_16x16x32_bf16 v[184:187], v[56:59], v[96:99], v[184:187]
    v_mfma_f32_16x16x32_bf16 v[188:191], v[56:59], v[100:103], v[188:191]
    v_mfma_f32_16x16x32_bf16 v[176:179], v[28:31], v[104:107], v[176:179]
    v_mfma_f32_16x16x32_bf16 v[180:183], v[28:31], v[108:111], v[180:183]
    v_mfma_f32_16x16x32_bf16 v[184:187], v[60:63], v[104:107], v[184:187]
    v_mfma_f32_16x16x32_bf16 v[188:191], v[60:63], v[108:111], v[188:191]
    v_mfma_f32_16x16x32_bf16 v[176:179], v[32:35], v[112:115], v[176:179]
    v_mfma_f32_16x16x32_bf16 v[180:183], v[32:35], v[116:119], v[180:183]
    v_mfma_f32_16x16x32_bf16 v[184:187], v[64:67], v[112:115], v[184:187]
    v_mfma_f32_16x16x32_bf16 v[188:191], v[64:67], v[116:119], v[188:191]
    v_mfma_f32_16x16x32_bf16 v[176:179], v[36:39], v[120:123], v[176:179]
    v_mfma_f32_16x16x32_bf16 v[180:183], v[36:39], v[124:127], v[180:183]
    v_mfma_f32_16x16x32_bf16 v[184:187], v[68:71], v[120:123], v[184:187]
    v_mfma_f32_16x16x32_bf16 v[188:191], v[68:71], v[124:127], v[188:191]
    v_mfma_f32_16x16x32_bf16 v[176:179], v[40:43], v[128:131], v[176:179]
    v_mfma_f32_16x16x32_bf16 v[180:183], v[40:43], v[132:135], v[180:183]
    v_mfma_f32_16x16x32_bf16 v[184:187], v[72:75], v[128:131], v[184:187]
    v_mfma_f32_16x16x32_bf16 v[188:191], v[72:75], v[132:135], v[188:191]
    v_mfma_f32_16x16x32_bf16 v[176:179], v[44:47], v[136:139], v[176:179]
    v_mfma_f32_16x16x32_bf16 v[180:183], v[44:47], v[140:143], v[180:183]
    v_mfma_f32_16x16x32_bf16 v[184:187], v[76:79], v[136:139], v[184:187]
    v_mfma_f32_16x16x32_bf16 v[188:191], v[76:79], v[140:143], v[188:191]
    v_mfma_f32_16x16x32_bf16 v[176:179], v[160:163], v[144:147], v[176:179]
    v_mfma_f32_16x16x32_bf16 v[180:183], v[160:163], v[148:151], v[180:183]
    v_mfma_f32_16x16x32_bf16 v[184:187], v[168:171], v[144:147], v[184:187]
    v_mfma_f32_16x16x32_bf16 v[188:191], v[168:171], v[148:151], v[188:191]
    v_mfma_f32_16x16x32_bf16 v[176:179], v[164:167], v[152:155], v[176:179]
    v_mfma_f32_16x16x32_bf16 v[180:183], v[164:167], v[156:159], v[180:183]
    v_mfma_f32_16x16x32_bf16 v[184:187], v[172:175], v[152:155], v[184:187]
    v_mfma_f32_16x16x32_bf16 v[188:191], v[172:175], v[156:159], v[188:191]
    s_nop 4
    ds_write_b128 v217, v[176:179] offset:0
    ds_write_b128 v217, v[180:183] offset:1024
    ds_write_b128 v217, v[184:187] offset:2048
    ds_write_b128 v217, v[188:191] offset:3072
    s_waitcnt lgkmcnt(0)
    s_barrier
    s_cmp_ge_u32 s3, 2
    s_cbranch_scc1 interleave_layers__linear_attn_block__memory_aug_recurrent_mem_tr__prompt_kernel_xs35
    ds_read_b128 v[16:19], v218 offset:0
    ds_read_b128 v[20:23], v218 offset:4096
    ds_read_b128 v[24:27], v218 offset:8192
    ds_read_b128 v[28:31], v218 offset:12288
    ds_read_b128 v[32:35], v218 offset:2048
    ds_read_b128 v[36:39], v218 offset:6144
    ds_read_b128 v[40:43], v218 offset:10240
    ds_read_b128 v[44:47], v218 offset:14336
    s_waitcnt lgkmcnt(4)
    v_pk_add_f32 v[16:17], v[16:17], v[20:21]
    v_pk_add_f32 v[24:25], v[24:25], v[28:29]
    v_pk_add_f32 v[18:19], v[18:19], v[22:23]
    v_pk_add_f32 v[26:27], v[26:27], v[30:31]
    v_pk_add_f32 v[16:17], v[16:17], v[24:25]
    v_pk_add_f32 v[18:19], v[18:19], v[26:27]
    v_cvt_pk_bf16_f32 v20, v16, v17
    v_cvt_pk_bf16_f32 v21, v18, v19
    v_lshlrev_b32 v16, 16, v20
    v_and_b32 v17, 0xffff0000, v20
    v_lshlrev_b32 v22, 16, v196
    v_and_b32 v23, 0xffff0000, v196
    v_pk_add_f32 v[16:17], v[16:17], v[22:23]
    v_cvt_pk_bf16_f32 v48, v16, v17
    v_lshlrev_b32 v16, 16, v21
    v_and_b32 v17, 0xffff0000, v21
    v_lshlrev_b32 v22, 16, v197
    v_and_b32 v23, 0xffff0000, v197
    v_pk_add_f32 v[16:17], v[16:17], v[22:23]
    v_cvt_pk_bf16_f32 v49, v16, v17
    s_waitcnt lgkmcnt(0)
    v_pk_add_f32 v[32:33], v[32:33], v[36:37]
    v_pk_add_f32 v[40:41], v[40:41], v[44:45]
    v_pk_add_f32 v[34:35], v[34:35], v[38:39]
    v_pk_add_f32 v[42:43], v[42:43], v[46:47]
    v_pk_add_f32 v[32:33], v[32:33], v[40:41]
    v_pk_add_f32 v[34:35], v[34:35], v[42:43]
    v_cvt_pk_bf16_f32 v36, v32, v33
    v_cvt_pk_bf16_f32 v37, v34, v35
    v_lshlrev_b32 v32, 16, v36
    v_and_b32 v33, 0xffff0000, v36
    v_lshlrev_b32 v38, 16, v198
    v_and_b32 v39, 0xffff0000, v198
    v_pk_add_f32 v[32:33], v[32:33], v[38:39]
    v_cvt_pk_bf16_f32 v50, v32, v33
    v_lshlrev_b32 v32, 16, v37
    v_and_b32 v33, 0xffff0000, v37
    v_lshlrev_b32 v38, 16, v199
    v_and_b32 v39, 0xffff0000, v199
    v_pk_add_f32 v[32:33], v[32:33], v[38:39]
    v_cvt_pk_bf16_f32 v51, v32, v33
    s_cmp_eq_u32 s92, 0
    s_cbranch_scc0 interleave_layers__linear_attn_block__memory_aug_recurrent_mem_tr__prompt_kernel_xo36
    s_add_u32 s24, s68, 4194304
    buffer_store_dwordx4 v[48:51], v219, s[8:11], s24 offen sc1
    s_branch interleave_layers__linear_attn_block__memory_aug_recurrent_mem_tr__prompt_kernel_xs35
interleave_layers__linear_attn_block__memory_aug_recurrent_mem_tr__prompt_kernel_xo36:
    buffer_store_dwordx2 v[48:49], v243, s[12:15], s68 offen
    buffer_store_dwordx2 v[50:51], v243, s[12:15], s68 offen offset:32
interleave_layers__linear_attn_block__memory_aug_recurrent_mem_tr__prompt_kernel_xs35:
    s_lshr_b32 s25, s64, 2
    s_add_u32 s25, s25, 1
    s_cmp_eq_u32 s92, 0
    s_cselect_b32 s79, s25, -1
    s_cmp_lt_u32 s40, 64
    s_cbranch_scc1 interleave_layers__linear_attn_block__memory_aug_recurrent_mem_tr__prompt_kernel_xp37
    s_waitcnt vmcnt(0)
    s_barrier
    s_cmp_ge_i32 s79, 0
    s_cselect_b32 s24, 0, 2146435072
    v_or_b32 v246, s24, v245
    v_mov_b32 v247, s79
    buffer_store_dword v247, v246, s[8:11], 0 offen sc1
    s_mov_b32 s79, -1
interleave_layers__linear_attn_block__memory_aug_recurrent_mem_tr__prompt_kernel_xp37:
    s_add_u32 s64, s64, 4
    s_add_u32 s65, s65, 5242880
    s_add_u32 s66, s66, 4194304
    s_add_u32 s67, s67, 4194304
    s_add_u32 s68, s68, 163840
    s_branch interleave_layers__linear_attn_block__memory_aug_recurrent_mem_tr__prompt_kernel_p_next
interleave_layers__linear_attn_block__memory_aug_recurrent_mem_tr__prompt_kernel_p_done:
    s_cmp_eq_u32 s92, 0
    s_cbranch_scc0 interleave_layers__linear_attn_block__memory_aug_recurrent_mem_tr__prompt_kernel_end
    s_mov_b32 s92, 1
    s_branch interleave_layers__linear_attn_block__memory_aug_recurrent_mem_tr__prompt_kernel_p_layer
interleave_layers__linear_attn_block__memory_aug_recurrent_mem_tr__prompt_kernel_roleO:
    s_sub_u32 s44, s2, 200
    s_load_dwordx2 s[6:7], s[0:1], 64
    s_waitcnt lgkmcnt(0)
    s_mov_b32 s12, s6
    s_mov_b32 s13, s7
    s_mov_b32 s14, 7864320
    s_mov_b32 s15, 0x00020000
    v_add_u32 v8, 0, v0
    s_mov_b32 s24, 3277
    v_mul_lo_u32 v9, v8, s24
    v_lshrrev_b32 v9, 18, v9
    v_mul_u32_u24 v10, 80, v9
    v_sub_u32 v10, v8, v10
    v_mul_u32_u24 v16, 1312, v9
    v_lshl_add_u32 v16, v10, 4, v16
    v_add_u32 v8, 256, v0
    s_mov_b32 s24, 3277
    v_mul_lo_u32 v9, v8, s24
    v_lshrrev_b32 v9, 18, v9
    v_mul_u32_u24 v10, 80, v9
    v_sub_u32 v10, v8, v10
    v_mul_u32_u24 v17, 1312, v9
    v_lshl_add_u32 v17, v10, 4, v17
    v_add_u32 v8, 512, v0
    s_mov_b32 s24, 3277
    v_mul_lo_u32 v9, v8, s24
    v_lshrrev_b32 v9, 18, v9
    v_mul_u32_u24 v10, 80, v9
    v_sub_u32 v10, v8, v10
    v_mul_u32_u24 v18, 1312, v9
    v_lshl_add_u32 v18, v10, 4, v18
    v_add_u32 v8, 768, v0
    s_mov_b32 s24, 3277
    v_mul_lo_u32 v9, v8, s24
    v_lshrrev_b32 v9, 18, v9
    v_mul_u32_u24 v10, 80, v9
    v_sub_u32 v10, v8, v10
    v_mul_u32_u24 v19, 1312, v9
    v_lshl_add_u32 v19, v10, 4, v19
    v_add_u32 v8, 1024, v0
    s_mov_b32 s24, 3277
    v_mul_lo_u32 v9, v8, s24
    v_lshrrev_b32 v9, 18, v9
    v_mul_u32_u24 v10, 80, v9
    v_sub_u32 v10, v8, v10
    v_mul_u32_u24 v20, 1312, v9
    v_lshl_add_u32 v20, v10, 4, v20
    v_add_u32 v8, 1280, v0
    s_mov_b32 s24, 3277
    v_mul_lo_u32 v9, v8, s24
    v_lshrrev_b32 v9, 18, v9
    v_mul_u32_u24 v10, 80, v9
    v_sub_u32 v10, v8, v10
    v_mul_u32_u24 v21, 1312, v9
    v_lshl_add_u32 v21, v10, 4, v21
    v_add_u32 v8, 1536, v0
    s_mov_b32 s24, 3277
    v_mul_lo_u32 v9, v8, s24
    v_lshrrev_b32 v9, 18, v9
    v_mul_u32_u24 v10, 80, v9
    v_sub_u32 v10, v8, v10
    v_mul_u32_u24 v22, 1312, v9
    v_lshl_add_u32 v22, v10, 4, v22
    v_add_u32 v8, 1792, v0
    s_mov_b32 s24, 3277
    v_mul_lo_u32 v9, v8, s24
    v_lshrrev_b32 v9, 18, v9
    v_mul_u32_u24 v10, 80, v9
    v_sub_u32 v10, v8, v10
    v_mul_u32_u24 v23, 1312, v9
    v_lshl_add_u32 v23, v10, 4, v23
    v_add_u32 v8, 2048, v0
    s_mov_b32 s24, 3277
    v_mul_lo_u32 v9, v8, s24
    v_lshrrev_b32 v9, 18, v9
    v_mul_u32_u24 v10, 80, v9
    v_sub_u32 v10, v8, v10
    v_mul_u32_u24 v24, 1312, v9
    v_lshl_add_u32 v24, v10, 4, v24
    v_add_u32 v8, 2304, v0
    s_mov_b32 s24, 3277
    v_mul_lo_u32 v9, v8, s24
    v_lshrrev_b32 v9, 18, v9
    v_mul_u32_u24 v10, 80, v9
    v_sub_u32 v10, v8, v10
    v_mul_u32_u24 v25, 1312, v9
    v_lshl_add_u32 v25, v10, 4, v25
    v_add_u32 v8, 2560, v0
    s_mov_b32 s24, 3277
    v_mul_lo_u32 v9, v8, s24
    v_lshrrev_b32 v9, 18, v9
    v_mul_u32_u24 v10, 80, v9
    v_sub_u32 v10, v8, v10
    v_mul_u32_u24 v26, 1312, v9
    v_lshl_add_u32 v26, v10, 4, v26
    v_add_u32 v8, 2816, v0
    s_mov_b32 s24, 3277
    v_mul_lo_u32 v9, v8, s24
    v_lshrrev_b32 v9, 18, v9
    v_mul_u32_u24 v10, 80, v9
    v_sub_u32 v10, v8, v10
    v_mul_u32_u24 v27, 1312, v9
    v_lshl_add_u32 v27, v10, 4, v27
    v_add_u32 v8, 3072, v0
    s_mov_b32 s24, 3277
    v_mul_lo_u32 v9, v8, s24
    v_lshrrev_b32 v9, 18, v9
    v_mul_u32_u24 v10, 80, v9
    v_sub_u32 v10, v8, v10
    v_mul_u32_u24 v28, 1312, v9
    v_lshl_add_u32 v28, v10, 4, v28
    v_add_u32 v8, 3328, v0
    s_mov_b32 s24, 3277
    v_mul_lo_u32 v9, v8, s24
    v_lshrrev_b32 v9, 18, v9
    v_mul_u32_u24 v10, 80, v9
    v_sub_u32 v10, v8, v10
    v_mul_u32_u24 v29, 1312, v9
    v_lshl_add_u32 v29, v10, 4, v29
    v_add_u32 v8, 3584, v0
    s_mov_b32 s24, 3277
    v_mul_lo_u32 v9, v8, s24
    v_lshrrev_b32 v9, 18, v9
    v_mul_u32_u24 v10, 80, v9
    v_sub_u32 v10, v8, v10
    v_mul_u32_u24 v30, 1312, v9
    v_lshl_add_u32 v30, v10, 4, v30
    v_add_u32 v8, 3840, v0
    s_mov_b32 s24, 3277
    v_mul_lo_u32 v9, v8, s24
    v_lshrrev_b32 v9, 18, v9
    v_mul_u32_u24 v10, 80, v9
    v_sub_u32 v10, v8, v10
    v_mul_u32_u24 v31, 1312, v9
    v_lshl_add_u32 v31, v10, 4, v31
    v_add_u32 v8, 4096, v0
    s_mov_b32 s24, 3277
    v_mul_lo_u32 v9, v8, s24
    v_lshrrev_b32 v9, 18, v9
    v_mul_u32_u24 v10, 80, v9
    v_sub_u32 v10, v8, v10
    v_mul_u32_u24 v32, 1312, v9
    v_lshl_add_u32 v32, v10, 4, v32
    v_add_u32 v8, 4352, v0
    s_mov_b32 s24, 3277
    v_mul_lo_u32 v9, v8, s24
    v_lshrrev_b32 v9, 18, v9
    v_mul_u32_u24 v10, 80, v9
    v_sub_u32 v10, v8, v10
    v_mul_u32_u24 v33, 1312, v9
    v_lshl_add_u32 v33, v10, 4, v33
    v_add_u32 v8, 4608, v0
    s_mov_b32 s24, 3277
    v_mul_lo_u32 v9, v8, s24
    v_lshrrev_b32 v9, 18, v9
    v_mul_u32_u24 v10, 80, v9
    v_sub_u32 v10, v8, v10
    v_mul_u32_u24 v34, 1312, v9
    v_lshl_add_u32 v34, v10, 4, v34
    v_add_u32 v8, 4864, v0
    s_mov_b32 s24, 3277
    v_mul_lo_u32 v9, v8, s24
    v_lshrrev_b32 v9, 18, v9
    v_mul_u32_u24 v10, 80, v9
    v_sub_u32 v10, v8, v10
    v_mul_u32_u24 v35, 1312, v9
    v_lshl_add_u32 v35, v10, 4, v35
    v_add_u32 v8, 5120, v0
    s_mov_b32 s24, 3277
    v_mul_lo_u32 v9, v8, s24
    v_lshrrev_b32 v9, 18, v9
    v_mul_u32_u24 v10, 80, v9
    v_sub_u32 v10, v8, v10
    v_mul_u32_u24 v36, 1312, v9
    v_lshl_add_u32 v36, v10, 4, v36
    v_add_u32 v8, 5376, v0
    s_mov_b32 s24, 3277
    v_mul_lo_u32 v9, v8, s24
    v_lshrrev_b32 v9, 18, v9
    v_mul_u32_u24 v10, 80, v9
    v_sub_u32 v10, v8, v10
    v_mul_u32_u24 v37, 1312, v9
    v_lshl_add_u32 v37, v10, 4, v37
    v_add_u32 v8, 5632, v0
    s_mov_b32 s24, 3277
    v_mul_lo_u32 v9, v8, s24
    v_lshrrev_b32 v9, 18, v9
    v_mul_u32_u24 v10, 80, v9
    v_sub_u32 v10, v8, v10
    v_mul_u32_u24 v38, 1312, v9
    v_lshl_add_u32 v38, v10, 4, v38
    v_add_u32 v8, 5888, v0
    s_mov_b32 s24, 3277
    v_mul_lo_u32 v9, v8, s24
    v_lshrrev_b32 v9, 18, v9
    v_mul_u32_u24 v10, 80, v9
    v_sub_u32 v10, v8, v10
    v_mul_u32_u24 v39, 1312, v9
    v_lshl_add_u32 v39, v10, 4, v39
    v_add_u32 v8, 6144, v0
    s_mov_b32 s24, 3277
    v_mul_lo_u32 v9, v8, s24
    v_lshrrev_b32 v9, 18, v9
    v_mul_u32_u24 v10, 80, v9
    v_sub_u32 v10, v8, v10
    v_mul_u32_u24 v40, 1312, v9
    v_lshl_add_u32 v40, v10, 4, v40
    v_add_u32 v8, 6400, v0
    s_mov_b32 s24, 3277
    v_mul_lo_u32 v9, v8, s24
    v_lshrrev_b32 v9, 18, v9
    v_mul_u32_u24 v10, 80, v9
    v_sub_u32 v10, v8, v10
    v_mul_u32_u24 v41, 1312, v9
    v_lshl_add_u32 v41, v10, 4, v41
    v_add_u32 v8, 6656, v0
    s_mov_b32 s24, 3277
    v_mul_lo_u32 v9, v8, s24
    v_lshrrev_b32 v9, 18, v9
    v_mul_u32_u24 v10, 80, v9
    v_sub_u32 v10, v8, v10
    v_mul_u32_u24 v42, 1312, v9
    v_lshl_add_u32 v42, v10, 4, v42
    v_add_u32 v8, 6912, v0
    s_mov_b32 s24, 3277
    v_mul_lo_u32 v9, v8, s24
    v_lshrrev_b32 v9, 18, v9
    v_mul_u32_u24 v10, 80, v9
    v_sub_u32 v10, v8, v10
    v_mul_u32_u24 v43, 1312, v9
    v_lshl_add_u32 v43, v10, 4, v43
    v_add_u32 v8, 7168, v0
    s_mov_b32 s24, 3277
    v_mul_lo_u32 v9, v8, s24
    v_lshrrev_b32 v9, 18, v9
    v_mul_u32_u24 v10, 80, v9
    v_sub_u32 v10, v8, v10
    v_mul_u32_u24 v44, 1312, v9
    v_lshl_add_u32 v44, v10, 4, v44
    v_add_u32 v8, 7424, v0
    s_mov_b32 s24, 3277
    v_mul_lo_u32 v9, v8, s24
    v_lshrrev_b32 v9, 18, v9
    v_mul_u32_u24 v10, 80, v9
    v_sub_u32 v10, v8, v10
    v_mul_u32_u24 v45, 1312, v9
    v_lshl_add_u32 v45, v10, 4, v45
    v_lshlrev_b32 v4, 4, v0
    s_mul_i32 s45, s44, 245760
    s_add_u32 s46, s45, 0
    buffer_load_dwordx4 v[48:51], v4, s[12:15], s46 offen
    s_add_u32 s46, s45, 4096
    buffer_load_dwordx4 v[52:55], v4, s[12:15], s46 offen
    s_add_u32 s46, s45, 8192
    buffer_load_dwordx4 v[56:59], v4, s[12:15], s46 offen
    s_add_u32 s46, s45, 12288
    buffer_load_dwordx4 v[60:63], v4, s[12:15], s46 offen
    s_add_u32 s46, s45, 16384
    buffer_load_dwordx4 v[64:67], v4, s[12:15], s46 offen
    s_add_u32 s46, s45, 20480
    buffer_load_dwordx4 v[68:71], v4, s[12:15], s46 offen
    s_add_u32 s46, s45, 24576
    buffer_load_dwordx4 v[72:75], v4, s[12:15], s46 offen
    s_add_u32 s46, s45, 28672
    buffer_load_dwordx4 v[76:79], v4, s[12:15], s46 offen
    s_add_u32 s46, s45, 32768
    buffer_load_dwordx4 v[80:83], v4, s[12:15], s46 offen
    s_add_u32 s46, s45, 36864
    buffer_load_dwordx4 v[84:87], v4, s[12:15], s46 offen
    s_add_u32 s46, s45, 40960
    buffer_load_dwordx4 v[88:91], v4, s[12:15], s46 offen
    s_add_u32 s46, s45, 45056
    buffer_load_dwordx4 v[92:95], v4, s[12:15], s46 offen
    s_add_u32 s46, s45, 49152
    buffer_load_dwordx4 v[96:99], v4, s[12:15], s46 offen
    s_add_u32 s46, s45, 53248
    buffer_load_dwordx4 v[100:103], v4, s[12:15], s46 offen
    s_add_u32 s46, s45, 57344
    buffer_load_dwordx4 v[104:107], v4, s[12:15], s46 offen
    s_add_u32 s46, s45, 61440
    buffer_load_dwordx4 v[108:111], v4, s[12:15], s46 offen
    s_add_u32 s46, s45, 65536
    buffer_load_dwordx4 v[112:115], v4, s[12:15], s46 offen
    s_add_u32 s46, s45, 69632
    buffer_load_dwordx4 v[116:119], v4, s[12:15], s46 offen
    s_add_u32 s46, s45, 73728
    buffer_load_dwordx4 v[120:123], v4, s[12:15], s46 offen
    s_add_u32 s46, s45, 77824
    buffer_load_dwordx4 v[124:127], v4, s[12:15], s46 offen
    s_add_u32 s46, s45, 81920
    buffer_load_dwordx4 v[128:131], v4, s[12:15], s46 offen
    s_add_u32 s46, s45, 86016
    buffer_load_dwordx4 v[132:135], v4, s[12:15], s46 offen
    s_add_u32 s46, s45, 90112
    buffer_load_dwordx4 v[136:139], v4, s[12:15], s46 offen
    s_add_u32 s46, s45, 94208
    buffer_load_dwordx4 v[140:143], v4, s[12:15], s46 offen
    s_add_u32 s46, s45, 98304
    buffer_load_dwordx4 v[144:147], v4, s[12:15], s46 offen
    s_add_u32 s46, s45, 102400
    buffer_load_dwordx4 v[148:151], v4, s[12:15], s46 offen
    s_add_u32 s46, s45, 106496
    buffer_load_dwordx4 v[152:155], v4, s[12:15], s46 offen
    s_add_u32 s46, s45, 110592
    buffer_load_dwordx4 v[156:159], v4, s[12:15], s46 offen
    s_add_u32 s46, s45, 114688
    buffer_load_dwordx4 v[160:163], v4, s[12:15], s46 offen
    s_add_u32 s46, s45, 118784
    buffer_load_dwordx4 v[164:167], v4, s[12:15], s46 offen
    s_add_u32 s46, s45, 122880
    buffer_load_dwordx4 v[168:171], v4, s[12:15], s46 offen
    s_add_u32 s46, s45, 126976
    buffer_load_dwordx4 v[172:175], v4, s[12:15], s46 offen
    s_add_u32 s46, s45, 131072
    buffer_load_dwordx4 v[176:179], v4, s[12:15], s46 offen
    s_add_u32 s46, s45, 135168
    buffer_load_dwordx4 v[180:183], v4, s[12:15], s46 offen
    s_add_u32 s46, s45, 139264
    buffer_load_dwordx4 v[184:187], v4, s[12:15], s46 offen
    s_add_u32 s46, s45, 143360
    buffer_load_dwordx4 v[188:191], v4, s[12:15], s46 offen
    s_add_u32 s46, s45, 147456
    buffer_load_dwordx4 v[192:195], v4, s[12:15], s46 offen
    s_add_u32 s46, s45, 151552
    buffer_load_dwordx4 v[196:199], v4, s[12:15], s46 offen
    s_add_u32 s46, s45, 155648
    buffer_load_dwordx4 v[200:203], v4, s[12:15], s46 offen
    s_add_u32 s46, s45, 159744
    buffer_load_dwordx4 v[204:207], v4, s[12:15], s46 offen
    s_add_u32 s46, s45, 163840
    buffer_load_dwordx4 v[208:211], v4, s[12:15], s46 offen
    s_add_u32 s46, s45, 167936
    buffer_load_dwordx4 v[212:215], v4, s[12:15], s46 offen
    s_add_u32 s46, s45, 172032
    buffer_load_dwordx4 v[216:219], v4, s[12:15], s46 offen
    s_add_u32 s46, s45, 176128
    buffer_load_dwordx4 v[220:223], v4, s[12:15], s46 offen
    s_add_u32 s46, s45, 180224
    buffer_load_dwordx4 v[224:227], v4, s[12:15], s46 offen
    s_add_u32 s46, s45, 184320
    buffer_load_dwordx4 v[228:231], v4, s[12:15], s46 offen
    s_add_u32 s46, s45, 188416
    buffer_load_dwordx4 v[232:235], v4, s[12:15], s46 offen
    s_add_u32 s46, s45, 192512
    buffer_load_dwordx4 v[236:239], v4, s[12:15], s46 offen
    s_add_u32 s46, s45, 196608
    buffer_load_dwordx4 v[240:243], v4, s[12:15], s46 offen
    s_add_u32 s46, s45, 200704
    buffer_load_dwordx4 v[244:247], v4, s[12:15], s46 offen
    s_add_u32 s46, s45, 204800
    buffer_load_dwordx4 v[248:251], v4, s[12:15], s46 offen
    s_add_u32 s46, s45, 208896
    buffer_load_dwordx4 v[252:255], v4, s[12:15], s46 offen
    v_lshrrev_b32 v8, 2, v2
    v_lshl_add_u32 v8, v3, 2, v8
    v_mul_u32_u24 v5, 1312, v8
    v_and_b32 v8, 3, v2
    v_lshl_add_u32 v5, v8, 3, v5
    s_mul_i32 s24, s3, 320
    v_add_u32 v5, s24, v5
    v_add_u32 v6, 62976, v5
    s_waitcnt vmcnt(22)
    ds_write_b128 v16, v[48:51]
    ds_write_b128 v17, v[52:55]
    ds_write_b128 v18, v[56:59]
    ds_write_b128 v19, v[60:63]
    ds_write_b128 v20, v[64:67]
    ds_write_b128 v21, v[68:71]
    ds_write_b128 v22, v[72:75]
    ds_write_b128 v23, v[76:79]
    ds_write_b128 v24, v[80:83]
    ds_write_b128 v25, v[84:87]
    ds_write_b128 v26, v[88:91]
    ds_write_b128 v27, v[92:95]
    ds_write_b128 v28, v[96:99]
    ds_write_b128 v29, v[100:103]
    ds_write_b128 v30, v[104:107]
    ds_write_b128 v31, v[108:111]
    ds_write_b128 v32, v[112:115]
    ds_write_b128 v33, v[116:119]
    ds_write_b128 v34, v[120:123]
    ds_write_b128 v35, v[124:127]
    ds_write_b128 v36, v[128:131]
    ds_write_b128 v37, v[132:135]
    ds_write_b128 v38, v[136:139]
    ds_write_b128 v39, v[140:143]
    ds_write_b128 v40, v[144:147]
    ds_write_b128 v41, v[148:151]
    ds_write_b128 v42, v[152:155]
    ds_write_b128 v43, v[156:159]
    ds_write_b128 v44, v[160:163]
    ds_write_b128 v45, v[164:167]
    s_waitcnt lgkmcnt(0)
    s_add_u32 s46, s45, 212992
    buffer_load_dwordx4 v[48:51], v4, s[12:15], s46 offen
    s_add_u32 s46, s45, 217088
    buffer_load_dwordx4 v[52:55], v4, s[12:15], s46 offen
    s_add_u32 s46, s45, 221184
    buffer_load_dwordx4 v[56:59], v4, s[12:15], s46 offen
    s_add_u32 s46, s45, 225280
    buffer_load_dwordx4 v[60:63], v4, s[12:15], s46 offen
    s_add_u32 s46, s45, 229376
    buffer_load_dwordx4 v[64:67], v4, s[12:15], s46 offen
    s_add_u32 s46, s45, 233472
    buffer_load_dwordx4 v[68:71], v4, s[12:15], s46 offen
    s_add_u32 s46, s45, 237568
    buffer_load_dwordx4 v[72:75], v4, s[12:15], s46 offen
    s_add_u32 s46, s45, 241664
    buffer_load_dwordx4 v[76:79], v4, s[12:15], s46 offen
    s_barrier
    ds_read_b64_tr_b16 a[0:1], v5 offset:0
    ds_read_b64_tr_b16 a[2:3], v5 offset:20992
    ds_read_b64_tr_b16 a[4:5], v6 offset:0
    ds_read_b64_tr_b16 a[6:7], v6 offset:20992
    ds_read_b64_tr_b16 a[16:17], v5 offset:41984
    ds_read_b64_tr_b16 a[18:19], v6 offset:41984
    ds_read_b64_tr_b16 a[24:25], v5 offset:32
    ds_read_b64_tr_b16 a[26:27], v5 offset:21024
    ds_read_b64_tr_b16 a[28:29], v6 offset:32
    ds_read_b64_tr_b16 a[30:31], v6 offset:21024
    ds_read_b64_tr_b16 a[40:41], v5 offset:42016
    ds_read_b64_tr_b16 a[42:43], v6 offset:42016
    ds_read_b64_tr_b16 a[48:49], v5 offset:64
    ds_read_b64_tr_b16 a[50:51], v5 offset:21056
    ds_read_b64_tr_b16 a[52:53], v6 offset:64
    ds_read_b64_tr_b16 a[54:55], v6 offset:21056
    ds_read_b64_tr_b16 a[64:65], v5 offset:42048
    ds_read_b64_tr_b16 a[66:67], v6 offset:42048
    ds_read_b64_tr_b16 a[72:73], v5 offset:96
    ds_read_b64_tr_b16 a[74:75], v5 offset:21088
    ds_read_b64_tr_b16 a[76:77], v6 offset:96
    ds_read_b64_tr_b16 a[78:79], v6 offset:21088
    ds_read_b64_tr_b16 a[88:89], v5 offset:42080
    ds_read_b64_tr_b16 a[90:91], v6 offset:42080
    ds_read_b64_tr_b16 a[96:97], v5 offset:128
    ds_read_b64_tr_b16 a[98:99], v5 offset:21120
    ds_read_b64_tr_b16 a[100:101], v6 offset:128
    ds_read_b64_tr_b16 a[102:103], v6 offset:21120
    ds_read_b64_tr_b16 a[112:113], v5 offset:42112
    ds_read_b64_tr_b16 a[114:115], v6 offset:42112
    ds_read_b64_tr_b16 a[120:121], v5 offset:160
    ds_read_b64_tr_b16 a[122:123], v5 offset:21152
    ds_read_b64_tr_b16 a[124:125], v6 offset:160
    ds_read_b64_tr_b16 a[126:127], v6 offset:21152
    ds_read_b64_tr_b16 a[136:137], v5 offset:42144
    ds_read_b64_tr_b16 a[138:139], v6 offset:42144
    ds_read_b64_tr_b16 a[144:145], v5 offset:192
    ds_read_b64_tr_b16 a[146:147], v5 offset:21184
    ds_read_b64_tr_b16 a[148:149], v6 offset:192
    ds_read_b64_tr_b16 a[150:151], v6 offset:21184
    ds_read_b64_tr_b16 a[160:161], v5 offset:42176
    ds_read_b64_tr_b16 a[162:163], v6 offset:42176
    ds_read_b64_tr_b16 a[168:169], v5 offset:224
    ds_read_b64_tr_b16 a[170:171], v5 offset:21216
    ds_read_b64_tr_b16 a[172:173], v6 offset:224
    ds_read_b64_tr_b16 a[174:175], v6 offset:21216
    ds_read_b64_tr_b16 a[184:185], v5 offset:42208
    ds_read_b64_tr_b16 a[186:187], v6 offset:42208
    ds_read_b64_tr_b16 a[192:193], v5 offset:256
    ds_read_b64_tr_b16 a[194:195], v5 offset:21248
    ds_read_b64_tr_b16 a[196:197], v6 offset:256
    ds_read_b64_tr_b16 a[198:199], v6 offset:21248
    ds_read_b64_tr_b16 a[208:209], v5 offset:42240
    ds_read_b64_tr_b16 a[210:211], v6 offset:42240
    ds_read_b64_tr_b16 a[216:217], v5 offset:288
    ds_read_b64_tr_b16 a[218:219], v5 offset:21280
    ds_read_b64_tr_b16 a[220:221], v6 offset:288
    ds_read_b64_tr_b16 a[222:223], v6 offset:21280
    ds_read_b64_tr_b16 a[232:233], v5 offset:42272
    ds_read_b64_tr_b16 a[234:235], v6 offset:42272
    s_waitcnt lgkmcnt(0)
    s_barrier
    s_waitcnt vmcnt(0)
    ds_write_b128 v16, v[168:171]
    ds_write_b128 v17, v[172:175]
    ds_write_b128 v18, v[176:179]
    ds_write_b128 v19, v[180:183]
    ds_write_b128 v20, v[184:187]
    ds_write_b128 v21, v[188:191]
    ds_write_b128 v22, v[192:195]
    ds_write_b128 v23, v[196:199]
    ds_write_b128 v24, v[200:203]
    ds_write_b128 v25, v[204:207]
    ds_write_b128 v26, v[208:211]
    ds_write_b128 v27, v[212:215]
    ds_write_b128 v28, v[216:219]
    ds_write_b128 v29, v[220:223]
    ds_write_b128 v30, v[224:227]
    ds_write_b128 v31, v[228:231]
    ds_write_b128 v32, v[232:235]
    ds_write_b128 v33, v[236:239]
    ds_write_b128 v34, v[240:243]
    ds_write_b128 v35, v[244:247]
    ds_write_b128 v36, v[248:251]
    ds_write_b128 v37, v[252:255]
    ds_write_b128 v38, v[48:51]
    ds_write_b128 v39, v[52:55]
    ds_write_b128 v40, v[56:59]
    ds_write_b128 v41, v[60:63]
    ds_write_b128 v42, v[64:67]
    ds_write_b128 v43, v[68:71]
    ds_write_b128 v44, v[72:75]
    ds_write_b128 v45, v[76:79]
    s_waitcnt lgkmcnt(0)
    s_barrier
    ds_read_b64_tr_b16 a[8:9], v5 offset:0
    ds_read_b64_tr_b16 a[10:11], v5 offset:20992
    ds_read_b64_tr_b16 a[12:13], v6 offset:0
    ds_read_b64_tr_b16 a[14:15], v6 offset:20992
    ds_read_b64_tr_b16 a[20:21], v5 offset:41984
    ds_read_b64_tr_b16 a[22:23], v6 offset:41984
    ds_read_b64_tr_b16 a[32:33], v5 offset:32
    ds_read_b64_tr_b16 a[34:35], v5 offset:21024
    ds_read_b64_tr_b16 a[36:37], v6 offset:32
    ds_read_b64_tr_b16 a[38:39], v6 offset:21024
    ds_read_b64_tr_b16 a[44:45], v5 offset:42016
    ds_read_b64_tr_b16 a[46:47], v6 offset:42016
    ds_read_b64_tr_b16 a[56:57], v5 offset:64
    ds_read_b64_tr_b16 a[58:59], v5 offset:21056
    ds_read_b64_tr_b16 a[60:61], v6 offset:64
    ds_read_b64_tr_b16 a[62:63], v6 offset:21056
    ds_read_b64_tr_b16 a[68:69], v5 offset:42048
    ds_read_b64_tr_b16 a[70:71], v6 offset:42048
    ds_read_b64_tr_b16 a[80:81], v5 offset:96
    ds_read_b64_tr_b16 a[82:83], v5 offset:21088
    ds_read_b64_tr_b16 a[84:85], v6 offset:96
    ds_read_b64_tr_b16 a[86:87], v6 offset:21088
    ds_read_b64_tr_b16 a[92:93], v5 offset:42080
    ds_read_b64_tr_b16 a[94:95], v6 offset:42080
    ds_read_b64_tr_b16 a[104:105], v5 offset:128
    ds_read_b64_tr_b16 a[106:107], v5 offset:21120
    ds_read_b64_tr_b16 a[108:109], v6 offset:128
    ds_read_b64_tr_b16 a[110:111], v6 offset:21120
    ds_read_b64_tr_b16 a[116:117], v5 offset:42112
    ds_read_b64_tr_b16 a[118:119], v6 offset:42112
    ds_read_b64_tr_b16 a[128:129], v5 offset:160
    ds_read_b64_tr_b16 a[130:131], v5 offset:21152
    ds_read_b64_tr_b16 a[132:133], v6 offset:160
    ds_read_b64_tr_b16 a[134:135], v6 offset:21152
    ds_read_b64_tr_b16 a[140:141], v5 offset:42144
    ds_read_b64_tr_b16 a[142:143], v6 offset:42144
    ds_read_b64_tr_b16 a[152:153], v5 offset:192
    ds_read_b64_tr_b16 a[154:155], v5 offset:21184
    ds_read_b64_tr_b16 a[156:157], v6 offset:192
    ds_read_b64_tr_b16 a[158:159], v6 offset:21184
    ds_read_b64_tr_b16 a[164:165], v5 offset:42176
    ds_read_b64_tr_b16 a[166:167], v6 offset:42176
    ds_read_b64_tr_b16 a[176:177], v5 offset:224
    ds_read_b64_tr_b16 a[178:179], v5 offset:21216
    ds_read_b64_tr_b16 a[180:181], v6 offset:224
    ds_read_b64_tr_b16 a[182:183], v6 offset:21216
    ds_read_b64_tr_b16 a[188:189], v5 offset:42208
    ds_read_b64_tr_b16 a[190:191], v6 offset:42208
    ds_read_b64_tr_b16 a[200:201], v5 offset:256
    ds_read_b64_tr_b16 a[202:203], v5 offset:21248
    ds_read_b64_tr_b16 a[204:205], v6 offset:256
    ds_read_b64_tr_b16 a[206:207], v6 offset:21248
    ds_read_b64_tr_b16 a[212:213], v5 offset:42240
    ds_read_b64_tr_b16 a[214:215], v6 offset:42240
    ds_read_b64_tr_b16 a[224:225], v5 offset:288
    ds_read_b64_tr_b16 a[226:227], v5 offset:21280
    ds_read_b64_tr_b16 a[228:229], v6 offset:288
    ds_read_b64_tr_b16 a[230:231], v6 offset:21280
    ds_read_b64_tr_b16 a[236:237], v5 offset:42272
    ds_read_b64_tr_b16 a[238:239], v6 offset:42272
    s_waitcnt lgkmcnt(0)
    s_barrier
    v_lshlrev_b32 v5, 4, v1
    s_mul_i32 s24, s44, 12288
    v_add_u32 v6, s24, v5
    v_add_u32 v7, 4096, v6
    v_add_u32 v8, 8192, v6
    s_mul_i32 s24, s3, 327680
    s_lshl_b32 s25, s44, 10
    s_add_u32 s24, s24, s25
    v_add_u32 v9, s24, v5
interleave_layers__linear_attn_block__memory_aug_recurrent_mem_tr__prompt_kernel_o_layer:
    s_mov_b32 s93, 0
    s_lshl_b32 s24, s93, 12
    s_and_b32 s24, s24, 0x2000
    s_xor_b32 s24, s24, s36
    s_lshl_b32 s93, s93, 20
    s_add_u32 s93, s93, s24
    s_add_u32 s93, s93, 117440512
    s_mul_i32 s94, s92, 16384
    s_add_u32 s94, s94, 23068672
    s_mov_b32 s24, 12288
    s_lshl_b32 s25, s44, 7
    s_add_u32 s24, s24, s25
    s_add_u32 s24, s24, s94
    v_mov_b32 v14, s24
    v_mov_b32 v15, 2146435072
    v_cmp_eq_u32 vcc, 0, v1
    s_nop 1
    v_cndmask_b32 v14, v15, v14, vcc
    s_lshl_b32 s24, s44, 7
    s_add_u32 s24, s24, 8192
    s_add_u32 s24, s24, s94
    v_mov_b32 v10, s24
    s_mov_b32 s41, 33554432
    s_mov_b32 s43, 184549376
    s_mov_b32 s40, 0
    s_mov_b32 s62, -1
    s_mov_b32 s63, 1
    s_cmp_ge_i32 s62, s63
    s_cbranch_scc1 interleave_layers__linear_attn_block__memory_aug_recurrent_mem_tr__prompt_kernel_o_en0_ok
    s_mov_b32 s61, 0
interleave_layers__linear_attn_block__memory_aug_recurrent_mem_tr__prompt_kernel_o_en0:
    buffer_load_dword v11, v10, s[8:11], 0 offen sc1
    s_waitcnt vmcnt(0)
    v_readlane_b32 s62, v11, 0
    s_cmp_ge_i32 s62, s63
    s_cbranch_scc1 interleave_layers__linear_attn_block__memory_aug_recurrent_mem_tr__prompt_kernel_o_en0_ok
    s_add_u32 s61, s61, 1
    s_cmp_ge_u32 s61, s60
    s_cbranch_scc1 interleave_layers__linear_attn_block__memory_aug_recurrent_mem_tr__prompt_kernel_o_en0_to
    s_sleep 2
    s_branch interleave_layers__linear_attn_block__memory_aug_recurrent_mem_tr__prompt_kernel_o_en0
interleave_layers__linear_attn_block__memory_aug_recurrent_mem_tr__prompt_kernel_o_en0_to:
    s_mov_b32 s60, 1
interleave_layers__linear_attn_block__memory_aug_recurrent_mem_tr__prompt_kernel_o_en0_ok:
    buffer_load_dwordx4 v[16:19], v6, s[8:11], s41 offen offset:0 sc1
    buffer_load_dwordx4 v[20:23], v6, s[8:11], s41 offen offset:1024 sc1
    buffer_load_dwordx4 v[24:27], v6, s[8:11], s41 offen offset:2048 sc1
    buffer_load_dwordx4 v[28:31], v6, s[8:11], s41 offen offset:3072 sc1
    buffer_load_dwordx4 v[32:35], v7, s[8:11], s41 offen offset:0 sc1
    buffer_load_dwordx4 v[36:39], v7, s[8:11], s41 offen offset:1024 sc1
    buffer_load_dwordx4 v[40:43], v7, s[8:11], s41 offen offset:2048 sc1
    buffer_load_dwordx4 v[44:47], v7, s[8:11], s41 offen offset:3072 sc1
    buffer_load_dwordx4 v[48:51], v8, s[8:11], s41 offen offset:0 sc1
    buffer_load_dwordx4 v[52:55], v8, s[8:11], s41 offen offset:1024 sc1
    buffer_load_dwordx4 v[56:59], v8, s[8:11], s41 offen offset:2048 sc1
    buffer_load_dwordx4 v[60:63], v8, s[8:11], s41 offen offset:3072 sc1
    s_add_u32 s41, s41, 393216
    s_waitcnt vmcnt(0)
interleave_layers__linear_attn_block__memory_aug_recurrent_mem_tr__prompt_kernel_o_seg:
    v_swap_b32 v26, v36
    v_swap_b32 v27, v37
    v_swap_b32 v50, v60
    v_swap_b32 v51, v61
    buffer_load_dword v232, v10, s[8:11], 0 offen sc1
    v_mfma_f32_16x16x32_bf16 v[112:115], v[16:19], a[0:3], 0
    v_mfma_f32_16x16x32_bf16 v[116:119], v[20:23], a[0:3], 0
    v_mfma_f32_16x16x32_bf16 v[120:123], v[16:19], a[24:27], 0
    v_mfma_f32_16x16x32_bf16 v[124:127], v[20:23], a[24:27], 0
    v_mfma_f32_16x16x32_bf16 v[128:131], v[16:19], a[48:51], 0
    v_mfma_f32_16x16x32_bf16 v[132:135], v[20:23], a[48:51], 0
    v_mfma_f32_16x16x32_bf16 v[136:139], v[16:19], a[72:75], 0
    v_mfma_f32_16x16x32_bf16 v[140:143], v[20:23], a[72:75], 0
    v_mfma_f32_16x16x32_bf16 v[144:147], v[16:19], a[96:99], 0
    v_mfma_f32_16x16x32_bf16 v[148:151], v[20:23], a[96:99], 0
    v_mfma_f32_16x16x32_bf16 v[152:155], v[16:19], a[120:123], 0
    v_mfma_f32_16x16x32_bf16 v[156:159], v[20:23], a[120:123], 0
    v_mfma_f32_16x16x32_bf16 v[160:163], v[16:19], a[144:147], 0
    v_mfma_f32_16x16x32_bf16 v[164:167], v[20:23], a[144:147], 0
    v_mfma_f32_16x16x32_bf16 v[168:171], v[16:19], a[168:171], 0
    v_mfma_f32_16x16x32_bf16 v[172:175], v[20:23], a[168:171], 0
    v_mfma_f32_16x16x32_bf16 v[176:179], v[16:19], a[192:195], 0
    v_mfma_f32_16x16x32_bf16 v[180:183], v[20:23], a[192:195], 0
    v_mfma_f32_16x16x32_bf16 v[184:187], v[16:19], a[216:219], 0
    v_mfma_f32_16x16x32_bf16 v[188:191], v[20:23], a[216:219], 0
    v_mfma_f32_16x16x32_bf16 v[112:115], v[28:31], a[4:7], v[112:115]
    v_mfma_f32_16x16x32_bf16 v[116:119], v[32:35], a[4:7], v[116:119]
    v_mfma_f32_16x16x32_bf16 v[120:123], v[28:31], a[28:31], v[120:123]
    v_mfma_f32_16x16x32_bf16 v[124:127], v[32:35], a[28:31], v[124:127]
    v_mfma_f32_16x16x32_bf16 v[128:131], v[28:31], a[52:55], v[128:131]
    v_mfma_f32_16x16x32_bf16 v[132:135], v[32:35], a[52:55], v[132:135]
    v_mfma_f32_16x16x32_bf16 v[136:139], v[28:31], a[76:79], v[136:139]
    v_mfma_f32_16x16x32_bf16 v[140:143], v[32:35], a[76:79], v[140:143]
    v_mfma_f32_16x16x32_bf16 v[144:147], v[28:31], a[100:103], v[144:147]
    v_mfma_f32_16x16x32_bf16 v[148:151], v[32:35], a[100:103], v[148:151]
    v_mfma_f32_16x16x32_bf16 v[152:155], v[28:31], a[124:127], v[152:155]
    v_mfma_f32_16x16x32_bf16 v[156:159], v[32:35], a[124:127], v[156:159]
    v_mfma_f32_16x16x32_bf16 v[160:163], v[28:31], a[148:151], v[160:163]
    v_mfma_f32_16x16x32_bf16 v[164:167], v[32:35], a[148:151], v[164:167]
    v_mfma_f32_16x16x32_bf16 v[168:171], v[28:31], a[172:175], v[168:171]
    v_mfma_f32_16x16x32_bf16 v[172:175], v[32:35], a[172:175], v[172:175]
    v_mfma_f32_16x16x32_bf16 v[176:179], v[28:31], a[196:199], v[176:179]
    v_mfma_f32_16x16x32_bf16 v[180:183], v[32:35], a[196:199], v[180:183]
    v_mfma_f32_16x16x32_bf16 v[184:187], v[28:31], a[220:223], v[184:187]
    v_mfma_f32_16x16x32_bf16 v[188:191], v[32:35], a[220:223], v[188:191]
    v_mfma_f32_16x16x32_bf16 v[112:115], v[40:43], a[8:11], v[112:115]
    v_mfma_f32_16x16x32_bf16 v[116:119], v[44:47], a[8:11], v[116:119]
    v_mfma_f32_16x16x32_bf16 v[120:123], v[40:43], a[32:35], v[120:123]
    v_mfma_f32_16x16x32_bf16 v[124:127], v[44:47], a[32:35], v[124:127]
    v_mfma_f32_16x16x32_bf16 v[128:131], v[40:43], a[56:59], v[128:131]
    v_mfma_f32_16x16x32_bf16 v[132:135], v[44:47], a[56:59], v[132:135]
    v_mfma_f32_16x16x32_bf16 v[136:139], v[40:43], a[80:83], v[136:139]
    v_mfma_f32_16x16x32_bf16 v[140:143], v[44:47], a[80:83], v[140:143]
    v_mfma_f32_16x16x32_bf16 v[144:147], v[40:43], a[104:107], v[144:147]
    v_mfma_f32_16x16x32_bf16 v[148:151], v[44:47], a[104:107], v[148:151]
    v_mfma_f32_16x16x32_bf16 v[152:155], v[40:43], a[128:131], v[152:155]
    v_mfma_f32_16x16x32_bf16 v[156:159], v[44:47], a[128:131], v[156:159]
    v_mfma_f32_16x16x32_bf16 v[160:163], v[40:43], a[152:155], v[160:163]
    v_mfma_f32_16x16x32_bf16 v[164:167], v[44:47], a[152:155], v[164:167]
    v_mfma_f32_16x16x32_bf16 v[168:171], v[40:43], a[176:179], v[168:171]
    v_mfma_f32_16x16x32_bf16 v[172:175], v[44:47], a[176:179], v[172:175]
    v_mfma_f32_16x16x32_bf16 v[176:179], v[40:43], a[200:203], v[176:179]
    v_mfma_f32_16x16x32_bf16 v[180:183], v[44:47], a[200:203], v[180:183]
    v_mfma_f32_16x16x32_bf16 v[184:187], v[40:43], a[224:227], v[184:187]
    v_mfma_f32_16x16x32_bf16 v[188:191], v[44:47], a[224:227], v[188:191]
    s_waitcnt vmcnt(0)
    v_readfirstlane_b32 s24, v232
    s_max_i32 s62, s62, s24
    s_add_u32 s63, s40, 2
    s_min_u32 s63, s63, 64
    s_cmp_ge_i32 s62, s63
    s_cselect_b32 s24, 1, 0
    s_lshl_b32 s25, s3, 4
    s_add_u32 s25, s25, 0
    v_mov_b32 v12, s25
    v_mov_b32 v13, s24
    ds_write_b32 v12, v13
    v_mov_b32 v12, 0
    s_waitcnt lgkmcnt(0)
    s_barrier
    ds_read_b32 v13, v12
    s_cmp_eq_u32 s3, 0
    s_cbranch_scc0 interleave_layers__linear_attn_block__memory_aug_recurrent_mem_tr__prompt_kernel_fp39
    v_mov_b32 v15, s40
    buffer_store_dword v15, v14, s[8:11], 0 offen sc1
interleave_layers__linear_attn_block__memory_aug_recurrent_mem_tr__prompt_kernel_fp39:
    s_waitcnt lgkmcnt(0)
    v_readfirstlane_b32 s58, v13
    s_cmp_eq_u32 s58, 1
    s_cbranch_scc0 interleave_layers__linear_attn_block__memory_aug_recurrent_mem_tr__prompt_kernel_of38
    s_max_i32 s62, s62, s63
    buffer_load_dwordx4 v[64:67], v6, s[8:11], s41 offen offset:0 sc1
    buffer_load_dwordx4 v[68:71], v6, s[8:11], s41 offen offset:1024 sc1
    buffer_load_dwordx4 v[72:75], v6, s[8:11], s41 offen offset:2048 sc1
    buffer_load_dwordx4 v[76:79], v6, s[8:11], s41 offen offset:3072 sc1
    buffer_load_dwordx4 v[80:83], v7, s[8:11], s41 offen offset:0 sc1
    buffer_load_dwordx4 v[84:87], v7, s[8:11], s41 offen offset:1024 sc1
    buffer_load_dwordx4 v[88:91], v7, s[8:11], s41 offen offset:2048 sc1
    buffer_load_dwordx4 v[92:95], v7, s[8:11], s41 offen offset:3072 sc1
    buffer_load_dwordx4 v[96:99], v8, s[8:11], s41 offen offset:0 sc1
    buffer_load_dwordx4 v[100:103], v8, s[8:11], s41 offen offset:1024 sc1
    buffer_load_dwordx4 v[104:107], v8, s[8:11], s41 offen offset:2048 sc1
    buffer_load_dwordx4 v[108:111], v8, s[8:11], s41 offen offset:3072 sc1
    s_add_u32 s41, s41, 393216
interleave_layers__linear_attn_block__memory_aug_recurrent_mem_tr__prompt_kernel_of38:
    v_mfma_f32_16x16x32_bf16 v[112:115], v[52:55], a[12:15], v[112:115]
    v_mfma_f32_16x16x32_bf16 v[116:119], v[56:59], a[12:15], v[116:119]
    v_mfma_f32_16x16x32_bf16 v[120:123], v[52:55], a[36:39], v[120:123]
    v_mfma_f32_16x16x32_bf16 v[124:127], v[56:59], a[36:39], v[124:127]
    v_mfma_f32_16x16x32_bf16 v[128:131], v[52:55], a[60:63], v[128:131]
    v_mfma_f32_16x16x32_bf16 v[132:135], v[56:59], a[60:63], v[132:135]
    v_mfma_f32_16x16x32_bf16 v[136:139], v[52:55], a[84:87], v[136:139]
    v_mfma_f32_16x16x32_bf16 v[140:143], v[56:59], a[84:87], v[140:143]
    v_mfma_f32_16x16x32_bf16 v[144:147], v[52:55], a[108:111], v[144:147]
    v_mfma_f32_16x16x32_bf16 v[148:151], v[56:59], a[108:111], v[148:151]
    v_mfma_f32_16x16x32_bf16 v[152:155], v[52:55], a[132:135], v[152:155]
    v_mfma_f32_16x16x32_bf16 v[156:159], v[56:59], a[132:135], v[156:159]
    v_mfma_f32_16x16x32_bf16 v[160:163], v[52:55], a[156:159], v[160:163]
    v_mfma_f32_16x16x32_bf16 v[164:167], v[56:59], a[156:159], v[164:167]
    v_mfma_f32_16x16x32_bf16 v[168:171], v[52:55], a[180:183], v[168:171]
    v_mfma_f32_16x16x32_bf16 v[172:175], v[56:59], a[180:183], v[172:175]
    v_mfma_f32_16x16x32_bf16 v[176:179], v[52:55], a[204:207], v[176:179]
    v_mfma_f32_16x16x32_bf16 v[180:183], v[56:59], a[204:207], v[180:183]
    v_mfma_f32_16x16x32_bf16 v[184:187], v[52:55], a[228:231], v[184:187]
    v_mfma_f32_16x16x32_bf16 v[188:191], v[56:59], a[228:231], v[188:191]
    v_mfma_f32_16x16x32_bf16 v[112:115], v[24:27], a[16:19], v[112:115]
    v_mfma_f32_16x16x32_bf16 v[116:119], v[36:39], a[16:19], v[116:119]
    v_mfma_f32_16x16x32_bf16 v[120:123], v[24:27], a[40:43], v[120:123]
    v_mfma_f32_16x16x32_bf16 v[124:127], v[36:39], a[40:43], v[124:127]
    v_mfma_f32_16x16x32_bf16 v[128:131], v[24:27], a[64:67], v[128:131]
    v_mfma_f32_16x16x32_bf16 v[132:135], v[36:39], a[64:67], v[132:135]
    v_mfma_f32_16x16x32_bf16 v[136:139], v[24:27], a[88:91], v[136:139]
    v_mfma_f32_16x16x32_bf16 v[140:143], v[36:39], a[88:91], v[140:143]
    v_mfma_f32_16x16x32_bf16 v[144:147], v[24:27], a[112:115], v[144:147]
    v_mfma_f32_16x16x32_bf16 v[148:151], v[36:39], a[112:115], v[148:151]
    v_mfma_f32_16x16x32_bf16 v[152:155], v[24:27], a[136:139], v[152:155]
    v_mfma_f32_16x16x32_bf16 v[156:159], v[36:39], a[136:139], v[156:159]
    v_mfma_f32_16x16x32_bf16 v[160:163], v[24:27], a[160:163], v[160:163]
    v_mfma_f32_16x16x32_bf16 v[164:167], v[36:39], a[160:163], v[164:167]
    v_mfma_f32_16x16x32_bf16 v[168:171], v[24:27], a[184:187], v[168:171]
    v_mfma_f32_16x16x32_bf16 v[172:175], v[36:39], a[184:187], v[172:175]
    v_mfma_f32_16x16x32_bf16 v[176:179], v[24:27], a[208:211], v[176:179]
    v_mfma_f32_16x16x32_bf16 v[180:183], v[36:39], a[208:211], v[180:183]
    v_mfma_f32_16x16x32_bf16 v[184:187], v[24:27], a[232:235], v[184:187]
    v_mfma_f32_16x16x32_bf16 v[188:191], v[36:39], a[232:235], v[188:191]
    v_mfma_f32_16x16x32_bf16 v[112:115], v[48:51], a[20:23], v[112:115]
    v_mfma_f32_16x16x32_bf16 v[116:119], v[60:63], a[20:23], v[116:119]
    v_mfma_f32_16x16x32_bf16 v[120:123], v[48:51], a[44:47], v[120:123]
    v_mfma_f32_16x16x32_bf16 v[124:127], v[60:63], a[44:47], v[124:127]
    v_mfma_f32_16x16x32_bf16 v[128:131], v[48:51], a[68:71], v[128:131]
    v_mfma_f32_16x16x32_bf16 v[132:135], v[60:63], a[68:71], v[132:135]
    v_mfma_f32_16x16x32_bf16 v[136:139], v[48:51], a[92:95], v[136:139]
    v_mfma_f32_16x16x32_bf16 v[140:143], v[60:63], a[92:95], v[140:143]
    v_mfma_f32_16x16x32_bf16 v[144:147], v[48:51], a[116:119], v[144:147]
    v_mfma_f32_16x16x32_bf16 v[148:151], v[60:63], a[116:119], v[148:151]
    v_mfma_f32_16x16x32_bf16 v[152:155], v[48:51], a[140:143], v[152:155]
    v_mfma_f32_16x16x32_bf16 v[156:159], v[60:63], a[140:143], v[156:159]
    v_mfma_f32_16x16x32_bf16 v[160:163], v[48:51], a[164:167], v[160:163]
    v_mfma_f32_16x16x32_bf16 v[164:167], v[60:63], a[164:167], v[164:167]
    v_mfma_f32_16x16x32_bf16 v[168:171], v[48:51], a[188:191], v[168:171]
    v_mfma_f32_16x16x32_bf16 v[172:175], v[60:63], a[188:191], v[172:175]
    v_mfma_f32_16x16x32_bf16 v[176:179], v[48:51], a[212:215], v[176:179]
    v_mfma_f32_16x16x32_bf16 v[180:183], v[60:63], a[212:215], v[180:183]
    v_mfma_f32_16x16x32_bf16 v[184:187], v[48:51], a[236:239], v[184:187]
    v_mfma_f32_16x16x32_bf16 v[188:191], v[60:63], a[236:239], v[188:191]
    s_mov_b32 s46, s43
    v_cvt_pk_bf16_f32 v192, v112, v113
    v_cvt_pk_bf16_f32 v193, v114, v115
    v_cvt_pk_bf16_f32 v194, v116, v117
    v_cvt_pk_bf16_f32 v195, v118, v119
    buffer_store_dwordx4 v[192:195], v9, s[8:11], s46 offen sc1
    s_add_u32 s46, s46, 32768
    v_cvt_pk_bf16_f32 v196, v120, v121
    v_cvt_pk_bf16_f32 v197, v122, v123
    v_cvt_pk_bf16_f32 v198, v124, v125
    v_cvt_pk_bf16_f32 v199, v126, v127
    buffer_store_dwordx4 v[196:199], v9, s[8:11], s46 offen sc1
    s_add_u32 s46, s46, 32768
    v_cvt_pk_bf16_f32 v200, v128, v129
    v_cvt_pk_bf16_f32 v201, v130, v131
    v_cvt_pk_bf16_f32 v202, v132, v133
    v_cvt_pk_bf16_f32 v203, v134, v135
    buffer_store_dwordx4 v[200:203], v9, s[8:11], s46 offen sc1
    s_add_u32 s46, s46, 32768
    v_cvt_pk_bf16_f32 v204, v136, v137
    v_cvt_pk_bf16_f32 v205, v138, v139
    v_cvt_pk_bf16_f32 v206, v140, v141
    v_cvt_pk_bf16_f32 v207, v142, v143
    buffer_store_dwordx4 v[204:207], v9, s[8:11], s46 offen sc1
    s_add_u32 s46, s46, 32768
    v_cvt_pk_bf16_f32 v208, v144, v145
    v_cvt_pk_bf16_f32 v209, v146, v147
    v_cvt_pk_bf16_f32 v210, v148, v149
    v_cvt_pk_bf16_f32 v211, v150, v151
    buffer_store_dwordx4 v[208:211], v9, s[8:11], s46 offen sc1
    s_add_u32 s46, s46, 32768
    v_cvt_pk_bf16_f32 v212, v152, v153
    v_cvt_pk_bf16_f32 v213, v154, v155
    v_cvt_pk_bf16_f32 v214, v156, v157
    v_cvt_pk_bf16_f32 v215, v158, v159
    buffer_store_dwordx4 v[212:215], v9, s[8:11], s46 offen sc1
    s_add_u32 s46, s46, 32768
    v_cvt_pk_bf16_f32 v216, v160, v161
    v_cvt_pk_bf16_f32 v217, v162, v163
    v_cvt_pk_bf16_f32 v218, v164, v165
    v_cvt_pk_bf16_f32 v219, v166, v167
    buffer_store_dwordx4 v[216:219], v9, s[8:11], s46 offen sc1
    s_add_u32 s46, s46, 32768
    v_cvt_pk_bf16_f32 v220, v168, v169
    v_cvt_pk_bf16_f32 v221, v170, v171
    v_cvt_pk_bf16_f32 v222, v172, v173
    v_cvt_pk_bf16_f32 v223, v174, v175
    buffer_store_dwordx4 v[220:223], v9, s[8:11], s46 offen sc1
    s_add_u32 s46, s46, 32768
    v_cvt_pk_bf16_f32 v224, v176, v177
    v_cvt_pk_bf16_f32 v225, v178, v179
    v_cvt_pk_bf16_f32 v226, v180, v181
    v_cvt_pk_bf16_f32 v227, v182, v183
    buffer_store_dwordx4 v[224:227], v9, s[8:11], s46 offen sc1
    s_add_u32 s46, s46, 32768
    v_cvt_pk_bf16_f32 v228, v184, v185
    v_cvt_pk_bf16_f32 v229, v186, v187
    v_cvt_pk_bf16_f32 v230, v188, v189
    v_cvt_pk_bf16_f32 v231, v190, v191
    buffer_store_dwordx4 v[228:231], v9, s[8:11], s46 offen sc1
    s_cmp_eq_u32 s58, 1
    s_cbranch_scc1 interleave_layers__linear_attn_block__memory_aug_recurrent_mem_tr__prompt_kernel_of40
    s_waitcnt vmcnt(0)
    s_barrier
    s_add_u32 s24, s40, 1
    s_cmp_eq_u32 s3, 0
    s_cbranch_scc0 interleave_layers__linear_attn_block__memory_aug_recurrent_mem_tr__prompt_kernel_fp41
    v_mov_b32 v15, s24
    buffer_store_dword v15, v14, s[8:11], 0 offen sc1
interleave_layers__linear_attn_block__memory_aug_recurrent_mem_tr__prompt_kernel_fp41:
    s_add_u32 s63, s40, 2
    s_min_u32 s63, s63, 64
    s_cmp_ge_i32 s62, s63
    s_cbranch_scc1 interleave_layers__linear_attn_block__memory_aug_recurrent_mem_tr__prompt_kernel_o_en3_ok
    s_mov_b32 s61, 0
interleave_layers__linear_attn_block__memory_aug_recurrent_mem_tr__prompt_kernel_o_en3:
    buffer_load_dword v11, v10, s[8:11], 0 offen sc1
    s_waitcnt vmcnt(0)
    v_readlane_b32 s62, v11, 0
    s_cmp_ge_i32 s62, s63
    s_cbranch_scc1 interleave_layers__linear_attn_block__memory_aug_recurrent_mem_tr__prompt_kernel_o_en3_ok
    s_add_u32 s61, s61, 1
    s_cmp_ge_u32 s61, s60
    s_cbranch_scc1 interleave_layers__linear_attn_block__memory_aug_recurrent_mem_tr__prompt_kernel_o_en3_to
    s_sleep 2
    s_branch interleave_layers__linear_attn_block__memory_aug_recurrent_mem_tr__prompt_kernel_o_en3
interleave_layers__linear_attn_block__memory_aug_recurrent_mem_tr__prompt_kernel_o_en3_to:
    s_mov_b32 s60, 1
interleave_layers__linear_attn_block__memory_aug_recurrent_mem_tr__prompt_kernel_o_en3_ok:
    buffer_load_dwordx4 v[64:67], v6, s[8:11], s41 offen offset:0 sc1
    buffer_load_dwordx4 v[68:71], v6, s[8:11], s41 offen offset:1024 sc1
    buffer_load_dwordx4 v[72:75], v6, s[8:11], s41 offen offset:2048 sc1
    buffer_load_dwordx4 v[76:79], v6, s[8:11], s41 offen offset:3072 sc1
    buffer_load_dwordx4 v[80:83], v7, s[8:11], s41 offen offset:0 sc1
    buffer_load_dwordx4 v[84:87], v7, s[8:11], s41 offen offset:1024 sc1
    buffer_load_dwordx4 v[88:91], v7, s[8:11], s41 offen offset:2048 sc1
    buffer_load_dwordx4 v[92:95], v7, s[8:11], s41 offen offset:3072 sc1
    buffer_load_dwordx4 v[96:99], v8, s[8:11], s41 offen offset:0 sc1
    buffer_load_dwordx4 v[100:103], v8, s[8:11], s41 offen offset:1024 sc1
    buffer_load_dwordx4 v[104:107], v8, s[8:11], s41 offen offset:2048 sc1
    buffer_load_dwordx4 v[108:111], v8, s[8:11], s41 offen offset:3072 sc1
    s_add_u32 s41, s41, 393216
    s_waitcnt vmcnt(0)
interleave_layers__linear_attn_block__memory_aug_recurrent_mem_tr__prompt_kernel_of40:
    s_waitcnt vmcnt(10)
    s_add_u32 s40, s40, 1
    s_add_u32 s43, s43, 1310720
    v_swap_b32 v74, v84
    v_swap_b32 v75, v85
    v_swap_b32 v98, v108
    v_swap_b32 v99, v109
    buffer_load_dword v232, v10, s[8:11], 0 offen sc1
    v_mfma_f32_16x16x32_bf16 v[112:115], v[64:67], a[0:3], 0
    v_mfma_f32_16x16x32_bf16 v[116:119], v[68:71], a[0:3], 0
    v_mfma_f32_16x16x32_bf16 v[120:123], v[64:67], a[24:27], 0
    v_mfma_f32_16x16x32_bf16 v[124:127], v[68:71], a[24:27], 0
    v_mfma_f32_16x16x32_bf16 v[128:131], v[64:67], a[48:51], 0
    v_mfma_f32_16x16x32_bf16 v[132:135], v[68:71], a[48:51], 0
    v_mfma_f32_16x16x32_bf16 v[136:139], v[64:67], a[72:75], 0
    v_mfma_f32_16x16x32_bf16 v[140:143], v[68:71], a[72:75], 0
    v_mfma_f32_16x16x32_bf16 v[144:147], v[64:67], a[96:99], 0
    v_mfma_f32_16x16x32_bf16 v[148:151], v[68:71], a[96:99], 0
    v_mfma_f32_16x16x32_bf16 v[152:155], v[64:67], a[120:123], 0
    v_mfma_f32_16x16x32_bf16 v[156:159], v[68:71], a[120:123], 0
    v_mfma_f32_16x16x32_bf16 v[160:163], v[64:67], a[144:147], 0
    v_mfma_f32_16x16x32_bf16 v[164:167], v[68:71], a[144:147], 0
    v_mfma_f32_16x16x32_bf16 v[168:171], v[64:67], a[168:171], 0
    v_mfma_f32_16x16x32_bf16 v[172:175], v[68:71], a[168:171], 0
    v_mfma_f32_16x16x32_bf16 v[176:179], v[64:67], a[192:195], 0
    v_mfma_f32_16x16x32_bf16 v[180:183], v[68:71], a[192:195], 0
    v_mfma_f32_16x16x32_bf16 v[184:187], v[64:67], a[216:219], 0
    v_mfma_f32_16x16x32_bf16 v[188:191], v[68:71], a[216:219], 0
    v_mfma_f32_16x16x32_bf16 v[112:115], v[76:79], a[4:7], v[112:115]
    v_mfma_f32_16x16x32_bf16 v[116:119], v[80:83], a[4:7], v[116:119]
    v_mfma_f32_16x16x32_bf16 v[120:123], v[76:79], a[28:31], v[120:123]
    v_mfma_f32_16x16x32_bf16 v[124:127], v[80:83], a[28:31], v[124:127]
    v_mfma_f32_16x16x32_bf16 v[128:131], v[76:79], a[52:55], v[128:131]
    v_mfma_f32_16x16x32_bf16 v[132:135], v[80:83], a[52:55], v[132:135]
    v_mfma_f32_16x16x32_bf16 v[136:139], v[76:79], a[76:79], v[136:139]
    v_mfma_f32_16x16x32_bf16 v[140:143], v[80:83], a[76:79], v[140:143]
    v_mfma_f32_16x16x32_bf16 v[144:147], v[76:79], a[100:103], v[144:147]
    v_mfma_f32_16x16x32_bf16 v[148:151], v[80:83], a[100:103], v[148:151]
    v_mfma_f32_16x16x32_bf16 v[152:155], v[76:79], a[124:127], v[152:155]
    v_mfma_f32_16x16x32_bf16 v[156:159], v[80:83], a[124:127], v[156:159]
    v_mfma_f32_16x16x32_bf16 v[160:163], v[76:79], a[148:151], v[160:163]
    v_mfma_f32_16x16x32_bf16 v[164:167], v[80:83], a[148:151], v[164:167]
    v_mfma_f32_16x16x32_bf16 v[168:171], v[76:79], a[172:175], v[168:171]
    v_mfma_f32_16x16x32_bf16 v[172:175], v[80:83], a[172:175], v[172:175]
    v_mfma_f32_16x16x32_bf16 v[176:179], v[76:79], a[196:199], v[176:179]
    v_mfma_f32_16x16x32_bf16 v[180:183], v[80:83], a[196:199], v[180:183]
    v_mfma_f32_16x16x32_bf16 v[184:187], v[76:79], a[220:223], v[184:187]
    v_mfma_f32_16x16x32_bf16 v[188:191], v[80:83], a[220:223], v[188:191]
    v_mfma_f32_16x16x32_bf16 v[112:115], v[88:91], a[8:11], v[112:115]
    v_mfma_f32_16x16x32_bf16 v[116:119], v[92:95], a[8:11], v[116:119]
    v_mfma_f32_16x16x32_bf16 v[120:123], v[88:91], a[32:35], v[120:123]
    v_mfma_f32_16x16x32_bf16 v[124:127], v[92:95], a[32:35], v[124:127]
    v_mfma_f32_16x16x32_bf16 v[128:131], v[88:91], a[56:59], v[128:131]
    v_mfma_f32_16x16x32_bf16 v[132:135], v[92:95], a[56:59], v[132:135]
    v_mfma_f32_16x16x32_bf16 v[136:139], v[88:91], a[80:83], v[136:139]
    v_mfma_f32_16x16x32_bf16 v[140:143], v[92:95], a[80:83], v[140:143]
    v_mfma_f32_16x16x32_bf16 v[144:147], v[88:91], a[104:107], v[144:147]
    v_mfma_f32_16x16x32_bf16 v[148:151], v[92:95], a[104:107], v[148:151]
    v_mfma_f32_16x16x32_bf16 v[152:155], v[88:91], a[128:131], v[152:155]
    v_mfma_f32_16x16x32_bf16 v[156:159], v[92:95], a[128:131], v[156:159]
    v_mfma_f32_16x16x32_bf16 v[160:163], v[88:91], a[152:155], v[160:163]
    v_mfma_f32_16x16x32_bf16 v[164:167], v[92:95], a[152:155], v[164:167]
    v_mfma_f32_16x16x32_bf16 v[168:171], v[88:91], a[176:179], v[168:171]
    v_mfma_f32_16x16x32_bf16 v[172:175], v[92:95], a[176:179], v[172:175]
    v_mfma_f32_16x16x32_bf16 v[176:179], v[88:91], a[200:203], v[176:179]
    v_mfma_f32_16x16x32_bf16 v[180:183], v[92:95], a[200:203], v[180:183]
    v_mfma_f32_16x16x32_bf16 v[184:187], v[88:91], a[224:227], v[184:187]
    v_mfma_f32_16x16x32_bf16 v[188:191], v[92:95], a[224:227], v[188:191]
    s_waitcnt vmcnt(0)
    v_readfirstlane_b32 s24, v232
    s_max_i32 s62, s62, s24
    s_add_u32 s63, s40, 2
    s_min_u32 s63, s63, 64
    s_cmp_ge_i32 s62, s63
    s_cselect_b32 s24, 1, 0
    s_lshl_b32 s25, s3, 4
    s_add_u32 s25, s25, 4
    v_mov_b32 v12, s25
    v_mov_b32 v13, s24
    ds_write_b32 v12, v13
    v_mov_b32 v12, 4
    s_waitcnt lgkmcnt(0)
    s_barrier
    ds_read_b32 v13, v12
    s_cmp_eq_u32 s3, 0
    s_cbranch_scc0 interleave_layers__linear_attn_block__memory_aug_recurrent_mem_tr__prompt_kernel_fp43
    v_mov_b32 v15, s40
    buffer_store_dword v15, v14, s[8:11], 0 offen sc1
interleave_layers__linear_attn_block__memory_aug_recurrent_mem_tr__prompt_kernel_fp43:
    s_waitcnt lgkmcnt(0)
    v_readfirstlane_b32 s58, v13
    s_cmp_eq_u32 s58, 1
    s_cbranch_scc0 interleave_layers__linear_attn_block__memory_aug_recurrent_mem_tr__prompt_kernel_of42
    s_max_i32 s62, s62, s63
    buffer_load_dwordx4 v[16:19], v6, s[8:11], s41 offen offset:0 sc1
    buffer_load_dwordx4 v[20:23], v6, s[8:11], s41 offen offset:1024 sc1
    buffer_load_dwordx4 v[24:27], v6, s[8:11], s41 offen offset:2048 sc1
    buffer_load_dwordx4 v[28:31], v6, s[8:11], s41 offen offset:3072 sc1
    buffer_load_dwordx4 v[32:35], v7, s[8:11], s41 offen offset:0 sc1
    buffer_load_dwordx4 v[36:39], v7, s[8:11], s41 offen offset:1024 sc1
    buffer_load_dwordx4 v[40:43], v7, s[8:11], s41 offen offset:2048 sc1
    buffer_load_dwordx4 v[44:47], v7, s[8:11], s41 offen offset:3072 sc1
    buffer_load_dwordx4 v[48:51], v8, s[8:11], s41 offen offset:0 sc1
    buffer_load_dwordx4 v[52:55], v8, s[8:11], s41 offen offset:1024 sc1
    buffer_load_dwordx4 v[56:59], v8, s[8:11], s41 offen offset:2048 sc1
    buffer_load_dwordx4 v[60:63], v8, s[8:11], s41 offen offset:3072 sc1
    s_add_u32 s41, s41, 393216
interleave_layers__linear_attn_block__memory_aug_recurrent_mem_tr__prompt_kernel_of42:
    v_mfma_f32_16x16x32_bf16 v[112:115], v[100:103], a[12:15], v[112:115]
    v_mfma_f32_16x16x32_bf16 v[116:119], v[104:107], a[12:15], v[116:119]
    v_mfma_f32_16x16x32_bf16 v[120:123], v[100:103], a[36:39], v[120:123]
    v_mfma_f32_16x16x32_bf16 v[124:127], v[104:107], a[36:39], v[124:127]
    v_mfma_f32_16x16x32_bf16 v[128:131], v[100:103], a[60:63], v[128:131]
    v_mfma_f32_16x16x32_bf16 v[132:135], v[104:107], a[60:63], v[132:135]
    v_mfma_f32_16x16x32_bf16 v[136:139], v[100:103], a[84:87], v[136:139]
    v_mfma_f32_16x16x32_bf16 v[140:143], v[104:107], a[84:87], v[140:143]
    v_mfma_f32_16x16x32_bf16 v[144:147], v[100:103], a[108:111], v[144:147]
    v_mfma_f32_16x16x32_bf16 v[148:151], v[104:107], a[108:111], v[148:151]
    v_mfma_f32_16x16x32_bf16 v[152:155], v[100:103], a[132:135], v[152:155]
    v_mfma_f32_16x16x32_bf16 v[156:159], v[104:107], a[132:135], v[156:159]
    v_mfma_f32_16x16x32_bf16 v[160:163], v[100:103], a[156:159], v[160:163]
    v_mfma_f32_16x16x32_bf16 v[164:167], v[104:107], a[156:159], v[164:167]
    v_mfma_f32_16x16x32_bf16 v[168:171], v[100:103], a[180:183], v[168:171]
    v_mfma_f32_16x16x32_bf16 v[172:175], v[104:107], a[180:183], v[172:175]
    v_mfma_f32_16x16x32_bf16 v[176:179], v[100:103], a[204:207], v[176:179]
    v_mfma_f32_16x16x32_bf16 v[180:183], v[104:107], a[204:207], v[180:183]
    v_mfma_f32_16x16x32_bf16 v[184:187], v[100:103], a[228:231], v[184:187]
    v_mfma_f32_16x16x32_bf16 v[188:191], v[104:107], a[228:231], v[188:191]
    v_mfma_f32_16x16x32_bf16 v[112:115], v[72:75], a[16:19], v[112:115]
    v_mfma_f32_16x16x32_bf16 v[116:119], v[84:87], a[16:19], v[116:119]
    v_mfma_f32_16x16x32_bf16 v[120:123], v[72:75], a[40:43], v[120:123]
    v_mfma_f32_16x16x32_bf16 v[124:127], v[84:87], a[40:43], v[124:127]
    v_mfma_f32_16x16x32_bf16 v[128:131], v[72:75], a[64:67], v[128:131]
    v_mfma_f32_16x16x32_bf16 v[132:135], v[84:87], a[64:67], v[132:135]
    v_mfma_f32_16x16x32_bf16 v[136:139], v[72:75], a[88:91], v[136:139]
    v_mfma_f32_16x16x32_bf16 v[140:143], v[84:87], a[88:91], v[140:143]
    v_mfma_f32_16x16x32_bf16 v[144:147], v[72:75], a[112:115], v[144:147]
    v_mfma_f32_16x16x32_bf16 v[148:151], v[84:87], a[112:115], v[148:151]
    v_mfma_f32_16x16x32_bf16 v[152:155], v[72:75], a[136:139], v[152:155]
    v_mfma_f32_16x16x32_bf16 v[156:159], v[84:87], a[136:139], v[156:159]
    v_mfma_f32_16x16x32_bf16 v[160:163], v[72:75], a[160:163], v[160:163]
    v_mfma_f32_16x16x32_bf16 v[164:167], v[84:87], a[160:163], v[164:167]
    v_mfma_f32_16x16x32_bf16 v[168:171], v[72:75], a[184:187], v[168:171]
    v_mfma_f32_16x16x32_bf16 v[172:175], v[84:87], a[184:187], v[172:175]
    v_mfma_f32_16x16x32_bf16 v[176:179], v[72:75], a[208:211], v[176:179]
    v_mfma_f32_16x16x32_bf16 v[180:183], v[84:87], a[208:211], v[180:183]
    v_mfma_f32_16x16x32_bf16 v[184:187], v[72:75], a[232:235], v[184:187]
    v_mfma_f32_16x16x32_bf16 v[188:191], v[84:87], a[232:235], v[188:191]
    v_mfma_f32_16x16x32_bf16 v[112:115], v[96:99], a[20:23], v[112:115]
    v_mfma_f32_16x16x32_bf16 v[116:119], v[108:111], a[20:23], v[116:119]
    v_mfma_f32_16x16x32_bf16 v[120:123], v[96:99], a[44:47], v[120:123]
    v_mfma_f32_16x16x32_bf16 v[124:127], v[108:111], a[44:47], v[124:127]
    v_mfma_f32_16x16x32_bf16 v[128:131], v[96:99], a[68:71], v[128:131]
    v_mfma_f32_16x16x32_bf16 v[132:135], v[108:111], a[68:71], v[132:135]
    v_mfma_f32_16x16x32_bf16 v[136:139], v[96:99], a[92:95], v[136:139]
    v_mfma_f32_16x16x32_bf16 v[140:143], v[108:111], a[92:95], v[140:143]
    v_mfma_f32_16x16x32_bf16 v[144:147], v[96:99], a[116:119], v[144:147]
    v_mfma_f32_16x16x32_bf16 v[148:151], v[108:111], a[116:119], v[148:151]
    v_mfma_f32_16x16x32_bf16 v[152:155], v[96:99], a[140:143], v[152:155]
    v_mfma_f32_16x16x32_bf16 v[156:159], v[108:111], a[140:143], v[156:159]
    v_mfma_f32_16x16x32_bf16 v[160:163], v[96:99], a[164:167], v[160:163]
    v_mfma_f32_16x16x32_bf16 v[164:167], v[108:111], a[164:167], v[164:167]
    v_mfma_f32_16x16x32_bf16 v[168:171], v[96:99], a[188:191], v[168:171]
    v_mfma_f32_16x16x32_bf16 v[172:175], v[108:111], a[188:191], v[172:175]
    v_mfma_f32_16x16x32_bf16 v[176:179], v[96:99], a[212:215], v[176:179]
    v_mfma_f32_16x16x32_bf16 v[180:183], v[108:111], a[212:215], v[180:183]
    v_mfma_f32_16x16x32_bf16 v[184:187], v[96:99], a[236:239], v[184:187]
    v_mfma_f32_16x16x32_bf16 v[188:191], v[108:111], a[236:239], v[188:191]
    s_mov_b32 s46, s43
    v_cvt_pk_bf16_f32 v192, v112, v113
    v_cvt_pk_bf16_f32 v193, v114, v115
    v_cvt_pk_bf16_f32 v194, v116, v117
    v_cvt_pk_bf16_f32 v195, v118, v119
    buffer_store_dwordx4 v[192:195], v9, s[8:11], s46 offen sc1
    s_add_u32 s46, s46, 32768
    v_cvt_pk_bf16_f32 v196, v120, v121
    v_cvt_pk_bf16_f32 v197, v122, v123
    v_cvt_pk_bf16_f32 v198, v124, v125
    v_cvt_pk_bf16_f32 v199, v126, v127
    buffer_store_dwordx4 v[196:199], v9, s[8:11], s46 offen sc1
    s_add_u32 s46, s46, 32768
    v_cvt_pk_bf16_f32 v200, v128, v129
    v_cvt_pk_bf16_f32 v201, v130, v131
    v_cvt_pk_bf16_f32 v202, v132, v133
    v_cvt_pk_bf16_f32 v203, v134, v135
    buffer_store_dwordx4 v[200:203], v9, s[8:11], s46 offen sc1
    s_add_u32 s46, s46, 32768
    v_cvt_pk_bf16_f32 v204, v136, v137
    v_cvt_pk_bf16_f32 v205, v138, v139
    v_cvt_pk_bf16_f32 v206, v140, v141
    v_cvt_pk_bf16_f32 v207, v142, v143
    buffer_store_dwordx4 v[204:207], v9, s[8:11], s46 offen sc1
    s_add_u32 s46, s46, 32768
    v_cvt_pk_bf16_f32 v208, v144, v145
    v_cvt_pk_bf16_f32 v209, v146, v147
    v_cvt_pk_bf16_f32 v210, v148, v149
    v_cvt_pk_bf16_f32 v211, v150, v151
    buffer_store_dwordx4 v[208:211], v9, s[8:11], s46 offen sc1
    s_add_u32 s46, s46, 32768
    v_cvt_pk_bf16_f32 v212, v152, v153
    v_cvt_pk_bf16_f32 v213, v154, v155
    v_cvt_pk_bf16_f32 v214, v156, v157
    v_cvt_pk_bf16_f32 v215, v158, v159
    buffer_store_dwordx4 v[212:215], v9, s[8:11], s46 offen sc1
    s_add_u32 s46, s46, 32768
    v_cvt_pk_bf16_f32 v216, v160, v161
    v_cvt_pk_bf16_f32 v217, v162, v163
    v_cvt_pk_bf16_f32 v218, v164, v165
    v_cvt_pk_bf16_f32 v219, v166, v167
    buffer_store_dwordx4 v[216:219], v9, s[8:11], s46 offen sc1
    s_add_u32 s46, s46, 32768
    v_cvt_pk_bf16_f32 v220, v168, v169
    v_cvt_pk_bf16_f32 v221, v170, v171
    v_cvt_pk_bf16_f32 v222, v172, v173
    v_cvt_pk_bf16_f32 v223, v174, v175
    buffer_store_dwordx4 v[220:223], v9, s[8:11], s46 offen sc1
    s_add_u32 s46, s46, 32768
    v_cvt_pk_bf16_f32 v224, v176, v177
    v_cvt_pk_bf16_f32 v225, v178, v179
    v_cvt_pk_bf16_f32 v226, v180, v181
    v_cvt_pk_bf16_f32 v227, v182, v183
    buffer_store_dwordx4 v[224:227], v9, s[8:11], s46 offen sc1
    s_add_u32 s46, s46, 32768
    v_cvt_pk_bf16_f32 v228, v184, v185
    v_cvt_pk_bf16_f32 v229, v186, v187
    v_cvt_pk_bf16_f32 v230, v188, v189
    v_cvt_pk_bf16_f32 v231, v190, v191
    buffer_store_dwordx4 v[228:231], v9, s[8:11], s46 offen sc1
    s_cmp_eq_u32 s58, 1
    s_cbranch_scc1 interleave_layers__linear_attn_block__memory_aug_recurrent_mem_tr__prompt_kernel_of44
    s_waitcnt vmcnt(0)
    s_barrier
    s_add_u32 s24, s40, 1
    s_cmp_eq_u32 s3, 0
    s_cbranch_scc0 interleave_layers__linear_attn_block__memory_aug_recurrent_mem_tr__prompt_kernel_fp45
    v_mov_b32 v15, s24
    buffer_store_dword v15, v14, s[8:11], 0 offen sc1
interleave_layers__linear_attn_block__memory_aug_recurrent_mem_tr__prompt_kernel_fp45:
    s_add_u32 s63, s40, 2
    s_min_u32 s63, s63, 64
    s_cmp_ge_i32 s62, s63
    s_cbranch_scc1 interleave_layers__linear_attn_block__memory_aug_recurrent_mem_tr__prompt_kernel_o_en4_ok
    s_mov_b32 s61, 0
interleave_layers__linear_attn_block__memory_aug_recurrent_mem_tr__prompt_kernel_o_en4:
    buffer_load_dword v11, v10, s[8:11], 0 offen sc1
    s_waitcnt vmcnt(0)
    v_readlane_b32 s62, v11, 0
    s_cmp_ge_i32 s62, s63
    s_cbranch_scc1 interleave_layers__linear_attn_block__memory_aug_recurrent_mem_tr__prompt_kernel_o_en4_ok
    s_add_u32 s61, s61, 1
    s_cmp_ge_u32 s61, s60
    s_cbranch_scc1 interleave_layers__linear_attn_block__memory_aug_recurrent_mem_tr__prompt_kernel_o_en4_to
    s_sleep 2
    s_branch interleave_layers__linear_attn_block__memory_aug_recurrent_mem_tr__prompt_kernel_o_en4
interleave_layers__linear_attn_block__memory_aug_recurrent_mem_tr__prompt_kernel_o_en4_to:
    s_mov_b32 s60, 1
interleave_layers__linear_attn_block__memory_aug_recurrent_mem_tr__prompt_kernel_o_en4_ok:
    buffer_load_dwordx4 v[16:19], v6, s[8:11], s41 offen offset:0 sc1
    buffer_load_dwordx4 v[20:23], v6, s[8:11], s41 offen offset:1024 sc1
    buffer_load_dwordx4 v[24:27], v6, s[8:11], s41 offen offset:2048 sc1
    buffer_load_dwordx4 v[28:31], v6, s[8:11], s41 offen offset:3072 sc1
    buffer_load_dwordx4 v[32:35], v7, s[8:11], s41 offen offset:0 sc1
    buffer_load_dwordx4 v[36:39], v7, s[8:11], s41 offen offset:1024 sc1
    buffer_load_dwordx4 v[40:43], v7, s[8:11], s41 offen offset:2048 sc1
    buffer_load_dwordx4 v[44:47], v7, s[8:11], s41 offen offset:3072 sc1
    buffer_load_dwordx4 v[48:51], v8, s[8:11], s41 offen offset:0 sc1
    buffer_load_dwordx4 v[52:55], v8, s[8:11], s41 offen offset:1024 sc1
    buffer_load_dwordx4 v[56:59], v8, s[8:11], s41 offen offset:2048 sc1
    buffer_load_dwordx4 v[60:63], v8, s[8:11], s41 offen offset:3072 sc1
    s_add_u32 s41, s41, 393216
    s_waitcnt vmcnt(0)
interleave_layers__linear_attn_block__memory_aug_recurrent_mem_tr__prompt_kernel_of44:
    s_waitcnt vmcnt(10)
    s_add_u32 s40, s40, 1
    s_add_u32 s43, s43, 1310720
    s_cmp_lt_u32 s40, 64
    s_cbranch_scc1 interleave_layers__linear_attn_block__memory_aug_recurrent_mem_tr__prompt_kernel_o_seg
    s_waitcnt vmcnt(0)
    s_barrier
    s_cmp_eq_u32 s3, 0
    s_cbranch_scc0 interleave_layers__linear_attn_block__memory_aug_recurrent_mem_tr__prompt_kernel_fp46
    v_mov_b32 v15, s40
    buffer_store_dword v15, v14, s[8:11], 0 offen sc1
interleave_layers__linear_attn_block__memory_aug_recurrent_mem_tr__prompt_kernel_fp46:
    s_cmp_eq_u32 s92, 0
    s_cbranch_scc0 interleave_layers__linear_attn_block__memory_aug_recurrent_mem_tr__prompt_kernel_end
    s_mov_b32 s92, 1
    s_branch interleave_layers__linear_attn_block__memory_aug_recurrent_mem_tr__prompt_kernel_o_layer
interleave_layers__linear_attn_block__memory_aug_recurrent_mem_tr__prompt_kernel_end:
    s_endpgm
.section .rodata,"a"
.p2align 6
.amdhsa_kernel interleave_layers__linear_attn_block__memory_aug_recurrent_mem_tr__prompt_kernel
  .amdhsa_next_free_vgpr 512
  .amdhsa_next_free_sgpr 100
  .amdhsa_accum_offset 256
  .amdhsa_group_segment_fixed_size 0
  .amdhsa_kernarg_size 104
  .amdhsa_user_sgpr_count 2
  .amdhsa_user_sgpr_kernarg_segment_ptr 1
  .amdhsa_system_sgpr_workgroup_id_x 1
.end_amdhsa_kernel
```

```asm
; @launch kernel=interleave_layers__linear_attn_block__memory_aug_recurrent_mem_tr__prompt_kernel grid=(256,1,1) block=(256,1,1) lds=135168
.amdgcn_target "amdgcn-amd-amdhsa--gfx950"
.text
.globl interleave_layers__linear_attn_block__memory_aug_recurrent_mem_tr__prompt_kernel
.p2align 8
.type interleave_layers__linear_attn_block__memory_aug_recurrent_mem_tr__prompt_kernel,@function
interleave_layers__linear_attn_block__memory_aug_recurrent_mem_tr__prompt_kernel:
    s_cmp_ge_u32 s2, 256
    s_cbranch_scc1 interleave_layers__linear_attn_block__memory_aug_recurrent_mem_tr__prompt_kernel_end
    s_load_dwordx2 s[4:5], s[0:1], 96
    s_load_dwordx2 s[6:7], s[0:1], 88
    s_load_dwordx2 s[24:25], s[0:1], 0
    s_load_dwordx2 s[98:99], s[0:1], 8
    s_and_b32 s44, s2, 7
    s_lshr_b32 s45, s2, 3
    s_and_b32 s26, s44, 3
    s_lshl_b32 s27, s45, 2
    s_add_u32 s26, s26, s27
    s_add_u32 s27, s26, 128
    s_cmp_lt_u32 s26, 104
    s_cselect_b32 s27, s26, s27
    s_add_u32 s26, s26, 104
    s_cmp_lt_u32 s44, 4
    s_cselect_b32 s2, s27, s26
    v_and_b32 v1, 63, v0
    v_lshrrev_b32 v4, 6, v0
    v_and_b32 v2, 15, v1
    v_lshrrev_b32 v3, 4, v1
    v_readfirstlane_b32 s3, v4
    s_mov_b32 s60, 131072
    s_mov_b32 s59, -1
    s_mov_b32 s92, 0
    s_mov_b32 s36, 0
    s_waitcnt lgkmcnt(0)
    s_mov_b32 s8, s4
    s_mov_b32 s9, s5
    s_mov_b32 s10, 268435456
    s_mov_b32 s11, 0x00020000
    s_mov_b32 s72, s6
    s_mov_b32 s73, s7
    s_mov_b32 s74, 256
    s_mov_b32 s75, 0x00020000
    s_mov_b32 s16, s24
    s_mov_b32 s17, s25
    s_mov_b32 s18, 2621440
    s_mov_b32 s19, 0x00020000
    s_cmp_eq_u32 s2, 255
    s_cbranch_scc0 interleave_layers__linear_attn_block__memory_aug_recurrent_mem_tr__prompt_kernel_cf1
    v_lshlrev_b32 v5, 4, v0
    v_mov_b32 v8, -1
    v_mov_b32 v9, -1
    v_mov_b32 v10, -1
    v_mov_b32 v11, -1
    s_mov_b32 s24, 23068672
    buffer_store_dwordx4 v[8:11], v5, s[8:11], s24 offen sc1
    s_add_u32 s24, s24, 4096
    buffer_store_dwordx4 v[8:11], v5, s[8:11], s24 offen sc1
    s_add_u32 s24, s24, 4096
    buffer_store_dwordx4 v[8:11], v5, s[8:11], s24 offen sc1
    s_add_u32 s24, s24, 4096
    buffer_store_dwordx4 v[8:11], v5, s[8:11], s24 offen sc1
    s_add_u32 s24, s24, 4096
    buffer_store_dwordx4 v[8:11], v5, s[8:11], s24 offen sc1
    s_add_u32 s24, s24, 4096
    buffer_store_dwordx4 v[8:11], v5, s[8:11], s24 offen sc1
    s_add_u32 s24, s24, 4096
    buffer_store_dwordx4 v[8:11], v5, s[8:11], s24 offen sc1
    s_add_u32 s24, s24, 4096
    buffer_store_dwordx4 v[8:11], v5, s[8:11], s24 offen sc1
    s_add_u32 s24, s24, 4096
    buffer_store_dwordx4 v[8:11], v5, s[8:11], s24 offen sc1
    s_add_u32 s24, s24, 4096
    buffer_store_dwordx4 v[8:11], v5, s[8:11], s24 offen sc1
    s_add_u32 s24, s24, 4096
    buffer_store_dwordx4 v[8:11], v5, s[8:11], s24 offen sc1
    s_add_u32 s24, s24, 4096
    buffer_store_dwordx4 v[8:11], v5, s[8:11], s24 offen sc1
    s_add_u32 s24, s24, 4096
    buffer_store_dwordx4 v[8:11], v5, s[8:11], s24 offen sc1
    s_add_u32 s24, s24, 4096
    buffer_store_dwordx4 v[8:11], v5, s[8:11], s24 offen sc1
    s_add_u32 s24, s24, 4096
    buffer_store_dwordx4 v[8:11], v5, s[8:11], s24 offen sc1
    s_add_u32 s24, s24, 4096
    buffer_store_dwordx4 v[8:11], v5, s[8:11], s24 offen sc1
    s_add_u32 s24, s24, 4096
interleave_layers__linear_attn_block__memory_aug_recurrent_mem_tr__prompt_kernel_cf1:
    s_mov_b32 s46, 64
    s_mov_b32 s47, 32
    s_mov_b32 s50, 0
    s_lshl_b32 s48, s45, 1
    s_mov_b32 s49, 1
    s_mov_b32 s40, 2
interleave_layers__linear_attn_block__memory_aug_recurrent_mem_tr__prompt_kernel_k1_entry:
    v_and_b32 v7, 31, v0
    v_lshrrev_b32 v8, 5, v0
    v_mul_u32_u24 v152, 3840, v8
    v_lshlrev_b32 v9, 4, v7
    v_add_u32 v152, v152, v9
    v_cmp_le_u32 vcc, 10, v7
    s_nop 1
    v_cndmask_b32 v10, 0, 1, vcc
    v_cmp_le_u32 vcc, 20, v7
    s_nop 1
    v_cndmask_b32 v11, 0, 1, vcc
    v_add_u32 v10, v10, v11
    v_mul_u32_u24 v10, 1120, v10
    v_add_u32 v152, v152, v10
    v_mov_b32 v10, 2146435072
    v_cmp_le_u32 vcc, 30, v7
    s_nop 1
    v_cndmask_b32 v152, v152, v10, vcc
    v_mul_u32_u24 v153, 544, v8
    v_add_u32 v153, v153, v9
    v_add_u32 v153, 40960, v153
    s_mov_b32 s12, s98
    s_mov_b32 s13, s99
    s_mov_b32 s14, 2457600
    s_mov_b32 s15, 0x00020000
    s_mul_i32 s52, s44, 160
    v_lshrrev_b32 v10, 2, v0
    v_mul_u32_u24 v10, 3840, v10
    v_and_b32 v11, 3, v0
    v_lshlrev_b32 v11, 6, v11
    v_min_u32 v11, 156, v11
    v_add_u32 v10, v10, v11
    s_mul_i32 s24, s45, 205
    s_lshr_b32 s24, s24, 11
    s_mul_i32 s24, s24, 10
    s_sub_u32 s24, s45, s24
    s_mul_i32 s24, s24, 245760
    s_add_u32 s24, s24, s52
    buffer_load_dword a254, v10, s[12:15], s24 offen
    s_add_u32 s24, s24, 1280
    buffer_load_dword a254, v10, s[12:15], s24 offen
    s_add_u32 s24, s24, 1280
    buffer_load_dword a254, v10, s[12:15], s24 offen
    s_add_u32 s24, s52, 0
    buffer_load_dwordx4 v[56:59], v152, s[12:15], s24 offen
    s_add_u32 s24, s24, 30720
    buffer_load_dwordx4 v[60:63], v152, s[12:15], s24 offen
    s_add_u32 s24, s24, 30720
    buffer_load_dwordx4 v[64:67], v152, s[12:15], s24 offen
    s_add_u32 s24, s24, 30720
    buffer_load_dwordx4 v[68:71], v152, s[12:15], s24 offen
    s_add_u32 s24, s24, 30720
    buffer_load_dwordx4 v[72:75], v152, s[12:15], s24 offen
    s_add_u32 s24, s24, 30720
    buffer_load_dwordx4 v[76:79], v152, s[12:15], s24 offen
    s_add_u32 s24, s24, 30720
    buffer_load_dwordx4 v[80:83], v152, s[12:15], s24 offen
    s_add_u32 s24, s24, 30720
    buffer_load_dwordx4 v[84:87], v152, s[12:15], s24 offen
    s_add_u32 s24, s52, 245760
    buffer_load_dwordx4 v[88:91], v152, s[12:15], s24 offen
    s_add_u32 s24, s24, 30720
    buffer_load_dwordx4 v[92:95], v152, s[12:15], s24 offen
    s_add_u32 s24, s24, 30720
    buffer_load_dwordx4 v[96:99], v152, s[12:15], s24 offen
    s_add_u32 s24, s24, 30720
    buffer_load_dwordx4 v[100:103], v152, s[12:15], s24 offen
    s_add_u32 s24, s24, 30720
    buffer_load_dwordx4 v[104:107], v152, s[12:15], s24 offen
    s_add_u32 s24, s24, 30720
    buffer_load_dwordx4 v[108:111], v152, s[12:15], s24 offen
    s_add_u32 s24, s24, 30720
    buffer_load_dwordx4 v[112:115], v152, s[12:15], s24 offen
    s_add_u32 s24, s24, 30720
    buffer_load_dwordx4 v[116:119], v152, s[12:15], s24 offen
    s_add_u32 s24, s52, 491520
    buffer_load_dwordx4 v[120:123], v152, s[12:15], s24 offen
    s_add_u32 s24, s24, 30720
    buffer_load_dwordx4 v[124:127], v152, s[12:15], s24 offen
    s_add_u32 s24, s24, 30720
    buffer_load_dwordx4 v[128:131], v152, s[12:15], s24 offen
    s_add_u32 s24, s24, 30720
    buffer_load_dwordx4 v[132:135], v152, s[12:15], s24 offen
    s_add_u32 s24, s24, 30720
    buffer_load_dwordx4 v[136:139], v152, s[12:15], s24 offen
    s_add_u32 s24, s24, 30720
    buffer_load_dwordx4 v[140:143], v152, s[12:15], s24 offen
    s_add_u32 s24, s24, 30720
    buffer_load_dwordx4 v[144:147], v152, s[12:15], s24 offen
    s_add_u32 s24, s24, 30720
    buffer_load_dwordx4 v[148:151], v152, s[12:15], s24 offen
    s_lshr_b32 s24, s3, 1
    s_mul_i32 s24, s24, 20480
    s_and_b32 s25, s3, 1
    s_mul_i32 s25, s25, 10
    s_mul_i32 s25, s25, s46
    s_add_u32 s24, s24, s25
    s_cmp_eq_u32 s50, 1
    s_cselect_b32 s25, 16, 1280
    s_cselect_b32 s26, 256, 8
    v_mul_u32_u24 v4, s25, v2
    v_mul_u32_u24 v5, s26, v3
    v_add3_u32 v4, v4, v5, s24
    v_add_u32 v5, s47, v4
    s_mul_i32 s43, s48, 40960
    s_mul_i32 s42, s49, 40960
    s_cmp_eq_u32 s92, 0
    s_cselect_b32 s51, 1, 0
    s_cselect_b32 s41, s43, 2146435072
    s_mov_b32 s24, s41
    buffer_load_dwordx2 v[16:17], v4, s[16:19], s24 offen
    buffer_load_dwordx2 v[18:19], v5, s[16:19], s24 offen
    s_add_u32 s24, s24, s46
    buffer_load_dwordx2 v[20:21], v4, s[16:19], s24 offen
    buffer_load_dwordx2 v[22:23], v5, s[16:19], s24 offen
    s_add_u32 s24, s24, s46
    buffer_load_dwordx2 v[24:25], v4, s[16:19], s24 offen
    buffer_load_dwordx2 v[26:27], v5, s[16:19], s24 offen
    s_add_u32 s24, s24, s46
    buffer_load_dwordx2 v[28:29], v4, s[16:19], s24 offen
    buffer_load_dwordx2 v[30:31], v5, s[16:19], s24 offen
    s_add_u32 s24, s24, s46
    buffer_load_dwordx2 v[32:33], v4, s[16:19], s24 offen
    buffer_load_dwordx2 v[34:35], v5, s[16:19], s24 offen
    s_add_u32 s24, s24, s46
    buffer_load_dwordx2 v[36:37], v4, s[16:19], s24 offen
    buffer_load_dwordx2 v[38:39], v5, s[16:19], s24 offen
    s_add_u32 s24, s24, s46
    buffer_load_dwordx2 v[40:41], v4, s[16:19], s24 offen
    buffer_load_dwordx2 v[42:43], v5, s[16:19], s24 offen
    s_add_u32 s24, s24, s46
    buffer_load_dwordx2 v[44:45], v4, s[16:19], s24 offen
    buffer_load_dwordx2 v[46:47], v5, s[16:19], s24 offen
    s_add_u32 s24, s24, s46
    buffer_load_dwordx2 v[48:49], v4, s[16:19], s24 offen
    buffer_load_dwordx2 v[50:51], v5, s[16:19], s24 offen
    s_add_u32 s24, s24, s46
    buffer_load_dwordx2 v[52:53], v4, s[16:19], s24 offen
    buffer_load_dwordx2 v[54:55], v5, s[16:19], s24 offen
    v_lshrrev_b32 v6, 2, v2
    v_lshl_add_u32 v6, v3, 2, v6
    v_mul_u32_u24 v6, 544, v6
    v_and_b32 v7, 3, v2
    v_lshl_add_u32 v6, v7, 3, v6
    v_add_u32 v6, 40960, v6
    s_mov_b32 s24, 0
    s_cmp_eq_u32 s3, 1
    s_cselect_b32 s24, 64, s24
    s_cmp_eq_u32 s3, 2
    s_cselect_b32 s24, 128, s24
    s_cmp_eq_u32 s3, 3
    s_cselect_b32 s24, 224, s24
    v_add_u32 v12, s24, v6
    s_mov_b32 s24, 32
    s_cmp_eq_u32 s3, 1
    s_cselect_b32 s24, 96, s24
    s_cmp_eq_u32 s3, 2
    s_cselect_b32 s24, 160, s24
    s_cmp_eq_u32 s3, 3
    s_cselect_b32 s24, 256, s24
    v_add_u32 v13, s24, v6
    s_mov_b32 s24, 320
    s_cmp_eq_u32 s3, 1
    s_cselect_b32 s24, 384, s24
    s_cmp_eq_u32 s3, 2
    s_cselect_b32 s24, 192, s24
    s_cmp_eq_u32 s3, 3
    s_cselect_b32 s24, 288, s24
    v_add_u32 v14, s24, v6
    s_mov_b32 s24, 352
    s_cmp_eq_u32 s3, 1
    s_cselect_b32 s24, 416, s24
    s_cmp_eq_u32 s3, 2
    s_cselect_b32 s24, 448, s24
    s_cmp_eq_u32 s3, 3
    s_cselect_b32 s24, 288, s24
    v_add_u32 v15, s24, v6
    v_mov_b32 v172, 0x3f803f80
    v_mov_b32 v173, 0x3f803f80
    v_mov_b32 v174, 0x3f803f80
    v_mov_b32 v175, 0x3f803f80
    s_waitcnt vmcnt(36)
    ds_write_b128 v153, v[56:59] offset:0
    ds_write_b128 v153, v[60:63] offset:4352
    ds_write_b128 v153, v[64:67] offset:8704
    ds_write_b128 v153, v[68:71] offset:13056
    ds_write_b128 v153, v[72:75] offset:17408
    ds_write_b128 v153, v[76:79] offset:21760
    ds_write_b128 v153, v[80:83] offset:26112
    ds_write_b128 v153, v[84:87] offset:30464
    s_waitcnt lgkmcnt(0)
    s_add_u32 s24, s52, 737280
    buffer_load_dwordx4 v[56:59], v152, s[12:15], s24 offen
    s_add_u32 s24, s24, 30720
    buffer_load_dwordx4 v[60:63], v152, s[12:15], s24 offen
    s_add_u32 s24, s24, 30720
    buffer_load_dwordx4 v[64:67], v152, s[12:15], s24 offen
    s_add_u32 s24, s24, 30720
    buffer_load_dwordx4 v[68:71], v152, s[12:15], s24 offen
    s_add_u32 s24, s24, 30720
    buffer_load_dwordx4 v[72:75], v152, s[12:15], s24 offen
    s_add_u32 s24, s24, 30720
    buffer_load_dwordx4 v[76:79], v152, s[12:15], s24 offen
    s_add_u32 s24, s24, 30720
    buffer_load_dwordx4 v[80:83], v152, s[12:15], s24 offen
    s_add_u32 s24, s24, 30720
    buffer_load_dwordx4 v[84:87], v152, s[12:15], s24 offen
    s_barrier
    ds_read_b64_tr_b16 a[0:1], v12 offset:0
    ds_read_b64_tr_b16 a[2:3], v12 offset:8704
    ds_read_b64_tr_b16 a[4:5], v12 offset:17408
    ds_read_b64_tr_b16 a[6:7], v12 offset:26112
    ds_read_b64_tr_b16 a[80:81], v13 offset:0
    ds_read_b64_tr_b16 a[82:83], v13 offset:8704
    ds_read_b64_tr_b16 a[84:85], v13 offset:17408
    ds_read_b64_tr_b16 a[86:87], v13 offset:26112
    ds_read_b64_tr_b16 a[160:161], v14 offset:0
    ds_read_b64_tr_b16 a[162:163], v14 offset:8704
    ds_read_b64_tr_b16 a[164:165], v14 offset:17408
    ds_read_b64_tr_b16 a[166:167], v14 offset:26112
    ds_read_b64_tr_b16 v[176:177], v15 offset:0
    ds_read_b64_tr_b16 v[178:179], v15 offset:8704
    ds_read_b64_tr_b16 v[180:181], v15 offset:17408
    ds_read_b64_tr_b16 v[182:183], v15 offset:26112
    s_waitcnt vmcnt(36)
    ds_write_b128 v153, v[88:91] offset:34816
    ds_write_b128 v153, v[92:95] offset:39168
    ds_write_b128 v153, v[96:99] offset:43520
    ds_write_b128 v153, v[100:103] offset:47872
    ds_write_b128 v153, v[104:107] offset:52224
    ds_write_b128 v153, v[108:111] offset:56576
    ds_write_b128 v153, v[112:115] offset:60928
    ds_write_b128 v153, v[116:119] offset:65280
    s_waitcnt lgkmcnt(0)
    s_add_u32 s24, s52, 983040
    buffer_load_dwordx4 v[88:91], v152, s[12:15], s24 offen
    s_add_u32 s24, s24, 30720
    buffer_load_dwordx4 v[92:95], v152, s[12:15], s24 offen
    s_add_u32 s24, s24, 30720
    buffer_load_dwordx4 v[96:99], v152, s[12:15], s24 offen
    s_add_u32 s24, s24, 30720
    buffer_load_dwordx4 v[100:103], v152, s[12:15], s24 offen
    s_add_u32 s24, s24, 30720
    buffer_load_dwordx4 v[104:107], v152, s[12:15], s24 offen
    s_add_u32 s24, s24, 30720
    buffer_load_dwordx4 v[108:111], v152, s[12:15], s24 offen
    s_add_u32 s24, s24, 30720
    buffer_load_dwordx4 v[112:115], v152, s[12:15], s24 offen
    s_add_u32 s24, s24, 30720
    buffer_load_dwordx4 v[116:119], v152, s[12:15], s24 offen
    v_mfma_f32_16x16x32_bf16 v[156:159], a[0:3], v[172:175], 0
    v_mfma_f32_16x16x32_bf16 v[160:163], a[80:83], v[172:175], 0
    v_mfma_f32_16x16x32_bf16 v[164:167], a[160:163], v[172:175], 0
    v_mfma_f32_16x16x32_bf16 v[168:171], v[176:179], v[172:175], 0
    v_mfma_f32_16x16x32_bf16 v[156:159], a[4:7], v[172:175], v[156:159]
    v_mfma_f32_16x16x32_bf16 v[160:163], a[84:87], v[172:175], v[160:163]
    v_mfma_f32_16x16x32_bf16 v[164:167], a[164:167], v[172:175], v[164:167]
    v_mfma_f32_16x16x32_bf16 v[168:171], v[180:183], v[172:175], v[168:171]
    s_barrier
    ds_read_b64_tr_b16 a[8:9], v12 offset:34816
    ds_read_b64_tr_b16 a[10:11], v12 offset:43520
    ds_read_b64_tr_b16 a[12:13], v12 offset:52224
    ds_read_b64_tr_b16 a[14:15], v12 offset:60928
    ds_read_b64_tr_b16 a[88:89], v13 offset:34816
    ds_read_b64_tr_b16 a[90:91], v13 offset:43520
    ds_read_b64_tr_b16 a[92:93], v13 offset:52224
    ds_read_b64_tr_b16 a[94:95], v13 offset:60928
    ds_read_b64_tr_b16 a[168:169], v14 offset:34816
    ds_read_b64_tr_b16 a[170:171], v14 offset:43520
    ds_read_b64_tr_b16 a[172:173], v14 offset:52224
    ds_read_b64_tr_b16 a[174:175], v14 offset:60928
    ds_read_b64_tr_b16 v[184:185], v15 offset:34816
    ds_read_b64_tr_b16 v[186:187], v15 offset:43520
    ds_read_b64_tr_b16 v[188:189], v15 offset:52224
    ds_read_b64_tr_b16 v[190:191], v15 offset:60928
    s_waitcnt vmcnt(36)
    ds_write_b128 v153, v[120:123] offset:0
    ds_write_b128 v153, v[124:127] offset:4352
    ds_write_b128 v153, v[128:131] offset:8704
    ds_write_b128 v153, v[132:135] offset:13056
    ds_write_b128 v153, v[136:139] offset:17408
    ds_write_b128 v153, v[140:143] offset:21760
    ds_write_b128 v153, v[144:147] offset:26112
    ds_write_b128 v153, v[148:151] offset:30464
    s_waitcnt lgkmcnt(0)
    s_add_u32 s24, s52, 1228800
    buffer_load_dwordx4 v[120:123], v152, s[12:15], s24 offen
    s_add_u32 s24, s24, 30720
    buffer_load_dwordx4 v[124:127], v152, s[12:15], s24 offen
    s_add_u32 s24, s24, 30720
    buffer_load_dwordx4 v[128:131], v152, s[12:15], s24 offen
    s_add_u32 s24, s24, 30720
    buffer_load_dwordx4 v[132:135], v152, s[12:15], s24 offen
    s_add_u32 s24, s24, 30720
    buffer_load_dwordx4 v[136:139], v152, s[12:15], s24 offen
    s_add_u32 s24, s24, 30720
    buffer_load_dwordx4 v[140:143], v152, s[12:15], s24 offen
    s_add_u32 s24, s24, 30720
    buffer_load_dwordx4 v[144:147], v152, s[12:15], s24 offen
    s_add_u32 s24, s24, 30720
    buffer_load_dwordx4 v[148:151], v152, s[12:15], s24 offen
    v_mfma_f32_16x16x32_bf16 v[156:159], a[8:11], v[172:175], v[156:159]
    v_mfma_f32_16x16x32_bf16 v[160:163], a[88:91], v[172:175], v[160:163]
    v_mfma_f32_16x16x32_bf16 v[164:167], a[168:171], v[172:175], v[164:167]
    v_mfma_f32_16x16x32_bf16 v[168:171], v[184:187], v[172:175], v[168:171]
    v_mfma_f32_16x16x32_bf16 v[156:159], a[12:15], v[172:175], v[156:159]
    v_mfma_f32_16x16x32_bf16 v[160:163], a[92:95], v[172:175], v[160:163]
    v_mfma_f32_16x16x32_bf16 v[164:167], a[172:175], v[172:175], v[164:167]
    v_mfma_f32_16x16x32_bf16 v[168:171], v[188:191], v[172:175], v[168:171]
    s_barrier
    ds_read_b64_tr_b16 a[16:17], v12 offset:0
    ds_read_b64_tr_b16 a[18:19], v12 offset:8704
    ds_read_b64_tr_b16 a[20:21], v12 offset:17408
    ds_read_b64_tr_b16 a[22:23], v12 offset:26112
    ds_read_b64_tr_b16 a[96:97], v13 offset:0
    ds_read_b64_tr_b16 a[98:99], v13 offset:8704
    ds_read_b64_tr_b16 a[100:101], v13 offset:17408
    ds_read_b64_tr_b16 a[102:103], v13 offset:26112
    ds_read_b64_tr_b16 a[176:177], v14 offset:0
    ds_read_b64_tr_b16 a[178:179], v14 offset:8704
    ds_read_b64_tr_b16 a[180:181], v14 offset:17408
    ds_read_b64_tr_b16 a[182:183], v14 offset:26112
    ds_read_b64_tr_b16 v[192:193], v15 offset:0
    ds_read_b64_tr_b16 v[194:195], v15 offset:8704
    ds_read_b64_tr_b16 v[196:197], v15 offset:17408
    ds_read_b64_tr_b16 v[198:199], v15 offset:26112
    s_waitcnt vmcnt(16)
    ds_write_b128 v153, v[56:59] offset:34816
    ds_write_b128 v153, v[60:63] offset:39168
    ds_write_b128 v153, v[64:67] offset:43520
    ds_write_b128 v153, v[68:71] offset:47872
    ds_write_b128 v153, v[72:75] offset:52224
    ds_write_b128 v153, v[76:79] offset:56576
    ds_write_b128 v153, v[80:83] offset:60928
    ds_write_b128 v153, v[84:87] offset:65280
    s_waitcnt lgkmcnt(0)
    s_add_u32 s24, s52, 1474560
    buffer_load_dwordx4 v[56:59], v152, s[12:15], s24 offen
    s_add_u32 s24, s24, 30720
    buffer_load_dwordx4 v[60:63], v152, s[12:15], s24 offen
    s_add_u32 s24, s24, 30720
    buffer_load_dwordx4 v[64:67], v152, s[12:15], s24 offen
    s_add_u32 s24, s24, 30720
    buffer_load_dwordx4 v[68:71], v152, s[12:15], s24 offen
    s_add_u32 s24, s24, 30720
    buffer_load_dwordx4 v[72:75], v152, s[12:15], s24 offen
    s_add_u32 s24, s24, 30720
    buffer_load_dwordx4 v[76:79], v152, s[12:15], s24 offen
    s_add_u32 s24, s24, 30720
    buffer_load_dwordx4 v[80:83], v152, s[12:15], s24 offen
    s_add_u32 s24, s24, 30720
    buffer_load_dwordx4 v[84:87], v152, s[12:15], s24 offen
    v_mfma_f32_16x16x32_bf16 v[156:159], a[16:19], v[172:175], v[156:159]
    v_mfma_f32_16x16x32_bf16 v[160:163], a[96:99], v[172:175], v[160:163]
    v_mfma_f32_16x16x32_bf16 v[164:167], a[176:179], v[172:175], v[164:167]
    v_mfma_f32_16x16x32_bf16 v[168:171], v[192:195], v[172:175], v[168:171]
    v_mfma_f32_16x16x32_bf16 v[156:159], a[20:23], v[172:175], v[156:159]
    v_mfma_f32_16x16x32_bf16 v[160:163], a[100:103], v[172:175], v[160:163]
    v_mfma_f32_16x16x32_bf16 v[164:167], a[180:183], v[172:175], v[164:167]
    v_mfma_f32_16x16x32_bf16 v[168:171], v[196:199], v[172:175], v[168:171]
    s_barrier
    ds_read_b64_tr_b16 a[24:25], v12 offset:34816
    ds_read_b64_tr_b16 a[26:27], v12 offset:43520
    ds_read_b64_tr_b16 a[28:29], v12 offset:52224
    ds_read_b64_tr_b16 a[30:31], v12 offset:60928
    ds_read_b64_tr_b16 a[104:105], v13 offset:34816
    ds_read_b64_tr_b16 a[106:107], v13 offset:43520
    ds_read_b64_tr_b16 a[108:109], v13 offset:52224
    ds_read_b64_tr_b16 a[110:111], v13 offset:60928
    ds_read_b64_tr_b16 a[184:185], v14 offset:34816
    ds_read_b64_tr_b16 a[186:187], v14 offset:43520
    ds_read_b64_tr_b16 a[188:189], v14 offset:52224
    ds_read_b64_tr_b16 a[190:191], v14 offset:60928
    ds_read_b64_tr_b16 v[200:201], v15 offset:34816
    ds_read_b64_tr_b16 v[202:203], v15 offset:43520
    ds_read_b64_tr_b16 v[204:205], v15 offset:52224
    ds_read_b64_tr_b16 v[206:207], v15 offset:60928
    s_waitcnt vmcnt(16)
    ds_write_b128 v153, v[88:91] offset:0
    ds_write_b128 v153, v[92:95] offset:4352
    ds_write_b128 v153, v[96:99] offset:8704
    ds_write_b128 v153, v[100:103] offset:13056
    ds_write_b128 v153, v[104:107] offset:17408
    ds_write_b128 v153, v[108:111] offset:21760
    ds_write_b128 v153, v[112:115] offset:26112
    ds_write_b128 v153, v[116:119] offset:30464
    s_waitcnt lgkmcnt(0)
    s_add_u32 s24, s52, 1720320
    buffer_load_dwordx4 v[88:91], v152, s[12:15], s24 offen
    s_add_u32 s24, s24, 30720
    buffer_load_dwordx4 v[92:95], v152, s[12:15], s24 offen
    s_add_u32 s24, s24, 30720
    buffer_load_dwordx4 v[96:99], v152, s[12:15], s24 offen
    s_add_u32 s24, s24, 30720
    buffer_load_dwordx4 v[100:103], v152, s[12:15], s24 offen
    s_add_u32 s24, s24, 30720
    buffer_load_dwordx4 v[104:107], v152, s[12:15], s24 offen
    s_add_u32 s24, s24, 30720
    buffer_load_dwordx4 v[108:111], v152, s[12:15], s24 offen
    s_add_u32 s24, s24, 30720
    buffer_load_dwordx4 v[112:115], v152, s[12:15], s24 offen
    s_add_u32 s24, s24, 30720
    buffer_load_dwordx4 v[116:119], v152, s[12:15], s24 offen
    v_mfma_f32_16x16x32_bf16 v[156:159], a[24:27], v[172:175], v[156:159]
    v_mfma_f32_16x16x32_bf16 v[160:163], a[104:107], v[172:175], v[160:163]
    v_mfma_f32_16x16x32_bf16 v[164:167], a[184:187], v[172:175], v[164:167]
    v_mfma_f32_16x16x32_bf16 v[168:171], v[200:203], v[172:175], v[168:171]
    v_mfma_f32_16x16x32_bf16 v[156:159], a[28:31], v[172:175], v[156:159]
    v_mfma_f32_16x16x32_bf16 v[160:163], a[108:111], v[172:175], v[160:163]
    v_mfma_f32_16x16x32_bf16 v[164:167], a[188:191], v[172:175], v[164:167]
    v_mfma_f32_16x16x32_bf16 v[168:171], v[204:207], v[172:175], v[168:171]
    s_barrier
    ds_read_b64_tr_b16 a[32:33], v12 offset:0
    ds_read_b64_tr_b16 a[34:35], v12 offset:8704
    ds_read_b64_tr_b16 a[36:37], v12 offset:17408
    ds_read_b64_tr_b16 a[38:39], v12 offset:26112
    ds_read_b64_tr_b16 a[112:113], v13 offset:0
    ds_read_b64_tr_b16 a[114:115], v13 offset:8704
    ds_read_b64_tr_b16 a[116:117], v13 offset:17408
    ds_read_b64_tr_b16 a[118:119], v13 offset:26112
    ds_read_b64_tr_b16 a[192:193], v14 offset:0
    ds_read_b64_tr_b16 a[194:195], v14 offset:8704
    ds_read_b64_tr_b16 a[196:197], v14 offset:17408
    ds_read_b64_tr_b16 a[198:199], v14 offset:26112
    ds_read_b64_tr_b16 v[208:209], v15 offset:0
    ds_read_b64_tr_b16 v[210:211], v15 offset:8704
    ds_read_b64_tr_b16 v[212:213], v15 offset:17408
    ds_read_b64_tr_b16 v[214:215], v15 offset:26112
    s_waitcnt vmcnt(16)
    ds_write_b128 v153, v[120:123] offset:34816
    ds_write_b128 v153, v[124:127] offset:39168
    ds_write_b128 v153, v[128:131] offset:43520
    ds_write_b128 v153, v[132:135] offset:47872
    ds_write_b128 v153, v[136:139] offset:52224
    ds_write_b128 v153, v[140:143] offset:56576
    ds_write_b128 v153, v[144:147] offset:60928
    ds_write_b128 v153, v[148:151] offset:65280
    s_waitcnt lgkmcnt(0)
    s_add_u32 s24, s52, 1966080
    buffer_load_dwordx4 v[120:123], v152, s[12:15], s24 offen
    s_add_u32 s24, s24, 30720
    buffer_load_dwordx4 v[124:127], v152, s[12:15], s24 offen
    s_add_u32 s24, s24, 30720
    buffer_load_dwordx4 v[128:131], v152, s[12:15], s24 offen
    s_add_u32 s24, s24, 30720
    buffer_load_dwordx4 v[132:135], v152, s[12:15], s24 offen
    s_add_u32 s24, s24, 30720
    buffer_load_dwordx4 v[136:139], v152, s[12:15], s24 offen
    s_add_u32 s24, s24, 30720
    buffer_load_dwordx4 v[140:143], v152, s[12:15], s24 offen
    s_add_u32 s24, s24, 30720
    buffer_load_dwordx4 v[144:147], v152, s[12:15], s24 offen
    s_add_u32 s24, s24, 30720
    buffer_load_dwordx4 v[148:151], v152, s[12:15], s24 offen
    v_mfma_f32_16x16x32_bf16 v[156:159], a[32:35], v[172:175], v[156:159]
    v_mfma_f32_16x16x32_bf16 v[160:163], a[112:115], v[172:175], v[160:163]
    v_mfma_f32_16x16x32_bf16 v[164:167], a[192:195], v[172:175], v[164:167]
    v_mfma_f32_16x16x32_bf16 v[168:171], v[208:211], v[172:175], v[168:171]
    v_mfma_f32_16x16x32_bf16 v[156:159], a[36:39], v[172:175], v[156:159]
    v_mfma_f32_16x16x32_bf16 v[160:163], a[116:119], v[172:175], v[160:163]
    v_mfma_f32_16x16x32_bf16 v[164:167], a[196:199], v[172:175], v[164:167]
    v_mfma_f32_16x16x32_bf16 v[168:171], v[212:215], v[172:175], v[168:171]
    s_barrier
    ds_read_b64_tr_b16 a[40:41], v12 offset:34816
    ds_read_b64_tr_b16 a[42:43], v12 offset:43520
    ds_read_b64_tr_b16 a[44:45], v12 offset:52224
    ds_read_b64_tr_b16 a[46:47], v12 offset:60928
    ds_read_b64_tr_b16 a[120:121], v13 offset:34816
    ds_read_b64_tr_b16 a[122:123], v13 offset:43520
    ds_read_b64_tr_b16 a[124:125], v13 offset:52224
    ds_read_b64_tr_b16 a[126:127], v13 offset:60928
    ds_read_b64_tr_b16 a[200:201], v14 offset:34816
    ds_read_b64_tr_b16 a[202:203], v14 offset:43520
    ds_read_b64_tr_b16 a[204:205], v14 offset:52224
    ds_read_b64_tr_b16 a[206:207], v14 offset:60928
    ds_read_b64_tr_b16 v[216:217], v15 offset:34816
    ds_read_b64_tr_b16 v[218:219], v15 offset:43520
    ds_read_b64_tr_b16 v[220:221], v15 offset:52224
    ds_read_b64_tr_b16 v[222:223], v15 offset:60928
    s_waitcnt vmcnt(16)
    ds_write_b128 v153, v[56:59] offset:0
    ds_write_b128 v153, v[60:63] offset:4352
    ds_write_b128 v153, v[64:67] offset:8704
    ds_write_b128 v153, v[68:71] offset:13056
    ds_write_b128 v153, v[72:75] offset:17408
    ds_write_b128 v153, v[76:79] offset:21760
    ds_write_b128 v153, v[80:83] offset:26112
    ds_write_b128 v153, v[84:87] offset:30464
    s_waitcnt lgkmcnt(0)
    s_add_u32 s24, s52, 2211840
    buffer_load_dwordx4 v[56:59], v152, s[12:15], s24 offen
    s_add_u32 s24, s24, 30720
    buffer_load_dwordx4 v[60:63], v152, s[12:15], s24 offen
    s_add_u32 s24, s24, 30720
    buffer_load_dwordx4 v[64:67], v152, s[12:15], s24 offen
    s_add_u32 s24, s24, 30720
    buffer_load_dwordx4 v[68:71], v152, s[12:15], s24 offen
    s_add_u32 s24, s24, 30720
    buffer_load_dwordx4 v[72:75], v152, s[12:15], s24 offen
    s_add_u32 s24, s24, 30720
    buffer_load_dwordx4 v[76:79], v152, s[12:15], s24 offen
    s_add_u32 s24, s24, 30720
    buffer_load_dwordx4 v[80:83], v152, s[12:15], s24 offen
    s_add_u32 s24, s24, 30720
    buffer_load_dwordx4 v[84:87], v152, s[12:15], s24 offen
    v_mfma_f32_16x16x32_bf16 v[156:159], a[40:43], v[172:175], v[156:159]
    v_mfma_f32_16x16x32_bf16 v[160:163], a[120:123], v[172:175], v[160:163]
    v_mfma_f32_16x16x32_bf16 v[164:167], a[200:203], v[172:175], v[164:167]
    v_mfma_f32_16x16x32_bf16 v[168:171], v[216:219], v[172:175], v[168:171]
    v_mfma_f32_16x16x32_bf16 v[156:159], a[44:47], v[172:175], v[156:159]
    v_mfma_f32_16x16x32_bf16 v[160:163], a[124:127], v[172:175], v[160:163]
    v_mfma_f32_16x16x32_bf16 v[164:167], a[204:207], v[172:175], v[164:167]
    v_mfma_f32_16x16x32_bf16 v[168:171], v[220:223], v[172:175], v[168:171]
    s_barrier
    ds_read_b64_tr_b16 a[48:49], v12 offset:0
    ds_read_b64_tr_b16 a[50:51], v12 offset:8704
    ds_read_b64_tr_b16 a[52:53], v12 offset:17408
    ds_read_b64_tr_b16 a[54:55], v12 offset:26112
    ds_read_b64_tr_b16 a[128:129], v13 offset:0
    ds_read_b64_tr_b16 a[130:131], v13 offset:8704
    ds_read_b64_tr_b16 a[132:133], v13 offset:17408
    ds_read_b64_tr_b16 a[134:135], v13 offset:26112
    ds_read_b64_tr_b16 a[208:209], v14 offset:0
    ds_read_b64_tr_b16 a[210:211], v14 offset:8704
    ds_read_b64_tr_b16 a[212:213], v14 offset:17408
    ds_read_b64_tr_b16 a[214:215], v14 offset:26112
    ds_read_b64_tr_b16 v[224:225], v15 offset:0
    ds_read_b64_tr_b16 v[226:227], v15 offset:8704
    ds_read_b64_tr_b16 v[228:229], v15 offset:17408
    ds_read_b64_tr_b16 v[230:231], v15 offset:26112
    s_waitcnt vmcnt(16)
    ds_write_b128 v153, v[88:91] offset:34816
    ds_write_b128 v153, v[92:95] offset:39168
    ds_write_b128 v153, v[96:99] offset:43520
    ds_write_b128 v153, v[100:103] offset:47872
    ds_write_b128 v153, v[104:107] offset:52224
    ds_write_b128 v153, v[108:111] offset:56576
    ds_write_b128 v153, v[112:115] offset:60928
    ds_write_b128 v153, v[116:119] offset:65280
    s_waitcnt lgkmcnt(0)
    v_mfma_f32_16x16x32_bf16 v[156:159], a[48:51], v[172:175], v[156:159]
    v_mfma_f32_16x16x32_bf16 v[160:163], a[128:131], v[172:175], v[160:163]
    v_mfma_f32_16x16x32_bf16 v[164:167], a[208:211], v[172:175], v[164:167]
    v_mfma_f32_16x16x32_bf16 v[168:171], v[224:227], v[172:175], v[168:171]
    v_mfma_f32_16x16x32_bf16 v[156:159], a[52:55], v[172:175], v[156:159]
    v_mfma_f32_16x16x32_bf16 v[160:163], a[132:135], v[172:175], v[160:163]
    v_mfma_f32_16x16x32_bf16 v[164:167], a[212:215], v[172:175], v[164:167]
    v_mfma_f32_16x16x32_bf16 v[168:171], v[228:231], v[172:175], v[168:171]
    s_barrier
    ds_read_b64_tr_b16 a[56:57], v12 offset:34816
    ds_read_b64_tr_b16 a[58:59], v12 offset:43520
    ds_read_b64_tr_b16 a[60:61], v12 offset:52224
    ds_read_b64_tr_b16 a[62:63], v12 offset:60928
    ds_read_b64_tr_b16 a[136:137], v13 offset:34816
    ds_read_b64_tr_b16 a[138:139], v13 offset:43520
    ds_read_b64_tr_b16 a[140:141], v13 offset:52224
    ds_read_b64_tr_b16 a[142:143], v13 offset:60928
    ds_read_b64_tr_b16 a[216:217], v14 offset:34816
    ds_read_b64_tr_b16 a[218:219], v14 offset:43520
    ds_read_b64_tr_b16 a[220:221], v14 offset:52224
    ds_read_b64_tr_b16 a[222:223], v14 offset:60928
    ds_read_b64_tr_b16 v[232:233], v15 offset:34816
    ds_read_b64_tr_b16 v[234:235], v15 offset:43520
    ds_read_b64_tr_b16 v[236:237], v15 offset:52224
    ds_read_b64_tr_b16 v[238:239], v15 offset:60928
    s_waitcnt vmcnt(8)
    ds_write_b128 v153, v[120:123] offset:0
    ds_write_b128 v153, v[124:127] offset:4352
    ds_write_b128 v153, v[128:131] offset:8704
    ds_write_b128 v153, v[132:135] offset:13056
    ds_write_b128 v153, v[136:139] offset:17408
    ds_write_b128 v153, v[140:143] offset:21760
    ds_write_b128 v153, v[144:147] offset:26112
    ds_write_b128 v153, v[148:151] offset:30464
    s_waitcnt lgkmcnt(0)
    v_mfma_f32_16x16x32_bf16 v[156:159], a[56:59], v[172:175], v[156:159]
    v_mfma_f32_16x16x32_bf16 v[160:163], a[136:139], v[172:175], v[160:163]
    v_mfma_f32_16x16x32_bf16 v[164:167], a[216:219], v[172:175], v[164:167]
    v_mfma_f32_16x16x32_bf16 v[168:171], v[232:235], v[172:175], v[168:171]
    v_mfma_f32_16x16x32_bf16 v[156:159], a[60:63], v[172:175], v[156:159]
    v_mfma_f32_16x16x32_bf16 v[160:163], a[140:143], v[172:175], v[160:163]
    v_mfma_f32_16x16x32_bf16 v[164:167], a[220:223], v[172:175], v[164:167]
    v_mfma_f32_16x16x32_bf16 v[168:171], v[236:239], v[172:175], v[168:171]
    s_barrier
    ds_read_b64_tr_b16 a[64:65], v12 offset:0
    ds_read_b64_tr_b16 a[66:67], v12 offset:8704
    ds_read_b64_tr_b16 a[68:69], v12 offset:17408
    ds_read_b64_tr_b16 a[70:71], v12 offset:26112
    ds_read_b64_tr_b16 a[144:145], v13 offset:0
    ds_read_b64_tr_b16 a[146:147], v13 offset:8704
    ds_read_b64_tr_b16 a[148:149], v13 offset:17408
    ds_read_b64_tr_b16 a[150:151], v13 offset:26112
    ds_read_b64_tr_b16 a[224:225], v14 offset:0
    ds_read_b64_tr_b16 a[226:227], v14 offset:8704
    ds_read_b64_tr_b16 a[228:229], v14 offset:17408
    ds_read_b64_tr_b16 a[230:231], v14 offset:26112
    ds_read_b64_tr_b16 v[240:241], v15 offset:0
    ds_read_b64_tr_b16 v[242:243], v15 offset:8704
    ds_read_b64_tr_b16 v[244:245], v15 offset:17408
    ds_read_b64_tr_b16 v[246:247], v15 offset:26112
    s_waitcnt vmcnt(0)
    ds_write_b128 v153, v[56:59] offset:34816
    ds_write_b128 v153, v[60:63] offset:39168
    ds_write_b128 v153, v[64:67] offset:43520
    ds_write_b128 v153, v[68:71] offset:47872
    ds_write_b128 v153, v[72:75] offset:52224
    ds_write_b128 v153, v[76:79] offset:56576
    ds_write_b128 v153, v[80:83] offset:60928
    ds_write_b128 v153, v[84:87] offset:65280
    s_waitcnt lgkmcnt(0)
    v_mfma_f32_16x16x32_bf16 v[156:159], a[64:67], v[172:175], v[156:159]
    v_mfma_f32_16x16x32_bf16 v[160:163], a[144:147], v[172:175], v[160:163]
    v_mfma_f32_16x16x32_bf16 v[164:167], a[224:227], v[172:175], v[164:167]
    v_mfma_f32_16x16x32_bf16 v[168:171], v[240:243], v[172:175], v[168:171]
    v_mfma_f32_16x16x32_bf16 v[156:159], a[68:71], v[172:175], v[156:159]
    v_mfma_f32_16x16x32_bf16 v[160:163], a[148:151], v[172:175], v[160:163]
    v_mfma_f32_16x16x32_bf16 v[164:167], a[228:231], v[172:175], v[164:167]
    v_mfma_f32_16x16x32_bf16 v[168:171], v[244:247], v[172:175], v[168:171]
    s_barrier
    ds_read_b64_tr_b16 a[72:73], v12 offset:34816
    ds_read_b64_tr_b16 a[74:75], v12 offset:43520
    ds_read_b64_tr_b16 a[76:77], v12 offset:52224
    ds_read_b64_tr_b16 a[78:79], v12 offset:60928
    ds_read_b64_tr_b16 a[152:153], v13 offset:34816
    ds_read_b64_tr_b16 a[154:155], v13 offset:43520
    ds_read_b64_tr_b16 a[156:157], v13 offset:52224
    ds_read_b64_tr_b16 a[158:159], v13 offset:60928
    ds_read_b64_tr_b16 a[232:233], v14 offset:34816
    ds_read_b64_tr_b16 a[234:235], v14 offset:43520
    ds_read_b64_tr_b16 a[236:237], v14 offset:52224
    ds_read_b64_tr_b16 a[238:239], v14 offset:60928
    ds_read_b64_tr_b16 v[248:249], v15 offset:34816
    ds_read_b64_tr_b16 v[250:251], v15 offset:43520
    ds_read_b64_tr_b16 v[252:253], v15 offset:52224
    ds_read_b64_tr_b16 v[254:255], v15 offset:60928
    s_cmp_eq_u32 s2, 255
    s_cbranch_scc0 interleave_layers__linear_attn_block__memory_aug_recurrent_mem_tr__prompt_kernel_fb2
    s_cmp_eq_u32 s92, 0
    s_cbranch_scc0 interleave_layers__linear_attn_block__memory_aug_recurrent_mem_tr__prompt_kernel_fb2
    s_waitcnt vmcnt(0)
    s_lshl_b32 s24, s3, 9
    s_add_u32 s24, s24, 118423552
    v_mov_b32 v154, 0
    s_lshl_b32 s27, s3, 3
    s_add_u32 s27, s27, 131072
    s_barrier
    s_mov_b32 s25, -1
    s_mov_b64 exec, 1
    v_mov_b32 v155, 0
    s_memtime s[28:29]
    s_waitcnt lgkmcnt(0)
    buffer_atomic_add v155, v154, s[8:11], s24 offen offset:0 sc0
    s_waitcnt vmcnt(0)
    s_memtime s[30:31]
    s_waitcnt lgkmcnt(0)
    s_sub_u32 s30, s30, s28
    s_min_u32 s25, s25, s30
    v_mov_b32 v155, 0
    s_memtime s[28:29]
    s_waitcnt lgkmcnt(0)
    buffer_atomic_add v155, v154, s[8:11], s24 offen offset:128 sc0
    s_waitcnt vmcnt(0)
    s_memtime s[30:31]
    s_waitcnt lgkmcnt(0)
    s_sub_u32 s30, s30, s28
    s_min_u32 s25, s25, s30
    v_mov_b32 v155, 0
    s_memtime s[28:29]
    s_waitcnt lgkmcnt(0)
    buffer_atomic_add v155, v154, s[8:11], s24 offen offset:256 sc0
    s_waitcnt vmcnt(0)
    s_memtime s[30:31]
    s_waitcnt lgkmcnt(0)
    s_sub_u32 s30, s30, s28
    s_min_u32 s25, s25, s30
    v_mov_b32 v148, s27
    v_mov_b32 v155, s25
    ds_write_b32 v148, v155 offset:0
    s_mov_b64 exec, -1
    s_add_u32 s24, s24, 0x2000
    s_barrier
    s_mov_b32 s25, -1
    s_mov_b64 exec, 1
    v_mov_b32 v155, 0
    s_memtime s[28:29]
    s_waitcnt lgkmcnt(0)
    buffer_atomic_add v155, v154, s[8:11], s24 offen offset:0 sc0
    s_waitcnt vmcnt(0)
    s_memtime s[30:31]
    s_waitcnt lgkmcnt(0)
    s_sub_u32 s30, s30, s28
    s_min_u32 s25, s25, s30
    v_mov_b32 v155, 0
    s_memtime s[28:29]
    s_waitcnt lgkmcnt(0)
    buffer_atomic_add v155, v154, s[8:11], s24 offen offset:128 sc0
    s_waitcnt vmcnt(0)
    s_memtime s[30:31]
    s_waitcnt lgkmcnt(0)
    s_sub_u32 s30, s30, s28
    s_min_u32 s25, s25, s30
    v_mov_b32 v155, 0
    s_memtime s[28:29]
    s_waitcnt lgkmcnt(0)
    buffer_atomic_add v155, v154, s[8:11], s24 offen offset:256 sc0
    s_waitcnt vmcnt(0)
    s_memtime s[30:31]
    s_waitcnt lgkmcnt(0)
    s_sub_u32 s30, s30, s28
    s_min_u32 s25, s25, s30
    v_mov_b32 v148, s27
    v_mov_b32 v155, s25
    ds_write_b32 v148, v155 offset:4
    s_mov_b64 exec, -1
    s_add_u32 s24, s24, 0x2000
    s_waitcnt lgkmcnt(0)
    s_barrier
    v_mov_b32 v154, 131072
    ds_read_b128 v[148:151], v154
    ds_read_b128 v[152:155], v154 offset:16
    s_waitcnt lgkmcnt(0)
    v_min_u32 v148, v148, v152
    v_min_u32 v149, v149, v153
    v_min_u32 v150, v150, v154
    v_min_u32 v151, v151, v155
    v_min_u32 v148, v148, v150
    v_min_u32 v149, v149, v151
    v_cmp_lt_u32 vcc, v149, v148
    s_nop 1
    v_cndmask_b32 v155, 1, 2, vcc
    s_cmp_eq_u32 s3, 0
    s_cbranch_scc0 interleave_layers__linear_attn_block__memory_aug_recurrent_mem_tr__prompt_kernel_fb2
    v_mov_b32 v154, 2146435072
    v_cmp_eq_u32 vcc, 0, v1
    s_nop 1
    v_cndmask_b32 v154, v154, 0, vcc
    buffer_store_dword v155, v154, s[72:75], 0 offen sc1
interleave_layers__linear_attn_block__memory_aug_recurrent_mem_tr__prompt_kernel_fb2:
    v_lshlrev_b32 v7, 4, v1
    s_lshr_b32 s24, s3, 1
    s_mul_i32 s24, s24, 20
    s_and_b32 s25, s3, 1
    s_mul_i32 s25, s25, 10
    s_add_u32 s24, s24, s25
    s_lshl_b32 s24, s24, 10
    v_add_u32 v6, s24, v7
    s_lshr_b32 s24, s3, 1
    s_lshl_b32 s24, s24, 8
    s_and_b32 s25, s3, 1
    s_lshl_b32 s25, s25, 3
    s_add_u32 s24, s24, s25
    s_add_u32 s24, s24, 51712
    v_lshlrev_b32 v9, 4, v2
    v_add_u32 v8, s24, v9
    v_add_u32 v9, 51712, v9
    v_mul_u32_u24 v10, 336, v2
    v_lshl_add_u32 v10, v3, 3, v10
    v_add_u32 v10, 40960, v10
    v_lshrrev_b32 v11, 2, v2
    v_lshl_add_u32 v11, v3, 3, v11
    v_mul_u32_u24 v11, 336, v11
    v_and_b32 v15, 3, v2
    v_lshl_add_u32 v11, v15, 3, v11
    s_lshl_b32 s24, s3, 5
    s_add_u32 s24, s24, 40960
    v_add_u32 v11, s24, v11
    s_lshl_b32 s24, s3, 10
    v_add_u32 v12, s24, v7
    v_lshlrev_b32 v15, 3, v1
    v_add_u32 v15, 2048, v15
    s_cmp_eq_u32 s3, 2
    s_cselect_b64 vcc, -1, 0
    v_cndmask_b32 v12, v12, v15, vcc
    s_mul_i32 s24, s44, 2560
    s_add_u32 s24, s24, 12582912
    v_add_u32 v12, s24, v12
    s_mov_b32 s52, 0x3fb8aa3b
    s_mov_b32 s53, s52
    s_mov_b32 s54, 0x358637bd
    s_mov_b32 s55, s54
    v_mov_b32 v120, 0
    v_mov_b32 v121, 0
    v_mov_b32 v122, 0
    v_mov_b32 v123, 0
    v_mov_b32 v124, 0
    v_mov_b32 v125, 0
    v_mov_b32 v126, 0
    v_mov_b32 v127, 0
    v_mov_b32 v128, 0
    v_mov_b32 v129, 0
    v_mov_b32 v130, 0
    v_mov_b32 v131, 0
    v_mov_b32 v132, 0
    v_mov_b32 v133, 0
    v_mov_b32 v134, 0
    v_mov_b32 v135, 0
    v_mov_b32 v136, 0
    v_mov_b32 v137, 0
    v_mov_b32 v138, 0
    v_mov_b32 v139, 0
    v_mov_b32 v140, 0
    v_mov_b32 v141, 0
    v_mov_b32 v142, 0
    v_mov_b32 v143, 0
    s_waitcnt lgkmcnt(0)
    v_mfma_f32_16x16x32_bf16 v[156:159], a[72:75], v[172:175], v[156:159]
    v_mfma_f32_16x16x32_bf16 v[160:163], a[152:155], v[172:175], v[160:163]
    v_mfma_f32_16x16x32_bf16 v[164:167], a[232:235], v[172:175], v[164:167]
    v_mfma_f32_16x16x32_bf16 v[168:171], v[248:251], v[172:175], v[168:171]
    v_mfma_f32_16x16x32_bf16 v[156:159], a[76:79], v[172:175], v[156:159]
    v_mfma_f32_16x16x32_bf16 v[160:163], a[156:159], v[172:175], v[160:163]
    v_mfma_f32_16x16x32_bf16 v[164:167], a[236:239], v[172:175], v[164:167]
    v_mfma_f32_16x16x32_bf16 v[168:171], v[252:255], v[172:175], v[168:171]
    s_mov_b32 s56, 1
interleave_layers__linear_attn_block__memory_aug_recurrent_mem_tr__prompt_kernel_k1_seg:
    s_cmp_eq_u32 s51, 1
    s_cbranch_scc1 interleave_layers__linear_attn_block__memory_aug_recurrent_mem_tr__prompt_kernel_k13
    s_and_b32 s24, s48, 3
    s_lshl_b32 s24, s24, 7
    s_add_u32 s24, s24, 23107584
    v_lshlrev_b32 v15, 2, v1
    v_add_u32 v15, s24, v15
    s_lshr_b32 s95, s48, 2
    s_add_u32 s95, s95, 1
    s_mov_b32 s61, 0
interleave_layers__linear_attn_block__memory_aug_recurrent_mem_tr__prompt_kernel_k1_wx:
    buffer_load_dword v14, v15, s[8:11], 0 offen sc1
    s_waitcnt vmcnt(0)
    v_cmp_le_i32 vcc, s95, v14
    s_mov_b32 s25, 0xfffff
    s_and_b32 s24, vcc_lo, s25
    s_cmp_eq_u32 s24, s25
    s_cbranch_scc1 interleave_layers__linear_attn_block__memory_aug_recurrent_mem_tr__prompt_kernel_k1_wx_ok
    s_add_u32 s61, s61, 1
    s_cmp_ge_u32 s61, s60
    s_cbranch_scc1 interleave_layers__linear_attn_block__memory_aug_recurrent_mem_tr__prompt_kernel_k1_wx_to
    s_sleep 4
    s_branch interleave_layers__linear_attn_block__memory_aug_recurrent_mem_tr__prompt_kernel_k1_wx
interleave_layers__linear_attn_block__memory_aug_recurrent_mem_tr__prompt_kernel_k1_wx_to:
    s_mov_b32 s60, 1
interleave_layers__linear_attn_block__memory_aug_recurrent_mem_tr__prompt_kernel_k1_wx_ok:
    s_mov_b32 s41, s43
    s_mov_b32 s24, s41
    buffer_load_dwordx4 v[16:19], v4, s[16:19], s24 offen sc1
    s_add_u32 s24, s24, s46
    buffer_load_dwordx4 v[20:23], v4, s[16:19], s24 offen sc1
    s_add_u32 s24, s24, s46
    buffer_load_dwordx4 v[24:27], v4, s[16:19], s24 offen sc1
    s_add_u32 s24, s24, s46
    buffer_load_dwordx4 v[28:31], v4, s[16:19], s24 offen sc1
    s_add_u32 s24, s24, s46
    buffer_load_dwordx4 v[32:35], v4, s[16:19], s24 offen sc1
    s_add_u32 s24, s24, s46
    buffer_load_dwordx4 v[36:39], v4, s[16:19], s24 offen sc1
    s_add_u32 s24, s24, s46
    buffer_load_dwordx4 v[40:43], v4, s[16:19], s24 offen sc1
    s_add_u32 s24, s24, s46
    buffer_load_dwordx4 v[44:47], v4, s[16:19], s24 offen sc1
    s_add_u32 s24, s24, s46
    buffer_load_dwordx4 v[48:51], v4, s[16:19], s24 offen sc1
    s_add_u32 s24, s24, s46
    buffer_load_dwordx4 v[52:55], v4, s[16:19], s24 offen sc1
    s_mul_i32 s24, s49, 1
    s_add_u32 s24, s24, s48
    s_and_b32 s24, s24, 3
    s_lshl_b32 s24, s24, 7
    s_add_u32 s24, s24, 23107584
    v_lshlrev_b32 v15, 2, v1
    v_add_u32 v15, s24, v15
    buffer_load_dword v13, v15, s[8:11], 0 offen sc1
interleave_layers__linear_attn_block__memory_aug_recurrent_mem_tr__prompt_kernel_k13:
    s_cmp_eq_u32 s92, 0
    s_cselect_b32 s24, s56, 0
    s_cmp_eq_u32 s24, 1
    s_cbranch_scc1 interleave_layers__linear_attn_block__memory_aug_recurrent_mem_tr__prompt_kernel_k1w4
    s_waitcnt vmcnt(0)
interleave_layers__linear_attn_block__memory_aug_recurrent_mem_tr__prompt_kernel_k1w4:
    s_mov_b32 s56, 0
    v_mov_b32 v148, 0
    v_mov_b32 v149, 0
    v_mov_b32 v150, 0
    v_mov_b32 v151, 0
    v_dot2c_f32_bf16 v148, v16, v172
    v_dot2c_f32_bf16 v149, v16, v16
    v_dot2c_f32_bf16 v150, v17, v172
    v_dot2c_f32_bf16 v151, v17, v17
    v_dot2c_f32_bf16 v148, v18, v172
    v_dot2c_f32_bf16 v149, v18, v18
    v_dot2c_f32_bf16 v150, v19, v172
    v_dot2c_f32_bf16 v151, v19, v19
    v_dot2c_f32_bf16 v148, v20, v172
    v_dot2c_f32_bf16 v149, v20, v20
    v_dot2c_f32_bf16 v150, v21, v172
    v_dot2c_f32_bf16 v151, v21, v21
    v_dot2c_f32_bf16 v148, v22, v172
    v_dot2c_f32_bf16 v149, v22, v22
    v_dot2c_f32_bf16 v150, v23, v172
    v_dot2c_f32_bf16 v151, v23, v23
    v_dot2c_f32_bf16 v148, v24, v172
    v_dot2c_f32_bf16 v149, v24, v24
    v_dot2c_f32_bf16 v150, v25, v172
    v_dot2c_f32_bf16 v151, v25, v25
    v_dot2c_f32_bf16 v148, v26, v172
    v_dot2c_f32_bf16 v149, v26, v26
    v_dot2c_f32_bf16 v150, v27, v172
    v_dot2c_f32_bf16 v151, v27, v27
    v_dot2c_f32_bf16 v148, v28, v172
    v_dot2c_f32_bf16 v149, v28, v28
    v_dot2c_f32_bf16 v150, v29, v172
    v_dot2c_f32_bf16 v151, v29, v29
    v_dot2c_f32_bf16 v148, v30, v172
    v_dot2c_f32_bf16 v149, v30, v30
    v_dot2c_f32_bf16 v150, v31, v172
    v_dot2c_f32_bf16 v151, v31, v31
    v_dot2c_f32_bf16 v148, v32, v172
    v_dot2c_f32_bf16 v149, v32, v32
    v_dot2c_f32_bf16 v150, v33, v172
    v_dot2c_f32_bf16 v151, v33, v33
    v_dot2c_f32_bf16 v148, v34, v172
    v_dot2c_f32_bf16 v149, v34, v34
    v_dot2c_f32_bf16 v150, v35, v172
    v_dot2c_f32_bf16 v151, v35, v35
    v_dot2c_f32_bf16 v148, v36, v172
    v_dot2c_f32_bf16 v149, v36, v36
    v_dot2c_f32_bf16 v150, v37, v172
    v_dot2c_f32_bf16 v151, v37, v37
    v_dot2c_f32_bf16 v148, v38, v172
    v_dot2c_f32_bf16 v149, v38, v38
    v_dot2c_f32_bf16 v150, v39, v172
    v_dot2c_f32_bf16 v151, v39, v39
    v_dot2c_f32_bf16 v148, v40, v172
    v_dot2c_f32_bf16 v149, v40, v40
    v_dot2c_f32_bf16 v150, v41, v172
    v_dot2c_f32_bf16 v151, v41, v41
    v_dot2c_f32_bf16 v148, v42, v172
    v_dot2c_f32_bf16 v149, v42, v42
    v_dot2c_f32_bf16 v150, v43, v172
    v_dot2c_f32_bf16 v151, v43, v43
    v_dot2c_f32_bf16 v148, v44, v172
    v_dot2c_f32_bf16 v149, v44, v44
    v_dot2c_f32_bf16 v150, v45, v172
    v_dot2c_f32_bf16 v151, v45, v45
    v_dot2c_f32_bf16 v148, v46, v172
    v_dot2c_f32_bf16 v149, v46, v46
    v_dot2c_f32_bf16 v150, v47, v172
    v_dot2c_f32_bf16 v151, v47, v47
    v_dot2c_f32_bf16 v148, v48, v172
    v_dot2c_f32_bf16 v149, v48, v48
    v_dot2c_f32_bf16 v150, v49, v172
    v_dot2c_f32_bf16 v151, v49, v49
    v_dot2c_f32_bf16 v148, v50, v172
    v_dot2c_f32_bf16 v149, v50, v50
    v_dot2c_f32_bf16 v150, v51, v172
    v_dot2c_f32_bf16 v151, v51, v51
    v_dot2c_f32_bf16 v148, v52, v172
    v_dot2c_f32_bf16 v149, v52, v52
    v_dot2c_f32_bf16 v150, v53, v172
    v_dot2c_f32_bf16 v151, v53, v53
    v_dot2c_f32_bf16 v148, v54, v172
    v_dot2c_f32_bf16 v149, v54, v54
    v_dot2c_f32_bf16 v150, v55, v172
    v_dot2c_f32_bf16 v151, v55, v55
    s_nop 1
    v_add_f32 v148, v148, v150
    v_add_f32 v149, v149, v151
    v_mov_b32 v150, v148
    v_mov_b32 v151, v149
    s_nop 0
    v_permlane16_swap_b32 v148, v150
    v_permlane16_swap_b32 v149, v151
    v_add_f32 v148, v148, v150
    v_add_f32 v149, v149, v151
    v_mov_b32 v150, v148
    v_mov_b32 v151, v149
    s_nop 0
    v_permlane32_swap_b32 v148, v150
    v_permlane32_swap_b32 v149, v151
    v_add_f32 v148, v148, v150
    v_add_f32 v149, v149, v151
    ds_write_b128 v6, v[16:19] offset:0
    ds_write_b128 v6, v[20:23] offset:1024
    ds_write_b128 v6, v[24:27] offset:2048
    ds_write_b128 v6, v[28:31] offset:3072
    ds_write_b128 v6, v[32:35] offset:4096
    ds_write_b128 v6, v[36:39] offset:5120
    ds_write_b128 v6, v[40:43] offset:6144
    ds_write_b128 v6, v[44:47] offset:7168
    ds_write_b128 v6, v[48:51] offset:8192
    ds_write_b128 v6, v[52:55] offset:9216
    ds_write_b64 v8, v[148:149]
    s_mov_b32 s51, 0
    s_waitcnt lgkmcnt(0)
    s_cmp_gt_u32 s40, 1
    s_cbranch_scc0 interleave_layers__linear_attn_block__memory_aug_recurrent_mem_tr__prompt_kernel_k15
    s_cmp_eq_u32 s92, 0
    s_cbranch_scc1 interleave_layers__linear_attn_block__memory_aug_recurrent_mem_tr__prompt_kernel_k16
    s_add_u32 s24, s48, s49
    s_lshr_b32 s24, s24, 2
    s_add_u32 s24, s24, 1
    v_cmp_le_i32 vcc, s24, v13
    s_and_b32 s24, vcc_lo, 0xfffff
    s_cmp_eq_u32 s24, 0xfffff
    s_cbranch_scc0 interleave_layers__linear_attn_block__memory_aug_recurrent_mem_tr__prompt_kernel_k15
    s_add_u32 s41, s43, s42
    s_mov_b32 s24, s41
    buffer_load_dwordx4 v[16:19], v4, s[16:19], s24 offen sc1
    s_add_u32 s24, s24, s46
    buffer_load_dwordx4 v[20:23], v4, s[16:19], s24 offen sc1
    s_add_u32 s24, s24, s46
    buffer_load_dwordx4 v[24:27], v4, s[16:19], s24 offen sc1
    s_add_u32 s24, s24, s46
    buffer_load_dwordx4 v[28:31], v4, s[16:19], s24 offen sc1
    s_add_u32 s24, s24, s46
    buffer_load_dwordx4 v[32:35], v4, s[16:19], s24 offen sc1
    s_add_u32 s24, s24, s46
    buffer_load_dwordx4 v[36:39], v4, s[16:19], s24 offen sc1
    s_add_u32 s24, s24, s46
    buffer_load_dwordx4 v[40:43], v4, s[16:19], s24 offen sc1
    s_add_u32 s24, s24, s46
    buffer_load_dwordx4 v[44:47], v4, s[16:19], s24 offen sc1
    s_add_u32 s24, s24, s46
    buffer_load_dwordx4 v[48:51], v4, s[16:19], s24 offen sc1
    s_add_u32 s24, s24, s46
    buffer_load_dwordx4 v[52:55], v4, s[16:19], s24 offen sc1
    s_mov_b32 s51, 1
    s_mul_i32 s24, s49, 2
    s_add_u32 s24, s24, s48
    s_and_b32 s24, s24, 3
    s_lshl_b32 s24, s24, 7
    s_add_u32 s24, s24, 23107584
    v_lshlrev_b32 v15, 2, v1
    v_add_u32 v15, s24, v15
    buffer_load_dword v13, v15, s[8:11], 0 offen sc1
    s_branch interleave_layers__linear_attn_block__memory_aug_recurrent_mem_tr__prompt_kernel_k15
interleave_layers__linear_attn_block__memory_aug_recurrent_mem_tr__prompt_kernel_k16:
    s_add_u32 s41, s43, s42
    s_mov_b32 s24, s41
    buffer_load_dwordx2 v[16:17], v4, s[16:19], s24 offen
    buffer_load_dwordx2 v[18:19], v5, s[16:19], s24 offen
    s_add_u32 s24, s24, s46
    buffer_load_dwordx2 v[20:21], v4, s[16:19], s24 offen
    buffer_load_dwordx2 v[22:23], v5, s[16:19], s24 offen
    s_add_u32 s24, s24, s46
    buffer_load_dwordx2 v[24:25], v4, s[16:19], s24 offen
    buffer_load_dwordx2 v[26:27], v5, s[16:19], s24 offen
    s_add_u32 s24, s24, s46
    buffer_load_dwordx2 v[28:29], v4, s[16:19], s24 offen
    buffer_load_dwordx2 v[30:31], v5, s[16:19], s24 offen
    s_add_u32 s24, s24, s46
    buffer_load_dwordx2 v[32:33], v4, s[16:19], s24 offen
    buffer_load_dwordx2 v[34:35], v5, s[16:19], s24 offen
    s_add_u32 s24, s24, s46
    buffer_load_dwordx2 v[36:37], v4, s[16:19], s24 offen
    buffer_load_dwordx2 v[38:39], v5, s[16:19], s24 offen
    s_add_u32 s24, s24, s46
    buffer_load_dwordx2 v[40:41], v4, s[16:19], s24 offen
    buffer_load_dwordx2 v[42:43], v5, s[16:19], s24 offen
    s_add_u32 s24, s24, s46
    buffer_load_dwordx2 v[44:45], v4, s[16:19], s24 offen
    buffer_load_dwordx2 v[46:47], v5, s[16:19], s24 offen
    s_add_u32 s24, s24, s46
    buffer_load_dwordx2 v[48:49], v4, s[16:19], s24 offen
    buffer_load_dwordx2 v[50:51], v5, s[16:19], s24 offen
    s_add_u32 s24, s24, s46
    buffer_load_dwordx2 v[52:53], v4, s[16:19], s24 offen
    buffer_load_dwordx2 v[54:55], v5, s[16:19], s24 offen
    s_mov_b32 s51, 1
interleave_layers__linear_attn_block__memory_aug_recurrent_mem_tr__prompt_kernel_k15:
    s_barrier
    ds_read_b128 v[148:151], v9
    ds_read_b128 v[152:155], v9 offset:256
    ds_read_b128 v[56:59], v7 offset:0
    ds_read_b128 v[60:63], v7 offset:20480
    ds_read_b128 v[64:67], v7 offset:1024
    ds_read_b128 v[68:71], v7 offset:21504
    ds_read_b128 v[72:75], v7 offset:2048
    ds_read_b128 v[76:79], v7 offset:22528
    s_waitcnt lgkmcnt(6)
    v_add_f32 v148, v148, v150
    v_add_f32 v149, v149, v151
    v_mul_f32 v148, 0x3acccccd, v148
    v_mul_f32 v150, v148, v148
    v_mov_b32 v151, 0x3acccccd
    v_fma_f32 v149, v149, v151, -v150
    v_max_f32 v149, 0, v149
    v_add_f32 v149, 0x3727c5ac, v149
    v_rsq_f32 v144, v149
    s_nop 0
    v_mul_f32 v145, v148, v144
    v_sub_f32 v145, 0, v145
    v_add_f32 v152, v152, v154
    v_add_f32 v153, v153, v155
    v_mul_f32 v152, 0x3acccccd, v152
    v_mul_f32 v154, v152, v152
    v_mov_b32 v155, 0x3acccccd
    v_fma_f32 v153, v153, v155, -v154
    v_max_f32 v153, 0, v153
    v_add_f32 v153, 0x3727c5ac, v153
    v_rsq_f32 v146, v153
    s_nop 0
    v_mul_f32 v147, v152, v146
    v_sub_f32 v147, 0, v147
    ds_read_b128 v[80:83], v7 offset:3072
    ds_read_b128 v[84:87], v7 offset:23552
    s_waitcnt lgkmcnt(6)
    v_mfma_f32_16x16x32_bf16 v[88:91], a[0:3], v[56:59], 0
    v_mfma_f32_16x16x32_bf16 v[96:99], a[80:83], v[56:59], 0
    v_mfma_f32_16x16x32_bf16 v[104:107], a[160:163], v[56:59], 0
    v_mfma_f32_16x16x32_bf16 v[112:115], v[176:179], v[56:59], 0
    v_mfma_f32_16x16x32_bf16 v[92:95], a[0:3], v[60:63], 0
    v_mfma_f32_16x16x32_bf16 v[100:103], a[80:83], v[60:63], 0
    v_mfma_f32_16x16x32_bf16 v[108:111], a[160:163], v[60:63], 0
    v_mfma_f32_16x16x32_bf16 v[116:119], v[176:179], v[60:63], 0
    ds_read_b128 v[56:59], v7 offset:4096
    ds_read_b128 v[60:63], v7 offset:24576
    s_waitcnt lgkmcnt(6)
    v_mfma_f32_16x16x32_bf16 v[88:91], a[4:7], v[64:67], v[88:91]
    v_mfma_f32_16x16x32_bf16 v[96:99], a[84:87], v[64:67], v[96:99]
    v_mfma_f32_16x16x32_bf16 v[104:107], a[164:167], v[64:67], v[104:107]
    v_mfma_f32_16x16x32_bf16 v[112:115], v[180:183], v[64:67], v[112:115]
    v_mfma_f32_16x16x32_bf16 v[92:95], a[4:7], v[68:71], v[92:95]
    v_mfma_f32_16x16x32_bf16 v[100:103], a[84:87], v[68:71], v[100:103]
    v_mfma_f32_16x16x32_bf16 v[108:111], a[164:167], v[68:71], v[108:111]
    v_mfma_f32_16x16x32_bf16 v[116:119], v[180:183], v[68:71], v[116:119]
    ds_read_b128 v[64:67], v7 offset:5120
    ds_read_b128 v[68:71], v7 offset:25600
    s_waitcnt lgkmcnt(6)
    v_mfma_f32_16x16x32_bf16 v[88:91], a[8:11], v[72:75], v[88:91]
    v_mfma_f32_16x16x32_bf16 v[96:99], a[88:91], v[72:75], v[96:99]
    v_mfma_f32_16x16x32_bf16 v[104:107], a[168:171], v[72:75], v[104:107]
    v_mfma_f32_16x16x32_bf16 v[112:115], v[184:187], v[72:75], v[112:115]
    v_mfma_f32_16x16x32_bf16 v[92:95], a[8:11], v[76:79], v[92:95]
    v_mfma_f32_16x16x32_bf16 v[100:103], a[88:91], v[76:79], v[100:103]
    v_mfma_f32_16x16x32_bf16 v[108:111], a[168:171], v[76:79], v[108:111]
    v_mfma_f32_16x16x32_bf16 v[116:119], v[184:187], v[76:79], v[116:119]
    ds_read_b128 v[72:75], v7 offset:6144
    ds_read_b128 v[76:79], v7 offset:26624
    s_waitcnt lgkmcnt(6)
    v_mfma_f32_16x16x32_bf16 v[88:91], a[12:15], v[80:83], v[88:91]
    v_mfma_f32_16x16x32_bf16 v[96:99], a[92:95], v[80:83], v[96:99]
    v_mfma_f32_16x16x32_bf16 v[104:107], a[172:175], v[80:83], v[104:107]
    v_mfma_f32_16x16x32_bf16 v[112:115], v[188:191], v[80:83], v[112:115]
    v_mfma_f32_16x16x32_bf16 v[92:95], a[12:15], v[84:87], v[92:95]
    v_mfma_f32_16x16x32_bf16 v[100:103], a[92:95], v[84:87], v[100:103]
    v_mfma_f32_16x16x32_bf16 v[108:111], a[172:175], v[84:87], v[108:111]
    v_mfma_f32_16x16x32_bf16 v[116:119], v[188:191], v[84:87], v[116:119]
    ds_read_b128 v[80:83], v7 offset:7168
    ds_read_b128 v[84:87], v7 offset:27648
    s_waitcnt lgkmcnt(6)
    v_mfma_f32_16x16x32_bf16 v[88:91], a[16:19], v[56:59], v[88:91]
    v_mfma_f32_16x16x32_bf16 v[96:99], a[96:99], v[56:59], v[96:99]
    v_mfma_f32_16x16x32_bf16 v[104:107], a[176:179], v[56:59], v[104:107]
    v_mfma_f32_16x16x32_bf16 v[112:115], v[192:195], v[56:59], v[112:115]
    v_mfma_f32_16x16x32_bf16 v[92:95], a[16:19], v[60:63], v[92:95]
    v_mfma_f32_16x16x32_bf16 v[100:103], a[96:99], v[60:63], v[100:103]
    v_mfma_f32_16x16x32_bf16 v[108:111], a[176:179], v[60:63], v[108:111]
    v_mfma_f32_16x16x32_bf16 v[116:119], v[192:195], v[60:63], v[116:119]
    ds_read_b128 v[56:59], v7 offset:8192
    ds_read_b128 v[60:63], v7 offset:28672
    s_waitcnt lgkmcnt(6)
    v_mfma_f32_16x16x32_bf16 v[88:91], a[20:23], v[64:67], v[88:91]
    v_mfma_f32_16x16x32_bf16 v[96:99], a[100:103], v[64:67], v[96:99]
    v_mfma_f32_16x16x32_bf16 v[104:107], a[180:183], v[64:67], v[104:107]
    v_mfma_f32_16x16x32_bf16 v[112:115], v[196:199], v[64:67], v[112:115]
    v_mfma_f32_16x16x32_bf16 v[92:95], a[20:23], v[68:71], v[92:95]
    v_mfma_f32_16x16x32_bf16 v[100:103], a[100:103], v[68:71], v[100:103]
    v_mfma_f32_16x16x32_bf16 v[108:111], a[180:183], v[68:71], v[108:111]
    v_mfma_f32_16x16x32_bf16 v[116:119], v[196:199], v[68:71], v[116:119]
    ds_read_b128 v[64:67], v7 offset:9216
    ds_read_b128 v[68:71], v7 offset:29696
    s_waitcnt lgkmcnt(6)
    v_mfma_f32_16x16x32_bf16 v[88:91], a[24:27], v[72:75], v[88:91]
    v_mfma_f32_16x16x32_bf16 v[96:99], a[104:107], v[72:75], v[96:99]
    v_mfma_f32_16x16x32_bf16 v[104:107], a[184:187], v[72:75], v[104:107]
    v_mfma_f32_16x16x32_bf16 v[112:115], v[200:203], v[72:75], v[112:115]
    v_mfma_f32_16x16x32_bf16 v[92:95], a[24:27], v[76:79], v[92:95]
    v_mfma_f32_16x16x32_bf16 v[100:103], a[104:107], v[76:79], v[100:103]
    v_mfma_f32_16x16x32_bf16 v[108:111], a[184:187], v[76:79], v[108:111]
    v_mfma_f32_16x16x32_bf16 v[116:119], v[200:203], v[76:79], v[116:119]
    ds_read_b128 v[72:75], v7 offset:10240
    ds_read_b128 v[76:79], v7 offset:30720
    s_waitcnt lgkmcnt(6)
    v_mfma_f32_16x16x32_bf16 v[88:91], a[28:31], v[80:83], v[88:91]
    v_mfma_f32_16x16x32_bf16 v[96:99], a[108:111], v[80:83], v[96:99]
    v_mfma_f32_16x16x32_bf16 v[104:107], a[188:191], v[80:83], v[104:107]
    v_mfma_f32_16x16x32_bf16 v[112:115], v[204:207], v[80:83], v[112:115]
    v_mfma_f32_16x16x32_bf16 v[92:95], a[28:31], v[84:87], v[92:95]
    v_mfma_f32_16x16x32_bf16 v[100:103], a[108:111], v[84:87], v[100:103]
    v_mfma_f32_16x16x32_bf16 v[108:111], a[188:191], v[84:87], v[108:111]
    v_mfma_f32_16x16x32_bf16 v[116:119], v[204:207], v[84:87], v[116:119]
    ds_read_b128 v[80:83], v7 offset:11264
    ds_read_b128 v[84:87], v7 offset:31744
    s_waitcnt lgkmcnt(6)
    v_mfma_f32_16x16x32_bf16 v[88:91], a[32:35], v[56:59], v[88:91]
    v_mfma_f32_16x16x32_bf16 v[96:99], a[112:115], v[56:59], v[96:99]
    v_mfma_f32_16x16x32_bf16 v[104:107], a[192:195], v[56:59], v[104:107]
    v_mfma_f32_16x16x32_bf16 v[112:115], v[208:211], v[56:59], v[112:115]
    v_mfma_f32_16x16x32_bf16 v[92:95], a[32:35], v[60:63], v[92:95]
    v_mfma_f32_16x16x32_bf16 v[100:103], a[112:115], v[60:63], v[100:103]
    v_mfma_f32_16x16x32_bf16 v[108:111], a[192:195], v[60:63], v[108:111]
    v_mfma_f32_16x16x32_bf16 v[116:119], v[208:211], v[60:63], v[116:119]
    ds_read_b128 v[56:59], v7 offset:12288
    ds_read_b128 v[60:63], v7 offset:32768
    s_waitcnt lgkmcnt(6)
    v_mfma_f32_16x16x32_bf16 v[88:91], a[36:39], v[64:67], v[88:91]
    v_mfma_f32_16x16x32_bf16 v[96:99], a[116:119], v[64:67], v[96:99]
    v_mfma_f32_16x16x32_bf16 v[104:107], a[196:199], v[64:67], v[104:107]
    v_mfma_f32_16x16x32_bf16 v[112:115], v[212:215], v[64:67], v[112:115]
    v_mfma_f32_16x16x32_bf16 v[92:95], a[36:39], v[68:71], v[92:95]
    v_mfma_f32_16x16x32_bf16 v[100:103], a[116:119], v[68:71], v[100:103]
    v_mfma_f32_16x16x32_bf16 v[108:111], a[196:199], v[68:71], v[108:111]
    v_mfma_f32_16x16x32_bf16 v[116:119], v[212:215], v[68:71], v[116:119]
    ds_read_b128 v[64:67], v7 offset:13312
    ds_read_b128 v[68:71], v7 offset:33792
    s_waitcnt lgkmcnt(6)
    v_mfma_f32_16x16x32_bf16 v[88:91], a[40:43], v[72:75], v[88:91]
    v_mfma_f32_16x16x32_bf16 v[96:99], a[120:123], v[72:75], v[96:99]
    v_mfma_f32_16x16x32_bf16 v[104:107], a[200:203], v[72:75], v[104:107]
    v_mfma_f32_16x16x32_bf16 v[112:115], v[216:219], v[72:75], v[112:115]
    v_mfma_f32_16x16x32_bf16 v[92:95], a[40:43], v[76:79], v[92:95]
    v_mfma_f32_16x16x32_bf16 v[100:103], a[120:123], v[76:79], v[100:103]
    v_mfma_f32_16x16x32_bf16 v[108:111], a[200:203], v[76:79], v[108:111]
    v_mfma_f32_16x16x32_bf16 v[116:119], v[216:219], v[76:79], v[116:119]
    ds_read_b128 v[72:75], v7 offset:14336
    ds_read_b128 v[76:79], v7 offset:34816
    s_waitcnt lgkmcnt(6)
    v_mfma_f32_16x16x32_bf16 v[88:91], a[44:47], v[80:83], v[88:91]
    v_mfma_f32_16x16x32_bf16 v[96:99], a[124:127], v[80:83], v[96:99]
    v_mfma_f32_16x16x32_bf16 v[104:107], a[204:207], v[80:83], v[104:107]
    v_mfma_f32_16x16x32_bf16 v[112:115], v[220:223], v[80:83], v[112:115]
    v_mfma_f32_16x16x32_bf16 v[92:95], a[44:47], v[84:87], v[92:95]
    v_mfma_f32_16x16x32_bf16 v[100:103], a[124:127], v[84:87], v[100:103]
    v_mfma_f32_16x16x32_bf16 v[108:111], a[204:207], v[84:87], v[108:111]
    v_mfma_f32_16x16x32_bf16 v[116:119], v[220:223], v[84:87], v[116:119]
    ds_read_b128 v[80:83], v7 offset:15360
    ds_read_b128 v[84:87], v7 offset:35840
    s_waitcnt lgkmcnt(6)
    v_mfma_f32_16x16x32_bf16 v[88:91], a[48:51], v[56:59], v[88:91]
    v_mfma_f32_16x16x32_bf16 v[96:99], a[128:131], v[56:59], v[96:99]
    v_mfma_f32_16x16x32_bf16 v[104:107], a[208:211], v[56:59], v[104:107]
    v_mfma_f32_16x16x32_bf16 v[112:115], v[224:227], v[56:59], v[112:115]
    v_mfma_f32_16x16x32_bf16 v[92:95], a[48:51], v[60:63], v[92:95]
    v_mfma_f32_16x16x32_bf16 v[100:103], a[128:131], v[60:63], v[100:103]
    v_mfma_f32_16x16x32_bf16 v[108:111], a[208:211], v[60:63], v[108:111]
    v_mfma_f32_16x16x32_bf16 v[116:119], v[224:227], v[60:63], v[116:119]
    ds_read_b128 v[56:59], v7 offset:16384
    ds_read_b128 v[60:63], v7 offset:36864
    s_waitcnt lgkmcnt(6)
    v_mfma_f32_16x16x32_bf16 v[88:91], a[52:55], v[64:67], v[88:91]
    v_mfma_f32_16x16x32_bf16 v[96:99], a[132:135], v[64:67], v[96:99]
    v_mfma_f32_16x16x32_bf16 v[104:107], a[212:215], v[64:67], v[104:107]
    v_mfma_f32_16x16x32_bf16 v[112:115], v[228:231], v[64:67], v[112:115]
    v_mfma_f32_16x16x32_bf16 v[92:95], a[52:55], v[68:71], v[92:95]
    v_mfma_f32_16x16x32_bf16 v[100:103], a[132:135], v[68:71], v[100:103]
    v_mfma_f32_16x16x32_bf16 v[108:111], a[212:215], v[68:71], v[108:111]
    v_mfma_f32_16x16x32_bf16 v[116:119], v[228:231], v[68:71], v[116:119]
    ds_read_b128 v[64:67], v7 offset:17408
    ds_read_b128 v[68:71], v7 offset:37888
    s_waitcnt lgkmcnt(6)
    v_mfma_f32_16x16x32_bf16 v[88:91], a[56:59], v[72:75], v[88:91]
    v_mfma_f32_16x16x32_bf16 v[96:99], a[136:139], v[72:75], v[96:99]
    v_mfma_f32_16x16x32_bf16 v[104:107], a[216:219], v[72:75], v[104:107]
    v_mfma_f32_16x16x32_bf16 v[112:115], v[232:235], v[72:75], v[112:115]
    v_mfma_f32_16x16x32_bf16 v[92:95], a[56:59], v[76:79], v[92:95]
    v_mfma_f32_16x16x32_bf16 v[100:103], a[136:139], v[76:79], v[100:103]
    v_mfma_f32_16x16x32_bf16 v[108:111], a[216:219], v[76:79], v[108:111]
    v_mfma_f32_16x16x32_bf16 v[116:119], v[232:235], v[76:79], v[116:119]
    ds_read_b128 v[72:75], v7 offset:18432
    ds_read_b128 v[76:79], v7 offset:38912
    s_waitcnt lgkmcnt(6)
    v_mfma_f32_16x16x32_bf16 v[88:91], a[60:63], v[80:83], v[88:91]
    v_mfma_f32_16x16x32_bf16 v[96:99], a[140:143], v[80:83], v[96:99]
    v_mfma_f32_16x16x32_bf16 v[104:107], a[220:223], v[80:83], v[104:107]
    v_mfma_f32_16x16x32_bf16 v[112:115], v[236:239], v[80:83], v[112:115]
    v_mfma_f32_16x16x32_bf16 v[92:95], a[60:63], v[84:87], v[92:95]
    v_mfma_f32_16x16x32_bf16 v[100:103], a[140:143], v[84:87], v[100:103]
    v_mfma_f32_16x16x32_bf16 v[108:111], a[220:223], v[84:87], v[108:111]
    v_mfma_f32_16x16x32_bf16 v[116:119], v[236:239], v[84:87], v[116:119]
    ds_read_b128 v[80:83], v7 offset:19456
    ds_read_b128 v[84:87], v7 offset:39936
    s_waitcnt lgkmcnt(6)
    v_mfma_f32_16x16x32_bf16 v[88:91], a[64:67], v[56:59], v[88:91]
    v_mfma_f32_16x16x32_bf16 v[96:99], a[144:147], v[56:59], v[96:99]
    v_mfma_f32_16x16x32_bf16 v[104:107], a[224:227], v[56:59], v[104:107]
    v_mfma_f32_16x16x32_bf16 v[112:115], v[240:243], v[56:59], v[112:115]
    v_mfma_f32_16x16x32_bf16 v[92:95], a[64:67], v[60:63], v[92:95]
    v_mfma_f32_16x16x32_bf16 v[100:103], a[144:147], v[60:63], v[100:103]
    v_mfma_f32_16x16x32_bf16 v[108:111], a[224:227], v[60:63], v[108:111]
    v_mfma_f32_16x16x32_bf16 v[116:119], v[240:243], v[60:63], v[116:119]
    s_waitcnt lgkmcnt(4)
    v_mfma_f32_16x16x32_bf16 v[88:91], a[68:71], v[64:67], v[88:91]
    v_mfma_f32_16x16x32_bf16 v[96:99], a[148:151], v[64:67], v[96:99]
    v_mfma_f32_16x16x32_bf16 v[104:107], a[228:231], v[64:67], v[104:107]
    v_mfma_f32_16x16x32_bf16 v[112:115], v[244:247], v[64:67], v[112:115]
    v_mfma_f32_16x16x32_bf16 v[92:95], a[68:71], v[68:71], v[92:95]
    v_mfma_f32_16x16x32_bf16 v[100:103], a[148:151], v[68:71], v[100:103]
    v_mfma_f32_16x16x32_bf16 v[108:111], a[228:231], v[68:71], v[108:111]
    v_mfma_f32_16x16x32_bf16 v[116:119], v[244:247], v[68:71], v[116:119]
    s_waitcnt lgkmcnt(2)
    v_mfma_f32_16x16x32_bf16 v[88:91], a[72:75], v[72:75], v[88:91]
    v_mfma_f32_16x16x32_bf16 v[96:99], a[152:155], v[72:75], v[96:99]
    v_mfma_f32_16x16x32_bf16 v[104:107], a[232:235], v[72:75], v[104:107]
    v_mfma_f32_16x16x32_bf16 v[112:115], v[248:251], v[72:75], v[112:115]
    v_mfma_f32_16x16x32_bf16 v[92:95], a[72:75], v[76:79], v[92:95]
    v_mfma_f32_16x16x32_bf16 v[100:103], a[152:155], v[76:79], v[100:103]
    v_mfma_f32_16x16x32_bf16 v[108:111], a[232:235], v[76:79], v[108:111]
    v_mfma_f32_16x16x32_bf16 v[116:119], v[248:251], v[76:79], v[116:119]
    s_waitcnt lgkmcnt(0)
    v_mfma_f32_16x16x32_bf16 v[88:91], a[76:79], v[80:83], v[88:91]
    v_mfma_f32_16x16x32_bf16 v[96:99], a[156:159], v[80:83], v[96:99]
    v_mfma_f32_16x16x32_bf16 v[104:107], a[236:239], v[80:83], v[104:107]
    v_mfma_f32_16x16x32_bf16 v[112:115], v[252:255], v[80:83], v[112:115]
    v_mfma_f32_16x16x32_bf16 v[92:95], a[76:79], v[84:87], v[92:95]
    v_mfma_f32_16x16x32_bf16 v[100:103], a[156:159], v[84:87], v[100:103]
    v_mfma_f32_16x16x32_bf16 v[108:111], a[236:239], v[84:87], v[108:111]
    v_mfma_f32_16x16x32_bf16 v[116:119], v[252:255], v[84:87], v[116:119]
    v_pk_mul_f32 v[148:149], v[156:157], v[144:145] op_sel:[0,1] op_sel_hi:[1,1]
    v_pk_mul_f32 v[150:151], v[158:159], v[144:145] op_sel:[0,1] op_sel_hi:[1,1]
    v_pk_fma_f32 v[88:89], v[88:89], v[144:145], v[148:149] op_sel:[0,0,0] op_sel_hi:[1,0,1]
    v_pk_fma_f32 v[90:91], v[90:91], v[144:145], v[150:151] op_sel:[0,0,0] op_sel_hi:[1,0,1]
    v_pk_mul_f32 v[148:149], v[156:157], v[146:147] op_sel:[0,1] op_sel_hi:[1,1]
    v_pk_mul_f32 v[150:151], v[158:159], v[146:147] op_sel:[0,1] op_sel_hi:[1,1]
    v_pk_fma_f32 v[92:93], v[92:93], v[146:147], v[148:149] op_sel:[0,0,0] op_sel_hi:[1,0,1]
    v_pk_fma_f32 v[94:95], v[94:95], v[146:147], v[150:151] op_sel:[0,0,0] op_sel_hi:[1,0,1]
    v_pk_mul_f32 v[148:149], v[160:161], v[144:145] op_sel:[0,1] op_sel_hi:[1,1]
    v_pk_mul_f32 v[150:151], v[162:163], v[144:145] op_sel:[0,1] op_sel_hi:[1,1]
    v_pk_fma_f32 v[96:97], v[96:97], v[144:145], v[148:149] op_sel:[0,0,0] op_sel_hi:[1,0,1]
    v_pk_fma_f32 v[98:99], v[98:99], v[144:145], v[150:151] op_sel:[0,0,0] op_sel_hi:[1,0,1]
    v_pk_mul_f32 v[148:149], v[160:161], v[146:147] op_sel:[0,1] op_sel_hi:[1,1]
    v_pk_mul_f32 v[150:151], v[162:163], v[146:147] op_sel:[0,1] op_sel_hi:[1,1]
    v_pk_fma_f32 v[100:101], v[100:101], v[146:147], v[148:149] op_sel:[0,0,0] op_sel_hi:[1,0,1]
    v_pk_fma_f32 v[102:103], v[102:103], v[146:147], v[150:151] op_sel:[0,0,0] op_sel_hi:[1,0,1]
    v_pk_mul_f32 v[148:149], v[164:165], v[144:145] op_sel:[0,1] op_sel_hi:[1,1]
    v_pk_mul_f32 v[150:151], v[166:167], v[144:145] op_sel:[0,1] op_sel_hi:[1,1]
    v_pk_fma_f32 v[104:105], v[104:105], v[144:145], v[148:149] op_sel:[0,0,0] op_sel_hi:[1,0,1]
    v_pk_fma_f32 v[106:107], v[106:107], v[144:145], v[150:151] op_sel:[0,0,0] op_sel_hi:[1,0,1]
    v_pk_mul_f32 v[148:149], v[164:165], v[146:147] op_sel:[0,1] op_sel_hi:[1,1]
    v_pk_mul_f32 v[150:151], v[166:167], v[146:147] op_sel:[0,1] op_sel_hi:[1,1]
    v_pk_fma_f32 v[108:109], v[108:109], v[146:147], v[148:149] op_sel:[0,0,0] op_sel_hi:[1,0,1]
    v_pk_fma_f32 v[110:111], v[110:111], v[146:147], v[150:151] op_sel:[0,0,0] op_sel_hi:[1,0,1]
    v_pk_mul_f32 v[148:149], v[168:169], v[144:145] op_sel:[0,1] op_sel_hi:[1,1]
    v_pk_mul_f32 v[150:151], v[170:171], v[144:145] op_sel:[0,1] op_sel_hi:[1,1]
    v_pk_fma_f32 v[112:113], v[112:113], v[144:145], v[148:149] op_sel:[0,0,0] op_sel_hi:[1,0,1]
    v_pk_fma_f32 v[114:115], v[114:115], v[144:145], v[150:151] op_sel:[0,0,0] op_sel_hi:[1,0,1]
    v_pk_mul_f32 v[148:149], v[168:169], v[146:147] op_sel:[0,1] op_sel_hi:[1,1]
    v_pk_mul_f32 v[150:151], v[170:171], v[146:147] op_sel:[0,1] op_sel_hi:[1,1]
    v_pk_fma_f32 v[116:117], v[116:117], v[146:147], v[148:149] op_sel:[0,0,0] op_sel_hi:[1,0,1]
    v_pk_fma_f32 v[118:119], v[118:119], v[146:147], v[150:151] op_sel:[0,0,0] op_sel_hi:[1,0,1]
    s_add_u32 s25, s43, 20480
    s_cmp_ge_u32 s3, 2
    s_cbranch_scc1 interleave_layers__linear_attn_block__memory_aug_recurrent_mem_tr__prompt_kernel_k1_e2
    s_lshl_b32 s24, s3, 6
    v_add_u32 v15, s24, v10
    v_cvt_pk_bf16_f32 v64, v104, v105
    v_cvt_pk_bf16_f32 v65, v106, v107
    ds_write_b64 v15, v[64:65] offset:160
    v_cvt_pk_bf16_f32 v66, v108, v109
    v_cvt_pk_bf16_f32 v67, v110, v111
    ds_write_b64 v15, v[66:67] offset:5536
    v_cvt_pk_bf16_f32 v68, v112, v113
    v_cvt_pk_bf16_f32 v69, v114, v115
    ds_write_b64 v15, v[68:69] offset:192
    v_cvt_pk_bf16_f32 v70, v116, v117
    v_cvt_pk_bf16_f32 v71, v118, v119
    ds_write_b64 v15, v[70:71] offset:5568
    v_min_f32 v148, 0, v88
    v_min_f32 v149, 0, v89
    v_pk_mul_f32 v[148:149], v[148:149], s[52:53]
    v_min_f32 v150, 0, v90
    v_min_f32 v151, 0, v91
    v_pk_mul_f32 v[150:151], v[150:151], s[52:53]
    v_exp_f32 v148, v148
    v_exp_f32 v149, v149
    v_exp_f32 v150, v150
    v_exp_f32 v151, v151
    v_max_f32 v88, 0, v88
    v_max_f32 v89, 0, v89
    v_max_f32 v90, 0, v90
    v_max_f32 v91, 0, v91
    v_pk_add_f32 v[88:89], v[88:89], v[148:149]
    v_pk_add_f32 v[90:91], v[90:91], v[150:151]
    v_pk_add_f32 v[88:89], v[88:89], s[54:55]
    v_pk_add_f32 v[90:91], v[90:91], s[54:55]
    v_min_f32 v148, 0, v96
    v_min_f32 v149, 0, v97
    v_pk_mul_f32 v[148:149], v[148:149], s[52:53]
    v_min_f32 v150, 0, v98
    v_min_f32 v151, 0, v99
    v_pk_mul_f32 v[150:151], v[150:151], s[52:53]
    v_exp_f32 v148, v148
    v_exp_f32 v149, v149
    v_exp_f32 v150, v150
    v_exp_f32 v151, v151
    v_max_f32 v96, 0, v96
    v_max_f32 v97, 0, v97
    v_max_f32 v98, 0, v98
    v_max_f32 v99, 0, v99
    v_pk_add_f32 v[96:97], v[96:97], v[148:149]
    v_pk_add_f32 v[98:99], v[98:99], v[150:151]
    v_pk_add_f32 v[96:97], v[96:97], s[54:55]
    v_pk_add_f32 v[98:99], v[98:99], s[54:55]
    v_cvt_pk_bf16_f32 v56, v88, v89
    v_cvt_pk_bf16_f32 v57, v90, v91
    v_cvt_pk_bf16_f32 v58, v96, v97
    v_cvt_pk_bf16_f32 v59, v98, v99
    buffer_store_dwordx4 v[56:59], v12, s[8:11], s43 offen sc1
    v_min_f32 v148, 0, v92
    v_min_f32 v149, 0, v93
    v_pk_mul_f32 v[148:149], v[148:149], s[52:53]
    v_min_f32 v150, 0, v94
    v_min_f32 v151, 0, v95
    v_pk_mul_f32 v[150:151], v[150:151], s[52:53]
    v_exp_f32 v148, v148
    v_exp_f32 v149, v149
    v_exp_f32 v150, v150
    v_exp_f32 v151, v151
    v_max_f32 v92, 0, v92
    v_max_f32 v93, 0, v93
    v_max_f32 v94, 0, v94
    v_max_f32 v95, 0, v95
    v_pk_add_f32 v[92:93], v[92:93], v[148:149]
    v_pk_add_f32 v[94:95], v[94:95], v[150:151]
    v_pk_add_f32 v[92:93], v[92:93], s[54:55]
    v_pk_add_f32 v[94:95], v[94:95], s[54:55]
    v_min_f32 v148, 0, v100
    v_min_f32 v149, 0, v101
    v_pk_mul_f32 v[148:149], v[148:149], s[52:53]
    v_min_f32 v150, 0, v102
    v_min_f32 v151, 0, v103
    v_pk_mul_f32 v[150:151], v[150:151], s[52:53]
    v_exp_f32 v148, v148
    v_exp_f32 v149, v149
    v_exp_f32 v150, v150
    v_exp_f32 v151, v151
    v_max_f32 v100, 0, v100
    v_max_f32 v101, 0, v101
    v_max_f32 v102, 0, v102
    v_max_f32 v103, 0, v103
    v_pk_add_f32 v[100:101], v[100:101], v[148:149]
    v_pk_add_f32 v[102:103], v[102:103], v[150:151]
    v_pk_add_f32 v[100:101], v[100:101], s[54:55]
    v_pk_add_f32 v[102:103], v[102:103], s[54:55]
    v_cvt_pk_bf16_f32 v60, v92, v93
    v_cvt_pk_bf16_f32 v61, v94, v95
    v_cvt_pk_bf16_f32 v62, v100, v101
    v_cvt_pk_bf16_f32 v63, v102, v103
    buffer_store_dwordx4 v[60:63], v12, s[8:11], s25 offen sc1
    s_branch interleave_layers__linear_attn_block__memory_aug_recurrent_mem_tr__prompt_kernel_k1_ej
interleave_layers__linear_attn_block__memory_aug_recurrent_mem_tr__prompt_kernel_k1_e2:
    s_cmp_eq_u32 s3, 3
    s_cbranch_scc1 interleave_layers__linear_attn_block__memory_aug_recurrent_mem_tr__prompt_kernel_k1_e3
    v_cvt_pk_bf16_f32 v68, v112, v113
    v_cvt_pk_bf16_f32 v69, v114, v115
    ds_write_b64 v10, v[68:69] offset:288
    v_cvt_pk_bf16_f32 v70, v116, v117
    v_cvt_pk_bf16_f32 v71, v118, v119
    ds_write_b64 v10, v[70:71] offset:5664
    v_min_f32 v148, 0, v96
    v_min_f32 v149, 0, v97
    v_pk_mul_f32 v[148:149], v[148:149], s[52:53]
    v_min_f32 v150, 0, v98
    v_min_f32 v151, 0, v99
    v_pk_mul_f32 v[150:151], v[150:151], s[52:53]
    v_exp_f32 v148, v148
    v_exp_f32 v149, v149
    v_exp_f32 v150, v150
    v_exp_f32 v151, v151
    v_max_f32 v96, 0, v96
    v_max_f32 v97, 0, v97
    v_max_f32 v98, 0, v98
    v_max_f32 v99, 0, v99
    v_pk_add_f32 v[96:97], v[96:97], v[148:149]
    v_pk_add_f32 v[98:99], v[98:99], v[150:151]
    v_pk_add_f32 v[96:97], v[96:97], s[54:55]
    v_pk_add_f32 v[98:99], v[98:99], s[54:55]
    v_min_f32 v148, 0, v104
    v_min_f32 v149, 0, v105
    v_pk_mul_f32 v[148:149], v[148:149], s[52:53]
    v_min_f32 v150, 0, v106
    v_min_f32 v151, 0, v107
    v_pk_mul_f32 v[150:151], v[150:151], s[52:53]
    v_exp_f32 v148, v148
    v_exp_f32 v149, v149
    v_exp_f32 v150, v150
    v_exp_f32 v151, v151
    v_max_f32 v104, 0, v104
    v_max_f32 v105, 0, v105
    v_max_f32 v106, 0, v106
    v_max_f32 v107, 0, v107
    v_pk_add_f32 v[104:105], v[104:105], v[148:149]
    v_pk_add_f32 v[106:107], v[106:107], v[150:151]
    v_pk_add_f32 v[104:105], v[104:105], s[54:55]
    v_pk_add_f32 v[106:107], v[106:107], s[54:55]
    v_min_f32 v148, 0, v100
    v_min_f32 v149, 0, v101
    v_pk_mul_f32 v[148:149], v[148:149], s[52:53]
    v_min_f32 v150, 0, v102
    v_min_f32 v151, 0, v103
    v_pk_mul_f32 v[150:151], v[150:151], s[52:53]
    v_exp_f32 v148, v148
    v_exp_f32 v149, v149
    v_exp_f32 v150, v150
    v_exp_f32 v151, v151
    v_max_f32 v100, 0, v100
    v_max_f32 v101, 0, v101
    v_max_f32 v102, 0, v102
    v_max_f32 v103, 0, v103
    v_pk_add_f32 v[100:101], v[100:101], v[148:149]
    v_pk_add_f32 v[102:103], v[102:103], v[150:151]
    v_pk_add_f32 v[100:101], v[100:101], s[54:55]
    v_pk_add_f32 v[102:103], v[102:103], s[54:55]
    v_min_f32 v148, 0, v108
    v_min_f32 v149, 0, v109
    v_pk_mul_f32 v[148:149], v[148:149], s[52:53]
    v_min_f32 v150, 0, v110
    v_min_f32 v151, 0, v111
    v_pk_mul_f32 v[150:151], v[150:151], s[52:53]
    v_exp_f32 v148, v148
    v_exp_f32 v149, v149
    v_exp_f32 v150, v150
    v_exp_f32 v151, v151
    v_max_f32 v108, 0, v108
    v_max_f32 v109, 0, v109
    v_max_f32 v110, 0, v110
    v_max_f32 v111, 0, v111
    v_pk_add_f32 v[108:109], v[108:109], v[148:149]
    v_pk_add_f32 v[110:111], v[110:111], v[150:151]
    v_pk_add_f32 v[108:109], v[108:109], s[54:55]
    v_pk_add_f32 v[110:111], v[110:111], s[54:55]
    v_cvt_pk_bf16_f32 v60, v96, v97
    v_cvt_pk_bf16_f32 v61, v98, v99
    ds_write_b64 v10, v[60:61] offset:0
    v_cvt_pk_bf16_f32 v62, v100, v101
    v_cvt_pk_bf16_f32 v63, v102, v103
    ds_write_b64 v10, v[62:63] offset:5376
    v_cvt_pk_bf16_f32 v64, v104, v105
    v_cvt_pk_bf16_f32 v65, v106, v107
    ds_write_b64 v10, v[64:65] offset:32
    v_cvt_pk_bf16_f32 v66, v108, v109
    v_cvt_pk_bf16_f32 v67, v110, v111
    ds_write_b64 v10, v[66:67] offset:5408
    v_min_f32 v148, 0, v88
    v_min_f32 v149, 0, v89
    v_pk_mul_f32 v[148:149], v[148:149], s[52:53]
    v_min_f32 v150, 0, v90
    v_min_f32 v151, 0, v91
    v_pk_mul_f32 v[150:151], v[150:151], s[52:53]
    v_exp_f32 v148, v148
    v_exp_f32 v149, v149
    v_exp_f32 v150, v150
    v_exp_f32 v151, v151
    v_max_f32 v88, 0, v88
    v_max_f32 v89, 0, v89
    v_max_f32 v90, 0, v90
    v_max_f32 v91, 0, v91
    v_pk_add_f32 v[88:89], v[88:89], v[148:149]
    v_pk_add_f32 v[90:91], v[90:91], v[150:151]
    v_pk_add_f32 v[88:89], v[88:89], s[54:55]
    v_pk_add_f32 v[90:91], v[90:91], s[54:55]
    v_cvt_pk_bf16_f32 v56, v88, v89
    v_cvt_pk_bf16_f32 v57, v90, v91
    buffer_store_dwordx2 v[56:57], v12, s[8:11], s43 offen sc1
    v_min_f32 v148, 0, v92
    v_min_f32 v149, 0, v93
    v_pk_mul_f32 v[148:149], v[148:149], s[52:53]
    v_min_f32 v150, 0, v94
    v_min_f32 v151, 0, v95
    v_pk_mul_f32 v[150:151], v[150:151], s[52:53]
    v_exp_f32 v148, v148
    v_exp_f32 v149, v149
    v_exp_f32 v150, v150
    v_exp_f32 v151, v151
    v_max_f32 v92, 0, v92
    v_max_f32 v93, 0, v93
    v_max_f32 v94, 0, v94
    v_max_f32 v95, 0, v95
    v_pk_add_f32 v[92:93], v[92:93], v[148:149]
    v_pk_add_f32 v[94:95], v[94:95], v[150:151]
    v_pk_add_f32 v[92:93], v[92:93], s[54:55]
    v_pk_add_f32 v[94:95], v[94:95], s[54:55]
    v_cvt_pk_bf16_f32 v58, v92, v93
    v_cvt_pk_bf16_f32 v59, v94, v95
    buffer_store_dwordx2 v[58:59], v12, s[8:11], s25 offen sc1
    s_branch interleave_layers__linear_attn_block__memory_aug_recurrent_mem_tr__prompt_kernel_k1_ej
interleave_layers__linear_attn_block__memory_aug_recurrent_mem_tr__prompt_kernel_k1_e3:
    v_min_f32 v148, 0, v88
    v_min_f32 v149, 0, v89
    v_pk_mul_f32 v[148:149], v[148:149], s[52:53]
    v_min_f32 v150, 0, v90
    v_min_f32 v151, 0, v91
    v_pk_mul_f32 v[150:151], v[150:151], s[52:53]
    v_exp_f32 v148, v148
    v_exp_f32 v149, v149
    v_exp_f32 v150, v150
    v_exp_f32 v151, v151
    v_max_f32 v88, 0, v88
    v_max_f32 v89, 0, v89
    v_max_f32 v90, 0, v90
    v_max_f32 v91, 0, v91
    v_pk_add_f32 v[88:89], v[88:89], v[148:149]
    v_pk_add_f32 v[90:91], v[90:91], v[150:151]
    v_pk_add_f32 v[88:89], v[88:89], s[54:55]
    v_pk_add_f32 v[90:91], v[90:91], s[54:55]
    v_min_f32 v148, 0, v92
    v_min_f32 v149, 0, v93
    v_pk_mul_f32 v[148:149], v[148:149], s[52:53]
    v_min_f32 v150, 0, v94
    v_min_f32 v151, 0, v95
    v_pk_mul_f32 v[150:151], v[150:151], s[52:53]
    v_exp_f32 v148, v148
    v_exp_f32 v149, v149
    v_exp_f32 v150, v150
    v_exp_f32 v151, v151
    v_max_f32 v92, 0, v92
    v_max_f32 v93, 0, v93
    v_max_f32 v94, 0, v94
    v_max_f32 v95, 0, v95
    v_pk_add_f32 v[92:93], v[92:93], v[148:149]
    v_pk_add_f32 v[94:95], v[94:95], v[150:151]
    v_pk_add_f32 v[92:93], v[92:93], s[54:55]
    v_pk_add_f32 v[94:95], v[94:95], s[54:55]
    v_cvt_pk_bf16_f32 v56, v88, v89
    v_cvt_pk_bf16_f32 v57, v90, v91
    ds_write_b64 v10, v[56:57] offset:64
    v_cvt_pk_bf16_f32 v58, v92, v93
    v_cvt_pk_bf16_f32 v59, v94, v95
    ds_write_b64 v10, v[58:59] offset:5440
    v_min_f32 v148, 0, v96
    v_min_f32 v149, 0, v97
    v_pk_mul_f32 v[148:149], v[148:149], s[52:53]
    v_min_f32 v150, 0, v98
    v_min_f32 v151, 0, v99
    v_pk_mul_f32 v[150:151], v[150:151], s[52:53]
    v_exp_f32 v148, v148
    v_exp_f32 v149, v149
    v_exp_f32 v150, v150
    v_exp_f32 v151, v151
    v_max_f32 v96, 0, v96
    v_max_f32 v97, 0, v97
    v_max_f32 v98, 0, v98
    v_max_f32 v99, 0, v99
    v_pk_add_f32 v[96:97], v[96:97], v[148:149]
    v_pk_add_f32 v[98:99], v[98:99], v[150:151]
    v_pk_add_f32 v[96:97], v[96:97], s[54:55]
    v_pk_add_f32 v[98:99], v[98:99], s[54:55]
    v_min_f32 v148, 0, v100
    v_min_f32 v149, 0, v101
    v_pk_mul_f32 v[148:149], v[148:149], s[52:53]
    v_min_f32 v150, 0, v102
    v_min_f32 v151, 0, v103
    v_pk_mul_f32 v[150:151], v[150:151], s[52:53]
    v_exp_f32 v148, v148
    v_exp_f32 v149, v149
    v_exp_f32 v150, v150
    v_exp_f32 v151, v151
    v_max_f32 v100, 0, v100
    v_max_f32 v101, 0, v101
    v_max_f32 v102, 0, v102
    v_max_f32 v103, 0, v103
    v_pk_add_f32 v[100:101], v[100:101], v[148:149]
    v_pk_add_f32 v[102:103], v[102:103], v[150:151]
    v_pk_add_f32 v[100:101], v[100:101], s[54:55]
    v_pk_add_f32 v[102:103], v[102:103], s[54:55]
    v_cvt_pk_bf16_f32 v60, v96, v97
    v_cvt_pk_bf16_f32 v61, v98, v99
    ds_write_b64 v10, v[60:61] offset:96
    v_cvt_pk_bf16_f32 v62, v100, v101
    v_cvt_pk_bf16_f32 v63, v102, v103
    ds_write_b64 v10, v[62:63] offset:5472
    v_min_f32 v148, 0, v104
    v_min_f32 v149, 0, v105
    v_pk_mul_f32 v[148:149], v[148:149], s[52:53]
    v_min_f32 v150, 0, v106
    v_min_f32 v151, 0, v107
    v_pk_mul_f32 v[150:151], v[150:151], s[52:53]
    v_exp_f32 v148, v148
    v_exp_f32 v149, v149
    v_exp_f32 v150, v150
    v_exp_f32 v151, v151
    v_max_f32 v104, 0, v104
    v_max_f32 v105, 0, v105
    v_max_f32 v106, 0, v106
    v_max_f32 v107, 0, v107
    v_pk_add_f32 v[104:105], v[104:105], v[148:149]
    v_pk_add_f32 v[106:107], v[106:107], v[150:151]
    v_pk_add_f32 v[104:105], v[104:105], s[54:55]
    v_pk_add_f32 v[106:107], v[106:107], s[54:55]
    v_min_f32 v148, 0, v108
    v_min_f32 v149, 0, v109
    v_pk_mul_f32 v[148:149], v[148:149], s[52:53]
    v_min_f32 v150, 0, v110
    v_min_f32 v151, 0, v111
    v_pk_mul_f32 v[150:151], v[150:151], s[52:53]
    v_exp_f32 v148, v148
    v_exp_f32 v149, v149
    v_exp_f32 v150, v150
    v_exp_f32 v151, v151
    v_max_f32 v108, 0, v108
    v_max_f32 v109, 0, v109
    v_max_f32 v110, 0, v110
    v_max_f32 v111, 0, v111
    v_pk_add_f32 v[108:109], v[108:109], v[148:149]
    v_pk_add_f32 v[110:111], v[110:111], v[150:151]
    v_pk_add_f32 v[108:109], v[108:109], s[54:55]
    v_pk_add_f32 v[110:111], v[110:111], s[54:55]
    v_cvt_pk_bf16_f32 v64, v104, v105
    v_cvt_pk_bf16_f32 v65, v106, v107
    ds_write_b64 v10, v[64:65] offset:128
    v_cvt_pk_bf16_f32 v66, v108, v109
    v_cvt_pk_bf16_f32 v67, v110, v111
    ds_write_b64 v10, v[66:67] offset:5504
interleave_layers__linear_attn_block__memory_aug_recurrent_mem_tr__prompt_kernel_k1_ej:
    s_waitcnt lgkmcnt(0)
    s_barrier
    ds_read_b64_tr_b16 v[72:73], v11 offset:0
    ds_read_b64_tr_b16 v[74:75], v11 offset:1344
    ds_read_b64_tr_b16 v[76:77], v11 offset:32
    ds_read_b64_tr_b16 v[78:79], v11 offset:1376
    ds_read_b64_tr_b16 v[80:81], v11 offset:160
    ds_read_b64_tr_b16 v[82:83], v11 offset:1504
    ds_read_b64_tr_b16 v[84:85], v11 offset:192
    ds_read_b64_tr_b16 v[86:87], v11 offset:1536
    s_waitcnt lgkmcnt(0)
    v_mfma_f32_16x16x32_bf16 v[120:123], v[72:75], v[84:87], v[120:123]
    v_mfma_f32_16x16x32_bf16 v[124:127], v[76:79], v[80:83], v[124:127]
    v_mfma_f32_16x16x32_bf16 v[128:131], v[76:79], v[84:87], v[128:131]
    v_mfma_f32_16x16x32_bf16 v[132:135], v[76:79], v[172:175], v[132:135]
    v_mfma_f32_16x16x32_bf16 v[136:139], v[72:75], v[80:83], v[136:139]
    v_mfma_f32_16x16x32_bf16 v[140:143], v[72:75], v[172:175], v[140:143]
    s_add_u32 s43, s43, s42
    s_add_u32 s48, s48, s49
    s_sub_u32 s40, s40, 1
    s_cmp_gt_u32 s40, 0
    s_cbranch_scc1 interleave_layers__linear_attn_block__memory_aug_recurrent_mem_tr__prompt_kernel_k1_seg
    s_cmp_eq_u32 s92, 0
    s_cbranch_scc0 interleave_layers__linear_attn_block__memory_aug_recurrent_mem_tr__prompt_kernel_ri7
    v_mov_b32 v15, 0
    buffer_load_dword v14, v15, s[72:75], 0 offen sc1
interleave_layers__linear_attn_block__memory_aug_recurrent_mem_tr__prompt_kernel_ri7:
    s_mul_i32 s24, s45, 147456
    s_mul_i32 s25, s44, 18432
    s_add_u32 s24, s24, s25
    s_add_u32 s24, s24, 16777216
    s_mul_i32 s25, s3, 3072
    s_add_u32 s25, s25, s24
    s_lshl_b32 s26, s3, 10
    s_add_u32 s26, s26, s24
    s_add_u32 s26, s26, 13312
    s_cmp_eq_u32 s3, 0
    s_cselect_b32 s27, 0, 2146435072
    s_add_u32 s27, s27, s24
    s_add_u32 s28, s27, 17408
    s_add_u32 s27, s27, 12288
    buffer_store_dwordx4 v[120:123], v7, s[8:11], s25 offen offset:0 sc1
    buffer_store_dwordx4 v[124:127], v7, s[8:11], s25 offen offset:1024 sc1
    buffer_store_dwordx4 v[128:131], v7, s[8:11], s25 offen offset:2048 sc1
    buffer_store_dwordx4 v[132:135], v7, s[8:11], s26 offen sc1
    buffer_store_dwordx4 v[136:139], v7, s[8:11], s27 offen sc1
    buffer_store_dwordx4 v[140:143], v7, s[8:11], s28 offen sc1
    s_waitcnt vmcnt(0)
    s_cmp_eq_u32 s92, 0
    s_cbranch_scc0 interleave_layers__linear_attn_block__memory_aug_recurrent_mem_tr__prompt_kernel_rc8_ok
    s_mov_b32 s61, 0
interleave_layers__linear_attn_block__memory_aug_recurrent_mem_tr__prompt_kernel_rc8:
    s_waitcnt vmcnt(0)
    v_readfirstlane_b32 s24, v14
    s_sub_u32 s36, s24, 1
    s_and_b32 s36, s36, 1
    s_lshl_b32 s36, s36, 13
    s_cmp_ge_u32 s24, 1
    s_cbranch_scc1 interleave_layers__linear_attn_block__memory_aug_recurrent_mem_tr__prompt_kernel_rc8_ok
    s_add_u32 s61, s61, 1
    s_cmp_ge_u32 s61, s60
    s_cbranch_scc1 interleave_layers__linear_attn_block__memory_aug_recurrent_mem_tr__prompt_kernel_rc8_to
    s_sleep 2
    v_mov_b32 v15, 0
    buffer_load_dword v14, v15, s[72:75], 0 offen sc1
    s_branch interleave_layers__linear_attn_block__memory_aug_recurrent_mem_tr__prompt_kernel_rc8
interleave_layers__linear_attn_block__memory_aug_recurrent_mem_tr__prompt_kernel_rc8_to:
    s_mov_b32 s60, 1
interleave_layers__linear_attn_block__memory_aug_recurrent_mem_tr__prompt_kernel_rc8_ok:
    s_barrier
    s_lshl_b32 s24, s92, 3
    s_add_u32 s24, s24, s44
    s_lshl_b32 s24, s24, 7
    s_lshl_b32 s25, s45, 2
    s_add_u32 s24, s24, s25
    s_add_u32 s24, s24, 23101440
    s_cmp_eq_u32 s3, 0
    s_cbranch_scc0 interleave_layers__linear_attn_block__memory_aug_recurrent_mem_tr__prompt_kernel_pb9
    v_lshlrev_b32 v14, 7, v1
    v_add_u32 v14, s24, v14
    v_mov_b32 v15, 2146435072
    v_cmp_le_u32 vcc, 1, v1
    s_nop 1
    v_cndmask_b32 v14, v14, v15, vcc
    v_mov_b32 v15, 1
    buffer_store_dword v15, v14, s[8:11], 0 offen sc1
interleave_layers__linear_attn_block__memory_aug_recurrent_mem_tr__prompt_kernel_pb9:
    s_cmp_eq_u32 s92, 0
    s_cbranch_scc0 interleave_layers__linear_attn_block__memory_aug_recurrent_mem_tr__prompt_kernel_end
    s_cmp_ge_u32 s2, 232
    s_cbranch_scc1 interleave_layers__linear_attn_block__memory_aug_recurrent_mem_tr__prompt_kernel_helper
    s_cmp_ge_u32 s2, 200
    s_cbranch_scc1 interleave_layers__linear_attn_block__memory_aug_recurrent_mem_tr__prompt_kernel_toO
    s_cmp_ge_u32 s2, 104
    s_cbranch_scc1 interleave_layers__linear_attn_block__memory_aug_recurrent_mem_tr__prompt_kernel_toP
    s_cmp_ge_u32 s2, 64
    s_cbranch_scc1 interleave_layers__linear_attn_block__memory_aug_recurrent_mem_tr__prompt_kernel_toR
    s_cmp_ge_u32 s2, 32
    s_cbranch_scc1 interleave_layers__linear_attn_block__memory_aug_recurrent_mem_tr__prompt_kernel_toV
    s_branch interleave_layers__linear_attn_block__memory_aug_recurrent_mem_tr__prompt_kernel_roleS
interleave_layers__linear_attn_block__memory_aug_recurrent_mem_tr__prompt_kernel_toV:
    s_branch interleave_layers__linear_attn_block__memory_aug_recurrent_mem_tr__prompt_kernel_roleV
interleave_layers__linear_attn_block__memory_aug_recurrent_mem_tr__prompt_kernel_toR:
    s_branch interleave_layers__linear_attn_block__memory_aug_recurrent_mem_tr__prompt_kernel_roleR
interleave_layers__linear_attn_block__memory_aug_recurrent_mem_tr__prompt_kernel_toP:
    s_branch interleave_layers__linear_attn_block__memory_aug_recurrent_mem_tr__prompt_kernel_roleP
interleave_layers__linear_attn_block__memory_aug_recurrent_mem_tr__prompt_kernel_toO:
    s_branch interleave_layers__linear_attn_block__memory_aug_recurrent_mem_tr__prompt_kernel_roleO
interleave_layers__linear_attn_block__memory_aug_recurrent_mem_tr__prompt_kernel_helper:
    s_sub_u32 s24, s2, 232
    s_cmp_ge_u32 s24, 21
    s_cbranch_scc1 interleave_layers__linear_attn_block__memory_aug_recurrent_mem_tr__prompt_kernel_helper_clr
    s_cmp_eq_u32 s24, 15
    s_cbranch_scc1 interleave_layers__linear_attn_block__memory_aug_recurrent_mem_tr__prompt_kernel_helper_k1
    s_mul_i32 s57, s24, 52
    s_lshr_b32 s57, s57, 8
    s_mul_i32 s56, s57, 5
    s_sub_u32 s56, s24, s56
    s_add_u32 s57, s57, 1
    s_sub_u32 s25, s24, 16
    s_cmp_ge_u32 s24, 16
    s_cselect_b32 s56, s25, s56
    s_cselect_b32 s57, 0, s57
    s_mul_i32 s78, s57, 5
    s_add_u32 s78, s78, s56
    s_load_dwordx2 s[6:7], s[0:1], 16
    v_lshrrev_b32 v12, 4, v0
    v_mul_u32_u24 v12, 1280, v12
    v_and_b32 v13, 15, v0
    v_lshl_add_u32 v12, v13, 4, v12
    s_waitcnt lgkmcnt(0)
    s_mov_b32 s12, s6
    s_mov_b32 s13, s7
    s_mov_b32 s14, 819200
    s_mov_b32 s15, 0x00020000
    s_lshl_b32 s52, s56, 8
    s_add_u32 s24, s52, 0
    buffer_load_dwordx4 a[0:3], v12, s[12:15], s24 offen
    s_add_u32 s24, s52, 20480
    buffer_load_dwordx4 a[4:7], v12, s[12:15], s24 offen
    s_add_u32 s24, s52, 40960
    buffer_load_dwordx4 a[8:11], v12, s[12:15], s24 offen
    s_add_u32 s24, s52, 61440
    buffer_load_dwordx4 a[12:15], v12, s[12:15], s24 offen
    s_add_u32 s24, s52, 81920
    buffer_load_dwordx4 a[16:19], v12, s[12:15], s24 offen
    s_add_u32 s24, s52, 102400
    buffer_load_dwordx4 a[20:23], v12, s[12:15], s24 offen
    s_add_u32 s24, s52, 122880
    buffer_load_dwordx4 a[24:27], v12, s[12:15], s24 offen
    s_add_u32 s24, s52, 143360
    buffer_load_dwordx4 a[28:31], v12, s[12:15], s24 offen
    s_add_u32 s24, s52, 163840
    buffer_load_dwordx4 a[32:35], v12, s[12:15], s24 offen
    s_add_u32 s24, s52, 184320
    buffer_load_dwordx4 a[36:39], v12, s[12:15], s24 offen
    s_add_u32 s24, s52, 204800
    buffer_load_dwordx4 a[40:43], v12, s[12:15], s24 offen
    s_add_u32 s24, s52, 225280
    buffer_load_dwordx4 a[44:47], v12, s[12:15], s24 offen
    s_add_u32 s24, s52, 245760
    buffer_load_dwordx4 a[48:51], v12, s[12:15], s24 offen
    s_add_u32 s24, s52, 266240
    buffer_load_dwordx4 a[52:55], v12, s[12:15], s24 offen
    s_add_u32 s24, s52, 286720
    buffer_load_dwordx4 a[56:59], v12, s[12:15], s24 offen
    s_add_u32 s24, s52, 307200
    buffer_load_dwordx4 a[60:63], v12, s[12:15], s24 offen
    s_add_u32 s24, s52, 327680
    buffer_load_dwordx4 a[64:67], v12, s[12:15], s24 offen
    s_add_u32 s24, s52, 348160
    buffer_load_dwordx4 a[68:71], v12, s[12:15], s24 offen
    s_add_u32 s24, s52, 368640
    buffer_load_dwordx4 a[72:75], v12, s[12:15], s24 offen
    s_add_u32 s24, s52, 389120
    buffer_load_dwordx4 a[76:79], v12, s[12:15], s24 offen
    s_add_u32 s24, s52, 409600
    buffer_load_dwordx4 a[80:83], v12, s[12:15], s24 offen
    s_add_u32 s24, s52, 430080
    buffer_load_dwordx4 a[84:87], v12, s[12:15], s24 offen
    s_add_u32 s24, s52, 450560
    buffer_load_dwordx4 a[88:91], v12, s[12:15], s24 offen
    s_add_u32 s24, s52, 471040
    buffer_load_dwordx4 a[92:95], v12, s[12:15], s24 offen
    s_add_u32 s24, s52, 491520
    buffer_load_dwordx4 a[96:99], v12, s[12:15], s24 offen
    s_add_u32 s24, s52, 512000
    buffer_load_dwordx4 a[100:103], v12, s[12:15], s24 offen
    s_add_u32 s24, s52, 532480
    buffer_load_dwordx4 a[104:107], v12, s[12:15], s24 offen
    s_add_u32 s24, s52, 552960
    buffer_load_dwordx4 a[108:111], v12, s[12:15], s24 offen
    s_add_u32 s24, s52, 573440
    buffer_load_dwordx4 a[112:115], v12, s[12:15], s24 offen
    s_add_u32 s24, s52, 593920
    buffer_load_dwordx4 a[116:119], v12, s[12:15], s24 offen
    s_add_u32 s24, s52, 614400
    buffer_load_dwordx4 a[120:123], v12, s[12:15], s24 offen
    s_add_u32 s24, s52, 634880
    buffer_load_dwordx4 a[124:127], v12, s[12:15], s24 offen
    s_add_u32 s24, s52, 655360
    buffer_load_dwordx4 a[128:131], v12, s[12:15], s24 offen
    s_add_u32 s24, s52, 675840
    buffer_load_dwordx4 a[132:135], v12, s[12:15], s24 offen
    s_add_u32 s24, s52, 696320
    buffer_load_dwordx4 a[136:139], v12, s[12:15], s24 offen
    s_add_u32 s24, s52, 716800
    buffer_load_dwordx4 a[140:143], v12, s[12:15], s24 offen
    s_add_u32 s24, s52, 737280
    buffer_load_dwordx4 a[144:147], v12, s[12:15], s24 offen
    s_add_u32 s24, s52, 757760
    buffer_load_dwordx4 a[148:151], v12, s[12:15], s24 offen
    s_add_u32 s24, s52, 778240
    buffer_load_dwordx4 a[152:155], v12, s[12:15], s24 offen
    s_add_u32 s24, s52, 798720
    buffer_load_dwordx4 a[156:159], v12, s[12:15], s24 offen
    v_lshrrev_b32 v6, 4, v0
    v_mul_u32_u24 v6, 288, v6
    v_and_b32 v7, 15, v0
    v_lshl_add_u32 v6, v7, 4, v6
    v_add_u32 v6, 81920, v6
    v_lshrrev_b32 v7, 2, v2
    v_lshl_add_u32 v7, v3, 2, v7
    v_mul_u32_u24 v7, 288, v7
    v_and_b32 v8, 3, v2
    v_lshl_add_u32 v7, v8, 3, v7
    s_lshl_b32 s24, s3, 6
    s_add_u32 s24, s24, 81920
    v_add_u32 v7, s24, v7
    s_waitcnt vmcnt(36)
    ds_write_b128 v6, a[0:3] offset:0
    ds_write_b128 v6, a[4:7] offset:4608
    ds_write_b128 v6, a[8:11] offset:9216
    ds_write_b128 v6, a[12:15] offset:13824
    s_waitcnt lgkmcnt(0)
    s_barrier
    ds_read_b64_tr_b16 a[0:1], v7 offset:0
    ds_read_b64_tr_b16 a[2:3], v7 offset:4608
    ds_read_b64_tr_b16 a[4:5], v7 offset:32
    ds_read_b64_tr_b16 a[6:7], v7 offset:4640
    ds_read_b64_tr_b16 a[8:9], v7 offset:9216
    ds_read_b64_tr_b16 a[10:11], v7 offset:13824
    ds_read_b64_tr_b16 a[12:13], v7 offset:9248
    ds_read_b64_tr_b16 a[14:15], v7 offset:13856
    s_waitcnt vmcnt(32)
    ds_write_b128 v6, a[16:19] offset:18432
    ds_write_b128 v6, a[20:23] offset:23040
    ds_write_b128 v6, a[24:27] offset:27648
    ds_write_b128 v6, a[28:31] offset:32256
    s_waitcnt lgkmcnt(0)
    s_barrier
    ds_read_b64_tr_b16 a[16:17], v7 offset:18432
    ds_read_b64_tr_b16 a[18:19], v7 offset:23040
    ds_read_b64_tr_b16 a[20:21], v7 offset:18464
    ds_read_b64_tr_b16 a[22:23], v7 offset:23072
    ds_read_b64_tr_b16 a[24:25], v7 offset:27648
    ds_read_b64_tr_b16 a[26:27], v7 offset:32256
    ds_read_b64_tr_b16 a[28:29], v7 offset:27680
    ds_read_b64_tr_b16 a[30:31], v7 offset:32288
    s_waitcnt vmcnt(28)
    ds_write_b128 v6, a[32:35] offset:0
    ds_write_b128 v6, a[36:39] offset:4608
    ds_write_b128 v6, a[40:43] offset:9216
    ds_write_b128 v6, a[44:47] offset:13824
    s_waitcnt lgkmcnt(0)
    s_barrier
    ds_read_b64_tr_b16 a[32:33], v7 offset:0
    ds_read_b64_tr_b16 a[34:35], v7 offset:4608
    ds_read_b64_tr_b16 a[36:37], v7 offset:32
    ds_read_b64_tr_b16 a[38:39], v7 offset:4640
    ds_read_b64_tr_b16 a[40:41], v7 offset:9216
    ds_read_b64_tr_b16 a[42:43], v7 offset:13824
    ds_read_b64_tr_b16 a[44:45], v7 offset:9248
    ds_read_b64_tr_b16 a[46:47], v7 offset:13856
    s_waitcnt vmcnt(24)
    ds_write_b128 v6, a[48:51] offset:18432
    ds_write_b128 v6, a[52:55] offset:23040
    ds_write_b128 v6, a[56:59] offset:27648
    ds_write_b128 v6, a[60:63] offset:32256
    s_waitcnt lgkmcnt(0)
    s_barrier
    ds_read_b64_tr_b16 a[48:49], v7 offset:18432
    ds_read_b64_tr_b16 a[50:51], v7 offset:23040
    ds_read_b64_tr_b16 a[52:53], v7 offset:18464
    ds_read_b64_tr_b16 a[54:55], v7 offset:23072
    ds_read_b64_tr_b16 a[56:57], v7 offset:27648
    ds_read_b64_tr_b16 a[58:59], v7 offset:32256
    ds_read_b64_tr_b16 a[60:61], v7 offset:27680
    ds_read_b64_tr_b16 a[62:63], v7 offset:32288
    s_waitcnt vmcnt(20)
    ds_write_b128 v6, a[64:67] offset:0
    ds_write_b128 v6, a[68:71] offset:4608
    ds_write_b128 v6, a[72:75] offset:9216
    ds_write_b128 v6, a[76:79] offset:13824
    s_waitcnt lgkmcnt(0)
    s_barrier
    ds_read_b64_tr_b16 a[64:65], v7 offset:0
    ds_read_b64_tr_b16 a[66:67], v7 offset:4608
    ds_read_b64_tr_b16 a[68:69], v7 offset:32
    ds_read_b64_tr_b16 a[70:71], v7 offset:4640
    ds_read_b64_tr_b16 a[72:73], v7 offset:9216
    ds_read_b64_tr_b16 a[74:75], v7 offset:13824
    ds_read_b64_tr_b16 a[76:77], v7 offset:9248
    ds_read_b64_tr_b16 a[78:79], v7 offset:13856
    s_waitcnt vmcnt(16)
    ds_write_b128 v6, a[80:83] offset:18432
    ds_write_b128 v6, a[84:87] offset:23040
    ds_write_b128 v6, a[88:91] offset:27648
    ds_write_b128 v6, a[92:95] offset:32256
    s_waitcnt lgkmcnt(0)
    s_barrier
    ds_read_b64_tr_b16 a[80:81], v7 offset:18432
    ds_read_b64_tr_b16 a[82:83], v7 offset:23040
    ds_read_b64_tr_b16 a[84:85], v7 offset:18464
    ds_read_b64_tr_b16 a[86:87], v7 offset:23072
    ds_read_b64_tr_b16 a[88:89], v7 offset:27648
    ds_read_b64_tr_b16 a[90:91], v7 offset:32256
    ds_read_b64_tr_b16 a[92:93], v7 offset:27680
    ds_read_b64_tr_b16 a[94:95], v7 offset:32288
    s_waitcnt vmcnt(12)
    ds_write_b128 v6, a[96:99] offset:0
    ds_write_b128 v6, a[100:103] offset:4608
    ds_write_b128 v6, a[104:107] offset:9216
    ds_write_b128 v6, a[108:111] offset:13824
    s_waitcnt lgkmcnt(0)
    s_barrier
    ds_read_b64_tr_b16 a[96:97], v7 offset:0
    ds_read_b64_tr_b16 a[98:99], v7 offset:4608
    ds_read_b64_tr_b16 a[100:101], v7 offset:32
    ds_read_b64_tr_b16 a[102:103], v7 offset:4640
    ds_read_b64_tr_b16 a[104:105], v7 offset:9216
    ds_read_b64_tr_b16 a[106:107], v7 offset:13824
    ds_read_b64_tr_b16 a[108:109], v7 offset:9248
    ds_read_b64_tr_b16 a[110:111], v7 offset:13856
    s_waitcnt vmcnt(8)
    ds_write_b128 v6, a[112:115] offset:18432
    ds_write_b128 v6, a[116:119] offset:23040
    ds_write_b128 v6, a[120:123] offset:27648
    ds_write_b128 v6, a[124:127] offset:32256
    s_waitcnt lgkmcnt(0)
    s_barrier
    ds_read_b64_tr_b16 a[112:113], v7 offset:18432
    ds_read_b64_tr_b16 a[114:115], v7 offset:23040
    ds_read_b64_tr_b16 a[116:117], v7 offset:18464
    ds_read_b64_tr_b16 a[118:119], v7 offset:23072
    ds_read_b64_tr_b16 a[120:121], v7 offset:27648
    ds_read_b64_tr_b16 a[122:123], v7 offset:32256
    ds_read_b64_tr_b16 a[124:125], v7 offset:27680
    ds_read_b64_tr_b16 a[126:127], v7 offset:32288
    s_waitcnt vmcnt(4)
    ds_write_b128 v6, a[128:131] offset:0
    ds_write_b128 v6, a[132:135] offset:4608
    ds_write_b128 v6, a[136:139] offset:9216
    ds_write_b128 v6, a[140:143] offset:13824
    s_waitcnt lgkmcnt(0)
    s_barrier
    ds_read_b64_tr_b16 a[128:129], v7 offset:0
    ds_read_b64_tr_b16 a[130:131], v7 offset:4608
    ds_read_b64_tr_b16 a[132:133], v7 offset:32
    ds_read_b64_tr_b16 a[134:135], v7 offset:4640
    ds_read_b64_tr_b16 a[136:137], v7 offset:9216
    ds_read_b64_tr_b16 a[138:139], v7 offset:13824
    ds_read_b64_tr_b16 a[140:141], v7 offset:9248
    ds_read_b64_tr_b16 a[142:143], v7 offset:13856
    s_waitcnt vmcnt(0)
    ds_write_b128 v6, a[144:147] offset:18432
    ds_write_b128 v6, a[148:151] offset:23040
    ds_write_b128 v6, a[152:155] offset:27648
    ds_write_b128 v6, a[156:159] offset:32256
    s_waitcnt lgkmcnt(0)
    s_barrier
    ds_read_b64_tr_b16 a[144:145], v7 offset:18432
    ds_read_b64_tr_b16 a[146:147], v7 offset:23040
    ds_read_b64_tr_b16 a[148:149], v7 offset:18464
    ds_read_b64_tr_b16 a[150:151], v7 offset:23072
    ds_read_b64_tr_b16 a[152:153], v7 offset:27648
    ds_read_b64_tr_b16 a[154:155], v7 offset:32256
    ds_read_b64_tr_b16 a[156:157], v7 offset:27680
    ds_read_b64_tr_b16 a[158:159], v7 offset:32288
    s_waitcnt lgkmcnt(0)
    s_load_dwordx2 s[6:7], s[0:1], 0
    s_waitcnt lgkmcnt(0)
    s_mov_b32 s16, s6
    s_mov_b32 s17, s7
    s_mov_b32 s18, 2621440
    s_mov_b32 s19, 0x00020000
    s_mov_b32 s46, 64
    s_mov_b32 s47, 32
    s_mov_b32 s50, 0
    s_mov_b32 s58, 0
    s_mov_b32 s76, 16
    s_mov_b32 s77, 163840
interleave_layers__linear_attn_block__memory_aug_recurrent_mem_tr__prompt_kernel_k3_entry:
    v_lshlrev_b32 v5, 4, v1
    s_mul_i32 s24, s3, 5120
    s_add_u32 s24, s24, 12582912
    v_add_u32 v8, s24, v5
    v_lshlrev_b32 v9, 3, v1
    s_add_u32 s24, s24, 2048
    v_add_u32 v9, s24, v9
    s_cmp_eq_u32 s50, 1
    s_cselect_b32 s25, 16, 1280
    s_cselect_b32 s26, 256, 8
    v_mul_u32_u24 v10, s25, v2
    v_mul_u32_u24 v11, s26, v3
    s_lshl_b32 s24, s56, 2
    s_add_u32 s24, s24, s3
    s_mul_i32 s25, s24, s46
    v_add3_u32 v10, v10, v11, s25
    v_add_u32 v11, s47, v10
    s_lshl_b32 s24, s24, 10
    s_add_u32 s24, s24, s58
    v_add_u32 v12, s24, v5
    s_mul_i32 s24, s3, 5120
    s_add_u32 s24, s24, 0
    v_add_u32 v13, s24, v5
    s_mov_b32 s54, 0x358637bd
    s_mul_i32 s43, s57, 40960
    s_mov_b32 s40, 0
    s_mov_b32 s42, 0
    s_cmp_eq_u32 s92, 0
    s_cselect_b32 s26, 32, 0
    s_cselect_b32 s27, 7, 1
    s_lshl_b32 s24, s92, 10
    s_add_u32 s24, s24, 23101440
    v_and_b32 v15, 7, v1
    v_lshlrev_b32 v15, 7, v15
    v_lshrrev_b32 v14, 3, v1
    v_and_b32 v14, s27, v14
    v_lshl_add_u32 v15, v14, 2, v15
    v_add_u32 v15, s24, v15
    s_lshl_b32 s27, s26, 1
    s_add_u32 s28, s27, s26
    s_mov_b32 s61, 0
interleave_layers__linear_attn_block__memory_aug_recurrent_mem_tr__prompt_kernel_k3_w0:
    buffer_load_dword v16, v15, s[8:11], 0 offen sc1
    buffer_load_dword v17, v15, s[8:11], s26 offen sc1
    buffer_load_dword v18, v15, s[8:11], s27 offen sc1
    buffer_load_dword v19, v15, s[8:11], s28 offen sc1
    s_waitcnt vmcnt(0)
    v_min_i32 v16, v16, v17
    v_min3_i32 v16, v16, v18, v19
    v_cmp_le_i32 vcc, 1, v16
    s_cmp_eq_u64 vcc, -1
    s_cbranch_scc1 interleave_layers__linear_attn_block__memory_aug_recurrent_mem_tr__prompt_kernel_k3_w0_ok
    s_add_u32 s61, s61, 1
    s_cmp_ge_u32 s61, s60
    s_cbranch_scc1 interleave_layers__linear_attn_block__memory_aug_recurrent_mem_tr__prompt_kernel_k3_w0_to
    s_sleep 4
    s_branch interleave_layers__linear_attn_block__memory_aug_recurrent_mem_tr__prompt_kernel_k3_w0
interleave_layers__linear_attn_block__memory_aug_recurrent_mem_tr__prompt_kernel_k3_w0_to:
    s_mov_b32 s60, 1
interleave_layers__linear_attn_block__memory_aug_recurrent_mem_tr__prompt_kernel_k3_w0_ok:
    s_mov_b32 s41, s43
    s_add_u32 s25, s41, 20480
    buffer_load_dwordx4 v[16:19], v8, s[8:11], s41 offen offset:0 sc1
    buffer_load_dwordx4 v[20:23], v8, s[8:11], s41 offen offset:1024 sc1
    buffer_load_dwordx2 v[24:25], v9, s[8:11], s41 offen offset:0 sc1
    buffer_load_dwordx4 v[26:29], v8, s[8:11], s41 offen offset:2560 sc1
    buffer_load_dwordx4 v[30:33], v8, s[8:11], s41 offen offset:3584 sc1
    buffer_load_dwordx2 v[34:35], v9, s[8:11], s41 offen offset:2560 sc1
    buffer_load_dwordx4 v[36:39], v8, s[8:11], s25 offen offset:0 sc1
    buffer_load_dwordx4 v[40:43], v8, s[8:11], s25 offen offset:1024 sc1
    buffer_load_dwordx2 v[44:45], v9, s[8:11], s25 offen offset:0 sc1
    buffer_load_dwordx4 v[46:49], v8, s[8:11], s25 offen offset:2560 sc1
    buffer_load_dwordx4 v[50:53], v8, s[8:11], s25 offen offset:3584 sc1
    buffer_load_dwordx2 v[54:55], v9, s[8:11], s25 offen offset:2560 sc1
    buffer_load_dwordx2 v[96:97], v10, s[16:19], s41 offen sc1
    buffer_load_dwordx2 v[98:99], v11, s[16:19], s41 offen sc1
    buffer_load_dwordx2 v[100:101], v10, s[16:19], s25 offen sc1
    buffer_load_dwordx2 v[102:103], v11, s[16:19], s25 offen sc1
    s_add_u32 s41, s43, s77
    s_add_u32 s25, s41, 20480
    buffer_load_dwordx4 v[56:59], v8, s[8:11], s41 offen offset:0 sc1
    buffer_load_dwordx4 v[60:63], v8, s[8:11], s41 offen offset:1024 sc1
    buffer_load_dwordx2 v[64:65], v9, s[8:11], s41 offen offset:0 sc1
    buffer_load_dwordx4 v[66:69], v8, s[8:11], s41 offen offset:2560 sc1
    buffer_load_dwordx4 v[70:73], v8, s[8:11], s41 offen offset:3584 sc1
    buffer_load_dwordx2 v[74:75], v9, s[8:11], s41 offen offset:2560 sc1
    buffer_load_dwordx4 v[76:79], v8, s[8:11], s25 offen offset:0 sc1
    buffer_load_dwordx4 v[80:83], v8, s[8:11], s25 offen offset:1024 sc1
    buffer_load_dwordx2 v[84:85], v9, s[8:11], s25 offen offset:0 sc1
    buffer_load_dwordx4 v[86:89], v8, s[8:11], s25 offen offset:2560 sc1
    buffer_load_dwordx4 v[90:93], v8, s[8:11], s25 offen offset:3584 sc1
    buffer_load_dwordx2 v[94:95], v9, s[8:11], s25 offen offset:2560 sc1
    buffer_load_dwordx2 v[104:105], v10, s[16:19], s41 offen sc1
    buffer_load_dwordx2 v[106:107], v11, s[16:19], s41 offen sc1
    buffer_load_dwordx2 v[108:109], v10, s[16:19], s25 offen sc1
    buffer_load_dwordx2 v[110:111], v11, s[16:19], s25 offen sc1
    s_lshl_b32 s24, s92, 7
    s_add_u32 s24, s24, 23103488
    v_lshlrev_b32 v15, 2, v1
    v_add_u32 v15, s24, v15
    s_mov_b32 s61, 0
interleave_layers__linear_attn_block__memory_aug_recurrent_mem_tr__prompt_kernel_k3_w:
    buffer_load_dword v14, v15, s[8:11], 0 offen sc1
    s_waitcnt vmcnt(0)
    v_cmp_le_i32 vcc, 1, v14
    s_mov_b32 s25, 0xffffff
    s_and_b32 s24, vcc_lo, s25
    s_cmp_eq_u32 s24, s25
    s_cbranch_scc1 interleave_layers__linear_attn_block__memory_aug_recurrent_mem_tr__prompt_kernel_k3_w_ok
    s_add_u32 s61, s61, 1
    s_cmp_ge_u32 s61, s60
    s_cbranch_scc1 interleave_layers__linear_attn_block__memory_aug_recurrent_mem_tr__prompt_kernel_k3_w_to
    s_sleep 2
    s_branch interleave_layers__linear_attn_block__memory_aug_recurrent_mem_tr__prompt_kernel_k3_w
interleave_layers__linear_attn_block__memory_aug_recurrent_mem_tr__prompt_kernel_k3_w_to:
    s_mov_b32 s60, 1
interleave_layers__linear_attn_block__memory_aug_recurrent_mem_tr__prompt_kernel_k3_w_ok:
    s_mul_i32 s24, s92, 131072
    s_mul_i32 s25, s3, 28672
    s_add_u32 s24, s24, s25
    s_add_u32 s24, s24, 22020096
    s_add_u32 s25, s24, 0
    buffer_load_dwordx4 a[160:163], v5, s[8:11], s25 offen sc1
    s_add_u32 s25, s24, 1024
    buffer_load_dwordx4 a[164:167], v5, s[8:11], s25 offen sc1
    s_add_u32 s25, s24, 2048
    buffer_load_dwordx4 a[168:171], v5, s[8:11], s25 offen sc1
    s_add_u32 s25, s24, 3072
    buffer_load_dwordx4 a[172:175], v5, s[8:11], s25 offen sc1
    s_add_u32 s25, s24, 4096
    buffer_load_dwordx4 a[176:179], v5, s[8:11], s25 offen sc1
    s_add_u32 s25, s24, 5120
    buffer_load_dwordx4 a[180:183], v5, s[8:11], s25 offen sc1
    s_add_u32 s25, s24, 6144
    buffer_load_dwordx2 a[184:185], v5, s[8:11], s25 offen sc1
    s_add_u32 s25, s24, 7168
    buffer_load_dwordx4 a[186:189], v5, s[8:11], s25 offen sc1
    s_add_u32 s25, s24, 8192
    buffer_load_dwordx2 a[190:191], v5, s[8:11], s25 offen sc1
    s_add_u32 s25, s24, 9216
    buffer_load_dwordx4 a[192:195], v5, s[8:11], s25 offen sc1
    s_add_u32 s25, s24, 10240
    buffer_load_dwordx4 a[196:199], v5, s[8:11], s25 offen sc1
    s_add_u32 s25, s24, 11264
    buffer_load_dwordx2 a[200:201], v5, s[8:11], s25 offen sc1
    s_add_u32 s25, s24, 12288
    buffer_load_dwordx4 a[202:205], v5, s[8:11], s25 offen sc1
    s_add_u32 s25, s24, 13312
    buffer_load_dwordx2 a[206:207], v5, s[8:11], s25 offen sc1
    s_add_u32 s25, s24, 14336
    buffer_load_dwordx4 a[208:211], v5, s[8:11], s25 offen sc1
    s_add_u32 s25, s24, 15360
    buffer_load_dwordx4 a[212:215], v5, s[8:11], s25 offen sc1
    s_add_u32 s25, s24, 16384
    buffer_load_dwordx4 a[216:219], v5, s[8:11], s25 offen sc1
    s_add_u32 s25, s24, 17408
    buffer_load_dwordx4 a[220:223], v5, s[8:11], s25 offen sc1
    s_add_u32 s25, s24, 18432
    buffer_load_dwordx4 a[224:227], v5, s[8:11], s25 offen sc1
    s_add_u32 s25, s24, 19456
    buffer_load_dwordx4 a[228:231], v5, s[8:11], s25 offen sc1
    s_add_u32 s25, s24, 20480
    buffer_load_dwordx2 a[232:233], v5, s[8:11], s25 offen sc1
    s_add_u32 s25, s24, 21504
    buffer_load_dwordx4 a[234:237], v5, s[8:11], s25 offen sc1
    s_add_u32 s25, s24, 22528
    buffer_load_dwordx2 a[238:239], v5, s[8:11], s25 offen sc1
    s_add_u32 s25, s24, 23552
    buffer_load_dwordx4 a[240:243], v5, s[8:11], s25 offen sc1
    s_add_u32 s25, s24, 24576
    buffer_load_dwordx4 a[244:247], v5, s[8:11], s25 offen sc1
    s_add_u32 s25, s24, 25600
    buffer_load_dwordx2 a[248:249], v5, s[8:11], s25 offen sc1
    s_add_u32 s25, s24, 26624
    buffer_load_dwordx4 a[250:253], v5, s[8:11], s25 offen sc1
    s_add_u32 s25, s24, 27648
    buffer_load_dwordx2 a[254:255], v5, s[8:11], s25 offen sc1
    s_waitcnt vmcnt(0)
    v_mfma_f32_16x16x32_bf16 v[132:135], a[192:195], v[16:19], 0
    v_mfma_f32_16x16x32_bf16 v[136:139], a[202:205], v[20:23], 0
    v_mfma_f32_16x16x32_bf16 v[112:115], a[160:163], v[16:19], 0
    v_mfma_f32_16x16x32_bf16 v[116:119], a[164:167], v[16:19], 0
    v_mfma_f32_16x16x32_bf16 v[120:123], a[172:175], v[16:19], 0
    v_mfma_f32_16x16x32_bf16 v[124:127], a[180:183], v[20:23], 0
    v_mfma_f32_16x16x32_bf16 v[128:131], a[186:189], v[20:23], 0
    v_mfma_f32_16x16x32_bf16 v[132:135], a[196:199], v[20:23], v[132:135]
    v_mfma_f32_16x16x32_bf16 v[116:119], a[168:171], v[20:23], v[116:119]
    v_mfma_f32_16x16x32_bf16 v[120:123], a[176:179], v[20:23], v[120:123]
    v_mfma_f32_16x16x16_bf16 v[136:139], a[206:207], v[24:25], v[136:139]
    s_nop 0
    v_mfma_f32_16x16x16_bf16 v[124:127], a[184:185], v[24:25], v[124:127]
    v_mfma_f32_16x16x16_bf16 v[128:131], a[190:191], v[24:25], v[128:131]
    v_mfma_f32_16x16x16_bf16 v[132:135], a[200:201], v[24:25], v[132:135]
    v_mfma_f32_16x16x32_bf16 v[160:163], a[240:243], v[26:29], 0
    v_mfma_f32_16x16x32_bf16 v[164:167], a[250:253], v[30:33], 0
    v_mfma_f32_16x16x32_bf16 v[140:143], a[208:211], v[26:29], 0
    v_mfma_f32_16x16x32_bf16 v[144:147], a[212:215], v[26:29], 0
    v_mfma_f32_16x16x32_bf16 v[148:151], a[220:223], v[26:29], 0
    v_mfma_f32_16x16x32_bf16 v[152:155], a[228:231], v[30:33], 0
    v_mfma_f32_16x16x32_bf16 v[156:159], a[234:237], v[30:33], 0
    v_mfma_f32_16x16x32_bf16 v[160:163], a[244:247], v[30:33], v[160:163]
    v_mfma_f32_16x16x32_bf16 v[144:147], a[216:219], v[30:33], v[144:147]
    v_mfma_f32_16x16x32_bf16 v[148:151], a[224:227], v[30:33], v[148:151]
    v_mfma_f32_16x16x16_bf16 v[164:167], a[254:255], v[34:35], v[164:167]
    s_nop 0
    v_mfma_f32_16x16x16_bf16 v[152:155], a[232:233], v[34:35], v[152:155]
    v_mfma_f32_16x16x16_bf16 v[156:159], a[238:239], v[34:35], v[156:159]
    v_mfma_f32_16x16x16_bf16 v[160:163], a[248:249], v[34:35], v[160:163]
    v_add_f32 v132, s54, v132
    v_add_f32 v133, s54, v133
    v_add_f32 v134, s54, v134
    v_add_f32 v135, s54, v135
    v_add_f32 v136, s54, v136
    v_rcp_f32 v132, v132
    v_rcp_f32 v133, v133
    v_rcp_f32 v134, v134
    v_rcp_f32 v135, v135
    v_rcp_f32 v136, v136
    v_mul_f32 v112, v112, v132
    v_mul_f32 v113, v113, v132
    v_mul_f32 v114, v114, v132
    v_mul_f32 v115, v115, v132
    v_cvt_pk_bf16_f32 v168, v112, v113
    v_cvt_pk_bf16_f32 v169, v114, v115
    v_mul_f32 v116, v116, v133
    v_mul_f32 v117, v117, v133
    v_mul_f32 v118, v118, v133
    v_mul_f32 v119, v119, v133
    v_cvt_pk_bf16_f32 v170, v116, v117
    v_cvt_pk_bf16_f32 v171, v118, v119
    v_mul_f32 v120, v120, v134
    v_mul_f32 v121, v121, v134
    v_mul_f32 v122, v122, v134
    v_mul_f32 v123, v123, v134
    v_cvt_pk_bf16_f32 v172, v120, v121
    v_cvt_pk_bf16_f32 v173, v122, v123
    v_mul_f32 v124, v124, v135
    v_mul_f32 v125, v125, v135
    v_mul_f32 v126, v126, v135
    v_mul_f32 v127, v127, v135
    v_cvt_pk_bf16_f32 v174, v124, v125
    v_cvt_pk_bf16_f32 v175, v126, v127
    v_mul_f32 v128, v128, v136
    v_mul_f32 v129, v129, v136
    v_mul_f32 v130, v130, v136
    v_mul_f32 v131, v131, v136
    v_cvt_pk_bf16_f32 v176, v128, v129
    v_cvt_pk_bf16_f32 v177, v130, v131
    v_add_f32 v160, s54, v160
    v_add_f32 v161, s54, v161
    v_add_f32 v162, s54, v162
    v_add_f32 v163, s54, v163
    v_add_f32 v164, s54, v164
    v_rcp_f32 v160, v160
    v_rcp_f32 v161, v161
    v_rcp_f32 v162, v162
    v_rcp_f32 v163, v163
    v_rcp_f32 v164, v164
    v_mul_f32 v140, v140, v160
    v_mul_f32 v141, v141, v160
    v_mul_f32 v142, v142, v160
    v_mul_f32 v143, v143, v160
    v_cvt_pk_bf16_f32 v178, v140, v141
    v_cvt_pk_bf16_f32 v179, v142, v143
    v_mul_f32 v144, v144, v161
    v_mul_f32 v145, v145, v161
    v_mul_f32 v146, v146, v161
    v_mul_f32 v147, v147, v161
    v_cvt_pk_bf16_f32 v180, v144, v145
    v_cvt_pk_bf16_f32 v181, v146, v147
    v_mul_f32 v148, v148, v162
    v_mul_f32 v149, v149, v162
    v_mul_f32 v150, v150, v162
    v_mul_f32 v151, v151, v162
    v_cvt_pk_bf16_f32 v182, v148, v149
    v_cvt_pk_bf16_f32 v183, v150, v151
    v_mul_f32 v152, v152, v163
    v_mul_f32 v153, v153, v163
    v_mul_f32 v154, v154, v163
    v_mul_f32 v155, v155, v163
    v_cvt_pk_bf16_f32 v184, v152, v153
    v_cvt_pk_bf16_f32 v185, v154, v155
    v_mul_f32 v156, v156, v164
    v_mul_f32 v157, v157, v164
    v_mul_f32 v158, v158, v164
    v_mul_f32 v159, v159, v164
    v_cvt_pk_bf16_f32 v186, v156, v157
    v_cvt_pk_bf16_f32 v187, v158, v159
    v_mfma_f32_16x16x32_bf16 v[132:135], a[192:195], v[36:39], 0
    v_mfma_f32_16x16x32_bf16 v[136:139], a[202:205], v[40:43], 0
    v_mfma_f32_16x16x32_bf16 v[112:115], a[160:163], v[36:39], 0
    v_mfma_f32_16x16x32_bf16 v[116:119], a[164:167], v[36:39], 0
    v_mfma_f32_16x16x32_bf16 v[120:123], a[172:175], v[36:39], 0
    v_mfma_f32_16x16x32_bf16 v[124:127], a[180:183], v[40:43], 0
    v_mfma_f32_16x16x32_bf16 v[128:131], a[186:189], v[40:43], 0
    v_mfma_f32_16x16x32_bf16 v[132:135], a[196:199], v[40:43], v[132:135]
    v_mfma_f32_16x16x32_bf16 v[116:119], a[168:171], v[40:43], v[116:119]
    v_mfma_f32_16x16x32_bf16 v[120:123], a[176:179], v[40:43], v[120:123]
    v_mfma_f32_16x16x16_bf16 v[136:139], a[206:207], v[44:45], v[136:139]
    s_nop 0
    v_mfma_f32_16x16x16_bf16 v[124:127], a[184:185], v[44:45], v[124:127]
    v_mfma_f32_16x16x16_bf16 v[128:131], a[190:191], v[44:45], v[128:131]
    v_mfma_f32_16x16x16_bf16 v[132:135], a[200:201], v[44:45], v[132:135]
    v_mfma_f32_16x16x32_bf16 v[160:163], a[240:243], v[46:49], 0
    v_mfma_f32_16x16x32_bf16 v[164:167], a[250:253], v[50:53], 0
    v_mfma_f32_16x16x32_bf16 v[140:143], a[208:211], v[46:49], 0
    v_mfma_f32_16x16x32_bf16 v[144:147], a[212:215], v[46:49], 0
    v_mfma_f32_16x16x32_bf16 v[148:151], a[220:223], v[46:49], 0
    v_mfma_f32_16x16x32_bf16 v[152:155], a[228:231], v[50:53], 0
    v_mfma_f32_16x16x32_bf16 v[156:159], a[234:237], v[50:53], 0
    v_mfma_f32_16x16x32_bf16 v[160:163], a[244:247], v[50:53], v[160:163]
    v_mfma_f32_16x16x32_bf16 v[144:147], a[216:219], v[50:53], v[144:147]
    v_mfma_f32_16x16x32_bf16 v[148:151], a[224:227], v[50:53], v[148:151]
    v_mfma_f32_16x16x16_bf16 v[164:167], a[254:255], v[54:55], v[164:167]
    s_nop 0
    v_mfma_f32_16x16x16_bf16 v[152:155], a[232:233], v[54:55], v[152:155]
    v_mfma_f32_16x16x16_bf16 v[156:159], a[238:239], v[54:55], v[156:159]
    v_mfma_f32_16x16x16_bf16 v[160:163], a[248:249], v[54:55], v[160:163]
    v_add_f32 v132, s54, v132
    v_add_f32 v133, s54, v133
    v_add_f32 v134, s54, v134
    v_add_f32 v135, s54, v135
    v_add_f32 v136, s54, v136
    v_rcp_f32 v132, v132
    v_rcp_f32 v133, v133
    v_rcp_f32 v134, v134
    v_rcp_f32 v135, v135
    v_rcp_f32 v136, v136
    v_mul_f32 v112, v112, v132
    v_mul_f32 v113, v113, v132
    v_mul_f32 v114, v114, v132
    v_mul_f32 v115, v115, v132
    v_cvt_pk_bf16_f32 v188, v112, v113
    v_cvt_pk_bf16_f32 v189, v114, v115
    v_mul_f32 v116, v116, v133
    v_mul_f32 v117, v117, v133
    v_mul_f32 v118, v118, v133
    v_mul_f32 v119, v119, v133
    v_cvt_pk_bf16_f32 v190, v116, v117
    v_cvt_pk_bf16_f32 v191, v118, v119
    v_mul_f32 v120, v120, v134
    v_mul_f32 v121, v121, v134
    v_mul_f32 v122, v122, v134
    v_mul_f32 v123, v123, v134
    v_cvt_pk_bf16_f32 v192, v120, v121
    v_cvt_pk_bf16_f32 v193, v122, v123
    v_mul_f32 v124, v124, v135
    v_mul_f32 v125, v125, v135
    v_mul_f32 v126, v126, v135
    v_mul_f32 v127, v127, v135
    v_cvt_pk_bf16_f32 v194, v124, v125
    v_cvt_pk_bf16_f32 v195, v126, v127
    v_mul_f32 v128, v128, v136
    v_mul_f32 v129, v129, v136
    v_mul_f32 v130, v130, v136
    v_mul_f32 v131, v131, v136
    v_cvt_pk_bf16_f32 v196, v128, v129
    v_cvt_pk_bf16_f32 v197, v130, v131
    v_add_f32 v160, s54, v160
    v_add_f32 v161, s54, v161
    v_add_f32 v162, s54, v162
    v_add_f32 v163, s54, v163
    v_add_f32 v164, s54, v164
    v_rcp_f32 v160, v160
    v_rcp_f32 v161, v161
    v_rcp_f32 v162, v162
    v_rcp_f32 v163, v163
    v_rcp_f32 v164, v164
    v_mul_f32 v140, v140, v160
    v_mul_f32 v141, v141, v160
    v_mul_f32 v142, v142, v160
    v_mul_f32 v143, v143, v160
    v_cvt_pk_bf16_f32 v198, v140, v141
    v_cvt_pk_bf16_f32 v199, v142, v143
    v_mul_f32 v144, v144, v161
    v_mul_f32 v145, v145, v161
    v_mul_f32 v146, v146, v161
    v_mul_f32 v147, v147, v161
    v_cvt_pk_bf16_f32 v200, v144, v145
    v_cvt_pk_bf16_f32 v201, v146, v147
    v_mul_f32 v148, v148, v162
    v_mul_f32 v149, v149, v162
    v_mul_f32 v150, v150, v162
    v_mul_f32 v151, v151, v162
    v_cvt_pk_bf16_f32 v202, v148, v149
    v_cvt_pk_bf16_f32 v203, v150, v151
    v_mul_f32 v152, v152, v163
    v_mul_f32 v153, v153, v163
    v_mul_f32 v154, v154, v163
    v_mul_f32 v155, v155, v163
    v_cvt_pk_bf16_f32 v204, v152, v153
    v_cvt_pk_bf16_f32 v205, v154, v155
    v_mul_f32 v156, v156, v164
    v_mul_f32 v157, v157, v164
    v_mul_f32 v158, v158, v164
    v_mul_f32 v159, v159, v164
    v_cvt_pk_bf16_f32 v206, v156, v157
    v_cvt_pk_bf16_f32 v207, v158, v159
    v_add_u32 v14, s42, v13
    ds_write_b128 v14, v[168:171] offset:0
    ds_write_b128 v14, v[172:175] offset:1024
    ds_write_b128 v14, v[176:179] offset:2048
    ds_write_b128 v14, v[180:183] offset:3072
    ds_write_b128 v14, v[184:187] offset:4096
    ds_write_b128 v14, v[188:191] offset:20480
    ds_write_b128 v14, v[192:195] offset:21504
    ds_write_b128 v14, v[196:199] offset:22528
    ds_write_b128 v14, v[200:203] offset:23552
    ds_write_b128 v14, v[204:207] offset:24576
    s_waitcnt lgkmcnt(0)
    s_barrier
interleave_layers__linear_attn_block__memory_aug_recurrent_mem_tr__prompt_kernel_k3_seg:
    v_add_u32 v15, s42, v5
    ds_read_b128 v[208:211], v15 offset:0
    ds_read_b128 v[212:215], v15 offset:20480
    ds_read_b128 v[216:219], v15 offset:1024
    ds_read_b128 v[220:223], v15 offset:21504
    ds_read_b128 v[224:227], v15 offset:2048
    ds_read_b128 v[228:231], v15 offset:22528
    ds_read_b128 v[232:235], v15 offset:3072
    ds_read_b128 v[236:239], v15 offset:23552
    s_waitcnt lgkmcnt(6)
    v_mfma_f32_16x16x32_bf16 v[240:243], a[0:3], v[208:211], 0
    v_mfma_f32_16x16x32_bf16 v[244:247], a[4:7], v[208:211], 0
    v_mfma_f32_16x16x32_bf16 v[248:251], a[0:3], v[212:215], 0
    v_mfma_f32_16x16x32_bf16 v[252:255], a[4:7], v[212:215], 0
    ds_read_b128 v[208:211], v15 offset:4096
    ds_read_b128 v[212:215], v15 offset:24576
    s_waitcnt lgkmcnt(6)
    v_mfma_f32_16x16x32_bf16 v[240:243], a[8:11], v[216:219], v[240:243]
    v_mfma_f32_16x16x32_bf16 v[244:247], a[12:15], v[216:219], v[244:247]
    v_mfma_f32_16x16x32_bf16 v[248:251], a[8:11], v[220:223], v[248:251]
    v_mfma_f32_16x16x32_bf16 v[252:255], a[12:15], v[220:223], v[252:255]
    ds_read_b128 v[216:219], v15 offset:5120
    ds_read_b128 v[220:223], v15 offset:25600
    s_waitcnt lgkmcnt(6)
    v_mfma_f32_16x16x32_bf16 v[240:243], a[16:19], v[224:227], v[240:243]
    v_mfma_f32_16x16x32_bf16 v[244:247], a[20:23], v[224:227], v[244:247]
    v_mfma_f32_16x16x32_bf16 v[248:251], a[16:19], v[228:231], v[248:251]
    v_mfma_f32_16x16x32_bf16 v[252:255], a[20:23], v[228:231], v[252:255]
    ds_read_b128 v[224:227], v15 offset:6144
    ds_read_b128 v[228:231], v15 offset:26624
    s_waitcnt lgkmcnt(6)
    v_mfma_f32_16x16x32_bf16 v[240:243], a[24:27], v[232:235], v[240:243]
    v_mfma_f32_16x16x32_bf16 v[244:247], a[28:31], v[232:235], v[244:247]
    v_mfma_f32_16x16x32_bf16 v[248:251], a[24:27], v[236:239], v[248:251]
    v_mfma_f32_16x16x32_bf16 v[252:255], a[28:31], v[236:239], v[252:255]
    ds_read_b128 v[232:235], v15 offset:7168
    ds_read_b128 v[236:239], v15 offset:27648
    s_waitcnt lgkmcnt(6)
    v_mfma_f32_16x16x32_bf16 v[240:243], a[32:35], v[208:211], v[240:243]
    v_mfma_f32_16x16x32_bf16 v[244:247], a[36:39], v[208:211], v[244:247]
    v_mfma_f32_16x16x32_bf16 v[248:251], a[32:35], v[212:215], v[248:251]
    v_mfma_f32_16x16x32_bf16 v[252:255], a[36:39], v[212:215], v[252:255]
    ds_read_b128 v[208:211], v15 offset:8192
    ds_read_b128 v[212:215], v15 offset:28672
    s_waitcnt lgkmcnt(6)
    v_mfma_f32_16x16x32_bf16 v[240:243], a[40:43], v[216:219], v[240:243]
    v_mfma_f32_16x16x32_bf16 v[244:247], a[44:47], v[216:219], v[244:247]
    v_mfma_f32_16x16x32_bf16 v[248:251], a[40:43], v[220:223], v[248:251]
    v_mfma_f32_16x16x32_bf16 v[252:255], a[44:47], v[220:223], v[252:255]
    ds_read_b128 v[216:219], v15 offset:9216
    ds_read_b128 v[220:223], v15 offset:29696
    s_waitcnt lgkmcnt(6)
    v_mfma_f32_16x16x32_bf16 v[240:243], a[48:51], v[224:227], v[240:243]
    v_mfma_f32_16x16x32_bf16 v[244:247], a[52:55], v[224:227], v[244:247]
    v_mfma_f32_16x16x32_bf16 v[248:251], a[48:51], v[228:231], v[248:251]
    v_mfma_f32_16x16x32_bf16 v[252:255], a[52:55], v[228:231], v[252:255]
    ds_read_b128 v[224:227], v15 offset:10240
    ds_read_b128 v[228:231], v15 offset:30720
    s_waitcnt lgkmcnt(6)
    v_mfma_f32_16x16x32_bf16 v[240:243], a[56:59], v[232:235], v[240:243]
    v_mfma_f32_16x16x32_bf16 v[244:247], a[60:63], v[232:235], v[244:247]
    v_mfma_f32_16x16x32_bf16 v[248:251], a[56:59], v[236:239], v[248:251]
    v_mfma_f32_16x16x32_bf16 v[252:255], a[60:63], v[236:239], v[252:255]
    ds_read_b128 v[232:235], v15 offset:11264
    ds_read_b128 v[236:239], v15 offset:31744
    s_waitcnt lgkmcnt(6)
    v_mfma_f32_16x16x32_bf16 v[240:243], a[64:67], v[208:211], v[240:243]
    v_mfma_f32_16x16x32_bf16 v[244:247], a[68:71], v[208:211], v[244:247]
    v_mfma_f32_16x16x32_bf16 v[248:251], a[64:67], v[212:215], v[248:251]
    v_mfma_f32_16x16x32_bf16 v[252:255], a[68:71], v[212:215], v[252:255]
    ds_read_b128 v[208:211], v15 offset:12288
    ds_read_b128 v[212:215], v15 offset:32768
    s_waitcnt lgkmcnt(6)
    v_mfma_f32_16x16x32_bf16 v[240:243], a[72:75], v[216:219], v[240:243]
    v_mfma_f32_16x16x32_bf16 v[244:247], a[76:79], v[216:219], v[244:247]
    v_mfma_f32_16x16x32_bf16 v[248:251], a[72:75], v[220:223], v[248:251]
    v_mfma_f32_16x16x32_bf16 v[252:255], a[76:79], v[220:223], v[252:255]
    ds_read_b128 v[216:219], v15 offset:13312
    ds_read_b128 v[220:223], v15 offset:33792
    s_waitcnt lgkmcnt(6)
    v_mfma_f32_16x16x32_bf16 v[240:243], a[80:83], v[224:227], v[240:243]
    v_mfma_f32_16x16x32_bf16 v[244:247], a[84:87], v[224:227], v[244:247]
    v_mfma_f32_16x16x32_bf16 v[248:251], a[80:83], v[228:231], v[248:251]
    v_mfma_f32_16x16x32_bf16 v[252:255], a[84:87], v[228:231], v[252:255]
    ds_read_b128 v[224:227], v15 offset:14336
    ds_read_b128 v[228:231], v15 offset:34816
    s_waitcnt lgkmcnt(6)
    v_mfma_f32_16x16x32_bf16 v[240:243], a[88:91], v[232:235], v[240:243]
    v_mfma_f32_16x16x32_bf16 v[244:247], a[92:95], v[232:235], v[244:247]
    v_mfma_f32_16x16x32_bf16 v[248:251], a[88:91], v[236:239], v[248:251]
    v_mfma_f32_16x16x32_bf16 v[252:255], a[92:95], v[236:239], v[252:255]
    ds_read_b128 v[232:235], v15 offset:15360
    ds_read_b128 v[236:239], v15 offset:35840
    s_waitcnt lgkmcnt(6)
    v_mfma_f32_16x16x32_bf16 v[240:243], a[96:99], v[208:211], v[240:243]
    v_mfma_f32_16x16x32_bf16 v[244:247], a[100:103], v[208:211], v[244:247]
    v_mfma_f32_16x16x32_bf16 v[248:251], a[96:99], v[212:215], v[248:251]
    v_mfma_f32_16x16x32_bf16 v[252:255], a[100:103], v[212:215], v[252:255]
    ds_read_b128 v[208:211], v15 offset:16384
    ds_read_b128 v[212:215], v15 offset:36864
    s_waitcnt lgkmcnt(6)
    v_mfma_f32_16x16x32_bf16 v[240:243], a[104:107], v[216:219], v[240:243]
    v_mfma_f32_16x16x32_bf16 v[244:247], a[108:111], v[216:219], v[244:247]
    v_mfma_f32_16x16x32_bf16 v[248:251], a[104:107], v[220:223], v[248:251]
    v_mfma_f32_16x16x32_bf16 v[252:255], a[108:111], v[220:223], v[252:255]
    ds_read_b128 v[216:219], v15 offset:17408
    ds_read_b128 v[220:223], v15 offset:37888
    s_waitcnt lgkmcnt(6)
    v_mfma_f32_16x16x32_bf16 v[240:243], a[112:115], v[224:227], v[240:243]
    v_mfma_f32_16x16x32_bf16 v[244:247], a[116:119], v[224:227], v[244:247]
    v_mfma_f32_16x16x32_bf16 v[248:251], a[112:115], v[228:231], v[248:251]
    v_mfma_f32_16x16x32_bf16 v[252:255], a[116:119], v[228:231], v[252:255]
    ds_read_b128 v[224:227], v15 offset:18432
    ds_read_b128 v[228:231], v15 offset:38912
    s_waitcnt lgkmcnt(6)
    v_mfma_f32_16x16x32_bf16 v[240:243], a[120:123], v[232:235], v[240:243]
    v_mfma_f32_16x16x32_bf16 v[244:247], a[124:127], v[232:235], v[244:247]
    v_mfma_f32_16x16x32_bf16 v[248:251], a[120:123], v[236:239], v[248:251]
    v_mfma_f32_16x16x32_bf16 v[252:255], a[124:127], v[236:239], v[252:255]
    ds_read_b128 v[232:235], v15 offset:19456
    ds_read_b128 v[236:239], v15 offset:39936
    s_waitcnt lgkmcnt(6)
    v_mfma_f32_16x16x32_bf16 v[240:243], a[128:131], v[208:211], v[240:243]
    v_mfma_f32_16x16x32_bf16 v[244:247], a[132:135], v[208:211], v[244:247]
    v_mfma_f32_16x16x32_bf16 v[248:251], a[128:131], v[212:215], v[248:251]
    v_mfma_f32_16x16x32_bf16 v[252:255], a[132:135], v[212:215], v[252:255]
    s_waitcnt lgkmcnt(4)
    v_mfma_f32_16x16x32_bf16 v[240:243], a[136:139], v[216:219], v[240:243]
    v_mfma_f32_16x16x32_bf16 v[244:247], a[140:143], v[216:219], v[244:247]
    v_mfma_f32_16x16x32_bf16 v[248:251], a[136:139], v[220:223], v[248:251]
    v_mfma_f32_16x16x32_bf16 v[252:255], a[140:143], v[220:223], v[252:255]
    s_waitcnt lgkmcnt(2)
    v_mfma_f32_16x16x32_bf16 v[240:243], a[144:147], v[224:227], v[240:243]
    v_mfma_f32_16x16x32_bf16 v[244:247], a[148:151], v[224:227], v[244:247]
    v_mfma_f32_16x16x32_bf16 v[248:251], a[144:147], v[228:231], v[248:251]
    v_mfma_f32_16x16x32_bf16 v[252:255], a[148:151], v[228:231], v[252:255]
    s_waitcnt lgkmcnt(0)
    v_mfma_f32_16x16x32_bf16 v[240:243], a[152:155], v[232:235], v[240:243]
    v_mfma_f32_16x16x32_bf16 v[244:247], a[156:159], v[232:235], v[244:247]
    v_mfma_f32_16x16x32_bf16 v[248:251], a[152:155], v[236:239], v[248:251]
    v_mfma_f32_16x16x32_bf16 v[252:255], a[156:159], v[236:239], v[252:255]
    s_nop 4
    v_cvt_pk_bf16_f32 v208, v240, v241
    v_cvt_pk_bf16_f32 v209, v242, v243
    v_lshlrev_b32 v210, 16, v208
    v_and_b32 v211, 0xffff0000, v208
    v_lshlrev_b32 v212, 16, v96
    v_and_b32 v213, 0xffff0000, v96
    v_pk_add_f32 v[210:211], v[210:211], v[212:213]
    v_cvt_pk_bf16_f32 v216, v210, v211
    v_lshlrev_b32 v210, 16, v209
    v_and_b32 v211, 0xffff0000, v209
    v_lshlrev_b32 v212, 16, v97
    v_and_b32 v213, 0xffff0000, v97
    v_pk_add_f32 v[210:211], v[210:211], v[212:213]
    v_cvt_pk_bf16_f32 v217, v210, v211
    v_cvt_pk_bf16_f32 v208, v244, v245
    v_cvt_pk_bf16_f32 v209, v246, v247
    v_lshlrev_b32 v210, 16, v208
    v_and_b32 v211, 0xffff0000, v208
    v_lshlrev_b32 v212, 16, v98
    v_and_b32 v213, 0xffff0000, v98
    v_pk_add_f32 v[210:211], v[210:211], v[212:213]
    v_cvt_pk_bf16_f32 v218, v210, v211
    v_lshlrev_b32 v210, 16, v209
    v_and_b32 v211, 0xffff0000, v209
    v_lshlrev_b32 v212, 16, v99
    v_and_b32 v213, 0xffff0000, v99
    v_pk_add_f32 v[210:211], v[210:211], v[212:213]
    v_cvt_pk_bf16_f32 v219, v210, v211
    v_cvt_pk_bf16_f32 v208, v248, v249
    v_cvt_pk_bf16_f32 v209, v250, v251
    v_lshlrev_b32 v210, 16, v208
    v_and_b32 v211, 0xffff0000, v208
    v_lshlrev_b32 v212, 16, v100
    v_and_b32 v213, 0xffff0000, v100
    v_pk_add_f32 v[210:211], v[210:211], v[212:213]
    v_cvt_pk_bf16_f32 v220, v210, v211
    v_lshlrev_b32 v210, 16, v209
    v_and_b32 v211, 0xffff0000, v209
    v_lshlrev_b32 v212, 16, v101
    v_and_b32 v213, 0xffff0000, v101
    v_pk_add_f32 v[210:211], v[210:211], v[212:213]
    v_cvt_pk_bf16_f32 v221, v210, v211
    v_cvt_pk_bf16_f32 v208, v252, v253
    v_cvt_pk_bf16_f32 v209, v254, v255
    v_lshlrev_b32 v210, 16, v208
    v_and_b32 v211, 0xffff0000, v208
    v_lshlrev_b32 v212, 16, v102
    v_and_b32 v213, 0xffff0000, v102
    v_pk_add_f32 v[210:211], v[210:211], v[212:213]
    v_cvt_pk_bf16_f32 v222, v210, v211
    v_lshlrev_b32 v210, 16, v209
    v_and_b32 v211, 0xffff0000, v209
    v_lshlrev_b32 v212, 16, v103
    v_and_b32 v213, 0xffff0000, v103
    v_pk_add_f32 v[210:211], v[210:211], v[212:213]
    v_cvt_pk_bf16_f32 v223, v210, v211
    s_add_u32 s25, s43, 20480
    buffer_store_dwordx4 v[216:219], v12, s[8:11], s43 offen sc1
    buffer_store_dwordx4 v[220:223], v12, s[8:11], s25 offen sc1
    s_add_u32 s40, s40, 1
    s_add_u32 s43, s43, s77
    s_cmp_ge_u32 s40, s76
    s_cbranch_scc1 interleave_layers__linear_attn_block__memory_aug_recurrent_mem_tr__prompt_kernel_k3_done
    s_cmp_eq_u32 s40, 1
    s_cbranch_scc0 interleave_layers__linear_attn_block__memory_aug_recurrent_mem_tr__prompt_kernel_k3q10
    s_waitcnt vmcnt(0)
    s_barrier
    s_lshl_b32 s24, s92, 10
    s_lshl_b32 s25, s78, 2
    s_add_u32 s24, s24, s25
    s_add_u32 s24, s24, 23105536
    s_cmp_eq_u32 s3, 0
    s_cbranch_scc0 interleave_layers__linear_attn_block__memory_aug_recurrent_mem_tr__prompt_kernel_pb11
    v_lshlrev_b32 v14, 7, v1
    v_add_u32 v14, s24, v14
    v_mov_b32 v15, 2146435072
    v_cmp_le_u32 vcc, 8, v1
    s_nop 1
    v_cndmask_b32 v14, v14, v15, vcc
    v_mov_b32 v15, s40
    buffer_store_dword v15, v14, s[8:11], 0 offen sc1
interleave_layers__linear_attn_block__memory_aug_recurrent_mem_tr__prompt_kernel_pb11:
interleave_layers__linear_attn_block__memory_aug_recurrent_mem_tr__prompt_kernel_k3q10:
    s_xor_b32 s42, s42, 40960
    s_waitcnt vmcnt(2)
    v_mfma_f32_16x16x32_bf16 v[132:135], a[192:195], v[56:59], 0
    v_mfma_f32_16x16x32_bf16 v[136:139], a[202:205], v[60:63], 0
    v_mfma_f32_16x16x32_bf16 v[112:115], a[160:163], v[56:59], 0
    v_mfma_f32_16x16x32_bf16 v[116:119], a[164:167], v[56:59], 0
    v_mfma_f32_16x16x32_bf16 v[120:123], a[172:175], v[56:59], 0
    v_mfma_f32_16x16x32_bf16 v[124:127], a[180:183], v[60:63], 0
    v_mfma_f32_16x16x32_bf16 v[128:131], a[186:189], v[60:63], 0
    v_mfma_f32_16x16x32_bf16 v[132:135], a[196:199], v[60:63], v[132:135]
    v_mfma_f32_16x16x32_bf16 v[116:119], a[168:171], v[60:63], v[116:119]
    v_mfma_f32_16x16x32_bf16 v[120:123], a[176:179], v[60:63], v[120:123]
    v_mfma_f32_16x16x16_bf16 v[136:139], a[206:207], v[64:65], v[136:139]
    s_nop 0
    v_mfma_f32_16x16x16_bf16 v[124:127], a[184:185], v[64:65], v[124:127]
    v_mfma_f32_16x16x16_bf16 v[128:131], a[190:191], v[64:65], v[128:131]
    v_mfma_f32_16x16x16_bf16 v[132:135], a[200:201], v[64:65], v[132:135]
    v_mfma_f32_16x16x32_bf16 v[160:163], a[240:243], v[66:69], 0
    v_mfma_f32_16x16x32_bf16 v[164:167], a[250:253], v[70:73], 0
    v_mfma_f32_16x16x32_bf16 v[140:143], a[208:211], v[66:69], 0
    v_mfma_f32_16x16x32_bf16 v[144:147], a[212:215], v[66:69], 0
    v_mfma_f32_16x16x32_bf16 v[148:151], a[220:223], v[66:69], 0
    v_mfma_f32_16x16x32_bf16 v[152:155], a[228:231], v[70:73], 0
    v_mfma_f32_16x16x32_bf16 v[156:159], a[234:237], v[70:73], 0
    v_mfma_f32_16x16x32_bf16 v[160:163], a[244:247], v[70:73], v[160:163]
    v_mfma_f32_16x16x32_bf16 v[144:147], a[216:219], v[70:73], v[144:147]
    v_mfma_f32_16x16x32_bf16 v[148:151], a[224:227], v[70:73], v[148:151]
    v_mfma_f32_16x16x16_bf16 v[164:167], a[254:255], v[74:75], v[164:167]
    s_nop 0
    v_mfma_f32_16x16x16_bf16 v[152:155], a[232:233], v[74:75], v[152:155]
    v_mfma_f32_16x16x16_bf16 v[156:159], a[238:239], v[74:75], v[156:159]
    v_mfma_f32_16x16x16_bf16 v[160:163], a[248:249], v[74:75], v[160:163]
    v_add_f32 v132, s54, v132
    v_add_f32 v133, s54, v133
    v_add_f32 v134, s54, v134
    v_add_f32 v135, s54, v135
    v_add_f32 v136, s54, v136
    v_rcp_f32 v132, v132
    v_rcp_f32 v133, v133
    v_rcp_f32 v134, v134
    v_rcp_f32 v135, v135
    v_rcp_f32 v136, v136
    v_mul_f32 v112, v112, v132
    v_mul_f32 v113, v113, v132
    v_mul_f32 v114, v114, v132
    v_mul_f32 v115, v115, v132
    v_cvt_pk_bf16_f32 v168, v112, v113
    v_cvt_pk_bf16_f32 v169, v114, v115
    v_mul_f32 v116, v116, v133
    v_mul_f32 v117, v117, v133
    v_mul_f32 v118, v118, v133
    v_mul_f32 v119, v119, v133
    v_cvt_pk_bf16_f32 v170, v116, v117
    v_cvt_pk_bf16_f32 v171, v118, v119
    v_mul_f32 v120, v120, v134
    v_mul_f32 v121, v121, v134
    v_mul_f32 v122, v122, v134
    v_mul_f32 v123, v123, v134
    v_cvt_pk_bf16_f32 v172, v120, v121
    v_cvt_pk_bf16_f32 v173, v122, v123
    v_mul_f32 v124, v124, v135
    v_mul_f32 v125, v125, v135
    v_mul_f32 v126, v126, v135
    v_mul_f32 v127, v127, v135
    v_cvt_pk_bf16_f32 v174, v124, v125
    v_cvt_pk_bf16_f32 v175, v126, v127
    v_mul_f32 v128, v128, v136
    v_mul_f32 v129, v129, v136
    v_mul_f32 v130, v130, v136
    v_mul_f32 v131, v131, v136
    v_cvt_pk_bf16_f32 v176, v128, v129
    v_cvt_pk_bf16_f32 v177, v130, v131
    v_add_f32 v160, s54, v160
    v_add_f32 v161, s54, v161
    v_add_f32 v162, s54, v162
    v_add_f32 v163, s54, v163
    v_add_f32 v164, s54, v164
    v_rcp_f32 v160, v160
    v_rcp_f32 v161, v161
    v_rcp_f32 v162, v162
    v_rcp_f32 v163, v163
    v_rcp_f32 v164, v164
    v_mul_f32 v140, v140, v160
    v_mul_f32 v141, v141, v160
    v_mul_f32 v142, v142, v160
    v_mul_f32 v143, v143, v160
    v_cvt_pk_bf16_f32 v178, v140, v141
    v_cvt_pk_bf16_f32 v179, v142, v143
    v_mul_f32 v144, v144, v161
    v_mul_f32 v145, v145, v161
    v_mul_f32 v146, v146, v161
    v_mul_f32 v147, v147, v161
    v_cvt_pk_bf16_f32 v180, v144, v145
    v_cvt_pk_bf16_f32 v181, v146, v147
    v_mul_f32 v148, v148, v162
    v_mul_f32 v149, v149, v162
    v_mul_f32 v150, v150, v162
    v_mul_f32 v151, v151, v162
    v_cvt_pk_bf16_f32 v182, v148, v149
    v_cvt_pk_bf16_f32 v183, v150, v151
    v_mul_f32 v152, v152, v163
    v_mul_f32 v153, v153, v163
    v_mul_f32 v154, v154, v163
    v_mul_f32 v155, v155, v163
    v_cvt_pk_bf16_f32 v184, v152, v153
    v_cvt_pk_bf16_f32 v185, v154, v155
    v_mul_f32 v156, v156, v164
    v_mul_f32 v157, v157, v164
    v_mul_f32 v158, v158, v164
    v_mul_f32 v159, v159, v164
    v_cvt_pk_bf16_f32 v186, v156, v157
    v_cvt_pk_bf16_f32 v187, v158, v159
    v_mfma_f32_16x16x32_bf16 v[132:135], a[192:195], v[76:79], 0
    v_mfma_f32_16x16x32_bf16 v[136:139], a[202:205], v[80:83], 0
    v_mfma_f32_16x16x32_bf16 v[112:115], a[160:163], v[76:79], 0
    v_mfma_f32_16x16x32_bf16 v[116:119], a[164:167], v[76:79], 0
    v_mfma_f32_16x16x32_bf16 v[120:123], a[172:175], v[76:79], 0
    v_mfma_f32_16x16x32_bf16 v[124:127], a[180:183], v[80:83], 0
    v_mfma_f32_16x16x32_bf16 v[128:131], a[186:189], v[80:83], 0
    v_mfma_f32_16x16x32_bf16 v[132:135], a[196:199], v[80:83], v[132:135]
    v_mfma_f32_16x16x32_bf16 v[116:119], a[168:171], v[80:83], v[116:119]
    v_mfma_f32_16x16x32_bf16 v[120:123], a[176:179], v[80:83], v[120:123]
    v_mfma_f32_16x16x16_bf16 v[136:139], a[206:207], v[84:85], v[136:139]
    s_nop 0
    v_mfma_f32_16x16x16_bf16 v[124:127], a[184:185], v[84:85], v[124:127]
    v_mfma_f32_16x16x16_bf16 v[128:131], a[190:191], v[84:85], v[128:131]
    v_mfma_f32_16x16x16_bf16 v[132:135], a[200:201], v[84:85], v[132:135]
    v_mfma_f32_16x16x32_bf16 v[160:163], a[240:243], v[86:89], 0
    v_mfma_f32_16x16x32_bf16 v[164:167], a[250:253], v[90:93], 0
    v_mfma_f32_16x16x32_bf16 v[140:143], a[208:211], v[86:89], 0
    v_mfma_f32_16x16x32_bf16 v[144:147], a[212:215], v[86:89], 0
    v_mfma_f32_16x16x32_bf16 v[148:151], a[220:223], v[86:89], 0
    v_mfma_f32_16x16x32_bf16 v[152:155], a[228:231], v[90:93], 0
    v_mfma_f32_16x16x32_bf16 v[156:159], a[234:237], v[90:93], 0
    v_mfma_f32_16x16x32_bf16 v[160:163], a[244:247], v[90:93], v[160:163]
    v_mfma_f32_16x16x32_bf16 v[144:147], a[216:219], v[90:93], v[144:147]
    v_mfma_f32_16x16x32_bf16 v[148:151], a[224:227], v[90:93], v[148:151]
    v_mfma_f32_16x16x16_bf16 v[164:167], a[254:255], v[94:95], v[164:167]
    s_nop 0
    v_mfma_f32_16x16x16_bf16 v[152:155], a[232:233], v[94:95], v[152:155]
    v_mfma_f32_16x16x16_bf16 v[156:159], a[238:239], v[94:95], v[156:159]
    v_mfma_f32_16x16x16_bf16 v[160:163], a[248:249], v[94:95], v[160:163]
    v_add_f32 v132, s54, v132
    v_add_f32 v133, s54, v133
    v_add_f32 v134, s54, v134
    v_add_f32 v135, s54, v135
    v_add_f32 v136, s54, v136
    v_rcp_f32 v132, v132
    v_rcp_f32 v133, v133
    v_rcp_f32 v134, v134
    v_rcp_f32 v135, v135
    v_rcp_f32 v136, v136
    v_mul_f32 v112, v112, v132
    v_mul_f32 v113, v113, v132
    v_mul_f32 v114, v114, v132
    v_mul_f32 v115, v115, v132
    v_cvt_pk_bf16_f32 v188, v112, v113
    v_cvt_pk_bf16_f32 v189, v114, v115
    v_mul_f32 v116, v116, v133
    v_mul_f32 v117, v117, v133
    v_mul_f32 v118, v118, v133
    v_mul_f32 v119, v119, v133
    v_cvt_pk_bf16_f32 v190, v116, v117
    v_cvt_pk_bf16_f32 v191, v118, v119
    v_mul_f32 v120, v120, v134
    v_mul_f32 v121, v121, v134
    v_mul_f32 v122, v122, v134
    v_mul_f32 v123, v123, v134
    v_cvt_pk_bf16_f32 v192, v120, v121
    v_cvt_pk_bf16_f32 v193, v122, v123
    v_mul_f32 v124, v124, v135
    v_mul_f32 v125, v125, v135
    v_mul_f32 v126, v126, v135
    v_mul_f32 v127, v127, v135
    v_cvt_pk_bf16_f32 v194, v124, v125
    v_cvt_pk_bf16_f32 v195, v126, v127
    v_mul_f32 v128, v128, v136
    v_mul_f32 v129, v129, v136
    v_mul_f32 v130, v130, v136
    v_mul_f32 v131, v131, v136
    v_cvt_pk_bf16_f32 v196, v128, v129
    v_cvt_pk_bf16_f32 v197, v130, v131
    v_add_f32 v160, s54, v160
    v_add_f32 v161, s54, v161
    v_add_f32 v162, s54, v162
    v_add_f32 v163, s54, v163
    v_add_f32 v164, s54, v164
    v_rcp_f32 v160, v160
    v_rcp_f32 v161, v161
    v_rcp_f32 v162, v162
    v_rcp_f32 v163, v163
    v_rcp_f32 v164, v164
    v_mul_f32 v140, v140, v160
    v_mul_f32 v141, v141, v160
    v_mul_f32 v142, v142, v160
    v_mul_f32 v143, v143, v160
    v_cvt_pk_bf16_f32 v198, v140, v141
    v_cvt_pk_bf16_f32 v199, v142, v143
    v_mul_f32 v144, v144, v161
    v_mul_f32 v145, v145, v161
    v_mul_f32 v146, v146, v161
    v_mul_f32 v147, v147, v161
    v_cvt_pk_bf16_f32 v200, v144, v145
    v_cvt_pk_bf16_f32 v201, v146, v147
    v_mul_f32 v148, v148, v162
    v_mul_f32 v149, v149, v162
    v_mul_f32 v150, v150, v162
    v_mul_f32 v151, v151, v162
    v_cvt_pk_bf16_f32 v202, v148, v149
    v_cvt_pk_bf16_f32 v203, v150, v151
    v_mul_f32 v152, v152, v163
    v_mul_f32 v153, v153, v163
    v_mul_f32 v154, v154, v163
    v_mul_f32 v155, v155, v163
    v_cvt_pk_bf16_f32 v204, v152, v153
    v_cvt_pk_bf16_f32 v205, v154, v155
    v_mul_f32 v156, v156, v164
    v_mul_f32 v157, v157, v164
    v_mul_f32 v158, v158, v164
    v_mul_f32 v159, v159, v164
    v_cvt_pk_bf16_f32 v206, v156, v157
    v_cvt_pk_bf16_f32 v207, v158, v159
    v_add_u32 v14, s42, v13
    ds_write_b128 v14, v[168:171] offset:0
    ds_write_b128 v14, v[172:175] offset:1024
    ds_write_b128 v14, v[176:179] offset:2048
    ds_write_b128 v14, v[180:183] offset:3072
    ds_write_b128 v14, v[184:187] offset:4096
    ds_write_b128 v14, v[188:191] offset:20480
    ds_write_b128 v14, v[192:195] offset:21504
    ds_write_b128 v14, v[196:199] offset:22528
    ds_write_b128 v14, v[200:203] offset:23552
    ds_write_b128 v14, v[204:207] offset:24576
    s_add_u32 s41, s43, s77
    s_add_u32 s24, s40, 1
    s_cmp_lt_u32 s24, s76
    s_cselect_b32 s41, s41, 2146435072
    s_waitcnt vmcnt(0)
    s_add_u32 s25, s41, 20480
    buffer_load_dwordx4 v[16:19], v8, s[8:11], s41 offen offset:0 sc1
    buffer_load_dwordx4 v[20:23], v8, s[8:11], s41 offen offset:1024 sc1
    buffer_load_dwordx2 v[24:25], v9, s[8:11], s41 offen offset:0 sc1
    buffer_load_dwordx4 v[26:29], v8, s[8:11], s41 offen offset:2560 sc1
    buffer_load_dwordx4 v[30:33], v8, s[8:11], s41 offen offset:3584 sc1
    buffer_load_dwordx2 v[34:35], v9, s[8:11], s41 offen offset:2560 sc1
    buffer_load_dwordx4 v[36:39], v8, s[8:11], s25 offen offset:0 sc1
    buffer_load_dwordx4 v[40:43], v8, s[8:11], s25 offen offset:1024 sc1
    buffer_load_dwordx2 v[44:45], v9, s[8:11], s25 offen offset:0 sc1
    buffer_load_dwordx4 v[46:49], v8, s[8:11], s25 offen offset:2560 sc1
    buffer_load_dwordx4 v[50:53], v8, s[8:11], s25 offen offset:3584 sc1
    buffer_load_dwordx2 v[54:55], v9, s[8:11], s25 offen offset:2560 sc1
    buffer_load_dwordx2 v[96:97], v10, s[16:19], s41 offen sc1
    buffer_load_dwordx2 v[98:99], v11, s[16:19], s41 offen sc1
    buffer_load_dwordx2 v[100:101], v10, s[16:19], s25 offen sc1
    buffer_load_dwordx2 v[102:103], v11, s[16:19], s25 offen sc1
    s_waitcnt lgkmcnt(0)
    s_barrier
    s_lshl_b32 s24, s92, 10
    s_lshl_b32 s25, s78, 2
    s_add_u32 s24, s24, s25
    s_add_u32 s24, s24, 23105536
    s_cmp_eq_u32 s3, 0
    s_cbranch_scc0 interleave_layers__linear_attn_block__memory_aug_recurrent_mem_tr__prompt_kernel_pb12
    v_lshlrev_b32 v14, 7, v1
    v_add_u32 v14, s24, v14
    v_mov_b32 v15, 2146435072
    v_cmp_le_u32 vcc, 8, v1
    s_nop 1
    v_cndmask_b32 v14, v14, v15, vcc
    v_mov_b32 v15, s40
    buffer_store_dword v15, v14, s[8:11], 0 offen sc1
interleave_layers__linear_attn_block__memory_aug_recurrent_mem_tr__prompt_kernel_pb12:
    v_add_u32 v15, s42, v5
    ds_read_b128 v[208:211], v15 offset:0
    ds_read_b128 v[212:215], v15 offset:20480
    ds_read_b128 v[216:219], v15 offset:1024
    ds_read_b128 v[220:223], v15 offset:21504
    ds_read_b128 v[224:227], v15 offset:2048
    ds_read_b128 v[228:231], v15 offset:22528
    ds_read_b128 v[232:235], v15 offset:3072
    ds_read_b128 v[236:239], v15 offset:23552
    s_waitcnt lgkmcnt(6)
    v_mfma_f32_16x16x32_bf16 v[240:243], a[0:3], v[208:211], 0
    v_mfma_f32_16x16x32_bf16 v[244:247], a[4:7], v[208:211], 0
    v_mfma_f32_16x16x32_bf16 v[248:251], a[0:3], v[212:215], 0
    v_mfma_f32_16x16x32_bf16 v[252:255], a[4:7], v[212:215], 0
    ds_read_b128 v[208:211], v15 offset:4096
    ds_read_b128 v[212:215], v15 offset:24576
    s_waitcnt lgkmcnt(6)
    v_mfma_f32_16x16x32_bf16 v[240:243], a[8:11], v[216:219], v[240:243]
    v_mfma_f32_16x16x32_bf16 v[244:247], a[12:15], v[216:219], v[244:247]
    v_mfma_f32_16x16x32_bf16 v[248:251], a[8:11], v[220:223], v[248:251]
    v_mfma_f32_16x16x32_bf16 v[252:255], a[12:15], v[220:223], v[252:255]
    ds_read_b128 v[216:219], v15 offset:5120
    ds_read_b128 v[220:223], v15 offset:25600
    s_waitcnt lgkmcnt(6)
    v_mfma_f32_16x16x32_bf16 v[240:243], a[16:19], v[224:227], v[240:243]
    v_mfma_f32_16x16x32_bf16 v[244:247], a[20:23], v[224:227], v[244:247]
    v_mfma_f32_16x16x32_bf16 v[248:251], a[16:19], v[228:231], v[248:251]
    v_mfma_f32_16x16x32_bf16 v[252:255], a[20:23], v[228:231], v[252:255]
    ds_read_b128 v[224:227], v15 offset:6144
    ds_read_b128 v[228:231], v15 offset:26624
    s_waitcnt lgkmcnt(6)
    v_mfma_f32_16x16x32_bf16 v[240:243], a[24:27], v[232:235], v[240:243]
    v_mfma_f32_16x16x32_bf16 v[244:247], a[28:31], v[232:235], v[244:247]
    v_mfma_f32_16x16x32_bf16 v[248:251], a[24:27], v[236:239], v[248:251]
    v_mfma_f32_16x16x32_bf16 v[252:255], a[28:31], v[236:239], v[252:255]
    ds_read_b128 v[232:235], v15 offset:7168
    ds_read_b128 v[236:239], v15 offset:27648
    s_waitcnt lgkmcnt(6)
    v_mfma_f32_16x16x32_bf16 v[240:243], a[32:35], v[208:211], v[240:243]
    v_mfma_f32_16x16x32_bf16 v[244:247], a[36:39], v[208:211], v[244:247]
    v_mfma_f32_16x16x32_bf16 v[248:251], a[32:35], v[212:215], v[248:251]
    v_mfma_f32_16x16x32_bf16 v[252:255], a[36:39], v[212:215], v[252:255]
    ds_read_b128 v[208:211], v15 offset:8192
    ds_read_b128 v[212:215], v15 offset:28672
    s_waitcnt lgkmcnt(6)
    v_mfma_f32_16x16x32_bf16 v[240:243], a[40:43], v[216:219], v[240:243]
    v_mfma_f32_16x16x32_bf16 v[244:247], a[44:47], v[216:219], v[244:247]
    v_mfma_f32_16x16x32_bf16 v[248:251], a[40:43], v[220:223], v[248:251]
    v_mfma_f32_16x16x32_bf16 v[252:255], a[44:47], v[220:223], v[252:255]
    ds_read_b128 v[216:219], v15 offset:9216
    ds_read_b128 v[220:223], v15 offset:29696
    s_waitcnt lgkmcnt(6)
    v_mfma_f32_16x16x32_bf16 v[240:243], a[48:51], v[224:227], v[240:243]
    v_mfma_f32_16x16x32_bf16 v[244:247], a[52:55], v[224:227], v[244:247]
    v_mfma_f32_16x16x32_bf16 v[248:251], a[48:51], v[228:231], v[248:251]
    v_mfma_f32_16x16x32_bf16 v[252:255], a[52:55], v[228:231], v[252:255]
    ds_read_b128 v[224:227], v15 offset:10240
    ds_read_b128 v[228:231], v15 offset:30720
    s_waitcnt lgkmcnt(6)
    v_mfma_f32_16x16x32_bf16 v[240:243], a[56:59], v[232:235], v[240:243]
    v_mfma_f32_16x16x32_bf16 v[244:247], a[60:63], v[232:235], v[244:247]
    v_mfma_f32_16x16x32_bf16 v[248:251], a[56:59], v[236:239], v[248:251]
    v_mfma_f32_16x16x32_bf16 v[252:255], a[60:63], v[236:239], v[252:255]
    ds_read_b128 v[232:235], v15 offset:11264
    ds_read_b128 v[236:239], v15 offset:31744
    s_waitcnt lgkmcnt(6)
    v_mfma_f32_16x16x32_bf16 v[240:243], a[64:67], v[208:211], v[240:243]
    v_mfma_f32_16x16x32_bf16 v[244:247], a[68:71], v[208:211], v[244:247]
    v_mfma_f32_16x16x32_bf16 v[248:251], a[64:67], v[212:215], v[248:251]
    v_mfma_f32_16x16x32_bf16 v[252:255], a[68:71], v[212:215], v[252:255]
    ds_read_b128 v[208:211], v15 offset:12288
    ds_read_b128 v[212:215], v15 offset:32768
    s_waitcnt lgkmcnt(6)
    v_mfma_f32_16x16x32_bf16 v[240:243], a[72:75], v[216:219], v[240:243]
    v_mfma_f32_16x16x32_bf16 v[244:247], a[76:79], v[216:219], v[244:247]
    v_mfma_f32_16x16x32_bf16 v[248:251], a[72:75], v[220:223], v[248:251]
    v_mfma_f32_16x16x32_bf16 v[252:255], a[76:79], v[220:223], v[252:255]
    ds_read_b128 v[216:219], v15 offset:13312
    ds_read_b128 v[220:223], v15 offset:33792
    s_waitcnt lgkmcnt(6)
    v_mfma_f32_16x16x32_bf16 v[240:243], a[80:83], v[224:227], v[240:243]
    v_mfma_f32_16x16x32_bf16 v[244:247], a[84:87], v[224:227], v[244:247]
    v_mfma_f32_16x16x32_bf16 v[248:251], a[80:83], v[228:231], v[248:251]
    v_mfma_f32_16x16x32_bf16 v[252:255], a[84:87], v[228:231], v[252:255]
    ds_read_b128 v[224:227], v15 offset:14336
    ds_read_b128 v[228:231], v15 offset:34816
    s_waitcnt lgkmcnt(6)
    v_mfma_f32_16x16x32_bf16 v[240:243], a[88:91], v[232:235], v[240:243]
    v_mfma_f32_16x16x32_bf16 v[244:247], a[92:95], v[232:235], v[244:247]
    v_mfma_f32_16x16x32_bf16 v[248:251], a[88:91], v[236:239], v[248:251]
    v_mfma_f32_16x16x32_bf16 v[252:255], a[92:95], v[236:239], v[252:255]
    ds_read_b128 v[232:235], v15 offset:15360
    ds_read_b128 v[236:239], v15 offset:35840
    s_waitcnt lgkmcnt(6)
    v_mfma_f32_16x16x32_bf16 v[240:243], a[96:99], v[208:211], v[240:243]
    v_mfma_f32_16x16x32_bf16 v[244:247], a[100:103], v[208:211], v[244:247]
    v_mfma_f32_16x16x32_bf16 v[248:251], a[96:99], v[212:215], v[248:251]
    v_mfma_f32_16x16x32_bf16 v[252:255], a[100:103], v[212:215], v[252:255]
    ds_read_b128 v[208:211], v15 offset:16384
    ds_read_b128 v[212:215], v15 offset:36864
    s_waitcnt lgkmcnt(6)
    v_mfma_f32_16x16x32_bf16 v[240:243], a[104:107], v[216:219], v[240:243]
    v_mfma_f32_16x16x32_bf16 v[244:247], a[108:111], v[216:219], v[244:247]
    v_mfma_f32_16x16x32_bf16 v[248:251], a[104:107], v[220:223], v[248:251]
    v_mfma_f32_16x16x32_bf16 v[252:255], a[108:111], v[220:223], v[252:255]
    ds_read_b128 v[216:219], v15 offset:17408
    ds_read_b128 v[220:223], v15 offset:37888
    s_waitcnt lgkmcnt(6)
    v_mfma_f32_16x16x32_bf16 v[240:243], a[112:115], v[224:227], v[240:243]
    v_mfma_f32_16x16x32_bf16 v[244:247], a[116:119], v[224:227], v[244:247]
    v_mfma_f32_16x16x32_bf16 v[248:251], a[112:115], v[228:231], v[248:251]
    v_mfma_f32_16x16x32_bf16 v[252:255], a[116:119], v[228:231], v[252:255]
    ds_read_b128 v[224:227], v15 offset:18432
    ds_read_b128 v[228:231], v15 offset:38912
    s_waitcnt lgkmcnt(6)
    v_mfma_f32_16x16x32_bf16 v[240:243], a[120:123], v[232:235], v[240:243]
    v_mfma_f32_16x16x32_bf16 v[244:247], a[124:127], v[232:235], v[244:247]
    v_mfma_f32_16x16x32_bf16 v[248:251], a[120:123], v[236:239], v[248:251]
    v_mfma_f32_16x16x32_bf16 v[252:255], a[124:127], v[236:239], v[252:255]
    ds_read_b128 v[232:235], v15 offset:19456
    ds_read_b128 v[236:239], v15 offset:39936
    s_waitcnt lgkmcnt(6)
    v_mfma_f32_16x16x32_bf16 v[240:243], a[128:131], v[208:211], v[240:243]
    v_mfma_f32_16x16x32_bf16 v[244:247], a[132:135], v[208:211], v[244:247]
    v_mfma_f32_16x16x32_bf16 v[248:251], a[128:131], v[212:215], v[248:251]
    v_mfma_f32_16x16x32_bf16 v[252:255], a[132:135], v[212:215], v[252:255]
    s_waitcnt lgkmcnt(4)
    v_mfma_f32_16x16x32_bf16 v[240:243], a[136:139], v[216:219], v[240:243]
    v_mfma_f32_16x16x32_bf16 v[244:247], a[140:143], v[216:219], v[244:247]
    v_mfma_f32_16x16x32_bf16 v[248:251], a[136:139], v[220:223], v[248:251]
    v_mfma_f32_16x16x32_bf16 v[252:255], a[140:143], v[220:223], v[252:255]
    s_waitcnt lgkmcnt(2)
    v_mfma_f32_16x16x32_bf16 v[240:243], a[144:147], v[224:227], v[240:243]
    v_mfma_f32_16x16x32_bf16 v[244:247], a[148:151], v[224:227], v[244:247]
    v_mfma_f32_16x16x32_bf16 v[248:251], a[144:147], v[228:231], v[248:251]
    v_mfma_f32_16x16x32_bf16 v[252:255], a[148:151], v[228:231], v[252:255]
    s_waitcnt lgkmcnt(0)
    v_mfma_f32_16x16x32_bf16 v[240:243], a[152:155], v[232:235], v[240:243]
    v_mfma_f32_16x16x32_bf16 v[244:247], a[156:159], v[232:235], v[244:247]
    v_mfma_f32_16x16x32_bf16 v[248:251], a[152:155], v[236:239], v[248:251]
    v_mfma_f32_16x16x32_bf16 v[252:255], a[156:159], v[236:239], v[252:255]
    s_nop 4
    v_cvt_pk_bf16_f32 v208, v240, v241
    v_cvt_pk_bf16_f32 v209, v242, v243
    v_lshlrev_b32 v210, 16, v208
    v_and_b32 v211, 0xffff0000, v208
    v_lshlrev_b32 v212, 16, v104
    v_and_b32 v213, 0xffff0000, v104
    v_pk_add_f32 v[210:211], v[210:211], v[212:213]
    v_cvt_pk_bf16_f32 v216, v210, v211
    v_lshlrev_b32 v210, 16, v209
    v_and_b32 v211, 0xffff0000, v209
    v_lshlrev_b32 v212, 16, v105
    v_and_b32 v213, 0xffff0000, v105
    v_pk_add_f32 v[210:211], v[210:211], v[212:213]
    v_cvt_pk_bf16_f32 v217, v210, v211
    v_cvt_pk_bf16_f32 v208, v244, v245
    v_cvt_pk_bf16_f32 v209, v246, v247
    v_lshlrev_b32 v210, 16, v208
    v_and_b32 v211, 0xffff0000, v208
    v_lshlrev_b32 v212, 16, v106
    v_and_b32 v213, 0xffff0000, v106
    v_pk_add_f32 v[210:211], v[210:211], v[212:213]
    v_cvt_pk_bf16_f32 v218, v210, v211
    v_lshlrev_b32 v210, 16, v209
    v_and_b32 v211, 0xffff0000, v209
    v_lshlrev_b32 v212, 16, v107
    v_and_b32 v213, 0xffff0000, v107
    v_pk_add_f32 v[210:211], v[210:211], v[212:213]
    v_cvt_pk_bf16_f32 v219, v210, v211
    v_cvt_pk_bf16_f32 v208, v248, v249
    v_cvt_pk_bf16_f32 v209, v250, v251
    v_lshlrev_b32 v210, 16, v208
    v_and_b32 v211, 0xffff0000, v208
    v_lshlrev_b32 v212, 16, v108
    v_and_b32 v213, 0xffff0000, v108
    v_pk_add_f32 v[210:211], v[210:211], v[212:213]
    v_cvt_pk_bf16_f32 v220, v210, v211
    v_lshlrev_b32 v210, 16, v209
    v_and_b32 v211, 0xffff0000, v209
    v_lshlrev_b32 v212, 16, v109
    v_and_b32 v213, 0xffff0000, v109
    v_pk_add_f32 v[210:211], v[210:211], v[212:213]
    v_cvt_pk_bf16_f32 v221, v210, v211
    v_cvt_pk_bf16_f32 v208, v252, v253
    v_cvt_pk_bf16_f32 v209, v254, v255
    v_lshlrev_b32 v210, 16, v208
    v_and_b32 v211, 0xffff0000, v208
    v_lshlrev_b32 v212, 16, v110
    v_and_b32 v213, 0xffff0000, v110
    v_pk_add_f32 v[210:211], v[210:211], v[212:213]
    v_cvt_pk_bf16_f32 v222, v210, v211
    v_lshlrev_b32 v210, 16, v209
    v_and_b32 v211, 0xffff0000, v209
    v_lshlrev_b32 v212, 16, v111
    v_and_b32 v213, 0xffff0000, v111
    v_pk_add_f32 v[210:211], v[210:211], v[212:213]
    v_cvt_pk_bf16_f32 v223, v210, v211
    s_add_u32 s25, s43, 20480
    buffer_store_dwordx4 v[216:219], v12, s[8:11], s43 offen sc1
    buffer_store_dwordx4 v[220:223], v12, s[8:11], s25 offen sc1
    s_add_u32 s40, s40, 1
    s_add_u32 s43, s43, s77
    s_cmp_ge_u32 s40, s76
    s_cbranch_scc1 interleave_layers__linear_attn_block__memory_aug_recurrent_mem_tr__prompt_kernel_k3_done
    s_xor_b32 s42, s42, 40960
    s_waitcnt vmcnt(2)
    v_mfma_f32_16x16x32_bf16 v[132:135], a[192:195], v[16:19], 0
    v_mfma_f32_16x16x32_bf16 v[136:139], a[202:205], v[20:23], 0
    v_mfma_f32_16x16x32_bf16 v[112:115], a[160:163], v[16:19], 0
    v_mfma_f32_16x16x32_bf16 v[116:119], a[164:167], v[16:19], 0
    v_mfma_f32_16x16x32_bf16 v[120:123], a[172:175], v[16:19], 0
    v_mfma_f32_16x16x32_bf16 v[124:127], a[180:183], v[20:23], 0
    v_mfma_f32_16x16x32_bf16 v[128:131], a[186:189], v[20:23], 0
    v_mfma_f32_16x16x32_bf16 v[132:135], a[196:199], v[20:23], v[132:135]
    v_mfma_f32_16x16x32_bf16 v[116:119], a[168:171], v[20:23], v[116:119]
    v_mfma_f32_16x16x32_bf16 v[120:123], a[176:179], v[20:23], v[120:123]
    v_mfma_f32_16x16x16_bf16 v[136:139], a[206:207], v[24:25], v[136:139]
    s_nop 0
    v_mfma_f32_16x16x16_bf16 v[124:127], a[184:185], v[24:25], v[124:127]
    v_mfma_f32_16x16x16_bf16 v[128:131], a[190:191], v[24:25], v[128:131]
    v_mfma_f32_16x16x16_bf16 v[132:135], a[200:201], v[24:25], v[132:135]
    v_mfma_f32_16x16x32_bf16 v[160:163], a[240:243], v[26:29], 0
    v_mfma_f32_16x16x32_bf16 v[164:167], a[250:253], v[30:33], 0
    v_mfma_f32_16x16x32_bf16 v[140:143], a[208:211], v[26:29], 0
    v_mfma_f32_16x16x32_bf16 v[144:147], a[212:215], v[26:29], 0
    v_mfma_f32_16x16x32_bf16 v[148:151], a[220:223], v[26:29], 0
    v_mfma_f32_16x16x32_bf16 v[152:155], a[228:231], v[30:33], 0
    v_mfma_f32_16x16x32_bf16 v[156:159], a[234:237], v[30:33], 0
    v_mfma_f32_16x16x32_bf16 v[160:163], a[244:247], v[30:33], v[160:163]
    v_mfma_f32_16x16x32_bf16 v[144:147], a[216:219], v[30:33], v[144:147]
    v_mfma_f32_16x16x32_bf16 v[148:151], a[224:227], v[30:33], v[148:151]
    v_mfma_f32_16x16x16_bf16 v[164:167], a[254:255], v[34:35], v[164:167]
    s_nop 0
    v_mfma_f32_16x16x16_bf16 v[152:155], a[232:233], v[34:35], v[152:155]
    v_mfma_f32_16x16x16_bf16 v[156:159], a[238:239], v[34:35], v[156:159]
    v_mfma_f32_16x16x16_bf16 v[160:163], a[248:249], v[34:35], v[160:163]
    v_add_f32 v132, s54, v132
    v_add_f32 v133, s54, v133
    v_add_f32 v134, s54, v134
    v_add_f32 v135, s54, v135
    v_add_f32 v136, s54, v136
    v_rcp_f32 v132, v132
    v_rcp_f32 v133, v133
    v_rcp_f32 v134, v134
    v_rcp_f32 v135, v135
    v_rcp_f32 v136, v136
    v_mul_f32 v112, v112, v132
    v_mul_f32 v113, v113, v132
    v_mul_f32 v114, v114, v132
    v_mul_f32 v115, v115, v132
    v_cvt_pk_bf16_f32 v168, v112, v113
    v_cvt_pk_bf16_f32 v169, v114, v115
    v_mul_f32 v116, v116, v133
    v_mul_f32 v117, v117, v133
    v_mul_f32 v118, v118, v133
    v_mul_f32 v119, v119, v133
    v_cvt_pk_bf16_f32 v170, v116, v117
    v_cvt_pk_bf16_f32 v171, v118, v119
    v_mul_f32 v120, v120, v134
    v_mul_f32 v121, v121, v134
    v_mul_f32 v122, v122, v134
    v_mul_f32 v123, v123, v134
    v_cvt_pk_bf16_f32 v172, v120, v121
    v_cvt_pk_bf16_f32 v173, v122, v123
    v_mul_f32 v124, v124, v135
    v_mul_f32 v125, v125, v135
    v_mul_f32 v126, v126, v135
    v_mul_f32 v127, v127, v135
    v_cvt_pk_bf16_f32 v174, v124, v125
    v_cvt_pk_bf16_f32 v175, v126, v127
    v_mul_f32 v128, v128, v136
    v_mul_f32 v129, v129, v136
    v_mul_f32 v130, v130, v136
    v_mul_f32 v131, v131, v136
    v_cvt_pk_bf16_f32 v176, v128, v129
    v_cvt_pk_bf16_f32 v177, v130, v131
    v_add_f32 v160, s54, v160
    v_add_f32 v161, s54, v161
    v_add_f32 v162, s54, v162
    v_add_f32 v163, s54, v163
    v_add_f32 v164, s54, v164
    v_rcp_f32 v160, v160
    v_rcp_f32 v161, v161
    v_rcp_f32 v162, v162
    v_rcp_f32 v163, v163
    v_rcp_f32 v164, v164
    v_mul_f32 v140, v140, v160
    v_mul_f32 v141, v141, v160
    v_mul_f32 v142, v142, v160
    v_mul_f32 v143, v143, v160
    v_cvt_pk_bf16_f32 v178, v140, v141
    v_cvt_pk_bf16_f32 v179, v142, v143
    v_mul_f32 v144, v144, v161
    v_mul_f32 v145, v145, v161
    v_mul_f32 v146, v146, v161
    v_mul_f32 v147, v147, v161
    v_cvt_pk_bf16_f32 v180, v144, v145
    v_cvt_pk_bf16_f32 v181, v146, v147
    v_mul_f32 v148, v148, v162
    v_mul_f32 v149, v149, v162
    v_mul_f32 v150, v150, v162
    v_mul_f32 v151, v151, v162
    v_cvt_pk_bf16_f32 v182, v148, v149
    v_cvt_pk_bf16_f32 v183, v150, v151
    v_mul_f32 v152, v152, v163
    v_mul_f32 v153, v153, v163
    v_mul_f32 v154, v154, v163
    v_mul_f32 v155, v155, v163
    v_cvt_pk_bf16_f32 v184, v152, v153
    v_cvt_pk_bf16_f32 v185, v154, v155
    v_mul_f32 v156, v156, v164
    v_mul_f32 v157, v157, v164
    v_mul_f32 v158, v158, v164
    v_mul_f32 v159, v159, v164
    v_cvt_pk_bf16_f32 v186, v156, v157
    v_cvt_pk_bf16_f32 v187, v158, v159
    v_mfma_f32_16x16x32_bf16 v[132:135], a[192:195], v[36:39], 0
    v_mfma_f32_16x16x32_bf16 v[136:139], a[202:205], v[40:43], 0
    v_mfma_f32_16x16x32_bf16 v[112:115], a[160:163], v[36:39], 0
    v_mfma_f32_16x16x32_bf16 v[116:119], a[164:167], v[36:39], 0
    v_mfma_f32_16x16x32_bf16 v[120:123], a[172:175], v[36:39], 0
    v_mfma_f32_16x16x32_bf16 v[124:127], a[180:183], v[40:43], 0
    v_mfma_f32_16x16x32_bf16 v[128:131], a[186:189], v[40:43], 0
    v_mfma_f32_16x16x32_bf16 v[132:135], a[196:199], v[40:43], v[132:135]
    v_mfma_f32_16x16x32_bf16 v[116:119], a[168:171], v[40:43], v[116:119]
    v_mfma_f32_16x16x32_bf16 v[120:123], a[176:179], v[40:43], v[120:123]
    v_mfma_f32_16x16x16_bf16 v[136:139], a[206:207], v[44:45], v[136:139]
    s_nop 0
    v_mfma_f32_16x16x16_bf16 v[124:127], a[184:185], v[44:45], v[124:127]
    v_mfma_f32_16x16x16_bf16 v[128:131], a[190:191], v[44:45], v[128:131]
    v_mfma_f32_16x16x16_bf16 v[132:135], a[200:201], v[44:45], v[132:135]
    v_mfma_f32_16x16x32_bf16 v[160:163], a[240:243], v[46:49], 0
    v_mfma_f32_16x16x32_bf16 v[164:167], a[250:253], v[50:53], 0
    v_mfma_f32_16x16x32_bf16 v[140:143], a[208:211], v[46:49], 0
    v_mfma_f32_16x16x32_bf16 v[144:147], a[212:215], v[46:49], 0
    v_mfma_f32_16x16x32_bf16 v[148:151], a[220:223], v[46:49], 0
    v_mfma_f32_16x16x32_bf16 v[152:155], a[228:231], v[50:53], 0
    v_mfma_f32_16x16x32_bf16 v[156:159], a[234:237], v[50:53], 0
    v_mfma_f32_16x16x32_bf16 v[160:163], a[244:247], v[50:53], v[160:163]
    v_mfma_f32_16x16x32_bf16 v[144:147], a[216:219], v[50:53], v[144:147]
    v_mfma_f32_16x16x32_bf16 v[148:151], a[224:227], v[50:53], v[148:151]
    v_mfma_f32_16x16x16_bf16 v[164:167], a[254:255], v[54:55], v[164:167]
    s_nop 0
    v_mfma_f32_16x16x16_bf16 v[152:155], a[232:233], v[54:55], v[152:155]
    v_mfma_f32_16x16x16_bf16 v[156:159], a[238:239], v[54:55], v[156:159]
    v_mfma_f32_16x16x16_bf16 v[160:163], a[248:249], v[54:55], v[160:163]
    v_add_f32 v132, s54, v132
    v_add_f32 v133, s54, v133
    v_add_f32 v134, s54, v134
    v_add_f32 v135, s54, v135
    v_add_f32 v136, s54, v136
    v_rcp_f32 v132, v132
    v_rcp_f32 v133, v133
    v_rcp_f32 v134, v134
    v_rcp_f32 v135, v135
    v_rcp_f32 v136, v136
    v_mul_f32 v112, v112, v132
    v_mul_f32 v113, v113, v132
    v_mul_f32 v114, v114, v132
    v_mul_f32 v115, v115, v132
    v_cvt_pk_bf16_f32 v188, v112, v113
    v_cvt_pk_bf16_f32 v189, v114, v115
    v_mul_f32 v116, v116, v133
    v_mul_f32 v117, v117, v133
    v_mul_f32 v118, v118, v133
    v_mul_f32 v119, v119, v133
    v_cvt_pk_bf16_f32 v190, v116, v117
    v_cvt_pk_bf16_f32 v191, v118, v119
    v_mul_f32 v120, v120, v134
    v_mul_f32 v121, v121, v134
    v_mul_f32 v122, v122, v134
    v_mul_f32 v123, v123, v134
    v_cvt_pk_bf16_f32 v192, v120, v121
    v_cvt_pk_bf16_f32 v193, v122, v123
    v_mul_f32 v124, v124, v135
    v_mul_f32 v125, v125, v135
    v_mul_f32 v126, v126, v135
    v_mul_f32 v127, v127, v135
    v_cvt_pk_bf16_f32 v194, v124, v125
    v_cvt_pk_bf16_f32 v195, v126, v127
    v_mul_f32 v128, v128, v136
    v_mul_f32 v129, v129, v136
    v_mul_f32 v130, v130, v136
    v_mul_f32 v131, v131, v136
    v_cvt_pk_bf16_f32 v196, v128, v129
    v_cvt_pk_bf16_f32 v197, v130, v131
    v_add_f32 v160, s54, v160
    v_add_f32 v161, s54, v161
    v_add_f32 v162, s54, v162
    v_add_f32 v163, s54, v163
    v_add_f32 v164, s54, v164
    v_rcp_f32 v160, v160
    v_rcp_f32 v161, v161
    v_rcp_f32 v162, v162
    v_rcp_f32 v163, v163
    v_rcp_f32 v164, v164
    v_mul_f32 v140, v140, v160
    v_mul_f32 v141, v141, v160
    v_mul_f32 v142, v142, v160
    v_mul_f32 v143, v143, v160
    v_cvt_pk_bf16_f32 v198, v140, v141
    v_cvt_pk_bf16_f32 v199, v142, v143
    v_mul_f32 v144, v144, v161
    v_mul_f32 v145, v145, v161
    v_mul_f32 v146, v146, v161
    v_mul_f32 v147, v147, v161
    v_cvt_pk_bf16_f32 v200, v144, v145
    v_cvt_pk_bf16_f32 v201, v146, v147
    v_mul_f32 v148, v148, v162
    v_mul_f32 v149, v149, v162
    v_mul_f32 v150, v150, v162
    v_mul_f32 v151, v151, v162
    v_cvt_pk_bf16_f32 v202, v148, v149
    v_cvt_pk_bf16_f32 v203, v150, v151
    v_mul_f32 v152, v152, v163
    v_mul_f32 v153, v153, v163
    v_mul_f32 v154, v154, v163
    v_mul_f32 v155, v155, v163
    v_cvt_pk_bf16_f32 v204, v152, v153
    v_cvt_pk_bf16_f32 v205, v154, v155
    v_mul_f32 v156, v156, v164
    v_mul_f32 v157, v157, v164
    v_mul_f32 v158, v158, v164
    v_mul_f32 v159, v159, v164
    v_cvt_pk_bf16_f32 v206, v156, v157
    v_cvt_pk_bf16_f32 v207, v158, v159
    v_add_u32 v14, s42, v13
    ds_write_b128 v14, v[168:171] offset:0
    ds_write_b128 v14, v[172:175] offset:1024
    ds_write_b128 v14, v[176:179] offset:2048
    ds_write_b128 v14, v[180:183] offset:3072
    ds_write_b128 v14, v[184:187] offset:4096
    ds_write_b128 v14, v[188:191] offset:20480
    ds_write_b128 v14, v[192:195] offset:21504
    ds_write_b128 v14, v[196:199] offset:22528
    ds_write_b128 v14, v[200:203] offset:23552
    ds_write_b128 v14, v[204:207] offset:24576
    s_add_u32 s41, s43, s77
    s_add_u32 s24, s40, 1
    s_cmp_lt_u32 s24, s76
    s_cselect_b32 s41, s41, 2146435072
    s_waitcnt vmcnt(0)
    s_add_u32 s25, s41, 20480
    buffer_load_dwordx4 v[56:59], v8, s[8:11], s41 offen offset:0 sc1
    buffer_load_dwordx4 v[60:63], v8, s[8:11], s41 offen offset:1024 sc1
    buffer_load_dwordx2 v[64:65], v9, s[8:11], s41 offen offset:0 sc1
    buffer_load_dwordx4 v[66:69], v8, s[8:11], s41 offen offset:2560 sc1
    buffer_load_dwordx4 v[70:73], v8, s[8:11], s41 offen offset:3584 sc1
    buffer_load_dwordx2 v[74:75], v9, s[8:11], s41 offen offset:2560 sc1
    buffer_load_dwordx4 v[76:79], v8, s[8:11], s25 offen offset:0 sc1
    buffer_load_dwordx4 v[80:83], v8, s[8:11], s25 offen offset:1024 sc1
    buffer_load_dwordx2 v[84:85], v9, s[8:11], s25 offen offset:0 sc1
    buffer_load_dwordx4 v[86:89], v8, s[8:11], s25 offen offset:2560 sc1
    buffer_load_dwordx4 v[90:93], v8, s[8:11], s25 offen offset:3584 sc1
    buffer_load_dwordx2 v[94:95], v9, s[8:11], s25 offen offset:2560 sc1
    buffer_load_dwordx2 v[104:105], v10, s[16:19], s41 offen sc1
    buffer_load_dwordx2 v[106:107], v11, s[16:19], s41 offen sc1
    buffer_load_dwordx2 v[108:109], v10, s[16:19], s25 offen sc1
    buffer_load_dwordx2 v[110:111], v11, s[16:19], s25 offen sc1
    s_waitcnt lgkmcnt(0)
    s_barrier
    s_lshl_b32 s24, s92, 10
    s_lshl_b32 s25, s78, 2
    s_add_u32 s24, s24, s25
    s_add_u32 s24, s24, 23105536
    s_cmp_eq_u32 s3, 0
    s_cbranch_scc0 interleave_layers__linear_attn_block__memory_aug_recurrent_mem_tr__prompt_kernel_pb13
    v_lshlrev_b32 v14, 7, v1
    v_add_u32 v14, s24, v14
    v_mov_b32 v15, 2146435072
    v_cmp_le_u32 vcc, 8, v1
    s_nop 1
    v_cndmask_b32 v14, v14, v15, vcc
    v_mov_b32 v15, s40
    buffer_store_dword v15, v14, s[8:11], 0 offen sc1
interleave_layers__linear_attn_block__memory_aug_recurrent_mem_tr__prompt_kernel_pb13:
    s_branch interleave_layers__linear_attn_block__memory_aug_recurrent_mem_tr__prompt_kernel_k3_seg
interleave_layers__linear_attn_block__memory_aug_recurrent_mem_tr__prompt_kernel_k3_done:
    s_waitcnt vmcnt(0)
    s_barrier
    s_lshl_b32 s24, s92, 10
    s_lshl_b32 s25, s78, 2
    s_add_u32 s24, s24, s25
    s_add_u32 s24, s24, 23105536
    s_cmp_eq_u32 s3, 0
    s_cbranch_scc0 interleave_layers__linear_attn_block__memory_aug_recurrent_mem_tr__prompt_kernel_pb14
    v_lshlrev_b32 v14, 7, v1
    v_add_u32 v14, s24, v14
    v_mov_b32 v15, 2146435072
    v_cmp_le_u32 vcc, 8, v1
    s_nop 1
    v_cndmask_b32 v14, v14, v15, vcc
    v_mov_b32 v15, s40
    buffer_store_dword v15, v14, s[8:11], 0 offen sc1
interleave_layers__linear_attn_block__memory_aug_recurrent_mem_tr__prompt_kernel_pb14:
    s_cmp_eq_u32 s92, 0
    s_cbranch_scc0 interleave_layers__linear_attn_block__memory_aug_recurrent_mem_tr__prompt_kernel_end
    s_mov_b32 s92, 1
    s_cmp_lt_u32 s2, 248
    s_cbranch_scc1 interleave_layers__linear_attn_block__memory_aug_recurrent_mem_tr__prompt_kernel_helper_k1
    s_add_u32 s16, s4, 4194304
    s_addc_u32 s17, s5, 0
    s_mov_b32 s18, 2621440
    s_mov_b32 s19, 0x00020000
    s_mov_b32 s46, 1024
    s_mov_b32 s47, 8
    s_mov_b32 s50, 1
    s_mov_b32 s58, 8388608
    s_mov_b32 s76, 64
    s_mov_b32 s77, 40960
    s_branch interleave_layers__linear_attn_block__memory_aug_recurrent_mem_tr__prompt_kernel_k3_entry
interleave_layers__linear_attn_block__memory_aug_recurrent_mem_tr__prompt_kernel_helper_k1:
    s_mov_b32 s92, 1
    s_sub_u32 s24, s2, 232
    s_add_u32 s16, s4, 4194304
    s_addc_u32 s17, s5, 0
    s_mov_b32 s18, 2621440
    s_mov_b32 s19, 0x00020000
    s_mov_b32 s46, 1024
    s_mov_b32 s47, 8
    s_mov_b32 s50, 1
    s_and_b32 s44, s24, 7
    s_lshr_b32 s45, s24, 3
    s_mov_b32 s48, s45
    s_mov_b32 s49, 2
    s_mov_b32 s40, 32
    s_branch interleave_layers__linear_attn_block__memory_aug_recurrent_mem_tr__prompt_kernel_k1_entry
interleave_layers__linear_attn_block__memory_aug_recurrent_mem_tr__prompt_kernel_helper_clr:
    s_sub_u32 s44, s2, 253
    s_lshl_b32 s24, s44, 2
    s_add_u32 s24, s24, s3
    s_mul_i32 s45, s24, 5
    s_add_u32 s24, s45, 0
    s_min_u32 s24, s24, 56
    s_sub_u32 s25, s24, 47
    s_cmp_ge_u32 s24, 47
    s_cselect_b32 s24, s25, s24
    s_cselect_b32 s69, 0x2000, 0
    s_lshl_b32 s64, s24, 14
    s_add_u32 s24, s45, 1
    s_min_u32 s24, s24, 56
    s_sub_u32 s25, s24, 47
    s_cmp_ge_u32 s24, 47
    s_cselect_b32 s24, s25, s24
    s_cselect_b32 s70, 0x2000, 0
    s_lshl_b32 s65, s24, 14
    s_add_u32 s24, s45, 2
    s_min_u32 s24, s24, 56
    s_sub_u32 s25, s24, 47
    s_cmp_ge_u32 s24, 47
    s_cselect_b32 s24, s25, s24
    s_cselect_b32 s71, 0x2000, 0
    s_lshl_b32 s66, s24, 14
    s_add_u32 s24, s45, 3
    s_min_u32 s24, s24, 56
    s_sub_u32 s25, s24, 47
    s_cmp_ge_u32 s24, 47
    s_cselect_b32 s24, s25, s24
    s_cselect_b32 s72, 0x2000, 0
    s_lshl_b32 s67, s24, 14
    s_add_u32 s24, s45, 4
    s_min_u32 s24, s24, 56
    s_sub_u32 s25, s24, 47
    s_cmp_ge_u32 s24, 47
    s_cselect_b32 s24, s25, s24
    s_cselect_b32 s73, 0x2000, 0
    s_lshl_b32 s68, s24, 14
    v_lshlrev_b32 v5, 4, v1
    v_mov_b32 v8, -1
    v_mov_b32 v9, -1
    v_mov_b32 v10, -1
    v_mov_b32 v11, -1
    s_lshl_b32 s24, s44, 2
    s_add_u32 s42, s24, 23109632
    s_mov_b32 s40, 0
interleave_layers__linear_attn_block__memory_aug_recurrent_mem_tr__prompt_kernel_clr_blk:
    s_lshl_b32 s24, s40, 12
    s_and_b32 s24, s24, 0x2000
    s_xor_b32 s24, s24, s36
    s_lshl_b32 s41, s40, 20
    s_add_u32 s41, s41, s24
    s_add_u32 s41, s41, 117440512
    s_add_u32 s43, s41, s64
    s_xor_b32 s43, s43, s69
    s_add_u32 s46, s43, 4096
    buffer_store_dwordx4 v[8:11], v5, s[8:11], s43 offen offset:0 sc1
    buffer_store_dwordx4 v[8:11], v5, s[8:11], s43 offen offset:1024 sc1
    buffer_store_dwordx4 v[8:11], v5, s[8:11], s43 offen offset:2048 sc1
    buffer_store_dwordx4 v[8:11], v5, s[8:11], s43 offen offset:3072 sc1
    buffer_store_dwordx4 v[8:11], v5, s[8:11], s46 offen offset:0 sc1
    buffer_store_dwordx4 v[8:11], v5, s[8:11], s46 offen offset:1024 sc1
    buffer_store_dwordx4 v[8:11], v5, s[8:11], s46 offen offset:2048 sc1
    buffer_store_dwordx4 v[8:11], v5, s[8:11], s46 offen offset:3072 sc1
    s_add_u32 s43, s41, s65
    s_xor_b32 s43, s43, s70
    s_add_u32 s46, s43, 4096
    buffer_store_dwordx4 v[8:11], v5, s[8:11], s43 offen offset:0 sc1
    buffer_store_dwordx4 v[8:11], v5, s[8:11], s43 offen offset:1024 sc1
    buffer_store_dwordx4 v[8:11], v5, s[8:11], s43 offen offset:2048 sc1
    buffer_store_dwordx4 v[8:11], v5, s[8:11], s43 offen offset:3072 sc1
    buffer_store_dwordx4 v[8:11], v5, s[8:11], s46 offen offset:0 sc1
    buffer_store_dwordx4 v[8:11], v5, s[8:11], s46 offen offset:1024 sc1
    buffer_store_dwordx4 v[8:11], v5, s[8:11], s46 offen offset:2048 sc1
    buffer_store_dwordx4 v[8:11], v5, s[8:11], s46 offen offset:3072 sc1
    s_add_u32 s43, s41, s66
    s_xor_b32 s43, s43, s71
    s_add_u32 s46, s43, 4096
    buffer_store_dwordx4 v[8:11], v5, s[8:11], s43 offen offset:0 sc1
    buffer_store_dwordx4 v[8:11], v5, s[8:11], s43 offen offset:1024 sc1
    buffer_store_dwordx4 v[8:11], v5, s[8:11], s43 offen offset:2048 sc1
    buffer_store_dwordx4 v[8:11], v5, s[8:11], s43 offen offset:3072 sc1
    buffer_store_dwordx4 v[8:11], v5, s[8:11], s46 offen offset:0 sc1
    buffer_store_dwordx4 v[8:11], v5, s[8:11], s46 offen offset:1024 sc1
    buffer_store_dwordx4 v[8:11], v5, s[8:11], s46 offen offset:2048 sc1
    buffer_store_dwordx4 v[8:11], v5, s[8:11], s46 offen offset:3072 sc1
    s_add_u32 s43, s41, s67
    s_xor_b32 s43, s43, s72
    s_add_u32 s46, s43, 4096
    buffer_store_dwordx4 v[8:11], v5, s[8:11], s43 offen offset:0 sc1
    buffer_store_dwordx4 v[8:11], v5, s[8:11], s43 offen offset:1024 sc1
    buffer_store_dwordx4 v[8:11], v5, s[8:11], s43 offen offset:2048 sc1
    buffer_store_dwordx4 v[8:11], v5, s[8:11], s43 offen offset:3072 sc1
    buffer_store_dwordx4 v[8:11], v5, s[8:11], s46 offen offset:0 sc1
    buffer_store_dwordx4 v[8:11], v5, s[8:11], s46 offen offset:1024 sc1
    buffer_store_dwordx4 v[8:11], v5, s[8:11], s46 offen offset:2048 sc1
    buffer_store_dwordx4 v[8:11], v5, s[8:11], s46 offen offset:3072 sc1
    s_add_u32 s43, s41, s68
    s_xor_b32 s43, s43, s73
    s_add_u32 s46, s43, 4096
    buffer_store_dwordx4 v[8:11], v5, s[8:11], s43 offen offset:0 sc1
    buffer_store_dwordx4 v[8:11], v5, s[8:11], s43 offen offset:1024 sc1
    buffer_store_dwordx4 v[8:11], v5, s[8:11], s43 offen offset:2048 sc1
    buffer_store_dwordx4 v[8:11], v5, s[8:11], s43 offen offset:3072 sc1
    buffer_store_dwordx4 v[8:11], v5, s[8:11], s46 offen offset:0 sc1
    buffer_store_dwordx4 v[8:11], v5, s[8:11], s46 offen offset:1024 sc1
    buffer_store_dwordx4 v[8:11], v5, s[8:11], s46 offen offset:2048 sc1
    buffer_store_dwordx4 v[8:11], v5, s[8:11], s46 offen offset:3072 sc1
    s_waitcnt vmcnt(40)
    s_barrier
    s_cmp_eq_u32 s3, 0
    s_cbranch_scc0 interleave_layers__linear_attn_block__memory_aug_recurrent_mem_tr__prompt_kernel_pb15
    v_lshlrev_b32 v14, 7, v1
    v_add_u32 v14, s42, v14
    v_mov_b32 v15, 2146435072
    v_cmp_le_u32 vcc, 8, v1
    s_nop 1
    v_cndmask_b32 v14, v14, v15, vcc
    v_mov_b32 v15, s40
    buffer_store_dword v15, v14, s[8:11], 0 offen sc1
interleave_layers__linear_attn_block__memory_aug_recurrent_mem_tr__prompt_kernel_pb15:
    s_add_u32 s40, s40, 1
    s_cmp_lt_u32 s40, 64
    s_cbranch_scc1 interleave_layers__linear_attn_block__memory_aug_recurrent_mem_tr__prompt_kernel_clr_blk
    s_waitcnt vmcnt(0)
    s_barrier
    s_cmp_eq_u32 s3, 0
    s_cbranch_scc0 interleave_layers__linear_attn_block__memory_aug_recurrent_mem_tr__prompt_kernel_pb16
    v_lshlrev_b32 v14, 7, v1
    v_add_u32 v14, s42, v14
    v_mov_b32 v15, 2146435072
    v_cmp_le_u32 vcc, 8, v1
    s_nop 1
    v_cndmask_b32 v14, v14, v15, vcc
    v_mov_b32 v15, s40
    buffer_store_dword v15, v14, s[8:11], 0 offen sc1
interleave_layers__linear_attn_block__memory_aug_recurrent_mem_tr__prompt_kernel_pb16:
interleave_layers__linear_attn_block__memory_aug_recurrent_mem_tr__prompt_kernel_clr_blk2:
    s_sub_u32 s47, s40, 64
    s_cmp_ge_u32 s47, 60
    s_cbranch_scc1 interleave_layers__linear_attn_block__memory_aug_recurrent_mem_tr__prompt_kernel_clr_last
    s_and_b32 s24, s47, 3
    s_lshl_b32 s24, s24, 7
    s_add_u32 s24, s24, 23107584
    v_lshlrev_b32 v15, 2, v1
    v_add_u32 v15, s24, v15
    s_lshr_b32 s95, s47, 2
    s_add_u32 s95, s95, 2
    s_mov_b32 s61, 0
interleave_layers__linear_attn_block__memory_aug_recurrent_mem_tr__prompt_kernel_clr_wx:
    buffer_load_dword v14, v15, s[8:11], 0 offen sc1
    s_waitcnt vmcnt(0)
    v_cmp_le_i32 vcc, s95, v14
    s_mov_b32 s25, 0xfffff
    s_and_b32 s24, vcc_lo, s25
    s_cmp_eq_u32 s24, s25
    s_cbranch_scc1 interleave_layers__linear_attn_block__memory_aug_recurrent_mem_tr__prompt_kernel_clr_wx_ok
    s_add_u32 s61, s61, 1
    s_cmp_ge_u32 s61, s60
    s_cbranch_scc1 interleave_layers__linear_attn_block__memory_aug_recurrent_mem_tr__prompt_kernel_clr_wx_to
    s_sleep 32
    s_branch interleave_layers__linear_attn_block__memory_aug_recurrent_mem_tr__prompt_kernel_clr_wx
interleave_layers__linear_attn_block__memory_aug_recurrent_mem_tr__prompt_kernel_clr_wx_to:
    s_mov_b32 s60, 1
interleave_layers__linear_attn_block__memory_aug_recurrent_mem_tr__prompt_kernel_clr_wx_ok:
    s_branch interleave_layers__linear_attn_block__memory_aug_recurrent_mem_tr__prompt_kernel_clr_go
interleave_layers__linear_attn_block__memory_aug_recurrent_mem_tr__prompt_kernel_clr_last:
    v_mov_b32 v15, 23111680
    s_mov_b32 s95, 66
    s_mov_b32 s61, 0
interleave_layers__linear_attn_block__memory_aug_recurrent_mem_tr__prompt_kernel_clr_ws:
    buffer_load_dword v14, v15, s[8:11], 0 offen sc1
    s_waitcnt vmcnt(0)
    v_cmp_le_i32 vcc, s95, v14
    s_mov_b32 s25, 0x1
    s_and_b32 s24, vcc_lo, s25
    s_cmp_eq_u32 s24, s25
    s_cbranch_scc1 interleave_layers__linear_attn_block__memory_aug_recurrent_mem_tr__prompt_kernel_clr_ws_ok
    s_add_u32 s61, s61, 1
    s_cmp_ge_u32 s61, s60
    s_cbranch_scc1 interleave_layers__linear_attn_block__memory_aug_recurrent_mem_tr__prompt_kernel_clr_ws_to
    s_sleep 32
    s_branch interleave_layers__linear_attn_block__memory_aug_recurrent_mem_tr__prompt_kernel_clr_ws
interleave_layers__linear_attn_block__memory_aug_recurrent_mem_tr__prompt_kernel_clr_ws_to:
    s_mov_b32 s60, 1
interleave_layers__linear_attn_block__memory_aug_recurrent_mem_tr__prompt_kernel_clr_ws_ok:
interleave_layers__linear_attn_block__memory_aug_recurrent_mem_tr__prompt_kernel_clr_go:
    s_lshl_b32 s24, s47, 12
    s_and_b32 s24, s24, 0x2000
    s_xor_b32 s24, s24, s36
    s_lshl_b32 s41, s47, 20
    s_add_u32 s41, s41, s24
    s_add_u32 s41, s41, 117440512
    s_add_u32 s43, s41, s64
    s_xor_b32 s43, s43, s69
    s_add_u32 s46, s43, 4096
    buffer_store_dwordx4 v[8:11], v5, s[8:11], s43 offen offset:0 sc1
    buffer_store_dwordx4 v[8:11], v5, s[8:11], s43 offen offset:1024 sc1
    buffer_store_dwordx4 v[8:11], v5, s[8:11], s43 offen offset:2048 sc1
    buffer_store_dwordx4 v[8:11], v5, s[8:11], s43 offen offset:3072 sc1
    buffer_store_dwordx4 v[8:11], v5, s[8:11], s46 offen offset:0 sc1
    buffer_store_dwordx4 v[8:11], v5, s[8:11], s46 offen offset:1024 sc1
    buffer_store_dwordx4 v[8:11], v5, s[8:11], s46 offen offset:2048 sc1
    buffer_store_dwordx4 v[8:11], v5, s[8:11], s46 offen offset:3072 sc1
    s_add_u32 s43, s41, s65
    s_xor_b32 s43, s43, s70
    s_add_u32 s46, s43, 4096
    buffer_store_dwordx4 v[8:11], v5, s[8:11], s43 offen offset:0 sc1
    buffer_store_dwordx4 v[8:11], v5, s[8:11], s43 offen offset:1024 sc1
    buffer_store_dwordx4 v[8:11], v5, s[8:11], s43 offen offset:2048 sc1
    buffer_store_dwordx4 v[8:11], v5, s[8:11], s43 offen offset:3072 sc1
    buffer_store_dwordx4 v[8:11], v5, s[8:11], s46 offen offset:0 sc1
    buffer_store_dwordx4 v[8:11], v5, s[8:11], s46 offen offset:1024 sc1
    buffer_store_dwordx4 v[8:11], v5, s[8:11], s46 offen offset:2048 sc1
    buffer_store_dwordx4 v[8:11], v5, s[8:11], s46 offen offset:3072 sc1
    s_add_u32 s43, s41, s66
    s_xor_b32 s43, s43, s71
    s_add_u32 s46, s43, 4096
    buffer_store_dwordx4 v[8:11], v5, s[8:11], s43 offen offset:0 sc1
    buffer_store_dwordx4 v[8:11], v5, s[8:11], s43 offen offset:1024 sc1
    buffer_store_dwordx4 v[8:11], v5, s[8:11], s43 offen offset:2048 sc1
    buffer_store_dwordx4 v[8:11], v5, s[8:11], s43 offen offset:3072 sc1
    buffer_store_dwordx4 v[8:11], v5, s[8:11], s46 offen offset:0 sc1
    buffer_store_dwordx4 v[8:11], v5, s[8:11], s46 offen offset:1024 sc1
    buffer_store_dwordx4 v[8:11], v5, s[8:11], s46 offen offset:2048 sc1
    buffer_store_dwordx4 v[8:11], v5, s[8:11], s46 offen offset:3072 sc1
    s_add_u32 s43, s41, s67
    s_xor_b32 s43, s43, s72
    s_add_u32 s46, s43, 4096
    buffer_store_dwordx4 v[8:11], v5, s[8:11], s43 offen offset:0 sc1
    buffer_store_dwordx4 v[8:11], v5, s[8:11], s43 offen offset:1024 sc1
    buffer_store_dwordx4 v[8:11], v5, s[8:11], s43 offen offset:2048 sc1
    buffer_store_dwordx4 v[8:11], v5, s[8:11], s43 offen offset:3072 sc1
    buffer_store_dwordx4 v[8:11], v5, s[8:11], s46 offen offset:0 sc1
    buffer_store_dwordx4 v[8:11], v5, s[8:11], s46 offen offset:1024 sc1
    buffer_store_dwordx4 v[8:11], v5, s[8:11], s46 offen offset:2048 sc1
    buffer_store_dwordx4 v[8:11], v5, s[8:11], s46 offen offset:3072 sc1
    s_add_u32 s43, s41, s68
    s_xor_b32 s43, s43, s73
    s_add_u32 s46, s43, 4096
    buffer_store_dwordx4 v[8:11], v5, s[8:11], s43 offen offset:0 sc1
    buffer_store_dwordx4 v[8:11], v5, s[8:11], s43 offen offset:1024 sc1
    buffer_store_dwordx4 v[8:11], v5, s[8:11], s43 offen offset:2048 sc1
    buffer_store_dwordx4 v[8:11], v5, s[8:11], s43 offen offset:3072 sc1
    buffer_store_dwordx4 v[8:11], v5, s[8:11], s46 offen offset:0 sc1
    buffer_store_dwordx4 v[8:11], v5, s[8:11], s46 offen offset:1024 sc1
    buffer_store_dwordx4 v[8:11], v5, s[8:11], s46 offen offset:2048 sc1
    buffer_store_dwordx4 v[8:11], v5, s[8:11], s46 offen offset:3072 sc1
    s_waitcnt vmcnt(0)
    s_barrier
    s_add_u32 s40, s40, 1
    s_cmp_eq_u32 s3, 0
    s_cbranch_scc0 interleave_layers__linear_attn_block__memory_aug_recurrent_mem_tr__prompt_kernel_pb17
    v_lshlrev_b32 v14, 7, v1
    v_add_u32 v14, s42, v14
    v_mov_b32 v15, 2146435072
    v_cmp_le_u32 vcc, 8, v1
    s_nop 1
    v_cndmask_b32 v14, v14, v15, vcc
    v_mov_b32 v15, s40
    buffer_store_dword v15, v14, s[8:11], 0 offen sc1
interleave_layers__linear_attn_block__memory_aug_recurrent_mem_tr__prompt_kernel_pb17:
    s_cmp_lt_u32 s40, 128
    s_cbranch_scc1 interleave_layers__linear_attn_block__memory_aug_recurrent_mem_tr__prompt_kernel_clr_blk2
    s_waitcnt vmcnt(0)
    s_branch interleave_layers__linear_attn_block__memory_aug_recurrent_mem_tr__prompt_kernel_end
interleave_layers__linear_attn_block__memory_aug_recurrent_mem_tr__prompt_kernel_roleS:
    s_mov_b32 s44, s2
    s_load_dwordx2 s[6:7], s[0:1], 40
    s_load_dwordx2 s[24:25], s[0:1], 48
    s_load_dwordx2 s[26:27], s[0:1], 32
    s_waitcnt lgkmcnt(0)
    s_mov_b32 s12, s6
    s_mov_b32 s13, s7
    s_mov_b32 s14, 7864320
    s_mov_b32 s15, 0x00020000
    s_mov_b32 s16, s24
    s_mov_b32 s17, s25
    s_mov_b32 s18, 7864320
    s_mov_b32 s19, 0x00020000
    s_mov_b32 s20, s26
    s_mov_b32 s21, s27
    s_mov_b32 s22, 10240
    s_mov_b32 s23, 0x00020000
    v_add_u32 v16, 0, v0
    s_mov_b32 s24, 683
    v_mul_lo_u32 v17, v16, s24
    v_lshrrev_b32 v17, 14, v17
    v_mul_u32_u24 v18, 24, v17
    v_sub_u32 v18, v16, v18
    s_mov_b32 s24, 12288
    v_mul_lo_u32 v4, v17, s24
    v_lshl_add_u32 v4, v18, 4, v4
    v_mul_u32_u24 v10, 400, v17
    v_lshl_add_u32 v10, v18, 4, v10
    v_add_u32 v10, 106496, v10
    v_add_u32 v16, 256, v0
    s_mov_b32 s24, 683
    v_mul_lo_u32 v17, v16, s24
    v_lshrrev_b32 v17, 14, v17
    v_mul_u32_u24 v18, 24, v17
    v_sub_u32 v18, v16, v18
    s_mov_b32 s24, 12288
    v_mul_lo_u32 v5, v17, s24
    v_lshl_add_u32 v5, v18, 4, v5
    v_mul_u32_u24 v11, 400, v17
    v_lshl_add_u32 v11, v18, 4, v11
    v_add_u32 v11, 106496, v11
    v_add_u32 v16, 512, v0
    s_mov_b32 s24, 683
    v_mul_lo_u32 v17, v16, s24
    v_lshrrev_b32 v17, 14, v17
    v_mul_u32_u24 v18, 24, v17
    v_sub_u32 v18, v16, v18
    s_mov_b32 s24, 12288
    v_mul_lo_u32 v6, v17, s24
    v_lshl_add_u32 v6, v18, 4, v6
    v_mul_u32_u24 v12, 400, v17
    v_lshl_add_u32 v12, v18, 4, v12
    v_add_u32 v12, 106496, v12
    v_add_u32 v16, 768, v0
    s_mov_b32 s24, 683
    v_mul_lo_u32 v17, v16, s24
    v_lshrrev_b32 v17, 14, v17
    v_mul_u32_u24 v18, 24, v17
    v_sub_u32 v18, v16, v18
    s_mov_b32 s24, 12288
    v_mul_lo_u32 v7, v17, s24
    v_lshl_add_u32 v7, v18, 4, v7
    v_mul_u32_u24 v13, 400, v17
    v_lshl_add_u32 v13, v18, 4, v13
    v_add_u32 v13, 106496, v13
    v_add_u32 v16, 1024, v0
    s_mov_b32 s24, 683
    v_mul_lo_u32 v17, v16, s24
    v_lshrrev_b32 v17, 14, v17
    v_mul_u32_u24 v18, 24, v17
    v_sub_u32 v18, v16, v18
    s_mov_b32 s24, 12288
    v_mul_lo_u32 v8, v17, s24
    v_lshl_add_u32 v8, v18, 4, v8
    v_mul_u32_u24 v14, 400, v17
    v_lshl_add_u32 v14, v18, 4, v14
    v_add_u32 v14, 106496, v14
    v_add_u32 v16, 1280, v0
    s_mov_b32 s24, 683
    v_mul_lo_u32 v17, v16, s24
    v_lshrrev_b32 v17, 14, v17
    v_mul_u32_u24 v18, 24, v17
    v_sub_u32 v18, v16, v18
    s_mov_b32 s24, 12288
    v_mul_lo_u32 v9, v17, s24
    v_lshl_add_u32 v9, v18, 4, v9
    v_mul_u32_u24 v15, 400, v17
    v_lshl_add_u32 v15, v18, 4, v15
    v_add_u32 v15, 106496, v15
    v_lshrrev_b32 v17, 1, v3
    v_lshlrev_b32 v17, 4, v17
    v_and_b32 v18, 1, v3
    v_lshl_add_u32 v17, v18, 2, v17
    v_lshrrev_b32 v18, 2, v2
    v_and_b32 v19, 1, v18
    v_add_u32 v17, v17, v19
    v_lshrrev_b32 v18, 1, v18
    v_lshl_add_u32 v17, v18, 3, v17
    v_mul_u32_u24 v16, 400, v17
    v_and_b32 v18, 3, v2
    v_lshl_add_u32 v16, v18, 3, v16
    v_add_u32 v16, 106496, v16
    s_mul_i32 s24, s3, 96
    v_add_u32 v16, s24, v16
    v_lshlrev_b32 v17, 4, v1
    s_mul_i32 s24, s3, 20480
    s_add_u32 s24, s24, 24576
    v_add_u32 v17, s24, v17
    s_mul_i32 s45, s44, 384
    s_add_u32 s46, s45, 0
    buffer_load_dwordx4 v[24:27], v4, s[12:15], s46 offen
    buffer_load_dwordx4 v[28:31], v5, s[12:15], s46 offen
    buffer_load_dwordx4 v[32:35], v6, s[12:15], s46 offen
    buffer_load_dwordx4 v[36:39], v7, s[12:15], s46 offen
    buffer_load_dwordx4 v[40:43], v8, s[12:15], s46 offen
    buffer_load_dwordx4 v[44:47], v9, s[12:15], s46 offen
    s_add_u32 s46, s45, 0
    buffer_load_dwordx4 v[48:51], v4, s[16:19], s46 offen
    buffer_load_dwordx4 v[52:55], v5, s[16:19], s46 offen
    buffer_load_dwordx4 v[56:59], v6, s[16:19], s46 offen
    buffer_load_dwordx4 v[60:63], v7, s[16:19], s46 offen
    buffer_load_dwordx4 v[64:67], v8, s[16:19], s46 offen
    buffer_load_dwordx4 v[68:71], v9, s[16:19], s46 offen
    s_waitcnt vmcnt(6)
    ds_write_b128 v10, v[24:27]
    ds_write_b128 v11, v[28:31]
    ds_write_b128 v12, v[32:35]
    ds_write_b128 v13, v[36:39]
    ds_write_b128 v14, v[40:43]
    ds_write_b128 v15, v[44:47]
    s_add_u32 s46, s45, 786432
    buffer_load_dwordx4 v[72:75], v4, s[12:15], s46 offen
    buffer_load_dwordx4 v[76:79], v5, s[12:15], s46 offen
    buffer_load_dwordx4 v[80:83], v6, s[12:15], s46 offen
    buffer_load_dwordx4 v[84:87], v7, s[12:15], s46 offen
    buffer_load_dwordx4 v[88:91], v8, s[12:15], s46 offen
    buffer_load_dwordx4 v[92:95], v9, s[12:15], s46 offen
    s_waitcnt lgkmcnt(0)
    s_barrier
    ds_read_b64_tr_b16 a[0:1], v16 offset:0
    ds_read_b64_tr_b16 a[2:3], v16 offset:800
    ds_read_b64_tr_b16 a[4:5], v16 offset:12800
    ds_read_b64_tr_b16 a[6:7], v16 offset:13600
    ds_read_b64_tr_b16 a[80:81], v16 offset:32
    ds_read_b64_tr_b16 a[82:83], v16 offset:832
    ds_read_b64_tr_b16 a[84:85], v16 offset:12832
    ds_read_b64_tr_b16 a[86:87], v16 offset:13632
    ds_read_b64_tr_b16 a[160:161], v16 offset:64
    ds_read_b64_tr_b16 a[162:163], v16 offset:864
    ds_read_b64_tr_b16 a[164:165], v16 offset:12864
    ds_read_b64_tr_b16 a[166:167], v16 offset:13664
    s_waitcnt lgkmcnt(0)
    s_barrier
    s_waitcnt vmcnt(6)
    ds_write_b128 v10, v[48:51]
    ds_write_b128 v11, v[52:55]
    ds_write_b128 v12, v[56:59]
    ds_write_b128 v13, v[60:63]
    ds_write_b128 v14, v[64:67]
    ds_write_b128 v15, v[68:71]
    s_add_u32 s46, s45, 786432
    buffer_load_dwordx4 v[24:27], v4, s[16:19], s46 offen
    buffer_load_dwordx4 v[28:31], v5, s[16:19], s46 offen
    buffer_load_dwordx4 v[32:35], v6, s[16:19], s46 offen
    buffer_load_dwordx4 v[36:39], v7, s[16:19], s46 offen
    buffer_load_dwordx4 v[40:43], v8, s[16:19], s46 offen
    buffer_load_dwordx4 v[44:47], v9, s[16:19], s46 offen
    s_waitcnt lgkmcnt(0)
    s_barrier
    ds_read_b64_tr_b16 v[96:97], v16 offset:32
    ds_read_b64_tr_b16 v[98:99], v16 offset:832
    ds_read_b64_tr_b16 v[100:101], v16 offset:12832
    ds_read_b64_tr_b16 v[102:103], v16 offset:13632
    ds_read_b64_tr_b16 v[176:177], v16 offset:64
    ds_read_b64_tr_b16 v[178:179], v16 offset:864
    ds_read_b64_tr_b16 v[180:181], v16 offset:12864
    ds_read_b64_tr_b16 v[182:183], v16 offset:13664
    ds_read_b64_tr_b16 v[48:49], v16 offset:0
    ds_read_b64_tr_b16 v[50:51], v16 offset:800
    ds_read_b64_tr_b16 v[52:53], v16 offset:12800
    ds_read_b64_tr_b16 v[54:55], v16 offset:13600
    s_waitcnt lgkmcnt(0)
    ds_write_b128 v17, v[48:51] offset:0
    ds_write_b128 v17, v[52:55] offset:1024
    s_waitcnt lgkmcnt(0)
    s_barrier
    s_waitcnt vmcnt(6)
    ds_write_b128 v10, v[72:75]
    ds_write_b128 v11, v[76:79]
    ds_write_b128 v12, v[80:83]
    ds_write_b128 v13, v[84:87]
    ds_write_b128 v14, v[88:91]
    ds_write_b128 v15, v[92:95]
    s_add_u32 s46, s45, 1572864
    buffer_load_dwordx4 v[48:51], v4, s[12:15], s46 offen
    buffer_load_dwordx4 v[52:55], v5, s[12:15], s46 offen
    buffer_load_dwordx4 v[56:59], v6, s[12:15], s46 offen
    buffer_load_dwordx4 v[60:63], v7, s[12:15], s46 offen
    buffer_load_dwordx4 v[64:67], v8, s[12:15], s46 offen
    buffer_load_dwordx4 v[68:71], v9, s[12:15], s46 offen
    s_waitcnt lgkmcnt(0)
    s_barrier
    ds_read_b64_tr_b16 a[8:9], v16 offset:0
    ds_read_b64_tr_b16 a[10:11], v16 offset:800
    ds_read_b64_tr_b16 a[12:13], v16 offset:12800
    ds_read_b64_tr_b16 a[14:15], v16 offset:13600
    ds_read_b64_tr_b16 a[88:89], v16 offset:32
    ds_read_b64_tr_b16 a[90:91], v16 offset:832
    ds_read_b64_tr_b16 a[92:93], v16 offset:12832
    ds_read_b64_tr_b16 a[94:95], v16 offset:13632
    ds_read_b64_tr_b16 a[168:169], v16 offset:64
    ds_read_b64_tr_b16 a[170:171], v16 offset:864
    ds_read_b64_tr_b16 a[172:173], v16 offset:12864
    ds_read_b64_tr_b16 a[174:175], v16 offset:13664
    s_waitcnt lgkmcnt(0)
    s_barrier
    s_waitcnt vmcnt(6)
    ds_write_b128 v10, v[24:27]
    ds_write_b128 v11, v[28:31]
    ds_write_b128 v12, v[32:35]
    ds_write_b128 v13, v[36:39]
    ds_write_b128 v14, v[40:43]
    ds_write_b128 v15, v[44:47]
    s_add_u32 s46, s45, 1572864
    buffer_load_dwordx4 v[72:75], v4, s[16:19], s46 offen
    buffer_load_dwordx4 v[76:79], v5, s[16:19], s46 offen
    buffer_load_dwordx4 v[80:83], v6, s[16:19], s46 offen
    buffer_load_dwordx4 v[84:87], v7, s[16:19], s46 offen
    buffer_load_dwordx4 v[88:91], v8, s[16:19], s46 offen
    buffer_load_dwordx4 v[92:95], v9, s[16:19], s46 offen
    s_waitcnt lgkmcnt(0)
    s_barrier
    ds_read_b64_tr_b16 v[104:105], v16 offset:32
    ds_read_b64_tr_b16 v[106:107], v16 offset:832
    ds_read_b64_tr_b16 v[108:109], v16 offset:12832
    ds_read_b64_tr_b16 v[110:111], v16 offset:13632
    ds_read_b64_tr_b16 v[184:185], v16 offset:64
    ds_read_b64_tr_b16 v[186:187], v16 offset:864
    ds_read_b64_tr_b16 v[188:189], v16 offset:12864
    ds_read_b64_tr_b16 v[190:191], v16 offset:13664
    ds_read_b64_tr_b16 v[24:25], v16 offset:0
    ds_read_b64_tr_b16 v[26:27], v16 offset:800
    ds_read_b64_tr_b16 v[28:29], v16 offset:12800
    ds_read_b64_tr_b16 v[30:31], v16 offset:13600
    s_waitcnt lgkmcnt(0)
    ds_write_b128 v17, v[24:27] offset:2048
    ds_write_b128 v17, v[28:31] offset:3072
    s_waitcnt lgkmcnt(0)
    s_barrier
    s_waitcnt vmcnt(6)
    ds_write_b128 v10, v[48:51]
    ds_write_b128 v11, v[52:55]
    ds_write_b128 v12, v[56:59]
    ds_write_b128 v13, v[60:63]
    ds_write_b128 v14, v[64:67]
    ds_write_b128 v15, v[68:71]
    s_add_u32 s46, s45, 2359296
    buffer_load_dwordx4 v[24:27], v4, s[12:15], s46 offen
    buffer_load_dwordx4 v[28:31], v5, s[12:15], s46 offen
    buffer_load_dwordx4 v[32:35], v6, s[12:15], s46 offen
    buffer_load_dwordx4 v[36:39], v7, s[12:15], s46 offen
    buffer_load_dwordx4 v[40:43], v8, s[12:15], s46 offen
    buffer_load_dwordx4 v[44:47], v9, s[12:15], s46 offen
    s_waitcnt lgkmcnt(0)
    s_barrier
    ds_read_b64_tr_b16 a[16:17], v16 offset:0
    ds_read_b64_tr_b16 a[18:19], v16 offset:800
    ds_read_b64_tr_b16 a[20:21], v16 offset:12800
    ds_read_b64_tr_b16 a[22:23], v16 offset:13600
    ds_read_b64_tr_b16 a[96:97], v16 offset:32
    ds_read_b64_tr_b16 a[98:99], v16 offset:832
    ds_read_b64_tr_b16 a[100:101], v16 offset:12832
    ds_read_b64_tr_b16 a[102:103], v16 offset:13632
    ds_read_b64_tr_b16 a[176:177], v16 offset:64
    ds_read_b64_tr_b16 a[178:179], v16 offset:864
    ds_read_b64_tr_b16 a[180:181], v16 offset:12864
    ds_read_b64_tr_b16 a[182:183], v16 offset:13664
    s_waitcnt lgkmcnt(0)
    s_barrier
    s_waitcnt vmcnt(6)
    ds_write_b128 v10, v[72:75]
    ds_write_b128 v11, v[76:79]
    ds_write_b128 v12, v[80:83]
    ds_write_b128 v13, v[84:87]
    ds_write_b128 v14, v[88:91]
    ds_write_b128 v15, v[92:95]
    s_add_u32 s46, s45, 2359296
    buffer_load_dwordx4 v[48:51], v4, s[16:19], s46 offen
    buffer_load_dwordx4 v[52:55], v5, s[16:19], s46 offen
    buffer_load_dwordx4 v[56:59], v6, s[16:19], s46 offen
    buffer_load_dwordx4 v[60:63], v7, s[16:19], s46 offen
    buffer_load_dwordx4 v[64:67], v8, s[16:19], s46 offen
    buffer_load_dwordx4 v[68:71], v9, s[16:19], s46 offen
    s_waitcnt lgkmcnt(0)
    s_barrier
    ds_read_b64_tr_b16 v[112:113], v16 offset:32
    ds_read_b64_tr_b16 v[114:115], v16 offset:832
    ds_read_b64_tr_b16 v[116:117], v16 offset:12832
    ds_read_b64_tr_b16 v[118:119], v16 offset:13632
    ds_read_b64_tr_b16 v[192:193], v16 offset:64
    ds_read_b64_tr_b16 v[194:195], v16 offset:864
    ds_read_b64_tr_b16 v[196:197], v16 offset:12864
    ds_read_b64_tr_b16 v[198:199], v16 offset:13664
    ds_read_b64_tr_b16 v[72:73], v16 offset:0
    ds_read_b64_tr_b16 v[74:75], v16 offset:800
    ds_read_b64_tr_b16 v[76:77], v16 offset:12800
    ds_read_b64_tr_b16 v[78:79], v16 offset:13600
    s_waitcnt lgkmcnt(0)
    ds_write_b128 v17, v[72:75] offset:4096
    ds_write_b128 v17, v[76:79] offset:5120
    s_waitcnt lgkmcnt(0)
    s_barrier
    s_waitcnt vmcnt(6)
    ds_write_b128 v10, v[24:27]
    ds_write_b128 v11, v[28:31]
    ds_write_b128 v12, v[32:35]
    ds_write_b128 v13, v[36:39]
    ds_write_b128 v14, v[40:43]
    ds_write_b128 v15, v[44:47]
    s_add_u32 s46, s45, 3145728
    buffer_load_dwordx4 v[72:75], v4, s[12:15], s46 offen
    buffer_load_dwordx4 v[76:79], v5, s[12:15], s46 offen
    buffer_load_dwordx4 v[80:83], v6, s[12:15], s46 offen
    buffer_load_dwordx4 v[84:87], v7, s[12:15], s46 offen
    buffer_load_dwordx4 v[88:91], v8, s[12:15], s46 offen
    buffer_load_dwordx4 v[92:95], v9, s[12:15], s46 offen
    s_waitcnt lgkmcnt(0)
    s_barrier
    ds_read_b64_tr_b16 a[24:25], v16 offset:0
    ds_read_b64_tr_b16 a[26:27], v16 offset:800
    ds_read_b64_tr_b16 a[28:29], v16 offset:12800
    ds_read_b64_tr_b16 a[30:31], v16 offset:13600
    ds_read_b64_tr_b16 a[104:105], v16 offset:32
    ds_read_b64_tr_b16 a[106:107], v16 offset:832
    ds_read_b64_tr_b16 a[108:109], v16 offset:12832
    ds_read_b64_tr_b16 a[110:111], v16 offset:13632
    ds_read_b64_tr_b16 a[184:185], v16 offset:64
    ds_read_b64_tr_b16 a[186:187], v16 offset:864
    ds_read_b64_tr_b16 a[188:189], v16 offset:12864
    ds_read_b64_tr_b16 a[190:191], v16 offset:13664
    s_waitcnt lgkmcnt(0)
    s_barrier
    s_waitcnt vmcnt(6)
    ds_write_b128 v10, v[48:51]
    ds_write_b128 v11, v[52:55]
    ds_write_b128 v12, v[56:59]
    ds_write_b128 v13, v[60:63]
    ds_write_b128 v14, v[64:67]
    ds_write_b128 v15, v[68:71]
    s_add_u32 s46, s45, 3145728
    buffer_load_dwordx4 v[24:27], v4, s[16:19], s46 offen
    buffer_load_dwordx4 v[28:31], v5, s[16:19], s46 offen
    buffer_load_dwordx4 v[32:35], v6, s[16:19], s46 offen
    buffer_load_dwordx4 v[36:39], v7, s[16:19], s46 offen
    buffer_load_dwordx4 v[40:43], v8, s[16:19], s46 offen
    buffer_load_dwordx4 v[44:47], v9, s[16:19], s46 offen
    s_waitcnt lgkmcnt(0)
    s_barrier
    ds_read_b64_tr_b16 v[120:121], v16 offset:32
    ds_read_b64_tr_b16 v[122:123], v16 offset:832
    ds_read_b64_tr_b16 v[124:125], v16 offset:12832
    ds_read_b64_tr_b16 v[126:127], v16 offset:13632
    ds_read_b64_tr_b16 v[200:201], v16 offset:64
    ds_read_b64_tr_b16 v[202:203], v16 offset:864
    ds_read_b64_tr_b16 v[204:205], v16 offset:12864
    ds_read_b64_tr_b16 v[206:207], v16 offset:13664
    ds_read_b64_tr_b16 v[48:49], v16 offset:0
    ds_read_b64_tr_b16 v[50:51], v16 offset:800
    ds_read_b64_tr_b16 v[52:53], v16 offset:12800
    ds_read_b64_tr_b16 v[54:55], v16 offset:13600
    s_waitcnt lgkmcnt(0)
    ds_write_b128 v17, v[48:51] offset:6144
    ds_write_b128 v17, v[52:55] offset:7168
    s_waitcnt lgkmcnt(0)
    s_barrier
    s_waitcnt vmcnt(6)
    ds_write_b128 v10, v[72:75]
    ds_write_b128 v11, v[76:79]
    ds_write_b128 v12, v[80:83]
    ds_write_b128 v13, v[84:87]
    ds_write_b128 v14, v[88:91]
    ds_write_b128 v15, v[92:95]
    s_add_u32 s46, s45, 3932160
    buffer_load_dwordx4 v[48:51], v4, s[12:15], s46 offen
    buffer_load_dwordx4 v[52:55], v5, s[12:15], s46 offen
    buffer_load_dwordx4 v[56:59], v6, s[12:15], s46 offen
    buffer_load_dwordx4 v[60:63], v7, s[12:15], s46 offen
    buffer_load_dwordx4 v[64:67], v8, s[12:15], s46 offen
    buffer_load_dwordx4 v[68:71], v9, s[12:15], s46 offen
    s_waitcnt lgkmcnt(0)
    s_barrier
    ds_read_b64_tr_b16 a[32:33], v16 offset:0
    ds_read_b64_tr_b16 a[34:35], v16 offset:800
    ds_read_b64_tr_b16 a[36:37], v16 offset:12800
    ds_read_b64_tr_b16 a[38:39], v16 offset:13600
    ds_read_b64_tr_b16 a[112:113], v16 offset:32
    ds_read_b64_tr_b16 a[114:115], v16 offset:832
    ds_read_b64_tr_b16 a[116:117], v16 offset:12832
    ds_read_b64_tr_b16 a[118:119], v16 offset:13632
    ds_read_b64_tr_b16 a[192:193], v16 offset:64
    ds_read_b64_tr_b16 a[194:195], v16 offset:864
    ds_read_b64_tr_b16 a[196:197], v16 offset:12864
    ds_read_b64_tr_b16 a[198:199], v16 offset:13664
    s_waitcnt lgkmcnt(0)
    s_barrier
    s_waitcnt vmcnt(6)
    ds_write_b128 v10, v[24:27]
    ds_write_b128 v11, v[28:31]
    ds_write_b128 v12, v[32:35]
    ds_write_b128 v13, v[36:39]
    ds_write_b128 v14, v[40:43]
    ds_write_b128 v15, v[44:47]
    s_add_u32 s46, s45, 3932160
    buffer_load_dwordx4 v[72:75], v4, s[16:19], s46 offen
    buffer_load_dwordx4 v[76:79], v5, s[16:19], s46 offen
    buffer_load_dwordx4 v[80:83], v6, s[16:19], s46 offen
    buffer_load_dwordx4 v[84:87], v7, s[16:19], s46 offen
    buffer_load_dwordx4 v[88:91], v8, s[16:19], s46 offen
    buffer_load_dwordx4 v[92:95], v9, s[16:19], s46 offen
    s_waitcnt lgkmcnt(0)
    s_barrier
    ds_read_b64_tr_b16 v[128:129], v16 offset:32
    ds_read_b64_tr_b16 v[130:131], v16 offset:832
    ds_read_b64_tr_b16 v[132:133], v16 offset:12832
    ds_read_b64_tr_b16 v[134:135], v16 offset:13632
    ds_read_b64_tr_b16 v[208:209], v16 offset:64
    ds_read_b64_tr_b16 v[210:211], v16 offset:864
    ds_read_b64_tr_b16 v[212:213], v16 offset:12864
    ds_read_b64_tr_b16 v[214:215], v16 offset:13664
    ds_read_b64_tr_b16 v[24:25], v16 offset:0
    ds_read_b64_tr_b16 v[26:27], v16 offset:800
    ds_read_b64_tr_b16 v[28:29], v16 offset:12800
    ds_read_b64_tr_b16 v[30:31], v16 offset:13600
    s_waitcnt lgkmcnt(0)
    ds_write_b128 v17, v[24:27] offset:8192
    ds_write_b128 v17, v[28:31] offset:9216
    s_waitcnt lgkmcnt(0)
    s_barrier
    s_waitcnt vmcnt(6)
    ds_write_b128 v10, v[48:51]
    ds_write_b128 v11, v[52:55]
    ds_write_b128 v12, v[56:59]
    ds_write_b128 v13, v[60:63]
    ds_write_b128 v14, v[64:67]
    ds_write_b128 v15, v[68:71]
    s_add_u32 s46, s45, 4718592
    buffer_load_dwordx4 v[24:27], v4, s[12:15], s46 offen
    buffer_load_dwordx4 v[28:31], v5, s[12:15], s46 offen
    buffer_load_dwordx4 v[32:35], v6, s[12:15], s46 offen
    buffer_load_dwordx4 v[36:39], v7, s[12:15], s46 offen
    buffer_load_dwordx4 v[40:43], v8, s[12:15], s46 offen
    buffer_load_dwordx4 v[44:47], v9, s[12:15], s46 offen
    s_waitcnt lgkmcnt(0)
    s_barrier
    ds_read_b64_tr_b16 a[40:41], v16 offset:0
    ds_read_b64_tr_b16 a[42:43], v16 offset:800
    ds_read_b64_tr_b16 a[44:45], v16 offset:12800
    ds_read_b64_tr_b16 a[46:47], v16 offset:13600
    ds_read_b64_tr_b16 a[120:121], v16 offset:32
    ds_read_b64_tr_b16 a[122:123], v16 offset:832
    ds_read_b64_tr_b16 a[124:125], v16 offset:12832
    ds_read_b64_tr_b16 a[126:127], v16 offset:13632
    ds_read_b64_tr_b16 a[200:201], v16 offset:64
    ds_read_b64_tr_b16 a[202:203], v16 offset:864
    ds_read_b64_tr_b16 a[204:205], v16 offset:12864
    ds_read_b64_tr_b16 a[206:207], v16 offset:13664
    s_waitcnt lgkmcnt(0)
    s_barrier
    s_waitcnt vmcnt(6)
    ds_write_b128 v10, v[72:75]
    ds_write_b128 v11, v[76:79]
    ds_write_b128 v12, v[80:83]
    ds_write_b128 v13, v[84:87]
    ds_write_b128 v14, v[88:91]
    ds_write_b128 v15, v[92:95]
    s_add_u32 s46, s45, 4718592
    buffer_load_dwordx4 v[48:51], v4, s[16:19], s46 offen
    buffer_load_dwordx4 v[52:55], v5, s[16:19], s46 offen
    buffer_load_dwordx4 v[56:59], v6, s[16:19], s46 offen
    buffer_load_dwordx4 v[60:63], v7, s[16:19], s46 offen
    buffer_load_dwordx4 v[64:67], v8, s[16:19], s46 offen
    buffer_load_dwordx4 v[68:71], v9, s[16:19], s46 offen
    s_waitcnt lgkmcnt(0)
    s_barrier
    ds_read_b64_tr_b16 v[136:137], v16 offset:32
    ds_read_b64_tr_b16 v[138:139], v16 offset:832
    ds_read_b64_tr_b16 v[140:141], v16 offset:12832
    ds_read_b64_tr_b16 v[142:143], v16 offset:13632
    ds_read_b64_tr_b16 v[216:217], v16 offset:64
    ds_read_b64_tr_b16 v[218:219], v16 offset:864
    ds_read_b64_tr_b16 v[220:221], v16 offset:12864
    ds_read_b64_tr_b16 v[222:223], v16 offset:13664
    ds_read_b64_tr_b16 v[72:73], v16 offset:0
    ds_read_b64_tr_b16 v[74:75], v16 offset:800
    ds_read_b64_tr_b16 v[76:77], v16 offset:12800
    ds_read_b64_tr_b16 v[78:79], v16 offset:13600
    s_waitcnt lgkmcnt(0)
    ds_write_b128 v17, v[72:75] offset:10240
    ds_write_b128 v17, v[76:79] offset:11264
    s_waitcnt lgkmcnt(0)
    s_barrier
    s_waitcnt vmcnt(6)
    ds_write_b128 v10, v[24:27]
    ds_write_b128 v11, v[28:31]
    ds_write_b128 v12, v[32:35]
    ds_write_b128 v13, v[36:39]
    ds_write_b128 v14, v[40:43]
    ds_write_b128 v15, v[44:47]
    s_add_u32 s46, s45, 5505024
    buffer_load_dwordx4 v[72:75], v4, s[12:15], s46 offen
    buffer_load_dwordx4 v[76:79], v5, s[12:15], s46 offen
    buffer_load_dwordx4 v[80:83], v6, s[12:15], s46 offen
    buffer_load_dwordx4 v[84:87], v7, s[12:15], s46 offen
    buffer_load_dwordx4 v[88:91], v8, s[12:15], s46 offen
    buffer_load_dwordx4 v[92:95], v9, s[12:15], s46 offen
    s_waitcnt lgkmcnt(0)
    s_barrier
    ds_read_b64_tr_b16 a[48:49], v16 offset:0
    ds_read_b64_tr_b16 a[50:51], v16 offset:800
    ds_read_b64_tr_b16 a[52:53], v16 offset:12800
    ds_read_b64_tr_b16 a[54:55], v16 offset:13600
    ds_read_b64_tr_b16 a[128:129], v16 offset:32
    ds_read_b64_tr_b16 a[130:131], v16 offset:832
    ds_read_b64_tr_b16 a[132:133], v16 offset:12832
    ds_read_b64_tr_b16 a[134:135], v16 offset:13632
    ds_read_b64_tr_b16 a[208:209], v16 offset:64
    ds_read_b64_tr_b16 a[210:211], v16 offset:864
    ds_read_b64_tr_b16 a[212:213], v16 offset:12864
    ds_read_b64_tr_b16 a[214:215], v16 offset:13664
    s_waitcnt lgkmcnt(0)
    s_barrier
    s_waitcnt vmcnt(6)
    ds_write_b128 v10, v[48:51]
    ds_write_b128 v11, v[52:55]
    ds_write_b128 v12, v[56:59]
    ds_write_b128 v13, v[60:63]
    ds_write_b128 v14, v[64:67]
    ds_write_b128 v15, v[68:71]
    s_add_u32 s46, s45, 5505024
    buffer_load_dwordx4 v[24:27], v4, s[16:19], s46 offen
    buffer_load_dwordx4 v[28:31], v5, s[16:19], s46 offen
    buffer_load_dwordx4 v[32:35], v6, s[16:19], s46 offen
    buffer_load_dwordx4 v[36:39], v7, s[16:19], s46 offen
    buffer_load_dwordx4 v[40:43], v8, s[16:19], s46 offen
    buffer_load_dwordx4 v[44:47], v9, s[16:19], s46 offen
    s_waitcnt lgkmcnt(0)
    s_barrier
    ds_read_b64_tr_b16 v[144:145], v16 offset:32
    ds_read_b64_tr_b16 v[146:147], v16 offset:832
    ds_read_b64_tr_b16 v[148:149], v16 offset:12832
    ds_read_b64_tr_b16 v[150:151], v16 offset:13632
    ds_read_b64_tr_b16 v[224:225], v16 offset:64
    ds_read_b64_tr_b16 v[226:227], v16 offset:864
    ds_read_b64_tr_b16 v[228:229], v16 offset:12864
    ds_read_b64_tr_b16 v[230:231], v16 offset:13664
    ds_read_b64_tr_b16 v[48:49], v16 offset:0
    ds_read_b64_tr_b16 v[50:51], v16 offset:800
    ds_read_b64_tr_b16 v[52:53], v16 offset:12800
    ds_read_b64_tr_b16 v[54:55], v16 offset:13600
    s_waitcnt lgkmcnt(0)
    ds_write_b128 v17, v[48:51] offset:12288
    ds_write_b128 v17, v[52:55] offset:13312
    s_waitcnt lgkmcnt(0)
    s_barrier
    s_waitcnt vmcnt(6)
    ds_write_b128 v10, v[72:75]
    ds_write_b128 v11, v[76:79]
    ds_write_b128 v12, v[80:83]
    ds_write_b128 v13, v[84:87]
    ds_write_b128 v14, v[88:91]
    ds_write_b128 v15, v[92:95]
    s_add_u32 s46, s45, 6291456
    buffer_load_dwordx4 v[48:51], v4, s[12:15], s46 offen
    buffer_load_dwordx4 v[52:55], v5, s[12:15], s46 offen
    buffer_load_dwordx4 v[56:59], v6, s[12:15], s46 offen
    buffer_load_dwordx4 v[60:63], v7, s[12:15], s46 offen
    buffer_load_dwordx4 v[64:67], v8, s[12:15], s46 offen
    buffer_load_dwordx4 v[68:71], v9, s[12:15], s46 offen
    s_waitcnt lgkmcnt(0)
    s_barrier
    ds_read_b64_tr_b16 a[56:57], v16 offset:0
    ds_read_b64_tr_b16 a[58:59], v16 offset:800
    ds_read_b64_tr_b16 a[60:61], v16 offset:12800
    ds_read_b64_tr_b16 a[62:63], v16 offset:13600
    ds_read_b64_tr_b16 a[136:137], v16 offset:32
    ds_read_b64_tr_b16 a[138:139], v16 offset:832
    ds_read_b64_tr_b16 a[140:141], v16 offset:12832
    ds_read_b64_tr_b16 a[142:143], v16 offset:13632
    ds_read_b64_tr_b16 a[216:217], v16 offset:64
    ds_read_b64_tr_b16 a[218:219], v16 offset:864
    ds_read_b64_tr_b16 a[220:221], v16 offset:12864
    ds_read_b64_tr_b16 a[222:223], v16 offset:13664
    s_waitcnt lgkmcnt(0)
    s_barrier
    s_waitcnt vmcnt(6)
    ds_write_b128 v10, v[24:27]
    ds_write_b128 v11, v[28:31]
    ds_write_b128 v12, v[32:35]
    ds_write_b128 v13, v[36:39]
    ds_write_b128 v14, v[40:43]
    ds_write_b128 v15, v[44:47]
    s_add_u32 s46, s45, 6291456
    buffer_load_dwordx4 v[72:75], v4, s[16:19], s46 offen
    buffer_load_dwordx4 v[76:79], v5, s[16:19], s46 offen
    buffer_load_dwordx4 v[80:83], v6, s[16:19], s46 offen
    buffer_load_dwordx4 v[84:87], v7, s[16:19], s46 offen
    buffer_load_dwordx4 v[88:91], v8, s[16:19], s46 offen
    buffer_load_dwordx4 v[92:95], v9, s[16:19], s46 offen
    s_waitcnt lgkmcnt(0)
    s_barrier
    ds_read_b64_tr_b16 v[152:153], v16 offset:32
    ds_read_b64_tr_b16 v[154:155], v16 offset:832
    ds_read_b64_tr_b16 v[156:157], v16 offset:12832
    ds_read_b64_tr_b16 v[158:159], v16 offset:13632
    ds_read_b64_tr_b16 v[232:233], v16 offset:64
    ds_read_b64_tr_b16 v[234:235], v16 offset:864
    ds_read_b64_tr_b16 v[236:237], v16 offset:12864
    ds_read_b64_tr_b16 v[238:239], v16 offset:13664
    ds_read_b64_tr_b16 v[24:25], v16 offset:0
    ds_read_b64_tr_b16 v[26:27], v16 offset:800
    ds_read_b64_tr_b16 v[28:29], v16 offset:12800
    ds_read_b64_tr_b16 v[30:31], v16 offset:13600
    s_waitcnt lgkmcnt(0)
    ds_write_b128 v17, v[24:27] offset:14336
    ds_write_b128 v17, v[28:31] offset:15360
    s_waitcnt lgkmcnt(0)
    s_barrier
    s_waitcnt vmcnt(6)
    ds_write_b128 v10, v[48:51]
    ds_write_b128 v11, v[52:55]
    ds_write_b128 v12, v[56:59]
    ds_write_b128 v13, v[60:63]
    ds_write_b128 v14, v[64:67]
    ds_write_b128 v15, v[68:71]
    s_add_u32 s46, s45, 7077888
    buffer_load_dwordx4 v[24:27], v4, s[12:15], s46 offen
    buffer_load_dwordx4 v[28:31], v5, s[12:15], s46 offen
    buffer_load_dwordx4 v[32:35], v6, s[12:15], s46 offen
    buffer_load_dwordx4 v[36:39], v7, s[12:15], s46 offen
    buffer_load_dwordx4 v[40:43], v8, s[12:15], s46 offen
    buffer_load_dwordx4 v[44:47], v9, s[12:15], s46 offen
    s_waitcnt lgkmcnt(0)
    s_barrier
    ds_read_b64_tr_b16 a[64:65], v16 offset:0
    ds_read_b64_tr_b16 a[66:67], v16 offset:800
    ds_read_b64_tr_b16 a[68:69], v16 offset:12800
    ds_read_b64_tr_b16 a[70:71], v16 offset:13600
    ds_read_b64_tr_b16 a[144:145], v16 offset:32
    ds_read_b64_tr_b16 a[146:147], v16 offset:832
    ds_read_b64_tr_b16 a[148:149], v16 offset:12832
    ds_read_b64_tr_b16 a[150:151], v16 offset:13632
    ds_read_b64_tr_b16 a[224:225], v16 offset:64
    ds_read_b64_tr_b16 a[226:227], v16 offset:864
    ds_read_b64_tr_b16 a[228:229], v16 offset:12864
    ds_read_b64_tr_b16 a[230:231], v16 offset:13664
    s_waitcnt lgkmcnt(0)
    s_barrier
    s_waitcnt vmcnt(6)
    ds_write_b128 v10, v[72:75]
    ds_write_b128 v11, v[76:79]
    ds_write_b128 v12, v[80:83]
    ds_write_b128 v13, v[84:87]
    ds_write_b128 v14, v[88:91]
    ds_write_b128 v15, v[92:95]
    s_add_u32 s46, s45, 7077888
    buffer_load_dwordx4 v[48:51], v4, s[16:19], s46 offen
    buffer_load_dwordx4 v[52:55], v5, s[16:19], s46 offen
    buffer_load_dwordx4 v[56:59], v6, s[16:19], s46 offen
    buffer_load_dwordx4 v[60:63], v7, s[16:19], s46 offen
    buffer_load_dwordx4 v[64:67], v8, s[16:19], s46 offen
    buffer_load_dwordx4 v[68:71], v9, s[16:19], s46 offen
    s_waitcnt lgkmcnt(0)
    s_barrier
    ds_read_b64_tr_b16 v[160:161], v16 offset:32
    ds_read_b64_tr_b16 v[162:163], v16 offset:832
    ds_read_b64_tr_b16 v[164:165], v16 offset:12832
    ds_read_b64_tr_b16 v[166:167], v16 offset:13632
    ds_read_b64_tr_b16 v[240:241], v16 offset:64
    ds_read_b64_tr_b16 v[242:243], v16 offset:864
    ds_read_b64_tr_b16 v[244:245], v16 offset:12864
    ds_read_b64_tr_b16 v[246:247], v16 offset:13664
    ds_read_b64_tr_b16 v[72:73], v16 offset:0
    ds_read_b64_tr_b16 v[74:75], v16 offset:800
    ds_read_b64_tr_b16 v[76:77], v16 offset:12800
    ds_read_b64_tr_b16 v[78:79], v16 offset:13600
    s_waitcnt lgkmcnt(0)
    ds_write_b128 v17, v[72:75] offset:16384
    ds_write_b128 v17, v[76:79] offset:17408
    s_waitcnt lgkmcnt(0)
    s_barrier
    s_waitcnt vmcnt(6)
    ds_write_b128 v10, v[24:27]
    ds_write_b128 v11, v[28:31]
    ds_write_b128 v12, v[32:35]
    ds_write_b128 v13, v[36:39]
    ds_write_b128 v14, v[40:43]
    ds_write_b128 v15, v[44:47]
    s_waitcnt lgkmcnt(0)
    s_barrier
    ds_read_b64_tr_b16 a[72:73], v16 offset:0
    ds_read_b64_tr_b16 a[74:75], v16 offset:800
    ds_read_b64_tr_b16 a[76:77], v16 offset:12800
    ds_read_b64_tr_b16 a[78:79], v16 offset:13600
    ds_read_b64_tr_b16 a[152:153], v16 offset:32
    ds_read_b64_tr_b16 a[154:155], v16 offset:832
    ds_read_b64_tr_b16 a[156:157], v16 offset:12832
    ds_read_b64_tr_b16 a[158:159], v16 offset:13632
    ds_read_b64_tr_b16 a[232:233], v16 offset:64
    ds_read_b64_tr_b16 a[234:235], v16 offset:864
    ds_read_b64_tr_b16 a[236:237], v16 offset:12864
    ds_read_b64_tr_b16 a[238:239], v16 offset:13664
    s_waitcnt lgkmcnt(0)
    s_barrier
    s_waitcnt vmcnt(0)
    ds_write_b128 v10, v[48:51]
    ds_write_b128 v11, v[52:55]
    ds_write_b128 v12, v[56:59]
    ds_write_b128 v13, v[60:63]
    ds_write_b128 v14, v[64:67]
    ds_write_b128 v15, v[68:71]
    s_waitcnt lgkmcnt(0)
    s_barrier
    ds_read_b64_tr_b16 v[168:169], v16 offset:32
    ds_read_b64_tr_b16 v[170:171], v16 offset:832
    ds_read_b64_tr_b16 v[172:173], v16 offset:12832
    ds_read_b64_tr_b16 v[174:175], v16 offset:13632
    ds_read_b64_tr_b16 v[248:249], v16 offset:64
    ds_read_b64_tr_b16 v[250:251], v16 offset:864
    ds_read_b64_tr_b16 v[252:253], v16 offset:12864
    ds_read_b64_tr_b16 v[254:255], v16 offset:13664
    ds_read_b64_tr_b16 v[48:49], v16 offset:0
    ds_read_b64_tr_b16 v[50:51], v16 offset:800
    ds_read_b64_tr_b16 v[52:53], v16 offset:12800
    ds_read_b64_tr_b16 v[54:55], v16 offset:13600
    s_waitcnt lgkmcnt(0)
    ds_write_b128 v17, v[48:51] offset:18432
    ds_write_b128 v17, v[52:55] offset:19456
    s_waitcnt lgkmcnt(0)
    s_barrier
    v_mov_b32 v6, v17
    v_mov_b32 v30, 0xeeee
    v_mov_b32 v4, 0x4444
    v_cmp_gt_u32 vcc, 8, v2
    s_nop 1
    v_cndmask_b32 v4, v30, v4, vcc
    v_lshlrev_b32 v5, 4, v1
    s_lshl_b32 s24, s3, 10
    v_add_u32 v7, s24, v5
    s_lshl_b32 s24, s3, 9
    s_add_u32 s24, s24, 8192
    v_lshlrev_b32 v8, 3, v1
    v_add_u32 v8, s24, v8
    v_and_b32 v30, 1, v2
    v_lshlrev_b32 v30, 4, v30
    v_mov_b32 v31, 0x3f80
    v_lshlrev_b32 v31, v30, v31
    v_lshrrev_b32 v30, 2, v2
    v_cmp_eq_u32 vcc, v30, v3
    s_nop 1
    v_cndmask_b32 v31, 0, v31, vcc
    v_and_b32 v30, 2, v2
    v_cmp_eq_u32 vcc, 0, v30
    s_nop 1
    v_cndmask_b32 v10, 0, v31, vcc
    v_cndmask_b32 v11, v31, 0, vcc
    v_add_u32 v33, 22528, v5
    s_mul_i32 s24, s3, 1408
    s_add_u32 s24, s24, 16384
    v_mul_u32_u24 v30, 176, v2
    v_add_u32 v30, s24, v30
    v_lshl_add_u32 v12, v3, 5, v30
    v_cmp_gt_u32 vcc, 8, v2
    s_nop 1
    v_cndmask_b32 v12, v33, v12, vcc
    v_lshl_add_u32 v13, v3, 4, v30
    v_add_u32 v13, 96, v13
    v_cmp_le_u32 s[24:25], 2, v3
    s_and_b64 vcc, vcc, s[24:25]
    v_cndmask_b32 v13, v33, v13, vcc
    s_mul_i32 s24, s3, 5632
    s_add_u32 s24, s24, 106496
    v_mul_u32_u24 v30, 176, v2
    v_add_u32 v30, s24, v30
    v_lshl_add_u32 v16, v3, 5, v30
    v_lshl_add_u32 v17, v3, 4, v30
    v_add_u32 v17, 96, v17
    v_add_u32 v18, 2816, v17
    v_cmp_le_u32 vcc, 2, v3
    s_nop 1
    v_cndmask_b32 v17, v33, v17, vcc
    v_cndmask_b32 v18, v33, v18, vcc
    v_lshrrev_b32 v30, 3, v1
    v_and_b32 v31, 7, v1
    v_min_u32 v32, 4, v31
    v_mul_u32_u24 v14, 176, v30
    v_lshl_add_u32 v14, v32, 5, v14
    s_mul_i32 s24, s3, 1408
    s_add_u32 s24, s24, 106496
    v_add_u32 v21, s24, v14
    v_add_u32 v14, 16384, v14
    v_cmp_gt_u32 s[50:51], 5, v31
    s_lshl_b32 s24, s3, 3
    v_add_u32 v32, s24, v30
    v_lshlrev_b32 v33, 2, v31
    v_sub_u32 v32, v32, v33
    v_mov_b32 v33, 100
    v_cmp_gt_u32 vcc, 4, v31
    s_nop 1
    v_cndmask_b32 v32, v33, v32, vcc
    v_cmp_le_i32 s[64:65], 0, v32
    v_cmp_le_i32 s[66:67], 1, v32
    v_cmp_le_i32 s[68:69], 2, v32
    v_cmp_le_i32 s[70:71], 3, v32
    v_cmp_le_i32 s[72:73], 16, v32
    v_cmp_le_i32 s[74:75], 17, v32
    v_cmp_le_i32 s[76:77], 18, v32
    v_cmp_le_i32 s[78:79], 19, v32
    s_lshr_b32 s24, s44, 1
    s_lshl_b32 s24, s24, 10
    s_and_b32 s25, s44, 1
    s_lshl_b32 s25, s25, 7
    s_add_u32 s24, s24, s25
    v_lshlrev_b32 v15, 8, v31
    v_lshl_add_u32 v15, v30, 4, v15
    v_add_u32 v15, s24, v15
    s_lshr_b32 s24, s44, 3
    s_lshl_b32 s24, s24, 10
    s_and_b32 s25, s44, 3
    s_lshl_b32 s25, s25, 8
    s_add_u32 s24, s24, s25
    s_lshr_b32 s25, s44, 2
    s_and_b32 s25, s25, 1
    s_lshl_b32 s25, s25, 7
    s_add_u32 s24, s24, s25
    s_add_u32 s24, s24, 16384
    v_lshlrev_b32 v32, 4, v30
    v_add_u32 v32, s24, v32
    v_cmp_eq_u32 vcc, 4, v31
    s_nop 1
    v_cndmask_b32 v15, v15, v32, vcc
    v_and_b32 v32, 0xffffe000, v15
    v_add_u32 v15, v15, v32
    v_mov_b32 v32, 2146435072
    v_cndmask_b32 v15, v32, v15, s[50:51]
    s_cmp_lt_u32 s3, 1
    s_cselect_b32 s24, 0, 2146435072
    v_or_b32 v15, s24, v15
    s_and_b32 s24, s3, 1
    s_lshl_b32 s24, s24, 7
    s_lshr_b32 s25, s3, 1
    s_lshl_b32 s25, s25, 10
    s_add_u32 s24, s24, s25
    s_lshl_b32 s25, s44, 11
    s_add_u32 s25, s25, s24
    v_lshlrev_b32 v22, 8, v31
    v_lshl_add_u32 v22, v30, 4, v22
    v_add_u32 v22, s25, v22
    s_lshr_b32 s25, s44, 2
    s_lshl_b32 s25, s25, 11
    s_add_u32 s25, s25, s24
    s_and_b32 s26, s44, 3
    s_lshl_b32 s26, s26, 8
    s_add_u32 s25, s25, s26
    s_add_u32 s25, s25, 65536
    v_lshlrev_b32 v32, 4, v30
    v_add_u32 v32, s25, v32
    v_cmp_eq_u32 vcc, 4, v31
    s_nop 1
    v_cndmask_b32 v22, v22, v32, vcc
    v_and_b32 v32, 0xffffe000, v22
    v_add_u32 v22, v22, v32
    v_mov_b32 v32, 2146435072
    v_cndmask_b32 v22, v32, v22, s[50:51]
    s_mul_i32 s24, s44, 12288
    s_mul_i32 s25, s3, 3072
    s_add_u32 s24, s24, s25
    v_add_u32 v19, s24, v5
    s_and_b32 s24, s2, 15
    s_mul_i32 s25, s3, 16
    s_add_u32 s24, s24, s25
    s_lshl_b32 s24, s24, 7
    v_mov_b32 v23, s24
    s_lshr_b32 s25, s44, 3
    s_mul_i32 s24, s25, 8
    v_add_u32 v20, s24, v1
    v_lshlrev_b32 v20, 7, v20
    v_mov_b32 v30, 2146435072
    v_cmp_le_u32 vcc, 8, v1
    s_nop 1
    v_cndmask_b32 v20, v20, v30, vcc
    s_cmp_eq_u32 s3, 0
    s_cselect_b32 s24, 0, 2146435072
    v_or_b32 v20, s24, v20
    v_mov_b32 v0, 1
interleave_layers__linear_attn_block__memory_aug_recurrent_mem_tr__prompt_kernel_s_layer:
    s_mov_b32 s93, 0
    s_lshl_b32 s24, s93, 12
    s_and_b32 s24, s24, 0x2000
    s_xor_b32 s24, s24, s36
    s_lshl_b32 s93, s93, 20
    s_add_u32 s93, s93, s24
    s_add_u32 s93, s93, 117440512
    s_mul_i32 s94, s92, 16384
    s_add_u32 s94, s94, 23068672
    v_and_b32 v9, 1, v1
    v_lshlrev_b32 v9, 12, v9
    s_lshl_b32 s24, s44, 7
    s_add_u32 s24, s24, s94
    v_add_u32 v9, s24, v9
    s_lshl_b32 s24, s3, 6
    s_add_u32 s24, s24, 0
    v_add_u32 v48, s24, v1
    v_and_b32 v49, 7, v48
    v_mul_u32_u24 v49, 1280, v49
    v_lshrrev_b32 v50, 3, v48
    v_lshl_add_u32 v49, v50, 4, v49
    v_cmp_gt_u32 vcc, 640, v48
    v_mov_b32 v51, 2146435072
    s_nop 0
    v_cndmask_b32 v49, v51, v49, vcc
    buffer_load_dwordx4 v[52:55], v49, s[20:23], 0 offen
    v_lshlrev_b32 v48, 4, v48
    s_waitcnt vmcnt(0)
    s_and_saveexec_b64 s[30:31], vcc
    ds_write_b128 v48, v[52:55]
    s_mov_b64 exec, s[30:31]
    s_lshl_b32 s24, s3, 6
    s_add_u32 s24, s24, 256
    v_add_u32 v48, s24, v1
    v_and_b32 v49, 7, v48
    v_mul_u32_u24 v49, 1280, v49
    v_lshrrev_b32 v50, 3, v48
    v_lshl_add_u32 v49, v50, 4, v49
    v_cmp_gt_u32 vcc, 640, v48
    v_mov_b32 v51, 2146435072
    s_nop 0
    v_cndmask_b32 v49, v51, v49, vcc
    buffer_load_dwordx4 v[52:55], v49, s[20:23], 0 offen
    v_lshlrev_b32 v48, 4, v48
    s_waitcnt vmcnt(0)
    s_and_saveexec_b64 s[30:31], vcc
    ds_write_b128 v48, v[52:55]
    s_mov_b64 exec, s[30:31]
    s_lshl_b32 s24, s3, 6
    s_add_u32 s24, s24, 512
    v_add_u32 v48, s24, v1
    v_and_b32 v49, 7, v48
    v_mul_u32_u24 v49, 1280, v49
    v_lshrrev_b32 v50, 3, v48
    v_lshl_add_u32 v49, v50, 4, v49
    v_cmp_gt_u32 vcc, 640, v48
    v_mov_b32 v51, 2146435072
    s_nop 0
    v_cndmask_b32 v49, v51, v49, vcc
    buffer_load_dwordx4 v[52:55], v49, s[20:23], 0 offen
    v_lshlrev_b32 v48, 4, v48
    s_waitcnt vmcnt(0)
    s_and_saveexec_b64 s[30:31], vcc
    ds_write_b128 v48, v[52:55]
    s_mov_b64 exec, s[30:31]
    s_mov_b32 s40, 0
    s_mov_b32 s41, 92274688
    s_mov_b32 s37, s93
    s_add_u32 s43, s93, 655360
    s_mov_b32 s45, 67108864
    s_add_u32 s49, s93, 753664
    s_lshl_b32 s95, s92, 6
    s_add_u32 s95, s95, s40
    s_add_u32 s95, s95, 1
    s_cmp_ge_i32 s59, s95
    s_cbranch_scc1 interleave_layers__linear_attn_block__memory_aug_recurrent_mem_tr__prompt_kernel_s_ec0_ok
    s_and_b32 s24, s2, 7
    s_lshl_b32 s24, s24, 7
    s_add_u32 s24, s24, 23109632
    v_and_b32 v49, 3, v1
    v_lshl_add_u32 v49, v49, 2, s24
    s_mov_b32 s61, 0
interleave_layers__linear_attn_block__memory_aug_recurrent_mem_tr__prompt_kernel_s_ec0:
    buffer_load_dword v48, v49, s[8:11], 0 offen sc1
    s_waitcnt vmcnt(0)
    v_readlane_b32 s59, v48, 0
    v_readlane_b32 s24, v48, 1
    s_min_i32 s59, s59, s24
    v_readlane_b32 s24, v48, 2
    s_min_i32 s59, s59, s24
    s_cmp_ge_i32 s59, s95
    s_cbranch_scc1 interleave_layers__linear_attn_block__memory_aug_recurrent_mem_tr__prompt_kernel_s_ec0_ok
    s_add_u32 s61, s61, 1
    s_cmp_ge_u32 s61, s60
    s_cbranch_scc1 interleave_layers__linear_attn_block__memory_aug_recurrent_mem_tr__prompt_kernel_s_ec0_to
    s_sleep 2
    s_branch interleave_layers__linear_attn_block__memory_aug_recurrent_mem_tr__prompt_kernel_s_ec0
interleave_layers__linear_attn_block__memory_aug_recurrent_mem_tr__prompt_kernel_s_ec0_to:
    s_mov_b32 s60, 1
interleave_layers__linear_attn_block__memory_aug_recurrent_mem_tr__prompt_kernel_s_ec0_ok:
    s_mov_b32 s62, -1
    s_mov_b32 s63, 1
    s_cmp_ge_i32 s62, s63
    s_cbranch_scc1 interleave_layers__linear_attn_block__memory_aug_recurrent_mem_tr__prompt_kernel_s_en0_ok
    s_mov_b32 s61, 0
interleave_layers__linear_attn_block__memory_aug_recurrent_mem_tr__prompt_kernel_s_en0:
    buffer_load_dword v48, v9, s[8:11], 0 offen sc1
    s_waitcnt vmcnt(0)
    v_readlane_b32 s62, v48, 0
    v_readlane_b32 s24, v48, 1
    s_min_i32 s62, s62, s24
    s_cmp_ge_i32 s62, s63
    s_cbranch_scc1 interleave_layers__linear_attn_block__memory_aug_recurrent_mem_tr__prompt_kernel_s_en0_ok
    s_add_u32 s61, s61, 1
    s_cmp_ge_u32 s61, s60
    s_cbranch_scc1 interleave_layers__linear_attn_block__memory_aug_recurrent_mem_tr__prompt_kernel_s_en0_to
    s_sleep 2
    s_branch interleave_layers__linear_attn_block__memory_aug_recurrent_mem_tr__prompt_kernel_s_en0
interleave_layers__linear_attn_block__memory_aug_recurrent_mem_tr__prompt_kernel_s_en0_to:
    s_mov_b32 s60, 1
interleave_layers__linear_attn_block__memory_aug_recurrent_mem_tr__prompt_kernel_s_en0_ok:
    buffer_load_dwordx4 a[240:243], v19, s[8:11], s41 offen offset:0 sc1
    buffer_load_dwordx4 a[244:247], v19, s[8:11], s41 offen offset:1024 sc1
    buffer_load_dwordx4 a[248:251], v19, s[8:11], s41 offen offset:2048 sc1
    s_waitcnt lgkmcnt(0)
    v_mov_b32 v24, 0
    v_mov_b32 v25, 0
    v_mov_b32 v26, 0
    v_mov_b32 v27, 0
    v_mov_b32 v28, 0
    v_mov_b32 v29, 0
    v_mov_b32 v30, 0
    v_mov_b32 v31, 0
    v_mov_b32 v32, 0
    v_mov_b32 v33, 0
    v_mov_b32 v34, 0
    v_mov_b32 v35, 0
    v_mov_b32 v36, 0
    v_mov_b32 v37, 0
    v_mov_b32 v38, 0
    v_mov_b32 v39, 0
    v_mov_b32 v40, 0
    v_mov_b32 v41, 0
    v_mov_b32 v42, 0
    v_mov_b32 v43, 0
    v_mov_b32 v44, 0
    v_mov_b32 v45, 0
    v_mov_b32 v46, 0
    v_mov_b32 v47, 0
    s_barrier
    ds_read_b128 v[84:87], v7
    ds_read_b128 v[88:91], v7 offset:4096
    s_waitcnt vmcnt(0) lgkmcnt(0)
    s_cmp_eq_u32 s3, 0
    s_cbranch_scc1 interleave_layers__linear_attn_block__memory_aug_recurrent_mem_tr__prompt_kernel_s_gow0
    s_cmp_eq_u32 s3, 1
    s_cbranch_scc1 interleave_layers__linear_attn_block__memory_aug_recurrent_mem_tr__prompt_kernel_s_gow1
    s_cmp_eq_u32 s3, 2
    s_cbranch_scc1 interleave_layers__linear_attn_block__memory_aug_recurrent_mem_tr__prompt_kernel_s_gow2
    s_branch interleave_layers__linear_attn_block__memory_aug_recurrent_mem_tr__prompt_kernel_s_gow3
interleave_layers__linear_attn_block__memory_aug_recurrent_mem_tr__prompt_kernel_s_stepw0:
    v_mov_b32 v24, 0
    v_mov_b32 v25, 0
    v_mov_b32 v26, 0
    v_mov_b32 v27, 0
    v_mov_b32 v28, 0
    v_mov_b32 v29, 0
    v_mov_b32 v30, 0
    v_mov_b32 v31, 0
    v_mov_b32 v32, 0
    v_mov_b32 v33, 0
    v_mov_b32 v34, 0
    v_mov_b32 v35, 0
    v_mov_b32 v36, 0
    v_mov_b32 v37, 0
    v_mov_b32 v38, 0
    v_mov_b32 v39, 0
    v_mov_b32 v40, 0
    v_mov_b32 v41, 0
    v_mov_b32 v42, 0
    v_mov_b32 v43, 0
    v_mov_b32 v44, 0
    v_mov_b32 v45, 0
    v_mov_b32 v46, 0
    v_mov_b32 v47, 0
    s_add_u32 s46, s47, 4096
    s_add_u32 s52, s47, 8192
    s_lshl_b32 s95, s92, 6
    s_add_u32 s95, s95, s40
    s_add_u32 s95, s95, 1
    s_cmp_ge_i32 s59, s95
    s_cbranch_scc1 interleave_layers__linear_attn_block__memory_aug_recurrent_mem_tr__prompt_kernel_s_ecw0_ok
    s_and_b32 s24, s2, 7
    s_lshl_b32 s24, s24, 7
    s_add_u32 s24, s24, 23109632
    v_and_b32 v49, 3, v1
    v_lshl_add_u32 v49, v49, 2, s24
    s_mov_b32 s61, 0
interleave_layers__linear_attn_block__memory_aug_recurrent_mem_tr__prompt_kernel_s_ecw0:
    buffer_load_dword v48, v49, s[8:11], 0 offen sc1
    s_waitcnt vmcnt(0)
    v_readlane_b32 s59, v48, 0
    v_readlane_b32 s24, v48, 1
    s_min_i32 s59, s59, s24
    v_readlane_b32 s24, v48, 2
    s_min_i32 s59, s59, s24
    s_cmp_ge_i32 s59, s95
    s_cbranch_scc1 interleave_layers__linear_attn_block__memory_aug_recurrent_mem_tr__prompt_kernel_s_ecw0_ok
    s_add_u32 s61, s61, 1
    s_cmp_ge_u32 s61, s60
    s_cbranch_scc1 interleave_layers__linear_attn_block__memory_aug_recurrent_mem_tr__prompt_kernel_s_ecw0_to
    s_sleep 2
    s_branch interleave_layers__linear_attn_block__memory_aug_recurrent_mem_tr__prompt_kernel_s_ecw0
interleave_layers__linear_attn_block__memory_aug_recurrent_mem_tr__prompt_kernel_s_ecw0_to:
    s_mov_b32 s60, 1
interleave_layers__linear_attn_block__memory_aug_recurrent_mem_tr__prompt_kernel_s_ecw0_ok:
    s_add_u32 s63, s40, 1
    s_cmp_ge_i32 s62, s63
    s_cbranch_scc1 interleave_layers__linear_attn_block__memory_aug_recurrent_mem_tr__prompt_kernel_s_enw0_ok
    s_mov_b32 s61, 0
interleave_layers__linear_attn_block__memory_aug_recurrent_mem_tr__prompt_kernel_s_enw0:
    buffer_load_dword v48, v9, s[8:11], 0 offen sc1
    s_waitcnt vmcnt(0)
    v_readlane_b32 s62, v48, 0
    v_readlane_b32 s24, v48, 1
    s_min_i32 s62, s62, s24
    s_cmp_ge_i32 s62, s63
    s_cbranch_scc1 interleave_layers__linear_attn_block__memory_aug_recurrent_mem_tr__prompt_kernel_s_enw0_ok
    s_add_u32 s61, s61, 1
    s_cmp_ge_u32 s61, s60
    s_cbranch_scc1 interleave_layers__linear_attn_block__memory_aug_recurrent_mem_tr__prompt_kernel_s_enw0_to
    s_sleep 2
    s_branch interleave_layers__linear_attn_block__memory_aug_recurrent_mem_tr__prompt_kernel_s_enw0
interleave_layers__linear_attn_block__memory_aug_recurrent_mem_tr__prompt_kernel_s_enw0_to:
    s_mov_b32 s60, 1
interleave_layers__linear_attn_block__memory_aug_recurrent_mem_tr__prompt_kernel_s_enw0_ok:
    buffer_load_dwordx4 a[240:243], v19, s[8:11], s41 offen offset:0 sc1
    buffer_load_dwordx4 a[244:247], v19, s[8:11], s41 offen offset:1024 sc1
    buffer_load_dwordx4 a[248:251], v19, s[8:11], s41 offen offset:2048 sc1
    s_sleep 5
    s_mov_b64 exec, 1
    s_mov_b32 s61, 0
    v_mov_b32 v83, 0
    buffer_atomic_add v83, v23, s[8:11], s48 offen sc0
    s_sleep 2
    v_mov_b32 v94, 0
    buffer_atomic_add v94, v23, s[8:11], s48 offen sc0
    s_sleep 2
    v_mov_b32 v95, 0
    buffer_atomic_add v95, v23, s[8:11], s48 offen sc0
    s_sleep 2
interleave_layers__linear_attn_block__memory_aug_recurrent_mem_tr__prompt_kernel_s_prw0:
    v_mov_b32 v82, 0
    buffer_atomic_add v82, v23, s[8:11], s48 offen sc0
    s_waitcnt vmcnt(3)
    v_cmp_le_i32 vcc, 9, v83
    s_add_u32 s61, s61, 1
    s_cbranch_vccnz interleave_layers__linear_attn_block__memory_aug_recurrent_mem_tr__prompt_kernel_s_prw0_out
    s_sleep 2
    v_mov_b32 v83, 0
    buffer_atomic_add v83, v23, s[8:11], s48 offen sc0
    s_waitcnt vmcnt(3)
    v_cmp_le_i32 vcc, 9, v94
    s_add_u32 s61, s61, 1
    s_cbranch_vccnz interleave_layers__linear_attn_block__memory_aug_recurrent_mem_tr__prompt_kernel_s_prw0_out
    s_sleep 2
    v_mov_b32 v94, 0
    buffer_atomic_add v94, v23, s[8:11], s48 offen sc0
    s_waitcnt vmcnt(3)
    v_cmp_le_i32 vcc, 9, v95
    s_add_u32 s61, s61, 1
    s_cbranch_vccnz interleave_layers__linear_attn_block__memory_aug_recurrent_mem_tr__prompt_kernel_s_prw0_out
    s_sleep 2
    v_mov_b32 v95, 0
    buffer_atomic_add v95, v23, s[8:11], s48 offen sc0
    s_waitcnt vmcnt(3)
    v_cmp_le_i32 vcc, 9, v82
    s_add_u32 s61, s61, 1
    s_cbranch_vccnz interleave_layers__linear_attn_block__memory_aug_recurrent_mem_tr__prompt_kernel_s_prw0_out
    s_sleep 2
    s_cmp_ge_u32 s61, s60
    s_cbranch_scc0 interleave_layers__linear_attn_block__memory_aug_recurrent_mem_tr__prompt_kernel_s_prw0
    s_mov_b32 s60, 1
interleave_layers__linear_attn_block__memory_aug_recurrent_mem_tr__prompt_kernel_s_prw0_out:
    s_mov_b64 exec, -1
    buffer_load_dwordx4 v[84:87], v7, s[8:11], s47 offen sc1
    buffer_load_dwordx4 v[88:91], v7, s[8:11], s46 offen sc1
    buffer_load_dwordx2 v[92:93], v8, s[8:11], s52 offen sc1
    ds_read_b128 v[48:51], v21 offset:0
    ds_read_b128 v[52:55], v21 offset:16
    ds_read_b128 v[56:59], v21 offset:5632
    ds_read_b128 v[60:63], v21 offset:5648
    ds_read_b128 v[64:67], v21 offset:11264
    ds_read_b128 v[68:71], v21 offset:11280
    ds_read_b128 v[72:75], v21 offset:16896
    ds_read_b128 v[76:79], v21 offset:16912
    s_waitcnt lgkmcnt(4)
    v_pk_add_f32 v[48:49], v[48:49], v[56:57]
    v_pk_add_f32 v[50:51], v[50:51], v[58:59]
    v_pk_add_f32 v[52:53], v[52:53], v[60:61]
    v_pk_add_f32 v[54:55], v[54:55], v[62:63]
    s_waitcnt lgkmcnt(0)
    v_pk_add_f32 v[64:65], v[64:65], v[72:73]
    v_pk_add_f32 v[66:67], v[66:67], v[74:75]
    v_pk_add_f32 v[68:69], v[68:69], v[76:77]
    v_pk_add_f32 v[70:71], v[70:71], v[78:79]
    v_pk_add_f32 v[48:49], v[48:49], v[64:65]
    v_pk_add_f32 v[50:51], v[50:51], v[66:67]
    v_pk_add_f32 v[52:53], v[52:53], v[68:69]
    v_pk_add_f32 v[54:55], v[54:55], v[70:71]
    v_mov_b32 v81, 0xff800000
    v_cndmask_b32 v48, v81, v48, s[64:65]
    v_cndmask_b32 v49, v81, v49, s[66:67]
    v_cndmask_b32 v50, v81, v50, s[68:69]
    v_cndmask_b32 v51, v81, v51, s[70:71]
    v_cndmask_b32 v52, v81, v52, s[72:73]
    v_cndmask_b32 v53, v81, v53, s[74:75]
    v_cndmask_b32 v54, v81, v54, s[76:77]
    v_cndmask_b32 v55, v81, v55, s[78:79]
    v_max3_f32 v80, v48, v49, v50
    v_max3_f32 v80, v80, v51, v52
    v_max3_f32 v80, v80, v53, v54
    v_max_f32 v80, v80, v55
    v_mov_b32 v81, 0xff800000
    v_cndmask_b32 v80, v81, v80, s[50:51]
    s_nop 1
    v_max_f32 v80, v80, v80 quad_perm:[1,0,3,2] row_mask:0xf bank_mask:0xf
    s_nop 1
    v_max_f32 v80, v80, v80 quad_perm:[2,3,0,1] row_mask:0xf bank_mask:0xf
    s_nop 1
    v_max_f32 v80, v80, v80 row_half_mirror row_mask:0xf bank_mask:0xf
    s_mov_b32 s24, 0x3dd53b95
    v_mul_f32 v80, s24, v80
    v_fma_f32 v48, v48, s24, -v80
    v_fma_f32 v49, v49, s24, -v80
    v_fma_f32 v50, v50, s24, -v80
    v_fma_f32 v51, v51, s24, -v80
    v_fma_f32 v52, v52, s24, -v80
    v_fma_f32 v53, v53, s24, -v80
    v_fma_f32 v54, v54, s24, -v80
    v_fma_f32 v55, v55, s24, -v80
    v_exp_f32 v48, v48
    v_exp_f32 v49, v49
    v_exp_f32 v50, v50
    v_exp_f32 v51, v51
    v_exp_f32 v52, v52
    v_exp_f32 v53, v53
    v_exp_f32 v54, v54
    v_exp_f32 v55, v55
    v_add_f32 v80, v48, v49
    v_add_f32 v81, v50, v51
    v_add_f32 v80, v80, v52
    v_add_f32 v81, v81, v53
    v_add_f32 v80, v80, v54
    v_add_f32 v81, v81, v55
    v_add_f32 v80, v80, v81
    v_cndmask_b32 v80, 0, v80, s[50:51]
    s_nop 1
    v_add_f32 v80, v80, v80 quad_perm:[1,0,3,2] row_mask:0xf bank_mask:0xf
    s_nop 1
    v_add_f32 v80, v80, v80 quad_perm:[2,3,0,1] row_mask:0xf bank_mask:0xf
    s_nop 1
    v_add_f32 v80, v80, v80 row_half_mirror row_mask:0xf bank_mask:0xf
    v_rcp_f32 v80, v80
    s_nop 0
    v_mul_f32 v48, v48, v80
    v_mul_f32 v49, v49, v80
    v_mul_f32 v50, v50, v80
    v_mul_f32 v51, v51, v80
    v_mul_f32 v52, v52, v80
    v_mul_f32 v53, v53, v80
    v_mul_f32 v54, v54, v80
    v_mul_f32 v55, v55, v80
    v_cvt_pk_bf16_f32 v56, v48, v49
    v_cvt_pk_bf16_f32 v57, v50, v51
    v_cvt_pk_bf16_f32 v58, v52, v53
    v_cvt_pk_bf16_f32 v59, v54, v55
    v_min_u32 v56, -2, v56
    v_min_u32 v57, -2, v57
    v_min_u32 v58, -2, v58
    v_min_u32 v59, -2, v59
    buffer_store_dwordx4 v[56:59], v22, s[8:11], s42 offen sc1
    s_waitcnt vmcnt(1)
    s_nop 0
    v_max3_u32 v58, v84, v85, v86
    v_max3_u32 v58, v58, v87, v88
    v_max3_u32 v58, v58, v89, v90
    v_max3_u32 v58, v58, v91, v92
    v_max_u32 v58, v58, v93
    v_cmp_eq_u32 vcc, -1, v58
    s_cbranch_vccz interleave_layers__linear_attn_block__memory_aug_recurrent_mem_tr__prompt_kernel_s_pmw0_out
    s_mov_b32 s61, 0
interleave_layers__linear_attn_block__memory_aug_recurrent_mem_tr__prompt_kernel_s_pmw0:
    buffer_load_dwordx4 v[84:87], v7, s[8:11], s47 offen sc1
    buffer_load_dwordx4 v[88:91], v7, s[8:11], s46 offen sc1
    buffer_load_dwordx2 v[92:93], v8, s[8:11], s52 offen sc1
    s_waitcnt vmcnt(0)
    v_max3_u32 v58, v84, v85, v86
    v_max3_u32 v58, v58, v87, v88
    v_max3_u32 v58, v58, v89, v90
    v_max3_u32 v58, v58, v91, v92
    v_max_u32 v58, v58, v93
    v_cmp_eq_u32 vcc, -1, v58
    s_add_u32 s61, s61, 1
    s_cbranch_vccz interleave_layers__linear_attn_block__memory_aug_recurrent_mem_tr__prompt_kernel_s_pmw0_out
    s_cmp_ge_u32 s61, s60
    s_cbranch_scc1 interleave_layers__linear_attn_block__memory_aug_recurrent_mem_tr__prompt_kernel_s_pmw0_to
    s_sleep 1
    s_branch interleave_layers__linear_attn_block__memory_aug_recurrent_mem_tr__prompt_kernel_s_pmw0
interleave_layers__linear_attn_block__memory_aug_recurrent_mem_tr__prompt_kernel_s_pmw0_to:
    s_mov_b32 s60, 1
interleave_layers__linear_attn_block__memory_aug_recurrent_mem_tr__prompt_kernel_s_pmw0_out:
    ds_write_b128 v7, v[84:87]
    ds_write_b128 v7, v[88:91] offset:4096
    ds_write_b64 v8, v[92:93]
interleave_layers__linear_attn_block__memory_aug_recurrent_mem_tr__prompt_kernel_s_gow0:
    ds_read_b128 v[68:71], v6 offset:0
    ds_read_b128 v[72:75], v6 offset:1024
    ds_read_b128 v[76:79], v6 offset:8192
    ds_read_b128 v[80:83], v6 offset:9216
    v_smfmac_f32_16x16x64_bf16 v[24:27], v[84:87], a[0:7], v4
    v_smfmac_f32_16x16x64_bf16 v[28:31], v[84:87], a[80:87], v4
    v_smfmac_f32_16x16x64_bf16 v[32:35], v[84:87], a[160:167], v4
    v_smfmac_f32_16x16x64_bf16 v[40:43], v[84:87], v[96:103], v4
    v_smfmac_f32_16x16x64_bf16 v[44:47], v[84:87], v[176:183], v4
    s_waitcnt lgkmcnt(2)
    v_smfmac_f32_16x16x64_bf16 v[36:39], v[84:87], v[68:75], v4
    ds_read_b128 v[68:71], v6 offset:2048
    ds_read_b128 v[72:75], v6 offset:3072
    s_barrier
    ds_read_b128 v[48:51], v5 offset:1024
    ds_read_b128 v[52:55], v5 offset:2048
    ds_read_b128 v[56:59], v5 offset:3072
    ds_read_b128 v[60:63], v5 offset:5120
    ds_read_b128 v[64:67], v5 offset:6144
    v_smfmac_f32_16x16x64_bf16 v[24:27], v[88:91], a[32:39], v4
    v_smfmac_f32_16x16x64_bf16 v[28:31], v[88:91], a[112:119], v4
    v_smfmac_f32_16x16x64_bf16 v[32:35], v[88:91], a[192:199], v4
    v_smfmac_f32_16x16x64_bf16 v[40:43], v[88:91], v[128:135], v4
    v_smfmac_f32_16x16x64_bf16 v[44:47], v[88:91], v[208:215], v4
    s_waitcnt lgkmcnt(7)
    v_smfmac_f32_16x16x64_bf16 v[36:39], v[88:91], v[76:83], v4
    ds_read_b128 v[76:79], v6 offset:4096
    ds_read_b128 v[80:83], v6 offset:5120
    s_waitcnt lgkmcnt(6)
    v_smfmac_f32_16x16x64_bf16 v[24:27], v[48:51], a[8:15], v4
    v_smfmac_f32_16x16x64_bf16 v[28:31], v[48:51], a[88:95], v4
    v_smfmac_f32_16x16x64_bf16 v[40:43], v[48:51], v[104:111], v4
    v_smfmac_f32_16x16x64_bf16 v[36:39], v[48:51], v[68:75], v4
    ds_read_b128 v[68:71], v6 offset:6144
    ds_read_b128 v[72:75], v6 offset:7168
    ds_read_b128 v[48:51], v5 offset:7168
    s_waitcnt lgkmcnt(8)
    v_smfmac_f32_16x16x64_bf16 v[24:27], v[52:55], a[16:23], v4
    v_smfmac_f32_16x16x64_bf16 v[28:31], v[52:55], a[96:103], v4
    v_smfmac_f32_16x16x64_bf16 v[40:43], v[52:55], v[112:119], v4
    s_waitcnt lgkmcnt(3)
    v_smfmac_f32_16x16x64_bf16 v[36:39], v[52:55], v[76:83], v4
    ds_read_b128 v[76:79], v6 offset:10240
    ds_read_b128 v[80:83], v6 offset:11264
    ds_read_b128 v[52:55], v5 offset:8192
    v_smfmac_f32_16x16x64_bf16 v[24:27], v[56:59], a[24:31], v4
    v_smfmac_f32_16x16x64_bf16 v[28:31], v[56:59], a[104:111], v4
    v_smfmac_f32_16x16x64_bf16 v[40:43], v[56:59], v[120:127], v4
    s_waitcnt lgkmcnt(4)
    v_smfmac_f32_16x16x64_bf16 v[36:39], v[56:59], v[68:75], v4
    ds_read_b128 v[68:71], v6 offset:12288
    ds_read_b128 v[72:75], v6 offset:13312
    ds_read_b128 v[56:59], v5 offset:9216
    v_smfmac_f32_16x16x64_bf16 v[24:27], v[60:63], a[40:47], v4
    v_smfmac_f32_16x16x64_bf16 v[28:31], v[60:63], a[120:127], v4
    v_smfmac_f32_16x16x64_bf16 v[40:43], v[60:63], v[136:143], v4
    s_waitcnt lgkmcnt(4)
    v_smfmac_f32_16x16x64_bf16 v[36:39], v[60:63], v[76:83], v4
    ds_read_b128 v[76:79], v6 offset:14336
    ds_read_b128 v[80:83], v6 offset:15360
    ds_read_b128 v[60:63], v5 offset:1024
    v_smfmac_f32_16x16x64_bf16 v[24:27], v[64:67], a[48:55], v4
    v_smfmac_f32_16x16x64_bf16 v[28:31], v[64:67], a[128:135], v4
    v_smfmac_f32_16x16x64_bf16 v[40:43], v[64:67], v[144:151], v4
    s_waitcnt lgkmcnt(4)
    v_smfmac_f32_16x16x64_bf16 v[36:39], v[64:67], v[68:75], v4
    ds_read_b128 v[68:71], v6 offset:16384
    ds_read_b128 v[72:75], v6 offset:17408
    ds_read_b128 v[64:67], v5 offset:2048
    v_smfmac_f32_16x16x64_bf16 v[24:27], v[48:51], a[56:63], v4
    v_smfmac_f32_16x16x64_bf16 v[28:31], v[48:51], a[136:143], v4
    v_smfmac_f32_16x16x64_bf16 v[40:43], v[48:51], v[152:159], v4
    s_waitcnt lgkmcnt(4)
    v_smfmac_f32_16x16x64_bf16 v[36:39], v[48:51], v[76:83], v4
    ds_read_b128 v[76:79], v6 offset:18432
    ds_read_b128 v[80:83], v6 offset:19456
    ds_read_b128 v[48:51], v5 offset:3072
    v_smfmac_f32_16x16x64_bf16 v[24:27], v[52:55], a[64:71], v4
    v_smfmac_f32_16x16x64_bf16 v[28:31], v[52:55], a[144:151], v4
    v_smfmac_f32_16x16x64_bf16 v[40:43], v[52:55], v[160:167], v4
    s_waitcnt lgkmcnt(4)
    v_smfmac_f32_16x16x64_bf16 v[36:39], v[52:55], v[68:75], v4
    ds_read_b128 v[52:55], v5 offset:5120
    v_smfmac_f32_16x16x64_bf16 v[24:27], v[56:59], a[72:79], v4
    v_smfmac_f32_16x16x64_bf16 v[28:31], v[56:59], a[152:159], v4
    v_smfmac_f32_16x16x64_bf16 v[40:43], v[56:59], v[168:175], v4
    s_waitcnt lgkmcnt(2)
    v_smfmac_f32_16x16x64_bf16 v[36:39], v[56:59], v[76:83], v4
    ds_read_b128 v[56:59], v5 offset:6144
    buffer_load_dwordx4 v[80:83], v19, s[8:11], s45 offen offset:0 sc1
    buffer_load_dwordx4 v[84:87], v19, s[8:11], s45 offen offset:1024 sc1
    buffer_load_dwordx4 v[88:91], v19, s[8:11], s45 offen offset:2048 sc1
    v_smfmac_f32_16x16x64_bf16 v[32:35], v[60:63], a[168:175], v4
    v_smfmac_f32_16x16x64_bf16 v[44:47], v[60:63], v[184:191], v4
    v_permlane32_swap_b32 v28, v40
    v_permlane32_swap_b32 v29, v41
    ds_read_b128 v[60:63], v5 offset:7168
    v_smfmac_f32_16x16x64_bf16 v[32:35], v[64:67], a[176:183], v4
    v_permlane32_swap_b32 v30, v42
    v_permlane32_swap_b32 v31, v43
    v_smfmac_f32_16x16x64_bf16 v[44:47], v[64:67], v[192:199], v4
    v_add_f32 v28, v28, v40
    v_add_f32 v29, v29, v41
    ds_read_b128 v[64:67], v5 offset:8192
    s_waitcnt lgkmcnt(4)
    v_smfmac_f32_16x16x64_bf16 v[32:35], v[48:51], a[184:191], v4
    v_add_f32 v30, v30, v42
    v_add_f32 v31, v31, v43
    v_smfmac_f32_16x16x64_bf16 v[44:47], v[48:51], v[200:207], v4
    v_cvt_pk_bf16_f32 v40, v28, v29
    v_cvt_pk_bf16_f32 v41, v30, v31
    ds_read_b128 v[48:51], v5 offset:9216
    s_waitcnt lgkmcnt(4)
    v_smfmac_f32_16x16x64_bf16 v[32:35], v[52:55], a[200:207], v4
    v_mfma_f32_16x16x16_bf16 v[28:31], v[40:41], v[10:11], 0
    v_permlane32_swap_b32 v24, v36
    v_smfmac_f32_16x16x64_bf16 v[44:47], v[52:55], v[216:223], v4
    v_permlane32_swap_b32 v25, v37
    v_permlane32_swap_b32 v26, v38
    s_waitcnt lgkmcnt(3)
    v_smfmac_f32_16x16x64_bf16 v[32:35], v[56:59], a[208:215], v4
    v_permlane32_swap_b32 v27, v39
    v_add_f32 v24, v24, v36
    v_smfmac_f32_16x16x64_bf16 v[44:47], v[56:59], v[224:231], v4
    v_add_f32 v25, v25, v37
    v_add_f32 v26, v26, v38
    s_waitcnt lgkmcnt(2)
    v_smfmac_f32_16x16x64_bf16 v[32:35], v[60:63], a[216:223], v4
    v_add_f32 v27, v27, v39
    v_cvt_pk_bf16_f32 v36, v24, v25
    v_smfmac_f32_16x16x64_bf16 v[44:47], v[60:63], v[232:239], v4
    v_cvt_pk_bf16_f32 v37, v26, v27
    s_nop 1
    v_mfma_f32_16x16x16_bf16 v[24:27], v[36:37], v[10:11], 0
    s_waitcnt lgkmcnt(1)
    v_smfmac_f32_16x16x64_bf16 v[32:35], v[64:67], a[224:231], v4
    s_nop 5
    v_cvt_pk_bf16_f32 v24, v24, v25
    v_smfmac_f32_16x16x64_bf16 v[44:47], v[64:67], v[240:247], v4
    v_cvt_pk_bf16_f32 v25, v26, v27
    v_cvt_pk_bf16_f32 v26, v28, v29
    s_waitcnt lgkmcnt(0)
    v_smfmac_f32_16x16x64_bf16 v[32:35], v[48:51], a[232:239], v4
    v_cvt_pk_bf16_f32 v27, v30, v31
    s_waitcnt vmcnt(3)
    v_smfmac_f32_16x16x64_bf16 v[44:47], v[48:51], v[248:255], v4
    v_mfma_f32_16x16x32_bf16 v[28:31], a[240:243], v[24:27], 0
    v_mfma_f32_16x16x32_bf16 v[36:39], a[244:247], v[24:27], 0
    v_mfma_f32_16x16x32_bf16 v[40:43], v[24:27], v[24:27], 0
    s_nop 4
    v_permlane32_swap_b32 v32, v44
    v_permlane32_swap_b32 v33, v45
    v_permlane32_swap_b32 v34, v46
    v_permlane32_swap_b32 v35, v47
    v_add_f32 v32, v32, v44
    v_add_f32 v33, v33, v45
    v_add_f32 v34, v34, v46
    v_add_f32 v35, v35, v47
    v_cvt_pk_bf16_f32 v44, v32, v33
    v_cvt_pk_bf16_f32 v45, v34, v35
    s_nop 1
    v_mfma_f32_16x16x16_bf16 v[32:35], v[44:45], v[10:11], 0
    s_nop 7
    v_cvt_pk_bf16_f32 v32, v32, v33
    v_cvt_pk_bf16_f32 v33, v34, v35
    s_nop 1
    v_mfma_f32_16x16x16_bf16 v[28:31], a[248:249], v[32:33], v[28:31]
    v_mfma_f32_16x16x16_bf16 v[36:39], a[250:251], v[32:33], v[36:39]
    v_mfma_f32_16x16x16_bf16 v[40:43], v[32:33], v[32:33], v[40:43]
    s_nop 5
    ds_write_b128 v12, v[28:31]
    ds_write_b128 v12, v[36:39] offset:16
    ds_write_b128 v13, v[40:43]
    buffer_atomic_add v0, v20, s[8:11], s49 offen
    s_waitcnt lgkmcnt(0)
    s_barrier
    ds_read_b128 v[48:51], v14 offset:0
    ds_read_b128 v[52:55], v14 offset:16
    ds_read_b128 v[56:59], v14 offset:1408
    ds_read_b128 v[60:63], v14 offset:1424
    ds_read_b128 v[64:67], v14 offset:2816
    ds_read_b128 v[68:71], v14 offset:2832
    ds_read_b128 v[72:75], v14 offset:4224
    ds_read_b128 v[76:79], v14 offset:4240
    s_waitcnt lgkmcnt(4)
    v_pk_add_f32 v[48:49], v[48:49], v[56:57]
    v_pk_add_f32 v[50:51], v[50:51], v[58:59]
    v_pk_add_f32 v[52:53], v[52:53], v[60:61]
    v_pk_add_f32 v[54:55], v[54:55], v[62:63]
    s_waitcnt lgkmcnt(0)
    v_pk_add_f32 v[64:65], v[64:65], v[72:73]
    v_pk_add_f32 v[66:67], v[66:67], v[74:75]
    v_pk_add_f32 v[68:69], v[68:69], v[76:77]
    v_pk_add_f32 v[70:71], v[70:71], v[78:79]
    v_pk_add_f32 v[48:49], v[48:49], v[64:65]
    v_pk_add_f32 v[50:51], v[50:51], v[66:67]
    v_pk_add_f32 v[52:53], v[52:53], v[68:69]
    v_pk_add_f32 v[54:55], v[54:55], v[70:71]
    v_max3_f32 v92, v48, v49, v50
    v_max3_f32 v92, v92, v51, v52
    v_max3_f32 v92, v92, v53, v54
    v_max_f32 v92, v92, v55
    v_mov_b32 v93, 0xff800000
    v_cndmask_b32 v92, v93, v92, s[50:51]
    s_nop 1
    v_max_f32 v92, v92, v92 quad_perm:[1,0,3,2] row_mask:0xf bank_mask:0xf
    s_nop 1
    v_max_f32 v92, v92, v92 quad_perm:[2,3,0,1] row_mask:0xf bank_mask:0xf
    s_nop 1
    v_max_f32 v92, v92, v92 row_half_mirror row_mask:0xf bank_mask:0xf
    s_mov_b32 s24, 0x3dd53b95
    v_mul_f32 v92, s24, v92
    v_fma_f32 v48, v48, s24, -v92
    v_fma_f32 v49, v49, s24, -v92
    v_fma_f32 v50, v50, s24, -v92
    v_fma_f32 v51, v51, s24, -v92
    v_fma_f32 v52, v52, s24, -v92
    v_fma_f32 v53, v53, s24, -v92
    v_fma_f32 v54, v54, s24, -v92
    v_fma_f32 v55, v55, s24, -v92
    v_exp_f32 v48, v48
    v_exp_f32 v49, v49
    v_exp_f32 v50, v50
    v_exp_f32 v51, v51
    v_exp_f32 v52, v52
    v_exp_f32 v53, v53
    v_exp_f32 v54, v54
    v_exp_f32 v55, v55
    v_add_f32 v92, v48, v49
    v_add_f32 v93, v50, v51
    v_add_f32 v92, v92, v52
    v_add_f32 v93, v93, v53
    v_add_f32 v92, v92, v54
    v_add_f32 v93, v93, v55
    v_add_f32 v92, v92, v93
    v_cndmask_b32 v92, 0, v92, s[50:51]
    s_nop 1
    v_add_f32 v92, v92, v92 quad_perm:[1,0,3,2] row_mask:0xf bank_mask:0xf
    s_nop 1
    v_add_f32 v92, v92, v92 quad_perm:[2,3,0,1] row_mask:0xf bank_mask:0xf
    s_nop 1
    v_add_f32 v92, v92, v92 row_half_mirror row_mask:0xf bank_mask:0xf
    v_rcp_f32 v92, v92
    s_nop 0
    v_mul_f32 v48, v48, v92
    v_mul_f32 v49, v49, v92
    v_mul_f32 v50, v50, v92
    v_mul_f32 v51, v51, v92
    v_mul_f32 v52, v52, v92
    v_mul_f32 v53, v53, v92
    v_mul_f32 v54, v54, v92
    v_mul_f32 v55, v55, v92
    v_cvt_pk_bf16_f32 v56, v48, v49
    v_cvt_pk_bf16_f32 v57, v50, v51
    v_cvt_pk_bf16_f32 v58, v52, v53
    v_cvt_pk_bf16_f32 v59, v54, v55
    v_min_u32 v56, -2, v56
    v_min_u32 v57, -2, v57
    v_min_u32 v58, -2, v58
    v_min_u32 v59, -2, v59
    buffer_store_dwordx4 v[56:59], v15, s[8:11], s43 offen sc1
    s_waitcnt vmcnt(2)
    v_mfma_f32_16x16x32_bf16 v[36:39], a[240:243], v[80:83], 0
    v_mfma_f32_16x16x32_bf16 v[44:47], a[244:247], v[80:83], 0
    v_mfma_f32_16x16x32_bf16 v[68:71], v[24:27], v[80:83], 0
    v_mfma_f32_16x16x32_bf16 v[40:43], a[240:243], v[84:87], 0
    v_mfma_f32_16x16x32_bf16 v[64:67], a[244:247], v[84:87], 0
    v_mfma_f32_16x16x32_bf16 v[72:75], v[24:27], v[84:87], 0
    s_nop 0
    v_mfma_f32_16x16x16_bf16 v[36:39], a[248:249], v[88:89], v[36:39]
    v_mfma_f32_16x16x16_bf16 v[44:47], a[250:251], v[88:89], v[44:47]
    v_mfma_f32_16x16x16_bf16 v[68:71], v[32:33], v[88:89], v[68:71]
    v_mfma_f32_16x16x16_bf16 v[40:43], a[248:249], v[90:91], v[40:43]
    v_mfma_f32_16x16x16_bf16 v[64:67], a[250:251], v[90:91], v[64:67]
    v_mfma_f32_16x16x16_bf16 v[72:75], v[32:33], v[90:91], v[72:75]
    s_nop 2
    ds_write_b128 v16, v[36:39] offset:0
    ds_write_b128 v16, v[44:47] offset:16
    ds_write_b128 v17, v[68:71]
    ds_write_b128 v16, v[40:43] offset:2816
    ds_write_b128 v16, v[64:67] offset:2832
    ds_write_b128 v18, v[72:75]
    s_add_u32 s40, s40, 1
    s_add_u32 s41, s41, 393216
    s_add_u32 s45, s45, 393216
    s_add_u32 s47, s37, 704512
    s_add_u32 s48, s37, 737280
    s_xor_b32 s42, s37, 0x2000
    s_lshl_b32 s24, s40, 12
    s_and_b32 s24, s24, 0x2000
    s_xor_b32 s24, s24, s36
    s_lshl_b32 s37, s40, 20
    s_add_u32 s37, s37, s24
    s_add_u32 s37, s37, 117440512
    s_add_u32 s43, s37, 655360
    s_add_u32 s49, s37, 753664
    s_waitcnt lgkmcnt(0)
    s_barrier
    s_cmp_lt_u32 s40, 64
    s_cbranch_scc1 interleave_layers__linear_attn_block__memory_aug_recurrent_mem_tr__prompt_kernel_s_stepw0
    s_branch interleave_layers__linear_attn_block__memory_aug_recurrent_mem_tr__prompt_kernel_s_end
interleave_layers__linear_attn_block__memory_aug_recurrent_mem_tr__prompt_kernel_s_stepw1:
    v_mov_b32 v24, 0
    v_mov_b32 v25, 0
    v_mov_b32 v26, 0
    v_mov_b32 v27, 0
    v_mov_b32 v28, 0
    v_mov_b32 v29, 0
    v_mov_b32 v30, 0
    v_mov_b32 v31, 0
    v_mov_b32 v32, 0
    v_mov_b32 v33, 0
    v_mov_b32 v34, 0
    v_mov_b32 v35, 0
    v_mov_b32 v36, 0
    v_mov_b32 v37, 0
    v_mov_b32 v38, 0
    v_mov_b32 v39, 0
    v_mov_b32 v40, 0
    v_mov_b32 v41, 0
    v_mov_b32 v42, 0
    v_mov_b32 v43, 0
    v_mov_b32 v44, 0
    v_mov_b32 v45, 0
    v_mov_b32 v46, 0
    v_mov_b32 v47, 0
    s_add_u32 s46, s47, 4096
    s_add_u32 s52, s47, 8192
    s_lshl_b32 s95, s92, 6
    s_add_u32 s95, s95, s40
    s_add_u32 s95, s95, 1
    s_cmp_ge_i32 s59, s95
    s_cbranch_scc1 interleave_layers__linear_attn_block__memory_aug_recurrent_mem_tr__prompt_kernel_s_ecw1_ok
    s_and_b32 s24, s2, 7
    s_lshl_b32 s24, s24, 7
    s_add_u32 s24, s24, 23109632
    v_and_b32 v49, 3, v1
    v_lshl_add_u32 v49, v49, 2, s24
    s_mov_b32 s61, 0
interleave_layers__linear_attn_block__memory_aug_recurrent_mem_tr__prompt_kernel_s_ecw1:
    buffer_load_dword v48, v49, s[8:11], 0 offen sc1
    s_waitcnt vmcnt(0)
    v_readlane_b32 s59, v48, 0
    v_readlane_b32 s24, v48, 1
    s_min_i32 s59, s59, s24
    v_readlane_b32 s24, v48, 2
    s_min_i32 s59, s59, s24
    s_cmp_ge_i32 s59, s95
    s_cbranch_scc1 interleave_layers__linear_attn_block__memory_aug_recurrent_mem_tr__prompt_kernel_s_ecw1_ok
    s_add_u32 s61, s61, 1
    s_cmp_ge_u32 s61, s60
    s_cbranch_scc1 interleave_layers__linear_attn_block__memory_aug_recurrent_mem_tr__prompt_kernel_s_ecw1_to
    s_sleep 2
    s_branch interleave_layers__linear_attn_block__memory_aug_recurrent_mem_tr__prompt_kernel_s_ecw1
interleave_layers__linear_attn_block__memory_aug_recurrent_mem_tr__prompt_kernel_s_ecw1_to:
    s_mov_b32 s60, 1
interleave_layers__linear_attn_block__memory_aug_recurrent_mem_tr__prompt_kernel_s_ecw1_ok:
    s_add_u32 s63, s40, 1
    s_cmp_ge_i32 s62, s63
    s_cbranch_scc1 interleave_layers__linear_attn_block__memory_aug_recurrent_mem_tr__prompt_kernel_s_enw1_ok
    s_mov_b32 s61, 0
interleave_layers__linear_attn_block__memory_aug_recurrent_mem_tr__prompt_kernel_s_enw1:
    buffer_load_dword v48, v9, s[8:11], 0 offen sc1
    s_waitcnt vmcnt(0)
    v_readlane_b32 s62, v48, 0
    v_readlane_b32 s24, v48, 1
    s_min_i32 s62, s62, s24
    s_cmp_ge_i32 s62, s63
    s_cbranch_scc1 interleave_layers__linear_attn_block__memory_aug_recurrent_mem_tr__prompt_kernel_s_enw1_ok
    s_add_u32 s61, s61, 1
    s_cmp_ge_u32 s61, s60
    s_cbranch_scc1 interleave_layers__linear_attn_block__memory_aug_recurrent_mem_tr__prompt_kernel_s_enw1_to
    s_sleep 2
    s_branch interleave_layers__linear_attn_block__memory_aug_recurrent_mem_tr__prompt_kernel_s_enw1
interleave_layers__linear_attn_block__memory_aug_recurrent_mem_tr__prompt_kernel_s_enw1_to:
    s_mov_b32 s60, 1
interleave_layers__linear_attn_block__memory_aug_recurrent_mem_tr__prompt_kernel_s_enw1_ok:
    buffer_load_dwordx4 a[240:243], v19, s[8:11], s41 offen offset:0 sc1
    buffer_load_dwordx4 a[244:247], v19, s[8:11], s41 offen offset:1024 sc1
    buffer_load_dwordx4 a[248:251], v19, s[8:11], s41 offen offset:2048 sc1
    s_sleep 5
    s_mov_b64 exec, 1
    s_mov_b32 s61, 0
    v_mov_b32 v83, 0
    buffer_atomic_add v83, v23, s[8:11], s48 offen sc0
    s_sleep 2
    v_mov_b32 v94, 0
    buffer_atomic_add v94, v23, s[8:11], s48 offen sc0
    s_sleep 2
    v_mov_b32 v95, 0
    buffer_atomic_add v95, v23, s[8:11], s48 offen sc0
    s_sleep 2
interleave_layers__linear_attn_block__memory_aug_recurrent_mem_tr__prompt_kernel_s_prw1:
    v_mov_b32 v82, 0
    buffer_atomic_add v82, v23, s[8:11], s48 offen sc0
    s_waitcnt vmcnt(3)
    v_cmp_le_i32 vcc, 9, v83
    s_add_u32 s61, s61, 1
    s_cbranch_vccnz interleave_layers__linear_attn_block__memory_aug_recurrent_mem_tr__prompt_kernel_s_prw1_out
    s_sleep 2
    v_mov_b32 v83, 0
    buffer_atomic_add v83, v23, s[8:11], s48 offen sc0
    s_waitcnt vmcnt(3)
    v_cmp_le_i32 vcc, 9, v94
    s_add_u32 s61, s61, 1
    s_cbranch_vccnz interleave_layers__linear_attn_block__memory_aug_recurrent_mem_tr__prompt_kernel_s_prw1_out
    s_sleep 2
    v_mov_b32 v94, 0
    buffer_atomic_add v94, v23, s[8:11], s48 offen sc0
    s_waitcnt vmcnt(3)
    v_cmp_le_i32 vcc, 9, v95
    s_add_u32 s61, s61, 1
    s_cbranch_vccnz interleave_layers__linear_attn_block__memory_aug_recurrent_mem_tr__prompt_kernel_s_prw1_out
    s_sleep 2
    v_mov_b32 v95, 0
    buffer_atomic_add v95, v23, s[8:11], s48 offen sc0
    s_waitcnt vmcnt(3)
    v_cmp_le_i32 vcc, 9, v82
    s_add_u32 s61, s61, 1
    s_cbranch_vccnz interleave_layers__linear_attn_block__memory_aug_recurrent_mem_tr__prompt_kernel_s_prw1_out
    s_sleep 2
    s_cmp_ge_u32 s61, s60
    s_cbranch_scc0 interleave_layers__linear_attn_block__memory_aug_recurrent_mem_tr__prompt_kernel_s_prw1
    s_mov_b32 s60, 1
interleave_layers__linear_attn_block__memory_aug_recurrent_mem_tr__prompt_kernel_s_prw1_out:
    s_mov_b64 exec, -1
    buffer_load_dwordx4 v[84:87], v7, s[8:11], s47 offen sc1
    buffer_load_dwordx4 v[88:91], v7, s[8:11], s46 offen sc1
    buffer_load_dwordx2 v[92:93], v8, s[8:11], s52 offen sc1
    ds_read_b128 v[48:51], v21 offset:0
    ds_read_b128 v[52:55], v21 offset:16
    ds_read_b128 v[56:59], v21 offset:5632
    ds_read_b128 v[60:63], v21 offset:5648
    ds_read_b128 v[64:67], v21 offset:11264
    ds_read_b128 v[68:71], v21 offset:11280
    ds_read_b128 v[72:75], v21 offset:16896
    ds_read_b128 v[76:79], v21 offset:16912
    s_waitcnt lgkmcnt(4)
    v_pk_add_f32 v[48:49], v[48:49], v[56:57]
    v_pk_add_f32 v[50:51], v[50:51], v[58:59]
    v_pk_add_f32 v[52:53], v[52:53], v[60:61]
    v_pk_add_f32 v[54:55], v[54:55], v[62:63]
    s_waitcnt lgkmcnt(0)
    v_pk_add_f32 v[64:65], v[64:65], v[72:73]
    v_pk_add_f32 v[66:67], v[66:67], v[74:75]
    v_pk_add_f32 v[68:69], v[68:69], v[76:77]
    v_pk_add_f32 v[70:71], v[70:71], v[78:79]
    v_pk_add_f32 v[48:49], v[48:49], v[64:65]
    v_pk_add_f32 v[50:51], v[50:51], v[66:67]
    v_pk_add_f32 v[52:53], v[52:53], v[68:69]
    v_pk_add_f32 v[54:55], v[54:55], v[70:71]
    v_mov_b32 v81, 0xff800000
    v_cndmask_b32 v48, v81, v48, s[64:65]
    v_cndmask_b32 v49, v81, v49, s[66:67]
    v_cndmask_b32 v50, v81, v50, s[68:69]
    v_cndmask_b32 v51, v81, v51, s[70:71]
    v_cndmask_b32 v52, v81, v52, s[72:73]
    v_cndmask_b32 v53, v81, v53, s[74:75]
    v_cndmask_b32 v54, v81, v54, s[76:77]
    v_cndmask_b32 v55, v81, v55, s[78:79]
    v_max3_f32 v80, v48, v49, v50
    v_max3_f32 v80, v80, v51, v52
    v_max3_f32 v80, v80, v53, v54
    v_max_f32 v80, v80, v55
    v_mov_b32 v81, 0xff800000
    v_cndmask_b32 v80, v81, v80, s[50:51]
    s_nop 1
    v_max_f32 v80, v80, v80 quad_perm:[1,0,3,2] row_mask:0xf bank_mask:0xf
    s_nop 1
    v_max_f32 v80, v80, v80 quad_perm:[2,3,0,1] row_mask:0xf bank_mask:0xf
    s_nop 1
    v_max_f32 v80, v80, v80 row_half_mirror row_mask:0xf bank_mask:0xf
    s_mov_b32 s24, 0x3dd53b95
    v_mul_f32 v80, s24, v80
    v_fma_f32 v48, v48, s24, -v80
    v_fma_f32 v49, v49, s24, -v80
    v_fma_f32 v50, v50, s24, -v80
    v_fma_f32 v51, v51, s24, -v80
    v_fma_f32 v52, v52, s24, -v80
    v_fma_f32 v53, v53, s24, -v80
    v_fma_f32 v54, v54, s24, -v80
    v_fma_f32 v55, v55, s24, -v80
    v_exp_f32 v48, v48
    v_exp_f32 v49, v49
    v_exp_f32 v50, v50
    v_exp_f32 v51, v51
    v_exp_f32 v52, v52
    v_exp_f32 v53, v53
    v_exp_f32 v54, v54
    v_exp_f32 v55, v55
    v_add_f32 v80, v48, v49
    v_add_f32 v81, v50, v51
    v_add_f32 v80, v80, v52
    v_add_f32 v81, v81, v53
    v_add_f32 v80, v80, v54
    v_add_f32 v81, v81, v55
    v_add_f32 v80, v80, v81
    v_cndmask_b32 v80, 0, v80, s[50:51]
    s_nop 1
    v_add_f32 v80, v80, v80 quad_perm:[1,0,3,2] row_mask:0xf bank_mask:0xf
    s_nop 1
    v_add_f32 v80, v80, v80 quad_perm:[2,3,0,1] row_mask:0xf bank_mask:0xf
    s_nop 1
    v_add_f32 v80, v80, v80 row_half_mirror row_mask:0xf bank_mask:0xf
    v_rcp_f32 v80, v80
    s_nop 0
    v_mul_f32 v48, v48, v80
    v_mul_f32 v49, v49, v80
    v_mul_f32 v50, v50, v80
    v_mul_f32 v51, v51, v80
    v_mul_f32 v52, v52, v80
    v_mul_f32 v53, v53, v80
    v_mul_f32 v54, v54, v80
    v_mul_f32 v55, v55, v80
    v_cvt_pk_bf16_f32 v56, v48, v49
    v_cvt_pk_bf16_f32 v57, v50, v51
    v_cvt_pk_bf16_f32 v58, v52, v53
    v_cvt_pk_bf16_f32 v59, v54, v55
    v_min_u32 v56, -2, v56
    v_min_u32 v57, -2, v57
    v_min_u32 v58, -2, v58
    v_min_u32 v59, -2, v59
    buffer_store_dwordx4 v[56:59], v22, s[8:11], s42 offen sc1
    s_waitcnt vmcnt(1)
    s_nop 0
    v_max3_u32 v58, v84, v85, v86
    v_max3_u32 v58, v58, v87, v88
    v_max3_u32 v58, v58, v89, v90
    v_max3_u32 v58, v58, v91, v92
    v_max_u32 v58, v58, v93
    v_cmp_eq_u32 vcc, -1, v58
    s_cbranch_vccz interleave_layers__linear_attn_block__memory_aug_recurrent_mem_tr__prompt_kernel_s_pmw1_out
    s_mov_b32 s61, 0
interleave_layers__linear_attn_block__memory_aug_recurrent_mem_tr__prompt_kernel_s_pmw1:
    buffer_load_dwordx4 v[84:87], v7, s[8:11], s47 offen sc1
    buffer_load_dwordx4 v[88:91], v7, s[8:11], s46 offen sc1
    buffer_load_dwordx2 v[92:93], v8, s[8:11], s52 offen sc1
    s_waitcnt vmcnt(0)
    v_max3_u32 v58, v84, v85, v86
    v_max3_u32 v58, v58, v87, v88
    v_max3_u32 v58, v58, v89, v90
    v_max3_u32 v58, v58, v91, v92
    v_max_u32 v58, v58, v93
    v_cmp_eq_u32 vcc, -1, v58
    s_add_u32 s61, s61, 1
    s_cbranch_vccz interleave_layers__linear_attn_block__memory_aug_recurrent_mem_tr__prompt_kernel_s_pmw1_out
    s_cmp_ge_u32 s61, s60
    s_cbranch_scc1 interleave_layers__linear_attn_block__memory_aug_recurrent_mem_tr__prompt_kernel_s_pmw1_to
    s_sleep 1
    s_branch interleave_layers__linear_attn_block__memory_aug_recurrent_mem_tr__prompt_kernel_s_pmw1
interleave_layers__linear_attn_block__memory_aug_recurrent_mem_tr__prompt_kernel_s_pmw1_to:
    s_mov_b32 s60, 1
interleave_layers__linear_attn_block__memory_aug_recurrent_mem_tr__prompt_kernel_s_pmw1_out:
    ds_write_b128 v7, v[84:87]
    ds_write_b128 v7, v[88:91] offset:4096
    ds_write_b64 v8, v[92:93]
interleave_layers__linear_attn_block__memory_aug_recurrent_mem_tr__prompt_kernel_s_gow1:
    ds_read_b128 v[68:71], v6 offset:2048
    ds_read_b128 v[72:75], v6 offset:3072
    ds_read_b128 v[76:79], v6 offset:10240
    ds_read_b128 v[80:83], v6 offset:11264
    v_smfmac_f32_16x16x64_bf16 v[24:27], v[84:87], a[8:15], v4
    v_smfmac_f32_16x16x64_bf16 v[28:31], v[84:87], a[88:95], v4
    v_smfmac_f32_16x16x64_bf16 v[32:35], v[84:87], a[168:175], v4
    v_smfmac_f32_16x16x64_bf16 v[40:43], v[84:87], v[104:111], v4
    v_smfmac_f32_16x16x64_bf16 v[44:47], v[84:87], v[184:191], v4
    s_waitcnt lgkmcnt(2)
    v_smfmac_f32_16x16x64_bf16 v[36:39], v[84:87], v[68:75], v4
    ds_read_b128 v[68:71], v6 offset:0
    ds_read_b128 v[72:75], v6 offset:1024
    s_barrier
    ds_read_b128 v[48:51], v5 offset:0
    ds_read_b128 v[52:55], v5 offset:2048
    ds_read_b128 v[56:59], v5 offset:3072
    ds_read_b128 v[60:63], v5 offset:4096
    ds_read_b128 v[64:67], v5 offset:6144
    v_smfmac_f32_16x16x64_bf16 v[24:27], v[88:91], a[40:47], v4
    v_smfmac_f32_16x16x64_bf16 v[28:31], v[88:91], a[120:127], v4
    v_smfmac_f32_16x16x64_bf16 v[32:35], v[88:91], a[200:207], v4
    v_smfmac_f32_16x16x64_bf16 v[40:43], v[88:91], v[136:143], v4
    v_smfmac_f32_16x16x64_bf16 v[44:47], v[88:91], v[216:223], v4
    s_waitcnt lgkmcnt(7)
    v_smfmac_f32_16x16x64_bf16 v[36:39], v[88:91], v[76:83], v4
    ds_read_b128 v[76:79], v6 offset:4096
    ds_read_b128 v[80:83], v6 offset:5120
    s_waitcnt lgkmcnt(6)
    v_smfmac_f32_16x16x64_bf16 v[24:27], v[48:51], a[0:7], v4
    v_smfmac_f32_16x16x64_bf16 v[28:31], v[48:51], a[80:87], v4
    v_smfmac_f32_16x16x64_bf16 v[40:43], v[48:51], v[96:103], v4
    v_smfmac_f32_16x16x64_bf16 v[36:39], v[48:51], v[68:75], v4
    ds_read_b128 v[68:71], v6 offset:6144
    ds_read_b128 v[72:75], v6 offset:7168
    ds_read_b128 v[48:51], v5 offset:7168
    s_waitcnt lgkmcnt(8)
    v_smfmac_f32_16x16x64_bf16 v[24:27], v[52:55], a[16:23], v4
    v_smfmac_f32_16x16x64_bf16 v[28:31], v[52:55], a[96:103], v4
    v_smfmac_f32_16x16x64_bf16 v[40:43], v[52:55], v[112:119], v4
    s_waitcnt lgkmcnt(3)
    v_smfmac_f32_16x16x64_bf16 v[36:39], v[52:55], v[76:83], v4
    ds_read_b128 v[76:79], v6 offset:8192
    ds_read_b128 v[80:83], v6 offset:9216
    ds_read_b128 v[52:55], v5 offset:8192
    v_smfmac_f32_16x16x64_bf16 v[24:27], v[56:59], a[24:31], v4
    v_smfmac_f32_16x16x64_bf16 v[28:31], v[56:59], a[104:111], v4
    v_smfmac_f32_16x16x64_bf16 v[40:43], v[56:59], v[120:127], v4
    s_waitcnt lgkmcnt(4)
    v_smfmac_f32_16x16x64_bf16 v[36:39], v[56:59], v[68:75], v4
    ds_read_b128 v[68:71], v6 offset:12288
    ds_read_b128 v[72:75], v6 offset:13312
    ds_read_b128 v[56:59], v5 offset:9216
    v_smfmac_f32_16x16x64_bf16 v[24:27], v[60:63], a[32:39], v4
    v_smfmac_f32_16x16x64_bf16 v[28:31], v[60:63], a[112:119], v4
    v_smfmac_f32_16x16x64_bf16 v[40:43], v[60:63], v[128:135], v4
    s_waitcnt lgkmcnt(4)
    v_smfmac_f32_16x16x64_bf16 v[36:39], v[60:63], v[76:83], v4
    ds_read_b128 v[76:79], v6 offset:14336
    ds_read_b128 v[80:83], v6 offset:15360
    ds_read_b128 v[60:63], v5 offset:0
    v_smfmac_f32_16x16x64_bf16 v[24:27], v[64:67], a[48:55], v4
    v_smfmac_f32_16x16x64_bf16 v[28:31], v[64:67], a[128:135], v4
    v_smfmac_f32_16x16x64_bf16 v[40:43], v[64:67], v[144:151], v4
    s_waitcnt lgkmcnt(4)
    v_smfmac_f32_16x16x64_bf16 v[36:39], v[64:67], v[68:75], v4
    ds_read_b128 v[68:71], v6 offset:16384
    ds_read_b128 v[72:75], v6 offset:17408
    ds_read_b128 v[64:67], v5 offset:2048
    v_smfmac_f32_16x16x64_bf16 v[24:27], v[48:51], a[56:63], v4
    v_smfmac_f32_16x16x64_bf16 v[28:31], v[48:51], a[136:143], v4
    v_smfmac_f32_16x16x64_bf16 v[40:43], v[48:51], v[152:159], v4
    s_waitcnt lgkmcnt(4)
    v_smfmac_f32_16x16x64_bf16 v[36:39], v[48:51], v[76:83], v4
    ds_read_b128 v[76:79], v6 offset:18432
    ds_read_b128 v[80:83], v6 offset:19456
    ds_read_b128 v[48:51], v5 offset:3072
    v_smfmac_f32_16x16x64_bf16 v[24:27], v[52:55], a[64:71], v4
    v_smfmac_f32_16x16x64_bf16 v[28:31], v[52:55], a[144:151], v4
    v_smfmac_f32_16x16x64_bf16 v[40:43], v[52:55], v[160:167], v4
    s_waitcnt lgkmcnt(4)
    v_smfmac_f32_16x16x64_bf16 v[36:39], v[52:55], v[68:75], v4
    ds_read_b128 v[52:55], v5 offset:4096
    v_smfmac_f32_16x16x64_bf16 v[24:27], v[56:59], a[72:79], v4
    v_smfmac_f32_16x16x64_bf16 v[28:31], v[56:59], a[152:159], v4
    v_smfmac_f32_16x16x64_bf16 v[40:43], v[56:59], v[168:175], v4
    s_waitcnt lgkmcnt(2)
    v_smfmac_f32_16x16x64_bf16 v[36:39], v[56:59], v[76:83], v4
    ds_read_b128 v[56:59], v5 offset:6144
    buffer_load_dwordx4 v[80:83], v19, s[8:11], s45 offen offset:0 sc1
    buffer_load_dwordx4 v[84:87], v19, s[8:11], s45 offen offset:1024 sc1
    buffer_load_dwordx4 v[88:91], v19, s[8:11], s45 offen offset:2048 sc1
    v_smfmac_f32_16x16x64_bf16 v[32:35], v[60:63], a[160:167], v4
    v_smfmac_f32_16x16x64_bf16 v[44:47], v[60:63], v[176:183], v4
    v_permlane32_swap_b32 v28, v40
    v_permlane32_swap_b32 v29, v41
    ds_read_b128 v[60:63], v5 offset:7168
    v_smfmac_f32_16x16x64_bf16 v[32:35], v[64:67], a[176:183], v4
    v_permlane32_swap_b32 v30, v42
    v_permlane32_swap_b32 v31, v43
    v_smfmac_f32_16x16x64_bf16 v[44:47], v[64:67], v[192:199], v4
    v_add_f32 v28, v28, v40
    v_add_f32 v29, v29, v41
    ds_read_b128 v[64:67], v5 offset:8192
    s_waitcnt lgkmcnt(4)
    v_smfmac_f32_16x16x64_bf16 v[32:35], v[48:51], a[184:191], v4
    v_add_f32 v30, v30, v42
    v_add_f32 v31, v31, v43
    v_smfmac_f32_16x16x64_bf16 v[44:47], v[48:51], v[200:207], v4
    v_cvt_pk_bf16_f32 v40, v28, v29
    v_cvt_pk_bf16_f32 v41, v30, v31
    ds_read_b128 v[48:51], v5 offset:9216
    s_waitcnt lgkmcnt(4)
    v_smfmac_f32_16x16x64_bf16 v[32:35], v[52:55], a[192:199], v4
    v_mfma_f32_16x16x16_bf16 v[28:31], v[40:41], v[10:11], 0
    v_permlane32_swap_b32 v24, v36
    v_smfmac_f32_16x16x64_bf16 v[44:47], v[52:55], v[208:215], v4
    v_permlane32_swap_b32 v25, v37
    v_permlane32_swap_b32 v26, v38
    s_waitcnt lgkmcnt(3)
    v_smfmac_f32_16x16x64_bf16 v[32:35], v[56:59], a[208:215], v4
    v_permlane32_swap_b32 v27, v39
    v_add_f32 v24, v24, v36
    v_smfmac_f32_16x16x64_bf16 v[44:47], v[56:59], v[224:231], v4
    v_add_f32 v25, v25, v37
    v_add_f32 v26, v26, v38
    s_waitcnt lgkmcnt(2)
    v_smfmac_f32_16x16x64_bf16 v[32:35], v[60:63], a[216:223], v4
    v_add_f32 v27, v27, v39
    v_cvt_pk_bf16_f32 v36, v24, v25
    v_smfmac_f32_16x16x64_bf16 v[44:47], v[60:63], v[232:239], v4
    v_cvt_pk_bf16_f32 v37, v26, v27
    s_nop 1
    v_mfma_f32_16x16x16_bf16 v[24:27], v[36:37], v[10:11], 0
    s_waitcnt lgkmcnt(1)
    v_smfmac_f32_16x16x64_bf16 v[32:35], v[64:67], a[224:231], v4
    s_nop 5
    v_cvt_pk_bf16_f32 v24, v24, v25
    v_smfmac_f32_16x16x64_bf16 v[44:47], v[64:67], v[240:247], v4
    v_cvt_pk_bf16_f32 v25, v26, v27
    v_cvt_pk_bf16_f32 v26, v28, v29
    s_waitcnt lgkmcnt(0)
    v_smfmac_f32_16x16x64_bf16 v[32:35], v[48:51], a[232:239], v4
    v_cvt_pk_bf16_f32 v27, v30, v31
    s_waitcnt vmcnt(3)
    v_smfmac_f32_16x16x64_bf16 v[44:47], v[48:51], v[248:255], v4
    v_mfma_f32_16x16x32_bf16 v[28:31], a[240:243], v[24:27], 0
    v_mfma_f32_16x16x32_bf16 v[36:39], a[244:247], v[24:27], 0
    v_mfma_f32_16x16x32_bf16 v[40:43], v[24:27], v[24:27], 0
    s_nop 4
    v_permlane32_swap_b32 v32, v44
    v_permlane32_swap_b32 v33, v45
    v_permlane32_swap_b32 v34, v46
    v_permlane32_swap_b32 v35, v47
    v_add_f32 v32, v32, v44
    v_add_f32 v33, v33, v45
    v_add_f32 v34, v34, v46
    v_add_f32 v35, v35, v47
    v_cvt_pk_bf16_f32 v44, v32, v33
    v_cvt_pk_bf16_f32 v45, v34, v35
    s_nop 1
    v_mfma_f32_16x16x16_bf16 v[32:35], v[44:45], v[10:11], 0
    s_nop 7
    v_cvt_pk_bf16_f32 v32, v32, v33
    v_cvt_pk_bf16_f32 v33, v34, v35
    s_nop 1
    v_mfma_f32_16x16x16_bf16 v[28:31], a[248:249], v[32:33], v[28:31]
    v_mfma_f32_16x16x16_bf16 v[36:39], a[250:251], v[32:33], v[36:39]
    v_mfma_f32_16x16x16_bf16 v[40:43], v[32:33], v[32:33], v[40:43]
    s_nop 5
    ds_write_b128 v12, v[28:31]
    ds_write_b128 v12, v[36:39] offset:16
    ds_write_b128 v13, v[40:43]
    s_waitcnt lgkmcnt(0)
    s_barrier
    s_waitcnt vmcnt(0)
    v_mfma_f32_16x16x32_bf16 v[36:39], a[240:243], v[80:83], 0
    v_mfma_f32_16x16x32_bf16 v[44:47], a[244:247], v[80:83], 0
    v_mfma_f32_16x16x32_bf16 v[68:71], v[24:27], v[80:83], 0
    v_mfma_f32_16x16x32_bf16 v[40:43], a[240:243], v[84:87], 0
    v_mfma_f32_16x16x32_bf16 v[64:67], a[244:247], v[84:87], 0
    v_mfma_f32_16x16x32_bf16 v[72:75], v[24:27], v[84:87], 0
    s_nop 0
    v_mfma_f32_16x16x16_bf16 v[36:39], a[248:249], v[88:89], v[36:39]
    v_mfma_f32_16x16x16_bf16 v[44:47], a[250:251], v[88:89], v[44:47]
    v_mfma_f32_16x16x16_bf16 v[68:71], v[32:33], v[88:89], v[68:71]
    v_mfma_f32_16x16x16_bf16 v[40:43], a[248:249], v[90:91], v[40:43]
    v_mfma_f32_16x16x16_bf16 v[64:67], a[250:251], v[90:91], v[64:67]
    v_mfma_f32_16x16x16_bf16 v[72:75], v[32:33], v[90:91], v[72:75]
    s_nop 2
    ds_write_b128 v16, v[36:39] offset:0
    ds_write_b128 v16, v[44:47] offset:16
    ds_write_b128 v17, v[68:71]
    ds_write_b128 v16, v[40:43] offset:2816
    ds_write_b128 v16, v[64:67] offset:2832
    ds_write_b128 v18, v[72:75]
    s_add_u32 s40, s40, 1
    s_add_u32 s41, s41, 393216
    s_add_u32 s45, s45, 393216
    s_add_u32 s47, s37, 704512
    s_add_u32 s48, s37, 737280
    s_xor_b32 s42, s37, 0x2000
    s_lshl_b32 s24, s40, 12
    s_and_b32 s24, s24, 0x2000
    s_xor_b32 s24, s24, s36
    s_lshl_b32 s37, s40, 20
    s_add_u32 s37, s37, s24
    s_add_u32 s37, s37, 117440512
    s_add_u32 s43, s37, 655360
    s_add_u32 s49, s37, 753664
    s_waitcnt lgkmcnt(0)
    s_barrier
    s_cmp_lt_u32 s40, 64
    s_cbranch_scc1 interleave_layers__linear_attn_block__memory_aug_recurrent_mem_tr__prompt_kernel_s_stepw1
    s_branch interleave_layers__linear_attn_block__memory_aug_recurrent_mem_tr__prompt_kernel_s_end
interleave_layers__linear_attn_block__memory_aug_recurrent_mem_tr__prompt_kernel_s_stepw2:
    v_mov_b32 v24, 0
    v_mov_b32 v25, 0
    v_mov_b32 v26, 0
    v_mov_b32 v27, 0
    v_mov_b32 v28, 0
    v_mov_b32 v29, 0
    v_mov_b32 v30, 0
    v_mov_b32 v31, 0
    v_mov_b32 v32, 0
    v_mov_b32 v33, 0
    v_mov_b32 v34, 0
    v_mov_b32 v35, 0
    v_mov_b32 v36, 0
    v_mov_b32 v37, 0
    v_mov_b32 v38, 0
    v_mov_b32 v39, 0
    v_mov_b32 v40, 0
    v_mov_b32 v41, 0
    v_mov_b32 v42, 0
    v_mov_b32 v43, 0
    v_mov_b32 v44, 0
    v_mov_b32 v45, 0
    v_mov_b32 v46, 0
    v_mov_b32 v47, 0
    s_add_u32 s46, s47, 4096
    s_add_u32 s52, s47, 8192
    s_lshl_b32 s95, s92, 6
    s_add_u32 s95, s95, s40
    s_add_u32 s95, s95, 1
    s_cmp_ge_i32 s59, s95
    s_cbranch_scc1 interleave_layers__linear_attn_block__memory_aug_recurrent_mem_tr__prompt_kernel_s_ecw2_ok
    s_and_b32 s24, s2, 7
    s_lshl_b32 s24, s24, 7
    s_add_u32 s24, s24, 23109632
    v_and_b32 v49, 3, v1
    v_lshl_add_u32 v49, v49, 2, s24
    s_mov_b32 s61, 0
interleave_layers__linear_attn_block__memory_aug_recurrent_mem_tr__prompt_kernel_s_ecw2:
    buffer_load_dword v48, v49, s[8:11], 0 offen sc1
    s_waitcnt vmcnt(0)
    v_readlane_b32 s59, v48, 0
    v_readlane_b32 s24, v48, 1
    s_min_i32 s59, s59, s24
    v_readlane_b32 s24, v48, 2
    s_min_i32 s59, s59, s24
    s_cmp_ge_i32 s59, s95
    s_cbranch_scc1 interleave_layers__linear_attn_block__memory_aug_recurrent_mem_tr__prompt_kernel_s_ecw2_ok
    s_add_u32 s61, s61, 1
    s_cmp_ge_u32 s61, s60
    s_cbranch_scc1 interleave_layers__linear_attn_block__memory_aug_recurrent_mem_tr__prompt_kernel_s_ecw2_to
    s_sleep 2
    s_branch interleave_layers__linear_attn_block__memory_aug_recurrent_mem_tr__prompt_kernel_s_ecw2
interleave_layers__linear_attn_block__memory_aug_recurrent_mem_tr__prompt_kernel_s_ecw2_to:
    s_mov_b32 s60, 1
interleave_layers__linear_attn_block__memory_aug_recurrent_mem_tr__prompt_kernel_s_ecw2_ok:
    s_add_u32 s63, s40, 1
    s_cmp_ge_i32 s62, s63
    s_cbranch_scc1 interleave_layers__linear_attn_block__memory_aug_recurrent_mem_tr__prompt_kernel_s_enw2_ok
    s_mov_b32 s61, 0
interleave_layers__linear_attn_block__memory_aug_recurrent_mem_tr__prompt_kernel_s_enw2:
    buffer_load_dword v48, v9, s[8:11], 0 offen sc1
    s_waitcnt vmcnt(0)
    v_readlane_b32 s62, v48, 0
    v_readlane_b32 s24, v48, 1
    s_min_i32 s62, s62, s24
    s_cmp_ge_i32 s62, s63
    s_cbranch_scc1 interleave_layers__linear_attn_block__memory_aug_recurrent_mem_tr__prompt_kernel_s_enw2_ok
    s_add_u32 s61, s61, 1
    s_cmp_ge_u32 s61, s60
    s_cbranch_scc1 interleave_layers__linear_attn_block__memory_aug_recurrent_mem_tr__prompt_kernel_s_enw2_to
    s_sleep 2
    s_branch interleave_layers__linear_attn_block__memory_aug_recurrent_mem_tr__prompt_kernel_s_enw2
interleave_layers__linear_attn_block__memory_aug_recurrent_mem_tr__prompt_kernel_s_enw2_to:
    s_mov_b32 s60, 1
interleave_layers__linear_attn_block__memory_aug_recurrent_mem_tr__prompt_kernel_s_enw2_ok:
    buffer_load_dwordx4 a[240:243], v19, s[8:11], s41 offen offset:0 sc1
    buffer_load_dwordx4 a[244:247], v19, s[8:11], s41 offen offset:1024 sc1
    buffer_load_dwordx4 a[248:251], v19, s[8:11], s41 offen offset:2048 sc1
    s_sleep 5
    s_mov_b64 exec, 1
    s_mov_b32 s61, 0
    v_mov_b32 v83, 0
    buffer_atomic_add v83, v23, s[8:11], s48 offen sc0
    s_sleep 2
    v_mov_b32 v94, 0
    buffer_atomic_add v94, v23, s[8:11], s48 offen sc0
    s_sleep 2
    v_mov_b32 v95, 0
    buffer_atomic_add v95, v23, s[8:11], s48 offen sc0
    s_sleep 2
interleave_layers__linear_attn_block__memory_aug_recurrent_mem_tr__prompt_kernel_s_prw2:
    v_mov_b32 v82, 0
    buffer_atomic_add v82, v23, s[8:11], s48 offen sc0
    s_waitcnt vmcnt(3)
    v_cmp_le_i32 vcc, 9, v83
    s_add_u32 s61, s61, 1
    s_cbranch_vccnz interleave_layers__linear_attn_block__memory_aug_recurrent_mem_tr__prompt_kernel_s_prw2_out
    s_sleep 2
    v_mov_b32 v83, 0
    buffer_atomic_add v83, v23, s[8:11], s48 offen sc0
    s_waitcnt vmcnt(3)
    v_cmp_le_i32 vcc, 9, v94
    s_add_u32 s61, s61, 1
    s_cbranch_vccnz interleave_layers__linear_attn_block__memory_aug_recurrent_mem_tr__prompt_kernel_s_prw2_out
    s_sleep 2
    v_mov_b32 v94, 0
    buffer_atomic_add v94, v23, s[8:11], s48 offen sc0
    s_waitcnt vmcnt(3)
    v_cmp_le_i32 vcc, 9, v95
    s_add_u32 s61, s61, 1
    s_cbranch_vccnz interleave_layers__linear_attn_block__memory_aug_recurrent_mem_tr__prompt_kernel_s_prw2_out
    s_sleep 2
    v_mov_b32 v95, 0
    buffer_atomic_add v95, v23, s[8:11], s48 offen sc0
    s_waitcnt vmcnt(3)
    v_cmp_le_i32 vcc, 9, v82
    s_add_u32 s61, s61, 1
    s_cbranch_vccnz interleave_layers__linear_attn_block__memory_aug_recurrent_mem_tr__prompt_kernel_s_prw2_out
    s_sleep 2
    s_cmp_ge_u32 s61, s60
    s_cbranch_scc0 interleave_layers__linear_attn_block__memory_aug_recurrent_mem_tr__prompt_kernel_s_prw2
    s_mov_b32 s60, 1
interleave_layers__linear_attn_block__memory_aug_recurrent_mem_tr__prompt_kernel_s_prw2_out:
    s_mov_b64 exec, -1
    buffer_load_dwordx4 v[84:87], v7, s[8:11], s47 offen sc1
    buffer_load_dwordx4 v[88:91], v7, s[8:11], s46 offen sc1
    buffer_load_dwordx2 v[92:93], v8, s[8:11], s52 offen sc1
    ds_read_b128 v[48:51], v21 offset:0
    ds_read_b128 v[52:55], v21 offset:16
    ds_read_b128 v[56:59], v21 offset:5632
    ds_read_b128 v[60:63], v21 offset:5648
    ds_read_b128 v[64:67], v21 offset:11264
    ds_read_b128 v[68:71], v21 offset:11280
    ds_read_b128 v[72:75], v21 offset:16896
    ds_read_b128 v[76:79], v21 offset:16912
    s_waitcnt lgkmcnt(4)
    v_pk_add_f32 v[48:49], v[48:49], v[56:57]
    v_pk_add_f32 v[50:51], v[50:51], v[58:59]
    v_pk_add_f32 v[52:53], v[52:53], v[60:61]
    v_pk_add_f32 v[54:55], v[54:55], v[62:63]
    s_waitcnt lgkmcnt(0)
    v_pk_add_f32 v[64:65], v[64:65], v[72:73]
    v_pk_add_f32 v[66:67], v[66:67], v[74:75]
    v_pk_add_f32 v[68:69], v[68:69], v[76:77]
    v_pk_add_f32 v[70:71], v[70:71], v[78:79]
    v_pk_add_f32 v[48:49], v[48:49], v[64:65]
    v_pk_add_f32 v[50:51], v[50:51], v[66:67]
    v_pk_add_f32 v[52:53], v[52:53], v[68:69]
    v_pk_add_f32 v[54:55], v[54:55], v[70:71]
    v_mov_b32 v81, 0xff800000
    v_cndmask_b32 v48, v81, v48, s[64:65]
    v_cndmask_b32 v49, v81, v49, s[66:67]
    v_cndmask_b32 v50, v81, v50, s[68:69]
    v_cndmask_b32 v51, v81, v51, s[70:71]
    v_cndmask_b32 v52, v81, v52, s[72:73]
    v_cndmask_b32 v53, v81, v53, s[74:75]
    v_cndmask_b32 v54, v81, v54, s[76:77]
    v_cndmask_b32 v55, v81, v55, s[78:79]
    v_max3_f32 v80, v48, v49, v50
    v_max3_f32 v80, v80, v51, v52
    v_max3_f32 v80, v80, v53, v54
    v_max_f32 v80, v80, v55
    v_mov_b32 v81, 0xff800000
    v_cndmask_b32 v80, v81, v80, s[50:51]
    s_nop 1
    v_max_f32 v80, v80, v80 quad_perm:[1,0,3,2] row_mask:0xf bank_mask:0xf
    s_nop 1
    v_max_f32 v80, v80, v80 quad_perm:[2,3,0,1] row_mask:0xf bank_mask:0xf
    s_nop 1
    v_max_f32 v80, v80, v80 row_half_mirror row_mask:0xf bank_mask:0xf
    s_mov_b32 s24, 0x3dd53b95
    v_mul_f32 v80, s24, v80
    v_fma_f32 v48, v48, s24, -v80
    v_fma_f32 v49, v49, s24, -v80
    v_fma_f32 v50, v50, s24, -v80
    v_fma_f32 v51, v51, s24, -v80
    v_fma_f32 v52, v52, s24, -v80
    v_fma_f32 v53, v53, s24, -v80
    v_fma_f32 v54, v54, s24, -v80
    v_fma_f32 v55, v55, s24, -v80
    v_exp_f32 v48, v48
    v_exp_f32 v49, v49
    v_exp_f32 v50, v50
    v_exp_f32 v51, v51
    v_exp_f32 v52, v52
    v_exp_f32 v53, v53
    v_exp_f32 v54, v54
    v_exp_f32 v55, v55
    v_add_f32 v80, v48, v49
    v_add_f32 v81, v50, v51
    v_add_f32 v80, v80, v52
    v_add_f32 v81, v81, v53
    v_add_f32 v80, v80, v54
    v_add_f32 v81, v81, v55
    v_add_f32 v80, v80, v81
    v_cndmask_b32 v80, 0, v80, s[50:51]
    s_nop 1
    v_add_f32 v80, v80, v80 quad_perm:[1,0,3,2] row_mask:0xf bank_mask:0xf
    s_nop 1
    v_add_f32 v80, v80, v80 quad_perm:[2,3,0,1] row_mask:0xf bank_mask:0xf
    s_nop 1
    v_add_f32 v80, v80, v80 row_half_mirror row_mask:0xf bank_mask:0xf
    v_rcp_f32 v80, v80
    s_nop 0
    v_mul_f32 v48, v48, v80
    v_mul_f32 v49, v49, v80
    v_mul_f32 v50, v50, v80
    v_mul_f32 v51, v51, v80
    v_mul_f32 v52, v52, v80
    v_mul_f32 v53, v53, v80
    v_mul_f32 v54, v54, v80
    v_mul_f32 v55, v55, v80
    v_cvt_pk_bf16_f32 v56, v48, v49
    v_cvt_pk_bf16_f32 v57, v50, v51
    v_cvt_pk_bf16_f32 v58, v52, v53
    v_cvt_pk_bf16_f32 v59, v54, v55
    v_min_u32 v56, -2, v56
    v_min_u32 v57, -2, v57
    v_min_u32 v58, -2, v58
    v_min_u32 v59, -2, v59
    buffer_store_dwordx4 v[56:59], v22, s[8:11], s42 offen sc1
    s_waitcnt vmcnt(1)
    s_nop 0
    v_max3_u32 v58, v84, v85, v86
    v_max3_u32 v58, v58, v87, v88
    v_max3_u32 v58, v58, v89, v90
    v_max3_u32 v58, v58, v91, v92
    v_max_u32 v58, v58, v93
    v_cmp_eq_u32 vcc, -1, v58
    s_cbranch_vccz interleave_layers__linear_attn_block__memory_aug_recurrent_mem_tr__prompt_kernel_s_pmw2_out
    s_mov_b32 s61, 0
interleave_layers__linear_attn_block__memory_aug_recurrent_mem_tr__prompt_kernel_s_pmw2:
    buffer_load_dwordx4 v[84:87], v7, s[8:11], s47 offen sc1
    buffer_load_dwordx4 v[88:91], v7, s[8:11], s46 offen sc1
    buffer_load_dwordx2 v[92:93], v8, s[8:11], s52 offen sc1
    s_waitcnt vmcnt(0)
    v_max3_u32 v58, v84, v85, v86
    v_max3_u32 v58, v58, v87, v88
    v_max3_u32 v58, v58, v89, v90
    v_max3_u32 v58, v58, v91, v92
    v_max_u32 v58, v58, v93
    v_cmp_eq_u32 vcc, -1, v58
    s_add_u32 s61, s61, 1
    s_cbranch_vccz interleave_layers__linear_attn_block__memory_aug_recurrent_mem_tr__prompt_kernel_s_pmw2_out
    s_cmp_ge_u32 s61, s60
    s_cbranch_scc1 interleave_layers__linear_attn_block__memory_aug_recurrent_mem_tr__prompt_kernel_s_pmw2_to
    s_sleep 1
    s_branch interleave_layers__linear_attn_block__memory_aug_recurrent_mem_tr__prompt_kernel_s_pmw2
interleave_layers__linear_attn_block__memory_aug_recurrent_mem_tr__prompt_kernel_s_pmw2_to:
    s_mov_b32 s60, 1
interleave_layers__linear_attn_block__memory_aug_recurrent_mem_tr__prompt_kernel_s_pmw2_out:
    ds_write_b128 v7, v[84:87]
    ds_write_b128 v7, v[88:91] offset:4096
    ds_write_b64 v8, v[92:93]
interleave_layers__linear_attn_block__memory_aug_recurrent_mem_tr__prompt_kernel_s_gow2:
    ds_read_b128 v[68:71], v6 offset:4096
    ds_read_b128 v[72:75], v6 offset:5120
    ds_read_b128 v[76:79], v6 offset:12288
    ds_read_b128 v[80:83], v6 offset:13312
    v_smfmac_f32_16x16x64_bf16 v[24:27], v[84:87], a[16:23], v4
    v_smfmac_f32_16x16x64_bf16 v[28:31], v[84:87], a[96:103], v4
    v_smfmac_f32_16x16x64_bf16 v[32:35], v[84:87], a[176:183], v4
    v_smfmac_f32_16x16x64_bf16 v[40:43], v[84:87], v[112:119], v4
    v_smfmac_f32_16x16x64_bf16 v[44:47], v[84:87], v[192:199], v4
    s_waitcnt lgkmcnt(2)
    v_smfmac_f32_16x16x64_bf16 v[36:39], v[84:87], v[68:75], v4
    ds_read_b128 v[68:71], v6 offset:0
    ds_read_b128 v[72:75], v6 offset:1024
    s_barrier
    ds_read_b128 v[48:51], v5 offset:0
    ds_read_b128 v[52:55], v5 offset:1024
    ds_read_b128 v[56:59], v5 offset:3072
    ds_read_b128 v[60:63], v5 offset:4096
    ds_read_b128 v[64:67], v5 offset:5120
    v_smfmac_f32_16x16x64_bf16 v[24:27], v[88:91], a[48:55], v4
    v_smfmac_f32_16x16x64_bf16 v[28:31], v[88:91], a[128:135], v4
    v_smfmac_f32_16x16x64_bf16 v[32:35], v[88:91], a[208:215], v4
    v_smfmac_f32_16x16x64_bf16 v[40:43], v[88:91], v[144:151], v4
    v_smfmac_f32_16x16x64_bf16 v[44:47], v[88:91], v[224:231], v4
    s_waitcnt lgkmcnt(7)
    v_smfmac_f32_16x16x64_bf16 v[36:39], v[88:91], v[76:83], v4
    ds_read_b128 v[76:79], v6 offset:2048
    ds_read_b128 v[80:83], v6 offset:3072
    s_waitcnt lgkmcnt(6)
    v_smfmac_f32_16x16x64_bf16 v[24:27], v[48:51], a[0:7], v4
    v_smfmac_f32_16x16x64_bf16 v[28:31], v[48:51], a[80:87], v4
    v_smfmac_f32_16x16x64_bf16 v[40:43], v[48:51], v[96:103], v4
    v_smfmac_f32_16x16x64_bf16 v[36:39], v[48:51], v[68:75], v4
    ds_read_b128 v[68:71], v6 offset:6144
    ds_read_b128 v[72:75], v6 offset:7168
    ds_read_b128 v[48:51], v5 offset:7168
    s_waitcnt lgkmcnt(8)
    v_smfmac_f32_16x16x64_bf16 v[24:27], v[52:55], a[8:15], v4
    v_smfmac_f32_16x16x64_bf16 v[28:31], v[52:55], a[88:95], v4
    v_smfmac_f32_16x16x64_bf16 v[40:43], v[52:55], v[104:111], v4
    s_waitcnt lgkmcnt(3)
    v_smfmac_f32_16x16x64_bf16 v[36:39], v[52:55], v[76:83], v4
    ds_read_b128 v[76:79], v6 offset:8192
    ds_read_b128 v[80:83], v6 offset:9216
    ds_read_b128 v[52:55], v5 offset:8192
    v_smfmac_f32_16x16x64_bf16 v[24:27], v[56:59], a[24:31], v4
    v_smfmac_f32_16x16x64_bf16 v[28:31], v[56:59], a[104:111], v4
    v_smfmac_f32_16x16x64_bf16 v[40:43], v[56:59], v[120:127], v4
    s_waitcnt lgkmcnt(4)
    v_smfmac_f32_16x16x64_bf16 v[36:39], v[56:59], v[68:75], v4
    ds_read_b128 v[68:71], v6 offset:10240
    ds_read_b128 v[72:75], v6 offset:11264
    ds_read_b128 v[56:59], v5 offset:9216
    v_smfmac_f32_16x16x64_bf16 v[24:27], v[60:63], a[32:39], v4
    v_smfmac_f32_16x16x64_bf16 v[28:31], v[60:63], a[112:119], v4
    v_smfmac_f32_16x16x64_bf16 v[40:43], v[60:63], v[128:135], v4
    s_waitcnt lgkmcnt(4)
    v_smfmac_f32_16x16x64_bf16 v[36:39], v[60:63], v[76:83], v4
    ds_read_b128 v[76:79], v6 offset:14336
    ds_read_b128 v[80:83], v6 offset:15360
    ds_read_b128 v[60:63], v5 offset:0
    v_smfmac_f32_16x16x64_bf16 v[24:27], v[64:67], a[40:47], v4
    v_smfmac_f32_16x16x64_bf16 v[28:31], v[64:67], a[120:127], v4
    v_smfmac_f32_16x16x64_bf16 v[40:43], v[64:67], v[136:143], v4
    s_waitcnt lgkmcnt(4)
    v_smfmac_f32_16x16x64_bf16 v[36:39], v[64:67], v[68:75], v4
    ds_read_b128 v[68:71], v6 offset:16384
    ds_read_b128 v[72:75], v6 offset:17408
    ds_read_b128 v[64:67], v5 offset:1024
    v_smfmac_f32_16x16x64_bf16 v[24:27], v[48:51], a[56:63], v4
    v_smfmac_f32_16x16x64_bf16 v[28:31], v[48:51], a[136:143], v4
    v_smfmac_f32_16x16x64_bf16 v[40:43], v[48:51], v[152:159], v4
    s_waitcnt lgkmcnt(4)
    v_smfmac_f32_16x16x64_bf16 v[36:39], v[48:51], v[76:83], v4
    ds_read_b128 v[76:79], v6 offset:18432
    ds_read_b128 v[80:83], v6 offset:19456
    ds_read_b128 v[48:51], v5 offset:3072
    v_smfmac_f32_16x16x64_bf16 v[24:27], v[52:55], a[64:71], v4
    v_smfmac_f32_16x16x64_bf16 v[28:31], v[52:55], a[144:151], v4
    v_smfmac_f32_16x16x64_bf16 v[40:43], v[52:55], v[160:167], v4
    s_waitcnt lgkmcnt(4)
    v_smfmac_f32_16x16x64_bf16 v[36:39], v[52:55], v[68:75], v4
    ds_read_b128 v[52:55], v5 offset:4096
    v_smfmac_f32_16x16x64_bf16 v[24:27], v[56:59], a[72:79], v4
    v_smfmac_f32_16x16x64_bf16 v[28:31], v[56:59], a[152:159], v4
    v_smfmac_f32_16x16x64_bf16 v[40:43], v[56:59], v[168:175], v4
    s_waitcnt lgkmcnt(2)
    v_smfmac_f32_16x16x64_bf16 v[36:39], v[56:59], v[76:83], v4
    ds_read_b128 v[56:59], v5 offset:5120
    buffer_load_dwordx4 v[80:83], v19, s[8:11], s45 offen offset:0 sc1
    buffer_load_dwordx4 v[84:87], v19, s[8:11], s45 offen offset:1024 sc1
    buffer_load_dwordx4 v[88:91], v19, s[8:11], s45 offen offset:2048 sc1
    v_smfmac_f32_16x16x64_bf16 v[32:35], v[60:63], a[160:167], v4
    v_smfmac_f32_16x16x64_bf16 v[44:47], v[60:63], v[176:183], v4
    v_permlane32_swap_b32 v28, v40
    v_permlane32_swap_b32 v29, v41
    ds_read_b128 v[60:63], v5 offset:7168
    v_smfmac_f32_16x16x64_bf16 v[32:35], v[64:67], a[168:175], v4
    v_permlane32_swap_b32 v30, v42
    v_permlane32_swap_b32 v31, v43
    v_smfmac_f32_16x16x64_bf16 v[44:47], v[64:67], v[184:191], v4
    v_add_f32 v28, v28, v40
    v_add_f32 v29, v29, v41
    ds_read_b128 v[64:67], v5 offset:8192
    s_waitcnt lgkmcnt(4)
    v_smfmac_f32_16x16x64_bf16 v[32:35], v[48:51], a[184:191], v4
    v_add_f32 v30, v30, v42
    v_add_f32 v31, v31, v43
    v_smfmac_f32_16x16x64_bf16 v[44:47], v[48:51], v[200:207], v4
    v_cvt_pk_bf16_f32 v40, v28, v29
    v_cvt_pk_bf16_f32 v41, v30, v31
    ds_read_b128 v[48:51], v5 offset:9216
    s_waitcnt lgkmcnt(4)
    v_smfmac_f32_16x16x64_bf16 v[32:35], v[52:55], a[192:199], v4
    v_mfma_f32_16x16x16_bf16 v[28:31], v[40:41], v[10:11], 0
    v_permlane32_swap_b32 v24, v36
    v_smfmac_f32_16x16x64_bf16 v[44:47], v[52:55], v[208:215], v4
    v_permlane32_swap_b32 v25, v37
    v_permlane32_swap_b32 v26, v38
    s_waitcnt lgkmcnt(3)
    v_smfmac_f32_16x16x64_bf16 v[32:35], v[56:59], a[200:207], v4
    v_permlane32_swap_b32 v27, v39
    v_add_f32 v24, v24, v36
    v_smfmac_f32_16x16x64_bf16 v[44:47], v[56:59], v[216:223], v4
    v_add_f32 v25, v25, v37
    v_add_f32 v26, v26, v38
    s_waitcnt lgkmcnt(2)
    v_smfmac_f32_16x16x64_bf16 v[32:35], v[60:63], a[216:223], v4
    v_add_f32 v27, v27, v39
    v_cvt_pk_bf16_f32 v36, v24, v25
    v_smfmac_f32_16x16x64_bf16 v[44:47], v[60:63], v[232:239], v4
    v_cvt_pk_bf16_f32 v37, v26, v27
    s_nop 1
    v_mfma_f32_16x16x16_bf16 v[24:27], v[36:37], v[10:11], 0
    s_waitcnt lgkmcnt(1)
    v_smfmac_f32_16x16x64_bf16 v[32:35], v[64:67], a[224:231], v4
    s_nop 5
    v_cvt_pk_bf16_f32 v24, v24, v25
    v_smfmac_f32_16x16x64_bf16 v[44:47], v[64:67], v[240:247], v4
    v_cvt_pk_bf16_f32 v25, v26, v27
    v_cvt_pk_bf16_f32 v26, v28, v29
    s_waitcnt lgkmcnt(0)
    v_smfmac_f32_16x16x64_bf16 v[32:35], v[48:51], a[232:239], v4
    v_cvt_pk_bf16_f32 v27, v30, v31
    s_waitcnt vmcnt(3)
    v_smfmac_f32_16x16x64_bf16 v[44:47], v[48:51], v[248:255], v4
    v_mfma_f32_16x16x32_bf16 v[28:31], a[240:243], v[24:27], 0
    v_mfma_f32_16x16x32_bf16 v[36:39], a[244:247], v[24:27], 0
    v_mfma_f32_16x16x32_bf16 v[40:43], v[24:27], v[24:27], 0
    s_nop 4
    v_permlane32_swap_b32 v32, v44
    v_permlane32_swap_b32 v33, v45
    v_permlane32_swap_b32 v34, v46
    v_permlane32_swap_b32 v35, v47
    v_add_f32 v32, v32, v44
    v_add_f32 v33, v33, v45
    v_add_f32 v34, v34, v46
    v_add_f32 v35, v35, v47
    v_cvt_pk_bf16_f32 v44, v32, v33
    v_cvt_pk_bf16_f32 v45, v34, v35
    s_nop 1
    v_mfma_f32_16x16x16_bf16 v[32:35], v[44:45], v[10:11], 0
    s_nop 7
    v_cvt_pk_bf16_f32 v32, v32, v33
    v_cvt_pk_bf16_f32 v33, v34, v35
    s_nop 1
    v_mfma_f32_16x16x16_bf16 v[28:31], a[248:249], v[32:33], v[28:31]
    v_mfma_f32_16x16x16_bf16 v[36:39], a[250:251], v[32:33], v[36:39]
    v_mfma_f32_16x16x16_bf16 v[40:43], v[32:33], v[32:33], v[40:43]
    s_nop 5
    ds_write_b128 v12, v[28:31]
    ds_write_b128 v12, v[36:39] offset:16
    ds_write_b128 v13, v[40:43]
    s_waitcnt lgkmcnt(0)
    s_barrier
    s_waitcnt vmcnt(0)
    v_mfma_f32_16x16x32_bf16 v[36:39], a[240:243], v[80:83], 0
    v_mfma_f32_16x16x32_bf16 v[44:47], a[244:247], v[80:83], 0
    v_mfma_f32_16x16x32_bf16 v[68:71], v[24:27], v[80:83], 0
    v_mfma_f32_16x16x32_bf16 v[40:43], a[240:243], v[84:87], 0
    v_mfma_f32_16x16x32_bf16 v[64:67], a[244:247], v[84:87], 0
    v_mfma_f32_16x16x32_bf16 v[72:75], v[24:27], v[84:87], 0
    s_nop 0
    v_mfma_f32_16x16x16_bf16 v[36:39], a[248:249], v[88:89], v[36:39]
    v_mfma_f32_16x16x16_bf16 v[44:47], a[250:251], v[88:89], v[44:47]
    v_mfma_f32_16x16x16_bf16 v[68:71], v[32:33], v[88:89], v[68:71]
    v_mfma_f32_16x16x16_bf16 v[40:43], a[248:249], v[90:91], v[40:43]
    v_mfma_f32_16x16x16_bf16 v[64:67], a[250:251], v[90:91], v[64:67]
    v_mfma_f32_16x16x16_bf16 v[72:75], v[32:33], v[90:91], v[72:75]
    s_nop 2
    ds_write_b128 v16, v[36:39] offset:0
    ds_write_b128 v16, v[44:47] offset:16
    ds_write_b128 v17, v[68:71]
    ds_write_b128 v16, v[40:43] offset:2816
    ds_write_b128 v16, v[64:67] offset:2832
    ds_write_b128 v18, v[72:75]
    s_add_u32 s40, s40, 1
    s_add_u32 s41, s41, 393216
    s_add_u32 s45, s45, 393216
    s_add_u32 s47, s37, 704512
    s_add_u32 s48, s37, 737280
    s_xor_b32 s42, s37, 0x2000
    s_lshl_b32 s24, s40, 12
    s_and_b32 s24, s24, 0x2000
    s_xor_b32 s24, s24, s36
    s_lshl_b32 s37, s40, 20
    s_add_u32 s37, s37, s24
    s_add_u32 s37, s37, 117440512
    s_add_u32 s43, s37, 655360
    s_add_u32 s49, s37, 753664
    s_waitcnt lgkmcnt(0)
    s_barrier
    s_cmp_lt_u32 s40, 64
    s_cbranch_scc1 interleave_layers__linear_attn_block__memory_aug_recurrent_mem_tr__prompt_kernel_s_stepw2
    s_branch interleave_layers__linear_attn_block__memory_aug_recurrent_mem_tr__prompt_kernel_s_end
interleave_layers__linear_attn_block__memory_aug_recurrent_mem_tr__prompt_kernel_s_stepw3:
    v_mov_b32 v24, 0
    v_mov_b32 v25, 0
    v_mov_b32 v26, 0
    v_mov_b32 v27, 0
    v_mov_b32 v28, 0
    v_mov_b32 v29, 0
    v_mov_b32 v30, 0
    v_mov_b32 v31, 0
    v_mov_b32 v32, 0
    v_mov_b32 v33, 0
    v_mov_b32 v34, 0
    v_mov_b32 v35, 0
    v_mov_b32 v36, 0
    v_mov_b32 v37, 0
    v_mov_b32 v38, 0
    v_mov_b32 v39, 0
    v_mov_b32 v40, 0
    v_mov_b32 v41, 0
    v_mov_b32 v42, 0
    v_mov_b32 v43, 0
    v_mov_b32 v44, 0
    v_mov_b32 v45, 0
    v_mov_b32 v46, 0
    v_mov_b32 v47, 0
    s_add_u32 s46, s47, 4096
    s_add_u32 s52, s47, 8192
    s_lshl_b32 s95, s92, 6
    s_add_u32 s95, s95, s40
    s_add_u32 s95, s95, 1
    s_cmp_ge_i32 s59, s95
    s_cbranch_scc1 interleave_layers__linear_attn_block__memory_aug_recurrent_mem_tr__prompt_kernel_s_ecw3_ok
    s_and_b32 s24, s2, 7
    s_lshl_b32 s24, s24, 7
    s_add_u32 s24, s24, 23109632
    v_and_b32 v49, 3, v1
    v_lshl_add_u32 v49, v49, 2, s24
    s_mov_b32 s61, 0
interleave_layers__linear_attn_block__memory_aug_recurrent_mem_tr__prompt_kernel_s_ecw3:
    buffer_load_dword v48, v49, s[8:11], 0 offen sc1
    s_waitcnt vmcnt(0)
    v_readlane_b32 s59, v48, 0
    v_readlane_b32 s24, v48, 1
    s_min_i32 s59, s59, s24
    v_readlane_b32 s24, v48, 2
    s_min_i32 s59, s59, s24
    s_cmp_ge_i32 s59, s95
    s_cbranch_scc1 interleave_layers__linear_attn_block__memory_aug_recurrent_mem_tr__prompt_kernel_s_ecw3_ok
    s_add_u32 s61, s61, 1
    s_cmp_ge_u32 s61, s60
    s_cbranch_scc1 interleave_layers__linear_attn_block__memory_aug_recurrent_mem_tr__prompt_kernel_s_ecw3_to
    s_sleep 2
    s_branch interleave_layers__linear_attn_block__memory_aug_recurrent_mem_tr__prompt_kernel_s_ecw3
interleave_layers__linear_attn_block__memory_aug_recurrent_mem_tr__prompt_kernel_s_ecw3_to:
    s_mov_b32 s60, 1
interleave_layers__linear_attn_block__memory_aug_recurrent_mem_tr__prompt_kernel_s_ecw3_ok:
    s_add_u32 s63, s40, 1
    s_cmp_ge_i32 s62, s63
    s_cbranch_scc1 interleave_layers__linear_attn_block__memory_aug_recurrent_mem_tr__prompt_kernel_s_enw3_ok
    s_mov_b32 s61, 0
interleave_layers__linear_attn_block__memory_aug_recurrent_mem_tr__prompt_kernel_s_enw3:
    buffer_load_dword v48, v9, s[8:11], 0 offen sc1
    s_waitcnt vmcnt(0)
    v_readlane_b32 s62, v48, 0
    v_readlane_b32 s24, v48, 1
    s_min_i32 s62, s62, s24
    s_cmp_ge_i32 s62, s63
    s_cbranch_scc1 interleave_layers__linear_attn_block__memory_aug_recurrent_mem_tr__prompt_kernel_s_enw3_ok
    s_add_u32 s61, s61, 1
    s_cmp_ge_u32 s61, s60
    s_cbranch_scc1 interleave_layers__linear_attn_block__memory_aug_recurrent_mem_tr__prompt_kernel_s_enw3_to
    s_sleep 2
    s_branch interleave_layers__linear_attn_block__memory_aug_recurrent_mem_tr__prompt_kernel_s_enw3
interleave_layers__linear_attn_block__memory_aug_recurrent_mem_tr__prompt_kernel_s_enw3_to:
    s_mov_b32 s60, 1
interleave_layers__linear_attn_block__memory_aug_recurrent_mem_tr__prompt_kernel_s_enw3_ok:
    buffer_load_dwordx4 a[240:243], v19, s[8:11], s41 offen offset:0 sc1
    buffer_load_dwordx4 a[244:247], v19, s[8:11], s41 offen offset:1024 sc1
    buffer_load_dwordx4 a[248:251], v19, s[8:11], s41 offen offset:2048 sc1
    s_sleep 5
    s_mov_b64 exec, 1
    s_mov_b32 s61, 0
    v_mov_b32 v83, 0
    buffer_atomic_add v83, v23, s[8:11], s48 offen sc0
    s_sleep 2
    v_mov_b32 v94, 0
    buffer_atomic_add v94, v23, s[8:11], s48 offen sc0
    s_sleep 2
    v_mov_b32 v95, 0
    buffer_atomic_add v95, v23, s[8:11], s48 offen sc0
    s_sleep 2
interleave_layers__linear_attn_block__memory_aug_recurrent_mem_tr__prompt_kernel_s_prw3:
    v_mov_b32 v82, 0
    buffer_atomic_add v82, v23, s[8:11], s48 offen sc0
    s_waitcnt vmcnt(3)
    v_cmp_le_i32 vcc, 9, v83
    s_add_u32 s61, s61, 1
    s_cbranch_vccnz interleave_layers__linear_attn_block__memory_aug_recurrent_mem_tr__prompt_kernel_s_prw3_out
    s_sleep 2
    v_mov_b32 v83, 0
    buffer_atomic_add v83, v23, s[8:11], s48 offen sc0
    s_waitcnt vmcnt(3)
    v_cmp_le_i32 vcc, 9, v94
    s_add_u32 s61, s61, 1
    s_cbranch_vccnz interleave_layers__linear_attn_block__memory_aug_recurrent_mem_tr__prompt_kernel_s_prw3_out
    s_sleep 2
    v_mov_b32 v94, 0
    buffer_atomic_add v94, v23, s[8:11], s48 offen sc0
    s_waitcnt vmcnt(3)
    v_cmp_le_i32 vcc, 9, v95
    s_add_u32 s61, s61, 1
    s_cbranch_vccnz interleave_layers__linear_attn_block__memory_aug_recurrent_mem_tr__prompt_kernel_s_prw3_out
    s_sleep 2
    v_mov_b32 v95, 0
    buffer_atomic_add v95, v23, s[8:11], s48 offen sc0
    s_waitcnt vmcnt(3)
    v_cmp_le_i32 vcc, 9, v82
    s_add_u32 s61, s61, 1
    s_cbranch_vccnz interleave_layers__linear_attn_block__memory_aug_recurrent_mem_tr__prompt_kernel_s_prw3_out
    s_sleep 2
    s_cmp_ge_u32 s61, s60
    s_cbranch_scc0 interleave_layers__linear_attn_block__memory_aug_recurrent_mem_tr__prompt_kernel_s_prw3
    s_mov_b32 s60, 1
interleave_layers__linear_attn_block__memory_aug_recurrent_mem_tr__prompt_kernel_s_prw3_out:
    s_mov_b64 exec, -1
    buffer_load_dwordx4 v[84:87], v7, s[8:11], s47 offen sc1
    buffer_load_dwordx4 v[88:91], v7, s[8:11], s46 offen sc1
    buffer_load_dwordx2 v[92:93], v8, s[8:11], s52 offen sc1
    ds_read_b128 v[48:51], v21 offset:0
    ds_read_b128 v[52:55], v21 offset:16
    ds_read_b128 v[56:59], v21 offset:5632
    ds_read_b128 v[60:63], v21 offset:5648
    ds_read_b128 v[64:67], v21 offset:11264
    ds_read_b128 v[68:71], v21 offset:11280
    ds_read_b128 v[72:75], v21 offset:16896
    ds_read_b128 v[76:79], v21 offset:16912
    s_waitcnt lgkmcnt(4)
    v_pk_add_f32 v[48:49], v[48:49], v[56:57]
    v_pk_add_f32 v[50:51], v[50:51], v[58:59]
    v_pk_add_f32 v[52:53], v[52:53], v[60:61]
    v_pk_add_f32 v[54:55], v[54:55], v[62:63]
    s_waitcnt lgkmcnt(0)
    v_pk_add_f32 v[64:65], v[64:65], v[72:73]
    v_pk_add_f32 v[66:67], v[66:67], v[74:75]
    v_pk_add_f32 v[68:69], v[68:69], v[76:77]
    v_pk_add_f32 v[70:71], v[70:71], v[78:79]
    v_pk_add_f32 v[48:49], v[48:49], v[64:65]
    v_pk_add_f32 v[50:51], v[50:51], v[66:67]
    v_pk_add_f32 v[52:53], v[52:53], v[68:69]
    v_pk_add_f32 v[54:55], v[54:55], v[70:71]
    v_mov_b32 v81, 0xff800000
    v_cndmask_b32 v48, v81, v48, s[64:65]
    v_cndmask_b32 v49, v81, v49, s[66:67]
    v_cndmask_b32 v50, v81, v50, s[68:69]
    v_cndmask_b32 v51, v81, v51, s[70:71]
    v_cndmask_b32 v52, v81, v52, s[72:73]
    v_cndmask_b32 v53, v81, v53, s[74:75]
    v_cndmask_b32 v54, v81, v54, s[76:77]
    v_cndmask_b32 v55, v81, v55, s[78:79]
    v_max3_f32 v80, v48, v49, v50
    v_max3_f32 v80, v80, v51, v52
    v_max3_f32 v80, v80, v53, v54
    v_max_f32 v80, v80, v55
    v_mov_b32 v81, 0xff800000
    v_cndmask_b32 v80, v81, v80, s[50:51]
    s_nop 1
    v_max_f32 v80, v80, v80 quad_perm:[1,0,3,2] row_mask:0xf bank_mask:0xf
    s_nop 1
    v_max_f32 v80, v80, v80 quad_perm:[2,3,0,1] row_mask:0xf bank_mask:0xf
    s_nop 1
    v_max_f32 v80, v80, v80 row_half_mirror row_mask:0xf bank_mask:0xf
    s_mov_b32 s24, 0x3dd53b95
    v_mul_f32 v80, s24, v80
    v_fma_f32 v48, v48, s24, -v80
    v_fma_f32 v49, v49, s24, -v80
    v_fma_f32 v50, v50, s24, -v80
    v_fma_f32 v51, v51, s24, -v80
    v_fma_f32 v52, v52, s24, -v80
    v_fma_f32 v53, v53, s24, -v80
    v_fma_f32 v54, v54, s24, -v80
    v_fma_f32 v55, v55, s24, -v80
    v_exp_f32 v48, v48
    v_exp_f32 v49, v49
    v_exp_f32 v50, v50
    v_exp_f32 v51, v51
    v_exp_f32 v52, v52
    v_exp_f32 v53, v53
    v_exp_f32 v54, v54
    v_exp_f32 v55, v55
    v_add_f32 v80, v48, v49
    v_add_f32 v81, v50, v51
    v_add_f32 v80, v80, v52
    v_add_f32 v81, v81, v53
    v_add_f32 v80, v80, v54
    v_add_f32 v81, v81, v55
    v_add_f32 v80, v80, v81
    v_cndmask_b32 v80, 0, v80, s[50:51]
    s_nop 1
    v_add_f32 v80, v80, v80 quad_perm:[1,0,3,2] row_mask:0xf bank_mask:0xf
    s_nop 1
    v_add_f32 v80, v80, v80 quad_perm:[2,3,0,1] row_mask:0xf bank_mask:0xf
    s_nop 1
    v_add_f32 v80, v80, v80 row_half_mirror row_mask:0xf bank_mask:0xf
    v_rcp_f32 v80, v80
    s_nop 0
    v_mul_f32 v48, v48, v80
    v_mul_f32 v49, v49, v80
    v_mul_f32 v50, v50, v80
    v_mul_f32 v51, v51, v80
    v_mul_f32 v52, v52, v80
    v_mul_f32 v53, v53, v80
    v_mul_f32 v54, v54, v80
    v_mul_f32 v55, v55, v80
    v_cvt_pk_bf16_f32 v56, v48, v49
    v_cvt_pk_bf16_f32 v57, v50, v51
    v_cvt_pk_bf16_f32 v58, v52, v53
    v_cvt_pk_bf16_f32 v59, v54, v55
    v_min_u32 v56, -2, v56
    v_min_u32 v57, -2, v57
    v_min_u32 v58, -2, v58
    v_min_u32 v59, -2, v59
    buffer_store_dwordx4 v[56:59], v22, s[8:11], s42 offen sc1
    s_waitcnt vmcnt(1)
    s_nop 0
    v_max3_u32 v58, v84, v85, v86
    v_max3_u32 v58, v58, v87, v88
    v_max3_u32 v58, v58, v89, v90
    v_max3_u32 v58, v58, v91, v92
    v_max_u32 v58, v58, v93
    v_cmp_eq_u32 vcc, -1, v58
    s_cbranch_vccz interleave_layers__linear_attn_block__memory_aug_recurrent_mem_tr__prompt_kernel_s_pmw3_out
    s_mov_b32 s61, 0
interleave_layers__linear_attn_block__memory_aug_recurrent_mem_tr__prompt_kernel_s_pmw3:
    buffer_load_dwordx4 v[84:87], v7, s[8:11], s47 offen sc1
    buffer_load_dwordx4 v[88:91], v7, s[8:11], s46 offen sc1
    buffer_load_dwordx2 v[92:93], v8, s[8:11], s52 offen sc1
    s_waitcnt vmcnt(0)
    v_max3_u32 v58, v84, v85, v86
    v_max3_u32 v58, v58, v87, v88
    v_max3_u32 v58, v58, v89, v90
    v_max3_u32 v58, v58, v91, v92
    v_max_u32 v58, v58, v93
    v_cmp_eq_u32 vcc, -1, v58
    s_add_u32 s61, s61, 1
    s_cbranch_vccz interleave_layers__linear_attn_block__memory_aug_recurrent_mem_tr__prompt_kernel_s_pmw3_out
    s_cmp_ge_u32 s61, s60
    s_cbranch_scc1 interleave_layers__linear_attn_block__memory_aug_recurrent_mem_tr__prompt_kernel_s_pmw3_to
    s_sleep 1
    s_branch interleave_layers__linear_attn_block__memory_aug_recurrent_mem_tr__prompt_kernel_s_pmw3
interleave_layers__linear_attn_block__memory_aug_recurrent_mem_tr__prompt_kernel_s_pmw3_to:
    s_mov_b32 s60, 1
interleave_layers__linear_attn_block__memory_aug_recurrent_mem_tr__prompt_kernel_s_pmw3_out:
    ds_write_b128 v7, v[84:87]
    ds_write_b128 v7, v[88:91] offset:4096
    ds_write_b64 v8, v[92:93]
interleave_layers__linear_attn_block__memory_aug_recurrent_mem_tr__prompt_kernel_s_gow3:
    ds_read_b128 v[68:71], v6 offset:6144
    ds_read_b128 v[72:75], v6 offset:7168
    ds_read_b128 v[76:79], v6 offset:14336
    ds_read_b128 v[80:83], v6 offset:15360
    v_smfmac_f32_16x16x64_bf16 v[24:27], v[84:87], a[24:31], v4
    v_smfmac_f32_16x16x64_bf16 v[28:31], v[84:87], a[104:111], v4
    v_smfmac_f32_16x16x64_bf16 v[32:35], v[84:87], a[184:191], v4
    v_smfmac_f32_16x16x64_bf16 v[40:43], v[84:87], v[120:127], v4
    v_smfmac_f32_16x16x64_bf16 v[44:47], v[84:87], v[200:207], v4
    s_waitcnt lgkmcnt(2)
    v_smfmac_f32_16x16x64_bf16 v[36:39], v[84:87], v[68:75], v4
    ds_read_b128 v[68:71], v6 offset:0
    ds_read_b128 v[72:75], v6 offset:1024
    s_barrier
    ds_read_b128 v[48:51], v5 offset:0
    ds_read_b128 v[52:55], v5 offset:1024
    ds_read_b128 v[56:59], v5 offset:2048
    ds_read_b128 v[60:63], v5 offset:4096
    ds_read_b128 v[64:67], v5 offset:5120
    v_smfmac_f32_16x16x64_bf16 v[24:27], v[88:91], a[56:63], v4
    v_smfmac_f32_16x16x64_bf16 v[28:31], v[88:91], a[136:143], v4
    v_smfmac_f32_16x16x64_bf16 v[32:35], v[88:91], a[216:223], v4
    v_smfmac_f32_16x16x64_bf16 v[40:43], v[88:91], v[152:159], v4
    v_smfmac_f32_16x16x64_bf16 v[44:47], v[88:91], v[232:239], v4
    s_waitcnt lgkmcnt(7)
    v_smfmac_f32_16x16x64_bf16 v[36:39], v[88:91], v[76:83], v4
    ds_read_b128 v[76:79], v6 offset:2048
    ds_read_b128 v[80:83], v6 offset:3072
    s_waitcnt lgkmcnt(6)
    v_smfmac_f32_16x16x64_bf16 v[24:27], v[48:51], a[0:7], v4
    v_smfmac_f32_16x16x64_bf16 v[28:31], v[48:51], a[80:87], v4
    v_smfmac_f32_16x16x64_bf16 v[40:43], v[48:51], v[96:103], v4
    v_smfmac_f32_16x16x64_bf16 v[36:39], v[48:51], v[68:75], v4
    ds_read_b128 v[68:71], v6 offset:4096
    ds_read_b128 v[72:75], v6 offset:5120
    ds_read_b128 v[48:51], v5 offset:6144
    s_waitcnt lgkmcnt(8)
    v_smfmac_f32_16x16x64_bf16 v[24:27], v[52:55], a[8:15], v4
    v_smfmac_f32_16x16x64_bf16 v[28:31], v[52:55], a[88:95], v4
    v_smfmac_f32_16x16x64_bf16 v[40:43], v[52:55], v[104:111], v4
    s_waitcnt lgkmcnt(3)
    v_smfmac_f32_16x16x64_bf16 v[36:39], v[52:55], v[76:83], v4
    ds_read_b128 v[76:79], v6 offset:8192
    ds_read_b128 v[80:83], v6 offset:9216
    ds_read_b128 v[52:55], v5 offset:8192
    v_smfmac_f32_16x16x64_bf16 v[24:27], v[56:59], a[16:23], v4
    v_smfmac_f32_16x16x64_bf16 v[28:31], v[56:59], a[96:103], v4
    v_smfmac_f32_16x16x64_bf16 v[40:43], v[56:59], v[112:119], v4
    s_waitcnt lgkmcnt(4)
    v_smfmac_f32_16x16x64_bf16 v[36:39], v[56:59], v[68:75], v4
    ds_read_b128 v[68:71], v6 offset:10240
    ds_read_b128 v[72:75], v6 offset:11264
    ds_read_b128 v[56:59], v5 offset:9216
    v_smfmac_f32_16x16x64_bf16 v[24:27], v[60:63], a[32:39], v4
    v_smfmac_f32_16x16x64_bf16 v[28:31], v[60:63], a[112:119], v4
    v_smfmac_f32_16x16x64_bf16 v[40:43], v[60:63], v[128:135], v4
    s_waitcnt lgkmcnt(4)
    v_smfmac_f32_16x16x64_bf16 v[36:39], v[60:63], v[76:83], v4
    ds_read_b128 v[76:79], v6 offset:12288
    ds_read_b128 v[80:83], v6 offset:13312
    ds_read_b128 v[60:63], v5 offset:0
    v_smfmac_f32_16x16x64_bf16 v[24:27], v[64:67], a[40:47], v4
    v_smfmac_f32_16x16x64_bf16 v[28:31], v[64:67], a[120:127], v4
    v_smfmac_f32_16x16x64_bf16 v[40:43], v[64:67], v[136:143], v4
    s_waitcnt lgkmcnt(4)
    v_smfmac_f32_16x16x64_bf16 v[36:39], v[64:67], v[68:75], v4
    ds_read_b128 v[68:71], v6 offset:16384
    ds_read_b128 v[72:75], v6 offset:17408
    ds_read_b128 v[64:67], v5 offset:1024
    v_smfmac_f32_16x16x64_bf16 v[24:27], v[48:51], a[48:55], v4
    v_smfmac_f32_16x16x64_bf16 v[28:31], v[48:51], a[128:135], v4
    v_smfmac_f32_16x16x64_bf16 v[40:43], v[48:51], v[144:151], v4
    s_waitcnt lgkmcnt(4)
    v_smfmac_f32_16x16x64_bf16 v[36:39], v[48:51], v[76:83], v4
    ds_read_b128 v[76:79], v6 offset:18432
    ds_read_b128 v[80:83], v6 offset:19456
    ds_read_b128 v[48:51], v5 offset:2048
    v_smfmac_f32_16x16x64_bf16 v[24:27], v[52:55], a[64:71], v4
    v_smfmac_f32_16x16x64_bf16 v[28:31], v[52:55], a[144:151], v4
    v_smfmac_f32_16x16x64_bf16 v[40:43], v[52:55], v[160:167], v4
    s_waitcnt lgkmcnt(4)
    v_smfmac_f32_16x16x64_bf16 v[36:39], v[52:55], v[68:75], v4
    ds_read_b128 v[52:55], v5 offset:4096
    v_smfmac_f32_16x16x64_bf16 v[24:27], v[56:59], a[72:79], v4
    v_smfmac_f32_16x16x64_bf16 v[28:31], v[56:59], a[152:159], v4
    v_smfmac_f32_16x16x64_bf16 v[40:43], v[56:59], v[168:175], v4
    s_waitcnt lgkmcnt(2)
    v_smfmac_f32_16x16x64_bf16 v[36:39], v[56:59], v[76:83], v4
    ds_read_b128 v[56:59], v5 offset:5120
    buffer_load_dwordx4 v[80:83], v19, s[8:11], s45 offen offset:0 sc1
    buffer_load_dwordx4 v[84:87], v19, s[8:11], s45 offen offset:1024 sc1
    buffer_load_dwordx4 v[88:91], v19, s[8:11], s45 offen offset:2048 sc1
    v_smfmac_f32_16x16x64_bf16 v[32:35], v[60:63], a[160:167], v4
    v_smfmac_f32_16x16x64_bf16 v[44:47], v[60:63], v[176:183], v4
    v_permlane32_swap_b32 v28, v40
    v_permlane32_swap_b32 v29, v41
    ds_read_b128 v[60:63], v5 offset:6144
    v_smfmac_f32_16x16x64_bf16 v[32:35], v[64:67], a[168:175], v4
    v_permlane32_swap_b32 v30, v42
    v_permlane32_swap_b32 v31, v43
    v_smfmac_f32_16x16x64_bf16 v[44:47], v[64:67], v[184:191], v4
    v_add_f32 v28, v28, v40
    v_add_f32 v29, v29, v41
    ds_read_b128 v[64:67], v5 offset:8192
    s_waitcnt lgkmcnt(4)
    v_smfmac_f32_16x16x64_bf16 v[32:35], v[48:51], a[176:183], v4
    v_add_f32 v30, v30, v42
    v_add_f32 v31, v31, v43
    v_smfmac_f32_16x16x64_bf16 v[44:47], v[48:51], v[192:199], v4
    v_cvt_pk_bf16_f32 v40, v28, v29
    v_cvt_pk_bf16_f32 v41, v30, v31
    ds_read_b128 v[48:51], v5 offset:9216
    s_waitcnt lgkmcnt(4)
    v_smfmac_f32_16x16x64_bf16 v[32:35], v[52:55], a[192:199], v4
    v_mfma_f32_16x16x16_bf16 v[28:31], v[40:41], v[10:11], 0
    v_permlane32_swap_b32 v24, v36
    v_smfmac_f32_16x16x64_bf16 v[44:47], v[52:55], v[208:215], v4
    v_permlane32_swap_b32 v25, v37
    v_permlane32_swap_b32 v26, v38
    s_waitcnt lgkmcnt(3)
    v_smfmac_f32_16x16x64_bf16 v[32:35], v[56:59], a[200:207], v4
    v_permlane32_swap_b32 v27, v39
    v_add_f32 v24, v24, v36
    v_smfmac_f32_16x16x64_bf16 v[44:47], v[56:59], v[216:223], v4
    v_add_f32 v25, v25, v37
    v_add_f32 v26, v26, v38
    s_waitcnt lgkmcnt(2)
    v_smfmac_f32_16x16x64_bf16 v[32:35], v[60:63], a[208:215], v4
    v_add_f32 v27, v27, v39
    v_cvt_pk_bf16_f32 v36, v24, v25
    v_smfmac_f32_16x16x64_bf16 v[44:47], v[60:63], v[224:231], v4
    v_cvt_pk_bf16_f32 v37, v26, v27
    s_nop 1
    v_mfma_f32_16x16x16_bf16 v[24:27], v[36:37], v[10:11], 0
    s_waitcnt lgkmcnt(1)
    v_smfmac_f32_16x16x64_bf16 v[32:35], v[64:67], a[224:231], v4
    s_nop 5
    v_cvt_pk_bf16_f32 v24, v24, v25
    v_smfmac_f32_16x16x64_bf16 v[44:47], v[64:67], v[240:247], v4
    v_cvt_pk_bf16_f32 v25, v26, v27
    v_cvt_pk_bf16_f32 v26, v28, v29
    s_waitcnt lgkmcnt(0)
    v_smfmac_f32_16x16x64_bf16 v[32:35], v[48:51], a[232:239], v4
    v_cvt_pk_bf16_f32 v27, v30, v31
    s_waitcnt vmcnt(3)
    v_smfmac_f32_16x16x64_bf16 v[44:47], v[48:51], v[248:255], v4
    v_mfma_f32_16x16x32_bf16 v[28:31], a[240:243], v[24:27], 0
    v_mfma_f32_16x16x32_bf16 v[36:39], a[244:247], v[24:27], 0
    v_mfma_f32_16x16x32_bf16 v[40:43], v[24:27], v[24:27], 0
    s_nop 4
    v_permlane32_swap_b32 v32, v44
    v_permlane32_swap_b32 v33, v45
    v_permlane32_swap_b32 v34, v46
    v_permlane32_swap_b32 v35, v47
    v_add_f32 v32, v32, v44
    v_add_f32 v33, v33, v45
    v_add_f32 v34, v34, v46
    v_add_f32 v35, v35, v47
    v_cvt_pk_bf16_f32 v44, v32, v33
    v_cvt_pk_bf16_f32 v45, v34, v35
    s_nop 1
    v_mfma_f32_16x16x16_bf16 v[32:35], v[44:45], v[10:11], 0
    s_nop 7
    v_cvt_pk_bf16_f32 v32, v32, v33
    v_cvt_pk_bf16_f32 v33, v34, v35
    s_nop 1
    v_mfma_f32_16x16x16_bf16 v[28:31], a[248:249], v[32:33], v[28:31]
    v_mfma_f32_16x16x16_bf16 v[36:39], a[250:251], v[32:33], v[36:39]
    v_mfma_f32_16x16x16_bf16 v[40:43], v[32:33], v[32:33], v[40:43]
    s_nop 5
    ds_write_b128 v12, v[28:31]
    ds_write_b128 v12, v[36:39] offset:16
    ds_write_b128 v13, v[40:43]
    s_waitcnt lgkmcnt(0)
    s_barrier
    s_waitcnt vmcnt(0)
    v_mfma_f32_16x16x32_bf16 v[36:39], a[240:243], v[80:83], 0
    v_mfma_f32_16x16x32_bf16 v[44:47], a[244:247], v[80:83], 0
    v_mfma_f32_16x16x32_bf16 v[68:71], v[24:27], v[80:83], 0
    v_mfma_f32_16x16x32_bf16 v[40:43], a[240:243], v[84:87], 0
    v_mfma_f32_16x16x32_bf16 v[64:67], a[244:247], v[84:87], 0
    v_mfma_f32_16x16x32_bf16 v[72:75], v[24:27], v[84:87], 0
    s_nop 0
    v_mfma_f32_16x16x16_bf16 v[36:39], a[248:249], v[88:89], v[36:39]
    v_mfma_f32_16x16x16_bf16 v[44:47], a[250:251], v[88:89], v[44:47]
    v_mfma_f32_16x16x16_bf16 v[68:71], v[32:33], v[88:89], v[68:71]
    v_mfma_f32_16x16x16_bf16 v[40:43], a[248:249], v[90:91], v[40:43]
    v_mfma_f32_16x16x16_bf16 v[64:67], a[250:251], v[90:91], v[64:67]
    v_mfma_f32_16x16x16_bf16 v[72:75], v[32:33], v[90:91], v[72:75]
    s_nop 2
    ds_write_b128 v16, v[36:39] offset:0
    ds_write_b128 v16, v[44:47] offset:16
    ds_write_b128 v17, v[68:71]
    ds_write_b128 v16, v[40:43] offset:2816
    ds_write_b128 v16, v[64:67] offset:2832
    ds_write_b128 v18, v[72:75]
    s_add_u32 s40, s40, 1
    s_add_u32 s41, s41, 393216
    s_add_u32 s45, s45, 393216
    s_add_u32 s47, s37, 704512
    s_add_u32 s48, s37, 737280
    s_xor_b32 s42, s37, 0x2000
    s_lshl_b32 s24, s40, 12
    s_and_b32 s24, s24, 0x2000
    s_xor_b32 s24, s24, s36
    s_lshl_b32 s37, s40, 20
    s_add_u32 s37, s37, s24
    s_add_u32 s37, s37, 117440512
    s_add_u32 s43, s37, 655360
    s_add_u32 s49, s37, 753664
    s_waitcnt lgkmcnt(0)
    s_barrier
    s_cmp_lt_u32 s40, 64
    s_cbranch_scc1 interleave_layers__linear_attn_block__memory_aug_recurrent_mem_tr__prompt_kernel_s_stepw3
interleave_layers__linear_attn_block__memory_aug_recurrent_mem_tr__prompt_kernel_s_end:
    ds_read_b128 v[48:51], v21 offset:0
    ds_read_b128 v[52:55], v21 offset:16
    ds_read_b128 v[56:59], v21 offset:5632
    ds_read_b128 v[60:63], v21 offset:5648
    ds_read_b128 v[64:67], v21 offset:11264
    ds_read_b128 v[68:71], v21 offset:11280
    ds_read_b128 v[72:75], v21 offset:16896
    ds_read_b128 v[76:79], v21 offset:16912
    s_waitcnt lgkmcnt(4)
    v_pk_add_f32 v[48:49], v[48:49], v[56:57]
    v_pk_add_f32 v[50:51], v[50:51], v[58:59]
    v_pk_add_f32 v[52:53], v[52:53], v[60:61]
    v_pk_add_f32 v[54:55], v[54:55], v[62:63]
    s_waitcnt lgkmcnt(0)
    v_pk_add_f32 v[64:65], v[64:65], v[72:73]
    v_pk_add_f32 v[66:67], v[66:67], v[74:75]
    v_pk_add_f32 v[68:69], v[68:69], v[76:77]
    v_pk_add_f32 v[70:71], v[70:71], v[78:79]
    v_pk_add_f32 v[48:49], v[48:49], v[64:65]
    v_pk_add_f32 v[50:51], v[50:51], v[66:67]
    v_pk_add_f32 v[52:53], v[52:53], v[68:69]
    v_pk_add_f32 v[54:55], v[54:55], v[70:71]
    v_mov_b32 v81, 0xff800000
    v_cndmask_b32 v48, v81, v48, s[64:65]
    v_cndmask_b32 v49, v81, v49, s[66:67]
    v_cndmask_b32 v50, v81, v50, s[68:69]
    v_cndmask_b32 v51, v81, v51, s[70:71]
    v_cndmask_b32 v52, v81, v52, s[72:73]
    v_cndmask_b32 v53, v81, v53, s[74:75]
    v_cndmask_b32 v54, v81, v54, s[76:77]
    v_cndmask_b32 v55, v81, v55, s[78:79]
    v_max3_f32 v80, v48, v49, v50
    v_max3_f32 v80, v80, v51, v52
    v_max3_f32 v80, v80, v53, v54
    v_max_f32 v80, v80, v55
    v_mov_b32 v81, 0xff800000
    v_cndmask_b32 v80, v81, v80, s[50:51]
    s_nop 1
    v_max_f32 v80, v80, v80 quad_perm:[1,0,3,2] row_mask:0xf bank_mask:0xf
    s_nop 1
    v_max_f32 v80, v80, v80 quad_perm:[2,3,0,1] row_mask:0xf bank_mask:0xf
    s_nop 1
    v_max_f32 v80, v80, v80 row_half_mirror row_mask:0xf bank_mask:0xf
    s_mov_b32 s24, 0x3dd53b95
    v_mul_f32 v80, s24, v80
    v_fma_f32 v48, v48, s24, -v80
    v_fma_f32 v49, v49, s24, -v80
    v_fma_f32 v50, v50, s24, -v80
    v_fma_f32 v51, v51, s24, -v80
    v_fma_f32 v52, v52, s24, -v80
    v_fma_f32 v53, v53, s24, -v80
    v_fma_f32 v54, v54, s24, -v80
    v_fma_f32 v55, v55, s24, -v80
    v_exp_f32 v48, v48
    v_exp_f32 v49, v49
    v_exp_f32 v50, v50
    v_exp_f32 v51, v51
    v_exp_f32 v52, v52
    v_exp_f32 v53, v53
    v_exp_f32 v54, v54
    v_exp_f32 v55, v55
    v_add_f32 v80, v48, v49
    v_add_f32 v81, v50, v51
    v_add_f32 v80, v80, v52
    v_add_f32 v81, v81, v53
    v_add_f32 v80, v80, v54
    v_add_f32 v81, v81, v55
    v_add_f32 v80, v80, v81
    v_cndmask_b32 v80, 0, v80, s[50:51]
    s_nop 1
    v_add_f32 v80, v80, v80 quad_perm:[1,0,3,2] row_mask:0xf bank_mask:0xf
    s_nop 1
    v_add_f32 v80, v80, v80 quad_perm:[2,3,0,1] row_mask:0xf bank_mask:0xf
    s_nop 1
    v_add_f32 v80, v80, v80 row_half_mirror row_mask:0xf bank_mask:0xf
    v_rcp_f32 v80, v80
    s_nop 0
    v_mul_f32 v48, v48, v80
    v_mul_f32 v49, v49, v80
    v_mul_f32 v50, v50, v80
    v_mul_f32 v51, v51, v80
    v_mul_f32 v52, v52, v80
    v_mul_f32 v53, v53, v80
    v_mul_f32 v54, v54, v80
    v_mul_f32 v55, v55, v80
    v_cvt_pk_bf16_f32 v56, v48, v49
    v_cvt_pk_bf16_f32 v57, v50, v51
    v_cvt_pk_bf16_f32 v58, v52, v53
    v_cvt_pk_bf16_f32 v59, v54, v55
    v_min_u32 v56, -2, v56
    v_min_u32 v57, -2, v57
    v_min_u32 v58, -2, v58
    v_min_u32 v59, -2, v59
    buffer_store_dwordx4 v[56:59], v22, s[8:11], s42 offen sc1
    s_cmp_eq_u32 s92, 0
    s_cbranch_scc0 interleave_layers__linear_attn_block__memory_aug_recurrent_mem_tr__prompt_kernel_end
    s_mov_b32 s92, 1
    s_branch interleave_layers__linear_attn_block__memory_aug_recurrent_mem_tr__prompt_kernel_s_layer
interleave_layers__linear_attn_block__memory_aug_recurrent_mem_tr__prompt_kernel_roleV:
    s_sub_u32 s44, s2, 32
    s_load_dwordx2 s[6:7], s[0:1], 56
    s_load_dwordx2 s[24:25], s[0:1], 64
    s_load_dwordx2 s[26:27], s[0:1], 32
    s_waitcnt lgkmcnt(0)
    s_mov_b32 s12, s6
    s_mov_b32 s13, s7
    s_mov_b32 s14, 7864320
    s_mov_b32 s15, 0x00020000
    s_mov_b32 s16, s24
    s_mov_b32 s17, s25
    s_mov_b32 s18, 7864320
    s_mov_b32 s19, 0x00020000
    s_mov_b32 s20, s26
    s_mov_b32 s21, s27
    s_mov_b32 s22, 10240
    s_mov_b32 s23, 0x00020000
    v_add_u32 v16, 0, v0
    s_mov_b32 s24, 683
    v_mul_lo_u32 v17, v16, s24
    v_lshrrev_b32 v17, 14, v17
    v_mul_u32_u24 v18, 24, v17
    v_sub_u32 v18, v16, v18
    s_mov_b32 s24, 12288
    v_mul_lo_u32 v4, v17, s24
    v_lshl_add_u32 v4, v18, 4, v4
    v_mul_u32_u24 v10, 400, v17
    v_lshl_add_u32 v10, v18, 4, v10
    v_add_u32 v10, 90112, v10
    v_add_u32 v16, 256, v0
    s_mov_b32 s24, 683
    v_mul_lo_u32 v17, v16, s24
    v_lshrrev_b32 v17, 14, v17
    v_mul_u32_u24 v18, 24, v17
    v_sub_u32 v18, v16, v18
    s_mov_b32 s24, 12288
    v_mul_lo_u32 v5, v17, s24
    v_lshl_add_u32 v5, v18, 4, v5
    v_mul_u32_u24 v11, 400, v17
    v_lshl_add_u32 v11, v18, 4, v11
    v_add_u32 v11, 90112, v11
    v_add_u32 v16, 512, v0
    s_mov_b32 s24, 683
    v_mul_lo_u32 v17, v16, s24
    v_lshrrev_b32 v17, 14, v17
    v_mul_u32_u24 v18, 24, v17
    v_sub_u32 v18, v16, v18
    s_mov_b32 s24, 12288
    v_mul_lo_u32 v6, v17, s24
    v_lshl_add_u32 v6, v18, 4, v6
    v_mul_u32_u24 v12, 400, v17
    v_lshl_add_u32 v12, v18, 4, v12
    v_add_u32 v12, 90112, v12
    v_add_u32 v16, 768, v0
    s_mov_b32 s24, 683
    v_mul_lo_u32 v17, v16, s24
    v_lshrrev_b32 v17, 14, v17
    v_mul_u32_u24 v18, 24, v17
    v_sub_u32 v18, v16, v18
    s_mov_b32 s24, 12288
    v_mul_lo_u32 v7, v17, s24
    v_lshl_add_u32 v7, v18, 4, v7
    v_mul_u32_u24 v13, 400, v17
    v_lshl_add_u32 v13, v18, 4, v13
    v_add_u32 v13, 90112, v13
    v_add_u32 v16, 1024, v0
    s_mov_b32 s24, 683
    v_mul_lo_u32 v17, v16, s24
    v_lshrrev_b32 v17, 14, v17
    v_mul_u32_u24 v18, 24, v17
    v_sub_u32 v18, v16, v18
    s_mov_b32 s24, 12288
    v_mul_lo_u32 v8, v17, s24
    v_lshl_add_u32 v8, v18, 4, v8
    v_mul_u32_u24 v14, 400, v17
    v_lshl_add_u32 v14, v18, 4, v14
    v_add_u32 v14, 90112, v14
    v_add_u32 v16, 1280, v0
    s_mov_b32 s24, 683
    v_mul_lo_u32 v17, v16, s24
    v_lshrrev_b32 v17, 14, v17
    v_mul_u32_u24 v18, 24, v17
    v_sub_u32 v18, v16, v18
    s_mov_b32 s24, 12288
    v_mul_lo_u32 v9, v17, s24
    v_lshl_add_u32 v9, v18, 4, v9
    v_mul_u32_u24 v15, 400, v17
    v_lshl_add_u32 v15, v18, 4, v15
    v_add_u32 v15, 90112, v15
    v_lshrrev_b32 v17, 1, v3
    v_lshlrev_b32 v17, 4, v17
    v_and_b32 v18, 1, v3
    v_lshl_add_u32 v17, v18, 2, v17
    v_lshrrev_b32 v18, 2, v2
    v_and_b32 v19, 1, v18
    v_add_u32 v17, v17, v19
    v_lshrrev_b32 v18, 1, v18
    v_lshl_add_u32 v17, v18, 3, v17
    v_mul_u32_u24 v16, 400, v17
    v_and_b32 v18, 3, v2
    v_lshl_add_u32 v16, v18, 3, v16
    v_add_u32 v16, 90112, v16
    s_mul_i32 s24, s3, 96
    v_add_u32 v16, s24, v16
    s_mul_i32 s45, s44, 384
    s_add_u32 s46, s45, 0
    buffer_load_dwordx4 v[24:27], v4, s[12:15], s46 offen
    buffer_load_dwordx4 v[28:31], v5, s[12:15], s46 offen
    buffer_load_dwordx4 v[32:35], v6, s[12:15], s46 offen
    buffer_load_dwordx4 v[36:39], v7, s[12:15], s46 offen
    buffer_load_dwordx4 v[40:43], v8, s[12:15], s46 offen
    buffer_load_dwordx4 v[44:47], v9, s[12:15], s46 offen
    s_add_u32 s46, s45, 786432
    buffer_load_dwordx4 v[48:51], v4, s[12:15], s46 offen
    buffer_load_dwordx4 v[52:55], v5, s[12:15], s46 offen
    buffer_load_dwordx4 v[56:59], v6, s[12:15], s46 offen
    buffer_load_dwordx4 v[60:63], v7, s[12:15], s46 offen
    buffer_load_dwordx4 v[64:67], v8, s[12:15], s46 offen
    buffer_load_dwordx4 v[68:71], v9, s[12:15], s46 offen
    s_waitcnt vmcnt(6)
    ds_write_b128 v10, v[24:27]
    ds_write_b128 v11, v[28:31]
    ds_write_b128 v12, v[32:35]
    ds_write_b128 v13, v[36:39]
    ds_write_b128 v14, v[40:43]
    ds_write_b128 v15, v[44:47]
    s_add_u32 s46, s45, 1572864
    buffer_load_dwordx4 v[72:75], v4, s[12:15], s46 offen
    buffer_load_dwordx4 v[76:79], v5, s[12:15], s46 offen
    buffer_load_dwordx4 v[80:83], v6, s[12:15], s46 offen
    buffer_load_dwordx4 v[84:87], v7, s[12:15], s46 offen
    buffer_load_dwordx4 v[88:91], v8, s[12:15], s46 offen
    buffer_load_dwordx4 v[92:95], v9, s[12:15], s46 offen
    s_waitcnt lgkmcnt(0)
    s_barrier
    ds_read_b64_tr_b16 a[0:1], v16 offset:0
    ds_read_b64_tr_b16 a[2:3], v16 offset:800
    ds_read_b64_tr_b16 a[4:5], v16 offset:12800
    ds_read_b64_tr_b16 a[6:7], v16 offset:13600
    ds_read_b64_tr_b16 a[80:81], v16 offset:32
    ds_read_b64_tr_b16 a[82:83], v16 offset:832
    ds_read_b64_tr_b16 a[84:85], v16 offset:12832
    ds_read_b64_tr_b16 a[86:87], v16 offset:13632
    ds_read_b64_tr_b16 a[160:161], v16 offset:64
    ds_read_b64_tr_b16 a[162:163], v16 offset:864
    ds_read_b64_tr_b16 a[164:165], v16 offset:12864
    ds_read_b64_tr_b16 a[166:167], v16 offset:13664
    s_waitcnt lgkmcnt(0)
    s_barrier
    s_waitcnt vmcnt(6)
    ds_write_b128 v10, v[48:51]
    ds_write_b128 v11, v[52:55]
    ds_write_b128 v12, v[56:59]
    ds_write_b128 v13, v[60:63]
    ds_write_b128 v14, v[64:67]
    ds_write_b128 v15, v[68:71]
    s_add_u32 s46, s45, 2359296
    buffer_load_dwordx4 v[24:27], v4, s[12:15], s46 offen
    buffer_load_dwordx4 v[28:31], v5, s[12:15], s46 offen
    buffer_load_dwordx4 v[32:35], v6, s[12:15], s46 offen
    buffer_load_dwordx4 v[36:39], v7, s[12:15], s46 offen
    buffer_load_dwordx4 v[40:43], v8, s[12:15], s46 offen
    buffer_load_dwordx4 v[44:47], v9, s[12:15], s46 offen
    s_waitcnt lgkmcnt(0)
    s_barrier
    ds_read_b64_tr_b16 a[8:9], v16 offset:0
    ds_read_b64_tr_b16 a[10:11], v16 offset:800
    ds_read_b64_tr_b16 a[12:13], v16 offset:12800
    ds_read_b64_tr_b16 a[14:15], v16 offset:13600
    ds_read_b64_tr_b16 a[88:89], v16 offset:32
    ds_read_b64_tr_b16 a[90:91], v16 offset:832
    ds_read_b64_tr_b16 a[92:93], v16 offset:12832
    ds_read_b64_tr_b16 a[94:95], v16 offset:13632
    ds_read_b64_tr_b16 a[168:169], v16 offset:64
    ds_read_b64_tr_b16 a[170:171], v16 offset:864
    ds_read_b64_tr_b16 a[172:173], v16 offset:12864
    ds_read_b64_tr_b16 a[174:175], v16 offset:13664
    s_waitcnt lgkmcnt(0)
    s_barrier
    s_waitcnt vmcnt(6)
    ds_write_b128 v10, v[72:75]
    ds_write_b128 v11, v[76:79]
    ds_write_b128 v12, v[80:83]
    ds_write_b128 v13, v[84:87]
    ds_write_b128 v14, v[88:91]
    ds_write_b128 v15, v[92:95]
    s_add_u32 s46, s45, 3145728
    buffer_load_dwordx4 v[48:51], v4, s[12:15], s46 offen
    buffer_load_dwordx4 v[52:55], v5, s[12:15], s46 offen
    buffer_load_dwordx4 v[56:59], v6, s[12:15], s46 offen
    buffer_load_dwordx4 v[60:63], v7, s[12:15], s46 offen
    buffer_load_dwordx4 v[64:67], v8, s[12:15], s46 offen
    buffer_load_dwordx4 v[68:71], v9, s[12:15], s46 offen
    s_waitcnt lgkmcnt(0)
    s_barrier
    ds_read_b64_tr_b16 a[16:17], v16 offset:0
    ds_read_b64_tr_b16 a[18:19], v16 offset:800
    ds_read_b64_tr_b16 a[20:21], v16 offset:12800
    ds_read_b64_tr_b16 a[22:23], v16 offset:13600
    ds_read_b64_tr_b16 a[96:97], v16 offset:32
    ds_read_b64_tr_b16 a[98:99], v16 offset:832
    ds_read_b64_tr_b16 a[100:101], v16 offset:12832
    ds_read_b64_tr_b16 a[102:103], v16 offset:13632
    ds_read_b64_tr_b16 a[176:177], v16 offset:64
    ds_read_b64_tr_b16 a[178:179], v16 offset:864
    ds_read_b64_tr_b16 a[180:181], v16 offset:12864
    ds_read_b64_tr_b16 a[182:183], v16 offset:13664
    s_waitcnt lgkmcnt(0)
    s_barrier
    s_waitcnt vmcnt(6)
    ds_write_b128 v10, v[24:27]
    ds_write_b128 v11, v[28:31]
    ds_write_b128 v12, v[32:35]
    ds_write_b128 v13, v[36:39]
    ds_write_b128 v14, v[40:43]
    ds_write_b128 v15, v[44:47]
    s_add_u32 s46, s45, 3932160
    buffer_load_dwordx4 v[72:75], v4, s[12:15], s46 offen
    buffer_load_dwordx4 v[76:79], v5, s[12:15], s46 offen
    buffer_load_dwordx4 v[80:83], v6, s[12:15], s46 offen
    buffer_load_dwordx4 v[84:87], v7, s[12:15], s46 offen
    buffer_load_dwordx4 v[88:91], v8, s[12:15], s46 offen
    buffer_load_dwordx4 v[92:95], v9, s[12:15], s46 offen
    s_waitcnt lgkmcnt(0)
    s_barrier
    ds_read_b64_tr_b16 a[24:25], v16 offset:0
    ds_read_b64_tr_b16 a[26:27], v16 offset:800
    ds_read_b64_tr_b16 a[28:29], v16 offset:12800
    ds_read_b64_tr_b16 a[30:31], v16 offset:13600
    ds_read_b64_tr_b16 a[104:105], v16 offset:32
    ds_read_b64_tr_b16 a[106:107], v16 offset:832
    ds_read_b64_tr_b16 a[108:109], v16 offset:12832
    ds_read_b64_tr_b16 a[110:111], v16 offset:13632
    ds_read_b64_tr_b16 a[184:185], v16 offset:64
    ds_read_b64_tr_b16 a[186:187], v16 offset:864
    ds_read_b64_tr_b16 a[188:189], v16 offset:12864
    ds_read_b64_tr_b16 a[190:191], v16 offset:13664
    s_waitcnt lgkmcnt(0)
    s_barrier
    s_waitcnt vmcnt(6)
    ds_write_b128 v10, v[48:51]
    ds_write_b128 v11, v[52:55]
    ds_write_b128 v12, v[56:59]
    ds_write_b128 v13, v[60:63]
    ds_write_b128 v14, v[64:67]
    ds_write_b128 v15, v[68:71]
    s_add_u32 s46, s45, 4718592
    buffer_load_dwordx4 v[24:27], v4, s[12:15], s46 offen
    buffer_load_dwordx4 v[28:31], v5, s[12:15], s46 offen
    buffer_load_dwordx4 v[32:35], v6, s[12:15], s46 offen
    buffer_load_dwordx4 v[36:39], v7, s[12:15], s46 offen
    buffer_load_dwordx4 v[40:43], v8, s[12:15], s46 offen
    buffer_load_dwordx4 v[44:47], v9, s[12:15], s46 offen
    s_waitcnt lgkmcnt(0)
    s_barrier
    ds_read_b64_tr_b16 a[32:33], v16 offset:0
    ds_read_b64_tr_b16 a[34:35], v16 offset:800
    ds_read_b64_tr_b16 a[36:37], v16 offset:12800
    ds_read_b64_tr_b16 a[38:39], v16 offset:13600
    ds_read_b64_tr_b16 a[112:113], v16 offset:32
    ds_read_b64_tr_b16 a[114:115], v16 offset:832
    ds_read_b64_tr_b16 a[116:117], v16 offset:12832
    ds_read_b64_tr_b16 a[118:119], v16 offset:13632
    ds_read_b64_tr_b16 a[192:193], v16 offset:64
    ds_read_b64_tr_b16 a[194:195], v16 offset:864
    ds_read_b64_tr_b16 a[196:197], v16 offset:12864
    ds_read_b64_tr_b16 a[198:199], v16 offset:13664
    s_waitcnt lgkmcnt(0)
    s_barrier
    s_waitcnt vmcnt(6)
    ds_write_b128 v10, v[72:75]
    ds_write_b128 v11, v[76:79]
    ds_write_b128 v12, v[80:83]
    ds_write_b128 v13, v[84:87]
    ds_write_b128 v14, v[88:91]
    ds_write_b128 v15, v[92:95]
    s_add_u32 s46, s45, 5505024
    buffer_load_dwordx4 v[48:51], v4, s[12:15], s46 offen
    buffer_load_dwordx4 v[52:55], v5, s[12:15], s46 offen
    buffer_load_dwordx4 v[56:59], v6, s[12:15], s46 offen
    buffer_load_dwordx4 v[60:63], v7, s[12:15], s46 offen
    buffer_load_dwordx4 v[64:67], v8, s[12:15], s46 offen
    buffer_load_dwordx4 v[68:71], v9, s[12:15], s46 offen
    s_waitcnt lgkmcnt(0)
    s_barrier
    ds_read_b64_tr_b16 a[40:41], v16 offset:0
    ds_read_b64_tr_b16 a[42:43], v16 offset:800
    ds_read_b64_tr_b16 a[44:45], v16 offset:12800
    ds_read_b64_tr_b16 a[46:47], v16 offset:13600
    ds_read_b64_tr_b16 a[120:121], v16 offset:32
    ds_read_b64_tr_b16 a[122:123], v16 offset:832
    ds_read_b64_tr_b16 a[124:125], v16 offset:12832
    ds_read_b64_tr_b16 a[126:127], v16 offset:13632
    ds_read_b64_tr_b16 a[200:201], v16 offset:64
    ds_read_b64_tr_b16 a[202:203], v16 offset:864
    ds_read_b64_tr_b16 a[204:205], v16 offset:12864
    ds_read_b64_tr_b16 a[206:207], v16 offset:13664
    s_waitcnt lgkmcnt(0)
    s_barrier
    s_waitcnt vmcnt(6)
    ds_write_b128 v10, v[24:27]
    ds_write_b128 v11, v[28:31]
    ds_write_b128 v12, v[32:35]
    ds_write_b128 v13, v[36:39]
    ds_write_b128 v14, v[40:43]
    ds_write_b128 v15, v[44:47]
    s_add_u32 s46, s45, 6291456
    buffer_load_dwordx4 v[72:75], v4, s[12:15], s46 offen
    buffer_load_dwordx4 v[76:79], v5, s[12:15], s46 offen
    buffer_load_dwordx4 v[80:83], v6, s[12:15], s46 offen
    buffer_load_dwordx4 v[84:87], v7, s[12:15], s46 offen
    buffer_load_dwordx4 v[88:91], v8, s[12:15], s46 offen
    buffer_load_dwordx4 v[92:95], v9, s[12:15], s46 offen
    s_waitcnt lgkmcnt(0)
    s_barrier
    ds_read_b64_tr_b16 a[48:49], v16 offset:0
    ds_read_b64_tr_b16 a[50:51], v16 offset:800
    ds_read_b64_tr_b16 a[52:53], v16 offset:12800
    ds_read_b64_tr_b16 a[54:55], v16 offset:13600
    ds_read_b64_tr_b16 a[128:129], v16 offset:32
    ds_read_b64_tr_b16 a[130:131], v16 offset:832
    ds_read_b64_tr_b16 a[132:133], v16 offset:12832
    ds_read_b64_tr_b16 a[134:135], v16 offset:13632
    ds_read_b64_tr_b16 a[208:209], v16 offset:64
    ds_read_b64_tr_b16 a[210:211], v16 offset:864
    ds_read_b64_tr_b16 a[212:213], v16 offset:12864
    ds_read_b64_tr_b16 a[214:215], v16 offset:13664
    s_waitcnt lgkmcnt(0)
    s_barrier
    s_waitcnt vmcnt(6)
    ds_write_b128 v10, v[48:51]
    ds_write_b128 v11, v[52:55]
    ds_write_b128 v12, v[56:59]
    ds_write_b128 v13, v[60:63]
    ds_write_b128 v14, v[64:67]
    ds_write_b128 v15, v[68:71]
    s_add_u32 s46, s45, 7077888
    buffer_load_dwordx4 v[24:27], v4, s[12:15], s46 offen
    buffer_load_dwordx4 v[28:31], v5, s[12:15], s46 offen
    buffer_load_dwordx4 v[32:35], v6, s[12:15], s46 offen
    buffer_load_dwordx4 v[36:39], v7, s[12:15], s46 offen
    buffer_load_dwordx4 v[40:43], v8, s[12:15], s46 offen
    buffer_load_dwordx4 v[44:47], v9, s[12:15], s46 offen
    s_waitcnt lgkmcnt(0)
    s_barrier
    ds_read_b64_tr_b16 a[56:57], v16 offset:0
    ds_read_b64_tr_b16 a[58:59], v16 offset:800
    ds_read_b64_tr_b16 a[60:61], v16 offset:12800
    ds_read_b64_tr_b16 a[62:63], v16 offset:13600
    ds_read_b64_tr_b16 a[136:137], v16 offset:32
    ds_read_b64_tr_b16 a[138:139], v16 offset:832
    ds_read_b64_tr_b16 a[140:141], v16 offset:12832
    ds_read_b64_tr_b16 a[142:143], v16 offset:13632
    ds_read_b64_tr_b16 a[216:217], v16 offset:64
    ds_read_b64_tr_b16 a[218:219], v16 offset:864
    ds_read_b64_tr_b16 a[220:221], v16 offset:12864
    ds_read_b64_tr_b16 a[222:223], v16 offset:13664
    s_waitcnt lgkmcnt(0)
    s_barrier
    s_waitcnt vmcnt(6)
    ds_write_b128 v10, v[72:75]
    ds_write_b128 v11, v[76:79]
    ds_write_b128 v12, v[80:83]
    ds_write_b128 v13, v[84:87]
    ds_write_b128 v14, v[88:91]
    ds_write_b128 v15, v[92:95]
    s_waitcnt lgkmcnt(0)
    s_barrier
    ds_read_b64_tr_b16 a[64:65], v16 offset:0
    ds_read_b64_tr_b16 a[66:67], v16 offset:800
    ds_read_b64_tr_b16 a[68:69], v16 offset:12800
    ds_read_b64_tr_b16 a[70:71], v16 offset:13600
    ds_read_b64_tr_b16 a[144:145], v16 offset:32
    ds_read_b64_tr_b16 a[146:147], v16 offset:832
    ds_read_b64_tr_b16 a[148:149], v16 offset:12832
    ds_read_b64_tr_b16 a[150:151], v16 offset:13632
    ds_read_b64_tr_b16 a[224:225], v16 offset:64
    ds_read_b64_tr_b16 a[226:227], v16 offset:864
    ds_read_b64_tr_b16 a[228:229], v16 offset:12864
    ds_read_b64_tr_b16 a[230:231], v16 offset:13664
    s_waitcnt lgkmcnt(0)
    s_barrier
    s_waitcnt vmcnt(0)
    ds_write_b128 v10, v[24:27]
    ds_write_b128 v11, v[28:31]
    ds_write_b128 v12, v[32:35]
    ds_write_b128 v13, v[36:39]
    ds_write_b128 v14, v[40:43]
    ds_write_b128 v15, v[44:47]
    s_waitcnt lgkmcnt(0)
    s_barrier
    ds_read_b64_tr_b16 a[72:73], v16 offset:0
    ds_read_b64_tr_b16 a[74:75], v16 offset:800
    ds_read_b64_tr_b16 a[76:77], v16 offset:12800
    ds_read_b64_tr_b16 a[78:79], v16 offset:13600
    ds_read_b64_tr_b16 a[152:153], v16 offset:32
    ds_read_b64_tr_b16 a[154:155], v16 offset:832
    ds_read_b64_tr_b16 a[156:157], v16 offset:12832
    ds_read_b64_tr_b16 a[158:159], v16 offset:13632
    ds_read_b64_tr_b16 a[232:233], v16 offset:64
    ds_read_b64_tr_b16 a[234:235], v16 offset:864
    ds_read_b64_tr_b16 a[236:237], v16 offset:12864
    ds_read_b64_tr_b16 a[238:239], v16 offset:13664
    s_waitcnt lgkmcnt(0)
    s_barrier
    v_add_u32 v64, 0, v0
    s_mov_b32 s24, 1639
    v_mul_lo_u32 v65, v64, s24
    v_lshrrev_b32 v65, 16, v65
    v_mul_u32_u24 v66, 40, v65
    v_sub_u32 v66, v64, v66
    s_mov_b32 s24, 1280
    v_mul_lo_u32 v4, v65, s24
    v_lshl_add_u32 v4, v66, 4, v4
    v_mul_u32_u24 v14, 656, v65
    v_lshl_add_u32 v14, v66, 4, v14
    v_add_u32 v14, 90112, v14
    v_add_u32 v64, 256, v0
    s_mov_b32 s24, 1639
    v_mul_lo_u32 v65, v64, s24
    v_lshrrev_b32 v65, 16, v65
    v_mul_u32_u24 v66, 40, v65
    v_sub_u32 v66, v64, v66
    s_mov_b32 s24, 1280
    v_mul_lo_u32 v5, v65, s24
    v_lshl_add_u32 v5, v66, 4, v5
    v_mul_u32_u24 v15, 656, v65
    v_lshl_add_u32 v15, v66, 4, v15
    v_add_u32 v15, 90112, v15
    v_add_u32 v64, 512, v0
    s_mov_b32 s24, 1639
    v_mul_lo_u32 v65, v64, s24
    v_lshrrev_b32 v65, 16, v65
    v_mul_u32_u24 v66, 40, v65
    v_sub_u32 v66, v64, v66
    s_mov_b32 s24, 1280
    v_mul_lo_u32 v6, v65, s24
    v_lshl_add_u32 v6, v66, 4, v6
    v_mul_u32_u24 v16, 656, v65
    v_lshl_add_u32 v16, v66, 4, v16
    v_add_u32 v16, 90112, v16
    v_add_u32 v64, 768, v0
    s_mov_b32 s24, 1639
    v_mul_lo_u32 v65, v64, s24
    v_lshrrev_b32 v65, 16, v65
    v_mul_u32_u24 v66, 40, v65
    v_sub_u32 v66, v64, v66
    s_mov_b32 s24, 1280
    v_mul_lo_u32 v7, v65, s24
    v_lshl_add_u32 v7, v66, 4, v7
    v_mul_u32_u24 v17, 656, v65
    v_lshl_add_u32 v17, v66, 4, v17
    v_add_u32 v17, 90112, v17
    v_add_u32 v64, 1024, v0
    s_mov_b32 s24, 1639
    v_mul_lo_u32 v65, v64, s24
    v_lshrrev_b32 v65, 16, v65
    v_mul_u32_u24 v66, 40, v65
    v_sub_u32 v66, v64, v66
    s_mov_b32 s24, 1280
    v_mul_lo_u32 v8, v65, s24
    v_lshl_add_u32 v8, v66, 4, v8
    v_mul_u32_u24 v18, 656, v65
    v_lshl_add_u32 v18, v66, 4, v18
    v_add_u32 v18, 90112, v18
    v_add_u32 v64, 1280, v0
    s_mov_b32 s24, 1639
    v_mul_lo_u32 v65, v64, s24
    v_lshrrev_b32 v65, 16, v65
    v_mul_u32_u24 v66, 40, v65
    v_sub_u32 v66, v64, v66
    s_mov_b32 s24, 1280
    v_mul_lo_u32 v9, v65, s24
    v_lshl_add_u32 v9, v66, 4, v9
    v_mul_u32_u24 v19, 656, v65
    v_lshl_add_u32 v19, v66, 4, v19
    v_add_u32 v19, 90112, v19
    v_add_u32 v64, 1536, v0
    s_mov_b32 s24, 1639
    v_mul_lo_u32 v65, v64, s24
    v_lshrrev_b32 v65, 16, v65
    v_mul_u32_u24 v66, 40, v65
    v_sub_u32 v66, v64, v66
    s_mov_b32 s24, 1280
    v_mul_lo_u32 v10, v65, s24
    v_lshl_add_u32 v10, v66, 4, v10
    v_mul_u32_u24 v20, 656, v65
    v_lshl_add_u32 v20, v66, 4, v20
    v_add_u32 v20, 90112, v20
    v_add_u32 v64, 1792, v0
    s_mov_b32 s24, 1639
    v_mul_lo_u32 v65, v64, s24
    v_lshrrev_b32 v65, 16, v65
    v_mul_u32_u24 v66, 40, v65
    v_sub_u32 v66, v64, v66
    s_mov_b32 s24, 1280
    v_mul_lo_u32 v11, v65, s24
    v_lshl_add_u32 v11, v66, 4, v11
    v_mul_u32_u24 v21, 656, v65
    v_lshl_add_u32 v21, v66, 4, v21
    v_add_u32 v21, 90112, v21
    v_add_u32 v64, 2048, v0
    s_mov_b32 s24, 1639
    v_mul_lo_u32 v65, v64, s24
    v_lshrrev_b32 v65, 16, v65
    v_mul_u32_u24 v66, 40, v65
    v_sub_u32 v66, v64, v66
    s_mov_b32 s24, 1280
    v_mul_lo_u32 v12, v65, s24
    v_lshl_add_u32 v12, v66, 4, v12
    v_mul_u32_u24 v22, 656, v65
    v_lshl_add_u32 v22, v66, 4, v22
    v_add_u32 v22, 90112, v22
    v_add_u32 v64, 2304, v0
    s_mov_b32 s24, 1639
    v_mul_lo_u32 v65, v64, s24
    v_lshrrev_b32 v65, 16, v65
    v_mul_u32_u24 v66, 40, v65
    v_sub_u32 v66, v64, v66
    s_mov_b32 s24, 1280
    v_mul_lo_u32 v13, v65, s24
    v_lshl_add_u32 v13, v66, 4, v13
    v_mul_u32_u24 v23, 656, v65
    v_lshl_add_u32 v23, v66, 4, v23
    v_add_u32 v23, 90112, v23
    v_lshrrev_b32 v64, 1, v3
    v_lshlrev_b32 v64, 4, v64
    v_and_b32 v65, 1, v3
    v_lshl_add_u32 v64, v65, 2, v64
    v_lshrrev_b32 v65, 2, v2
    v_and_b32 v66, 1, v65
    v_add_u32 v64, v64, v66
    v_lshrrev_b32 v65, 1, v65
    v_lshl_add_u32 v64, v65, 3, v64
    v_mul_u32_u24 v72, 656, v64
    v_and_b32 v65, 3, v2
    v_lshl_add_u32 v72, v65, 3, v72
    v_add_u32 v72, 90112, v72
    s_and_b32 s24, s3, 1
    s_mul_i32 s24, s24, 320
    v_add_u32 v72, s24, v72
    v_lshlrev_b32 v73, 4, v1
    s_mul_i32 s24, s3, 18432
    s_add_u32 s24, s24, 16384
    v_add_u32 v73, s24, v73
    s_mul_i32 s45, s44, 245760
    s_add_u32 s46, s45, 0
    buffer_load_dwordx4 v[24:27], v4, s[16:19], s46 offen
    buffer_load_dwordx4 v[28:31], v5, s[16:19], s46 offen
    buffer_load_dwordx4 v[32:35], v6, s[16:19], s46 offen
    buffer_load_dwordx4 v[36:39], v7, s[16:19], s46 offen
    buffer_load_dwordx4 v[40:43], v8, s[16:19], s46 offen
    buffer_load_dwordx4 v[44:47], v9, s[16:19], s46 offen
    buffer_load_dwordx4 v[48:51], v10, s[16:19], s46 offen
    buffer_load_dwordx4 v[52:55], v11, s[16:19], s46 offen
    buffer_load_dwordx4 v[56:59], v12, s[16:19], s46 offen
    buffer_load_dwordx4 v[60:63], v13, s[16:19], s46 offen
    s_waitcnt vmcnt(0)
    ds_write_b128 v14, v[24:27]
    ds_write_b128 v15, v[28:31]
    ds_write_b128 v16, v[32:35]
    ds_write_b128 v17, v[36:39]
    ds_write_b128 v18, v[40:43]
    ds_write_b128 v19, v[44:47]
    ds_write_b128 v20, v[48:51]
    ds_write_b128 v21, v[52:55]
    ds_write_b128 v22, v[56:59]
    ds_write_b128 v23, v[60:63]
    s_waitcnt lgkmcnt(0)
    s_barrier
    s_lshr_b32 s24, s3, 1
    s_cmp_eq_u32 s24, 0
    s_cbranch_scc0 interleave_layers__linear_attn_block__memory_aug_recurrent_mem_tr__prompt_kernel_wo18
    ds_read_b64_tr_b16 a[240:241], v72 offset:0
    ds_read_b64_tr_b16 a[242:243], v72 offset:1312
    ds_read_b64_tr_b16 a[244:245], v72 offset:20992
    ds_read_b64_tr_b16 a[246:247], v72 offset:22304
    ds_read_b64_tr_b16 v[112:113], v72 offset:32
    ds_read_b64_tr_b16 v[114:115], v72 offset:1344
    ds_read_b64_tr_b16 v[116:117], v72 offset:21024
    ds_read_b64_tr_b16 v[118:119], v72 offset:22336
    ds_read_b64_tr_b16 v[136:137], v72 offset:64
    ds_read_b64_tr_b16 v[138:139], v72 offset:1376
    ds_read_b64_tr_b16 v[140:141], v72 offset:21056
    ds_read_b64_tr_b16 v[142:143], v72 offset:22368
    ds_read_b64_tr_b16 v[160:161], v72 offset:96
    ds_read_b64_tr_b16 v[162:163], v72 offset:1408
    ds_read_b64_tr_b16 v[164:165], v72 offset:21088
    ds_read_b64_tr_b16 v[166:167], v72 offset:22400
    ds_read_b64_tr_b16 v[184:185], v72 offset:128
    ds_read_b64_tr_b16 v[186:187], v72 offset:1440
    ds_read_b64_tr_b16 v[188:189], v72 offset:21120
    ds_read_b64_tr_b16 v[190:191], v72 offset:22432
    ds_read_b64_tr_b16 v[208:209], v72 offset:160
    ds_read_b64_tr_b16 v[210:211], v72 offset:1472
    ds_read_b64_tr_b16 v[212:213], v72 offset:21152
    ds_read_b64_tr_b16 v[214:215], v72 offset:22464
    ds_read_b64_tr_b16 v[232:233], v72 offset:192
    ds_read_b64_tr_b16 v[234:235], v72 offset:1504
    ds_read_b64_tr_b16 v[236:237], v72 offset:21184
    ds_read_b64_tr_b16 v[238:239], v72 offset:22496
    ds_read_b64_tr_b16 v[64:65], v72 offset:224
    ds_read_b64_tr_b16 v[66:67], v72 offset:1536
    ds_read_b64_tr_b16 v[68:69], v72 offset:21216
    ds_read_b64_tr_b16 v[70:71], v72 offset:22528
    s_waitcnt lgkmcnt(0)
    ds_write_b128 v73, v[64:67] offset:0
    ds_write_b128 v73, v[68:71] offset:1024
    s_waitcnt lgkmcnt(0)
    ds_read_b64_tr_b16 v[64:65], v72 offset:256
    ds_read_b64_tr_b16 v[66:67], v72 offset:1568
    ds_read_b64_tr_b16 v[68:69], v72 offset:21248
    ds_read_b64_tr_b16 v[70:71], v72 offset:22560
    s_waitcnt lgkmcnt(0)
    ds_write_b128 v73, v[64:67] offset:6144
    ds_write_b128 v73, v[68:71] offset:7168
    s_waitcnt lgkmcnt(0)
    ds_read_b64_tr_b16 v[64:65], v72 offset:288
    ds_read_b64_tr_b16 v[66:67], v72 offset:1600
    ds_read_b64_tr_b16 v[68:69], v72 offset:21280
    ds_read_b64_tr_b16 v[70:71], v72 offset:22592
    s_waitcnt lgkmcnt(0)
    ds_write_b128 v73, v[64:67] offset:12288
    ds_write_b128 v73, v[68:71] offset:13312
    s_waitcnt lgkmcnt(0)
    s_waitcnt lgkmcnt(0)
interleave_layers__linear_attn_block__memory_aug_recurrent_mem_tr__prompt_kernel_wo18:
    s_barrier
    s_add_u32 s46, s45, 640
    buffer_load_dwordx4 v[24:27], v4, s[16:19], s46 offen
    buffer_load_dwordx4 v[28:31], v5, s[16:19], s46 offen
    buffer_load_dwordx4 v[32:35], v6, s[16:19], s46 offen
    buffer_load_dwordx4 v[36:39], v7, s[16:19], s46 offen
    buffer_load_dwordx4 v[40:43], v8, s[16:19], s46 offen
    buffer_load_dwordx4 v[44:47], v9, s[16:19], s46 offen
    buffer_load_dwordx4 v[48:51], v10, s[16:19], s46 offen
    buffer_load_dwordx4 v[52:55], v11, s[16:19], s46 offen
    buffer_load_dwordx4 v[56:59], v12, s[16:19], s46 offen
    buffer_load_dwordx4 v[60:63], v13, s[16:19], s46 offen
    s_waitcnt vmcnt(0)
    ds_write_b128 v14, v[24:27]
    ds_write_b128 v15, v[28:31]
    ds_write_b128 v16, v[32:35]
    ds_write_b128 v17, v[36:39]
    ds_write_b128 v18, v[40:43]
    ds_write_b128 v19, v[44:47]
    ds_write_b128 v20, v[48:51]
    ds_write_b128 v21, v[52:55]
    ds_write_b128 v22, v[56:59]
    ds_write_b128 v23, v[60:63]
    s_waitcnt lgkmcnt(0)
    s_barrier
    s_lshr_b32 s24, s3, 1
    s_cmp_eq_u32 s24, 1
    s_cbranch_scc0 interleave_layers__linear_attn_block__memory_aug_recurrent_mem_tr__prompt_kernel_wo19
    ds_read_b64_tr_b16 a[240:241], v72 offset:0
    ds_read_b64_tr_b16 a[242:243], v72 offset:1312
    ds_read_b64_tr_b16 a[244:245], v72 offset:20992
    ds_read_b64_tr_b16 a[246:247], v72 offset:22304
    ds_read_b64_tr_b16 v[112:113], v72 offset:32
    ds_read_b64_tr_b16 v[114:115], v72 offset:1344
    ds_read_b64_tr_b16 v[116:117], v72 offset:21024
    ds_read_b64_tr_b16 v[118:119], v72 offset:22336
    ds_read_b64_tr_b16 v[136:137], v72 offset:64
    ds_read_b64_tr_b16 v[138:139], v72 offset:1376
    ds_read_b64_tr_b16 v[140:141], v72 offset:21056
    ds_read_b64_tr_b16 v[142:143], v72 offset:22368
    ds_read_b64_tr_b16 v[160:161], v72 offset:96
    ds_read_b64_tr_b16 v[162:163], v72 offset:1408
    ds_read_b64_tr_b16 v[164:165], v72 offset:21088
    ds_read_b64_tr_b16 v[166:167], v72 offset:22400
    ds_read_b64_tr_b16 v[184:185], v72 offset:128
    ds_read_b64_tr_b16 v[186:187], v72 offset:1440
    ds_read_b64_tr_b16 v[188:189], v72 offset:21120
    ds_read_b64_tr_b16 v[190:191], v72 offset:22432
    ds_read_b64_tr_b16 v[208:209], v72 offset:160
    ds_read_b64_tr_b16 v[210:211], v72 offset:1472
    ds_read_b64_tr_b16 v[212:213], v72 offset:21152
    ds_read_b64_tr_b16 v[214:215], v72 offset:22464
    ds_read_b64_tr_b16 v[232:233], v72 offset:192
    ds_read_b64_tr_b16 v[234:235], v72 offset:1504
    ds_read_b64_tr_b16 v[236:237], v72 offset:21184
    ds_read_b64_tr_b16 v[238:239], v72 offset:22496
    ds_read_b64_tr_b16 v[64:65], v72 offset:224
    ds_read_b64_tr_b16 v[66:67], v72 offset:1536
    ds_read_b64_tr_b16 v[68:69], v72 offset:21216
    ds_read_b64_tr_b16 v[70:71], v72 offset:22528
    s_waitcnt lgkmcnt(0)
    ds_write_b128 v73, v[64:67] offset:0
    ds_write_b128 v73, v[68:71] offset:1024
    s_waitcnt lgkmcnt(0)
    ds_read_b64_tr_b16 v[64:65], v72 offset:256
    ds_read_b64_tr_b16 v[66:67], v72 offset:1568
    ds_read_b64_tr_b16 v[68:69], v72 offset:21248
    ds_read_b64_tr_b16 v[70:71], v72 offset:22560
    s_waitcnt lgkmcnt(0)
    ds_write_b128 v73, v[64:67] offset:6144
    ds_write_b128 v73, v[68:71] offset:7168
    s_waitcnt lgkmcnt(0)
    ds_read_b64_tr_b16 v[64:65], v72 offset:288
    ds_read_b64_tr_b16 v[66:67], v72 offset:1600
    ds_read_b64_tr_b16 v[68:69], v72 offset:21280
    ds_read_b64_tr_b16 v[70:71], v72 offset:22592
    s_waitcnt lgkmcnt(0)
    ds_write_b128 v73, v[64:67] offset:12288
    ds_write_b128 v73, v[68:71] offset:13312
    s_waitcnt lgkmcnt(0)
    s_waitcnt lgkmcnt(0)
interleave_layers__linear_attn_block__memory_aug_recurrent_mem_tr__prompt_kernel_wo19:
    s_barrier
    s_add_u32 s46, s45, 81920
    buffer_load_dwordx4 v[24:27], v4, s[16:19], s46 offen
    buffer_load_dwordx4 v[28:31], v5, s[16:19], s46 offen
    buffer_load_dwordx4 v[32:35], v6, s[16:19], s46 offen
    buffer_load_dwordx4 v[36:39], v7, s[16:19], s46 offen
    buffer_load_dwordx4 v[40:43], v8, s[16:19], s46 offen
    buffer_load_dwordx4 v[44:47], v9, s[16:19], s46 offen
    buffer_load_dwordx4 v[48:51], v10, s[16:19], s46 offen
    buffer_load_dwordx4 v[52:55], v11, s[16:19], s46 offen
    buffer_load_dwordx4 v[56:59], v12, s[16:19], s46 offen
    buffer_load_dwordx4 v[60:63], v13, s[16:19], s46 offen
    s_waitcnt vmcnt(0)
    ds_write_b128 v14, v[24:27]
    ds_write_b128 v15, v[28:31]
    ds_write_b128 v16, v[32:35]
    ds_write_b128 v17, v[36:39]
    ds_write_b128 v18, v[40:43]
    ds_write_b128 v19, v[44:47]
    ds_write_b128 v20, v[48:51]
    ds_write_b128 v21, v[52:55]
    ds_write_b128 v22, v[56:59]
    ds_write_b128 v23, v[60:63]
    s_waitcnt lgkmcnt(0)
    s_barrier
    s_lshr_b32 s24, s3, 1
    s_cmp_eq_u32 s24, 0
    s_cbranch_scc0 interleave_layers__linear_attn_block__memory_aug_recurrent_mem_tr__prompt_kernel_wo20
    ds_read_b64_tr_b16 a[248:249], v72 offset:0
    ds_read_b64_tr_b16 a[250:251], v72 offset:1312
    ds_read_b64_tr_b16 a[252:253], v72 offset:20992
    ds_read_b64_tr_b16 a[254:255], v72 offset:22304
    ds_read_b64_tr_b16 v[120:121], v72 offset:32
    ds_read_b64_tr_b16 v[122:123], v72 offset:1344
    ds_read_b64_tr_b16 v[124:125], v72 offset:21024
    ds_read_b64_tr_b16 v[126:127], v72 offset:22336
    ds_read_b64_tr_b16 v[144:145], v72 offset:64
    ds_read_b64_tr_b16 v[146:147], v72 offset:1376
    ds_read_b64_tr_b16 v[148:149], v72 offset:21056
    ds_read_b64_tr_b16 v[150:151], v72 offset:22368
    ds_read_b64_tr_b16 v[168:169], v72 offset:96
    ds_read_b64_tr_b16 v[170:171], v72 offset:1408
    ds_read_b64_tr_b16 v[172:173], v72 offset:21088
    ds_read_b64_tr_b16 v[174:175], v72 offset:22400
    ds_read_b64_tr_b16 v[192:193], v72 offset:128
    ds_read_b64_tr_b16 v[194:195], v72 offset:1440
    ds_read_b64_tr_b16 v[196:197], v72 offset:21120
    ds_read_b64_tr_b16 v[198:199], v72 offset:22432
    ds_read_b64_tr_b16 v[216:217], v72 offset:160
    ds_read_b64_tr_b16 v[218:219], v72 offset:1472
    ds_read_b64_tr_b16 v[220:221], v72 offset:21152
    ds_read_b64_tr_b16 v[222:223], v72 offset:22464
    ds_read_b64_tr_b16 v[240:241], v72 offset:192
    ds_read_b64_tr_b16 v[242:243], v72 offset:1504
    ds_read_b64_tr_b16 v[244:245], v72 offset:21184
    ds_read_b64_tr_b16 v[246:247], v72 offset:22496
    ds_read_b64_tr_b16 v[64:65], v72 offset:224
    ds_read_b64_tr_b16 v[66:67], v72 offset:1536
    ds_read_b64_tr_b16 v[68:69], v72 offset:21216
    ds_read_b64_tr_b16 v[70:71], v72 offset:22528
    s_waitcnt lgkmcnt(0)
    ds_write_b128 v73, v[64:67] offset:2048
    ds_write_b128 v73, v[68:71] offset:3072
    s_waitcnt lgkmcnt(0)
    ds_read_b64_tr_b16 v[64:65], v72 offset:256
    ds_read_b64_tr_b16 v[66:67], v72 offset:1568
    ds_read_b64_tr_b16 v[68:69], v72 offset:21248
    ds_read_b64_tr_b16 v[70:71], v72 offset:22560
    s_waitcnt lgkmcnt(0)
    ds_write_b128 v73, v[64:67] offset:8192
    ds_write_b128 v73, v[68:71] offset:9216
    s_waitcnt lgkmcnt(0)
    ds_read_b64_tr_b16 v[64:65], v72 offset:288
    ds_read_b64_tr_b16 v[66:67], v72 offset:1600
    ds_read_b64_tr_b16 v[68:69], v72 offset:21280
    ds_read_b64_tr_b16 v[70:71], v72 offset:22592
    s_waitcnt lgkmcnt(0)
    ds_write_b128 v73, v[64:67] offset:14336
    ds_write_b128 v73, v[68:71] offset:15360
    s_waitcnt lgkmcnt(0)
    s_waitcnt lgkmcnt(0)
interleave_layers__linear_attn_block__memory_aug_recurrent_mem_tr__prompt_kernel_wo20:
    s_barrier
    s_add_u32 s46, s45, 82560
    buffer_load_dwordx4 v[24:27], v4, s[16:19], s46 offen
    buffer_load_dwordx4 v[28:31], v5, s[16:19], s46 offen
    buffer_load_dwordx4 v[32:35], v6, s[16:19], s46 offen
    buffer_load_dwordx4 v[36:39], v7, s[16:19], s46 offen
    buffer_load_dwordx4 v[40:43], v8, s[16:19], s46 offen
    buffer_load_dwordx4 v[44:47], v9, s[16:19], s46 offen
    buffer_load_dwordx4 v[48:51], v10, s[16:19], s46 offen
    buffer_load_dwordx4 v[52:55], v11, s[16:19], s46 offen
    buffer_load_dwordx4 v[56:59], v12, s[16:19], s46 offen
    buffer_load_dwordx4 v[60:63], v13, s[16:19], s46 offen
    s_waitcnt vmcnt(0)
    ds_write_b128 v14, v[24:27]
    ds_write_b128 v15, v[28:31]
    ds_write_b128 v16, v[32:35]
    ds_write_b128 v17, v[36:39]
    ds_write_b128 v18, v[40:43]
    ds_write_b128 v19, v[44:47]
    ds_write_b128 v20, v[48:51]
    ds_write_b128 v21, v[52:55]
    ds_write_b128 v22, v[56:59]
    ds_write_b128 v23, v[60:63]
    s_waitcnt lgkmcnt(0)
    s_barrier
    s_lshr_b32 s24, s3, 1
    s_cmp_eq_u32 s24, 1
    s_cbranch_scc0 interleave_layers__linear_attn_block__memory_aug_recurrent_mem_tr__prompt_kernel_wo21
    ds_read_b64_tr_b16 a[248:249], v72 offset:0
    ds_read_b64_tr_b16 a[250:251], v72 offset:1312
    ds_read_b64_tr_b16 a[252:253], v72 offset:20992
    ds_read_b64_tr_b16 a[254:255], v72 offset:22304
    ds_read_b64_tr_b16 v[120:121], v72 offset:32
    ds_read_b64_tr_b16 v[122:123], v72 offset:1344
    ds_read_b64_tr_b16 v[124:125], v72 offset:21024
    ds_read_b64_tr_b16 v[126:127], v72 offset:22336
    ds_read_b64_tr_b16 v[144:145], v72 offset:64
    ds_read_b64_tr_b16 v[146:147], v72 offset:1376
    ds_read_b64_tr_b16 v[148:149], v72 offset:21056
    ds_read_b64_tr_b16 v[150:151], v72 offset:22368
    ds_read_b64_tr_b16 v[168:169], v72 offset:96
    ds_read_b64_tr_b16 v[170:171], v72 offset:1408
    ds_read_b64_tr_b16 v[172:173], v72 offset:21088
    ds_read_b64_tr_b16 v[174:175], v72 offset:22400
    ds_read_b64_tr_b16 v[192:193], v72 offset:128
    ds_read_b64_tr_b16 v[194:195], v72 offset:1440
    ds_read_b64_tr_b16 v[196:197], v72 offset:21120
    ds_read_b64_tr_b16 v[198:199], v72 offset:22432
    ds_read_b64_tr_b16 v[216:217], v72 offset:160
    ds_read_b64_tr_b16 v[218:219], v72 offset:1472
    ds_read_b64_tr_b16 v[220:221], v72 offset:21152
    ds_read_b64_tr_b16 v[222:223], v72 offset:22464
    ds_read_b64_tr_b16 v[240:241], v72 offset:192
    ds_read_b64_tr_b16 v[242:243], v72 offset:1504
    ds_read_b64_tr_b16 v[244:245], v72 offset:21184
    ds_read_b64_tr_b16 v[246:247], v72 offset:22496
    ds_read_b64_tr_b16 v[64:65], v72 offset:224
    ds_read_b64_tr_b16 v[66:67], v72 offset:1536
    ds_read_b64_tr_b16 v[68:69], v72 offset:21216
    ds_read_b64_tr_b16 v[70:71], v72 offset:22528
    s_waitcnt lgkmcnt(0)
    ds_write_b128 v73, v[64:67] offset:2048
    ds_write_b128 v73, v[68:71] offset:3072
    s_waitcnt lgkmcnt(0)
    ds_read_b64_tr_b16 v[64:65], v72 offset:256
    ds_read_b64_tr_b16 v[66:67], v72 offset:1568
    ds_read_b64_tr_b16 v[68:69], v72 offset:21248
    ds_read_b64_tr_b16 v[70:71], v72 offset:22560
    s_waitcnt lgkmcnt(0)
    ds_write_b128 v73, v[64:67] offset:8192
    ds_write_b128 v73, v[68:71] offset:9216
    s_waitcnt lgkmcnt(0)
    ds_read_b64_tr_b16 v[64:65], v72 offset:288
    ds_read_b64_tr_b16 v[66:67], v72 offset:1600
    ds_read_b64_tr_b16 v[68:69], v72 offset:21280
    ds_read_b64_tr_b16 v[70:71], v72 offset:22592
    s_waitcnt lgkmcnt(0)
    ds_write_b128 v73, v[64:67] offset:14336
    ds_write_b128 v73, v[68:71] offset:15360
    s_waitcnt lgkmcnt(0)
    s_waitcnt lgkmcnt(0)
interleave_layers__linear_attn_block__memory_aug_recurrent_mem_tr__prompt_kernel_wo21:
    s_barrier
    s_add_u32 s46, s45, 163840
    buffer_load_dwordx4 v[24:27], v4, s[16:19], s46 offen
    buffer_load_dwordx4 v[28:31], v5, s[16:19], s46 offen
    buffer_load_dwordx4 v[32:35], v6, s[16:19], s46 offen
    buffer_load_dwordx4 v[36:39], v7, s[16:19], s46 offen
    buffer_load_dwordx4 v[40:43], v8, s[16:19], s46 offen
    buffer_load_dwordx4 v[44:47], v9, s[16:19], s46 offen
    buffer_load_dwordx4 v[48:51], v10, s[16:19], s46 offen
    buffer_load_dwordx4 v[52:55], v11, s[16:19], s46 offen
    buffer_load_dwordx4 v[56:59], v12, s[16:19], s46 offen
    buffer_load_dwordx4 v[60:63], v13, s[16:19], s46 offen
    s_waitcnt vmcnt(0)
    ds_write_b128 v14, v[24:27]
    ds_write_b128 v15, v[28:31]
    ds_write_b128 v16, v[32:35]
    ds_write_b128 v17, v[36:39]
    ds_write_b128 v18, v[40:43]
    ds_write_b128 v19, v[44:47]
    ds_write_b128 v20, v[48:51]
    ds_write_b128 v21, v[52:55]
    ds_write_b128 v22, v[56:59]
    ds_write_b128 v23, v[60:63]
    s_waitcnt lgkmcnt(0)
    s_barrier
    s_lshr_b32 s24, s3, 1
    s_cmp_eq_u32 s24, 0
    s_cbranch_scc0 interleave_layers__linear_attn_block__memory_aug_recurrent_mem_tr__prompt_kernel_wo22
    ds_read_b64_tr_b16 v[104:105], v72 offset:0
    ds_read_b64_tr_b16 v[106:107], v72 offset:1312
    ds_read_b64_tr_b16 v[108:109], v72 offset:20992
    ds_read_b64_tr_b16 v[110:111], v72 offset:22304
    ds_read_b64_tr_b16 v[128:129], v72 offset:32
    ds_read_b64_tr_b16 v[130:131], v72 offset:1344
    ds_read_b64_tr_b16 v[132:133], v72 offset:21024
    ds_read_b64_tr_b16 v[134:135], v72 offset:22336
    ds_read_b64_tr_b16 v[152:153], v72 offset:64
    ds_read_b64_tr_b16 v[154:155], v72 offset:1376
    ds_read_b64_tr_b16 v[156:157], v72 offset:21056
    ds_read_b64_tr_b16 v[158:159], v72 offset:22368
    ds_read_b64_tr_b16 v[176:177], v72 offset:96
    ds_read_b64_tr_b16 v[178:179], v72 offset:1408
    ds_read_b64_tr_b16 v[180:181], v72 offset:21088
    ds_read_b64_tr_b16 v[182:183], v72 offset:22400
    ds_read_b64_tr_b16 v[200:201], v72 offset:128
    ds_read_b64_tr_b16 v[202:203], v72 offset:1440
    ds_read_b64_tr_b16 v[204:205], v72 offset:21120
    ds_read_b64_tr_b16 v[206:207], v72 offset:22432
    ds_read_b64_tr_b16 v[224:225], v72 offset:160
    ds_read_b64_tr_b16 v[226:227], v72 offset:1472
    ds_read_b64_tr_b16 v[228:229], v72 offset:21152
    ds_read_b64_tr_b16 v[230:231], v72 offset:22464
    ds_read_b64_tr_b16 v[248:249], v72 offset:192
    ds_read_b64_tr_b16 v[250:251], v72 offset:1504
    ds_read_b64_tr_b16 v[252:253], v72 offset:21184
    ds_read_b64_tr_b16 v[254:255], v72 offset:22496
    ds_read_b64_tr_b16 v[64:65], v72 offset:224
    ds_read_b64_tr_b16 v[66:67], v72 offset:1536
    ds_read_b64_tr_b16 v[68:69], v72 offset:21216
    ds_read_b64_tr_b16 v[70:71], v72 offset:22528
    s_waitcnt lgkmcnt(0)
    ds_write_b128 v73, v[64:67] offset:4096
    ds_write_b128 v73, v[68:71] offset:5120
    s_waitcnt lgkmcnt(0)
    ds_read_b64_tr_b16 v[64:65], v72 offset:256
    ds_read_b64_tr_b16 v[66:67], v72 offset:1568
    ds_read_b64_tr_b16 v[68:69], v72 offset:21248
    ds_read_b64_tr_b16 v[70:71], v72 offset:22560
    s_waitcnt lgkmcnt(0)
    ds_write_b128 v73, v[64:67] offset:10240
    ds_write_b128 v73, v[68:71] offset:11264
    s_waitcnt lgkmcnt(0)
    ds_read_b64_tr_b16 v[64:65], v72 offset:288
    ds_read_b64_tr_b16 v[66:67], v72 offset:1600
    ds_read_b64_tr_b16 v[68:69], v72 offset:21280
    ds_read_b64_tr_b16 v[70:71], v72 offset:22592
    s_waitcnt lgkmcnt(0)
    ds_write_b128 v73, v[64:67] offset:16384
    ds_write_b128 v73, v[68:71] offset:17408
    s_waitcnt lgkmcnt(0)
    s_waitcnt lgkmcnt(0)
interleave_layers__linear_attn_block__memory_aug_recurrent_mem_tr__prompt_kernel_wo22:
    s_barrier
    s_add_u32 s46, s45, 164480
    buffer_load_dwordx4 v[24:27], v4, s[16:19], s46 offen
    buffer_load_dwordx4 v[28:31], v5, s[16:19], s46 offen
    buffer_load_dwordx4 v[32:35], v6, s[16:19], s46 offen
    buffer_load_dwordx4 v[36:39], v7, s[16:19], s46 offen
    buffer_load_dwordx4 v[40:43], v8, s[16:19], s46 offen
    buffer_load_dwordx4 v[44:47], v9, s[16:19], s46 offen
    buffer_load_dwordx4 v[48:51], v10, s[16:19], s46 offen
    buffer_load_dwordx4 v[52:55], v11, s[16:19], s46 offen
    buffer_load_dwordx4 v[56:59], v12, s[16:19], s46 offen
    buffer_load_dwordx4 v[60:63], v13, s[16:19], s46 offen
    s_waitcnt vmcnt(0)
    ds_write_b128 v14, v[24:27]
    ds_write_b128 v15, v[28:31]
    ds_write_b128 v16, v[32:35]
    ds_write_b128 v17, v[36:39]
    ds_write_b128 v18, v[40:43]
    ds_write_b128 v19, v[44:47]
    ds_write_b128 v20, v[48:51]
    ds_write_b128 v21, v[52:55]
    ds_write_b128 v22, v[56:59]
    ds_write_b128 v23, v[60:63]
    s_waitcnt lgkmcnt(0)
    s_barrier
    s_lshr_b32 s24, s3, 1
    s_cmp_eq_u32 s24, 1
    s_cbranch_scc0 interleave_layers__linear_attn_block__memory_aug_recurrent_mem_tr__prompt_kernel_wo23
    ds_read_b64_tr_b16 v[104:105], v72 offset:0
    ds_read_b64_tr_b16 v[106:107], v72 offset:1312
    ds_read_b64_tr_b16 v[108:109], v72 offset:20992
    ds_read_b64_tr_b16 v[110:111], v72 offset:22304
    ds_read_b64_tr_b16 v[128:129], v72 offset:32
    ds_read_b64_tr_b16 v[130:131], v72 offset:1344
    ds_read_b64_tr_b16 v[132:133], v72 offset:21024
    ds_read_b64_tr_b16 v[134:135], v72 offset:22336
    ds_read_b64_tr_b16 v[152:153], v72 offset:64
    ds_read_b64_tr_b16 v[154:155], v72 offset:1376
    ds_read_b64_tr_b16 v[156:157], v72 offset:21056
    ds_read_b64_tr_b16 v[158:159], v72 offset:22368
    ds_read_b64_tr_b16 v[176:177], v72 offset:96
    ds_read_b64_tr_b16 v[178:179], v72 offset:1408
    ds_read_b64_tr_b16 v[180:181], v72 offset:21088
    ds_read_b64_tr_b16 v[182:183], v72 offset:22400
    ds_read_b64_tr_b16 v[200:201], v72 offset:128
    ds_read_b64_tr_b16 v[202:203], v72 offset:1440
    ds_read_b64_tr_b16 v[204:205], v72 offset:21120
    ds_read_b64_tr_b16 v[206:207], v72 offset:22432
    ds_read_b64_tr_b16 v[224:225], v72 offset:160
    ds_read_b64_tr_b16 v[226:227], v72 offset:1472
    ds_read_b64_tr_b16 v[228:229], v72 offset:21152
    ds_read_b64_tr_b16 v[230:231], v72 offset:22464
    ds_read_b64_tr_b16 v[248:249], v72 offset:192
    ds_read_b64_tr_b16 v[250:251], v72 offset:1504
    ds_read_b64_tr_b16 v[252:253], v72 offset:21184
    ds_read_b64_tr_b16 v[254:255], v72 offset:22496
    ds_read_b64_tr_b16 v[64:65], v72 offset:224
    ds_read_b64_tr_b16 v[66:67], v72 offset:1536
    ds_read_b64_tr_b16 v[68:69], v72 offset:21216
    ds_read_b64_tr_b16 v[70:71], v72 offset:22528
    s_waitcnt lgkmcnt(0)
    ds_write_b128 v73, v[64:67] offset:4096
    ds_write_b128 v73, v[68:71] offset:5120
    s_waitcnt lgkmcnt(0)
    ds_read_b64_tr_b16 v[64:65], v72 offset:256
    ds_read_b64_tr_b16 v[66:67], v72 offset:1568
    ds_read_b64_tr_b16 v[68:69], v72 offset:21248
    ds_read_b64_tr_b16 v[70:71], v72 offset:22560
    s_waitcnt lgkmcnt(0)
    ds_write_b128 v73, v[64:67] offset:10240
    ds_write_b128 v73, v[68:71] offset:11264
    s_waitcnt lgkmcnt(0)
    ds_read_b64_tr_b16 v[64:65], v72 offset:288
    ds_read_b64_tr_b16 v[66:67], v72 offset:1600
    ds_read_b64_tr_b16 v[68:69], v72 offset:21280
    ds_read_b64_tr_b16 v[70:71], v72 offset:22592
    s_waitcnt lgkmcnt(0)
    ds_write_b128 v73, v[64:67] offset:16384
    ds_write_b128 v73, v[68:71] offset:17408
    s_waitcnt lgkmcnt(0)
    s_waitcnt lgkmcnt(0)
interleave_layers__linear_attn_block__memory_aug_recurrent_mem_tr__prompt_kernel_wo23:
    s_barrier
    v_mov_b32 v6, v73
    v_mov_b32 v4, 0x4444
    v_mov_b32 v5, 0xeeee
    v_cmp_gt_u32 vcc, 8, v2
    s_nop 1
    v_cndmask_b32 v4, v5, v4, vcc
    v_lshlrev_b32 v5, 4, v1
    s_lshl_b32 s24, s3, 10
    v_add_u32 v7, s24, v5
    s_lshl_b32 s24, s3, 9
    s_add_u32 s24, s24, 8192
    v_lshlrev_b32 v8, 3, v1
    v_add_u32 v8, s24, v8
    v_and_b32 v64, 7, v2
    v_lshlrev_b32 v9, 5, v64
    v_lshrrev_b32 v64, 3, v2
    v_lshl_add_u32 v9, v64, 4, v9
    v_and_b32 v64, 1, v3
    v_lshl_add_u32 v9, v64, 3, v9
    s_mul_i32 s24, s3, 768
    s_add_u32 s24, s24, 10240
    v_add_u32 v9, s24, v9
    v_lshrrev_b32 v65, 1, v3
    v_lshl_add_u32 v10, v65, 8, v9
    v_lshrrev_b32 v64, 2, v2
    v_lshlrev_b32 v11, 5, v64
    v_and_b32 v64, 3, v2
    v_lshl_add_u32 v11, v64, 3, v11
    v_lshl_add_u32 v11, v3, 8, v11
    v_add_u32 v11, 10240, v11
    s_mul_i32 s24, s3, 10
    s_lshl_b32 s24, s24, 14
    s_lshl_b32 s25, s44, 8
    s_add_u32 s24, s24, s25
    v_lshlrev_b32 v14, 14, v3
    v_lshl_add_u32 v14, v2, 4, v14
    v_add_u32 v14, s24, v14
    v_lshrrev_b32 v64, 1, v3
    v_lshlrev_b32 v15, 14, v64
    v_lshl_add_u32 v15, v2, 4, v15
    v_add_u32 v15, s24, v15
    v_add_u32 v15, 131072, v15
    v_and_b32 v64, 1, v3
    v_cmp_eq_u32 vcc, 0, v64
    v_mov_b32 v64, 2146435072
    s_nop 0
    v_cndmask_b32 v15, v64, v15, vcc
    s_and_b32 s24, s2, 15
    s_mul_i32 s25, s3, 16
    s_add_u32 s24, s24, s25
    s_lshl_b32 s24, s24, 7
    v_mov_b32 v12, s24
    v_mov_b32 v0, 1
interleave_layers__linear_attn_block__memory_aug_recurrent_mem_tr__prompt_kernel_v_layer:
    s_mov_b32 s93, 0
    s_lshl_b32 s24, s93, 12
    s_and_b32 s24, s24, 0x2000
    s_xor_b32 s24, s24, s36
    s_lshl_b32 s93, s93, 20
    s_add_u32 s93, s93, s24
    s_add_u32 s93, s93, 117440512
    s_mul_i32 s94, s92, 16384
    s_add_u32 s94, s94, 23068672
    s_lshl_b32 s24, s3, 6
    s_add_u32 s24, s24, 0
    v_add_u32 v64, s24, v1
    v_and_b32 v65, 7, v64
    v_mul_u32_u24 v65, 1280, v65
    v_lshrrev_b32 v66, 3, v64
    v_lshl_add_u32 v65, v66, 4, v65
    v_cmp_gt_u32 vcc, 640, v64
    v_mov_b32 v67, 2146435072
    s_nop 0
    v_cndmask_b32 v65, v67, v65, vcc
    buffer_load_dwordx4 v[68:71], v65, s[20:23], 0 offen
    v_lshlrev_b32 v64, 4, v64
    s_waitcnt vmcnt(0)
    s_and_saveexec_b64 s[30:31], vcc
    ds_write_b128 v64, v[68:71]
    s_mov_b64 exec, s[30:31]
    s_lshl_b32 s24, s3, 6
    s_add_u32 s24, s24, 256
    v_add_u32 v64, s24, v1
    v_and_b32 v65, 7, v64
    v_mul_u32_u24 v65, 1280, v65
    v_lshrrev_b32 v66, 3, v64
    v_lshl_add_u32 v65, v66, 4, v65
    v_cmp_gt_u32 vcc, 640, v64
    v_mov_b32 v67, 2146435072
    s_nop 0
    v_cndmask_b32 v65, v67, v65, vcc
    buffer_load_dwordx4 v[68:71], v65, s[20:23], 0 offen
    v_lshlrev_b32 v64, 4, v64
    s_waitcnt vmcnt(0)
    s_and_saveexec_b64 s[30:31], vcc
    ds_write_b128 v64, v[68:71]
    s_mov_b64 exec, s[30:31]
    s_lshl_b32 s24, s3, 6
    s_add_u32 s24, s24, 512
    v_add_u32 v64, s24, v1
    v_and_b32 v65, 7, v64
    v_mul_u32_u24 v65, 1280, v65
    v_lshrrev_b32 v66, 3, v64
    v_lshl_add_u32 v65, v66, 4, v65
    v_cmp_gt_u32 vcc, 640, v64
    v_mov_b32 v67, 2146435072
    s_nop 0
    v_cndmask_b32 v65, v67, v65, vcc
    buffer_load_dwordx4 v[68:71], v65, s[20:23], 0 offen
    v_lshlrev_b32 v64, 4, v64
    s_waitcnt vmcnt(0)
    s_and_saveexec_b64 s[30:31], vcc
    ds_write_b128 v64, v[68:71]
    s_mov_b64 exec, s[30:31]
    s_mov_b32 s40, 0
    s_mov_b32 s37, s93
    s_add_u32 s43, s93, 0
    s_lshl_b32 s95, s92, 6
    s_add_u32 s95, s95, s40
    s_add_u32 s95, s95, 1
    s_cmp_ge_i32 s59, s95
    s_cbranch_scc1 interleave_layers__linear_attn_block__memory_aug_recurrent_mem_tr__prompt_kernel_v_ec0_ok
    s_and_b32 s24, s2, 7
    s_lshl_b32 s24, s24, 7
    s_add_u32 s24, s24, 23109632
    v_and_b32 v65, 3, v1
    v_lshl_add_u32 v65, v65, 2, s24
    s_mov_b32 s61, 0
interleave_layers__linear_attn_block__memory_aug_recurrent_mem_tr__prompt_kernel_v_ec0:
    buffer_load_dword v64, v65, s[8:11], 0 offen sc1
    s_waitcnt vmcnt(0)
    v_readlane_b32 s59, v64, 0
    v_readlane_b32 s24, v64, 1
    s_min_i32 s59, s59, s24
    v_readlane_b32 s24, v64, 2
    s_min_i32 s59, s59, s24
    s_cmp_ge_i32 s59, s95
    s_cbranch_scc1 interleave_layers__linear_attn_block__memory_aug_recurrent_mem_tr__prompt_kernel_v_ec0_ok
    s_add_u32 s61, s61, 1
    s_cmp_ge_u32 s61, s60
    s_cbranch_scc1 interleave_layers__linear_attn_block__memory_aug_recurrent_mem_tr__prompt_kernel_v_ec0_to
    s_sleep 2
    s_branch interleave_layers__linear_attn_block__memory_aug_recurrent_mem_tr__prompt_kernel_v_ec0
interleave_layers__linear_attn_block__memory_aug_recurrent_mem_tr__prompt_kernel_v_ec0_to:
    s_mov_b32 s60, 1
interleave_layers__linear_attn_block__memory_aug_recurrent_mem_tr__prompt_kernel_v_ec0_ok:
    v_mov_b32 v16, 0
    v_mov_b32 v17, 0
    v_mov_b32 v18, 0
    v_mov_b32 v19, 0
    v_mov_b32 v20, 0
    v_mov_b32 v21, 0
    v_mov_b32 v22, 0
    v_mov_b32 v23, 0
    v_mov_b32 v24, 0
    v_mov_b32 v25, 0
    v_mov_b32 v26, 0
    v_mov_b32 v27, 0
    v_mov_b32 v28, 0
    v_mov_b32 v29, 0
    v_mov_b32 v30, 0
    v_mov_b32 v31, 0
    v_mov_b32 v32, 0
    v_mov_b32 v33, 0
    v_mov_b32 v34, 0
    v_mov_b32 v35, 0
    v_mov_b32 v36, 0
    v_mov_b32 v37, 0
    v_mov_b32 v38, 0
    v_mov_b32 v39, 0
    v_mov_b32 v40, 0
    v_mov_b32 v41, 0
    v_mov_b32 v42, 0
    v_mov_b32 v43, 0
    v_mov_b32 v44, 0
    v_mov_b32 v45, 0
    v_mov_b32 v46, 0
    v_mov_b32 v47, 0
    v_mov_b32 v48, 0
    v_mov_b32 v49, 0
    v_mov_b32 v50, 0
    v_mov_b32 v51, 0
    v_mov_b32 v52, 0
    v_mov_b32 v53, 0
    v_mov_b32 v54, 0
    v_mov_b32 v55, 0
    v_mov_b32 v56, 0
    v_mov_b32 v57, 0
    v_mov_b32 v58, 0
    v_mov_b32 v59, 0
    v_mov_b32 v60, 0
    v_mov_b32 v61, 0
    v_mov_b32 v62, 0
    v_mov_b32 v63, 0
    v_mov_b32 v64, 0
    v_mov_b32 v65, 0
    v_mov_b32 v66, 0
    v_mov_b32 v67, 0
    s_waitcnt lgkmcnt(0)
    s_barrier
    ds_read_b128 v[68:71], v7
    ds_read_b128 v[72:75], v7 offset:4096
    s_waitcnt lgkmcnt(0)
    s_cmp_eq_u32 s3, 0
    s_cbranch_scc1 interleave_layers__linear_attn_block__memory_aug_recurrent_mem_tr__prompt_kernel_v_gow0
    s_cmp_eq_u32 s3, 1
    s_cbranch_scc1 interleave_layers__linear_attn_block__memory_aug_recurrent_mem_tr__prompt_kernel_v_gow1
    s_cmp_eq_u32 s3, 2
    s_cbranch_scc1 interleave_layers__linear_attn_block__memory_aug_recurrent_mem_tr__prompt_kernel_v_gow2
    s_branch interleave_layers__linear_attn_block__memory_aug_recurrent_mem_tr__prompt_kernel_v_gow3
interleave_layers__linear_attn_block__memory_aug_recurrent_mem_tr__prompt_kernel_v_stepw0:
    v_mov_b32 v16, 0
    v_mov_b32 v17, 0
    v_mov_b32 v18, 0
    v_mov_b32 v19, 0
    v_mov_b32 v20, 0
    v_mov_b32 v21, 0
    v_mov_b32 v22, 0
    v_mov_b32 v23, 0
    v_mov_b32 v24, 0
    v_mov_b32 v25, 0
    v_mov_b32 v26, 0
    v_mov_b32 v27, 0
    v_mov_b32 v28, 0
    v_mov_b32 v29, 0
    v_mov_b32 v30, 0
    v_mov_b32 v31, 0
    v_mov_b32 v32, 0
    v_mov_b32 v33, 0
    v_mov_b32 v34, 0
    v_mov_b32 v35, 0
    v_mov_b32 v36, 0
    v_mov_b32 v37, 0
    v_mov_b32 v38, 0
    v_mov_b32 v39, 0
    v_mov_b32 v40, 0
    v_mov_b32 v41, 0
    v_mov_b32 v42, 0
    v_mov_b32 v43, 0
    v_mov_b32 v44, 0
    v_mov_b32 v45, 0
    v_mov_b32 v46, 0
    v_mov_b32 v47, 0
    v_mov_b32 v48, 0
    v_mov_b32 v49, 0
    v_mov_b32 v50, 0
    v_mov_b32 v51, 0
    v_mov_b32 v52, 0
    v_mov_b32 v53, 0
    v_mov_b32 v54, 0
    v_mov_b32 v55, 0
    v_mov_b32 v56, 0
    v_mov_b32 v57, 0
    v_mov_b32 v58, 0
    v_mov_b32 v59, 0
    v_mov_b32 v60, 0
    v_mov_b32 v61, 0
    v_mov_b32 v62, 0
    v_mov_b32 v63, 0
    v_mov_b32 v64, 0
    v_mov_b32 v65, 0
    v_mov_b32 v66, 0
    v_mov_b32 v67, 0
    s_add_u32 s48, s47, 4096
    s_add_u32 s50, s47, 8192
    s_lshl_b32 s95, s92, 6
    s_add_u32 s95, s95, s40
    s_add_u32 s95, s95, 1
    s_cmp_ge_i32 s59, s95
    s_cbranch_scc1 interleave_layers__linear_attn_block__memory_aug_recurrent_mem_tr__prompt_kernel_v_ecw0_ok
    s_and_b32 s24, s2, 7
    s_lshl_b32 s24, s24, 7
    s_add_u32 s24, s24, 23109632
    v_and_b32 v79, 3, v1
    v_lshl_add_u32 v79, v79, 2, s24
    s_mov_b32 s61, 0
interleave_layers__linear_attn_block__memory_aug_recurrent_mem_tr__prompt_kernel_v_ecw0:
    buffer_load_dword v78, v79, s[8:11], 0 offen sc1
    s_waitcnt vmcnt(0)
    v_readlane_b32 s59, v78, 0
    v_readlane_b32 s24, v78, 1
    s_min_i32 s59, s59, s24
    v_readlane_b32 s24, v78, 2
    s_min_i32 s59, s59, s24
    s_cmp_ge_i32 s59, s95
    s_cbranch_scc1 interleave_layers__linear_attn_block__memory_aug_recurrent_mem_tr__prompt_kernel_v_ecw0_ok
    s_add_u32 s61, s61, 1
    s_cmp_ge_u32 s61, s60
    s_cbranch_scc1 interleave_layers__linear_attn_block__memory_aug_recurrent_mem_tr__prompt_kernel_v_ecw0_to
    s_sleep 2
    s_branch interleave_layers__linear_attn_block__memory_aug_recurrent_mem_tr__prompt_kernel_v_ecw0
interleave_layers__linear_attn_block__memory_aug_recurrent_mem_tr__prompt_kernel_v_ecw0_to:
    s_mov_b32 s60, 1
interleave_layers__linear_attn_block__memory_aug_recurrent_mem_tr__prompt_kernel_v_ecw0_ok:
    s_sleep 20
    s_mov_b64 exec, 1
    s_mov_b32 s61, 0
    v_mov_b32 v81, 0
    buffer_atomic_add v81, v12, s[8:11], s45 offen sc0
    s_sleep 2
    v_mov_b32 v82, 0
    buffer_atomic_add v82, v12, s[8:11], s45 offen sc0
    s_sleep 2
    v_mov_b32 v83, 0
    buffer_atomic_add v83, v12, s[8:11], s45 offen sc0
    s_sleep 2
interleave_layers__linear_attn_block__memory_aug_recurrent_mem_tr__prompt_kernel_v_prw0:
    v_mov_b32 v80, 0
    buffer_atomic_add v80, v12, s[8:11], s45 offen sc0
    s_waitcnt vmcnt(3)
    v_cmp_le_i32 vcc, 9, v81
    s_add_u32 s61, s61, 1
    s_cbranch_vccnz interleave_layers__linear_attn_block__memory_aug_recurrent_mem_tr__prompt_kernel_v_prw0_out
    s_sleep 2
    v_mov_b32 v81, 0
    buffer_atomic_add v81, v12, s[8:11], s45 offen sc0
    s_waitcnt vmcnt(3)
    v_cmp_le_i32 vcc, 9, v82
    s_add_u32 s61, s61, 1
    s_cbranch_vccnz interleave_layers__linear_attn_block__memory_aug_recurrent_mem_tr__prompt_kernel_v_prw0_out
    s_sleep 2
    v_mov_b32 v82, 0
    buffer_atomic_add v82, v12, s[8:11], s45 offen sc0
    s_waitcnt vmcnt(3)
    v_cmp_le_i32 vcc, 9, v83
    s_add_u32 s61, s61, 1
    s_cbranch_vccnz interleave_layers__linear_attn_block__memory_aug_recurrent_mem_tr__prompt_kernel_v_prw0_out
    s_sleep 2
    v_mov_b32 v83, 0
    buffer_atomic_add v83, v12, s[8:11], s45 offen sc0
    s_waitcnt vmcnt(3)
    v_cmp_le_i32 vcc, 9, v80
    s_add_u32 s61, s61, 1
    s_cbranch_vccnz interleave_layers__linear_attn_block__memory_aug_recurrent_mem_tr__prompt_kernel_v_prw0_out
    s_sleep 2
    s_cmp_ge_u32 s61, s60
    s_cbranch_scc0 interleave_layers__linear_attn_block__memory_aug_recurrent_mem_tr__prompt_kernel_v_prw0
    s_mov_b32 s60, 1
interleave_layers__linear_attn_block__memory_aug_recurrent_mem_tr__prompt_kernel_v_prw0_out:
    s_mov_b64 exec, -1
    buffer_load_dwordx4 v[68:71], v7, s[8:11], s47 offen sc1
    buffer_load_dwordx4 v[72:75], v7, s[8:11], s48 offen sc1
    buffer_load_dwordx2 v[76:77], v8, s[8:11], s50 offen sc1
    s_waitcnt vmcnt(0)
    v_max3_u32 v103, v68, v69, v70
    v_max3_u32 v103, v103, v71, v72
    v_max3_u32 v103, v103, v73, v74
    v_max3_u32 v103, v103, v75, v76
    v_max_u32 v103, v103, v77
    v_cmp_eq_u32 vcc, -1, v103
    s_cbranch_vccz interleave_layers__linear_attn_block__memory_aug_recurrent_mem_tr__prompt_kernel_v_pmw0_out
    s_mov_b32 s61, 0
interleave_layers__linear_attn_block__memory_aug_recurrent_mem_tr__prompt_kernel_v_pmw0:
    buffer_load_dwordx4 v[68:71], v7, s[8:11], s47 offen sc1
    buffer_load_dwordx4 v[72:75], v7, s[8:11], s48 offen sc1
    buffer_load_dwordx2 v[76:77], v8, s[8:11], s50 offen sc1
    s_waitcnt vmcnt(0)
    v_max3_u32 v103, v68, v69, v70
    v_max3_u32 v103, v103, v71, v72
    v_max3_u32 v103, v103, v73, v74
    v_max3_u32 v103, v103, v75, v76
    v_max_u32 v103, v103, v77
    v_cmp_eq_u32 vcc, -1, v103
    s_add_u32 s61, s61, 1
    s_cbranch_vccz interleave_layers__linear_attn_block__memory_aug_recurrent_mem_tr__prompt_kernel_v_pmw0_out
    s_cmp_ge_u32 s61, s60
    s_cbranch_scc1 interleave_layers__linear_attn_block__memory_aug_recurrent_mem_tr__prompt_kernel_v_pmw0_to
    s_sleep 1
    s_branch interleave_layers__linear_attn_block__memory_aug_recurrent_mem_tr__prompt_kernel_v_pmw0
interleave_layers__linear_attn_block__memory_aug_recurrent_mem_tr__prompt_kernel_v_pmw0_to:
    s_mov_b32 s60, 1
interleave_layers__linear_attn_block__memory_aug_recurrent_mem_tr__prompt_kernel_v_pmw0_out:
    ds_write_b128 v7, v[68:71]
    ds_write_b128 v7, v[72:75] offset:4096
    ds_write_b64 v8, v[76:77]
interleave_layers__linear_attn_block__memory_aug_recurrent_mem_tr__prompt_kernel_v_gow0:
    v_smfmac_f32_16x16x64_bf16 v[56:59], v[68:71], a[0:7], v4
    v_smfmac_f32_16x16x64_bf16 v[60:63], v[68:71], a[80:87], v4
    v_smfmac_f32_16x16x64_bf16 v[64:67], v[68:71], a[160:167], v4
    s_waitcnt lgkmcnt(0)
    s_barrier
    ds_read_b128 v[80:83], v5 offset:1024
    ds_read_b128 v[84:87], v5 offset:2048
    ds_read_b128 v[88:91], v5 offset:3072
    ds_read_b128 v[92:95], v5 offset:5120
    ds_read_b128 v[96:99], v5 offset:6144
    ds_read_b128 v[100:103], v5 offset:7168
    ds_read_b128 v[76:79], v5 offset:8192
    ds_read_b128 v[68:71], v5 offset:9216
    v_smfmac_f32_16x16x64_bf16 v[64:67], v[72:75], a[192:199], v4
    v_smfmac_f32_16x16x64_bf16 v[56:59], v[72:75], a[32:39], v4
    v_smfmac_f32_16x16x64_bf16 v[60:63], v[72:75], a[112:119], v4
    s_waitcnt lgkmcnt(7)
    v_smfmac_f32_16x16x64_bf16 v[64:67], v[80:83], a[168:175], v4
    s_waitcnt lgkmcnt(6)
    v_smfmac_f32_16x16x64_bf16 v[64:67], v[84:87], a[176:183], v4
    s_waitcnt lgkmcnt(5)
    v_smfmac_f32_16x16x64_bf16 v[64:67], v[88:91], a[184:191], v4
    s_waitcnt lgkmcnt(4)
    v_smfmac_f32_16x16x64_bf16 v[64:67], v[92:95], a[200:207], v4
    s_waitcnt lgkmcnt(3)
    v_smfmac_f32_16x16x64_bf16 v[64:67], v[96:99], a[208:215], v4
    s_waitcnt lgkmcnt(2)
    v_smfmac_f32_16x16x64_bf16 v[64:67], v[100:103], a[216:223], v4
    s_waitcnt lgkmcnt(1)
    v_smfmac_f32_16x16x64_bf16 v[64:67], v[76:79], a[224:231], v4
    s_waitcnt lgkmcnt(0)
    v_smfmac_f32_16x16x64_bf16 v[64:67], v[68:71], a[232:239], v4
    v_smfmac_f32_16x16x64_bf16 v[56:59], v[80:83], a[8:15], v4
    v_smfmac_f32_16x16x64_bf16 v[60:63], v[80:83], a[88:95], v4
    v_smfmac_f32_16x16x64_bf16 v[56:59], v[84:87], a[16:23], v4
    s_nop 4
    v_mov_b32 v72, v64
    v_smfmac_f32_16x16x64_bf16 v[60:63], v[84:87], a[96:103], v4
    v_mov_b32 v73, v65
    v_mov_b32 v74, v66
    v_smfmac_f32_16x16x64_bf16 v[56:59], v[88:91], a[24:31], v4
    v_mov_b32 v75, v67
    v_smfmac_f32_16x16x64_bf16 v[60:63], v[88:91], a[104:111], v4
    v_permlane32_swap_b32 v64, v72
    v_permlane32_swap_b32 v65, v73
    v_smfmac_f32_16x16x64_bf16 v[56:59], v[92:95], a[40:47], v4
    v_permlane32_swap_b32 v66, v74
    v_permlane32_swap_b32 v67, v75
    v_smfmac_f32_16x16x64_bf16 v[60:63], v[92:95], a[120:127], v4
    v_add_f32 v64, v64, v72
    v_add_f32 v65, v65, v73
    v_smfmac_f32_16x16x64_bf16 v[56:59], v[96:99], a[48:55], v4
    v_add_f32 v66, v66, v74
    v_add_f32 v67, v67, v75
    v_smfmac_f32_16x16x64_bf16 v[60:63], v[96:99], a[128:135], v4
    v_cvt_pk_bf16_f32 v72, v64, v65
    v_cvt_pk_bf16_f32 v73, v66, v67
    v_smfmac_f32_16x16x64_bf16 v[56:59], v[100:103], a[56:63], v4
    ds_write_b64 v9, v[72:73] offset:512
    v_smfmac_f32_16x16x64_bf16 v[60:63], v[100:103], a[136:143], v4
    v_smfmac_f32_16x16x64_bf16 v[56:59], v[76:79], a[64:71], v4
    v_smfmac_f32_16x16x64_bf16 v[60:63], v[76:79], a[144:151], v4
    v_smfmac_f32_16x16x64_bf16 v[56:59], v[68:71], a[72:79], v4
    v_smfmac_f32_16x16x64_bf16 v[60:63], v[68:71], a[152:159], v4
    s_nop 7
    v_permlane32_swap_b32 v56, v60
    v_permlane32_swap_b32 v57, v61
    v_permlane32_swap_b32 v58, v62
    v_permlane32_swap_b32 v59, v63
    v_add_f32 v56, v56, v60
    v_add_f32 v57, v57, v61
    v_add_f32 v58, v58, v62
    v_add_f32 v59, v59, v63
    v_cvt_pk_bf16_f32 v68, v56, v57
    v_cvt_pk_bf16_f32 v69, v58, v59
    ds_write_b64 v10, v[68:69]
    s_waitcnt lgkmcnt(0)
    s_barrier
    ds_read_b64_tr_b16 v[68:69], v11 offset:0
    ds_read_b64_tr_b16 v[70:71], v11 offset:128
    ds_read_b64_tr_b16 v[72:73], v11 offset:1024
    ds_read_b64_tr_b16 v[74:75], v11 offset:1152
    ds_read_b64_tr_b16 v[76:77], v11 offset:2048
    ds_read_b64_tr_b16 v[78:79], v11 offset:2176
    ds_read_b128 v[80:83], v6 offset:0
    ds_read_b128 v[84:87], v6 offset:1024
    ds_read_b128 v[88:91], v6 offset:2048
    ds_read_b128 v[92:95], v6 offset:3072
    ds_read_b128 v[96:99], v6 offset:4096
    ds_read_b128 v[100:103], v6 offset:5120
    s_waitcnt lgkmcnt(10)
    v_smfmac_f32_16x16x64_bf16 v[16:19], v[68:71], a[240:247], v4
    v_smfmac_f32_16x16x64_bf16 v[20:23], v[68:71], v[112:119], v4
    v_smfmac_f32_16x16x64_bf16 v[24:27], v[68:71], v[136:143], v4
    v_smfmac_f32_16x16x64_bf16 v[28:31], v[68:71], v[160:167], v4
    s_waitcnt lgkmcnt(8)
    v_smfmac_f32_16x16x64_bf16 v[16:19], v[72:75], a[248:255], v4
    v_smfmac_f32_16x16x64_bf16 v[20:23], v[72:75], v[120:127], v4
    v_smfmac_f32_16x16x64_bf16 v[24:27], v[72:75], v[144:151], v4
    v_smfmac_f32_16x16x64_bf16 v[28:31], v[72:75], v[168:175], v4
    s_waitcnt lgkmcnt(6)
    v_smfmac_f32_16x16x64_bf16 v[16:19], v[76:79], v[104:111], v4
    v_smfmac_f32_16x16x64_bf16 v[20:23], v[76:79], v[128:135], v4
    v_smfmac_f32_16x16x64_bf16 v[24:27], v[76:79], v[152:159], v4
    v_smfmac_f32_16x16x64_bf16 v[28:31], v[76:79], v[176:183], v4
    v_smfmac_f32_16x16x64_bf16 v[32:35], v[68:71], v[184:191], v4
    v_smfmac_f32_16x16x64_bf16 v[36:39], v[68:71], v[208:215], v4
    s_nop 4
    v_permlane32_swap_b32 v16, v24
    v_permlane32_swap_b32 v17, v25
    v_smfmac_f32_16x16x64_bf16 v[40:43], v[68:71], v[232:239], v4
    v_permlane32_swap_b32 v18, v26
    v_permlane32_swap_b32 v19, v27
    s_waitcnt lgkmcnt(4)
    v_smfmac_f32_16x16x64_bf16 v[44:47], v[68:71], v[80:87], v4
    v_add_f32 v16, v16, v24
    v_add_f32 v17, v17, v25
    ds_read_b128 v[80:83], v6 offset:6144
    ds_read_b128 v[84:87], v6 offset:7168
    v_smfmac_f32_16x16x64_bf16 v[32:35], v[72:75], v[192:199], v4
    v_add_f32 v18, v18, v26
    v_add_f32 v19, v19, v27
    v_smfmac_f32_16x16x64_bf16 v[36:39], v[72:75], v[216:223], v4
    v_permlane32_swap_b32 v20, v28
    v_permlane32_swap_b32 v21, v29
    v_smfmac_f32_16x16x64_bf16 v[40:43], v[72:75], v[240:247], v4
    v_permlane32_swap_b32 v22, v30
    v_permlane32_swap_b32 v23, v31
    s_waitcnt lgkmcnt(4)
    v_smfmac_f32_16x16x64_bf16 v[44:47], v[72:75], v[88:95], v4
    v_add_f32 v20, v20, v28
    v_add_f32 v21, v21, v29
    ds_read_b128 v[88:91], v6 offset:8192
    ds_read_b128 v[92:95], v6 offset:9216
    v_smfmac_f32_16x16x64_bf16 v[32:35], v[76:79], v[200:207], v4
    v_add_f32 v22, v22, v30
    v_add_f32 v23, v23, v31
    v_smfmac_f32_16x16x64_bf16 v[36:39], v[76:79], v[224:231], v4
    v_cvt_pk_bf16_f32 v56, v16, v17
    v_cvt_pk_bf16_f32 v57, v18, v19
    v_smfmac_f32_16x16x64_bf16 v[40:43], v[76:79], v[248:255], v4
    v_cvt_pk_bf16_f32 v58, v20, v21
    v_cvt_pk_bf16_f32 v59, v22, v23
    s_waitcnt lgkmcnt(4)
    v_smfmac_f32_16x16x64_bf16 v[44:47], v[76:79], v[96:103], v4
    v_permlane16_swap_b32 v56, v58
    ds_read_b128 v[96:99], v6 offset:10240
    ds_read_b128 v[100:103], v6 offset:11264
    v_permlane16_swap_b32 v57, v59
    v_min_u32 v56, -2, v56
    v_min_u32 v57, -2, v57
    v_min_u32 v58, -2, v58
    v_min_u32 v59, -2, v59
    buffer_store_dwordx4 v[56:59], v14, s[8:11], s43 offen sc1
    s_add_u32 s49, s43, 65536
    s_waitcnt lgkmcnt(4)
    v_smfmac_f32_16x16x64_bf16 v[48:51], v[68:71], v[80:87], v4
    v_permlane32_swap_b32 v32, v40
    v_permlane32_swap_b32 v33, v41
    v_permlane32_swap_b32 v34, v42
    ds_read_b128 v[80:83], v6 offset:12288
    ds_read_b128 v[84:87], v6 offset:13312
    s_waitcnt lgkmcnt(4)
    v_smfmac_f32_16x16x64_bf16 v[48:51], v[72:75], v[88:95], v4
    v_permlane32_swap_b32 v35, v43
    v_add_f32 v32, v32, v40
    v_add_f32 v33, v33, v41
    v_add_f32 v34, v34, v42
    ds_read_b128 v[88:91], v6 offset:14336
    ds_read_b128 v[92:95], v6 offset:15360
    s_waitcnt lgkmcnt(4)
    v_smfmac_f32_16x16x64_bf16 v[48:51], v[76:79], v[96:103], v4
    v_add_f32 v35, v35, v43
    v_permlane32_swap_b32 v36, v44
    v_permlane32_swap_b32 v37, v45
    v_permlane32_swap_b32 v38, v46
    ds_read_b128 v[96:99], v6 offset:16384
    ds_read_b128 v[100:103], v6 offset:17408
    v_permlane32_swap_b32 v39, v47
    v_add_f32 v36, v36, v44
    v_add_f32 v37, v37, v45
    v_add_f32 v38, v38, v46
    s_waitcnt lgkmcnt(4)
    v_smfmac_f32_16x16x64_bf16 v[52:55], v[68:71], v[80:87], v4
    v_add_f32 v39, v39, v47
    v_cvt_pk_bf16_f32 v60, v32, v33
    v_cvt_pk_bf16_f32 v61, v34, v35
    s_waitcnt lgkmcnt(2)
    v_smfmac_f32_16x16x64_bf16 v[52:55], v[72:75], v[88:95], v4
    v_cvt_pk_bf16_f32 v62, v36, v37
    v_cvt_pk_bf16_f32 v63, v38, v39
    s_waitcnt lgkmcnt(0)
    v_smfmac_f32_16x16x64_bf16 v[52:55], v[76:79], v[96:103], v4
    v_permlane16_swap_b32 v60, v62
    v_permlane16_swap_b32 v61, v63
    v_min_u32 v60, -2, v60
    v_min_u32 v61, -2, v61
    v_min_u32 v62, -2, v62
    v_min_u32 v63, -2, v63
    buffer_store_dwordx4 v[60:63], v14, s[8:11], s49 offen sc1
    s_nop 0
    v_permlane32_swap_b32 v48, v52
    v_permlane32_swap_b32 v49, v53
    v_permlane32_swap_b32 v50, v54
    v_permlane32_swap_b32 v51, v55
    v_add_f32 v48, v48, v52
    v_add_f32 v49, v49, v53
    v_add_f32 v50, v50, v54
    v_add_f32 v51, v51, v55
    v_cvt_pk_bf16_f32 v64, v48, v49
    v_cvt_pk_bf16_f32 v65, v50, v51
    v_mov_b32 v66, v64
    v_mov_b32 v67, v65
    s_nop 0
    v_permlane16_swap_b32 v64, v66
    v_permlane16_swap_b32 v65, v67
    v_min_u32 v64, -2, v64
    v_min_u32 v65, -2, v65
    v_min_u32 v66, -2, v66
    v_min_u32 v67, -2, v67
    buffer_store_dwordx4 v[64:67], v15, s[8:11], s43 offen sc1
    s_add_u32 s40, s40, 1
    s_add_u32 s47, s37, 704512
    s_add_u32 s45, s37, 737280
    s_lshl_b32 s24, s40, 12
    s_and_b32 s24, s24, 0x2000
    s_xor_b32 s24, s24, s36
    s_lshl_b32 s37, s40, 20
    s_add_u32 s37, s37, s24
    s_add_u32 s37, s37, 117440512
    s_add_u32 s43, s37, 0
    s_cmp_lt_u32 s40, 64
    s_cbranch_scc1 interleave_layers__linear_attn_block__memory_aug_recurrent_mem_tr__prompt_kernel_v_stepw0
    s_branch interleave_layers__linear_attn_block__memory_aug_recurrent_mem_tr__prompt_kernel_v_end
interleave_layers__linear_attn_block__memory_aug_recurrent_mem_tr__prompt_kernel_v_stepw1:
    v_mov_b32 v16, 0
    v_mov_b32 v17, 0
    v_mov_b32 v18, 0
    v_mov_b32 v19, 0
    v_mov_b32 v20, 0
    v_mov_b32 v21, 0
    v_mov_b32 v22, 0
    v_mov_b32 v23, 0
    v_mov_b32 v24, 0
    v_mov_b32 v25, 0
    v_mov_b32 v26, 0
    v_mov_b32 v27, 0
    v_mov_b32 v28, 0
    v_mov_b32 v29, 0
    v_mov_b32 v30, 0
    v_mov_b32 v31, 0
    v_mov_b32 v32, 0
    v_mov_b32 v33, 0
    v_mov_b32 v34, 0
    v_mov_b32 v35, 0
    v_mov_b32 v36, 0
    v_mov_b32 v37, 0
    v_mov_b32 v38, 0
    v_mov_b32 v39, 0
    v_mov_b32 v40, 0
    v_mov_b32 v41, 0
    v_mov_b32 v42, 0
    v_mov_b32 v43, 0
    v_mov_b32 v44, 0
    v_mov_b32 v45, 0
    v_mov_b32 v46, 0
    v_mov_b32 v47, 0
    v_mov_b32 v48, 0
    v_mov_b32 v49, 0
    v_mov_b32 v50, 0
    v_mov_b32 v51, 0
    v_mov_b32 v52, 0
    v_mov_b32 v53, 0
    v_mov_b32 v54, 0
    v_mov_b32 v55, 0
    v_mov_b32 v56, 0
    v_mov_b32 v57, 0
    v_mov_b32 v58, 0
    v_mov_b32 v59, 0
    v_mov_b32 v60, 0
    v_mov_b32 v61, 0
    v_mov_b32 v62, 0
    v_mov_b32 v63, 0
    v_mov_b32 v64, 0
    v_mov_b32 v65, 0
    v_mov_b32 v66, 0
    v_mov_b32 v67, 0
    s_add_u32 s48, s47, 4096
    s_add_u32 s50, s47, 8192
    s_lshl_b32 s95, s92, 6
    s_add_u32 s95, s95, s40
    s_add_u32 s95, s95, 1
    s_cmp_ge_i32 s59, s95
    s_cbranch_scc1 interleave_layers__linear_attn_block__memory_aug_recurrent_mem_tr__prompt_kernel_v_ecw1_ok
    s_and_b32 s24, s2, 7
    s_lshl_b32 s24, s24, 7
    s_add_u32 s24, s24, 23109632
    v_and_b32 v79, 3, v1
    v_lshl_add_u32 v79, v79, 2, s24
    s_mov_b32 s61, 0
interleave_layers__linear_attn_block__memory_aug_recurrent_mem_tr__prompt_kernel_v_ecw1:
    buffer_load_dword v78, v79, s[8:11], 0 offen sc1
    s_waitcnt vmcnt(0)
    v_readlane_b32 s59, v78, 0
    v_readlane_b32 s24, v78, 1
    s_min_i32 s59, s59, s24
    v_readlane_b32 s24, v78, 2
    s_min_i32 s59, s59, s24
    s_cmp_ge_i32 s59, s95
    s_cbranch_scc1 interleave_layers__linear_attn_block__memory_aug_recurrent_mem_tr__prompt_kernel_v_ecw1_ok
    s_add_u32 s61, s61, 1
    s_cmp_ge_u32 s61, s60
    s_cbranch_scc1 interleave_layers__linear_attn_block__memory_aug_recurrent_mem_tr__prompt_kernel_v_ecw1_to
    s_sleep 2
    s_branch interleave_layers__linear_attn_block__memory_aug_recurrent_mem_tr__prompt_kernel_v_ecw1
interleave_layers__linear_attn_block__memory_aug_recurrent_mem_tr__prompt_kernel_v_ecw1_to:
    s_mov_b32 s60, 1
interleave_layers__linear_attn_block__memory_aug_recurrent_mem_tr__prompt_kernel_v_ecw1_ok:
    s_sleep 20
    s_mov_b64 exec, 1
    s_mov_b32 s61, 0
    v_mov_b32 v81, 0
    buffer_atomic_add v81, v12, s[8:11], s45 offen sc0
    s_sleep 2
    v_mov_b32 v82, 0
    buffer_atomic_add v82, v12, s[8:11], s45 offen sc0
    s_sleep 2
    v_mov_b32 v83, 0
    buffer_atomic_add v83, v12, s[8:11], s45 offen sc0
    s_sleep 2
interleave_layers__linear_attn_block__memory_aug_recurrent_mem_tr__prompt_kernel_v_prw1:
    v_mov_b32 v80, 0
    buffer_atomic_add v80, v12, s[8:11], s45 offen sc0
    s_waitcnt vmcnt(3)
    v_cmp_le_i32 vcc, 9, v81
    s_add_u32 s61, s61, 1
    s_cbranch_vccnz interleave_layers__linear_attn_block__memory_aug_recurrent_mem_tr__prompt_kernel_v_prw1_out
    s_sleep 2
    v_mov_b32 v81, 0
    buffer_atomic_add v81, v12, s[8:11], s45 offen sc0
    s_waitcnt vmcnt(3)
    v_cmp_le_i32 vcc, 9, v82
    s_add_u32 s61, s61, 1
    s_cbranch_vccnz interleave_layers__linear_attn_block__memory_aug_recurrent_mem_tr__prompt_kernel_v_prw1_out
    s_sleep 2
    v_mov_b32 v82, 0
    buffer_atomic_add v82, v12, s[8:11], s45 offen sc0
    s_waitcnt vmcnt(3)
    v_cmp_le_i32 vcc, 9, v83
    s_add_u32 s61, s61, 1
    s_cbranch_vccnz interleave_layers__linear_attn_block__memory_aug_recurrent_mem_tr__prompt_kernel_v_prw1_out
    s_sleep 2
    v_mov_b32 v83, 0
    buffer_atomic_add v83, v12, s[8:11], s45 offen sc0
    s_waitcnt vmcnt(3)
    v_cmp_le_i32 vcc, 9, v80
    s_add_u32 s61, s61, 1
    s_cbranch_vccnz interleave_layers__linear_attn_block__memory_aug_recurrent_mem_tr__prompt_kernel_v_prw1_out
    s_sleep 2
    s_cmp_ge_u32 s61, s60
    s_cbranch_scc0 interleave_layers__linear_attn_block__memory_aug_recurrent_mem_tr__prompt_kernel_v_prw1
    s_mov_b32 s60, 1
interleave_layers__linear_attn_block__memory_aug_recurrent_mem_tr__prompt_kernel_v_prw1_out:
    s_mov_b64 exec, -1
    buffer_load_dwordx4 v[68:71], v7, s[8:11], s47 offen sc1
    buffer_load_dwordx4 v[72:75], v7, s[8:11], s48 offen sc1
    buffer_load_dwordx2 v[76:77], v8, s[8:11], s50 offen sc1
    s_waitcnt vmcnt(0)
    v_max3_u32 v103, v68, v69, v70
    v_max3_u32 v103, v103, v71, v72
    v_max3_u32 v103, v103, v73, v74
    v_max3_u32 v103, v103, v75, v76
    v_max_u32 v103, v103, v77
    v_cmp_eq_u32 vcc, -1, v103
    s_cbranch_vccz interleave_layers__linear_attn_block__memory_aug_recurrent_mem_tr__prompt_kernel_v_pmw1_out
    s_mov_b32 s61, 0
interleave_layers__linear_attn_block__memory_aug_recurrent_mem_tr__prompt_kernel_v_pmw1:
    buffer_load_dwordx4 v[68:71], v7, s[8:11], s47 offen sc1
    buffer_load_dwordx4 v[72:75], v7, s[8:11], s48 offen sc1
    buffer_load_dwordx2 v[76:77], v8, s[8:11], s50 offen sc1
    s_waitcnt vmcnt(0)
    v_max3_u32 v103, v68, v69, v70
    v_max3_u32 v103, v103, v71, v72
    v_max3_u32 v103, v103, v73, v74
    v_max3_u32 v103, v103, v75, v76
    v_max_u32 v103, v103, v77
    v_cmp_eq_u32 vcc, -1, v103
    s_add_u32 s61, s61, 1
    s_cbranch_vccz interleave_layers__linear_attn_block__memory_aug_recurrent_mem_tr__prompt_kernel_v_pmw1_out
    s_cmp_ge_u32 s61, s60
    s_cbranch_scc1 interleave_layers__linear_attn_block__memory_aug_recurrent_mem_tr__prompt_kernel_v_pmw1_to
    s_sleep 1
    s_branch interleave_layers__linear_attn_block__memory_aug_recurrent_mem_tr__prompt_kernel_v_pmw1
interleave_layers__linear_attn_block__memory_aug_recurrent_mem_tr__prompt_kernel_v_pmw1_to:
    s_mov_b32 s60, 1
interleave_layers__linear_attn_block__memory_aug_recurrent_mem_tr__prompt_kernel_v_pmw1_out:
    ds_write_b128 v7, v[68:71]
    ds_write_b128 v7, v[72:75] offset:4096
    ds_write_b64 v8, v[76:77]
interleave_layers__linear_attn_block__memory_aug_recurrent_mem_tr__prompt_kernel_v_gow1:
    v_smfmac_f32_16x16x64_bf16 v[56:59], v[68:71], a[8:15], v4
    v_smfmac_f32_16x16x64_bf16 v[60:63], v[68:71], a[88:95], v4
    v_smfmac_f32_16x16x64_bf16 v[64:67], v[68:71], a[168:175], v4
    s_waitcnt lgkmcnt(0)
    s_barrier
    ds_read_b128 v[80:83], v5 offset:0
    ds_read_b128 v[84:87], v5 offset:2048
    ds_read_b128 v[88:91], v5 offset:3072
    ds_read_b128 v[92:95], v5 offset:4096
    ds_read_b128 v[96:99], v5 offset:6144
    ds_read_b128 v[100:103], v5 offset:7168
    ds_read_b128 v[76:79], v5 offset:8192
    ds_read_b128 v[68:71], v5 offset:9216
    v_smfmac_f32_16x16x64_bf16 v[64:67], v[72:75], a[200:207], v4
    v_smfmac_f32_16x16x64_bf16 v[56:59], v[72:75], a[40:47], v4
    v_smfmac_f32_16x16x64_bf16 v[60:63], v[72:75], a[120:127], v4
    s_waitcnt lgkmcnt(7)
    v_smfmac_f32_16x16x64_bf16 v[64:67], v[80:83], a[160:167], v4
    s_waitcnt lgkmcnt(6)
    v_smfmac_f32_16x16x64_bf16 v[64:67], v[84:87], a[176:183], v4
    s_waitcnt lgkmcnt(5)
    v_smfmac_f32_16x16x64_bf16 v[64:67], v[88:91], a[184:191], v4
    s_waitcnt lgkmcnt(4)
    v_smfmac_f32_16x16x64_bf16 v[64:67], v[92:95], a[192:199], v4
    s_waitcnt lgkmcnt(3)
    v_smfmac_f32_16x16x64_bf16 v[64:67], v[96:99], a[208:215], v4
    s_waitcnt lgkmcnt(2)
    v_smfmac_f32_16x16x64_bf16 v[64:67], v[100:103], a[216:223], v4
    s_waitcnt lgkmcnt(1)
    v_smfmac_f32_16x16x64_bf16 v[64:67], v[76:79], a[224:231], v4
    s_waitcnt lgkmcnt(0)
    v_smfmac_f32_16x16x64_bf16 v[64:67], v[68:71], a[232:239], v4
    v_smfmac_f32_16x16x64_bf16 v[56:59], v[80:83], a[0:7], v4
    v_smfmac_f32_16x16x64_bf16 v[60:63], v[80:83], a[80:87], v4
    v_smfmac_f32_16x16x64_bf16 v[56:59], v[84:87], a[16:23], v4
    s_nop 4
    v_mov_b32 v72, v64
    v_smfmac_f32_16x16x64_bf16 v[60:63], v[84:87], a[96:103], v4
    v_mov_b32 v73, v65
    v_mov_b32 v74, v66
    v_smfmac_f32_16x16x64_bf16 v[56:59], v[88:91], a[24:31], v4
    v_mov_b32 v75, v67
    v_smfmac_f32_16x16x64_bf16 v[60:63], v[88:91], a[104:111], v4
    v_permlane32_swap_b32 v64, v72
    v_permlane32_swap_b32 v65, v73
    v_smfmac_f32_16x16x64_bf16 v[56:59], v[92:95], a[32:39], v4
    v_permlane32_swap_b32 v66, v74
    v_permlane32_swap_b32 v67, v75
    v_smfmac_f32_16x16x64_bf16 v[60:63], v[92:95], a[112:119], v4
    v_add_f32 v64, v64, v72
    v_add_f32 v65, v65, v73
    v_smfmac_f32_16x16x64_bf16 v[56:59], v[96:99], a[48:55], v4
    v_add_f32 v66, v66, v74
    v_add_f32 v67, v67, v75
    v_smfmac_f32_16x16x64_bf16 v[60:63], v[96:99], a[128:135], v4
    v_cvt_pk_bf16_f32 v72, v64, v65
    v_cvt_pk_bf16_f32 v73, v66, v67
    v_smfmac_f32_16x16x64_bf16 v[56:59], v[100:103], a[56:63], v4
    ds_write_b64 v9, v[72:73] offset:512
    v_smfmac_f32_16x16x64_bf16 v[60:63], v[100:103], a[136:143], v4
    v_smfmac_f32_16x16x64_bf16 v[56:59], v[76:79], a[64:71], v4
    v_smfmac_f32_16x16x64_bf16 v[60:63], v[76:79], a[144:151], v4
    v_smfmac_f32_16x16x64_bf16 v[56:59], v[68:71], a[72:79], v4
    v_smfmac_f32_16x16x64_bf16 v[60:63], v[68:71], a[152:159], v4
    s_nop 7
    v_permlane32_swap_b32 v56, v60
    v_permlane32_swap_b32 v57, v61
    v_permlane32_swap_b32 v58, v62
    v_permlane32_swap_b32 v59, v63
    v_add_f32 v56, v56, v60
    v_add_f32 v57, v57, v61
    v_add_f32 v58, v58, v62
    v_add_f32 v59, v59, v63
    v_cvt_pk_bf16_f32 v68, v56, v57
    v_cvt_pk_bf16_f32 v69, v58, v59
    ds_write_b64 v10, v[68:69]
    s_waitcnt lgkmcnt(0)
    s_barrier
    ds_read_b64_tr_b16 v[68:69], v11 offset:0
    ds_read_b64_tr_b16 v[70:71], v11 offset:128
    ds_read_b64_tr_b16 v[72:73], v11 offset:1024
    ds_read_b64_tr_b16 v[74:75], v11 offset:1152
    ds_read_b64_tr_b16 v[76:77], v11 offset:2048
    ds_read_b64_tr_b16 v[78:79], v11 offset:2176
    ds_read_b128 v[80:83], v6 offset:0
    ds_read_b128 v[84:87], v6 offset:1024
    ds_read_b128 v[88:91], v6 offset:2048
    ds_read_b128 v[92:95], v6 offset:3072
    ds_read_b128 v[96:99], v6 offset:4096
    ds_read_b128 v[100:103], v6 offset:5120
    s_waitcnt lgkmcnt(10)
    v_smfmac_f32_16x16x64_bf16 v[16:19], v[68:71], a[240:247], v4
    v_smfmac_f32_16x16x64_bf16 v[20:23], v[68:71], v[112:119], v4
    v_smfmac_f32_16x16x64_bf16 v[24:27], v[68:71], v[136:143], v4
    v_smfmac_f32_16x16x64_bf16 v[28:31], v[68:71], v[160:167], v4
    s_waitcnt lgkmcnt(8)
    v_smfmac_f32_16x16x64_bf16 v[16:19], v[72:75], a[248:255], v4
    v_smfmac_f32_16x16x64_bf16 v[20:23], v[72:75], v[120:127], v4
    v_smfmac_f32_16x16x64_bf16 v[24:27], v[72:75], v[144:151], v4
    v_smfmac_f32_16x16x64_bf16 v[28:31], v[72:75], v[168:175], v4
    s_waitcnt lgkmcnt(6)
    v_smfmac_f32_16x16x64_bf16 v[16:19], v[76:79], v[104:111], v4
    v_smfmac_f32_16x16x64_bf16 v[20:23], v[76:79], v[128:135], v4
    v_smfmac_f32_16x16x64_bf16 v[24:27], v[76:79], v[152:159], v4
    v_smfmac_f32_16x16x64_bf16 v[28:31], v[76:79], v[176:183], v4
    v_smfmac_f32_16x16x64_bf16 v[32:35], v[68:71], v[184:191], v4
    v_smfmac_f32_16x16x64_bf16 v[36:39], v[68:71], v[208:215], v4
    s_nop 4
    v_permlane32_swap_b32 v16, v24
    v_permlane32_swap_b32 v17, v25
    v_smfmac_f32_16x16x64_bf16 v[40:43], v[68:71], v[232:239], v4
    v_permlane32_swap_b32 v18, v26
    v_permlane32_swap_b32 v19, v27
    s_waitcnt lgkmcnt(4)
    v_smfmac_f32_16x16x64_bf16 v[44:47], v[68:71], v[80:87], v4
    v_add_f32 v16, v16, v24
    v_add_f32 v17, v17, v25
    ds_read_b128 v[80:83], v6 offset:6144
    ds_read_b128 v[84:87], v6 offset:7168
    v_smfmac_f32_16x16x64_bf16 v[32:35], v[72:75], v[192:199], v4
    v_add_f32 v18, v18, v26
    v_add_f32 v19, v19, v27
    v_smfmac_f32_16x16x64_bf16 v[36:39], v[72:75], v[216:223], v4
    v_permlane32_swap_b32 v20, v28
    v_permlane32_swap_b32 v21, v29
    v_smfmac_f32_16x16x64_bf16 v[40:43], v[72:75], v[240:247], v4
    v_permlane32_swap_b32 v22, v30
    v_permlane32_swap_b32 v23, v31
    s_waitcnt lgkmcnt(4)
    v_smfmac_f32_16x16x64_bf16 v[44:47], v[72:75], v[88:95], v4
    v_add_f32 v20, v20, v28
    v_add_f32 v21, v21, v29
    ds_read_b128 v[88:91], v6 offset:8192
    ds_read_b128 v[92:95], v6 offset:9216
    v_smfmac_f32_16x16x64_bf16 v[32:35], v[76:79], v[200:207], v4
    v_add_f32 v22, v22, v30
    v_add_f32 v23, v23, v31
    v_smfmac_f32_16x16x64_bf16 v[36:39], v[76:79], v[224:231], v4
    v_cvt_pk_bf16_f32 v56, v16, v17
    v_cvt_pk_bf16_f32 v57, v18, v19
    v_smfmac_f32_16x16x64_bf16 v[40:43], v[76:79], v[248:255], v4
    v_cvt_pk_bf16_f32 v58, v20, v21
    v_cvt_pk_bf16_f32 v59, v22, v23
    s_waitcnt lgkmcnt(4)
    v_smfmac_f32_16x16x64_bf16 v[44:47], v[76:79], v[96:103], v4
    v_permlane16_swap_b32 v56, v58
    ds_read_b128 v[96:99], v6 offset:10240
    ds_read_b128 v[100:103], v6 offset:11264
    v_permlane16_swap_b32 v57, v59
    v_min_u32 v56, -2, v56
    v_min_u32 v57, -2, v57
    v_min_u32 v58, -2, v58
    v_min_u32 v59, -2, v59
    buffer_store_dwordx4 v[56:59], v14, s[8:11], s43 offen sc1
    s_add_u32 s49, s43, 65536
    s_waitcnt lgkmcnt(4)
    v_smfmac_f32_16x16x64_bf16 v[48:51], v[68:71], v[80:87], v4
    v_permlane32_swap_b32 v32, v40
    v_permlane32_swap_b32 v33, v41
    v_permlane32_swap_b32 v34, v42
    ds_read_b128 v[80:83], v6 offset:12288
    ds_read_b128 v[84:87], v6 offset:13312
    s_waitcnt lgkmcnt(4)
    v_smfmac_f32_16x16x64_bf16 v[48:51], v[72:75], v[88:95], v4
    v_permlane32_swap_b32 v35, v43
    v_add_f32 v32, v32, v40
    v_add_f32 v33, v33, v41
    v_add_f32 v34, v34, v42
    ds_read_b128 v[88:91], v6 offset:14336
    ds_read_b128 v[92:95], v6 offset:15360
    s_waitcnt lgkmcnt(4)
    v_smfmac_f32_16x16x64_bf16 v[48:51], v[76:79], v[96:103], v4
    v_add_f32 v35, v35, v43
    v_permlane32_swap_b32 v36, v44
    v_permlane32_swap_b32 v37, v45
    v_permlane32_swap_b32 v38, v46
    ds_read_b128 v[96:99], v6 offset:16384
    ds_read_b128 v[100:103], v6 offset:17408
    v_permlane32_swap_b32 v39, v47
    v_add_f32 v36, v36, v44
    v_add_f32 v37, v37, v45
    v_add_f32 v38, v38, v46
    s_waitcnt lgkmcnt(4)
    v_smfmac_f32_16x16x64_bf16 v[52:55], v[68:71], v[80:87], v4
    v_add_f32 v39, v39, v47
    v_cvt_pk_bf16_f32 v60, v32, v33
    v_cvt_pk_bf16_f32 v61, v34, v35
    s_waitcnt lgkmcnt(2)
    v_smfmac_f32_16x16x64_bf16 v[52:55], v[72:75], v[88:95], v4
    v_cvt_pk_bf16_f32 v62, v36, v37
    v_cvt_pk_bf16_f32 v63, v38, v39
    s_waitcnt lgkmcnt(0)
    v_smfmac_f32_16x16x64_bf16 v[52:55], v[76:79], v[96:103], v4
    v_permlane16_swap_b32 v60, v62
    v_permlane16_swap_b32 v61, v63
    v_min_u32 v60, -2, v60
    v_min_u32 v61, -2, v61
    v_min_u32 v62, -2, v62
    v_min_u32 v63, -2, v63
    buffer_store_dwordx4 v[60:63], v14, s[8:11], s49 offen sc1
    s_nop 0
    v_permlane32_swap_b32 v48, v52
    v_permlane32_swap_b32 v49, v53
    v_permlane32_swap_b32 v50, v54
    v_permlane32_swap_b32 v51, v55
    v_add_f32 v48, v48, v52
    v_add_f32 v49, v49, v53
    v_add_f32 v50, v50, v54
    v_add_f32 v51, v51, v55
    v_cvt_pk_bf16_f32 v64, v48, v49
    v_cvt_pk_bf16_f32 v65, v50, v51
    v_mov_b32 v66, v64
    v_mov_b32 v67, v65
    s_nop 0
    v_permlane16_swap_b32 v64, v66
    v_permlane16_swap_b32 v65, v67
    v_min_u32 v64, -2, v64
    v_min_u32 v65, -2, v65
    v_min_u32 v66, -2, v66
    v_min_u32 v67, -2, v67
    buffer_store_dwordx4 v[64:67], v15, s[8:11], s43 offen sc1
    s_add_u32 s40, s40, 1
    s_add_u32 s47, s37, 704512
    s_add_u32 s45, s37, 737280
    s_lshl_b32 s24, s40, 12
    s_and_b32 s24, s24, 0x2000
    s_xor_b32 s24, s24, s36
    s_lshl_b32 s37, s40, 20
    s_add_u32 s37, s37, s24
    s_add_u32 s37, s37, 117440512
    s_add_u32 s43, s37, 0
    s_cmp_lt_u32 s40, 64
    s_cbranch_scc1 interleave_layers__linear_attn_block__memory_aug_recurrent_mem_tr__prompt_kernel_v_stepw1
    s_branch interleave_layers__linear_attn_block__memory_aug_recurrent_mem_tr__prompt_kernel_v_end
interleave_layers__linear_attn_block__memory_aug_recurrent_mem_tr__prompt_kernel_v_stepw2:
    v_mov_b32 v16, 0
    v_mov_b32 v17, 0
    v_mov_b32 v18, 0
    v_mov_b32 v19, 0
    v_mov_b32 v20, 0
    v_mov_b32 v21, 0
    v_mov_b32 v22, 0
    v_mov_b32 v23, 0
    v_mov_b32 v24, 0
    v_mov_b32 v25, 0
    v_mov_b32 v26, 0
    v_mov_b32 v27, 0
    v_mov_b32 v28, 0
    v_mov_b32 v29, 0
    v_mov_b32 v30, 0
    v_mov_b32 v31, 0
    v_mov_b32 v32, 0
    v_mov_b32 v33, 0
    v_mov_b32 v34, 0
    v_mov_b32 v35, 0
    v_mov_b32 v36, 0
    v_mov_b32 v37, 0
    v_mov_b32 v38, 0
    v_mov_b32 v39, 0
    v_mov_b32 v40, 0
    v_mov_b32 v41, 0
    v_mov_b32 v42, 0
    v_mov_b32 v43, 0
    v_mov_b32 v44, 0
    v_mov_b32 v45, 0
    v_mov_b32 v46, 0
    v_mov_b32 v47, 0
    v_mov_b32 v48, 0
    v_mov_b32 v49, 0
    v_mov_b32 v50, 0
    v_mov_b32 v51, 0
    v_mov_b32 v52, 0
    v_mov_b32 v53, 0
    v_mov_b32 v54, 0
    v_mov_b32 v55, 0
    v_mov_b32 v56, 0
    v_mov_b32 v57, 0
    v_mov_b32 v58, 0
    v_mov_b32 v59, 0
    v_mov_b32 v60, 0
    v_mov_b32 v61, 0
    v_mov_b32 v62, 0
    v_mov_b32 v63, 0
    v_mov_b32 v64, 0
    v_mov_b32 v65, 0
    v_mov_b32 v66, 0
    v_mov_b32 v67, 0
    s_add_u32 s48, s47, 4096
    s_add_u32 s50, s47, 8192
    s_lshl_b32 s95, s92, 6
    s_add_u32 s95, s95, s40
    s_add_u32 s95, s95, 1
    s_cmp_ge_i32 s59, s95
    s_cbranch_scc1 interleave_layers__linear_attn_block__memory_aug_recurrent_mem_tr__prompt_kernel_v_ecw2_ok
    s_and_b32 s24, s2, 7
    s_lshl_b32 s24, s24, 7
    s_add_u32 s24, s24, 23109632
    v_and_b32 v79, 3, v1
    v_lshl_add_u32 v79, v79, 2, s24
    s_mov_b32 s61, 0
interleave_layers__linear_attn_block__memory_aug_recurrent_mem_tr__prompt_kernel_v_ecw2:
    buffer_load_dword v78, v79, s[8:11], 0 offen sc1
    s_waitcnt vmcnt(0)
    v_readlane_b32 s59, v78, 0
    v_readlane_b32 s24, v78, 1
    s_min_i32 s59, s59, s24
    v_readlane_b32 s24, v78, 2
    s_min_i32 s59, s59, s24
    s_cmp_ge_i32 s59, s95
    s_cbranch_scc1 interleave_layers__linear_attn_block__memory_aug_recurrent_mem_tr__prompt_kernel_v_ecw2_ok
    s_add_u32 s61, s61, 1
    s_cmp_ge_u32 s61, s60
    s_cbranch_scc1 interleave_layers__linear_attn_block__memory_aug_recurrent_mem_tr__prompt_kernel_v_ecw2_to
    s_sleep 2
    s_branch interleave_layers__linear_attn_block__memory_aug_recurrent_mem_tr__prompt_kernel_v_ecw2
interleave_layers__linear_attn_block__memory_aug_recurrent_mem_tr__prompt_kernel_v_ecw2_to:
    s_mov_b32 s60, 1
interleave_layers__linear_attn_block__memory_aug_recurrent_mem_tr__prompt_kernel_v_ecw2_ok:
    s_sleep 20
    s_mov_b64 exec, 1
    s_mov_b32 s61, 0
    v_mov_b32 v81, 0
    buffer_atomic_add v81, v12, s[8:11], s45 offen sc0
    s_sleep 2
    v_mov_b32 v82, 0
    buffer_atomic_add v82, v12, s[8:11], s45 offen sc0
    s_sleep 2
    v_mov_b32 v83, 0
    buffer_atomic_add v83, v12, s[8:11], s45 offen sc0
    s_sleep 2
interleave_layers__linear_attn_block__memory_aug_recurrent_mem_tr__prompt_kernel_v_prw2:
    v_mov_b32 v80, 0
    buffer_atomic_add v80, v12, s[8:11], s45 offen sc0
    s_waitcnt vmcnt(3)
    v_cmp_le_i32 vcc, 9, v81
    s_add_u32 s61, s61, 1
    s_cbranch_vccnz interleave_layers__linear_attn_block__memory_aug_recurrent_mem_tr__prompt_kernel_v_prw2_out
    s_sleep 2
    v_mov_b32 v81, 0
    buffer_atomic_add v81, v12, s[8:11], s45 offen sc0
    s_waitcnt vmcnt(3)
    v_cmp_le_i32 vcc, 9, v82
    s_add_u32 s61, s61, 1
    s_cbranch_vccnz interleave_layers__linear_attn_block__memory_aug_recurrent_mem_tr__prompt_kernel_v_prw2_out
    s_sleep 2
    v_mov_b32 v82, 0
    buffer_atomic_add v82, v12, s[8:11], s45 offen sc0
    s_waitcnt vmcnt(3)
    v_cmp_le_i32 vcc, 9, v83
    s_add_u32 s61, s61, 1
    s_cbranch_vccnz interleave_layers__linear_attn_block__memory_aug_recurrent_mem_tr__prompt_kernel_v_prw2_out
    s_sleep 2
    v_mov_b32 v83, 0
    buffer_atomic_add v83, v12, s[8:11], s45 offen sc0
    s_waitcnt vmcnt(3)
    v_cmp_le_i32 vcc, 9, v80
    s_add_u32 s61, s61, 1
    s_cbranch_vccnz interleave_layers__linear_attn_block__memory_aug_recurrent_mem_tr__prompt_kernel_v_prw2_out
    s_sleep 2
    s_cmp_ge_u32 s61, s60
    s_cbranch_scc0 interleave_layers__linear_attn_block__memory_aug_recurrent_mem_tr__prompt_kernel_v_prw2
    s_mov_b32 s60, 1
interleave_layers__linear_attn_block__memory_aug_recurrent_mem_tr__prompt_kernel_v_prw2_out:
    s_mov_b64 exec, -1
    buffer_load_dwordx4 v[68:71], v7, s[8:11], s47 offen sc1
    buffer_load_dwordx4 v[72:75], v7, s[8:11], s48 offen sc1
    buffer_load_dwordx2 v[76:77], v8, s[8:11], s50 offen sc1
    s_waitcnt vmcnt(0)
    v_max3_u32 v103, v68, v69, v70
    v_max3_u32 v103, v103, v71, v72
    v_max3_u32 v103, v103, v73, v74
    v_max3_u32 v103, v103, v75, v76
    v_max_u32 v103, v103, v77
    v_cmp_eq_u32 vcc, -1, v103
    s_cbranch_vccz interleave_layers__linear_attn_block__memory_aug_recurrent_mem_tr__prompt_kernel_v_pmw2_out
    s_mov_b32 s61, 0
interleave_layers__linear_attn_block__memory_aug_recurrent_mem_tr__prompt_kernel_v_pmw2:
    buffer_load_dwordx4 v[68:71], v7, s[8:11], s47 offen sc1
    buffer_load_dwordx4 v[72:75], v7, s[8:11], s48 offen sc1
    buffer_load_dwordx2 v[76:77], v8, s[8:11], s50 offen sc1
    s_waitcnt vmcnt(0)
    v_max3_u32 v103, v68, v69, v70
    v_max3_u32 v103, v103, v71, v72
    v_max3_u32 v103, v103, v73, v74
    v_max3_u32 v103, v103, v75, v76
    v_max_u32 v103, v103, v77
    v_cmp_eq_u32 vcc, -1, v103
    s_add_u32 s61, s61, 1
    s_cbranch_vccz interleave_layers__linear_attn_block__memory_aug_recurrent_mem_tr__prompt_kernel_v_pmw2_out
    s_cmp_ge_u32 s61, s60
    s_cbranch_scc1 interleave_layers__linear_attn_block__memory_aug_recurrent_mem_tr__prompt_kernel_v_pmw2_to
    s_sleep 1
    s_branch interleave_layers__linear_attn_block__memory_aug_recurrent_mem_tr__prompt_kernel_v_pmw2
interleave_layers__linear_attn_block__memory_aug_recurrent_mem_tr__prompt_kernel_v_pmw2_to:
    s_mov_b32 s60, 1
interleave_layers__linear_attn_block__memory_aug_recurrent_mem_tr__prompt_kernel_v_pmw2_out:
    ds_write_b128 v7, v[68:71]
    ds_write_b128 v7, v[72:75] offset:4096
    ds_write_b64 v8, v[76:77]
interleave_layers__linear_attn_block__memory_aug_recurrent_mem_tr__prompt_kernel_v_gow2:
    v_smfmac_f32_16x16x64_bf16 v[56:59], v[68:71], a[16:23], v4
    v_smfmac_f32_16x16x64_bf16 v[60:63], v[68:71], a[96:103], v4
    v_smfmac_f32_16x16x64_bf16 v[64:67], v[68:71], a[176:183], v4
    s_waitcnt lgkmcnt(0)
    s_barrier
    ds_read_b128 v[80:83], v5 offset:0
    ds_read_b128 v[84:87], v5 offset:1024
    ds_read_b128 v[88:91], v5 offset:3072
    ds_read_b128 v[92:95], v5 offset:4096
    ds_read_b128 v[96:99], v5 offset:5120
    ds_read_b128 v[100:103], v5 offset:7168
    ds_read_b128 v[76:79], v5 offset:8192
    ds_read_b128 v[68:71], v5 offset:9216
    v_smfmac_f32_16x16x64_bf16 v[64:67], v[72:75], a[208:215], v4
    v_smfmac_f32_16x16x64_bf16 v[56:59], v[72:75], a[48:55], v4
    v_smfmac_f32_16x16x64_bf16 v[60:63], v[72:75], a[128:135], v4
    s_waitcnt lgkmcnt(7)
    v_smfmac_f32_16x16x64_bf16 v[64:67], v[80:83], a[160:167], v4
    s_waitcnt lgkmcnt(6)
    v_smfmac_f32_16x16x64_bf16 v[64:67], v[84:87], a[168:175], v4
    s_waitcnt lgkmcnt(5)
    v_smfmac_f32_16x16x64_bf16 v[64:67], v[88:91], a[184:191], v4
    s_waitcnt lgkmcnt(4)
    v_smfmac_f32_16x16x64_bf16 v[64:67], v[92:95], a[192:199], v4
    s_waitcnt lgkmcnt(3)
    v_smfmac_f32_16x16x64_bf16 v[64:67], v[96:99], a[200:207], v4
    s_waitcnt lgkmcnt(2)
    v_smfmac_f32_16x16x64_bf16 v[64:67], v[100:103], a[216:223], v4
    s_waitcnt lgkmcnt(1)
    v_smfmac_f32_16x16x64_bf16 v[64:67], v[76:79], a[224:231], v4
    s_waitcnt lgkmcnt(0)
    v_smfmac_f32_16x16x64_bf16 v[64:67], v[68:71], a[232:239], v4
    v_smfmac_f32_16x16x64_bf16 v[56:59], v[80:83], a[0:7], v4
    v_smfmac_f32_16x16x64_bf16 v[60:63], v[80:83], a[80:87], v4
    v_smfmac_f32_16x16x64_bf16 v[56:59], v[84:87], a[8:15], v4
    s_nop 4
    v_mov_b32 v72, v64
    v_smfmac_f32_16x16x64_bf16 v[60:63], v[84:87], a[88:95], v4
    v_mov_b32 v73, v65
    v_mov_b32 v74, v66
    v_smfmac_f32_16x16x64_bf16 v[56:59], v[88:91], a[24:31], v4
    v_mov_b32 v75, v67
    v_smfmac_f32_16x16x64_bf16 v[60:63], v[88:91], a[104:111], v4
    v_permlane32_swap_b32 v64, v72
    v_permlane32_swap_b32 v65, v73
    v_smfmac_f32_16x16x64_bf16 v[56:59], v[92:95], a[32:39], v4
    v_permlane32_swap_b32 v66, v74
    v_permlane32_swap_b32 v67, v75
    v_smfmac_f32_16x16x64_bf16 v[60:63], v[92:95], a[112:119], v4
    v_add_f32 v64, v64, v72
    v_add_f32 v65, v65, v73
    v_smfmac_f32_16x16x64_bf16 v[56:59], v[96:99], a[40:47], v4
    v_add_f32 v66, v66, v74
    v_add_f32 v67, v67, v75
    v_smfmac_f32_16x16x64_bf16 v[60:63], v[96:99], a[120:127], v4
    v_cvt_pk_bf16_f32 v72, v64, v65
    v_cvt_pk_bf16_f32 v73, v66, v67
    v_smfmac_f32_16x16x64_bf16 v[56:59], v[100:103], a[56:63], v4
    ds_write_b64 v9, v[72:73] offset:512
    v_smfmac_f32_16x16x64_bf16 v[60:63], v[100:103], a[136:143], v4
    v_smfmac_f32_16x16x64_bf16 v[56:59], v[76:79], a[64:71], v4
    v_smfmac_f32_16x16x64_bf16 v[60:63], v[76:79], a[144:151], v4
    v_smfmac_f32_16x16x64_bf16 v[56:59], v[68:71], a[72:79], v4
    v_smfmac_f32_16x16x64_bf16 v[60:63], v[68:71], a[152:159], v4
    s_nop 7
    v_permlane32_swap_b32 v56, v60
    v_permlane32_swap_b32 v57, v61
    v_permlane32_swap_b32 v58, v62
    v_permlane32_swap_b32 v59, v63
    v_add_f32 v56, v56, v60
    v_add_f32 v57, v57, v61
    v_add_f32 v58, v58, v62
    v_add_f32 v59, v59, v63
    v_cvt_pk_bf16_f32 v68, v56, v57
    v_cvt_pk_bf16_f32 v69, v58, v59
    ds_write_b64 v10, v[68:69]
    s_waitcnt lgkmcnt(0)
    s_barrier
    ds_read_b64_tr_b16 v[68:69], v11 offset:0
    ds_read_b64_tr_b16 v[70:71], v11 offset:128
    ds_read_b64_tr_b16 v[72:73], v11 offset:1024
    ds_read_b64_tr_b16 v[74:75], v11 offset:1152
    ds_read_b64_tr_b16 v[76:77], v11 offset:2048
    ds_read_b64_tr_b16 v[78:79], v11 offset:2176
    ds_read_b128 v[80:83], v6 offset:0
    ds_read_b128 v[84:87], v6 offset:1024
    ds_read_b128 v[88:91], v6 offset:2048
    ds_read_b128 v[92:95], v6 offset:3072
    ds_read_b128 v[96:99], v6 offset:4096
    ds_read_b128 v[100:103], v6 offset:5120
    s_waitcnt lgkmcnt(10)
    v_smfmac_f32_16x16x64_bf16 v[16:19], v[68:71], a[240:247], v4
    v_smfmac_f32_16x16x64_bf16 v[20:23], v[68:71], v[112:119], v4
    v_smfmac_f32_16x16x64_bf16 v[24:27], v[68:71], v[136:143], v4
    v_smfmac_f32_16x16x64_bf16 v[28:31], v[68:71], v[160:167], v4
    s_waitcnt lgkmcnt(8)
    v_smfmac_f32_16x16x64_bf16 v[16:19], v[72:75], a[248:255], v4
    v_smfmac_f32_16x16x64_bf16 v[20:23], v[72:75], v[120:127], v4
    v_smfmac_f32_16x16x64_bf16 v[24:27], v[72:75], v[144:151], v4
    v_smfmac_f32_16x16x64_bf16 v[28:31], v[72:75], v[168:175], v4
    s_waitcnt lgkmcnt(6)
    v_smfmac_f32_16x16x64_bf16 v[16:19], v[76:79], v[104:111], v4
    v_smfmac_f32_16x16x64_bf16 v[20:23], v[76:79], v[128:135], v4
    v_smfmac_f32_16x16x64_bf16 v[24:27], v[76:79], v[152:159], v4
    v_smfmac_f32_16x16x64_bf16 v[28:31], v[76:79], v[176:183], v4
    v_smfmac_f32_16x16x64_bf16 v[32:35], v[68:71], v[184:191], v4
    v_smfmac_f32_16x16x64_bf16 v[36:39], v[68:71], v[208:215], v4
    s_nop 4
    v_permlane32_swap_b32 v16, v24
    v_permlane32_swap_b32 v17, v25
    v_smfmac_f32_16x16x64_bf16 v[40:43], v[68:71], v[232:239], v4
    v_permlane32_swap_b32 v18, v26
    v_permlane32_swap_b32 v19, v27
    s_waitcnt lgkmcnt(4)
    v_smfmac_f32_16x16x64_bf16 v[44:47], v[68:71], v[80:87], v4
    v_add_f32 v16, v16, v24
    v_add_f32 v17, v17, v25
    ds_read_b128 v[80:83], v6 offset:6144
    ds_read_b128 v[84:87], v6 offset:7168
    v_smfmac_f32_16x16x64_bf16 v[32:35], v[72:75], v[192:199], v4
    v_add_f32 v18, v18, v26
    v_add_f32 v19, v19, v27
    v_smfmac_f32_16x16x64_bf16 v[36:39], v[72:75], v[216:223], v4
    v_permlane32_swap_b32 v20, v28
    v_permlane32_swap_b32 v21, v29
    v_smfmac_f32_16x16x64_bf16 v[40:43], v[72:75], v[240:247], v4
    v_permlane32_swap_b32 v22, v30
    v_permlane32_swap_b32 v23, v31
    s_waitcnt lgkmcnt(4)
    v_smfmac_f32_16x16x64_bf16 v[44:47], v[72:75], v[88:95], v4
    v_add_f32 v20, v20, v28
    v_add_f32 v21, v21, v29
    ds_read_b128 v[88:91], v6 offset:8192
    ds_read_b128 v[92:95], v6 offset:9216
    v_smfmac_f32_16x16x64_bf16 v[32:35], v[76:79], v[200:207], v4
    v_add_f32 v22, v22, v30
    v_add_f32 v23, v23, v31
    v_smfmac_f32_16x16x64_bf16 v[36:39], v[76:79], v[224:231], v4
    v_cvt_pk_bf16_f32 v56, v16, v17
    v_cvt_pk_bf16_f32 v57, v18, v19
    v_smfmac_f32_16x16x64_bf16 v[40:43], v[76:79], v[248:255], v4
    v_cvt_pk_bf16_f32 v58, v20, v21
    v_cvt_pk_bf16_f32 v59, v22, v23
    s_waitcnt lgkmcnt(4)
    v_smfmac_f32_16x16x64_bf16 v[44:47], v[76:79], v[96:103], v4
    v_permlane16_swap_b32 v56, v58
    ds_read_b128 v[96:99], v6 offset:10240
    ds_read_b128 v[100:103], v6 offset:11264
    v_permlane16_swap_b32 v57, v59
    v_min_u32 v56, -2, v56
    v_min_u32 v57, -2, v57
    v_min_u32 v58, -2, v58
    v_min_u32 v59, -2, v59
    buffer_store_dwordx4 v[56:59], v14, s[8:11], s43 offen sc1
    s_add_u32 s49, s43, 65536
    s_waitcnt lgkmcnt(4)
    v_smfmac_f32_16x16x64_bf16 v[48:51], v[68:71], v[80:87], v4
    v_permlane32_swap_b32 v32, v40
    v_permlane32_swap_b32 v33, v41
    v_permlane32_swap_b32 v34, v42
    ds_read_b128 v[80:83], v6 offset:12288
    ds_read_b128 v[84:87], v6 offset:13312
    s_waitcnt lgkmcnt(4)
    v_smfmac_f32_16x16x64_bf16 v[48:51], v[72:75], v[88:95], v4
    v_permlane32_swap_b32 v35, v43
    v_add_f32 v32, v32, v40
    v_add_f32 v33, v33, v41
    v_add_f32 v34, v34, v42
    ds_read_b128 v[88:91], v6 offset:14336
    ds_read_b128 v[92:95], v6 offset:15360
    s_waitcnt lgkmcnt(4)
    v_smfmac_f32_16x16x64_bf16 v[48:51], v[76:79], v[96:103], v4
    v_add_f32 v35, v35, v43
    v_permlane32_swap_b32 v36, v44
    v_permlane32_swap_b32 v37, v45
    v_permlane32_swap_b32 v38, v46
    ds_read_b128 v[96:99], v6 offset:16384
    ds_read_b128 v[100:103], v6 offset:17408
    v_permlane32_swap_b32 v39, v47
    v_add_f32 v36, v36, v44
    v_add_f32 v37, v37, v45
    v_add_f32 v38, v38, v46
    s_waitcnt lgkmcnt(4)
    v_smfmac_f32_16x16x64_bf16 v[52:55], v[68:71], v[80:87], v4
    v_add_f32 v39, v39, v47
    v_cvt_pk_bf16_f32 v60, v32, v33
    v_cvt_pk_bf16_f32 v61, v34, v35
    s_waitcnt lgkmcnt(2)
    v_smfmac_f32_16x16x64_bf16 v[52:55], v[72:75], v[88:95], v4
    v_cvt_pk_bf16_f32 v62, v36, v37
    v_cvt_pk_bf16_f32 v63, v38, v39
    s_waitcnt lgkmcnt(0)
    v_smfmac_f32_16x16x64_bf16 v[52:55], v[76:79], v[96:103], v4
    v_permlane16_swap_b32 v60, v62
    v_permlane16_swap_b32 v61, v63
    v_min_u32 v60, -2, v60
    v_min_u32 v61, -2, v61
    v_min_u32 v62, -2, v62
    v_min_u32 v63, -2, v63
    buffer_store_dwordx4 v[60:63], v14, s[8:11], s49 offen sc1
    s_nop 0
    v_permlane32_swap_b32 v48, v52
    v_permlane32_swap_b32 v49, v53
    v_permlane32_swap_b32 v50, v54
    v_permlane32_swap_b32 v51, v55
    v_add_f32 v48, v48, v52
    v_add_f32 v49, v49, v53
    v_add_f32 v50, v50, v54
    v_add_f32 v51, v51, v55
    v_cvt_pk_bf16_f32 v64, v48, v49
    v_cvt_pk_bf16_f32 v65, v50, v51
    v_mov_b32 v66, v64
    v_mov_b32 v67, v65
    s_nop 0
    v_permlane16_swap_b32 v64, v66
    v_permlane16_swap_b32 v65, v67
    v_min_u32 v64, -2, v64
    v_min_u32 v65, -2, v65
    v_min_u32 v66, -2, v66
    v_min_u32 v67, -2, v67
    buffer_store_dwordx4 v[64:67], v15, s[8:11], s43 offen sc1
    s_add_u32 s40, s40, 1
    s_add_u32 s47, s37, 704512
    s_add_u32 s45, s37, 737280
    s_lshl_b32 s24, s40, 12
    s_and_b32 s24, s24, 0x2000
    s_xor_b32 s24, s24, s36
    s_lshl_b32 s37, s40, 20
    s_add_u32 s37, s37, s24
    s_add_u32 s37, s37, 117440512
    s_add_u32 s43, s37, 0
    s_cmp_lt_u32 s40, 64
    s_cbranch_scc1 interleave_layers__linear_attn_block__memory_aug_recurrent_mem_tr__prompt_kernel_v_stepw2
    s_branch interleave_layers__linear_attn_block__memory_aug_recurrent_mem_tr__prompt_kernel_v_end
interleave_layers__linear_attn_block__memory_aug_recurrent_mem_tr__prompt_kernel_v_stepw3:
    v_mov_b32 v16, 0
    v_mov_b32 v17, 0
    v_mov_b32 v18, 0
    v_mov_b32 v19, 0
    v_mov_b32 v20, 0
    v_mov_b32 v21, 0
    v_mov_b32 v22, 0
    v_mov_b32 v23, 0
    v_mov_b32 v24, 0
    v_mov_b32 v25, 0
    v_mov_b32 v26, 0
    v_mov_b32 v27, 0
    v_mov_b32 v28, 0
    v_mov_b32 v29, 0
    v_mov_b32 v30, 0
    v_mov_b32 v31, 0
    v_mov_b32 v32, 0
    v_mov_b32 v33, 0
    v_mov_b32 v34, 0
    v_mov_b32 v35, 0
    v_mov_b32 v36, 0
    v_mov_b32 v37, 0
    v_mov_b32 v38, 0
    v_mov_b32 v39, 0
    v_mov_b32 v40, 0
    v_mov_b32 v41, 0
    v_mov_b32 v42, 0
    v_mov_b32 v43, 0
    v_mov_b32 v44, 0
    v_mov_b32 v45, 0
    v_mov_b32 v46, 0
    v_mov_b32 v47, 0
    v_mov_b32 v48, 0
    v_mov_b32 v49, 0
    v_mov_b32 v50, 0
    v_mov_b32 v51, 0
    v_mov_b32 v52, 0
    v_mov_b32 v53, 0
    v_mov_b32 v54, 0
    v_mov_b32 v55, 0
    v_mov_b32 v56, 0
    v_mov_b32 v57, 0
    v_mov_b32 v58, 0
    v_mov_b32 v59, 0
    v_mov_b32 v60, 0
    v_mov_b32 v61, 0
    v_mov_b32 v62, 0
    v_mov_b32 v63, 0
    v_mov_b32 v64, 0
    v_mov_b32 v65, 0
    v_mov_b32 v66, 0
    v_mov_b32 v67, 0
    s_add_u32 s48, s47, 4096
    s_add_u32 s50, s47, 8192
    s_lshl_b32 s95, s92, 6
    s_add_u32 s95, s95, s40
    s_add_u32 s95, s95, 1
    s_cmp_ge_i32 s59, s95
    s_cbranch_scc1 interleave_layers__linear_attn_block__memory_aug_recurrent_mem_tr__prompt_kernel_v_ecw3_ok
    s_and_b32 s24, s2, 7
    s_lshl_b32 s24, s24, 7
    s_add_u32 s24, s24, 23109632
    v_and_b32 v79, 3, v1
    v_lshl_add_u32 v79, v79, 2, s24
    s_mov_b32 s61, 0
interleave_layers__linear_attn_block__memory_aug_recurrent_mem_tr__prompt_kernel_v_ecw3:
    buffer_load_dword v78, v79, s[8:11], 0 offen sc1
    s_waitcnt vmcnt(0)
    v_readlane_b32 s59, v78, 0
    v_readlane_b32 s24, v78, 1
    s_min_i32 s59, s59, s24
    v_readlane_b32 s24, v78, 2
    s_min_i32 s59, s59, s24
    s_cmp_ge_i32 s59, s95
    s_cbranch_scc1 interleave_layers__linear_attn_block__memory_aug_recurrent_mem_tr__prompt_kernel_v_ecw3_ok
    s_add_u32 s61, s61, 1
    s_cmp_ge_u32 s61, s60
    s_cbranch_scc1 interleave_layers__linear_attn_block__memory_aug_recurrent_mem_tr__prompt_kernel_v_ecw3_to
    s_sleep 2
    s_branch interleave_layers__linear_attn_block__memory_aug_recurrent_mem_tr__prompt_kernel_v_ecw3
interleave_layers__linear_attn_block__memory_aug_recurrent_mem_tr__prompt_kernel_v_ecw3_to:
    s_mov_b32 s60, 1
interleave_layers__linear_attn_block__memory_aug_recurrent_mem_tr__prompt_kernel_v_ecw3_ok:
    s_sleep 20
    s_mov_b64 exec, 1
    s_mov_b32 s61, 0
    v_mov_b32 v81, 0
    buffer_atomic_add v81, v12, s[8:11], s45 offen sc0
    s_sleep 2
    v_mov_b32 v82, 0
    buffer_atomic_add v82, v12, s[8:11], s45 offen sc0
    s_sleep 2
    v_mov_b32 v83, 0
    buffer_atomic_add v83, v12, s[8:11], s45 offen sc0
    s_sleep 2
interleave_layers__linear_attn_block__memory_aug_recurrent_mem_tr__prompt_kernel_v_prw3:
    v_mov_b32 v80, 0
    buffer_atomic_add v80, v12, s[8:11], s45 offen sc0
    s_waitcnt vmcnt(3)
    v_cmp_le_i32 vcc, 9, v81
    s_add_u32 s61, s61, 1
    s_cbranch_vccnz interleave_layers__linear_attn_block__memory_aug_recurrent_mem_tr__prompt_kernel_v_prw3_out
    s_sleep 2
    v_mov_b32 v81, 0
    buffer_atomic_add v81, v12, s[8:11], s45 offen sc0
    s_waitcnt vmcnt(3)
    v_cmp_le_i32 vcc, 9, v82
    s_add_u32 s61, s61, 1
    s_cbranch_vccnz interleave_layers__linear_attn_block__memory_aug_recurrent_mem_tr__prompt_kernel_v_prw3_out
    s_sleep 2
    v_mov_b32 v82, 0
    buffer_atomic_add v82, v12, s[8:11], s45 offen sc0
    s_waitcnt vmcnt(3)
    v_cmp_le_i32 vcc, 9, v83
    s_add_u32 s61, s61, 1
    s_cbranch_vccnz interleave_layers__linear_attn_block__memory_aug_recurrent_mem_tr__prompt_kernel_v_prw3_out
    s_sleep 2
    v_mov_b32 v83, 0
    buffer_atomic_add v83, v12, s[8:11], s45 offen sc0
    s_waitcnt vmcnt(3)
    v_cmp_le_i32 vcc, 9, v80
    s_add_u32 s61, s61, 1
    s_cbranch_vccnz interleave_layers__linear_attn_block__memory_aug_recurrent_mem_tr__prompt_kernel_v_prw3_out
    s_sleep 2
    s_cmp_ge_u32 s61, s60
    s_cbranch_scc0 interleave_layers__linear_attn_block__memory_aug_recurrent_mem_tr__prompt_kernel_v_prw3
    s_mov_b32 s60, 1
interleave_layers__linear_attn_block__memory_aug_recurrent_mem_tr__prompt_kernel_v_prw3_out:
    s_mov_b64 exec, -1
    buffer_load_dwordx4 v[68:71], v7, s[8:11], s47 offen sc1
    buffer_load_dwordx4 v[72:75], v7, s[8:11], s48 offen sc1
    buffer_load_dwordx2 v[76:77], v8, s[8:11], s50 offen sc1
    s_waitcnt vmcnt(0)
    v_max3_u32 v103, v68, v69, v70
    v_max3_u32 v103, v103, v71, v72
    v_max3_u32 v103, v103, v73, v74
    v_max3_u32 v103, v103, v75, v76
    v_max_u32 v103, v103, v77
    v_cmp_eq_u32 vcc, -1, v103
    s_cbranch_vccz interleave_layers__linear_attn_block__memory_aug_recurrent_mem_tr__prompt_kernel_v_pmw3_out
    s_mov_b32 s61, 0
interleave_layers__linear_attn_block__memory_aug_recurrent_mem_tr__prompt_kernel_v_pmw3:
    buffer_load_dwordx4 v[68:71], v7, s[8:11], s47 offen sc1
    buffer_load_dwordx4 v[72:75], v7, s[8:11], s48 offen sc1
    buffer_load_dwordx2 v[76:77], v8, s[8:11], s50 offen sc1
    s_waitcnt vmcnt(0)
    v_max3_u32 v103, v68, v69, v70
    v_max3_u32 v103, v103, v71, v72
    v_max3_u32 v103, v103, v73, v74
    v_max3_u32 v103, v103, v75, v76
    v_max_u32 v103, v103, v77
    v_cmp_eq_u32 vcc, -1, v103
    s_add_u32 s61, s61, 1
    s_cbranch_vccz interleave_layers__linear_attn_block__memory_aug_recurrent_mem_tr__prompt_kernel_v_pmw3_out
    s_cmp_ge_u32 s61, s60
    s_cbranch_scc1 interleave_layers__linear_attn_block__memory_aug_recurrent_mem_tr__prompt_kernel_v_pmw3_to
    s_sleep 1
    s_branch interleave_layers__linear_attn_block__memory_aug_recurrent_mem_tr__prompt_kernel_v_pmw3
interleave_layers__linear_attn_block__memory_aug_recurrent_mem_tr__prompt_kernel_v_pmw3_to:
    s_mov_b32 s60, 1
interleave_layers__linear_attn_block__memory_aug_recurrent_mem_tr__prompt_kernel_v_pmw3_out:
    ds_write_b128 v7, v[68:71]
    ds_write_b128 v7, v[72:75] offset:4096
    ds_write_b64 v8, v[76:77]
interleave_layers__linear_attn_block__memory_aug_recurrent_mem_tr__prompt_kernel_v_gow3:
    v_smfmac_f32_16x16x64_bf16 v[56:59], v[68:71], a[24:31], v4
    v_smfmac_f32_16x16x64_bf16 v[60:63], v[68:71], a[104:111], v4
    v_smfmac_f32_16x16x64_bf16 v[64:67], v[68:71], a[184:191], v4
    s_waitcnt lgkmcnt(0)
    s_barrier
    ds_read_b128 v[80:83], v5 offset:0
    ds_read_b128 v[84:87], v5 offset:1024
    ds_read_b128 v[88:91], v5 offset:2048
    ds_read_b128 v[92:95], v5 offset:4096
    ds_read_b128 v[96:99], v5 offset:5120
    ds_read_b128 v[100:103], v5 offset:6144
    ds_read_b128 v[76:79], v5 offset:8192
    ds_read_b128 v[68:71], v5 offset:9216
    v_smfmac_f32_16x16x64_bf16 v[64:67], v[72:75], a[216:223], v4
    v_smfmac_f32_16x16x64_bf16 v[56:59], v[72:75], a[56:63], v4
    v_smfmac_f32_16x16x64_bf16 v[60:63], v[72:75], a[136:143], v4
    s_waitcnt lgkmcnt(7)
    v_smfmac_f32_16x16x64_bf16 v[64:67], v[80:83], a[160:167], v4
    s_waitcnt lgkmcnt(6)
    v_smfmac_f32_16x16x64_bf16 v[64:67], v[84:87], a[168:175], v4
    s_waitcnt lgkmcnt(5)
    v_smfmac_f32_16x16x64_bf16 v[64:67], v[88:91], a[176:183], v4
    s_waitcnt lgkmcnt(4)
    v_smfmac_f32_16x16x64_bf16 v[64:67], v[92:95], a[192:199], v4
    s_waitcnt lgkmcnt(3)
    v_smfmac_f32_16x16x64_bf16 v[64:67], v[96:99], a[200:207], v4
    s_waitcnt lgkmcnt(2)
    v_smfmac_f32_16x16x64_bf16 v[64:67], v[100:103], a[208:215], v4
    s_waitcnt lgkmcnt(1)
    v_smfmac_f32_16x16x64_bf16 v[64:67], v[76:79], a[224:231], v4
    s_waitcnt lgkmcnt(0)
    v_smfmac_f32_16x16x64_bf16 v[64:67], v[68:71], a[232:239], v4
    v_smfmac_f32_16x16x64_bf16 v[56:59], v[80:83], a[0:7], v4
    v_smfmac_f32_16x16x64_bf16 v[60:63], v[80:83], a[80:87], v4
    v_smfmac_f32_16x16x64_bf16 v[56:59], v[84:87], a[8:15], v4
    s_nop 4
    v_mov_b32 v72, v64
    v_smfmac_f32_16x16x64_bf16 v[60:63], v[84:87], a[88:95], v4
    v_mov_b32 v73, v65
    v_mov_b32 v74, v66
    v_smfmac_f32_16x16x64_bf16 v[56:59], v[88:91], a[16:23], v4
    v_mov_b32 v75, v67
    v_smfmac_f32_16x16x64_bf16 v[60:63], v[88:91], a[96:103], v4
    v_permlane32_swap_b32 v64, v72
    v_permlane32_swap_b32 v65, v73
    v_smfmac_f32_16x16x64_bf16 v[56:59], v[92:95], a[32:39], v4
    v_permlane32_swap_b32 v66, v74
    v_permlane32_swap_b32 v67, v75
    v_smfmac_f32_16x16x64_bf16 v[60:63], v[92:95], a[112:119], v4
    v_add_f32 v64, v64, v72
    v_add_f32 v65, v65, v73
    v_smfmac_f32_16x16x64_bf16 v[56:59], v[96:99], a[40:47], v4
    v_add_f32 v66, v66, v74
    v_add_f32 v67, v67, v75
    v_smfmac_f32_16x16x64_bf16 v[60:63], v[96:99], a[120:127], v4
    v_cvt_pk_bf16_f32 v72, v64, v65
    v_cvt_pk_bf16_f32 v73, v66, v67
    v_smfmac_f32_16x16x64_bf16 v[56:59], v[100:103], a[48:55], v4
    ds_write_b64 v9, v[72:73] offset:512
    v_smfmac_f32_16x16x64_bf16 v[60:63], v[100:103], a[128:135], v4
    v_smfmac_f32_16x16x64_bf16 v[56:59], v[76:79], a[64:71], v4
    v_smfmac_f32_16x16x64_bf16 v[60:63], v[76:79], a[144:151], v4
    v_smfmac_f32_16x16x64_bf16 v[56:59], v[68:71], a[72:79], v4
    v_smfmac_f32_16x16x64_bf16 v[60:63], v[68:71], a[152:159], v4
    s_nop 7
    v_permlane32_swap_b32 v56, v60
    v_permlane32_swap_b32 v57, v61
    v_permlane32_swap_b32 v58, v62
    v_permlane32_swap_b32 v59, v63
    v_add_f32 v56, v56, v60
    v_add_f32 v57, v57, v61
    v_add_f32 v58, v58, v62
    v_add_f32 v59, v59, v63
    v_cvt_pk_bf16_f32 v68, v56, v57
    v_cvt_pk_bf16_f32 v69, v58, v59
    ds_write_b64 v10, v[68:69]
    s_waitcnt lgkmcnt(0)
    s_barrier
    ds_read_b64_tr_b16 v[68:69], v11 offset:0
    ds_read_b64_tr_b16 v[70:71], v11 offset:128
    ds_read_b64_tr_b16 v[72:73], v11 offset:1024
    ds_read_b64_tr_b16 v[74:75], v11 offset:1152
    ds_read_b64_tr_b16 v[76:77], v11 offset:2048
    ds_read_b64_tr_b16 v[78:79], v11 offset:2176
    ds_read_b128 v[80:83], v6 offset:0
    ds_read_b128 v[84:87], v6 offset:1024
    ds_read_b128 v[88:91], v6 offset:2048
    ds_read_b128 v[92:95], v6 offset:3072
    ds_read_b128 v[96:99], v6 offset:4096
    ds_read_b128 v[100:103], v6 offset:5120
    s_waitcnt lgkmcnt(10)
    v_smfmac_f32_16x16x64_bf16 v[16:19], v[68:71], a[240:247], v4
    v_smfmac_f32_16x16x64_bf16 v[20:23], v[68:71], v[112:119], v4
    v_smfmac_f32_16x16x64_bf16 v[24:27], v[68:71], v[136:143], v4
    v_smfmac_f32_16x16x64_bf16 v[28:31], v[68:71], v[160:167], v4
    s_waitcnt lgkmcnt(8)
    v_smfmac_f32_16x16x64_bf16 v[16:19], v[72:75], a[248:255], v4
    v_smfmac_f32_16x16x64_bf16 v[20:23], v[72:75], v[120:127], v4
    v_smfmac_f32_16x16x64_bf16 v[24:27], v[72:75], v[144:151], v4
    v_smfmac_f32_16x16x64_bf16 v[28:31], v[72:75], v[168:175], v4
    s_waitcnt lgkmcnt(6)
    v_smfmac_f32_16x16x64_bf16 v[16:19], v[76:79], v[104:111], v4
    v_smfmac_f32_16x16x64_bf16 v[20:23], v[76:79], v[128:135], v4
    v_smfmac_f32_16x16x64_bf16 v[24:27], v[76:79], v[152:159], v4
    v_smfmac_f32_16x16x64_bf16 v[28:31], v[76:79], v[176:183], v4
    v_smfmac_f32_16x16x64_bf16 v[32:35], v[68:71], v[184:191], v4
    v_smfmac_f32_16x16x64_bf16 v[36:39], v[68:71], v[208:215], v4
    s_nop 4
    v_permlane32_swap_b32 v16, v24
    v_permlane32_swap_b32 v17, v25
    v_smfmac_f32_16x16x64_bf16 v[40:43], v[68:71], v[232:239], v4
    v_permlane32_swap_b32 v18, v26
    v_permlane32_swap_b32 v19, v27
    s_waitcnt lgkmcnt(4)
    v_smfmac_f32_16x16x64_bf16 v[44:47], v[68:71], v[80:87], v4
    v_add_f32 v16, v16, v24
    v_add_f32 v17, v17, v25
    ds_read_b128 v[80:83], v6 offset:6144
    ds_read_b128 v[84:87], v6 offset:7168
    v_smfmac_f32_16x16x64_bf16 v[32:35], v[72:75], v[192:199], v4
    v_add_f32 v18, v18, v26
    v_add_f32 v19, v19, v27
    v_smfmac_f32_16x16x64_bf16 v[36:39], v[72:75], v[216:223], v4
    v_permlane32_swap_b32 v20, v28
    v_permlane32_swap_b32 v21, v29
    v_smfmac_f32_16x16x64_bf16 v[40:43], v[72:75], v[240:247], v4
    v_permlane32_swap_b32 v22, v30
    v_permlane32_swap_b32 v23, v31
    s_waitcnt lgkmcnt(4)
    v_smfmac_f32_16x16x64_bf16 v[44:47], v[72:75], v[88:95], v4
    v_add_f32 v20, v20, v28
    v_add_f32 v21, v21, v29
    ds_read_b128 v[88:91], v6 offset:8192
    ds_read_b128 v[92:95], v6 offset:9216
    v_smfmac_f32_16x16x64_bf16 v[32:35], v[76:79], v[200:207], v4
    v_add_f32 v22, v22, v30
    v_add_f32 v23, v23, v31
    v_smfmac_f32_16x16x64_bf16 v[36:39], v[76:79], v[224:231], v4
    v_cvt_pk_bf16_f32 v56, v16, v17
    v_cvt_pk_bf16_f32 v57, v18, v19
    v_smfmac_f32_16x16x64_bf16 v[40:43], v[76:79], v[248:255], v4
    v_cvt_pk_bf16_f32 v58, v20, v21
    v_cvt_pk_bf16_f32 v59, v22, v23
    s_waitcnt lgkmcnt(4)
    v_smfmac_f32_16x16x64_bf16 v[44:47], v[76:79], v[96:103], v4
    v_permlane16_swap_b32 v56, v58
    ds_read_b128 v[96:99], v6 offset:10240
    ds_read_b128 v[100:103], v6 offset:11264
    v_permlane16_swap_b32 v57, v59
    v_min_u32 v56, -2, v56
    v_min_u32 v57, -2, v57
    v_min_u32 v58, -2, v58
    v_min_u32 v59, -2, v59
    buffer_store_dwordx4 v[56:59], v14, s[8:11], s43 offen sc1
    s_add_u32 s49, s43, 65536
    s_waitcnt lgkmcnt(4)
    v_smfmac_f32_16x16x64_bf16 v[48:51], v[68:71], v[80:87], v4
    v_permlane32_swap_b32 v32, v40
    v_permlane32_swap_b32 v33, v41
    v_permlane32_swap_b32 v34, v42
    ds_read_b128 v[80:83], v6 offset:12288
    ds_read_b128 v[84:87], v6 offset:13312
    s_waitcnt lgkmcnt(4)
    v_smfmac_f32_16x16x64_bf16 v[48:51], v[72:75], v[88:95], v4
    v_permlane32_swap_b32 v35, v43
    v_add_f32 v32, v32, v40
    v_add_f32 v33, v33, v41
    v_add_f32 v34, v34, v42
    ds_read_b128 v[88:91], v6 offset:14336
    ds_read_b128 v[92:95], v6 offset:15360
    s_waitcnt lgkmcnt(4)
    v_smfmac_f32_16x16x64_bf16 v[48:51], v[76:79], v[96:103], v4
    v_add_f32 v35, v35, v43
    v_permlane32_swap_b32 v36, v44
    v_permlane32_swap_b32 v37, v45
    v_permlane32_swap_b32 v38, v46
    ds_read_b128 v[96:99], v6 offset:16384
    ds_read_b128 v[100:103], v6 offset:17408
    v_permlane32_swap_b32 v39, v47
    v_add_f32 v36, v36, v44
    v_add_f32 v37, v37, v45
    v_add_f32 v38, v38, v46
    s_waitcnt lgkmcnt(4)
    v_smfmac_f32_16x16x64_bf16 v[52:55], v[68:71], v[80:87], v4
    v_add_f32 v39, v39, v47
    v_cvt_pk_bf16_f32 v60, v32, v33
    v_cvt_pk_bf16_f32 v61, v34, v35
    s_waitcnt lgkmcnt(2)
    v_smfmac_f32_16x16x64_bf16 v[52:55], v[72:75], v[88:95], v4
    v_cvt_pk_bf16_f32 v62, v36, v37
    v_cvt_pk_bf16_f32 v63, v38, v39
    s_waitcnt lgkmcnt(0)
    v_smfmac_f32_16x16x64_bf16 v[52:55], v[76:79], v[96:103], v4
    v_permlane16_swap_b32 v60, v62
    v_permlane16_swap_b32 v61, v63
    v_min_u32 v60, -2, v60
    v_min_u32 v61, -2, v61
    v_min_u32 v62, -2, v62
    v_min_u32 v63, -2, v63
    buffer_store_dwordx4 v[60:63], v14, s[8:11], s49 offen sc1
    s_nop 0
    v_permlane32_swap_b32 v48, v52
    v_permlane32_swap_b32 v49, v53
    v_permlane32_swap_b32 v50, v54
    v_permlane32_swap_b32 v51, v55
    v_add_f32 v48, v48, v52
    v_add_f32 v49, v49, v53
    v_add_f32 v50, v50, v54
    v_add_f32 v51, v51, v55
    v_cvt_pk_bf16_f32 v64, v48, v49
    v_cvt_pk_bf16_f32 v65, v50, v51
    v_mov_b32 v66, v64
    v_mov_b32 v67, v65
    s_nop 0
    v_permlane16_swap_b32 v64, v66
    v_permlane16_swap_b32 v65, v67
    v_min_u32 v64, -2, v64
    v_min_u32 v65, -2, v65
    v_min_u32 v66, -2, v66
    v_min_u32 v67, -2, v67
    buffer_store_dwordx4 v[64:67], v15, s[8:11], s43 offen sc1
    s_add_u32 s40, s40, 1
    s_add_u32 s47, s37, 704512
    s_add_u32 s45, s37, 737280
    s_lshl_b32 s24, s40, 12
    s_and_b32 s24, s24, 0x2000
    s_xor_b32 s24, s24, s36
    s_lshl_b32 s37, s40, 20
    s_add_u32 s37, s37, s24
    s_add_u32 s37, s37, 117440512
    s_add_u32 s43, s37, 0
    s_cmp_lt_u32 s40, 64
    s_cbranch_scc1 interleave_layers__linear_attn_block__memory_aug_recurrent_mem_tr__prompt_kernel_v_stepw3
interleave_layers__linear_attn_block__memory_aug_recurrent_mem_tr__prompt_kernel_v_end:
    s_cmp_eq_u32 s92, 0
    s_cbranch_scc0 interleave_layers__linear_attn_block__memory_aug_recurrent_mem_tr__prompt_kernel_end
    s_mov_b32 s92, 1
    s_branch interleave_layers__linear_attn_block__memory_aug_recurrent_mem_tr__prompt_kernel_v_layer
interleave_layers__linear_attn_block__memory_aug_recurrent_mem_tr__prompt_kernel_roleR:
interleave_layers__linear_attn_block__memory_aug_recurrent_mem_tr__prompt_kernel_r_top:
    s_barrier
    s_sub_u32 s24, s2, 64
    s_cmp_ge_u32 s24, 24
    s_cbranch_scc1 interleave_layers__linear_attn_block__memory_aug_recurrent_mem_tr__prompt_kernel_rk24
    s_and_b32 s44, s24, 7
    s_lshr_b32 s45, s24, 3
    s_cmp_eq_u32 s92, 0
    s_cselect_b32 s46, 32, 2
    v_lshlrev_b32 v5, 4, v1
    s_mov_b32 s64, 12288
    s_cmp_eq_u32 s45, 1
    s_cselect_b32 s64, 5120, s64
    s_cmp_eq_u32 s45, 2
    s_cselect_b32 s64, 17408, s64
    s_mov_b32 s65, 1024
    s_cmp_eq_u32 s45, 1
    s_cselect_b32 s65, 7168, s65
    s_cmp_eq_u32 s45, 2
    s_cselect_b32 s65, 13312, s65
    s_mov_b32 s66, 0
    s_cmp_eq_u32 s45, 1
    s_cselect_b32 s66, 6144, s66
    s_cmp_eq_u32 s45, 2
    s_cselect_b32 s66, 14336, s66
    s_mov_b32 s67, 2048
    s_cmp_eq_u32 s45, 1
    s_cselect_b32 s67, 8192, s67
    s_cmp_eq_u32 s45, 2
    s_cselect_b32 s67, 15360, s67
    s_mov_b32 s68, 4096
    s_cmp_eq_u32 s45, 1
    s_cselect_b32 s68, 10240, s68
    s_cmp_eq_u32 s45, 2
    s_cselect_b32 s68, 16384, s68
    s_mov_b32 s69, 3072
    s_cmp_eq_u32 s45, 1
    s_cselect_b32 s69, 9216, s69
    s_cmp_eq_u32 s45, 2
    s_cselect_b32 s69, 16384, s69
    s_mov_b32 s70, 3072
    s_cmp_eq_u32 s45, 1
    s_cselect_b32 s70, 11264, s70
    s_cmp_eq_u32 s45, 2
    s_cselect_b32 s70, 16384, s70
    s_lshl_b32 s24, s92, 3
    s_add_u32 s24, s24, s44
    s_lshl_b32 s24, s24, 7
    s_add_u32 s24, s24, 23101440
    v_lshlrev_b32 v15, 2, v1
    v_add_u32 v15, s24, v15
    s_cmp_eq_u32 s92, 0
    s_cselect_b32 s26, -1, 3
    s_mov_b32 s61, 0
interleave_layers__linear_attn_block__memory_aug_recurrent_mem_tr__prompt_kernel_k2_w:
    buffer_load_dword v14, v15, s[8:11], 0 offen sc1
    s_waitcnt vmcnt(0)
    v_cmp_le_i32 vcc, 1, v14
    s_and_b32 s24, vcc_lo, s26
    s_cmp_eq_u32 s24, s26
    s_cbranch_scc1 interleave_layers__linear_attn_block__memory_aug_recurrent_mem_tr__prompt_kernel_k2_w_ok
    s_add_u32 s61, s61, 1
    s_cmp_ge_u32 s61, s60
    s_cbranch_scc1 interleave_layers__linear_attn_block__memory_aug_recurrent_mem_tr__prompt_kernel_k2_w_to
    s_sleep 2
    s_branch interleave_layers__linear_attn_block__memory_aug_recurrent_mem_tr__prompt_kernel_k2_w
interleave_layers__linear_attn_block__memory_aug_recurrent_mem_tr__prompt_kernel_k2_w_to:
    s_mov_b32 s60, 1
interleave_layers__linear_attn_block__memory_aug_recurrent_mem_tr__prompt_kernel_k2_w_ok:
    s_add_u32 s25, s3, 0
    s_mul_i32 s24, s25, 147456
    s_mul_i32 s26, s44, 18432
    s_add_u32 s24, s24, s26
    s_add_u32 s24, s24, 16777216
    s_cmp_lt_u32 s25, s46
    s_cselect_b32 s24, s24, 2146435072
    s_add_u32 s26, s24, s64
    buffer_load_dwordx4 v[16:19], v5, s[8:11], s26 offen sc1
    s_add_u32 s26, s24, s65
    buffer_load_dwordx4 v[20:23], v5, s[8:11], s26 offen sc1
    s_add_u32 s26, s24, s66
    buffer_load_dwordx4 v[24:27], v5, s[8:11], s26 offen sc1
    s_add_u32 s26, s24, s67
    buffer_load_dwordx4 v[28:31], v5, s[8:11], s26 offen sc1
    s_add_u32 s26, s24, s68
    buffer_load_dwordx4 v[32:35], v5, s[8:11], s26 offen sc1
    s_add_u32 s26, s24, s69
    buffer_load_dwordx4 v[36:39], v5, s[8:11], s26 offen sc1
    s_add_u32 s26, s24, s70
    buffer_load_dwordx4 v[40:43], v5, s[8:11], s26 offen sc1
    s_add_u32 s25, s3, 4
    s_mul_i32 s24, s25, 147456
    s_mul_i32 s26, s44, 18432
    s_add_u32 s24, s24, s26
    s_add_u32 s24, s24, 16777216
    s_cmp_lt_u32 s25, s46
    s_cselect_b32 s24, s24, 2146435072
    s_add_u32 s26, s24, s64
    buffer_load_dwordx4 v[44:47], v5, s[8:11], s26 offen sc1
    s_add_u32 s26, s24, s65
    buffer_load_dwordx4 v[48:51], v5, s[8:11], s26 offen sc1
    s_add_u32 s26, s24, s66
    buffer_load_dwordx4 v[52:55], v5, s[8:11], s26 offen sc1
    s_add_u32 s26, s24, s67
    buffer_load_dwordx4 v[56:59], v5, s[8:11], s26 offen sc1
    s_add_u32 s26, s24, s68
    buffer_load_dwordx4 v[60:63], v5, s[8:11], s26 offen sc1
    s_add_u32 s26, s24, s69
    buffer_load_dwordx4 v[64:67], v5, s[8:11], s26 offen sc1
    s_add_u32 s26, s24, s70
    buffer_load_dwordx4 v[68:71], v5, s[8:11], s26 offen sc1
    s_add_u32 s25, s3, 8
    s_mul_i32 s24, s25, 147456
    s_mul_i32 s26, s44, 18432
    s_add_u32 s24, s24, s26
    s_add_u32 s24, s24, 16777216
    s_cmp_lt_u32 s25, s46
    s_cselect_b32 s24, s24, 2146435072
    s_add_u32 s26, s24, s64
    buffer_load_dwordx4 v[72:75], v5, s[8:11], s26 offen sc1
    s_add_u32 s26, s24, s65
    buffer_load_dwordx4 v[76:79], v5, s[8:11], s26 offen sc1
    s_add_u32 s26, s24, s66
    buffer_load_dwordx4 v[80:83], v5, s[8:11], s26 offen sc1
    s_add_u32 s26, s24, s67
    buffer_load_dwordx4 v[84:87], v5, s[8:11], s26 offen sc1
    s_add_u32 s26, s24, s68
    buffer_load_dwordx4 v[88:91], v5, s[8:11], s26 offen sc1
    s_add_u32 s26, s24, s69
    buffer_load_dwordx4 v[92:95], v5, s[8:11], s26 offen sc1
    s_add_u32 s26, s24, s70
    buffer_load_dwordx4 v[96:99], v5, s[8:11], s26 offen sc1
    s_add_u32 s25, s3, 12
    s_mul_i32 s24, s25, 147456
    s_mul_i32 s26, s44, 18432
    s_add_u32 s24, s24, s26
    s_add_u32 s24, s24, 16777216
    s_cmp_lt_u32 s25, s46
    s_cselect_b32 s24, s24, 2146435072
    s_add_u32 s26, s24, s64
    buffer_load_dwordx4 v[100:103], v5, s[8:11], s26 offen sc1
    s_add_u32 s26, s24, s65
    buffer_load_dwordx4 v[104:107], v5, s[8:11], s26 offen sc1
    s_add_u32 s26, s24, s66
    buffer_load_dwordx4 v[108:111], v5, s[8:11], s26 offen sc1
    s_add_u32 s26, s24, s67
    buffer_load_dwordx4 v[112:115], v5, s[8:11], s26 offen sc1
    s_add_u32 s26, s24, s68
    buffer_load_dwordx4 v[116:119], v5, s[8:11], s26 offen sc1
    s_add_u32 s26, s24, s69
    buffer_load_dwordx4 v[120:123], v5, s[8:11], s26 offen sc1
    s_add_u32 s26, s24, s70
    buffer_load_dwordx4 v[124:127], v5, s[8:11], s26 offen sc1
    s_add_u32 s25, s3, 16
    s_mul_i32 s24, s25, 147456
    s_mul_i32 s26, s44, 18432
    s_add_u32 s24, s24, s26
    s_add_u32 s24, s24, 16777216
    s_cmp_lt_u32 s25, s46
    s_cselect_b32 s24, s24, 2146435072
    s_add_u32 s26, s24, s64
    buffer_load_dwordx4 v[128:131], v5, s[8:11], s26 offen sc1
    s_add_u32 s26, s24, s65
    buffer_load_dwordx4 v[132:135], v5, s[8:11], s26 offen sc1
    s_add_u32 s26, s24, s66
    buffer_load_dwordx4 v[136:139], v5, s[8:11], s26 offen sc1
    s_add_u32 s26, s24, s67
    buffer_load_dwordx4 v[140:143], v5, s[8:11], s26 offen sc1
    s_add_u32 s26, s24, s68
    buffer_load_dwordx4 v[144:147], v5, s[8:11], s26 offen sc1
    s_add_u32 s26, s24, s69
    buffer_load_dwordx4 v[148:151], v5, s[8:11], s26 offen sc1
    s_add_u32 s26, s24, s70
    buffer_load_dwordx4 v[152:155], v5, s[8:11], s26 offen sc1
    s_add_u32 s25, s3, 20
    s_mul_i32 s24, s25, 147456
    s_mul_i32 s26, s44, 18432
    s_add_u32 s24, s24, s26
    s_add_u32 s24, s24, 16777216
    s_cmp_lt_u32 s25, s46
    s_cselect_b32 s24, s24, 2146435072
    s_add_u32 s26, s24, s64
    buffer_load_dwordx4 v[156:159], v5, s[8:11], s26 offen sc1
    s_add_u32 s26, s24, s65
    buffer_load_dwordx4 v[160:163], v5, s[8:11], s26 offen sc1
    s_add_u32 s26, s24, s66
    buffer_load_dwordx4 v[164:167], v5, s[8:11], s26 offen sc1
    s_add_u32 s26, s24, s67
    buffer_load_dwordx4 v[168:171], v5, s[8:11], s26 offen sc1
    s_add_u32 s26, s24, s68
    buffer_load_dwordx4 v[172:175], v5, s[8:11], s26 offen sc1
    s_add_u32 s26, s24, s69
    buffer_load_dwordx4 v[176:179], v5, s[8:11], s26 offen sc1
    s_add_u32 s26, s24, s70
    buffer_load_dwordx4 v[180:183], v5, s[8:11], s26 offen sc1
    s_add_u32 s25, s3, 24
    s_mul_i32 s24, s25, 147456
    s_mul_i32 s26, s44, 18432
    s_add_u32 s24, s24, s26
    s_add_u32 s24, s24, 16777216
    s_cmp_lt_u32 s25, s46
    s_cselect_b32 s24, s24, 2146435072
    s_add_u32 s26, s24, s64
    buffer_load_dwordx4 v[184:187], v5, s[8:11], s26 offen sc1
    s_add_u32 s26, s24, s65
    buffer_load_dwordx4 v[188:191], v5, s[8:11], s26 offen sc1
    s_add_u32 s26, s24, s66
    buffer_load_dwordx4 v[192:195], v5, s[8:11], s26 offen sc1
    s_add_u32 s26, s24, s67
    buffer_load_dwordx4 v[196:199], v5, s[8:11], s26 offen sc1
    s_add_u32 s26, s24, s68
    buffer_load_dwordx4 v[200:203], v5, s[8:11], s26 offen sc1
    s_add_u32 s26, s24, s69
    buffer_load_dwordx4 v[204:207], v5, s[8:11], s26 offen sc1
    s_add_u32 s26, s24, s70
    buffer_load_dwordx4 v[208:211], v5, s[8:11], s26 offen sc1
    s_add_u32 s25, s3, 28
    s_mul_i32 s24, s25, 147456
    s_mul_i32 s26, s44, 18432
    s_add_u32 s24, s24, s26
    s_add_u32 s24, s24, 16777216
    s_cmp_lt_u32 s25, s46
    s_cselect_b32 s24, s24, 2146435072
    s_add_u32 s26, s24, s64
    buffer_load_dwordx4 v[212:215], v5, s[8:11], s26 offen sc1
    s_add_u32 s26, s24, s65
    buffer_load_dwordx4 v[216:219], v5, s[8:11], s26 offen sc1
    s_add_u32 s26, s24, s66
    buffer_load_dwordx4 v[220:223], v5, s[8:11], s26 offen sc1
    s_add_u32 s26, s24, s67
    buffer_load_dwordx4 v[224:227], v5, s[8:11], s26 offen sc1
    s_add_u32 s26, s24, s68
    buffer_load_dwordx4 v[228:231], v5, s[8:11], s26 offen sc1
    s_add_u32 s26, s24, s69
    buffer_load_dwordx4 v[232:235], v5, s[8:11], s26 offen sc1
    s_add_u32 s26, s24, s70
    buffer_load_dwordx4 v[236:239], v5, s[8:11], s26 offen sc1
    s_waitcnt vmcnt(42)
    v_pk_add_f32 v[16:17], v[16:17], v[44:45]
    v_pk_add_f32 v[18:19], v[18:19], v[46:47]
    v_pk_add_f32 v[20:21], v[20:21], v[48:49]
    v_pk_add_f32 v[22:23], v[22:23], v[50:51]
    v_pk_add_f32 v[24:25], v[24:25], v[52:53]
    v_pk_add_f32 v[26:27], v[26:27], v[54:55]
    v_pk_add_f32 v[28:29], v[28:29], v[56:57]
    v_pk_add_f32 v[30:31], v[30:31], v[58:59]
    v_pk_add_f32 v[32:33], v[32:33], v[60:61]
    v_pk_add_f32 v[34:35], v[34:35], v[62:63]
    v_pk_add_f32 v[36:37], v[36:37], v[64:65]
    v_pk_add_f32 v[38:39], v[38:39], v[66:67]
    v_pk_add_f32 v[40:41], v[40:41], v[68:69]
    v_pk_add_f32 v[42:43], v[42:43], v[70:71]
    s_waitcnt vmcnt(35)
    v_pk_add_f32 v[16:17], v[16:17], v[72:73]
    v_pk_add_f32 v[18:19], v[18:19], v[74:75]
    v_pk_add_f32 v[20:21], v[20:21], v[76:77]
    v_pk_add_f32 v[22:23], v[22:23], v[78:79]
    v_pk_add_f32 v[24:25], v[24:25], v[80:81]
    v_pk_add_f32 v[26:27], v[26:27], v[82:83]
    v_pk_add_f32 v[28:29], v[28:29], v[84:85]
    v_pk_add_f32 v[30:31], v[30:31], v[86:87]
    v_pk_add_f32 v[32:33], v[32:33], v[88:89]
    v_pk_add_f32 v[34:35], v[34:35], v[90:91]
    v_pk_add_f32 v[36:37], v[36:37], v[92:93]
    v_pk_add_f32 v[38:39], v[38:39], v[94:95]
    v_pk_add_f32 v[40:41], v[40:41], v[96:97]
    v_pk_add_f32 v[42:43], v[42:43], v[98:99]
    s_waitcnt vmcnt(28)
    v_pk_add_f32 v[16:17], v[16:17], v[100:101]
    v_pk_add_f32 v[18:19], v[18:19], v[102:103]
    v_pk_add_f32 v[20:21], v[20:21], v[104:105]
    v_pk_add_f32 v[22:23], v[22:23], v[106:107]
    v_pk_add_f32 v[24:25], v[24:25], v[108:109]
    v_pk_add_f32 v[26:27], v[26:27], v[110:111]
    v_pk_add_f32 v[28:29], v[28:29], v[112:113]
    v_pk_add_f32 v[30:31], v[30:31], v[114:115]
    v_pk_add_f32 v[32:33], v[32:33], v[116:117]
    v_pk_add_f32 v[34:35], v[34:35], v[118:119]
    v_pk_add_f32 v[36:37], v[36:37], v[120:121]
    v_pk_add_f32 v[38:39], v[38:39], v[122:123]
    v_pk_add_f32 v[40:41], v[40:41], v[124:125]
    v_pk_add_f32 v[42:43], v[42:43], v[126:127]
    s_waitcnt vmcnt(21)
    v_pk_add_f32 v[16:17], v[16:17], v[128:129]
    v_pk_add_f32 v[18:19], v[18:19], v[130:131]
    v_pk_add_f32 v[20:21], v[20:21], v[132:133]
    v_pk_add_f32 v[22:23], v[22:23], v[134:135]
    v_pk_add_f32 v[24:25], v[24:25], v[136:137]
    v_pk_add_f32 v[26:27], v[26:27], v[138:139]
    v_pk_add_f32 v[28:29], v[28:29], v[140:141]
    v_pk_add_f32 v[30:31], v[30:31], v[142:143]
    v_pk_add_f32 v[32:33], v[32:33], v[144:145]
    v_pk_add_f32 v[34:35], v[34:35], v[146:147]
    v_pk_add_f32 v[36:37], v[36:37], v[148:149]
    v_pk_add_f32 v[38:39], v[38:39], v[150:151]
    v_pk_add_f32 v[40:41], v[40:41], v[152:153]
    v_pk_add_f32 v[42:43], v[42:43], v[154:155]
    s_waitcnt vmcnt(14)
    v_pk_add_f32 v[16:17], v[16:17], v[156:157]
    v_pk_add_f32 v[18:19], v[18:19], v[158:159]
    v_pk_add_f32 v[20:21], v[20:21], v[160:161]
    v_pk_add_f32 v[22:23], v[22:23], v[162:163]
    v_pk_add_f32 v[24:25], v[24:25], v[164:165]
    v_pk_add_f32 v[26:27], v[26:27], v[166:167]
    v_pk_add_f32 v[28:29], v[28:29], v[168:169]
    v_pk_add_f32 v[30:31], v[30:31], v[170:171]
    v_pk_add_f32 v[32:33], v[32:33], v[172:173]
    v_pk_add_f32 v[34:35], v[34:35], v[174:175]
    v_pk_add_f32 v[36:37], v[36:37], v[176:177]
    v_pk_add_f32 v[38:39], v[38:39], v[178:179]
    v_pk_add_f32 v[40:41], v[40:41], v[180:181]
    v_pk_add_f32 v[42:43], v[42:43], v[182:183]
    s_waitcnt vmcnt(7)
    v_pk_add_f32 v[16:17], v[16:17], v[184:185]
    v_pk_add_f32 v[18:19], v[18:19], v[186:187]
    v_pk_add_f32 v[20:21], v[20:21], v[188:189]
    v_pk_add_f32 v[22:23], v[22:23], v[190:191]
    v_pk_add_f32 v[24:25], v[24:25], v[192:193]
    v_pk_add_f32 v[26:27], v[26:27], v[194:195]
    v_pk_add_f32 v[28:29], v[28:29], v[196:197]
    v_pk_add_f32 v[30:31], v[30:31], v[198:199]
    v_pk_add_f32 v[32:33], v[32:33], v[200:201]
    v_pk_add_f32 v[34:35], v[34:35], v[202:203]
    v_pk_add_f32 v[36:37], v[36:37], v[204:205]
    v_pk_add_f32 v[38:39], v[38:39], v[206:207]
    v_pk_add_f32 v[40:41], v[40:41], v[208:209]
    v_pk_add_f32 v[42:43], v[42:43], v[210:211]
    s_waitcnt vmcnt(0)
    v_pk_add_f32 v[16:17], v[16:17], v[212:213]
    v_pk_add_f32 v[18:19], v[18:19], v[214:215]
    v_pk_add_f32 v[20:21], v[20:21], v[216:217]
    v_pk_add_f32 v[22:23], v[22:23], v[218:219]
    v_pk_add_f32 v[24:25], v[24:25], v[220:221]
    v_pk_add_f32 v[26:27], v[26:27], v[222:223]
    v_pk_add_f32 v[28:29], v[28:29], v[224:225]
    v_pk_add_f32 v[30:31], v[30:31], v[226:227]
    v_pk_add_f32 v[32:33], v[32:33], v[228:229]
    v_pk_add_f32 v[34:35], v[34:35], v[230:231]
    v_pk_add_f32 v[36:37], v[36:37], v[232:233]
    v_pk_add_f32 v[38:39], v[38:39], v[234:235]
    v_pk_add_f32 v[40:41], v[40:41], v[236:237]
    v_pk_add_f32 v[42:43], v[42:43], v[238:239]
    s_mul_i32 s24, s3, 7168
    v_add_u32 v6, s24, v5
    ds_write_b128 v6, v[16:19] offset:0
    ds_write_b128 v6, v[20:23] offset:1024
    ds_write_b128 v6, v[24:27] offset:2048
    ds_write_b128 v6, v[28:31] offset:3072
    ds_write_b128 v6, v[32:35] offset:4096
    ds_write_b128 v6, v[36:39] offset:5120
    ds_write_b128 v6, v[40:43] offset:6144
    s_waitcnt lgkmcnt(0)
    s_barrier
    s_mov_b32 s41, 0
    s_cmp_eq_u32 s45, 1
    s_cselect_b32 s41, 4, s41
    s_cmp_eq_u32 s45, 2
    s_cselect_b32 s41, 9, s41
    s_mov_b32 s42, 4
    s_cmp_eq_u32 s45, 1
    s_cselect_b32 s42, 5, s42
    s_cmp_eq_u32 s45, 2
    s_cselect_b32 s42, 5, s42
    s_mul_i32 s43, s92, 131072
    s_mul_i32 s24, s44, 14336
    s_add_u32 s43, s43, s24
    s_add_u32 s43, s43, 22020096
    v_and_b32 v7, 3, v2
    v_lshrrev_b32 v8, 2, v2
    s_add_u32 s40, s3, 0
    s_cmp_lt_u32 s40, s42
    s_cbranch_scc0 interleave_layers__linear_attn_block__memory_aug_recurrent_mem_tr__prompt_kernel_k2f25
    s_add_u32 s40, s40, s41
    s_mov_b32 s47, 67633672
    s_cmp_eq_u32 s40, 1
    s_cselect_b32 s47, 67699226, s47
    s_cmp_eq_u32 s40, 2
    s_cselect_b32 s47, 67702404, s47
    s_cmp_eq_u32 s40, 3
    s_cselect_b32 s47, 67765224, s47
    s_cmp_eq_u32 s40, 4
    s_cselect_b32 s47, 67765896, s47
    s_cmp_eq_u32 s40, 5
    s_cselect_b32 s47, 67831450, s47
    s_cmp_eq_u32 s40, 6
    s_cselect_b32 s47, 67833604, s47
    s_cmp_eq_u32 s40, 7
    s_cselect_b32 s47, 67897320, s47
    s_cmp_eq_u32 s40, 8
    s_cselect_b32 s47, 67899142, s47
    s_cmp_eq_u32 s40, 9
    s_cselect_b32 s47, 75497992, s47
    s_cmp_eq_u32 s40, 10
    s_cselect_b32 s47, 75499162, s47
    s_cmp_eq_u32 s40, 11
    s_cselect_b32 s47, 75501316, s47
    s_cmp_eq_u32 s40, 12
    s_cselect_b32 s47, 247768, s47
    s_cmp_eq_u32 s40, 13
    s_cselect_b32 s47, 249604, s47
    s_bfe_u32 s24, s47, 0x7000c
    s_bfe_u32 s25, s47, 0x50013
    s_bfe_u32 s26, s47, 0x30018
    v_mul_u32_u24 v9, s25, v7
    v_mul_u32_u24 v10, s26, v8
    v_add3_u32 v9, v9, v10, s24
    v_mul_u32_u24 v9, 205, v9
    v_lshrrev_b32 v9, 12, v9
    s_bfe_u32 s24, s47, 196608
    s_lshl_b32 s24, s24, 10
    v_add_u32 v10, s24, v5
    ds_read_b128 v[160:163], v10 offset:0
    ds_read_b128 v[164:167], v10 offset:7168
    ds_read_b128 v[168:171], v10 offset:14336
    ds_read_b128 v[172:175], v10 offset:21504
    s_bfe_u32 s25, s47, 196614
    s_lshl_b32 s25, s25, 4
    v_lshl_add_u32 v11, v3, 2, s25
    v_mul_u32_u24 v11, 205, v11
    v_lshrrev_b32 v11, 12, v11
    v_cmp_eq_u32 vcc, v9, v11
    s_waitcnt lgkmcnt(0)
    v_pk_add_f32 v[160:161], v[160:161], v[164:165]
    v_pk_add_f32 v[168:169], v[168:169], v[172:173]
    v_pk_add_f32 v[162:163], v[162:163], v[166:167]
    v_pk_add_f32 v[170:171], v[170:171], v[174:175]
    v_pk_add_f32 v[160:161], v[160:161], v[168:169]
    v_pk_add_f32 v[162:163], v[162:163], v[170:171]
    v_cvt_pk_bf16_f32 v176, v160, v161
    v_cvt_pk_bf16_f32 v177, v162, v163
    v_cndmask_b32 v176, 0, v176, vcc
    v_cndmask_b32 v177, 0, v177, vcc
    s_bfe_u32 s24, s47, 196611
    s_lshl_b32 s24, s24, 10
    v_add_u32 v10, s24, v5
    ds_read_b128 v[160:163], v10 offset:0
    ds_read_b128 v[164:167], v10 offset:7168
    ds_read_b128 v[168:171], v10 offset:14336
    ds_read_b128 v[172:175], v10 offset:21504
    s_bfe_u32 s25, s47, 196617
    s_lshl_b32 s25, s25, 4
    v_lshl_add_u32 v11, v3, 2, s25
    v_mul_u32_u24 v11, 205, v11
    v_lshrrev_b32 v11, 12, v11
    v_cmp_eq_u32 vcc, v9, v11
    s_waitcnt lgkmcnt(0)
    v_pk_add_f32 v[160:161], v[160:161], v[164:165]
    v_pk_add_f32 v[168:169], v[168:169], v[172:173]
    v_pk_add_f32 v[162:163], v[162:163], v[166:167]
    v_pk_add_f32 v[170:171], v[170:171], v[174:175]
    v_pk_add_f32 v[160:161], v[160:161], v[168:169]
    v_pk_add_f32 v[162:163], v[162:163], v[170:171]
    v_cvt_pk_bf16_f32 v178, v160, v161
    v_cvt_pk_bf16_f32 v179, v162, v163
    v_cndmask_b32 v178, 0, v178, vcc
    v_cndmask_b32 v179, 0, v179, vcc
    s_lshl_b32 s24, s40, 10
    s_add_u32 s24, s24, s43
    buffer_store_dwordx4 v[176:179], v5, s[8:11], s24 offen sc1
interleave_layers__linear_attn_block__memory_aug_recurrent_mem_tr__prompt_kernel_k2f25:
    s_add_u32 s40, s3, 4
    s_cmp_lt_u32 s40, s42
    s_cbranch_scc0 interleave_layers__linear_attn_block__memory_aug_recurrent_mem_tr__prompt_kernel_k2f26
    s_add_u32 s40, s40, s41
    s_mov_b32 s47, 67633672
    s_cmp_eq_u32 s40, 1
    s_cselect_b32 s47, 67699226, s47
    s_cmp_eq_u32 s40, 2
    s_cselect_b32 s47, 67702404, s47
    s_cmp_eq_u32 s40, 3
    s_cselect_b32 s47, 67765224, s47
    s_cmp_eq_u32 s40, 4
    s_cselect_b32 s47, 67765896, s47
    s_cmp_eq_u32 s40, 5
    s_cselect_b32 s47, 67831450, s47
    s_cmp_eq_u32 s40, 6
    s_cselect_b32 s47, 67833604, s47
    s_cmp_eq_u32 s40, 7
    s_cselect_b32 s47, 67897320, s47
    s_cmp_eq_u32 s40, 8
    s_cselect_b32 s47, 67899142, s47
    s_cmp_eq_u32 s40, 9
    s_cselect_b32 s47, 75497992, s47
    s_cmp_eq_u32 s40, 10
    s_cselect_b32 s47, 75499162, s47
    s_cmp_eq_u32 s40, 11
    s_cselect_b32 s47, 75501316, s47
    s_cmp_eq_u32 s40, 12
    s_cselect_b32 s47, 247768, s47
    s_cmp_eq_u32 s40, 13
    s_cselect_b32 s47, 249604, s47
    s_bfe_u32 s24, s47, 0x7000c
    s_bfe_u32 s25, s47, 0x50013
    s_bfe_u32 s26, s47, 0x30018
    v_mul_u32_u24 v9, s25, v7
    v_mul_u32_u24 v10, s26, v8
    v_add3_u32 v9, v9, v10, s24
    v_mul_u32_u24 v9, 205, v9
    v_lshrrev_b32 v9, 12, v9
    s_bfe_u32 s24, s47, 196608
    s_lshl_b32 s24, s24, 10
    v_add_u32 v10, s24, v5
    ds_read_b128 v[160:163], v10 offset:0
    ds_read_b128 v[164:167], v10 offset:7168
    ds_read_b128 v[168:171], v10 offset:14336
    ds_read_b128 v[172:175], v10 offset:21504
    s_bfe_u32 s25, s47, 196614
    s_lshl_b32 s25, s25, 4
    v_lshl_add_u32 v11, v3, 2, s25
    v_mul_u32_u24 v11, 205, v11
    v_lshrrev_b32 v11, 12, v11
    v_cmp_eq_u32 vcc, v9, v11
    s_waitcnt lgkmcnt(0)
    v_pk_add_f32 v[160:161], v[160:161], v[164:165]
    v_pk_add_f32 v[168:169], v[168:169], v[172:173]
    v_pk_add_f32 v[162:163], v[162:163], v[166:167]
    v_pk_add_f32 v[170:171], v[170:171], v[174:175]
    v_pk_add_f32 v[160:161], v[160:161], v[168:169]
    v_pk_add_f32 v[162:163], v[162:163], v[170:171]
    v_cvt_pk_bf16_f32 v176, v160, v161
    v_cvt_pk_bf16_f32 v177, v162, v163
    v_cndmask_b32 v176, 0, v176, vcc
    v_cndmask_b32 v177, 0, v177, vcc
    s_bfe_u32 s24, s47, 196611
    s_lshl_b32 s24, s24, 10
    v_add_u32 v10, s24, v5
    ds_read_b128 v[160:163], v10 offset:0
    ds_read_b128 v[164:167], v10 offset:7168
    ds_read_b128 v[168:171], v10 offset:14336
    ds_read_b128 v[172:175], v10 offset:21504
    s_bfe_u32 s25, s47, 196617
    s_lshl_b32 s25, s25, 4
    v_lshl_add_u32 v11, v3, 2, s25
    v_mul_u32_u24 v11, 205, v11
    v_lshrrev_b32 v11, 12, v11
    v_cmp_eq_u32 vcc, v9, v11
    s_waitcnt lgkmcnt(0)
    v_pk_add_f32 v[160:161], v[160:161], v[164:165]
    v_pk_add_f32 v[168:169], v[168:169], v[172:173]
    v_pk_add_f32 v[162:163], v[162:163], v[166:167]
    v_pk_add_f32 v[170:171], v[170:171], v[174:175]
    v_pk_add_f32 v[160:161], v[160:161], v[168:169]
    v_pk_add_f32 v[162:163], v[162:163], v[170:171]
    v_cvt_pk_bf16_f32 v178, v160, v161
    v_cvt_pk_bf16_f32 v179, v162, v163
    v_cndmask_b32 v178, 0, v178, vcc
    v_cndmask_b32 v179, 0, v179, vcc
    s_lshl_b32 s24, s40, 10
    s_add_u32 s24, s24, s43
    buffer_store_dwordx4 v[176:179], v5, s[8:11], s24 offen sc1
interleave_layers__linear_attn_block__memory_aug_recurrent_mem_tr__prompt_kernel_k2f26:
    s_waitcnt vmcnt(0)
    s_barrier
    s_lshl_b32 s24, s92, 7
    s_sub_u32 s25, s2, 64
    s_lshl_b32 s25, s25, 2
    s_add_u32 s24, s24, s25
    s_add_u32 s24, s24, 23103488
    s_cmp_eq_u32 s3, 0
    s_cbranch_scc0 interleave_layers__linear_attn_block__memory_aug_recurrent_mem_tr__prompt_kernel_pb27
    v_lshlrev_b32 v14, 7, v1
    v_add_u32 v14, s24, v14
    v_mov_b32 v15, 2146435072
    v_cmp_le_u32 vcc, 1, v1
    s_nop 1
    v_cndmask_b32 v14, v14, v15, vcc
    v_mov_b32 v15, 1
    buffer_store_dword v15, v14, s[8:11], 0 offen sc1
interleave_layers__linear_attn_block__memory_aug_recurrent_mem_tr__prompt_kernel_pb27:
interleave_layers__linear_attn_block__memory_aug_recurrent_mem_tr__prompt_kernel_rk24:
    s_sub_u32 s44, s2, 64
    v_lshlrev_b32 v5, 4, v1
    s_lshl_b32 s24, s44, 15
    s_lshl_b32 s25, s3, 13
    s_add_u32 s24, s24, s25
    v_add_u32 v6, s24, v5
    v_add_u32 v7, 4096, v6
    s_lshl_b32 s24, s3, 12
    s_and_b32 s25, s24, 0x2000
    s_add_u32 s24, s24, s25
    v_add_u32 v8, s24, v5
    s_lshl_b32 s24, s3, 10
    s_add_u32 s24, s24, 32768
    v_add_u32 v9, s24, v5
    s_lshl_b32 s24, s44, 14
    s_lshl_b32 s25, s3, 11
    s_add_u32 s24, s24, s25
    v_add_u32 v10, s24, v5
    v_and_b32 v204, 7, v2
    v_mul_u32_u24 v11, 80, v204
    v_lshl_add_u32 v11, v3, 4, v11
    s_mul_i32 s24, s3, 640
    v_add_u32 v11, s24, v11
    v_add_u32 v204, 8192, v5
    v_cmp_gt_u32 vcc, 8, v2
    s_nop 1
    v_cndmask_b32 v11, v204, v11, vcc
    v_and_b32 v204, 7, v2
    v_mul_u32_u24 v12, 80, v204
    v_lshrrev_b32 v204, 3, v2
    v_lshl_add_u32 v12, v204, 5, v12
    v_lshlrev_b32 v13, 4, v2
    s_lshl_b32 s24, s44, 8
    s_and_b32 s25, s24, 0x2000
    s_add_u32 s24, s24, s25
    v_add_u32 v13, s24, v13
    v_mov_b32 v204, 2146435072
    v_cmp_gt_u32 vcc, 1, v3
    s_nop 1
    v_cndmask_b32 v13, v204, v13, vcc
    v_cmp_le_u32 s[50:51], 8, v2
    s_and_b32 s25, s44, 15
    s_lshr_b32 s25, s25, 2
    s_sub_u32 s26, s44, 32
    s_lshr_b32 s26, s26, 1
    s_cmp_ge_u32 s44, 32
    s_cselect_b32 s25, s26, s25
    s_mul_i32 s24, s25, 16
    v_add_u32 v120, s24, v1
    v_lshlrev_b32 v120, 7, v120
    v_mov_b32 v204, 2146435072
    v_cmp_le_u32 vcc, 16, v1
    s_nop 1
    v_cndmask_b32 v120, v120, v204, vcc
    s_and_b32 s24, s44, 7
    s_mul_i32 s25, s3, 8
    s_add_u32 s24, s24, s25
    s_lshl_b32 s24, s24, 7
    v_mov_b32 v125, s24
    v_mov_b32 v122, 12288
    v_mov_b32 v123, 0
    s_barrier
    ds_write_b32 v122, v123
    v_mov_b32 v123, 1
    s_waitcnt lgkmcnt(0)
    s_barrier
    s_mov_b32 s93, 0
    s_lshl_b32 s24, s93, 12
    s_and_b32 s24, s24, 0x2000
    s_xor_b32 s24, s24, s36
    s_lshl_b32 s93, s93, 20
    s_add_u32 s93, s93, s24
    s_add_u32 s93, s93, 117440512
    s_mul_i32 s94, s92, 16384
    s_add_u32 s94, s94, 23068672
    s_mov_b32 s40, 0
    s_mov_b32 s41, 184549376
    s_add_u32 s45, s93, 753664
    s_add_u32 s46, s93, 737280
    s_add_u32 s43, s93, 655360
    s_add_u32 s42, s93, 0
    s_add_u32 s47, s93, 704512
    v_and_b32 v252, 7, v1
    v_lshlrev_b32 v252, 7, v252
    s_lshl_b32 s24, s3, 10
    s_add_u32 s24, s24, 12288
    s_add_u32 s24, s24, s94
    v_add_u32 v252, s24, v252
    s_mov_b32 s62, -1
    s_mov_b32 s63, 1
    s_cmp_ge_i32 s62, s63
    s_cbranch_scc1 interleave_layers__linear_attn_block__memory_aug_recurrent_mem_tr__prompt_kernel_r_en0_ok
    s_mov_b32 s61, 0
interleave_layers__linear_attn_block__memory_aug_recurrent_mem_tr__prompt_kernel_r_en0:
    buffer_load_dword v253, v252, s[8:11], 0 offen sc1
    s_waitcnt vmcnt(0)
    v_readlane_b32 s62, v253, 0
    v_readlane_b32 s24, v253, 1
    s_min_i32 s62, s62, s24
    v_readlane_b32 s24, v253, 2
    s_min_i32 s62, s62, s24
    v_readlane_b32 s24, v253, 3
    s_min_i32 s62, s62, s24
    v_readlane_b32 s24, v253, 4
    s_min_i32 s62, s62, s24
    v_readlane_b32 s24, v253, 5
    s_min_i32 s62, s62, s24
    v_readlane_b32 s24, v253, 6
    s_min_i32 s62, s62, s24
    v_readlane_b32 s24, v253, 7
    s_min_i32 s62, s62, s24
    s_cmp_ge_i32 s62, s63
    s_cbranch_scc1 interleave_layers__linear_attn_block__memory_aug_recurrent_mem_tr__prompt_kernel_r_en0_ok
    s_add_u32 s61, s61, 1
    s_cmp_ge_u32 s61, s60
    s_cbranch_scc1 interleave_layers__linear_attn_block__memory_aug_recurrent_mem_tr__prompt_kernel_r_en0_to
    s_sleep 2
    s_branch interleave_layers__linear_attn_block__memory_aug_recurrent_mem_tr__prompt_kernel_r_en0
interleave_layers__linear_attn_block__memory_aug_recurrent_mem_tr__prompt_kernel_r_en0_to:
    s_mov_b32 s60, 1
interleave_layers__linear_attn_block__memory_aug_recurrent_mem_tr__prompt_kernel_r_en0_ok:
    buffer_load_dwordx4 v[48:51], v6, s[8:11], s41 offen offset:0 sc1
    buffer_load_dwordx4 v[52:55], v6, s[8:11], s41 offen offset:1024 sc1
    buffer_load_dwordx4 v[56:59], v6, s[8:11], s41 offen offset:2048 sc1
    buffer_load_dwordx4 v[60:63], v6, s[8:11], s41 offen offset:3072 sc1
    buffer_load_dwordx4 v[64:67], v7, s[8:11], s41 offen offset:0 sc1
    buffer_load_dwordx4 v[68:71], v7, s[8:11], s41 offen offset:1024 sc1
    buffer_load_dwordx4 v[72:75], v7, s[8:11], s41 offen offset:2048 sc1
    buffer_load_dwordx4 v[76:79], v7, s[8:11], s41 offen offset:3072 sc1
    s_add_u32 s41, s41, 1310720
interleave_layers__linear_attn_block__memory_aug_recurrent_mem_tr__prompt_kernel_r_step:
    s_waitcnt vmcnt(0)
    v_mov_b32 v16, v48
    v_mov_b32 v17, v49
    v_mov_b32 v18, v50
    v_mov_b32 v19, v51
    v_mov_b32 v20, v52
    v_mov_b32 v21, v53
    v_mov_b32 v22, v54
    v_mov_b32 v23, v55
    v_mov_b32 v24, v56
    v_mov_b32 v25, v57
    v_mov_b32 v26, v58
    v_mov_b32 v27, v59
    v_mov_b32 v28, v60
    v_mov_b32 v29, v61
    v_mov_b32 v30, v62
    v_mov_b32 v31, v63
    v_mov_b32 v32, v64
    v_mov_b32 v33, v65
    v_mov_b32 v34, v66
    v_mov_b32 v35, v67
    v_mov_b32 v36, v68
    v_mov_b32 v37, v69
    v_mov_b32 v38, v70
    v_mov_b32 v39, v71
    v_mov_b32 v40, v72
    v_mov_b32 v41, v73
    v_mov_b32 v42, v74
    v_mov_b32 v43, v75
    v_mov_b32 v44, v76
    v_mov_b32 v45, v77
    v_mov_b32 v46, v78
    v_mov_b32 v47, v79
    s_lshl_b32 s95, s92, 6
    s_add_u32 s95, s95, s40
    s_add_u32 s95, s95, 1
    s_cmp_ge_i32 s59, s95
    s_cbranch_scc1 interleave_layers__linear_attn_block__memory_aug_recurrent_mem_tr__prompt_kernel_r_ec_ok
    s_and_b32 s24, s2, 7
    s_lshl_b32 s24, s24, 7
    s_add_u32 s24, s24, 23109632
    v_and_b32 v254, 3, v1
    v_lshl_add_u32 v254, v254, 2, s24
    s_mov_b32 s61, 0
interleave_layers__linear_attn_block__memory_aug_recurrent_mem_tr__prompt_kernel_r_ec:
    buffer_load_dword v253, v254, s[8:11], 0 offen sc1
    s_waitcnt vmcnt(0)
    v_readlane_b32 s59, v253, 0
    v_readlane_b32 s24, v253, 1
    s_min_i32 s59, s59, s24
    v_readlane_b32 s24, v253, 2
    s_min_i32 s59, s59, s24
    s_cmp_ge_i32 s59, s95
    s_cbranch_scc1 interleave_layers__linear_attn_block__memory_aug_recurrent_mem_tr__prompt_kernel_r_ec_ok
    s_add_u32 s61, s61, 1
    s_cmp_ge_u32 s61, s60
    s_cbranch_scc1 interleave_layers__linear_attn_block__memory_aug_recurrent_mem_tr__prompt_kernel_r_ec_to
    s_sleep 2
    s_branch interleave_layers__linear_attn_block__memory_aug_recurrent_mem_tr__prompt_kernel_r_ec
interleave_layers__linear_attn_block__memory_aug_recurrent_mem_tr__prompt_kernel_r_ec_to:
    s_mov_b32 s60, 1
interleave_layers__linear_attn_block__memory_aug_recurrent_mem_tr__prompt_kernel_r_ec_ok:
    s_mov_b64 exec, 1
    s_mov_b32 s61, 0
    v_mov_b32 v117, 0
    buffer_atomic_add v117, v125, s[8:11], s45 offen sc0
    s_sleep 1
    v_mov_b32 v118, 0
    buffer_atomic_add v118, v125, s[8:11], s45 offen sc0
    s_sleep 1
    v_mov_b32 v119, 0
    buffer_atomic_add v119, v125, s[8:11], s45 offen sc0
    s_sleep 1
interleave_layers__linear_attn_block__memory_aug_recurrent_mem_tr__prompt_kernel_r_pr:
    v_mov_b32 v116, 0
    buffer_atomic_add v116, v125, s[8:11], s45 offen sc0
    s_waitcnt vmcnt(3)
    v_cmp_le_i32 vcc, 7, v117
    s_add_u32 s61, s61, 1
    s_cbranch_vccnz interleave_layers__linear_attn_block__memory_aug_recurrent_mem_tr__prompt_kernel_r_pr_out
    s_sleep 1
    v_mov_b32 v117, 0
    buffer_atomic_add v117, v125, s[8:11], s45 offen sc0
    s_waitcnt vmcnt(3)
    v_cmp_le_i32 vcc, 7, v118
    s_add_u32 s61, s61, 1
    s_cbranch_vccnz interleave_layers__linear_attn_block__memory_aug_recurrent_mem_tr__prompt_kernel_r_pr_out
    s_sleep 1
    v_mov_b32 v118, 0
    buffer_atomic_add v118, v125, s[8:11], s45 offen sc0
    s_waitcnt vmcnt(3)
    v_cmp_le_i32 vcc, 7, v119
    s_add_u32 s61, s61, 1
    s_cbranch_vccnz interleave_layers__linear_attn_block__memory_aug_recurrent_mem_tr__prompt_kernel_r_pr_out
    s_sleep 1
    v_mov_b32 v119, 0
    buffer_atomic_add v119, v125, s[8:11], s45 offen sc0
    s_waitcnt vmcnt(3)
    v_cmp_le_i32 vcc, 7, v116
    s_add_u32 s61, s61, 1
    s_cbranch_vccnz interleave_layers__linear_attn_block__memory_aug_recurrent_mem_tr__prompt_kernel_r_pr_out
    s_sleep 1
    s_cmp_ge_u32 s61, s60
    s_cbranch_scc0 interleave_layers__linear_attn_block__memory_aug_recurrent_mem_tr__prompt_kernel_r_pr
    s_mov_b32 s60, 1
interleave_layers__linear_attn_block__memory_aug_recurrent_mem_tr__prompt_kernel_r_pr_out:
    s_mov_b64 exec, -1
    buffer_load_dwordx4 v[100:103], v10, s[8:11], s42 offen offset:0 sc1
    buffer_load_dwordx4 v[104:107], v10, s[8:11], s42 offen offset:1024 sc1
    buffer_load_dwordx4 v[80:83], v8, s[8:11], s43 offen offset:0 sc1
    buffer_load_dwordx4 v[84:87], v8, s[8:11], s43 offen offset:1024 sc1
    buffer_load_dwordx4 v[88:91], v8, s[8:11], s43 offen offset:2048 sc1
    buffer_load_dwordx4 v[92:95], v8, s[8:11], s43 offen offset:3072 sc1
    buffer_load_dwordx4 v[96:99], v9, s[8:11], s43 offen sc1
    s_waitcnt vmcnt(0)
    v_max3_u32 v204, v80, v81, v82
    v_max3_u32 v204, v204, v83, v84
    v_max3_u32 v204, v204, v85, v86
    v_max3_u32 v204, v204, v87, v88
    v_max3_u32 v204, v204, v89, v90
    v_max3_u32 v204, v204, v91, v92
    v_max3_u32 v204, v204, v93, v94
    v_max3_u32 v204, v204, v95, v96
    v_max3_u32 v204, v204, v97, v98
    v_max3_u32 v204, v204, v99, v100
    v_max3_u32 v204, v204, v101, v102
    v_max3_u32 v204, v204, v103, v104
    v_max3_u32 v204, v204, v105, v106
    v_max_u32 v204, v204, v107
    v_cmp_eq_u32 vcc, -1, v204
    s_cbranch_vccz interleave_layers__linear_attn_block__memory_aug_recurrent_mem_tr__prompt_kernel_r_p_out
    s_mov_b32 s61, 0
interleave_layers__linear_attn_block__memory_aug_recurrent_mem_tr__prompt_kernel_r_p:
    buffer_load_dwordx4 v[100:103], v10, s[8:11], s42 offen offset:0 sc1
    buffer_load_dwordx4 v[104:107], v10, s[8:11], s42 offen offset:1024 sc1
    buffer_load_dwordx4 v[80:83], v8, s[8:11], s43 offen offset:0 sc1
    buffer_load_dwordx4 v[84:87], v8, s[8:11], s43 offen offset:1024 sc1
    buffer_load_dwordx4 v[88:91], v8, s[8:11], s43 offen offset:2048 sc1
    buffer_load_dwordx4 v[92:95], v8, s[8:11], s43 offen offset:3072 sc1
    buffer_load_dwordx4 v[96:99], v9, s[8:11], s43 offen sc1
    s_waitcnt vmcnt(0)
    v_max3_u32 v204, v80, v81, v82
    v_max3_u32 v204, v204, v83, v84
    v_max3_u32 v204, v204, v85, v86
    v_max3_u32 v204, v204, v87, v88
    v_max3_u32 v204, v204, v89, v90
    v_max3_u32 v204, v204, v91, v92
    v_max3_u32 v204, v204, v93, v94
    v_max3_u32 v204, v204, v95, v96
    v_max3_u32 v204, v204, v97, v98
    v_max3_u32 v204, v204, v99, v100
    v_max3_u32 v204, v204, v101, v102
    v_max3_u32 v204, v204, v103, v104
    v_max3_u32 v204, v204, v105, v106
    v_max_u32 v204, v204, v107
    v_cmp_eq_u32 vcc, -1, v204
    s_add_u32 s61, s61, 1
    s_cbranch_vccz interleave_layers__linear_attn_block__memory_aug_recurrent_mem_tr__prompt_kernel_r_p_out
    s_cmp_ge_u32 s61, s60
    s_cbranch_scc1 interleave_layers__linear_attn_block__memory_aug_recurrent_mem_tr__prompt_kernel_r_p_to
    s_sleep 1
    s_branch interleave_layers__linear_attn_block__memory_aug_recurrent_mem_tr__prompt_kernel_r_p
interleave_layers__linear_attn_block__memory_aug_recurrent_mem_tr__prompt_kernel_r_p_to:
    s_mov_b32 s60, 1
interleave_layers__linear_attn_block__memory_aug_recurrent_mem_tr__prompt_kernel_r_p_out:
    s_mov_b64 exec, 1
    ds_add_rtn_u32 v124, v122, v123
    s_mov_b64 exec, -1
    v_mfma_f32_16x16x32_bf16 v[108:111], v[100:103], v[96:99], 0
    v_mfma_f32_16x16x32_bf16 v[112:115], v[104:107], v[96:99], 0
    v_mfma_f32_16x16x32_bf16 v[108:111], v[16:19], v[80:83], v[108:111]
    v_mfma_f32_16x16x32_bf16 v[112:115], v[20:23], v[80:83], v[112:115]
    s_waitcnt lgkmcnt(0)
    v_readfirstlane_b32 s24, v124
    s_and_b32 s24, s24, 3
    s_cmp_eq_u32 s24, 3
    s_cbranch_scc0 interleave_layers__linear_attn_block__memory_aug_recurrent_mem_tr__prompt_kernel_nh28
    buffer_atomic_add v123, v120, s[8:11], s46 offen
interleave_layers__linear_attn_block__memory_aug_recurrent_mem_tr__prompt_kernel_nh28:
    v_mfma_f32_16x16x32_bf16 v[108:111], v[24:27], v[84:87], v[108:111]
    v_mfma_f32_16x16x32_bf16 v[112:115], v[28:31], v[84:87], v[112:115]
    v_mfma_f32_16x16x32_bf16 v[108:111], v[32:35], v[88:91], v[108:111]
    v_mfma_f32_16x16x32_bf16 v[112:115], v[36:39], v[88:91], v[112:115]
    v_mfma_f32_16x16x32_bf16 v[108:111], v[40:43], v[92:95], v[108:111]
    v_mfma_f32_16x16x32_bf16 v[112:115], v[44:47], v[92:95], v[112:115]
    s_and_b32 s24, s40, 1
    s_mul_i32 s24, s24, 2560
    v_add_u32 v14, s24, v11
    v_add_u32 v15, s24, v12
    s_nop 3
    v_cndmask_b32 v108, v108, v112, s[50:51]
    v_cndmask_b32 v109, v109, v113, s[50:51]
    v_cndmask_b32 v110, v110, v114, s[50:51]
    v_cndmask_b32 v111, v111, v115, s[50:51]
    v_add_f32 v108, v108, v108 row_ror:8 row_mask:0xf bank_mask:0xf
    v_add_f32 v109, v109, v109 row_ror:8 row_mask:0xf bank_mask:0xf
    v_add_f32 v110, v110, v110 row_ror:8 row_mask:0xf bank_mask:0xf
    v_add_f32 v111, v111, v111 row_ror:8 row_mask:0xf bank_mask:0xf
    ds_write_b128 v14, v[108:111]
    s_waitcnt lgkmcnt(0)
    s_barrier
    s_cmp_eq_u32 s3, 0
    s_cbranch_scc0 interleave_layers__linear_attn_block__memory_aug_recurrent_mem_tr__prompt_kernel_np29
    ds_read_b128 v[220:223], v15 offset:0
    ds_read_b128 v[224:227], v15 offset:16
    ds_read_b128 v[228:231], v15 offset:640
    ds_read_b128 v[232:235], v15 offset:656
    ds_read_b128 v[236:239], v15 offset:1280
    ds_read_b128 v[240:243], v15 offset:1296
    ds_read_b128 v[244:247], v15 offset:1920
    ds_read_b128 v[248:251], v15 offset:1936
    s_waitcnt lgkmcnt(4)
    v_pk_add_f32 v[220:221], v[220:221], v[228:229]
    v_pk_add_f32 v[222:223], v[222:223], v[230:231]
    v_pk_add_f32 v[224:225], v[224:225], v[232:233]
    v_pk_add_f32 v[226:227], v[226:227], v[234:235]
    s_waitcnt lgkmcnt(0)
    v_pk_add_f32 v[236:237], v[236:237], v[244:245]
    v_pk_add_f32 v[238:239], v[238:239], v[246:247]
    v_pk_add_f32 v[240:241], v[240:241], v[248:249]
    v_pk_add_f32 v[242:243], v[242:243], v[250:251]
    v_pk_add_f32 v[220:221], v[220:221], v[236:237]
    v_pk_add_f32 v[222:223], v[222:223], v[238:239]
    v_pk_add_f32 v[224:225], v[224:225], v[240:241]
    v_pk_add_f32 v[226:227], v[226:227], v[242:243]
    v_cvt_pk_bf16_f32 v228, v220, v221
    v_cvt_pk_bf16_f32 v229, v222, v223
    v_cvt_pk_bf16_f32 v230, v224, v225
    v_cvt_pk_bf16_f32 v231, v226, v227
    v_min_u32 v228, -2, v228
    v_min_u32 v229, -2, v229
    v_min_u32 v230, -2, v230
    v_min_u32 v231, -2, v231
    buffer_store_dwordx4 v[228:231], v13, s[8:11], s47 offen sc1
interleave_layers__linear_attn_block__memory_aug_recurrent_mem_tr__prompt_kernel_np29:
    s_cmp_eq_u32 s3, 1
    s_cbranch_scc0 interleave_layers__linear_attn_block__memory_aug_recurrent_mem_tr__prompt_kernel_xf30
    s_cmp_eq_u32 s44, 39
    s_cbranch_scc0 interleave_layers__linear_attn_block__memory_aug_recurrent_mem_tr__prompt_kernel_xf30
    s_lshl_b32 s24, s92, 6
    s_add_u32 s24, s24, s40
    s_add_u32 s24, s24, 1
    v_lshlrev_b32 v204, 7, v1
    v_add_u32 v204, 23111680, v204
    v_mov_b32 v205, 2146435072
    v_cmp_le_u32 vcc, 8, v1
    s_nop 1
    v_cndmask_b32 v204, v204, v205, vcc
    v_mov_b32 v205, s24
    buffer_store_dword v205, v204, s[8:11], 0 offen sc1
interleave_layers__linear_attn_block__memory_aug_recurrent_mem_tr__prompt_kernel_xf30:
    s_add_u32 s63, s40, 2
    s_min_u32 s63, s63, 64
    s_sleep 18
    s_cmp_ge_i32 s62, s63
    s_cbranch_scc1 interleave_layers__linear_attn_block__memory_aug_recurrent_mem_tr__prompt_kernel_r_en_ok
    s_mov_b32 s61, 0
interleave_layers__linear_attn_block__memory_aug_recurrent_mem_tr__prompt_kernel_r_en:
    buffer_load_dword v253, v252, s[8:11], 0 offen sc1
    s_waitcnt vmcnt(0)
    v_readlane_b32 s62, v253, 0
    v_readlane_b32 s24, v253, 1
    s_min_i32 s62, s62, s24
    v_readlane_b32 s24, v253, 2
    s_min_i32 s62, s62, s24
    v_readlane_b32 s24, v253, 3
    s_min_i32 s62, s62, s24
    v_readlane_b32 s24, v253, 4
    s_min_i32 s62, s62, s24
    v_readlane_b32 s24, v253, 5
    s_min_i32 s62, s62, s24
    v_readlane_b32 s24, v253, 6
    s_min_i32 s62, s62, s24
    v_readlane_b32 s24, v253, 7
    s_min_i32 s62, s62, s24
    s_cmp_ge_i32 s62, s63
    s_cbranch_scc1 interleave_layers__linear_attn_block__memory_aug_recurrent_mem_tr__prompt_kernel_r_en_ok
    s_add_u32 s61, s61, 1
    s_cmp_ge_u32 s61, s60
    s_cbranch_scc1 interleave_layers__linear_attn_block__memory_aug_recurrent_mem_tr__prompt_kernel_r_en_to
    s_sleep 2
    s_branch interleave_layers__linear_attn_block__memory_aug_recurrent_mem_tr__prompt_kernel_r_en
interleave_layers__linear_attn_block__memory_aug_recurrent_mem_tr__prompt_kernel_r_en_to:
    s_mov_b32 s60, 1
interleave_layers__linear_attn_block__memory_aug_recurrent_mem_tr__prompt_kernel_r_en_ok:
    buffer_load_dwordx4 v[48:51], v6, s[8:11], s41 offen offset:0 sc1
    buffer_load_dwordx4 v[52:55], v6, s[8:11], s41 offen offset:1024 sc1
    buffer_load_dwordx4 v[56:59], v6, s[8:11], s41 offen offset:2048 sc1
    buffer_load_dwordx4 v[60:63], v6, s[8:11], s41 offen offset:3072 sc1
    buffer_load_dwordx4 v[64:67], v7, s[8:11], s41 offen offset:0 sc1
    buffer_load_dwordx4 v[68:71], v7, s[8:11], s41 offen offset:1024 sc1
    buffer_load_dwordx4 v[72:75], v7, s[8:11], s41 offen offset:2048 sc1
    buffer_load_dwordx4 v[76:79], v7, s[8:11], s41 offen offset:3072 sc1
    s_add_u32 s41, s41, 1310720
    s_add_u32 s40, s40, 1
    s_lshl_b32 s24, s40, 12
    s_and_b32 s24, s24, 0x2000
    s_xor_b32 s24, s24, s36
    s_lshl_b32 s37, s40, 20
    s_add_u32 s37, s37, s24
    s_add_u32 s37, s37, 117440512
    s_add_u32 s42, s37, 0
    s_add_u32 s43, s37, 655360
    s_add_u32 s47, s37, 704512
    s_add_u32 s45, s37, 753664
    s_add_u32 s46, s37, 737280
    s_cmp_lt_u32 s40, 64
    s_cbranch_scc1 interleave_layers__linear_attn_block__memory_aug_recurrent_mem_tr__prompt_kernel_r_step
    s_waitcnt vmcnt(0)
    s_cmp_eq_u32 s92, 0
    s_cbranch_scc0 interleave_layers__linear_attn_block__memory_aug_recurrent_mem_tr__prompt_kernel_end
    s_mov_b32 s92, 1
    s_branch interleave_layers__linear_attn_block__memory_aug_recurrent_mem_tr__prompt_kernel_r_top
interleave_layers__linear_attn_block__memory_aug_recurrent_mem_tr__prompt_kernel_roleP:
    s_sub_u32 s44, s2, 104
    s_lshr_b32 s46, s44, 5
    s_and_b32 s44, s44, 31
    s_load_dwordx2 s[6:7], s[0:1], 40
    s_load_dwordx2 s[24:25], s[0:1], 48
    s_load_dwordx2 s[26:27], s[0:1], 56
    s_waitcnt lgkmcnt(0)
    s_cmp_eq_u32 s46, 1
    s_cselect_b32 s6, s24, s6
    s_cselect_b32 s7, s25, s7
    s_cmp_eq_u32 s46, 2
    s_cselect_b32 s6, s26, s6
    s_cselect_b32 s7, s27, s7
    s_mov_b32 s12, s6
    s_mov_b32 s13, s7
    s_mov_b32 s14, 7864320
    s_mov_b32 s15, 0x00020000
    v_add_u32 v16, 0, v0
    s_mov_b32 s24, 683
    v_mul_lo_u32 v17, v16, s24
    v_lshrrev_b32 v17, 14, v17
    v_mul_u32_u24 v18, 24, v17
    v_sub_u32 v18, v16, v18
    s_mov_b32 s24, 12288
    v_mul_lo_u32 v4, v17, s24
    v_lshl_add_u32 v4, v18, 4, v4
    v_mul_u32_u24 v10, 400, v17
    v_lshl_add_u32 v10, v18, 4, v10
    v_add_u32 v10, 81920, v10
    v_add_u32 v16, 256, v0
    s_mov_b32 s24, 683
    v_mul_lo_u32 v17, v16, s24
    v_lshrrev_b32 v17, 14, v17
    v_mul_u32_u24 v18, 24, v17
    v_sub_u32 v18, v16, v18
    s_mov_b32 s24, 12288
    v_mul_lo_u32 v5, v17, s24
    v_lshl_add_u32 v5, v18, 4, v5
    v_mul_u32_u24 v11, 400, v17
    v_lshl_add_u32 v11, v18, 4, v11
    v_add_u32 v11, 81920, v11
    v_add_u32 v16, 512, v0
    s_mov_b32 s24, 683
    v_mul_lo_u32 v17, v16, s24
    v_lshrrev_b32 v17, 14, v17
    v_mul_u32_u24 v18, 24, v17
    v_sub_u32 v18, v16, v18
    s_mov_b32 s24, 12288
    v_mul_lo_u32 v6, v17, s24
    v_lshl_add_u32 v6, v18, 4, v6
    v_mul_u32_u24 v12, 400, v17
    v_lshl_add_u32 v12, v18, 4, v12
    v_add_u32 v12, 81920, v12
    v_add_u32 v16, 768, v0
    s_mov_b32 s24, 683
    v_mul_lo_u32 v17, v16, s24
    v_lshrrev_b32 v17, 14, v17
    v_mul_u32_u24 v18, 24, v17
    v_sub_u32 v18, v16, v18
    s_mov_b32 s24, 12288
    v_mul_lo_u32 v7, v17, s24
    v_lshl_add_u32 v7, v18, 4, v7
    v_mul_u32_u24 v13, 400, v17
    v_lshl_add_u32 v13, v18, 4, v13
    v_add_u32 v13, 81920, v13
    v_add_u32 v16, 1024, v0
    s_mov_b32 s24, 683
    v_mul_lo_u32 v17, v16, s24
    v_lshrrev_b32 v17, 14, v17
    v_mul_u32_u24 v18, 24, v17
    v_sub_u32 v18, v16, v18
    s_mov_b32 s24, 12288
    v_mul_lo_u32 v8, v17, s24
    v_lshl_add_u32 v8, v18, 4, v8
    v_mul_u32_u24 v14, 400, v17
    v_lshl_add_u32 v14, v18, 4, v14
    v_add_u32 v14, 81920, v14
    v_add_u32 v16, 1280, v0
    s_mov_b32 s24, 683
    v_mul_lo_u32 v17, v16, s24
    v_lshrrev_b32 v17, 14, v17
    v_mul_u32_u24 v18, 24, v17
    v_sub_u32 v18, v16, v18
    s_mov_b32 s24, 12288
    v_mul_lo_u32 v9, v17, s24
    v_lshl_add_u32 v9, v18, 4, v9
    v_mul_u32_u24 v15, 400, v17
    v_lshl_add_u32 v15, v18, 4, v15
    v_add_u32 v15, 81920, v15
    v_lshrrev_b32 v16, 2, v2
    v_lshl_add_u32 v16, v3, 2, v16
    v_mul_u32_u24 v32, 400, v16
    v_and_b32 v16, 3, v2
    v_lshl_add_u32 v32, v16, 3, v32
    s_mul_i32 s24, s3, 96
    s_add_u32 s24, s24, 81920
    v_add_u32 v32, s24, v32
    s_mul_i32 s45, s44, 384
    s_add_u32 s47, s45, 0
    buffer_load_dwordx4 v[56:59], v4, s[12:15], s47 offen
    buffer_load_dwordx4 v[60:63], v5, s[12:15], s47 offen
    buffer_load_dwordx4 v[64:67], v6, s[12:15], s47 offen
    buffer_load_dwordx4 v[68:71], v7, s[12:15], s47 offen
    buffer_load_dwordx4 v[72:75], v8, s[12:15], s47 offen
    buffer_load_dwordx4 v[76:79], v9, s[12:15], s47 offen
    s_add_u32 s47, s45, 786432
    buffer_load_dwordx4 v[80:83], v4, s[12:15], s47 offen
    buffer_load_dwordx4 v[84:87], v5, s[12:15], s47 offen
    buffer_load_dwordx4 v[88:91], v6, s[12:15], s47 offen
    buffer_load_dwordx4 v[92:95], v7, s[12:15], s47 offen
    buffer_load_dwordx4 v[96:99], v8, s[12:15], s47 offen
    buffer_load_dwordx4 v[100:103], v9, s[12:15], s47 offen
    s_add_u32 s47, s45, 1572864
    buffer_load_dwordx4 v[104:107], v4, s[12:15], s47 offen
    buffer_load_dwordx4 v[108:111], v5, s[12:15], s47 offen
    buffer_load_dwordx4 v[112:115], v6, s[12:15], s47 offen
    buffer_load_dwordx4 v[116:119], v7, s[12:15], s47 offen
    buffer_load_dwordx4 v[120:123], v8, s[12:15], s47 offen
    buffer_load_dwordx4 v[124:127], v9, s[12:15], s47 offen
    s_add_u32 s47, s45, 2359296
    buffer_load_dwordx4 v[128:131], v4, s[12:15], s47 offen
    buffer_load_dwordx4 v[132:135], v5, s[12:15], s47 offen
    buffer_load_dwordx4 v[136:139], v6, s[12:15], s47 offen
    buffer_load_dwordx4 v[140:143], v7, s[12:15], s47 offen
    buffer_load_dwordx4 v[144:147], v8, s[12:15], s47 offen
    buffer_load_dwordx4 v[148:151], v9, s[12:15], s47 offen
    s_add_u32 s47, s45, 3145728
    buffer_load_dwordx4 v[152:155], v4, s[12:15], s47 offen
    buffer_load_dwordx4 v[156:159], v5, s[12:15], s47 offen
    buffer_load_dwordx4 v[160:163], v6, s[12:15], s47 offen
    buffer_load_dwordx4 v[164:167], v7, s[12:15], s47 offen
    buffer_load_dwordx4 v[168:171], v8, s[12:15], s47 offen
    buffer_load_dwordx4 v[172:175], v9, s[12:15], s47 offen
    s_add_u32 s47, s45, 3932160
    buffer_load_dwordx4 v[176:179], v4, s[12:15], s47 offen
    buffer_load_dwordx4 v[180:183], v5, s[12:15], s47 offen
    buffer_load_dwordx4 v[184:187], v6, s[12:15], s47 offen
    buffer_load_dwordx4 v[188:191], v7, s[12:15], s47 offen
    buffer_load_dwordx4 v[192:195], v8, s[12:15], s47 offen
    buffer_load_dwordx4 v[196:199], v9, s[12:15], s47 offen
    s_add_u32 s47, s45, 4718592
    buffer_load_dwordx4 v[200:203], v4, s[12:15], s47 offen
    buffer_load_dwordx4 v[204:207], v5, s[12:15], s47 offen
    buffer_load_dwordx4 v[208:211], v6, s[12:15], s47 offen
    buffer_load_dwordx4 v[212:215], v7, s[12:15], s47 offen
    buffer_load_dwordx4 v[216:219], v8, s[12:15], s47 offen
    buffer_load_dwordx4 v[220:223], v9, s[12:15], s47 offen
    s_add_u32 s47, s45, 5505024
    buffer_load_dwordx4 v[224:227], v4, s[12:15], s47 offen
    buffer_load_dwordx4 v[228:231], v5, s[12:15], s47 offen
    buffer_load_dwordx4 v[232:235], v6, s[12:15], s47 offen
    buffer_load_dwordx4 v[236:239], v7, s[12:15], s47 offen
    buffer_load_dwordx4 v[240:243], v8, s[12:15], s47 offen
    buffer_load_dwordx4 v[244:247], v9, s[12:15], s47 offen
    v_mov_b32 v28, 0x3f803f80
    v_mov_b32 v29, 0x3f803f80
    v_mov_b32 v30, 0x3f803f80
    v_mov_b32 v31, 0x3f803f80
    s_waitcnt vmcnt(42)
    ds_write_b128 v10, v[56:59] offset:0
    ds_write_b128 v11, v[60:63] offset:0
    ds_write_b128 v12, v[64:67] offset:0
    ds_write_b128 v13, v[68:71] offset:0
    ds_write_b128 v14, v[72:75] offset:0
    ds_write_b128 v15, v[76:79] offset:0
    s_waitcnt lgkmcnt(0)
    s_add_u32 s47, s45, 6291456
    buffer_load_dwordx4 v[56:59], v4, s[12:15], s47 offen
    buffer_load_dwordx4 v[60:63], v5, s[12:15], s47 offen
    buffer_load_dwordx4 v[64:67], v6, s[12:15], s47 offen
    buffer_load_dwordx4 v[68:71], v7, s[12:15], s47 offen
    buffer_load_dwordx4 v[72:75], v8, s[12:15], s47 offen
    buffer_load_dwordx4 v[76:79], v9, s[12:15], s47 offen
    s_barrier
    ds_read_b64_tr_b16 a[0:1], v32 offset:0
    ds_read_b64_tr_b16 a[2:3], v32 offset:6400
    ds_read_b64_tr_b16 a[4:5], v32 offset:12800
    ds_read_b64_tr_b16 a[6:7], v32 offset:19200
    ds_read_b64_tr_b16 a[80:81], v32 offset:32
    ds_read_b64_tr_b16 a[82:83], v32 offset:6432
    ds_read_b64_tr_b16 a[84:85], v32 offset:12832
    ds_read_b64_tr_b16 a[86:87], v32 offset:19232
    ds_read_b64_tr_b16 a[160:161], v32 offset:64
    ds_read_b64_tr_b16 a[162:163], v32 offset:6464
    ds_read_b64_tr_b16 a[164:165], v32 offset:12864
    ds_read_b64_tr_b16 a[166:167], v32 offset:19264
    s_waitcnt vmcnt(42)
    ds_write_b128 v10, v[80:83] offset:25600
    ds_write_b128 v11, v[84:87] offset:25600
    ds_write_b128 v12, v[88:91] offset:25600
    ds_write_b128 v13, v[92:95] offset:25600
    ds_write_b128 v14, v[96:99] offset:25600
    ds_write_b128 v15, v[100:103] offset:25600
    s_waitcnt lgkmcnt(0)
    s_add_u32 s47, s45, 7077888
    buffer_load_dwordx4 v[80:83], v4, s[12:15], s47 offen
    buffer_load_dwordx4 v[84:87], v5, s[12:15], s47 offen
    buffer_load_dwordx4 v[88:91], v6, s[12:15], s47 offen
    buffer_load_dwordx4 v[92:95], v7, s[12:15], s47 offen
    buffer_load_dwordx4 v[96:99], v8, s[12:15], s47 offen
    buffer_load_dwordx4 v[100:103], v9, s[12:15], s47 offen
    v_mfma_f32_16x16x32_bf16 v[16:19], a[0:3], v[28:31], 0
    v_mfma_f32_16x16x32_bf16 v[20:23], a[80:83], v[28:31], 0
    v_mfma_f32_16x16x32_bf16 v[24:27], a[160:163], v[28:31], 0
    v_mfma_f32_16x16x32_bf16 v[16:19], a[4:7], v[28:31], v[16:19]
    v_mfma_f32_16x16x32_bf16 v[20:23], a[84:87], v[28:31], v[20:23]
    v_mfma_f32_16x16x32_bf16 v[24:27], a[164:167], v[28:31], v[24:27]
    s_barrier
    ds_read_b64_tr_b16 a[8:9], v32 offset:25600
    ds_read_b64_tr_b16 a[10:11], v32 offset:32000
    ds_read_b64_tr_b16 a[12:13], v32 offset:38400
    ds_read_b64_tr_b16 a[14:15], v32 offset:44800
    ds_read_b64_tr_b16 a[88:89], v32 offset:25632
    ds_read_b64_tr_b16 a[90:91], v32 offset:32032
    ds_read_b64_tr_b16 a[92:93], v32 offset:38432
    ds_read_b64_tr_b16 a[94:95], v32 offset:44832
    ds_read_b64_tr_b16 a[168:169], v32 offset:25664
    ds_read_b64_tr_b16 a[170:171], v32 offset:32064
    ds_read_b64_tr_b16 a[172:173], v32 offset:38464
    ds_read_b64_tr_b16 a[174:175], v32 offset:44864
    s_waitcnt vmcnt(42)
    ds_write_b128 v10, v[104:107] offset:0
    ds_write_b128 v11, v[108:111] offset:0
    ds_write_b128 v12, v[112:115] offset:0
    ds_write_b128 v13, v[116:119] offset:0
    ds_write_b128 v14, v[120:123] offset:0
    ds_write_b128 v15, v[124:127] offset:0
    s_waitcnt lgkmcnt(0)
    v_mfma_f32_16x16x32_bf16 v[16:19], a[8:11], v[28:31], v[16:19]
    v_mfma_f32_16x16x32_bf16 v[20:23], a[88:91], v[28:31], v[20:23]
    v_mfma_f32_16x16x32_bf16 v[24:27], a[168:171], v[28:31], v[24:27]
    v_mfma_f32_16x16x32_bf16 v[16:19], a[12:15], v[28:31], v[16:19]
    v_mfma_f32_16x16x32_bf16 v[20:23], a[92:95], v[28:31], v[20:23]
    v_mfma_f32_16x16x32_bf16 v[24:27], a[172:175], v[28:31], v[24:27]
    s_barrier
    ds_read_b64_tr_b16 a[16:17], v32 offset:0
    ds_read_b64_tr_b16 a[18:19], v32 offset:6400
    ds_read_b64_tr_b16 a[20:21], v32 offset:12800
    ds_read_b64_tr_b16 a[22:23], v32 offset:19200
    ds_read_b64_tr_b16 a[96:97], v32 offset:32
    ds_read_b64_tr_b16 a[98:99], v32 offset:6432
    ds_read_b64_tr_b16 a[100:101], v32 offset:12832
    ds_read_b64_tr_b16 a[102:103], v32 offset:19232
    ds_read_b64_tr_b16 a[176:177], v32 offset:64
    ds_read_b64_tr_b16 a[178:179], v32 offset:6464
    ds_read_b64_tr_b16 a[180:181], v32 offset:12864
    ds_read_b64_tr_b16 a[182:183], v32 offset:19264
    s_waitcnt vmcnt(36)
    ds_write_b128 v10, v[128:131] offset:25600
    ds_write_b128 v11, v[132:135] offset:25600
    ds_write_b128 v12, v[136:139] offset:25600
    ds_write_b128 v13, v[140:143] offset:25600
    ds_write_b128 v14, v[144:147] offset:25600
    ds_write_b128 v15, v[148:151] offset:25600
    s_waitcnt lgkmcnt(0)
    v_mfma_f32_16x16x32_bf16 v[16:19], a[16:19], v[28:31], v[16:19]
    v_mfma_f32_16x16x32_bf16 v[20:23], a[96:99], v[28:31], v[20:23]
    v_mfma_f32_16x16x32_bf16 v[24:27], a[176:179], v[28:31], v[24:27]
    v_mfma_f32_16x16x32_bf16 v[16:19], a[20:23], v[28:31], v[16:19]
    v_mfma_f32_16x16x32_bf16 v[20:23], a[100:103], v[28:31], v[20:23]
    v_mfma_f32_16x16x32_bf16 v[24:27], a[180:183], v[28:31], v[24:27]
    s_barrier
    ds_read_b64_tr_b16 a[24:25], v32 offset:25600
    ds_read_b64_tr_b16 a[26:27], v32 offset:32000
    ds_read_b64_tr_b16 a[28:29], v32 offset:38400
    ds_read_b64_tr_b16 a[30:31], v32 offset:44800
    ds_read_b64_tr_b16 a[104:105], v32 offset:25632
    ds_read_b64_tr_b16 a[106:107], v32 offset:32032
    ds_read_b64_tr_b16 a[108:109], v32 offset:38432
    ds_read_b64_tr_b16 a[110:111], v32 offset:44832
    ds_read_b64_tr_b16 a[184:185], v32 offset:25664
    ds_read_b64_tr_b16 a[186:187], v32 offset:32064
    ds_read_b64_tr_b16 a[188:189], v32 offset:38464
    ds_read_b64_tr_b16 a[190:191], v32 offset:44864
    s_waitcnt vmcnt(30)
    ds_write_b128 v10, v[152:155] offset:0
    ds_write_b128 v11, v[156:159] offset:0
    ds_write_b128 v12, v[160:163] offset:0
    ds_write_b128 v13, v[164:167] offset:0
    ds_write_b128 v14, v[168:171] offset:0
    ds_write_b128 v15, v[172:175] offset:0
    s_waitcnt lgkmcnt(0)
    v_mfma_f32_16x16x32_bf16 v[16:19], a[24:27], v[28:31], v[16:19]
    v_mfma_f32_16x16x32_bf16 v[20:23], a[104:107], v[28:31], v[20:23]
    v_mfma_f32_16x16x32_bf16 v[24:27], a[184:187], v[28:31], v[24:27]
    v_mfma_f32_16x16x32_bf16 v[16:19], a[28:31], v[28:31], v[16:19]
    v_mfma_f32_16x16x32_bf16 v[20:23], a[108:111], v[28:31], v[20:23]
    v_mfma_f32_16x16x32_bf16 v[24:27], a[188:191], v[28:31], v[24:27]
    s_barrier
    ds_read_b64_tr_b16 a[32:33], v32 offset:0
    ds_read_b64_tr_b16 a[34:35], v32 offset:6400
    ds_read_b64_tr_b16 a[36:37], v32 offset:12800
    ds_read_b64_tr_b16 a[38:39], v32 offset:19200
    ds_read_b64_tr_b16 a[112:113], v32 offset:32
    ds_read_b64_tr_b16 a[114:115], v32 offset:6432
    ds_read_b64_tr_b16 a[116:117], v32 offset:12832
    ds_read_b64_tr_b16 a[118:119], v32 offset:19232
    ds_read_b64_tr_b16 a[192:193], v32 offset:64
    ds_read_b64_tr_b16 a[194:195], v32 offset:6464
    ds_read_b64_tr_b16 a[196:197], v32 offset:12864
    ds_read_b64_tr_b16 a[198:199], v32 offset:19264
    s_waitcnt vmcnt(24)
    ds_write_b128 v10, v[176:179] offset:25600
    ds_write_b128 v11, v[180:183] offset:25600
    ds_write_b128 v12, v[184:187] offset:25600
    ds_write_b128 v13, v[188:191] offset:25600
    ds_write_b128 v14, v[192:195] offset:25600
    ds_write_b128 v15, v[196:199] offset:25600
    s_waitcnt lgkmcnt(0)
    v_mfma_f32_16x16x32_bf16 v[16:19], a[32:35], v[28:31], v[16:19]
    v_mfma_f32_16x16x32_bf16 v[20:23], a[112:115], v[28:31], v[20:23]
    v_mfma_f32_16x16x32_bf16 v[24:27], a[192:195], v[28:31], v[24:27]
    v_mfma_f32_16x16x32_bf16 v[16:19], a[36:39], v[28:31], v[16:19]
    v_mfma_f32_16x16x32_bf16 v[20:23], a[116:119], v[28:31], v[20:23]
    v_mfma_f32_16x16x32_bf16 v[24:27], a[196:199], v[28:31], v[24:27]
    s_barrier
    ds_read_b64_tr_b16 a[40:41], v32 offset:25600
    ds_read_b64_tr_b16 a[42:43], v32 offset:32000
    ds_read_b64_tr_b16 a[44:45], v32 offset:38400
    ds_read_b64_tr_b16 a[46:47], v32 offset:44800
    ds_read_b64_tr_b16 a[120:121], v32 offset:25632
    ds_read_b64_tr_b16 a[122:123], v32 offset:32032
    ds_read_b64_tr_b16 a[124:125], v32 offset:38432
    ds_read_b64_tr_b16 a[126:127], v32 offset:44832
    ds_read_b64_tr_b16 a[200:201], v32 offset:25664
    ds_read_b64_tr_b16 a[202:203], v32 offset:32064
    ds_read_b64_tr_b16 a[204:205], v32 offset:38464
    ds_read_b64_tr_b16 a[206:207], v32 offset:44864
    s_waitcnt vmcnt(18)
    ds_write_b128 v10, v[200:203] offset:0
    ds_write_b128 v11, v[204:207] offset:0
    ds_write_b128 v12, v[208:211] offset:0
    ds_write_b128 v13, v[212:215] offset:0
    ds_write_b128 v14, v[216:219] offset:0
    ds_write_b128 v15, v[220:223] offset:0
    s_waitcnt lgkmcnt(0)
    v_mfma_f32_16x16x32_bf16 v[16:19], a[40:43], v[28:31], v[16:19]
    v_mfma_f32_16x16x32_bf16 v[20:23], a[120:123], v[28:31], v[20:23]
    v_mfma_f32_16x16x32_bf16 v[24:27], a[200:203], v[28:31], v[24:27]
    v_mfma_f32_16x16x32_bf16 v[16:19], a[44:47], v[28:31], v[16:19]
    v_mfma_f32_16x16x32_bf16 v[20:23], a[124:127], v[28:31], v[20:23]
    v_mfma_f32_16x16x32_bf16 v[24:27], a[204:207], v[28:31], v[24:27]
    s_barrier
    ds_read_b64_tr_b16 a[48:49], v32 offset:0
    ds_read_b64_tr_b16 a[50:51], v32 offset:6400
    ds_read_b64_tr_b16 a[52:53], v32 offset:12800
    ds_read_b64_tr_b16 a[54:55], v32 offset:19200
    ds_read_b64_tr_b16 a[128:129], v32 offset:32
    ds_read_b64_tr_b16 a[130:131], v32 offset:6432
    ds_read_b64_tr_b16 a[132:133], v32 offset:12832
    ds_read_b64_tr_b16 a[134:135], v32 offset:19232
    ds_read_b64_tr_b16 a[208:209], v32 offset:64
    ds_read_b64_tr_b16 a[210:211], v32 offset:6464
    ds_read_b64_tr_b16 a[212:213], v32 offset:12864
    ds_read_b64_tr_b16 a[214:215], v32 offset:19264
    s_waitcnt vmcnt(12)
    ds_write_b128 v10, v[224:227] offset:25600
    ds_write_b128 v11, v[228:231] offset:25600
    ds_write_b128 v12, v[232:235] offset:25600
    ds_write_b128 v13, v[236:239] offset:25600
    ds_write_b128 v14, v[240:243] offset:25600
    ds_write_b128 v15, v[244:247] offset:25600
    s_waitcnt lgkmcnt(0)
    v_mfma_f32_16x16x32_bf16 v[16:19], a[48:51], v[28:31], v[16:19]
    v_mfma_f32_16x16x32_bf16 v[20:23], a[128:131], v[28:31], v[20:23]
    v_mfma_f32_16x16x32_bf16 v[24:27], a[208:211], v[28:31], v[24:27]
    v_mfma_f32_16x16x32_bf16 v[16:19], a[52:55], v[28:31], v[16:19]
    v_mfma_f32_16x16x32_bf16 v[20:23], a[132:135], v[28:31], v[20:23]
    v_mfma_f32_16x16x32_bf16 v[24:27], a[212:215], v[28:31], v[24:27]
    s_barrier
    ds_read_b64_tr_b16 a[56:57], v32 offset:25600
    ds_read_b64_tr_b16 a[58:59], v32 offset:32000
    ds_read_b64_tr_b16 a[60:61], v32 offset:38400
    ds_read_b64_tr_b16 a[62:63], v32 offset:44800
    ds_read_b64_tr_b16 a[136:137], v32 offset:25632
    ds_read_b64_tr_b16 a[138:139], v32 offset:32032
    ds_read_b64_tr_b16 a[140:141], v32 offset:38432
    ds_read_b64_tr_b16 a[142:143], v32 offset:44832
    ds_read_b64_tr_b16 a[216:217], v32 offset:25664
    ds_read_b64_tr_b16 a[218:219], v32 offset:32064
    ds_read_b64_tr_b16 a[220:221], v32 offset:38464
    ds_read_b64_tr_b16 a[222:223], v32 offset:44864
    s_waitcnt vmcnt(6)
    ds_write_b128 v10, v[56:59] offset:0
    ds_write_b128 v11, v[60:63] offset:0
    ds_write_b128 v12, v[64:67] offset:0
    ds_write_b128 v13, v[68:71] offset:0
    ds_write_b128 v14, v[72:75] offset:0
    ds_write_b128 v15, v[76:79] offset:0
    s_waitcnt lgkmcnt(0)
    v_mfma_f32_16x16x32_bf16 v[16:19], a[56:59], v[28:31], v[16:19]
    v_mfma_f32_16x16x32_bf16 v[20:23], a[136:139], v[28:31], v[20:23]
    v_mfma_f32_16x16x32_bf16 v[24:27], a[216:219], v[28:31], v[24:27]
    v_mfma_f32_16x16x32_bf16 v[16:19], a[60:63], v[28:31], v[16:19]
    v_mfma_f32_16x16x32_bf16 v[20:23], a[140:143], v[28:31], v[20:23]
    v_mfma_f32_16x16x32_bf16 v[24:27], a[220:223], v[28:31], v[24:27]
    s_barrier
    ds_read_b64_tr_b16 a[64:65], v32 offset:0
    ds_read_b64_tr_b16 a[66:67], v32 offset:6400
    ds_read_b64_tr_b16 a[68:69], v32 offset:12800
    ds_read_b64_tr_b16 a[70:71], v32 offset:19200
    ds_read_b64_tr_b16 a[144:145], v32 offset:32
    ds_read_b64_tr_b16 a[146:147], v32 offset:6432
    ds_read_b64_tr_b16 a[148:149], v32 offset:12832
    ds_read_b64_tr_b16 a[150:151], v32 offset:19232
    ds_read_b64_tr_b16 a[224:225], v32 offset:64
    ds_read_b64_tr_b16 a[226:227], v32 offset:6464
    ds_read_b64_tr_b16 a[228:229], v32 offset:12864
    ds_read_b64_tr_b16 a[230:231], v32 offset:19264
    s_waitcnt vmcnt(0)
    ds_write_b128 v10, v[80:83] offset:25600
    ds_write_b128 v11, v[84:87] offset:25600
    ds_write_b128 v12, v[88:91] offset:25600
    ds_write_b128 v13, v[92:95] offset:25600
    ds_write_b128 v14, v[96:99] offset:25600
    ds_write_b128 v15, v[100:103] offset:25600
    s_waitcnt lgkmcnt(0)
    v_mfma_f32_16x16x32_bf16 v[16:19], a[64:67], v[28:31], v[16:19]
    v_mfma_f32_16x16x32_bf16 v[20:23], a[144:147], v[28:31], v[20:23]
    v_mfma_f32_16x16x32_bf16 v[24:27], a[224:227], v[28:31], v[24:27]
    v_mfma_f32_16x16x32_bf16 v[16:19], a[68:71], v[28:31], v[16:19]
    v_mfma_f32_16x16x32_bf16 v[20:23], a[148:151], v[28:31], v[20:23]
    v_mfma_f32_16x16x32_bf16 v[24:27], a[228:231], v[28:31], v[24:27]
    s_barrier
    ds_read_b64_tr_b16 a[72:73], v32 offset:25600
    ds_read_b64_tr_b16 a[74:75], v32 offset:32000
    ds_read_b64_tr_b16 a[76:77], v32 offset:38400
    ds_read_b64_tr_b16 a[78:79], v32 offset:44800
    ds_read_b64_tr_b16 a[152:153], v32 offset:25632
    ds_read_b64_tr_b16 a[154:155], v32 offset:32032
    ds_read_b64_tr_b16 a[156:157], v32 offset:38432
    ds_read_b64_tr_b16 a[158:159], v32 offset:44832
    ds_read_b64_tr_b16 a[232:233], v32 offset:25664
    ds_read_b64_tr_b16 a[234:235], v32 offset:32064
    ds_read_b64_tr_b16 a[236:237], v32 offset:38464
    ds_read_b64_tr_b16 a[238:239], v32 offset:44864
    s_waitcnt lgkmcnt(0)
    v_mfma_f32_16x16x32_bf16 v[16:19], a[72:75], v[28:31], v[16:19]
    v_mfma_f32_16x16x32_bf16 v[20:23], a[152:155], v[28:31], v[20:23]
    v_mfma_f32_16x16x32_bf16 v[24:27], a[232:235], v[28:31], v[24:27]
    v_mfma_f32_16x16x32_bf16 v[16:19], a[76:79], v[28:31], v[16:19]
    v_mfma_f32_16x16x32_bf16 v[20:23], a[156:159], v[28:31], v[20:23]
    v_mfma_f32_16x16x32_bf16 v[24:27], a[236:239], v[28:31], v[24:27]
    s_nop 5
    v_mov_b32 v224, v16
    v_mov_b32 v225, v17
    v_mov_b32 v226, v18
    v_mov_b32 v227, v19
    v_mov_b32 v228, v20
    v_mov_b32 v229, v21
    v_mov_b32 v230, v22
    v_mov_b32 v231, v23
    v_mov_b32 v232, v24
    v_mov_b32 v233, v25
    v_mov_b32 v234, v26
    v_mov_b32 v235, v27
    v_mov_b32 v236, v28
    v_mov_b32 v237, v29
    v_mov_b32 v238, v30
    v_mov_b32 v239, v31
    s_barrier
interleave_layers__linear_attn_block__memory_aug_recurrent_mem_tr__prompt_kernel_p_layer:
    s_mov_b32 s93, 0
    s_lshl_b32 s24, s93, 12
    s_and_b32 s24, s24, 0x2000
    s_xor_b32 s24, s24, s36
    s_lshl_b32 s93, s93, 20
    s_add_u32 s93, s93, s24
    s_add_u32 s93, s93, 117440512
    s_mul_i32 s94, s92, 16384
    s_add_u32 s94, s94, 23068672
    s_sub_u32 s44, s2, 104
    s_lshr_b32 s46, s44, 5
    s_and_b32 s44, s44, 31
    s_mov_b32 s43, 67108864
    s_cmp_eq_u32 s46, 1
    s_cselect_b32 s43, 92274688, s43
    s_cmp_eq_u32 s46, 2
    s_cselect_b32 s43, 33554432, s43
    s_cmp_eq_u32 s92, 0
    s_cselect_b32 s73, 0, 8388608
    v_lshlrev_b32 v5, 4, v1
    s_mul_i32 s24, s3, 10240
    v_add_u32 v6, s24, v5
    v_add_u32 v7, 4096, v6
    v_add_u32 v8, 8192, v6
    s_mul_i32 s24, s44, 12288
    s_mul_i32 s25, s3, 3072
    s_add_u32 s24, s24, s25
    v_add_u32 v11, s24, v5
    s_lshr_b32 s24, s3, 1
    s_lshl_b32 s24, s24, 8
    s_and_b32 s25, s3, 1
    s_lshl_b32 s25, s25, 3
    s_add_u32 s24, s24, s25
    s_add_u32 s24, s24, 81920
    v_lshlrev_b32 v13, 4, v2
    v_add_u32 v12, s24, v13
    v_add_u32 v13, 81920, v13
    v_lshrrev_b32 v15, 2, v2
    v_cmp_eq_u32 vcc, v15, v3
    v_lshlrev_b32 v15, 3, v1
    v_add_u32 v15, 82944, v15
    v_cndmask_b32 v12, v15, v12, vcc
    v_and_b32 v15, 3, v2
    v_cmp_eq_u32 s[48:49], 1, v15
    v_cmp_eq_u32 s[50:51], 2, v15
    v_cmp_eq_u32 s[54:55], 3, v15
    s_and_b32 s24, s2, 7
    s_lshl_b32 s24, s24, 7
    s_lshl_b32 s25, s92, 10
    s_add_u32 s24, s24, s25
    s_add_u32 s24, s24, 23105536
    s_cmp_eq_u32 s92, 0
    s_cselect_b32 s25, 20, 5
    s_cselect_b32 s75, 2, 0
    s_cselect_b32 s74, 16, 64
    v_cmp_gt_u32 vcc, s25, v1
    s_nop 1
    v_cndmask_b32 v4, 0, v1, vcc
    v_lshlrev_b32 v4, 2, v4
    v_add_u32 v4, s24, v4
    s_lshl_b32 s24, s46, 12
    s_lshl_b32 s25, s44, 7
    s_add_u32 s24, s24, s25
    s_add_u32 s24, s24, s94
    v_mov_b32 v14, s24
    v_mov_b32 v15, 2146435072
    v_cmp_eq_u32 vcc, 0, v1
    s_nop 1
    v_cndmask_b32 v14, v15, v14, vcc
    s_cmp_eq_u32 s3, 0
    s_cselect_b32 s24, 0, 2146435072
    v_or_b32 v14, s24, v14
    s_sub_u32 s70, s2, 104
    s_mul_i32 s71, s70, 205
    s_lshr_b32 s71, s71, 12
    s_mul_i32 s24, s71, 20
    s_sub_u32 s70, s70, s24
    s_cmp_lt_u32 s71, 4
    s_cselect_b32 s64, s71, 64
    s_lshl_b32 s24, s70, 16
    s_lshl_b32 s25, s3, 13
    s_add_u32 s24, s24, s25
    v_add_u32 v240, s24, v5
    v_add_u32 v241, 4096, v240
    s_lshl_b32 s24, s70, 15
    s_lshl_b32 s25, s3, 11
    s_add_u32 s24, s24, s25
    v_add_u32 v242, s24, v5
    s_lshl_b32 s24, s3, 15
    v_add_u32 v193, s24, v5
    v_add_u32 v212, 0, v193
    v_add_u32 v213, 4096, v193
    v_add_u32 v214, 16384, v193
    v_add_u32 v215, 20480, v193
    s_lshl_b32 s24, s3, 12
    s_and_b32 s25, s24, 0x2000
    s_add_u32 s24, s24, s25
    s_add_u32 s24, s24, 131072
    v_add_u32 v216, s24, v5
    s_lshl_b32 s24, s3, 12
    s_add_u32 s24, s24, 83968
    v_add_u32 v217, s24, v5
    s_and_b32 s24, s3, 1
    s_lshl_b32 s24, s24, 10
    s_add_u32 s24, s24, 83968
    v_add_u32 v218, s24, v5
    s_and_b32 s24, s3, 1
    s_mul_i32 s24, s24, 20480
    s_lshl_b32 s25, s70, 10
    s_add_u32 s24, s24, s25
    v_add_u32 v219, s24, v5
    s_and_b32 s24, s3, 1
    s_lshl_b32 s24, s24, 4
    v_add_u32 v243, s24, v2
    v_mul_u32_u24 v243, 1280, v243
    v_lshl_add_u32 v243, v3, 3, v243
    s_lshl_b32 s24, s70, 6
    v_add_u32 v243, s24, v243
    s_load_dwordx2 s[26:27], s[0:1], 80
    s_waitcnt lgkmcnt(0)
    s_mov_b32 s12, s26
    s_mov_b32 s13, s27
    s_mov_b32 s14, 2621440
    s_mov_b32 s15, 0x00020000
    s_mul_i32 s65, s71, 1310720
    s_add_u32 s65, s65, 184549376
    s_lshl_b32 s24, s71, 12
    s_and_b32 s24, s24, 0x2000
    s_xor_b32 s24, s24, s36
    s_lshl_b32 s66, s71, 20
    s_add_u32 s66, s66, s24
    s_add_u32 s66, s66, 117440512
    s_xor_b32 s67, s66, 0x2000
    s_mul_i32 s68, s71, 40960
    v_and_b32 v252, 7, v1
    v_lshlrev_b32 v252, 7, v252
    s_lshl_b32 s24, s3, 10
    s_add_u32 s24, s24, 12288
    s_add_u32 s24, s24, s94
    v_add_u32 v252, s24, v252
    s_mov_b32 s69, -1
    s_lshl_b32 s24, s71, 7
    s_lshl_b32 s25, s70, 2
    s_add_u32 s24, s24, s25
    s_add_u32 s24, s24, 23107584
    s_cmp_eq_u32 s3, 0
    s_cselect_b32 s24, s24, 2146435072
    v_mov_b32 v245, s24
    v_mov_b32 v246, 2146435072
    v_cmp_eq_u32 vcc, 0, v1
    s_nop 1
    v_cndmask_b32 v245, v246, v245, vcc
    s_mov_b32 s79, -1
    s_mov_b32 s76, -1
    s_mov_b32 s62, -1
    s_mov_b32 s63, 1
    s_cmp_ge_i32 s62, s63
    s_cbranch_scc1 interleave_layers__linear_attn_block__memory_aug_recurrent_mem_tr__prompt_kernel_p_en0_ok
    s_mov_b32 s61, 0
interleave_layers__linear_attn_block__memory_aug_recurrent_mem_tr__prompt_kernel_p_en0:
    buffer_load_dword v16, v4, s[8:11], 0 offen sc1
    s_waitcnt vmcnt(0)
    v_readlane_b32 s62, v16, 0
    v_readlane_b32 s24, v16, 1
    s_min_i32 s62, s62, s24
    v_readlane_b32 s24, v16, 2
    s_min_i32 s62, s62, s24
    v_readlane_b32 s24, v16, 3
    s_min_i32 s62, s62, s24
    v_readlane_b32 s24, v16, 4
    s_min_i32 s62, s62, s24
    v_readlane_b32 s24, v16, 5
    s_min_i32 s62, s62, s24
    v_readlane_b32 s24, v16, 6
    s_min_i32 s62, s62, s24
    v_readlane_b32 s24, v16, 7
    s_min_i32 s62, s62, s24
    v_readlane_b32 s24, v16, 8
    s_min_i32 s62, s62, s24
    v_readlane_b32 s24, v16, 9
    s_min_i32 s62, s62, s24
    v_readlane_b32 s24, v16, 10
    s_min_i32 s62, s62, s24
    v_readlane_b32 s24, v16, 11
    s_min_i32 s62, s62, s24
    v_readlane_b32 s24, v16, 12
    s_min_i32 s62, s62, s24
    v_readlane_b32 s24, v16, 13
    s_min_i32 s62, s62, s24
    v_readlane_b32 s24, v16, 14
    s_min_i32 s62, s62, s24
    v_readlane_b32 s24, v16, 15
    s_min_i32 s62, s62, s24
    v_readlane_b32 s24, v16, 16
    s_min_i32 s62, s62, s24
    v_readlane_b32 s24, v16, 17
    s_min_i32 s62, s62, s24
    v_readlane_b32 s24, v16, 18
    s_min_i32 s62, s62, s24
    v_readlane_b32 s24, v16, 19
    s_min_i32 s62, s62, s24
    s_cmp_ge_i32 s62, s63
    s_cbranch_scc1 interleave_layers__linear_attn_block__memory_aug_recurrent_mem_tr__prompt_kernel_p_en0_ok
    s_add_u32 s61, s61, 1
    s_cmp_ge_u32 s61, s60
    s_cbranch_scc1 interleave_layers__linear_attn_block__memory_aug_recurrent_mem_tr__prompt_kernel_p_en0_to
    s_sleep 2
    s_branch interleave_layers__linear_attn_block__memory_aug_recurrent_mem_tr__prompt_kernel_p_en0
interleave_layers__linear_attn_block__memory_aug_recurrent_mem_tr__prompt_kernel_p_en0_to:
    s_mov_b32 s60, 1
interleave_layers__linear_attn_block__memory_aug_recurrent_mem_tr__prompt_kernel_p_en0_ok:
    s_mov_b32 s41, s73
    buffer_load_dwordx4 v[16:19], v6, s[8:11], s41 offen offset:0
    buffer_load_dwordx4 v[20:23], v6, s[8:11], s41 offen offset:1024
    buffer_load_dwordx4 v[24:27], v6, s[8:11], s41 offen offset:2048
    buffer_load_dwordx4 v[28:31], v6, s[8:11], s41 offen offset:3072
    buffer_load_dwordx4 v[32:35], v7, s[8:11], s41 offen offset:0
    buffer_load_dwordx4 v[36:39], v7, s[8:11], s41 offen offset:1024
    buffer_load_dwordx4 v[40:43], v7, s[8:11], s41 offen offset:2048
    buffer_load_dwordx4 v[44:47], v7, s[8:11], s41 offen offset:3072
    buffer_load_dwordx4 v[48:51], v8, s[8:11], s41 offen offset:0
    buffer_load_dwordx4 v[52:55], v8, s[8:11], s41 offen offset:1024
    s_mov_b32 s40, 0
    s_mov_b32 s42, 0
    s_waitcnt vmcnt(0)
    v_mfma_f32_16x16x32_bf16 v[148:151], v[16:19], v[16:19], 0
    v_mfma_f32_16x16x32_bf16 v[144:147], v[236:239], v[16:19], 0
    v_mfma_f32_16x16x32_bf16 v[148:151], v[20:23], v[20:23], v[148:151]
    v_mfma_f32_16x16x32_bf16 v[144:147], v[236:239], v[20:23], v[144:147]
    v_mfma_f32_16x16x32_bf16 v[148:151], v[24:27], v[24:27], v[148:151]
    v_mfma_f32_16x16x32_bf16 v[144:147], v[236:239], v[24:27], v[144:147]
    v_mfma_f32_16x16x32_bf16 v[148:151], v[28:31], v[28:31], v[148:151]
    v_mfma_f32_16x16x32_bf16 v[144:147], v[236:239], v[28:31], v[144:147]
    v_mfma_f32_16x16x32_bf16 v[148:151], v[32:35], v[32:35], v[148:151]
    v_mfma_f32_16x16x32_bf16 v[144:147], v[236:239], v[32:35], v[144:147]
    v_mfma_f32_16x16x32_bf16 v[148:151], v[36:39], v[36:39], v[148:151]
    v_mfma_f32_16x16x32_bf16 v[144:147], v[236:239], v[36:39], v[144:147]
    v_mfma_f32_16x16x32_bf16 v[148:151], v[40:43], v[40:43], v[148:151]
    v_mfma_f32_16x16x32_bf16 v[144:147], v[236:239], v[40:43], v[144:147]
    v_mfma_f32_16x16x32_bf16 v[148:151], v[44:47], v[44:47], v[148:151]
    v_mfma_f32_16x16x32_bf16 v[144:147], v[236:239], v[44:47], v[144:147]
    v_mfma_f32_16x16x32_bf16 v[148:151], v[48:51], v[48:51], v[148:151]
    v_mfma_f32_16x16x32_bf16 v[144:147], v[236:239], v[48:51], v[144:147]
    v_mfma_f32_16x16x32_bf16 v[148:151], v[52:55], v[52:55], v[148:151]
    v_mfma_f32_16x16x32_bf16 v[144:147], v[236:239], v[52:55], v[144:147]
    ds_write_b128 v6, v[16:19] offset:0
    ds_write_b128 v6, v[20:23] offset:1024
    ds_write_b128 v6, v[24:27] offset:2048
    ds_write_b128 v6, v[28:31] offset:3072
    ds_write_b128 v6, v[32:35] offset:4096
    ds_write_b128 v6, v[36:39] offset:5120
    ds_write_b128 v6, v[40:43] offset:6144
    ds_write_b128 v6, v[44:47] offset:7168
    ds_write_b128 v6, v[48:51] offset:8192
    ds_write_b128 v6, v[52:55] offset:9216
    v_cndmask_b32 v145, v148, v149, s[48:49]
    v_cndmask_b32 v145, v145, v150, s[50:51]
    v_cndmask_b32 v145, v145, v151, s[54:55]
    ds_write_b64 v12, v[144:145]
    s_waitcnt lgkmcnt(0)
    s_barrier
    s_branch interleave_layers__linear_attn_block__memory_aug_recurrent_mem_tr__prompt_kernel_p_segA
interleave_layers__linear_attn_block__memory_aug_recurrent_mem_tr__prompt_kernel_p_pubA:
    s_waitcnt vmcnt(0)
    s_barrier
    s_cmp_eq_u32 s3, 0
    s_cbranch_scc0 interleave_layers__linear_attn_block__memory_aug_recurrent_mem_tr__prompt_kernel_fp31
    v_mov_b32 v15, s40
    buffer_store_dword v15, v14, s[8:11], 0 offen sc1
interleave_layers__linear_attn_block__memory_aug_recurrent_mem_tr__prompt_kernel_fp31:
interleave_layers__linear_attn_block__memory_aug_recurrent_mem_tr__prompt_kernel_p_segA:
    v_add_u32 v9, s42, v5
    s_xor_b32 s42, s42, 40960
    v_add_u32 v10, s42, v6
    s_and_b32 s24, s40, 1
    s_lshl_b32 s24, s24, 9
    v_add_u32 v124, s24, v13
    s_xor_b32 s24, s24, 512
    v_add_u32 v140, s24, v12
    ds_read_b128 v[112:115], v124
    ds_read_b128 v[116:119], v124 offset:256
    ds_read_b128 v[56:59], v9 offset:0
    ds_read_b128 v[60:63], v9 offset:20480
    ds_read_b128 v[64:67], v9 offset:1024
    ds_read_b128 v[68:71], v9 offset:21504
    ds_read_b128 v[72:75], v9 offset:2048
    ds_read_b128 v[76:79], v9 offset:22528
    ds_read_b128 v[80:83], v9 offset:3072
    ds_read_b128 v[84:87], v9 offset:23552
    s_waitcnt lgkmcnt(6)
    v_mfma_f32_16x16x32_bf16 v[88:91], a[0:3], v[56:59], 0
    v_add_f32 v112, v112, v114
    v_mfma_f32_16x16x32_bf16 v[92:95], a[80:83], v[56:59], 0
    v_add_f32 v113, v113, v115
    v_mfma_f32_16x16x32_bf16 v[96:99], a[160:163], v[56:59], 0
    v_mul_f32 v112, 0x3acccccd, v112
    v_mfma_f32_16x16x32_bf16 v[100:103], a[0:3], v[60:63], 0
    v_mul_f32 v114, v112, v112
    v_mfma_f32_16x16x32_bf16 v[104:107], a[80:83], v[60:63], 0
    v_mov_b32 v115, 0x3acccccd
    v_mfma_f32_16x16x32_bf16 v[108:111], a[160:163], v[60:63], 0
    v_fma_f32 v113, v113, v115, -v114
    ds_read_b128 v[56:59], v9 offset:4096
    ds_read_b128 v[60:63], v9 offset:24576
    s_waitcnt lgkmcnt(6)
    v_mfma_f32_16x16x32_bf16 v[88:91], a[4:7], v[64:67], v[88:91]
    v_max_f32 v113, 0, v113
    v_mfma_f32_16x16x32_bf16 v[92:95], a[84:87], v[64:67], v[92:95]
    v_add_f32 v113, 0x3727c5ac, v113
    v_mfma_f32_16x16x32_bf16 v[96:99], a[164:167], v[64:67], v[96:99]
    v_rsq_f32 v132, v113
    v_mfma_f32_16x16x32_bf16 v[100:103], a[4:7], v[68:71], v[100:103]
    v_mul_f32 v133, v112, v132
    v_mfma_f32_16x16x32_bf16 v[104:107], a[84:87], v[68:71], v[104:107]
    v_sub_f32 v133, 0, v133
    v_mfma_f32_16x16x32_bf16 v[108:111], a[164:167], v[68:71], v[108:111]
    v_add_f32 v116, v116, v118
    ds_read_b128 v[64:67], v9 offset:5120
    ds_read_b128 v[68:71], v9 offset:25600
    s_waitcnt lgkmcnt(6)
    v_mfma_f32_16x16x32_bf16 v[88:91], a[8:11], v[72:75], v[88:91]
    v_add_f32 v117, v117, v119
    v_mfma_f32_16x16x32_bf16 v[92:95], a[88:91], v[72:75], v[92:95]
    v_mul_f32 v116, 0x3acccccd, v116
    v_mfma_f32_16x16x32_bf16 v[96:99], a[168:171], v[72:75], v[96:99]
    v_mul_f32 v118, v116, v116
    v_mfma_f32_16x16x32_bf16 v[100:103], a[8:11], v[76:79], v[100:103]
    v_mov_b32 v119, 0x3acccccd
    v_mfma_f32_16x16x32_bf16 v[104:107], a[88:91], v[76:79], v[104:107]
    v_fma_f32 v117, v117, v119, -v118
    v_mfma_f32_16x16x32_bf16 v[108:111], a[168:171], v[76:79], v[108:111]
    v_max_f32 v117, 0, v117
    ds_read_b128 v[72:75], v9 offset:6144
    ds_read_b128 v[76:79], v9 offset:26624
    s_waitcnt lgkmcnt(6)
    v_mfma_f32_16x16x32_bf16 v[88:91], a[12:15], v[80:83], v[88:91]
    v_add_f32 v117, 0x3727c5ac, v117
    v_mfma_f32_16x16x32_bf16 v[92:95], a[92:95], v[80:83], v[92:95]
    v_rsq_f32 v134, v117
    v_mfma_f32_16x16x32_bf16 v[96:99], a[172:175], v[80:83], v[96:99]
    v_mul_f32 v135, v116, v134
    v_mfma_f32_16x16x32_bf16 v[100:103], a[12:15], v[84:87], v[100:103]
    v_sub_f32 v135, 0, v135
    v_mfma_f32_16x16x32_bf16 v[104:107], a[92:95], v[84:87], v[104:107]
    v_mfma_f32_16x16x32_bf16 v[108:111], a[172:175], v[84:87], v[108:111]
    ds_read_b128 v[80:83], v9 offset:7168
    ds_read_b128 v[84:87], v9 offset:27648
    s_waitcnt lgkmcnt(6)
    v_mfma_f32_16x16x32_bf16 v[88:91], a[16:19], v[56:59], v[88:91]
    v_mfma_f32_16x16x32_bf16 v[92:95], a[96:99], v[56:59], v[92:95]
    v_mfma_f32_16x16x32_bf16 v[96:99], a[176:179], v[56:59], v[96:99]
    v_mfma_f32_16x16x32_bf16 v[100:103], a[16:19], v[60:63], v[100:103]
    v_mfma_f32_16x16x32_bf16 v[104:107], a[96:99], v[60:63], v[104:107]
    v_mfma_f32_16x16x32_bf16 v[108:111], a[176:179], v[60:63], v[108:111]
    ds_read_b128 v[56:59], v9 offset:8192
    ds_read_b128 v[60:63], v9 offset:28672
    s_waitcnt lgkmcnt(6)
    v_mfma_f32_16x16x32_bf16 v[88:91], a[20:23], v[64:67], v[88:91]
    v_mfma_f32_16x16x32_bf16 v[92:95], a[100:103], v[64:67], v[92:95]
    v_mfma_f32_16x16x32_bf16 v[96:99], a[180:183], v[64:67], v[96:99]
    v_mfma_f32_16x16x32_bf16 v[100:103], a[20:23], v[68:71], v[100:103]
    v_mfma_f32_16x16x32_bf16 v[104:107], a[100:103], v[68:71], v[104:107]
    v_mfma_f32_16x16x32_bf16 v[108:111], a[180:183], v[68:71], v[108:111]
    ds_read_b128 v[64:67], v9 offset:9216
    ds_read_b128 v[68:71], v9 offset:29696
    s_waitcnt lgkmcnt(6)
    v_mfma_f32_16x16x32_bf16 v[88:91], a[24:27], v[72:75], v[88:91]
    v_mfma_f32_16x16x32_bf16 v[92:95], a[104:107], v[72:75], v[92:95]
    v_mfma_f32_16x16x32_bf16 v[96:99], a[184:187], v[72:75], v[96:99]
    v_mfma_f32_16x16x32_bf16 v[100:103], a[24:27], v[76:79], v[100:103]
    v_mfma_f32_16x16x32_bf16 v[104:107], a[104:107], v[76:79], v[104:107]
    v_mfma_f32_16x16x32_bf16 v[108:111], a[184:187], v[76:79], v[108:111]
    ds_read_b128 v[72:75], v9 offset:10240
    ds_read_b128 v[76:79], v9 offset:30720
    s_waitcnt lgkmcnt(6)
    v_mfma_f32_16x16x32_bf16 v[88:91], a[28:31], v[80:83], v[88:91]
    v_mfma_f32_16x16x32_bf16 v[92:95], a[108:111], v[80:83], v[92:95]
    v_mfma_f32_16x16x32_bf16 v[96:99], a[188:191], v[80:83], v[96:99]
    v_mfma_f32_16x16x32_bf16 v[100:103], a[28:31], v[84:87], v[100:103]
    v_mfma_f32_16x16x32_bf16 v[104:107], a[108:111], v[84:87], v[104:107]
    v_mfma_f32_16x16x32_bf16 v[108:111], a[188:191], v[84:87], v[108:111]
    ds_read_b128 v[80:83], v9 offset:11264
    ds_read_b128 v[84:87], v9 offset:31744
    s_waitcnt lgkmcnt(6)
    v_mfma_f32_16x16x32_bf16 v[88:91], a[32:35], v[56:59], v[88:91]
    v_mfma_f32_16x16x32_bf16 v[92:95], a[112:115], v[56:59], v[92:95]
    v_mfma_f32_16x16x32_bf16 v[96:99], a[192:195], v[56:59], v[96:99]
    v_mfma_f32_16x16x32_bf16 v[100:103], a[32:35], v[60:63], v[100:103]
    v_mfma_f32_16x16x32_bf16 v[104:107], a[112:115], v[60:63], v[104:107]
    v_mfma_f32_16x16x32_bf16 v[108:111], a[192:195], v[60:63], v[108:111]
    ds_read_b128 v[56:59], v9 offset:12288
    ds_read_b128 v[60:63], v9 offset:32768
    s_waitcnt lgkmcnt(6)
    v_mfma_f32_16x16x32_bf16 v[88:91], a[36:39], v[64:67], v[88:91]
    v_mfma_f32_16x16x32_bf16 v[92:95], a[116:119], v[64:67], v[92:95]
    v_mfma_f32_16x16x32_bf16 v[96:99], a[196:199], v[64:67], v[96:99]
    v_mfma_f32_16x16x32_bf16 v[100:103], a[36:39], v[68:71], v[100:103]
    v_mfma_f32_16x16x32_bf16 v[104:107], a[116:119], v[68:71], v[104:107]
    v_mfma_f32_16x16x32_bf16 v[108:111], a[196:199], v[68:71], v[108:111]
    ds_read_b128 v[64:67], v9 offset:13312
    ds_read_b128 v[68:71], v9 offset:33792
    s_waitcnt lgkmcnt(6)
    v_mfma_f32_16x16x32_bf16 v[88:91], a[40:43], v[72:75], v[88:91]
    v_mfma_f32_16x16x32_bf16 v[92:95], a[120:123], v[72:75], v[92:95]
    v_mfma_f32_16x16x32_bf16 v[96:99], a[200:203], v[72:75], v[96:99]
    v_mfma_f32_16x16x32_bf16 v[100:103], a[40:43], v[76:79], v[100:103]
    v_mfma_f32_16x16x32_bf16 v[104:107], a[120:123], v[76:79], v[104:107]
    v_mfma_f32_16x16x32_bf16 v[108:111], a[200:203], v[76:79], v[108:111]
    ds_read_b128 v[72:75], v9 offset:14336
    ds_read_b128 v[76:79], v9 offset:34816
    s_waitcnt lgkmcnt(6)
    v_mfma_f32_16x16x32_bf16 v[88:91], a[44:47], v[80:83], v[88:91]
    v_mfma_f32_16x16x32_bf16 v[92:95], a[124:127], v[80:83], v[92:95]
    v_mfma_f32_16x16x32_bf16 v[96:99], a[204:207], v[80:83], v[96:99]
    v_mfma_f32_16x16x32_bf16 v[100:103], a[44:47], v[84:87], v[100:103]
    v_mfma_f32_16x16x32_bf16 v[104:107], a[124:127], v[84:87], v[104:107]
    v_mfma_f32_16x16x32_bf16 v[108:111], a[204:207], v[84:87], v[108:111]
    ds_read_b128 v[80:83], v9 offset:15360
    ds_read_b128 v[84:87], v9 offset:35840
    s_waitcnt lgkmcnt(6)
    v_mfma_f32_16x16x32_bf16 v[88:91], a[48:51], v[56:59], v[88:91]
    v_mfma_f32_16x16x32_bf16 v[92:95], a[128:131], v[56:59], v[92:95]
    v_mfma_f32_16x16x32_bf16 v[96:99], a[208:211], v[56:59], v[96:99]
    v_mfma_f32_16x16x32_bf16 v[100:103], a[48:51], v[60:63], v[100:103]
    v_mfma_f32_16x16x32_bf16 v[104:107], a[128:131], v[60:63], v[104:107]
    v_mfma_f32_16x16x32_bf16 v[108:111], a[208:211], v[60:63], v[108:111]
    ds_read_b128 v[56:59], v9 offset:16384
    ds_read_b128 v[60:63], v9 offset:36864
    s_waitcnt lgkmcnt(6)
    v_mfma_f32_16x16x32_bf16 v[88:91], a[52:55], v[64:67], v[88:91]
    v_mfma_f32_16x16x32_bf16 v[92:95], a[132:135], v[64:67], v[92:95]
    v_mfma_f32_16x16x32_bf16 v[96:99], a[212:215], v[64:67], v[96:99]
    v_mfma_f32_16x16x32_bf16 v[100:103], a[52:55], v[68:71], v[100:103]
    v_mfma_f32_16x16x32_bf16 v[104:107], a[132:135], v[68:71], v[104:107]
    v_mfma_f32_16x16x32_bf16 v[108:111], a[212:215], v[68:71], v[108:111]
    ds_read_b128 v[64:67], v9 offset:17408
    ds_read_b128 v[68:71], v9 offset:37888
    s_waitcnt lgkmcnt(6)
    v_mfma_f32_16x16x32_bf16 v[88:91], a[56:59], v[72:75], v[88:91]
    v_mfma_f32_16x16x32_bf16 v[92:95], a[136:139], v[72:75], v[92:95]
    v_mfma_f32_16x16x32_bf16 v[96:99], a[216:219], v[72:75], v[96:99]
    v_mfma_f32_16x16x32_bf16 v[100:103], a[56:59], v[76:79], v[100:103]
    v_mfma_f32_16x16x32_bf16 v[104:107], a[136:139], v[76:79], v[104:107]
    v_mfma_f32_16x16x32_bf16 v[108:111], a[216:219], v[76:79], v[108:111]
    ds_read_b128 v[72:75], v9 offset:18432
    ds_read_b128 v[76:79], v9 offset:38912
    s_waitcnt lgkmcnt(6)
    v_mfma_f32_16x16x32_bf16 v[88:91], a[60:63], v[80:83], v[88:91]
    v_mfma_f32_16x16x32_bf16 v[92:95], a[140:143], v[80:83], v[92:95]
    v_mfma_f32_16x16x32_bf16 v[96:99], a[220:223], v[80:83], v[96:99]
    v_mfma_f32_16x16x32_bf16 v[100:103], a[60:63], v[84:87], v[100:103]
    v_mfma_f32_16x16x32_bf16 v[104:107], a[140:143], v[84:87], v[104:107]
    v_mfma_f32_16x16x32_bf16 v[108:111], a[220:223], v[84:87], v[108:111]
    ds_read_b128 v[80:83], v9 offset:19456
    ds_read_b128 v[84:87], v9 offset:39936
    s_waitcnt lgkmcnt(6)
    v_mfma_f32_16x16x32_bf16 v[88:91], a[64:67], v[56:59], v[88:91]
    v_mfma_f32_16x16x32_bf16 v[92:95], a[144:147], v[56:59], v[92:95]
    v_mfma_f32_16x16x32_bf16 v[96:99], a[224:227], v[56:59], v[96:99]
    v_mfma_f32_16x16x32_bf16 v[100:103], a[64:67], v[60:63], v[100:103]
    v_mfma_f32_16x16x32_bf16 v[104:107], a[144:147], v[60:63], v[104:107]
    v_mfma_f32_16x16x32_bf16 v[108:111], a[224:227], v[60:63], v[108:111]
    s_waitcnt lgkmcnt(4)
    v_mfma_f32_16x16x32_bf16 v[88:91], a[68:71], v[64:67], v[88:91]
    v_mfma_f32_16x16x32_bf16 v[92:95], a[148:151], v[64:67], v[92:95]
    v_mfma_f32_16x16x32_bf16 v[96:99], a[228:231], v[64:67], v[96:99]
    v_mfma_f32_16x16x32_bf16 v[100:103], a[68:71], v[68:71], v[100:103]
    v_mfma_f32_16x16x32_bf16 v[104:107], a[148:151], v[68:71], v[104:107]
    v_mfma_f32_16x16x32_bf16 v[108:111], a[228:231], v[68:71], v[108:111]
    s_waitcnt lgkmcnt(2)
    v_mfma_f32_16x16x32_bf16 v[88:91], a[72:75], v[72:75], v[88:91]
    v_mfma_f32_16x16x32_bf16 v[92:95], a[152:155], v[72:75], v[92:95]
    v_mfma_f32_16x16x32_bf16 v[96:99], a[232:235], v[72:75], v[96:99]
    v_mfma_f32_16x16x32_bf16 v[100:103], a[72:75], v[76:79], v[100:103]
    v_mfma_f32_16x16x32_bf16 v[104:107], a[152:155], v[76:79], v[104:107]
    v_mfma_f32_16x16x32_bf16 v[108:111], a[232:235], v[76:79], v[108:111]
    s_waitcnt lgkmcnt(0)
    v_mfma_f32_16x16x32_bf16 v[88:91], a[76:79], v[80:83], v[88:91]
    v_mfma_f32_16x16x32_bf16 v[92:95], a[156:159], v[80:83], v[92:95]
    v_mfma_f32_16x16x32_bf16 v[96:99], a[236:239], v[80:83], v[96:99]
    v_mfma_f32_16x16x32_bf16 v[100:103], a[76:79], v[84:87], v[100:103]
    v_mfma_f32_16x16x32_bf16 v[104:107], a[156:159], v[84:87], v[104:107]
    v_mfma_f32_16x16x32_bf16 v[108:111], a[236:239], v[84:87], v[108:111]
    v_pk_mul_f32 v[124:125], v[224:225], v[132:133] op_sel:[0,1] op_sel_hi:[1,1]
    v_pk_mul_f32 v[126:127], v[226:227], v[132:133] op_sel:[0,1] op_sel_hi:[1,1]
    s_nop 0
    v_pk_fma_f32 v[88:89], v[88:89], v[132:133], v[124:125] op_sel:[0,0,0] op_sel_hi:[1,0,1]
    v_pk_fma_f32 v[90:91], v[90:91], v[132:133], v[126:127] op_sel:[0,0,0] op_sel_hi:[1,0,1]
    v_pk_mul_f32 v[124:125], v[228:229], v[132:133] op_sel:[0,1] op_sel_hi:[1,1]
    v_pk_mul_f32 v[126:127], v[230:231], v[132:133] op_sel:[0,1] op_sel_hi:[1,1]
    v_pk_fma_f32 v[92:93], v[92:93], v[132:133], v[124:125] op_sel:[0,0,0] op_sel_hi:[1,0,1]
    v_pk_fma_f32 v[94:95], v[94:95], v[132:133], v[126:127] op_sel:[0,0,0] op_sel_hi:[1,0,1]
    v_pk_mul_f32 v[124:125], v[232:233], v[132:133] op_sel:[0,1] op_sel_hi:[1,1]
    v_pk_mul_f32 v[126:127], v[234:235], v[132:133] op_sel:[0,1] op_sel_hi:[1,1]
    v_pk_fma_f32 v[96:97], v[96:97], v[132:133], v[124:125] op_sel:[0,0,0] op_sel_hi:[1,0,1]
    v_pk_fma_f32 v[98:99], v[98:99], v[132:133], v[126:127] op_sel:[0,0,0] op_sel_hi:[1,0,1]
    v_pk_mul_f32 v[124:125], v[224:225], v[134:135] op_sel:[0,1] op_sel_hi:[1,1]
    v_pk_mul_f32 v[126:127], v[226:227], v[134:135] op_sel:[0,1] op_sel_hi:[1,1]
    v_pk_fma_f32 v[100:101], v[100:101], v[134:135], v[124:125] op_sel:[0,0,0] op_sel_hi:[1,0,1]
    v_pk_fma_f32 v[102:103], v[102:103], v[134:135], v[126:127] op_sel:[0,0,0] op_sel_hi:[1,0,1]
    v_pk_mul_f32 v[124:125], v[228:229], v[134:135] op_sel:[0,1] op_sel_hi:[1,1]
    v_pk_mul_f32 v[126:127], v[230:231], v[134:135] op_sel:[0,1] op_sel_hi:[1,1]
    v_pk_fma_f32 v[104:105], v[104:105], v[134:135], v[124:125] op_sel:[0,0,0] op_sel_hi:[1,0,1]
    v_pk_fma_f32 v[106:107], v[106:107], v[134:135], v[126:127] op_sel:[0,0,0] op_sel_hi:[1,0,1]
    v_pk_mul_f32 v[124:125], v[232:233], v[134:135] op_sel:[0,1] op_sel_hi:[1,1]
    v_pk_mul_f32 v[126:127], v[234:235], v[134:135] op_sel:[0,1] op_sel_hi:[1,1]
    v_pk_fma_f32 v[108:109], v[108:109], v[134:135], v[124:125] op_sel:[0,0,0] op_sel_hi:[1,0,1]
    v_pk_fma_f32 v[110:111], v[110:111], v[134:135], v[126:127] op_sel:[0,0,0] op_sel_hi:[1,0,1]
    v_cvt_pk_bf16_f32 v112, v88, v89
    v_cvt_pk_bf16_f32 v113, v90, v91
    v_cvt_pk_bf16_f32 v114, v92, v93
    v_cvt_pk_bf16_f32 v115, v94, v95
    v_cvt_pk_bf16_f32 v116, v100, v101
    v_cvt_pk_bf16_f32 v117, v102, v103
    v_cvt_pk_bf16_f32 v118, v104, v105
    v_cvt_pk_bf16_f32 v119, v106, v107
    v_cvt_pk_bf16_f32 v120, v96, v97
    v_cvt_pk_bf16_f32 v121, v98, v99
    v_cvt_pk_bf16_f32 v122, v108, v109
    v_cvt_pk_bf16_f32 v123, v110, v111
    buffer_store_dwordx4 v[112:115], v11, s[8:11], s43 offen offset:0 sc1
    buffer_store_dwordx4 v[116:119], v11, s[8:11], s43 offen offset:1024 sc1
    buffer_store_dwordx4 v[120:123], v11, s[8:11], s43 offen offset:2048 sc1
    s_add_u32 s43, s43, 393216
    s_waitcnt vmcnt(0)
    s_barrier
    s_add_u32 s24, s40, 1
    v_mov_b32 v15, s24
    buffer_store_dword v15, v14, s[8:11], 0 offen sc1
    s_add_u32 s63, s40, 1
    s_lshr_b32 s63, s63, s75
    s_add_u32 s63, s63, 1
    s_min_u32 s63, s63, s74
    s_cmp_ge_i32 s62, s63
    s_cbranch_scc1 interleave_layers__linear_attn_block__memory_aug_recurrent_mem_tr__prompt_kernel_p_enA_ok
    s_mov_b32 s61, 0
interleave_layers__linear_attn_block__memory_aug_recurrent_mem_tr__prompt_kernel_p_enA:
    buffer_load_dword v16, v4, s[8:11], 0 offen sc1
    s_waitcnt vmcnt(0)
    v_readlane_b32 s62, v16, 0
    v_readlane_b32 s24, v16, 1
    s_min_i32 s62, s62, s24
    v_readlane_b32 s24, v16, 2
    s_min_i32 s62, s62, s24
    v_readlane_b32 s24, v16, 3
    s_min_i32 s62, s62, s24
    v_readlane_b32 s24, v16, 4
    s_min_i32 s62, s62, s24
    v_readlane_b32 s24, v16, 5
    s_min_i32 s62, s62, s24
    v_readlane_b32 s24, v16, 6
    s_min_i32 s62, s62, s24
    v_readlane_b32 s24, v16, 7
    s_min_i32 s62, s62, s24
    v_readlane_b32 s24, v16, 8
    s_min_i32 s62, s62, s24
    v_readlane_b32 s24, v16, 9
    s_min_i32 s62, s62, s24
    v_readlane_b32 s24, v16, 10
    s_min_i32 s62, s62, s24
    v_readlane_b32 s24, v16, 11
    s_min_i32 s62, s62, s24
    v_readlane_b32 s24, v16, 12
    s_min_i32 s62, s62, s24
    v_readlane_b32 s24, v16, 13
    s_min_i32 s62, s62, s24
    v_readlane_b32 s24, v16, 14
    s_min_i32 s62, s62, s24
    v_readlane_b32 s24, v16, 15
    s_min_i32 s62, s62, s24
    v_readlane_b32 s24, v16, 16
    s_min_i32 s62, s62, s24
    v_readlane_b32 s24, v16, 17
    s_min_i32 s62, s62, s24
    v_readlane_b32 s24, v16, 18
    s_min_i32 s62, s62, s24
    v_readlane_b32 s24, v16, 19
    s_min_i32 s62, s62, s24
    s_cmp_ge_i32 s62, s63
    s_cbranch_scc1 interleave_layers__linear_attn_block__memory_aug_recurrent_mem_tr__prompt_kernel_p_enA_ok
    s_add_u32 s61, s61, 1
    s_cmp_ge_u32 s61, s60
    s_cbranch_scc1 interleave_layers__linear_attn_block__memory_aug_recurrent_mem_tr__prompt_kernel_p_enA_to
    s_sleep 2
    s_branch interleave_layers__linear_attn_block__memory_aug_recurrent_mem_tr__prompt_kernel_p_enA
interleave_layers__linear_attn_block__memory_aug_recurrent_mem_tr__prompt_kernel_p_enA_to:
    s_mov_b32 s60, 1
interleave_layers__linear_attn_block__memory_aug_recurrent_mem_tr__prompt_kernel_p_enA_ok:
    s_add_u32 s41, s41, 40960
    buffer_load_dwordx4 v[16:19], v6, s[8:11], s41 offen offset:0
    buffer_load_dwordx4 v[20:23], v6, s[8:11], s41 offen offset:1024
    buffer_load_dwordx4 v[24:27], v6, s[8:11], s41 offen offset:2048
    buffer_load_dwordx4 v[28:31], v6, s[8:11], s41 offen offset:3072
    buffer_load_dwordx4 v[32:35], v7, s[8:11], s41 offen offset:0
    buffer_load_dwordx4 v[36:39], v7, s[8:11], s41 offen offset:1024
    buffer_load_dwordx4 v[40:43], v7, s[8:11], s41 offen offset:2048
    buffer_load_dwordx4 v[44:47], v7, s[8:11], s41 offen offset:3072
    buffer_load_dwordx4 v[48:51], v8, s[8:11], s41 offen offset:0
    buffer_load_dwordx4 v[52:55], v8, s[8:11], s41 offen offset:1024
    buffer_load_dword v152, v4, s[8:11], 0 offen sc1
    s_waitcnt vmcnt(0)
    v_mfma_f32_16x16x32_bf16 v[148:151], v[16:19], v[16:19], 0
    v_mfma_f32_16x16x32_bf16 v[144:147], v[236:239], v[16:19], 0
    v_mfma_f32_16x16x32_bf16 v[148:151], v[20:23], v[20:23], v[148:151]
    v_mfma_f32_16x16x32_bf16 v[144:147], v[236:239], v[20:23], v[144:147]
    v_mfma_f32_16x16x32_bf16 v[148:151], v[24:27], v[24:27], v[148:151]
    v_mfma_f32_16x16x32_bf16 v[144:147], v[236:239], v[24:27], v[144:147]
    v_mfma_f32_16x16x32_bf16 v[148:151], v[28:31], v[28:31], v[148:151]
    v_mfma_f32_16x16x32_bf16 v[144:147], v[236:239], v[28:31], v[144:147]
    v_mfma_f32_16x16x32_bf16 v[148:151], v[32:35], v[32:35], v[148:151]
    v_mfma_f32_16x16x32_bf16 v[144:147], v[236:239], v[32:35], v[144:147]
    v_mfma_f32_16x16x32_bf16 v[148:151], v[36:39], v[36:39], v[148:151]
    v_mfma_f32_16x16x32_bf16 v[144:147], v[236:239], v[36:39], v[144:147]
    v_mfma_f32_16x16x32_bf16 v[148:151], v[40:43], v[40:43], v[148:151]
    v_mfma_f32_16x16x32_bf16 v[144:147], v[236:239], v[40:43], v[144:147]
    v_mfma_f32_16x16x32_bf16 v[148:151], v[44:47], v[44:47], v[148:151]
    v_mfma_f32_16x16x32_bf16 v[144:147], v[236:239], v[44:47], v[144:147]
    v_mfma_f32_16x16x32_bf16 v[148:151], v[48:51], v[48:51], v[148:151]
    v_mfma_f32_16x16x32_bf16 v[144:147], v[236:239], v[48:51], v[144:147]
    v_mfma_f32_16x16x32_bf16 v[148:151], v[52:55], v[52:55], v[148:151]
    v_mfma_f32_16x16x32_bf16 v[144:147], v[236:239], v[52:55], v[144:147]
    ds_write_b128 v10, v[16:19] offset:0
    ds_write_b128 v10, v[20:23] offset:1024
    ds_write_b128 v10, v[24:27] offset:2048
    ds_write_b128 v10, v[28:31] offset:3072
    ds_write_b128 v10, v[32:35] offset:4096
    ds_write_b128 v10, v[36:39] offset:5120
    ds_write_b128 v10, v[40:43] offset:6144
    ds_write_b128 v10, v[44:47] offset:7168
    ds_write_b128 v10, v[48:51] offset:8192
    ds_write_b128 v10, v[52:55] offset:9216
    v_cndmask_b32 v145, v148, v149, s[48:49]
    v_cndmask_b32 v145, v145, v150, s[50:51]
    v_cndmask_b32 v145, v145, v151, s[54:55]
    ds_write_b64 v140, v[144:145]
    s_add_u32 s40, s40, 1
    s_add_u32 s63, s40, 1
    s_lshr_b32 s63, s63, s75
    s_add_u32 s63, s63, 1
    s_min_u32 s63, s63, s74
    v_cmp_le_i32 vcc, s63, v152
    s_cmp_eq_u64 vcc, -1
    s_cselect_b32 s58, 1, 0
    s_cmp_ge_i32 s62, s63
    s_cselect_b32 s58, 1, s58
    s_and_b32 s24, s40, 1
    s_lshl_b32 s24, s24, 2
    s_add_u32 s24, s24, 83456
    s_lshl_b32 s25, s3, 4
    s_add_u32 s25, s25, s24
    v_mov_b32 v15, s25
    v_mov_b32 v152, s58
    ds_write_b32 v15, v152
    v_mov_b32 v15, s24
    s_waitcnt lgkmcnt(0)
    s_barrier
    ds_read_b32 v152, v15
    s_waitcnt lgkmcnt(0)
    v_readfirstlane_b32 s58, v152
    s_cmp_eq_u32 s58, 1
    s_cselect_b32 s24, s63, s62
    s_max_i32 s62, s62, s24
    s_branch interleave_layers__linear_attn_block__memory_aug_recurrent_mem_tr__prompt_kernel_p_next
interleave_layers__linear_attn_block__memory_aug_recurrent_mem_tr__prompt_kernel_p_seg:
    v_add_u32 v9, s42, v5
    s_xor_b32 s42, s42, 40960
    v_add_u32 v10, s42, v6
    s_add_u32 s63, s40, 1
    s_lshr_b32 s63, s63, s75
    s_add_u32 s63, s63, 1
    s_min_u32 s63, s63, s74
    s_cmp_ge_i32 s62, s63
    s_cbranch_scc1 interleave_layers__linear_attn_block__memory_aug_recurrent_mem_tr__prompt_kernel_p_en_ok
    s_mov_b32 s61, 0
interleave_layers__linear_attn_block__memory_aug_recurrent_mem_tr__prompt_kernel_p_en:
    buffer_load_dword v16, v4, s[8:11], 0 offen sc1
    s_waitcnt vmcnt(0)
    v_readlane_b32 s62, v16, 0
    v_readlane_b32 s24, v16, 1
    s_min_i32 s62, s62, s24
    v_readlane_b32 s24, v16, 2
    s_min_i32 s62, s62, s24
    v_readlane_b32 s24, v16, 3
    s_min_i32 s62, s62, s24
    v_readlane_b32 s24, v16, 4
    s_min_i32 s62, s62, s24
    v_readlane_b32 s24, v16, 5
    s_min_i32 s62, s62, s24
    v_readlane_b32 s24, v16, 6
    s_min_i32 s62, s62, s24
    v_readlane_b32 s24, v16, 7
    s_min_i32 s62, s62, s24
    v_readlane_b32 s24, v16, 8
    s_min_i32 s62, s62, s24
    v_readlane_b32 s24, v16, 9
    s_min_i32 s62, s62, s24
    v_readlane_b32 s24, v16, 10
    s_min_i32 s62, s62, s24
    v_readlane_b32 s24, v16, 11
    s_min_i32 s62, s62, s24
    v_readlane_b32 s24, v16, 12
    s_min_i32 s62, s62, s24
    v_readlane_b32 s24, v16, 13
    s_min_i32 s62, s62, s24
    v_readlane_b32 s24, v16, 14
    s_min_i32 s62, s62, s24
    v_readlane_b32 s24, v16, 15
    s_min_i32 s62, s62, s24
    v_readlane_b32 s24, v16, 16
    s_min_i32 s62, s62, s24
    v_readlane_b32 s24, v16, 17
    s_min_i32 s62, s62, s24
    v_readlane_b32 s24, v16, 18
    s_min_i32 s62, s62, s24
    v_readlane_b32 s24, v16, 19
    s_min_i32 s62, s62, s24
    s_cmp_ge_i32 s62, s63
    s_cbranch_scc1 interleave_layers__linear_attn_block__memory_aug_recurrent_mem_tr__prompt_kernel_p_en_ok
    s_add_u32 s61, s61, 1
    s_cmp_ge_u32 s61, s60
    s_cbranch_scc1 interleave_layers__linear_attn_block__memory_aug_recurrent_mem_tr__prompt_kernel_p_en_to
    s_sleep 2
    s_branch interleave_layers__linear_attn_block__memory_aug_recurrent_mem_tr__prompt_kernel_p_en
interleave_layers__linear_attn_block__memory_aug_recurrent_mem_tr__prompt_kernel_p_en_to:
    s_mov_b32 s60, 1
interleave_layers__linear_attn_block__memory_aug_recurrent_mem_tr__prompt_kernel_p_en_ok:
    s_add_u32 s41, s41, 40960
    buffer_load_dwordx4 v[16:19], v6, s[8:11], s41 offen offset:0
    buffer_load_dwordx4 v[20:23], v6, s[8:11], s41 offen offset:1024
    buffer_load_dwordx4 v[24:27], v6, s[8:11], s41 offen offset:2048
    buffer_load_dwordx4 v[28:31], v6, s[8:11], s41 offen offset:3072
    buffer_load_dwordx4 v[32:35], v7, s[8:11], s41 offen offset:0
    buffer_load_dwordx4 v[36:39], v7, s[8:11], s41 offen offset:1024
    buffer_load_dwordx4 v[40:43], v7, s[8:11], s41 offen offset:2048
    buffer_load_dwordx4 v[44:47], v7, s[8:11], s41 offen offset:3072
    buffer_load_dwordx4 v[48:51], v8, s[8:11], s41 offen offset:0
    buffer_load_dwordx4 v[52:55], v8, s[8:11], s41 offen offset:1024
    s_and_b32 s24, s40, 1
    s_lshl_b32 s24, s24, 9
    v_add_u32 v124, s24, v13
    s_xor_b32 s24, s24, 512
    v_add_u32 v140, s24, v12
    ds_read_b128 v[112:115], v124
    ds_read_b128 v[116:119], v124 offset:256
    ds_read_b128 v[56:59], v9 offset:0
    ds_read_b128 v[60:63], v9 offset:20480
    ds_read_b128 v[64:67], v9 offset:1024
    ds_read_b128 v[68:71], v9 offset:21504
    ds_read_b128 v[72:75], v9 offset:2048
    ds_read_b128 v[76:79], v9 offset:22528
    ds_read_b128 v[80:83], v9 offset:3072
    ds_read_b128 v[84:87], v9 offset:23552
    s_waitcnt lgkmcnt(6)
    v_mfma_f32_16x16x32_bf16 v[88:91], a[0:3], v[56:59], 0
    v_add_f32 v112, v112, v114
    v_mfma_f32_16x16x32_bf16 v[92:95], a[80:83], v[56:59], 0
    v_add_f32 v113, v113, v115
    v_mfma_f32_16x16x32_bf16 v[96:99], a[160:163], v[56:59], 0
    v_mul_f32 v112, 0x3acccccd, v112
    v_mfma_f32_16x16x32_bf16 v[100:103], a[0:3], v[60:63], 0
    v_mul_f32 v114, v112, v112
    v_mfma_f32_16x16x32_bf16 v[104:107], a[80:83], v[60:63], 0
    v_mov_b32 v115, 0x3acccccd
    v_mfma_f32_16x16x32_bf16 v[108:111], a[160:163], v[60:63], 0
    v_fma_f32 v113, v113, v115, -v114
    ds_read_b128 v[56:59], v9 offset:4096
    ds_read_b128 v[60:63], v9 offset:24576
    s_waitcnt lgkmcnt(6)
    v_mfma_f32_16x16x32_bf16 v[88:91], a[4:7], v[64:67], v[88:91]
    v_max_f32 v113, 0, v113
    v_mfma_f32_16x16x32_bf16 v[92:95], a[84:87], v[64:67], v[92:95]
    v_add_f32 v113, 0x3727c5ac, v113
    v_mfma_f32_16x16x32_bf16 v[96:99], a[164:167], v[64:67], v[96:99]
    v_rsq_f32 v132, v113
    v_mfma_f32_16x16x32_bf16 v[100:103], a[4:7], v[68:71], v[100:103]
    v_mul_f32 v133, v112, v132
    v_mfma_f32_16x16x32_bf16 v[104:107], a[84:87], v[68:71], v[104:107]
    v_sub_f32 v133, 0, v133
    v_mfma_f32_16x16x32_bf16 v[108:111], a[164:167], v[68:71], v[108:111]
    v_add_f32 v116, v116, v118
    ds_read_b128 v[64:67], v9 offset:5120
    ds_read_b128 v[68:71], v9 offset:25600
    s_waitcnt lgkmcnt(6)
    v_mfma_f32_16x16x32_bf16 v[88:91], a[8:11], v[72:75], v[88:91]
    v_add_f32 v117, v117, v119
    v_mfma_f32_16x16x32_bf16 v[92:95], a[88:91], v[72:75], v[92:95]
    v_mul_f32 v116, 0x3acccccd, v116
    v_mfma_f32_16x16x32_bf16 v[96:99], a[168:171], v[72:75], v[96:99]
    v_mul_f32 v118, v116, v116
    v_mfma_f32_16x16x32_bf16 v[100:103], a[8:11], v[76:79], v[100:103]
    v_mov_b32 v119, 0x3acccccd
    v_mfma_f32_16x16x32_bf16 v[104:107], a[88:91], v[76:79], v[104:107]
    v_fma_f32 v117, v117, v119, -v118
    v_mfma_f32_16x16x32_bf16 v[108:111], a[168:171], v[76:79], v[108:111]
    v_max_f32 v117, 0, v117
    ds_read_b128 v[72:75], v9 offset:6144
    ds_read_b128 v[76:79], v9 offset:26624
    s_waitcnt lgkmcnt(6)
    v_mfma_f32_16x16x32_bf16 v[88:91], a[12:15], v[80:83], v[88:91]
    v_add_f32 v117, 0x3727c5ac, v117
    v_mfma_f32_16x16x32_bf16 v[92:95], a[92:95], v[80:83], v[92:95]
    v_rsq_f32 v134, v117
    v_mfma_f32_16x16x32_bf16 v[96:99], a[172:175], v[80:83], v[96:99]
    v_mul_f32 v135, v116, v134
    v_mfma_f32_16x16x32_bf16 v[100:103], a[12:15], v[84:87], v[100:103]
    v_sub_f32 v135, 0, v135
    v_mfma_f32_16x16x32_bf16 v[104:107], a[92:95], v[84:87], v[104:107]
    v_mfma_f32_16x16x32_bf16 v[108:111], a[172:175], v[84:87], v[108:111]
    ds_read_b128 v[80:83], v9 offset:7168
    ds_read_b128 v[84:87], v9 offset:27648
    s_waitcnt lgkmcnt(6)
    v_mfma_f32_16x16x32_bf16 v[88:91], a[16:19], v[56:59], v[88:91]
    v_mfma_f32_16x16x32_bf16 v[92:95], a[96:99], v[56:59], v[92:95]
    v_mfma_f32_16x16x32_bf16 v[96:99], a[176:179], v[56:59], v[96:99]
    v_mfma_f32_16x16x32_bf16 v[100:103], a[16:19], v[60:63], v[100:103]
    v_mfma_f32_16x16x32_bf16 v[104:107], a[96:99], v[60:63], v[104:107]
    v_mfma_f32_16x16x32_bf16 v[108:111], a[176:179], v[60:63], v[108:111]
    ds_read_b128 v[56:59], v9 offset:8192
    ds_read_b128 v[60:63], v9 offset:28672
    s_waitcnt lgkmcnt(6)
    v_mfma_f32_16x16x32_bf16 v[88:91], a[20:23], v[64:67], v[88:91]
    v_mfma_f32_16x16x32_bf16 v[92:95], a[100:103], v[64:67], v[92:95]
    v_mfma_f32_16x16x32_bf16 v[96:99], a[180:183], v[64:67], v[96:99]
    v_mfma_f32_16x16x32_bf16 v[100:103], a[20:23], v[68:71], v[100:103]
    v_mfma_f32_16x16x32_bf16 v[104:107], a[100:103], v[68:71], v[104:107]
    v_mfma_f32_16x16x32_bf16 v[108:111], a[180:183], v[68:71], v[108:111]
    ds_read_b128 v[64:67], v9 offset:9216
    ds_read_b128 v[68:71], v9 offset:29696
    s_waitcnt lgkmcnt(6)
    v_mfma_f32_16x16x32_bf16 v[88:91], a[24:27], v[72:75], v[88:91]
    v_mfma_f32_16x16x32_bf16 v[92:95], a[104:107], v[72:75], v[92:95]
    v_mfma_f32_16x16x32_bf16 v[96:99], a[184:187], v[72:75], v[96:99]
    v_mfma_f32_16x16x32_bf16 v[100:103], a[24:27], v[76:79], v[100:103]
    v_mfma_f32_16x16x32_bf16 v[104:107], a[104:107], v[76:79], v[104:107]
    v_mfma_f32_16x16x32_bf16 v[108:111], a[184:187], v[76:79], v[108:111]
    ds_read_b128 v[72:75], v9 offset:10240
    ds_read_b128 v[76:79], v9 offset:30720
    s_waitcnt lgkmcnt(6)
    v_mfma_f32_16x16x32_bf16 v[88:91], a[28:31], v[80:83], v[88:91]
    v_mfma_f32_16x16x32_bf16 v[92:95], a[108:111], v[80:83], v[92:95]
    v_mfma_f32_16x16x32_bf16 v[96:99], a[188:191], v[80:83], v[96:99]
    v_mfma_f32_16x16x32_bf16 v[100:103], a[28:31], v[84:87], v[100:103]
    v_mfma_f32_16x16x32_bf16 v[104:107], a[108:111], v[84:87], v[104:107]
    v_mfma_f32_16x16x32_bf16 v[108:111], a[188:191], v[84:87], v[108:111]
    ds_read_b128 v[80:83], v9 offset:11264
    ds_read_b128 v[84:87], v9 offset:31744
    s_waitcnt lgkmcnt(6)
    v_mfma_f32_16x16x32_bf16 v[88:91], a[32:35], v[56:59], v[88:91]
    v_mfma_f32_16x16x32_bf16 v[92:95], a[112:115], v[56:59], v[92:95]
    v_mfma_f32_16x16x32_bf16 v[96:99], a[192:195], v[56:59], v[96:99]
    v_mfma_f32_16x16x32_bf16 v[100:103], a[32:35], v[60:63], v[100:103]
    v_mfma_f32_16x16x32_bf16 v[104:107], a[112:115], v[60:63], v[104:107]
    v_mfma_f32_16x16x32_bf16 v[108:111], a[192:195], v[60:63], v[108:111]
    ds_read_b128 v[56:59], v9 offset:12288
    ds_read_b128 v[60:63], v9 offset:32768
    s_waitcnt lgkmcnt(6)
    v_mfma_f32_16x16x32_bf16 v[88:91], a[36:39], v[64:67], v[88:91]
    v_mfma_f32_16x16x32_bf16 v[92:95], a[116:119], v[64:67], v[92:95]
    v_mfma_f32_16x16x32_bf16 v[96:99], a[196:199], v[64:67], v[96:99]
    v_mfma_f32_16x16x32_bf16 v[100:103], a[36:39], v[68:71], v[100:103]
    v_mfma_f32_16x16x32_bf16 v[104:107], a[116:119], v[68:71], v[104:107]
    v_mfma_f32_16x16x32_bf16 v[108:111], a[196:199], v[68:71], v[108:111]
    s_waitcnt vmcnt(10)
    s_barrier
    v_mov_b32 v15, s40
    buffer_store_dword v15, v14, s[8:11], 0 offen sc1
    s_cmp_ge_i32 s79, 0
    s_cselect_b32 s24, 0, 2146435072
    v_or_b32 v246, s24, v245
    v_mov_b32 v247, s79
    buffer_store_dword v247, v246, s[8:11], 0 offen sc1
    s_mov_b32 s79, -1
    buffer_load_dword v152, v4, s[8:11], 0 offen sc1
    ds_read_b128 v[64:67], v9 offset:13312
    ds_read_b128 v[68:71], v9 offset:33792
    s_waitcnt lgkmcnt(6)
    v_mfma_f32_16x16x32_bf16 v[88:91], a[40:43], v[72:75], v[88:91]
    v_mfma_f32_16x16x32_bf16 v[92:95], a[120:123], v[72:75], v[92:95]
    v_mfma_f32_16x16x32_bf16 v[96:99], a[200:203], v[72:75], v[96:99]
    v_mfma_f32_16x16x32_bf16 v[100:103], a[40:43], v[76:79], v[100:103]
    v_mfma_f32_16x16x32_bf16 v[104:107], a[120:123], v[76:79], v[104:107]
    v_mfma_f32_16x16x32_bf16 v[108:111], a[200:203], v[76:79], v[108:111]
    ds_read_b128 v[72:75], v9 offset:14336
    ds_read_b128 v[76:79], v9 offset:34816
    s_waitcnt lgkmcnt(6)
    s_waitcnt vmcnt(3)
    v_mfma_f32_16x16x32_bf16 v[88:91], a[44:47], v[80:83], v[88:91]
    v_mfma_f32_16x16x32_bf16 v[92:95], a[124:127], v[80:83], v[92:95]
    ds_write_b128 v10, v[16:19] offset:0
    v_mfma_f32_16x16x32_bf16 v[96:99], a[204:207], v[80:83], v[96:99]
    v_mfma_f32_16x16x32_bf16 v[100:103], a[44:47], v[84:87], v[100:103]
    v_mfma_f32_16x16x32_bf16 v[104:107], a[124:127], v[84:87], v[104:107]
    v_mfma_f32_16x16x32_bf16 v[108:111], a[204:207], v[84:87], v[108:111]
    v_mfma_f32_16x16x32_bf16 v[148:151], v[16:19], v[16:19], 0
    v_mfma_f32_16x16x32_bf16 v[144:147], v[236:239], v[16:19], 0
    v_mfma_f32_16x16x32_bf16 v[148:151], v[20:23], v[20:23], v[148:151]
    ds_read_b128 v[80:83], v9 offset:15360
    ds_read_b128 v[84:87], v9 offset:35840
    s_waitcnt lgkmcnt(7)
    v_mfma_f32_16x16x32_bf16 v[88:91], a[48:51], v[56:59], v[88:91]
    v_mfma_f32_16x16x32_bf16 v[92:95], a[128:131], v[56:59], v[92:95]
    ds_write_b128 v10, v[20:23] offset:1024
    v_mfma_f32_16x16x32_bf16 v[96:99], a[208:211], v[56:59], v[96:99]
    v_mfma_f32_16x16x32_bf16 v[100:103], a[48:51], v[60:63], v[100:103]
    v_mfma_f32_16x16x32_bf16 v[104:107], a[128:131], v[60:63], v[104:107]
    v_mfma_f32_16x16x32_bf16 v[108:111], a[208:211], v[60:63], v[108:111]
    v_mfma_f32_16x16x32_bf16 v[144:147], v[236:239], v[20:23], v[144:147]
    v_mfma_f32_16x16x32_bf16 v[148:151], v[24:27], v[24:27], v[148:151]
    v_mfma_f32_16x16x32_bf16 v[144:147], v[236:239], v[24:27], v[144:147]
    ds_read_b128 v[56:59], v9 offset:16384
    ds_read_b128 v[60:63], v9 offset:36864
    s_waitcnt lgkmcnt(8)
    v_mfma_f32_16x16x32_bf16 v[88:91], a[52:55], v[64:67], v[88:91]
    v_mfma_f32_16x16x32_bf16 v[92:95], a[132:135], v[64:67], v[92:95]
    ds_write_b128 v10, v[24:27] offset:2048
    v_mfma_f32_16x16x32_bf16 v[96:99], a[212:215], v[64:67], v[96:99]
    v_mfma_f32_16x16x32_bf16 v[100:103], a[52:55], v[68:71], v[100:103]
    v_mfma_f32_16x16x32_bf16 v[104:107], a[132:135], v[68:71], v[104:107]
    v_mfma_f32_16x16x32_bf16 v[108:111], a[212:215], v[68:71], v[108:111]
    v_mfma_f32_16x16x32_bf16 v[148:151], v[28:31], v[28:31], v[148:151]
    v_mfma_f32_16x16x32_bf16 v[144:147], v[236:239], v[28:31], v[144:147]
    v_mfma_f32_16x16x32_bf16 v[148:151], v[32:35], v[32:35], v[148:151]
    ds_read_b128 v[64:67], v9 offset:17408
    ds_read_b128 v[68:71], v9 offset:37888
    s_waitcnt lgkmcnt(9)
    v_mfma_f32_16x16x32_bf16 v[88:91], a[56:59], v[72:75], v[88:91]
    v_mfma_f32_16x16x32_bf16 v[92:95], a[136:139], v[72:75], v[92:95]
    ds_write_b128 v10, v[28:31] offset:3072
    v_mfma_f32_16x16x32_bf16 v[96:99], a[216:219], v[72:75], v[96:99]
    v_mfma_f32_16x16x32_bf16 v[100:103], a[56:59], v[76:79], v[100:103]
    v_mfma_f32_16x16x32_bf16 v[104:107], a[136:139], v[76:79], v[104:107]
    v_mfma_f32_16x16x32_bf16 v[108:111], a[216:219], v[76:79], v[108:111]
    v_mfma_f32_16x16x32_bf16 v[144:147], v[236:239], v[32:35], v[144:147]
    v_mfma_f32_16x16x32_bf16 v[148:151], v[36:39], v[36:39], v[148:151]
    v_mfma_f32_16x16x32_bf16 v[144:147], v[236:239], v[36:39], v[144:147]
    ds_read_b128 v[72:75], v9 offset:18432
    ds_read_b128 v[76:79], v9 offset:38912
    s_waitcnt lgkmcnt(9)
    v_mfma_f32_16x16x32_bf16 v[88:91], a[60:63], v[80:83], v[88:91]
    v_mfma_f32_16x16x32_bf16 v[92:95], a[140:143], v[80:83], v[92:95]
    ds_write_b128 v10, v[32:35] offset:4096
    v_mfma_f32_16x16x32_bf16 v[96:99], a[220:223], v[80:83], v[96:99]
    v_mfma_f32_16x16x32_bf16 v[100:103], a[60:63], v[84:87], v[100:103]
    v_mfma_f32_16x16x32_bf16 v[104:107], a[140:143], v[84:87], v[104:107]
    v_mfma_f32_16x16x32_bf16 v[108:111], a[220:223], v[84:87], v[108:111]
    v_mfma_f32_16x16x32_bf16 v[148:151], v[40:43], v[40:43], v[148:151]
    v_mfma_f32_16x16x32_bf16 v[144:147], v[236:239], v[40:43], v[144:147]
    v_mfma_f32_16x16x32_bf16 v[148:151], v[44:47], v[44:47], v[148:151]
    ds_read_b128 v[80:83], v9 offset:19456
    ds_read_b128 v[84:87], v9 offset:39936
    s_waitcnt lgkmcnt(9)
    v_mfma_f32_16x16x32_bf16 v[88:91], a[64:67], v[56:59], v[88:91]
    v_mfma_f32_16x16x32_bf16 v[92:95], a[144:147], v[56:59], v[92:95]
    ds_write_b128 v10, v[36:39] offset:5120
    v_mfma_f32_16x16x32_bf16 v[96:99], a[224:227], v[56:59], v[96:99]
    v_mfma_f32_16x16x32_bf16 v[100:103], a[64:67], v[60:63], v[100:103]
    v_mfma_f32_16x16x32_bf16 v[104:107], a[144:147], v[60:63], v[104:107]
    v_mfma_f32_16x16x32_bf16 v[108:111], a[224:227], v[60:63], v[108:111]
    v_mfma_f32_16x16x32_bf16 v[144:147], v[236:239], v[44:47], v[144:147]
    v_mfma_f32_16x16x32_bf16 v[148:151], v[48:51], v[48:51], v[148:151]
    v_mfma_f32_16x16x32_bf16 v[144:147], v[236:239], v[48:51], v[144:147]
    s_waitcnt lgkmcnt(7)
    v_mfma_f32_16x16x32_bf16 v[88:91], a[68:71], v[64:67], v[88:91]
    v_mfma_f32_16x16x32_bf16 v[92:95], a[148:151], v[64:67], v[92:95]
    ds_write_b128 v10, v[40:43] offset:6144
    v_mfma_f32_16x16x32_bf16 v[96:99], a[228:231], v[64:67], v[96:99]
    v_mfma_f32_16x16x32_bf16 v[100:103], a[68:71], v[68:71], v[100:103]
    v_mfma_f32_16x16x32_bf16 v[104:107], a[148:151], v[68:71], v[104:107]
    v_mfma_f32_16x16x32_bf16 v[108:111], a[228:231], v[68:71], v[108:111]
    v_mfma_f32_16x16x32_bf16 v[148:151], v[52:55], v[52:55], v[148:151]
    v_mfma_f32_16x16x32_bf16 v[144:147], v[236:239], v[52:55], v[144:147]
    s_waitcnt lgkmcnt(5)
    v_mfma_f32_16x16x32_bf16 v[88:91], a[72:75], v[72:75], v[88:91]
    v_mfma_f32_16x16x32_bf16 v[92:95], a[152:155], v[72:75], v[92:95]
    ds_write_b128 v10, v[44:47] offset:7168
    v_mfma_f32_16x16x32_bf16 v[96:99], a[232:235], v[72:75], v[96:99]
    v_mfma_f32_16x16x32_bf16 v[100:103], a[72:75], v[76:79], v[100:103]
    v_mfma_f32_16x16x32_bf16 v[104:107], a[152:155], v[76:79], v[104:107]
    v_mfma_f32_16x16x32_bf16 v[108:111], a[232:235], v[76:79], v[108:111]
    s_waitcnt lgkmcnt(3)
    v_mfma_f32_16x16x32_bf16 v[88:91], a[76:79], v[80:83], v[88:91]
    v_mfma_f32_16x16x32_bf16 v[92:95], a[156:159], v[80:83], v[92:95]
    ds_write_b128 v10, v[48:51] offset:8192
    v_mfma_f32_16x16x32_bf16 v[96:99], a[236:239], v[80:83], v[96:99]
    v_mfma_f32_16x16x32_bf16 v[100:103], a[76:79], v[84:87], v[100:103]
    v_mfma_f32_16x16x32_bf16 v[104:107], a[156:159], v[84:87], v[104:107]
    v_mfma_f32_16x16x32_bf16 v[108:111], a[236:239], v[84:87], v[108:111]
    v_cndmask_b32 v145, v148, v149, s[48:49]
    v_cndmask_b32 v145, v145, v150, s[50:51]
    v_cndmask_b32 v145, v145, v151, s[54:55]
    ds_write_b128 v10, v[52:55] offset:9216
    ds_write_b64 v140, v[144:145]
    v_pk_mul_f32 v[124:125], v[224:225], v[132:133] op_sel:[0,1] op_sel_hi:[1,1]
    v_pk_mul_f32 v[126:127], v[226:227], v[132:133] op_sel:[0,1] op_sel_hi:[1,1]
    v_pk_fma_f32 v[88:89], v[88:89], v[132:133], v[124:125] op_sel:[0,0,0] op_sel_hi:[1,0,1]
    v_pk_fma_f32 v[90:91], v[90:91], v[132:133], v[126:127] op_sel:[0,0,0] op_sel_hi:[1,0,1]
    v_pk_mul_f32 v[124:125], v[228:229], v[132:133] op_sel:[0,1] op_sel_hi:[1,1]
    v_pk_mul_f32 v[126:127], v[230:231], v[132:133] op_sel:[0,1] op_sel_hi:[1,1]
    v_pk_fma_f32 v[92:93], v[92:93], v[132:133], v[124:125] op_sel:[0,0,0] op_sel_hi:[1,0,1]
    v_pk_fma_f32 v[94:95], v[94:95], v[132:133], v[126:127] op_sel:[0,0,0] op_sel_hi:[1,0,1]
    v_pk_mul_f32 v[124:125], v[232:233], v[132:133] op_sel:[0,1] op_sel_hi:[1,1]
    v_pk_mul_f32 v[126:127], v[234:235], v[132:133] op_sel:[0,1] op_sel_hi:[1,1]
    v_pk_fma_f32 v[96:97], v[96:97], v[132:133], v[124:125] op_sel:[0,0,0] op_sel_hi:[1,0,1]
    v_pk_fma_f32 v[98:99], v[98:99], v[132:133], v[126:127] op_sel:[0,0,0] op_sel_hi:[1,0,1]
    v_pk_mul_f32 v[124:125], v[224:225], v[134:135] op_sel:[0,1] op_sel_hi:[1,1]
    v_pk_mul_f32 v[126:127], v[226:227], v[134:135] op_sel:[0,1] op_sel_hi:[1,1]
    v_pk_fma_f32 v[100:101], v[100:101], v[134:135], v[124:125] op_sel:[0,0,0] op_sel_hi:[1,0,1]
    v_pk_fma_f32 v[102:103], v[102:103], v[134:135], v[126:127] op_sel:[0,0,0] op_sel_hi:[1,0,1]
    v_pk_mul_f32 v[124:125], v[228:229], v[134:135] op_sel:[0,1] op_sel_hi:[1,1]
    v_pk_mul_f32 v[126:127], v[230:231], v[134:135] op_sel:[0,1] op_sel_hi:[1,1]
    v_pk_fma_f32 v[104:105], v[104:105], v[134:135], v[124:125] op_sel:[0,0,0] op_sel_hi:[1,0,1]
    v_pk_fma_f32 v[106:107], v[106:107], v[134:135], v[126:127] op_sel:[0,0,0] op_sel_hi:[1,0,1]
    v_pk_mul_f32 v[124:125], v[232:233], v[134:135] op_sel:[0,1] op_sel_hi:[1,1]
    v_pk_mul_f32 v[126:127], v[234:235], v[134:135] op_sel:[0,1] op_sel_hi:[1,1]
    v_pk_fma_f32 v[108:109], v[108:109], v[134:135], v[124:125] op_sel:[0,0,0] op_sel_hi:[1,0,1]
    v_pk_fma_f32 v[110:111], v[110:111], v[134:135], v[126:127] op_sel:[0,0,0] op_sel_hi:[1,0,1]
    v_cvt_pk_bf16_f32 v112, v88, v89
    v_cvt_pk_bf16_f32 v113, v90, v91
    v_cvt_pk_bf16_f32 v114, v92, v93
    v_cvt_pk_bf16_f32 v115, v94, v95
    v_cvt_pk_bf16_f32 v116, v100, v101
    v_cvt_pk_bf16_f32 v117, v102, v103
    v_cvt_pk_bf16_f32 v118, v104, v105
    v_cvt_pk_bf16_f32 v119, v106, v107
    v_cvt_pk_bf16_f32 v120, v96, v97
    v_cvt_pk_bf16_f32 v121, v98, v99
    v_cvt_pk_bf16_f32 v122, v108, v109
    v_cvt_pk_bf16_f32 v123, v110, v111
    buffer_store_dwordx4 v[112:115], v11, s[8:11], s43 offen offset:0 sc1
    buffer_store_dwordx4 v[116:119], v11, s[8:11], s43 offen offset:1024 sc1
    buffer_store_dwordx4 v[120:123], v11, s[8:11], s43 offen offset:2048 sc1
    s_add_u32 s43, s43, 393216
    s_waitcnt vmcnt(3)
    s_add_u32 s40, s40, 1
    s_add_u32 s63, s40, 1
    s_lshr_b32 s63, s63, s75
    s_add_u32 s63, s63, 1
    s_min_u32 s63, s63, s74
    v_cmp_le_i32 vcc, s63, v152
    s_cmp_eq_u64 vcc, -1
    s_cselect_b32 s58, 1, 0
    s_cmp_ge_i32 s62, s63
    s_cselect_b32 s58, 1, s58
    s_and_b32 s24, s40, 1
    s_lshl_b32 s24, s24, 2
    s_add_u32 s24, s24, 83456
    s_lshl_b32 s25, s3, 4
    s_add_u32 s25, s25, s24
    v_mov_b32 v15, s25
    v_mov_b32 v152, s58
    ds_write_b32 v15, v152
    v_mov_b32 v15, s24
    s_waitcnt lgkmcnt(0)
    s_barrier
    ds_read_b32 v152, v15
    s_waitcnt lgkmcnt(0)
    v_readfirstlane_b32 s58, v152
    s_cmp_eq_u32 s58, 1
    s_cselect_b32 s24, s63, s62
    s_max_i32 s62, s62, s24
interleave_layers__linear_attn_block__memory_aug_recurrent_mem_tr__prompt_kernel_p_next:
    s_add_u32 s24, s64, 8
    s_cmp_le_u32 s24, s40
    s_cbranch_scc1 interleave_layers__linear_attn_block__memory_aug_recurrent_mem_tr__prompt_kernel_p_pub
    s_cmp_lt_u32 s40, 64
    s_cbranch_scc0 interleave_layers__linear_attn_block__memory_aug_recurrent_mem_tr__prompt_kernel_pg32
    s_cmp_eq_u32 s58, 1
    s_cbranch_scc1 interleave_layers__linear_attn_block__memory_aug_recurrent_mem_tr__prompt_kernel_p_seg
    s_branch interleave_layers__linear_attn_block__memory_aug_recurrent_mem_tr__prompt_kernel_p_pubA
interleave_layers__linear_attn_block__memory_aug_recurrent_mem_tr__prompt_kernel_pg32:
interleave_layers__linear_attn_block__memory_aug_recurrent_mem_tr__prompt_kernel_p_pub:
    s_waitcnt vmcnt(0)
    s_barrier
    s_cmp_eq_u32 s3, 0
    s_cbranch_scc0 interleave_layers__linear_attn_block__memory_aug_recurrent_mem_tr__prompt_kernel_fp33
    v_mov_b32 v15, s40
    buffer_store_dword v15, v14, s[8:11], 0 offen sc1
interleave_layers__linear_attn_block__memory_aug_recurrent_mem_tr__prompt_kernel_fp33:
    s_add_u32 s24, s64, 8
    s_cmp_le_u32 s24, s40
    s_cbranch_scc1 interleave_layers__linear_attn_block__memory_aug_recurrent_mem_tr__prompt_kernel_p_x
    s_cmp_lt_u32 s40, 64
    s_cbranch_scc0 interleave_layers__linear_attn_block__memory_aug_recurrent_mem_tr__prompt_kernel_pg34
    s_cmp_eq_u32 s58, 1
    s_cbranch_scc1 interleave_layers__linear_attn_block__memory_aug_recurrent_mem_tr__prompt_kernel_p_seg
    s_branch interleave_layers__linear_attn_block__memory_aug_recurrent_mem_tr__prompt_kernel_p_pubA
interleave_layers__linear_attn_block__memory_aug_recurrent_mem_tr__prompt_kernel_pg34:
    s_cmp_ge_u32 s64, 64
    s_cbranch_scc1 interleave_layers__linear_attn_block__memory_aug_recurrent_mem_tr__prompt_kernel_p_done
interleave_layers__linear_attn_block__memory_aug_recurrent_mem_tr__prompt_kernel_p_x:
    s_add_u32 s63, s64, 1
    s_cmp_ge_i32 s69, s63
    s_cbranch_scc1 interleave_layers__linear_attn_block__memory_aug_recurrent_mem_tr__prompt_kernel_x_en_ok
    s_mov_b32 s61, 0
interleave_layers__linear_attn_block__memory_aug_recurrent_mem_tr__prompt_kernel_x_en:
    buffer_load_dword v253, v252, s[8:11], 0 offen sc1
    s_waitcnt vmcnt(0)
    v_readlane_b32 s69, v253, 0
    v_readlane_b32 s24, v253, 1
    s_min_i32 s69, s69, s24
    v_readlane_b32 s24, v253, 2
    s_min_i32 s69, s69, s24
    v_readlane_b32 s24, v253, 3
    s_min_i32 s69, s69, s24
    v_readlane_b32 s24, v253, 4
    s_min_i32 s69, s69, s24
    v_readlane_b32 s24, v253, 5
    s_min_i32 s69, s69, s24
    v_readlane_b32 s24, v253, 6
    s_min_i32 s69, s69, s24
    v_readlane_b32 s24, v253, 7
    s_min_i32 s69, s69, s24
    s_cmp_ge_i32 s69, s63
    s_cbranch_scc1 interleave_layers__linear_attn_block__memory_aug_recurrent_mem_tr__prompt_kernel_x_en_ok
    s_add_u32 s61, s61, 1
    s_cmp_ge_u32 s61, s60
    s_cbranch_scc1 interleave_layers__linear_attn_block__memory_aug_recurrent_mem_tr__prompt_kernel_x_en_to
    s_sleep 2
    s_branch interleave_layers__linear_attn_block__memory_aug_recurrent_mem_tr__prompt_kernel_x_en
interleave_layers__linear_attn_block__memory_aug_recurrent_mem_tr__prompt_kernel_x_en_to:
    s_mov_b32 s60, 1
interleave_layers__linear_attn_block__memory_aug_recurrent_mem_tr__prompt_kernel_x_en_ok:
    s_lshl_b32 s95, s92, 6
    s_add_u32 s95, s95, s64
    s_add_u32 s95, s95, 1
    s_cmp_ge_i32 s59, s95
    s_cbranch_scc1 interleave_layers__linear_attn_block__memory_aug_recurrent_mem_tr__prompt_kernel_x_ec_ok
    s_and_b32 s24, s2, 7
    s_lshl_b32 s24, s24, 7
    s_add_u32 s24, s24, 23109632
    v_and_b32 v254, 3, v1
    v_lshl_add_u32 v254, v254, 2, s24
    s_mov_b32 s61, 0
interleave_layers__linear_attn_block__memory_aug_recurrent_mem_tr__prompt_kernel_x_ec:
    buffer_load_dword v253, v254, s[8:11], 0 offen sc1
    s_waitcnt vmcnt(0)
    v_readlane_b32 s59, v253, 0
    v_readlane_b32 s24, v253, 1
    s_min_i32 s59, s59, s24
    v_readlane_b32 s24, v253, 2
    s_min_i32 s59, s59, s24
    s_cmp_ge_i32 s59, s95
    s_cbranch_scc1 interleave_layers__linear_attn_block__memory_aug_recurrent_mem_tr__prompt_kernel_x_ec_ok
    s_add_u32 s61, s61, 1
    s_cmp_ge_u32 s61, s60
    s_cbranch_scc1 interleave_layers__linear_attn_block__memory_aug_recurrent_mem_tr__prompt_kernel_x_ec_to
    s_sleep 2
    s_branch interleave_layers__linear_attn_block__memory_aug_recurrent_mem_tr__prompt_kernel_x_ec
interleave_layers__linear_attn_block__memory_aug_recurrent_mem_tr__prompt_kernel_x_ec_to:
    s_mov_b32 s60, 1
interleave_layers__linear_attn_block__memory_aug_recurrent_mem_tr__prompt_kernel_x_ec_ok:
    s_add_u32 s52, s65, 32768
    buffer_load_dwordx4 v[16:19], v240, s[8:11], s65 offen offset:0 sc1
    buffer_load_dwordx4 v[20:23], v240, s[8:11], s65 offen offset:1024 sc1
    buffer_load_dwordx4 v[24:27], v240, s[8:11], s65 offen offset:2048 sc1
    buffer_load_dwordx4 v[28:31], v240, s[8:11], s65 offen offset:3072 sc1
    buffer_load_dwordx4 v[32:35], v241, s[8:11], s65 offen offset:0 sc1
    buffer_load_dwordx4 v[36:39], v241, s[8:11], s65 offen offset:1024 sc1
    buffer_load_dwordx4 v[40:43], v241, s[8:11], s65 offen offset:2048 sc1
    buffer_load_dwordx4 v[44:47], v241, s[8:11], s65 offen offset:3072 sc1
    buffer_load_dwordx4 v[48:51], v240, s[8:11], s52 offen offset:0 sc1
    buffer_load_dwordx4 v[52:55], v240, s[8:11], s52 offen offset:1024 sc1
    buffer_load_dwordx4 v[56:59], v240, s[8:11], s52 offen offset:2048 sc1
    buffer_load_dwordx4 v[60:63], v240, s[8:11], s52 offen offset:3072 sc1
    buffer_load_dwordx4 v[64:67], v241, s[8:11], s52 offen offset:0 sc1
    buffer_load_dwordx4 v[68:71], v241, s[8:11], s52 offen offset:1024 sc1
    buffer_load_dwordx4 v[72:75], v241, s[8:11], s52 offen offset:2048 sc1
    buffer_load_dwordx4 v[76:79], v241, s[8:11], s52 offen offset:3072 sc1
    s_add_u32 s24, s68, s73
    buffer_load_dwordx4 v[196:199], v219, s[8:11], s24 offen sc1
    s_lshl_b32 s77, s92, 6
    s_add_u32 s77, s77, s64
    s_add_u32 s77, s77, 1
    s_cmp_ge_i32 s76, s77
    s_cbranch_scc1 interleave_layers__linear_attn_block__memory_aug_recurrent_mem_tr__prompt_kernel_x_cs_ok
    s_and_b32 s24, s2, 7
    s_lshl_b32 s24, s24, 7
    s_add_u32 s24, s24, 23111680
    v_mov_b32 v254, s24
    s_mov_b32 s61, 0
interleave_layers__linear_attn_block__memory_aug_recurrent_mem_tr__prompt_kernel_x_cs:
    buffer_load_dword v253, v254, s[8:11], 0 offen sc1
    s_waitcnt vmcnt(0)
    v_readlane_b32 s76, v253, 0
    s_cmp_ge_i32 s76, s77
    s_cbranch_scc1 interleave_layers__linear_attn_block__memory_aug_recurrent_mem_tr__prompt_kernel_x_cs_ok
    s_add_u32 s61, s61, 1
    s_cmp_ge_u32 s61, s60
    s_cbranch_scc1 interleave_layers__linear_attn_block__memory_aug_recurrent_mem_tr__prompt_kernel_x_cs_to
    s_sleep 16
    s_branch interleave_layers__linear_attn_block__memory_aug_recurrent_mem_tr__prompt_kernel_x_cs
interleave_layers__linear_attn_block__memory_aug_recurrent_mem_tr__prompt_kernel_x_cs_to:
    s_mov_b32 s60, 1
interleave_layers__linear_attn_block__memory_aug_recurrent_mem_tr__prompt_kernel_x_cs_ok:
    s_add_u32 s53, s66, 16384
    s_mov_b32 s61, 0
interleave_layers__linear_attn_block__memory_aug_recurrent_mem_tr__prompt_kernel_x_p1:
    buffer_load_dwordx4 v[80:83], v212, s[8:11], s67 offen offset:0 sc1
    buffer_load_dwordx4 v[84:87], v212, s[8:11], s67 offen offset:1024 sc1
    buffer_load_dwordx4 v[88:91], v212, s[8:11], s67 offen offset:2048 sc1
    buffer_load_dwordx4 v[92:95], v212, s[8:11], s67 offen offset:3072 sc1
    buffer_load_dwordx4 v[96:99], v213, s[8:11], s67 offen offset:0 sc1
    buffer_load_dwordx4 v[100:103], v213, s[8:11], s67 offen offset:1024 sc1
    buffer_load_dwordx4 v[104:107], v213, s[8:11], s67 offen offset:2048 sc1
    buffer_load_dwordx4 v[108:111], v213, s[8:11], s67 offen offset:3072 sc1
    buffer_load_dwordx4 v[112:115], v214, s[8:11], s67 offen offset:0 sc1
    buffer_load_dwordx4 v[116:119], v214, s[8:11], s67 offen offset:1024 sc1
    buffer_load_dwordx4 v[120:123], v214, s[8:11], s67 offen offset:2048 sc1
    buffer_load_dwordx4 v[124:127], v214, s[8:11], s67 offen offset:3072 sc1
    buffer_load_dwordx4 v[128:131], v215, s[8:11], s67 offen offset:0 sc1
    buffer_load_dwordx4 v[132:135], v215, s[8:11], s67 offen offset:1024 sc1
    buffer_load_dwordx4 v[136:139], v215, s[8:11], s67 offen offset:2048 sc1
    buffer_load_dwordx4 v[140:143], v215, s[8:11], s67 offen offset:3072 sc1
    buffer_load_dwordx4 v[144:147], v216, s[8:11], s67 offen offset:0 sc1
    buffer_load_dwordx4 v[148:151], v216, s[8:11], s67 offen offset:1024 sc1
    buffer_load_dwordx4 v[152:155], v216, s[8:11], s67 offen offset:2048 sc1
    buffer_load_dwordx4 v[156:159], v216, s[8:11], s67 offen offset:3072 sc1
    buffer_load_dwordx4 v[160:163], v242, s[8:11], s66 offen offset:0 sc1
    buffer_load_dwordx4 v[164:167], v242, s[8:11], s66 offen offset:1024 sc1
    buffer_load_dwordx4 v[168:171], v242, s[8:11], s53 offen offset:0 sc1
    buffer_load_dwordx4 v[172:175], v242, s[8:11], s53 offen offset:1024 sc1
    s_waitcnt vmcnt(0)
    v_max3_u32 v192, v80, v81, v82
    v_max3_u32 v192, v192, v83, v84
    v_max3_u32 v192, v192, v85, v86
    v_max3_u32 v192, v192, v87, v88
    v_max3_u32 v192, v192, v89, v90
    v_max3_u32 v192, v192, v91, v92
    v_max3_u32 v192, v192, v93, v94
    v_max3_u32 v192, v192, v95, v96
    v_max3_u32 v192, v192, v97, v98
    v_max3_u32 v192, v192, v99, v100
    v_max3_u32 v192, v192, v101, v102
    v_max3_u32 v192, v192, v103, v104
    v_max3_u32 v192, v192, v105, v106
    v_max3_u32 v192, v192, v107, v108
    v_max3_u32 v192, v192, v109, v110
    v_max3_u32 v192, v192, v111, v112
    v_max3_u32 v192, v192, v113, v114
    v_max3_u32 v192, v192, v115, v116
    v_max3_u32 v192, v192, v117, v118
    v_max3_u32 v192, v192, v119, v120
    v_max3_u32 v192, v192, v121, v122
    v_max3_u32 v192, v192, v123, v124
    v_max3_u32 v192, v192, v125, v126
    v_max3_u32 v192, v192, v127, v128
    v_max3_u32 v192, v192, v129, v130
    v_max3_u32 v192, v192, v131, v132
    v_max3_u32 v192, v192, v133, v134
    v_max3_u32 v192, v192, v135, v136
    v_max3_u32 v192, v192, v137, v138
    v_max3_u32 v192, v192, v139, v140
    v_max3_u32 v192, v192, v141, v142
    v_max3_u32 v192, v192, v143, v144
    v_max3_u32 v192, v192, v145, v146
    v_max3_u32 v192, v192, v147, v148
    v_max3_u32 v192, v192, v149, v150
    v_max3_u32 v192, v192, v151, v152
    v_max3_u32 v192, v192, v153, v154
    v_max3_u32 v192, v192, v155, v156
    v_max3_u32 v192, v192, v157, v158
    v_max3_u32 v192, v192, v159, v160
    v_max3_u32 v192, v192, v161, v162
    v_max3_u32 v192, v192, v163, v164
    v_max3_u32 v192, v192, v165, v166
    v_max3_u32 v192, v192, v167, v168
    v_max3_u32 v192, v192, v169, v170
    v_max3_u32 v192, v192, v171, v172
    v_max3_u32 v192, v192, v173, v174
    v_max_u32 v192, v192, v175
    v_cmp_eq_u32 vcc, -1, v192
    s_add_u32 s61, s61, 1
    s_cbranch_vccz interleave_layers__linear_attn_block__memory_aug_recurrent_mem_tr__prompt_kernel_x_p1_out
    s_cmp_ge_u32 s61, s60
    s_cbranch_scc1 interleave_layers__linear_attn_block__memory_aug_recurrent_mem_tr__prompt_kernel_x_p1_to
    s_sleep 2
    s_branch interleave_layers__linear_attn_block__memory_aug_recurrent_mem_tr__prompt_kernel_x_p1
interleave_layers__linear_attn_block__memory_aug_recurrent_mem_tr__prompt_kernel_x_p1_to:
    s_mov_b32 s60, 1
interleave_layers__linear_attn_block__memory_aug_recurrent_mem_tr__prompt_kernel_x_p1_out:
    v_mfma_f32_16x16x32_bf16 v[176:179], v[16:19], v[80:83], 0
    v_mfma_f32_16x16x32_bf16 v[180:183], v[16:19], v[84:87], 0
    v_mfma_f32_16x16x32_bf16 v[184:187], v[48:51], v[80:83], 0
    v_mfma_f32_16x16x32_bf16 v[188:191], v[48:51], v[84:87], 0
    v_mfma_f32_16x16x32_bf16 v[176:179], v[20:23], v[88:91], v[176:179]
    v_mfma_f32_16x16x32_bf16 v[180:183], v[20:23], v[92:95], v[180:183]
    v_mfma_f32_16x16x32_bf16 v[184:187], v[52:55], v[88:91], v[184:187]
    v_mfma_f32_16x16x32_bf16 v[188:191], v[52:55], v[92:95], v[188:191]
    v_mfma_f32_16x16x32_bf16 v[176:179], v[24:27], v[96:99], v[176:179]
    v_mfma_f32_16x16x32_bf16 v[180:183], v[24:27], v[100:103], v[180:183]
    v_mfma_f32_16x16x32_bf16 v[184:187], v[56:59], v[96:99], v[184:187]
    v_mfma_f32_16x16x32_bf16 v[188:191], v[56:59], v[100:103], v[188:191]
    v_mfma_f32_16x16x32_bf16 v[176:179], v[28:31], v[104:107], v[176:179]
    v_mfma_f32_16x16x32_bf16 v[180:183], v[28:31], v[108:111], v[180:183]
    v_mfma_f32_16x16x32_bf16 v[184:187], v[60:63], v[104:107], v[184:187]
    v_mfma_f32_16x16x32_bf16 v[188:191], v[60:63], v[108:111], v[188:191]
    v_mfma_f32_16x16x32_bf16 v[176:179], v[32:35], v[112:115], v[176:179]
    v_mfma_f32_16x16x32_bf16 v[180:183], v[32:35], v[116:119], v[180:183]
    v_mfma_f32_16x16x32_bf16 v[184:187], v[64:67], v[112:115], v[184:187]
    v_mfma_f32_16x16x32_bf16 v[188:191], v[64:67], v[116:119], v[188:191]
    v_mfma_f32_16x16x32_bf16 v[176:179], v[36:39], v[120:123], v[176:179]
    v_mfma_f32_16x16x32_bf16 v[180:183], v[36:39], v[124:127], v[180:183]
    v_mfma_f32_16x16x32_bf16 v[184:187], v[68:71], v[120:123], v[184:187]
    v_mfma_f32_16x16x32_bf16 v[188:191], v[68:71], v[124:127], v[188:191]
    v_mfma_f32_16x16x32_bf16 v[176:179], v[40:43], v[128:131], v[176:179]
    v_mfma_f32_16x16x32_bf16 v[180:183], v[40:43], v[132:135], v[180:183]
    v_mfma_f32_16x16x32_bf16 v[184:187], v[72:75], v[128:131], v[184:187]
    v_mfma_f32_16x16x32_bf16 v[188:191], v[72:75], v[132:135], v[188:191]
    v_mfma_f32_16x16x32_bf16 v[176:179], v[44:47], v[136:139], v[176:179]
    v_mfma_f32_16x16x32_bf16 v[180:183], v[44:47], v[140:143], v[180:183]
    v_mfma_f32_16x16x32_bf16 v[184:187], v[76:79], v[136:139], v[184:187]
    v_mfma_f32_16x16x32_bf16 v[188:191], v[76:79], v[140:143], v[188:191]
    v_mfma_f32_16x16x32_bf16 v[176:179], v[160:163], v[144:147], v[176:179]
    v_mfma_f32_16x16x32_bf16 v[180:183], v[160:163], v[148:151], v[180:183]
    v_mfma_f32_16x16x32_bf16 v[184:187], v[168:171], v[144:147], v[184:187]
    v_mfma_f32_16x16x32_bf16 v[188:191], v[168:171], v[148:151], v[188:191]
    v_mfma_f32_16x16x32_bf16 v[176:179], v[164:167], v[152:155], v[176:179]
    v_mfma_f32_16x16x32_bf16 v[180:183], v[164:167], v[156:159], v[180:183]
    v_mfma_f32_16x16x32_bf16 v[184:187], v[172:175], v[152:155], v[184:187]
    v_mfma_f32_16x16x32_bf16 v[188:191], v[172:175], v[156:159], v[188:191]
    s_nop 4
    ds_write_b128 v217, v[176:179] offset:0
    ds_write_b128 v217, v[180:183] offset:1024
    ds_write_b128 v217, v[184:187] offset:2048
    ds_write_b128 v217, v[188:191] offset:3072
    s_waitcnt lgkmcnt(0)
    s_barrier
    s_cmp_ge_u32 s3, 2
    s_cbranch_scc1 interleave_layers__linear_attn_block__memory_aug_recurrent_mem_tr__prompt_kernel_xs35
    ds_read_b128 v[16:19], v218 offset:0
    ds_read_b128 v[20:23], v218 offset:4096
    ds_read_b128 v[24:27], v218 offset:8192
    ds_read_b128 v[28:31], v218 offset:12288
    ds_read_b128 v[32:35], v218 offset:2048
    ds_read_b128 v[36:39], v218 offset:6144
    ds_read_b128 v[40:43], v218 offset:10240
    ds_read_b128 v[44:47], v218 offset:14336
    s_waitcnt lgkmcnt(4)
    v_pk_add_f32 v[16:17], v[16:17], v[20:21]
    v_pk_add_f32 v[24:25], v[24:25], v[28:29]
    v_pk_add_f32 v[18:19], v[18:19], v[22:23]
    v_pk_add_f32 v[26:27], v[26:27], v[30:31]
    v_pk_add_f32 v[16:17], v[16:17], v[24:25]
    v_pk_add_f32 v[18:19], v[18:19], v[26:27]
    v_cvt_pk_bf16_f32 v20, v16, v17
    v_cvt_pk_bf16_f32 v21, v18, v19
    v_lshlrev_b32 v16, 16, v20
    v_and_b32 v17, 0xffff0000, v20
    v_lshlrev_b32 v22, 16, v196
    v_and_b32 v23, 0xffff0000, v196
    v_pk_add_f32 v[16:17], v[16:17], v[22:23]
    v_cvt_pk_bf16_f32 v48, v16, v17
    v_lshlrev_b32 v16, 16, v21
    v_and_b32 v17, 0xffff0000, v21
    v_lshlrev_b32 v22, 16, v197
    v_and_b32 v23, 0xffff0000, v197
    v_pk_add_f32 v[16:17], v[16:17], v[22:23]
    v_cvt_pk_bf16_f32 v49, v16, v17
    s_waitcnt lgkmcnt(0)
    v_pk_add_f32 v[32:33], v[32:33], v[36:37]
    v_pk_add_f32 v[40:41], v[40:41], v[44:45]
    v_pk_add_f32 v[34:35], v[34:35], v[38:39]
    v_pk_add_f32 v[42:43], v[42:43], v[46:47]
    v_pk_add_f32 v[32:33], v[32:33], v[40:41]
    v_pk_add_f32 v[34:35], v[34:35], v[42:43]
    v_cvt_pk_bf16_f32 v36, v32, v33
    v_cvt_pk_bf16_f32 v37, v34, v35
    v_lshlrev_b32 v32, 16, v36
    v_and_b32 v33, 0xffff0000, v36
    v_lshlrev_b32 v38, 16, v198
    v_and_b32 v39, 0xffff0000, v198
    v_pk_add_f32 v[32:33], v[32:33], v[38:39]
    v_cvt_pk_bf16_f32 v50, v32, v33
    v_lshlrev_b32 v32, 16, v37
    v_and_b32 v33, 0xffff0000, v37
    v_lshlrev_b32 v38, 16, v199
    v_and_b32 v39, 0xffff0000, v199
    v_pk_add_f32 v[32:33], v[32:33], v[38:39]
    v_cvt_pk_bf16_f32 v51, v32, v33
    s_cmp_eq_u32 s92, 0
    s_cbranch_scc0 interleave_layers__linear_attn_block__memory_aug_recurrent_mem_tr__prompt_kernel_xo36
    s_add_u32 s24, s68, 4194304
    buffer_store_dwordx4 v[48:51], v219, s[8:11], s24 offen sc1
    s_branch interleave_layers__linear_attn_block__memory_aug_recurrent_mem_tr__prompt_kernel_xs35
interleave_layers__linear_attn_block__memory_aug_recurrent_mem_tr__prompt_kernel_xo36:
    buffer_store_dwordx2 v[48:49], v243, s[12:15], s68 offen
    buffer_store_dwordx2 v[50:51], v243, s[12:15], s68 offen offset:32
interleave_layers__linear_attn_block__memory_aug_recurrent_mem_tr__prompt_kernel_xs35:
    s_lshr_b32 s25, s64, 2
    s_add_u32 s25, s25, 1
    s_cmp_eq_u32 s92, 0
    s_cselect_b32 s79, s25, -1
    s_cmp_lt_u32 s40, 64
    s_cbranch_scc1 interleave_layers__linear_attn_block__memory_aug_recurrent_mem_tr__prompt_kernel_xp37
    s_waitcnt vmcnt(0)
    s_barrier
    s_cmp_ge_i32 s79, 0
    s_cselect_b32 s24, 0, 2146435072
    v_or_b32 v246, s24, v245
    v_mov_b32 v247, s79
    buffer_store_dword v247, v246, s[8:11], 0 offen sc1
    s_mov_b32 s79, -1
interleave_layers__linear_attn_block__memory_aug_recurrent_mem_tr__prompt_kernel_xp37:
    s_add_u32 s64, s64, 4
    s_add_u32 s65, s65, 5242880
    s_add_u32 s66, s66, 4194304
    s_add_u32 s67, s67, 4194304
    s_add_u32 s68, s68, 163840
    s_branch interleave_layers__linear_attn_block__memory_aug_recurrent_mem_tr__prompt_kernel_p_next
interleave_layers__linear_attn_block__memory_aug_recurrent_mem_tr__prompt_kernel_p_done:
    s_cmp_eq_u32 s92, 0
    s_cbranch_scc0 interleave_layers__linear_attn_block__memory_aug_recurrent_mem_tr__prompt_kernel_end
    s_mov_b32 s92, 1
    s_branch interleave_layers__linear_attn_block__memory_aug_recurrent_mem_tr__prompt_kernel_p_layer
interleave_layers__linear_attn_block__memory_aug_recurrent_mem_tr__prompt_kernel_roleO:
    s_sub_u32 s44, s2, 200
    s_load_dwordx2 s[6:7], s[0:1], 64
    s_waitcnt lgkmcnt(0)
    s_mov_b32 s12, s6
    s_mov_b32 s13, s7
    s_mov_b32 s14, 7864320
    s_mov_b32 s15, 0x00020000
    v_add_u32 v8, 0, v0
    s_mov_b32 s24, 3277
    v_mul_lo_u32 v9, v8, s24
    v_lshrrev_b32 v9, 18, v9
    v_mul_u32_u24 v10, 80, v9
    v_sub_u32 v10, v8, v10
    v_mul_u32_u24 v16, 1312, v9
    v_lshl_add_u32 v16, v10, 4, v16
    v_add_u32 v8, 256, v0
    s_mov_b32 s24, 3277
    v_mul_lo_u32 v9, v8, s24
    v_lshrrev_b32 v9, 18, v9
    v_mul_u32_u24 v10, 80, v9
    v_sub_u32 v10, v8, v10
    v_mul_u32_u24 v17, 1312, v9
    v_lshl_add_u32 v17, v10, 4, v17
    v_add_u32 v8, 512, v0
    s_mov_b32 s24, 3277
    v_mul_lo_u32 v9, v8, s24
    v_lshrrev_b32 v9, 18, v9
    v_mul_u32_u24 v10, 80, v9
    v_sub_u32 v10, v8, v10
    v_mul_u32_u24 v18, 1312, v9
    v_lshl_add_u32 v18, v10, 4, v18
    v_add_u32 v8, 768, v0
    s_mov_b32 s24, 3277
    v_mul_lo_u32 v9, v8, s24
    v_lshrrev_b32 v9, 18, v9
    v_mul_u32_u24 v10, 80, v9
    v_sub_u32 v10, v8, v10
    v_mul_u32_u24 v19, 1312, v9
    v_lshl_add_u32 v19, v10, 4, v19
    v_add_u32 v8, 1024, v0
    s_mov_b32 s24, 3277
    v_mul_lo_u32 v9, v8, s24
    v_lshrrev_b32 v9, 18, v9
    v_mul_u32_u24 v10, 80, v9
    v_sub_u32 v10, v8, v10
    v_mul_u32_u24 v20, 1312, v9
    v_lshl_add_u32 v20, v10, 4, v20
    v_add_u32 v8, 1280, v0
    s_mov_b32 s24, 3277
    v_mul_lo_u32 v9, v8, s24
    v_lshrrev_b32 v9, 18, v9
    v_mul_u32_u24 v10, 80, v9
    v_sub_u32 v10, v8, v10
    v_mul_u32_u24 v21, 1312, v9
    v_lshl_add_u32 v21, v10, 4, v21
    v_add_u32 v8, 1536, v0
    s_mov_b32 s24, 3277
    v_mul_lo_u32 v9, v8, s24
    v_lshrrev_b32 v9, 18, v9
    v_mul_u32_u24 v10, 80, v9
    v_sub_u32 v10, v8, v10
    v_mul_u32_u24 v22, 1312, v9
    v_lshl_add_u32 v22, v10, 4, v22
    v_add_u32 v8, 1792, v0
    s_mov_b32 s24, 3277
    v_mul_lo_u32 v9, v8, s24
    v_lshrrev_b32 v9, 18, v9
    v_mul_u32_u24 v10, 80, v9
    v_sub_u32 v10, v8, v10
    v_mul_u32_u24 v23, 1312, v9
    v_lshl_add_u32 v23, v10, 4, v23
    v_add_u32 v8, 2048, v0
    s_mov_b32 s24, 3277
    v_mul_lo_u32 v9, v8, s24
    v_lshrrev_b32 v9, 18, v9
    v_mul_u32_u24 v10, 80, v9
    v_sub_u32 v10, v8, v10
    v_mul_u32_u24 v24, 1312, v9
    v_lshl_add_u32 v24, v10, 4, v24
    v_add_u32 v8, 2304, v0
    s_mov_b32 s24, 3277
    v_mul_lo_u32 v9, v8, s24
    v_lshrrev_b32 v9, 18, v9
    v_mul_u32_u24 v10, 80, v9
    v_sub_u32 v10, v8, v10
    v_mul_u32_u24 v25, 1312, v9
    v_lshl_add_u32 v25, v10, 4, v25
    v_add_u32 v8, 2560, v0
    s_mov_b32 s24, 3277
    v_mul_lo_u32 v9, v8, s24
    v_lshrrev_b32 v9, 18, v9
    v_mul_u32_u24 v10, 80, v9
    v_sub_u32 v10, v8, v10
    v_mul_u32_u24 v26, 1312, v9
    v_lshl_add_u32 v26, v10, 4, v26
    v_add_u32 v8, 2816, v0
    s_mov_b32 s24, 3277
    v_mul_lo_u32 v9, v8, s24
    v_lshrrev_b32 v9, 18, v9
    v_mul_u32_u24 v10, 80, v9
    v_sub_u32 v10, v8, v10
    v_mul_u32_u24 v27, 1312, v9
    v_lshl_add_u32 v27, v10, 4, v27
    v_add_u32 v8, 3072, v0
    s_mov_b32 s24, 3277
    v_mul_lo_u32 v9, v8, s24
    v_lshrrev_b32 v9, 18, v9
    v_mul_u32_u24 v10, 80, v9
    v_sub_u32 v10, v8, v10
    v_mul_u32_u24 v28, 1312, v9
    v_lshl_add_u32 v28, v10, 4, v28
    v_add_u32 v8, 3328, v0
    s_mov_b32 s24, 3277
    v_mul_lo_u32 v9, v8, s24
    v_lshrrev_b32 v9, 18, v9
    v_mul_u32_u24 v10, 80, v9
    v_sub_u32 v10, v8, v10
    v_mul_u32_u24 v29, 1312, v9
    v_lshl_add_u32 v29, v10, 4, v29
    v_add_u32 v8, 3584, v0
    s_mov_b32 s24, 3277
    v_mul_lo_u32 v9, v8, s24
    v_lshrrev_b32 v9, 18, v9
    v_mul_u32_u24 v10, 80, v9
    v_sub_u32 v10, v8, v10
    v_mul_u32_u24 v30, 1312, v9
    v_lshl_add_u32 v30, v10, 4, v30
    v_add_u32 v8, 3840, v0
    s_mov_b32 s24, 3277
    v_mul_lo_u32 v9, v8, s24
    v_lshrrev_b32 v9, 18, v9
    v_mul_u32_u24 v10, 80, v9
    v_sub_u32 v10, v8, v10
    v_mul_u32_u24 v31, 1312, v9
    v_lshl_add_u32 v31, v10, 4, v31
    v_add_u32 v8, 4096, v0
    s_mov_b32 s24, 3277
    v_mul_lo_u32 v9, v8, s24
    v_lshrrev_b32 v9, 18, v9
    v_mul_u32_u24 v10, 80, v9
    v_sub_u32 v10, v8, v10
    v_mul_u32_u24 v32, 1312, v9
    v_lshl_add_u32 v32, v10, 4, v32
    v_add_u32 v8, 4352, v0
    s_mov_b32 s24, 3277
    v_mul_lo_u32 v9, v8, s24
    v_lshrrev_b32 v9, 18, v9
    v_mul_u32_u24 v10, 80, v9
    v_sub_u32 v10, v8, v10
    v_mul_u32_u24 v33, 1312, v9
    v_lshl_add_u32 v33, v10, 4, v33
    v_add_u32 v8, 4608, v0
    s_mov_b32 s24, 3277
    v_mul_lo_u32 v9, v8, s24
    v_lshrrev_b32 v9, 18, v9
    v_mul_u32_u24 v10, 80, v9
    v_sub_u32 v10, v8, v10
    v_mul_u32_u24 v34, 1312, v9
    v_lshl_add_u32 v34, v10, 4, v34
    v_add_u32 v8, 4864, v0
    s_mov_b32 s24, 3277
    v_mul_lo_u32 v9, v8, s24
    v_lshrrev_b32 v9, 18, v9
    v_mul_u32_u24 v10, 80, v9
    v_sub_u32 v10, v8, v10
    v_mul_u32_u24 v35, 1312, v9
    v_lshl_add_u32 v35, v10, 4, v35
    v_add_u32 v8, 5120, v0
    s_mov_b32 s24, 3277
    v_mul_lo_u32 v9, v8, s24
    v_lshrrev_b32 v9, 18, v9
    v_mul_u32_u24 v10, 80, v9
    v_sub_u32 v10, v8, v10
    v_mul_u32_u24 v36, 1312, v9
    v_lshl_add_u32 v36, v10, 4, v36
    v_add_u32 v8, 5376, v0
    s_mov_b32 s24, 3277
    v_mul_lo_u32 v9, v8, s24
    v_lshrrev_b32 v9, 18, v9
    v_mul_u32_u24 v10, 80, v9
    v_sub_u32 v10, v8, v10
    v_mul_u32_u24 v37, 1312, v9
    v_lshl_add_u32 v37, v10, 4, v37
    v_add_u32 v8, 5632, v0
    s_mov_b32 s24, 3277
    v_mul_lo_u32 v9, v8, s24
    v_lshrrev_b32 v9, 18, v9
    v_mul_u32_u24 v10, 80, v9
    v_sub_u32 v10, v8, v10
    v_mul_u32_u24 v38, 1312, v9
    v_lshl_add_u32 v38, v10, 4, v38
    v_add_u32 v8, 5888, v0
    s_mov_b32 s24, 3277
    v_mul_lo_u32 v9, v8, s24
    v_lshrrev_b32 v9, 18, v9
    v_mul_u32_u24 v10, 80, v9
    v_sub_u32 v10, v8, v10
    v_mul_u32_u24 v39, 1312, v9
    v_lshl_add_u32 v39, v10, 4, v39
    v_add_u32 v8, 6144, v0
    s_mov_b32 s24, 3277
    v_mul_lo_u32 v9, v8, s24
    v_lshrrev_b32 v9, 18, v9
    v_mul_u32_u24 v10, 80, v9
    v_sub_u32 v10, v8, v10
    v_mul_u32_u24 v40, 1312, v9
    v_lshl_add_u32 v40, v10, 4, v40
    v_add_u32 v8, 6400, v0
    s_mov_b32 s24, 3277
    v_mul_lo_u32 v9, v8, s24
    v_lshrrev_b32 v9, 18, v9
    v_mul_u32_u24 v10, 80, v9
    v_sub_u32 v10, v8, v10
    v_mul_u32_u24 v41, 1312, v9
    v_lshl_add_u32 v41, v10, 4, v41
    v_add_u32 v8, 6656, v0
    s_mov_b32 s24, 3277
    v_mul_lo_u32 v9, v8, s24
    v_lshrrev_b32 v9, 18, v9
    v_mul_u32_u24 v10, 80, v9
    v_sub_u32 v10, v8, v10
    v_mul_u32_u24 v42, 1312, v9
    v_lshl_add_u32 v42, v10, 4, v42
    v_add_u32 v8, 6912, v0
    s_mov_b32 s24, 3277
    v_mul_lo_u32 v9, v8, s24
    v_lshrrev_b32 v9, 18, v9
    v_mul_u32_u24 v10, 80, v9
    v_sub_u32 v10, v8, v10
    v_mul_u32_u24 v43, 1312, v9
    v_lshl_add_u32 v43, v10, 4, v43
    v_add_u32 v8, 7168, v0
    s_mov_b32 s24, 3277
    v_mul_lo_u32 v9, v8, s24
    v_lshrrev_b32 v9, 18, v9
    v_mul_u32_u24 v10, 80, v9
    v_sub_u32 v10, v8, v10
    v_mul_u32_u24 v44, 1312, v9
    v_lshl_add_u32 v44, v10, 4, v44
    v_add_u32 v8, 7424, v0
    s_mov_b32 s24, 3277
    v_mul_lo_u32 v9, v8, s24
    v_lshrrev_b32 v9, 18, v9
    v_mul_u32_u24 v10, 80, v9
    v_sub_u32 v10, v8, v10
    v_mul_u32_u24 v45, 1312, v9
    v_lshl_add_u32 v45, v10, 4, v45
    v_lshlrev_b32 v4, 4, v0
    s_mul_i32 s45, s44, 245760
    s_add_u32 s46, s45, 0
    buffer_load_dwordx4 v[48:51], v4, s[12:15], s46 offen
    s_add_u32 s46, s45, 4096
    buffer_load_dwordx4 v[52:55], v4, s[12:15], s46 offen
    s_add_u32 s46, s45, 8192
    buffer_load_dwordx4 v[56:59], v4, s[12:15], s46 offen
    s_add_u32 s46, s45, 12288
    buffer_load_dwordx4 v[60:63], v4, s[12:15], s46 offen
    s_add_u32 s46, s45, 16384
    buffer_load_dwordx4 v[64:67], v4, s[12:15], s46 offen
    s_add_u32 s46, s45, 20480
    buffer_load_dwordx4 v[68:71], v4, s[12:15], s46 offen
    s_add_u32 s46, s45, 24576
    buffer_load_dwordx4 v[72:75], v4, s[12:15], s46 offen
    s_add_u32 s46, s45, 28672
    buffer_load_dwordx4 v[76:79], v4, s[12:15], s46 offen
    s_add_u32 s46, s45, 32768
    buffer_load_dwordx4 v[80:83], v4, s[12:15], s46 offen
    s_add_u32 s46, s45, 36864
    buffer_load_dwordx4 v[84:87], v4, s[12:15], s46 offen
    s_add_u32 s46, s45, 40960
    buffer_load_dwordx4 v[88:91], v4, s[12:15], s46 offen
    s_add_u32 s46, s45, 45056
    buffer_load_dwordx4 v[92:95], v4, s[12:15], s46 offen
    s_add_u32 s46, s45, 49152
    buffer_load_dwordx4 v[96:99], v4, s[12:15], s46 offen
    s_add_u32 s46, s45, 53248
    buffer_load_dwordx4 v[100:103], v4, s[12:15], s46 offen
    s_add_u32 s46, s45, 57344
    buffer_load_dwordx4 v[104:107], v4, s[12:15], s46 offen
    s_add_u32 s46, s45, 61440
    buffer_load_dwordx4 v[108:111], v4, s[12:15], s46 offen
    s_add_u32 s46, s45, 65536
    buffer_load_dwordx4 v[112:115], v4, s[12:15], s46 offen
    s_add_u32 s46, s45, 69632
    buffer_load_dwordx4 v[116:119], v4, s[12:15], s46 offen
    s_add_u32 s46, s45, 73728
    buffer_load_dwordx4 v[120:123], v4, s[12:15], s46 offen
    s_add_u32 s46, s45, 77824
    buffer_load_dwordx4 v[124:127], v4, s[12:15], s46 offen
    s_add_u32 s46, s45, 81920
    buffer_load_dwordx4 v[128:131], v4, s[12:15], s46 offen
    s_add_u32 s46, s45, 86016
    buffer_load_dwordx4 v[132:135], v4, s[12:15], s46 offen
    s_add_u32 s46, s45, 90112
    buffer_load_dwordx4 v[136:139], v4, s[12:15], s46 offen
    s_add_u32 s46, s45, 94208
    buffer_load_dwordx4 v[140:143], v4, s[12:15], s46 offen
    s_add_u32 s46, s45, 98304
    buffer_load_dwordx4 v[144:147], v4, s[12:15], s46 offen
    s_add_u32 s46, s45, 102400
    buffer_load_dwordx4 v[148:151], v4, s[12:15], s46 offen
    s_add_u32 s46, s45, 106496
    buffer_load_dwordx4 v[152:155], v4, s[12:15], s46 offen
    s_add_u32 s46, s45, 110592
    buffer_load_dwordx4 v[156:159], v4, s[12:15], s46 offen
    s_add_u32 s46, s45, 114688
    buffer_load_dwordx4 v[160:163], v4, s[12:15], s46 offen
    s_add_u32 s46, s45, 118784
    buffer_load_dwordx4 v[164:167], v4, s[12:15], s46 offen
    s_add_u32 s46, s45, 122880
    buffer_load_dwordx4 v[168:171], v4, s[12:15], s46 offen
    s_add_u32 s46, s45, 126976
    buffer_load_dwordx4 v[172:175], v4, s[12:15], s46 offen
    s_add_u32 s46, s45, 131072
    buffer_load_dwordx4 v[176:179], v4, s[12:15], s46 offen
    s_add_u32 s46, s45, 135168
    buffer_load_dwordx4 v[180:183], v4, s[12:15], s46 offen
    s_add_u32 s46, s45, 139264
    buffer_load_dwordx4 v[184:187], v4, s[12:15], s46 offen
    s_add_u32 s46, s45, 143360
    buffer_load_dwordx4 v[188:191], v4, s[12:15], s46 offen
    s_add_u32 s46, s45, 147456
    buffer_load_dwordx4 v[192:195], v4, s[12:15], s46 offen
    s_add_u32 s46, s45, 151552
    buffer_load_dwordx4 v[196:199], v4, s[12:15], s46 offen
    s_add_u32 s46, s45, 155648
    buffer_load_dwordx4 v[200:203], v4, s[12:15], s46 offen
    s_add_u32 s46, s45, 159744
    buffer_load_dwordx4 v[204:207], v4, s[12:15], s46 offen
    s_add_u32 s46, s45, 163840
    buffer_load_dwordx4 v[208:211], v4, s[12:15], s46 offen
    s_add_u32 s46, s45, 167936
    buffer_load_dwordx4 v[212:215], v4, s[12:15], s46 offen
    s_add_u32 s46, s45, 172032
    buffer_load_dwordx4 v[216:219], v4, s[12:15], s46 offen
    s_add_u32 s46, s45, 176128
    buffer_load_dwordx4 v[220:223], v4, s[12:15], s46 offen
    s_add_u32 s46, s45, 180224
    buffer_load_dwordx4 v[224:227], v4, s[12:15], s46 offen
    s_add_u32 s46, s45, 184320
    buffer_load_dwordx4 v[228:231], v4, s[12:15], s46 offen
    s_add_u32 s46, s45, 188416
    buffer_load_dwordx4 v[232:235], v4, s[12:15], s46 offen
    s_add_u32 s46, s45, 192512
    buffer_load_dwordx4 v[236:239], v4, s[12:15], s46 offen
    s_add_u32 s46, s45, 196608
    buffer_load_dwordx4 v[240:243], v4, s[12:15], s46 offen
    s_add_u32 s46, s45, 200704
    buffer_load_dwordx4 v[244:247], v4, s[12:15], s46 offen
    s_add_u32 s46, s45, 204800
    buffer_load_dwordx4 v[248:251], v4, s[12:15], s46 offen
    s_add_u32 s46, s45, 208896
    buffer_load_dwordx4 v[252:255], v4, s[12:15], s46 offen
    v_lshrrev_b32 v8, 2, v2
    v_lshl_add_u32 v8, v3, 2, v8
    v_mul_u32_u24 v5, 1312, v8
    v_and_b32 v8, 3, v2
    v_lshl_add_u32 v5, v8, 3, v5
    s_mul_i32 s24, s3, 320
    v_add_u32 v5, s24, v5
    v_add_u32 v6, 62976, v5
    s_waitcnt vmcnt(22)
    ds_write_b128 v16, v[48:51]
    ds_write_b128 v17, v[52:55]
    ds_write_b128 v18, v[56:59]
    ds_write_b128 v19, v[60:63]
    ds_write_b128 v20, v[64:67]
    ds_write_b128 v21, v[68:71]
    ds_write_b128 v22, v[72:75]
    ds_write_b128 v23, v[76:79]
    ds_write_b128 v24, v[80:83]
    ds_write_b128 v25, v[84:87]
    ds_write_b128 v26, v[88:91]
    ds_write_b128 v27, v[92:95]
    ds_write_b128 v28, v[96:99]
    ds_write_b128 v29, v[100:103]
    ds_write_b128 v30, v[104:107]
    ds_write_b128 v31, v[108:111]
    ds_write_b128 v32, v[112:115]
    ds_write_b128 v33, v[116:119]
    ds_write_b128 v34, v[120:123]
    ds_write_b128 v35, v[124:127]
    ds_write_b128 v36, v[128:131]
    ds_write_b128 v37, v[132:135]
    ds_write_b128 v38, v[136:139]
    ds_write_b128 v39, v[140:143]
    ds_write_b128 v40, v[144:147]
    ds_write_b128 v41, v[148:151]
    ds_write_b128 v42, v[152:155]
    ds_write_b128 v43, v[156:159]
    ds_write_b128 v44, v[160:163]
    ds_write_b128 v45, v[164:167]
    s_waitcnt lgkmcnt(0)
    s_add_u32 s46, s45, 212992
    buffer_load_dwordx4 v[48:51], v4, s[12:15], s46 offen
    s_add_u32 s46, s45, 217088
    buffer_load_dwordx4 v[52:55], v4, s[12:15], s46 offen
    s_add_u32 s46, s45, 221184
    buffer_load_dwordx4 v[56:59], v4, s[12:15], s46 offen
    s_add_u32 s46, s45, 225280
    buffer_load_dwordx4 v[60:63], v4, s[12:15], s46 offen
    s_add_u32 s46, s45, 229376
    buffer_load_dwordx4 v[64:67], v4, s[12:15], s46 offen
    s_add_u32 s46, s45, 233472
    buffer_load_dwordx4 v[68:71], v4, s[12:15], s46 offen
    s_add_u32 s46, s45, 237568
    buffer_load_dwordx4 v[72:75], v4, s[12:15], s46 offen
    s_add_u32 s46, s45, 241664
    buffer_load_dwordx4 v[76:79], v4, s[12:15], s46 offen
    s_barrier
    ds_read_b64_tr_b16 a[0:1], v5 offset:0
    ds_read_b64_tr_b16 a[2:3], v5 offset:20992
    ds_read_b64_tr_b16 a[4:5], v6 offset:0
    ds_read_b64_tr_b16 a[6:7], v6 offset:20992
    ds_read_b64_tr_b16 a[16:17], v5 offset:41984
    ds_read_b64_tr_b16 a[18:19], v6 offset:41984
    ds_read_b64_tr_b16 a[24:25], v5 offset:32
    ds_read_b64_tr_b16 a[26:27], v5 offset:21024
    ds_read_b64_tr_b16 a[28:29], v6 offset:32
    ds_read_b64_tr_b16 a[30:31], v6 offset:21024
    ds_read_b64_tr_b16 a[40:41], v5 offset:42016
    ds_read_b64_tr_b16 a[42:43], v6 offset:42016
    ds_read_b64_tr_b16 a[48:49], v5 offset:64
    ds_read_b64_tr_b16 a[50:51], v5 offset:21056
    ds_read_b64_tr_b16 a[52:53], v6 offset:64
    ds_read_b64_tr_b16 a[54:55], v6 offset:21056
    ds_read_b64_tr_b16 a[64:65], v5 offset:42048
    ds_read_b64_tr_b16 a[66:67], v6 offset:42048
    ds_read_b64_tr_b16 a[72:73], v5 offset:96
    ds_read_b64_tr_b16 a[74:75], v5 offset:21088
    ds_read_b64_tr_b16 a[76:77], v6 offset:96
    ds_read_b64_tr_b16 a[78:79], v6 offset:21088
    ds_read_b64_tr_b16 a[88:89], v5 offset:42080
    ds_read_b64_tr_b16 a[90:91], v6 offset:42080
    ds_read_b64_tr_b16 a[96:97], v5 offset:128
    ds_read_b64_tr_b16 a[98:99], v5 offset:21120
    ds_read_b64_tr_b16 a[100:101], v6 offset:128
    ds_read_b64_tr_b16 a[102:103], v6 offset:21120
    ds_read_b64_tr_b16 a[112:113], v5 offset:42112
    ds_read_b64_tr_b16 a[114:115], v6 offset:42112
    ds_read_b64_tr_b16 a[120:121], v5 offset:160
    ds_read_b64_tr_b16 a[122:123], v5 offset:21152
    ds_read_b64_tr_b16 a[124:125], v6 offset:160
    ds_read_b64_tr_b16 a[126:127], v6 offset:21152
    ds_read_b64_tr_b16 a[136:137], v5 offset:42144
    ds_read_b64_tr_b16 a[138:139], v6 offset:42144
    ds_read_b64_tr_b16 a[144:145], v5 offset:192
    ds_read_b64_tr_b16 a[146:147], v5 offset:21184
    ds_read_b64_tr_b16 a[148:149], v6 offset:192
    ds_read_b64_tr_b16 a[150:151], v6 offset:21184
    ds_read_b64_tr_b16 a[160:161], v5 offset:42176
    ds_read_b64_tr_b16 a[162:163], v6 offset:42176
    ds_read_b64_tr_b16 a[168:169], v5 offset:224
    ds_read_b64_tr_b16 a[170:171], v5 offset:21216
    ds_read_b64_tr_b16 a[172:173], v6 offset:224
    ds_read_b64_tr_b16 a[174:175], v6 offset:21216
    ds_read_b64_tr_b16 a[184:185], v5 offset:42208
    ds_read_b64_tr_b16 a[186:187], v6 offset:42208
    ds_read_b64_tr_b16 a[192:193], v5 offset:256
    ds_read_b64_tr_b16 a[194:195], v5 offset:21248
    ds_read_b64_tr_b16 a[196:197], v6 offset:256
    ds_read_b64_tr_b16 a[198:199], v6 offset:21248
    ds_read_b64_tr_b16 a[208:209], v5 offset:42240
    ds_read_b64_tr_b16 a[210:211], v6 offset:42240
    ds_read_b64_tr_b16 a[216:217], v5 offset:288
    ds_read_b64_tr_b16 a[218:219], v5 offset:21280
    ds_read_b64_tr_b16 a[220:221], v6 offset:288
    ds_read_b64_tr_b16 a[222:223], v6 offset:21280
    ds_read_b64_tr_b16 a[232:233], v5 offset:42272
    ds_read_b64_tr_b16 a[234:235], v6 offset:42272
    s_waitcnt lgkmcnt(0)
    s_barrier
    s_waitcnt vmcnt(0)
    ds_write_b128 v16, v[168:171]
    ds_write_b128 v17, v[172:175]
    ds_write_b128 v18, v[176:179]
    ds_write_b128 v19, v[180:183]
    ds_write_b128 v20, v[184:187]
    ds_write_b128 v21, v[188:191]
    ds_write_b128 v22, v[192:195]
    ds_write_b128 v23, v[196:199]
    ds_write_b128 v24, v[200:203]
    ds_write_b128 v25, v[204:207]
    ds_write_b128 v26, v[208:211]
    ds_write_b128 v27, v[212:215]
    ds_write_b128 v28, v[216:219]
    ds_write_b128 v29, v[220:223]
    ds_write_b128 v30, v[224:227]
    ds_write_b128 v31, v[228:231]
    ds_write_b128 v32, v[232:235]
    ds_write_b128 v33, v[236:239]
    ds_write_b128 v34, v[240:243]
    ds_write_b128 v35, v[244:247]
    ds_write_b128 v36, v[248:251]
    ds_write_b128 v37, v[252:255]
    ds_write_b128 v38, v[48:51]
    ds_write_b128 v39, v[52:55]
    ds_write_b128 v40, v[56:59]
    ds_write_b128 v41, v[60:63]
    ds_write_b128 v42, v[64:67]
    ds_write_b128 v43, v[68:71]
    ds_write_b128 v44, v[72:75]
    ds_write_b128 v45, v[76:79]
    s_waitcnt lgkmcnt(0)
    s_barrier
    ds_read_b64_tr_b16 a[8:9], v5 offset:0
    ds_read_b64_tr_b16 a[10:11], v5 offset:20992
    ds_read_b64_tr_b16 a[12:13], v6 offset:0
    ds_read_b64_tr_b16 a[14:15], v6 offset:20992
    ds_read_b64_tr_b16 a[20:21], v5 offset:41984
    ds_read_b64_tr_b16 a[22:23], v6 offset:41984
    ds_read_b64_tr_b16 a[32:33], v5 offset:32
    ds_read_b64_tr_b16 a[34:35], v5 offset:21024
    ds_read_b64_tr_b16 a[36:37], v6 offset:32
    ds_read_b64_tr_b16 a[38:39], v6 offset:21024
    ds_read_b64_tr_b16 a[44:45], v5 offset:42016
    ds_read_b64_tr_b16 a[46:47], v6 offset:42016
    ds_read_b64_tr_b16 a[56:57], v5 offset:64
    ds_read_b64_tr_b16 a[58:59], v5 offset:21056
    ds_read_b64_tr_b16 a[60:61], v6 offset:64
    ds_read_b64_tr_b16 a[62:63], v6 offset:21056
    ds_read_b64_tr_b16 a[68:69], v5 offset:42048
    ds_read_b64_tr_b16 a[70:71], v6 offset:42048
    ds_read_b64_tr_b16 a[80:81], v5 offset:96
    ds_read_b64_tr_b16 a[82:83], v5 offset:21088
    ds_read_b64_tr_b16 a[84:85], v6 offset:96
    ds_read_b64_tr_b16 a[86:87], v6 offset:21088
    ds_read_b64_tr_b16 a[92:93], v5 offset:42080
    ds_read_b64_tr_b16 a[94:95], v6 offset:42080
    ds_read_b64_tr_b16 a[104:105], v5 offset:128
    ds_read_b64_tr_b16 a[106:107], v5 offset:21120
    ds_read_b64_tr_b16 a[108:109], v6 offset:128
    ds_read_b64_tr_b16 a[110:111], v6 offset:21120
    ds_read_b64_tr_b16 a[116:117], v5 offset:42112
    ds_read_b64_tr_b16 a[118:119], v6 offset:42112
    ds_read_b64_tr_b16 a[128:129], v5 offset:160
    ds_read_b64_tr_b16 a[130:131], v5 offset:21152
    ds_read_b64_tr_b16 a[132:133], v6 offset:160
    ds_read_b64_tr_b16 a[134:135], v6 offset:21152
    ds_read_b64_tr_b16 a[140:141], v5 offset:42144
    ds_read_b64_tr_b16 a[142:143], v6 offset:42144
    ds_read_b64_tr_b16 a[152:153], v5 offset:192
    ds_read_b64_tr_b16 a[154:155], v5 offset:21184
    ds_read_b64_tr_b16 a[156:157], v6 offset:192
    ds_read_b64_tr_b16 a[158:159], v6 offset:21184
    ds_read_b64_tr_b16 a[164:165], v5 offset:42176
    ds_read_b64_tr_b16 a[166:167], v6 offset:42176
    ds_read_b64_tr_b16 a[176:177], v5 offset:224
    ds_read_b64_tr_b16 a[178:179], v5 offset:21216
    ds_read_b64_tr_b16 a[180:181], v6 offset:224
    ds_read_b64_tr_b16 a[182:183], v6 offset:21216
    ds_read_b64_tr_b16 a[188:189], v5 offset:42208
    ds_read_b64_tr_b16 a[190:191], v6 offset:42208
    ds_read_b64_tr_b16 a[200:201], v5 offset:256
    ds_read_b64_tr_b16 a[202:203], v5 offset:21248
    ds_read_b64_tr_b16 a[204:205], v6 offset:256
    ds_read_b64_tr_b16 a[206:207], v6 offset:21248
    ds_read_b64_tr_b16 a[212:213], v5 offset:42240
    ds_read_b64_tr_b16 a[214:215], v6 offset:42240
    ds_read_b64_tr_b16 a[224:225], v5 offset:288
    ds_read_b64_tr_b16 a[226:227], v5 offset:21280
    ds_read_b64_tr_b16 a[228:229], v6 offset:288
    ds_read_b64_tr_b16 a[230:231], v6 offset:21280
    ds_read_b64_tr_b16 a[236:237], v5 offset:42272
    ds_read_b64_tr_b16 a[238:239], v6 offset:42272
    s_waitcnt lgkmcnt(0)
    s_barrier
    v_lshlrev_b32 v5, 4, v1
    s_mul_i32 s24, s44, 12288
    v_add_u32 v6, s24, v5
    v_add_u32 v7, 4096, v6
    v_add_u32 v8, 8192, v6
    s_mul_i32 s24, s3, 327680
    s_lshl_b32 s25, s44, 10
    s_add_u32 s24, s24, s25
    v_add_u32 v9, s24, v5
interleave_layers__linear_attn_block__memory_aug_recurrent_mem_tr__prompt_kernel_o_layer:
    s_mov_b32 s93, 0
    s_lshl_b32 s24, s93, 12
    s_and_b32 s24, s24, 0x2000
    s_xor_b32 s24, s24, s36
    s_lshl_b32 s93, s93, 20
    s_add_u32 s93, s93, s24
    s_add_u32 s93, s93, 117440512
    s_mul_i32 s94, s92, 16384
    s_add_u32 s94, s94, 23068672
    s_mov_b32 s24, 12288
    s_lshl_b32 s25, s44, 7
    s_add_u32 s24, s24, s25
    s_add_u32 s24, s24, s94
    v_mov_b32 v14, s24
    v_mov_b32 v15, 2146435072
    v_cmp_eq_u32 vcc, 0, v1
    s_nop 1
    v_cndmask_b32 v14, v15, v14, vcc
    s_lshl_b32 s24, s44, 7
    s_add_u32 s24, s24, 8192
    s_add_u32 s24, s24, s94
    v_mov_b32 v10, s24
    s_mov_b32 s41, 33554432
    s_mov_b32 s43, 184549376
    s_mov_b32 s40, 0
    s_mov_b32 s62, -1
    s_mov_b32 s63, 1
    s_cmp_ge_i32 s62, s63
    s_cbranch_scc1 interleave_layers__linear_attn_block__memory_aug_recurrent_mem_tr__prompt_kernel_o_en0_ok
    s_mov_b32 s61, 0
interleave_layers__linear_attn_block__memory_aug_recurrent_mem_tr__prompt_kernel_o_en0:
    buffer_load_dword v11, v10, s[8:11], 0 offen sc1
    s_waitcnt vmcnt(0)
    v_readlane_b32 s62, v11, 0
    s_cmp_ge_i32 s62, s63
    s_cbranch_scc1 interleave_layers__linear_attn_block__memory_aug_recurrent_mem_tr__prompt_kernel_o_en0_ok
    s_add_u32 s61, s61, 1
    s_cmp_ge_u32 s61, s60
    s_cbranch_scc1 interleave_layers__linear_attn_block__memory_aug_recurrent_mem_tr__prompt_kernel_o_en0_to
    s_sleep 2
    s_branch interleave_layers__linear_attn_block__memory_aug_recurrent_mem_tr__prompt_kernel_o_en0
interleave_layers__linear_attn_block__memory_aug_recurrent_mem_tr__prompt_kernel_o_en0_to:
    s_mov_b32 s60, 1
interleave_layers__linear_attn_block__memory_aug_recurrent_mem_tr__prompt_kernel_o_en0_ok:
    buffer_load_dwordx4 v[16:19], v6, s[8:11], s41 offen offset:0 sc1
    buffer_load_dwordx4 v[20:23], v6, s[8:11], s41 offen offset:1024 sc1
    buffer_load_dwordx4 v[24:27], v6, s[8:11], s41 offen offset:2048 sc1
    buffer_load_dwordx4 v[28:31], v6, s[8:11], s41 offen offset:3072 sc1
    buffer_load_dwordx4 v[32:35], v7, s[8:11], s41 offen offset:0 sc1
    buffer_load_dwordx4 v[36:39], v7, s[8:11], s41 offen offset:1024 sc1
    buffer_load_dwordx4 v[40:43], v7, s[8:11], s41 offen offset:2048 sc1
    buffer_load_dwordx4 v[44:47], v7, s[8:11], s41 offen offset:3072 sc1
    buffer_load_dwordx4 v[48:51], v8, s[8:11], s41 offen offset:0 sc1
    buffer_load_dwordx4 v[52:55], v8, s[8:11], s41 offen offset:1024 sc1
    buffer_load_dwordx4 v[56:59], v8, s[8:11], s41 offen offset:2048 sc1
    buffer_load_dwordx4 v[60:63], v8, s[8:11], s41 offen offset:3072 sc1
    s_add_u32 s41, s41, 393216
    s_waitcnt vmcnt(0)
interleave_layers__linear_attn_block__memory_aug_recurrent_mem_tr__prompt_kernel_o_seg:
    v_swap_b32 v26, v36
    v_swap_b32 v27, v37
    v_swap_b32 v50, v60
    v_swap_b32 v51, v61
    buffer_load_dword v232, v10, s[8:11], 0 offen sc1
    v_mfma_f32_16x16x32_bf16 v[112:115], v[16:19], a[0:3], 0
    v_mfma_f32_16x16x32_bf16 v[116:119], v[20:23], a[0:3], 0
    v_mfma_f32_16x16x32_bf16 v[120:123], v[16:19], a[24:27], 0
    v_mfma_f32_16x16x32_bf16 v[124:127], v[20:23], a[24:27], 0
    v_mfma_f32_16x16x32_bf16 v[128:131], v[16:19], a[48:51], 0
    v_mfma_f32_16x16x32_bf16 v[132:135], v[20:23], a[48:51], 0
    v_mfma_f32_16x16x32_bf16 v[136:139], v[16:19], a[72:75], 0
    v_mfma_f32_16x16x32_bf16 v[140:143], v[20:23], a[72:75], 0
    v_mfma_f32_16x16x32_bf16 v[144:147], v[16:19], a[96:99], 0
    v_mfma_f32_16x16x32_bf16 v[148:151], v[20:23], a[96:99], 0
    v_mfma_f32_16x16x32_bf16 v[152:155], v[16:19], a[120:123], 0
    v_mfma_f32_16x16x32_bf16 v[156:159], v[20:23], a[120:123], 0
    v_mfma_f32_16x16x32_bf16 v[160:163], v[16:19], a[144:147], 0
    v_mfma_f32_16x16x32_bf16 v[164:167], v[20:23], a[144:147], 0
    v_mfma_f32_16x16x32_bf16 v[168:171], v[16:19], a[168:171], 0
    v_mfma_f32_16x16x32_bf16 v[172:175], v[20:23], a[168:171], 0
    v_mfma_f32_16x16x32_bf16 v[176:179], v[16:19], a[192:195], 0
    v_mfma_f32_16x16x32_bf16 v[180:183], v[20:23], a[192:195], 0
    v_mfma_f32_16x16x32_bf16 v[184:187], v[16:19], a[216:219], 0
    v_mfma_f32_16x16x32_bf16 v[188:191], v[20:23], a[216:219], 0
    v_mfma_f32_16x16x32_bf16 v[112:115], v[28:31], a[4:7], v[112:115]
    v_mfma_f32_16x16x32_bf16 v[116:119], v[32:35], a[4:7], v[116:119]
    v_mfma_f32_16x16x32_bf16 v[120:123], v[28:31], a[28:31], v[120:123]
    v_mfma_f32_16x16x32_bf16 v[124:127], v[32:35], a[28:31], v[124:127]
    v_mfma_f32_16x16x32_bf16 v[128:131], v[28:31], a[52:55], v[128:131]
    v_mfma_f32_16x16x32_bf16 v[132:135], v[32:35], a[52:55], v[132:135]
    v_mfma_f32_16x16x32_bf16 v[136:139], v[28:31], a[76:79], v[136:139]
    v_mfma_f32_16x16x32_bf16 v[140:143], v[32:35], a[76:79], v[140:143]
    v_mfma_f32_16x16x32_bf16 v[144:147], v[28:31], a[100:103], v[144:147]
    v_mfma_f32_16x16x32_bf16 v[148:151], v[32:35], a[100:103], v[148:151]
    v_mfma_f32_16x16x32_bf16 v[152:155], v[28:31], a[124:127], v[152:155]
    v_mfma_f32_16x16x32_bf16 v[156:159], v[32:35], a[124:127], v[156:159]
    v_mfma_f32_16x16x32_bf16 v[160:163], v[28:31], a[148:151], v[160:163]
    v_mfma_f32_16x16x32_bf16 v[164:167], v[32:35], a[148:151], v[164:167]
    v_mfma_f32_16x16x32_bf16 v[168:171], v[28:31], a[172:175], v[168:171]
    v_mfma_f32_16x16x32_bf16 v[172:175], v[32:35], a[172:175], v[172:175]
    v_mfma_f32_16x16x32_bf16 v[176:179], v[28:31], a[196:199], v[176:179]
    v_mfma_f32_16x16x32_bf16 v[180:183], v[32:35], a[196:199], v[180:183]
    v_mfma_f32_16x16x32_bf16 v[184:187], v[28:31], a[220:223], v[184:187]
    v_mfma_f32_16x16x32_bf16 v[188:191], v[32:35], a[220:223], v[188:191]
    v_mfma_f32_16x16x32_bf16 v[112:115], v[40:43], a[8:11], v[112:115]
    v_mfma_f32_16x16x32_bf16 v[116:119], v[44:47], a[8:11], v[116:119]
    v_mfma_f32_16x16x32_bf16 v[120:123], v[40:43], a[32:35], v[120:123]
    v_mfma_f32_16x16x32_bf16 v[124:127], v[44:47], a[32:35], v[124:127]
    v_mfma_f32_16x16x32_bf16 v[128:131], v[40:43], a[56:59], v[128:131]
    v_mfma_f32_16x16x32_bf16 v[132:135], v[44:47], a[56:59], v[132:135]
    v_mfma_f32_16x16x32_bf16 v[136:139], v[40:43], a[80:83], v[136:139]
    v_mfma_f32_16x16x32_bf16 v[140:143], v[44:47], a[80:83], v[140:143]
    v_mfma_f32_16x16x32_bf16 v[144:147], v[40:43], a[104:107], v[144:147]
    v_mfma_f32_16x16x32_bf16 v[148:151], v[44:47], a[104:107], v[148:151]
    v_mfma_f32_16x16x32_bf16 v[152:155], v[40:43], a[128:131], v[152:155]
    v_mfma_f32_16x16x32_bf16 v[156:159], v[44:47], a[128:131], v[156:159]
    v_mfma_f32_16x16x32_bf16 v[160:163], v[40:43], a[152:155], v[160:163]
    v_mfma_f32_16x16x32_bf16 v[164:167], v[44:47], a[152:155], v[164:167]
    v_mfma_f32_16x16x32_bf16 v[168:171], v[40:43], a[176:179], v[168:171]
    v_mfma_f32_16x16x32_bf16 v[172:175], v[44:47], a[176:179], v[172:175]
    v_mfma_f32_16x16x32_bf16 v[176:179], v[40:43], a[200:203], v[176:179]
    v_mfma_f32_16x16x32_bf16 v[180:183], v[44:47], a[200:203], v[180:183]
    v_mfma_f32_16x16x32_bf16 v[184:187], v[40:43], a[224:227], v[184:187]
    v_mfma_f32_16x16x32_bf16 v[188:191], v[44:47], a[224:227], v[188:191]
    s_waitcnt vmcnt(0)
    v_readfirstlane_b32 s24, v232
    s_max_i32 s62, s62, s24
    s_add_u32 s63, s40, 2
    s_min_u32 s63, s63, 64
    s_cmp_ge_i32 s62, s63
    s_cselect_b32 s24, 1, 0
    s_lshl_b32 s25, s3, 4
    s_add_u32 s25, s25, 0
    v_mov_b32 v12, s25
    v_mov_b32 v13, s24
    ds_write_b32 v12, v13
    v_mov_b32 v12, 0
    s_waitcnt lgkmcnt(0)
    s_barrier
    ds_read_b32 v13, v12
    s_cmp_eq_u32 s3, 0
    s_cbranch_scc0 interleave_layers__linear_attn_block__memory_aug_recurrent_mem_tr__prompt_kernel_fp39
    v_mov_b32 v15, s40
    buffer_store_dword v15, v14, s[8:11], 0 offen sc1
interleave_layers__linear_attn_block__memory_aug_recurrent_mem_tr__prompt_kernel_fp39:
    s_waitcnt lgkmcnt(0)
    v_readfirstlane_b32 s58, v13
    s_cmp_eq_u32 s58, 1
    s_cbranch_scc0 interleave_layers__linear_attn_block__memory_aug_recurrent_mem_tr__prompt_kernel_of38
    s_max_i32 s62, s62, s63
    buffer_load_dwordx4 v[64:67], v6, s[8:11], s41 offen offset:0 sc1
    buffer_load_dwordx4 v[68:71], v6, s[8:11], s41 offen offset:1024 sc1
    buffer_load_dwordx4 v[72:75], v6, s[8:11], s41 offen offset:2048 sc1
    buffer_load_dwordx4 v[76:79], v6, s[8:11], s41 offen offset:3072 sc1
    buffer_load_dwordx4 v[80:83], v7, s[8:11], s41 offen offset:0 sc1
    buffer_load_dwordx4 v[84:87], v7, s[8:11], s41 offen offset:1024 sc1
    buffer_load_dwordx4 v[88:91], v7, s[8:11], s41 offen offset:2048 sc1
    buffer_load_dwordx4 v[92:95], v7, s[8:11], s41 offen offset:3072 sc1
    buffer_load_dwordx4 v[96:99], v8, s[8:11], s41 offen offset:0 sc1
    buffer_load_dwordx4 v[100:103], v8, s[8:11], s41 offen offset:1024 sc1
    buffer_load_dwordx4 v[104:107], v8, s[8:11], s41 offen offset:2048 sc1
    buffer_load_dwordx4 v[108:111], v8, s[8:11], s41 offen offset:3072 sc1
    s_add_u32 s41, s41, 393216
interleave_layers__linear_attn_block__memory_aug_recurrent_mem_tr__prompt_kernel_of38:
    v_mfma_f32_16x16x32_bf16 v[112:115], v[52:55], a[12:15], v[112:115]
    v_mfma_f32_16x16x32_bf16 v[116:119], v[56:59], a[12:15], v[116:119]
    v_mfma_f32_16x16x32_bf16 v[120:123], v[52:55], a[36:39], v[120:123]
    v_mfma_f32_16x16x32_bf16 v[124:127], v[56:59], a[36:39], v[124:127]
    v_mfma_f32_16x16x32_bf16 v[128:131], v[52:55], a[60:63], v[128:131]
    v_mfma_f32_16x16x32_bf16 v[132:135], v[56:59], a[60:63], v[132:135]
    v_mfma_f32_16x16x32_bf16 v[136:139], v[52:55], a[84:87], v[136:139]
    v_mfma_f32_16x16x32_bf16 v[140:143], v[56:59], a[84:87], v[140:143]
    v_mfma_f32_16x16x32_bf16 v[144:147], v[52:55], a[108:111], v[144:147]
    v_mfma_f32_16x16x32_bf16 v[148:151], v[56:59], a[108:111], v[148:151]
    v_mfma_f32_16x16x32_bf16 v[152:155], v[52:55], a[132:135], v[152:155]
    v_mfma_f32_16x16x32_bf16 v[156:159], v[56:59], a[132:135], v[156:159]
    v_mfma_f32_16x16x32_bf16 v[160:163], v[52:55], a[156:159], v[160:163]
    v_mfma_f32_16x16x32_bf16 v[164:167], v[56:59], a[156:159], v[164:167]
    v_mfma_f32_16x16x32_bf16 v[168:171], v[52:55], a[180:183], v[168:171]
    v_mfma_f32_16x16x32_bf16 v[172:175], v[56:59], a[180:183], v[172:175]
    v_mfma_f32_16x16x32_bf16 v[176:179], v[52:55], a[204:207], v[176:179]
    v_mfma_f32_16x16x32_bf16 v[180:183], v[56:59], a[204:207], v[180:183]
    v_mfma_f32_16x16x32_bf16 v[184:187], v[52:55], a[228:231], v[184:187]
    v_mfma_f32_16x16x32_bf16 v[188:191], v[56:59], a[228:231], v[188:191]
    v_mfma_f32_16x16x32_bf16 v[112:115], v[24:27], a[16:19], v[112:115]
    v_mfma_f32_16x16x32_bf16 v[116:119], v[36:39], a[16:19], v[116:119]
    v_mfma_f32_16x16x32_bf16 v[120:123], v[24:27], a[40:43], v[120:123]
    v_mfma_f32_16x16x32_bf16 v[124:127], v[36:39], a[40:43], v[124:127]
    v_mfma_f32_16x16x32_bf16 v[128:131], v[24:27], a[64:67], v[128:131]
    v_mfma_f32_16x16x32_bf16 v[132:135], v[36:39], a[64:67], v[132:135]
    v_mfma_f32_16x16x32_bf16 v[136:139], v[24:27], a[88:91], v[136:139]
    v_mfma_f32_16x16x32_bf16 v[140:143], v[36:39], a[88:91], v[140:143]
    v_mfma_f32_16x16x32_bf16 v[144:147], v[24:27], a[112:115], v[144:147]
    v_mfma_f32_16x16x32_bf16 v[148:151], v[36:39], a[112:115], v[148:151]
    v_mfma_f32_16x16x32_bf16 v[152:155], v[24:27], a[136:139], v[152:155]
    v_mfma_f32_16x16x32_bf16 v[156:159], v[36:39], a[136:139], v[156:159]
    v_mfma_f32_16x16x32_bf16 v[160:163], v[24:27], a[160:163], v[160:163]
    v_mfma_f32_16x16x32_bf16 v[164:167], v[36:39], a[160:163], v[164:167]
    v_mfma_f32_16x16x32_bf16 v[168:171], v[24:27], a[184:187], v[168:171]
    v_mfma_f32_16x16x32_bf16 v[172:175], v[36:39], a[184:187], v[172:175]
    v_mfma_f32_16x16x32_bf16 v[176:179], v[24:27], a[208:211], v[176:179]
    v_mfma_f32_16x16x32_bf16 v[180:183], v[36:39], a[208:211], v[180:183]
    v_mfma_f32_16x16x32_bf16 v[184:187], v[24:27], a[232:235], v[184:187]
    v_mfma_f32_16x16x32_bf16 v[188:191], v[36:39], a[232:235], v[188:191]
    v_mfma_f32_16x16x32_bf16 v[112:115], v[48:51], a[20:23], v[112:115]
    v_mfma_f32_16x16x32_bf16 v[116:119], v[60:63], a[20:23], v[116:119]
    v_mfma_f32_16x16x32_bf16 v[120:123], v[48:51], a[44:47], v[120:123]
    v_mfma_f32_16x16x32_bf16 v[124:127], v[60:63], a[44:47], v[124:127]
    v_mfma_f32_16x16x32_bf16 v[128:131], v[48:51], a[68:71], v[128:131]
    v_mfma_f32_16x16x32_bf16 v[132:135], v[60:63], a[68:71], v[132:135]
    v_mfma_f32_16x16x32_bf16 v[136:139], v[48:51], a[92:95], v[136:139]
    v_mfma_f32_16x16x32_bf16 v[140:143], v[60:63], a[92:95], v[140:143]
    v_mfma_f32_16x16x32_bf16 v[144:147], v[48:51], a[116:119], v[144:147]
    v_mfma_f32_16x16x32_bf16 v[148:151], v[60:63], a[116:119], v[148:151]
    v_mfma_f32_16x16x32_bf16 v[152:155], v[48:51], a[140:143], v[152:155]
    v_mfma_f32_16x16x32_bf16 v[156:159], v[60:63], a[140:143], v[156:159]
    v_mfma_f32_16x16x32_bf16 v[160:163], v[48:51], a[164:167], v[160:163]
    v_mfma_f32_16x16x32_bf16 v[164:167], v[60:63], a[164:167], v[164:167]
    v_mfma_f32_16x16x32_bf16 v[168:171], v[48:51], a[188:191], v[168:171]
    v_mfma_f32_16x16x32_bf16 v[172:175], v[60:63], a[188:191], v[172:175]
    v_mfma_f32_16x16x32_bf16 v[176:179], v[48:51], a[212:215], v[176:179]
    v_mfma_f32_16x16x32_bf16 v[180:183], v[60:63], a[212:215], v[180:183]
    v_mfma_f32_16x16x32_bf16 v[184:187], v[48:51], a[236:239], v[184:187]
    v_mfma_f32_16x16x32_bf16 v[188:191], v[60:63], a[236:239], v[188:191]
    s_mov_b32 s46, s43
    v_cvt_pk_bf16_f32 v192, v112, v113
    v_cvt_pk_bf16_f32 v193, v114, v115
    v_cvt_pk_bf16_f32 v194, v116, v117
    v_cvt_pk_bf16_f32 v195, v118, v119
    buffer_store_dwordx4 v[192:195], v9, s[8:11], s46 offen sc1
    s_add_u32 s46, s46, 32768
    v_cvt_pk_bf16_f32 v196, v120, v121
    v_cvt_pk_bf16_f32 v197, v122, v123
    v_cvt_pk_bf16_f32 v198, v124, v125
    v_cvt_pk_bf16_f32 v199, v126, v127
    buffer_store_dwordx4 v[196:199], v9, s[8:11], s46 offen sc1
    s_add_u32 s46, s46, 32768
    v_cvt_pk_bf16_f32 v200, v128, v129
    v_cvt_pk_bf16_f32 v201, v130, v131
    v_cvt_pk_bf16_f32 v202, v132, v133
    v_cvt_pk_bf16_f32 v203, v134, v135
    buffer_store_dwordx4 v[200:203], v9, s[8:11], s46 offen sc1
    s_add_u32 s46, s46, 32768
    v_cvt_pk_bf16_f32 v204, v136, v137
    v_cvt_pk_bf16_f32 v205, v138, v139
    v_cvt_pk_bf16_f32 v206, v140, v141
    v_cvt_pk_bf16_f32 v207, v142, v143
    buffer_store_dwordx4 v[204:207], v9, s[8:11], s46 offen sc1
    s_add_u32 s46, s46, 32768
    v_cvt_pk_bf16_f32 v208, v144, v145
    v_cvt_pk_bf16_f32 v209, v146, v147
    v_cvt_pk_bf16_f32 v210, v148, v149
    v_cvt_pk_bf16_f32 v211, v150, v151
    buffer_store_dwordx4 v[208:211], v9, s[8:11], s46 offen sc1
    s_add_u32 s46, s46, 32768
    v_cvt_pk_bf16_f32 v212, v152, v153
    v_cvt_pk_bf16_f32 v213, v154, v155
    v_cvt_pk_bf16_f32 v214, v156, v157
    v_cvt_pk_bf16_f32 v215, v158, v159
    buffer_store_dwordx4 v[212:215], v9, s[8:11], s46 offen sc1
    s_add_u32 s46, s46, 32768
    v_cvt_pk_bf16_f32 v216, v160, v161
    v_cvt_pk_bf16_f32 v217, v162, v163
    v_cvt_pk_bf16_f32 v218, v164, v165
    v_cvt_pk_bf16_f32 v219, v166, v167
    buffer_store_dwordx4 v[216:219], v9, s[8:11], s46 offen sc1
    s_add_u32 s46, s46, 32768
    v_cvt_pk_bf16_f32 v220, v168, v169
    v_cvt_pk_bf16_f32 v221, v170, v171
    v_cvt_pk_bf16_f32 v222, v172, v173
    v_cvt_pk_bf16_f32 v223, v174, v175
    buffer_store_dwordx4 v[220:223], v9, s[8:11], s46 offen sc1
    s_add_u32 s46, s46, 32768
    v_cvt_pk_bf16_f32 v224, v176, v177
    v_cvt_pk_bf16_f32 v225, v178, v179
    v_cvt_pk_bf16_f32 v226, v180, v181
    v_cvt_pk_bf16_f32 v227, v182, v183
    buffer_store_dwordx4 v[224:227], v9, s[8:11], s46 offen sc1
    s_add_u32 s46, s46, 32768
    v_cvt_pk_bf16_f32 v228, v184, v185
    v_cvt_pk_bf16_f32 v229, v186, v187
    v_cvt_pk_bf16_f32 v230, v188, v189
    v_cvt_pk_bf16_f32 v231, v190, v191
    buffer_store_dwordx4 v[228:231], v9, s[8:11], s46 offen sc1
    s_cmp_eq_u32 s58, 1
    s_cbranch_scc1 interleave_layers__linear_attn_block__memory_aug_recurrent_mem_tr__prompt_kernel_of40
    s_waitcnt vmcnt(0)
    s_barrier
    s_add_u32 s24, s40, 1
    s_cmp_eq_u32 s3, 0
    s_cbranch_scc0 interleave_layers__linear_attn_block__memory_aug_recurrent_mem_tr__prompt_kernel_fp41
    v_mov_b32 v15, s24
    buffer_store_dword v15, v14, s[8:11], 0 offen sc1
interleave_layers__linear_attn_block__memory_aug_recurrent_mem_tr__prompt_kernel_fp41:
    s_add_u32 s63, s40, 2
    s_min_u32 s63, s63, 64
    s_cmp_ge_i32 s62, s63
    s_cbranch_scc1 interleave_layers__linear_attn_block__memory_aug_recurrent_mem_tr__prompt_kernel_o_en3_ok
    s_mov_b32 s61, 0
interleave_layers__linear_attn_block__memory_aug_recurrent_mem_tr__prompt_kernel_o_en3:
    buffer_load_dword v11, v10, s[8:11], 0 offen sc1
    s_waitcnt vmcnt(0)
    v_readlane_b32 s62, v11, 0
    s_cmp_ge_i32 s62, s63
    s_cbranch_scc1 interleave_layers__linear_attn_block__memory_aug_recurrent_mem_tr__prompt_kernel_o_en3_ok
    s_add_u32 s61, s61, 1
    s_cmp_ge_u32 s61, s60
    s_cbranch_scc1 interleave_layers__linear_attn_block__memory_aug_recurrent_mem_tr__prompt_kernel_o_en3_to
    s_sleep 2
    s_branch interleave_layers__linear_attn_block__memory_aug_recurrent_mem_tr__prompt_kernel_o_en3
interleave_layers__linear_attn_block__memory_aug_recurrent_mem_tr__prompt_kernel_o_en3_to:
    s_mov_b32 s60, 1
interleave_layers__linear_attn_block__memory_aug_recurrent_mem_tr__prompt_kernel_o_en3_ok:
    buffer_load_dwordx4 v[64:67], v6, s[8:11], s41 offen offset:0 sc1
    buffer_load_dwordx4 v[68:71], v6, s[8:11], s41 offen offset:1024 sc1
    buffer_load_dwordx4 v[72:75], v6, s[8:11], s41 offen offset:2048 sc1
    buffer_load_dwordx4 v[76:79], v6, s[8:11], s41 offen offset:3072 sc1
    buffer_load_dwordx4 v[80:83], v7, s[8:11], s41 offen offset:0 sc1
    buffer_load_dwordx4 v[84:87], v7, s[8:11], s41 offen offset:1024 sc1
    buffer_load_dwordx4 v[88:91], v7, s[8:11], s41 offen offset:2048 sc1
    buffer_load_dwordx4 v[92:95], v7, s[8:11], s41 offen offset:3072 sc1
    buffer_load_dwordx4 v[96:99], v8, s[8:11], s41 offen offset:0 sc1
    buffer_load_dwordx4 v[100:103], v8, s[8:11], s41 offen offset:1024 sc1
    buffer_load_dwordx4 v[104:107], v8, s[8:11], s41 offen offset:2048 sc1
    buffer_load_dwordx4 v[108:111], v8, s[8:11], s41 offen offset:3072 sc1
    s_add_u32 s41, s41, 393216
    s_waitcnt vmcnt(0)
interleave_layers__linear_attn_block__memory_aug_recurrent_mem_tr__prompt_kernel_of40:
    s_waitcnt vmcnt(10)
    s_add_u32 s40, s40, 1
    s_add_u32 s43, s43, 1310720
    v_swap_b32 v74, v84
    v_swap_b32 v75, v85
    v_swap_b32 v98, v108
    v_swap_b32 v99, v109
    buffer_load_dword v232, v10, s[8:11], 0 offen sc1
    v_mfma_f32_16x16x32_bf16 v[112:115], v[64:67], a[0:3], 0
    v_mfma_f32_16x16x32_bf16 v[116:119], v[68:71], a[0:3], 0
    v_mfma_f32_16x16x32_bf16 v[120:123], v[64:67], a[24:27], 0
    v_mfma_f32_16x16x32_bf16 v[124:127], v[68:71], a[24:27], 0
    v_mfma_f32_16x16x32_bf16 v[128:131], v[64:67], a[48:51], 0
    v_mfma_f32_16x16x32_bf16 v[132:135], v[68:71], a[48:51], 0
    v_mfma_f32_16x16x32_bf16 v[136:139], v[64:67], a[72:75], 0
    v_mfma_f32_16x16x32_bf16 v[140:143], v[68:71], a[72:75], 0
    v_mfma_f32_16x16x32_bf16 v[144:147], v[64:67], a[96:99], 0
    v_mfma_f32_16x16x32_bf16 v[148:151], v[68:71], a[96:99], 0
    v_mfma_f32_16x16x32_bf16 v[152:155], v[64:67], a[120:123], 0
    v_mfma_f32_16x16x32_bf16 v[156:159], v[68:71], a[120:123], 0
    v_mfma_f32_16x16x32_bf16 v[160:163], v[64:67], a[144:147], 0
    v_mfma_f32_16x16x32_bf16 v[164:167], v[68:71], a[144:147], 0
    v_mfma_f32_16x16x32_bf16 v[168:171], v[64:67], a[168:171], 0
    v_mfma_f32_16x16x32_bf16 v[172:175], v[68:71], a[168:171], 0
    v_mfma_f32_16x16x32_bf16 v[176:179], v[64:67], a[192:195], 0
    v_mfma_f32_16x16x32_bf16 v[180:183], v[68:71], a[192:195], 0
    v_mfma_f32_16x16x32_bf16 v[184:187], v[64:67], a[216:219], 0
    v_mfma_f32_16x16x32_bf16 v[188:191], v[68:71], a[216:219], 0
    v_mfma_f32_16x16x32_bf16 v[112:115], v[76:79], a[4:7], v[112:115]
    v_mfma_f32_16x16x32_bf16 v[116:119], v[80:83], a[4:7], v[116:119]
    v_mfma_f32_16x16x32_bf16 v[120:123], v[76:79], a[28:31], v[120:123]
    v_mfma_f32_16x16x32_bf16 v[124:127], v[80:83], a[28:31], v[124:127]
    v_mfma_f32_16x16x32_bf16 v[128:131], v[76:79], a[52:55], v[128:131]
    v_mfma_f32_16x16x32_bf16 v[132:135], v[80:83], a[52:55], v[132:135]
    v_mfma_f32_16x16x32_bf16 v[136:139], v[76:79], a[76:79], v[136:139]
    v_mfma_f32_16x16x32_bf16 v[140:143], v[80:83], a[76:79], v[140:143]
    v_mfma_f32_16x16x32_bf16 v[144:147], v[76:79], a[100:103], v[144:147]
    v_mfma_f32_16x16x32_bf16 v[148:151], v[80:83], a[100:103], v[148:151]
    v_mfma_f32_16x16x32_bf16 v[152:155], v[76:79], a[124:127], v[152:155]
    v_mfma_f32_16x16x32_bf16 v[156:159], v[80:83], a[124:127], v[156:159]
    v_mfma_f32_16x16x32_bf16 v[160:163], v[76:79], a[148:151], v[160:163]
    v_mfma_f32_16x16x32_bf16 v[164:167], v[80:83], a[148:151], v[164:167]
    v_mfma_f32_16x16x32_bf16 v[168:171], v[76:79], a[172:175], v[168:171]
    v_mfma_f32_16x16x32_bf16 v[172:175], v[80:83], a[172:175], v[172:175]
    v_mfma_f32_16x16x32_bf16 v[176:179], v[76:79], a[196:199], v[176:179]
    v_mfma_f32_16x16x32_bf16 v[180:183], v[80:83], a[196:199], v[180:183]
    v_mfma_f32_16x16x32_bf16 v[184:187], v[76:79], a[220:223], v[184:187]
    v_mfma_f32_16x16x32_bf16 v[188:191], v[80:83], a[220:223], v[188:191]
    v_mfma_f32_16x16x32_bf16 v[112:115], v[88:91], a[8:11], v[112:115]
    v_mfma_f32_16x16x32_bf16 v[116:119], v[92:95], a[8:11], v[116:119]
    v_mfma_f32_16x16x32_bf16 v[120:123], v[88:91], a[32:35], v[120:123]
    v_mfma_f32_16x16x32_bf16 v[124:127], v[92:95], a[32:35], v[124:127]
    v_mfma_f32_16x16x32_bf16 v[128:131], v[88:91], a[56:59], v[128:131]
    v_mfma_f32_16x16x32_bf16 v[132:135], v[92:95], a[56:59], v[132:135]
    v_mfma_f32_16x16x32_bf16 v[136:139], v[88:91], a[80:83], v[136:139]
    v_mfma_f32_16x16x32_bf16 v[140:143], v[92:95], a[80:83], v[140:143]
    v_mfma_f32_16x16x32_bf16 v[144:147], v[88:91], a[104:107], v[144:147]
    v_mfma_f32_16x16x32_bf16 v[148:151], v[92:95], a[104:107], v[148:151]
    v_mfma_f32_16x16x32_bf16 v[152:155], v[88:91], a[128:131], v[152:155]
    v_mfma_f32_16x16x32_bf16 v[156:159], v[92:95], a[128:131], v[156:159]
    v_mfma_f32_16x16x32_bf16 v[160:163], v[88:91], a[152:155], v[160:163]
    v_mfma_f32_16x16x32_bf16 v[164:167], v[92:95], a[152:155], v[164:167]
    v_mfma_f32_16x16x32_bf16 v[168:171], v[88:91], a[176:179], v[168:171]
    v_mfma_f32_16x16x32_bf16 v[172:175], v[92:95], a[176:179], v[172:175]
    v_mfma_f32_16x16x32_bf16 v[176:179], v[88:91], a[200:203], v[176:179]
    v_mfma_f32_16x16x32_bf16 v[180:183], v[92:95], a[200:203], v[180:183]
    v_mfma_f32_16x16x32_bf16 v[184:187], v[88:91], a[224:227], v[184:187]
    v_mfma_f32_16x16x32_bf16 v[188:191], v[92:95], a[224:227], v[188:191]
    s_waitcnt vmcnt(0)
    v_readfirstlane_b32 s24, v232
    s_max_i32 s62, s62, s24
    s_add_u32 s63, s40, 2
    s_min_u32 s63, s63, 64
    s_cmp_ge_i32 s62, s63
    s_cselect_b32 s24, 1, 0
    s_lshl_b32 s25, s3, 4
    s_add_u32 s25, s25, 4
    v_mov_b32 v12, s25
    v_mov_b32 v13, s24
    ds_write_b32 v12, v13
    v_mov_b32 v12, 4
    s_waitcnt lgkmcnt(0)
    s_barrier
    ds_read_b32 v13, v12
    s_cmp_eq_u32 s3, 0
    s_cbranch_scc0 interleave_layers__linear_attn_block__memory_aug_recurrent_mem_tr__prompt_kernel_fp43
    v_mov_b32 v15, s40
    buffer_store_dword v15, v14, s[8:11], 0 offen sc1
interleave_layers__linear_attn_block__memory_aug_recurrent_mem_tr__prompt_kernel_fp43:
    s_waitcnt lgkmcnt(0)
    v_readfirstlane_b32 s58, v13
    s_cmp_eq_u32 s58, 1
    s_cbranch_scc0 interleave_layers__linear_attn_block__memory_aug_recurrent_mem_tr__prompt_kernel_of42
    s_max_i32 s62, s62, s63
    buffer_load_dwordx4 v[16:19], v6, s[8:11], s41 offen offset:0 sc1
    buffer_load_dwordx4 v[20:23], v6, s[8:11], s41 offen offset:1024 sc1
    buffer_load_dwordx4 v[24:27], v6, s[8:11], s41 offen offset:2048 sc1
    buffer_load_dwordx4 v[28:31], v6, s[8:11], s41 offen offset:3072 sc1
    buffer_load_dwordx4 v[32:35], v7, s[8:11], s41 offen offset:0 sc1
    buffer_load_dwordx4 v[36:39], v7, s[8:11], s41 offen offset:1024 sc1
    buffer_load_dwordx4 v[40:43], v7, s[8:11], s41 offen offset:2048 sc1
    buffer_load_dwordx4 v[44:47], v7, s[8:11], s41 offen offset:3072 sc1
    buffer_load_dwordx4 v[48:51], v8, s[8:11], s41 offen offset:0 sc1
    buffer_load_dwordx4 v[52:55], v8, s[8:11], s41 offen offset:1024 sc1
    buffer_load_dwordx4 v[56:59], v8, s[8:11], s41 offen offset:2048 sc1
    buffer_load_dwordx4 v[60:63], v8, s[8:11], s41 offen offset:3072 sc1
    s_add_u32 s41, s41, 393216
interleave_layers__linear_attn_block__memory_aug_recurrent_mem_tr__prompt_kernel_of42:
    v_mfma_f32_16x16x32_bf16 v[112:115], v[100:103], a[12:15], v[112:115]
    v_mfma_f32_16x16x32_bf16 v[116:119], v[104:107], a[12:15], v[116:119]
    v_mfma_f32_16x16x32_bf16 v[120:123], v[100:103], a[36:39], v[120:123]
    v_mfma_f32_16x16x32_bf16 v[124:127], v[104:107], a[36:39], v[124:127]
    v_mfma_f32_16x16x32_bf16 v[128:131], v[100:103], a[60:63], v[128:131]
    v_mfma_f32_16x16x32_bf16 v[132:135], v[104:107], a[60:63], v[132:135]
    v_mfma_f32_16x16x32_bf16 v[136:139], v[100:103], a[84:87], v[136:139]
    v_mfma_f32_16x16x32_bf16 v[140:143], v[104:107], a[84:87], v[140:143]
    v_mfma_f32_16x16x32_bf16 v[144:147], v[100:103], a[108:111], v[144:147]
    v_mfma_f32_16x16x32_bf16 v[148:151], v[104:107], a[108:111], v[148:151]
    v_mfma_f32_16x16x32_bf16 v[152:155], v[100:103], a[132:135], v[152:155]
    v_mfma_f32_16x16x32_bf16 v[156:159], v[104:107], a[132:135], v[156:159]
    v_mfma_f32_16x16x32_bf16 v[160:163], v[100:103], a[156:159], v[160:163]
    v_mfma_f32_16x16x32_bf16 v[164:167], v[104:107], a[156:159], v[164:167]
    v_mfma_f32_16x16x32_bf16 v[168:171], v[100:103], a[180:183], v[168:171]
    v_mfma_f32_16x16x32_bf16 v[172:175], v[104:107], a[180:183], v[172:175]
    v_mfma_f32_16x16x32_bf16 v[176:179], v[100:103], a[204:207], v[176:179]
    v_mfma_f32_16x16x32_bf16 v[180:183], v[104:107], a[204:207], v[180:183]
    v_mfma_f32_16x16x32_bf16 v[184:187], v[100:103], a[228:231], v[184:187]
    v_mfma_f32_16x16x32_bf16 v[188:191], v[104:107], a[228:231], v[188:191]
    v_mfma_f32_16x16x32_bf16 v[112:115], v[72:75], a[16:19], v[112:115]
    v_mfma_f32_16x16x32_bf16 v[116:119], v[84:87], a[16:19], v[116:119]
    v_mfma_f32_16x16x32_bf16 v[120:123], v[72:75], a[40:43], v[120:123]
    v_mfma_f32_16x16x32_bf16 v[124:127], v[84:87], a[40:43], v[124:127]
    v_mfma_f32_16x16x32_bf16 v[128:131], v[72:75], a[64:67], v[128:131]
    v_mfma_f32_16x16x32_bf16 v[132:135], v[84:87], a[64:67], v[132:135]
    v_mfma_f32_16x16x32_bf16 v[136:139], v[72:75], a[88:91], v[136:139]
    v_mfma_f32_16x16x32_bf16 v[140:143], v[84:87], a[88:91], v[140:143]
    v_mfma_f32_16x16x32_bf16 v[144:147], v[72:75], a[112:115], v[144:147]
    v_mfma_f32_16x16x32_bf16 v[148:151], v[84:87], a[112:115], v[148:151]
    v_mfma_f32_16x16x32_bf16 v[152:155], v[72:75], a[136:139], v[152:155]
    v_mfma_f32_16x16x32_bf16 v[156:159], v[84:87], a[136:139], v[156:159]
    v_mfma_f32_16x16x32_bf16 v[160:163], v[72:75], a[160:163], v[160:163]
    v_mfma_f32_16x16x32_bf16 v[164:167], v[84:87], a[160:163], v[164:167]
    v_mfma_f32_16x16x32_bf16 v[168:171], v[72:75], a[184:187], v[168:171]
    v_mfma_f32_16x16x32_bf16 v[172:175], v[84:87], a[184:187], v[172:175]
    v_mfma_f32_16x16x32_bf16 v[176:179], v[72:75], a[208:211], v[176:179]
    v_mfma_f32_16x16x32_bf16 v[180:183], v[84:87], a[208:211], v[180:183]
    v_mfma_f32_16x16x32_bf16 v[184:187], v[72:75], a[232:235], v[184:187]
    v_mfma_f32_16x16x32_bf16 v[188:191], v[84:87], a[232:235], v[188:191]
    v_mfma_f32_16x16x32_bf16 v[112:115], v[96:99], a[20:23], v[112:115]
    v_mfma_f32_16x16x32_bf16 v[116:119], v[108:111], a[20:23], v[116:119]
    v_mfma_f32_16x16x32_bf16 v[120:123], v[96:99], a[44:47], v[120:123]
    v_mfma_f32_16x16x32_bf16 v[124:127], v[108:111], a[44:47], v[124:127]
    v_mfma_f32_16x16x32_bf16 v[128:131], v[96:99], a[68:71], v[128:131]
    v_mfma_f32_16x16x32_bf16 v[132:135], v[108:111], a[68:71], v[132:135]
    v_mfma_f32_16x16x32_bf16 v[136:139], v[96:99], a[92:95], v[136:139]
    v_mfma_f32_16x16x32_bf16 v[140:143], v[108:111], a[92:95], v[140:143]
    v_mfma_f32_16x16x32_bf16 v[144:147], v[96:99], a[116:119], v[144:147]
    v_mfma_f32_16x16x32_bf16 v[148:151], v[108:111], a[116:119], v[148:151]
    v_mfma_f32_16x16x32_bf16 v[152:155], v[96:99], a[140:143], v[152:155]
    v_mfma_f32_16x16x32_bf16 v[156:159], v[108:111], a[140:143], v[156:159]
    v_mfma_f32_16x16x32_bf16 v[160:163], v[96:99], a[164:167], v[160:163]
    v_mfma_f32_16x16x32_bf16 v[164:167], v[108:111], a[164:167], v[164:167]
    v_mfma_f32_16x16x32_bf16 v[168:171], v[96:99], a[188:191], v[168:171]
    v_mfma_f32_16x16x32_bf16 v[172:175], v[108:111], a[188:191], v[172:175]
    v_mfma_f32_16x16x32_bf16 v[176:179], v[96:99], a[212:215], v[176:179]
    v_mfma_f32_16x16x32_bf16 v[180:183], v[108:111], a[212:215], v[180:183]
    v_mfma_f32_16x16x32_bf16 v[184:187], v[96:99], a[236:239], v[184:187]
    v_mfma_f32_16x16x32_bf16 v[188:191], v[108:111], a[236:239], v[188:191]
    s_mov_b32 s46, s43
    v_cvt_pk_bf16_f32 v192, v112, v113
    v_cvt_pk_bf16_f32 v193, v114, v115
    v_cvt_pk_bf16_f32 v194, v116, v117
    v_cvt_pk_bf16_f32 v195, v118, v119
    buffer_store_dwordx4 v[192:195], v9, s[8:11], s46 offen sc1
    s_add_u32 s46, s46, 32768
    v_cvt_pk_bf16_f32 v196, v120, v121
    v_cvt_pk_bf16_f32 v197, v122, v123
    v_cvt_pk_bf16_f32 v198, v124, v125
    v_cvt_pk_bf16_f32 v199, v126, v127
    buffer_store_dwordx4 v[196:199], v9, s[8:11], s46 offen sc1
    s_add_u32 s46, s46, 32768
    v_cvt_pk_bf16_f32 v200, v128, v129
    v_cvt_pk_bf16_f32 v201, v130, v131
    v_cvt_pk_bf16_f32 v202, v132, v133
    v_cvt_pk_bf16_f32 v203, v134, v135
    buffer_store_dwordx4 v[200:203], v9, s[8:11], s46 offen sc1
    s_add_u32 s46, s46, 32768
    v_cvt_pk_bf16_f32 v204, v136, v137
    v_cvt_pk_bf16_f32 v205, v138, v139
    v_cvt_pk_bf16_f32 v206, v140, v141
    v_cvt_pk_bf16_f32 v207, v142, v143
    buffer_store_dwordx4 v[204:207], v9, s[8:11], s46 offen sc1
    s_add_u32 s46, s46, 32768
    v_cvt_pk_bf16_f32 v208, v144, v145
    v_cvt_pk_bf16_f32 v209, v146, v147
    v_cvt_pk_bf16_f32 v210, v148, v149
    v_cvt_pk_bf16_f32 v211, v150, v151
    buffer_store_dwordx4 v[208:211], v9, s[8:11], s46 offen sc1
    s_add_u32 s46, s46, 32768
    v_cvt_pk_bf16_f32 v212, v152, v153
    v_cvt_pk_bf16_f32 v213, v154, v155
    v_cvt_pk_bf16_f32 v214, v156, v157
    v_cvt_pk_bf16_f32 v215, v158, v159
    buffer_store_dwordx4 v[212:215], v9, s[8:11], s46 offen sc1
    s_add_u32 s46, s46, 32768
    v_cvt_pk_bf16_f32 v216, v160, v161
    v_cvt_pk_bf16_f32 v217, v162, v163
    v_cvt_pk_bf16_f32 v218, v164, v165
    v_cvt_pk_bf16_f32 v219, v166, v167
    buffer_store_dwordx4 v[216:219], v9, s[8:11], s46 offen sc1
    s_add_u32 s46, s46, 32768
    v_cvt_pk_bf16_f32 v220, v168, v169
    v_cvt_pk_bf16_f32 v221, v170, v171
    v_cvt_pk_bf16_f32 v222, v172, v173
    v_cvt_pk_bf16_f32 v223, v174, v175
    buffer_store_dwordx4 v[220:223], v9, s[8:11], s46 offen sc1
    s_add_u32 s46, s46, 32768
    v_cvt_pk_bf16_f32 v224, v176, v177
    v_cvt_pk_bf16_f32 v225, v178, v179
    v_cvt_pk_bf16_f32 v226, v180, v181
    v_cvt_pk_bf16_f32 v227, v182, v183
    buffer_store_dwordx4 v[224:227], v9, s[8:11], s46 offen sc1
    s_add_u32 s46, s46, 32768
    v_cvt_pk_bf16_f32 v228, v184, v185
    v_cvt_pk_bf16_f32 v229, v186, v187
    v_cvt_pk_bf16_f32 v230, v188, v189
    v_cvt_pk_bf16_f32 v231, v190, v191
    buffer_store_dwordx4 v[228:231], v9, s[8:11], s46 offen sc1
    s_cmp_eq_u32 s58, 1
    s_cbranch_scc1 interleave_layers__linear_attn_block__memory_aug_recurrent_mem_tr__prompt_kernel_of44
    s_waitcnt vmcnt(0)
    s_barrier
    s_add_u32 s24, s40, 1
    s_cmp_eq_u32 s3, 0
    s_cbranch_scc0 interleave_layers__linear_attn_block__memory_aug_recurrent_mem_tr__prompt_kernel_fp45
    v_mov_b32 v15, s24
    buffer_store_dword v15, v14, s[8:11], 0 offen sc1
interleave_layers__linear_attn_block__memory_aug_recurrent_mem_tr__prompt_kernel_fp45:
    s_add_u32 s63, s40, 2
    s_min_u32 s63, s63, 64
    s_cmp_ge_i32 s62, s63
    s_cbranch_scc1 interleave_layers__linear_attn_block__memory_aug_recurrent_mem_tr__prompt_kernel_o_en4_ok
    s_mov_b32 s61, 0
interleave_layers__linear_attn_block__memory_aug_recurrent_mem_tr__prompt_kernel_o_en4:
    buffer_load_dword v11, v10, s[8:11], 0 offen sc1
    s_waitcnt vmcnt(0)
    v_readlane_b32 s62, v11, 0
    s_cmp_ge_i32 s62, s63
    s_cbranch_scc1 interleave_layers__linear_attn_block__memory_aug_recurrent_mem_tr__prompt_kernel_o_en4_ok
    s_add_u32 s61, s61, 1
    s_cmp_ge_u32 s61, s60
    s_cbranch_scc1 interleave_layers__linear_attn_block__memory_aug_recurrent_mem_tr__prompt_kernel_o_en4_to
    s_sleep 2
    s_branch interleave_layers__linear_attn_block__memory_aug_recurrent_mem_tr__prompt_kernel_o_en4
interleave_layers__linear_attn_block__memory_aug_recurrent_mem_tr__prompt_kernel_o_en4_to:
    s_mov_b32 s60, 1
interleave_layers__linear_attn_block__memory_aug_recurrent_mem_tr__prompt_kernel_o_en4_ok:
    buffer_load_dwordx4 v[16:19], v6, s[8:11], s41 offen offset:0 sc1
    buffer_load_dwordx4 v[20:23], v6, s[8:11], s41 offen offset:1024 sc1
    buffer_load_dwordx4 v[24:27], v6, s[8:11], s41 offen offset:2048 sc1
    buffer_load_dwordx4 v[28:31], v6, s[8:11], s41 offen offset:3072 sc1
    buffer_load_dwordx4 v[32:35], v7, s[8:11], s41 offen offset:0 sc1
    buffer_load_dwordx4 v[36:39], v7, s[8:11], s41 offen offset:1024 sc1
    buffer_load_dwordx4 v[40:43], v7, s[8:11], s41 offen offset:2048 sc1
    buffer_load_dwordx4 v[44:47], v7, s[8:11], s41 offen offset:3072 sc1
    buffer_load_dwordx4 v[48:51], v8, s[8:11], s41 offen offset:0 sc1
    buffer_load_dwordx4 v[52:55], v8, s[8:11], s41 offen offset:1024 sc1
    buffer_load_dwordx4 v[56:59], v8, s[8:11], s41 offen offset:2048 sc1
    buffer_load_dwordx4 v[60:63], v8, s[8:11], s41 offen offset:3072 sc1
    s_add_u32 s41, s41, 393216
    s_waitcnt vmcnt(0)
interleave_layers__linear_attn_block__memory_aug_recurrent_mem_tr__prompt_kernel_of44:
    s_waitcnt vmcnt(10)
    s_add_u32 s40, s40, 1
    s_add_u32 s43, s43, 1310720
    s_cmp_lt_u32 s40, 64
    s_cbranch_scc1 interleave_layers__linear_attn_block__memory_aug_recurrent_mem_tr__prompt_kernel_o_seg
    s_waitcnt vmcnt(0)
    s_barrier
    s_cmp_eq_u32 s3, 0
    s_cbranch_scc0 interleave_layers__linear_attn_block__memory_aug_recurrent_mem_tr__prompt_kernel_fp46
    v_mov_b32 v15, s40
    buffer_store_dword v15, v14, s[8:11], 0 offen sc1
interleave_layers__linear_attn_block__memory_aug_recurrent_mem_tr__prompt_kernel_fp46:
    s_cmp_eq_u32 s92, 0
    s_cbranch_scc0 interleave_layers__linear_attn_block__memory_aug_recurrent_mem_tr__prompt_kernel_end
    s_mov_b32 s92, 1
    s_branch interleave_layers__linear_attn_block__memory_aug_recurrent_mem_tr__prompt_kernel_o_layer
interleave_layers__linear_attn_block__memory_aug_recurrent_mem_tr__prompt_kernel_end:
    s_endpgm
.section .rodata,"a"
.p2align 6
.amdhsa_kernel interleave_layers__linear_attn_block__memory_aug_recurrent_mem_tr__prompt_kernel
  .amdhsa_next_free_vgpr 512
  .amdhsa_next_free_sgpr 100
  .amdhsa_accum_offset 256
  .amdhsa_group_segment_fixed_size 0
  .amdhsa_kernarg_size 104
  .amdhsa_user_sgpr_count 2
  .amdhsa_user_sgpr_kernarg_segment_ptr 1
  .amdhsa_system_sgpr_workgroup_id_x 1
.end_amdhsa_kernel
```

```asm
; @launch kernel=interleave_layers__linear_attn_block__memory_aug_recurrent_mem_tr__prompt_kernel grid=(256,1,1) block=(256,1,1) lds=135168
.amdgcn_target "amdgcn-amd-amdhsa--gfx950"
.text
.globl interleave_layers__linear_attn_block__memory_aug_recurrent_mem_tr__prompt_kernel
.p2align 8
.type interleave_layers__linear_attn_block__memory_aug_recurrent_mem_tr__prompt_kernel,@function
interleave_layers__linear_attn_block__memory_aug_recurrent_mem_tr__prompt_kernel:
    s_cmp_ge_u32 s2, 256
    s_cbranch_scc1 interleave_layers__linear_attn_block__memory_aug_recurrent_mem_tr__prompt_kernel_end
    s_load_dwordx2 s[4:5], s[0:1], 96
    s_load_dwordx2 s[6:7], s[0:1], 88
    s_load_dwordx2 s[24:25], s[0:1], 0
    s_load_dwordx2 s[98:99], s[0:1], 8
    s_and_b32 s44, s2, 7
    s_lshr_b32 s45, s2, 3
    s_and_b32 s26, s44, 3
    s_lshl_b32 s27, s45, 2
    s_add_u32 s26, s26, s27
    s_add_u32 s27, s26, 128
    s_cmp_lt_u32 s26, 104
    s_cselect_b32 s27, s26, s27
    s_add_u32 s26, s26, 104
    s_cmp_lt_u32 s44, 4
    s_cselect_b32 s2, s27, s26
    v_and_b32 v1, 63, v0
    v_lshrrev_b32 v4, 6, v0
    v_and_b32 v2, 15, v1
    v_lshrrev_b32 v3, 4, v1
    v_readfirstlane_b32 s3, v4
    s_mov_b32 s60, 131072
    s_mov_b32 s59, -1
    s_mov_b32 s92, 0
    s_mov_b32 s36, 0
    s_waitcnt lgkmcnt(0)
    s_mov_b32 s8, s4
    s_mov_b32 s9, s5
    s_mov_b32 s10, 268435456
    s_mov_b32 s11, 0x00020000
    s_mov_b32 s72, s6
    s_mov_b32 s73, s7
    s_mov_b32 s74, 256
    s_mov_b32 s75, 0x00020000
    s_mov_b32 s16, s24
    s_mov_b32 s17, s25
    s_mov_b32 s18, 2621440
    s_mov_b32 s19, 0x00020000
    s_cmp_eq_u32 s2, 255
    s_cbranch_scc0 interleave_layers__linear_attn_block__memory_aug_recurrent_mem_tr__prompt_kernel_cf1
    v_lshlrev_b32 v5, 4, v0
    v_mov_b32 v8, -1
    v_mov_b32 v9, -1
    v_mov_b32 v10, -1
    v_mov_b32 v11, -1
    s_mov_b32 s24, 23068672
    buffer_store_dwordx4 v[8:11], v5, s[8:11], s24 offen sc1
    s_add_u32 s24, s24, 4096
    buffer_store_dwordx4 v[8:11], v5, s[8:11], s24 offen sc1
    s_add_u32 s24, s24, 4096
    buffer_store_dwordx4 v[8:11], v5, s[8:11], s24 offen sc1
    s_add_u32 s24, s24, 4096
    buffer_store_dwordx4 v[8:11], v5, s[8:11], s24 offen sc1
    s_add_u32 s24, s24, 4096
    buffer_store_dwordx4 v[8:11], v5, s[8:11], s24 offen sc1
    s_add_u32 s24, s24, 4096
    buffer_store_dwordx4 v[8:11], v5, s[8:11], s24 offen sc1
    s_add_u32 s24, s24, 4096
    buffer_store_dwordx4 v[8:11], v5, s[8:11], s24 offen sc1
    s_add_u32 s24, s24, 4096
    buffer_store_dwordx4 v[8:11], v5, s[8:11], s24 offen sc1
    s_add_u32 s24, s24, 4096
    buffer_store_dwordx4 v[8:11], v5, s[8:11], s24 offen sc1
    s_add_u32 s24, s24, 4096
    buffer_store_dwordx4 v[8:11], v5, s[8:11], s24 offen sc1
    s_add_u32 s24, s24, 4096
    buffer_store_dwordx4 v[8:11], v5, s[8:11], s24 offen sc1
    s_add_u32 s24, s24, 4096
    buffer_store_dwordx4 v[8:11], v5, s[8:11], s24 offen sc1
    s_add_u32 s24, s24, 4096
    buffer_store_dwordx4 v[8:11], v5, s[8:11], s24 offen sc1
    s_add_u32 s24, s24, 4096
    buffer_store_dwordx4 v[8:11], v5, s[8:11], s24 offen sc1
    s_add_u32 s24, s24, 4096
    buffer_store_dwordx4 v[8:11], v5, s[8:11], s24 offen sc1
    s_add_u32 s24, s24, 4096
    buffer_store_dwordx4 v[8:11], v5, s[8:11], s24 offen sc1
    s_add_u32 s24, s24, 4096
interleave_layers__linear_attn_block__memory_aug_recurrent_mem_tr__prompt_kernel_cf1:
    s_mov_b32 s46, 64
    s_mov_b32 s47, 32
    s_mov_b32 s50, 0
    s_lshl_b32 s48, s45, 1
    s_mov_b32 s49, 1
    s_mov_b32 s40, 2
interleave_layers__linear_attn_block__memory_aug_recurrent_mem_tr__prompt_kernel_k1_entry:
    v_and_b32 v7, 31, v0
    v_lshrrev_b32 v8, 5, v0
    v_mul_u32_u24 v152, 3840, v8
    v_lshlrev_b32 v9, 4, v7
    v_add_u32 v152, v152, v9
    v_cmp_le_u32 vcc, 10, v7
    s_nop 1
    v_cndmask_b32 v10, 0, 1, vcc
    v_cmp_le_u32 vcc, 20, v7
    s_nop 1
    v_cndmask_b32 v11, 0, 1, vcc
    v_add_u32 v10, v10, v11
    v_mul_u32_u24 v10, 1120, v10
    v_add_u32 v152, v152, v10
    v_mov_b32 v10, 2146435072
    v_cmp_le_u32 vcc, 30, v7
    s_nop 1
    v_cndmask_b32 v152, v152, v10, vcc
    v_mul_u32_u24 v153, 544, v8
    v_add_u32 v153, v153, v9
    v_add_u32 v153, 40960, v153
    s_mov_b32 s12, s98
    s_mov_b32 s13, s99
    s_mov_b32 s14, 2457600
    s_mov_b32 s15, 0x00020000
    s_mul_i32 s52, s44, 160
    v_lshrrev_b32 v10, 2, v0
    v_mul_u32_u24 v10, 3840, v10
    v_and_b32 v11, 3, v0
    v_lshlrev_b32 v11, 6, v11
    v_min_u32 v11, 156, v11
    v_add_u32 v10, v10, v11
    s_mul_i32 s24, s45, 205
    s_lshr_b32 s24, s24, 11
    s_mul_i32 s24, s24, 10
    s_sub_u32 s24, s45, s24
    s_mul_i32 s24, s24, 245760
    s_add_u32 s24, s24, s52
    buffer_load_dword a254, v10, s[12:15], s24 offen
    s_add_u32 s24, s24, 1280
    buffer_load_dword a254, v10, s[12:15], s24 offen
    s_add_u32 s24, s24, 1280
    buffer_load_dword a254, v10, s[12:15], s24 offen
    s_add_u32 s24, s52, 0
    buffer_load_dwordx4 v[56:59], v152, s[12:15], s24 offen
    s_add_u32 s24, s24, 30720
    buffer_load_dwordx4 v[60:63], v152, s[12:15], s24 offen
    s_add_u32 s24, s24, 30720
    buffer_load_dwordx4 v[64:67], v152, s[12:15], s24 offen
    s_add_u32 s24, s24, 30720
    buffer_load_dwordx4 v[68:71], v152, s[12:15], s24 offen
    s_add_u32 s24, s24, 30720
    buffer_load_dwordx4 v[72:75], v152, s[12:15], s24 offen
    s_add_u32 s24, s24, 30720
    buffer_load_dwordx4 v[76:79], v152, s[12:15], s24 offen
    s_add_u32 s24, s24, 30720
    buffer_load_dwordx4 v[80:83], v152, s[12:15], s24 offen
    s_add_u32 s24, s24, 30720
    buffer_load_dwordx4 v[84:87], v152, s[12:15], s24 offen
    s_add_u32 s24, s52, 245760
    buffer_load_dwordx4 v[88:91], v152, s[12:15], s24 offen
    s_add_u32 s24, s24, 30720
    buffer_load_dwordx4 v[92:95], v152, s[12:15], s24 offen
    s_add_u32 s24, s24, 30720
    buffer_load_dwordx4 v[96:99], v152, s[12:15], s24 offen
    s_add_u32 s24, s24, 30720
    buffer_load_dwordx4 v[100:103], v152, s[12:15], s24 offen
    s_add_u32 s24, s24, 30720
    buffer_load_dwordx4 v[104:107], v152, s[12:15], s24 offen
    s_add_u32 s24, s24, 30720
    buffer_load_dwordx4 v[108:111], v152, s[12:15], s24 offen
    s_add_u32 s24, s24, 30720
    buffer_load_dwordx4 v[112:115], v152, s[12:15], s24 offen
    s_add_u32 s24, s24, 30720
    buffer_load_dwordx4 v[116:119], v152, s[12:15], s24 offen
    s_add_u32 s24, s52, 491520
    buffer_load_dwordx4 v[120:123], v152, s[12:15], s24 offen
    s_add_u32 s24, s24, 30720
    buffer_load_dwordx4 v[124:127], v152, s[12:15], s24 offen
    s_add_u32 s24, s24, 30720
    buffer_load_dwordx4 v[128:131], v152, s[12:15], s24 offen
    s_add_u32 s24, s24, 30720
    buffer_load_dwordx4 v[132:135], v152, s[12:15], s24 offen
    s_add_u32 s24, s24, 30720
    buffer_load_dwordx4 v[136:139], v152, s[12:15], s24 offen
    s_add_u32 s24, s24, 30720
    buffer_load_dwordx4 v[140:143], v152, s[12:15], s24 offen
    s_add_u32 s24, s24, 30720
    buffer_load_dwordx4 v[144:147], v152, s[12:15], s24 offen
    s_add_u32 s24, s24, 30720
    buffer_load_dwordx4 v[148:151], v152, s[12:15], s24 offen
    s_lshr_b32 s24, s3, 1
    s_mul_i32 s24, s24, 20480
    s_and_b32 s25, s3, 1
    s_mul_i32 s25, s25, 10
    s_mul_i32 s25, s25, s46
    s_add_u32 s24, s24, s25
    s_cmp_eq_u32 s50, 1
    s_cselect_b32 s25, 16, 1280
    s_cselect_b32 s26, 256, 8
    v_mul_u32_u24 v4, s25, v2
    v_mul_u32_u24 v5, s26, v3
    v_add3_u32 v4, v4, v5, s24
    v_add_u32 v5, s47, v4
    s_mul_i32 s43, s48, 40960
    s_mul_i32 s42, s49, 40960
    s_cmp_eq_u32 s92, 0
    s_cselect_b32 s51, 1, 0
    s_cselect_b32 s41, s43, 2146435072
    s_mov_b32 s24, s41
    buffer_load_dwordx2 v[16:17], v4, s[16:19], s24 offen
    buffer_load_dwordx2 v[18:19], v5, s[16:19], s24 offen
    s_add_u32 s24, s24, s46
    buffer_load_dwordx2 v[20:21], v4, s[16:19], s24 offen
    buffer_load_dwordx2 v[22:23], v5, s[16:19], s24 offen
    s_add_u32 s24, s24, s46
    buffer_load_dwordx2 v[24:25], v4, s[16:19], s24 offen
    buffer_load_dwordx2 v[26:27], v5, s[16:19], s24 offen
    s_add_u32 s24, s24, s46
    buffer_load_dwordx2 v[28:29], v4, s[16:19], s24 offen
    buffer_load_dwordx2 v[30:31], v5, s[16:19], s24 offen
    s_add_u32 s24, s24, s46
    buffer_load_dwordx2 v[32:33], v4, s[16:19], s24 offen
    buffer_load_dwordx2 v[34:35], v5, s[16:19], s24 offen
    s_add_u32 s24, s24, s46
    buffer_load_dwordx2 v[36:37], v4, s[16:19], s24 offen
    buffer_load_dwordx2 v[38:39], v5, s[16:19], s24 offen
    s_add_u32 s24, s24, s46
    buffer_load_dwordx2 v[40:41], v4, s[16:19], s24 offen
    buffer_load_dwordx2 v[42:43], v5, s[16:19], s24 offen
    s_add_u32 s24, s24, s46
    buffer_load_dwordx2 v[44:45], v4, s[16:19], s24 offen
    buffer_load_dwordx2 v[46:47], v5, s[16:19], s24 offen
    s_add_u32 s24, s24, s46
    buffer_load_dwordx2 v[48:49], v4, s[16:19], s24 offen
    buffer_load_dwordx2 v[50:51], v5, s[16:19], s24 offen
    s_add_u32 s24, s24, s46
    buffer_load_dwordx2 v[52:53], v4, s[16:19], s24 offen
    buffer_load_dwordx2 v[54:55], v5, s[16:19], s24 offen
    v_lshrrev_b32 v6, 2, v2
    v_lshl_add_u32 v6, v3, 2, v6
    v_mul_u32_u24 v6, 544, v6
    v_and_b32 v7, 3, v2
    v_lshl_add_u32 v6, v7, 3, v6
    v_add_u32 v6, 40960, v6
    s_mov_b32 s24, 0
    s_cmp_eq_u32 s3, 1
    s_cselect_b32 s24, 64, s24
    s_cmp_eq_u32 s3, 2
    s_cselect_b32 s24, 128, s24
    s_cmp_eq_u32 s3, 3
    s_cselect_b32 s24, 224, s24
    v_add_u32 v12, s24, v6
    s_mov_b32 s24, 32
    s_cmp_eq_u32 s3, 1
    s_cselect_b32 s24, 96, s24
    s_cmp_eq_u32 s3, 2
    s_cselect_b32 s24, 160, s24
    s_cmp_eq_u32 s3, 3
    s_cselect_b32 s24, 256, s24
    v_add_u32 v13, s24, v6
    s_mov_b32 s24, 320
    s_cmp_eq_u32 s3, 1
    s_cselect_b32 s24, 384, s24
    s_cmp_eq_u32 s3, 2
    s_cselect_b32 s24, 192, s24
    s_cmp_eq_u32 s3, 3
    s_cselect_b32 s24, 288, s24
    v_add_u32 v14, s24, v6
    s_mov_b32 s24, 352
    s_cmp_eq_u32 s3, 1
    s_cselect_b32 s24, 416, s24
    s_cmp_eq_u32 s3, 2
    s_cselect_b32 s24, 448, s24
    s_cmp_eq_u32 s3, 3
    s_cselect_b32 s24, 288, s24
    v_add_u32 v15, s24, v6
    v_mov_b32 v172, 0x3f803f80
    v_mov_b32 v173, 0x3f803f80
    v_mov_b32 v174, 0x3f803f80
    v_mov_b32 v175, 0x3f803f80
    s_waitcnt vmcnt(36)
    ds_write_b128 v153, v[56:59] offset:0
    ds_write_b128 v153, v[60:63] offset:4352
    ds_write_b128 v153, v[64:67] offset:8704
    ds_write_b128 v153, v[68:71] offset:13056
    ds_write_b128 v153, v[72:75] offset:17408
    ds_write_b128 v153, v[76:79] offset:21760
    ds_write_b128 v153, v[80:83] offset:26112
    ds_write_b128 v153, v[84:87] offset:30464
    s_waitcnt lgkmcnt(0)
    s_add_u32 s24, s52, 737280
    buffer_load_dwordx4 v[56:59], v152, s[12:15], s24 offen
    s_add_u32 s24, s24, 30720
    buffer_load_dwordx4 v[60:63], v152, s[12:15], s24 offen
    s_add_u32 s24, s24, 30720
    buffer_load_dwordx4 v[64:67], v152, s[12:15], s24 offen
    s_add_u32 s24, s24, 30720
    buffer_load_dwordx4 v[68:71], v152, s[12:15], s24 offen
    s_add_u32 s24, s24, 30720
    buffer_load_dwordx4 v[72:75], v152, s[12:15], s24 offen
    s_add_u32 s24, s24, 30720
    buffer_load_dwordx4 v[76:79], v152, s[12:15], s24 offen
    s_add_u32 s24, s24, 30720
    buffer_load_dwordx4 v[80:83], v152, s[12:15], s24 offen
    s_add_u32 s24, s24, 30720
    buffer_load_dwordx4 v[84:87], v152, s[12:15], s24 offen
    s_barrier
    ds_read_b64_tr_b16 a[0:1], v12 offset:0
    ds_read_b64_tr_b16 a[2:3], v12 offset:8704
    ds_read_b64_tr_b16 a[4:5], v12 offset:17408
    ds_read_b64_tr_b16 a[6:7], v12 offset:26112
    ds_read_b64_tr_b16 a[80:81], v13 offset:0
    ds_read_b64_tr_b16 a[82:83], v13 offset:8704
    ds_read_b64_tr_b16 a[84:85], v13 offset:17408
    ds_read_b64_tr_b16 a[86:87], v13 offset:26112
    ds_read_b64_tr_b16 a[160:161], v14 offset:0
    ds_read_b64_tr_b16 a[162:163], v14 offset:8704
    ds_read_b64_tr_b16 a[164:165], v14 offset:17408
    ds_read_b64_tr_b16 a[166:167], v14 offset:26112
    ds_read_b64_tr_b16 v[176:177], v15 offset:0
    ds_read_b64_tr_b16 v[178:179], v15 offset:8704
    ds_read_b64_tr_b16 v[180:181], v15 offset:17408
    ds_read_b64_tr_b16 v[182:183], v15 offset:26112
    s_waitcnt vmcnt(36)
    ds_write_b128 v153, v[88:91] offset:34816
    ds_write_b128 v153, v[92:95] offset:39168
    ds_write_b128 v153, v[96:99] offset:43520
    ds_write_b128 v153, v[100:103] offset:47872
    ds_write_b128 v153, v[104:107] offset:52224
    ds_write_b128 v153, v[108:111] offset:56576
    ds_write_b128 v153, v[112:115] offset:60928
    ds_write_b128 v153, v[116:119] offset:65280
    s_waitcnt lgkmcnt(0)
    s_add_u32 s24, s52, 983040
    buffer_load_dwordx4 v[88:91], v152, s[12:15], s24 offen
    s_add_u32 s24, s24, 30720
    buffer_load_dwordx4 v[92:95], v152, s[12:15], s24 offen
    s_add_u32 s24, s24, 30720
    buffer_load_dwordx4 v[96:99], v152, s[12:15], s24 offen
    s_add_u32 s24, s24, 30720
    buffer_load_dwordx4 v[100:103], v152, s[12:15], s24 offen
    s_add_u32 s24, s24, 30720
    buffer_load_dwordx4 v[104:107], v152, s[12:15], s24 offen
    s_add_u32 s24, s24, 30720
    buffer_load_dwordx4 v[108:111], v152, s[12:15], s24 offen
    s_add_u32 s24, s24, 30720
    buffer_load_dwordx4 v[112:115], v152, s[12:15], s24 offen
    s_add_u32 s24, s24, 30720
    buffer_load_dwordx4 v[116:119], v152, s[12:15], s24 offen
    v_mfma_f32_16x16x32_bf16 v[156:159], a[0:3], v[172:175], 0
    v_mfma_f32_16x16x32_bf16 v[160:163], a[80:83], v[172:175], 0
    v_mfma_f32_16x16x32_bf16 v[164:167], a[160:163], v[172:175], 0
    v_mfma_f32_16x16x32_bf16 v[168:171], v[176:179], v[172:175], 0
    v_mfma_f32_16x16x32_bf16 v[156:159], a[4:7], v[172:175], v[156:159]
    v_mfma_f32_16x16x32_bf16 v[160:163], a[84:87], v[172:175], v[160:163]
    v_mfma_f32_16x16x32_bf16 v[164:167], a[164:167], v[172:175], v[164:167]
    v_mfma_f32_16x16x32_bf16 v[168:171], v[180:183], v[172:175], v[168:171]
    s_barrier
    ds_read_b64_tr_b16 a[8:9], v12 offset:34816
    ds_read_b64_tr_b16 a[10:11], v12 offset:43520
    ds_read_b64_tr_b16 a[12:13], v12 offset:52224
    ds_read_b64_tr_b16 a[14:15], v12 offset:60928
    ds_read_b64_tr_b16 a[88:89], v13 offset:34816
    ds_read_b64_tr_b16 a[90:91], v13 offset:43520
    ds_read_b64_tr_b16 a[92:93], v13 offset:52224
    ds_read_b64_tr_b16 a[94:95], v13 offset:60928
    ds_read_b64_tr_b16 a[168:169], v14 offset:34816
    ds_read_b64_tr_b16 a[170:171], v14 offset:43520
    ds_read_b64_tr_b16 a[172:173], v14 offset:52224
    ds_read_b64_tr_b16 a[174:175], v14 offset:60928
    ds_read_b64_tr_b16 v[184:185], v15 offset:34816
    ds_read_b64_tr_b16 v[186:187], v15 offset:43520
    ds_read_b64_tr_b16 v[188:189], v15 offset:52224
    ds_read_b64_tr_b16 v[190:191], v15 offset:60928
    s_waitcnt vmcnt(36)
    ds_write_b128 v153, v[120:123] offset:0
    ds_write_b128 v153, v[124:127] offset:4352
    ds_write_b128 v153, v[128:131] offset:8704
    ds_write_b128 v153, v[132:135] offset:13056
    ds_write_b128 v153, v[136:139] offset:17408
    ds_write_b128 v153, v[140:143] offset:21760
    ds_write_b128 v153, v[144:147] offset:26112
    ds_write_b128 v153, v[148:151] offset:30464
    s_waitcnt lgkmcnt(0)
    s_add_u32 s24, s52, 1228800
    buffer_load_dwordx4 v[120:123], v152, s[12:15], s24 offen
    s_add_u32 s24, s24, 30720
    buffer_load_dwordx4 v[124:127], v152, s[12:15], s24 offen
    s_add_u32 s24, s24, 30720
    buffer_load_dwordx4 v[128:131], v152, s[12:15], s24 offen
    s_add_u32 s24, s24, 30720
    buffer_load_dwordx4 v[132:135], v152, s[12:15], s24 offen
    s_add_u32 s24, s24, 30720
    buffer_load_dwordx4 v[136:139], v152, s[12:15], s24 offen
    s_add_u32 s24, s24, 30720
    buffer_load_dwordx4 v[140:143], v152, s[12:15], s24 offen
    s_add_u32 s24, s24, 30720
    buffer_load_dwordx4 v[144:147], v152, s[12:15], s24 offen
    s_add_u32 s24, s24, 30720
    buffer_load_dwordx4 v[148:151], v152, s[12:15], s24 offen
    v_mfma_f32_16x16x32_bf16 v[156:159], a[8:11], v[172:175], v[156:159]
    v_mfma_f32_16x16x32_bf16 v[160:163], a[88:91], v[172:175], v[160:163]
    v_mfma_f32_16x16x32_bf16 v[164:167], a[168:171], v[172:175], v[164:167]
    v_mfma_f32_16x16x32_bf16 v[168:171], v[184:187], v[172:175], v[168:171]
    v_mfma_f32_16x16x32_bf16 v[156:159], a[12:15], v[172:175], v[156:159]
    v_mfma_f32_16x16x32_bf16 v[160:163], a[92:95], v[172:175], v[160:163]
    v_mfma_f32_16x16x32_bf16 v[164:167], a[172:175], v[172:175], v[164:167]
    v_mfma_f32_16x16x32_bf16 v[168:171], v[188:191], v[172:175], v[168:171]
    s_barrier
    ds_read_b64_tr_b16 a[16:17], v12 offset:0
    ds_read_b64_tr_b16 a[18:19], v12 offset:8704
    ds_read_b64_tr_b16 a[20:21], v12 offset:17408
    ds_read_b64_tr_b16 a[22:23], v12 offset:26112
    ds_read_b64_tr_b16 a[96:97], v13 offset:0
    ds_read_b64_tr_b16 a[98:99], v13 offset:8704
    ds_read_b64_tr_b16 a[100:101], v13 offset:17408
    ds_read_b64_tr_b16 a[102:103], v13 offset:26112
    ds_read_b64_tr_b16 a[176:177], v14 offset:0
    ds_read_b64_tr_b16 a[178:179], v14 offset:8704
    ds_read_b64_tr_b16 a[180:181], v14 offset:17408
    ds_read_b64_tr_b16 a[182:183], v14 offset:26112
    ds_read_b64_tr_b16 v[192:193], v15 offset:0
    ds_read_b64_tr_b16 v[194:195], v15 offset:8704
    ds_read_b64_tr_b16 v[196:197], v15 offset:17408
    ds_read_b64_tr_b16 v[198:199], v15 offset:26112
    s_waitcnt vmcnt(16)
    ds_write_b128 v153, v[56:59] offset:34816
    ds_write_b128 v153, v[60:63] offset:39168
    ds_write_b128 v153, v[64:67] offset:43520
    ds_write_b128 v153, v[68:71] offset:47872
    ds_write_b128 v153, v[72:75] offset:52224
    ds_write_b128 v153, v[76:79] offset:56576
    ds_write_b128 v153, v[80:83] offset:60928
    ds_write_b128 v153, v[84:87] offset:65280
    s_waitcnt lgkmcnt(0)
    s_add_u32 s24, s52, 1474560
    buffer_load_dwordx4 v[56:59], v152, s[12:15], s24 offen
    s_add_u32 s24, s24, 30720
    buffer_load_dwordx4 v[60:63], v152, s[12:15], s24 offen
    s_add_u32 s24, s24, 30720
    buffer_load_dwordx4 v[64:67], v152, s[12:15], s24 offen
    s_add_u32 s24, s24, 30720
    buffer_load_dwordx4 v[68:71], v152, s[12:15], s24 offen
    s_add_u32 s24, s24, 30720
    buffer_load_dwordx4 v[72:75], v152, s[12:15], s24 offen
    s_add_u32 s24, s24, 30720
    buffer_load_dwordx4 v[76:79], v152, s[12:15], s24 offen
    s_add_u32 s24, s24, 30720
    buffer_load_dwordx4 v[80:83], v152, s[12:15], s24 offen
    s_add_u32 s24, s24, 30720
    buffer_load_dwordx4 v[84:87], v152, s[12:15], s24 offen
    v_mfma_f32_16x16x32_bf16 v[156:159], a[16:19], v[172:175], v[156:159]
    v_mfma_f32_16x16x32_bf16 v[160:163], a[96:99], v[172:175], v[160:163]
    v_mfma_f32_16x16x32_bf16 v[164:167], a[176:179], v[172:175], v[164:167]
    v_mfma_f32_16x16x32_bf16 v[168:171], v[192:195], v[172:175], v[168:171]
    v_mfma_f32_16x16x32_bf16 v[156:159], a[20:23], v[172:175], v[156:159]
    v_mfma_f32_16x16x32_bf16 v[160:163], a[100:103], v[172:175], v[160:163]
    v_mfma_f32_16x16x32_bf16 v[164:167], a[180:183], v[172:175], v[164:167]
    v_mfma_f32_16x16x32_bf16 v[168:171], v[196:199], v[172:175], v[168:171]
    s_barrier
    ds_read_b64_tr_b16 a[24:25], v12 offset:34816
    ds_read_b64_tr_b16 a[26:27], v12 offset:43520
    ds_read_b64_tr_b16 a[28:29], v12 offset:52224
    ds_read_b64_tr_b16 a[30:31], v12 offset:60928
    ds_read_b64_tr_b16 a[104:105], v13 offset:34816
    ds_read_b64_tr_b16 a[106:107], v13 offset:43520
    ds_read_b64_tr_b16 a[108:109], v13 offset:52224
    ds_read_b64_tr_b16 a[110:111], v13 offset:60928
    ds_read_b64_tr_b16 a[184:185], v14 offset:34816
    ds_read_b64_tr_b16 a[186:187], v14 offset:43520
    ds_read_b64_tr_b16 a[188:189], v14 offset:52224
    ds_read_b64_tr_b16 a[190:191], v14 offset:60928
    ds_read_b64_tr_b16 v[200:201], v15 offset:34816
    ds_read_b64_tr_b16 v[202:203], v15 offset:43520
    ds_read_b64_tr_b16 v[204:205], v15 offset:52224
    ds_read_b64_tr_b16 v[206:207], v15 offset:60928
    s_waitcnt vmcnt(16)
    ds_write_b128 v153, v[88:91] offset:0
    ds_write_b128 v153, v[92:95] offset:4352
    ds_write_b128 v153, v[96:99] offset:8704
    ds_write_b128 v153, v[100:103] offset:13056
    ds_write_b128 v153, v[104:107] offset:17408
    ds_write_b128 v153, v[108:111] offset:21760
    ds_write_b128 v153, v[112:115] offset:26112
    ds_write_b128 v153, v[116:119] offset:30464
    s_waitcnt lgkmcnt(0)
    s_add_u32 s24, s52, 1720320
    buffer_load_dwordx4 v[88:91], v152, s[12:15], s24 offen
    s_add_u32 s24, s24, 30720
    buffer_load_dwordx4 v[92:95], v152, s[12:15], s24 offen
    s_add_u32 s24, s24, 30720
    buffer_load_dwordx4 v[96:99], v152, s[12:15], s24 offen
    s_add_u32 s24, s24, 30720
    buffer_load_dwordx4 v[100:103], v152, s[12:15], s24 offen
    s_add_u32 s24, s24, 30720
    buffer_load_dwordx4 v[104:107], v152, s[12:15], s24 offen
    s_add_u32 s24, s24, 30720
    buffer_load_dwordx4 v[108:111], v152, s[12:15], s24 offen
    s_add_u32 s24, s24, 30720
    buffer_load_dwordx4 v[112:115], v152, s[12:15], s24 offen
    s_add_u32 s24, s24, 30720
    buffer_load_dwordx4 v[116:119], v152, s[12:15], s24 offen
    v_mfma_f32_16x16x32_bf16 v[156:159], a[24:27], v[172:175], v[156:159]
    v_mfma_f32_16x16x32_bf16 v[160:163], a[104:107], v[172:175], v[160:163]
    v_mfma_f32_16x16x32_bf16 v[164:167], a[184:187], v[172:175], v[164:167]
    v_mfma_f32_16x16x32_bf16 v[168:171], v[200:203], v[172:175], v[168:171]
    v_mfma_f32_16x16x32_bf16 v[156:159], a[28:31], v[172:175], v[156:159]
    v_mfma_f32_16x16x32_bf16 v[160:163], a[108:111], v[172:175], v[160:163]
    v_mfma_f32_16x16x32_bf16 v[164:167], a[188:191], v[172:175], v[164:167]
    v_mfma_f32_16x16x32_bf16 v[168:171], v[204:207], v[172:175], v[168:171]
    s_barrier
    ds_read_b64_tr_b16 a[32:33], v12 offset:0
    ds_read_b64_tr_b16 a[34:35], v12 offset:8704
    ds_read_b64_tr_b16 a[36:37], v12 offset:17408
    ds_read_b64_tr_b16 a[38:39], v12 offset:26112
    ds_read_b64_tr_b16 a[112:113], v13 offset:0
    ds_read_b64_tr_b16 a[114:115], v13 offset:8704
    ds_read_b64_tr_b16 a[116:117], v13 offset:17408
    ds_read_b64_tr_b16 a[118:119], v13 offset:26112
    ds_read_b64_tr_b16 a[192:193], v14 offset:0
    ds_read_b64_tr_b16 a[194:195], v14 offset:8704
    ds_read_b64_tr_b16 a[196:197], v14 offset:17408
    ds_read_b64_tr_b16 a[198:199], v14 offset:26112
    ds_read_b64_tr_b16 v[208:209], v15 offset:0
    ds_read_b64_tr_b16 v[210:211], v15 offset:8704
    ds_read_b64_tr_b16 v[212:213], v15 offset:17408
    ds_read_b64_tr_b16 v[214:215], v15 offset:26112
    s_waitcnt vmcnt(16)
    ds_write_b128 v153, v[120:123] offset:34816
    ds_write_b128 v153, v[124:127] offset:39168
    ds_write_b128 v153, v[128:131] offset:43520
    ds_write_b128 v153, v[132:135] offset:47872
    ds_write_b128 v153, v[136:139] offset:52224
    ds_write_b128 v153, v[140:143] offset:56576
    ds_write_b128 v153, v[144:147] offset:60928
    ds_write_b128 v153, v[148:151] offset:65280
    s_waitcnt lgkmcnt(0)
    s_add_u32 s24, s52, 1966080
    buffer_load_dwordx4 v[120:123], v152, s[12:15], s24 offen
    s_add_u32 s24, s24, 30720
    buffer_load_dwordx4 v[124:127], v152, s[12:15], s24 offen
    s_add_u32 s24, s24, 30720
    buffer_load_dwordx4 v[128:131], v152, s[12:15], s24 offen
    s_add_u32 s24, s24, 30720
    buffer_load_dwordx4 v[132:135], v152, s[12:15], s24 offen
    s_add_u32 s24, s24, 30720
    buffer_load_dwordx4 v[136:139], v152, s[12:15], s24 offen
    s_add_u32 s24, s24, 30720
    buffer_load_dwordx4 v[140:143], v152, s[12:15], s24 offen
    s_add_u32 s24, s24, 30720
    buffer_load_dwordx4 v[144:147], v152, s[12:15], s24 offen
    s_add_u32 s24, s24, 30720
    buffer_load_dwordx4 v[148:151], v152, s[12:15], s24 offen
    v_mfma_f32_16x16x32_bf16 v[156:159], a[32:35], v[172:175], v[156:159]
    v_mfma_f32_16x16x32_bf16 v[160:163], a[112:115], v[172:175], v[160:163]
    v_mfma_f32_16x16x32_bf16 v[164:167], a[192:195], v[172:175], v[164:167]
    v_mfma_f32_16x16x32_bf16 v[168:171], v[208:211], v[172:175], v[168:171]
    v_mfma_f32_16x16x32_bf16 v[156:159], a[36:39], v[172:175], v[156:159]
    v_mfma_f32_16x16x32_bf16 v[160:163], a[116:119], v[172:175], v[160:163]
    v_mfma_f32_16x16x32_bf16 v[164:167], a[196:199], v[172:175], v[164:167]
    v_mfma_f32_16x16x32_bf16 v[168:171], v[212:215], v[172:175], v[168:171]
    s_barrier
    ds_read_b64_tr_b16 a[40:41], v12 offset:34816
    ds_read_b64_tr_b16 a[42:43], v12 offset:43520
    ds_read_b64_tr_b16 a[44:45], v12 offset:52224
    ds_read_b64_tr_b16 a[46:47], v12 offset:60928
    ds_read_b64_tr_b16 a[120:121], v13 offset:34816
    ds_read_b64_tr_b16 a[122:123], v13 offset:43520
    ds_read_b64_tr_b16 a[124:125], v13 offset:52224
    ds_read_b64_tr_b16 a[126:127], v13 offset:60928
    ds_read_b64_tr_b16 a[200:201], v14 offset:34816
    ds_read_b64_tr_b16 a[202:203], v14 offset:43520
    ds_read_b64_tr_b16 a[204:205], v14 offset:52224
    ds_read_b64_tr_b16 a[206:207], v14 offset:60928
    ds_read_b64_tr_b16 v[216:217], v15 offset:34816
    ds_read_b64_tr_b16 v[218:219], v15 offset:43520
    ds_read_b64_tr_b16 v[220:221], v15 offset:52224
    ds_read_b64_tr_b16 v[222:223], v15 offset:60928
    s_waitcnt vmcnt(16)
    ds_write_b128 v153, v[56:59] offset:0
    ds_write_b128 v153, v[60:63] offset:4352
    ds_write_b128 v153, v[64:67] offset:8704
    ds_write_b128 v153, v[68:71] offset:13056
    ds_write_b128 v153, v[72:75] offset:17408
    ds_write_b128 v153, v[76:79] offset:21760
    ds_write_b128 v153, v[80:83] offset:26112
    ds_write_b128 v153, v[84:87] offset:30464
    s_waitcnt lgkmcnt(0)
    s_add_u32 s24, s52, 2211840
    buffer_load_dwordx4 v[56:59], v152, s[12:15], s24 offen
    s_add_u32 s24, s24, 30720
    buffer_load_dwordx4 v[60:63], v152, s[12:15], s24 offen
    s_add_u32 s24, s24, 30720
    buffer_load_dwordx4 v[64:67], v152, s[12:15], s24 offen
    s_add_u32 s24, s24, 30720
    buffer_load_dwordx4 v[68:71], v152, s[12:15], s24 offen
    s_add_u32 s24, s24, 30720
    buffer_load_dwordx4 v[72:75], v152, s[12:15], s24 offen
    s_add_u32 s24, s24, 30720
    buffer_load_dwordx4 v[76:79], v152, s[12:15], s24 offen
    s_add_u32 s24, s24, 30720
    buffer_load_dwordx4 v[80:83], v152, s[12:15], s24 offen
    s_add_u32 s24, s24, 30720
    buffer_load_dwordx4 v[84:87], v152, s[12:15], s24 offen
    v_mfma_f32_16x16x32_bf16 v[156:159], a[40:43], v[172:175], v[156:159]
    v_mfma_f32_16x16x32_bf16 v[160:163], a[120:123], v[172:175], v[160:163]
    v_mfma_f32_16x16x32_bf16 v[164:167], a[200:203], v[172:175], v[164:167]
    v_mfma_f32_16x16x32_bf16 v[168:171], v[216:219], v[172:175], v[168:171]
    v_mfma_f32_16x16x32_bf16 v[156:159], a[44:47], v[172:175], v[156:159]
    v_mfma_f32_16x16x32_bf16 v[160:163], a[124:127], v[172:175], v[160:163]
    v_mfma_f32_16x16x32_bf16 v[164:167], a[204:207], v[172:175], v[164:167]
    v_mfma_f32_16x16x32_bf16 v[168:171], v[220:223], v[172:175], v[168:171]
    s_barrier
    ds_read_b64_tr_b16 a[48:49], v12 offset:0
    ds_read_b64_tr_b16 a[50:51], v12 offset:8704
    ds_read_b64_tr_b16 a[52:53], v12 offset:17408
    ds_read_b64_tr_b16 a[54:55], v12 offset:26112
    ds_read_b64_tr_b16 a[128:129], v13 offset:0
    ds_read_b64_tr_b16 a[130:131], v13 offset:8704
    ds_read_b64_tr_b16 a[132:133], v13 offset:17408
    ds_read_b64_tr_b16 a[134:135], v13 offset:26112
    ds_read_b64_tr_b16 a[208:209], v14 offset:0
    ds_read_b64_tr_b16 a[210:211], v14 offset:8704
    ds_read_b64_tr_b16 a[212:213], v14 offset:17408
    ds_read_b64_tr_b16 a[214:215], v14 offset:26112
    ds_read_b64_tr_b16 v[224:225], v15 offset:0
    ds_read_b64_tr_b16 v[226:227], v15 offset:8704
    ds_read_b64_tr_b16 v[228:229], v15 offset:17408
    ds_read_b64_tr_b16 v[230:231], v15 offset:26112
    s_waitcnt vmcnt(16)
    ds_write_b128 v153, v[88:91] offset:34816
    ds_write_b128 v153, v[92:95] offset:39168
    ds_write_b128 v153, v[96:99] offset:43520
    ds_write_b128 v153, v[100:103] offset:47872
    ds_write_b128 v153, v[104:107] offset:52224
    ds_write_b128 v153, v[108:111] offset:56576
    ds_write_b128 v153, v[112:115] offset:60928
    ds_write_b128 v153, v[116:119] offset:65280
    s_waitcnt lgkmcnt(0)
    v_mfma_f32_16x16x32_bf16 v[156:159], a[48:51], v[172:175], v[156:159]
    v_mfma_f32_16x16x32_bf16 v[160:163], a[128:131], v[172:175], v[160:163]
    v_mfma_f32_16x16x32_bf16 v[164:167], a[208:211], v[172:175], v[164:167]
    v_mfma_f32_16x16x32_bf16 v[168:171], v[224:227], v[172:175], v[168:171]
    v_mfma_f32_16x16x32_bf16 v[156:159], a[52:55], v[172:175], v[156:159]
    v_mfma_f32_16x16x32_bf16 v[160:163], a[132:135], v[172:175], v[160:163]
    v_mfma_f32_16x16x32_bf16 v[164:167], a[212:215], v[172:175], v[164:167]
    v_mfma_f32_16x16x32_bf16 v[168:171], v[228:231], v[172:175], v[168:171]
    s_barrier
    ds_read_b64_tr_b16 a[56:57], v12 offset:34816
    ds_read_b64_tr_b16 a[58:59], v12 offset:43520
    ds_read_b64_tr_b16 a[60:61], v12 offset:52224
    ds_read_b64_tr_b16 a[62:63], v12 offset:60928
    ds_read_b64_tr_b16 a[136:137], v13 offset:34816
    ds_read_b64_tr_b16 a[138:139], v13 offset:43520
    ds_read_b64_tr_b16 a[140:141], v13 offset:52224
    ds_read_b64_tr_b16 a[142:143], v13 offset:60928
    ds_read_b64_tr_b16 a[216:217], v14 offset:34816
    ds_read_b64_tr_b16 a[218:219], v14 offset:43520
    ds_read_b64_tr_b16 a[220:221], v14 offset:52224
    ds_read_b64_tr_b16 a[222:223], v14 offset:60928
    ds_read_b64_tr_b16 v[232:233], v15 offset:34816
    ds_read_b64_tr_b16 v[234:235], v15 offset:43520
    ds_read_b64_tr_b16 v[236:237], v15 offset:52224
    ds_read_b64_tr_b16 v[238:239], v15 offset:60928
    s_waitcnt vmcnt(8)
    ds_write_b128 v153, v[120:123] offset:0
    ds_write_b128 v153, v[124:127] offset:4352
    ds_write_b128 v153, v[128:131] offset:8704
    ds_write_b128 v153, v[132:135] offset:13056
    ds_write_b128 v153, v[136:139] offset:17408
    ds_write_b128 v153, v[140:143] offset:21760
    ds_write_b128 v153, v[144:147] offset:26112
    ds_write_b128 v153, v[148:151] offset:30464
    s_waitcnt lgkmcnt(0)
    v_mfma_f32_16x16x32_bf16 v[156:159], a[56:59], v[172:175], v[156:159]
    v_mfma_f32_16x16x32_bf16 v[160:163], a[136:139], v[172:175], v[160:163]
    v_mfma_f32_16x16x32_bf16 v[164:167], a[216:219], v[172:175], v[164:167]
    v_mfma_f32_16x16x32_bf16 v[168:171], v[232:235], v[172:175], v[168:171]
    v_mfma_f32_16x16x32_bf16 v[156:159], a[60:63], v[172:175], v[156:159]
    v_mfma_f32_16x16x32_bf16 v[160:163], a[140:143], v[172:175], v[160:163]
    v_mfma_f32_16x16x32_bf16 v[164:167], a[220:223], v[172:175], v[164:167]
    v_mfma_f32_16x16x32_bf16 v[168:171], v[236:239], v[172:175], v[168:171]
    s_barrier
    ds_read_b64_tr_b16 a[64:65], v12 offset:0
    ds_read_b64_tr_b16 a[66:67], v12 offset:8704
    ds_read_b64_tr_b16 a[68:69], v12 offset:17408
    ds_read_b64_tr_b16 a[70:71], v12 offset:26112
    ds_read_b64_tr_b16 a[144:145], v13 offset:0
    ds_read_b64_tr_b16 a[146:147], v13 offset:8704
    ds_read_b64_tr_b16 a[148:149], v13 offset:17408
    ds_read_b64_tr_b16 a[150:151], v13 offset:26112
    ds_read_b64_tr_b16 a[224:225], v14 offset:0
    ds_read_b64_tr_b16 a[226:227], v14 offset:8704
    ds_read_b64_tr_b16 a[228:229], v14 offset:17408
    ds_read_b64_tr_b16 a[230:231], v14 offset:26112
    ds_read_b64_tr_b16 v[240:241], v15 offset:0
    ds_read_b64_tr_b16 v[242:243], v15 offset:8704
    ds_read_b64_tr_b16 v[244:245], v15 offset:17408
    ds_read_b64_tr_b16 v[246:247], v15 offset:26112
    s_waitcnt vmcnt(0)
    ds_write_b128 v153, v[56:59] offset:34816
    ds_write_b128 v153, v[60:63] offset:39168
    ds_write_b128 v153, v[64:67] offset:43520
    ds_write_b128 v153, v[68:71] offset:47872
    ds_write_b128 v153, v[72:75] offset:52224
    ds_write_b128 v153, v[76:79] offset:56576
    ds_write_b128 v153, v[80:83] offset:60928
    ds_write_b128 v153, v[84:87] offset:65280
    s_waitcnt lgkmcnt(0)
    v_mfma_f32_16x16x32_bf16 v[156:159], a[64:67], v[172:175], v[156:159]
    v_mfma_f32_16x16x32_bf16 v[160:163], a[144:147], v[172:175], v[160:163]
    v_mfma_f32_16x16x32_bf16 v[164:167], a[224:227], v[172:175], v[164:167]
    v_mfma_f32_16x16x32_bf16 v[168:171], v[240:243], v[172:175], v[168:171]
    v_mfma_f32_16x16x32_bf16 v[156:159], a[68:71], v[172:175], v[156:159]
    v_mfma_f32_16x16x32_bf16 v[160:163], a[148:151], v[172:175], v[160:163]
    v_mfma_f32_16x16x32_bf16 v[164:167], a[228:231], v[172:175], v[164:167]
    v_mfma_f32_16x16x32_bf16 v[168:171], v[244:247], v[172:175], v[168:171]
    s_barrier
    ds_read_b64_tr_b16 a[72:73], v12 offset:34816
    ds_read_b64_tr_b16 a[74:75], v12 offset:43520
    ds_read_b64_tr_b16 a[76:77], v12 offset:52224
    ds_read_b64_tr_b16 a[78:79], v12 offset:60928
    ds_read_b64_tr_b16 a[152:153], v13 offset:34816
    ds_read_b64_tr_b16 a[154:155], v13 offset:43520
    ds_read_b64_tr_b16 a[156:157], v13 offset:52224
    ds_read_b64_tr_b16 a[158:159], v13 offset:60928
    ds_read_b64_tr_b16 a[232:233], v14 offset:34816
    ds_read_b64_tr_b16 a[234:235], v14 offset:43520
    ds_read_b64_tr_b16 a[236:237], v14 offset:52224
    ds_read_b64_tr_b16 a[238:239], v14 offset:60928
    ds_read_b64_tr_b16 v[248:249], v15 offset:34816
    ds_read_b64_tr_b16 v[250:251], v15 offset:43520
    ds_read_b64_tr_b16 v[252:253], v15 offset:52224
    ds_read_b64_tr_b16 v[254:255], v15 offset:60928
    s_cmp_eq_u32 s2, 255
    s_cbranch_scc0 interleave_layers__linear_attn_block__memory_aug_recurrent_mem_tr__prompt_kernel_fb2
    s_cmp_eq_u32 s92, 0
    s_cbranch_scc0 interleave_layers__linear_attn_block__memory_aug_recurrent_mem_tr__prompt_kernel_fb2
    s_waitcnt vmcnt(0)
    s_lshl_b32 s24, s3, 9
    s_add_u32 s24, s24, 118423552
    v_mov_b32 v154, 0
    s_lshl_b32 s27, s3, 3
    s_add_u32 s27, s27, 131072
    s_barrier
    s_mov_b32 s25, -1
    s_mov_b64 exec, 1
    v_mov_b32 v155, 0
    s_memtime s[28:29]
    s_waitcnt lgkmcnt(0)
    buffer_atomic_add v155, v154, s[8:11], s24 offen offset:0 sc0
    s_waitcnt vmcnt(0)
    s_memtime s[30:31]
    s_waitcnt lgkmcnt(0)
    s_sub_u32 s30, s30, s28
    s_min_u32 s25, s25, s30
    v_mov_b32 v155, 0
    s_memtime s[28:29]
    s_waitcnt lgkmcnt(0)
    buffer_atomic_add v155, v154, s[8:11], s24 offen offset:128 sc0
    s_waitcnt vmcnt(0)
    s_memtime s[30:31]
    s_waitcnt lgkmcnt(0)
    s_sub_u32 s30, s30, s28
    s_min_u32 s25, s25, s30
    v_mov_b32 v155, 0
    s_memtime s[28:29]
    s_waitcnt lgkmcnt(0)
    buffer_atomic_add v155, v154, s[8:11], s24 offen offset:256 sc0
    s_waitcnt vmcnt(0)
    s_memtime s[30:31]
    s_waitcnt lgkmcnt(0)
    s_sub_u32 s30, s30, s28
    s_min_u32 s25, s25, s30
    v_mov_b32 v148, s27
    v_mov_b32 v155, s25
    ds_write_b32 v148, v155 offset:0
    s_mov_b64 exec, -1
    s_add_u32 s24, s24, 0x2000
    s_barrier
    s_mov_b32 s25, -1
    s_mov_b64 exec, 1
    v_mov_b32 v155, 0
    s_memtime s[28:29]
    s_waitcnt lgkmcnt(0)
    buffer_atomic_add v155, v154, s[8:11], s24 offen offset:0 sc0
    s_waitcnt vmcnt(0)
    s_memtime s[30:31]
    s_waitcnt lgkmcnt(0)
    s_sub_u32 s30, s30, s28
    s_min_u32 s25, s25, s30
    v_mov_b32 v155, 0
    s_memtime s[28:29]
    s_waitcnt lgkmcnt(0)
    buffer_atomic_add v155, v154, s[8:11], s24 offen offset:128 sc0
    s_waitcnt vmcnt(0)
    s_memtime s[30:31]
    s_waitcnt lgkmcnt(0)
    s_sub_u32 s30, s30, s28
    s_min_u32 s25, s25, s30
    v_mov_b32 v155, 0
    s_memtime s[28:29]
    s_waitcnt lgkmcnt(0)
    buffer_atomic_add v155, v154, s[8:11], s24 offen offset:256 sc0
    s_waitcnt vmcnt(0)
    s_memtime s[30:31]
    s_waitcnt lgkmcnt(0)
    s_sub_u32 s30, s30, s28
    s_min_u32 s25, s25, s30
    v_mov_b32 v148, s27
    v_mov_b32 v155, s25
    ds_write_b32 v148, v155 offset:4
    s_mov_b64 exec, -1
    s_add_u32 s24, s24, 0x2000
    s_waitcnt lgkmcnt(0)
    s_barrier
    v_mov_b32 v154, 131072
    ds_read_b128 v[148:151], v154
    ds_read_b128 v[152:155], v154 offset:16
    s_waitcnt lgkmcnt(0)
    v_min_u32 v148, v148, v152
    v_min_u32 v149, v149, v153
    v_min_u32 v150, v150, v154
    v_min_u32 v151, v151, v155
    v_min_u32 v148, v148, v150
    v_min_u32 v149, v149, v151
    v_cmp_lt_u32 vcc, v149, v148
    s_nop 1
    v_cndmask_b32 v155, 1, 2, vcc
    s_cmp_eq_u32 s3, 0
    s_cbranch_scc0 interleave_layers__linear_attn_block__memory_aug_recurrent_mem_tr__prompt_kernel_fb2
    v_mov_b32 v154, 2146435072
    v_cmp_eq_u32 vcc, 0, v1
    s_nop 1
    v_cndmask_b32 v154, v154, 0, vcc
    buffer_store_dword v155, v154, s[72:75], 0 offen sc1
interleave_layers__linear_attn_block__memory_aug_recurrent_mem_tr__prompt_kernel_fb2:
    v_lshlrev_b32 v7, 4, v1
    s_lshr_b32 s24, s3, 1
    s_mul_i32 s24, s24, 20
    s_and_b32 s25, s3, 1
    s_mul_i32 s25, s25, 10
    s_add_u32 s24, s24, s25
    s_lshl_b32 s24, s24, 10
    v_add_u32 v6, s24, v7
    s_lshr_b32 s24, s3, 1
    s_lshl_b32 s24, s24, 8
    s_and_b32 s25, s3, 1
    s_lshl_b32 s25, s25, 3
    s_add_u32 s24, s24, s25
    s_add_u32 s24, s24, 51712
    v_lshlrev_b32 v9, 4, v2
    v_add_u32 v8, s24, v9
    v_add_u32 v9, 51712, v9
    v_mul_u32_u24 v10, 336, v2
    v_lshl_add_u32 v10, v3, 3, v10
    v_add_u32 v10, 40960, v10
    v_lshrrev_b32 v11, 2, v2
    v_lshl_add_u32 v11, v3, 3, v11
    v_mul_u32_u24 v11, 336, v11
    v_and_b32 v15, 3, v2
    v_lshl_add_u32 v11, v15, 3, v11
    s_lshl_b32 s24, s3, 5
    s_add_u32 s24, s24, 40960
    v_add_u32 v11, s24, v11
    s_lshl_b32 s24, s3, 10
    v_add_u32 v12, s24, v7
    v_lshlrev_b32 v15, 3, v1
    v_add_u32 v15, 2048, v15
    s_cmp_eq_u32 s3, 2
    s_cselect_b64 vcc, -1, 0
    v_cndmask_b32 v12, v12, v15, vcc
    s_mul_i32 s24, s44, 2560
    s_add_u32 s24, s24, 12582912
    v_add_u32 v12, s24, v12
    s_mov_b32 s52, 0x3fb8aa3b
    s_mov_b32 s53, s52
    s_mov_b32 s54, 0x358637bd
    s_mov_b32 s55, s54
    v_mov_b32 v120, 0
    v_mov_b32 v121, 0
    v_mov_b32 v122, 0
    v_mov_b32 v123, 0
    v_mov_b32 v124, 0
    v_mov_b32 v125, 0
    v_mov_b32 v126, 0
    v_mov_b32 v127, 0
    v_mov_b32 v128, 0
    v_mov_b32 v129, 0
    v_mov_b32 v130, 0
    v_mov_b32 v131, 0
    v_mov_b32 v132, 0
    v_mov_b32 v133, 0
    v_mov_b32 v134, 0
    v_mov_b32 v135, 0
    v_mov_b32 v136, 0
    v_mov_b32 v137, 0
    v_mov_b32 v138, 0
    v_mov_b32 v139, 0
    v_mov_b32 v140, 0
    v_mov_b32 v141, 0
    v_mov_b32 v142, 0
    v_mov_b32 v143, 0
    s_waitcnt lgkmcnt(0)
    v_mfma_f32_16x16x32_bf16 v[156:159], a[72:75], v[172:175], v[156:159]
    v_mfma_f32_16x16x32_bf16 v[160:163], a[152:155], v[172:175], v[160:163]
    v_mfma_f32_16x16x32_bf16 v[164:167], a[232:235], v[172:175], v[164:167]
    v_mfma_f32_16x16x32_bf16 v[168:171], v[248:251], v[172:175], v[168:171]
    v_mfma_f32_16x16x32_bf16 v[156:159], a[76:79], v[172:175], v[156:159]
    v_mfma_f32_16x16x32_bf16 v[160:163], a[156:159], v[172:175], v[160:163]
    v_mfma_f32_16x16x32_bf16 v[164:167], a[236:239], v[172:175], v[164:167]
    v_mfma_f32_16x16x32_bf16 v[168:171], v[252:255], v[172:175], v[168:171]
    s_mov_b32 s56, 1
interleave_layers__linear_attn_block__memory_aug_recurrent_mem_tr__prompt_kernel_k1_seg:
    s_cmp_eq_u32 s51, 1
    s_cbranch_scc1 interleave_layers__linear_attn_block__memory_aug_recurrent_mem_tr__prompt_kernel_k13
    s_and_b32 s24, s48, 3
    s_lshl_b32 s24, s24, 7
    s_add_u32 s24, s24, 23107584
    v_lshlrev_b32 v15, 2, v1
    v_add_u32 v15, s24, v15
    s_lshr_b32 s95, s48, 2
    s_add_u32 s95, s95, 1
    s_mov_b32 s61, 0
interleave_layers__linear_attn_block__memory_aug_recurrent_mem_tr__prompt_kernel_k1_wx:
    buffer_load_dword v14, v15, s[8:11], 0 offen sc1
    s_waitcnt vmcnt(0)
    v_cmp_le_i32 vcc, s95, v14
    s_mov_b32 s25, 0xfffff
    s_and_b32 s24, vcc_lo, s25
    s_cmp_eq_u32 s24, s25
    s_cbranch_scc1 interleave_layers__linear_attn_block__memory_aug_recurrent_mem_tr__prompt_kernel_k1_wx_ok
    s_add_u32 s61, s61, 1
    s_cmp_ge_u32 s61, s60
    s_cbranch_scc1 interleave_layers__linear_attn_block__memory_aug_recurrent_mem_tr__prompt_kernel_k1_wx_to
    s_sleep 4
    s_branch interleave_layers__linear_attn_block__memory_aug_recurrent_mem_tr__prompt_kernel_k1_wx
interleave_layers__linear_attn_block__memory_aug_recurrent_mem_tr__prompt_kernel_k1_wx_to:
    s_mov_b32 s60, 1
interleave_layers__linear_attn_block__memory_aug_recurrent_mem_tr__prompt_kernel_k1_wx_ok:
    s_mov_b32 s41, s43
    s_mov_b32 s24, s41
    buffer_load_dwordx4 v[16:19], v4, s[16:19], s24 offen sc1
    s_add_u32 s24, s24, s46
    buffer_load_dwordx4 v[20:23], v4, s[16:19], s24 offen sc1
    s_add_u32 s24, s24, s46
    buffer_load_dwordx4 v[24:27], v4, s[16:19], s24 offen sc1
    s_add_u32 s24, s24, s46
    buffer_load_dwordx4 v[28:31], v4, s[16:19], s24 offen sc1
    s_add_u32 s24, s24, s46
    buffer_load_dwordx4 v[32:35], v4, s[16:19], s24 offen sc1
    s_add_u32 s24, s24, s46
    buffer_load_dwordx4 v[36:39], v4, s[16:19], s24 offen sc1
    s_add_u32 s24, s24, s46
    buffer_load_dwordx4 v[40:43], v4, s[16:19], s24 offen sc1
    s_add_u32 s24, s24, s46
    buffer_load_dwordx4 v[44:47], v4, s[16:19], s24 offen sc1
    s_add_u32 s24, s24, s46
    buffer_load_dwordx4 v[48:51], v4, s[16:19], s24 offen sc1
    s_add_u32 s24, s24, s46
    buffer_load_dwordx4 v[52:55], v4, s[16:19], s24 offen sc1
    s_mul_i32 s24, s49, 1
    s_add_u32 s24, s24, s48
    s_and_b32 s24, s24, 3
    s_lshl_b32 s24, s24, 7
    s_add_u32 s24, s24, 23107584
    v_lshlrev_b32 v15, 2, v1
    v_add_u32 v15, s24, v15
    buffer_load_dword v13, v15, s[8:11], 0 offen sc1
interleave_layers__linear_attn_block__memory_aug_recurrent_mem_tr__prompt_kernel_k13:
    s_cmp_eq_u32 s92, 0
    s_cselect_b32 s24, s56, 0
    s_cmp_eq_u32 s24, 1
    s_cbranch_scc1 interleave_layers__linear_attn_block__memory_aug_recurrent_mem_tr__prompt_kernel_k1w4
    s_waitcnt vmcnt(0)
interleave_layers__linear_attn_block__memory_aug_recurrent_mem_tr__prompt_kernel_k1w4:
    s_mov_b32 s56, 0
    v_mov_b32 v148, 0
    v_mov_b32 v149, 0
    v_mov_b32 v150, 0
    v_mov_b32 v151, 0
    v_dot2c_f32_bf16 v148, v16, v172
    v_dot2c_f32_bf16 v149, v16, v16
    v_dot2c_f32_bf16 v150, v17, v172
    v_dot2c_f32_bf16 v151, v17, v17
    v_dot2c_f32_bf16 v148, v18, v172
    v_dot2c_f32_bf16 v149, v18, v18
    v_dot2c_f32_bf16 v150, v19, v172
    v_dot2c_f32_bf16 v151, v19, v19
    v_dot2c_f32_bf16 v148, v20, v172
    v_dot2c_f32_bf16 v149, v20, v20
    v_dot2c_f32_bf16 v150, v21, v172
    v_dot2c_f32_bf16 v151, v21, v21
    v_dot2c_f32_bf16 v148, v22, v172
    v_dot2c_f32_bf16 v149, v22, v22
    v_dot2c_f32_bf16 v150, v23, v172
    v_dot2c_f32_bf16 v151, v23, v23
    v_dot2c_f32_bf16 v148, v24, v172
    v_dot2c_f32_bf16 v149, v24, v24
    v_dot2c_f32_bf16 v150, v25, v172
    v_dot2c_f32_bf16 v151, v25, v25
    v_dot2c_f32_bf16 v148, v26, v172
    v_dot2c_f32_bf16 v149, v26, v26
    v_dot2c_f32_bf16 v150, v27, v172
    v_dot2c_f32_bf16 v151, v27, v27
    v_dot2c_f32_bf16 v148, v28, v172
    v_dot2c_f32_bf16 v149, v28, v28
    v_dot2c_f32_bf16 v150, v29, v172
    v_dot2c_f32_bf16 v151, v29, v29
    v_dot2c_f32_bf16 v148, v30, v172
    v_dot2c_f32_bf16 v149, v30, v30
    v_dot2c_f32_bf16 v150, v31, v172
    v_dot2c_f32_bf16 v151, v31, v31
    v_dot2c_f32_bf16 v148, v32, v172
    v_dot2c_f32_bf16 v149, v32, v32
    v_dot2c_f32_bf16 v150, v33, v172
    v_dot2c_f32_bf16 v151, v33, v33
    v_dot2c_f32_bf16 v148, v34, v172
    v_dot2c_f32_bf16 v149, v34, v34
    v_dot2c_f32_bf16 v150, v35, v172
    v_dot2c_f32_bf16 v151, v35, v35
    v_dot2c_f32_bf16 v148, v36, v172
    v_dot2c_f32_bf16 v149, v36, v36
    v_dot2c_f32_bf16 v150, v37, v172
    v_dot2c_f32_bf16 v151, v37, v37
    v_dot2c_f32_bf16 v148, v38, v172
    v_dot2c_f32_bf16 v149, v38, v38
    v_dot2c_f32_bf16 v150, v39, v172
    v_dot2c_f32_bf16 v151, v39, v39
    v_dot2c_f32_bf16 v148, v40, v172
    v_dot2c_f32_bf16 v149, v40, v40
    v_dot2c_f32_bf16 v150, v41, v172
    v_dot2c_f32_bf16 v151, v41, v41
    v_dot2c_f32_bf16 v148, v42, v172
    v_dot2c_f32_bf16 v149, v42, v42
    v_dot2c_f32_bf16 v150, v43, v172
    v_dot2c_f32_bf16 v151, v43, v43
    v_dot2c_f32_bf16 v148, v44, v172
    v_dot2c_f32_bf16 v149, v44, v44
    v_dot2c_f32_bf16 v150, v45, v172
    v_dot2c_f32_bf16 v151, v45, v45
    v_dot2c_f32_bf16 v148, v46, v172
    v_dot2c_f32_bf16 v149, v46, v46
    v_dot2c_f32_bf16 v150, v47, v172
    v_dot2c_f32_bf16 v151, v47, v47
    v_dot2c_f32_bf16 v148, v48, v172
    v_dot2c_f32_bf16 v149, v48, v48
    v_dot2c_f32_bf16 v150, v49, v172
    v_dot2c_f32_bf16 v151, v49, v49
    v_dot2c_f32_bf16 v148, v50, v172
    v_dot2c_f32_bf16 v149, v50, v50
    v_dot2c_f32_bf16 v150, v51, v172
    v_dot2c_f32_bf16 v151, v51, v51
    v_dot2c_f32_bf16 v148, v52, v172
    v_dot2c_f32_bf16 v149, v52, v52
    v_dot2c_f32_bf16 v150, v53, v172
    v_dot2c_f32_bf16 v151, v53, v53
    v_dot2c_f32_bf16 v148, v54, v172
    v_dot2c_f32_bf16 v149, v54, v54
    v_dot2c_f32_bf16 v150, v55, v172
    v_dot2c_f32_bf16 v151, v55, v55
    s_nop 1
    v_add_f32 v148, v148, v150
    v_add_f32 v149, v149, v151
    v_mov_b32 v150, v148
    v_mov_b32 v151, v149
    s_nop 0
    v_permlane16_swap_b32 v148, v150
    v_permlane16_swap_b32 v149, v151
    v_add_f32 v148, v148, v150
    v_add_f32 v149, v149, v151
    v_mov_b32 v150, v148
    v_mov_b32 v151, v149
    s_nop 0
    v_permlane32_swap_b32 v148, v150
    v_permlane32_swap_b32 v149, v151
    v_add_f32 v148, v148, v150
    v_add_f32 v149, v149, v151
    ds_write_b128 v6, v[16:19] offset:0
    ds_write_b128 v6, v[20:23] offset:1024
    ds_write_b128 v6, v[24:27] offset:2048
    ds_write_b128 v6, v[28:31] offset:3072
    ds_write_b128 v6, v[32:35] offset:4096
    ds_write_b128 v6, v[36:39] offset:5120
    ds_write_b128 v6, v[40:43] offset:6144
    ds_write_b128 v6, v[44:47] offset:7168
    ds_write_b128 v6, v[48:51] offset:8192
    ds_write_b128 v6, v[52:55] offset:9216
    ds_write_b64 v8, v[148:149]
    s_mov_b32 s51, 0
    s_waitcnt lgkmcnt(0)
    s_cmp_gt_u32 s40, 1
    s_cbranch_scc0 interleave_layers__linear_attn_block__memory_aug_recurrent_mem_tr__prompt_kernel_k15
    s_cmp_eq_u32 s92, 0
    s_cbranch_scc1 interleave_layers__linear_attn_block__memory_aug_recurrent_mem_tr__prompt_kernel_k16
    s_add_u32 s24, s48, s49
    s_lshr_b32 s24, s24, 2
    s_add_u32 s24, s24, 1
    v_cmp_le_i32 vcc, s24, v13
    s_and_b32 s24, vcc_lo, 0xfffff
    s_cmp_eq_u32 s24, 0xfffff
    s_cbranch_scc0 interleave_layers__linear_attn_block__memory_aug_recurrent_mem_tr__prompt_kernel_k15
    s_add_u32 s41, s43, s42
    s_mov_b32 s24, s41
    buffer_load_dwordx4 v[16:19], v4, s[16:19], s24 offen sc1
    s_add_u32 s24, s24, s46
    buffer_load_dwordx4 v[20:23], v4, s[16:19], s24 offen sc1
    s_add_u32 s24, s24, s46
    buffer_load_dwordx4 v[24:27], v4, s[16:19], s24 offen sc1
    s_add_u32 s24, s24, s46
    buffer_load_dwordx4 v[28:31], v4, s[16:19], s24 offen sc1
    s_add_u32 s24, s24, s46
    buffer_load_dwordx4 v[32:35], v4, s[16:19], s24 offen sc1
    s_add_u32 s24, s24, s46
    buffer_load_dwordx4 v[36:39], v4, s[16:19], s24 offen sc1
    s_add_u32 s24, s24, s46
    buffer_load_dwordx4 v[40:43], v4, s[16:19], s24 offen sc1
    s_add_u32 s24, s24, s46
    buffer_load_dwordx4 v[44:47], v4, s[16:19], s24 offen sc1
    s_add_u32 s24, s24, s46
    buffer_load_dwordx4 v[48:51], v4, s[16:19], s24 offen sc1
    s_add_u32 s24, s24, s46
    buffer_load_dwordx4 v[52:55], v4, s[16:19], s24 offen sc1
    s_mov_b32 s51, 1
    s_mul_i32 s24, s49, 2
    s_add_u32 s24, s24, s48
    s_and_b32 s24, s24, 3
    s_lshl_b32 s24, s24, 7
    s_add_u32 s24, s24, 23107584
    v_lshlrev_b32 v15, 2, v1
    v_add_u32 v15, s24, v15
    buffer_load_dword v13, v15, s[8:11], 0 offen sc1
    s_branch interleave_layers__linear_attn_block__memory_aug_recurrent_mem_tr__prompt_kernel_k15
interleave_layers__linear_attn_block__memory_aug_recurrent_mem_tr__prompt_kernel_k16:
    s_add_u32 s41, s43, s42
    s_mov_b32 s24, s41
    buffer_load_dwordx2 v[16:17], v4, s[16:19], s24 offen
    buffer_load_dwordx2 v[18:19], v5, s[16:19], s24 offen
    s_add_u32 s24, s24, s46
    buffer_load_dwordx2 v[20:21], v4, s[16:19], s24 offen
    buffer_load_dwordx2 v[22:23], v5, s[16:19], s24 offen
    s_add_u32 s24, s24, s46
    buffer_load_dwordx2 v[24:25], v4, s[16:19], s24 offen
    buffer_load_dwordx2 v[26:27], v5, s[16:19], s24 offen
    s_add_u32 s24, s24, s46
    buffer_load_dwordx2 v[28:29], v4, s[16:19], s24 offen
    buffer_load_dwordx2 v[30:31], v5, s[16:19], s24 offen
    s_add_u32 s24, s24, s46
    buffer_load_dwordx2 v[32:33], v4, s[16:19], s24 offen
    buffer_load_dwordx2 v[34:35], v5, s[16:19], s24 offen
    s_add_u32 s24, s24, s46
    buffer_load_dwordx2 v[36:37], v4, s[16:19], s24 offen
    buffer_load_dwordx2 v[38:39], v5, s[16:19], s24 offen
    s_add_u32 s24, s24, s46
    buffer_load_dwordx2 v[40:41], v4, s[16:19], s24 offen
    buffer_load_dwordx2 v[42:43], v5, s[16:19], s24 offen
    s_add_u32 s24, s24, s46
    buffer_load_dwordx2 v[44:45], v4, s[16:19], s24 offen
    buffer_load_dwordx2 v[46:47], v5, s[16:19], s24 offen
    s_add_u32 s24, s24, s46
    buffer_load_dwordx2 v[48:49], v4, s[16:19], s24 offen
    buffer_load_dwordx2 v[50:51], v5, s[16:19], s24 offen
    s_add_u32 s24, s24, s46
    buffer_load_dwordx2 v[52:53], v4, s[16:19], s24 offen
    buffer_load_dwordx2 v[54:55], v5, s[16:19], s24 offen
    s_mov_b32 s51, 1
interleave_layers__linear_attn_block__memory_aug_recurrent_mem_tr__prompt_kernel_k15:
    s_barrier
    ds_read_b128 v[148:151], v9
    ds_read_b128 v[152:155], v9 offset:256
    ds_read_b128 v[56:59], v7 offset:0
    ds_read_b128 v[60:63], v7 offset:20480
    ds_read_b128 v[64:67], v7 offset:1024
    ds_read_b128 v[68:71], v7 offset:21504
    ds_read_b128 v[72:75], v7 offset:2048
    ds_read_b128 v[76:79], v7 offset:22528
    s_waitcnt lgkmcnt(6)
    v_add_f32 v148, v148, v150
    v_add_f32 v149, v149, v151
    v_mul_f32 v148, 0x3acccccd, v148
    v_mul_f32 v150, v148, v148
    v_mov_b32 v151, 0x3acccccd
    v_fma_f32 v149, v149, v151, -v150
    v_max_f32 v149, 0, v149
    v_add_f32 v149, 0x3727c5ac, v149
    v_rsq_f32 v144, v149
    s_nop 0
    v_mul_f32 v145, v148, v144
    v_sub_f32 v145, 0, v145
    v_add_f32 v152, v152, v154
    v_add_f32 v153, v153, v155
    v_mul_f32 v152, 0x3acccccd, v152
    v_mul_f32 v154, v152, v152
    v_mov_b32 v155, 0x3acccccd
    v_fma_f32 v153, v153, v155, -v154
    v_max_f32 v153, 0, v153
    v_add_f32 v153, 0x3727c5ac, v153
    v_rsq_f32 v146, v153
    s_nop 0
    v_mul_f32 v147, v152, v146
    v_sub_f32 v147, 0, v147
    ds_read_b128 v[80:83], v7 offset:3072
    ds_read_b128 v[84:87], v7 offset:23552
    s_waitcnt lgkmcnt(6)
    v_mfma_f32_16x16x32_bf16 v[88:91], a[0:3], v[56:59], 0
    v_mfma_f32_16x16x32_bf16 v[96:99], a[80:83], v[56:59], 0
    v_mfma_f32_16x16x32_bf16 v[104:107], a[160:163], v[56:59], 0
    v_mfma_f32_16x16x32_bf16 v[112:115], v[176:179], v[56:59], 0
    v_mfma_f32_16x16x32_bf16 v[92:95], a[0:3], v[60:63], 0
    v_mfma_f32_16x16x32_bf16 v[100:103], a[80:83], v[60:63], 0
    v_mfma_f32_16x16x32_bf16 v[108:111], a[160:163], v[60:63], 0
    v_mfma_f32_16x16x32_bf16 v[116:119], v[176:179], v[60:63], 0
    ds_read_b128 v[56:59], v7 offset:4096
    ds_read_b128 v[60:63], v7 offset:24576
    s_waitcnt lgkmcnt(6)
    v_mfma_f32_16x16x32_bf16 v[88:91], a[4:7], v[64:67], v[88:91]
    v_mfma_f32_16x16x32_bf16 v[96:99], a[84:87], v[64:67], v[96:99]
    v_mfma_f32_16x16x32_bf16 v[104:107], a[164:167], v[64:67], v[104:107]
    v_mfma_f32_16x16x32_bf16 v[112:115], v[180:183], v[64:67], v[112:115]
    v_mfma_f32_16x16x32_bf16 v[92:95], a[4:7], v[68:71], v[92:95]
    v_mfma_f32_16x16x32_bf16 v[100:103], a[84:87], v[68:71], v[100:103]
    v_mfma_f32_16x16x32_bf16 v[108:111], a[164:167], v[68:71], v[108:111]
    v_mfma_f32_16x16x32_bf16 v[116:119], v[180:183], v[68:71], v[116:119]
    ds_read_b128 v[64:67], v7 offset:5120
    ds_read_b128 v[68:71], v7 offset:25600
    s_waitcnt lgkmcnt(6)
    v_mfma_f32_16x16x32_bf16 v[88:91], a[8:11], v[72:75], v[88:91]
    v_mfma_f32_16x16x32_bf16 v[96:99], a[88:91], v[72:75], v[96:99]
    v_mfma_f32_16x16x32_bf16 v[104:107], a[168:171], v[72:75], v[104:107]
    v_mfma_f32_16x16x32_bf16 v[112:115], v[184:187], v[72:75], v[112:115]
    v_mfma_f32_16x16x32_bf16 v[92:95], a[8:11], v[76:79], v[92:95]
    v_mfma_f32_16x16x32_bf16 v[100:103], a[88:91], v[76:79], v[100:103]
    v_mfma_f32_16x16x32_bf16 v[108:111], a[168:171], v[76:79], v[108:111]
    v_mfma_f32_16x16x32_bf16 v[116:119], v[184:187], v[76:79], v[116:119]
    ds_read_b128 v[72:75], v7 offset:6144
    ds_read_b128 v[76:79], v7 offset:26624
    s_waitcnt lgkmcnt(6)
    v_mfma_f32_16x16x32_bf16 v[88:91], a[12:15], v[80:83], v[88:91]
    v_mfma_f32_16x16x32_bf16 v[96:99], a[92:95], v[80:83], v[96:99]
    v_mfma_f32_16x16x32_bf16 v[104:107], a[172:175], v[80:83], v[104:107]
    v_mfma_f32_16x16x32_bf16 v[112:115], v[188:191], v[80:83], v[112:115]
    v_mfma_f32_16x16x32_bf16 v[92:95], a[12:15], v[84:87], v[92:95]
    v_mfma_f32_16x16x32_bf16 v[100:103], a[92:95], v[84:87], v[100:103]
    v_mfma_f32_16x16x32_bf16 v[108:111], a[172:175], v[84:87], v[108:111]
    v_mfma_f32_16x16x32_bf16 v[116:119], v[188:191], v[84:87], v[116:119]
    ds_read_b128 v[80:83], v7 offset:7168
    ds_read_b128 v[84:87], v7 offset:27648
    s_waitcnt lgkmcnt(6)
    v_mfma_f32_16x16x32_bf16 v[88:91], a[16:19], v[56:59], v[88:91]
    v_mfma_f32_16x16x32_bf16 v[96:99], a[96:99], v[56:59], v[96:99]
    v_mfma_f32_16x16x32_bf16 v[104:107], a[176:179], v[56:59], v[104:107]
    v_mfma_f32_16x16x32_bf16 v[112:115], v[192:195], v[56:59], v[112:115]
    v_mfma_f32_16x16x32_bf16 v[92:95], a[16:19], v[60:63], v[92:95]
    v_mfma_f32_16x16x32_bf16 v[100:103], a[96:99], v[60:63], v[100:103]
    v_mfma_f32_16x16x32_bf16 v[108:111], a[176:179], v[60:63], v[108:111]
    v_mfma_f32_16x16x32_bf16 v[116:119], v[192:195], v[60:63], v[116:119]
    ds_read_b128 v[56:59], v7 offset:8192
    ds_read_b128 v[60:63], v7 offset:28672
    s_waitcnt lgkmcnt(6)
    v_mfma_f32_16x16x32_bf16 v[88:91], a[20:23], v[64:67], v[88:91]
    v_mfma_f32_16x16x32_bf16 v[96:99], a[100:103], v[64:67], v[96:99]
    v_mfma_f32_16x16x32_bf16 v[104:107], a[180:183], v[64:67], v[104:107]
    v_mfma_f32_16x16x32_bf16 v[112:115], v[196:199], v[64:67], v[112:115]
    v_mfma_f32_16x16x32_bf16 v[92:95], a[20:23], v[68:71], v[92:95]
    v_mfma_f32_16x16x32_bf16 v[100:103], a[100:103], v[68:71], v[100:103]
    v_mfma_f32_16x16x32_bf16 v[108:111], a[180:183], v[68:71], v[108:111]
    v_mfma_f32_16x16x32_bf16 v[116:119], v[196:199], v[68:71], v[116:119]
    ds_read_b128 v[64:67], v7 offset:9216
    ds_read_b128 v[68:71], v7 offset:29696
    s_waitcnt lgkmcnt(6)
    v_mfma_f32_16x16x32_bf16 v[88:91], a[24:27], v[72:75], v[88:91]
    v_mfma_f32_16x16x32_bf16 v[96:99], a[104:107], v[72:75], v[96:99]
    v_mfma_f32_16x16x32_bf16 v[104:107], a[184:187], v[72:75], v[104:107]
    v_mfma_f32_16x16x32_bf16 v[112:115], v[200:203], v[72:75], v[112:115]
    v_mfma_f32_16x16x32_bf16 v[92:95], a[24:27], v[76:79], v[92:95]
    v_mfma_f32_16x16x32_bf16 v[100:103], a[104:107], v[76:79], v[100:103]
    v_mfma_f32_16x16x32_bf16 v[108:111], a[184:187], v[76:79], v[108:111]
    v_mfma_f32_16x16x32_bf16 v[116:119], v[200:203], v[76:79], v[116:119]
    ds_read_b128 v[72:75], v7 offset:10240
    ds_read_b128 v[76:79], v7 offset:30720
    s_waitcnt lgkmcnt(6)
    v_mfma_f32_16x16x32_bf16 v[88:91], a[28:31], v[80:83], v[88:91]
    v_mfma_f32_16x16x32_bf16 v[96:99], a[108:111], v[80:83], v[96:99]
    v_mfma_f32_16x16x32_bf16 v[104:107], a[188:191], v[80:83], v[104:107]
    v_mfma_f32_16x16x32_bf16 v[112:115], v[204:207], v[80:83], v[112:115]
    v_mfma_f32_16x16x32_bf16 v[92:95], a[28:31], v[84:87], v[92:95]
    v_mfma_f32_16x16x32_bf16 v[100:103], a[108:111], v[84:87], v[100:103]
    v_mfma_f32_16x16x32_bf16 v[108:111], a[188:191], v[84:87], v[108:111]
    v_mfma_f32_16x16x32_bf16 v[116:119], v[204:207], v[84:87], v[116:119]
    ds_read_b128 v[80:83], v7 offset:11264
    ds_read_b128 v[84:87], v7 offset:31744
    s_waitcnt lgkmcnt(6)
    v_mfma_f32_16x16x32_bf16 v[88:91], a[32:35], v[56:59], v[88:91]
    v_mfma_f32_16x16x32_bf16 v[96:99], a[112:115], v[56:59], v[96:99]
    v_mfma_f32_16x16x32_bf16 v[104:107], a[192:195], v[56:59], v[104:107]
    v_mfma_f32_16x16x32_bf16 v[112:115], v[208:211], v[56:59], v[112:115]
    v_mfma_f32_16x16x32_bf16 v[92:95], a[32:35], v[60:63], v[92:95]
    v_mfma_f32_16x16x32_bf16 v[100:103], a[112:115], v[60:63], v[100:103]
    v_mfma_f32_16x16x32_bf16 v[108:111], a[192:195], v[60:63], v[108:111]
    v_mfma_f32_16x16x32_bf16 v[116:119], v[208:211], v[60:63], v[116:119]
    ds_read_b128 v[56:59], v7 offset:12288
    ds_read_b128 v[60:63], v7 offset:32768
    s_waitcnt lgkmcnt(6)
    v_mfma_f32_16x16x32_bf16 v[88:91], a[36:39], v[64:67], v[88:91]
    v_mfma_f32_16x16x32_bf16 v[96:99], a[116:119], v[64:67], v[96:99]
    v_mfma_f32_16x16x32_bf16 v[104:107], a[196:199], v[64:67], v[104:107]
    v_mfma_f32_16x16x32_bf16 v[112:115], v[212:215], v[64:67], v[112:115]
    v_mfma_f32_16x16x32_bf16 v[92:95], a[36:39], v[68:71], v[92:95]
    v_mfma_f32_16x16x32_bf16 v[100:103], a[116:119], v[68:71], v[100:103]
    v_mfma_f32_16x16x32_bf16 v[108:111], a[196:199], v[68:71], v[108:111]
    v_mfma_f32_16x16x32_bf16 v[116:119], v[212:215], v[68:71], v[116:119]
    ds_read_b128 v[64:67], v7 offset:13312
    ds_read_b128 v[68:71], v7 offset:33792
    s_waitcnt lgkmcnt(6)
    v_mfma_f32_16x16x32_bf16 v[88:91], a[40:43], v[72:75], v[88:91]
    v_mfma_f32_16x16x32_bf16 v[96:99], a[120:123], v[72:75], v[96:99]
    v_mfma_f32_16x16x32_bf16 v[104:107], a[200:203], v[72:75], v[104:107]
    v_mfma_f32_16x16x32_bf16 v[112:115], v[216:219], v[72:75], v[112:115]
    v_mfma_f32_16x16x32_bf16 v[92:95], a[40:43], v[76:79], v[92:95]
    v_mfma_f32_16x16x32_bf16 v[100:103], a[120:123], v[76:79], v[100:103]
    v_mfma_f32_16x16x32_bf16 v[108:111], a[200:203], v[76:79], v[108:111]
    v_mfma_f32_16x16x32_bf16 v[116:119], v[216:219], v[76:79], v[116:119]
    ds_read_b128 v[72:75], v7 offset:14336
    ds_read_b128 v[76:79], v7 offset:34816
    s_waitcnt lgkmcnt(6)
    v_mfma_f32_16x16x32_bf16 v[88:91], a[44:47], v[80:83], v[88:91]
    v_mfma_f32_16x16x32_bf16 v[96:99], a[124:127], v[80:83], v[96:99]
    v_mfma_f32_16x16x32_bf16 v[104:107], a[204:207], v[80:83], v[104:107]
    v_mfma_f32_16x16x32_bf16 v[112:115], v[220:223], v[80:83], v[112:115]
    v_mfma_f32_16x16x32_bf16 v[92:95], a[44:47], v[84:87], v[92:95]
    v_mfma_f32_16x16x32_bf16 v[100:103], a[124:127], v[84:87], v[100:103]
    v_mfma_f32_16x16x32_bf16 v[108:111], a[204:207], v[84:87], v[108:111]
    v_mfma_f32_16x16x32_bf16 v[116:119], v[220:223], v[84:87], v[116:119]
    ds_read_b128 v[80:83], v7 offset:15360
    ds_read_b128 v[84:87], v7 offset:35840
    s_waitcnt lgkmcnt(6)
    v_mfma_f32_16x16x32_bf16 v[88:91], a[48:51], v[56:59], v[88:91]
    v_mfma_f32_16x16x32_bf16 v[96:99], a[128:131], v[56:59], v[96:99]
    v_mfma_f32_16x16x32_bf16 v[104:107], a[208:211], v[56:59], v[104:107]
    v_mfma_f32_16x16x32_bf16 v[112:115], v[224:227], v[56:59], v[112:115]
    v_mfma_f32_16x16x32_bf16 v[92:95], a[48:51], v[60:63], v[92:95]
    v_mfma_f32_16x16x32_bf16 v[100:103], a[128:131], v[60:63], v[100:103]
    v_mfma_f32_16x16x32_bf16 v[108:111], a[208:211], v[60:63], v[108:111]
    v_mfma_f32_16x16x32_bf16 v[116:119], v[224:227], v[60:63], v[116:119]
    ds_read_b128 v[56:59], v7 offset:16384
    ds_read_b128 v[60:63], v7 offset:36864
    s_waitcnt lgkmcnt(6)
    v_mfma_f32_16x16x32_bf16 v[88:91], a[52:55], v[64:67], v[88:91]
    v_mfma_f32_16x16x32_bf16 v[96:99], a[132:135], v[64:67], v[96:99]
    v_mfma_f32_16x16x32_bf16 v[104:107], a[212:215], v[64:67], v[104:107]
    v_mfma_f32_16x16x32_bf16 v[112:115], v[228:231], v[64:67], v[112:115]
    v_mfma_f32_16x16x32_bf16 v[92:95], a[52:55], v[68:71], v[92:95]
    v_mfma_f32_16x16x32_bf16 v[100:103], a[132:135], v[68:71], v[100:103]
    v_mfma_f32_16x16x32_bf16 v[108:111], a[212:215], v[68:71], v[108:111]
    v_mfma_f32_16x16x32_bf16 v[116:119], v[228:231], v[68:71], v[116:119]
    ds_read_b128 v[64:67], v7 offset:17408
    ds_read_b128 v[68:71], v7 offset:37888
    s_waitcnt lgkmcnt(6)
    v_mfma_f32_16x16x32_bf16 v[88:91], a[56:59], v[72:75], v[88:91]
    v_mfma_f32_16x16x32_bf16 v[96:99], a[136:139], v[72:75], v[96:99]
    v_mfma_f32_16x16x32_bf16 v[104:107], a[216:219], v[72:75], v[104:107]
    v_mfma_f32_16x16x32_bf16 v[112:115], v[232:235], v[72:75], v[112:115]
    v_mfma_f32_16x16x32_bf16 v[92:95], a[56:59], v[76:79], v[92:95]
    v_mfma_f32_16x16x32_bf16 v[100:103], a[136:139], v[76:79], v[100:103]
    v_mfma_f32_16x16x32_bf16 v[108:111], a[216:219], v[76:79], v[108:111]
    v_mfma_f32_16x16x32_bf16 v[116:119], v[232:235], v[76:79], v[116:119]
    ds_read_b128 v[72:75], v7 offset:18432
    ds_read_b128 v[76:79], v7 offset:38912
    s_waitcnt lgkmcnt(6)
    v_mfma_f32_16x16x32_bf16 v[88:91], a[60:63], v[80:83], v[88:91]
    v_mfma_f32_16x16x32_bf16 v[96:99], a[140:143], v[80:83], v[96:99]
    v_mfma_f32_16x16x32_bf16 v[104:107], a[220:223], v[80:83], v[104:107]
    v_mfma_f32_16x16x32_bf16 v[112:115], v[236:239], v[80:83], v[112:115]
    v_mfma_f32_16x16x32_bf16 v[92:95], a[60:63], v[84:87], v[92:95]
    v_mfma_f32_16x16x32_bf16 v[100:103], a[140:143], v[84:87], v[100:103]
    v_mfma_f32_16x16x32_bf16 v[108:111], a[220:223], v[84:87], v[108:111]
    v_mfma_f32_16x16x32_bf16 v[116:119], v[236:239], v[84:87], v[116:119]
    ds_read_b128 v[80:83], v7 offset:19456
    ds_read_b128 v[84:87], v7 offset:39936
    s_waitcnt lgkmcnt(6)
    v_mfma_f32_16x16x32_bf16 v[88:91], a[64:67], v[56:59], v[88:91]
    v_mfma_f32_16x16x32_bf16 v[96:99], a[144:147], v[56:59], v[96:99]
    v_mfma_f32_16x16x32_bf16 v[104:107], a[224:227], v[56:59], v[104:107]
    v_mfma_f32_16x16x32_bf16 v[112:115], v[240:243], v[56:59], v[112:115]
    v_mfma_f32_16x16x32_bf16 v[92:95], a[64:67], v[60:63], v[92:95]
    v_mfma_f32_16x16x32_bf16 v[100:103], a[144:147], v[60:63], v[100:103]
    v_mfma_f32_16x16x32_bf16 v[108:111], a[224:227], v[60:63], v[108:111]
    v_mfma_f32_16x16x32_bf16 v[116:119], v[240:243], v[60:63], v[116:119]
    s_waitcnt lgkmcnt(4)
    v_mfma_f32_16x16x32_bf16 v[88:91], a[68:71], v[64:67], v[88:91]
    v_mfma_f32_16x16x32_bf16 v[96:99], a[148:151], v[64:67], v[96:99]
    v_mfma_f32_16x16x32_bf16 v[104:107], a[228:231], v[64:67], v[104:107]
    v_mfma_f32_16x16x32_bf16 v[112:115], v[244:247], v[64:67], v[112:115]
    v_mfma_f32_16x16x32_bf16 v[92:95], a[68:71], v[68:71], v[92:95]
    v_mfma_f32_16x16x32_bf16 v[100:103], a[148:151], v[68:71], v[100:103]
    v_mfma_f32_16x16x32_bf16 v[108:111], a[228:231], v[68:71], v[108:111]
    v_mfma_f32_16x16x32_bf16 v[116:119], v[244:247], v[68:71], v[116:119]
    s_waitcnt lgkmcnt(2)
    v_mfma_f32_16x16x32_bf16 v[88:91], a[72:75], v[72:75], v[88:91]
    v_mfma_f32_16x16x32_bf16 v[96:99], a[152:155], v[72:75], v[96:99]
    v_mfma_f32_16x16x32_bf16 v[104:107], a[232:235], v[72:75], v[104:107]
    v_mfma_f32_16x16x32_bf16 v[112:115], v[248:251], v[72:75], v[112:115]
    v_mfma_f32_16x16x32_bf16 v[92:95], a[72:75], v[76:79], v[92:95]
    v_mfma_f32_16x16x32_bf16 v[100:103], a[152:155], v[76:79], v[100:103]
    v_mfma_f32_16x16x32_bf16 v[108:111], a[232:235], v[76:79], v[108:111]
    v_mfma_f32_16x16x32_bf16 v[116:119], v[248:251], v[76:79], v[116:119]
    s_waitcnt lgkmcnt(0)
    v_mfma_f32_16x16x32_bf16 v[88:91], a[76:79], v[80:83], v[88:91]
    v_mfma_f32_16x16x32_bf16 v[96:99], a[156:159], v[80:83], v[96:99]
    v_mfma_f32_16x16x32_bf16 v[104:107], a[236:239], v[80:83], v[104:107]
    v_mfma_f32_16x16x32_bf16 v[112:115], v[252:255], v[80:83], v[112:115]
    v_mfma_f32_16x16x32_bf16 v[92:95], a[76:79], v[84:87], v[92:95]
    v_mfma_f32_16x16x32_bf16 v[100:103], a[156:159], v[84:87], v[100:103]
    v_mfma_f32_16x16x32_bf16 v[108:111], a[236:239], v[84:87], v[108:111]
    v_mfma_f32_16x16x32_bf16 v[116:119], v[252:255], v[84:87], v[116:119]
    v_pk_mul_f32 v[148:149], v[156:157], v[144:145] op_sel:[0,1] op_sel_hi:[1,1]
    v_pk_mul_f32 v[150:151], v[158:159], v[144:145] op_sel:[0,1] op_sel_hi:[1,1]
    v_pk_fma_f32 v[88:89], v[88:89], v[144:145], v[148:149] op_sel:[0,0,0] op_sel_hi:[1,0,1]
    v_pk_fma_f32 v[90:91], v[90:91], v[144:145], v[150:151] op_sel:[0,0,0] op_sel_hi:[1,0,1]
    v_pk_mul_f32 v[148:149], v[156:157], v[146:147] op_sel:[0,1] op_sel_hi:[1,1]
    v_pk_mul_f32 v[150:151], v[158:159], v[146:147] op_sel:[0,1] op_sel_hi:[1,1]
    v_pk_fma_f32 v[92:93], v[92:93], v[146:147], v[148:149] op_sel:[0,0,0] op_sel_hi:[1,0,1]
    v_pk_fma_f32 v[94:95], v[94:95], v[146:147], v[150:151] op_sel:[0,0,0] op_sel_hi:[1,0,1]
    v_pk_mul_f32 v[148:149], v[160:161], v[144:145] op_sel:[0,1] op_sel_hi:[1,1]
    v_pk_mul_f32 v[150:151], v[162:163], v[144:145] op_sel:[0,1] op_sel_hi:[1,1]
    v_pk_fma_f32 v[96:97], v[96:97], v[144:145], v[148:149] op_sel:[0,0,0] op_sel_hi:[1,0,1]
    v_pk_fma_f32 v[98:99], v[98:99], v[144:145], v[150:151] op_sel:[0,0,0] op_sel_hi:[1,0,1]
    v_pk_mul_f32 v[148:149], v[160:161], v[146:147] op_sel:[0,1] op_sel_hi:[1,1]
    v_pk_mul_f32 v[150:151], v[162:163], v[146:147] op_sel:[0,1] op_sel_hi:[1,1]
    v_pk_fma_f32 v[100:101], v[100:101], v[146:147], v[148:149] op_sel:[0,0,0] op_sel_hi:[1,0,1]
    v_pk_fma_f32 v[102:103], v[102:103], v[146:147], v[150:151] op_sel:[0,0,0] op_sel_hi:[1,0,1]
    v_pk_mul_f32 v[148:149], v[164:165], v[144:145] op_sel:[0,1] op_sel_hi:[1,1]
    v_pk_mul_f32 v[150:151], v[166:167], v[144:145] op_sel:[0,1] op_sel_hi:[1,1]
    v_pk_fma_f32 v[104:105], v[104:105], v[144:145], v[148:149] op_sel:[0,0,0] op_sel_hi:[1,0,1]
    v_pk_fma_f32 v[106:107], v[106:107], v[144:145], v[150:151] op_sel:[0,0,0] op_sel_hi:[1,0,1]
    v_pk_mul_f32 v[148:149], v[164:165], v[146:147] op_sel:[0,1] op_sel_hi:[1,1]
    v_pk_mul_f32 v[150:151], v[166:167], v[146:147] op_sel:[0,1] op_sel_hi:[1,1]
    v_pk_fma_f32 v[108:109], v[108:109], v[146:147], v[148:149] op_sel:[0,0,0] op_sel_hi:[1,0,1]
    v_pk_fma_f32 v[110:111], v[110:111], v[146:147], v[150:151] op_sel:[0,0,0] op_sel_hi:[1,0,1]
    v_pk_mul_f32 v[148:149], v[168:169], v[144:145] op_sel:[0,1] op_sel_hi:[1,1]
    v_pk_mul_f32 v[150:151], v[170:171], v[144:145] op_sel:[0,1] op_sel_hi:[1,1]
    v_pk_fma_f32 v[112:113], v[112:113], v[144:145], v[148:149] op_sel:[0,0,0] op_sel_hi:[1,0,1]
    v_pk_fma_f32 v[114:115], v[114:115], v[144:145], v[150:151] op_sel:[0,0,0] op_sel_hi:[1,0,1]
    v_pk_mul_f32 v[148:149], v[168:169], v[146:147] op_sel:[0,1] op_sel_hi:[1,1]
    v_pk_mul_f32 v[150:151], v[170:171], v[146:147] op_sel:[0,1] op_sel_hi:[1,1]
    v_pk_fma_f32 v[116:117], v[116:117], v[146:147], v[148:149] op_sel:[0,0,0] op_sel_hi:[1,0,1]
    v_pk_fma_f32 v[118:119], v[118:119], v[146:147], v[150:151] op_sel:[0,0,0] op_sel_hi:[1,0,1]
    s_add_u32 s25, s43, 20480
    s_cmp_ge_u32 s3, 2
    s_cbranch_scc1 interleave_layers__linear_attn_block__memory_aug_recurrent_mem_tr__prompt_kernel_k1_e2
    s_lshl_b32 s24, s3, 6
    v_add_u32 v15, s24, v10
    v_cvt_pk_bf16_f32 v64, v104, v105
    v_cvt_pk_bf16_f32 v65, v106, v107
    ds_write_b64 v15, v[64:65] offset:160
    v_cvt_pk_bf16_f32 v66, v108, v109
    v_cvt_pk_bf16_f32 v67, v110, v111
    ds_write_b64 v15, v[66:67] offset:5536
    v_cvt_pk_bf16_f32 v68, v112, v113
    v_cvt_pk_bf16_f32 v69, v114, v115
    ds_write_b64 v15, v[68:69] offset:192
    v_cvt_pk_bf16_f32 v70, v116, v117
    v_cvt_pk_bf16_f32 v71, v118, v119
    ds_write_b64 v15, v[70:71] offset:5568
    v_min_f32 v148, 0, v88
    v_min_f32 v149, 0, v89
    v_pk_mul_f32 v[148:149], v[148:149], s[52:53]
    v_min_f32 v150, 0, v90
    v_min_f32 v151, 0, v91
    v_pk_mul_f32 v[150:151], v[150:151], s[52:53]
    v_exp_f32 v148, v148
    v_exp_f32 v149, v149
    v_exp_f32 v150, v150
    v_exp_f32 v151, v151
    v_max_f32 v88, 0, v88
    v_max_f32 v89, 0, v89
    v_max_f32 v90, 0, v90
    v_max_f32 v91, 0, v91
    v_pk_add_f32 v[88:89], v[88:89], v[148:149]
    v_pk_add_f32 v[90:91], v[90:91], v[150:151]
    v_pk_add_f32 v[88:89], v[88:89], s[54:55]
    v_pk_add_f32 v[90:91], v[90:91], s[54:55]
    v_min_f32 v148, 0, v96
    v_min_f32 v149, 0, v97
    v_pk_mul_f32 v[148:149], v[148:149], s[52:53]
    v_min_f32 v150, 0, v98
    v_min_f32 v151, 0, v99
    v_pk_mul_f32 v[150:151], v[150:151], s[52:53]
    v_exp_f32 v148, v148
    v_exp_f32 v149, v149
    v_exp_f32 v150, v150
    v_exp_f32 v151, v151
    v_max_f32 v96, 0, v96
    v_max_f32 v97, 0, v97
    v_max_f32 v98, 0, v98
    v_max_f32 v99, 0, v99
    v_pk_add_f32 v[96:97], v[96:97], v[148:149]
    v_pk_add_f32 v[98:99], v[98:99], v[150:151]
    v_pk_add_f32 v[96:97], v[96:97], s[54:55]
    v_pk_add_f32 v[98:99], v[98:99], s[54:55]
    v_cvt_pk_bf16_f32 v56, v88, v89
    v_cvt_pk_bf16_f32 v57, v90, v91
    v_cvt_pk_bf16_f32 v58, v96, v97
    v_cvt_pk_bf16_f32 v59, v98, v99
    buffer_store_dwordx4 v[56:59], v12, s[8:11], s43 offen sc1
    v_min_f32 v148, 0, v92
    v_min_f32 v149, 0, v93
    v_pk_mul_f32 v[148:149], v[148:149], s[52:53]
    v_min_f32 v150, 0, v94
    v_min_f32 v151, 0, v95
    v_pk_mul_f32 v[150:151], v[150:151], s[52:53]
    v_exp_f32 v148, v148
    v_exp_f32 v149, v149
    v_exp_f32 v150, v150
    v_exp_f32 v151, v151
    v_max_f32 v92, 0, v92
    v_max_f32 v93, 0, v93
    v_max_f32 v94, 0, v94
    v_max_f32 v95, 0, v95
    v_pk_add_f32 v[92:93], v[92:93], v[148:149]
    v_pk_add_f32 v[94:95], v[94:95], v[150:151]
    v_pk_add_f32 v[92:93], v[92:93], s[54:55]
    v_pk_add_f32 v[94:95], v[94:95], s[54:55]
    v_min_f32 v148, 0, v100
    v_min_f32 v149, 0, v101
    v_pk_mul_f32 v[148:149], v[148:149], s[52:53]
    v_min_f32 v150, 0, v102
    v_min_f32 v151, 0, v103
    v_pk_mul_f32 v[150:151], v[150:151], s[52:53]
    v_exp_f32 v148, v148
    v_exp_f32 v149, v149
    v_exp_f32 v150, v150
    v_exp_f32 v151, v151
    v_max_f32 v100, 0, v100
    v_max_f32 v101, 0, v101
    v_max_f32 v102, 0, v102
    v_max_f32 v103, 0, v103
    v_pk_add_f32 v[100:101], v[100:101], v[148:149]
    v_pk_add_f32 v[102:103], v[102:103], v[150:151]
    v_pk_add_f32 v[100:101], v[100:101], s[54:55]
    v_pk_add_f32 v[102:103], v[102:103], s[54:55]
    v_cvt_pk_bf16_f32 v60, v92, v93
    v_cvt_pk_bf16_f32 v61, v94, v95
    v_cvt_pk_bf16_f32 v62, v100, v101
    v_cvt_pk_bf16_f32 v63, v102, v103
    buffer_store_dwordx4 v[60:63], v12, s[8:11], s25 offen sc1
    s_branch interleave_layers__linear_attn_block__memory_aug_recurrent_mem_tr__prompt_kernel_k1_ej
interleave_layers__linear_attn_block__memory_aug_recurrent_mem_tr__prompt_kernel_k1_e2:
    s_cmp_eq_u32 s3, 3
    s_cbranch_scc1 interleave_layers__linear_attn_block__memory_aug_recurrent_mem_tr__prompt_kernel_k1_e3
    v_cvt_pk_bf16_f32 v68, v112, v113
    v_cvt_pk_bf16_f32 v69, v114, v115
    ds_write_b64 v10, v[68:69] offset:288
    v_cvt_pk_bf16_f32 v70, v116, v117
    v_cvt_pk_bf16_f32 v71, v118, v119
    ds_write_b64 v10, v[70:71] offset:5664
    v_min_f32 v148, 0, v96
    v_min_f32 v149, 0, v97
    v_pk_mul_f32 v[148:149], v[148:149], s[52:53]
    v_min_f32 v150, 0, v98
    v_min_f32 v151, 0, v99
    v_pk_mul_f32 v[150:151], v[150:151], s[52:53]
    v_exp_f32 v148, v148
    v_exp_f32 v149, v149
    v_exp_f32 v150, v150
    v_exp_f32 v151, v151
    v_max_f32 v96, 0, v96
    v_max_f32 v97, 0, v97
    v_max_f32 v98, 0, v98
    v_max_f32 v99, 0, v99
    v_pk_add_f32 v[96:97], v[96:97], v[148:149]
    v_pk_add_f32 v[98:99], v[98:99], v[150:151]
    v_pk_add_f32 v[96:97], v[96:97], s[54:55]
    v_pk_add_f32 v[98:99], v[98:99], s[54:55]
    v_min_f32 v148, 0, v104
    v_min_f32 v149, 0, v105
    v_pk_mul_f32 v[148:149], v[148:149], s[52:53]
    v_min_f32 v150, 0, v106
    v_min_f32 v151, 0, v107
    v_pk_mul_f32 v[150:151], v[150:151], s[52:53]
    v_exp_f32 v148, v148
    v_exp_f32 v149, v149
    v_exp_f32 v150, v150
    v_exp_f32 v151, v151
    v_max_f32 v104, 0, v104
    v_max_f32 v105, 0, v105
    v_max_f32 v106, 0, v106
    v_max_f32 v107, 0, v107
    v_pk_add_f32 v[104:105], v[104:105], v[148:149]
    v_pk_add_f32 v[106:107], v[106:107], v[150:151]
    v_pk_add_f32 v[104:105], v[104:105], s[54:55]
    v_pk_add_f32 v[106:107], v[106:107], s[54:55]
    v_min_f32 v148, 0, v100
    v_min_f32 v149, 0, v101
    v_pk_mul_f32 v[148:149], v[148:149], s[52:53]
    v_min_f32 v150, 0, v102
    v_min_f32 v151, 0, v103
    v_pk_mul_f32 v[150:151], v[150:151], s[52:53]
    v_exp_f32 v148, v148
    v_exp_f32 v149, v149
    v_exp_f32 v150, v150
    v_exp_f32 v151, v151
    v_max_f32 v100, 0, v100
    v_max_f32 v101, 0, v101
    v_max_f32 v102, 0, v102
    v_max_f32 v103, 0, v103
    v_pk_add_f32 v[100:101], v[100:101], v[148:149]
    v_pk_add_f32 v[102:103], v[102:103], v[150:151]
    v_pk_add_f32 v[100:101], v[100:101], s[54:55]
    v_pk_add_f32 v[102:103], v[102:103], s[54:55]
    v_min_f32 v148, 0, v108
    v_min_f32 v149, 0, v109
    v_pk_mul_f32 v[148:149], v[148:149], s[52:53]
    v_min_f32 v150, 0, v110
    v_min_f32 v151, 0, v111
    v_pk_mul_f32 v[150:151], v[150:151], s[52:53]
    v_exp_f32 v148, v148
    v_exp_f32 v149, v149
    v_exp_f32 v150, v150
    v_exp_f32 v151, v151
    v_max_f32 v108, 0, v108
    v_max_f32 v109, 0, v109
    v_max_f32 v110, 0, v110
    v_max_f32 v111, 0, v111
    v_pk_add_f32 v[108:109], v[108:109], v[148:149]
    v_pk_add_f32 v[110:111], v[110:111], v[150:151]
    v_pk_add_f32 v[108:109], v[108:109], s[54:55]
    v_pk_add_f32 v[110:111], v[110:111], s[54:55]
    v_cvt_pk_bf16_f32 v60, v96, v97
    v_cvt_pk_bf16_f32 v61, v98, v99
    ds_write_b64 v10, v[60:61] offset:0
    v_cvt_pk_bf16_f32 v62, v100, v101
    v_cvt_pk_bf16_f32 v63, v102, v103
    ds_write_b64 v10, v[62:63] offset:5376
    v_cvt_pk_bf16_f32 v64, v104, v105
    v_cvt_pk_bf16_f32 v65, v106, v107
    ds_write_b64 v10, v[64:65] offset:32
    v_cvt_pk_bf16_f32 v66, v108, v109
    v_cvt_pk_bf16_f32 v67, v110, v111
    ds_write_b64 v10, v[66:67] offset:5408
    v_min_f32 v148, 0, v88
    v_min_f32 v149, 0, v89
    v_pk_mul_f32 v[148:149], v[148:149], s[52:53]
    v_min_f32 v150, 0, v90
    v_min_f32 v151, 0, v91
    v_pk_mul_f32 v[150:151], v[150:151], s[52:53]
    v_exp_f32 v148, v148
    v_exp_f32 v149, v149
    v_exp_f32 v150, v150
    v_exp_f32 v151, v151
    v_max_f32 v88, 0, v88
    v_max_f32 v89, 0, v89
    v_max_f32 v90, 0, v90
    v_max_f32 v91, 0, v91
    v_pk_add_f32 v[88:89], v[88:89], v[148:149]
    v_pk_add_f32 v[90:91], v[90:91], v[150:151]
    v_pk_add_f32 v[88:89], v[88:89], s[54:55]
    v_pk_add_f32 v[90:91], v[90:91], s[54:55]
    v_cvt_pk_bf16_f32 v56, v88, v89
    v_cvt_pk_bf16_f32 v57, v90, v91
    buffer_store_dwordx2 v[56:57], v12, s[8:11], s43 offen sc1
    v_min_f32 v148, 0, v92
    v_min_f32 v149, 0, v93
    v_pk_mul_f32 v[148:149], v[148:149], s[52:53]
    v_min_f32 v150, 0, v94
    v_min_f32 v151, 0, v95
    v_pk_mul_f32 v[150:151], v[150:151], s[52:53]
    v_exp_f32 v148, v148
    v_exp_f32 v149, v149
    v_exp_f32 v150, v150
    v_exp_f32 v151, v151
    v_max_f32 v92, 0, v92
    v_max_f32 v93, 0, v93
    v_max_f32 v94, 0, v94
    v_max_f32 v95, 0, v95
    v_pk_add_f32 v[92:93], v[92:93], v[148:149]
    v_pk_add_f32 v[94:95], v[94:95], v[150:151]
    v_pk_add_f32 v[92:93], v[92:93], s[54:55]
    v_pk_add_f32 v[94:95], v[94:95], s[54:55]
    v_cvt_pk_bf16_f32 v58, v92, v93
    v_cvt_pk_bf16_f32 v59, v94, v95
    buffer_store_dwordx2 v[58:59], v12, s[8:11], s25 offen sc1
    s_branch interleave_layers__linear_attn_block__memory_aug_recurrent_mem_tr__prompt_kernel_k1_ej
interleave_layers__linear_attn_block__memory_aug_recurrent_mem_tr__prompt_kernel_k1_e3:
    v_min_f32 v148, 0, v88
    v_min_f32 v149, 0, v89
    v_pk_mul_f32 v[148:149], v[148:149], s[52:53]
    v_min_f32 v150, 0, v90
    v_min_f32 v151, 0, v91
    v_pk_mul_f32 v[150:151], v[150:151], s[52:53]
    v_exp_f32 v148, v148
    v_exp_f32 v149, v149
    v_exp_f32 v150, v150
    v_exp_f32 v151, v151
    v_max_f32 v88, 0, v88
    v_max_f32 v89, 0, v89
    v_max_f32 v90, 0, v90
    v_max_f32 v91, 0, v91
    v_pk_add_f32 v[88:89], v[88:89], v[148:149]
    v_pk_add_f32 v[90:91], v[90:91], v[150:151]
    v_pk_add_f32 v[88:89], v[88:89], s[54:55]
    v_pk_add_f32 v[90:91], v[90:91], s[54:55]
    v_min_f32 v148, 0, v92
    v_min_f32 v149, 0, v93
    v_pk_mul_f32 v[148:149], v[148:149], s[52:53]
    v_min_f32 v150, 0, v94
    v_min_f32 v151, 0, v95
    v_pk_mul_f32 v[150:151], v[150:151], s[52:53]
    v_exp_f32 v148, v148
    v_exp_f32 v149, v149
    v_exp_f32 v150, v150
    v_exp_f32 v151, v151
    v_max_f32 v92, 0, v92
    v_max_f32 v93, 0, v93
    v_max_f32 v94, 0, v94
    v_max_f32 v95, 0, v95
    v_pk_add_f32 v[92:93], v[92:93], v[148:149]
    v_pk_add_f32 v[94:95], v[94:95], v[150:151]
    v_pk_add_f32 v[92:93], v[92:93], s[54:55]
    v_pk_add_f32 v[94:95], v[94:95], s[54:55]
    v_cvt_pk_bf16_f32 v56, v88, v89
    v_cvt_pk_bf16_f32 v57, v90, v91
    ds_write_b64 v10, v[56:57] offset:64
    v_cvt_pk_bf16_f32 v58, v92, v93
    v_cvt_pk_bf16_f32 v59, v94, v95
    ds_write_b64 v10, v[58:59] offset:5440
    v_min_f32 v148, 0, v96
    v_min_f32 v149, 0, v97
    v_pk_mul_f32 v[148:149], v[148:149], s[52:53]
    v_min_f32 v150, 0, v98
    v_min_f32 v151, 0, v99
    v_pk_mul_f32 v[150:151], v[150:151], s[52:53]
    v_exp_f32 v148, v148
    v_exp_f32 v149, v149
    v_exp_f32 v150, v150
    v_exp_f32 v151, v151
    v_max_f32 v96, 0, v96
    v_max_f32 v97, 0, v97
    v_max_f32 v98, 0, v98
    v_max_f32 v99, 0, v99
    v_pk_add_f32 v[96:97], v[96:97], v[148:149]
    v_pk_add_f32 v[98:99], v[98:99], v[150:151]
    v_pk_add_f32 v[96:97], v[96:97], s[54:55]
    v_pk_add_f32 v[98:99], v[98:99], s[54:55]
    v_min_f32 v148, 0, v100
    v_min_f32 v149, 0, v101
    v_pk_mul_f32 v[148:149], v[148:149], s[52:53]
    v_min_f32 v150, 0, v102
    v_min_f32 v151, 0, v103
    v_pk_mul_f32 v[150:151], v[150:151], s[52:53]
    v_exp_f32 v148, v148
    v_exp_f32 v149, v149
    v_exp_f32 v150, v150
    v_exp_f32 v151, v151
    v_max_f32 v100, 0, v100
    v_max_f32 v101, 0, v101
    v_max_f32 v102, 0, v102
    v_max_f32 v103, 0, v103
    v_pk_add_f32 v[100:101], v[100:101], v[148:149]
    v_pk_add_f32 v[102:103], v[102:103], v[150:151]
    v_pk_add_f32 v[100:101], v[100:101], s[54:55]
    v_pk_add_f32 v[102:103], v[102:103], s[54:55]
    v_cvt_pk_bf16_f32 v60, v96, v97
    v_cvt_pk_bf16_f32 v61, v98, v99
    ds_write_b64 v10, v[60:61] offset:96
    v_cvt_pk_bf16_f32 v62, v100, v101
    v_cvt_pk_bf16_f32 v63, v102, v103
    ds_write_b64 v10, v[62:63] offset:5472
    v_min_f32 v148, 0, v104
    v_min_f32 v149, 0, v105
    v_pk_mul_f32 v[148:149], v[148:149], s[52:53]
    v_min_f32 v150, 0, v106
    v_min_f32 v151, 0, v107
    v_pk_mul_f32 v[150:151], v[150:151], s[52:53]
    v_exp_f32 v148, v148
    v_exp_f32 v149, v149
    v_exp_f32 v150, v150
    v_exp_f32 v151, v151
    v_max_f32 v104, 0, v104
    v_max_f32 v105, 0, v105
    v_max_f32 v106, 0, v106
    v_max_f32 v107, 0, v107
    v_pk_add_f32 v[104:105], v[104:105], v[148:149]
    v_pk_add_f32 v[106:107], v[106:107], v[150:151]
    v_pk_add_f32 v[104:105], v[104:105], s[54:55]
    v_pk_add_f32 v[106:107], v[106:107], s[54:55]
    v_min_f32 v148, 0, v108
    v_min_f32 v149, 0, v109
    v_pk_mul_f32 v[148:149], v[148:149], s[52:53]
    v_min_f32 v150, 0, v110
    v_min_f32 v151, 0, v111
    v_pk_mul_f32 v[150:151], v[150:151], s[52:53]
    v_exp_f32 v148, v148
    v_exp_f32 v149, v149
    v_exp_f32 v150, v150
    v_exp_f32 v151, v151
    v_max_f32 v108, 0, v108
    v_max_f32 v109, 0, v109
    v_max_f32 v110, 0, v110
    v_max_f32 v111, 0, v111
    v_pk_add_f32 v[108:109], v[108:109], v[148:149]
    v_pk_add_f32 v[110:111], v[110:111], v[150:151]
    v_pk_add_f32 v[108:109], v[108:109], s[54:55]
    v_pk_add_f32 v[110:111], v[110:111], s[54:55]
    v_cvt_pk_bf16_f32 v64, v104, v105
    v_cvt_pk_bf16_f32 v65, v106, v107
    ds_write_b64 v10, v[64:65] offset:128
    v_cvt_pk_bf16_f32 v66, v108, v109
    v_cvt_pk_bf16_f32 v67, v110, v111
    ds_write_b64 v10, v[66:67] offset:5504
interleave_layers__linear_attn_block__memory_aug_recurrent_mem_tr__prompt_kernel_k1_ej:
    s_waitcnt lgkmcnt(0)
    s_barrier
    ds_read_b64_tr_b16 v[72:73], v11 offset:0
    ds_read_b64_tr_b16 v[74:75], v11 offset:1344
    ds_read_b64_tr_b16 v[76:77], v11 offset:32
    ds_read_b64_tr_b16 v[78:79], v11 offset:1376
    ds_read_b64_tr_b16 v[80:81], v11 offset:160
    ds_read_b64_tr_b16 v[82:83], v11 offset:1504
    ds_read_b64_tr_b16 v[84:85], v11 offset:192
    ds_read_b64_tr_b16 v[86:87], v11 offset:1536
    s_waitcnt lgkmcnt(0)
    v_mfma_f32_16x16x32_bf16 v[120:123], v[72:75], v[84:87], v[120:123]
    v_mfma_f32_16x16x32_bf16 v[124:127], v[76:79], v[80:83], v[124:127]
    v_mfma_f32_16x16x32_bf16 v[128:131], v[76:79], v[84:87], v[128:131]
    v_mfma_f32_16x16x32_bf16 v[132:135], v[76:79], v[172:175], v[132:135]
    v_mfma_f32_16x16x32_bf16 v[136:139], v[72:75], v[80:83], v[136:139]
    v_mfma_f32_16x16x32_bf16 v[140:143], v[72:75], v[172:175], v[140:143]
    s_add_u32 s43, s43, s42
    s_add_u32 s48, s48, s49
    s_sub_u32 s40, s40, 1
    s_cmp_gt_u32 s40, 0
    s_cbranch_scc1 interleave_layers__linear_attn_block__memory_aug_recurrent_mem_tr__prompt_kernel_k1_seg
    s_cmp_eq_u32 s92, 0
    s_cbranch_scc0 interleave_layers__linear_attn_block__memory_aug_recurrent_mem_tr__prompt_kernel_ri7
    v_mov_b32 v15, 0
    buffer_load_dword v14, v15, s[72:75], 0 offen sc1
interleave_layers__linear_attn_block__memory_aug_recurrent_mem_tr__prompt_kernel_ri7:
    s_mul_i32 s24, s45, 147456
    s_mul_i32 s25, s44, 18432
    s_add_u32 s24, s24, s25
    s_add_u32 s24, s24, 16777216
    s_mul_i32 s25, s3, 3072
    s_add_u32 s25, s25, s24
    s_lshl_b32 s26, s3, 10
    s_add_u32 s26, s26, s24
    s_add_u32 s26, s26, 13312
    s_cmp_eq_u32 s3, 0
    s_cselect_b32 s27, 0, 2146435072
    s_add_u32 s27, s27, s24
    s_add_u32 s28, s27, 17408
    s_add_u32 s27, s27, 12288
    buffer_store_dwordx4 v[120:123], v7, s[8:11], s25 offen offset:0 sc1
    buffer_store_dwordx4 v[124:127], v7, s[8:11], s25 offen offset:1024 sc1
    buffer_store_dwordx4 v[128:131], v7, s[8:11], s25 offen offset:2048 sc1
    buffer_store_dwordx4 v[132:135], v7, s[8:11], s26 offen sc1
    buffer_store_dwordx4 v[136:139], v7, s[8:11], s27 offen sc1
    buffer_store_dwordx4 v[140:143], v7, s[8:11], s28 offen sc1
    s_waitcnt vmcnt(0)
    s_cmp_eq_u32 s92, 0
    s_cbranch_scc0 interleave_layers__linear_attn_block__memory_aug_recurrent_mem_tr__prompt_kernel_rc8_ok
    s_mov_b32 s61, 0
interleave_layers__linear_attn_block__memory_aug_recurrent_mem_tr__prompt_kernel_rc8:
    s_waitcnt vmcnt(0)
    v_readfirstlane_b32 s24, v14
    s_sub_u32 s36, s24, 1
    s_and_b32 s36, s36, 1
    s_lshl_b32 s36, s36, 13
    s_cmp_ge_u32 s24, 1
    s_cbranch_scc1 interleave_layers__linear_attn_block__memory_aug_recurrent_mem_tr__prompt_kernel_rc8_ok
    s_add_u32 s61, s61, 1
    s_cmp_ge_u32 s61, s60
    s_cbranch_scc1 interleave_layers__linear_attn_block__memory_aug_recurrent_mem_tr__prompt_kernel_rc8_to
    s_sleep 2
    v_mov_b32 v15, 0
    buffer_load_dword v14, v15, s[72:75], 0 offen sc1
    s_branch interleave_layers__linear_attn_block__memory_aug_recurrent_mem_tr__prompt_kernel_rc8
interleave_layers__linear_attn_block__memory_aug_recurrent_mem_tr__prompt_kernel_rc8_to:
    s_mov_b32 s60, 1
interleave_layers__linear_attn_block__memory_aug_recurrent_mem_tr__prompt_kernel_rc8_ok:
    s_barrier
    s_lshl_b32 s24, s92, 3
    s_add_u32 s24, s24, s44
    s_lshl_b32 s24, s24, 7
    s_lshl_b32 s25, s45, 2
    s_add_u32 s24, s24, s25
    s_add_u32 s24, s24, 23101440
    s_cmp_eq_u32 s3, 0
    s_cbranch_scc0 interleave_layers__linear_attn_block__memory_aug_recurrent_mem_tr__prompt_kernel_pb9
    v_lshlrev_b32 v14, 7, v1
    v_add_u32 v14, s24, v14
    v_mov_b32 v15, 2146435072
    v_cmp_le_u32 vcc, 1, v1
    s_nop 1
    v_cndmask_b32 v14, v14, v15, vcc
    v_mov_b32 v15, 1
    buffer_store_dword v15, v14, s[8:11], 0 offen sc1
interleave_layers__linear_attn_block__memory_aug_recurrent_mem_tr__prompt_kernel_pb9:
    s_cmp_eq_u32 s92, 0
    s_cbranch_scc1 interleave_layers__linear_attn_block__memory_aug_recurrent_mem_tr__prompt_kernel_k3w10
    s_cmp_eq_u32 s2, 247
    s_cbranch_scc1 interleave_layers__linear_attn_block__memory_aug_recurrent_mem_tr__prompt_kernel_end
    s_branch interleave_layers__linear_attn_block__memory_aug_recurrent_mem_tr__prompt_kernel_helper
interleave_layers__linear_attn_block__memory_aug_recurrent_mem_tr__prompt_kernel_k3w10:
    s_cmp_ge_u32 s2, 232
    s_cbranch_scc1 interleave_layers__linear_attn_block__memory_aug_recurrent_mem_tr__prompt_kernel_helper
    s_cmp_ge_u32 s2, 200
    s_cbranch_scc1 interleave_layers__linear_attn_block__memory_aug_recurrent_mem_tr__prompt_kernel_toO
    s_cmp_ge_u32 s2, 104
    s_cbranch_scc1 interleave_layers__linear_attn_block__memory_aug_recurrent_mem_tr__prompt_kernel_toP
    s_cmp_ge_u32 s2, 64
    s_cbranch_scc1 interleave_layers__linear_attn_block__memory_aug_recurrent_mem_tr__prompt_kernel_toR
    s_cmp_ge_u32 s2, 32
    s_cbranch_scc1 interleave_layers__linear_attn_block__memory_aug_recurrent_mem_tr__prompt_kernel_toV
    s_branch interleave_layers__linear_attn_block__memory_aug_recurrent_mem_tr__prompt_kernel_roleS
interleave_layers__linear_attn_block__memory_aug_recurrent_mem_tr__prompt_kernel_toV:
    s_branch interleave_layers__linear_attn_block__memory_aug_recurrent_mem_tr__prompt_kernel_roleV
interleave_layers__linear_attn_block__memory_aug_recurrent_mem_tr__prompt_kernel_toR:
    s_branch interleave_layers__linear_attn_block__memory_aug_recurrent_mem_tr__prompt_kernel_roleR
interleave_layers__linear_attn_block__memory_aug_recurrent_mem_tr__prompt_kernel_toP:
    s_branch interleave_layers__linear_attn_block__memory_aug_recurrent_mem_tr__prompt_kernel_roleP
interleave_layers__linear_attn_block__memory_aug_recurrent_mem_tr__prompt_kernel_toO:
    s_branch interleave_layers__linear_attn_block__memory_aug_recurrent_mem_tr__prompt_kernel_roleO
interleave_layers__linear_attn_block__memory_aug_recurrent_mem_tr__prompt_kernel_helper:
    s_sub_u32 s24, s2, 232
    s_cmp_ge_u32 s24, 21
    s_cbranch_scc1 interleave_layers__linear_attn_block__memory_aug_recurrent_mem_tr__prompt_kernel_helper_clr
    s_cmp_eq_u32 s24, 15
    s_cbranch_scc1 interleave_layers__linear_attn_block__memory_aug_recurrent_mem_tr__prompt_kernel_helper_k1
    s_mul_i32 s57, s24, 52
    s_lshr_b32 s57, s57, 8
    s_mul_i32 s56, s57, 5
    s_sub_u32 s56, s24, s56
    s_add_u32 s57, s57, 1
    s_sub_u32 s25, s24, 16
    s_cmp_ge_u32 s24, 16
    s_cselect_b32 s56, s25, s56
    s_cselect_b32 s57, 0, s57
    s_mul_i32 s78, s57, 5
    s_add_u32 s78, s78, s56
    s_load_dwordx2 s[6:7], s[0:1], 16
    v_lshrrev_b32 v12, 4, v0
    v_mul_u32_u24 v12, 1280, v12
    v_and_b32 v13, 15, v0
    v_lshl_add_u32 v12, v13, 4, v12
    s_waitcnt lgkmcnt(0)
    s_mov_b32 s12, s6
    s_mov_b32 s13, s7
    s_mov_b32 s14, 819200
    s_mov_b32 s15, 0x00020000
    s_lshl_b32 s52, s56, 8
    s_add_u32 s24, s52, 0
    buffer_load_dwordx4 a[0:3], v12, s[12:15], s24 offen
    s_add_u32 s24, s52, 20480
    buffer_load_dwordx4 a[4:7], v12, s[12:15], s24 offen
    s_add_u32 s24, s52, 40960
    buffer_load_dwordx4 a[8:11], v12, s[12:15], s24 offen
    s_add_u32 s24, s52, 61440
    buffer_load_dwordx4 a[12:15], v12, s[12:15], s24 offen
    s_add_u32 s24, s52, 81920
    buffer_load_dwordx4 a[16:19], v12, s[12:15], s24 offen
    s_add_u32 s24, s52, 102400
    buffer_load_dwordx4 a[20:23], v12, s[12:15], s24 offen
    s_add_u32 s24, s52, 122880
    buffer_load_dwordx4 a[24:27], v12, s[12:15], s24 offen
    s_add_u32 s24, s52, 143360
    buffer_load_dwordx4 a[28:31], v12, s[12:15], s24 offen
    s_add_u32 s24, s52, 163840
    buffer_load_dwordx4 a[32:35], v12, s[12:15], s24 offen
    s_add_u32 s24, s52, 184320
    buffer_load_dwordx4 a[36:39], v12, s[12:15], s24 offen
    s_add_u32 s24, s52, 204800
    buffer_load_dwordx4 a[40:43], v12, s[12:15], s24 offen
    s_add_u32 s24, s52, 225280
    buffer_load_dwordx4 a[44:47], v12, s[12:15], s24 offen
    s_add_u32 s24, s52, 245760
    buffer_load_dwordx4 a[48:51], v12, s[12:15], s24 offen
    s_add_u32 s24, s52, 266240
    buffer_load_dwordx4 a[52:55], v12, s[12:15], s24 offen
    s_add_u32 s24, s52, 286720
    buffer_load_dwordx4 a[56:59], v12, s[12:15], s24 offen
    s_add_u32 s24, s52, 307200
    buffer_load_dwordx4 a[60:63], v12, s[12:15], s24 offen
    s_add_u32 s24, s52, 327680
    buffer_load_dwordx4 a[64:67], v12, s[12:15], s24 offen
    s_add_u32 s24, s52, 348160
    buffer_load_dwordx4 a[68:71], v12, s[12:15], s24 offen
    s_add_u32 s24, s52, 368640
    buffer_load_dwordx4 a[72:75], v12, s[12:15], s24 offen
    s_add_u32 s24, s52, 389120
    buffer_load_dwordx4 a[76:79], v12, s[12:15], s24 offen
    s_add_u32 s24, s52, 409600
    buffer_load_dwordx4 a[80:83], v12, s[12:15], s24 offen
    s_add_u32 s24, s52, 430080
    buffer_load_dwordx4 a[84:87], v12, s[12:15], s24 offen
    s_add_u32 s24, s52, 450560
    buffer_load_dwordx4 a[88:91], v12, s[12:15], s24 offen
    s_add_u32 s24, s52, 471040
    buffer_load_dwordx4 a[92:95], v12, s[12:15], s24 offen
    s_add_u32 s24, s52, 491520
    buffer_load_dwordx4 a[96:99], v12, s[12:15], s24 offen
    s_add_u32 s24, s52, 512000
    buffer_load_dwordx4 a[100:103], v12, s[12:15], s24 offen
    s_add_u32 s24, s52, 532480
    buffer_load_dwordx4 a[104:107], v12, s[12:15], s24 offen
    s_add_u32 s24, s52, 552960
    buffer_load_dwordx4 a[108:111], v12, s[12:15], s24 offen
    s_add_u32 s24, s52, 573440
    buffer_load_dwordx4 a[112:115], v12, s[12:15], s24 offen
    s_add_u32 s24, s52, 593920
    buffer_load_dwordx4 a[116:119], v12, s[12:15], s24 offen
    s_add_u32 s24, s52, 614400
    buffer_load_dwordx4 a[120:123], v12, s[12:15], s24 offen
    s_add_u32 s24, s52, 634880
    buffer_load_dwordx4 a[124:127], v12, s[12:15], s24 offen
    s_add_u32 s24, s52, 655360
    buffer_load_dwordx4 a[128:131], v12, s[12:15], s24 offen
    s_add_u32 s24, s52, 675840
    buffer_load_dwordx4 a[132:135], v12, s[12:15], s24 offen
    s_add_u32 s24, s52, 696320
    buffer_load_dwordx4 a[136:139], v12, s[12:15], s24 offen
    s_add_u32 s24, s52, 716800
    buffer_load_dwordx4 a[140:143], v12, s[12:15], s24 offen
    s_add_u32 s24, s52, 737280
    buffer_load_dwordx4 a[144:147], v12, s[12:15], s24 offen
    s_add_u32 s24, s52, 757760
    buffer_load_dwordx4 a[148:151], v12, s[12:15], s24 offen
    s_add_u32 s24, s52, 778240
    buffer_load_dwordx4 a[152:155], v12, s[12:15], s24 offen
    s_add_u32 s24, s52, 798720
    buffer_load_dwordx4 a[156:159], v12, s[12:15], s24 offen
    v_lshrrev_b32 v6, 4, v0
    v_mul_u32_u24 v6, 288, v6
    v_and_b32 v7, 15, v0
    v_lshl_add_u32 v6, v7, 4, v6
    v_add_u32 v6, 81920, v6
    v_lshrrev_b32 v7, 2, v2
    v_lshl_add_u32 v7, v3, 2, v7
    v_mul_u32_u24 v7, 288, v7
    v_and_b32 v8, 3, v2
    v_lshl_add_u32 v7, v8, 3, v7
    s_lshl_b32 s24, s3, 6
    s_add_u32 s24, s24, 81920
    v_add_u32 v7, s24, v7
    s_waitcnt vmcnt(36)
    ds_write_b128 v6, a[0:3] offset:0
    ds_write_b128 v6, a[4:7] offset:4608
    ds_write_b128 v6, a[8:11] offset:9216
    ds_write_b128 v6, a[12:15] offset:13824
    s_waitcnt lgkmcnt(0)
    s_barrier
    ds_read_b64_tr_b16 a[0:1], v7 offset:0
    ds_read_b64_tr_b16 a[2:3], v7 offset:4608
    ds_read_b64_tr_b16 a[4:5], v7 offset:32
    ds_read_b64_tr_b16 a[6:7], v7 offset:4640
    ds_read_b64_tr_b16 a[8:9], v7 offset:9216
    ds_read_b64_tr_b16 a[10:11], v7 offset:13824
    ds_read_b64_tr_b16 a[12:13], v7 offset:9248
    ds_read_b64_tr_b16 a[14:15], v7 offset:13856
    s_waitcnt vmcnt(32)
    ds_write_b128 v6, a[16:19] offset:18432
    ds_write_b128 v6, a[20:23] offset:23040
    ds_write_b128 v6, a[24:27] offset:27648
    ds_write_b128 v6, a[28:31] offset:32256
    s_waitcnt lgkmcnt(0)
    s_barrier
    ds_read_b64_tr_b16 a[16:17], v7 offset:18432
    ds_read_b64_tr_b16 a[18:19], v7 offset:23040
    ds_read_b64_tr_b16 a[20:21], v7 offset:18464
    ds_read_b64_tr_b16 a[22:23], v7 offset:23072
    ds_read_b64_tr_b16 a[24:25], v7 offset:27648
    ds_read_b64_tr_b16 a[26:27], v7 offset:32256
    ds_read_b64_tr_b16 a[28:29], v7 offset:27680
    ds_read_b64_tr_b16 a[30:31], v7 offset:32288
    s_waitcnt vmcnt(28)
    ds_write_b128 v6, a[32:35] offset:0
    ds_write_b128 v6, a[36:39] offset:4608
    ds_write_b128 v6, a[40:43] offset:9216
    ds_write_b128 v6, a[44:47] offset:13824
    s_waitcnt lgkmcnt(0)
    s_barrier
    ds_read_b64_tr_b16 a[32:33], v7 offset:0
    ds_read_b64_tr_b16 a[34:35], v7 offset:4608
    ds_read_b64_tr_b16 a[36:37], v7 offset:32
    ds_read_b64_tr_b16 a[38:39], v7 offset:4640
    ds_read_b64_tr_b16 a[40:41], v7 offset:9216
    ds_read_b64_tr_b16 a[42:43], v7 offset:13824
    ds_read_b64_tr_b16 a[44:45], v7 offset:9248
    ds_read_b64_tr_b16 a[46:47], v7 offset:13856
    s_waitcnt vmcnt(24)
    ds_write_b128 v6, a[48:51] offset:18432
    ds_write_b128 v6, a[52:55] offset:23040
    ds_write_b128 v6, a[56:59] offset:27648
    ds_write_b128 v6, a[60:63] offset:32256
    s_waitcnt lgkmcnt(0)
    s_barrier
    ds_read_b64_tr_b16 a[48:49], v7 offset:18432
    ds_read_b64_tr_b16 a[50:51], v7 offset:23040
    ds_read_b64_tr_b16 a[52:53], v7 offset:18464
    ds_read_b64_tr_b16 a[54:55], v7 offset:23072
    ds_read_b64_tr_b16 a[56:57], v7 offset:27648
    ds_read_b64_tr_b16 a[58:59], v7 offset:32256
    ds_read_b64_tr_b16 a[60:61], v7 offset:27680
    ds_read_b64_tr_b16 a[62:63], v7 offset:32288
    s_waitcnt vmcnt(20)
    ds_write_b128 v6, a[64:67] offset:0
    ds_write_b128 v6, a[68:71] offset:4608
    ds_write_b128 v6, a[72:75] offset:9216
    ds_write_b128 v6, a[76:79] offset:13824
    s_waitcnt lgkmcnt(0)
    s_barrier
    ds_read_b64_tr_b16 a[64:65], v7 offset:0
    ds_read_b64_tr_b16 a[66:67], v7 offset:4608
    ds_read_b64_tr_b16 a[68:69], v7 offset:32
    ds_read_b64_tr_b16 a[70:71], v7 offset:4640
    ds_read_b64_tr_b16 a[72:73], v7 offset:9216
    ds_read_b64_tr_b16 a[74:75], v7 offset:13824
    ds_read_b64_tr_b16 a[76:77], v7 offset:9248
    ds_read_b64_tr_b16 a[78:79], v7 offset:13856
    s_waitcnt vmcnt(16)
    ds_write_b128 v6, a[80:83] offset:18432
    ds_write_b128 v6, a[84:87] offset:23040
    ds_write_b128 v6, a[88:91] offset:27648
    ds_write_b128 v6, a[92:95] offset:32256
    s_waitcnt lgkmcnt(0)
    s_barrier
    ds_read_b64_tr_b16 a[80:81], v7 offset:18432
    ds_read_b64_tr_b16 a[82:83], v7 offset:23040
    ds_read_b64_tr_b16 a[84:85], v7 offset:18464
    ds_read_b64_tr_b16 a[86:87], v7 offset:23072
    ds_read_b64_tr_b16 a[88:89], v7 offset:27648
    ds_read_b64_tr_b16 a[90:91], v7 offset:32256
    ds_read_b64_tr_b16 a[92:93], v7 offset:27680
    ds_read_b64_tr_b16 a[94:95], v7 offset:32288
    s_waitcnt vmcnt(12)
    ds_write_b128 v6, a[96:99] offset:0
    ds_write_b128 v6, a[100:103] offset:4608
    ds_write_b128 v6, a[104:107] offset:9216
    ds_write_b128 v6, a[108:111] offset:13824
    s_waitcnt lgkmcnt(0)
    s_barrier
    ds_read_b64_tr_b16 a[96:97], v7 offset:0
    ds_read_b64_tr_b16 a[98:99], v7 offset:4608
    ds_read_b64_tr_b16 a[100:101], v7 offset:32
    ds_read_b64_tr_b16 a[102:103], v7 offset:4640
    ds_read_b64_tr_b16 a[104:105], v7 offset:9216
    ds_read_b64_tr_b16 a[106:107], v7 offset:13824
    ds_read_b64_tr_b16 a[108:109], v7 offset:9248
    ds_read_b64_tr_b16 a[110:111], v7 offset:13856
    s_waitcnt vmcnt(8)
    ds_write_b128 v6, a[112:115] offset:18432
    ds_write_b128 v6, a[116:119] offset:23040
    ds_write_b128 v6, a[120:123] offset:27648
    ds_write_b128 v6, a[124:127] offset:32256
    s_waitcnt lgkmcnt(0)
    s_barrier
    ds_read_b64_tr_b16 a[112:113], v7 offset:18432
    ds_read_b64_tr_b16 a[114:115], v7 offset:23040
    ds_read_b64_tr_b16 a[116:117], v7 offset:18464
    ds_read_b64_tr_b16 a[118:119], v7 offset:23072
    ds_read_b64_tr_b16 a[120:121], v7 offset:27648
    ds_read_b64_tr_b16 a[122:123], v7 offset:32256
    ds_read_b64_tr_b16 a[124:125], v7 offset:27680
    ds_read_b64_tr_b16 a[126:127], v7 offset:32288
    s_waitcnt vmcnt(4)
    ds_write_b128 v6, a[128:131] offset:0
    ds_write_b128 v6, a[132:135] offset:4608
    ds_write_b128 v6, a[136:139] offset:9216
    ds_write_b128 v6, a[140:143] offset:13824
    s_waitcnt lgkmcnt(0)
    s_barrier
    ds_read_b64_tr_b16 a[128:129], v7 offset:0
    ds_read_b64_tr_b16 a[130:131], v7 offset:4608
    ds_read_b64_tr_b16 a[132:133], v7 offset:32
    ds_read_b64_tr_b16 a[134:135], v7 offset:4640
    ds_read_b64_tr_b16 a[136:137], v7 offset:9216
    ds_read_b64_tr_b16 a[138:139], v7 offset:13824
    ds_read_b64_tr_b16 a[140:141], v7 offset:9248
    ds_read_b64_tr_b16 a[142:143], v7 offset:13856
    s_waitcnt vmcnt(0)
    ds_write_b128 v6, a[144:147] offset:18432
    ds_write_b128 v6, a[148:151] offset:23040
    ds_write_b128 v6, a[152:155] offset:27648
    ds_write_b128 v6, a[156:159] offset:32256
    s_waitcnt lgkmcnt(0)
    s_barrier
    ds_read_b64_tr_b16 a[144:145], v7 offset:18432
    ds_read_b64_tr_b16 a[146:147], v7 offset:23040
    ds_read_b64_tr_b16 a[148:149], v7 offset:18464
    ds_read_b64_tr_b16 a[150:151], v7 offset:23072
    ds_read_b64_tr_b16 a[152:153], v7 offset:27648
    ds_read_b64_tr_b16 a[154:155], v7 offset:32256
    ds_read_b64_tr_b16 a[156:157], v7 offset:27680
    ds_read_b64_tr_b16 a[158:159], v7 offset:32288
    s_waitcnt lgkmcnt(0)
    s_cmp_eq_u32 s92, 1
    s_cbranch_scc1 interleave_layers__linear_attn_block__memory_aug_recurrent_mem_tr__prompt_kernel_k3_l1
    s_load_dwordx2 s[6:7], s[0:1], 0
    s_waitcnt lgkmcnt(0)
    s_mov_b32 s16, s6
    s_mov_b32 s17, s7
    s_mov_b32 s18, 2621440
    s_mov_b32 s19, 0x00020000
    s_mov_b32 s46, 64
    s_mov_b32 s47, 32
    s_mov_b32 s50, 0
    s_mov_b32 s58, 0
    s_mov_b32 s76, 16
    s_mov_b32 s77, 163840
interleave_layers__linear_attn_block__memory_aug_recurrent_mem_tr__prompt_kernel_k3_entry:
    v_lshlrev_b32 v5, 4, v1
    s_mul_i32 s24, s3, 5120
    s_add_u32 s24, s24, 12582912
    v_add_u32 v8, s24, v5
    v_lshlrev_b32 v9, 3, v1
    s_add_u32 s24, s24, 2048
    v_add_u32 v9, s24, v9
    s_cmp_eq_u32 s50, 1
    s_cselect_b32 s25, 16, 1280
    s_cselect_b32 s26, 256, 8
    v_mul_u32_u24 v10, s25, v2
    v_mul_u32_u24 v11, s26, v3
    s_lshl_b32 s24, s56, 2
    s_add_u32 s24, s24, s3
    s_mul_i32 s25, s24, s46
    v_add3_u32 v10, v10, v11, s25
    v_add_u32 v11, s47, v10
    s_lshl_b32 s24, s24, 10
    s_add_u32 s24, s24, s58
    v_add_u32 v12, s24, v5
    s_mul_i32 s24, s3, 5120
    s_add_u32 s24, s24, 0
    v_add_u32 v13, s24, v5
    s_mov_b32 s54, 0x358637bd
    s_mul_i32 s43, s57, 40960
    s_mov_b32 s40, 0
    s_mov_b32 s42, 0
    s_cmp_eq_u32 s92, 0
    s_cselect_b32 s26, 32, 0
    s_cselect_b32 s27, 7, 1
    s_lshl_b32 s24, s92, 10
    s_add_u32 s24, s24, 23101440
    v_and_b32 v15, 7, v1
    v_lshlrev_b32 v15, 7, v15
    v_lshrrev_b32 v14, 3, v1
    v_and_b32 v14, s27, v14
    v_lshl_add_u32 v15, v14, 2, v15
    v_add_u32 v15, s24, v15
    s_lshl_b32 s27, s26, 1
    s_add_u32 s28, s27, s26
    s_mov_b32 s61, 0
interleave_layers__linear_attn_block__memory_aug_recurrent_mem_tr__prompt_kernel_k3_w0:
    buffer_load_dword v16, v15, s[8:11], 0 offen sc1
    buffer_load_dword v17, v15, s[8:11], s26 offen sc1
    buffer_load_dword v18, v15, s[8:11], s27 offen sc1
    buffer_load_dword v19, v15, s[8:11], s28 offen sc1
    s_waitcnt vmcnt(0)
    v_min_i32 v16, v16, v17
    v_min3_i32 v16, v16, v18, v19
    v_cmp_le_i32 vcc, 1, v16
    s_cmp_eq_u64 vcc, -1
    s_cbranch_scc1 interleave_layers__linear_attn_block__memory_aug_recurrent_mem_tr__prompt_kernel_k3_w0_ok
    s_add_u32 s61, s61, 1
    s_cmp_ge_u32 s61, s60
    s_cbranch_scc1 interleave_layers__linear_attn_block__memory_aug_recurrent_mem_tr__prompt_kernel_k3_w0_to
    s_sleep 4
    s_branch interleave_layers__linear_attn_block__memory_aug_recurrent_mem_tr__prompt_kernel_k3_w0
interleave_layers__linear_attn_block__memory_aug_recurrent_mem_tr__prompt_kernel_k3_w0_to:
    s_mov_b32 s60, 1
interleave_layers__linear_attn_block__memory_aug_recurrent_mem_tr__prompt_kernel_k3_w0_ok:
    s_mov_b32 s41, s43
    s_add_u32 s25, s41, 20480
    buffer_load_dwordx4 v[16:19], v8, s[8:11], s41 offen offset:0 sc1
    buffer_load_dwordx4 v[20:23], v8, s[8:11], s41 offen offset:1024 sc1
    buffer_load_dwordx2 v[24:25], v9, s[8:11], s41 offen offset:0 sc1
    buffer_load_dwordx4 v[26:29], v8, s[8:11], s41 offen offset:2560 sc1
    buffer_load_dwordx4 v[30:33], v8, s[8:11], s41 offen offset:3584 sc1
    buffer_load_dwordx2 v[34:35], v9, s[8:11], s41 offen offset:2560 sc1
    buffer_load_dwordx4 v[36:39], v8, s[8:11], s25 offen offset:0 sc1
    buffer_load_dwordx4 v[40:43], v8, s[8:11], s25 offen offset:1024 sc1
    buffer_load_dwordx2 v[44:45], v9, s[8:11], s25 offen offset:0 sc1
    buffer_load_dwordx4 v[46:49], v8, s[8:11], s25 offen offset:2560 sc1
    buffer_load_dwordx4 v[50:53], v8, s[8:11], s25 offen offset:3584 sc1
    buffer_load_dwordx2 v[54:55], v9, s[8:11], s25 offen offset:2560 sc1
    buffer_load_dwordx2 v[96:97], v10, s[16:19], s41 offen sc1
    buffer_load_dwordx2 v[98:99], v11, s[16:19], s41 offen sc1
    buffer_load_dwordx2 v[100:101], v10, s[16:19], s25 offen sc1
    buffer_load_dwordx2 v[102:103], v11, s[16:19], s25 offen sc1
    s_add_u32 s41, s43, s77
    s_add_u32 s25, s41, 20480
    buffer_load_dwordx4 v[56:59], v8, s[8:11], s41 offen offset:0 sc1
    buffer_load_dwordx4 v[60:63], v8, s[8:11], s41 offen offset:1024 sc1
    buffer_load_dwordx2 v[64:65], v9, s[8:11], s41 offen offset:0 sc1
    buffer_load_dwordx4 v[66:69], v8, s[8:11], s41 offen offset:2560 sc1
    buffer_load_dwordx4 v[70:73], v8, s[8:11], s41 offen offset:3584 sc1
    buffer_load_dwordx2 v[74:75], v9, s[8:11], s41 offen offset:2560 sc1
    buffer_load_dwordx4 v[76:79], v8, s[8:11], s25 offen offset:0 sc1
    buffer_load_dwordx4 v[80:83], v8, s[8:11], s25 offen offset:1024 sc1
    buffer_load_dwordx2 v[84:85], v9, s[8:11], s25 offen offset:0 sc1
    buffer_load_dwordx4 v[86:89], v8, s[8:11], s25 offen offset:2560 sc1
    buffer_load_dwordx4 v[90:93], v8, s[8:11], s25 offen offset:3584 sc1
    buffer_load_dwordx2 v[94:95], v9, s[8:11], s25 offen offset:2560 sc1
    buffer_load_dwordx2 v[104:105], v10, s[16:19], s41 offen sc1
    buffer_load_dwordx2 v[106:107], v11, s[16:19], s41 offen sc1
    buffer_load_dwordx2 v[108:109], v10, s[16:19], s25 offen sc1
    buffer_load_dwordx2 v[110:111], v11, s[16:19], s25 offen sc1
    s_lshl_b32 s24, s92, 7
    s_add_u32 s24, s24, 23103488
    v_lshlrev_b32 v15, 2, v1
    v_add_u32 v15, s24, v15
    s_mov_b32 s61, 0
interleave_layers__linear_attn_block__memory_aug_recurrent_mem_tr__prompt_kernel_k3_w:
    buffer_load_dword v14, v15, s[8:11], 0 offen sc1
    s_waitcnt vmcnt(0)
    v_cmp_le_i32 vcc, 1, v14
    s_mov_b32 s25, 0xffffff
    s_and_b32 s24, vcc_lo, s25
    s_cmp_eq_u32 s24, s25
    s_cbranch_scc1 interleave_layers__linear_attn_block__memory_aug_recurrent_mem_tr__prompt_kernel_k3_w_ok
    s_add_u32 s61, s61, 1
    s_cmp_ge_u32 s61, s60
    s_cbranch_scc1 interleave_layers__linear_attn_block__memory_aug_recurrent_mem_tr__prompt_kernel_k3_w_to
    s_sleep 2
    s_branch interleave_layers__linear_attn_block__memory_aug_recurrent_mem_tr__prompt_kernel_k3_w
interleave_layers__linear_attn_block__memory_aug_recurrent_mem_tr__prompt_kernel_k3_w_to:
    s_mov_b32 s60, 1
interleave_layers__linear_attn_block__memory_aug_recurrent_mem_tr__prompt_kernel_k3_w_ok:
    s_mul_i32 s24, s92, 131072
    s_mul_i32 s25, s3, 28672
    s_add_u32 s24, s24, s25
    s_add_u32 s24, s24, 22020096
    s_add_u32 s25, s24, 0
    buffer_load_dwordx4 a[160:163], v5, s[8:11], s25 offen sc1
    s_add_u32 s25, s24, 1024
    buffer_load_dwordx4 a[164:167], v5, s[8:11], s25 offen sc1
    s_add_u32 s25, s24, 2048
    buffer_load_dwordx4 a[168:171], v5, s[8:11], s25 offen sc1
    s_add_u32 s25, s24, 3072
    buffer_load_dwordx4 a[172:175], v5, s[8:11], s25 offen sc1
    s_add_u32 s25, s24, 4096
    buffer_load_dwordx4 a[176:179], v5, s[8:11], s25 offen sc1
    s_add_u32 s25, s24, 5120
    buffer_load_dwordx4 a[180:183], v5, s[8:11], s25 offen sc1
    s_add_u32 s25, s24, 6144
    buffer_load_dwordx2 a[184:185], v5, s[8:11], s25 offen sc1
    s_add_u32 s25, s24, 7168
    buffer_load_dwordx4 a[186:189], v5, s[8:11], s25 offen sc1
    s_add_u32 s25, s24, 8192
    buffer_load_dwordx2 a[190:191], v5, s[8:11], s25 offen sc1
    s_add_u32 s25, s24, 9216
    buffer_load_dwordx4 a[192:195], v5, s[8:11], s25 offen sc1
    s_add_u32 s25, s24, 10240
    buffer_load_dwordx4 a[196:199], v5, s[8:11], s25 offen sc1
    s_add_u32 s25, s24, 11264
    buffer_load_dwordx2 a[200:201], v5, s[8:11], s25 offen sc1
    s_add_u32 s25, s24, 12288
    buffer_load_dwordx4 a[202:205], v5, s[8:11], s25 offen sc1
    s_add_u32 s25, s24, 13312
    buffer_load_dwordx2 a[206:207], v5, s[8:11], s25 offen sc1
    s_add_u32 s25, s24, 14336
    buffer_load_dwordx4 a[208:211], v5, s[8:11], s25 offen sc1
    s_add_u32 s25, s24, 15360
    buffer_load_dwordx4 a[212:215], v5, s[8:11], s25 offen sc1
    s_add_u32 s25, s24, 16384
    buffer_load_dwordx4 a[216:219], v5, s[8:11], s25 offen sc1
    s_add_u32 s25, s24, 17408
    buffer_load_dwordx4 a[220:223], v5, s[8:11], s25 offen sc1
    s_add_u32 s25, s24, 18432
    buffer_load_dwordx4 a[224:227], v5, s[8:11], s25 offen sc1
    s_add_u32 s25, s24, 19456
    buffer_load_dwordx4 a[228:231], v5, s[8:11], s25 offen sc1
    s_add_u32 s25, s24, 20480
    buffer_load_dwordx2 a[232:233], v5, s[8:11], s25 offen sc1
    s_add_u32 s25, s24, 21504
    buffer_load_dwordx4 a[234:237], v5, s[8:11], s25 offen sc1
    s_add_u32 s25, s24, 22528
    buffer_load_dwordx2 a[238:239], v5, s[8:11], s25 offen sc1
    s_add_u32 s25, s24, 23552
    buffer_load_dwordx4 a[240:243], v5, s[8:11], s25 offen sc1
    s_add_u32 s25, s24, 24576
    buffer_load_dwordx4 a[244:247], v5, s[8:11], s25 offen sc1
    s_add_u32 s25, s24, 25600
    buffer_load_dwordx2 a[248:249], v5, s[8:11], s25 offen sc1
    s_add_u32 s25, s24, 26624
    buffer_load_dwordx4 a[250:253], v5, s[8:11], s25 offen sc1
    s_add_u32 s25, s24, 27648
    buffer_load_dwordx2 a[254:255], v5, s[8:11], s25 offen sc1
    s_waitcnt vmcnt(0)
    v_mfma_f32_16x16x32_bf16 v[132:135], a[192:195], v[16:19], 0
    v_mfma_f32_16x16x32_bf16 v[136:139], a[202:205], v[20:23], 0
    v_mfma_f32_16x16x32_bf16 v[112:115], a[160:163], v[16:19], 0
    v_mfma_f32_16x16x32_bf16 v[116:119], a[164:167], v[16:19], 0
    v_mfma_f32_16x16x32_bf16 v[120:123], a[172:175], v[16:19], 0
    v_mfma_f32_16x16x32_bf16 v[124:127], a[180:183], v[20:23], 0
    v_mfma_f32_16x16x32_bf16 v[128:131], a[186:189], v[20:23], 0
    v_mfma_f32_16x16x32_bf16 v[132:135], a[196:199], v[20:23], v[132:135]
    v_mfma_f32_16x16x32_bf16 v[116:119], a[168:171], v[20:23], v[116:119]
    v_mfma_f32_16x16x32_bf16 v[120:123], a[176:179], v[20:23], v[120:123]
    v_mfma_f32_16x16x16_bf16 v[136:139], a[206:207], v[24:25], v[136:139]
    s_nop 0
    v_mfma_f32_16x16x16_bf16 v[124:127], a[184:185], v[24:25], v[124:127]
    v_mfma_f32_16x16x16_bf16 v[128:131], a[190:191], v[24:25], v[128:131]
    v_mfma_f32_16x16x16_bf16 v[132:135], a[200:201], v[24:25], v[132:135]
    v_mfma_f32_16x16x32_bf16 v[160:163], a[240:243], v[26:29], 0
    v_mfma_f32_16x16x32_bf16 v[164:167], a[250:253], v[30:33], 0
    v_mfma_f32_16x16x32_bf16 v[140:143], a[208:211], v[26:29], 0
    v_mfma_f32_16x16x32_bf16 v[144:147], a[212:215], v[26:29], 0
    v_mfma_f32_16x16x32_bf16 v[148:151], a[220:223], v[26:29], 0
    v_mfma_f32_16x16x32_bf16 v[152:155], a[228:231], v[30:33], 0
    v_mfma_f32_16x16x32_bf16 v[156:159], a[234:237], v[30:33], 0
    v_mfma_f32_16x16x32_bf16 v[160:163], a[244:247], v[30:33], v[160:163]
    v_mfma_f32_16x16x32_bf16 v[144:147], a[216:219], v[30:33], v[144:147]
    v_mfma_f32_16x16x32_bf16 v[148:151], a[224:227], v[30:33], v[148:151]
    v_mfma_f32_16x16x16_bf16 v[164:167], a[254:255], v[34:35], v[164:167]
    s_nop 0
    v_mfma_f32_16x16x16_bf16 v[152:155], a[232:233], v[34:35], v[152:155]
    v_mfma_f32_16x16x16_bf16 v[156:159], a[238:239], v[34:35], v[156:159]
    v_mfma_f32_16x16x16_bf16 v[160:163], a[248:249], v[34:35], v[160:163]
    v_add_f32 v132, s54, v132
    v_add_f32 v133, s54, v133
    v_add_f32 v134, s54, v134
    v_add_f32 v135, s54, v135
    v_add_f32 v136, s54, v136
    v_rcp_f32 v132, v132
    v_rcp_f32 v133, v133
    v_rcp_f32 v134, v134
    v_rcp_f32 v135, v135
    v_rcp_f32 v136, v136
    v_mul_f32 v112, v112, v132
    v_mul_f32 v113, v113, v132
    v_mul_f32 v114, v114, v132
    v_mul_f32 v115, v115, v132
    v_cvt_pk_bf16_f32 v168, v112, v113
    v_cvt_pk_bf16_f32 v169, v114, v115
    v_mul_f32 v116, v116, v133
    v_mul_f32 v117, v117, v133
    v_mul_f32 v118, v118, v133
    v_mul_f32 v119, v119, v133
    v_cvt_pk_bf16_f32 v170, v116, v117
    v_cvt_pk_bf16_f32 v171, v118, v119
    v_mul_f32 v120, v120, v134
    v_mul_f32 v121, v121, v134
    v_mul_f32 v122, v122, v134
    v_mul_f32 v123, v123, v134
    v_cvt_pk_bf16_f32 v172, v120, v121
    v_cvt_pk_bf16_f32 v173, v122, v123
    v_mul_f32 v124, v124, v135
    v_mul_f32 v125, v125, v135
    v_mul_f32 v126, v126, v135
    v_mul_f32 v127, v127, v135
    v_cvt_pk_bf16_f32 v174, v124, v125
    v_cvt_pk_bf16_f32 v175, v126, v127
    v_mul_f32 v128, v128, v136
    v_mul_f32 v129, v129, v136
    v_mul_f32 v130, v130, v136
    v_mul_f32 v131, v131, v136
    v_cvt_pk_bf16_f32 v176, v128, v129
    v_cvt_pk_bf16_f32 v177, v130, v131
    v_add_f32 v160, s54, v160
    v_add_f32 v161, s54, v161
    v_add_f32 v162, s54, v162
    v_add_f32 v163, s54, v163
    v_add_f32 v164, s54, v164
    v_rcp_f32 v160, v160
    v_rcp_f32 v161, v161
    v_rcp_f32 v162, v162
    v_rcp_f32 v163, v163
    v_rcp_f32 v164, v164
    v_mul_f32 v140, v140, v160
    v_mul_f32 v141, v141, v160
    v_mul_f32 v142, v142, v160
    v_mul_f32 v143, v143, v160
    v_cvt_pk_bf16_f32 v178, v140, v141
    v_cvt_pk_bf16_f32 v179, v142, v143
    v_mul_f32 v144, v144, v161
    v_mul_f32 v145, v145, v161
    v_mul_f32 v146, v146, v161
    v_mul_f32 v147, v147, v161
    v_cvt_pk_bf16_f32 v180, v144, v145
    v_cvt_pk_bf16_f32 v181, v146, v147
    v_mul_f32 v148, v148, v162
    v_mul_f32 v149, v149, v162
    v_mul_f32 v150, v150, v162
    v_mul_f32 v151, v151, v162
    v_cvt_pk_bf16_f32 v182, v148, v149
    v_cvt_pk_bf16_f32 v183, v150, v151
    v_mul_f32 v152, v152, v163
    v_mul_f32 v153, v153, v163
    v_mul_f32 v154, v154, v163
    v_mul_f32 v155, v155, v163
    v_cvt_pk_bf16_f32 v184, v152, v153
    v_cvt_pk_bf16_f32 v185, v154, v155
    v_mul_f32 v156, v156, v164
    v_mul_f32 v157, v157, v164
    v_mul_f32 v158, v158, v164
    v_mul_f32 v159, v159, v164
    v_cvt_pk_bf16_f32 v186, v156, v157
    v_cvt_pk_bf16_f32 v187, v158, v159
    v_mfma_f32_16x16x32_bf16 v[132:135], a[192:195], v[36:39], 0
    v_mfma_f32_16x16x32_bf16 v[136:139], a[202:205], v[40:43], 0
    v_mfma_f32_16x16x32_bf16 v[112:115], a[160:163], v[36:39], 0
    v_mfma_f32_16x16x32_bf16 v[116:119], a[164:167], v[36:39], 0
    v_mfma_f32_16x16x32_bf16 v[120:123], a[172:175], v[36:39], 0
    v_mfma_f32_16x16x32_bf16 v[124:127], a[180:183], v[40:43], 0
    v_mfma_f32_16x16x32_bf16 v[128:131], a[186:189], v[40:43], 0
    v_mfma_f32_16x16x32_bf16 v[132:135], a[196:199], v[40:43], v[132:135]
    v_mfma_f32_16x16x32_bf16 v[116:119], a[168:171], v[40:43], v[116:119]
    v_mfma_f32_16x16x32_bf16 v[120:123], a[176:179], v[40:43], v[120:123]
    v_mfma_f32_16x16x16_bf16 v[136:139], a[206:207], v[44:45], v[136:139]
    s_nop 0
    v_mfma_f32_16x16x16_bf16 v[124:127], a[184:185], v[44:45], v[124:127]
    v_mfma_f32_16x16x16_bf16 v[128:131], a[190:191], v[44:45], v[128:131]
    v_mfma_f32_16x16x16_bf16 v[132:135], a[200:201], v[44:45], v[132:135]
    v_mfma_f32_16x16x32_bf16 v[160:163], a[240:243], v[46:49], 0
    v_mfma_f32_16x16x32_bf16 v[164:167], a[250:253], v[50:53], 0
    v_mfma_f32_16x16x32_bf16 v[140:143], a[208:211], v[46:49], 0
    v_mfma_f32_16x16x32_bf16 v[144:147], a[212:215], v[46:49], 0
    v_mfma_f32_16x16x32_bf16 v[148:151], a[220:223], v[46:49], 0
    v_mfma_f32_16x16x32_bf16 v[152:155], a[228:231], v[50:53], 0
    v_mfma_f32_16x16x32_bf16 v[156:159], a[234:237], v[50:53], 0
    v_mfma_f32_16x16x32_bf16 v[160:163], a[244:247], v[50:53], v[160:163]
    v_mfma_f32_16x16x32_bf16 v[144:147], a[216:219], v[50:53], v[144:147]
    v_mfma_f32_16x16x32_bf16 v[148:151], a[224:227], v[50:53], v[148:151]
    v_mfma_f32_16x16x16_bf16 v[164:167], a[254:255], v[54:55], v[164:167]
    s_nop 0
    v_mfma_f32_16x16x16_bf16 v[152:155], a[232:233], v[54:55], v[152:155]
    v_mfma_f32_16x16x16_bf16 v[156:159], a[238:239], v[54:55], v[156:159]
    v_mfma_f32_16x16x16_bf16 v[160:163], a[248:249], v[54:55], v[160:163]
    v_add_f32 v132, s54, v132
    v_add_f32 v133, s54, v133
    v_add_f32 v134, s54, v134
    v_add_f32 v135, s54, v135
    v_add_f32 v136, s54, v136
    v_rcp_f32 v132, v132
    v_rcp_f32 v133, v133
    v_rcp_f32 v134, v134
    v_rcp_f32 v135, v135
    v_rcp_f32 v136, v136
    v_mul_f32 v112, v112, v132
    v_mul_f32 v113, v113, v132
    v_mul_f32 v114, v114, v132
    v_mul_f32 v115, v115, v132
    v_cvt_pk_bf16_f32 v188, v112, v113
    v_cvt_pk_bf16_f32 v189, v114, v115
    v_mul_f32 v116, v116, v133
    v_mul_f32 v117, v117, v133
    v_mul_f32 v118, v118, v133
    v_mul_f32 v119, v119, v133
    v_cvt_pk_bf16_f32 v190, v116, v117
    v_cvt_pk_bf16_f32 v191, v118, v119
    v_mul_f32 v120, v120, v134
    v_mul_f32 v121, v121, v134
    v_mul_f32 v122, v122, v134
    v_mul_f32 v123, v123, v134
    v_cvt_pk_bf16_f32 v192, v120, v121
    v_cvt_pk_bf16_f32 v193, v122, v123
    v_mul_f32 v124, v124, v135
    v_mul_f32 v125, v125, v135
    v_mul_f32 v126, v126, v135
    v_mul_f32 v127, v127, v135
    v_cvt_pk_bf16_f32 v194, v124, v125
    v_cvt_pk_bf16_f32 v195, v126, v127
    v_mul_f32 v128, v128, v136
    v_mul_f32 v129, v129, v136
    v_mul_f32 v130, v130, v136
    v_mul_f32 v131, v131, v136
    v_cvt_pk_bf16_f32 v196, v128, v129
    v_cvt_pk_bf16_f32 v197, v130, v131
    v_add_f32 v160, s54, v160
    v_add_f32 v161, s54, v161
    v_add_f32 v162, s54, v162
    v_add_f32 v163, s54, v163
    v_add_f32 v164, s54, v164
    v_rcp_f32 v160, v160
    v_rcp_f32 v161, v161
    v_rcp_f32 v162, v162
    v_rcp_f32 v163, v163
    v_rcp_f32 v164, v164
    v_mul_f32 v140, v140, v160
    v_mul_f32 v141, v141, v160
    v_mul_f32 v142, v142, v160
    v_mul_f32 v143, v143, v160
    v_cvt_pk_bf16_f32 v198, v140, v141
    v_cvt_pk_bf16_f32 v199, v142, v143
    v_mul_f32 v144, v144, v161
    v_mul_f32 v145, v145, v161
    v_mul_f32 v146, v146, v161
    v_mul_f32 v147, v147, v161
    v_cvt_pk_bf16_f32 v200, v144, v145
    v_cvt_pk_bf16_f32 v201, v146, v147
    v_mul_f32 v148, v148, v162
    v_mul_f32 v149, v149, v162
    v_mul_f32 v150, v150, v162
    v_mul_f32 v151, v151, v162
    v_cvt_pk_bf16_f32 v202, v148, v149
    v_cvt_pk_bf16_f32 v203, v150, v151
    v_mul_f32 v152, v152, v163
    v_mul_f32 v153, v153, v163
    v_mul_f32 v154, v154, v163
    v_mul_f32 v155, v155, v163
    v_cvt_pk_bf16_f32 v204, v152, v153
    v_cvt_pk_bf16_f32 v205, v154, v155
    v_mul_f32 v156, v156, v164
    v_mul_f32 v157, v157, v164
    v_mul_f32 v158, v158, v164
    v_mul_f32 v159, v159, v164
    v_cvt_pk_bf16_f32 v206, v156, v157
    v_cvt_pk_bf16_f32 v207, v158, v159
    v_add_u32 v14, s42, v13
    ds_write_b128 v14, v[168:171] offset:0
    ds_write_b128 v14, v[172:175] offset:1024
    ds_write_b128 v14, v[176:179] offset:2048
    ds_write_b128 v14, v[180:183] offset:3072
    ds_write_b128 v14, v[184:187] offset:4096
    ds_write_b128 v14, v[188:191] offset:20480
    ds_write_b128 v14, v[192:195] offset:21504
    ds_write_b128 v14, v[196:199] offset:22528
    ds_write_b128 v14, v[200:203] offset:23552
    ds_write_b128 v14, v[204:207] offset:24576
    s_waitcnt lgkmcnt(0)
    s_barrier
interleave_layers__linear_attn_block__memory_aug_recurrent_mem_tr__prompt_kernel_k3_seg:
    v_add_u32 v15, s42, v5
    ds_read_b128 v[208:211], v15 offset:0
    ds_read_b128 v[212:215], v15 offset:20480
    ds_read_b128 v[216:219], v15 offset:1024
    ds_read_b128 v[220:223], v15 offset:21504
    ds_read_b128 v[224:227], v15 offset:2048
    ds_read_b128 v[228:231], v15 offset:22528
    ds_read_b128 v[232:235], v15 offset:3072
    ds_read_b128 v[236:239], v15 offset:23552
    s_waitcnt lgkmcnt(6)
    v_mfma_f32_16x16x32_bf16 v[240:243], a[0:3], v[208:211], 0
    v_mfma_f32_16x16x32_bf16 v[244:247], a[4:7], v[208:211], 0
    v_mfma_f32_16x16x32_bf16 v[248:251], a[0:3], v[212:215], 0
    v_mfma_f32_16x16x32_bf16 v[252:255], a[4:7], v[212:215], 0
    ds_read_b128 v[208:211], v15 offset:4096
    ds_read_b128 v[212:215], v15 offset:24576
    s_waitcnt lgkmcnt(6)
    v_mfma_f32_16x16x32_bf16 v[240:243], a[8:11], v[216:219], v[240:243]
    v_mfma_f32_16x16x32_bf16 v[244:247], a[12:15], v[216:219], v[244:247]
    v_mfma_f32_16x16x32_bf16 v[248:251], a[8:11], v[220:223], v[248:251]
    v_mfma_f32_16x16x32_bf16 v[252:255], a[12:15], v[220:223], v[252:255]
    ds_read_b128 v[216:219], v15 offset:5120
    ds_read_b128 v[220:223], v15 offset:25600
    s_waitcnt lgkmcnt(6)
    v_mfma_f32_16x16x32_bf16 v[240:243], a[16:19], v[224:227], v[240:243]
    v_mfma_f32_16x16x32_bf16 v[244:247], a[20:23], v[224:227], v[244:247]
    v_mfma_f32_16x16x32_bf16 v[248:251], a[16:19], v[228:231], v[248:251]
    v_mfma_f32_16x16x32_bf16 v[252:255], a[20:23], v[228:231], v[252:255]
    ds_read_b128 v[224:227], v15 offset:6144
    ds_read_b128 v[228:231], v15 offset:26624
    s_waitcnt lgkmcnt(6)
    v_mfma_f32_16x16x32_bf16 v[240:243], a[24:27], v[232:235], v[240:243]
    v_mfma_f32_16x16x32_bf16 v[244:247], a[28:31], v[232:235], v[244:247]
    v_mfma_f32_16x16x32_bf16 v[248:251], a[24:27], v[236:239], v[248:251]
    v_mfma_f32_16x16x32_bf16 v[252:255], a[28:31], v[236:239], v[252:255]
    ds_read_b128 v[232:235], v15 offset:7168
    ds_read_b128 v[236:239], v15 offset:27648
    s_waitcnt lgkmcnt(6)
    v_mfma_f32_16x16x32_bf16 v[240:243], a[32:35], v[208:211], v[240:243]
    v_mfma_f32_16x16x32_bf16 v[244:247], a[36:39], v[208:211], v[244:247]
    v_mfma_f32_16x16x32_bf16 v[248:251], a[32:35], v[212:215], v[248:251]
    v_mfma_f32_16x16x32_bf16 v[252:255], a[36:39], v[212:215], v[252:255]
    ds_read_b128 v[208:211], v15 offset:8192
    ds_read_b128 v[212:215], v15 offset:28672
    s_waitcnt lgkmcnt(6)
    v_mfma_f32_16x16x32_bf16 v[240:243], a[40:43], v[216:219], v[240:243]
    v_mfma_f32_16x16x32_bf16 v[244:247], a[44:47], v[216:219], v[244:247]
    v_mfma_f32_16x16x32_bf16 v[248:251], a[40:43], v[220:223], v[248:251]
    v_mfma_f32_16x16x32_bf16 v[252:255], a[44:47], v[220:223], v[252:255]
    ds_read_b128 v[216:219], v15 offset:9216
    ds_read_b128 v[220:223], v15 offset:29696
    s_waitcnt lgkmcnt(6)
    v_mfma_f32_16x16x32_bf16 v[240:243], a[48:51], v[224:227], v[240:243]
    v_mfma_f32_16x16x32_bf16 v[244:247], a[52:55], v[224:227], v[244:247]
    v_mfma_f32_16x16x32_bf16 v[248:251], a[48:51], v[228:231], v[248:251]
    v_mfma_f32_16x16x32_bf16 v[252:255], a[52:55], v[228:231], v[252:255]
    ds_read_b128 v[224:227], v15 offset:10240
    ds_read_b128 v[228:231], v15 offset:30720
    s_waitcnt lgkmcnt(6)
    v_mfma_f32_16x16x32_bf16 v[240:243], a[56:59], v[232:235], v[240:243]
    v_mfma_f32_16x16x32_bf16 v[244:247], a[60:63], v[232:235], v[244:247]
    v_mfma_f32_16x16x32_bf16 v[248:251], a[56:59], v[236:239], v[248:251]
    v_mfma_f32_16x16x32_bf16 v[252:255], a[60:63], v[236:239], v[252:255]
    ds_read_b128 v[232:235], v15 offset:11264
    ds_read_b128 v[236:239], v15 offset:31744
    s_waitcnt lgkmcnt(6)
    v_mfma_f32_16x16x32_bf16 v[240:243], a[64:67], v[208:211], v[240:243]
    v_mfma_f32_16x16x32_bf16 v[244:247], a[68:71], v[208:211], v[244:247]
    v_mfma_f32_16x16x32_bf16 v[248:251], a[64:67], v[212:215], v[248:251]
    v_mfma_f32_16x16x32_bf16 v[252:255], a[68:71], v[212:215], v[252:255]
    ds_read_b128 v[208:211], v15 offset:12288
    ds_read_b128 v[212:215], v15 offset:32768
    s_waitcnt lgkmcnt(6)
    v_mfma_f32_16x16x32_bf16 v[240:243], a[72:75], v[216:219], v[240:243]
    v_mfma_f32_16x16x32_bf16 v[244:247], a[76:79], v[216:219], v[244:247]
    v_mfma_f32_16x16x32_bf16 v[248:251], a[72:75], v[220:223], v[248:251]
    v_mfma_f32_16x16x32_bf16 v[252:255], a[76:79], v[220:223], v[252:255]
    ds_read_b128 v[216:219], v15 offset:13312
    ds_read_b128 v[220:223], v15 offset:33792
    s_waitcnt lgkmcnt(6)
    v_mfma_f32_16x16x32_bf16 v[240:243], a[80:83], v[224:227], v[240:243]
    v_mfma_f32_16x16x32_bf16 v[244:247], a[84:87], v[224:227], v[244:247]
    v_mfma_f32_16x16x32_bf16 v[248:251], a[80:83], v[228:231], v[248:251]
    v_mfma_f32_16x16x32_bf16 v[252:255], a[84:87], v[228:231], v[252:255]
    ds_read_b128 v[224:227], v15 offset:14336
    ds_read_b128 v[228:231], v15 offset:34816
    s_waitcnt lgkmcnt(6)
    v_mfma_f32_16x16x32_bf16 v[240:243], a[88:91], v[232:235], v[240:243]
    v_mfma_f32_16x16x32_bf16 v[244:247], a[92:95], v[232:235], v[244:247]
    v_mfma_f32_16x16x32_bf16 v[248:251], a[88:91], v[236:239], v[248:251]
    v_mfma_f32_16x16x32_bf16 v[252:255], a[92:95], v[236:239], v[252:255]
    ds_read_b128 v[232:235], v15 offset:15360
    ds_read_b128 v[236:239], v15 offset:35840
    s_waitcnt lgkmcnt(6)
    v_mfma_f32_16x16x32_bf16 v[240:243], a[96:99], v[208:211], v[240:243]
    v_mfma_f32_16x16x32_bf16 v[244:247], a[100:103], v[208:211], v[244:247]
    v_mfma_f32_16x16x32_bf16 v[248:251], a[96:99], v[212:215], v[248:251]
    v_mfma_f32_16x16x32_bf16 v[252:255], a[100:103], v[212:215], v[252:255]
    ds_read_b128 v[208:211], v15 offset:16384
    ds_read_b128 v[212:215], v15 offset:36864
    s_waitcnt lgkmcnt(6)
    v_mfma_f32_16x16x32_bf16 v[240:243], a[104:107], v[216:219], v[240:243]
    v_mfma_f32_16x16x32_bf16 v[244:247], a[108:111], v[216:219], v[244:247]
    v_mfma_f32_16x16x32_bf16 v[248:251], a[104:107], v[220:223], v[248:251]
    v_mfma_f32_16x16x32_bf16 v[252:255], a[108:111], v[220:223], v[252:255]
    ds_read_b128 v[216:219], v15 offset:17408
    ds_read_b128 v[220:223], v15 offset:37888
    s_waitcnt lgkmcnt(6)
    v_mfma_f32_16x16x32_bf16 v[240:243], a[112:115], v[224:227], v[240:243]
    v_mfma_f32_16x16x32_bf16 v[244:247], a[116:119], v[224:227], v[244:247]
    v_mfma_f32_16x16x32_bf16 v[248:251], a[112:115], v[228:231], v[248:251]
    v_mfma_f32_16x16x32_bf16 v[252:255], a[116:119], v[228:231], v[252:255]
    ds_read_b128 v[224:227], v15 offset:18432
    ds_read_b128 v[228:231], v15 offset:38912
    s_waitcnt lgkmcnt(6)
    v_mfma_f32_16x16x32_bf16 v[240:243], a[120:123], v[232:235], v[240:243]
    v_mfma_f32_16x16x32_bf16 v[244:247], a[124:127], v[232:235], v[244:247]
    v_mfma_f32_16x16x32_bf16 v[248:251], a[120:123], v[236:239], v[248:251]
    v_mfma_f32_16x16x32_bf16 v[252:255], a[124:127], v[236:239], v[252:255]
    ds_read_b128 v[232:235], v15 offset:19456
    ds_read_b128 v[236:239], v15 offset:39936
    s_waitcnt lgkmcnt(6)
    v_mfma_f32_16x16x32_bf16 v[240:243], a[128:131], v[208:211], v[240:243]
    v_mfma_f32_16x16x32_bf16 v[244:247], a[132:135], v[208:211], v[244:247]
    v_mfma_f32_16x16x32_bf16 v[248:251], a[128:131], v[212:215], v[248:251]
    v_mfma_f32_16x16x32_bf16 v[252:255], a[132:135], v[212:215], v[252:255]
    s_waitcnt lgkmcnt(4)
    v_mfma_f32_16x16x32_bf16 v[240:243], a[136:139], v[216:219], v[240:243]
    v_mfma_f32_16x16x32_bf16 v[244:247], a[140:143], v[216:219], v[244:247]
    v_mfma_f32_16x16x32_bf16 v[248:251], a[136:139], v[220:223], v[248:251]
    v_mfma_f32_16x16x32_bf16 v[252:255], a[140:143], v[220:223], v[252:255]
    s_waitcnt lgkmcnt(2)
    v_mfma_f32_16x16x32_bf16 v[240:243], a[144:147], v[224:227], v[240:243]
    v_mfma_f32_16x16x32_bf16 v[244:247], a[148:151], v[224:227], v[244:247]
    v_mfma_f32_16x16x32_bf16 v[248:251], a[144:147], v[228:231], v[248:251]
    v_mfma_f32_16x16x32_bf16 v[252:255], a[148:151], v[228:231], v[252:255]
    s_waitcnt lgkmcnt(0)
    v_mfma_f32_16x16x32_bf16 v[240:243], a[152:155], v[232:235], v[240:243]
    v_mfma_f32_16x16x32_bf16 v[244:247], a[156:159], v[232:235], v[244:247]
    v_mfma_f32_16x16x32_bf16 v[248:251], a[152:155], v[236:239], v[248:251]
    v_mfma_f32_16x16x32_bf16 v[252:255], a[156:159], v[236:239], v[252:255]
    s_nop 4
    v_cvt_pk_bf16_f32 v208, v240, v241
    v_cvt_pk_bf16_f32 v209, v242, v243
    v_lshlrev_b32 v210, 16, v208
    v_and_b32 v211, 0xffff0000, v208
    v_lshlrev_b32 v212, 16, v96
    v_and_b32 v213, 0xffff0000, v96
    v_pk_add_f32 v[210:211], v[210:211], v[212:213]
    v_cvt_pk_bf16_f32 v216, v210, v211
    v_lshlrev_b32 v210, 16, v209
    v_and_b32 v211, 0xffff0000, v209
    v_lshlrev_b32 v212, 16, v97
    v_and_b32 v213, 0xffff0000, v97
    v_pk_add_f32 v[210:211], v[210:211], v[212:213]
    v_cvt_pk_bf16_f32 v217, v210, v211
    v_cvt_pk_bf16_f32 v208, v244, v245
    v_cvt_pk_bf16_f32 v209, v246, v247
    v_lshlrev_b32 v210, 16, v208
    v_and_b32 v211, 0xffff0000, v208
    v_lshlrev_b32 v212, 16, v98
    v_and_b32 v213, 0xffff0000, v98
    v_pk_add_f32 v[210:211], v[210:211], v[212:213]
    v_cvt_pk_bf16_f32 v218, v210, v211
    v_lshlrev_b32 v210, 16, v209
    v_and_b32 v211, 0xffff0000, v209
    v_lshlrev_b32 v212, 16, v99
    v_and_b32 v213, 0xffff0000, v99
    v_pk_add_f32 v[210:211], v[210:211], v[212:213]
    v_cvt_pk_bf16_f32 v219, v210, v211
    v_cvt_pk_bf16_f32 v208, v248, v249
    v_cvt_pk_bf16_f32 v209, v250, v251
    v_lshlrev_b32 v210, 16, v208
    v_and_b32 v211, 0xffff0000, v208
    v_lshlrev_b32 v212, 16, v100
    v_and_b32 v213, 0xffff0000, v100
    v_pk_add_f32 v[210:211], v[210:211], v[212:213]
    v_cvt_pk_bf16_f32 v220, v210, v211
    v_lshlrev_b32 v210, 16, v209
    v_and_b32 v211, 0xffff0000, v209
    v_lshlrev_b32 v212, 16, v101
    v_and_b32 v213, 0xffff0000, v101
    v_pk_add_f32 v[210:211], v[210:211], v[212:213]
    v_cvt_pk_bf16_f32 v221, v210, v211
    v_cvt_pk_bf16_f32 v208, v252, v253
    v_cvt_pk_bf16_f32 v209, v254, v255
    v_lshlrev_b32 v210, 16, v208
    v_and_b32 v211, 0xffff0000, v208
    v_lshlrev_b32 v212, 16, v102
    v_and_b32 v213, 0xffff0000, v102
    v_pk_add_f32 v[210:211], v[210:211], v[212:213]
    v_cvt_pk_bf16_f32 v222, v210, v211
    v_lshlrev_b32 v210, 16, v209
    v_and_b32 v211, 0xffff0000, v209
    v_lshlrev_b32 v212, 16, v103
    v_and_b32 v213, 0xffff0000, v103
    v_pk_add_f32 v[210:211], v[210:211], v[212:213]
    v_cvt_pk_bf16_f32 v223, v210, v211
    s_add_u32 s25, s43, 20480
    buffer_store_dwordx4 v[216:219], v12, s[8:11], s43 offen sc1
    buffer_store_dwordx4 v[220:223], v12, s[8:11], s25 offen sc1
    s_add_u32 s40, s40, 1
    s_add_u32 s43, s43, s77
    s_cmp_ge_u32 s40, s76
    s_cbranch_scc1 interleave_layers__linear_attn_block__memory_aug_recurrent_mem_tr__prompt_kernel_k3_done
    s_cmp_eq_u32 s40, 1
    s_cbranch_scc0 interleave_layers__linear_attn_block__memory_aug_recurrent_mem_tr__prompt_kernel_k3q11
    s_waitcnt vmcnt(0)
    s_barrier
    s_lshl_b32 s24, s92, 10
    s_lshl_b32 s25, s78, 2
    s_add_u32 s24, s24, s25
    s_add_u32 s24, s24, 23105536
    s_cmp_eq_u32 s3, 0
    s_cbranch_scc0 interleave_layers__linear_attn_block__memory_aug_recurrent_mem_tr__prompt_kernel_pb12
    v_lshlrev_b32 v14, 7, v1
    v_add_u32 v14, s24, v14
    v_mov_b32 v15, 2146435072
    v_cmp_le_u32 vcc, 8, v1
    s_nop 1
    v_cndmask_b32 v14, v14, v15, vcc
    v_mov_b32 v15, s40
    buffer_store_dword v15, v14, s[8:11], 0 offen sc1
interleave_layers__linear_attn_block__memory_aug_recurrent_mem_tr__prompt_kernel_pb12:
interleave_layers__linear_attn_block__memory_aug_recurrent_mem_tr__prompt_kernel_k3q11:
    s_xor_b32 s42, s42, 40960
    s_waitcnt vmcnt(2)
    v_mfma_f32_16x16x32_bf16 v[132:135], a[192:195], v[56:59], 0
    v_mfma_f32_16x16x32_bf16 v[136:139], a[202:205], v[60:63], 0
    v_mfma_f32_16x16x32_bf16 v[112:115], a[160:163], v[56:59], 0
    v_mfma_f32_16x16x32_bf16 v[116:119], a[164:167], v[56:59], 0
    v_mfma_f32_16x16x32_bf16 v[120:123], a[172:175], v[56:59], 0
    v_mfma_f32_16x16x32_bf16 v[124:127], a[180:183], v[60:63], 0
    v_mfma_f32_16x16x32_bf16 v[128:131], a[186:189], v[60:63], 0
    v_mfma_f32_16x16x32_bf16 v[132:135], a[196:199], v[60:63], v[132:135]
    v_mfma_f32_16x16x32_bf16 v[116:119], a[168:171], v[60:63], v[116:119]
    v_mfma_f32_16x16x32_bf16 v[120:123], a[176:179], v[60:63], v[120:123]
    v_mfma_f32_16x16x16_bf16 v[136:139], a[206:207], v[64:65], v[136:139]
    s_nop 0
    v_mfma_f32_16x16x16_bf16 v[124:127], a[184:185], v[64:65], v[124:127]
    v_mfma_f32_16x16x16_bf16 v[128:131], a[190:191], v[64:65], v[128:131]
    v_mfma_f32_16x16x16_bf16 v[132:135], a[200:201], v[64:65], v[132:135]
    v_mfma_f32_16x16x32_bf16 v[160:163], a[240:243], v[66:69], 0
    v_mfma_f32_16x16x32_bf16 v[164:167], a[250:253], v[70:73], 0
    v_mfma_f32_16x16x32_bf16 v[140:143], a[208:211], v[66:69], 0
    v_mfma_f32_16x16x32_bf16 v[144:147], a[212:215], v[66:69], 0
    v_mfma_f32_16x16x32_bf16 v[148:151], a[220:223], v[66:69], 0
    v_mfma_f32_16x16x32_bf16 v[152:155], a[228:231], v[70:73], 0
    v_mfma_f32_16x16x32_bf16 v[156:159], a[234:237], v[70:73], 0
    v_mfma_f32_16x16x32_bf16 v[160:163], a[244:247], v[70:73], v[160:163]
    v_mfma_f32_16x16x32_bf16 v[144:147], a[216:219], v[70:73], v[144:147]
    v_mfma_f32_16x16x32_bf16 v[148:151], a[224:227], v[70:73], v[148:151]
    v_mfma_f32_16x16x16_bf16 v[164:167], a[254:255], v[74:75], v[164:167]
    s_nop 0
    v_mfma_f32_16x16x16_bf16 v[152:155], a[232:233], v[74:75], v[152:155]
    v_mfma_f32_16x16x16_bf16 v[156:159], a[238:239], v[74:75], v[156:159]
    v_mfma_f32_16x16x16_bf16 v[160:163], a[248:249], v[74:75], v[160:163]
    v_add_f32 v132, s54, v132
    v_add_f32 v133, s54, v133
    v_add_f32 v134, s54, v134
    v_add_f32 v135, s54, v135
    v_add_f32 v136, s54, v136
    v_rcp_f32 v132, v132
    v_rcp_f32 v133, v133
    v_rcp_f32 v134, v134
    v_rcp_f32 v135, v135
    v_rcp_f32 v136, v136
    v_mul_f32 v112, v112, v132
    v_mul_f32 v113, v113, v132
    v_mul_f32 v114, v114, v132
    v_mul_f32 v115, v115, v132
    v_cvt_pk_bf16_f32 v168, v112, v113
    v_cvt_pk_bf16_f32 v169, v114, v115
    v_mul_f32 v116, v116, v133
    v_mul_f32 v117, v117, v133
    v_mul_f32 v118, v118, v133
    v_mul_f32 v119, v119, v133
    v_cvt_pk_bf16_f32 v170, v116, v117
    v_cvt_pk_bf16_f32 v171, v118, v119
    v_mul_f32 v120, v120, v134
    v_mul_f32 v121, v121, v134
    v_mul_f32 v122, v122, v134
    v_mul_f32 v123, v123, v134
    v_cvt_pk_bf16_f32 v172, v120, v121
    v_cvt_pk_bf16_f32 v173, v122, v123
    v_mul_f32 v124, v124, v135
    v_mul_f32 v125, v125, v135
    v_mul_f32 v126, v126, v135
    v_mul_f32 v127, v127, v135
    v_cvt_pk_bf16_f32 v174, v124, v125
    v_cvt_pk_bf16_f32 v175, v126, v127
    v_mul_f32 v128, v128, v136
    v_mul_f32 v129, v129, v136
    v_mul_f32 v130, v130, v136
    v_mul_f32 v131, v131, v136
    v_cvt_pk_bf16_f32 v176, v128, v129
    v_cvt_pk_bf16_f32 v177, v130, v131
    v_add_f32 v160, s54, v160
    v_add_f32 v161, s54, v161
    v_add_f32 v162, s54, v162
    v_add_f32 v163, s54, v163
    v_add_f32 v164, s54, v164
    v_rcp_f32 v160, v160
    v_rcp_f32 v161, v161
    v_rcp_f32 v162, v162
    v_rcp_f32 v163, v163
    v_rcp_f32 v164, v164
    v_mul_f32 v140, v140, v160
    v_mul_f32 v141, v141, v160
    v_mul_f32 v142, v142, v160
    v_mul_f32 v143, v143, v160
    v_cvt_pk_bf16_f32 v178, v140, v141
    v_cvt_pk_bf16_f32 v179, v142, v143
    v_mul_f32 v144, v144, v161
    v_mul_f32 v145, v145, v161
    v_mul_f32 v146, v146, v161
    v_mul_f32 v147, v147, v161
    v_cvt_pk_bf16_f32 v180, v144, v145
    v_cvt_pk_bf16_f32 v181, v146, v147
    v_mul_f32 v148, v148, v162
    v_mul_f32 v149, v149, v162
    v_mul_f32 v150, v150, v162
    v_mul_f32 v151, v151, v162
    v_cvt_pk_bf16_f32 v182, v148, v149
    v_cvt_pk_bf16_f32 v183, v150, v151
    v_mul_f32 v152, v152, v163
    v_mul_f32 v153, v153, v163
    v_mul_f32 v154, v154, v163
    v_mul_f32 v155, v155, v163
    v_cvt_pk_bf16_f32 v184, v152, v153
    v_cvt_pk_bf16_f32 v185, v154, v155
    v_mul_f32 v156, v156, v164
    v_mul_f32 v157, v157, v164
    v_mul_f32 v158, v158, v164
    v_mul_f32 v159, v159, v164
    v_cvt_pk_bf16_f32 v186, v156, v157
    v_cvt_pk_bf16_f32 v187, v158, v159
    v_mfma_f32_16x16x32_bf16 v[132:135], a[192:195], v[76:79], 0
    v_mfma_f32_16x16x32_bf16 v[136:139], a[202:205], v[80:83], 0
    v_mfma_f32_16x16x32_bf16 v[112:115], a[160:163], v[76:79], 0
    v_mfma_f32_16x16x32_bf16 v[116:119], a[164:167], v[76:79], 0
    v_mfma_f32_16x16x32_bf16 v[120:123], a[172:175], v[76:79], 0
    v_mfma_f32_16x16x32_bf16 v[124:127], a[180:183], v[80:83], 0
    v_mfma_f32_16x16x32_bf16 v[128:131], a[186:189], v[80:83], 0
    v_mfma_f32_16x16x32_bf16 v[132:135], a[196:199], v[80:83], v[132:135]
    v_mfma_f32_16x16x32_bf16 v[116:119], a[168:171], v[80:83], v[116:119]
    v_mfma_f32_16x16x32_bf16 v[120:123], a[176:179], v[80:83], v[120:123]
    v_mfma_f32_16x16x16_bf16 v[136:139], a[206:207], v[84:85], v[136:139]
    s_nop 0
    v_mfma_f32_16x16x16_bf16 v[124:127], a[184:185], v[84:85], v[124:127]
    v_mfma_f32_16x16x16_bf16 v[128:131], a[190:191], v[84:85], v[128:131]
    v_mfma_f32_16x16x16_bf16 v[132:135], a[200:201], v[84:85], v[132:135]
    v_mfma_f32_16x16x32_bf16 v[160:163], a[240:243], v[86:89], 0
    v_mfma_f32_16x16x32_bf16 v[164:167], a[250:253], v[90:93], 0
    v_mfma_f32_16x16x32_bf16 v[140:143], a[208:211], v[86:89], 0
    v_mfma_f32_16x16x32_bf16 v[144:147], a[212:215], v[86:89], 0
    v_mfma_f32_16x16x32_bf16 v[148:151], a[220:223], v[86:89], 0
    v_mfma_f32_16x16x32_bf16 v[152:155], a[228:231], v[90:93], 0
    v_mfma_f32_16x16x32_bf16 v[156:159], a[234:237], v[90:93], 0
    v_mfma_f32_16x16x32_bf16 v[160:163], a[244:247], v[90:93], v[160:163]
    v_mfma_f32_16x16x32_bf16 v[144:147], a[216:219], v[90:93], v[144:147]
    v_mfma_f32_16x16x32_bf16 v[148:151], a[224:227], v[90:93], v[148:151]
    v_mfma_f32_16x16x16_bf16 v[164:167], a[254:255], v[94:95], v[164:167]
    s_nop 0
    v_mfma_f32_16x16x16_bf16 v[152:155], a[232:233], v[94:95], v[152:155]
    v_mfma_f32_16x16x16_bf16 v[156:159], a[238:239], v[94:95], v[156:159]
    v_mfma_f32_16x16x16_bf16 v[160:163], a[248:249], v[94:95], v[160:163]
    v_add_f32 v132, s54, v132
    v_add_f32 v133, s54, v133
    v_add_f32 v134, s54, v134
    v_add_f32 v135, s54, v135
    v_add_f32 v136, s54, v136
    v_rcp_f32 v132, v132
    v_rcp_f32 v133, v133
    v_rcp_f32 v134, v134
    v_rcp_f32 v135, v135
    v_rcp_f32 v136, v136
    v_mul_f32 v112, v112, v132
    v_mul_f32 v113, v113, v132
    v_mul_f32 v114, v114, v132
    v_mul_f32 v115, v115, v132
    v_cvt_pk_bf16_f32 v188, v112, v113
    v_cvt_pk_bf16_f32 v189, v114, v115
    v_mul_f32 v116, v116, v133
    v_mul_f32 v117, v117, v133
    v_mul_f32 v118, v118, v133
    v_mul_f32 v119, v119, v133
    v_cvt_pk_bf16_f32 v190, v116, v117
    v_cvt_pk_bf16_f32 v191, v118, v119
    v_mul_f32 v120, v120, v134
    v_mul_f32 v121, v121, v134
    v_mul_f32 v122, v122, v134
    v_mul_f32 v123, v123, v134
    v_cvt_pk_bf16_f32 v192, v120, v121
    v_cvt_pk_bf16_f32 v193, v122, v123
    v_mul_f32 v124, v124, v135
    v_mul_f32 v125, v125, v135
    v_mul_f32 v126, v126, v135
    v_mul_f32 v127, v127, v135
    v_cvt_pk_bf16_f32 v194, v124, v125
    v_cvt_pk_bf16_f32 v195, v126, v127
    v_mul_f32 v128, v128, v136
    v_mul_f32 v129, v129, v136
    v_mul_f32 v130, v130, v136
    v_mul_f32 v131, v131, v136
    v_cvt_pk_bf16_f32 v196, v128, v129
    v_cvt_pk_bf16_f32 v197, v130, v131
    v_add_f32 v160, s54, v160
    v_add_f32 v161, s54, v161
    v_add_f32 v162, s54, v162
    v_add_f32 v163, s54, v163
    v_add_f32 v164, s54, v164
    v_rcp_f32 v160, v160
    v_rcp_f32 v161, v161
    v_rcp_f32 v162, v162
    v_rcp_f32 v163, v163
    v_rcp_f32 v164, v164
    v_mul_f32 v140, v140, v160
    v_mul_f32 v141, v141, v160
    v_mul_f32 v142, v142, v160
    v_mul_f32 v143, v143, v160
    v_cvt_pk_bf16_f32 v198, v140, v141
    v_cvt_pk_bf16_f32 v199, v142, v143
    v_mul_f32 v144, v144, v161
    v_mul_f32 v145, v145, v161
    v_mul_f32 v146, v146, v161
    v_mul_f32 v147, v147, v161
    v_cvt_pk_bf16_f32 v200, v144, v145
    v_cvt_pk_bf16_f32 v201, v146, v147
    v_mul_f32 v148, v148, v162
    v_mul_f32 v149, v149, v162
    v_mul_f32 v150, v150, v162
    v_mul_f32 v151, v151, v162
    v_cvt_pk_bf16_f32 v202, v148, v149
    v_cvt_pk_bf16_f32 v203, v150, v151
    v_mul_f32 v152, v152, v163
    v_mul_f32 v153, v153, v163
    v_mul_f32 v154, v154, v163
    v_mul_f32 v155, v155, v163
    v_cvt_pk_bf16_f32 v204, v152, v153
    v_cvt_pk_bf16_f32 v205, v154, v155
    v_mul_f32 v156, v156, v164
    v_mul_f32 v157, v157, v164
    v_mul_f32 v158, v158, v164
    v_mul_f32 v159, v159, v164
    v_cvt_pk_bf16_f32 v206, v156, v157
    v_cvt_pk_bf16_f32 v207, v158, v159
    v_add_u32 v14, s42, v13
    ds_write_b128 v14, v[168:171] offset:0
    ds_write_b128 v14, v[172:175] offset:1024
    ds_write_b128 v14, v[176:179] offset:2048
    ds_write_b128 v14, v[180:183] offset:3072
    ds_write_b128 v14, v[184:187] offset:4096
    ds_write_b128 v14, v[188:191] offset:20480
    ds_write_b128 v14, v[192:195] offset:21504
    ds_write_b128 v14, v[196:199] offset:22528
    ds_write_b128 v14, v[200:203] offset:23552
    ds_write_b128 v14, v[204:207] offset:24576
    s_add_u32 s41, s43, s77
    s_add_u32 s24, s40, 1
    s_cmp_lt_u32 s24, s76
    s_cselect_b32 s41, s41, 2146435072
    s_waitcnt vmcnt(0)
    s_add_u32 s25, s41, 20480
    buffer_load_dwordx4 v[16:19], v8, s[8:11], s41 offen offset:0 sc1
    buffer_load_dwordx4 v[20:23], v8, s[8:11], s41 offen offset:1024 sc1
    buffer_load_dwordx2 v[24:25], v9, s[8:11], s41 offen offset:0 sc1
    buffer_load_dwordx4 v[26:29], v8, s[8:11], s41 offen offset:2560 sc1
    buffer_load_dwordx4 v[30:33], v8, s[8:11], s41 offen offset:3584 sc1
    buffer_load_dwordx2 v[34:35], v9, s[8:11], s41 offen offset:2560 sc1
    buffer_load_dwordx4 v[36:39], v8, s[8:11], s25 offen offset:0 sc1
    buffer_load_dwordx4 v[40:43], v8, s[8:11], s25 offen offset:1024 sc1
    buffer_load_dwordx2 v[44:45], v9, s[8:11], s25 offen offset:0 sc1
    buffer_load_dwordx4 v[46:49], v8, s[8:11], s25 offen offset:2560 sc1
    buffer_load_dwordx4 v[50:53], v8, s[8:11], s25 offen offset:3584 sc1
    buffer_load_dwordx2 v[54:55], v9, s[8:11], s25 offen offset:2560 sc1
    buffer_load_dwordx2 v[96:97], v10, s[16:19], s41 offen sc1
    buffer_load_dwordx2 v[98:99], v11, s[16:19], s41 offen sc1
    buffer_load_dwordx2 v[100:101], v10, s[16:19], s25 offen sc1
    buffer_load_dwordx2 v[102:103], v11, s[16:19], s25 offen sc1
    s_waitcnt lgkmcnt(0)
    s_barrier
    s_lshl_b32 s24, s92, 10
    s_lshl_b32 s25, s78, 2
    s_add_u32 s24, s24, s25
    s_add_u32 s24, s24, 23105536
    s_cmp_eq_u32 s3, 0
    s_cbranch_scc0 interleave_layers__linear_attn_block__memory_aug_recurrent_mem_tr__prompt_kernel_pb13
    v_lshlrev_b32 v14, 7, v1
    v_add_u32 v14, s24, v14
    v_mov_b32 v15, 2146435072
    v_cmp_le_u32 vcc, 8, v1
    s_nop 1
    v_cndmask_b32 v14, v14, v15, vcc
    v_mov_b32 v15, s40
    buffer_store_dword v15, v14, s[8:11], 0 offen sc1
interleave_layers__linear_attn_block__memory_aug_recurrent_mem_tr__prompt_kernel_pb13:
    v_add_u32 v15, s42, v5
    ds_read_b128 v[208:211], v15 offset:0
    ds_read_b128 v[212:215], v15 offset:20480
    ds_read_b128 v[216:219], v15 offset:1024
    ds_read_b128 v[220:223], v15 offset:21504
    ds_read_b128 v[224:227], v15 offset:2048
    ds_read_b128 v[228:231], v15 offset:22528
    ds_read_b128 v[232:235], v15 offset:3072
    ds_read_b128 v[236:239], v15 offset:23552
    s_waitcnt lgkmcnt(6)
    v_mfma_f32_16x16x32_bf16 v[240:243], a[0:3], v[208:211], 0
    v_mfma_f32_16x16x32_bf16 v[244:247], a[4:7], v[208:211], 0
    v_mfma_f32_16x16x32_bf16 v[248:251], a[0:3], v[212:215], 0
    v_mfma_f32_16x16x32_bf16 v[252:255], a[4:7], v[212:215], 0
    ds_read_b128 v[208:211], v15 offset:4096
    ds_read_b128 v[212:215], v15 offset:24576
    s_waitcnt lgkmcnt(6)
    v_mfma_f32_16x16x32_bf16 v[240:243], a[8:11], v[216:219], v[240:243]
    v_mfma_f32_16x16x32_bf16 v[244:247], a[12:15], v[216:219], v[244:247]
    v_mfma_f32_16x16x32_bf16 v[248:251], a[8:11], v[220:223], v[248:251]
    v_mfma_f32_16x16x32_bf16 v[252:255], a[12:15], v[220:223], v[252:255]
    ds_read_b128 v[216:219], v15 offset:5120
    ds_read_b128 v[220:223], v15 offset:25600
    s_waitcnt lgkmcnt(6)
    v_mfma_f32_16x16x32_bf16 v[240:243], a[16:19], v[224:227], v[240:243]
    v_mfma_f32_16x16x32_bf16 v[244:247], a[20:23], v[224:227], v[244:247]
    v_mfma_f32_16x16x32_bf16 v[248:251], a[16:19], v[228:231], v[248:251]
    v_mfma_f32_16x16x32_bf16 v[252:255], a[20:23], v[228:231], v[252:255]
    ds_read_b128 v[224:227], v15 offset:6144
    ds_read_b128 v[228:231], v15 offset:26624
    s_waitcnt lgkmcnt(6)
    v_mfma_f32_16x16x32_bf16 v[240:243], a[24:27], v[232:235], v[240:243]
    v_mfma_f32_16x16x32_bf16 v[244:247], a[28:31], v[232:235], v[244:247]
    v_mfma_f32_16x16x32_bf16 v[248:251], a[24:27], v[236:239], v[248:251]
    v_mfma_f32_16x16x32_bf16 v[252:255], a[28:31], v[236:239], v[252:255]
    ds_read_b128 v[232:235], v15 offset:7168
    ds_read_b128 v[236:239], v15 offset:27648
    s_waitcnt lgkmcnt(6)
    v_mfma_f32_16x16x32_bf16 v[240:243], a[32:35], v[208:211], v[240:243]
    v_mfma_f32_16x16x32_bf16 v[244:247], a[36:39], v[208:211], v[244:247]
    v_mfma_f32_16x16x32_bf16 v[248:251], a[32:35], v[212:215], v[248:251]
    v_mfma_f32_16x16x32_bf16 v[252:255], a[36:39], v[212:215], v[252:255]
    ds_read_b128 v[208:211], v15 offset:8192
    ds_read_b128 v[212:215], v15 offset:28672
    s_waitcnt lgkmcnt(6)
    v_mfma_f32_16x16x32_bf16 v[240:243], a[40:43], v[216:219], v[240:243]
    v_mfma_f32_16x16x32_bf16 v[244:247], a[44:47], v[216:219], v[244:247]
    v_mfma_f32_16x16x32_bf16 v[248:251], a[40:43], v[220:223], v[248:251]
    v_mfma_f32_16x16x32_bf16 v[252:255], a[44:47], v[220:223], v[252:255]
    ds_read_b128 v[216:219], v15 offset:9216
    ds_read_b128 v[220:223], v15 offset:29696
    s_waitcnt lgkmcnt(6)
    v_mfma_f32_16x16x32_bf16 v[240:243], a[48:51], v[224:227], v[240:243]
    v_mfma_f32_16x16x32_bf16 v[244:247], a[52:55], v[224:227], v[244:247]
    v_mfma_f32_16x16x32_bf16 v[248:251], a[48:51], v[228:231], v[248:251]
    v_mfma_f32_16x16x32_bf16 v[252:255], a[52:55], v[228:231], v[252:255]
    ds_read_b128 v[224:227], v15 offset:10240
    ds_read_b128 v[228:231], v15 offset:30720
    s_waitcnt lgkmcnt(6)
    v_mfma_f32_16x16x32_bf16 v[240:243], a[56:59], v[232:235], v[240:243]
    v_mfma_f32_16x16x32_bf16 v[244:247], a[60:63], v[232:235], v[244:247]
    v_mfma_f32_16x16x32_bf16 v[248:251], a[56:59], v[236:239], v[248:251]
    v_mfma_f32_16x16x32_bf16 v[252:255], a[60:63], v[236:239], v[252:255]
    ds_read_b128 v[232:235], v15 offset:11264
    ds_read_b128 v[236:239], v15 offset:31744
    s_waitcnt lgkmcnt(6)
    v_mfma_f32_16x16x32_bf16 v[240:243], a[64:67], v[208:211], v[240:243]
    v_mfma_f32_16x16x32_bf16 v[244:247], a[68:71], v[208:211], v[244:247]
    v_mfma_f32_16x16x32_bf16 v[248:251], a[64:67], v[212:215], v[248:251]
    v_mfma_f32_16x16x32_bf16 v[252:255], a[68:71], v[212:215], v[252:255]
    ds_read_b128 v[208:211], v15 offset:12288
    ds_read_b128 v[212:215], v15 offset:32768
    s_waitcnt lgkmcnt(6)
    v_mfma_f32_16x16x32_bf16 v[240:243], a[72:75], v[216:219], v[240:243]
    v_mfma_f32_16x16x32_bf16 v[244:247], a[76:79], v[216:219], v[244:247]
    v_mfma_f32_16x16x32_bf16 v[248:251], a[72:75], v[220:223], v[248:251]
    v_mfma_f32_16x16x32_bf16 v[252:255], a[76:79], v[220:223], v[252:255]
    ds_read_b128 v[216:219], v15 offset:13312
    ds_read_b128 v[220:223], v15 offset:33792
    s_waitcnt lgkmcnt(6)
    v_mfma_f32_16x16x32_bf16 v[240:243], a[80:83], v[224:227], v[240:243]
    v_mfma_f32_16x16x32_bf16 v[244:247], a[84:87], v[224:227], v[244:247]
    v_mfma_f32_16x16x32_bf16 v[248:251], a[80:83], v[228:231], v[248:251]
    v_mfma_f32_16x16x32_bf16 v[252:255], a[84:87], v[228:231], v[252:255]
    ds_read_b128 v[224:227], v15 offset:14336
    ds_read_b128 v[228:231], v15 offset:34816
    s_waitcnt lgkmcnt(6)
    v_mfma_f32_16x16x32_bf16 v[240:243], a[88:91], v[232:235], v[240:243]
    v_mfma_f32_16x16x32_bf16 v[244:247], a[92:95], v[232:235], v[244:247]
    v_mfma_f32_16x16x32_bf16 v[248:251], a[88:91], v[236:239], v[248:251]
    v_mfma_f32_16x16x32_bf16 v[252:255], a[92:95], v[236:239], v[252:255]
    ds_read_b128 v[232:235], v15 offset:15360
    ds_read_b128 v[236:239], v15 offset:35840
    s_waitcnt lgkmcnt(6)
    v_mfma_f32_16x16x32_bf16 v[240:243], a[96:99], v[208:211], v[240:243]
    v_mfma_f32_16x16x32_bf16 v[244:247], a[100:103], v[208:211], v[244:247]
    v_mfma_f32_16x16x32_bf16 v[248:251], a[96:99], v[212:215], v[248:251]
    v_mfma_f32_16x16x32_bf16 v[252:255], a[100:103], v[212:215], v[252:255]
    ds_read_b128 v[208:211], v15 offset:16384
    ds_read_b128 v[212:215], v15 offset:36864
    s_waitcnt lgkmcnt(6)
    v_mfma_f32_16x16x32_bf16 v[240:243], a[104:107], v[216:219], v[240:243]
    v_mfma_f32_16x16x32_bf16 v[244:247], a[108:111], v[216:219], v[244:247]
    v_mfma_f32_16x16x32_bf16 v[248:251], a[104:107], v[220:223], v[248:251]
    v_mfma_f32_16x16x32_bf16 v[252:255], a[108:111], v[220:223], v[252:255]
    ds_read_b128 v[216:219], v15 offset:17408
    ds_read_b128 v[220:223], v15 offset:37888
    s_waitcnt lgkmcnt(6)
    v_mfma_f32_16x16x32_bf16 v[240:243], a[112:115], v[224:227], v[240:243]
    v_mfma_f32_16x16x32_bf16 v[244:247], a[116:119], v[224:227], v[244:247]
    v_mfma_f32_16x16x32_bf16 v[248:251], a[112:115], v[228:231], v[248:251]
    v_mfma_f32_16x16x32_bf16 v[252:255], a[116:119], v[228:231], v[252:255]
    ds_read_b128 v[224:227], v15 offset:18432
    ds_read_b128 v[228:231], v15 offset:38912
    s_waitcnt lgkmcnt(6)
    v_mfma_f32_16x16x32_bf16 v[240:243], a[120:123], v[232:235], v[240:243]
    v_mfma_f32_16x16x32_bf16 v[244:247], a[124:127], v[232:235], v[244:247]
    v_mfma_f32_16x16x32_bf16 v[248:251], a[120:123], v[236:239], v[248:251]
    v_mfma_f32_16x16x32_bf16 v[252:255], a[124:127], v[236:239], v[252:255]
    ds_read_b128 v[232:235], v15 offset:19456
    ds_read_b128 v[236:239], v15 offset:39936
    s_waitcnt lgkmcnt(6)
    v_mfma_f32_16x16x32_bf16 v[240:243], a[128:131], v[208:211], v[240:243]
    v_mfma_f32_16x16x32_bf16 v[244:247], a[132:135], v[208:211], v[244:247]
    v_mfma_f32_16x16x32_bf16 v[248:251], a[128:131], v[212:215], v[248:251]
    v_mfma_f32_16x16x32_bf16 v[252:255], a[132:135], v[212:215], v[252:255]
    s_waitcnt lgkmcnt(4)
    v_mfma_f32_16x16x32_bf16 v[240:243], a[136:139], v[216:219], v[240:243]
    v_mfma_f32_16x16x32_bf16 v[244:247], a[140:143], v[216:219], v[244:247]
    v_mfma_f32_16x16x32_bf16 v[248:251], a[136:139], v[220:223], v[248:251]
    v_mfma_f32_16x16x32_bf16 v[252:255], a[140:143], v[220:223], v[252:255]
    s_waitcnt lgkmcnt(2)
    v_mfma_f32_16x16x32_bf16 v[240:243], a[144:147], v[224:227], v[240:243]
    v_mfma_f32_16x16x32_bf16 v[244:247], a[148:151], v[224:227], v[244:247]
    v_mfma_f32_16x16x32_bf16 v[248:251], a[144:147], v[228:231], v[248:251]
    v_mfma_f32_16x16x32_bf16 v[252:255], a[148:151], v[228:231], v[252:255]
    s_waitcnt lgkmcnt(0)
    v_mfma_f32_16x16x32_bf16 v[240:243], a[152:155], v[232:235], v[240:243]
    v_mfma_f32_16x16x32_bf16 v[244:247], a[156:159], v[232:235], v[244:247]
    v_mfma_f32_16x16x32_bf16 v[248:251], a[152:155], v[236:239], v[248:251]
    v_mfma_f32_16x16x32_bf16 v[252:255], a[156:159], v[236:239], v[252:255]
    s_nop 4
    v_cvt_pk_bf16_f32 v208, v240, v241
    v_cvt_pk_bf16_f32 v209, v242, v243
    v_lshlrev_b32 v210, 16, v208
    v_and_b32 v211, 0xffff0000, v208
    v_lshlrev_b32 v212, 16, v104
    v_and_b32 v213, 0xffff0000, v104
    v_pk_add_f32 v[210:211], v[210:211], v[212:213]
    v_cvt_pk_bf16_f32 v216, v210, v211
    v_lshlrev_b32 v210, 16, v209
    v_and_b32 v211, 0xffff0000, v209
    v_lshlrev_b32 v212, 16, v105
    v_and_b32 v213, 0xffff0000, v105
    v_pk_add_f32 v[210:211], v[210:211], v[212:213]
    v_cvt_pk_bf16_f32 v217, v210, v211
    v_cvt_pk_bf16_f32 v208, v244, v245
    v_cvt_pk_bf16_f32 v209, v246, v247
    v_lshlrev_b32 v210, 16, v208
    v_and_b32 v211, 0xffff0000, v208
    v_lshlrev_b32 v212, 16, v106
    v_and_b32 v213, 0xffff0000, v106
    v_pk_add_f32 v[210:211], v[210:211], v[212:213]
    v_cvt_pk_bf16_f32 v218, v210, v211
    v_lshlrev_b32 v210, 16, v209
    v_and_b32 v211, 0xffff0000, v209
    v_lshlrev_b32 v212, 16, v107
    v_and_b32 v213, 0xffff0000, v107
    v_pk_add_f32 v[210:211], v[210:211], v[212:213]
    v_cvt_pk_bf16_f32 v219, v210, v211
    v_cvt_pk_bf16_f32 v208, v248, v249
    v_cvt_pk_bf16_f32 v209, v250, v251
    v_lshlrev_b32 v210, 16, v208
    v_and_b32 v211, 0xffff0000, v208
    v_lshlrev_b32 v212, 16, v108
    v_and_b32 v213, 0xffff0000, v108
    v_pk_add_f32 v[210:211], v[210:211], v[212:213]
    v_cvt_pk_bf16_f32 v220, v210, v211
    v_lshlrev_b32 v210, 16, v209
    v_and_b32 v211, 0xffff0000, v209
    v_lshlrev_b32 v212, 16, v109
    v_and_b32 v213, 0xffff0000, v109
    v_pk_add_f32 v[210:211], v[210:211], v[212:213]
    v_cvt_pk_bf16_f32 v221, v210, v211
    v_cvt_pk_bf16_f32 v208, v252, v253
    v_cvt_pk_bf16_f32 v209, v254, v255
    v_lshlrev_b32 v210, 16, v208
    v_and_b32 v211, 0xffff0000, v208
    v_lshlrev_b32 v212, 16, v110
    v_and_b32 v213, 0xffff0000, v110
    v_pk_add_f32 v[210:211], v[210:211], v[212:213]
    v_cvt_pk_bf16_f32 v222, v210, v211
    v_lshlrev_b32 v210, 16, v209
    v_and_b32 v211, 0xffff0000, v209
    v_lshlrev_b32 v212, 16, v111
    v_and_b32 v213, 0xffff0000, v111
    v_pk_add_f32 v[210:211], v[210:211], v[212:213]
    v_cvt_pk_bf16_f32 v223, v210, v211
    s_add_u32 s25, s43, 20480
    buffer_store_dwordx4 v[216:219], v12, s[8:11], s43 offen sc1
    buffer_store_dwordx4 v[220:223], v12, s[8:11], s25 offen sc1
    s_add_u32 s40, s40, 1
    s_add_u32 s43, s43, s77
    s_cmp_ge_u32 s40, s76
    s_cbranch_scc1 interleave_layers__linear_attn_block__memory_aug_recurrent_mem_tr__prompt_kernel_k3_done
    s_xor_b32 s42, s42, 40960
    s_waitcnt vmcnt(2)
    v_mfma_f32_16x16x32_bf16 v[132:135], a[192:195], v[16:19], 0
    v_mfma_f32_16x16x32_bf16 v[136:139], a[202:205], v[20:23], 0
    v_mfma_f32_16x16x32_bf16 v[112:115], a[160:163], v[16:19], 0
    v_mfma_f32_16x16x32_bf16 v[116:119], a[164:167], v[16:19], 0
    v_mfma_f32_16x16x32_bf16 v[120:123], a[172:175], v[16:19], 0
    v_mfma_f32_16x16x32_bf16 v[124:127], a[180:183], v[20:23], 0
    v_mfma_f32_16x16x32_bf16 v[128:131], a[186:189], v[20:23], 0
    v_mfma_f32_16x16x32_bf16 v[132:135], a[196:199], v[20:23], v[132:135]
    v_mfma_f32_16x16x32_bf16 v[116:119], a[168:171], v[20:23], v[116:119]
    v_mfma_f32_16x16x32_bf16 v[120:123], a[176:179], v[20:23], v[120:123]
    v_mfma_f32_16x16x16_bf16 v[136:139], a[206:207], v[24:25], v[136:139]
    s_nop 0
    v_mfma_f32_16x16x16_bf16 v[124:127], a[184:185], v[24:25], v[124:127]
    v_mfma_f32_16x16x16_bf16 v[128:131], a[190:191], v[24:25], v[128:131]
    v_mfma_f32_16x16x16_bf16 v[132:135], a[200:201], v[24:25], v[132:135]
    v_mfma_f32_16x16x32_bf16 v[160:163], a[240:243], v[26:29], 0
    v_mfma_f32_16x16x32_bf16 v[164:167], a[250:253], v[30:33], 0
    v_mfma_f32_16x16x32_bf16 v[140:143], a[208:211], v[26:29], 0
    v_mfma_f32_16x16x32_bf16 v[144:147], a[212:215], v[26:29], 0
    v_mfma_f32_16x16x32_bf16 v[148:151], a[220:223], v[26:29], 0
    v_mfma_f32_16x16x32_bf16 v[152:155], a[228:231], v[30:33], 0
    v_mfma_f32_16x16x32_bf16 v[156:159], a[234:237], v[30:33], 0
    v_mfma_f32_16x16x32_bf16 v[160:163], a[244:247], v[30:33], v[160:163]
    v_mfma_f32_16x16x32_bf16 v[144:147], a[216:219], v[30:33], v[144:147]
    v_mfma_f32_16x16x32_bf16 v[148:151], a[224:227], v[30:33], v[148:151]
    v_mfma_f32_16x16x16_bf16 v[164:167], a[254:255], v[34:35], v[164:167]
    s_nop 0
    v_mfma_f32_16x16x16_bf16 v[152:155], a[232:233], v[34:35], v[152:155]
    v_mfma_f32_16x16x16_bf16 v[156:159], a[238:239], v[34:35], v[156:159]
    v_mfma_f32_16x16x16_bf16 v[160:163], a[248:249], v[34:35], v[160:163]
    v_add_f32 v132, s54, v132
    v_add_f32 v133, s54, v133
    v_add_f32 v134, s54, v134
    v_add_f32 v135, s54, v135
    v_add_f32 v136, s54, v136
    v_rcp_f32 v132, v132
    v_rcp_f32 v133, v133
    v_rcp_f32 v134, v134
    v_rcp_f32 v135, v135
    v_rcp_f32 v136, v136
    v_mul_f32 v112, v112, v132
    v_mul_f32 v113, v113, v132
    v_mul_f32 v114, v114, v132
    v_mul_f32 v115, v115, v132
    v_cvt_pk_bf16_f32 v168, v112, v113
    v_cvt_pk_bf16_f32 v169, v114, v115
    v_mul_f32 v116, v116, v133
    v_mul_f32 v117, v117, v133
    v_mul_f32 v118, v118, v133
    v_mul_f32 v119, v119, v133
    v_cvt_pk_bf16_f32 v170, v116, v117
    v_cvt_pk_bf16_f32 v171, v118, v119
    v_mul_f32 v120, v120, v134
    v_mul_f32 v121, v121, v134
    v_mul_f32 v122, v122, v134
    v_mul_f32 v123, v123, v134
    v_cvt_pk_bf16_f32 v172, v120, v121
    v_cvt_pk_bf16_f32 v173, v122, v123
    v_mul_f32 v124, v124, v135
    v_mul_f32 v125, v125, v135
    v_mul_f32 v126, v126, v135
    v_mul_f32 v127, v127, v135
    v_cvt_pk_bf16_f32 v174, v124, v125
    v_cvt_pk_bf16_f32 v175, v126, v127
    v_mul_f32 v128, v128, v136
    v_mul_f32 v129, v129, v136
    v_mul_f32 v130, v130, v136
    v_mul_f32 v131, v131, v136
    v_cvt_pk_bf16_f32 v176, v128, v129
    v_cvt_pk_bf16_f32 v177, v130, v131
    v_add_f32 v160, s54, v160
    v_add_f32 v161, s54, v161
    v_add_f32 v162, s54, v162
    v_add_f32 v163, s54, v163
    v_add_f32 v164, s54, v164
    v_rcp_f32 v160, v160
    v_rcp_f32 v161, v161
    v_rcp_f32 v162, v162
    v_rcp_f32 v163, v163
    v_rcp_f32 v164, v164
    v_mul_f32 v140, v140, v160
    v_mul_f32 v141, v141, v160
    v_mul_f32 v142, v142, v160
    v_mul_f32 v143, v143, v160
    v_cvt_pk_bf16_f32 v178, v140, v141
    v_cvt_pk_bf16_f32 v179, v142, v143
    v_mul_f32 v144, v144, v161
    v_mul_f32 v145, v145, v161
    v_mul_f32 v146, v146, v161
    v_mul_f32 v147, v147, v161
    v_cvt_pk_bf16_f32 v180, v144, v145
    v_cvt_pk_bf16_f32 v181, v146, v147
    v_mul_f32 v148, v148, v162
    v_mul_f32 v149, v149, v162
    v_mul_f32 v150, v150, v162
    v_mul_f32 v151, v151, v162
    v_cvt_pk_bf16_f32 v182, v148, v149
    v_cvt_pk_bf16_f32 v183, v150, v151
    v_mul_f32 v152, v152, v163
    v_mul_f32 v153, v153, v163
    v_mul_f32 v154, v154, v163
    v_mul_f32 v155, v155, v163
    v_cvt_pk_bf16_f32 v184, v152, v153
    v_cvt_pk_bf16_f32 v185, v154, v155
    v_mul_f32 v156, v156, v164
    v_mul_f32 v157, v157, v164
    v_mul_f32 v158, v158, v164
    v_mul_f32 v159, v159, v164
    v_cvt_pk_bf16_f32 v186, v156, v157
    v_cvt_pk_bf16_f32 v187, v158, v159
    v_mfma_f32_16x16x32_bf16 v[132:135], a[192:195], v[36:39], 0
    v_mfma_f32_16x16x32_bf16 v[136:139], a[202:205], v[40:43], 0
    v_mfma_f32_16x16x32_bf16 v[112:115], a[160:163], v[36:39], 0
    v_mfma_f32_16x16x32_bf16 v[116:119], a[164:167], v[36:39], 0
    v_mfma_f32_16x16x32_bf16 v[120:123], a[172:175], v[36:39], 0
    v_mfma_f32_16x16x32_bf16 v[124:127], a[180:183], v[40:43], 0
    v_mfma_f32_16x16x32_bf16 v[128:131], a[186:189], v[40:43], 0
    v_mfma_f32_16x16x32_bf16 v[132:135], a[196:199], v[40:43], v[132:135]
    v_mfma_f32_16x16x32_bf16 v[116:119], a[168:171], v[40:43], v[116:119]
    v_mfma_f32_16x16x32_bf16 v[120:123], a[176:179], v[40:43], v[120:123]
    v_mfma_f32_16x16x16_bf16 v[136:139], a[206:207], v[44:45], v[136:139]
    s_nop 0
    v_mfma_f32_16x16x16_bf16 v[124:127], a[184:185], v[44:45], v[124:127]
    v_mfma_f32_16x16x16_bf16 v[128:131], a[190:191], v[44:45], v[128:131]
    v_mfma_f32_16x16x16_bf16 v[132:135], a[200:201], v[44:45], v[132:135]
    v_mfma_f32_16x16x32_bf16 v[160:163], a[240:243], v[46:49], 0
    v_mfma_f32_16x16x32_bf16 v[164:167], a[250:253], v[50:53], 0
    v_mfma_f32_16x16x32_bf16 v[140:143], a[208:211], v[46:49], 0
    v_mfma_f32_16x16x32_bf16 v[144:147], a[212:215], v[46:49], 0
    v_mfma_f32_16x16x32_bf16 v[148:151], a[220:223], v[46:49], 0
    v_mfma_f32_16x16x32_bf16 v[152:155], a[228:231], v[50:53], 0
    v_mfma_f32_16x16x32_bf16 v[156:159], a[234:237], v[50:53], 0
    v_mfma_f32_16x16x32_bf16 v[160:163], a[244:247], v[50:53], v[160:163]
    v_mfma_f32_16x16x32_bf16 v[144:147], a[216:219], v[50:53], v[144:147]
    v_mfma_f32_16x16x32_bf16 v[148:151], a[224:227], v[50:53], v[148:151]
    v_mfma_f32_16x16x16_bf16 v[164:167], a[254:255], v[54:55], v[164:167]
    s_nop 0
    v_mfma_f32_16x16x16_bf16 v[152:155], a[232:233], v[54:55], v[152:155]
    v_mfma_f32_16x16x16_bf16 v[156:159], a[238:239], v[54:55], v[156:159]
    v_mfma_f32_16x16x16_bf16 v[160:163], a[248:249], v[54:55], v[160:163]
    v_add_f32 v132, s54, v132
    v_add_f32 v133, s54, v133
    v_add_f32 v134, s54, v134
    v_add_f32 v135, s54, v135
    v_add_f32 v136, s54, v136
    v_rcp_f32 v132, v132
    v_rcp_f32 v133, v133
    v_rcp_f32 v134, v134
    v_rcp_f32 v135, v135
    v_rcp_f32 v136, v136
    v_mul_f32 v112, v112, v132
    v_mul_f32 v113, v113, v132
    v_mul_f32 v114, v114, v132
    v_mul_f32 v115, v115, v132
    v_cvt_pk_bf16_f32 v188, v112, v113
    v_cvt_pk_bf16_f32 v189, v114, v115
    v_mul_f32 v116, v116, v133
    v_mul_f32 v117, v117, v133
    v_mul_f32 v118, v118, v133
    v_mul_f32 v119, v119, v133
    v_cvt_pk_bf16_f32 v190, v116, v117
    v_cvt_pk_bf16_f32 v191, v118, v119
    v_mul_f32 v120, v120, v134
    v_mul_f32 v121, v121, v134
    v_mul_f32 v122, v122, v134
    v_mul_f32 v123, v123, v134
    v_cvt_pk_bf16_f32 v192, v120, v121
    v_cvt_pk_bf16_f32 v193, v122, v123
    v_mul_f32 v124, v124, v135
    v_mul_f32 v125, v125, v135
    v_mul_f32 v126, v126, v135
    v_mul_f32 v127, v127, v135
    v_cvt_pk_bf16_f32 v194, v124, v125
    v_cvt_pk_bf16_f32 v195, v126, v127
    v_mul_f32 v128, v128, v136
    v_mul_f32 v129, v129, v136
    v_mul_f32 v130, v130, v136
    v_mul_f32 v131, v131, v136
    v_cvt_pk_bf16_f32 v196, v128, v129
    v_cvt_pk_bf16_f32 v197, v130, v131
    v_add_f32 v160, s54, v160
    v_add_f32 v161, s54, v161
    v_add_f32 v162, s54, v162
    v_add_f32 v163, s54, v163
    v_add_f32 v164, s54, v164
    v_rcp_f32 v160, v160
    v_rcp_f32 v161, v161
    v_rcp_f32 v162, v162
    v_rcp_f32 v163, v163
    v_rcp_f32 v164, v164
    v_mul_f32 v140, v140, v160
    v_mul_f32 v141, v141, v160
    v_mul_f32 v142, v142, v160
    v_mul_f32 v143, v143, v160
    v_cvt_pk_bf16_f32 v198, v140, v141
    v_cvt_pk_bf16_f32 v199, v142, v143
    v_mul_f32 v144, v144, v161
    v_mul_f32 v145, v145, v161
    v_mul_f32 v146, v146, v161
    v_mul_f32 v147, v147, v161
    v_cvt_pk_bf16_f32 v200, v144, v145
    v_cvt_pk_bf16_f32 v201, v146, v147
    v_mul_f32 v148, v148, v162
    v_mul_f32 v149, v149, v162
    v_mul_f32 v150, v150, v162
    v_mul_f32 v151, v151, v162
    v_cvt_pk_bf16_f32 v202, v148, v149
    v_cvt_pk_bf16_f32 v203, v150, v151
    v_mul_f32 v152, v152, v163
    v_mul_f32 v153, v153, v163
    v_mul_f32 v154, v154, v163
    v_mul_f32 v155, v155, v163
    v_cvt_pk_bf16_f32 v204, v152, v153
    v_cvt_pk_bf16_f32 v205, v154, v155
    v_mul_f32 v156, v156, v164
    v_mul_f32 v157, v157, v164
    v_mul_f32 v158, v158, v164
    v_mul_f32 v159, v159, v164
    v_cvt_pk_bf16_f32 v206, v156, v157
    v_cvt_pk_bf16_f32 v207, v158, v159
    v_add_u32 v14, s42, v13
    ds_write_b128 v14, v[168:171] offset:0
    ds_write_b128 v14, v[172:175] offset:1024
    ds_write_b128 v14, v[176:179] offset:2048
    ds_write_b128 v14, v[180:183] offset:3072
    ds_write_b128 v14, v[184:187] offset:4096
    ds_write_b128 v14, v[188:191] offset:20480
    ds_write_b128 v14, v[192:195] offset:21504
    ds_write_b128 v14, v[196:199] offset:22528
    ds_write_b128 v14, v[200:203] offset:23552
    ds_write_b128 v14, v[204:207] offset:24576
    s_add_u32 s41, s43, s77
    s_add_u32 s24, s40, 1
    s_cmp_lt_u32 s24, s76
    s_cselect_b32 s41, s41, 2146435072
    s_waitcnt vmcnt(0)
    s_add_u32 s25, s41, 20480
    buffer_load_dwordx4 v[56:59], v8, s[8:11], s41 offen offset:0 sc1
    buffer_load_dwordx4 v[60:63], v8, s[8:11], s41 offen offset:1024 sc1
    buffer_load_dwordx2 v[64:65], v9, s[8:11], s41 offen offset:0 sc1
    buffer_load_dwordx4 v[66:69], v8, s[8:11], s41 offen offset:2560 sc1
    buffer_load_dwordx4 v[70:73], v8, s[8:11], s41 offen offset:3584 sc1
    buffer_load_dwordx2 v[74:75], v9, s[8:11], s41 offen offset:2560 sc1
    buffer_load_dwordx4 v[76:79], v8, s[8:11], s25 offen offset:0 sc1
    buffer_load_dwordx4 v[80:83], v8, s[8:11], s25 offen offset:1024 sc1
    buffer_load_dwordx2 v[84:85], v9, s[8:11], s25 offen offset:0 sc1
    buffer_load_dwordx4 v[86:89], v8, s[8:11], s25 offen offset:2560 sc1
    buffer_load_dwordx4 v[90:93], v8, s[8:11], s25 offen offset:3584 sc1
    buffer_load_dwordx2 v[94:95], v9, s[8:11], s25 offen offset:2560 sc1
    buffer_load_dwordx2 v[104:105], v10, s[16:19], s41 offen sc1
    buffer_load_dwordx2 v[106:107], v11, s[16:19], s41 offen sc1
    buffer_load_dwordx2 v[108:109], v10, s[16:19], s25 offen sc1
    buffer_load_dwordx2 v[110:111], v11, s[16:19], s25 offen sc1
    s_waitcnt lgkmcnt(0)
    s_barrier
    s_lshl_b32 s24, s92, 10
    s_lshl_b32 s25, s78, 2
    s_add_u32 s24, s24, s25
    s_add_u32 s24, s24, 23105536
    s_cmp_eq_u32 s3, 0
    s_cbranch_scc0 interleave_layers__linear_attn_block__memory_aug_recurrent_mem_tr__prompt_kernel_pb14
    v_lshlrev_b32 v14, 7, v1
    v_add_u32 v14, s24, v14
    v_mov_b32 v15, 2146435072
    v_cmp_le_u32 vcc, 8, v1
    s_nop 1
    v_cndmask_b32 v14, v14, v15, vcc
    v_mov_b32 v15, s40
    buffer_store_dword v15, v14, s[8:11], 0 offen sc1
interleave_layers__linear_attn_block__memory_aug_recurrent_mem_tr__prompt_kernel_pb14:
    s_branch interleave_layers__linear_attn_block__memory_aug_recurrent_mem_tr__prompt_kernel_k3_seg
interleave_layers__linear_attn_block__memory_aug_recurrent_mem_tr__prompt_kernel_k3_done:
    s_waitcnt vmcnt(0)
    s_barrier
    s_lshl_b32 s24, s92, 10
    s_lshl_b32 s25, s78, 2
    s_add_u32 s24, s24, s25
    s_add_u32 s24, s24, 23105536
    s_cmp_eq_u32 s3, 0
    s_cbranch_scc0 interleave_layers__linear_attn_block__memory_aug_recurrent_mem_tr__prompt_kernel_pb15
    v_lshlrev_b32 v14, 7, v1
    v_add_u32 v14, s24, v14
    v_mov_b32 v15, 2146435072
    v_cmp_le_u32 vcc, 8, v1
    s_nop 1
    v_cndmask_b32 v14, v14, v15, vcc
    v_mov_b32 v15, s40
    buffer_store_dword v15, v14, s[8:11], 0 offen sc1
interleave_layers__linear_attn_block__memory_aug_recurrent_mem_tr__prompt_kernel_pb15:
    s_cmp_eq_u32 s92, 0
    s_cbranch_scc0 interleave_layers__linear_attn_block__memory_aug_recurrent_mem_tr__prompt_kernel_end
    s_mov_b32 s92, 1
    s_cmp_lt_u32 s2, 248
    s_cbranch_scc1 interleave_layers__linear_attn_block__memory_aug_recurrent_mem_tr__prompt_kernel_helper_k1
interleave_layers__linear_attn_block__memory_aug_recurrent_mem_tr__prompt_kernel_k3_l1:
    s_add_u32 s16, s4, 4194304
    s_addc_u32 s17, s5, 0
    s_mov_b32 s18, 2621440
    s_mov_b32 s19, 0x00020000
    s_mov_b32 s46, 1024
    s_mov_b32 s47, 8
    s_mov_b32 s50, 1
    s_mov_b32 s58, 8388608
    s_mov_b32 s76, 16
    s_mov_b32 s77, 163840
    s_branch interleave_layers__linear_attn_block__memory_aug_recurrent_mem_tr__prompt_kernel_k3_entry
interleave_layers__linear_attn_block__memory_aug_recurrent_mem_tr__prompt_kernel_helper_k1:
    s_mov_b32 s92, 1
    s_sub_u32 s24, s2, 232
    s_add_u32 s16, s4, 4194304
    s_addc_u32 s17, s5, 0
    s_mov_b32 s18, 2621440
    s_mov_b32 s19, 0x00020000
    s_mov_b32 s46, 1024
    s_mov_b32 s47, 8
    s_mov_b32 s50, 1
    s_and_b32 s44, s24, 7
    s_lshr_b32 s45, s24, 3
    s_mov_b32 s48, s45
    s_mov_b32 s49, 2
    s_mov_b32 s40, 32
    s_branch interleave_layers__linear_attn_block__memory_aug_recurrent_mem_tr__prompt_kernel_k1_entry
interleave_layers__linear_attn_block__memory_aug_recurrent_mem_tr__prompt_kernel_helper_clr:
    s_sub_u32 s44, s2, 253
    s_lshl_b32 s24, s44, 2
    s_add_u32 s24, s24, s3
    s_mul_i32 s45, s24, 5
    s_add_u32 s24, s45, 0
    s_min_u32 s24, s24, 56
    s_sub_u32 s25, s24, 47
    s_cmp_ge_u32 s24, 47
    s_cselect_b32 s24, s25, s24
    s_cselect_b32 s69, 0x2000, 0
    s_lshl_b32 s64, s24, 14
    s_add_u32 s24, s45, 1
    s_min_u32 s24, s24, 56
    s_sub_u32 s25, s24, 47
    s_cmp_ge_u32 s24, 47
    s_cselect_b32 s24, s25, s24
    s_cselect_b32 s70, 0x2000, 0
    s_lshl_b32 s65, s24, 14
    s_add_u32 s24, s45, 2
    s_min_u32 s24, s24, 56
    s_sub_u32 s25, s24, 47
    s_cmp_ge_u32 s24, 47
    s_cselect_b32 s24, s25, s24
    s_cselect_b32 s71, 0x2000, 0
    s_lshl_b32 s66, s24, 14
    s_add_u32 s24, s45, 3
    s_min_u32 s24, s24, 56
    s_sub_u32 s25, s24, 47
    s_cmp_ge_u32 s24, 47
    s_cselect_b32 s24, s25, s24
    s_cselect_b32 s72, 0x2000, 0
    s_lshl_b32 s67, s24, 14
    s_add_u32 s24, s45, 4
    s_min_u32 s24, s24, 56
    s_sub_u32 s25, s24, 47
    s_cmp_ge_u32 s24, 47
    s_cselect_b32 s24, s25, s24
    s_cselect_b32 s73, 0x2000, 0
    s_lshl_b32 s68, s24, 14
    v_lshlrev_b32 v5, 4, v1
    v_mov_b32 v8, -1
    v_mov_b32 v9, -1
    v_mov_b32 v10, -1
    v_mov_b32 v11, -1
    s_lshl_b32 s24, s44, 2
    s_add_u32 s42, s24, 23109632
    s_mov_b32 s40, 0
interleave_layers__linear_attn_block__memory_aug_recurrent_mem_tr__prompt_kernel_clr_blk:
    s_lshl_b32 s24, s40, 12
    s_and_b32 s24, s24, 0x2000
    s_xor_b32 s24, s24, s36
    s_lshl_b32 s41, s40, 20
    s_add_u32 s41, s41, s24
    s_add_u32 s41, s41, 117440512
    s_add_u32 s43, s41, s64
    s_xor_b32 s43, s43, s69
    s_add_u32 s46, s43, 4096
    buffer_store_dwordx4 v[8:11], v5, s[8:11], s43 offen offset:0 sc1
    buffer_store_dwordx4 v[8:11], v5, s[8:11], s43 offen offset:1024 sc1
    buffer_store_dwordx4 v[8:11], v5, s[8:11], s43 offen offset:2048 sc1
    buffer_store_dwordx4 v[8:11], v5, s[8:11], s43 offen offset:3072 sc1
    buffer_store_dwordx4 v[8:11], v5, s[8:11], s46 offen offset:0 sc1
    buffer_store_dwordx4 v[8:11], v5, s[8:11], s46 offen offset:1024 sc1
    buffer_store_dwordx4 v[8:11], v5, s[8:11], s46 offen offset:2048 sc1
    buffer_store_dwordx4 v[8:11], v5, s[8:11], s46 offen offset:3072 sc1
    s_add_u32 s43, s41, s65
    s_xor_b32 s43, s43, s70
    s_add_u32 s46, s43, 4096
    buffer_store_dwordx4 v[8:11], v5, s[8:11], s43 offen offset:0 sc1
    buffer_store_dwordx4 v[8:11], v5, s[8:11], s43 offen offset:1024 sc1
    buffer_store_dwordx4 v[8:11], v5, s[8:11], s43 offen offset:2048 sc1
    buffer_store_dwordx4 v[8:11], v5, s[8:11], s43 offen offset:3072 sc1
    buffer_store_dwordx4 v[8:11], v5, s[8:11], s46 offen offset:0 sc1
    buffer_store_dwordx4 v[8:11], v5, s[8:11], s46 offen offset:1024 sc1
    buffer_store_dwordx4 v[8:11], v5, s[8:11], s46 offen offset:2048 sc1
    buffer_store_dwordx4 v[8:11], v5, s[8:11], s46 offen offset:3072 sc1
    s_add_u32 s43, s41, s66
    s_xor_b32 s43, s43, s71
    s_add_u32 s46, s43, 4096
    buffer_store_dwordx4 v[8:11], v5, s[8:11], s43 offen offset:0 sc1
    buffer_store_dwordx4 v[8:11], v5, s[8:11], s43 offen offset:1024 sc1
    buffer_store_dwordx4 v[8:11], v5, s[8:11], s43 offen offset:2048 sc1
    buffer_store_dwordx4 v[8:11], v5, s[8:11], s43 offen offset:3072 sc1
    buffer_store_dwordx4 v[8:11], v5, s[8:11], s46 offen offset:0 sc1
    buffer_store_dwordx4 v[8:11], v5, s[8:11], s46 offen offset:1024 sc1
    buffer_store_dwordx4 v[8:11], v5, s[8:11], s46 offen offset:2048 sc1
    buffer_store_dwordx4 v[8:11], v5, s[8:11], s46 offen offset:3072 sc1
    s_add_u32 s43, s41, s67
    s_xor_b32 s43, s43, s72
    s_add_u32 s46, s43, 4096
    buffer_store_dwordx4 v[8:11], v5, s[8:11], s43 offen offset:0 sc1
    buffer_store_dwordx4 v[8:11], v5, s[8:11], s43 offen offset:1024 sc1
    buffer_store_dwordx4 v[8:11], v5, s[8:11], s43 offen offset:2048 sc1
    buffer_store_dwordx4 v[8:11], v5, s[8:11], s43 offen offset:3072 sc1
    buffer_store_dwordx4 v[8:11], v5, s[8:11], s46 offen offset:0 sc1
    buffer_store_dwordx4 v[8:11], v5, s[8:11], s46 offen offset:1024 sc1
    buffer_store_dwordx4 v[8:11], v5, s[8:11], s46 offen offset:2048 sc1
    buffer_store_dwordx4 v[8:11], v5, s[8:11], s46 offen offset:3072 sc1
    s_add_u32 s43, s41, s68
    s_xor_b32 s43, s43, s73
    s_add_u32 s46, s43, 4096
    buffer_store_dwordx4 v[8:11], v5, s[8:11], s43 offen offset:0 sc1
    buffer_store_dwordx4 v[8:11], v5, s[8:11], s43 offen offset:1024 sc1
    buffer_store_dwordx4 v[8:11], v5, s[8:11], s43 offen offset:2048 sc1
    buffer_store_dwordx4 v[8:11], v5, s[8:11], s43 offen offset:3072 sc1
    buffer_store_dwordx4 v[8:11], v5, s[8:11], s46 offen offset:0 sc1
    buffer_store_dwordx4 v[8:11], v5, s[8:11], s46 offen offset:1024 sc1
    buffer_store_dwordx4 v[8:11], v5, s[8:11], s46 offen offset:2048 sc1
    buffer_store_dwordx4 v[8:11], v5, s[8:11], s46 offen offset:3072 sc1
    s_waitcnt vmcnt(40)
    s_barrier
    s_cmp_eq_u32 s3, 0
    s_cbranch_scc0 interleave_layers__linear_attn_block__memory_aug_recurrent_mem_tr__prompt_kernel_pb16
    v_lshlrev_b32 v14, 7, v1
    v_add_u32 v14, s42, v14
    v_mov_b32 v15, 2146435072
    v_cmp_le_u32 vcc, 8, v1
    s_nop 1
    v_cndmask_b32 v14, v14, v15, vcc
    v_mov_b32 v15, s40
    buffer_store_dword v15, v14, s[8:11], 0 offen sc1
interleave_layers__linear_attn_block__memory_aug_recurrent_mem_tr__prompt_kernel_pb16:
    s_add_u32 s40, s40, 1
    s_cmp_lt_u32 s40, 64
    s_cbranch_scc1 interleave_layers__linear_attn_block__memory_aug_recurrent_mem_tr__prompt_kernel_clr_blk
    s_waitcnt vmcnt(0)
    s_barrier
    s_cmp_eq_u32 s3, 0
    s_cbranch_scc0 interleave_layers__linear_attn_block__memory_aug_recurrent_mem_tr__prompt_kernel_pb17
    v_lshlrev_b32 v14, 7, v1
    v_add_u32 v14, s42, v14
    v_mov_b32 v15, 2146435072
    v_cmp_le_u32 vcc, 8, v1
    s_nop 1
    v_cndmask_b32 v14, v14, v15, vcc
    v_mov_b32 v15, s40
    buffer_store_dword v15, v14, s[8:11], 0 offen sc1
interleave_layers__linear_attn_block__memory_aug_recurrent_mem_tr__prompt_kernel_pb17:
interleave_layers__linear_attn_block__memory_aug_recurrent_mem_tr__prompt_kernel_clr_blk2:
    s_sub_u32 s47, s40, 64
    s_cmp_ge_u32 s47, 60
    s_cbranch_scc1 interleave_layers__linear_attn_block__memory_aug_recurrent_mem_tr__prompt_kernel_clr_last
    s_and_b32 s24, s47, 3
    s_lshl_b32 s24, s24, 7
    s_add_u32 s24, s24, 23107584
    v_lshlrev_b32 v15, 2, v1
    v_add_u32 v15, s24, v15
    s_lshr_b32 s95, s47, 2
    s_add_u32 s95, s95, 2
    s_mov_b32 s61, 0
interleave_layers__linear_attn_block__memory_aug_recurrent_mem_tr__prompt_kernel_clr_wx:
    buffer_load_dword v14, v15, s[8:11], 0 offen sc1
    s_waitcnt vmcnt(0)
    v_cmp_le_i32 vcc, s95, v14
    s_mov_b32 s25, 0xfffff
    s_and_b32 s24, vcc_lo, s25
    s_cmp_eq_u32 s24, s25
    s_cbranch_scc1 interleave_layers__linear_attn_block__memory_aug_recurrent_mem_tr__prompt_kernel_clr_wx_ok
    s_add_u32 s61, s61, 1
    s_cmp_ge_u32 s61, s60
    s_cbranch_scc1 interleave_layers__linear_attn_block__memory_aug_recurrent_mem_tr__prompt_kernel_clr_wx_to
    s_sleep 32
    s_branch interleave_layers__linear_attn_block__memory_aug_recurrent_mem_tr__prompt_kernel_clr_wx
interleave_layers__linear_attn_block__memory_aug_recurrent_mem_tr__prompt_kernel_clr_wx_to:
    s_mov_b32 s60, 1
interleave_layers__linear_attn_block__memory_aug_recurrent_mem_tr__prompt_kernel_clr_wx_ok:
    s_branch interleave_layers__linear_attn_block__memory_aug_recurrent_mem_tr__prompt_kernel_clr_go
interleave_layers__linear_attn_block__memory_aug_recurrent_mem_tr__prompt_kernel_clr_last:
    v_mov_b32 v15, 23111680
    s_mov_b32 s95, 66
    s_mov_b32 s61, 0
interleave_layers__linear_attn_block__memory_aug_recurrent_mem_tr__prompt_kernel_clr_ws:
    buffer_load_dword v14, v15, s[8:11], 0 offen sc1
    s_waitcnt vmcnt(0)
    v_cmp_le_i32 vcc, s95, v14
    s_mov_b32 s25, 0x1
    s_and_b32 s24, vcc_lo, s25
    s_cmp_eq_u32 s24, s25
    s_cbranch_scc1 interleave_layers__linear_attn_block__memory_aug_recurrent_mem_tr__prompt_kernel_clr_ws_ok
    s_add_u32 s61, s61, 1
    s_cmp_ge_u32 s61, s60
    s_cbranch_scc1 interleave_layers__linear_attn_block__memory_aug_recurrent_mem_tr__prompt_kernel_clr_ws_to
    s_sleep 32
    s_branch interleave_layers__linear_attn_block__memory_aug_recurrent_mem_tr__prompt_kernel_clr_ws
interleave_layers__linear_attn_block__memory_aug_recurrent_mem_tr__prompt_kernel_clr_ws_to:
    s_mov_b32 s60, 1
interleave_layers__linear_attn_block__memory_aug_recurrent_mem_tr__prompt_kernel_clr_ws_ok:
interleave_layers__linear_attn_block__memory_aug_recurrent_mem_tr__prompt_kernel_clr_go:
    s_lshl_b32 s24, s47, 12
    s_and_b32 s24, s24, 0x2000
    s_xor_b32 s24, s24, s36
    s_lshl_b32 s41, s47, 20
    s_add_u32 s41, s41, s24
    s_add_u32 s41, s41, 117440512
    s_add_u32 s43, s41, s64
    s_xor_b32 s43, s43, s69
    s_add_u32 s46, s43, 4096
    buffer_store_dwordx4 v[8:11], v5, s[8:11], s43 offen offset:0 sc1
    buffer_store_dwordx4 v[8:11], v5, s[8:11], s43 offen offset:1024 sc1
    buffer_store_dwordx4 v[8:11], v5, s[8:11], s43 offen offset:2048 sc1
    buffer_store_dwordx4 v[8:11], v5, s[8:11], s43 offen offset:3072 sc1
    buffer_store_dwordx4 v[8:11], v5, s[8:11], s46 offen offset:0 sc1
    buffer_store_dwordx4 v[8:11], v5, s[8:11], s46 offen offset:1024 sc1
    buffer_store_dwordx4 v[8:11], v5, s[8:11], s46 offen offset:2048 sc1
    buffer_store_dwordx4 v[8:11], v5, s[8:11], s46 offen offset:3072 sc1
    s_add_u32 s43, s41, s65
    s_xor_b32 s43, s43, s70
    s_add_u32 s46, s43, 4096
    buffer_store_dwordx4 v[8:11], v5, s[8:11], s43 offen offset:0 sc1
    buffer_store_dwordx4 v[8:11], v5, s[8:11], s43 offen offset:1024 sc1
    buffer_store_dwordx4 v[8:11], v5, s[8:11], s43 offen offset:2048 sc1
    buffer_store_dwordx4 v[8:11], v5, s[8:11], s43 offen offset:3072 sc1
    buffer_store_dwordx4 v[8:11], v5, s[8:11], s46 offen offset:0 sc1
    buffer_store_dwordx4 v[8:11], v5, s[8:11], s46 offen offset:1024 sc1
    buffer_store_dwordx4 v[8:11], v5, s[8:11], s46 offen offset:2048 sc1
    buffer_store_dwordx4 v[8:11], v5, s[8:11], s46 offen offset:3072 sc1
    s_add_u32 s43, s41, s66
    s_xor_b32 s43, s43, s71
    s_add_u32 s46, s43, 4096
    buffer_store_dwordx4 v[8:11], v5, s[8:11], s43 offen offset:0 sc1
    buffer_store_dwordx4 v[8:11], v5, s[8:11], s43 offen offset:1024 sc1
    buffer_store_dwordx4 v[8:11], v5, s[8:11], s43 offen offset:2048 sc1
    buffer_store_dwordx4 v[8:11], v5, s[8:11], s43 offen offset:3072 sc1
    buffer_store_dwordx4 v[8:11], v5, s[8:11], s46 offen offset:0 sc1
    buffer_store_dwordx4 v[8:11], v5, s[8:11], s46 offen offset:1024 sc1
    buffer_store_dwordx4 v[8:11], v5, s[8:11], s46 offen offset:2048 sc1
    buffer_store_dwordx4 v[8:11], v5, s[8:11], s46 offen offset:3072 sc1
    s_add_u32 s43, s41, s67
    s_xor_b32 s43, s43, s72
    s_add_u32 s46, s43, 4096
    buffer_store_dwordx4 v[8:11], v5, s[8:11], s43 offen offset:0 sc1
    buffer_store_dwordx4 v[8:11], v5, s[8:11], s43 offen offset:1024 sc1
    buffer_store_dwordx4 v[8:11], v5, s[8:11], s43 offen offset:2048 sc1
    buffer_store_dwordx4 v[8:11], v5, s[8:11], s43 offen offset:3072 sc1
    buffer_store_dwordx4 v[8:11], v5, s[8:11], s46 offen offset:0 sc1
    buffer_store_dwordx4 v[8:11], v5, s[8:11], s46 offen offset:1024 sc1
    buffer_store_dwordx4 v[8:11], v5, s[8:11], s46 offen offset:2048 sc1
    buffer_store_dwordx4 v[8:11], v5, s[8:11], s46 offen offset:3072 sc1
    s_add_u32 s43, s41, s68
    s_xor_b32 s43, s43, s73
    s_add_u32 s46, s43, 4096
    buffer_store_dwordx4 v[8:11], v5, s[8:11], s43 offen offset:0 sc1
    buffer_store_dwordx4 v[8:11], v5, s[8:11], s43 offen offset:1024 sc1
    buffer_store_dwordx4 v[8:11], v5, s[8:11], s43 offen offset:2048 sc1
    buffer_store_dwordx4 v[8:11], v5, s[8:11], s43 offen offset:3072 sc1
    buffer_store_dwordx4 v[8:11], v5, s[8:11], s46 offen offset:0 sc1
    buffer_store_dwordx4 v[8:11], v5, s[8:11], s46 offen offset:1024 sc1
    buffer_store_dwordx4 v[8:11], v5, s[8:11], s46 offen offset:2048 sc1
    buffer_store_dwordx4 v[8:11], v5, s[8:11], s46 offen offset:3072 sc1
    s_waitcnt vmcnt(0)
    s_barrier
    s_add_u32 s40, s40, 1
    s_cmp_eq_u32 s3, 0
    s_cbranch_scc0 interleave_layers__linear_attn_block__memory_aug_recurrent_mem_tr__prompt_kernel_pb18
    v_lshlrev_b32 v14, 7, v1
    v_add_u32 v14, s42, v14
    v_mov_b32 v15, 2146435072
    v_cmp_le_u32 vcc, 8, v1
    s_nop 1
    v_cndmask_b32 v14, v14, v15, vcc
    v_mov_b32 v15, s40
    buffer_store_dword v15, v14, s[8:11], 0 offen sc1
interleave_layers__linear_attn_block__memory_aug_recurrent_mem_tr__prompt_kernel_pb18:
    s_cmp_lt_u32 s40, 128
    s_cbranch_scc1 interleave_layers__linear_attn_block__memory_aug_recurrent_mem_tr__prompt_kernel_clr_blk2
    s_waitcnt vmcnt(0)
    s_branch interleave_layers__linear_attn_block__memory_aug_recurrent_mem_tr__prompt_kernel_end
interleave_layers__linear_attn_block__memory_aug_recurrent_mem_tr__prompt_kernel_roleS:
    s_mov_b32 s44, s2
    s_load_dwordx2 s[6:7], s[0:1], 40
    s_load_dwordx2 s[24:25], s[0:1], 48
    s_load_dwordx2 s[26:27], s[0:1], 32
    s_waitcnt lgkmcnt(0)
    s_mov_b32 s12, s6
    s_mov_b32 s13, s7
    s_mov_b32 s14, 7864320
    s_mov_b32 s15, 0x00020000
    s_mov_b32 s16, s24
    s_mov_b32 s17, s25
    s_mov_b32 s18, 7864320
    s_mov_b32 s19, 0x00020000
    s_mov_b32 s20, s26
    s_mov_b32 s21, s27
    s_mov_b32 s22, 10240
    s_mov_b32 s23, 0x00020000
    v_add_u32 v16, 0, v0
    s_mov_b32 s24, 683
    v_mul_lo_u32 v17, v16, s24
    v_lshrrev_b32 v17, 14, v17
    v_mul_u32_u24 v18, 24, v17
    v_sub_u32 v18, v16, v18
    s_mov_b32 s24, 12288
    v_mul_lo_u32 v4, v17, s24
    v_lshl_add_u32 v4, v18, 4, v4
    v_mul_u32_u24 v10, 400, v17
    v_lshl_add_u32 v10, v18, 4, v10
    v_add_u32 v10, 106496, v10
    v_add_u32 v16, 256, v0
    s_mov_b32 s24, 683
    v_mul_lo_u32 v17, v16, s24
    v_lshrrev_b32 v17, 14, v17
    v_mul_u32_u24 v18, 24, v17
    v_sub_u32 v18, v16, v18
    s_mov_b32 s24, 12288
    v_mul_lo_u32 v5, v17, s24
    v_lshl_add_u32 v5, v18, 4, v5
    v_mul_u32_u24 v11, 400, v17
    v_lshl_add_u32 v11, v18, 4, v11
    v_add_u32 v11, 106496, v11
    v_add_u32 v16, 512, v0
    s_mov_b32 s24, 683
    v_mul_lo_u32 v17, v16, s24
    v_lshrrev_b32 v17, 14, v17
    v_mul_u32_u24 v18, 24, v17
    v_sub_u32 v18, v16, v18
    s_mov_b32 s24, 12288
    v_mul_lo_u32 v6, v17, s24
    v_lshl_add_u32 v6, v18, 4, v6
    v_mul_u32_u24 v12, 400, v17
    v_lshl_add_u32 v12, v18, 4, v12
    v_add_u32 v12, 106496, v12
    v_add_u32 v16, 768, v0
    s_mov_b32 s24, 683
    v_mul_lo_u32 v17, v16, s24
    v_lshrrev_b32 v17, 14, v17
    v_mul_u32_u24 v18, 24, v17
    v_sub_u32 v18, v16, v18
    s_mov_b32 s24, 12288
    v_mul_lo_u32 v7, v17, s24
    v_lshl_add_u32 v7, v18, 4, v7
    v_mul_u32_u24 v13, 400, v17
    v_lshl_add_u32 v13, v18, 4, v13
    v_add_u32 v13, 106496, v13
    v_add_u32 v16, 1024, v0
    s_mov_b32 s24, 683
    v_mul_lo_u32 v17, v16, s24
    v_lshrrev_b32 v17, 14, v17
    v_mul_u32_u24 v18, 24, v17
    v_sub_u32 v18, v16, v18
    s_mov_b32 s24, 12288
    v_mul_lo_u32 v8, v17, s24
    v_lshl_add_u32 v8, v18, 4, v8
    v_mul_u32_u24 v14, 400, v17
    v_lshl_add_u32 v14, v18, 4, v14
    v_add_u32 v14, 106496, v14
    v_add_u32 v16, 1280, v0
    s_mov_b32 s24, 683
    v_mul_lo_u32 v17, v16, s24
    v_lshrrev_b32 v17, 14, v17
    v_mul_u32_u24 v18, 24, v17
    v_sub_u32 v18, v16, v18
    s_mov_b32 s24, 12288
    v_mul_lo_u32 v9, v17, s24
    v_lshl_add_u32 v9, v18, 4, v9
    v_mul_u32_u24 v15, 400, v17
    v_lshl_add_u32 v15, v18, 4, v15
    v_add_u32 v15, 106496, v15
    v_lshrrev_b32 v17, 1, v3
    v_lshlrev_b32 v17, 4, v17
    v_and_b32 v18, 1, v3
    v_lshl_add_u32 v17, v18, 2, v17
    v_lshrrev_b32 v18, 2, v2
    v_and_b32 v19, 1, v18
    v_add_u32 v17, v17, v19
    v_lshrrev_b32 v18, 1, v18
    v_lshl_add_u32 v17, v18, 3, v17
    v_mul_u32_u24 v16, 400, v17
    v_and_b32 v18, 3, v2
    v_lshl_add_u32 v16, v18, 3, v16
    v_add_u32 v16, 106496, v16
    s_mul_i32 s24, s3, 96
    v_add_u32 v16, s24, v16
    v_lshlrev_b32 v17, 4, v1
    s_mul_i32 s24, s3, 20480
    s_add_u32 s24, s24, 24576
    v_add_u32 v17, s24, v17
    s_mul_i32 s45, s44, 384
    s_add_u32 s46, s45, 0
    buffer_load_dwordx4 v[24:27], v4, s[12:15], s46 offen
    buffer_load_dwordx4 v[28:31], v5, s[12:15], s46 offen
    buffer_load_dwordx4 v[32:35], v6, s[12:15], s46 offen
    buffer_load_dwordx4 v[36:39], v7, s[12:15], s46 offen
    buffer_load_dwordx4 v[40:43], v8, s[12:15], s46 offen
    buffer_load_dwordx4 v[44:47], v9, s[12:15], s46 offen
    s_add_u32 s46, s45, 0
    buffer_load_dwordx4 v[48:51], v4, s[16:19], s46 offen
    buffer_load_dwordx4 v[52:55], v5, s[16:19], s46 offen
    buffer_load_dwordx4 v[56:59], v6, s[16:19], s46 offen
    buffer_load_dwordx4 v[60:63], v7, s[16:19], s46 offen
    buffer_load_dwordx4 v[64:67], v8, s[16:19], s46 offen
    buffer_load_dwordx4 v[68:71], v9, s[16:19], s46 offen
    s_waitcnt vmcnt(6)
    ds_write_b128 v10, v[24:27]
    ds_write_b128 v11, v[28:31]
    ds_write_b128 v12, v[32:35]
    ds_write_b128 v13, v[36:39]
    ds_write_b128 v14, v[40:43]
    ds_write_b128 v15, v[44:47]
    s_add_u32 s46, s45, 786432
    buffer_load_dwordx4 v[72:75], v4, s[12:15], s46 offen
    buffer_load_dwordx4 v[76:79], v5, s[12:15], s46 offen
    buffer_load_dwordx4 v[80:83], v6, s[12:15], s46 offen
    buffer_load_dwordx4 v[84:87], v7, s[12:15], s46 offen
    buffer_load_dwordx4 v[88:91], v8, s[12:15], s46 offen
    buffer_load_dwordx4 v[92:95], v9, s[12:15], s46 offen
    s_waitcnt lgkmcnt(0)
    s_barrier
    ds_read_b64_tr_b16 a[0:1], v16 offset:0
    ds_read_b64_tr_b16 a[2:3], v16 offset:800
    ds_read_b64_tr_b16 a[4:5], v16 offset:12800
    ds_read_b64_tr_b16 a[6:7], v16 offset:13600
    ds_read_b64_tr_b16 a[80:81], v16 offset:32
    ds_read_b64_tr_b16 a[82:83], v16 offset:832
    ds_read_b64_tr_b16 a[84:85], v16 offset:12832
    ds_read_b64_tr_b16 a[86:87], v16 offset:13632
    ds_read_b64_tr_b16 a[160:161], v16 offset:64
    ds_read_b64_tr_b16 a[162:163], v16 offset:864
    ds_read_b64_tr_b16 a[164:165], v16 offset:12864
    ds_read_b64_tr_b16 a[166:167], v16 offset:13664
    s_waitcnt lgkmcnt(0)
    s_barrier
    s_waitcnt vmcnt(6)
    ds_write_b128 v10, v[48:51]
    ds_write_b128 v11, v[52:55]
    ds_write_b128 v12, v[56:59]
    ds_write_b128 v13, v[60:63]
    ds_write_b128 v14, v[64:67]
    ds_write_b128 v15, v[68:71]
    s_add_u32 s46, s45, 786432
    buffer_load_dwordx4 v[24:27], v4, s[16:19], s46 offen
    buffer_load_dwordx4 v[28:31], v5, s[16:19], s46 offen
    buffer_load_dwordx4 v[32:35], v6, s[16:19], s46 offen
    buffer_load_dwordx4 v[36:39], v7, s[16:19], s46 offen
    buffer_load_dwordx4 v[40:43], v8, s[16:19], s46 offen
    buffer_load_dwordx4 v[44:47], v9, s[16:19], s46 offen
    s_waitcnt lgkmcnt(0)
    s_barrier
    ds_read_b64_tr_b16 v[96:97], v16 offset:32
    ds_read_b64_tr_b16 v[98:99], v16 offset:832
    ds_read_b64_tr_b16 v[100:101], v16 offset:12832
    ds_read_b64_tr_b16 v[102:103], v16 offset:13632
    ds_read_b64_tr_b16 v[176:177], v16 offset:64
    ds_read_b64_tr_b16 v[178:179], v16 offset:864
    ds_read_b64_tr_b16 v[180:181], v16 offset:12864
    ds_read_b64_tr_b16 v[182:183], v16 offset:13664
    ds_read_b64_tr_b16 v[48:49], v16 offset:0
    ds_read_b64_tr_b16 v[50:51], v16 offset:800
    ds_read_b64_tr_b16 v[52:53], v16 offset:12800
    ds_read_b64_tr_b16 v[54:55], v16 offset:13600
    s_waitcnt lgkmcnt(0)
    ds_write_b128 v17, v[48:51] offset:0
    ds_write_b128 v17, v[52:55] offset:1024
    s_waitcnt lgkmcnt(0)
    s_barrier
    s_waitcnt vmcnt(6)
    ds_write_b128 v10, v[72:75]
    ds_write_b128 v11, v[76:79]
    ds_write_b128 v12, v[80:83]
    ds_write_b128 v13, v[84:87]
    ds_write_b128 v14, v[88:91]
    ds_write_b128 v15, v[92:95]
    s_add_u32 s46, s45, 1572864
    buffer_load_dwordx4 v[48:51], v4, s[12:15], s46 offen
    buffer_load_dwordx4 v[52:55], v5, s[12:15], s46 offen
    buffer_load_dwordx4 v[56:59], v6, s[12:15], s46 offen
    buffer_load_dwordx4 v[60:63], v7, s[12:15], s46 offen
    buffer_load_dwordx4 v[64:67], v8, s[12:15], s46 offen
    buffer_load_dwordx4 v[68:71], v9, s[12:15], s46 offen
    s_waitcnt lgkmcnt(0)
    s_barrier
    ds_read_b64_tr_b16 a[8:9], v16 offset:0
    ds_read_b64_tr_b16 a[10:11], v16 offset:800
    ds_read_b64_tr_b16 a[12:13], v16 offset:12800
    ds_read_b64_tr_b16 a[14:15], v16 offset:13600
    ds_read_b64_tr_b16 a[88:89], v16 offset:32
    ds_read_b64_tr_b16 a[90:91], v16 offset:832
    ds_read_b64_tr_b16 a[92:93], v16 offset:12832
    ds_read_b64_tr_b16 a[94:95], v16 offset:13632
    ds_read_b64_tr_b16 a[168:169], v16 offset:64
    ds_read_b64_tr_b16 a[170:171], v16 offset:864
    ds_read_b64_tr_b16 a[172:173], v16 offset:12864
    ds_read_b64_tr_b16 a[174:175], v16 offset:13664
    s_waitcnt lgkmcnt(0)
    s_barrier
    s_waitcnt vmcnt(6)
    ds_write_b128 v10, v[24:27]
    ds_write_b128 v11, v[28:31]
    ds_write_b128 v12, v[32:35]
    ds_write_b128 v13, v[36:39]
    ds_write_b128 v14, v[40:43]
    ds_write_b128 v15, v[44:47]
    s_add_u32 s46, s45, 1572864
    buffer_load_dwordx4 v[72:75], v4, s[16:19], s46 offen
    buffer_load_dwordx4 v[76:79], v5, s[16:19], s46 offen
    buffer_load_dwordx4 v[80:83], v6, s[16:19], s46 offen
    buffer_load_dwordx4 v[84:87], v7, s[16:19], s46 offen
    buffer_load_dwordx4 v[88:91], v8, s[16:19], s46 offen
    buffer_load_dwordx4 v[92:95], v9, s[16:19], s46 offen
    s_waitcnt lgkmcnt(0)
    s_barrier
    ds_read_b64_tr_b16 v[104:105], v16 offset:32
    ds_read_b64_tr_b16 v[106:107], v16 offset:832
    ds_read_b64_tr_b16 v[108:109], v16 offset:12832
    ds_read_b64_tr_b16 v[110:111], v16 offset:13632
    ds_read_b64_tr_b16 v[184:185], v16 offset:64
    ds_read_b64_tr_b16 v[186:187], v16 offset:864
    ds_read_b64_tr_b16 v[188:189], v16 offset:12864
    ds_read_b64_tr_b16 v[190:191], v16 offset:13664
    ds_read_b64_tr_b16 v[24:25], v16 offset:0
    ds_read_b64_tr_b16 v[26:27], v16 offset:800
    ds_read_b64_tr_b16 v[28:29], v16 offset:12800
    ds_read_b64_tr_b16 v[30:31], v16 offset:13600
    s_waitcnt lgkmcnt(0)
    ds_write_b128 v17, v[24:27] offset:2048
    ds_write_b128 v17, v[28:31] offset:3072
    s_waitcnt lgkmcnt(0)
    s_barrier
    s_waitcnt vmcnt(6)
    ds_write_b128 v10, v[48:51]
    ds_write_b128 v11, v[52:55]
    ds_write_b128 v12, v[56:59]
    ds_write_b128 v13, v[60:63]
    ds_write_b128 v14, v[64:67]
    ds_write_b128 v15, v[68:71]
    s_add_u32 s46, s45, 2359296
    buffer_load_dwordx4 v[24:27], v4, s[12:15], s46 offen
    buffer_load_dwordx4 v[28:31], v5, s[12:15], s46 offen
    buffer_load_dwordx4 v[32:35], v6, s[12:15], s46 offen
    buffer_load_dwordx4 v[36:39], v7, s[12:15], s46 offen
    buffer_load_dwordx4 v[40:43], v8, s[12:15], s46 offen
    buffer_load_dwordx4 v[44:47], v9, s[12:15], s46 offen
    s_waitcnt lgkmcnt(0)
    s_barrier
    ds_read_b64_tr_b16 a[16:17], v16 offset:0
    ds_read_b64_tr_b16 a[18:19], v16 offset:800
    ds_read_b64_tr_b16 a[20:21], v16 offset:12800
    ds_read_b64_tr_b16 a[22:23], v16 offset:13600
    ds_read_b64_tr_b16 a[96:97], v16 offset:32
    ds_read_b64_tr_b16 a[98:99], v16 offset:832
    ds_read_b64_tr_b16 a[100:101], v16 offset:12832
    ds_read_b64_tr_b16 a[102:103], v16 offset:13632
    ds_read_b64_tr_b16 a[176:177], v16 offset:64
    ds_read_b64_tr_b16 a[178:179], v16 offset:864
    ds_read_b64_tr_b16 a[180:181], v16 offset:12864
    ds_read_b64_tr_b16 a[182:183], v16 offset:13664
    s_waitcnt lgkmcnt(0)
    s_barrier
    s_waitcnt vmcnt(6)
    ds_write_b128 v10, v[72:75]
    ds_write_b128 v11, v[76:79]
    ds_write_b128 v12, v[80:83]
    ds_write_b128 v13, v[84:87]
    ds_write_b128 v14, v[88:91]
    ds_write_b128 v15, v[92:95]
    s_add_u32 s46, s45, 2359296
    buffer_load_dwordx4 v[48:51], v4, s[16:19], s46 offen
    buffer_load_dwordx4 v[52:55], v5, s[16:19], s46 offen
    buffer_load_dwordx4 v[56:59], v6, s[16:19], s46 offen
    buffer_load_dwordx4 v[60:63], v7, s[16:19], s46 offen
    buffer_load_dwordx4 v[64:67], v8, s[16:19], s46 offen
    buffer_load_dwordx4 v[68:71], v9, s[16:19], s46 offen
    s_waitcnt lgkmcnt(0)
    s_barrier
    ds_read_b64_tr_b16 v[112:113], v16 offset:32
    ds_read_b64_tr_b16 v[114:115], v16 offset:832
    ds_read_b64_tr_b16 v[116:117], v16 offset:12832
    ds_read_b64_tr_b16 v[118:119], v16 offset:13632
    ds_read_b64_tr_b16 v[192:193], v16 offset:64
    ds_read_b64_tr_b16 v[194:195], v16 offset:864
    ds_read_b64_tr_b16 v[196:197], v16 offset:12864
    ds_read_b64_tr_b16 v[198:199], v16 offset:13664
    ds_read_b64_tr_b16 v[72:73], v16 offset:0
    ds_read_b64_tr_b16 v[74:75], v16 offset:800
    ds_read_b64_tr_b16 v[76:77], v16 offset:12800
    ds_read_b64_tr_b16 v[78:79], v16 offset:13600
    s_waitcnt lgkmcnt(0)
    ds_write_b128 v17, v[72:75] offset:4096
    ds_write_b128 v17, v[76:79] offset:5120
    s_waitcnt lgkmcnt(0)
    s_barrier
    s_waitcnt vmcnt(6)
    ds_write_b128 v10, v[24:27]
    ds_write_b128 v11, v[28:31]
    ds_write_b128 v12, v[32:35]
    ds_write_b128 v13, v[36:39]
    ds_write_b128 v14, v[40:43]
    ds_write_b128 v15, v[44:47]
    s_add_u32 s46, s45, 3145728
    buffer_load_dwordx4 v[72:75], v4, s[12:15], s46 offen
    buffer_load_dwordx4 v[76:79], v5, s[12:15], s46 offen
    buffer_load_dwordx4 v[80:83], v6, s[12:15], s46 offen
    buffer_load_dwordx4 v[84:87], v7, s[12:15], s46 offen
    buffer_load_dwordx4 v[88:91], v8, s[12:15], s46 offen
    buffer_load_dwordx4 v[92:95], v9, s[12:15], s46 offen
    s_waitcnt lgkmcnt(0)
    s_barrier
    ds_read_b64_tr_b16 a[24:25], v16 offset:0
    ds_read_b64_tr_b16 a[26:27], v16 offset:800
    ds_read_b64_tr_b16 a[28:29], v16 offset:12800
    ds_read_b64_tr_b16 a[30:31], v16 offset:13600
    ds_read_b64_tr_b16 a[104:105], v16 offset:32
    ds_read_b64_tr_b16 a[106:107], v16 offset:832
    ds_read_b64_tr_b16 a[108:109], v16 offset:12832
    ds_read_b64_tr_b16 a[110:111], v16 offset:13632
    ds_read_b64_tr_b16 a[184:185], v16 offset:64
    ds_read_b64_tr_b16 a[186:187], v16 offset:864
    ds_read_b64_tr_b16 a[188:189], v16 offset:12864
    ds_read_b64_tr_b16 a[190:191], v16 offset:13664
    s_waitcnt lgkmcnt(0)
    s_barrier
    s_waitcnt vmcnt(6)
    ds_write_b128 v10, v[48:51]
    ds_write_b128 v11, v[52:55]
    ds_write_b128 v12, v[56:59]
    ds_write_b128 v13, v[60:63]
    ds_write_b128 v14, v[64:67]
    ds_write_b128 v15, v[68:71]
    s_add_u32 s46, s45, 3145728
    buffer_load_dwordx4 v[24:27], v4, s[16:19], s46 offen
    buffer_load_dwordx4 v[28:31], v5, s[16:19], s46 offen
    buffer_load_dwordx4 v[32:35], v6, s[16:19], s46 offen
    buffer_load_dwordx4 v[36:39], v7, s[16:19], s46 offen
    buffer_load_dwordx4 v[40:43], v8, s[16:19], s46 offen
    buffer_load_dwordx4 v[44:47], v9, s[16:19], s46 offen
    s_waitcnt lgkmcnt(0)
    s_barrier
    ds_read_b64_tr_b16 v[120:121], v16 offset:32
    ds_read_b64_tr_b16 v[122:123], v16 offset:832
    ds_read_b64_tr_b16 v[124:125], v16 offset:12832
    ds_read_b64_tr_b16 v[126:127], v16 offset:13632
    ds_read_b64_tr_b16 v[200:201], v16 offset:64
    ds_read_b64_tr_b16 v[202:203], v16 offset:864
    ds_read_b64_tr_b16 v[204:205], v16 offset:12864
    ds_read_b64_tr_b16 v[206:207], v16 offset:13664
    ds_read_b64_tr_b16 v[48:49], v16 offset:0
    ds_read_b64_tr_b16 v[50:51], v16 offset:800
    ds_read_b64_tr_b16 v[52:53], v16 offset:12800
    ds_read_b64_tr_b16 v[54:55], v16 offset:13600
    s_waitcnt lgkmcnt(0)
    ds_write_b128 v17, v[48:51] offset:6144
    ds_write_b128 v17, v[52:55] offset:7168
    s_waitcnt lgkmcnt(0)
    s_barrier
    s_waitcnt vmcnt(6)
    ds_write_b128 v10, v[72:75]
    ds_write_b128 v11, v[76:79]
    ds_write_b128 v12, v[80:83]
    ds_write_b128 v13, v[84:87]
    ds_write_b128 v14, v[88:91]
    ds_write_b128 v15, v[92:95]
    s_add_u32 s46, s45, 3932160
    buffer_load_dwordx4 v[48:51], v4, s[12:15], s46 offen
    buffer_load_dwordx4 v[52:55], v5, s[12:15], s46 offen
    buffer_load_dwordx4 v[56:59], v6, s[12:15], s46 offen
    buffer_load_dwordx4 v[60:63], v7, s[12:15], s46 offen
    buffer_load_dwordx4 v[64:67], v8, s[12:15], s46 offen
    buffer_load_dwordx4 v[68:71], v9, s[12:15], s46 offen
    s_waitcnt lgkmcnt(0)
    s_barrier
    ds_read_b64_tr_b16 a[32:33], v16 offset:0
    ds_read_b64_tr_b16 a[34:35], v16 offset:800
    ds_read_b64_tr_b16 a[36:37], v16 offset:12800
    ds_read_b64_tr_b16 a[38:39], v16 offset:13600
    ds_read_b64_tr_b16 a[112:113], v16 offset:32
    ds_read_b64_tr_b16 a[114:115], v16 offset:832
    ds_read_b64_tr_b16 a[116:117], v16 offset:12832
    ds_read_b64_tr_b16 a[118:119], v16 offset:13632
    ds_read_b64_tr_b16 a[192:193], v16 offset:64
    ds_read_b64_tr_b16 a[194:195], v16 offset:864
    ds_read_b64_tr_b16 a[196:197], v16 offset:12864
    ds_read_b64_tr_b16 a[198:199], v16 offset:13664
    s_waitcnt lgkmcnt(0)
    s_barrier
    s_waitcnt vmcnt(6)
    ds_write_b128 v10, v[24:27]
    ds_write_b128 v11, v[28:31]
    ds_write_b128 v12, v[32:35]
    ds_write_b128 v13, v[36:39]
    ds_write_b128 v14, v[40:43]
    ds_write_b128 v15, v[44:47]
    s_add_u32 s46, s45, 3932160
    buffer_load_dwordx4 v[72:75], v4, s[16:19], s46 offen
    buffer_load_dwordx4 v[76:79], v5, s[16:19], s46 offen
    buffer_load_dwordx4 v[80:83], v6, s[16:19], s46 offen
    buffer_load_dwordx4 v[84:87], v7, s[16:19], s46 offen
    buffer_load_dwordx4 v[88:91], v8, s[16:19], s46 offen
    buffer_load_dwordx4 v[92:95], v9, s[16:19], s46 offen
    s_waitcnt lgkmcnt(0)
    s_barrier
    ds_read_b64_tr_b16 v[128:129], v16 offset:32
    ds_read_b64_tr_b16 v[130:131], v16 offset:832
    ds_read_b64_tr_b16 v[132:133], v16 offset:12832
    ds_read_b64_tr_b16 v[134:135], v16 offset:13632
    ds_read_b64_tr_b16 v[208:209], v16 offset:64
    ds_read_b64_tr_b16 v[210:211], v16 offset:864
    ds_read_b64_tr_b16 v[212:213], v16 offset:12864
    ds_read_b64_tr_b16 v[214:215], v16 offset:13664
    ds_read_b64_tr_b16 v[24:25], v16 offset:0
    ds_read_b64_tr_b16 v[26:27], v16 offset:800
    ds_read_b64_tr_b16 v[28:29], v16 offset:12800
    ds_read_b64_tr_b16 v[30:31], v16 offset:13600
    s_waitcnt lgkmcnt(0)
    ds_write_b128 v17, v[24:27] offset:8192
    ds_write_b128 v17, v[28:31] offset:9216
    s_waitcnt lgkmcnt(0)
    s_barrier
    s_waitcnt vmcnt(6)
    ds_write_b128 v10, v[48:51]
    ds_write_b128 v11, v[52:55]
    ds_write_b128 v12, v[56:59]
    ds_write_b128 v13, v[60:63]
    ds_write_b128 v14, v[64:67]
    ds_write_b128 v15, v[68:71]
    s_add_u32 s46, s45, 4718592
    buffer_load_dwordx4 v[24:27], v4, s[12:15], s46 offen
    buffer_load_dwordx4 v[28:31], v5, s[12:15], s46 offen
    buffer_load_dwordx4 v[32:35], v6, s[12:15], s46 offen
    buffer_load_dwordx4 v[36:39], v7, s[12:15], s46 offen
    buffer_load_dwordx4 v[40:43], v8, s[12:15], s46 offen
    buffer_load_dwordx4 v[44:47], v9, s[12:15], s46 offen
    s_waitcnt lgkmcnt(0)
    s_barrier
    ds_read_b64_tr_b16 a[40:41], v16 offset:0
    ds_read_b64_tr_b16 a[42:43], v16 offset:800
    ds_read_b64_tr_b16 a[44:45], v16 offset:12800
    ds_read_b64_tr_b16 a[46:47], v16 offset:13600
    ds_read_b64_tr_b16 a[120:121], v16 offset:32
    ds_read_b64_tr_b16 a[122:123], v16 offset:832
    ds_read_b64_tr_b16 a[124:125], v16 offset:12832
    ds_read_b64_tr_b16 a[126:127], v16 offset:13632
    ds_read_b64_tr_b16 a[200:201], v16 offset:64
    ds_read_b64_tr_b16 a[202:203], v16 offset:864
    ds_read_b64_tr_b16 a[204:205], v16 offset:12864
    ds_read_b64_tr_b16 a[206:207], v16 offset:13664
    s_waitcnt lgkmcnt(0)
    s_barrier
    s_waitcnt vmcnt(6)
    ds_write_b128 v10, v[72:75]
    ds_write_b128 v11, v[76:79]
    ds_write_b128 v12, v[80:83]
    ds_write_b128 v13, v[84:87]
    ds_write_b128 v14, v[88:91]
    ds_write_b128 v15, v[92:95]
    s_add_u32 s46, s45, 4718592
    buffer_load_dwordx4 v[48:51], v4, s[16:19], s46 offen
    buffer_load_dwordx4 v[52:55], v5, s[16:19], s46 offen
    buffer_load_dwordx4 v[56:59], v6, s[16:19], s46 offen
    buffer_load_dwordx4 v[60:63], v7, s[16:19], s46 offen
    buffer_load_dwordx4 v[64:67], v8, s[16:19], s46 offen
    buffer_load_dwordx4 v[68:71], v9, s[16:19], s46 offen
    s_waitcnt lgkmcnt(0)
    s_barrier
    ds_read_b64_tr_b16 v[136:137], v16 offset:32
    ds_read_b64_tr_b16 v[138:139], v16 offset:832
    ds_read_b64_tr_b16 v[140:141], v16 offset:12832
    ds_read_b64_tr_b16 v[142:143], v16 offset:13632
    ds_read_b64_tr_b16 v[216:217], v16 offset:64
    ds_read_b64_tr_b16 v[218:219], v16 offset:864
    ds_read_b64_tr_b16 v[220:221], v16 offset:12864
    ds_read_b64_tr_b16 v[222:223], v16 offset:13664
    ds_read_b64_tr_b16 v[72:73], v16 offset:0
    ds_read_b64_tr_b16 v[74:75], v16 offset:800
    ds_read_b64_tr_b16 v[76:77], v16 offset:12800
    ds_read_b64_tr_b16 v[78:79], v16 offset:13600
    s_waitcnt lgkmcnt(0)
    ds_write_b128 v17, v[72:75] offset:10240
    ds_write_b128 v17, v[76:79] offset:11264
    s_waitcnt lgkmcnt(0)
    s_barrier
    s_waitcnt vmcnt(6)
    ds_write_b128 v10, v[24:27]
    ds_write_b128 v11, v[28:31]
    ds_write_b128 v12, v[32:35]
    ds_write_b128 v13, v[36:39]
    ds_write_b128 v14, v[40:43]
    ds_write_b128 v15, v[44:47]
    s_add_u32 s46, s45, 5505024
    buffer_load_dwordx4 v[72:75], v4, s[12:15], s46 offen
    buffer_load_dwordx4 v[76:79], v5, s[12:15], s46 offen
    buffer_load_dwordx4 v[80:83], v6, s[12:15], s46 offen
    buffer_load_dwordx4 v[84:87], v7, s[12:15], s46 offen
    buffer_load_dwordx4 v[88:91], v8, s[12:15], s46 offen
    buffer_load_dwordx4 v[92:95], v9, s[12:15], s46 offen
    s_waitcnt lgkmcnt(0)
    s_barrier
    ds_read_b64_tr_b16 a[48:49], v16 offset:0
    ds_read_b64_tr_b16 a[50:51], v16 offset:800
    ds_read_b64_tr_b16 a[52:53], v16 offset:12800
    ds_read_b64_tr_b16 a[54:55], v16 offset:13600
    ds_read_b64_tr_b16 a[128:129], v16 offset:32
    ds_read_b64_tr_b16 a[130:131], v16 offset:832
    ds_read_b64_tr_b16 a[132:133], v16 offset:12832
    ds_read_b64_tr_b16 a[134:135], v16 offset:13632
    ds_read_b64_tr_b16 a[208:209], v16 offset:64
    ds_read_b64_tr_b16 a[210:211], v16 offset:864
    ds_read_b64_tr_b16 a[212:213], v16 offset:12864
    ds_read_b64_tr_b16 a[214:215], v16 offset:13664
    s_waitcnt lgkmcnt(0)
    s_barrier
    s_waitcnt vmcnt(6)
    ds_write_b128 v10, v[48:51]
    ds_write_b128 v11, v[52:55]
    ds_write_b128 v12, v[56:59]
    ds_write_b128 v13, v[60:63]
    ds_write_b128 v14, v[64:67]
    ds_write_b128 v15, v[68:71]
    s_add_u32 s46, s45, 5505024
    buffer_load_dwordx4 v[24:27], v4, s[16:19], s46 offen
    buffer_load_dwordx4 v[28:31], v5, s[16:19], s46 offen
    buffer_load_dwordx4 v[32:35], v6, s[16:19], s46 offen
    buffer_load_dwordx4 v[36:39], v7, s[16:19], s46 offen
    buffer_load_dwordx4 v[40:43], v8, s[16:19], s46 offen
    buffer_load_dwordx4 v[44:47], v9, s[16:19], s46 offen
    s_waitcnt lgkmcnt(0)
    s_barrier
    ds_read_b64_tr_b16 v[144:145], v16 offset:32
    ds_read_b64_tr_b16 v[146:147], v16 offset:832
    ds_read_b64_tr_b16 v[148:149], v16 offset:12832
    ds_read_b64_tr_b16 v[150:151], v16 offset:13632
    ds_read_b64_tr_b16 v[224:225], v16 offset:64
    ds_read_b64_tr_b16 v[226:227], v16 offset:864
    ds_read_b64_tr_b16 v[228:229], v16 offset:12864
    ds_read_b64_tr_b16 v[230:231], v16 offset:13664
    ds_read_b64_tr_b16 v[48:49], v16 offset:0
    ds_read_b64_tr_b16 v[50:51], v16 offset:800
    ds_read_b64_tr_b16 v[52:53], v16 offset:12800
    ds_read_b64_tr_b16 v[54:55], v16 offset:13600
    s_waitcnt lgkmcnt(0)
    ds_write_b128 v17, v[48:51] offset:12288
    ds_write_b128 v17, v[52:55] offset:13312
    s_waitcnt lgkmcnt(0)
    s_barrier
    s_waitcnt vmcnt(6)
    ds_write_b128 v10, v[72:75]
    ds_write_b128 v11, v[76:79]
    ds_write_b128 v12, v[80:83]
    ds_write_b128 v13, v[84:87]
    ds_write_b128 v14, v[88:91]
    ds_write_b128 v15, v[92:95]
    s_add_u32 s46, s45, 6291456
    buffer_load_dwordx4 v[48:51], v4, s[12:15], s46 offen
    buffer_load_dwordx4 v[52:55], v5, s[12:15], s46 offen
    buffer_load_dwordx4 v[56:59], v6, s[12:15], s46 offen
    buffer_load_dwordx4 v[60:63], v7, s[12:15], s46 offen
    buffer_load_dwordx4 v[64:67], v8, s[12:15], s46 offen
    buffer_load_dwordx4 v[68:71], v9, s[12:15], s46 offen
    s_waitcnt lgkmcnt(0)
    s_barrier
    ds_read_b64_tr_b16 a[56:57], v16 offset:0
    ds_read_b64_tr_b16 a[58:59], v16 offset:800
    ds_read_b64_tr_b16 a[60:61], v16 offset:12800
    ds_read_b64_tr_b16 a[62:63], v16 offset:13600
    ds_read_b64_tr_b16 a[136:137], v16 offset:32
    ds_read_b64_tr_b16 a[138:139], v16 offset:832
    ds_read_b64_tr_b16 a[140:141], v16 offset:12832
    ds_read_b64_tr_b16 a[142:143], v16 offset:13632
    ds_read_b64_tr_b16 a[216:217], v16 offset:64
    ds_read_b64_tr_b16 a[218:219], v16 offset:864
    ds_read_b64_tr_b16 a[220:221], v16 offset:12864
    ds_read_b64_tr_b16 a[222:223], v16 offset:13664
    s_waitcnt lgkmcnt(0)
    s_barrier
    s_waitcnt vmcnt(6)
    ds_write_b128 v10, v[24:27]
    ds_write_b128 v11, v[28:31]
    ds_write_b128 v12, v[32:35]
    ds_write_b128 v13, v[36:39]
    ds_write_b128 v14, v[40:43]
    ds_write_b128 v15, v[44:47]
    s_add_u32 s46, s45, 6291456
    buffer_load_dwordx4 v[72:75], v4, s[16:19], s46 offen
    buffer_load_dwordx4 v[76:79], v5, s[16:19], s46 offen
    buffer_load_dwordx4 v[80:83], v6, s[16:19], s46 offen
    buffer_load_dwordx4 v[84:87], v7, s[16:19], s46 offen
    buffer_load_dwordx4 v[88:91], v8, s[16:19], s46 offen
    buffer_load_dwordx4 v[92:95], v9, s[16:19], s46 offen
    s_waitcnt lgkmcnt(0)
    s_barrier
    ds_read_b64_tr_b16 v[152:153], v16 offset:32
    ds_read_b64_tr_b16 v[154:155], v16 offset:832
    ds_read_b64_tr_b16 v[156:157], v16 offset:12832
    ds_read_b64_tr_b16 v[158:159], v16 offset:13632
    ds_read_b64_tr_b16 v[232:233], v16 offset:64
    ds_read_b64_tr_b16 v[234:235], v16 offset:864
    ds_read_b64_tr_b16 v[236:237], v16 offset:12864
    ds_read_b64_tr_b16 v[238:239], v16 offset:13664
    ds_read_b64_tr_b16 v[24:25], v16 offset:0
    ds_read_b64_tr_b16 v[26:27], v16 offset:800
    ds_read_b64_tr_b16 v[28:29], v16 offset:12800
    ds_read_b64_tr_b16 v[30:31], v16 offset:13600
    s_waitcnt lgkmcnt(0)
    ds_write_b128 v17, v[24:27] offset:14336
    ds_write_b128 v17, v[28:31] offset:15360
    s_waitcnt lgkmcnt(0)
    s_barrier
    s_waitcnt vmcnt(6)
    ds_write_b128 v10, v[48:51]
    ds_write_b128 v11, v[52:55]
    ds_write_b128 v12, v[56:59]
    ds_write_b128 v13, v[60:63]
    ds_write_b128 v14, v[64:67]
    ds_write_b128 v15, v[68:71]
    s_add_u32 s46, s45, 7077888
    buffer_load_dwordx4 v[24:27], v4, s[12:15], s46 offen
    buffer_load_dwordx4 v[28:31], v5, s[12:15], s46 offen
    buffer_load_dwordx4 v[32:35], v6, s[12:15], s46 offen
    buffer_load_dwordx4 v[36:39], v7, s[12:15], s46 offen
    buffer_load_dwordx4 v[40:43], v8, s[12:15], s46 offen
    buffer_load_dwordx4 v[44:47], v9, s[12:15], s46 offen
    s_waitcnt lgkmcnt(0)
    s_barrier
    ds_read_b64_tr_b16 a[64:65], v16 offset:0
    ds_read_b64_tr_b16 a[66:67], v16 offset:800
    ds_read_b64_tr_b16 a[68:69], v16 offset:12800
    ds_read_b64_tr_b16 a[70:71], v16 offset:13600
    ds_read_b64_tr_b16 a[144:145], v16 offset:32
    ds_read_b64_tr_b16 a[146:147], v16 offset:832
    ds_read_b64_tr_b16 a[148:149], v16 offset:12832
    ds_read_b64_tr_b16 a[150:151], v16 offset:13632
    ds_read_b64_tr_b16 a[224:225], v16 offset:64
    ds_read_b64_tr_b16 a[226:227], v16 offset:864
    ds_read_b64_tr_b16 a[228:229], v16 offset:12864
    ds_read_b64_tr_b16 a[230:231], v16 offset:13664
    s_waitcnt lgkmcnt(0)
    s_barrier
    s_waitcnt vmcnt(6)
    ds_write_b128 v10, v[72:75]
    ds_write_b128 v11, v[76:79]
    ds_write_b128 v12, v[80:83]
    ds_write_b128 v13, v[84:87]
    ds_write_b128 v14, v[88:91]
    ds_write_b128 v15, v[92:95]
    s_add_u32 s46, s45, 7077888
    buffer_load_dwordx4 v[48:51], v4, s[16:19], s46 offen
    buffer_load_dwordx4 v[52:55], v5, s[16:19], s46 offen
    buffer_load_dwordx4 v[56:59], v6, s[16:19], s46 offen
    buffer_load_dwordx4 v[60:63], v7, s[16:19], s46 offen
    buffer_load_dwordx4 v[64:67], v8, s[16:19], s46 offen
    buffer_load_dwordx4 v[68:71], v9, s[16:19], s46 offen
    s_waitcnt lgkmcnt(0)
    s_barrier
    ds_read_b64_tr_b16 v[160:161], v16 offset:32
    ds_read_b64_tr_b16 v[162:163], v16 offset:832
    ds_read_b64_tr_b16 v[164:165], v16 offset:12832
    ds_read_b64_tr_b16 v[166:167], v16 offset:13632
    ds_read_b64_tr_b16 v[240:241], v16 offset:64
    ds_read_b64_tr_b16 v[242:243], v16 offset:864
    ds_read_b64_tr_b16 v[244:245], v16 offset:12864
    ds_read_b64_tr_b16 v[246:247], v16 offset:13664
    ds_read_b64_tr_b16 v[72:73], v16 offset:0
    ds_read_b64_tr_b16 v[74:75], v16 offset:800
    ds_read_b64_tr_b16 v[76:77], v16 offset:12800
    ds_read_b64_tr_b16 v[78:79], v16 offset:13600
    s_waitcnt lgkmcnt(0)
    ds_write_b128 v17, v[72:75] offset:16384
    ds_write_b128 v17, v[76:79] offset:17408
    s_waitcnt lgkmcnt(0)
    s_barrier
    s_waitcnt vmcnt(6)
    ds_write_b128 v10, v[24:27]
    ds_write_b128 v11, v[28:31]
    ds_write_b128 v12, v[32:35]
    ds_write_b128 v13, v[36:39]
    ds_write_b128 v14, v[40:43]
    ds_write_b128 v15, v[44:47]
    s_waitcnt lgkmcnt(0)
    s_barrier
    ds_read_b64_tr_b16 a[72:73], v16 offset:0
    ds_read_b64_tr_b16 a[74:75], v16 offset:800
    ds_read_b64_tr_b16 a[76:77], v16 offset:12800
    ds_read_b64_tr_b16 a[78:79], v16 offset:13600
    ds_read_b64_tr_b16 a[152:153], v16 offset:32
    ds_read_b64_tr_b16 a[154:155], v16 offset:832
    ds_read_b64_tr_b16 a[156:157], v16 offset:12832
    ds_read_b64_tr_b16 a[158:159], v16 offset:13632
    ds_read_b64_tr_b16 a[232:233], v16 offset:64
    ds_read_b64_tr_b16 a[234:235], v16 offset:864
    ds_read_b64_tr_b16 a[236:237], v16 offset:12864
    ds_read_b64_tr_b16 a[238:239], v16 offset:13664
    s_waitcnt lgkmcnt(0)
    s_barrier
    s_waitcnt vmcnt(0)
    ds_write_b128 v10, v[48:51]
    ds_write_b128 v11, v[52:55]
    ds_write_b128 v12, v[56:59]
    ds_write_b128 v13, v[60:63]
    ds_write_b128 v14, v[64:67]
    ds_write_b128 v15, v[68:71]
    s_waitcnt lgkmcnt(0)
    s_barrier
    ds_read_b64_tr_b16 v[168:169], v16 offset:32
    ds_read_b64_tr_b16 v[170:171], v16 offset:832
    ds_read_b64_tr_b16 v[172:173], v16 offset:12832
    ds_read_b64_tr_b16 v[174:175], v16 offset:13632
    ds_read_b64_tr_b16 v[248:249], v16 offset:64
    ds_read_b64_tr_b16 v[250:251], v16 offset:864
    ds_read_b64_tr_b16 v[252:253], v16 offset:12864
    ds_read_b64_tr_b16 v[254:255], v16 offset:13664
    ds_read_b64_tr_b16 v[48:49], v16 offset:0
    ds_read_b64_tr_b16 v[50:51], v16 offset:800
    ds_read_b64_tr_b16 v[52:53], v16 offset:12800
    ds_read_b64_tr_b16 v[54:55], v16 offset:13600
    s_waitcnt lgkmcnt(0)
    ds_write_b128 v17, v[48:51] offset:18432
    ds_write_b128 v17, v[52:55] offset:19456
    s_waitcnt lgkmcnt(0)
    s_barrier
    v_mov_b32 v6, v17
    v_mov_b32 v30, 0xeeee
    v_mov_b32 v4, 0x4444
    v_cmp_gt_u32 vcc, 8, v2
    s_nop 1
    v_cndmask_b32 v4, v30, v4, vcc
    v_lshlrev_b32 v5, 4, v1
    s_lshl_b32 s24, s3, 10
    v_add_u32 v7, s24, v5
    s_lshl_b32 s24, s3, 9
    s_add_u32 s24, s24, 8192
    v_lshlrev_b32 v8, 3, v1
    v_add_u32 v8, s24, v8
    v_and_b32 v30, 1, v2
    v_lshlrev_b32 v30, 4, v30
    v_mov_b32 v31, 0x3f80
    v_lshlrev_b32 v31, v30, v31
    v_lshrrev_b32 v30, 2, v2
    v_cmp_eq_u32 vcc, v30, v3
    s_nop 1
    v_cndmask_b32 v31, 0, v31, vcc
    v_and_b32 v30, 2, v2
    v_cmp_eq_u32 vcc, 0, v30
    s_nop 1
    v_cndmask_b32 v10, 0, v31, vcc
    v_cndmask_b32 v11, v31, 0, vcc
    v_add_u32 v33, 22528, v5
    s_mul_i32 s24, s3, 1408
    s_add_u32 s24, s24, 16384
    v_mul_u32_u24 v30, 176, v2
    v_add_u32 v30, s24, v30
    v_lshl_add_u32 v12, v3, 5, v30
    v_cmp_gt_u32 vcc, 8, v2
    s_nop 1
    v_cndmask_b32 v12, v33, v12, vcc
    v_lshl_add_u32 v13, v3, 4, v30
    v_add_u32 v13, 96, v13
    v_cmp_le_u32 s[24:25], 2, v3
    s_and_b64 vcc, vcc, s[24:25]
    v_cndmask_b32 v13, v33, v13, vcc
    s_mul_i32 s24, s3, 5632
    s_add_u32 s24, s24, 106496
    v_mul_u32_u24 v30, 176, v2
    v_add_u32 v30, s24, v30
    v_lshl_add_u32 v16, v3, 5, v30
    v_lshl_add_u32 v17, v3, 4, v30
    v_add_u32 v17, 96, v17
    v_add_u32 v18, 2816, v17
    v_cmp_le_u32 vcc, 2, v3
    s_nop 1
    v_cndmask_b32 v17, v33, v17, vcc
    v_cndmask_b32 v18, v33, v18, vcc
    v_lshrrev_b32 v30, 3, v1
    v_and_b32 v31, 7, v1
    v_min_u32 v32, 4, v31
    v_mul_u32_u24 v14, 176, v30
    v_lshl_add_u32 v14, v32, 5, v14
    s_mul_i32 s24, s3, 1408
    s_add_u32 s24, s24, 106496
    v_add_u32 v21, s24, v14
    v_add_u32 v14, 16384, v14
    v_cmp_gt_u32 s[50:51], 5, v31
    s_lshl_b32 s24, s3, 3
    v_add_u32 v32, s24, v30
    v_lshlrev_b32 v33, 2, v31
    v_sub_u32 v32, v32, v33
    v_mov_b32 v33, 100
    v_cmp_gt_u32 vcc, 4, v31
    s_nop 1
    v_cndmask_b32 v32, v33, v32, vcc
    v_cmp_le_i32 s[64:65], 0, v32
    v_cmp_le_i32 s[66:67], 1, v32
    v_cmp_le_i32 s[68:69], 2, v32
    v_cmp_le_i32 s[70:71], 3, v32
    v_cmp_le_i32 s[72:73], 16, v32
    v_cmp_le_i32 s[74:75], 17, v32
    v_cmp_le_i32 s[76:77], 18, v32
    v_cmp_le_i32 s[78:79], 19, v32
    s_lshr_b32 s24, s44, 1
    s_lshl_b32 s24, s24, 10
    s_and_b32 s25, s44, 1
    s_lshl_b32 s25, s25, 7
    s_add_u32 s24, s24, s25
    v_lshlrev_b32 v15, 8, v31
    v_lshl_add_u32 v15, v30, 4, v15
    v_add_u32 v15, s24, v15
    s_lshr_b32 s24, s44, 3
    s_lshl_b32 s24, s24, 10
    s_and_b32 s25, s44, 3
    s_lshl_b32 s25, s25, 8
    s_add_u32 s24, s24, s25
    s_lshr_b32 s25, s44, 2
    s_and_b32 s25, s25, 1
    s_lshl_b32 s25, s25, 7
    s_add_u32 s24, s24, s25
    s_add_u32 s24, s24, 16384
    v_lshlrev_b32 v32, 4, v30
    v_add_u32 v32, s24, v32
    v_cmp_eq_u32 vcc, 4, v31
    s_nop 1
    v_cndmask_b32 v15, v15, v32, vcc
    v_and_b32 v32, 0xffffe000, v15
    v_add_u32 v15, v15, v32
    v_mov_b32 v32, 2146435072
    v_cndmask_b32 v15, v32, v15, s[50:51]
    s_cmp_lt_u32 s3, 1
    s_cselect_b32 s24, 0, 2146435072
    v_or_b32 v15, s24, v15
    s_and_b32 s24, s3, 1
    s_lshl_b32 s24, s24, 7
    s_lshr_b32 s25, s3, 1
    s_lshl_b32 s25, s25, 10
    s_add_u32 s24, s24, s25
    s_lshl_b32 s25, s44, 11
    s_add_u32 s25, s25, s24
    v_lshlrev_b32 v22, 8, v31
    v_lshl_add_u32 v22, v30, 4, v22
    v_add_u32 v22, s25, v22
    s_lshr_b32 s25, s44, 2
    s_lshl_b32 s25, s25, 11
    s_add_u32 s25, s25, s24
    s_and_b32 s26, s44, 3
    s_lshl_b32 s26, s26, 8
    s_add_u32 s25, s25, s26
    s_add_u32 s25, s25, 65536
    v_lshlrev_b32 v32, 4, v30
    v_add_u32 v32, s25, v32
    v_cmp_eq_u32 vcc, 4, v31
    s_nop 1
    v_cndmask_b32 v22, v22, v32, vcc
    v_and_b32 v32, 0xffffe000, v22
    v_add_u32 v22, v22, v32
    v_mov_b32 v32, 2146435072
    v_cndmask_b32 v22, v32, v22, s[50:51]
    s_mul_i32 s24, s44, 12288
    s_mul_i32 s25, s3, 3072
    s_add_u32 s24, s24, s25
    v_add_u32 v19, s24, v5
    s_and_b32 s24, s2, 15
    s_mul_i32 s25, s3, 16
    s_add_u32 s24, s24, s25
    s_lshl_b32 s24, s24, 7
    v_mov_b32 v23, s24
    s_lshr_b32 s25, s44, 3
    s_mul_i32 s24, s25, 8
    v_add_u32 v20, s24, v1
    v_lshlrev_b32 v20, 7, v20
    v_mov_b32 v30, 2146435072
    v_cmp_le_u32 vcc, 8, v1
    s_nop 1
    v_cndmask_b32 v20, v20, v30, vcc
    s_cmp_eq_u32 s3, 0
    s_cselect_b32 s24, 0, 2146435072
    v_or_b32 v20, s24, v20
    v_mov_b32 v0, 1
interleave_layers__linear_attn_block__memory_aug_recurrent_mem_tr__prompt_kernel_s_layer:
    s_mov_b32 s93, 0
    s_lshl_b32 s24, s93, 12
    s_and_b32 s24, s24, 0x2000
    s_xor_b32 s24, s24, s36
    s_lshl_b32 s93, s93, 20
    s_add_u32 s93, s93, s24
    s_add_u32 s93, s93, 117440512
    s_mul_i32 s94, s92, 16384
    s_add_u32 s94, s94, 23068672
    v_and_b32 v9, 1, v1
    v_lshlrev_b32 v9, 12, v9
    s_lshl_b32 s24, s44, 7
    s_add_u32 s24, s24, s94
    v_add_u32 v9, s24, v9
    s_lshl_b32 s24, s3, 6
    s_add_u32 s24, s24, 0
    v_add_u32 v48, s24, v1
    v_and_b32 v49, 7, v48
    v_mul_u32_u24 v49, 1280, v49
    v_lshrrev_b32 v50, 3, v48
    v_lshl_add_u32 v49, v50, 4, v49
    v_cmp_gt_u32 vcc, 640, v48
    v_mov_b32 v51, 2146435072
    s_nop 0
    v_cndmask_b32 v49, v51, v49, vcc
    buffer_load_dwordx4 v[52:55], v49, s[20:23], 0 offen
    v_lshlrev_b32 v48, 4, v48
    s_waitcnt vmcnt(0)
    s_and_saveexec_b64 s[30:31], vcc
    ds_write_b128 v48, v[52:55]
    s_mov_b64 exec, s[30:31]
    s_lshl_b32 s24, s3, 6
    s_add_u32 s24, s24, 256
    v_add_u32 v48, s24, v1
    v_and_b32 v49, 7, v48
    v_mul_u32_u24 v49, 1280, v49
    v_lshrrev_b32 v50, 3, v48
    v_lshl_add_u32 v49, v50, 4, v49
    v_cmp_gt_u32 vcc, 640, v48
    v_mov_b32 v51, 2146435072
    s_nop 0
    v_cndmask_b32 v49, v51, v49, vcc
    buffer_load_dwordx4 v[52:55], v49, s[20:23], 0 offen
    v_lshlrev_b32 v48, 4, v48
    s_waitcnt vmcnt(0)
    s_and_saveexec_b64 s[30:31], vcc
    ds_write_b128 v48, v[52:55]
    s_mov_b64 exec, s[30:31]
    s_lshl_b32 s24, s3, 6
    s_add_u32 s24, s24, 512
    v_add_u32 v48, s24, v1
    v_and_b32 v49, 7, v48
    v_mul_u32_u24 v49, 1280, v49
    v_lshrrev_b32 v50, 3, v48
    v_lshl_add_u32 v49, v50, 4, v49
    v_cmp_gt_u32 vcc, 640, v48
    v_mov_b32 v51, 2146435072
    s_nop 0
    v_cndmask_b32 v49, v51, v49, vcc
    buffer_load_dwordx4 v[52:55], v49, s[20:23], 0 offen
    v_lshlrev_b32 v48, 4, v48
    s_waitcnt vmcnt(0)
    s_and_saveexec_b64 s[30:31], vcc
    ds_write_b128 v48, v[52:55]
    s_mov_b64 exec, s[30:31]
    s_mov_b32 s40, 0
    s_mov_b32 s41, 92274688
    s_mov_b32 s37, s93
    s_add_u32 s43, s93, 655360
    s_mov_b32 s45, 67108864
    s_add_u32 s49, s93, 753664
    s_lshl_b32 s95, s92, 6
    s_add_u32 s95, s95, s40
    s_add_u32 s95, s95, 1
    s_cmp_ge_i32 s59, s95
    s_cbranch_scc1 interleave_layers__linear_attn_block__memory_aug_recurrent_mem_tr__prompt_kernel_s_ec0_ok
    s_and_b32 s24, s2, 7
    s_lshl_b32 s24, s24, 7
    s_add_u32 s24, s24, 23109632
    v_and_b32 v49, 3, v1
    v_lshl_add_u32 v49, v49, 2, s24
    s_mov_b32 s61, 0
interleave_layers__linear_attn_block__memory_aug_recurrent_mem_tr__prompt_kernel_s_ec0:
    buffer_load_dword v48, v49, s[8:11], 0 offen sc1
    s_waitcnt vmcnt(0)
    v_readlane_b32 s59, v48, 0
    v_readlane_b32 s24, v48, 1
    s_min_i32 s59, s59, s24
    v_readlane_b32 s24, v48, 2
    s_min_i32 s59, s59, s24
    s_cmp_ge_i32 s59, s95
    s_cbranch_scc1 interleave_layers__linear_attn_block__memory_aug_recurrent_mem_tr__prompt_kernel_s_ec0_ok
    s_add_u32 s61, s61, 1
    s_cmp_ge_u32 s61, s60
    s_cbranch_scc1 interleave_layers__linear_attn_block__memory_aug_recurrent_mem_tr__prompt_kernel_s_ec0_to
    s_sleep 2
    s_branch interleave_layers__linear_attn_block__memory_aug_recurrent_mem_tr__prompt_kernel_s_ec0
interleave_layers__linear_attn_block__memory_aug_recurrent_mem_tr__prompt_kernel_s_ec0_to:
    s_mov_b32 s60, 1
interleave_layers__linear_attn_block__memory_aug_recurrent_mem_tr__prompt_kernel_s_ec0_ok:
    s_mov_b32 s62, -1
    s_mov_b32 s63, 1
    s_cmp_ge_i32 s62, s63
    s_cbranch_scc1 interleave_layers__linear_attn_block__memory_aug_recurrent_mem_tr__prompt_kernel_s_en0_ok
    s_mov_b32 s61, 0
interleave_layers__linear_attn_block__memory_aug_recurrent_mem_tr__prompt_kernel_s_en0:
    buffer_load_dword v48, v9, s[8:11], 0 offen sc1
    s_waitcnt vmcnt(0)
    v_readlane_b32 s62, v48, 0
    v_readlane_b32 s24, v48, 1
    s_min_i32 s62, s62, s24
    s_cmp_ge_i32 s62, s63
    s_cbranch_scc1 interleave_layers__linear_attn_block__memory_aug_recurrent_mem_tr__prompt_kernel_s_en0_ok
    s_add_u32 s61, s61, 1
    s_cmp_ge_u32 s61, s60
    s_cbranch_scc1 interleave_layers__linear_attn_block__memory_aug_recurrent_mem_tr__prompt_kernel_s_en0_to
    s_sleep 2
    s_branch interleave_layers__linear_attn_block__memory_aug_recurrent_mem_tr__prompt_kernel_s_en0
interleave_layers__linear_attn_block__memory_aug_recurrent_mem_tr__prompt_kernel_s_en0_to:
    s_mov_b32 s60, 1
interleave_layers__linear_attn_block__memory_aug_recurrent_mem_tr__prompt_kernel_s_en0_ok:
    buffer_load_dwordx4 a[240:243], v19, s[8:11], s41 offen offset:0 sc1
    buffer_load_dwordx4 a[244:247], v19, s[8:11], s41 offen offset:1024 sc1
    buffer_load_dwordx4 a[248:251], v19, s[8:11], s41 offen offset:2048 sc1
    s_waitcnt lgkmcnt(0)
    v_mov_b32 v24, 0
    v_mov_b32 v25, 0
    v_mov_b32 v26, 0
    v_mov_b32 v27, 0
    v_mov_b32 v28, 0
    v_mov_b32 v29, 0
    v_mov_b32 v30, 0
    v_mov_b32 v31, 0
    v_mov_b32 v32, 0
    v_mov_b32 v33, 0
    v_mov_b32 v34, 0
    v_mov_b32 v35, 0
    v_mov_b32 v36, 0
    v_mov_b32 v37, 0
    v_mov_b32 v38, 0
    v_mov_b32 v39, 0
    v_mov_b32 v40, 0
    v_mov_b32 v41, 0
    v_mov_b32 v42, 0
    v_mov_b32 v43, 0
    v_mov_b32 v44, 0
    v_mov_b32 v45, 0
    v_mov_b32 v46, 0
    v_mov_b32 v47, 0
    s_barrier
    ds_read_b128 v[84:87], v7
    ds_read_b128 v[88:91], v7 offset:4096
    s_waitcnt vmcnt(0) lgkmcnt(0)
    s_cmp_eq_u32 s3, 0
    s_cbranch_scc1 interleave_layers__linear_attn_block__memory_aug_recurrent_mem_tr__prompt_kernel_s_gow0
    s_cmp_eq_u32 s3, 1
    s_cbranch_scc1 interleave_layers__linear_attn_block__memory_aug_recurrent_mem_tr__prompt_kernel_s_gow1
    s_cmp_eq_u32 s3, 2
    s_cbranch_scc1 interleave_layers__linear_attn_block__memory_aug_recurrent_mem_tr__prompt_kernel_s_gow2
    s_branch interleave_layers__linear_attn_block__memory_aug_recurrent_mem_tr__prompt_kernel_s_gow3
interleave_layers__linear_attn_block__memory_aug_recurrent_mem_tr__prompt_kernel_s_stepw0:
    v_mov_b32 v24, 0
    v_mov_b32 v25, 0
    v_mov_b32 v26, 0
    v_mov_b32 v27, 0
    v_mov_b32 v28, 0
    v_mov_b32 v29, 0
    v_mov_b32 v30, 0
    v_mov_b32 v31, 0
    v_mov_b32 v32, 0
    v_mov_b32 v33, 0
    v_mov_b32 v34, 0
    v_mov_b32 v35, 0
    v_mov_b32 v36, 0
    v_mov_b32 v37, 0
    v_mov_b32 v38, 0
    v_mov_b32 v39, 0
    v_mov_b32 v40, 0
    v_mov_b32 v41, 0
    v_mov_b32 v42, 0
    v_mov_b32 v43, 0
    v_mov_b32 v44, 0
    v_mov_b32 v45, 0
    v_mov_b32 v46, 0
    v_mov_b32 v47, 0
    s_add_u32 s46, s47, 4096
    s_add_u32 s52, s47, 8192
    s_lshl_b32 s95, s92, 6
    s_add_u32 s95, s95, s40
    s_add_u32 s95, s95, 1
    s_cmp_ge_i32 s59, s95
    s_cbranch_scc1 interleave_layers__linear_attn_block__memory_aug_recurrent_mem_tr__prompt_kernel_s_ecw0_ok
    s_and_b32 s24, s2, 7
    s_lshl_b32 s24, s24, 7
    s_add_u32 s24, s24, 23109632
    v_and_b32 v49, 3, v1
    v_lshl_add_u32 v49, v49, 2, s24
    s_mov_b32 s61, 0
interleave_layers__linear_attn_block__memory_aug_recurrent_mem_tr__prompt_kernel_s_ecw0:
    buffer_load_dword v48, v49, s[8:11], 0 offen sc1
    s_waitcnt vmcnt(0)
    v_readlane_b32 s59, v48, 0
    v_readlane_b32 s24, v48, 1
    s_min_i32 s59, s59, s24
    v_readlane_b32 s24, v48, 2
    s_min_i32 s59, s59, s24
    s_cmp_ge_i32 s59, s95
    s_cbranch_scc1 interleave_layers__linear_attn_block__memory_aug_recurrent_mem_tr__prompt_kernel_s_ecw0_ok
    s_add_u32 s61, s61, 1
    s_cmp_ge_u32 s61, s60
    s_cbranch_scc1 interleave_layers__linear_attn_block__memory_aug_recurrent_mem_tr__prompt_kernel_s_ecw0_to
    s_sleep 2
    s_branch interleave_layers__linear_attn_block__memory_aug_recurrent_mem_tr__prompt_kernel_s_ecw0
interleave_layers__linear_attn_block__memory_aug_recurrent_mem_tr__prompt_kernel_s_ecw0_to:
    s_mov_b32 s60, 1
interleave_layers__linear_attn_block__memory_aug_recurrent_mem_tr__prompt_kernel_s_ecw0_ok:
    s_add_u32 s63, s40, 1
    s_cmp_ge_i32 s62, s63
    s_cbranch_scc1 interleave_layers__linear_attn_block__memory_aug_recurrent_mem_tr__prompt_kernel_s_enw0_ok
    s_mov_b32 s61, 0
interleave_layers__linear_attn_block__memory_aug_recurrent_mem_tr__prompt_kernel_s_enw0:
    buffer_load_dword v48, v9, s[8:11], 0 offen sc1
    s_waitcnt vmcnt(0)
    v_readlane_b32 s62, v48, 0
    v_readlane_b32 s24, v48, 1
    s_min_i32 s62, s62, s24
    s_cmp_ge_i32 s62, s63
    s_cbranch_scc1 interleave_layers__linear_attn_block__memory_aug_recurrent_mem_tr__prompt_kernel_s_enw0_ok
    s_add_u32 s61, s61, 1
    s_cmp_ge_u32 s61, s60
    s_cbranch_scc1 interleave_layers__linear_attn_block__memory_aug_recurrent_mem_tr__prompt_kernel_s_enw0_to
    s_sleep 2
    s_branch interleave_layers__linear_attn_block__memory_aug_recurrent_mem_tr__prompt_kernel_s_enw0
interleave_layers__linear_attn_block__memory_aug_recurrent_mem_tr__prompt_kernel_s_enw0_to:
    s_mov_b32 s60, 1
interleave_layers__linear_attn_block__memory_aug_recurrent_mem_tr__prompt_kernel_s_enw0_ok:
    buffer_load_dwordx4 a[240:243], v19, s[8:11], s41 offen offset:0 sc1
    buffer_load_dwordx4 a[244:247], v19, s[8:11], s41 offen offset:1024 sc1
    buffer_load_dwordx4 a[248:251], v19, s[8:11], s41 offen offset:2048 sc1
    s_sleep 5
    s_mov_b64 exec, 1
    s_mov_b32 s61, 0
    v_mov_b32 v83, 0
    buffer_atomic_add v83, v23, s[8:11], s48 offen sc0
    s_sleep 2
    v_mov_b32 v94, 0
    buffer_atomic_add v94, v23, s[8:11], s48 offen sc0
    s_sleep 2
    v_mov_b32 v95, 0
    buffer_atomic_add v95, v23, s[8:11], s48 offen sc0
    s_sleep 2
interleave_layers__linear_attn_block__memory_aug_recurrent_mem_tr__prompt_kernel_s_prw0:
    v_mov_b32 v82, 0
    buffer_atomic_add v82, v23, s[8:11], s48 offen sc0
    s_waitcnt vmcnt(3)
    v_cmp_le_i32 vcc, 9, v83
    s_add_u32 s61, s61, 1
    s_cbranch_vccnz interleave_layers__linear_attn_block__memory_aug_recurrent_mem_tr__prompt_kernel_s_prw0_out
    s_sleep 2
    v_mov_b32 v83, 0
    buffer_atomic_add v83, v23, s[8:11], s48 offen sc0
    s_waitcnt vmcnt(3)
    v_cmp_le_i32 vcc, 9, v94
    s_add_u32 s61, s61, 1
    s_cbranch_vccnz interleave_layers__linear_attn_block__memory_aug_recurrent_mem_tr__prompt_kernel_s_prw0_out
    s_sleep 2
    v_mov_b32 v94, 0
    buffer_atomic_add v94, v23, s[8:11], s48 offen sc0
    s_waitcnt vmcnt(3)
    v_cmp_le_i32 vcc, 9, v95
    s_add_u32 s61, s61, 1
    s_cbranch_vccnz interleave_layers__linear_attn_block__memory_aug_recurrent_mem_tr__prompt_kernel_s_prw0_out
    s_sleep 2
    v_mov_b32 v95, 0
    buffer_atomic_add v95, v23, s[8:11], s48 offen sc0
    s_waitcnt vmcnt(3)
    v_cmp_le_i32 vcc, 9, v82
    s_add_u32 s61, s61, 1
    s_cbranch_vccnz interleave_layers__linear_attn_block__memory_aug_recurrent_mem_tr__prompt_kernel_s_prw0_out
    s_sleep 2
    s_cmp_ge_u32 s61, s60
    s_cbranch_scc0 interleave_layers__linear_attn_block__memory_aug_recurrent_mem_tr__prompt_kernel_s_prw0
    s_mov_b32 s60, 1
interleave_layers__linear_attn_block__memory_aug_recurrent_mem_tr__prompt_kernel_s_prw0_out:
    s_mov_b64 exec, -1
    buffer_load_dwordx4 v[84:87], v7, s[8:11], s47 offen sc1
    buffer_load_dwordx4 v[88:91], v7, s[8:11], s46 offen sc1
    buffer_load_dwordx2 v[92:93], v8, s[8:11], s52 offen sc1
    ds_read_b128 v[48:51], v21 offset:0
    ds_read_b128 v[52:55], v21 offset:16
    ds_read_b128 v[56:59], v21 offset:5632
    ds_read_b128 v[60:63], v21 offset:5648
    ds_read_b128 v[64:67], v21 offset:11264
    ds_read_b128 v[68:71], v21 offset:11280
    ds_read_b128 v[72:75], v21 offset:16896
    ds_read_b128 v[76:79], v21 offset:16912
    s_waitcnt lgkmcnt(4)
    v_pk_add_f32 v[48:49], v[48:49], v[56:57]
    v_pk_add_f32 v[50:51], v[50:51], v[58:59]
    v_pk_add_f32 v[52:53], v[52:53], v[60:61]
    v_pk_add_f32 v[54:55], v[54:55], v[62:63]
    s_waitcnt lgkmcnt(0)
    v_pk_add_f32 v[64:65], v[64:65], v[72:73]
    v_pk_add_f32 v[66:67], v[66:67], v[74:75]
    v_pk_add_f32 v[68:69], v[68:69], v[76:77]
    v_pk_add_f32 v[70:71], v[70:71], v[78:79]
    v_pk_add_f32 v[48:49], v[48:49], v[64:65]
    v_pk_add_f32 v[50:51], v[50:51], v[66:67]
    v_pk_add_f32 v[52:53], v[52:53], v[68:69]
    v_pk_add_f32 v[54:55], v[54:55], v[70:71]
    v_mov_b32 v81, 0xff800000
    v_cndmask_b32 v48, v81, v48, s[64:65]
    v_cndmask_b32 v49, v81, v49, s[66:67]
    v_cndmask_b32 v50, v81, v50, s[68:69]
    v_cndmask_b32 v51, v81, v51, s[70:71]
    v_cndmask_b32 v52, v81, v52, s[72:73]
    v_cndmask_b32 v53, v81, v53, s[74:75]
    v_cndmask_b32 v54, v81, v54, s[76:77]
    v_cndmask_b32 v55, v81, v55, s[78:79]
    v_max3_f32 v80, v48, v49, v50
    v_max3_f32 v80, v80, v51, v52
    v_max3_f32 v80, v80, v53, v54
    v_max_f32 v80, v80, v55
    v_mov_b32 v81, 0xff800000
    v_cndmask_b32 v80, v81, v80, s[50:51]
    s_nop 1
    v_max_f32 v80, v80, v80 quad_perm:[1,0,3,2] row_mask:0xf bank_mask:0xf
    s_nop 1
    v_max_f32 v80, v80, v80 quad_perm:[2,3,0,1] row_mask:0xf bank_mask:0xf
    s_nop 1
    v_max_f32 v80, v80, v80 row_half_mirror row_mask:0xf bank_mask:0xf
    s_mov_b32 s24, 0x3dd53b95
    v_mul_f32 v80, s24, v80
    v_fma_f32 v48, v48, s24, -v80
    v_fma_f32 v49, v49, s24, -v80
    v_fma_f32 v50, v50, s24, -v80
    v_fma_f32 v51, v51, s24, -v80
    v_fma_f32 v52, v52, s24, -v80
    v_fma_f32 v53, v53, s24, -v80
    v_fma_f32 v54, v54, s24, -v80
    v_fma_f32 v55, v55, s24, -v80
    v_exp_f32 v48, v48
    v_exp_f32 v49, v49
    v_exp_f32 v50, v50
    v_exp_f32 v51, v51
    v_exp_f32 v52, v52
    v_exp_f32 v53, v53
    v_exp_f32 v54, v54
    v_exp_f32 v55, v55
    v_add_f32 v80, v48, v49
    v_add_f32 v81, v50, v51
    v_add_f32 v80, v80, v52
    v_add_f32 v81, v81, v53
    v_add_f32 v80, v80, v54
    v_add_f32 v81, v81, v55
    v_add_f32 v80, v80, v81
    v_cndmask_b32 v80, 0, v80, s[50:51]
    s_nop 1
    v_add_f32 v80, v80, v80 quad_perm:[1,0,3,2] row_mask:0xf bank_mask:0xf
    s_nop 1
    v_add_f32 v80, v80, v80 quad_perm:[2,3,0,1] row_mask:0xf bank_mask:0xf
    s_nop 1
    v_add_f32 v80, v80, v80 row_half_mirror row_mask:0xf bank_mask:0xf
    v_rcp_f32 v80, v80
    s_nop 0
    v_mul_f32 v48, v48, v80
    v_mul_f32 v49, v49, v80
    v_mul_f32 v50, v50, v80
    v_mul_f32 v51, v51, v80
    v_mul_f32 v52, v52, v80
    v_mul_f32 v53, v53, v80
    v_mul_f32 v54, v54, v80
    v_mul_f32 v55, v55, v80
    v_cvt_pk_bf16_f32 v56, v48, v49
    v_cvt_pk_bf16_f32 v57, v50, v51
    v_cvt_pk_bf16_f32 v58, v52, v53
    v_cvt_pk_bf16_f32 v59, v54, v55
    v_min_u32 v56, -2, v56
    v_min_u32 v57, -2, v57
    v_min_u32 v58, -2, v58
    v_min_u32 v59, -2, v59
    buffer_store_dwordx4 v[56:59], v22, s[8:11], s42 offen sc1
    s_waitcnt vmcnt(1)
    s_nop 0
    v_max3_u32 v58, v84, v85, v86
    v_max3_u32 v58, v58, v87, v88
    v_max3_u32 v58, v58, v89, v90
    v_max3_u32 v58, v58, v91, v92
    v_max_u32 v58, v58, v93
    v_cmp_eq_u32 vcc, -1, v58
    s_cbranch_vccz interleave_layers__linear_attn_block__memory_aug_recurrent_mem_tr__prompt_kernel_s_pmw0_out
    s_mov_b32 s61, 0
interleave_layers__linear_attn_block__memory_aug_recurrent_mem_tr__prompt_kernel_s_pmw0:
    buffer_load_dwordx4 v[84:87], v7, s[8:11], s47 offen sc1
    buffer_load_dwordx4 v[88:91], v7, s[8:11], s46 offen sc1
    buffer_load_dwordx2 v[92:93], v8, s[8:11], s52 offen sc1
    s_waitcnt vmcnt(0)
    v_max3_u32 v58, v84, v85, v86
    v_max3_u32 v58, v58, v87, v88
    v_max3_u32 v58, v58, v89, v90
    v_max3_u32 v58, v58, v91, v92
    v_max_u32 v58, v58, v93
    v_cmp_eq_u32 vcc, -1, v58
    s_add_u32 s61, s61, 1
    s_cbranch_vccz interleave_layers__linear_attn_block__memory_aug_recurrent_mem_tr__prompt_kernel_s_pmw0_out
    s_cmp_ge_u32 s61, s60
    s_cbranch_scc1 interleave_layers__linear_attn_block__memory_aug_recurrent_mem_tr__prompt_kernel_s_pmw0_to
    s_sleep 1
    s_branch interleave_layers__linear_attn_block__memory_aug_recurrent_mem_tr__prompt_kernel_s_pmw0
interleave_layers__linear_attn_block__memory_aug_recurrent_mem_tr__prompt_kernel_s_pmw0_to:
    s_mov_b32 s60, 1
interleave_layers__linear_attn_block__memory_aug_recurrent_mem_tr__prompt_kernel_s_pmw0_out:
    ds_write_b128 v7, v[84:87]
    ds_write_b128 v7, v[88:91] offset:4096
    ds_write_b64 v8, v[92:93]
interleave_layers__linear_attn_block__memory_aug_recurrent_mem_tr__prompt_kernel_s_gow0:
    ds_read_b128 v[68:71], v6 offset:0
    ds_read_b128 v[72:75], v6 offset:1024
    ds_read_b128 v[76:79], v6 offset:8192
    ds_read_b128 v[80:83], v6 offset:9216
    v_smfmac_f32_16x16x64_bf16 v[24:27], v[84:87], a[0:7], v4
    v_smfmac_f32_16x16x64_bf16 v[28:31], v[84:87], a[80:87], v4
    v_smfmac_f32_16x16x64_bf16 v[32:35], v[84:87], a[160:167], v4
    v_smfmac_f32_16x16x64_bf16 v[40:43], v[84:87], v[96:103], v4
    v_smfmac_f32_16x16x64_bf16 v[44:47], v[84:87], v[176:183], v4
    s_waitcnt lgkmcnt(2)
    v_smfmac_f32_16x16x64_bf16 v[36:39], v[84:87], v[68:75], v4
    ds_read_b128 v[68:71], v6 offset:2048
    ds_read_b128 v[72:75], v6 offset:3072
    s_barrier
    ds_read_b128 v[48:51], v5 offset:1024
    ds_read_b128 v[52:55], v5 offset:2048
    ds_read_b128 v[56:59], v5 offset:3072
    ds_read_b128 v[60:63], v5 offset:5120
    ds_read_b128 v[64:67], v5 offset:6144
    v_smfmac_f32_16x16x64_bf16 v[24:27], v[88:91], a[32:39], v4
    v_smfmac_f32_16x16x64_bf16 v[28:31], v[88:91], a[112:119], v4
    v_smfmac_f32_16x16x64_bf16 v[32:35], v[88:91], a[192:199], v4
    v_smfmac_f32_16x16x64_bf16 v[40:43], v[88:91], v[128:135], v4
    v_smfmac_f32_16x16x64_bf16 v[44:47], v[88:91], v[208:215], v4
    s_waitcnt lgkmcnt(7)
    v_smfmac_f32_16x16x64_bf16 v[36:39], v[88:91], v[76:83], v4
    ds_read_b128 v[76:79], v6 offset:4096
    ds_read_b128 v[80:83], v6 offset:5120
    s_waitcnt lgkmcnt(6)
    v_smfmac_f32_16x16x64_bf16 v[24:27], v[48:51], a[8:15], v4
    v_smfmac_f32_16x16x64_bf16 v[28:31], v[48:51], a[88:95], v4
    v_smfmac_f32_16x16x64_bf16 v[40:43], v[48:51], v[104:111], v4
    v_smfmac_f32_16x16x64_bf16 v[36:39], v[48:51], v[68:75], v4
    ds_read_b128 v[68:71], v6 offset:6144
    ds_read_b128 v[72:75], v6 offset:7168
    ds_read_b128 v[48:51], v5 offset:7168
    s_waitcnt lgkmcnt(8)
    v_smfmac_f32_16x16x64_bf16 v[24:27], v[52:55], a[16:23], v4
    v_smfmac_f32_16x16x64_bf16 v[28:31], v[52:55], a[96:103], v4
    v_smfmac_f32_16x16x64_bf16 v[40:43], v[52:55], v[112:119], v4
    s_waitcnt lgkmcnt(3)
    v_smfmac_f32_16x16x64_bf16 v[36:39], v[52:55], v[76:83], v4
    ds_read_b128 v[76:79], v6 offset:10240
    ds_read_b128 v[80:83], v6 offset:11264
    ds_read_b128 v[52:55], v5 offset:8192
    v_smfmac_f32_16x16x64_bf16 v[24:27], v[56:59], a[24:31], v4
    v_smfmac_f32_16x16x64_bf16 v[28:31], v[56:59], a[104:111], v4
    v_smfmac_f32_16x16x64_bf16 v[40:43], v[56:59], v[120:127], v4
    s_waitcnt lgkmcnt(4)
    v_smfmac_f32_16x16x64_bf16 v[36:39], v[56:59], v[68:75], v4
    ds_read_b128 v[68:71], v6 offset:12288
    ds_read_b128 v[72:75], v6 offset:13312
    ds_read_b128 v[56:59], v5 offset:9216
    v_smfmac_f32_16x16x64_bf16 v[24:27], v[60:63], a[40:47], v4
    v_smfmac_f32_16x16x64_bf16 v[28:31], v[60:63], a[120:127], v4
    v_smfmac_f32_16x16x64_bf16 v[40:43], v[60:63], v[136:143], v4
    s_waitcnt lgkmcnt(4)
    v_smfmac_f32_16x16x64_bf16 v[36:39], v[60:63], v[76:83], v4
    ds_read_b128 v[76:79], v6 offset:14336
    ds_read_b128 v[80:83], v6 offset:15360
    ds_read_b128 v[60:63], v5 offset:1024
    v_smfmac_f32_16x16x64_bf16 v[24:27], v[64:67], a[48:55], v4
    v_smfmac_f32_16x16x64_bf16 v[28:31], v[64:67], a[128:135], v4
    v_smfmac_f32_16x16x64_bf16 v[40:43], v[64:67], v[144:151], v4
    s_waitcnt lgkmcnt(4)
    v_smfmac_f32_16x16x64_bf16 v[36:39], v[64:67], v[68:75], v4
    ds_read_b128 v[68:71], v6 offset:16384
    ds_read_b128 v[72:75], v6 offset:17408
    ds_read_b128 v[64:67], v5 offset:2048
    v_smfmac_f32_16x16x64_bf16 v[24:27], v[48:51], a[56:63], v4
    v_smfmac_f32_16x16x64_bf16 v[28:31], v[48:51], a[136:143], v4
    v_smfmac_f32_16x16x64_bf16 v[40:43], v[48:51], v[152:159], v4
    s_waitcnt lgkmcnt(4)
    v_smfmac_f32_16x16x64_bf16 v[36:39], v[48:51], v[76:83], v4
    ds_read_b128 v[76:79], v6 offset:18432
    ds_read_b128 v[80:83], v6 offset:19456
    ds_read_b128 v[48:51], v5 offset:3072
    v_smfmac_f32_16x16x64_bf16 v[24:27], v[52:55], a[64:71], v4
    v_smfmac_f32_16x16x64_bf16 v[28:31], v[52:55], a[144:151], v4
    v_smfmac_f32_16x16x64_bf16 v[40:43], v[52:55], v[160:167], v4
    s_waitcnt lgkmcnt(4)
    v_smfmac_f32_16x16x64_bf16 v[36:39], v[52:55], v[68:75], v4
    ds_read_b128 v[52:55], v5 offset:5120
    v_smfmac_f32_16x16x64_bf16 v[24:27], v[56:59], a[72:79], v4
    v_smfmac_f32_16x16x64_bf16 v[28:31], v[56:59], a[152:159], v4
    v_smfmac_f32_16x16x64_bf16 v[40:43], v[56:59], v[168:175], v4
    s_waitcnt lgkmcnt(2)
    v_smfmac_f32_16x16x64_bf16 v[36:39], v[56:59], v[76:83], v4
    ds_read_b128 v[56:59], v5 offset:6144
    buffer_load_dwordx4 v[80:83], v19, s[8:11], s45 offen offset:0 sc1
    buffer_load_dwordx4 v[84:87], v19, s[8:11], s45 offen offset:1024 sc1
    buffer_load_dwordx4 v[88:91], v19, s[8:11], s45 offen offset:2048 sc1
    v_smfmac_f32_16x16x64_bf16 v[32:35], v[60:63], a[168:175], v4
    v_smfmac_f32_16x16x64_bf16 v[44:47], v[60:63], v[184:191], v4
    v_permlane32_swap_b32 v28, v40
    v_permlane32_swap_b32 v29, v41
    ds_read_b128 v[60:63], v5 offset:7168
    v_smfmac_f32_16x16x64_bf16 v[32:35], v[64:67], a[176:183], v4
    v_permlane32_swap_b32 v30, v42
    v_permlane32_swap_b32 v31, v43
    v_smfmac_f32_16x16x64_bf16 v[44:47], v[64:67], v[192:199], v4
    v_add_f32 v28, v28, v40
    v_add_f32 v29, v29, v41
    ds_read_b128 v[64:67], v5 offset:8192
    s_waitcnt lgkmcnt(4)
    v_smfmac_f32_16x16x64_bf16 v[32:35], v[48:51], a[184:191], v4
    v_add_f32 v30, v30, v42
    v_add_f32 v31, v31, v43
    v_smfmac_f32_16x16x64_bf16 v[44:47], v[48:51], v[200:207], v4
    v_cvt_pk_bf16_f32 v40, v28, v29
    v_cvt_pk_bf16_f32 v41, v30, v31
    ds_read_b128 v[48:51], v5 offset:9216
    s_waitcnt lgkmcnt(4)
    v_smfmac_f32_16x16x64_bf16 v[32:35], v[52:55], a[200:207], v4
    v_mfma_f32_16x16x16_bf16 v[28:31], v[40:41], v[10:11], 0
    v_permlane32_swap_b32 v24, v36
    v_smfmac_f32_16x16x64_bf16 v[44:47], v[52:55], v[216:223], v4
    v_permlane32_swap_b32 v25, v37
    v_permlane32_swap_b32 v26, v38
    s_waitcnt lgkmcnt(3)
    v_smfmac_f32_16x16x64_bf16 v[32:35], v[56:59], a[208:215], v4
    v_permlane32_swap_b32 v27, v39
    v_add_f32 v24, v24, v36
    v_smfmac_f32_16x16x64_bf16 v[44:47], v[56:59], v[224:231], v4
    v_add_f32 v25, v25, v37
    v_add_f32 v26, v26, v38
    s_waitcnt lgkmcnt(2)
    v_smfmac_f32_16x16x64_bf16 v[32:35], v[60:63], a[216:223], v4
    v_add_f32 v27, v27, v39
    v_cvt_pk_bf16_f32 v36, v24, v25
    v_smfmac_f32_16x16x64_bf16 v[44:47], v[60:63], v[232:239], v4
    v_cvt_pk_bf16_f32 v37, v26, v27
    s_nop 1
    v_mfma_f32_16x16x16_bf16 v[24:27], v[36:37], v[10:11], 0
    s_waitcnt lgkmcnt(1)
    v_smfmac_f32_16x16x64_bf16 v[32:35], v[64:67], a[224:231], v4
    s_nop 5
    v_cvt_pk_bf16_f32 v24, v24, v25
    v_smfmac_f32_16x16x64_bf16 v[44:47], v[64:67], v[240:247], v4
    v_cvt_pk_bf16_f32 v25, v26, v27
    v_cvt_pk_bf16_f32 v26, v28, v29
    s_waitcnt lgkmcnt(0)
    v_smfmac_f32_16x16x64_bf16 v[32:35], v[48:51], a[232:239], v4
    v_cvt_pk_bf16_f32 v27, v30, v31
    s_waitcnt vmcnt(3)
    v_smfmac_f32_16x16x64_bf16 v[44:47], v[48:51], v[248:255], v4
    v_mfma_f32_16x16x32_bf16 v[28:31], a[240:243], v[24:27], 0
    v_mfma_f32_16x16x32_bf16 v[36:39], a[244:247], v[24:27], 0
    v_mfma_f32_16x16x32_bf16 v[40:43], v[24:27], v[24:27], 0
    s_nop 4
    v_permlane32_swap_b32 v32, v44
    v_permlane32_swap_b32 v33, v45
    v_permlane32_swap_b32 v34, v46
    v_permlane32_swap_b32 v35, v47
    v_add_f32 v32, v32, v44
    v_add_f32 v33, v33, v45
    v_add_f32 v34, v34, v46
    v_add_f32 v35, v35, v47
    v_cvt_pk_bf16_f32 v44, v32, v33
    v_cvt_pk_bf16_f32 v45, v34, v35
    s_nop 1
    v_mfma_f32_16x16x16_bf16 v[32:35], v[44:45], v[10:11], 0
    s_nop 7
    v_cvt_pk_bf16_f32 v32, v32, v33
    v_cvt_pk_bf16_f32 v33, v34, v35
    s_nop 1
    v_mfma_f32_16x16x16_bf16 v[28:31], a[248:249], v[32:33], v[28:31]
    v_mfma_f32_16x16x16_bf16 v[36:39], a[250:251], v[32:33], v[36:39]
    v_mfma_f32_16x16x16_bf16 v[40:43], v[32:33], v[32:33], v[40:43]
    s_nop 5
    ds_write_b128 v12, v[28:31]
    ds_write_b128 v12, v[36:39] offset:16
    ds_write_b128 v13, v[40:43]
    buffer_atomic_add v0, v20, s[8:11], s49 offen
    s_waitcnt lgkmcnt(0)
    s_barrier
    ds_read_b128 v[48:51], v14 offset:0
    ds_read_b128 v[52:55], v14 offset:16
    ds_read_b128 v[56:59], v14 offset:1408
    ds_read_b128 v[60:63], v14 offset:1424
    ds_read_b128 v[64:67], v14 offset:2816
    ds_read_b128 v[68:71], v14 offset:2832
    ds_read_b128 v[72:75], v14 offset:4224
    ds_read_b128 v[76:79], v14 offset:4240
    s_waitcnt lgkmcnt(4)
    v_pk_add_f32 v[48:49], v[48:49], v[56:57]
    v_pk_add_f32 v[50:51], v[50:51], v[58:59]
    v_pk_add_f32 v[52:53], v[52:53], v[60:61]
    v_pk_add_f32 v[54:55], v[54:55], v[62:63]
    s_waitcnt lgkmcnt(0)
    v_pk_add_f32 v[64:65], v[64:65], v[72:73]
    v_pk_add_f32 v[66:67], v[66:67], v[74:75]
    v_pk_add_f32 v[68:69], v[68:69], v[76:77]
    v_pk_add_f32 v[70:71], v[70:71], v[78:79]
    v_pk_add_f32 v[48:49], v[48:49], v[64:65]
    v_pk_add_f32 v[50:51], v[50:51], v[66:67]
    v_pk_add_f32 v[52:53], v[52:53], v[68:69]
    v_pk_add_f32 v[54:55], v[54:55], v[70:71]
    v_max3_f32 v92, v48, v49, v50
    v_max3_f32 v92, v92, v51, v52
    v_max3_f32 v92, v92, v53, v54
    v_max_f32 v92, v92, v55
    v_mov_b32 v93, 0xff800000
    v_cndmask_b32 v92, v93, v92, s[50:51]
    s_nop 1
    v_max_f32 v92, v92, v92 quad_perm:[1,0,3,2] row_mask:0xf bank_mask:0xf
    s_nop 1
    v_max_f32 v92, v92, v92 quad_perm:[2,3,0,1] row_mask:0xf bank_mask:0xf
    s_nop 1
    v_max_f32 v92, v92, v92 row_half_mirror row_mask:0xf bank_mask:0xf
    s_mov_b32 s24, 0x3dd53b95
    v_mul_f32 v92, s24, v92
    v_fma_f32 v48, v48, s24, -v92
    v_fma_f32 v49, v49, s24, -v92
    v_fma_f32 v50, v50, s24, -v92
    v_fma_f32 v51, v51, s24, -v92
    v_fma_f32 v52, v52, s24, -v92
    v_fma_f32 v53, v53, s24, -v92
    v_fma_f32 v54, v54, s24, -v92
    v_fma_f32 v55, v55, s24, -v92
    v_exp_f32 v48, v48
    v_exp_f32 v49, v49
    v_exp_f32 v50, v50
    v_exp_f32 v51, v51
    v_exp_f32 v52, v52
    v_exp_f32 v53, v53
    v_exp_f32 v54, v54
    v_exp_f32 v55, v55
    v_add_f32 v92, v48, v49
    v_add_f32 v93, v50, v51
    v_add_f32 v92, v92, v52
    v_add_f32 v93, v93, v53
    v_add_f32 v92, v92, v54
    v_add_f32 v93, v93, v55
    v_add_f32 v92, v92, v93
    v_cndmask_b32 v92, 0, v92, s[50:51]
    s_nop 1
    v_add_f32 v92, v92, v92 quad_perm:[1,0,3,2] row_mask:0xf bank_mask:0xf
    s_nop 1
    v_add_f32 v92, v92, v92 quad_perm:[2,3,0,1] row_mask:0xf bank_mask:0xf
    s_nop 1
    v_add_f32 v92, v92, v92 row_half_mirror row_mask:0xf bank_mask:0xf
    v_rcp_f32 v92, v92
    s_nop 0
    v_mul_f32 v48, v48, v92
    v_mul_f32 v49, v49, v92
    v_mul_f32 v50, v50, v92
    v_mul_f32 v51, v51, v92
    v_mul_f32 v52, v52, v92
    v_mul_f32 v53, v53, v92
    v_mul_f32 v54, v54, v92
    v_mul_f32 v55, v55, v92
    v_cvt_pk_bf16_f32 v56, v48, v49
    v_cvt_pk_bf16_f32 v57, v50, v51
    v_cvt_pk_bf16_f32 v58, v52, v53
    v_cvt_pk_bf16_f32 v59, v54, v55
    v_min_u32 v56, -2, v56
    v_min_u32 v57, -2, v57
    v_min_u32 v58, -2, v58
    v_min_u32 v59, -2, v59
    buffer_store_dwordx4 v[56:59], v15, s[8:11], s43 offen sc1
    s_waitcnt vmcnt(2)
    v_mfma_f32_16x16x32_bf16 v[36:39], a[240:243], v[80:83], 0
    v_mfma_f32_16x16x32_bf16 v[44:47], a[244:247], v[80:83], 0
    v_mfma_f32_16x16x32_bf16 v[68:71], v[24:27], v[80:83], 0
    v_mfma_f32_16x16x32_bf16 v[40:43], a[240:243], v[84:87], 0
    v_mfma_f32_16x16x32_bf16 v[64:67], a[244:247], v[84:87], 0
    v_mfma_f32_16x16x32_bf16 v[72:75], v[24:27], v[84:87], 0
    s_nop 0
    v_mfma_f32_16x16x16_bf16 v[36:39], a[248:249], v[88:89], v[36:39]
    v_mfma_f32_16x16x16_bf16 v[44:47], a[250:251], v[88:89], v[44:47]
    v_mfma_f32_16x16x16_bf16 v[68:71], v[32:33], v[88:89], v[68:71]
    v_mfma_f32_16x16x16_bf16 v[40:43], a[248:249], v[90:91], v[40:43]
    v_mfma_f32_16x16x16_bf16 v[64:67], a[250:251], v[90:91], v[64:67]
    v_mfma_f32_16x16x16_bf16 v[72:75], v[32:33], v[90:91], v[72:75]
    s_nop 2
    ds_write_b128 v16, v[36:39] offset:0
    ds_write_b128 v16, v[44:47] offset:16
    ds_write_b128 v17, v[68:71]
    ds_write_b128 v16, v[40:43] offset:2816
    ds_write_b128 v16, v[64:67] offset:2832
    ds_write_b128 v18, v[72:75]
    s_add_u32 s40, s40, 1
    s_add_u32 s41, s41, 393216
    s_add_u32 s45, s45, 393216
    s_add_u32 s47, s37, 704512
    s_add_u32 s48, s37, 737280
    s_xor_b32 s42, s37, 0x2000
    s_lshl_b32 s24, s40, 12
    s_and_b32 s24, s24, 0x2000
    s_xor_b32 s24, s24, s36
    s_lshl_b32 s37, s40, 20
    s_add_u32 s37, s37, s24
    s_add_u32 s37, s37, 117440512
    s_add_u32 s43, s37, 655360
    s_add_u32 s49, s37, 753664
    s_waitcnt lgkmcnt(0)
    s_barrier
    s_cmp_lt_u32 s40, 64
    s_cbranch_scc1 interleave_layers__linear_attn_block__memory_aug_recurrent_mem_tr__prompt_kernel_s_stepw0
    s_branch interleave_layers__linear_attn_block__memory_aug_recurrent_mem_tr__prompt_kernel_s_end
interleave_layers__linear_attn_block__memory_aug_recurrent_mem_tr__prompt_kernel_s_stepw1:
    v_mov_b32 v24, 0
    v_mov_b32 v25, 0
    v_mov_b32 v26, 0
    v_mov_b32 v27, 0
    v_mov_b32 v28, 0
    v_mov_b32 v29, 0
    v_mov_b32 v30, 0
    v_mov_b32 v31, 0
    v_mov_b32 v32, 0
    v_mov_b32 v33, 0
    v_mov_b32 v34, 0
    v_mov_b32 v35, 0
    v_mov_b32 v36, 0
    v_mov_b32 v37, 0
    v_mov_b32 v38, 0
    v_mov_b32 v39, 0
    v_mov_b32 v40, 0
    v_mov_b32 v41, 0
    v_mov_b32 v42, 0
    v_mov_b32 v43, 0
    v_mov_b32 v44, 0
    v_mov_b32 v45, 0
    v_mov_b32 v46, 0
    v_mov_b32 v47, 0
    s_add_u32 s46, s47, 4096
    s_add_u32 s52, s47, 8192
    s_lshl_b32 s95, s92, 6
    s_add_u32 s95, s95, s40
    s_add_u32 s95, s95, 1
    s_cmp_ge_i32 s59, s95
    s_cbranch_scc1 interleave_layers__linear_attn_block__memory_aug_recurrent_mem_tr__prompt_kernel_s_ecw1_ok
    s_and_b32 s24, s2, 7
    s_lshl_b32 s24, s24, 7
    s_add_u32 s24, s24, 23109632
    v_and_b32 v49, 3, v1
    v_lshl_add_u32 v49, v49, 2, s24
    s_mov_b32 s61, 0
interleave_layers__linear_attn_block__memory_aug_recurrent_mem_tr__prompt_kernel_s_ecw1:
    buffer_load_dword v48, v49, s[8:11], 0 offen sc1
    s_waitcnt vmcnt(0)
    v_readlane_b32 s59, v48, 0
    v_readlane_b32 s24, v48, 1
    s_min_i32 s59, s59, s24
    v_readlane_b32 s24, v48, 2
    s_min_i32 s59, s59, s24
    s_cmp_ge_i32 s59, s95
    s_cbranch_scc1 interleave_layers__linear_attn_block__memory_aug_recurrent_mem_tr__prompt_kernel_s_ecw1_ok
    s_add_u32 s61, s61, 1
    s_cmp_ge_u32 s61, s60
    s_cbranch_scc1 interleave_layers__linear_attn_block__memory_aug_recurrent_mem_tr__prompt_kernel_s_ecw1_to
    s_sleep 2
    s_branch interleave_layers__linear_attn_block__memory_aug_recurrent_mem_tr__prompt_kernel_s_ecw1
interleave_layers__linear_attn_block__memory_aug_recurrent_mem_tr__prompt_kernel_s_ecw1_to:
    s_mov_b32 s60, 1
interleave_layers__linear_attn_block__memory_aug_recurrent_mem_tr__prompt_kernel_s_ecw1_ok:
    s_add_u32 s63, s40, 1
    s_cmp_ge_i32 s62, s63
    s_cbranch_scc1 interleave_layers__linear_attn_block__memory_aug_recurrent_mem_tr__prompt_kernel_s_enw1_ok
    s_mov_b32 s61, 0
interleave_layers__linear_attn_block__memory_aug_recurrent_mem_tr__prompt_kernel_s_enw1:
    buffer_load_dword v48, v9, s[8:11], 0 offen sc1
    s_waitcnt vmcnt(0)
    v_readlane_b32 s62, v48, 0
    v_readlane_b32 s24, v48, 1
    s_min_i32 s62, s62, s24
    s_cmp_ge_i32 s62, s63
    s_cbranch_scc1 interleave_layers__linear_attn_block__memory_aug_recurrent_mem_tr__prompt_kernel_s_enw1_ok
    s_add_u32 s61, s61, 1
    s_cmp_ge_u32 s61, s60
    s_cbranch_scc1 interleave_layers__linear_attn_block__memory_aug_recurrent_mem_tr__prompt_kernel_s_enw1_to
    s_sleep 2
    s_branch interleave_layers__linear_attn_block__memory_aug_recurrent_mem_tr__prompt_kernel_s_enw1
interleave_layers__linear_attn_block__memory_aug_recurrent_mem_tr__prompt_kernel_s_enw1_to:
    s_mov_b32 s60, 1
interleave_layers__linear_attn_block__memory_aug_recurrent_mem_tr__prompt_kernel_s_enw1_ok:
    buffer_load_dwordx4 a[240:243], v19, s[8:11], s41 offen offset:0 sc1
    buffer_load_dwordx4 a[244:247], v19, s[8:11], s41 offen offset:1024 sc1
    buffer_load_dwordx4 a[248:251], v19, s[8:11], s41 offen offset:2048 sc1
    s_sleep 5
    s_mov_b64 exec, 1
    s_mov_b32 s61, 0
    v_mov_b32 v83, 0
    buffer_atomic_add v83, v23, s[8:11], s48 offen sc0
    s_sleep 2
    v_mov_b32 v94, 0
    buffer_atomic_add v94, v23, s[8:11], s48 offen sc0
    s_sleep 2
    v_mov_b32 v95, 0
    buffer_atomic_add v95, v23, s[8:11], s48 offen sc0
    s_sleep 2
interleave_layers__linear_attn_block__memory_aug_recurrent_mem_tr__prompt_kernel_s_prw1:
    v_mov_b32 v82, 0
    buffer_atomic_add v82, v23, s[8:11], s48 offen sc0
    s_waitcnt vmcnt(3)
    v_cmp_le_i32 vcc, 9, v83
    s_add_u32 s61, s61, 1
    s_cbranch_vccnz interleave_layers__linear_attn_block__memory_aug_recurrent_mem_tr__prompt_kernel_s_prw1_out
    s_sleep 2
    v_mov_b32 v83, 0
    buffer_atomic_add v83, v23, s[8:11], s48 offen sc0
    s_waitcnt vmcnt(3)
    v_cmp_le_i32 vcc, 9, v94
    s_add_u32 s61, s61, 1
    s_cbranch_vccnz interleave_layers__linear_attn_block__memory_aug_recurrent_mem_tr__prompt_kernel_s_prw1_out
    s_sleep 2
    v_mov_b32 v94, 0
    buffer_atomic_add v94, v23, s[8:11], s48 offen sc0
    s_waitcnt vmcnt(3)
    v_cmp_le_i32 vcc, 9, v95
    s_add_u32 s61, s61, 1
    s_cbranch_vccnz interleave_layers__linear_attn_block__memory_aug_recurrent_mem_tr__prompt_kernel_s_prw1_out
    s_sleep 2
    v_mov_b32 v95, 0
    buffer_atomic_add v95, v23, s[8:11], s48 offen sc0
    s_waitcnt vmcnt(3)
    v_cmp_le_i32 vcc, 9, v82
    s_add_u32 s61, s61, 1
    s_cbranch_vccnz interleave_layers__linear_attn_block__memory_aug_recurrent_mem_tr__prompt_kernel_s_prw1_out
    s_sleep 2
    s_cmp_ge_u32 s61, s60
    s_cbranch_scc0 interleave_layers__linear_attn_block__memory_aug_recurrent_mem_tr__prompt_kernel_s_prw1
    s_mov_b32 s60, 1
interleave_layers__linear_attn_block__memory_aug_recurrent_mem_tr__prompt_kernel_s_prw1_out:
    s_mov_b64 exec, -1
    buffer_load_dwordx4 v[84:87], v7, s[8:11], s47 offen sc1
    buffer_load_dwordx4 v[88:91], v7, s[8:11], s46 offen sc1
    buffer_load_dwordx2 v[92:93], v8, s[8:11], s52 offen sc1
    ds_read_b128 v[48:51], v21 offset:0
    ds_read_b128 v[52:55], v21 offset:16
    ds_read_b128 v[56:59], v21 offset:5632
    ds_read_b128 v[60:63], v21 offset:5648
    ds_read_b128 v[64:67], v21 offset:11264
    ds_read_b128 v[68:71], v21 offset:11280
    ds_read_b128 v[72:75], v21 offset:16896
    ds_read_b128 v[76:79], v21 offset:16912
    s_waitcnt lgkmcnt(4)
    v_pk_add_f32 v[48:49], v[48:49], v[56:57]
    v_pk_add_f32 v[50:51], v[50:51], v[58:59]
    v_pk_add_f32 v[52:53], v[52:53], v[60:61]
    v_pk_add_f32 v[54:55], v[54:55], v[62:63]
    s_waitcnt lgkmcnt(0)
    v_pk_add_f32 v[64:65], v[64:65], v[72:73]
    v_pk_add_f32 v[66:67], v[66:67], v[74:75]
    v_pk_add_f32 v[68:69], v[68:69], v[76:77]
    v_pk_add_f32 v[70:71], v[70:71], v[78:79]
    v_pk_add_f32 v[48:49], v[48:49], v[64:65]
    v_pk_add_f32 v[50:51], v[50:51], v[66:67]
    v_pk_add_f32 v[52:53], v[52:53], v[68:69]
    v_pk_add_f32 v[54:55], v[54:55], v[70:71]
    v_mov_b32 v81, 0xff800000
    v_cndmask_b32 v48, v81, v48, s[64:65]
    v_cndmask_b32 v49, v81, v49, s[66:67]
    v_cndmask_b32 v50, v81, v50, s[68:69]
    v_cndmask_b32 v51, v81, v51, s[70:71]
    v_cndmask_b32 v52, v81, v52, s[72:73]
    v_cndmask_b32 v53, v81, v53, s[74:75]
    v_cndmask_b32 v54, v81, v54, s[76:77]
    v_cndmask_b32 v55, v81, v55, s[78:79]
    v_max3_f32 v80, v48, v49, v50
    v_max3_f32 v80, v80, v51, v52
    v_max3_f32 v80, v80, v53, v54
    v_max_f32 v80, v80, v55
    v_mov_b32 v81, 0xff800000
    v_cndmask_b32 v80, v81, v80, s[50:51]
    s_nop 1
    v_max_f32 v80, v80, v80 quad_perm:[1,0,3,2] row_mask:0xf bank_mask:0xf
    s_nop 1
    v_max_f32 v80, v80, v80 quad_perm:[2,3,0,1] row_mask:0xf bank_mask:0xf
    s_nop 1
    v_max_f32 v80, v80, v80 row_half_mirror row_mask:0xf bank_mask:0xf
    s_mov_b32 s24, 0x3dd53b95
    v_mul_f32 v80, s24, v80
    v_fma_f32 v48, v48, s24, -v80
    v_fma_f32 v49, v49, s24, -v80
    v_fma_f32 v50, v50, s24, -v80
    v_fma_f32 v51, v51, s24, -v80
    v_fma_f32 v52, v52, s24, -v80
    v_fma_f32 v53, v53, s24, -v80
    v_fma_f32 v54, v54, s24, -v80
    v_fma_f32 v55, v55, s24, -v80
    v_exp_f32 v48, v48
    v_exp_f32 v49, v49
    v_exp_f32 v50, v50
    v_exp_f32 v51, v51
    v_exp_f32 v52, v52
    v_exp_f32 v53, v53
    v_exp_f32 v54, v54
    v_exp_f32 v55, v55
    v_add_f32 v80, v48, v49
    v_add_f32 v81, v50, v51
    v_add_f32 v80, v80, v52
    v_add_f32 v81, v81, v53
    v_add_f32 v80, v80, v54
    v_add_f32 v81, v81, v55
    v_add_f32 v80, v80, v81
    v_cndmask_b32 v80, 0, v80, s[50:51]
    s_nop 1
    v_add_f32 v80, v80, v80 quad_perm:[1,0,3,2] row_mask:0xf bank_mask:0xf
    s_nop 1
    v_add_f32 v80, v80, v80 quad_perm:[2,3,0,1] row_mask:0xf bank_mask:0xf
    s_nop 1
    v_add_f32 v80, v80, v80 row_half_mirror row_mask:0xf bank_mask:0xf
    v_rcp_f32 v80, v80
    s_nop 0
    v_mul_f32 v48, v48, v80
    v_mul_f32 v49, v49, v80
    v_mul_f32 v50, v50, v80
    v_mul_f32 v51, v51, v80
    v_mul_f32 v52, v52, v80
    v_mul_f32 v53, v53, v80
    v_mul_f32 v54, v54, v80
    v_mul_f32 v55, v55, v80
    v_cvt_pk_bf16_f32 v56, v48, v49
    v_cvt_pk_bf16_f32 v57, v50, v51
    v_cvt_pk_bf16_f32 v58, v52, v53
    v_cvt_pk_bf16_f32 v59, v54, v55
    v_min_u32 v56, -2, v56
    v_min_u32 v57, -2, v57
    v_min_u32 v58, -2, v58
    v_min_u32 v59, -2, v59
    buffer_store_dwordx4 v[56:59], v22, s[8:11], s42 offen sc1
    s_waitcnt vmcnt(1)
    s_nop 0
    v_max3_u32 v58, v84, v85, v86
    v_max3_u32 v58, v58, v87, v88
    v_max3_u32 v58, v58, v89, v90
    v_max3_u32 v58, v58, v91, v92
    v_max_u32 v58, v58, v93
    v_cmp_eq_u32 vcc, -1, v58
    s_cbranch_vccz interleave_layers__linear_attn_block__memory_aug_recurrent_mem_tr__prompt_kernel_s_pmw1_out
    s_mov_b32 s61, 0
interleave_layers__linear_attn_block__memory_aug_recurrent_mem_tr__prompt_kernel_s_pmw1:
    buffer_load_dwordx4 v[84:87], v7, s[8:11], s47 offen sc1
    buffer_load_dwordx4 v[88:91], v7, s[8:11], s46 offen sc1
    buffer_load_dwordx2 v[92:93], v8, s[8:11], s52 offen sc1
    s_waitcnt vmcnt(0)
    v_max3_u32 v58, v84, v85, v86
    v_max3_u32 v58, v58, v87, v88
    v_max3_u32 v58, v58, v89, v90
    v_max3_u32 v58, v58, v91, v92
    v_max_u32 v58, v58, v93
    v_cmp_eq_u32 vcc, -1, v58
    s_add_u32 s61, s61, 1
    s_cbranch_vccz interleave_layers__linear_attn_block__memory_aug_recurrent_mem_tr__prompt_kernel_s_pmw1_out
    s_cmp_ge_u32 s61, s60
    s_cbranch_scc1 interleave_layers__linear_attn_block__memory_aug_recurrent_mem_tr__prompt_kernel_s_pmw1_to
    s_sleep 1
    s_branch interleave_layers__linear_attn_block__memory_aug_recurrent_mem_tr__prompt_kernel_s_pmw1
interleave_layers__linear_attn_block__memory_aug_recurrent_mem_tr__prompt_kernel_s_pmw1_to:
    s_mov_b32 s60, 1
interleave_layers__linear_attn_block__memory_aug_recurrent_mem_tr__prompt_kernel_s_pmw1_out:
    ds_write_b128 v7, v[84:87]
    ds_write_b128 v7, v[88:91] offset:4096
    ds_write_b64 v8, v[92:93]
interleave_layers__linear_attn_block__memory_aug_recurrent_mem_tr__prompt_kernel_s_gow1:
    ds_read_b128 v[68:71], v6 offset:2048
    ds_read_b128 v[72:75], v6 offset:3072
    ds_read_b128 v[76:79], v6 offset:10240
    ds_read_b128 v[80:83], v6 offset:11264
    v_smfmac_f32_16x16x64_bf16 v[24:27], v[84:87], a[8:15], v4
    v_smfmac_f32_16x16x64_bf16 v[28:31], v[84:87], a[88:95], v4
    v_smfmac_f32_16x16x64_bf16 v[32:35], v[84:87], a[168:175], v4
    v_smfmac_f32_16x16x64_bf16 v[40:43], v[84:87], v[104:111], v4
    v_smfmac_f32_16x16x64_bf16 v[44:47], v[84:87], v[184:191], v4
    s_waitcnt lgkmcnt(2)
    v_smfmac_f32_16x16x64_bf16 v[36:39], v[84:87], v[68:75], v4
    ds_read_b128 v[68:71], v6 offset:0
    ds_read_b128 v[72:75], v6 offset:1024
    s_barrier
    ds_read_b128 v[48:51], v5 offset:0
    ds_read_b128 v[52:55], v5 offset:2048
    ds_read_b128 v[56:59], v5 offset:3072
    ds_read_b128 v[60:63], v5 offset:4096
    ds_read_b128 v[64:67], v5 offset:6144
    v_smfmac_f32_16x16x64_bf16 v[24:27], v[88:91], a[40:47], v4
    v_smfmac_f32_16x16x64_bf16 v[28:31], v[88:91], a[120:127], v4
    v_smfmac_f32_16x16x64_bf16 v[32:35], v[88:91], a[200:207], v4
    v_smfmac_f32_16x16x64_bf16 v[40:43], v[88:91], v[136:143], v4
    v_smfmac_f32_16x16x64_bf16 v[44:47], v[88:91], v[216:223], v4
    s_waitcnt lgkmcnt(7)
    v_smfmac_f32_16x16x64_bf16 v[36:39], v[88:91], v[76:83], v4
    ds_read_b128 v[76:79], v6 offset:4096
    ds_read_b128 v[80:83], v6 offset:5120
    s_waitcnt lgkmcnt(6)
    v_smfmac_f32_16x16x64_bf16 v[24:27], v[48:51], a[0:7], v4
    v_smfmac_f32_16x16x64_bf16 v[28:31], v[48:51], a[80:87], v4
    v_smfmac_f32_16x16x64_bf16 v[40:43], v[48:51], v[96:103], v4
    v_smfmac_f32_16x16x64_bf16 v[36:39], v[48:51], v[68:75], v4
    ds_read_b128 v[68:71], v6 offset:6144
    ds_read_b128 v[72:75], v6 offset:7168
    ds_read_b128 v[48:51], v5 offset:7168
    s_waitcnt lgkmcnt(8)
    v_smfmac_f32_16x16x64_bf16 v[24:27], v[52:55], a[16:23], v4
    v_smfmac_f32_16x16x64_bf16 v[28:31], v[52:55], a[96:103], v4
    v_smfmac_f32_16x16x64_bf16 v[40:43], v[52:55], v[112:119], v4
    s_waitcnt lgkmcnt(3)
    v_smfmac_f32_16x16x64_bf16 v[36:39], v[52:55], v[76:83], v4
    ds_read_b128 v[76:79], v6 offset:8192
    ds_read_b128 v[80:83], v6 offset:9216
    ds_read_b128 v[52:55], v5 offset:8192
    v_smfmac_f32_16x16x64_bf16 v[24:27], v[56:59], a[24:31], v4
    v_smfmac_f32_16x16x64_bf16 v[28:31], v[56:59], a[104:111], v4
    v_smfmac_f32_16x16x64_bf16 v[40:43], v[56:59], v[120:127], v4
    s_waitcnt lgkmcnt(4)
    v_smfmac_f32_16x16x64_bf16 v[36:39], v[56:59], v[68:75], v4
    ds_read_b128 v[68:71], v6 offset:12288
    ds_read_b128 v[72:75], v6 offset:13312
    ds_read_b128 v[56:59], v5 offset:9216
    v_smfmac_f32_16x16x64_bf16 v[24:27], v[60:63], a[32:39], v4
    v_smfmac_f32_16x16x64_bf16 v[28:31], v[60:63], a[112:119], v4
    v_smfmac_f32_16x16x64_bf16 v[40:43], v[60:63], v[128:135], v4
    s_waitcnt lgkmcnt(4)
    v_smfmac_f32_16x16x64_bf16 v[36:39], v[60:63], v[76:83], v4
    ds_read_b128 v[76:79], v6 offset:14336
    ds_read_b128 v[80:83], v6 offset:15360
    ds_read_b128 v[60:63], v5 offset:0
    v_smfmac_f32_16x16x64_bf16 v[24:27], v[64:67], a[48:55], v4
    v_smfmac_f32_16x16x64_bf16 v[28:31], v[64:67], a[128:135], v4
    v_smfmac_f32_16x16x64_bf16 v[40:43], v[64:67], v[144:151], v4
    s_waitcnt lgkmcnt(4)
    v_smfmac_f32_16x16x64_bf16 v[36:39], v[64:67], v[68:75], v4
    ds_read_b128 v[68:71], v6 offset:16384
    ds_read_b128 v[72:75], v6 offset:17408
    ds_read_b128 v[64:67], v5 offset:2048
    v_smfmac_f32_16x16x64_bf16 v[24:27], v[48:51], a[56:63], v4
    v_smfmac_f32_16x16x64_bf16 v[28:31], v[48:51], a[136:143], v4
    v_smfmac_f32_16x16x64_bf16 v[40:43], v[48:51], v[152:159], v4
    s_waitcnt lgkmcnt(4)
    v_smfmac_f32_16x16x64_bf16 v[36:39], v[48:51], v[76:83], v4
    ds_read_b128 v[76:79], v6 offset:18432
    ds_read_b128 v[80:83], v6 offset:19456
    ds_read_b128 v[48:51], v5 offset:3072
    v_smfmac_f32_16x16x64_bf16 v[24:27], v[52:55], a[64:71], v4
    v_smfmac_f32_16x16x64_bf16 v[28:31], v[52:55], a[144:151], v4
    v_smfmac_f32_16x16x64_bf16 v[40:43], v[52:55], v[160:167], v4
    s_waitcnt lgkmcnt(4)
    v_smfmac_f32_16x16x64_bf16 v[36:39], v[52:55], v[68:75], v4
    ds_read_b128 v[52:55], v5 offset:4096
    v_smfmac_f32_16x16x64_bf16 v[24:27], v[56:59], a[72:79], v4
    v_smfmac_f32_16x16x64_bf16 v[28:31], v[56:59], a[152:159], v4
    v_smfmac_f32_16x16x64_bf16 v[40:43], v[56:59], v[168:175], v4
    s_waitcnt lgkmcnt(2)
    v_smfmac_f32_16x16x64_bf16 v[36:39], v[56:59], v[76:83], v4
    ds_read_b128 v[56:59], v5 offset:6144
    buffer_load_dwordx4 v[80:83], v19, s[8:11], s45 offen offset:0 sc1
    buffer_load_dwordx4 v[84:87], v19, s[8:11], s45 offen offset:1024 sc1
    buffer_load_dwordx4 v[88:91], v19, s[8:11], s45 offen offset:2048 sc1
    v_smfmac_f32_16x16x64_bf16 v[32:35], v[60:63], a[160:167], v4
    v_smfmac_f32_16x16x64_bf16 v[44:47], v[60:63], v[176:183], v4
    v_permlane32_swap_b32 v28, v40
    v_permlane32_swap_b32 v29, v41
    ds_read_b128 v[60:63], v5 offset:7168
    v_smfmac_f32_16x16x64_bf16 v[32:35], v[64:67], a[176:183], v4
    v_permlane32_swap_b32 v30, v42
    v_permlane32_swap_b32 v31, v43
    v_smfmac_f32_16x16x64_bf16 v[44:47], v[64:67], v[192:199], v4
    v_add_f32 v28, v28, v40
    v_add_f32 v29, v29, v41
    ds_read_b128 v[64:67], v5 offset:8192
    s_waitcnt lgkmcnt(4)
    v_smfmac_f32_16x16x64_bf16 v[32:35], v[48:51], a[184:191], v4
    v_add_f32 v30, v30, v42
    v_add_f32 v31, v31, v43
    v_smfmac_f32_16x16x64_bf16 v[44:47], v[48:51], v[200:207], v4
    v_cvt_pk_bf16_f32 v40, v28, v29
    v_cvt_pk_bf16_f32 v41, v30, v31
    ds_read_b128 v[48:51], v5 offset:9216
    s_waitcnt lgkmcnt(4)
    v_smfmac_f32_16x16x64_bf16 v[32:35], v[52:55], a[192:199], v4
    v_mfma_f32_16x16x16_bf16 v[28:31], v[40:41], v[10:11], 0
    v_permlane32_swap_b32 v24, v36
    v_smfmac_f32_16x16x64_bf16 v[44:47], v[52:55], v[208:215], v4
    v_permlane32_swap_b32 v25, v37
    v_permlane32_swap_b32 v26, v38
    s_waitcnt lgkmcnt(3)
    v_smfmac_f32_16x16x64_bf16 v[32:35], v[56:59], a[208:215], v4
    v_permlane32_swap_b32 v27, v39
    v_add_f32 v24, v24, v36
    v_smfmac_f32_16x16x64_bf16 v[44:47], v[56:59], v[224:231], v4
    v_add_f32 v25, v25, v37
    v_add_f32 v26, v26, v38
    s_waitcnt lgkmcnt(2)
    v_smfmac_f32_16x16x64_bf16 v[32:35], v[60:63], a[216:223], v4
    v_add_f32 v27, v27, v39
    v_cvt_pk_bf16_f32 v36, v24, v25
    v_smfmac_f32_16x16x64_bf16 v[44:47], v[60:63], v[232:239], v4
    v_cvt_pk_bf16_f32 v37, v26, v27
    s_nop 1
    v_mfma_f32_16x16x16_bf16 v[24:27], v[36:37], v[10:11], 0
    s_waitcnt lgkmcnt(1)
    v_smfmac_f32_16x16x64_bf16 v[32:35], v[64:67], a[224:231], v4
    s_nop 5
    v_cvt_pk_bf16_f32 v24, v24, v25
    v_smfmac_f32_16x16x64_bf16 v[44:47], v[64:67], v[240:247], v4
    v_cvt_pk_bf16_f32 v25, v26, v27
    v_cvt_pk_bf16_f32 v26, v28, v29
    s_waitcnt lgkmcnt(0)
    v_smfmac_f32_16x16x64_bf16 v[32:35], v[48:51], a[232:239], v4
    v_cvt_pk_bf16_f32 v27, v30, v31
    s_waitcnt vmcnt(3)
    v_smfmac_f32_16x16x64_bf16 v[44:47], v[48:51], v[248:255], v4
    v_mfma_f32_16x16x32_bf16 v[28:31], a[240:243], v[24:27], 0
    v_mfma_f32_16x16x32_bf16 v[36:39], a[244:247], v[24:27], 0
    v_mfma_f32_16x16x32_bf16 v[40:43], v[24:27], v[24:27], 0
    s_nop 4
    v_permlane32_swap_b32 v32, v44
    v_permlane32_swap_b32 v33, v45
    v_permlane32_swap_b32 v34, v46
    v_permlane32_swap_b32 v35, v47
    v_add_f32 v32, v32, v44
    v_add_f32 v33, v33, v45
    v_add_f32 v34, v34, v46
    v_add_f32 v35, v35, v47
    v_cvt_pk_bf16_f32 v44, v32, v33
    v_cvt_pk_bf16_f32 v45, v34, v35
    s_nop 1
    v_mfma_f32_16x16x16_bf16 v[32:35], v[44:45], v[10:11], 0
    s_nop 7
    v_cvt_pk_bf16_f32 v32, v32, v33
    v_cvt_pk_bf16_f32 v33, v34, v35
    s_nop 1
    v_mfma_f32_16x16x16_bf16 v[28:31], a[248:249], v[32:33], v[28:31]
    v_mfma_f32_16x16x16_bf16 v[36:39], a[250:251], v[32:33], v[36:39]
    v_mfma_f32_16x16x16_bf16 v[40:43], v[32:33], v[32:33], v[40:43]
    s_nop 5
    ds_write_b128 v12, v[28:31]
    ds_write_b128 v12, v[36:39] offset:16
    ds_write_b128 v13, v[40:43]
    s_waitcnt lgkmcnt(0)
    s_barrier
    s_waitcnt vmcnt(0)
    v_mfma_f32_16x16x32_bf16 v[36:39], a[240:243], v[80:83], 0
    v_mfma_f32_16x16x32_bf16 v[44:47], a[244:247], v[80:83], 0
    v_mfma_f32_16x16x32_bf16 v[68:71], v[24:27], v[80:83], 0
    v_mfma_f32_16x16x32_bf16 v[40:43], a[240:243], v[84:87], 0
    v_mfma_f32_16x16x32_bf16 v[64:67], a[244:247], v[84:87], 0
    v_mfma_f32_16x16x32_bf16 v[72:75], v[24:27], v[84:87], 0
    s_nop 0
    v_mfma_f32_16x16x16_bf16 v[36:39], a[248:249], v[88:89], v[36:39]
    v_mfma_f32_16x16x16_bf16 v[44:47], a[250:251], v[88:89], v[44:47]
    v_mfma_f32_16x16x16_bf16 v[68:71], v[32:33], v[88:89], v[68:71]
    v_mfma_f32_16x16x16_bf16 v[40:43], a[248:249], v[90:91], v[40:43]
    v_mfma_f32_16x16x16_bf16 v[64:67], a[250:251], v[90:91], v[64:67]
    v_mfma_f32_16x16x16_bf16 v[72:75], v[32:33], v[90:91], v[72:75]
    s_nop 2
    ds_write_b128 v16, v[36:39] offset:0
    ds_write_b128 v16, v[44:47] offset:16
    ds_write_b128 v17, v[68:71]
    ds_write_b128 v16, v[40:43] offset:2816
    ds_write_b128 v16, v[64:67] offset:2832
    ds_write_b128 v18, v[72:75]
    s_add_u32 s40, s40, 1
    s_add_u32 s41, s41, 393216
    s_add_u32 s45, s45, 393216
    s_add_u32 s47, s37, 704512
    s_add_u32 s48, s37, 737280
    s_xor_b32 s42, s37, 0x2000
    s_lshl_b32 s24, s40, 12
    s_and_b32 s24, s24, 0x2000
    s_xor_b32 s24, s24, s36
    s_lshl_b32 s37, s40, 20
    s_add_u32 s37, s37, s24
    s_add_u32 s37, s37, 117440512
    s_add_u32 s43, s37, 655360
    s_add_u32 s49, s37, 753664
    s_waitcnt lgkmcnt(0)
    s_barrier
    s_cmp_lt_u32 s40, 64
    s_cbranch_scc1 interleave_layers__linear_attn_block__memory_aug_recurrent_mem_tr__prompt_kernel_s_stepw1
    s_branch interleave_layers__linear_attn_block__memory_aug_recurrent_mem_tr__prompt_kernel_s_end
interleave_layers__linear_attn_block__memory_aug_recurrent_mem_tr__prompt_kernel_s_stepw2:
    v_mov_b32 v24, 0
    v_mov_b32 v25, 0
    v_mov_b32 v26, 0
    v_mov_b32 v27, 0
    v_mov_b32 v28, 0
    v_mov_b32 v29, 0
    v_mov_b32 v30, 0
    v_mov_b32 v31, 0
    v_mov_b32 v32, 0
    v_mov_b32 v33, 0
    v_mov_b32 v34, 0
    v_mov_b32 v35, 0
    v_mov_b32 v36, 0
    v_mov_b32 v37, 0
    v_mov_b32 v38, 0
    v_mov_b32 v39, 0
    v_mov_b32 v40, 0
    v_mov_b32 v41, 0
    v_mov_b32 v42, 0
    v_mov_b32 v43, 0
    v_mov_b32 v44, 0
    v_mov_b32 v45, 0
    v_mov_b32 v46, 0
    v_mov_b32 v47, 0
    s_add_u32 s46, s47, 4096
    s_add_u32 s52, s47, 8192
    s_lshl_b32 s95, s92, 6
    s_add_u32 s95, s95, s40
    s_add_u32 s95, s95, 1
    s_cmp_ge_i32 s59, s95
    s_cbranch_scc1 interleave_layers__linear_attn_block__memory_aug_recurrent_mem_tr__prompt_kernel_s_ecw2_ok
    s_and_b32 s24, s2, 7
    s_lshl_b32 s24, s24, 7
    s_add_u32 s24, s24, 23109632
    v_and_b32 v49, 3, v1
    v_lshl_add_u32 v49, v49, 2, s24
    s_mov_b32 s61, 0
interleave_layers__linear_attn_block__memory_aug_recurrent_mem_tr__prompt_kernel_s_ecw2:
    buffer_load_dword v48, v49, s[8:11], 0 offen sc1
    s_waitcnt vmcnt(0)
    v_readlane_b32 s59, v48, 0
    v_readlane_b32 s24, v48, 1
    s_min_i32 s59, s59, s24
    v_readlane_b32 s24, v48, 2
    s_min_i32 s59, s59, s24
    s_cmp_ge_i32 s59, s95
    s_cbranch_scc1 interleave_layers__linear_attn_block__memory_aug_recurrent_mem_tr__prompt_kernel_s_ecw2_ok
    s_add_u32 s61, s61, 1
    s_cmp_ge_u32 s61, s60
    s_cbranch_scc1 interleave_layers__linear_attn_block__memory_aug_recurrent_mem_tr__prompt_kernel_s_ecw2_to
    s_sleep 2
    s_branch interleave_layers__linear_attn_block__memory_aug_recurrent_mem_tr__prompt_kernel_s_ecw2
interleave_layers__linear_attn_block__memory_aug_recurrent_mem_tr__prompt_kernel_s_ecw2_to:
    s_mov_b32 s60, 1
interleave_layers__linear_attn_block__memory_aug_recurrent_mem_tr__prompt_kernel_s_ecw2_ok:
    s_add_u32 s63, s40, 1
    s_cmp_ge_i32 s62, s63
    s_cbranch_scc1 interleave_layers__linear_attn_block__memory_aug_recurrent_mem_tr__prompt_kernel_s_enw2_ok
    s_mov_b32 s61, 0
interleave_layers__linear_attn_block__memory_aug_recurrent_mem_tr__prompt_kernel_s_enw2:
    buffer_load_dword v48, v9, s[8:11], 0 offen sc1
    s_waitcnt vmcnt(0)
    v_readlane_b32 s62, v48, 0
    v_readlane_b32 s24, v48, 1
    s_min_i32 s62, s62, s24
    s_cmp_ge_i32 s62, s63
    s_cbranch_scc1 interleave_layers__linear_attn_block__memory_aug_recurrent_mem_tr__prompt_kernel_s_enw2_ok
    s_add_u32 s61, s61, 1
    s_cmp_ge_u32 s61, s60
    s_cbranch_scc1 interleave_layers__linear_attn_block__memory_aug_recurrent_mem_tr__prompt_kernel_s_enw2_to
    s_sleep 2
    s_branch interleave_layers__linear_attn_block__memory_aug_recurrent_mem_tr__prompt_kernel_s_enw2
interleave_layers__linear_attn_block__memory_aug_recurrent_mem_tr__prompt_kernel_s_enw2_to:
    s_mov_b32 s60, 1
interleave_layers__linear_attn_block__memory_aug_recurrent_mem_tr__prompt_kernel_s_enw2_ok:
    buffer_load_dwordx4 a[240:243], v19, s[8:11], s41 offen offset:0 sc1
    buffer_load_dwordx4 a[244:247], v19, s[8:11], s41 offen offset:1024 sc1
    buffer_load_dwordx4 a[248:251], v19, s[8:11], s41 offen offset:2048 sc1
    s_sleep 5
    s_mov_b64 exec, 1
    s_mov_b32 s61, 0
    v_mov_b32 v83, 0
    buffer_atomic_add v83, v23, s[8:11], s48 offen sc0
    s_sleep 2
    v_mov_b32 v94, 0
    buffer_atomic_add v94, v23, s[8:11], s48 offen sc0
    s_sleep 2
    v_mov_b32 v95, 0
    buffer_atomic_add v95, v23, s[8:11], s48 offen sc0
    s_sleep 2
interleave_layers__linear_attn_block__memory_aug_recurrent_mem_tr__prompt_kernel_s_prw2:
    v_mov_b32 v82, 0
    buffer_atomic_add v82, v23, s[8:11], s48 offen sc0
    s_waitcnt vmcnt(3)
    v_cmp_le_i32 vcc, 9, v83
    s_add_u32 s61, s61, 1
    s_cbranch_vccnz interleave_layers__linear_attn_block__memory_aug_recurrent_mem_tr__prompt_kernel_s_prw2_out
    s_sleep 2
    v_mov_b32 v83, 0
    buffer_atomic_add v83, v23, s[8:11], s48 offen sc0
    s_waitcnt vmcnt(3)
    v_cmp_le_i32 vcc, 9, v94
    s_add_u32 s61, s61, 1
    s_cbranch_vccnz interleave_layers__linear_attn_block__memory_aug_recurrent_mem_tr__prompt_kernel_s_prw2_out
    s_sleep 2
    v_mov_b32 v94, 0
    buffer_atomic_add v94, v23, s[8:11], s48 offen sc0
    s_waitcnt vmcnt(3)
    v_cmp_le_i32 vcc, 9, v95
    s_add_u32 s61, s61, 1
    s_cbranch_vccnz interleave_layers__linear_attn_block__memory_aug_recurrent_mem_tr__prompt_kernel_s_prw2_out
    s_sleep 2
    v_mov_b32 v95, 0
    buffer_atomic_add v95, v23, s[8:11], s48 offen sc0
    s_waitcnt vmcnt(3)
    v_cmp_le_i32 vcc, 9, v82
    s_add_u32 s61, s61, 1
    s_cbranch_vccnz interleave_layers__linear_attn_block__memory_aug_recurrent_mem_tr__prompt_kernel_s_prw2_out
    s_sleep 2
    s_cmp_ge_u32 s61, s60
    s_cbranch_scc0 interleave_layers__linear_attn_block__memory_aug_recurrent_mem_tr__prompt_kernel_s_prw2
    s_mov_b32 s60, 1
interleave_layers__linear_attn_block__memory_aug_recurrent_mem_tr__prompt_kernel_s_prw2_out:
    s_mov_b64 exec, -1
    buffer_load_dwordx4 v[84:87], v7, s[8:11], s47 offen sc1
    buffer_load_dwordx4 v[88:91], v7, s[8:11], s46 offen sc1
    buffer_load_dwordx2 v[92:93], v8, s[8:11], s52 offen sc1
    ds_read_b128 v[48:51], v21 offset:0
    ds_read_b128 v[52:55], v21 offset:16
    ds_read_b128 v[56:59], v21 offset:5632
    ds_read_b128 v[60:63], v21 offset:5648
    ds_read_b128 v[64:67], v21 offset:11264
    ds_read_b128 v[68:71], v21 offset:11280
    ds_read_b128 v[72:75], v21 offset:16896
    ds_read_b128 v[76:79], v21 offset:16912
    s_waitcnt lgkmcnt(4)
    v_pk_add_f32 v[48:49], v[48:49], v[56:57]
    v_pk_add_f32 v[50:51], v[50:51], v[58:59]
    v_pk_add_f32 v[52:53], v[52:53], v[60:61]
    v_pk_add_f32 v[54:55], v[54:55], v[62:63]
    s_waitcnt lgkmcnt(0)
    v_pk_add_f32 v[64:65], v[64:65], v[72:73]
    v_pk_add_f32 v[66:67], v[66:67], v[74:75]
    v_pk_add_f32 v[68:69], v[68:69], v[76:77]
    v_pk_add_f32 v[70:71], v[70:71], v[78:79]
    v_pk_add_f32 v[48:49], v[48:49], v[64:65]
    v_pk_add_f32 v[50:51], v[50:51], v[66:67]
    v_pk_add_f32 v[52:53], v[52:53], v[68:69]
    v_pk_add_f32 v[54:55], v[54:55], v[70:71]
    v_mov_b32 v81, 0xff800000
    v_cndmask_b32 v48, v81, v48, s[64:65]
    v_cndmask_b32 v49, v81, v49, s[66:67]
    v_cndmask_b32 v50, v81, v50, s[68:69]
    v_cndmask_b32 v51, v81, v51, s[70:71]
    v_cndmask_b32 v52, v81, v52, s[72:73]
    v_cndmask_b32 v53, v81, v53, s[74:75]
    v_cndmask_b32 v54, v81, v54, s[76:77]
    v_cndmask_b32 v55, v81, v55, s[78:79]
    v_max3_f32 v80, v48, v49, v50
    v_max3_f32 v80, v80, v51, v52
    v_max3_f32 v80, v80, v53, v54
    v_max_f32 v80, v80, v55
    v_mov_b32 v81, 0xff800000
    v_cndmask_b32 v80, v81, v80, s[50:51]
    s_nop 1
    v_max_f32 v80, v80, v80 quad_perm:[1,0,3,2] row_mask:0xf bank_mask:0xf
    s_nop 1
    v_max_f32 v80, v80, v80 quad_perm:[2,3,0,1] row_mask:0xf bank_mask:0xf
    s_nop 1
    v_max_f32 v80, v80, v80 row_half_mirror row_mask:0xf bank_mask:0xf
    s_mov_b32 s24, 0x3dd53b95
    v_mul_f32 v80, s24, v80
    v_fma_f32 v48, v48, s24, -v80
    v_fma_f32 v49, v49, s24, -v80
    v_fma_f32 v50, v50, s24, -v80
    v_fma_f32 v51, v51, s24, -v80
    v_fma_f32 v52, v52, s24, -v80
    v_fma_f32 v53, v53, s24, -v80
    v_fma_f32 v54, v54, s24, -v80
    v_fma_f32 v55, v55, s24, -v80
    v_exp_f32 v48, v48
    v_exp_f32 v49, v49
    v_exp_f32 v50, v50
    v_exp_f32 v51, v51
    v_exp_f32 v52, v52
    v_exp_f32 v53, v53
    v_exp_f32 v54, v54
    v_exp_f32 v55, v55
    v_add_f32 v80, v48, v49
    v_add_f32 v81, v50, v51
    v_add_f32 v80, v80, v52
    v_add_f32 v81, v81, v53
    v_add_f32 v80, v80, v54
    v_add_f32 v81, v81, v55
    v_add_f32 v80, v80, v81
    v_cndmask_b32 v80, 0, v80, s[50:51]
    s_nop 1
    v_add_f32 v80, v80, v80 quad_perm:[1,0,3,2] row_mask:0xf bank_mask:0xf
    s_nop 1
    v_add_f32 v80, v80, v80 quad_perm:[2,3,0,1] row_mask:0xf bank_mask:0xf
    s_nop 1
    v_add_f32 v80, v80, v80 row_half_mirror row_mask:0xf bank_mask:0xf
    v_rcp_f32 v80, v80
    s_nop 0
    v_mul_f32 v48, v48, v80
    v_mul_f32 v49, v49, v80
    v_mul_f32 v50, v50, v80
    v_mul_f32 v51, v51, v80
    v_mul_f32 v52, v52, v80
    v_mul_f32 v53, v53, v80
    v_mul_f32 v54, v54, v80
    v_mul_f32 v55, v55, v80
    v_cvt_pk_bf16_f32 v56, v48, v49
    v_cvt_pk_bf16_f32 v57, v50, v51
    v_cvt_pk_bf16_f32 v58, v52, v53
    v_cvt_pk_bf16_f32 v59, v54, v55
    v_min_u32 v56, -2, v56
    v_min_u32 v57, -2, v57
    v_min_u32 v58, -2, v58
    v_min_u32 v59, -2, v59
    buffer_store_dwordx4 v[56:59], v22, s[8:11], s42 offen sc1
    s_waitcnt vmcnt(1)
    s_nop 0
    v_max3_u32 v58, v84, v85, v86
    v_max3_u32 v58, v58, v87, v88
    v_max3_u32 v58, v58, v89, v90
    v_max3_u32 v58, v58, v91, v92
    v_max_u32 v58, v58, v93
    v_cmp_eq_u32 vcc, -1, v58
    s_cbranch_vccz interleave_layers__linear_attn_block__memory_aug_recurrent_mem_tr__prompt_kernel_s_pmw2_out
    s_mov_b32 s61, 0
interleave_layers__linear_attn_block__memory_aug_recurrent_mem_tr__prompt_kernel_s_pmw2:
    buffer_load_dwordx4 v[84:87], v7, s[8:11], s47 offen sc1
    buffer_load_dwordx4 v[88:91], v7, s[8:11], s46 offen sc1
    buffer_load_dwordx2 v[92:93], v8, s[8:11], s52 offen sc1
    s_waitcnt vmcnt(0)
    v_max3_u32 v58, v84, v85, v86
    v_max3_u32 v58, v58, v87, v88
    v_max3_u32 v58, v58, v89, v90
    v_max3_u32 v58, v58, v91, v92
    v_max_u32 v58, v58, v93
    v_cmp_eq_u32 vcc, -1, v58
    s_add_u32 s61, s61, 1
    s_cbranch_vccz interleave_layers__linear_attn_block__memory_aug_recurrent_mem_tr__prompt_kernel_s_pmw2_out
    s_cmp_ge_u32 s61, s60
    s_cbranch_scc1 interleave_layers__linear_attn_block__memory_aug_recurrent_mem_tr__prompt_kernel_s_pmw2_to
    s_sleep 1
    s_branch interleave_layers__linear_attn_block__memory_aug_recurrent_mem_tr__prompt_kernel_s_pmw2
interleave_layers__linear_attn_block__memory_aug_recurrent_mem_tr__prompt_kernel_s_pmw2_to:
    s_mov_b32 s60, 1
interleave_layers__linear_attn_block__memory_aug_recurrent_mem_tr__prompt_kernel_s_pmw2_out:
    ds_write_b128 v7, v[84:87]
    ds_write_b128 v7, v[88:91] offset:4096
    ds_write_b64 v8, v[92:93]
interleave_layers__linear_attn_block__memory_aug_recurrent_mem_tr__prompt_kernel_s_gow2:
    ds_read_b128 v[68:71], v6 offset:4096
    ds_read_b128 v[72:75], v6 offset:5120
    ds_read_b128 v[76:79], v6 offset:12288
    ds_read_b128 v[80:83], v6 offset:13312
    v_smfmac_f32_16x16x64_bf16 v[24:27], v[84:87], a[16:23], v4
    v_smfmac_f32_16x16x64_bf16 v[28:31], v[84:87], a[96:103], v4
    v_smfmac_f32_16x16x64_bf16 v[32:35], v[84:87], a[176:183], v4
    v_smfmac_f32_16x16x64_bf16 v[40:43], v[84:87], v[112:119], v4
    v_smfmac_f32_16x16x64_bf16 v[44:47], v[84:87], v[192:199], v4
    s_waitcnt lgkmcnt(2)
    v_smfmac_f32_16x16x64_bf16 v[36:39], v[84:87], v[68:75], v4
    ds_read_b128 v[68:71], v6 offset:0
    ds_read_b128 v[72:75], v6 offset:1024
    s_barrier
    ds_read_b128 v[48:51], v5 offset:0
    ds_read_b128 v[52:55], v5 offset:1024
    ds_read_b128 v[56:59], v5 offset:3072
    ds_read_b128 v[60:63], v5 offset:4096
    ds_read_b128 v[64:67], v5 offset:5120
    v_smfmac_f32_16x16x64_bf16 v[24:27], v[88:91], a[48:55], v4
    v_smfmac_f32_16x16x64_bf16 v[28:31], v[88:91], a[128:135], v4
    v_smfmac_f32_16x16x64_bf16 v[32:35], v[88:91], a[208:215], v4
    v_smfmac_f32_16x16x64_bf16 v[40:43], v[88:91], v[144:151], v4
    v_smfmac_f32_16x16x64_bf16 v[44:47], v[88:91], v[224:231], v4
    s_waitcnt lgkmcnt(7)
    v_smfmac_f32_16x16x64_bf16 v[36:39], v[88:91], v[76:83], v4
    ds_read_b128 v[76:79], v6 offset:2048
    ds_read_b128 v[80:83], v6 offset:3072
    s_waitcnt lgkmcnt(6)
    v_smfmac_f32_16x16x64_bf16 v[24:27], v[48:51], a[0:7], v4
    v_smfmac_f32_16x16x64_bf16 v[28:31], v[48:51], a[80:87], v4
    v_smfmac_f32_16x16x64_bf16 v[40:43], v[48:51], v[96:103], v4
    v_smfmac_f32_16x16x64_bf16 v[36:39], v[48:51], v[68:75], v4
    ds_read_b128 v[68:71], v6 offset:6144
    ds_read_b128 v[72:75], v6 offset:7168
    ds_read_b128 v[48:51], v5 offset:7168
    s_waitcnt lgkmcnt(8)
    v_smfmac_f32_16x16x64_bf16 v[24:27], v[52:55], a[8:15], v4
    v_smfmac_f32_16x16x64_bf16 v[28:31], v[52:55], a[88:95], v4
    v_smfmac_f32_16x16x64_bf16 v[40:43], v[52:55], v[104:111], v4
    s_waitcnt lgkmcnt(3)
    v_smfmac_f32_16x16x64_bf16 v[36:39], v[52:55], v[76:83], v4
    ds_read_b128 v[76:79], v6 offset:8192
    ds_read_b128 v[80:83], v6 offset:9216
    ds_read_b128 v[52:55], v5 offset:8192
    v_smfmac_f32_16x16x64_bf16 v[24:27], v[56:59], a[24:31], v4
    v_smfmac_f32_16x16x64_bf16 v[28:31], v[56:59], a[104:111], v4
    v_smfmac_f32_16x16x64_bf16 v[40:43], v[56:59], v[120:127], v4
    s_waitcnt lgkmcnt(4)
    v_smfmac_f32_16x16x64_bf16 v[36:39], v[56:59], v[68:75], v4
    ds_read_b128 v[68:71], v6 offset:10240
    ds_read_b128 v[72:75], v6 offset:11264
    ds_read_b128 v[56:59], v5 offset:9216
    v_smfmac_f32_16x16x64_bf16 v[24:27], v[60:63], a[32:39], v4
    v_smfmac_f32_16x16x64_bf16 v[28:31], v[60:63], a[112:119], v4
    v_smfmac_f32_16x16x64_bf16 v[40:43], v[60:63], v[128:135], v4
    s_waitcnt lgkmcnt(4)
    v_smfmac_f32_16x16x64_bf16 v[36:39], v[60:63], v[76:83], v4
    ds_read_b128 v[76:79], v6 offset:14336
    ds_read_b128 v[80:83], v6 offset:15360
    ds_read_b128 v[60:63], v5 offset:0
    v_smfmac_f32_16x16x64_bf16 v[24:27], v[64:67], a[40:47], v4
    v_smfmac_f32_16x16x64_bf16 v[28:31], v[64:67], a[120:127], v4
    v_smfmac_f32_16x16x64_bf16 v[40:43], v[64:67], v[136:143], v4
    s_waitcnt lgkmcnt(4)
    v_smfmac_f32_16x16x64_bf16 v[36:39], v[64:67], v[68:75], v4
    ds_read_b128 v[68:71], v6 offset:16384
    ds_read_b128 v[72:75], v6 offset:17408
    ds_read_b128 v[64:67], v5 offset:1024
    v_smfmac_f32_16x16x64_bf16 v[24:27], v[48:51], a[56:63], v4
    v_smfmac_f32_16x16x64_bf16 v[28:31], v[48:51], a[136:143], v4
    v_smfmac_f32_16x16x64_bf16 v[40:43], v[48:51], v[152:159], v4
    s_waitcnt lgkmcnt(4)
    v_smfmac_f32_16x16x64_bf16 v[36:39], v[48:51], v[76:83], v4
    ds_read_b128 v[76:79], v6 offset:18432
    ds_read_b128 v[80:83], v6 offset:19456
    ds_read_b128 v[48:51], v5 offset:3072
    v_smfmac_f32_16x16x64_bf16 v[24:27], v[52:55], a[64:71], v4
    v_smfmac_f32_16x16x64_bf16 v[28:31], v[52:55], a[144:151], v4
    v_smfmac_f32_16x16x64_bf16 v[40:43], v[52:55], v[160:167], v4
    s_waitcnt lgkmcnt(4)
    v_smfmac_f32_16x16x64_bf16 v[36:39], v[52:55], v[68:75], v4
    ds_read_b128 v[52:55], v5 offset:4096
    v_smfmac_f32_16x16x64_bf16 v[24:27], v[56:59], a[72:79], v4
    v_smfmac_f32_16x16x64_bf16 v[28:31], v[56:59], a[152:159], v4
    v_smfmac_f32_16x16x64_bf16 v[40:43], v[56:59], v[168:175], v4
    s_waitcnt lgkmcnt(2)
    v_smfmac_f32_16x16x64_bf16 v[36:39], v[56:59], v[76:83], v4
    ds_read_b128 v[56:59], v5 offset:5120
    buffer_load_dwordx4 v[80:83], v19, s[8:11], s45 offen offset:0 sc1
    buffer_load_dwordx4 v[84:87], v19, s[8:11], s45 offen offset:1024 sc1
    buffer_load_dwordx4 v[88:91], v19, s[8:11], s45 offen offset:2048 sc1
    v_smfmac_f32_16x16x64_bf16 v[32:35], v[60:63], a[160:167], v4
    v_smfmac_f32_16x16x64_bf16 v[44:47], v[60:63], v[176:183], v4
    v_permlane32_swap_b32 v28, v40
    v_permlane32_swap_b32 v29, v41
    ds_read_b128 v[60:63], v5 offset:7168
    v_smfmac_f32_16x16x64_bf16 v[32:35], v[64:67], a[168:175], v4
    v_permlane32_swap_b32 v30, v42
    v_permlane32_swap_b32 v31, v43
    v_smfmac_f32_16x16x64_bf16 v[44:47], v[64:67], v[184:191], v4
    v_add_f32 v28, v28, v40
    v_add_f32 v29, v29, v41
    ds_read_b128 v[64:67], v5 offset:8192
    s_waitcnt lgkmcnt(4)
    v_smfmac_f32_16x16x64_bf16 v[32:35], v[48:51], a[184:191], v4
    v_add_f32 v30, v30, v42
    v_add_f32 v31, v31, v43
    v_smfmac_f32_16x16x64_bf16 v[44:47], v[48:51], v[200:207], v4
    v_cvt_pk_bf16_f32 v40, v28, v29
    v_cvt_pk_bf16_f32 v41, v30, v31
    ds_read_b128 v[48:51], v5 offset:9216
    s_waitcnt lgkmcnt(4)
    v_smfmac_f32_16x16x64_bf16 v[32:35], v[52:55], a[192:199], v4
    v_mfma_f32_16x16x16_bf16 v[28:31], v[40:41], v[10:11], 0
    v_permlane32_swap_b32 v24, v36
    v_smfmac_f32_16x16x64_bf16 v[44:47], v[52:55], v[208:215], v4
    v_permlane32_swap_b32 v25, v37
    v_permlane32_swap_b32 v26, v38
    s_waitcnt lgkmcnt(3)
    v_smfmac_f32_16x16x64_bf16 v[32:35], v[56:59], a[200:207], v4
    v_permlane32_swap_b32 v27, v39
    v_add_f32 v24, v24, v36
    v_smfmac_f32_16x16x64_bf16 v[44:47], v[56:59], v[216:223], v4
    v_add_f32 v25, v25, v37
    v_add_f32 v26, v26, v38
    s_waitcnt lgkmcnt(2)
    v_smfmac_f32_16x16x64_bf16 v[32:35], v[60:63], a[216:223], v4
    v_add_f32 v27, v27, v39
    v_cvt_pk_bf16_f32 v36, v24, v25
    v_smfmac_f32_16x16x64_bf16 v[44:47], v[60:63], v[232:239], v4
    v_cvt_pk_bf16_f32 v37, v26, v27
    s_nop 1
    v_mfma_f32_16x16x16_bf16 v[24:27], v[36:37], v[10:11], 0
    s_waitcnt lgkmcnt(1)
    v_smfmac_f32_16x16x64_bf16 v[32:35], v[64:67], a[224:231], v4
    s_nop 5
    v_cvt_pk_bf16_f32 v24, v24, v25
    v_smfmac_f32_16x16x64_bf16 v[44:47], v[64:67], v[240:247], v4
    v_cvt_pk_bf16_f32 v25, v26, v27
    v_cvt_pk_bf16_f32 v26, v28, v29
    s_waitcnt lgkmcnt(0)
    v_smfmac_f32_16x16x64_bf16 v[32:35], v[48:51], a[232:239], v4
    v_cvt_pk_bf16_f32 v27, v30, v31
    s_waitcnt vmcnt(3)
    v_smfmac_f32_16x16x64_bf16 v[44:47], v[48:51], v[248:255], v4
    v_mfma_f32_16x16x32_bf16 v[28:31], a[240:243], v[24:27], 0
    v_mfma_f32_16x16x32_bf16 v[36:39], a[244:247], v[24:27], 0
    v_mfma_f32_16x16x32_bf16 v[40:43], v[24:27], v[24:27], 0
    s_nop 4
    v_permlane32_swap_b32 v32, v44
    v_permlane32_swap_b32 v33, v45
    v_permlane32_swap_b32 v34, v46
    v_permlane32_swap_b32 v35, v47
    v_add_f32 v32, v32, v44
    v_add_f32 v33, v33, v45
    v_add_f32 v34, v34, v46
    v_add_f32 v35, v35, v47
    v_cvt_pk_bf16_f32 v44, v32, v33
    v_cvt_pk_bf16_f32 v45, v34, v35
    s_nop 1
    v_mfma_f32_16x16x16_bf16 v[32:35], v[44:45], v[10:11], 0
    s_nop 7
    v_cvt_pk_bf16_f32 v32, v32, v33
    v_cvt_pk_bf16_f32 v33, v34, v35
    s_nop 1
    v_mfma_f32_16x16x16_bf16 v[28:31], a[248:249], v[32:33], v[28:31]
    v_mfma_f32_16x16x16_bf16 v[36:39], a[250:251], v[32:33], v[36:39]
    v_mfma_f32_16x16x16_bf16 v[40:43], v[32:33], v[32:33], v[40:43]
    s_nop 5
    ds_write_b128 v12, v[28:31]
    ds_write_b128 v12, v[36:39] offset:16
    ds_write_b128 v13, v[40:43]
    s_waitcnt lgkmcnt(0)
    s_barrier
    s_waitcnt vmcnt(0)
    v_mfma_f32_16x16x32_bf16 v[36:39], a[240:243], v[80:83], 0
    v_mfma_f32_16x16x32_bf16 v[44:47], a[244:247], v[80:83], 0
    v_mfma_f32_16x16x32_bf16 v[68:71], v[24:27], v[80:83], 0
    v_mfma_f32_16x16x32_bf16 v[40:43], a[240:243], v[84:87], 0
    v_mfma_f32_16x16x32_bf16 v[64:67], a[244:247], v[84:87], 0
    v_mfma_f32_16x16x32_bf16 v[72:75], v[24:27], v[84:87], 0
    s_nop 0
    v_mfma_f32_16x16x16_bf16 v[36:39], a[248:249], v[88:89], v[36:39]
    v_mfma_f32_16x16x16_bf16 v[44:47], a[250:251], v[88:89], v[44:47]
    v_mfma_f32_16x16x16_bf16 v[68:71], v[32:33], v[88:89], v[68:71]
    v_mfma_f32_16x16x16_bf16 v[40:43], a[248:249], v[90:91], v[40:43]
    v_mfma_f32_16x16x16_bf16 v[64:67], a[250:251], v[90:91], v[64:67]
    v_mfma_f32_16x16x16_bf16 v[72:75], v[32:33], v[90:91], v[72:75]
    s_nop 2
    ds_write_b128 v16, v[36:39] offset:0
    ds_write_b128 v16, v[44:47] offset:16
    ds_write_b128 v17, v[68:71]
    ds_write_b128 v16, v[40:43] offset:2816
    ds_write_b128 v16, v[64:67] offset:2832
    ds_write_b128 v18, v[72:75]
    s_add_u32 s40, s40, 1
    s_add_u32 s41, s41, 393216
    s_add_u32 s45, s45, 393216
    s_add_u32 s47, s37, 704512
    s_add_u32 s48, s37, 737280
    s_xor_b32 s42, s37, 0x2000
    s_lshl_b32 s24, s40, 12
    s_and_b32 s24, s24, 0x2000
    s_xor_b32 s24, s24, s36
    s_lshl_b32 s37, s40, 20
    s_add_u32 s37, s37, s24
    s_add_u32 s37, s37, 117440512
    s_add_u32 s43, s37, 655360
    s_add_u32 s49, s37, 753664
    s_waitcnt lgkmcnt(0)
    s_barrier
    s_cmp_lt_u32 s40, 64
    s_cbranch_scc1 interleave_layers__linear_attn_block__memory_aug_recurrent_mem_tr__prompt_kernel_s_stepw2
    s_branch interleave_layers__linear_attn_block__memory_aug_recurrent_mem_tr__prompt_kernel_s_end
interleave_layers__linear_attn_block__memory_aug_recurrent_mem_tr__prompt_kernel_s_stepw3:
    v_mov_b32 v24, 0
    v_mov_b32 v25, 0
    v_mov_b32 v26, 0
    v_mov_b32 v27, 0
    v_mov_b32 v28, 0
    v_mov_b32 v29, 0
    v_mov_b32 v30, 0
    v_mov_b32 v31, 0
    v_mov_b32 v32, 0
    v_mov_b32 v33, 0
    v_mov_b32 v34, 0
    v_mov_b32 v35, 0
    v_mov_b32 v36, 0
    v_mov_b32 v37, 0
    v_mov_b32 v38, 0
    v_mov_b32 v39, 0
    v_mov_b32 v40, 0
    v_mov_b32 v41, 0
    v_mov_b32 v42, 0
    v_mov_b32 v43, 0
    v_mov_b32 v44, 0
    v_mov_b32 v45, 0
    v_mov_b32 v46, 0
    v_mov_b32 v47, 0
    s_add_u32 s46, s47, 4096
    s_add_u32 s52, s47, 8192
    s_lshl_b32 s95, s92, 6
    s_add_u32 s95, s95, s40
    s_add_u32 s95, s95, 1
    s_cmp_ge_i32 s59, s95
    s_cbranch_scc1 interleave_layers__linear_attn_block__memory_aug_recurrent_mem_tr__prompt_kernel_s_ecw3_ok
    s_and_b32 s24, s2, 7
    s_lshl_b32 s24, s24, 7
    s_add_u32 s24, s24, 23109632
    v_and_b32 v49, 3, v1
    v_lshl_add_u32 v49, v49, 2, s24
    s_mov_b32 s61, 0
interleave_layers__linear_attn_block__memory_aug_recurrent_mem_tr__prompt_kernel_s_ecw3:
    buffer_load_dword v48, v49, s[8:11], 0 offen sc1
    s_waitcnt vmcnt(0)
    v_readlane_b32 s59, v48, 0
    v_readlane_b32 s24, v48, 1
    s_min_i32 s59, s59, s24
    v_readlane_b32 s24, v48, 2
    s_min_i32 s59, s59, s24
    s_cmp_ge_i32 s59, s95
    s_cbranch_scc1 interleave_layers__linear_attn_block__memory_aug_recurrent_mem_tr__prompt_kernel_s_ecw3_ok
    s_add_u32 s61, s61, 1
    s_cmp_ge_u32 s61, s60
    s_cbranch_scc1 interleave_layers__linear_attn_block__memory_aug_recurrent_mem_tr__prompt_kernel_s_ecw3_to
    s_sleep 2
    s_branch interleave_layers__linear_attn_block__memory_aug_recurrent_mem_tr__prompt_kernel_s_ecw3
interleave_layers__linear_attn_block__memory_aug_recurrent_mem_tr__prompt_kernel_s_ecw3_to:
    s_mov_b32 s60, 1
interleave_layers__linear_attn_block__memory_aug_recurrent_mem_tr__prompt_kernel_s_ecw3_ok:
    s_add_u32 s63, s40, 1
    s_cmp_ge_i32 s62, s63
    s_cbranch_scc1 interleave_layers__linear_attn_block__memory_aug_recurrent_mem_tr__prompt_kernel_s_enw3_ok
    s_mov_b32 s61, 0
interleave_layers__linear_attn_block__memory_aug_recurrent_mem_tr__prompt_kernel_s_enw3:
    buffer_load_dword v48, v9, s[8:11], 0 offen sc1
    s_waitcnt vmcnt(0)
    v_readlane_b32 s62, v48, 0
    v_readlane_b32 s24, v48, 1
    s_min_i32 s62, s62, s24
    s_cmp_ge_i32 s62, s63
    s_cbranch_scc1 interleave_layers__linear_attn_block__memory_aug_recurrent_mem_tr__prompt_kernel_s_enw3_ok
    s_add_u32 s61, s61, 1
    s_cmp_ge_u32 s61, s60
    s_cbranch_scc1 interleave_layers__linear_attn_block__memory_aug_recurrent_mem_tr__prompt_kernel_s_enw3_to
    s_sleep 2
    s_branch interleave_layers__linear_attn_block__memory_aug_recurrent_mem_tr__prompt_kernel_s_enw3
interleave_layers__linear_attn_block__memory_aug_recurrent_mem_tr__prompt_kernel_s_enw3_to:
    s_mov_b32 s60, 1
interleave_layers__linear_attn_block__memory_aug_recurrent_mem_tr__prompt_kernel_s_enw3_ok:
    buffer_load_dwordx4 a[240:243], v19, s[8:11], s41 offen offset:0 sc1
    buffer_load_dwordx4 a[244:247], v19, s[8:11], s41 offen offset:1024 sc1
    buffer_load_dwordx4 a[248:251], v19, s[8:11], s41 offen offset:2048 sc1
    s_sleep 5
    s_mov_b64 exec, 1
    s_mov_b32 s61, 0
    v_mov_b32 v83, 0
    buffer_atomic_add v83, v23, s[8:11], s48 offen sc0
    s_sleep 2
    v_mov_b32 v94, 0
    buffer_atomic_add v94, v23, s[8:11], s48 offen sc0
    s_sleep 2
    v_mov_b32 v95, 0
    buffer_atomic_add v95, v23, s[8:11], s48 offen sc0
    s_sleep 2
interleave_layers__linear_attn_block__memory_aug_recurrent_mem_tr__prompt_kernel_s_prw3:
    v_mov_b32 v82, 0
    buffer_atomic_add v82, v23, s[8:11], s48 offen sc0
    s_waitcnt vmcnt(3)
    v_cmp_le_i32 vcc, 9, v83
    s_add_u32 s61, s61, 1
    s_cbranch_vccnz interleave_layers__linear_attn_block__memory_aug_recurrent_mem_tr__prompt_kernel_s_prw3_out
    s_sleep 2
    v_mov_b32 v83, 0
    buffer_atomic_add v83, v23, s[8:11], s48 offen sc0
    s_waitcnt vmcnt(3)
    v_cmp_le_i32 vcc, 9, v94
    s_add_u32 s61, s61, 1
    s_cbranch_vccnz interleave_layers__linear_attn_block__memory_aug_recurrent_mem_tr__prompt_kernel_s_prw3_out
    s_sleep 2
    v_mov_b32 v94, 0
    buffer_atomic_add v94, v23, s[8:11], s48 offen sc0
    s_waitcnt vmcnt(3)
    v_cmp_le_i32 vcc, 9, v95
    s_add_u32 s61, s61, 1
    s_cbranch_vccnz interleave_layers__linear_attn_block__memory_aug_recurrent_mem_tr__prompt_kernel_s_prw3_out
    s_sleep 2
    v_mov_b32 v95, 0
    buffer_atomic_add v95, v23, s[8:11], s48 offen sc0
    s_waitcnt vmcnt(3)
    v_cmp_le_i32 vcc, 9, v82
    s_add_u32 s61, s61, 1
    s_cbranch_vccnz interleave_layers__linear_attn_block__memory_aug_recurrent_mem_tr__prompt_kernel_s_prw3_out
    s_sleep 2
    s_cmp_ge_u32 s61, s60
    s_cbranch_scc0 interleave_layers__linear_attn_block__memory_aug_recurrent_mem_tr__prompt_kernel_s_prw3
    s_mov_b32 s60, 1
interleave_layers__linear_attn_block__memory_aug_recurrent_mem_tr__prompt_kernel_s_prw3_out:
    s_mov_b64 exec, -1
    buffer_load_dwordx4 v[84:87], v7, s[8:11], s47 offen sc1
    buffer_load_dwordx4 v[88:91], v7, s[8:11], s46 offen sc1
    buffer_load_dwordx2 v[92:93], v8, s[8:11], s52 offen sc1
    ds_read_b128 v[48:51], v21 offset:0
    ds_read_b128 v[52:55], v21 offset:16
    ds_read_b128 v[56:59], v21 offset:5632
    ds_read_b128 v[60:63], v21 offset:5648
    ds_read_b128 v[64:67], v21 offset:11264
    ds_read_b128 v[68:71], v21 offset:11280
    ds_read_b128 v[72:75], v21 offset:16896
    ds_read_b128 v[76:79], v21 offset:16912
    s_waitcnt lgkmcnt(4)
    v_pk_add_f32 v[48:49], v[48:49], v[56:57]
    v_pk_add_f32 v[50:51], v[50:51], v[58:59]
    v_pk_add_f32 v[52:53], v[52:53], v[60:61]
    v_pk_add_f32 v[54:55], v[54:55], v[62:63]
    s_waitcnt lgkmcnt(0)
    v_pk_add_f32 v[64:65], v[64:65], v[72:73]
    v_pk_add_f32 v[66:67], v[66:67], v[74:75]
    v_pk_add_f32 v[68:69], v[68:69], v[76:77]
    v_pk_add_f32 v[70:71], v[70:71], v[78:79]
    v_pk_add_f32 v[48:49], v[48:49], v[64:65]
    v_pk_add_f32 v[50:51], v[50:51], v[66:67]
    v_pk_add_f32 v[52:53], v[52:53], v[68:69]
    v_pk_add_f32 v[54:55], v[54:55], v[70:71]
    v_mov_b32 v81, 0xff800000
    v_cndmask_b32 v48, v81, v48, s[64:65]
    v_cndmask_b32 v49, v81, v49, s[66:67]
    v_cndmask_b32 v50, v81, v50, s[68:69]
    v_cndmask_b32 v51, v81, v51, s[70:71]
    v_cndmask_b32 v52, v81, v52, s[72:73]
    v_cndmask_b32 v53, v81, v53, s[74:75]
    v_cndmask_b32 v54, v81, v54, s[76:77]
    v_cndmask_b32 v55, v81, v55, s[78:79]
    v_max3_f32 v80, v48, v49, v50
    v_max3_f32 v80, v80, v51, v52
    v_max3_f32 v80, v80, v53, v54
    v_max_f32 v80, v80, v55
    v_mov_b32 v81, 0xff800000
    v_cndmask_b32 v80, v81, v80, s[50:51]
    s_nop 1
    v_max_f32 v80, v80, v80 quad_perm:[1,0,3,2] row_mask:0xf bank_mask:0xf
    s_nop 1
    v_max_f32 v80, v80, v80 quad_perm:[2,3,0,1] row_mask:0xf bank_mask:0xf
    s_nop 1
    v_max_f32 v80, v80, v80 row_half_mirror row_mask:0xf bank_mask:0xf
    s_mov_b32 s24, 0x3dd53b95
    v_mul_f32 v80, s24, v80
    v_fma_f32 v48, v48, s24, -v80
    v_fma_f32 v49, v49, s24, -v80
    v_fma_f32 v50, v50, s24, -v80
    v_fma_f32 v51, v51, s24, -v80
    v_fma_f32 v52, v52, s24, -v80
    v_fma_f32 v53, v53, s24, -v80
    v_fma_f32 v54, v54, s24, -v80
    v_fma_f32 v55, v55, s24, -v80
    v_exp_f32 v48, v48
    v_exp_f32 v49, v49
    v_exp_f32 v50, v50
    v_exp_f32 v51, v51
    v_exp_f32 v52, v52
    v_exp_f32 v53, v53
    v_exp_f32 v54, v54
    v_exp_f32 v55, v55
    v_add_f32 v80, v48, v49
    v_add_f32 v81, v50, v51
    v_add_f32 v80, v80, v52
    v_add_f32 v81, v81, v53
    v_add_f32 v80, v80, v54
    v_add_f32 v81, v81, v55
    v_add_f32 v80, v80, v81
    v_cndmask_b32 v80, 0, v80, s[50:51]
    s_nop 1
    v_add_f32 v80, v80, v80 quad_perm:[1,0,3,2] row_mask:0xf bank_mask:0xf
    s_nop 1
    v_add_f32 v80, v80, v80 quad_perm:[2,3,0,1] row_mask:0xf bank_mask:0xf
    s_nop 1
    v_add_f32 v80, v80, v80 row_half_mirror row_mask:0xf bank_mask:0xf
    v_rcp_f32 v80, v80
    s_nop 0
    v_mul_f32 v48, v48, v80
    v_mul_f32 v49, v49, v80
    v_mul_f32 v50, v50, v80
    v_mul_f32 v51, v51, v80
    v_mul_f32 v52, v52, v80
    v_mul_f32 v53, v53, v80
    v_mul_f32 v54, v54, v80
    v_mul_f32 v55, v55, v80
    v_cvt_pk_bf16_f32 v56, v48, v49
    v_cvt_pk_bf16_f32 v57, v50, v51
    v_cvt_pk_bf16_f32 v58, v52, v53
    v_cvt_pk_bf16_f32 v59, v54, v55
    v_min_u32 v56, -2, v56
    v_min_u32 v57, -2, v57
    v_min_u32 v58, -2, v58
    v_min_u32 v59, -2, v59
    buffer_store_dwordx4 v[56:59], v22, s[8:11], s42 offen sc1
    s_waitcnt vmcnt(1)
    s_nop 0
    v_max3_u32 v58, v84, v85, v86
    v_max3_u32 v58, v58, v87, v88
    v_max3_u32 v58, v58, v89, v90
    v_max3_u32 v58, v58, v91, v92
    v_max_u32 v58, v58, v93
    v_cmp_eq_u32 vcc, -1, v58
    s_cbranch_vccz interleave_layers__linear_attn_block__memory_aug_recurrent_mem_tr__prompt_kernel_s_pmw3_out
    s_mov_b32 s61, 0
interleave_layers__linear_attn_block__memory_aug_recurrent_mem_tr__prompt_kernel_s_pmw3:
    buffer_load_dwordx4 v[84:87], v7, s[8:11], s47 offen sc1
    buffer_load_dwordx4 v[88:91], v7, s[8:11], s46 offen sc1
    buffer_load_dwordx2 v[92:93], v8, s[8:11], s52 offen sc1
    s_waitcnt vmcnt(0)
    v_max3_u32 v58, v84, v85, v86
    v_max3_u32 v58, v58, v87, v88
    v_max3_u32 v58, v58, v89, v90
    v_max3_u32 v58, v58, v91, v92
    v_max_u32 v58, v58, v93
    v_cmp_eq_u32 vcc, -1, v58
    s_add_u32 s61, s61, 1
    s_cbranch_vccz interleave_layers__linear_attn_block__memory_aug_recurrent_mem_tr__prompt_kernel_s_pmw3_out
    s_cmp_ge_u32 s61, s60
    s_cbranch_scc1 interleave_layers__linear_attn_block__memory_aug_recurrent_mem_tr__prompt_kernel_s_pmw3_to
    s_sleep 1
    s_branch interleave_layers__linear_attn_block__memory_aug_recurrent_mem_tr__prompt_kernel_s_pmw3
interleave_layers__linear_attn_block__memory_aug_recurrent_mem_tr__prompt_kernel_s_pmw3_to:
    s_mov_b32 s60, 1
interleave_layers__linear_attn_block__memory_aug_recurrent_mem_tr__prompt_kernel_s_pmw3_out:
    ds_write_b128 v7, v[84:87]
    ds_write_b128 v7, v[88:91] offset:4096
    ds_write_b64 v8, v[92:93]
interleave_layers__linear_attn_block__memory_aug_recurrent_mem_tr__prompt_kernel_s_gow3:
    ds_read_b128 v[68:71], v6 offset:6144
    ds_read_b128 v[72:75], v6 offset:7168
    ds_read_b128 v[76:79], v6 offset:14336
    ds_read_b128 v[80:83], v6 offset:15360
    v_smfmac_f32_16x16x64_bf16 v[24:27], v[84:87], a[24:31], v4
    v_smfmac_f32_16x16x64_bf16 v[28:31], v[84:87], a[104:111], v4
    v_smfmac_f32_16x16x64_bf16 v[32:35], v[84:87], a[184:191], v4
    v_smfmac_f32_16x16x64_bf16 v[40:43], v[84:87], v[120:127], v4
    v_smfmac_f32_16x16x64_bf16 v[44:47], v[84:87], v[200:207], v4
    s_waitcnt lgkmcnt(2)
    v_smfmac_f32_16x16x64_bf16 v[36:39], v[84:87], v[68:75], v4
    ds_read_b128 v[68:71], v6 offset:0
    ds_read_b128 v[72:75], v6 offset:1024
    s_barrier
    ds_read_b128 v[48:51], v5 offset:0
    ds_read_b128 v[52:55], v5 offset:1024
    ds_read_b128 v[56:59], v5 offset:2048
    ds_read_b128 v[60:63], v5 offset:4096
    ds_read_b128 v[64:67], v5 offset:5120
    v_smfmac_f32_16x16x64_bf16 v[24:27], v[88:91], a[56:63], v4
    v_smfmac_f32_16x16x64_bf16 v[28:31], v[88:91], a[136:143], v4
    v_smfmac_f32_16x16x64_bf16 v[32:35], v[88:91], a[216:223], v4
    v_smfmac_f32_16x16x64_bf16 v[40:43], v[88:91], v[152:159], v4
    v_smfmac_f32_16x16x64_bf16 v[44:47], v[88:91], v[232:239], v4
    s_waitcnt lgkmcnt(7)
    v_smfmac_f32_16x16x64_bf16 v[36:39], v[88:91], v[76:83], v4
    ds_read_b128 v[76:79], v6 offset:2048
    ds_read_b128 v[80:83], v6 offset:3072
    s_waitcnt lgkmcnt(6)
    v_smfmac_f32_16x16x64_bf16 v[24:27], v[48:51], a[0:7], v4
    v_smfmac_f32_16x16x64_bf16 v[28:31], v[48:51], a[80:87], v4
    v_smfmac_f32_16x16x64_bf16 v[40:43], v[48:51], v[96:103], v4
    v_smfmac_f32_16x16x64_bf16 v[36:39], v[48:51], v[68:75], v4
    ds_read_b128 v[68:71], v6 offset:4096
    ds_read_b128 v[72:75], v6 offset:5120
    ds_read_b128 v[48:51], v5 offset:6144
    s_waitcnt lgkmcnt(8)
    v_smfmac_f32_16x16x64_bf16 v[24:27], v[52:55], a[8:15], v4
    v_smfmac_f32_16x16x64_bf16 v[28:31], v[52:55], a[88:95], v4
    v_smfmac_f32_16x16x64_bf16 v[40:43], v[52:55], v[104:111], v4
    s_waitcnt lgkmcnt(3)
    v_smfmac_f32_16x16x64_bf16 v[36:39], v[52:55], v[76:83], v4
    ds_read_b128 v[76:79], v6 offset:8192
    ds_read_b128 v[80:83], v6 offset:9216
    ds_read_b128 v[52:55], v5 offset:8192
    v_smfmac_f32_16x16x64_bf16 v[24:27], v[56:59], a[16:23], v4
    v_smfmac_f32_16x16x64_bf16 v[28:31], v[56:59], a[96:103], v4
    v_smfmac_f32_16x16x64_bf16 v[40:43], v[56:59], v[112:119], v4
    s_waitcnt lgkmcnt(4)
    v_smfmac_f32_16x16x64_bf16 v[36:39], v[56:59], v[68:75], v4
    ds_read_b128 v[68:71], v6 offset:10240
    ds_read_b128 v[72:75], v6 offset:11264
    ds_read_b128 v[56:59], v5 offset:9216
    v_smfmac_f32_16x16x64_bf16 v[24:27], v[60:63], a[32:39], v4
    v_smfmac_f32_16x16x64_bf16 v[28:31], v[60:63], a[112:119], v4
    v_smfmac_f32_16x16x64_bf16 v[40:43], v[60:63], v[128:135], v4
    s_waitcnt lgkmcnt(4)
    v_smfmac_f32_16x16x64_bf16 v[36:39], v[60:63], v[76:83], v4
    ds_read_b128 v[76:79], v6 offset:12288
    ds_read_b128 v[80:83], v6 offset:13312
    ds_read_b128 v[60:63], v5 offset:0
    v_smfmac_f32_16x16x64_bf16 v[24:27], v[64:67], a[40:47], v4
    v_smfmac_f32_16x16x64_bf16 v[28:31], v[64:67], a[120:127], v4
    v_smfmac_f32_16x16x64_bf16 v[40:43], v[64:67], v[136:143], v4
    s_waitcnt lgkmcnt(4)
    v_smfmac_f32_16x16x64_bf16 v[36:39], v[64:67], v[68:75], v4
    ds_read_b128 v[68:71], v6 offset:16384
    ds_read_b128 v[72:75], v6 offset:17408
    ds_read_b128 v[64:67], v5 offset:1024
    v_smfmac_f32_16x16x64_bf16 v[24:27], v[48:51], a[48:55], v4
    v_smfmac_f32_16x16x64_bf16 v[28:31], v[48:51], a[128:135], v4
    v_smfmac_f32_16x16x64_bf16 v[40:43], v[48:51], v[144:151], v4
    s_waitcnt lgkmcnt(4)
    v_smfmac_f32_16x16x64_bf16 v[36:39], v[48:51], v[76:83], v4
    ds_read_b128 v[76:79], v6 offset:18432
    ds_read_b128 v[80:83], v6 offset:19456
    ds_read_b128 v[48:51], v5 offset:2048
    v_smfmac_f32_16x16x64_bf16 v[24:27], v[52:55], a[64:71], v4
    v_smfmac_f32_16x16x64_bf16 v[28:31], v[52:55], a[144:151], v4
    v_smfmac_f32_16x16x64_bf16 v[40:43], v[52:55], v[160:167], v4
    s_waitcnt lgkmcnt(4)
    v_smfmac_f32_16x16x64_bf16 v[36:39], v[52:55], v[68:75], v4
    ds_read_b128 v[52:55], v5 offset:4096
    v_smfmac_f32_16x16x64_bf16 v[24:27], v[56:59], a[72:79], v4
    v_smfmac_f32_16x16x64_bf16 v[28:31], v[56:59], a[152:159], v4
    v_smfmac_f32_16x16x64_bf16 v[40:43], v[56:59], v[168:175], v4
    s_waitcnt lgkmcnt(2)
    v_smfmac_f32_16x16x64_bf16 v[36:39], v[56:59], v[76:83], v4
    ds_read_b128 v[56:59], v5 offset:5120
    buffer_load_dwordx4 v[80:83], v19, s[8:11], s45 offen offset:0 sc1
    buffer_load_dwordx4 v[84:87], v19, s[8:11], s45 offen offset:1024 sc1
    buffer_load_dwordx4 v[88:91], v19, s[8:11], s45 offen offset:2048 sc1
    v_smfmac_f32_16x16x64_bf16 v[32:35], v[60:63], a[160:167], v4
    v_smfmac_f32_16x16x64_bf16 v[44:47], v[60:63], v[176:183], v4
    v_permlane32_swap_b32 v28, v40
    v_permlane32_swap_b32 v29, v41
    ds_read_b128 v[60:63], v5 offset:6144
    v_smfmac_f32_16x16x64_bf16 v[32:35], v[64:67], a[168:175], v4
    v_permlane32_swap_b32 v30, v42
    v_permlane32_swap_b32 v31, v43
    v_smfmac_f32_16x16x64_bf16 v[44:47], v[64:67], v[184:191], v4
    v_add_f32 v28, v28, v40
    v_add_f32 v29, v29, v41
    ds_read_b128 v[64:67], v5 offset:8192
    s_waitcnt lgkmcnt(4)
    v_smfmac_f32_16x16x64_bf16 v[32:35], v[48:51], a[176:183], v4
    v_add_f32 v30, v30, v42
    v_add_f32 v31, v31, v43
    v_smfmac_f32_16x16x64_bf16 v[44:47], v[48:51], v[192:199], v4
    v_cvt_pk_bf16_f32 v40, v28, v29
    v_cvt_pk_bf16_f32 v41, v30, v31
    ds_read_b128 v[48:51], v5 offset:9216
    s_waitcnt lgkmcnt(4)
    v_smfmac_f32_16x16x64_bf16 v[32:35], v[52:55], a[192:199], v4
    v_mfma_f32_16x16x16_bf16 v[28:31], v[40:41], v[10:11], 0
    v_permlane32_swap_b32 v24, v36
    v_smfmac_f32_16x16x64_bf16 v[44:47], v[52:55], v[208:215], v4
    v_permlane32_swap_b32 v25, v37
    v_permlane32_swap_b32 v26, v38
    s_waitcnt lgkmcnt(3)
    v_smfmac_f32_16x16x64_bf16 v[32:35], v[56:59], a[200:207], v4
    v_permlane32_swap_b32 v27, v39
    v_add_f32 v24, v24, v36
    v_smfmac_f32_16x16x64_bf16 v[44:47], v[56:59], v[216:223], v4
    v_add_f32 v25, v25, v37
    v_add_f32 v26, v26, v38
    s_waitcnt lgkmcnt(2)
    v_smfmac_f32_16x16x64_bf16 v[32:35], v[60:63], a[208:215], v4
    v_add_f32 v27, v27, v39
    v_cvt_pk_bf16_f32 v36, v24, v25
    v_smfmac_f32_16x16x64_bf16 v[44:47], v[60:63], v[224:231], v4
    v_cvt_pk_bf16_f32 v37, v26, v27
    s_nop 1
    v_mfma_f32_16x16x16_bf16 v[24:27], v[36:37], v[10:11], 0
    s_waitcnt lgkmcnt(1)
    v_smfmac_f32_16x16x64_bf16 v[32:35], v[64:67], a[224:231], v4
    s_nop 5
    v_cvt_pk_bf16_f32 v24, v24, v25
    v_smfmac_f32_16x16x64_bf16 v[44:47], v[64:67], v[240:247], v4
    v_cvt_pk_bf16_f32 v25, v26, v27
    v_cvt_pk_bf16_f32 v26, v28, v29
    s_waitcnt lgkmcnt(0)
    v_smfmac_f32_16x16x64_bf16 v[32:35], v[48:51], a[232:239], v4
    v_cvt_pk_bf16_f32 v27, v30, v31
    s_waitcnt vmcnt(3)
    v_smfmac_f32_16x16x64_bf16 v[44:47], v[48:51], v[248:255], v4
    v_mfma_f32_16x16x32_bf16 v[28:31], a[240:243], v[24:27], 0
    v_mfma_f32_16x16x32_bf16 v[36:39], a[244:247], v[24:27], 0
    v_mfma_f32_16x16x32_bf16 v[40:43], v[24:27], v[24:27], 0
    s_nop 4
    v_permlane32_swap_b32 v32, v44
    v_permlane32_swap_b32 v33, v45
    v_permlane32_swap_b32 v34, v46
    v_permlane32_swap_b32 v35, v47
    v_add_f32 v32, v32, v44
    v_add_f32 v33, v33, v45
    v_add_f32 v34, v34, v46
    v_add_f32 v35, v35, v47
    v_cvt_pk_bf16_f32 v44, v32, v33
    v_cvt_pk_bf16_f32 v45, v34, v35
    s_nop 1
    v_mfma_f32_16x16x16_bf16 v[32:35], v[44:45], v[10:11], 0
    s_nop 7
    v_cvt_pk_bf16_f32 v32, v32, v33
    v_cvt_pk_bf16_f32 v33, v34, v35
    s_nop 1
    v_mfma_f32_16x16x16_bf16 v[28:31], a[248:249], v[32:33], v[28:31]
    v_mfma_f32_16x16x16_bf16 v[36:39], a[250:251], v[32:33], v[36:39]
    v_mfma_f32_16x16x16_bf16 v[40:43], v[32:33], v[32:33], v[40:43]
    s_nop 5
    ds_write_b128 v12, v[28:31]
    ds_write_b128 v12, v[36:39] offset:16
    ds_write_b128 v13, v[40:43]
    s_waitcnt lgkmcnt(0)
    s_barrier
    s_waitcnt vmcnt(0)
    v_mfma_f32_16x16x32_bf16 v[36:39], a[240:243], v[80:83], 0
    v_mfma_f32_16x16x32_bf16 v[44:47], a[244:247], v[80:83], 0
    v_mfma_f32_16x16x32_bf16 v[68:71], v[24:27], v[80:83], 0
    v_mfma_f32_16x16x32_bf16 v[40:43], a[240:243], v[84:87], 0
    v_mfma_f32_16x16x32_bf16 v[64:67], a[244:247], v[84:87], 0
    v_mfma_f32_16x16x32_bf16 v[72:75], v[24:27], v[84:87], 0
    s_nop 0
    v_mfma_f32_16x16x16_bf16 v[36:39], a[248:249], v[88:89], v[36:39]
    v_mfma_f32_16x16x16_bf16 v[44:47], a[250:251], v[88:89], v[44:47]
    v_mfma_f32_16x16x16_bf16 v[68:71], v[32:33], v[88:89], v[68:71]
    v_mfma_f32_16x16x16_bf16 v[40:43], a[248:249], v[90:91], v[40:43]
    v_mfma_f32_16x16x16_bf16 v[64:67], a[250:251], v[90:91], v[64:67]
    v_mfma_f32_16x16x16_bf16 v[72:75], v[32:33], v[90:91], v[72:75]
    s_nop 2
    ds_write_b128 v16, v[36:39] offset:0
    ds_write_b128 v16, v[44:47] offset:16
    ds_write_b128 v17, v[68:71]
    ds_write_b128 v16, v[40:43] offset:2816
    ds_write_b128 v16, v[64:67] offset:2832
    ds_write_b128 v18, v[72:75]
    s_add_u32 s40, s40, 1
    s_add_u32 s41, s41, 393216
    s_add_u32 s45, s45, 393216
    s_add_u32 s47, s37, 704512
    s_add_u32 s48, s37, 737280
    s_xor_b32 s42, s37, 0x2000
    s_lshl_b32 s24, s40, 12
    s_and_b32 s24, s24, 0x2000
    s_xor_b32 s24, s24, s36
    s_lshl_b32 s37, s40, 20
    s_add_u32 s37, s37, s24
    s_add_u32 s37, s37, 117440512
    s_add_u32 s43, s37, 655360
    s_add_u32 s49, s37, 753664
    s_waitcnt lgkmcnt(0)
    s_barrier
    s_cmp_lt_u32 s40, 64
    s_cbranch_scc1 interleave_layers__linear_attn_block__memory_aug_recurrent_mem_tr__prompt_kernel_s_stepw3
interleave_layers__linear_attn_block__memory_aug_recurrent_mem_tr__prompt_kernel_s_end:
    ds_read_b128 v[48:51], v21 offset:0
    ds_read_b128 v[52:55], v21 offset:16
    ds_read_b128 v[56:59], v21 offset:5632
    ds_read_b128 v[60:63], v21 offset:5648
    ds_read_b128 v[64:67], v21 offset:11264
    ds_read_b128 v[68:71], v21 offset:11280
    ds_read_b128 v[72:75], v21 offset:16896
    ds_read_b128 v[76:79], v21 offset:16912
    s_waitcnt lgkmcnt(4)
    v_pk_add_f32 v[48:49], v[48:49], v[56:57]
    v_pk_add_f32 v[50:51], v[50:51], v[58:59]
    v_pk_add_f32 v[52:53], v[52:53], v[60:61]
    v_pk_add_f32 v[54:55], v[54:55], v[62:63]
    s_waitcnt lgkmcnt(0)
    v_pk_add_f32 v[64:65], v[64:65], v[72:73]
    v_pk_add_f32 v[66:67], v[66:67], v[74:75]
    v_pk_add_f32 v[68:69], v[68:69], v[76:77]
    v_pk_add_f32 v[70:71], v[70:71], v[78:79]
    v_pk_add_f32 v[48:49], v[48:49], v[64:65]
    v_pk_add_f32 v[50:51], v[50:51], v[66:67]
    v_pk_add_f32 v[52:53], v[52:53], v[68:69]
    v_pk_add_f32 v[54:55], v[54:55], v[70:71]
    v_mov_b32 v81, 0xff800000
    v_cndmask_b32 v48, v81, v48, s[64:65]
    v_cndmask_b32 v49, v81, v49, s[66:67]
    v_cndmask_b32 v50, v81, v50, s[68:69]
    v_cndmask_b32 v51, v81, v51, s[70:71]
    v_cndmask_b32 v52, v81, v52, s[72:73]
    v_cndmask_b32 v53, v81, v53, s[74:75]
    v_cndmask_b32 v54, v81, v54, s[76:77]
    v_cndmask_b32 v55, v81, v55, s[78:79]
    v_max3_f32 v80, v48, v49, v50
    v_max3_f32 v80, v80, v51, v52
    v_max3_f32 v80, v80, v53, v54
    v_max_f32 v80, v80, v55
    v_mov_b32 v81, 0xff800000
    v_cndmask_b32 v80, v81, v80, s[50:51]
    s_nop 1
    v_max_f32 v80, v80, v80 quad_perm:[1,0,3,2] row_mask:0xf bank_mask:0xf
    s_nop 1
    v_max_f32 v80, v80, v80 quad_perm:[2,3,0,1] row_mask:0xf bank_mask:0xf
    s_nop 1
    v_max_f32 v80, v80, v80 row_half_mirror row_mask:0xf bank_mask:0xf
    s_mov_b32 s24, 0x3dd53b95
    v_mul_f32 v80, s24, v80
    v_fma_f32 v48, v48, s24, -v80
    v_fma_f32 v49, v49, s24, -v80
    v_fma_f32 v50, v50, s24, -v80
    v_fma_f32 v51, v51, s24, -v80
    v_fma_f32 v52, v52, s24, -v80
    v_fma_f32 v53, v53, s24, -v80
    v_fma_f32 v54, v54, s24, -v80
    v_fma_f32 v55, v55, s24, -v80
    v_exp_f32 v48, v48
    v_exp_f32 v49, v49
    v_exp_f32 v50, v50
    v_exp_f32 v51, v51
    v_exp_f32 v52, v52
    v_exp_f32 v53, v53
    v_exp_f32 v54, v54
    v_exp_f32 v55, v55
    v_add_f32 v80, v48, v49
    v_add_f32 v81, v50, v51
    v_add_f32 v80, v80, v52
    v_add_f32 v81, v81, v53
    v_add_f32 v80, v80, v54
    v_add_f32 v81, v81, v55
    v_add_f32 v80, v80, v81
    v_cndmask_b32 v80, 0, v80, s[50:51]
    s_nop 1
    v_add_f32 v80, v80, v80 quad_perm:[1,0,3,2] row_mask:0xf bank_mask:0xf
    s_nop 1
    v_add_f32 v80, v80, v80 quad_perm:[2,3,0,1] row_mask:0xf bank_mask:0xf
    s_nop 1
    v_add_f32 v80, v80, v80 row_half_mirror row_mask:0xf bank_mask:0xf
    v_rcp_f32 v80, v80
    s_nop 0
    v_mul_f32 v48, v48, v80
    v_mul_f32 v49, v49, v80
    v_mul_f32 v50, v50, v80
    v_mul_f32 v51, v51, v80
    v_mul_f32 v52, v52, v80
    v_mul_f32 v53, v53, v80
    v_mul_f32 v54, v54, v80
    v_mul_f32 v55, v55, v80
    v_cvt_pk_bf16_f32 v56, v48, v49
    v_cvt_pk_bf16_f32 v57, v50, v51
    v_cvt_pk_bf16_f32 v58, v52, v53
    v_cvt_pk_bf16_f32 v59, v54, v55
    v_min_u32 v56, -2, v56
    v_min_u32 v57, -2, v57
    v_min_u32 v58, -2, v58
    v_min_u32 v59, -2, v59
    buffer_store_dwordx4 v[56:59], v22, s[8:11], s42 offen sc1
    s_cmp_eq_u32 s92, 0
    s_cbranch_scc0 interleave_layers__linear_attn_block__memory_aug_recurrent_mem_tr__prompt_kernel_end
    s_mov_b32 s92, 1
    s_branch interleave_layers__linear_attn_block__memory_aug_recurrent_mem_tr__prompt_kernel_s_layer
interleave_layers__linear_attn_block__memory_aug_recurrent_mem_tr__prompt_kernel_roleV:
    s_sub_u32 s44, s2, 32
    s_load_dwordx2 s[6:7], s[0:1], 56
    s_load_dwordx2 s[24:25], s[0:1], 64
    s_load_dwordx2 s[26:27], s[0:1], 32
    s_waitcnt lgkmcnt(0)
    s_mov_b32 s12, s6
    s_mov_b32 s13, s7
    s_mov_b32 s14, 7864320
    s_mov_b32 s15, 0x00020000
    s_mov_b32 s16, s24
    s_mov_b32 s17, s25
    s_mov_b32 s18, 7864320
    s_mov_b32 s19, 0x00020000
    s_mov_b32 s20, s26
    s_mov_b32 s21, s27
    s_mov_b32 s22, 10240
    s_mov_b32 s23, 0x00020000
    v_add_u32 v16, 0, v0
    s_mov_b32 s24, 683
    v_mul_lo_u32 v17, v16, s24
    v_lshrrev_b32 v17, 14, v17
    v_mul_u32_u24 v18, 24, v17
    v_sub_u32 v18, v16, v18
    s_mov_b32 s24, 12288
    v_mul_lo_u32 v4, v17, s24
    v_lshl_add_u32 v4, v18, 4, v4
    v_mul_u32_u24 v10, 400, v17
    v_lshl_add_u32 v10, v18, 4, v10
    v_add_u32 v10, 90112, v10
    v_add_u32 v16, 256, v0
    s_mov_b32 s24, 683
    v_mul_lo_u32 v17, v16, s24
    v_lshrrev_b32 v17, 14, v17
    v_mul_u32_u24 v18, 24, v17
    v_sub_u32 v18, v16, v18
    s_mov_b32 s24, 12288
    v_mul_lo_u32 v5, v17, s24
    v_lshl_add_u32 v5, v18, 4, v5
    v_mul_u32_u24 v11, 400, v17
    v_lshl_add_u32 v11, v18, 4, v11
    v_add_u32 v11, 90112, v11
    v_add_u32 v16, 512, v0
    s_mov_b32 s24, 683
    v_mul_lo_u32 v17, v16, s24
    v_lshrrev_b32 v17, 14, v17
    v_mul_u32_u24 v18, 24, v17
    v_sub_u32 v18, v16, v18
    s_mov_b32 s24, 12288
    v_mul_lo_u32 v6, v17, s24
    v_lshl_add_u32 v6, v18, 4, v6
    v_mul_u32_u24 v12, 400, v17
    v_lshl_add_u32 v12, v18, 4, v12
    v_add_u32 v12, 90112, v12
    v_add_u32 v16, 768, v0
    s_mov_b32 s24, 683
    v_mul_lo_u32 v17, v16, s24
    v_lshrrev_b32 v17, 14, v17
    v_mul_u32_u24 v18, 24, v17
    v_sub_u32 v18, v16, v18
    s_mov_b32 s24, 12288
    v_mul_lo_u32 v7, v17, s24
    v_lshl_add_u32 v7, v18, 4, v7
    v_mul_u32_u24 v13, 400, v17
    v_lshl_add_u32 v13, v18, 4, v13
    v_add_u32 v13, 90112, v13
    v_add_u32 v16, 1024, v0
    s_mov_b32 s24, 683
    v_mul_lo_u32 v17, v16, s24
    v_lshrrev_b32 v17, 14, v17
    v_mul_u32_u24 v18, 24, v17
    v_sub_u32 v18, v16, v18
    s_mov_b32 s24, 12288
    v_mul_lo_u32 v8, v17, s24
    v_lshl_add_u32 v8, v18, 4, v8
    v_mul_u32_u24 v14, 400, v17
    v_lshl_add_u32 v14, v18, 4, v14
    v_add_u32 v14, 90112, v14
    v_add_u32 v16, 1280, v0
    s_mov_b32 s24, 683
    v_mul_lo_u32 v17, v16, s24
    v_lshrrev_b32 v17, 14, v17
    v_mul_u32_u24 v18, 24, v17
    v_sub_u32 v18, v16, v18
    s_mov_b32 s24, 12288
    v_mul_lo_u32 v9, v17, s24
    v_lshl_add_u32 v9, v18, 4, v9
    v_mul_u32_u24 v15, 400, v17
    v_lshl_add_u32 v15, v18, 4, v15
    v_add_u32 v15, 90112, v15
    v_lshrrev_b32 v17, 1, v3
    v_lshlrev_b32 v17, 4, v17
    v_and_b32 v18, 1, v3
    v_lshl_add_u32 v17, v18, 2, v17
    v_lshrrev_b32 v18, 2, v2
    v_and_b32 v19, 1, v18
    v_add_u32 v17, v17, v19
    v_lshrrev_b32 v18, 1, v18
    v_lshl_add_u32 v17, v18, 3, v17
    v_mul_u32_u24 v16, 400, v17
    v_and_b32 v18, 3, v2
    v_lshl_add_u32 v16, v18, 3, v16
    v_add_u32 v16, 90112, v16
    s_mul_i32 s24, s3, 96
    v_add_u32 v16, s24, v16
    s_mul_i32 s45, s44, 384
    s_add_u32 s46, s45, 0
    buffer_load_dwordx4 v[24:27], v4, s[12:15], s46 offen
    buffer_load_dwordx4 v[28:31], v5, s[12:15], s46 offen
    buffer_load_dwordx4 v[32:35], v6, s[12:15], s46 offen
    buffer_load_dwordx4 v[36:39], v7, s[12:15], s46 offen
    buffer_load_dwordx4 v[40:43], v8, s[12:15], s46 offen
    buffer_load_dwordx4 v[44:47], v9, s[12:15], s46 offen
    s_add_u32 s46, s45, 786432
    buffer_load_dwordx4 v[48:51], v4, s[12:15], s46 offen
    buffer_load_dwordx4 v[52:55], v5, s[12:15], s46 offen
    buffer_load_dwordx4 v[56:59], v6, s[12:15], s46 offen
    buffer_load_dwordx4 v[60:63], v7, s[12:15], s46 offen
    buffer_load_dwordx4 v[64:67], v8, s[12:15], s46 offen
    buffer_load_dwordx4 v[68:71], v9, s[12:15], s46 offen
    s_waitcnt vmcnt(6)
    ds_write_b128 v10, v[24:27]
    ds_write_b128 v11, v[28:31]
    ds_write_b128 v12, v[32:35]
    ds_write_b128 v13, v[36:39]
    ds_write_b128 v14, v[40:43]
    ds_write_b128 v15, v[44:47]
    s_add_u32 s46, s45, 1572864
    buffer_load_dwordx4 v[72:75], v4, s[12:15], s46 offen
    buffer_load_dwordx4 v[76:79], v5, s[12:15], s46 offen
    buffer_load_dwordx4 v[80:83], v6, s[12:15], s46 offen
    buffer_load_dwordx4 v[84:87], v7, s[12:15], s46 offen
    buffer_load_dwordx4 v[88:91], v8, s[12:15], s46 offen
    buffer_load_dwordx4 v[92:95], v9, s[12:15], s46 offen
    s_waitcnt lgkmcnt(0)
    s_barrier
    ds_read_b64_tr_b16 a[0:1], v16 offset:0
    ds_read_b64_tr_b16 a[2:3], v16 offset:800
    ds_read_b64_tr_b16 a[4:5], v16 offset:12800
    ds_read_b64_tr_b16 a[6:7], v16 offset:13600
    ds_read_b64_tr_b16 a[80:81], v16 offset:32
    ds_read_b64_tr_b16 a[82:83], v16 offset:832
    ds_read_b64_tr_b16 a[84:85], v16 offset:12832
    ds_read_b64_tr_b16 a[86:87], v16 offset:13632
    ds_read_b64_tr_b16 a[160:161], v16 offset:64
    ds_read_b64_tr_b16 a[162:163], v16 offset:864
    ds_read_b64_tr_b16 a[164:165], v16 offset:12864
    ds_read_b64_tr_b16 a[166:167], v16 offset:13664
    s_waitcnt lgkmcnt(0)
    s_barrier
    s_waitcnt vmcnt(6)
    ds_write_b128 v10, v[48:51]
    ds_write_b128 v11, v[52:55]
    ds_write_b128 v12, v[56:59]
    ds_write_b128 v13, v[60:63]
    ds_write_b128 v14, v[64:67]
    ds_write_b128 v15, v[68:71]
    s_add_u32 s46, s45, 2359296
    buffer_load_dwordx4 v[24:27], v4, s[12:15], s46 offen
    buffer_load_dwordx4 v[28:31], v5, s[12:15], s46 offen
    buffer_load_dwordx4 v[32:35], v6, s[12:15], s46 offen
    buffer_load_dwordx4 v[36:39], v7, s[12:15], s46 offen
    buffer_load_dwordx4 v[40:43], v8, s[12:15], s46 offen
    buffer_load_dwordx4 v[44:47], v9, s[12:15], s46 offen
    s_waitcnt lgkmcnt(0)
    s_barrier
    ds_read_b64_tr_b16 a[8:9], v16 offset:0
    ds_read_b64_tr_b16 a[10:11], v16 offset:800
    ds_read_b64_tr_b16 a[12:13], v16 offset:12800
    ds_read_b64_tr_b16 a[14:15], v16 offset:13600
    ds_read_b64_tr_b16 a[88:89], v16 offset:32
    ds_read_b64_tr_b16 a[90:91], v16 offset:832
    ds_read_b64_tr_b16 a[92:93], v16 offset:12832
    ds_read_b64_tr_b16 a[94:95], v16 offset:13632
    ds_read_b64_tr_b16 a[168:169], v16 offset:64
    ds_read_b64_tr_b16 a[170:171], v16 offset:864
    ds_read_b64_tr_b16 a[172:173], v16 offset:12864
    ds_read_b64_tr_b16 a[174:175], v16 offset:13664
    s_waitcnt lgkmcnt(0)
    s_barrier
    s_waitcnt vmcnt(6)
    ds_write_b128 v10, v[72:75]
    ds_write_b128 v11, v[76:79]
    ds_write_b128 v12, v[80:83]
    ds_write_b128 v13, v[84:87]
    ds_write_b128 v14, v[88:91]
    ds_write_b128 v15, v[92:95]
    s_add_u32 s46, s45, 3145728
    buffer_load_dwordx4 v[48:51], v4, s[12:15], s46 offen
    buffer_load_dwordx4 v[52:55], v5, s[12:15], s46 offen
    buffer_load_dwordx4 v[56:59], v6, s[12:15], s46 offen
    buffer_load_dwordx4 v[60:63], v7, s[12:15], s46 offen
    buffer_load_dwordx4 v[64:67], v8, s[12:15], s46 offen
    buffer_load_dwordx4 v[68:71], v9, s[12:15], s46 offen
    s_waitcnt lgkmcnt(0)
    s_barrier
    ds_read_b64_tr_b16 a[16:17], v16 offset:0
    ds_read_b64_tr_b16 a[18:19], v16 offset:800
    ds_read_b64_tr_b16 a[20:21], v16 offset:12800
    ds_read_b64_tr_b16 a[22:23], v16 offset:13600
    ds_read_b64_tr_b16 a[96:97], v16 offset:32
    ds_read_b64_tr_b16 a[98:99], v16 offset:832
    ds_read_b64_tr_b16 a[100:101], v16 offset:12832
    ds_read_b64_tr_b16 a[102:103], v16 offset:13632
    ds_read_b64_tr_b16 a[176:177], v16 offset:64
    ds_read_b64_tr_b16 a[178:179], v16 offset:864
    ds_read_b64_tr_b16 a[180:181], v16 offset:12864
    ds_read_b64_tr_b16 a[182:183], v16 offset:13664
    s_waitcnt lgkmcnt(0)
    s_barrier
    s_waitcnt vmcnt(6)
    ds_write_b128 v10, v[24:27]
    ds_write_b128 v11, v[28:31]
    ds_write_b128 v12, v[32:35]
    ds_write_b128 v13, v[36:39]
    ds_write_b128 v14, v[40:43]
    ds_write_b128 v15, v[44:47]
    s_add_u32 s46, s45, 3932160
    buffer_load_dwordx4 v[72:75], v4, s[12:15], s46 offen
    buffer_load_dwordx4 v[76:79], v5, s[12:15], s46 offen
    buffer_load_dwordx4 v[80:83], v6, s[12:15], s46 offen
    buffer_load_dwordx4 v[84:87], v7, s[12:15], s46 offen
    buffer_load_dwordx4 v[88:91], v8, s[12:15], s46 offen
    buffer_load_dwordx4 v[92:95], v9, s[12:15], s46 offen
    s_waitcnt lgkmcnt(0)
    s_barrier
    ds_read_b64_tr_b16 a[24:25], v16 offset:0
    ds_read_b64_tr_b16 a[26:27], v16 offset:800
    ds_read_b64_tr_b16 a[28:29], v16 offset:12800
    ds_read_b64_tr_b16 a[30:31], v16 offset:13600
    ds_read_b64_tr_b16 a[104:105], v16 offset:32
    ds_read_b64_tr_b16 a[106:107], v16 offset:832
    ds_read_b64_tr_b16 a[108:109], v16 offset:12832
    ds_read_b64_tr_b16 a[110:111], v16 offset:13632
    ds_read_b64_tr_b16 a[184:185], v16 offset:64
    ds_read_b64_tr_b16 a[186:187], v16 offset:864
    ds_read_b64_tr_b16 a[188:189], v16 offset:12864
    ds_read_b64_tr_b16 a[190:191], v16 offset:13664
    s_waitcnt lgkmcnt(0)
    s_barrier
    s_waitcnt vmcnt(6)
    ds_write_b128 v10, v[48:51]
    ds_write_b128 v11, v[52:55]
    ds_write_b128 v12, v[56:59]
    ds_write_b128 v13, v[60:63]
    ds_write_b128 v14, v[64:67]
    ds_write_b128 v15, v[68:71]
    s_add_u32 s46, s45, 4718592
    buffer_load_dwordx4 v[24:27], v4, s[12:15], s46 offen
    buffer_load_dwordx4 v[28:31], v5, s[12:15], s46 offen
    buffer_load_dwordx4 v[32:35], v6, s[12:15], s46 offen
    buffer_load_dwordx4 v[36:39], v7, s[12:15], s46 offen
    buffer_load_dwordx4 v[40:43], v8, s[12:15], s46 offen
    buffer_load_dwordx4 v[44:47], v9, s[12:15], s46 offen
    s_waitcnt lgkmcnt(0)
    s_barrier
    ds_read_b64_tr_b16 a[32:33], v16 offset:0
    ds_read_b64_tr_b16 a[34:35], v16 offset:800
    ds_read_b64_tr_b16 a[36:37], v16 offset:12800
    ds_read_b64_tr_b16 a[38:39], v16 offset:13600
    ds_read_b64_tr_b16 a[112:113], v16 offset:32
    ds_read_b64_tr_b16 a[114:115], v16 offset:832
    ds_read_b64_tr_b16 a[116:117], v16 offset:12832
    ds_read_b64_tr_b16 a[118:119], v16 offset:13632
    ds_read_b64_tr_b16 a[192:193], v16 offset:64
    ds_read_b64_tr_b16 a[194:195], v16 offset:864
    ds_read_b64_tr_b16 a[196:197], v16 offset:12864
    ds_read_b64_tr_b16 a[198:199], v16 offset:13664
    s_waitcnt lgkmcnt(0)
    s_barrier
    s_waitcnt vmcnt(6)
    ds_write_b128 v10, v[72:75]
    ds_write_b128 v11, v[76:79]
    ds_write_b128 v12, v[80:83]
    ds_write_b128 v13, v[84:87]
    ds_write_b128 v14, v[88:91]
    ds_write_b128 v15, v[92:95]
    s_add_u32 s46, s45, 5505024
    buffer_load_dwordx4 v[48:51], v4, s[12:15], s46 offen
    buffer_load_dwordx4 v[52:55], v5, s[12:15], s46 offen
    buffer_load_dwordx4 v[56:59], v6, s[12:15], s46 offen
    buffer_load_dwordx4 v[60:63], v7, s[12:15], s46 offen
    buffer_load_dwordx4 v[64:67], v8, s[12:15], s46 offen
    buffer_load_dwordx4 v[68:71], v9, s[12:15], s46 offen
    s_waitcnt lgkmcnt(0)
    s_barrier
    ds_read_b64_tr_b16 a[40:41], v16 offset:0
    ds_read_b64_tr_b16 a[42:43], v16 offset:800
    ds_read_b64_tr_b16 a[44:45], v16 offset:12800
    ds_read_b64_tr_b16 a[46:47], v16 offset:13600
    ds_read_b64_tr_b16 a[120:121], v16 offset:32
    ds_read_b64_tr_b16 a[122:123], v16 offset:832
    ds_read_b64_tr_b16 a[124:125], v16 offset:12832
    ds_read_b64_tr_b16 a[126:127], v16 offset:13632
    ds_read_b64_tr_b16 a[200:201], v16 offset:64
    ds_read_b64_tr_b16 a[202:203], v16 offset:864
    ds_read_b64_tr_b16 a[204:205], v16 offset:12864
    ds_read_b64_tr_b16 a[206:207], v16 offset:13664
    s_waitcnt lgkmcnt(0)
    s_barrier
    s_waitcnt vmcnt(6)
    ds_write_b128 v10, v[24:27]
    ds_write_b128 v11, v[28:31]
    ds_write_b128 v12, v[32:35]
    ds_write_b128 v13, v[36:39]
    ds_write_b128 v14, v[40:43]
    ds_write_b128 v15, v[44:47]
    s_add_u32 s46, s45, 6291456
    buffer_load_dwordx4 v[72:75], v4, s[12:15], s46 offen
    buffer_load_dwordx4 v[76:79], v5, s[12:15], s46 offen
    buffer_load_dwordx4 v[80:83], v6, s[12:15], s46 offen
    buffer_load_dwordx4 v[84:87], v7, s[12:15], s46 offen
    buffer_load_dwordx4 v[88:91], v8, s[12:15], s46 offen
    buffer_load_dwordx4 v[92:95], v9, s[12:15], s46 offen
    s_waitcnt lgkmcnt(0)
    s_barrier
    ds_read_b64_tr_b16 a[48:49], v16 offset:0
    ds_read_b64_tr_b16 a[50:51], v16 offset:800
    ds_read_b64_tr_b16 a[52:53], v16 offset:12800
    ds_read_b64_tr_b16 a[54:55], v16 offset:13600
    ds_read_b64_tr_b16 a[128:129], v16 offset:32
    ds_read_b64_tr_b16 a[130:131], v16 offset:832
    ds_read_b64_tr_b16 a[132:133], v16 offset:12832
    ds_read_b64_tr_b16 a[134:135], v16 offset:13632
    ds_read_b64_tr_b16 a[208:209], v16 offset:64
    ds_read_b64_tr_b16 a[210:211], v16 offset:864
    ds_read_b64_tr_b16 a[212:213], v16 offset:12864
    ds_read_b64_tr_b16 a[214:215], v16 offset:13664
    s_waitcnt lgkmcnt(0)
    s_barrier
    s_waitcnt vmcnt(6)
    ds_write_b128 v10, v[48:51]
    ds_write_b128 v11, v[52:55]
    ds_write_b128 v12, v[56:59]
    ds_write_b128 v13, v[60:63]
    ds_write_b128 v14, v[64:67]
    ds_write_b128 v15, v[68:71]
    s_add_u32 s46, s45, 7077888
    buffer_load_dwordx4 v[24:27], v4, s[12:15], s46 offen
    buffer_load_dwordx4 v[28:31], v5, s[12:15], s46 offen
    buffer_load_dwordx4 v[32:35], v6, s[12:15], s46 offen
    buffer_load_dwordx4 v[36:39], v7, s[12:15], s46 offen
    buffer_load_dwordx4 v[40:43], v8, s[12:15], s46 offen
    buffer_load_dwordx4 v[44:47], v9, s[12:15], s46 offen
    s_waitcnt lgkmcnt(0)
    s_barrier
    ds_read_b64_tr_b16 a[56:57], v16 offset:0
    ds_read_b64_tr_b16 a[58:59], v16 offset:800
    ds_read_b64_tr_b16 a[60:61], v16 offset:12800
    ds_read_b64_tr_b16 a[62:63], v16 offset:13600
    ds_read_b64_tr_b16 a[136:137], v16 offset:32
    ds_read_b64_tr_b16 a[138:139], v16 offset:832
    ds_read_b64_tr_b16 a[140:141], v16 offset:12832
    ds_read_b64_tr_b16 a[142:143], v16 offset:13632
    ds_read_b64_tr_b16 a[216:217], v16 offset:64
    ds_read_b64_tr_b16 a[218:219], v16 offset:864
    ds_read_b64_tr_b16 a[220:221], v16 offset:12864
    ds_read_b64_tr_b16 a[222:223], v16 offset:13664
    s_waitcnt lgkmcnt(0)
    s_barrier
    s_waitcnt vmcnt(6)
    ds_write_b128 v10, v[72:75]
    ds_write_b128 v11, v[76:79]
    ds_write_b128 v12, v[80:83]
    ds_write_b128 v13, v[84:87]
    ds_write_b128 v14, v[88:91]
    ds_write_b128 v15, v[92:95]
    s_waitcnt lgkmcnt(0)
    s_barrier
    ds_read_b64_tr_b16 a[64:65], v16 offset:0
    ds_read_b64_tr_b16 a[66:67], v16 offset:800
    ds_read_b64_tr_b16 a[68:69], v16 offset:12800
    ds_read_b64_tr_b16 a[70:71], v16 offset:13600
    ds_read_b64_tr_b16 a[144:145], v16 offset:32
    ds_read_b64_tr_b16 a[146:147], v16 offset:832
    ds_read_b64_tr_b16 a[148:149], v16 offset:12832
    ds_read_b64_tr_b16 a[150:151], v16 offset:13632
    ds_read_b64_tr_b16 a[224:225], v16 offset:64
    ds_read_b64_tr_b16 a[226:227], v16 offset:864
    ds_read_b64_tr_b16 a[228:229], v16 offset:12864
    ds_read_b64_tr_b16 a[230:231], v16 offset:13664
    s_waitcnt lgkmcnt(0)
    s_barrier
    s_waitcnt vmcnt(0)
    ds_write_b128 v10, v[24:27]
    ds_write_b128 v11, v[28:31]
    ds_write_b128 v12, v[32:35]
    ds_write_b128 v13, v[36:39]
    ds_write_b128 v14, v[40:43]
    ds_write_b128 v15, v[44:47]
    s_waitcnt lgkmcnt(0)
    s_barrier
    ds_read_b64_tr_b16 a[72:73], v16 offset:0
    ds_read_b64_tr_b16 a[74:75], v16 offset:800
    ds_read_b64_tr_b16 a[76:77], v16 offset:12800
    ds_read_b64_tr_b16 a[78:79], v16 offset:13600
    ds_read_b64_tr_b16 a[152:153], v16 offset:32
    ds_read_b64_tr_b16 a[154:155], v16 offset:832
    ds_read_b64_tr_b16 a[156:157], v16 offset:12832
    ds_read_b64_tr_b16 a[158:159], v16 offset:13632
    ds_read_b64_tr_b16 a[232:233], v16 offset:64
    ds_read_b64_tr_b16 a[234:235], v16 offset:864
    ds_read_b64_tr_b16 a[236:237], v16 offset:12864
    ds_read_b64_tr_b16 a[238:239], v16 offset:13664
    s_waitcnt lgkmcnt(0)
    s_barrier
    v_add_u32 v64, 0, v0
    s_mov_b32 s24, 1639
    v_mul_lo_u32 v65, v64, s24
    v_lshrrev_b32 v65, 16, v65
    v_mul_u32_u24 v66, 40, v65
    v_sub_u32 v66, v64, v66
    s_mov_b32 s24, 1280
    v_mul_lo_u32 v4, v65, s24
    v_lshl_add_u32 v4, v66, 4, v4
    v_mul_u32_u24 v14, 656, v65
    v_lshl_add_u32 v14, v66, 4, v14
    v_add_u32 v14, 90112, v14
    v_add_u32 v64, 256, v0
    s_mov_b32 s24, 1639
    v_mul_lo_u32 v65, v64, s24
    v_lshrrev_b32 v65, 16, v65
    v_mul_u32_u24 v66, 40, v65
    v_sub_u32 v66, v64, v66
    s_mov_b32 s24, 1280
    v_mul_lo_u32 v5, v65, s24
    v_lshl_add_u32 v5, v66, 4, v5
    v_mul_u32_u24 v15, 656, v65
    v_lshl_add_u32 v15, v66, 4, v15
    v_add_u32 v15, 90112, v15
    v_add_u32 v64, 512, v0
    s_mov_b32 s24, 1639
    v_mul_lo_u32 v65, v64, s24
    v_lshrrev_b32 v65, 16, v65
    v_mul_u32_u24 v66, 40, v65
    v_sub_u32 v66, v64, v66
    s_mov_b32 s24, 1280
    v_mul_lo_u32 v6, v65, s24
    v_lshl_add_u32 v6, v66, 4, v6
    v_mul_u32_u24 v16, 656, v65
    v_lshl_add_u32 v16, v66, 4, v16
    v_add_u32 v16, 90112, v16
    v_add_u32 v64, 768, v0
    s_mov_b32 s24, 1639
    v_mul_lo_u32 v65, v64, s24
    v_lshrrev_b32 v65, 16, v65
    v_mul_u32_u24 v66, 40, v65
    v_sub_u32 v66, v64, v66
    s_mov_b32 s24, 1280
    v_mul_lo_u32 v7, v65, s24
    v_lshl_add_u32 v7, v66, 4, v7
    v_mul_u32_u24 v17, 656, v65
    v_lshl_add_u32 v17, v66, 4, v17
    v_add_u32 v17, 90112, v17
    v_add_u32 v64, 1024, v0
    s_mov_b32 s24, 1639
    v_mul_lo_u32 v65, v64, s24
    v_lshrrev_b32 v65, 16, v65
    v_mul_u32_u24 v66, 40, v65
    v_sub_u32 v66, v64, v66
    s_mov_b32 s24, 1280
    v_mul_lo_u32 v8, v65, s24
    v_lshl_add_u32 v8, v66, 4, v8
    v_mul_u32_u24 v18, 656, v65
    v_lshl_add_u32 v18, v66, 4, v18
    v_add_u32 v18, 90112, v18
    v_add_u32 v64, 1280, v0
    s_mov_b32 s24, 1639
    v_mul_lo_u32 v65, v64, s24
    v_lshrrev_b32 v65, 16, v65
    v_mul_u32_u24 v66, 40, v65
    v_sub_u32 v66, v64, v66
    s_mov_b32 s24, 1280
    v_mul_lo_u32 v9, v65, s24
    v_lshl_add_u32 v9, v66, 4, v9
    v_mul_u32_u24 v19, 656, v65
    v_lshl_add_u32 v19, v66, 4, v19
    v_add_u32 v19, 90112, v19
    v_add_u32 v64, 1536, v0
    s_mov_b32 s24, 1639
    v_mul_lo_u32 v65, v64, s24
    v_lshrrev_b32 v65, 16, v65
    v_mul_u32_u24 v66, 40, v65
    v_sub_u32 v66, v64, v66
    s_mov_b32 s24, 1280
    v_mul_lo_u32 v10, v65, s24
    v_lshl_add_u32 v10, v66, 4, v10
    v_mul_u32_u24 v20, 656, v65
    v_lshl_add_u32 v20, v66, 4, v20
    v_add_u32 v20, 90112, v20
    v_add_u32 v64, 1792, v0
    s_mov_b32 s24, 1639
    v_mul_lo_u32 v65, v64, s24
    v_lshrrev_b32 v65, 16, v65
    v_mul_u32_u24 v66, 40, v65
    v_sub_u32 v66, v64, v66
    s_mov_b32 s24, 1280
    v_mul_lo_u32 v11, v65, s24
    v_lshl_add_u32 v11, v66, 4, v11
    v_mul_u32_u24 v21, 656, v65
    v_lshl_add_u32 v21, v66, 4, v21
    v_add_u32 v21, 90112, v21
    v_add_u32 v64, 2048, v0
    s_mov_b32 s24, 1639
    v_mul_lo_u32 v65, v64, s24
    v_lshrrev_b32 v65, 16, v65
    v_mul_u32_u24 v66, 40, v65
    v_sub_u32 v66, v64, v66
    s_mov_b32 s24, 1280
    v_mul_lo_u32 v12, v65, s24
    v_lshl_add_u32 v12, v66, 4, v12
    v_mul_u32_u24 v22, 656, v65
    v_lshl_add_u32 v22, v66, 4, v22
    v_add_u32 v22, 90112, v22
    v_add_u32 v64, 2304, v0
    s_mov_b32 s24, 1639
    v_mul_lo_u32 v65, v64, s24
    v_lshrrev_b32 v65, 16, v65
    v_mul_u32_u24 v66, 40, v65
    v_sub_u32 v66, v64, v66
    s_mov_b32 s24, 1280
    v_mul_lo_u32 v13, v65, s24
    v_lshl_add_u32 v13, v66, 4, v13
    v_mul_u32_u24 v23, 656, v65
    v_lshl_add_u32 v23, v66, 4, v23
    v_add_u32 v23, 90112, v23
    v_lshrrev_b32 v64, 1, v3
    v_lshlrev_b32 v64, 4, v64
    v_and_b32 v65, 1, v3
    v_lshl_add_u32 v64, v65, 2, v64
    v_lshrrev_b32 v65, 2, v2
    v_and_b32 v66, 1, v65
    v_add_u32 v64, v64, v66
    v_lshrrev_b32 v65, 1, v65
    v_lshl_add_u32 v64, v65, 3, v64
    v_mul_u32_u24 v72, 656, v64
    v_and_b32 v65, 3, v2
    v_lshl_add_u32 v72, v65, 3, v72
    v_add_u32 v72, 90112, v72
    s_and_b32 s24, s3, 1
    s_mul_i32 s24, s24, 320
    v_add_u32 v72, s24, v72
    v_lshlrev_b32 v73, 4, v1
    s_mul_i32 s24, s3, 18432
    s_add_u32 s24, s24, 16384
    v_add_u32 v73, s24, v73
    s_mul_i32 s45, s44, 245760
    s_add_u32 s46, s45, 0
    buffer_load_dwordx4 v[24:27], v4, s[16:19], s46 offen
    buffer_load_dwordx4 v[28:31], v5, s[16:19], s46 offen
    buffer_load_dwordx4 v[32:35], v6, s[16:19], s46 offen
    buffer_load_dwordx4 v[36:39], v7, s[16:19], s46 offen
    buffer_load_dwordx4 v[40:43], v8, s[16:19], s46 offen
    buffer_load_dwordx4 v[44:47], v9, s[16:19], s46 offen
    buffer_load_dwordx4 v[48:51], v10, s[16:19], s46 offen
    buffer_load_dwordx4 v[52:55], v11, s[16:19], s46 offen
    buffer_load_dwordx4 v[56:59], v12, s[16:19], s46 offen
    buffer_load_dwordx4 v[60:63], v13, s[16:19], s46 offen
    s_waitcnt vmcnt(0)
    ds_write_b128 v14, v[24:27]
    ds_write_b128 v15, v[28:31]
    ds_write_b128 v16, v[32:35]
    ds_write_b128 v17, v[36:39]
    ds_write_b128 v18, v[40:43]
    ds_write_b128 v19, v[44:47]
    ds_write_b128 v20, v[48:51]
    ds_write_b128 v21, v[52:55]
    ds_write_b128 v22, v[56:59]
    ds_write_b128 v23, v[60:63]
    s_waitcnt lgkmcnt(0)
    s_barrier
    s_lshr_b32 s24, s3, 1
    s_cmp_eq_u32 s24, 0
    s_cbranch_scc0 interleave_layers__linear_attn_block__memory_aug_recurrent_mem_tr__prompt_kernel_wo19
    ds_read_b64_tr_b16 a[240:241], v72 offset:0
    ds_read_b64_tr_b16 a[242:243], v72 offset:1312
    ds_read_b64_tr_b16 a[244:245], v72 offset:20992
    ds_read_b64_tr_b16 a[246:247], v72 offset:22304
    ds_read_b64_tr_b16 v[112:113], v72 offset:32
    ds_read_b64_tr_b16 v[114:115], v72 offset:1344
    ds_read_b64_tr_b16 v[116:117], v72 offset:21024
    ds_read_b64_tr_b16 v[118:119], v72 offset:22336
    ds_read_b64_tr_b16 v[136:137], v72 offset:64
    ds_read_b64_tr_b16 v[138:139], v72 offset:1376
    ds_read_b64_tr_b16 v[140:141], v72 offset:21056
    ds_read_b64_tr_b16 v[142:143], v72 offset:22368
    ds_read_b64_tr_b16 v[160:161], v72 offset:96
    ds_read_b64_tr_b16 v[162:163], v72 offset:1408
    ds_read_b64_tr_b16 v[164:165], v72 offset:21088
    ds_read_b64_tr_b16 v[166:167], v72 offset:22400
    ds_read_b64_tr_b16 v[184:185], v72 offset:128
    ds_read_b64_tr_b16 v[186:187], v72 offset:1440
    ds_read_b64_tr_b16 v[188:189], v72 offset:21120
    ds_read_b64_tr_b16 v[190:191], v72 offset:22432
    ds_read_b64_tr_b16 v[208:209], v72 offset:160
    ds_read_b64_tr_b16 v[210:211], v72 offset:1472
    ds_read_b64_tr_b16 v[212:213], v72 offset:21152
    ds_read_b64_tr_b16 v[214:215], v72 offset:22464
    ds_read_b64_tr_b16 v[232:233], v72 offset:192
    ds_read_b64_tr_b16 v[234:235], v72 offset:1504
    ds_read_b64_tr_b16 v[236:237], v72 offset:21184
    ds_read_b64_tr_b16 v[238:239], v72 offset:22496
    ds_read_b64_tr_b16 v[64:65], v72 offset:224
    ds_read_b64_tr_b16 v[66:67], v72 offset:1536
    ds_read_b64_tr_b16 v[68:69], v72 offset:21216
    ds_read_b64_tr_b16 v[70:71], v72 offset:22528
    s_waitcnt lgkmcnt(0)
    ds_write_b128 v73, v[64:67] offset:0
    ds_write_b128 v73, v[68:71] offset:1024
    s_waitcnt lgkmcnt(0)
    ds_read_b64_tr_b16 v[64:65], v72 offset:256
    ds_read_b64_tr_b16 v[66:67], v72 offset:1568
    ds_read_b64_tr_b16 v[68:69], v72 offset:21248
    ds_read_b64_tr_b16 v[70:71], v72 offset:22560
    s_waitcnt lgkmcnt(0)
    ds_write_b128 v73, v[64:67] offset:6144
    ds_write_b128 v73, v[68:71] offset:7168
    s_waitcnt lgkmcnt(0)
    ds_read_b64_tr_b16 v[64:65], v72 offset:288
    ds_read_b64_tr_b16 v[66:67], v72 offset:1600
    ds_read_b64_tr_b16 v[68:69], v72 offset:21280
    ds_read_b64_tr_b16 v[70:71], v72 offset:22592
    s_waitcnt lgkmcnt(0)
    ds_write_b128 v73, v[64:67] offset:12288
    ds_write_b128 v73, v[68:71] offset:13312
    s_waitcnt lgkmcnt(0)
    s_waitcnt lgkmcnt(0)
interleave_layers__linear_attn_block__memory_aug_recurrent_mem_tr__prompt_kernel_wo19:
    s_barrier
    s_add_u32 s46, s45, 640
    buffer_load_dwordx4 v[24:27], v4, s[16:19], s46 offen
    buffer_load_dwordx4 v[28:31], v5, s[16:19], s46 offen
    buffer_load_dwordx4 v[32:35], v6, s[16:19], s46 offen
    buffer_load_dwordx4 v[36:39], v7, s[16:19], s46 offen
    buffer_load_dwordx4 v[40:43], v8, s[16:19], s46 offen
    buffer_load_dwordx4 v[44:47], v9, s[16:19], s46 offen
    buffer_load_dwordx4 v[48:51], v10, s[16:19], s46 offen
    buffer_load_dwordx4 v[52:55], v11, s[16:19], s46 offen
    buffer_load_dwordx4 v[56:59], v12, s[16:19], s46 offen
    buffer_load_dwordx4 v[60:63], v13, s[16:19], s46 offen
    s_waitcnt vmcnt(0)
    ds_write_b128 v14, v[24:27]
    ds_write_b128 v15, v[28:31]
    ds_write_b128 v16, v[32:35]
    ds_write_b128 v17, v[36:39]
    ds_write_b128 v18, v[40:43]
    ds_write_b128 v19, v[44:47]
    ds_write_b128 v20, v[48:51]
    ds_write_b128 v21, v[52:55]
    ds_write_b128 v22, v[56:59]
    ds_write_b128 v23, v[60:63]
    s_waitcnt lgkmcnt(0)
    s_barrier
    s_lshr_b32 s24, s3, 1
    s_cmp_eq_u32 s24, 1
    s_cbranch_scc0 interleave_layers__linear_attn_block__memory_aug_recurrent_mem_tr__prompt_kernel_wo20
    ds_read_b64_tr_b16 a[240:241], v72 offset:0
    ds_read_b64_tr_b16 a[242:243], v72 offset:1312
    ds_read_b64_tr_b16 a[244:245], v72 offset:20992
    ds_read_b64_tr_b16 a[246:247], v72 offset:22304
    ds_read_b64_tr_b16 v[112:113], v72 offset:32
    ds_read_b64_tr_b16 v[114:115], v72 offset:1344
    ds_read_b64_tr_b16 v[116:117], v72 offset:21024
    ds_read_b64_tr_b16 v[118:119], v72 offset:22336
    ds_read_b64_tr_b16 v[136:137], v72 offset:64
    ds_read_b64_tr_b16 v[138:139], v72 offset:1376
    ds_read_b64_tr_b16 v[140:141], v72 offset:21056
    ds_read_b64_tr_b16 v[142:143], v72 offset:22368
    ds_read_b64_tr_b16 v[160:161], v72 offset:96
    ds_read_b64_tr_b16 v[162:163], v72 offset:1408
    ds_read_b64_tr_b16 v[164:165], v72 offset:21088
    ds_read_b64_tr_b16 v[166:167], v72 offset:22400
    ds_read_b64_tr_b16 v[184:185], v72 offset:128
    ds_read_b64_tr_b16 v[186:187], v72 offset:1440
    ds_read_b64_tr_b16 v[188:189], v72 offset:21120
    ds_read_b64_tr_b16 v[190:191], v72 offset:22432
    ds_read_b64_tr_b16 v[208:209], v72 offset:160
    ds_read_b64_tr_b16 v[210:211], v72 offset:1472
    ds_read_b64_tr_b16 v[212:213], v72 offset:21152
    ds_read_b64_tr_b16 v[214:215], v72 offset:22464
    ds_read_b64_tr_b16 v[232:233], v72 offset:192
    ds_read_b64_tr_b16 v[234:235], v72 offset:1504
    ds_read_b64_tr_b16 v[236:237], v72 offset:21184
    ds_read_b64_tr_b16 v[238:239], v72 offset:22496
    ds_read_b64_tr_b16 v[64:65], v72 offset:224
    ds_read_b64_tr_b16 v[66:67], v72 offset:1536
    ds_read_b64_tr_b16 v[68:69], v72 offset:21216
    ds_read_b64_tr_b16 v[70:71], v72 offset:22528
    s_waitcnt lgkmcnt(0)
    ds_write_b128 v73, v[64:67] offset:0
    ds_write_b128 v73, v[68:71] offset:1024
    s_waitcnt lgkmcnt(0)
    ds_read_b64_tr_b16 v[64:65], v72 offset:256
    ds_read_b64_tr_b16 v[66:67], v72 offset:1568
    ds_read_b64_tr_b16 v[68:69], v72 offset:21248
    ds_read_b64_tr_b16 v[70:71], v72 offset:22560
    s_waitcnt lgkmcnt(0)
    ds_write_b128 v73, v[64:67] offset:6144
    ds_write_b128 v73, v[68:71] offset:7168
    s_waitcnt lgkmcnt(0)
    ds_read_b64_tr_b16 v[64:65], v72 offset:288
    ds_read_b64_tr_b16 v[66:67], v72 offset:1600
    ds_read_b64_tr_b16 v[68:69], v72 offset:21280
    ds_read_b64_tr_b16 v[70:71], v72 offset:22592
    s_waitcnt lgkmcnt(0)
    ds_write_b128 v73, v[64:67] offset:12288
    ds_write_b128 v73, v[68:71] offset:13312
    s_waitcnt lgkmcnt(0)
    s_waitcnt lgkmcnt(0)
interleave_layers__linear_attn_block__memory_aug_recurrent_mem_tr__prompt_kernel_wo20:
    s_barrier
    s_add_u32 s46, s45, 81920
    buffer_load_dwordx4 v[24:27], v4, s[16:19], s46 offen
    buffer_load_dwordx4 v[28:31], v5, s[16:19], s46 offen
    buffer_load_dwordx4 v[32:35], v6, s[16:19], s46 offen
    buffer_load_dwordx4 v[36:39], v7, s[16:19], s46 offen
    buffer_load_dwordx4 v[40:43], v8, s[16:19], s46 offen
    buffer_load_dwordx4 v[44:47], v9, s[16:19], s46 offen
    buffer_load_dwordx4 v[48:51], v10, s[16:19], s46 offen
    buffer_load_dwordx4 v[52:55], v11, s[16:19], s46 offen
    buffer_load_dwordx4 v[56:59], v12, s[16:19], s46 offen
    buffer_load_dwordx4 v[60:63], v13, s[16:19], s46 offen
    s_waitcnt vmcnt(0)
    ds_write_b128 v14, v[24:27]
    ds_write_b128 v15, v[28:31]
    ds_write_b128 v16, v[32:35]
    ds_write_b128 v17, v[36:39]
    ds_write_b128 v18, v[40:43]
    ds_write_b128 v19, v[44:47]
    ds_write_b128 v20, v[48:51]
    ds_write_b128 v21, v[52:55]
    ds_write_b128 v22, v[56:59]
    ds_write_b128 v23, v[60:63]
    s_waitcnt lgkmcnt(0)
    s_barrier
    s_lshr_b32 s24, s3, 1
    s_cmp_eq_u32 s24, 0
    s_cbranch_scc0 interleave_layers__linear_attn_block__memory_aug_recurrent_mem_tr__prompt_kernel_wo21
    ds_read_b64_tr_b16 a[248:249], v72 offset:0
    ds_read_b64_tr_b16 a[250:251], v72 offset:1312
    ds_read_b64_tr_b16 a[252:253], v72 offset:20992
    ds_read_b64_tr_b16 a[254:255], v72 offset:22304
    ds_read_b64_tr_b16 v[120:121], v72 offset:32
    ds_read_b64_tr_b16 v[122:123], v72 offset:1344
    ds_read_b64_tr_b16 v[124:125], v72 offset:21024
    ds_read_b64_tr_b16 v[126:127], v72 offset:22336
    ds_read_b64_tr_b16 v[144:145], v72 offset:64
    ds_read_b64_tr_b16 v[146:147], v72 offset:1376
    ds_read_b64_tr_b16 v[148:149], v72 offset:21056
    ds_read_b64_tr_b16 v[150:151], v72 offset:22368
    ds_read_b64_tr_b16 v[168:169], v72 offset:96
    ds_read_b64_tr_b16 v[170:171], v72 offset:1408
    ds_read_b64_tr_b16 v[172:173], v72 offset:21088
    ds_read_b64_tr_b16 v[174:175], v72 offset:22400
    ds_read_b64_tr_b16 v[192:193], v72 offset:128
    ds_read_b64_tr_b16 v[194:195], v72 offset:1440
    ds_read_b64_tr_b16 v[196:197], v72 offset:21120
    ds_read_b64_tr_b16 v[198:199], v72 offset:22432
    ds_read_b64_tr_b16 v[216:217], v72 offset:160
    ds_read_b64_tr_b16 v[218:219], v72 offset:1472
    ds_read_b64_tr_b16 v[220:221], v72 offset:21152
    ds_read_b64_tr_b16 v[222:223], v72 offset:22464
    ds_read_b64_tr_b16 v[240:241], v72 offset:192
    ds_read_b64_tr_b16 v[242:243], v72 offset:1504
    ds_read_b64_tr_b16 v[244:245], v72 offset:21184
    ds_read_b64_tr_b16 v[246:247], v72 offset:22496
    ds_read_b64_tr_b16 v[64:65], v72 offset:224
    ds_read_b64_tr_b16 v[66:67], v72 offset:1536
    ds_read_b64_tr_b16 v[68:69], v72 offset:21216
    ds_read_b64_tr_b16 v[70:71], v72 offset:22528
    s_waitcnt lgkmcnt(0)
    ds_write_b128 v73, v[64:67] offset:2048
    ds_write_b128 v73, v[68:71] offset:3072
    s_waitcnt lgkmcnt(0)
    ds_read_b64_tr_b16 v[64:65], v72 offset:256
    ds_read_b64_tr_b16 v[66:67], v72 offset:1568
    ds_read_b64_tr_b16 v[68:69], v72 offset:21248
    ds_read_b64_tr_b16 v[70:71], v72 offset:22560
    s_waitcnt lgkmcnt(0)
    ds_write_b128 v73, v[64:67] offset:8192
    ds_write_b128 v73, v[68:71] offset:9216
    s_waitcnt lgkmcnt(0)
    ds_read_b64_tr_b16 v[64:65], v72 offset:288
    ds_read_b64_tr_b16 v[66:67], v72 offset:1600
    ds_read_b64_tr_b16 v[68:69], v72 offset:21280
    ds_read_b64_tr_b16 v[70:71], v72 offset:22592
    s_waitcnt lgkmcnt(0)
    ds_write_b128 v73, v[64:67] offset:14336
    ds_write_b128 v73, v[68:71] offset:15360
    s_waitcnt lgkmcnt(0)
    s_waitcnt lgkmcnt(0)
interleave_layers__linear_attn_block__memory_aug_recurrent_mem_tr__prompt_kernel_wo21:
    s_barrier
    s_add_u32 s46, s45, 82560
    buffer_load_dwordx4 v[24:27], v4, s[16:19], s46 offen
    buffer_load_dwordx4 v[28:31], v5, s[16:19], s46 offen
    buffer_load_dwordx4 v[32:35], v6, s[16:19], s46 offen
    buffer_load_dwordx4 v[36:39], v7, s[16:19], s46 offen
    buffer_load_dwordx4 v[40:43], v8, s[16:19], s46 offen
    buffer_load_dwordx4 v[44:47], v9, s[16:19], s46 offen
    buffer_load_dwordx4 v[48:51], v10, s[16:19], s46 offen
    buffer_load_dwordx4 v[52:55], v11, s[16:19], s46 offen
    buffer_load_dwordx4 v[56:59], v12, s[16:19], s46 offen
    buffer_load_dwordx4 v[60:63], v13, s[16:19], s46 offen
    s_waitcnt vmcnt(0)
    ds_write_b128 v14, v[24:27]
    ds_write_b128 v15, v[28:31]
    ds_write_b128 v16, v[32:35]
    ds_write_b128 v17, v[36:39]
    ds_write_b128 v18, v[40:43]
    ds_write_b128 v19, v[44:47]
    ds_write_b128 v20, v[48:51]
    ds_write_b128 v21, v[52:55]
    ds_write_b128 v22, v[56:59]
    ds_write_b128 v23, v[60:63]
    s_waitcnt lgkmcnt(0)
    s_barrier
    s_lshr_b32 s24, s3, 1
    s_cmp_eq_u32 s24, 1
    s_cbranch_scc0 interleave_layers__linear_attn_block__memory_aug_recurrent_mem_tr__prompt_kernel_wo22
    ds_read_b64_tr_b16 a[248:249], v72 offset:0
    ds_read_b64_tr_b16 a[250:251], v72 offset:1312
    ds_read_b64_tr_b16 a[252:253], v72 offset:20992
    ds_read_b64_tr_b16 a[254:255], v72 offset:22304
    ds_read_b64_tr_b16 v[120:121], v72 offset:32
    ds_read_b64_tr_b16 v[122:123], v72 offset:1344
    ds_read_b64_tr_b16 v[124:125], v72 offset:21024
    ds_read_b64_tr_b16 v[126:127], v72 offset:22336
    ds_read_b64_tr_b16 v[144:145], v72 offset:64
    ds_read_b64_tr_b16 v[146:147], v72 offset:1376
    ds_read_b64_tr_b16 v[148:149], v72 offset:21056
    ds_read_b64_tr_b16 v[150:151], v72 offset:22368
    ds_read_b64_tr_b16 v[168:169], v72 offset:96
    ds_read_b64_tr_b16 v[170:171], v72 offset:1408
    ds_read_b64_tr_b16 v[172:173], v72 offset:21088
    ds_read_b64_tr_b16 v[174:175], v72 offset:22400
    ds_read_b64_tr_b16 v[192:193], v72 offset:128
    ds_read_b64_tr_b16 v[194:195], v72 offset:1440
    ds_read_b64_tr_b16 v[196:197], v72 offset:21120
    ds_read_b64_tr_b16 v[198:199], v72 offset:22432
    ds_read_b64_tr_b16 v[216:217], v72 offset:160
    ds_read_b64_tr_b16 v[218:219], v72 offset:1472
    ds_read_b64_tr_b16 v[220:221], v72 offset:21152
    ds_read_b64_tr_b16 v[222:223], v72 offset:22464
    ds_read_b64_tr_b16 v[240:241], v72 offset:192
    ds_read_b64_tr_b16 v[242:243], v72 offset:1504
    ds_read_b64_tr_b16 v[244:245], v72 offset:21184
    ds_read_b64_tr_b16 v[246:247], v72 offset:22496
    ds_read_b64_tr_b16 v[64:65], v72 offset:224
    ds_read_b64_tr_b16 v[66:67], v72 offset:1536
    ds_read_b64_tr_b16 v[68:69], v72 offset:21216
    ds_read_b64_tr_b16 v[70:71], v72 offset:22528
    s_waitcnt lgkmcnt(0)
    ds_write_b128 v73, v[64:67] offset:2048
    ds_write_b128 v73, v[68:71] offset:3072
    s_waitcnt lgkmcnt(0)
    ds_read_b64_tr_b16 v[64:65], v72 offset:256
    ds_read_b64_tr_b16 v[66:67], v72 offset:1568
    ds_read_b64_tr_b16 v[68:69], v72 offset:21248
    ds_read_b64_tr_b16 v[70:71], v72 offset:22560
    s_waitcnt lgkmcnt(0)
    ds_write_b128 v73, v[64:67] offset:8192
    ds_write_b128 v73, v[68:71] offset:9216
    s_waitcnt lgkmcnt(0)
    ds_read_b64_tr_b16 v[64:65], v72 offset:288
    ds_read_b64_tr_b16 v[66:67], v72 offset:1600
    ds_read_b64_tr_b16 v[68:69], v72 offset:21280
    ds_read_b64_tr_b16 v[70:71], v72 offset:22592
    s_waitcnt lgkmcnt(0)
    ds_write_b128 v73, v[64:67] offset:14336
    ds_write_b128 v73, v[68:71] offset:15360
    s_waitcnt lgkmcnt(0)
    s_waitcnt lgkmcnt(0)
interleave_layers__linear_attn_block__memory_aug_recurrent_mem_tr__prompt_kernel_wo22:
    s_barrier
    s_add_u32 s46, s45, 163840
    buffer_load_dwordx4 v[24:27], v4, s[16:19], s46 offen
    buffer_load_dwordx4 v[28:31], v5, s[16:19], s46 offen
    buffer_load_dwordx4 v[32:35], v6, s[16:19], s46 offen
    buffer_load_dwordx4 v[36:39], v7, s[16:19], s46 offen
    buffer_load_dwordx4 v[40:43], v8, s[16:19], s46 offen
    buffer_load_dwordx4 v[44:47], v9, s[16:19], s46 offen
    buffer_load_dwordx4 v[48:51], v10, s[16:19], s46 offen
    buffer_load_dwordx4 v[52:55], v11, s[16:19], s46 offen
    buffer_load_dwordx4 v[56:59], v12, s[16:19], s46 offen
    buffer_load_dwordx4 v[60:63], v13, s[16:19], s46 offen
    s_waitcnt vmcnt(0)
    ds_write_b128 v14, v[24:27]
    ds_write_b128 v15, v[28:31]
    ds_write_b128 v16, v[32:35]
    ds_write_b128 v17, v[36:39]
    ds_write_b128 v18, v[40:43]
    ds_write_b128 v19, v[44:47]
    ds_write_b128 v20, v[48:51]
    ds_write_b128 v21, v[52:55]
    ds_write_b128 v22, v[56:59]
    ds_write_b128 v23, v[60:63]
    s_waitcnt lgkmcnt(0)
    s_barrier
    s_lshr_b32 s24, s3, 1
    s_cmp_eq_u32 s24, 0
    s_cbranch_scc0 interleave_layers__linear_attn_block__memory_aug_recurrent_mem_tr__prompt_kernel_wo23
    ds_read_b64_tr_b16 v[104:105], v72 offset:0
    ds_read_b64_tr_b16 v[106:107], v72 offset:1312
    ds_read_b64_tr_b16 v[108:109], v72 offset:20992
    ds_read_b64_tr_b16 v[110:111], v72 offset:22304
    ds_read_b64_tr_b16 v[128:129], v72 offset:32
    ds_read_b64_tr_b16 v[130:131], v72 offset:1344
    ds_read_b64_tr_b16 v[132:133], v72 offset:21024
    ds_read_b64_tr_b16 v[134:135], v72 offset:22336
    ds_read_b64_tr_b16 v[152:153], v72 offset:64
    ds_read_b64_tr_b16 v[154:155], v72 offset:1376
    ds_read_b64_tr_b16 v[156:157], v72 offset:21056
    ds_read_b64_tr_b16 v[158:159], v72 offset:22368
    ds_read_b64_tr_b16 v[176:177], v72 offset:96
    ds_read_b64_tr_b16 v[178:179], v72 offset:1408
    ds_read_b64_tr_b16 v[180:181], v72 offset:21088
    ds_read_b64_tr_b16 v[182:183], v72 offset:22400
    ds_read_b64_tr_b16 v[200:201], v72 offset:128
    ds_read_b64_tr_b16 v[202:203], v72 offset:1440
    ds_read_b64_tr_b16 v[204:205], v72 offset:21120
    ds_read_b64_tr_b16 v[206:207], v72 offset:22432
    ds_read_b64_tr_b16 v[224:225], v72 offset:160
    ds_read_b64_tr_b16 v[226:227], v72 offset:1472
    ds_read_b64_tr_b16 v[228:229], v72 offset:21152
    ds_read_b64_tr_b16 v[230:231], v72 offset:22464
    ds_read_b64_tr_b16 v[248:249], v72 offset:192
    ds_read_b64_tr_b16 v[250:251], v72 offset:1504
    ds_read_b64_tr_b16 v[252:253], v72 offset:21184
    ds_read_b64_tr_b16 v[254:255], v72 offset:22496
    ds_read_b64_tr_b16 v[64:65], v72 offset:224
    ds_read_b64_tr_b16 v[66:67], v72 offset:1536
    ds_read_b64_tr_b16 v[68:69], v72 offset:21216
    ds_read_b64_tr_b16 v[70:71], v72 offset:22528
    s_waitcnt lgkmcnt(0)
    ds_write_b128 v73, v[64:67] offset:4096
    ds_write_b128 v73, v[68:71] offset:5120
    s_waitcnt lgkmcnt(0)
    ds_read_b64_tr_b16 v[64:65], v72 offset:256
    ds_read_b64_tr_b16 v[66:67], v72 offset:1568
    ds_read_b64_tr_b16 v[68:69], v72 offset:21248
    ds_read_b64_tr_b16 v[70:71], v72 offset:22560
    s_waitcnt lgkmcnt(0)
    ds_write_b128 v73, v[64:67] offset:10240
    ds_write_b128 v73, v[68:71] offset:11264
    s_waitcnt lgkmcnt(0)
    ds_read_b64_tr_b16 v[64:65], v72 offset:288
    ds_read_b64_tr_b16 v[66:67], v72 offset:1600
    ds_read_b64_tr_b16 v[68:69], v72 offset:21280
    ds_read_b64_tr_b16 v[70:71], v72 offset:22592
    s_waitcnt lgkmcnt(0)
    ds_write_b128 v73, v[64:67] offset:16384
    ds_write_b128 v73, v[68:71] offset:17408
    s_waitcnt lgkmcnt(0)
    s_waitcnt lgkmcnt(0)
interleave_layers__linear_attn_block__memory_aug_recurrent_mem_tr__prompt_kernel_wo23:
    s_barrier
    s_add_u32 s46, s45, 164480
    buffer_load_dwordx4 v[24:27], v4, s[16:19], s46 offen
    buffer_load_dwordx4 v[28:31], v5, s[16:19], s46 offen
    buffer_load_dwordx4 v[32:35], v6, s[16:19], s46 offen
    buffer_load_dwordx4 v[36:39], v7, s[16:19], s46 offen
    buffer_load_dwordx4 v[40:43], v8, s[16:19], s46 offen
    buffer_load_dwordx4 v[44:47], v9, s[16:19], s46 offen
    buffer_load_dwordx4 v[48:51], v10, s[16:19], s46 offen
    buffer_load_dwordx4 v[52:55], v11, s[16:19], s46 offen
    buffer_load_dwordx4 v[56:59], v12, s[16:19], s46 offen
    buffer_load_dwordx4 v[60:63], v13, s[16:19], s46 offen
    s_waitcnt vmcnt(0)
    ds_write_b128 v14, v[24:27]
    ds_write_b128 v15, v[28:31]
    ds_write_b128 v16, v[32:35]
    ds_write_b128 v17, v[36:39]
    ds_write_b128 v18, v[40:43]
    ds_write_b128 v19, v[44:47]
    ds_write_b128 v20, v[48:51]
    ds_write_b128 v21, v[52:55]
    ds_write_b128 v22, v[56:59]
    ds_write_b128 v23, v[60:63]
    s_waitcnt lgkmcnt(0)
    s_barrier
    s_lshr_b32 s24, s3, 1
    s_cmp_eq_u32 s24, 1
    s_cbranch_scc0 interleave_layers__linear_attn_block__memory_aug_recurrent_mem_tr__prompt_kernel_wo24
    ds_read_b64_tr_b16 v[104:105], v72 offset:0
    ds_read_b64_tr_b16 v[106:107], v72 offset:1312
    ds_read_b64_tr_b16 v[108:109], v72 offset:20992
    ds_read_b64_tr_b16 v[110:111], v72 offset:22304
    ds_read_b64_tr_b16 v[128:129], v72 offset:32
    ds_read_b64_tr_b16 v[130:131], v72 offset:1344
    ds_read_b64_tr_b16 v[132:133], v72 offset:21024
    ds_read_b64_tr_b16 v[134:135], v72 offset:22336
    ds_read_b64_tr_b16 v[152:153], v72 offset:64
    ds_read_b64_tr_b16 v[154:155], v72 offset:1376
    ds_read_b64_tr_b16 v[156:157], v72 offset:21056
    ds_read_b64_tr_b16 v[158:159], v72 offset:22368
    ds_read_b64_tr_b16 v[176:177], v72 offset:96
    ds_read_b64_tr_b16 v[178:179], v72 offset:1408
    ds_read_b64_tr_b16 v[180:181], v72 offset:21088
    ds_read_b64_tr_b16 v[182:183], v72 offset:22400
    ds_read_b64_tr_b16 v[200:201], v72 offset:128
    ds_read_b64_tr_b16 v[202:203], v72 offset:1440
    ds_read_b64_tr_b16 v[204:205], v72 offset:21120
    ds_read_b64_tr_b16 v[206:207], v72 offset:22432
    ds_read_b64_tr_b16 v[224:225], v72 offset:160
    ds_read_b64_tr_b16 v[226:227], v72 offset:1472
    ds_read_b64_tr_b16 v[228:229], v72 offset:21152
    ds_read_b64_tr_b16 v[230:231], v72 offset:22464
    ds_read_b64_tr_b16 v[248:249], v72 offset:192
    ds_read_b64_tr_b16 v[250:251], v72 offset:1504
    ds_read_b64_tr_b16 v[252:253], v72 offset:21184
    ds_read_b64_tr_b16 v[254:255], v72 offset:22496
    ds_read_b64_tr_b16 v[64:65], v72 offset:224
    ds_read_b64_tr_b16 v[66:67], v72 offset:1536
    ds_read_b64_tr_b16 v[68:69], v72 offset:21216
    ds_read_b64_tr_b16 v[70:71], v72 offset:22528
    s_waitcnt lgkmcnt(0)
    ds_write_b128 v73, v[64:67] offset:4096
    ds_write_b128 v73, v[68:71] offset:5120
    s_waitcnt lgkmcnt(0)
    ds_read_b64_tr_b16 v[64:65], v72 offset:256
    ds_read_b64_tr_b16 v[66:67], v72 offset:1568
    ds_read_b64_tr_b16 v[68:69], v72 offset:21248
    ds_read_b64_tr_b16 v[70:71], v72 offset:22560
    s_waitcnt lgkmcnt(0)
    ds_write_b128 v73, v[64:67] offset:10240
    ds_write_b128 v73, v[68:71] offset:11264
    s_waitcnt lgkmcnt(0)
    ds_read_b64_tr_b16 v[64:65], v72 offset:288
    ds_read_b64_tr_b16 v[66:67], v72 offset:1600
    ds_read_b64_tr_b16 v[68:69], v72 offset:21280
    ds_read_b64_tr_b16 v[70:71], v72 offset:22592
    s_waitcnt lgkmcnt(0)
    ds_write_b128 v73, v[64:67] offset:16384
    ds_write_b128 v73, v[68:71] offset:17408
    s_waitcnt lgkmcnt(0)
    s_waitcnt lgkmcnt(0)
interleave_layers__linear_attn_block__memory_aug_recurrent_mem_tr__prompt_kernel_wo24:
    s_barrier
    v_mov_b32 v6, v73
    v_mov_b32 v4, 0x4444
    v_mov_b32 v5, 0xeeee
    v_cmp_gt_u32 vcc, 8, v2
    s_nop 1
    v_cndmask_b32 v4, v5, v4, vcc
    v_lshlrev_b32 v5, 4, v1
    s_lshl_b32 s24, s3, 10
    v_add_u32 v7, s24, v5
    s_lshl_b32 s24, s3, 9
    s_add_u32 s24, s24, 8192
    v_lshlrev_b32 v8, 3, v1
    v_add_u32 v8, s24, v8
    v_and_b32 v64, 7, v2
    v_lshlrev_b32 v9, 5, v64
    v_lshrrev_b32 v64, 3, v2
    v_lshl_add_u32 v9, v64, 4, v9
    v_and_b32 v64, 1, v3
    v_lshl_add_u32 v9, v64, 3, v9
    s_mul_i32 s24, s3, 768
    s_add_u32 s24, s24, 10240
    v_add_u32 v9, s24, v9
    v_lshrrev_b32 v65, 1, v3
    v_lshl_add_u32 v10, v65, 8, v9
    v_lshrrev_b32 v64, 2, v2
    v_lshlrev_b32 v11, 5, v64
    v_and_b32 v64, 3, v2
    v_lshl_add_u32 v11, v64, 3, v11
    v_lshl_add_u32 v11, v3, 8, v11
    v_add_u32 v11, 10240, v11
    s_mul_i32 s24, s3, 10
    s_lshl_b32 s24, s24, 14
    s_lshl_b32 s25, s44, 8
    s_add_u32 s24, s24, s25
    v_lshlrev_b32 v14, 14, v3
    v_lshl_add_u32 v14, v2, 4, v14
    v_add_u32 v14, s24, v14
    v_lshrrev_b32 v64, 1, v3
    v_lshlrev_b32 v15, 14, v64
    v_lshl_add_u32 v15, v2, 4, v15
    v_add_u32 v15, s24, v15
    v_add_u32 v15, 131072, v15
    v_and_b32 v64, 1, v3
    v_cmp_eq_u32 vcc, 0, v64
    v_mov_b32 v64, 2146435072
    s_nop 0
    v_cndmask_b32 v15, v64, v15, vcc
    s_and_b32 s24, s2, 15
    s_mul_i32 s25, s3, 16
    s_add_u32 s24, s24, s25
    s_lshl_b32 s24, s24, 7
    v_mov_b32 v12, s24
    v_mov_b32 v0, 1
interleave_layers__linear_attn_block__memory_aug_recurrent_mem_tr__prompt_kernel_v_layer:
    s_mov_b32 s93, 0
    s_lshl_b32 s24, s93, 12
    s_and_b32 s24, s24, 0x2000
    s_xor_b32 s24, s24, s36
    s_lshl_b32 s93, s93, 20
    s_add_u32 s93, s93, s24
    s_add_u32 s93, s93, 117440512
    s_mul_i32 s94, s92, 16384
    s_add_u32 s94, s94, 23068672
    s_lshl_b32 s24, s3, 6
    s_add_u32 s24, s24, 0
    v_add_u32 v64, s24, v1
    v_and_b32 v65, 7, v64
    v_mul_u32_u24 v65, 1280, v65
    v_lshrrev_b32 v66, 3, v64
    v_lshl_add_u32 v65, v66, 4, v65
    v_cmp_gt_u32 vcc, 640, v64
    v_mov_b32 v67, 2146435072
    s_nop 0
    v_cndmask_b32 v65, v67, v65, vcc
    buffer_load_dwordx4 v[68:71], v65, s[20:23], 0 offen
    v_lshlrev_b32 v64, 4, v64
    s_waitcnt vmcnt(0)
    s_and_saveexec_b64 s[30:31], vcc
    ds_write_b128 v64, v[68:71]
    s_mov_b64 exec, s[30:31]
    s_lshl_b32 s24, s3, 6
    s_add_u32 s24, s24, 256
    v_add_u32 v64, s24, v1
    v_and_b32 v65, 7, v64
    v_mul_u32_u24 v65, 1280, v65
    v_lshrrev_b32 v66, 3, v64
    v_lshl_add_u32 v65, v66, 4, v65
    v_cmp_gt_u32 vcc, 640, v64
    v_mov_b32 v67, 2146435072
    s_nop 0
    v_cndmask_b32 v65, v67, v65, vcc
    buffer_load_dwordx4 v[68:71], v65, s[20:23], 0 offen
    v_lshlrev_b32 v64, 4, v64
    s_waitcnt vmcnt(0)
    s_and_saveexec_b64 s[30:31], vcc
    ds_write_b128 v64, v[68:71]
    s_mov_b64 exec, s[30:31]
    s_lshl_b32 s24, s3, 6
    s_add_u32 s24, s24, 512
    v_add_u32 v64, s24, v1
    v_and_b32 v65, 7, v64
    v_mul_u32_u24 v65, 1280, v65
    v_lshrrev_b32 v66, 3, v64
    v_lshl_add_u32 v65, v66, 4, v65
    v_cmp_gt_u32 vcc, 640, v64
    v_mov_b32 v67, 2146435072
    s_nop 0
    v_cndmask_b32 v65, v67, v65, vcc
    buffer_load_dwordx4 v[68:71], v65, s[20:23], 0 offen
    v_lshlrev_b32 v64, 4, v64
    s_waitcnt vmcnt(0)
    s_and_saveexec_b64 s[30:31], vcc
    ds_write_b128 v64, v[68:71]
    s_mov_b64 exec, s[30:31]
    s_mov_b32 s40, 0
    s_mov_b32 s37, s93
    s_add_u32 s43, s93, 0
    s_lshl_b32 s95, s92, 6
    s_add_u32 s95, s95, s40
    s_add_u32 s95, s95, 1
    s_cmp_ge_i32 s59, s95
    s_cbranch_scc1 interleave_layers__linear_attn_block__memory_aug_recurrent_mem_tr__prompt_kernel_v_ec0_ok
    s_and_b32 s24, s2, 7
    s_lshl_b32 s24, s24, 7
    s_add_u32 s24, s24, 23109632
    v_and_b32 v65, 3, v1
    v_lshl_add_u32 v65, v65, 2, s24
    s_mov_b32 s61, 0
interleave_layers__linear_attn_block__memory_aug_recurrent_mem_tr__prompt_kernel_v_ec0:
    buffer_load_dword v64, v65, s[8:11], 0 offen sc1
    s_waitcnt vmcnt(0)
    v_readlane_b32 s59, v64, 0
    v_readlane_b32 s24, v64, 1
    s_min_i32 s59, s59, s24
    v_readlane_b32 s24, v64, 2
    s_min_i32 s59, s59, s24
    s_cmp_ge_i32 s59, s95
    s_cbranch_scc1 interleave_layers__linear_attn_block__memory_aug_recurrent_mem_tr__prompt_kernel_v_ec0_ok
    s_add_u32 s61, s61, 1
    s_cmp_ge_u32 s61, s60
    s_cbranch_scc1 interleave_layers__linear_attn_block__memory_aug_recurrent_mem_tr__prompt_kernel_v_ec0_to
    s_sleep 2
    s_branch interleave_layers__linear_attn_block__memory_aug_recurrent_mem_tr__prompt_kernel_v_ec0
interleave_layers__linear_attn_block__memory_aug_recurrent_mem_tr__prompt_kernel_v_ec0_to:
    s_mov_b32 s60, 1
interleave_layers__linear_attn_block__memory_aug_recurrent_mem_tr__prompt_kernel_v_ec0_ok:
    v_mov_b32 v16, 0
    v_mov_b32 v17, 0
    v_mov_b32 v18, 0
    v_mov_b32 v19, 0
    v_mov_b32 v20, 0
    v_mov_b32 v21, 0
    v_mov_b32 v22, 0
    v_mov_b32 v23, 0
    v_mov_b32 v24, 0
    v_mov_b32 v25, 0
    v_mov_b32 v26, 0
    v_mov_b32 v27, 0
    v_mov_b32 v28, 0
    v_mov_b32 v29, 0
    v_mov_b32 v30, 0
    v_mov_b32 v31, 0
    v_mov_b32 v32, 0
    v_mov_b32 v33, 0
    v_mov_b32 v34, 0
    v_mov_b32 v35, 0
    v_mov_b32 v36, 0
    v_mov_b32 v37, 0
    v_mov_b32 v38, 0
    v_mov_b32 v39, 0
    v_mov_b32 v40, 0
    v_mov_b32 v41, 0
    v_mov_b32 v42, 0
    v_mov_b32 v43, 0
    v_mov_b32 v44, 0
    v_mov_b32 v45, 0
    v_mov_b32 v46, 0
    v_mov_b32 v47, 0
    v_mov_b32 v48, 0
    v_mov_b32 v49, 0
    v_mov_b32 v50, 0
    v_mov_b32 v51, 0
    v_mov_b32 v52, 0
    v_mov_b32 v53, 0
    v_mov_b32 v54, 0
    v_mov_b32 v55, 0
    v_mov_b32 v56, 0
    v_mov_b32 v57, 0
    v_mov_b32 v58, 0
    v_mov_b32 v59, 0
    v_mov_b32 v60, 0
    v_mov_b32 v61, 0
    v_mov_b32 v62, 0
    v_mov_b32 v63, 0
    v_mov_b32 v64, 0
    v_mov_b32 v65, 0
    v_mov_b32 v66, 0
    v_mov_b32 v67, 0
    s_waitcnt lgkmcnt(0)
    s_barrier
    ds_read_b128 v[68:71], v7
    ds_read_b128 v[72:75], v7 offset:4096
    s_waitcnt lgkmcnt(0)
    s_cmp_eq_u32 s3, 0
    s_cbranch_scc1 interleave_layers__linear_attn_block__memory_aug_recurrent_mem_tr__prompt_kernel_v_gow0
    s_cmp_eq_u32 s3, 1
    s_cbranch_scc1 interleave_layers__linear_attn_block__memory_aug_recurrent_mem_tr__prompt_kernel_v_gow1
    s_cmp_eq_u32 s3, 2
    s_cbranch_scc1 interleave_layers__linear_attn_block__memory_aug_recurrent_mem_tr__prompt_kernel_v_gow2
    s_branch interleave_layers__linear_attn_block__memory_aug_recurrent_mem_tr__prompt_kernel_v_gow3
interleave_layers__linear_attn_block__memory_aug_recurrent_mem_tr__prompt_kernel_v_stepw0:
    v_mov_b32 v16, 0
    v_mov_b32 v17, 0
    v_mov_b32 v18, 0
    v_mov_b32 v19, 0
    v_mov_b32 v20, 0
    v_mov_b32 v21, 0
    v_mov_b32 v22, 0
    v_mov_b32 v23, 0
    v_mov_b32 v24, 0
    v_mov_b32 v25, 0
    v_mov_b32 v26, 0
    v_mov_b32 v27, 0
    v_mov_b32 v28, 0
    v_mov_b32 v29, 0
    v_mov_b32 v30, 0
    v_mov_b32 v31, 0
    v_mov_b32 v32, 0
    v_mov_b32 v33, 0
    v_mov_b32 v34, 0
    v_mov_b32 v35, 0
    v_mov_b32 v36, 0
    v_mov_b32 v37, 0
    v_mov_b32 v38, 0
    v_mov_b32 v39, 0
    v_mov_b32 v40, 0
    v_mov_b32 v41, 0
    v_mov_b32 v42, 0
    v_mov_b32 v43, 0
    v_mov_b32 v44, 0
    v_mov_b32 v45, 0
    v_mov_b32 v46, 0
    v_mov_b32 v47, 0
    v_mov_b32 v48, 0
    v_mov_b32 v49, 0
    v_mov_b32 v50, 0
    v_mov_b32 v51, 0
    v_mov_b32 v52, 0
    v_mov_b32 v53, 0
    v_mov_b32 v54, 0
    v_mov_b32 v55, 0
    v_mov_b32 v56, 0
    v_mov_b32 v57, 0
    v_mov_b32 v58, 0
    v_mov_b32 v59, 0
    v_mov_b32 v60, 0
    v_mov_b32 v61, 0
    v_mov_b32 v62, 0
    v_mov_b32 v63, 0
    v_mov_b32 v64, 0
    v_mov_b32 v65, 0
    v_mov_b32 v66, 0
    v_mov_b32 v67, 0
    s_add_u32 s48, s47, 4096
    s_add_u32 s50, s47, 8192
    s_lshl_b32 s95, s92, 6
    s_add_u32 s95, s95, s40
    s_add_u32 s95, s95, 1
    s_cmp_ge_i32 s59, s95
    s_cbranch_scc1 interleave_layers__linear_attn_block__memory_aug_recurrent_mem_tr__prompt_kernel_v_ecw0_ok
    s_and_b32 s24, s2, 7
    s_lshl_b32 s24, s24, 7
    s_add_u32 s24, s24, 23109632
    v_and_b32 v79, 3, v1
    v_lshl_add_u32 v79, v79, 2, s24
    s_mov_b32 s61, 0
interleave_layers__linear_attn_block__memory_aug_recurrent_mem_tr__prompt_kernel_v_ecw0:
    buffer_load_dword v78, v79, s[8:11], 0 offen sc1
    s_waitcnt vmcnt(0)
    v_readlane_b32 s59, v78, 0
    v_readlane_b32 s24, v78, 1
    s_min_i32 s59, s59, s24
    v_readlane_b32 s24, v78, 2
    s_min_i32 s59, s59, s24
    s_cmp_ge_i32 s59, s95
    s_cbranch_scc1 interleave_layers__linear_attn_block__memory_aug_recurrent_mem_tr__prompt_kernel_v_ecw0_ok
    s_add_u32 s61, s61, 1
    s_cmp_ge_u32 s61, s60
    s_cbranch_scc1 interleave_layers__linear_attn_block__memory_aug_recurrent_mem_tr__prompt_kernel_v_ecw0_to
    s_sleep 2
    s_branch interleave_layers__linear_attn_block__memory_aug_recurrent_mem_tr__prompt_kernel_v_ecw0
interleave_layers__linear_attn_block__memory_aug_recurrent_mem_tr__prompt_kernel_v_ecw0_to:
    s_mov_b32 s60, 1
interleave_layers__linear_attn_block__memory_aug_recurrent_mem_tr__prompt_kernel_v_ecw0_ok:
    s_sleep 20
    s_mov_b64 exec, 1
    s_mov_b32 s61, 0
    v_mov_b32 v81, 0
    buffer_atomic_add v81, v12, s[8:11], s45 offen sc0
    s_sleep 2
    v_mov_b32 v82, 0
    buffer_atomic_add v82, v12, s[8:11], s45 offen sc0
    s_sleep 2
    v_mov_b32 v83, 0
    buffer_atomic_add v83, v12, s[8:11], s45 offen sc0
    s_sleep 2
interleave_layers__linear_attn_block__memory_aug_recurrent_mem_tr__prompt_kernel_v_prw0:
    v_mov_b32 v80, 0
    buffer_atomic_add v80, v12, s[8:11], s45 offen sc0
    s_waitcnt vmcnt(3)
    v_cmp_le_i32 vcc, 9, v81
    s_add_u32 s61, s61, 1
    s_cbranch_vccnz interleave_layers__linear_attn_block__memory_aug_recurrent_mem_tr__prompt_kernel_v_prw0_out
    s_sleep 2
    v_mov_b32 v81, 0
    buffer_atomic_add v81, v12, s[8:11], s45 offen sc0
    s_waitcnt vmcnt(3)
    v_cmp_le_i32 vcc, 9, v82
    s_add_u32 s61, s61, 1
    s_cbranch_vccnz interleave_layers__linear_attn_block__memory_aug_recurrent_mem_tr__prompt_kernel_v_prw0_out
    s_sleep 2
    v_mov_b32 v82, 0
    buffer_atomic_add v82, v12, s[8:11], s45 offen sc0
    s_waitcnt vmcnt(3)
    v_cmp_le_i32 vcc, 9, v83
    s_add_u32 s61, s61, 1
    s_cbranch_vccnz interleave_layers__linear_attn_block__memory_aug_recurrent_mem_tr__prompt_kernel_v_prw0_out
    s_sleep 2
    v_mov_b32 v83, 0
    buffer_atomic_add v83, v12, s[8:11], s45 offen sc0
    s_waitcnt vmcnt(3)
    v_cmp_le_i32 vcc, 9, v80
    s_add_u32 s61, s61, 1
    s_cbranch_vccnz interleave_layers__linear_attn_block__memory_aug_recurrent_mem_tr__prompt_kernel_v_prw0_out
    s_sleep 2
    s_cmp_ge_u32 s61, s60
    s_cbranch_scc0 interleave_layers__linear_attn_block__memory_aug_recurrent_mem_tr__prompt_kernel_v_prw0
    s_mov_b32 s60, 1
interleave_layers__linear_attn_block__memory_aug_recurrent_mem_tr__prompt_kernel_v_prw0_out:
    s_mov_b64 exec, -1
    buffer_load_dwordx4 v[68:71], v7, s[8:11], s47 offen sc1
    buffer_load_dwordx4 v[72:75], v7, s[8:11], s48 offen sc1
    buffer_load_dwordx2 v[76:77], v8, s[8:11], s50 offen sc1
    s_waitcnt vmcnt(0)
    v_max3_u32 v103, v68, v69, v70
    v_max3_u32 v103, v103, v71, v72
    v_max3_u32 v103, v103, v73, v74
    v_max3_u32 v103, v103, v75, v76
    v_max_u32 v103, v103, v77
    v_cmp_eq_u32 vcc, -1, v103
    s_cbranch_vccz interleave_layers__linear_attn_block__memory_aug_recurrent_mem_tr__prompt_kernel_v_pmw0_out
    s_mov_b32 s61, 0
interleave_layers__linear_attn_block__memory_aug_recurrent_mem_tr__prompt_kernel_v_pmw0:
    buffer_load_dwordx4 v[68:71], v7, s[8:11], s47 offen sc1
    buffer_load_dwordx4 v[72:75], v7, s[8:11], s48 offen sc1
    buffer_load_dwordx2 v[76:77], v8, s[8:11], s50 offen sc1
    s_waitcnt vmcnt(0)
    v_max3_u32 v103, v68, v69, v70
    v_max3_u32 v103, v103, v71, v72
    v_max3_u32 v103, v103, v73, v74
    v_max3_u32 v103, v103, v75, v76
    v_max_u32 v103, v103, v77
    v_cmp_eq_u32 vcc, -1, v103
    s_add_u32 s61, s61, 1
    s_cbranch_vccz interleave_layers__linear_attn_block__memory_aug_recurrent_mem_tr__prompt_kernel_v_pmw0_out
    s_cmp_ge_u32 s61, s60
    s_cbranch_scc1 interleave_layers__linear_attn_block__memory_aug_recurrent_mem_tr__prompt_kernel_v_pmw0_to
    s_sleep 1
    s_branch interleave_layers__linear_attn_block__memory_aug_recurrent_mem_tr__prompt_kernel_v_pmw0
interleave_layers__linear_attn_block__memory_aug_recurrent_mem_tr__prompt_kernel_v_pmw0_to:
    s_mov_b32 s60, 1
interleave_layers__linear_attn_block__memory_aug_recurrent_mem_tr__prompt_kernel_v_pmw0_out:
    ds_write_b128 v7, v[68:71]
    ds_write_b128 v7, v[72:75] offset:4096
    ds_write_b64 v8, v[76:77]
interleave_layers__linear_attn_block__memory_aug_recurrent_mem_tr__prompt_kernel_v_gow0:
    v_smfmac_f32_16x16x64_bf16 v[56:59], v[68:71], a[0:7], v4
    v_smfmac_f32_16x16x64_bf16 v[60:63], v[68:71], a[80:87], v4
    v_smfmac_f32_16x16x64_bf16 v[64:67], v[68:71], a[160:167], v4
    s_waitcnt lgkmcnt(0)
    s_barrier
    ds_read_b128 v[80:83], v5 offset:1024
    ds_read_b128 v[84:87], v5 offset:2048
    ds_read_b128 v[88:91], v5 offset:3072
    ds_read_b128 v[92:95], v5 offset:5120
    ds_read_b128 v[96:99], v5 offset:6144
    ds_read_b128 v[100:103], v5 offset:7168
    ds_read_b128 v[76:79], v5 offset:8192
    ds_read_b128 v[68:71], v5 offset:9216
    v_smfmac_f32_16x16x64_bf16 v[64:67], v[72:75], a[192:199], v4
    v_smfmac_f32_16x16x64_bf16 v[56:59], v[72:75], a[32:39], v4
    v_smfmac_f32_16x16x64_bf16 v[60:63], v[72:75], a[112:119], v4
    s_waitcnt lgkmcnt(7)
    v_smfmac_f32_16x16x64_bf16 v[64:67], v[80:83], a[168:175], v4
    s_waitcnt lgkmcnt(6)
    v_smfmac_f32_16x16x64_bf16 v[64:67], v[84:87], a[176:183], v4
    s_waitcnt lgkmcnt(5)
    v_smfmac_f32_16x16x64_bf16 v[64:67], v[88:91], a[184:191], v4
    s_waitcnt lgkmcnt(4)
    v_smfmac_f32_16x16x64_bf16 v[64:67], v[92:95], a[200:207], v4
    s_waitcnt lgkmcnt(3)
    v_smfmac_f32_16x16x64_bf16 v[64:67], v[96:99], a[208:215], v4
    s_waitcnt lgkmcnt(2)
    v_smfmac_f32_16x16x64_bf16 v[64:67], v[100:103], a[216:223], v4
    s_waitcnt lgkmcnt(1)
    v_smfmac_f32_16x16x64_bf16 v[64:67], v[76:79], a[224:231], v4
    s_waitcnt lgkmcnt(0)
    v_smfmac_f32_16x16x64_bf16 v[64:67], v[68:71], a[232:239], v4
    v_smfmac_f32_16x16x64_bf16 v[56:59], v[80:83], a[8:15], v4
    v_smfmac_f32_16x16x64_bf16 v[60:63], v[80:83], a[88:95], v4
    v_smfmac_f32_16x16x64_bf16 v[56:59], v[84:87], a[16:23], v4
    s_nop 4
    v_mov_b32 v72, v64
    v_smfmac_f32_16x16x64_bf16 v[60:63], v[84:87], a[96:103], v4
    v_mov_b32 v73, v65
    v_mov_b32 v74, v66
    v_smfmac_f32_16x16x64_bf16 v[56:59], v[88:91], a[24:31], v4
    v_mov_b32 v75, v67
    v_smfmac_f32_16x16x64_bf16 v[60:63], v[88:91], a[104:111], v4
    v_permlane32_swap_b32 v64, v72
    v_permlane32_swap_b32 v65, v73
    v_smfmac_f32_16x16x64_bf16 v[56:59], v[92:95], a[40:47], v4
    v_permlane32_swap_b32 v66, v74
    v_permlane32_swap_b32 v67, v75
    v_smfmac_f32_16x16x64_bf16 v[60:63], v[92:95], a[120:127], v4
    v_add_f32 v64, v64, v72
    v_add_f32 v65, v65, v73
    v_smfmac_f32_16x16x64_bf16 v[56:59], v[96:99], a[48:55], v4
    v_add_f32 v66, v66, v74
    v_add_f32 v67, v67, v75
    v_smfmac_f32_16x16x64_bf16 v[60:63], v[96:99], a[128:135], v4
    v_cvt_pk_bf16_f32 v72, v64, v65
    v_cvt_pk_bf16_f32 v73, v66, v67
    v_smfmac_f32_16x16x64_bf16 v[56:59], v[100:103], a[56:63], v4
    ds_write_b64 v9, v[72:73] offset:512
    v_smfmac_f32_16x16x64_bf16 v[60:63], v[100:103], a[136:143], v4
    v_smfmac_f32_16x16x64_bf16 v[56:59], v[76:79], a[64:71], v4
    v_smfmac_f32_16x16x64_bf16 v[60:63], v[76:79], a[144:151], v4
    v_smfmac_f32_16x16x64_bf16 v[56:59], v[68:71], a[72:79], v4
    v_smfmac_f32_16x16x64_bf16 v[60:63], v[68:71], a[152:159], v4
    s_nop 7
    v_permlane32_swap_b32 v56, v60
    v_permlane32_swap_b32 v57, v61
    v_permlane32_swap_b32 v58, v62
    v_permlane32_swap_b32 v59, v63
    v_add_f32 v56, v56, v60
    v_add_f32 v57, v57, v61
    v_add_f32 v58, v58, v62
    v_add_f32 v59, v59, v63
    v_cvt_pk_bf16_f32 v68, v56, v57
    v_cvt_pk_bf16_f32 v69, v58, v59
    ds_write_b64 v10, v[68:69]
    s_waitcnt lgkmcnt(0)
    s_barrier
    ds_read_b64_tr_b16 v[68:69], v11 offset:0
    ds_read_b64_tr_b16 v[70:71], v11 offset:128
    ds_read_b64_tr_b16 v[72:73], v11 offset:1024
    ds_read_b64_tr_b16 v[74:75], v11 offset:1152
    ds_read_b64_tr_b16 v[76:77], v11 offset:2048
    ds_read_b64_tr_b16 v[78:79], v11 offset:2176
    ds_read_b128 v[80:83], v6 offset:0
    ds_read_b128 v[84:87], v6 offset:1024
    ds_read_b128 v[88:91], v6 offset:2048
    ds_read_b128 v[92:95], v6 offset:3072
    ds_read_b128 v[96:99], v6 offset:4096
    ds_read_b128 v[100:103], v6 offset:5120
    s_waitcnt lgkmcnt(10)
    v_smfmac_f32_16x16x64_bf16 v[16:19], v[68:71], a[240:247], v4
    v_smfmac_f32_16x16x64_bf16 v[20:23], v[68:71], v[112:119], v4
    v_smfmac_f32_16x16x64_bf16 v[24:27], v[68:71], v[136:143], v4
    v_smfmac_f32_16x16x64_bf16 v[28:31], v[68:71], v[160:167], v4
    s_waitcnt lgkmcnt(8)
    v_smfmac_f32_16x16x64_bf16 v[16:19], v[72:75], a[248:255], v4
    v_smfmac_f32_16x16x64_bf16 v[20:23], v[72:75], v[120:127], v4
    v_smfmac_f32_16x16x64_bf16 v[24:27], v[72:75], v[144:151], v4
    v_smfmac_f32_16x16x64_bf16 v[28:31], v[72:75], v[168:175], v4
    s_waitcnt lgkmcnt(6)
    v_smfmac_f32_16x16x64_bf16 v[16:19], v[76:79], v[104:111], v4
    v_smfmac_f32_16x16x64_bf16 v[20:23], v[76:79], v[128:135], v4
    v_smfmac_f32_16x16x64_bf16 v[24:27], v[76:79], v[152:159], v4
    v_smfmac_f32_16x16x64_bf16 v[28:31], v[76:79], v[176:183], v4
    v_smfmac_f32_16x16x64_bf16 v[32:35], v[68:71], v[184:191], v4
    v_smfmac_f32_16x16x64_bf16 v[36:39], v[68:71], v[208:215], v4
    s_nop 4
    v_permlane32_swap_b32 v16, v24
    v_permlane32_swap_b32 v17, v25
    v_smfmac_f32_16x16x64_bf16 v[40:43], v[68:71], v[232:239], v4
    v_permlane32_swap_b32 v18, v26
    v_permlane32_swap_b32 v19, v27
    s_waitcnt lgkmcnt(4)
    v_smfmac_f32_16x16x64_bf16 v[44:47], v[68:71], v[80:87], v4
    v_add_f32 v16, v16, v24
    v_add_f32 v17, v17, v25
    ds_read_b128 v[80:83], v6 offset:6144
    ds_read_b128 v[84:87], v6 offset:7168
    v_smfmac_f32_16x16x64_bf16 v[32:35], v[72:75], v[192:199], v4
    v_add_f32 v18, v18, v26
    v_add_f32 v19, v19, v27
    v_smfmac_f32_16x16x64_bf16 v[36:39], v[72:75], v[216:223], v4
    v_permlane32_swap_b32 v20, v28
    v_permlane32_swap_b32 v21, v29
    v_smfmac_f32_16x16x64_bf16 v[40:43], v[72:75], v[240:247], v4
    v_permlane32_swap_b32 v22, v30
    v_permlane32_swap_b32 v23, v31
    s_waitcnt lgkmcnt(4)
    v_smfmac_f32_16x16x64_bf16 v[44:47], v[72:75], v[88:95], v4
    v_add_f32 v20, v20, v28
    v_add_f32 v21, v21, v29
    ds_read_b128 v[88:91], v6 offset:8192
    ds_read_b128 v[92:95], v6 offset:9216
    v_smfmac_f32_16x16x64_bf16 v[32:35], v[76:79], v[200:207], v4
    v_add_f32 v22, v22, v30
    v_add_f32 v23, v23, v31
    v_smfmac_f32_16x16x64_bf16 v[36:39], v[76:79], v[224:231], v4
    v_cvt_pk_bf16_f32 v56, v16, v17
    v_cvt_pk_bf16_f32 v57, v18, v19
    v_smfmac_f32_16x16x64_bf16 v[40:43], v[76:79], v[248:255], v4
    v_cvt_pk_bf16_f32 v58, v20, v21
    v_cvt_pk_bf16_f32 v59, v22, v23
    s_waitcnt lgkmcnt(4)
    v_smfmac_f32_16x16x64_bf16 v[44:47], v[76:79], v[96:103], v4
    v_permlane16_swap_b32 v56, v58
    ds_read_b128 v[96:99], v6 offset:10240
    ds_read_b128 v[100:103], v6 offset:11264
    v_permlane16_swap_b32 v57, v59
    v_min_u32 v56, -2, v56
    v_min_u32 v57, -2, v57
    v_min_u32 v58, -2, v58
    v_min_u32 v59, -2, v59
    buffer_store_dwordx4 v[56:59], v14, s[8:11], s43 offen sc1
    s_add_u32 s49, s43, 65536
    s_waitcnt lgkmcnt(4)
    v_smfmac_f32_16x16x64_bf16 v[48:51], v[68:71], v[80:87], v4
    v_permlane32_swap_b32 v32, v40
    v_permlane32_swap_b32 v33, v41
    v_permlane32_swap_b32 v34, v42
    ds_read_b128 v[80:83], v6 offset:12288
    ds_read_b128 v[84:87], v6 offset:13312
    s_waitcnt lgkmcnt(4)
    v_smfmac_f32_16x16x64_bf16 v[48:51], v[72:75], v[88:95], v4
    v_permlane32_swap_b32 v35, v43
    v_add_f32 v32, v32, v40
    v_add_f32 v33, v33, v41
    v_add_f32 v34, v34, v42
    ds_read_b128 v[88:91], v6 offset:14336
    ds_read_b128 v[92:95], v6 offset:15360
    s_waitcnt lgkmcnt(4)
    v_smfmac_f32_16x16x64_bf16 v[48:51], v[76:79], v[96:103], v4
    v_add_f32 v35, v35, v43
    v_permlane32_swap_b32 v36, v44
    v_permlane32_swap_b32 v37, v45
    v_permlane32_swap_b32 v38, v46
    ds_read_b128 v[96:99], v6 offset:16384
    ds_read_b128 v[100:103], v6 offset:17408
    v_permlane32_swap_b32 v39, v47
    v_add_f32 v36, v36, v44
    v_add_f32 v37, v37, v45
    v_add_f32 v38, v38, v46
    s_waitcnt lgkmcnt(4)
    v_smfmac_f32_16x16x64_bf16 v[52:55], v[68:71], v[80:87], v4
    v_add_f32 v39, v39, v47
    v_cvt_pk_bf16_f32 v60, v32, v33
    v_cvt_pk_bf16_f32 v61, v34, v35
    s_waitcnt lgkmcnt(2)
    v_smfmac_f32_16x16x64_bf16 v[52:55], v[72:75], v[88:95], v4
    v_cvt_pk_bf16_f32 v62, v36, v37
    v_cvt_pk_bf16_f32 v63, v38, v39
    s_waitcnt lgkmcnt(0)
    v_smfmac_f32_16x16x64_bf16 v[52:55], v[76:79], v[96:103], v4
    v_permlane16_swap_b32 v60, v62
    v_permlane16_swap_b32 v61, v63
    v_min_u32 v60, -2, v60
    v_min_u32 v61, -2, v61
    v_min_u32 v62, -2, v62
    v_min_u32 v63, -2, v63
    buffer_store_dwordx4 v[60:63], v14, s[8:11], s49 offen sc1
    s_nop 0
    v_permlane32_swap_b32 v48, v52
    v_permlane32_swap_b32 v49, v53
    v_permlane32_swap_b32 v50, v54
    v_permlane32_swap_b32 v51, v55
    v_add_f32 v48, v48, v52
    v_add_f32 v49, v49, v53
    v_add_f32 v50, v50, v54
    v_add_f32 v51, v51, v55
    v_cvt_pk_bf16_f32 v64, v48, v49
    v_cvt_pk_bf16_f32 v65, v50, v51
    v_mov_b32 v66, v64
    v_mov_b32 v67, v65
    s_nop 0
    v_permlane16_swap_b32 v64, v66
    v_permlane16_swap_b32 v65, v67
    v_min_u32 v64, -2, v64
    v_min_u32 v65, -2, v65
    v_min_u32 v66, -2, v66
    v_min_u32 v67, -2, v67
    buffer_store_dwordx4 v[64:67], v15, s[8:11], s43 offen sc1
    s_add_u32 s40, s40, 1
    s_add_u32 s47, s37, 704512
    s_add_u32 s45, s37, 737280
    s_lshl_b32 s24, s40, 12
    s_and_b32 s24, s24, 0x2000
    s_xor_b32 s24, s24, s36
    s_lshl_b32 s37, s40, 20
    s_add_u32 s37, s37, s24
    s_add_u32 s37, s37, 117440512
    s_add_u32 s43, s37, 0
    s_cmp_lt_u32 s40, 64
    s_cbranch_scc1 interleave_layers__linear_attn_block__memory_aug_recurrent_mem_tr__prompt_kernel_v_stepw0
    s_branch interleave_layers__linear_attn_block__memory_aug_recurrent_mem_tr__prompt_kernel_v_end
interleave_layers__linear_attn_block__memory_aug_recurrent_mem_tr__prompt_kernel_v_stepw1:
    v_mov_b32 v16, 0
    v_mov_b32 v17, 0
    v_mov_b32 v18, 0
    v_mov_b32 v19, 0
    v_mov_b32 v20, 0
    v_mov_b32 v21, 0
    v_mov_b32 v22, 0
    v_mov_b32 v23, 0
    v_mov_b32 v24, 0
    v_mov_b32 v25, 0
    v_mov_b32 v26, 0
    v_mov_b32 v27, 0
    v_mov_b32 v28, 0
    v_mov_b32 v29, 0
    v_mov_b32 v30, 0
    v_mov_b32 v31, 0
    v_mov_b32 v32, 0
    v_mov_b32 v33, 0
    v_mov_b32 v34, 0
    v_mov_b32 v35, 0
    v_mov_b32 v36, 0
    v_mov_b32 v37, 0
    v_mov_b32 v38, 0
    v_mov_b32 v39, 0
    v_mov_b32 v40, 0
    v_mov_b32 v41, 0
    v_mov_b32 v42, 0
    v_mov_b32 v43, 0
    v_mov_b32 v44, 0
    v_mov_b32 v45, 0
    v_mov_b32 v46, 0
    v_mov_b32 v47, 0
    v_mov_b32 v48, 0
    v_mov_b32 v49, 0
    v_mov_b32 v50, 0
    v_mov_b32 v51, 0
    v_mov_b32 v52, 0
    v_mov_b32 v53, 0
    v_mov_b32 v54, 0
    v_mov_b32 v55, 0
    v_mov_b32 v56, 0
    v_mov_b32 v57, 0
    v_mov_b32 v58, 0
    v_mov_b32 v59, 0
    v_mov_b32 v60, 0
    v_mov_b32 v61, 0
    v_mov_b32 v62, 0
    v_mov_b32 v63, 0
    v_mov_b32 v64, 0
    v_mov_b32 v65, 0
    v_mov_b32 v66, 0
    v_mov_b32 v67, 0
    s_add_u32 s48, s47, 4096
    s_add_u32 s50, s47, 8192
    s_lshl_b32 s95, s92, 6
    s_add_u32 s95, s95, s40
    s_add_u32 s95, s95, 1
    s_cmp_ge_i32 s59, s95
    s_cbranch_scc1 interleave_layers__linear_attn_block__memory_aug_recurrent_mem_tr__prompt_kernel_v_ecw1_ok
    s_and_b32 s24, s2, 7
    s_lshl_b32 s24, s24, 7
    s_add_u32 s24, s24, 23109632
    v_and_b32 v79, 3, v1
    v_lshl_add_u32 v79, v79, 2, s24
    s_mov_b32 s61, 0
interleave_layers__linear_attn_block__memory_aug_recurrent_mem_tr__prompt_kernel_v_ecw1:
    buffer_load_dword v78, v79, s[8:11], 0 offen sc1
    s_waitcnt vmcnt(0)
    v_readlane_b32 s59, v78, 0
    v_readlane_b32 s24, v78, 1
    s_min_i32 s59, s59, s24
    v_readlane_b32 s24, v78, 2
    s_min_i32 s59, s59, s24
    s_cmp_ge_i32 s59, s95
    s_cbranch_scc1 interleave_layers__linear_attn_block__memory_aug_recurrent_mem_tr__prompt_kernel_v_ecw1_ok
    s_add_u32 s61, s61, 1
    s_cmp_ge_u32 s61, s60
    s_cbranch_scc1 interleave_layers__linear_attn_block__memory_aug_recurrent_mem_tr__prompt_kernel_v_ecw1_to
    s_sleep 2
    s_branch interleave_layers__linear_attn_block__memory_aug_recurrent_mem_tr__prompt_kernel_v_ecw1
interleave_layers__linear_attn_block__memory_aug_recurrent_mem_tr__prompt_kernel_v_ecw1_to:
    s_mov_b32 s60, 1
interleave_layers__linear_attn_block__memory_aug_recurrent_mem_tr__prompt_kernel_v_ecw1_ok:
    s_sleep 20
    s_mov_b64 exec, 1
    s_mov_b32 s61, 0
    v_mov_b32 v81, 0
    buffer_atomic_add v81, v12, s[8:11], s45 offen sc0
    s_sleep 2
    v_mov_b32 v82, 0
    buffer_atomic_add v82, v12, s[8:11], s45 offen sc0
    s_sleep 2
    v_mov_b32 v83, 0
    buffer_atomic_add v83, v12, s[8:11], s45 offen sc0
    s_sleep 2
interleave_layers__linear_attn_block__memory_aug_recurrent_mem_tr__prompt_kernel_v_prw1:
    v_mov_b32 v80, 0
    buffer_atomic_add v80, v12, s[8:11], s45 offen sc0
    s_waitcnt vmcnt(3)
    v_cmp_le_i32 vcc, 9, v81
    s_add_u32 s61, s61, 1
    s_cbranch_vccnz interleave_layers__linear_attn_block__memory_aug_recurrent_mem_tr__prompt_kernel_v_prw1_out
    s_sleep 2
    v_mov_b32 v81, 0
    buffer_atomic_add v81, v12, s[8:11], s45 offen sc0
    s_waitcnt vmcnt(3)
    v_cmp_le_i32 vcc, 9, v82
    s_add_u32 s61, s61, 1
    s_cbranch_vccnz interleave_layers__linear_attn_block__memory_aug_recurrent_mem_tr__prompt_kernel_v_prw1_out
    s_sleep 2
    v_mov_b32 v82, 0
    buffer_atomic_add v82, v12, s[8:11], s45 offen sc0
    s_waitcnt vmcnt(3)
    v_cmp_le_i32 vcc, 9, v83
    s_add_u32 s61, s61, 1
    s_cbranch_vccnz interleave_layers__linear_attn_block__memory_aug_recurrent_mem_tr__prompt_kernel_v_prw1_out
    s_sleep 2
    v_mov_b32 v83, 0
    buffer_atomic_add v83, v12, s[8:11], s45 offen sc0
    s_waitcnt vmcnt(3)
    v_cmp_le_i32 vcc, 9, v80
    s_add_u32 s61, s61, 1
    s_cbranch_vccnz interleave_layers__linear_attn_block__memory_aug_recurrent_mem_tr__prompt_kernel_v_prw1_out
    s_sleep 2
    s_cmp_ge_u32 s61, s60
    s_cbranch_scc0 interleave_layers__linear_attn_block__memory_aug_recurrent_mem_tr__prompt_kernel_v_prw1
    s_mov_b32 s60, 1
interleave_layers__linear_attn_block__memory_aug_recurrent_mem_tr__prompt_kernel_v_prw1_out:
    s_mov_b64 exec, -1
    buffer_load_dwordx4 v[68:71], v7, s[8:11], s47 offen sc1
    buffer_load_dwordx4 v[72:75], v7, s[8:11], s48 offen sc1
    buffer_load_dwordx2 v[76:77], v8, s[8:11], s50 offen sc1
    s_waitcnt vmcnt(0)
    v_max3_u32 v103, v68, v69, v70
    v_max3_u32 v103, v103, v71, v72
    v_max3_u32 v103, v103, v73, v74
    v_max3_u32 v103, v103, v75, v76
    v_max_u32 v103, v103, v77
    v_cmp_eq_u32 vcc, -1, v103
    s_cbranch_vccz interleave_layers__linear_attn_block__memory_aug_recurrent_mem_tr__prompt_kernel_v_pmw1_out
    s_mov_b32 s61, 0
interleave_layers__linear_attn_block__memory_aug_recurrent_mem_tr__prompt_kernel_v_pmw1:
    buffer_load_dwordx4 v[68:71], v7, s[8:11], s47 offen sc1
    buffer_load_dwordx4 v[72:75], v7, s[8:11], s48 offen sc1
    buffer_load_dwordx2 v[76:77], v8, s[8:11], s50 offen sc1
    s_waitcnt vmcnt(0)
    v_max3_u32 v103, v68, v69, v70
    v_max3_u32 v103, v103, v71, v72
    v_max3_u32 v103, v103, v73, v74
    v_max3_u32 v103, v103, v75, v76
    v_max_u32 v103, v103, v77
    v_cmp_eq_u32 vcc, -1, v103
    s_add_u32 s61, s61, 1
    s_cbranch_vccz interleave_layers__linear_attn_block__memory_aug_recurrent_mem_tr__prompt_kernel_v_pmw1_out
    s_cmp_ge_u32 s61, s60
    s_cbranch_scc1 interleave_layers__linear_attn_block__memory_aug_recurrent_mem_tr__prompt_kernel_v_pmw1_to
    s_sleep 1
    s_branch interleave_layers__linear_attn_block__memory_aug_recurrent_mem_tr__prompt_kernel_v_pmw1
interleave_layers__linear_attn_block__memory_aug_recurrent_mem_tr__prompt_kernel_v_pmw1_to:
    s_mov_b32 s60, 1
interleave_layers__linear_attn_block__memory_aug_recurrent_mem_tr__prompt_kernel_v_pmw1_out:
    ds_write_b128 v7, v[68:71]
    ds_write_b128 v7, v[72:75] offset:4096
    ds_write_b64 v8, v[76:77]
interleave_layers__linear_attn_block__memory_aug_recurrent_mem_tr__prompt_kernel_v_gow1:
    v_smfmac_f32_16x16x64_bf16 v[56:59], v[68:71], a[8:15], v4
    v_smfmac_f32_16x16x64_bf16 v[60:63], v[68:71], a[88:95], v4
    v_smfmac_f32_16x16x64_bf16 v[64:67], v[68:71], a[168:175], v4
    s_waitcnt lgkmcnt(0)
    s_barrier
    ds_read_b128 v[80:83], v5 offset:0
    ds_read_b128 v[84:87], v5 offset:2048
    ds_read_b128 v[88:91], v5 offset:3072
    ds_read_b128 v[92:95], v5 offset:4096
    ds_read_b128 v[96:99], v5 offset:6144
    ds_read_b128 v[100:103], v5 offset:7168
    ds_read_b128 v[76:79], v5 offset:8192
    ds_read_b128 v[68:71], v5 offset:9216
    v_smfmac_f32_16x16x64_bf16 v[64:67], v[72:75], a[200:207], v4
    v_smfmac_f32_16x16x64_bf16 v[56:59], v[72:75], a[40:47], v4
    v_smfmac_f32_16x16x64_bf16 v[60:63], v[72:75], a[120:127], v4
    s_waitcnt lgkmcnt(7)
    v_smfmac_f32_16x16x64_bf16 v[64:67], v[80:83], a[160:167], v4
    s_waitcnt lgkmcnt(6)
    v_smfmac_f32_16x16x64_bf16 v[64:67], v[84:87], a[176:183], v4
    s_waitcnt lgkmcnt(5)
    v_smfmac_f32_16x16x64_bf16 v[64:67], v[88:91], a[184:191], v4
    s_waitcnt lgkmcnt(4)
    v_smfmac_f32_16x16x64_bf16 v[64:67], v[92:95], a[192:199], v4
    s_waitcnt lgkmcnt(3)
    v_smfmac_f32_16x16x64_bf16 v[64:67], v[96:99], a[208:215], v4
    s_waitcnt lgkmcnt(2)
    v_smfmac_f32_16x16x64_bf16 v[64:67], v[100:103], a[216:223], v4
    s_waitcnt lgkmcnt(1)
    v_smfmac_f32_16x16x64_bf16 v[64:67], v[76:79], a[224:231], v4
    s_waitcnt lgkmcnt(0)
    v_smfmac_f32_16x16x64_bf16 v[64:67], v[68:71], a[232:239], v4
    v_smfmac_f32_16x16x64_bf16 v[56:59], v[80:83], a[0:7], v4
    v_smfmac_f32_16x16x64_bf16 v[60:63], v[80:83], a[80:87], v4
    v_smfmac_f32_16x16x64_bf16 v[56:59], v[84:87], a[16:23], v4
    s_nop 4
    v_mov_b32 v72, v64
    v_smfmac_f32_16x16x64_bf16 v[60:63], v[84:87], a[96:103], v4
    v_mov_b32 v73, v65
    v_mov_b32 v74, v66
    v_smfmac_f32_16x16x64_bf16 v[56:59], v[88:91], a[24:31], v4
    v_mov_b32 v75, v67
    v_smfmac_f32_16x16x64_bf16 v[60:63], v[88:91], a[104:111], v4
    v_permlane32_swap_b32 v64, v72
    v_permlane32_swap_b32 v65, v73
    v_smfmac_f32_16x16x64_bf16 v[56:59], v[92:95], a[32:39], v4
    v_permlane32_swap_b32 v66, v74
    v_permlane32_swap_b32 v67, v75
    v_smfmac_f32_16x16x64_bf16 v[60:63], v[92:95], a[112:119], v4
    v_add_f32 v64, v64, v72
    v_add_f32 v65, v65, v73
    v_smfmac_f32_16x16x64_bf16 v[56:59], v[96:99], a[48:55], v4
    v_add_f32 v66, v66, v74
    v_add_f32 v67, v67, v75
    v_smfmac_f32_16x16x64_bf16 v[60:63], v[96:99], a[128:135], v4
    v_cvt_pk_bf16_f32 v72, v64, v65
    v_cvt_pk_bf16_f32 v73, v66, v67
    v_smfmac_f32_16x16x64_bf16 v[56:59], v[100:103], a[56:63], v4
    ds_write_b64 v9, v[72:73] offset:512
    v_smfmac_f32_16x16x64_bf16 v[60:63], v[100:103], a[136:143], v4
    v_smfmac_f32_16x16x64_bf16 v[56:59], v[76:79], a[64:71], v4
    v_smfmac_f32_16x16x64_bf16 v[60:63], v[76:79], a[144:151], v4
    v_smfmac_f32_16x16x64_bf16 v[56:59], v[68:71], a[72:79], v4
    v_smfmac_f32_16x16x64_bf16 v[60:63], v[68:71], a[152:159], v4
    s_nop 7
    v_permlane32_swap_b32 v56, v60
    v_permlane32_swap_b32 v57, v61
    v_permlane32_swap_b32 v58, v62
    v_permlane32_swap_b32 v59, v63
    v_add_f32 v56, v56, v60
    v_add_f32 v57, v57, v61
    v_add_f32 v58, v58, v62
    v_add_f32 v59, v59, v63
    v_cvt_pk_bf16_f32 v68, v56, v57
    v_cvt_pk_bf16_f32 v69, v58, v59
    ds_write_b64 v10, v[68:69]
    s_waitcnt lgkmcnt(0)
    s_barrier
    ds_read_b64_tr_b16 v[68:69], v11 offset:0
    ds_read_b64_tr_b16 v[70:71], v11 offset:128
    ds_read_b64_tr_b16 v[72:73], v11 offset:1024
    ds_read_b64_tr_b16 v[74:75], v11 offset:1152
    ds_read_b64_tr_b16 v[76:77], v11 offset:2048
    ds_read_b64_tr_b16 v[78:79], v11 offset:2176
    ds_read_b128 v[80:83], v6 offset:0
    ds_read_b128 v[84:87], v6 offset:1024
    ds_read_b128 v[88:91], v6 offset:2048
    ds_read_b128 v[92:95], v6 offset:3072
    ds_read_b128 v[96:99], v6 offset:4096
    ds_read_b128 v[100:103], v6 offset:5120
    s_waitcnt lgkmcnt(10)
    v_smfmac_f32_16x16x64_bf16 v[16:19], v[68:71], a[240:247], v4
    v_smfmac_f32_16x16x64_bf16 v[20:23], v[68:71], v[112:119], v4
    v_smfmac_f32_16x16x64_bf16 v[24:27], v[68:71], v[136:143], v4
    v_smfmac_f32_16x16x64_bf16 v[28:31], v[68:71], v[160:167], v4
    s_waitcnt lgkmcnt(8)
    v_smfmac_f32_16x16x64_bf16 v[16:19], v[72:75], a[248:255], v4
    v_smfmac_f32_16x16x64_bf16 v[20:23], v[72:75], v[120:127], v4
    v_smfmac_f32_16x16x64_bf16 v[24:27], v[72:75], v[144:151], v4
    v_smfmac_f32_16x16x64_bf16 v[28:31], v[72:75], v[168:175], v4
    s_waitcnt lgkmcnt(6)
    v_smfmac_f32_16x16x64_bf16 v[16:19], v[76:79], v[104:111], v4
    v_smfmac_f32_16x16x64_bf16 v[20:23], v[76:79], v[128:135], v4
    v_smfmac_f32_16x16x64_bf16 v[24:27], v[76:79], v[152:159], v4
    v_smfmac_f32_16x16x64_bf16 v[28:31], v[76:79], v[176:183], v4
    v_smfmac_f32_16x16x64_bf16 v[32:35], v[68:71], v[184:191], v4
    v_smfmac_f32_16x16x64_bf16 v[36:39], v[68:71], v[208:215], v4
    s_nop 4
    v_permlane32_swap_b32 v16, v24
    v_permlane32_swap_b32 v17, v25
    v_smfmac_f32_16x16x64_bf16 v[40:43], v[68:71], v[232:239], v4
    v_permlane32_swap_b32 v18, v26
    v_permlane32_swap_b32 v19, v27
    s_waitcnt lgkmcnt(4)
    v_smfmac_f32_16x16x64_bf16 v[44:47], v[68:71], v[80:87], v4
    v_add_f32 v16, v16, v24
    v_add_f32 v17, v17, v25
    ds_read_b128 v[80:83], v6 offset:6144
    ds_read_b128 v[84:87], v6 offset:7168
    v_smfmac_f32_16x16x64_bf16 v[32:35], v[72:75], v[192:199], v4
    v_add_f32 v18, v18, v26
    v_add_f32 v19, v19, v27
    v_smfmac_f32_16x16x64_bf16 v[36:39], v[72:75], v[216:223], v4
    v_permlane32_swap_b32 v20, v28
    v_permlane32_swap_b32 v21, v29
    v_smfmac_f32_16x16x64_bf16 v[40:43], v[72:75], v[240:247], v4
    v_permlane32_swap_b32 v22, v30
    v_permlane32_swap_b32 v23, v31
    s_waitcnt lgkmcnt(4)
    v_smfmac_f32_16x16x64_bf16 v[44:47], v[72:75], v[88:95], v4
    v_add_f32 v20, v20, v28
    v_add_f32 v21, v21, v29
    ds_read_b128 v[88:91], v6 offset:8192
    ds_read_b128 v[92:95], v6 offset:9216
    v_smfmac_f32_16x16x64_bf16 v[32:35], v[76:79], v[200:207], v4
    v_add_f32 v22, v22, v30
    v_add_f32 v23, v23, v31
    v_smfmac_f32_16x16x64_bf16 v[36:39], v[76:79], v[224:231], v4
    v_cvt_pk_bf16_f32 v56, v16, v17
    v_cvt_pk_bf16_f32 v57, v18, v19
    v_smfmac_f32_16x16x64_bf16 v[40:43], v[76:79], v[248:255], v4
    v_cvt_pk_bf16_f32 v58, v20, v21
    v_cvt_pk_bf16_f32 v59, v22, v23
    s_waitcnt lgkmcnt(4)
    v_smfmac_f32_16x16x64_bf16 v[44:47], v[76:79], v[96:103], v4
    v_permlane16_swap_b32 v56, v58
    ds_read_b128 v[96:99], v6 offset:10240
    ds_read_b128 v[100:103], v6 offset:11264
    v_permlane16_swap_b32 v57, v59
    v_min_u32 v56, -2, v56
    v_min_u32 v57, -2, v57
    v_min_u32 v58, -2, v58
    v_min_u32 v59, -2, v59
    buffer_store_dwordx4 v[56:59], v14, s[8:11], s43 offen sc1
    s_add_u32 s49, s43, 65536
    s_waitcnt lgkmcnt(4)
    v_smfmac_f32_16x16x64_bf16 v[48:51], v[68:71], v[80:87], v4
    v_permlane32_swap_b32 v32, v40
    v_permlane32_swap_b32 v33, v41
    v_permlane32_swap_b32 v34, v42
    ds_read_b128 v[80:83], v6 offset:12288
    ds_read_b128 v[84:87], v6 offset:13312
    s_waitcnt lgkmcnt(4)
    v_smfmac_f32_16x16x64_bf16 v[48:51], v[72:75], v[88:95], v4
    v_permlane32_swap_b32 v35, v43
    v_add_f32 v32, v32, v40
    v_add_f32 v33, v33, v41
    v_add_f32 v34, v34, v42
    ds_read_b128 v[88:91], v6 offset:14336
    ds_read_b128 v[92:95], v6 offset:15360
    s_waitcnt lgkmcnt(4)
    v_smfmac_f32_16x16x64_bf16 v[48:51], v[76:79], v[96:103], v4
    v_add_f32 v35, v35, v43
    v_permlane32_swap_b32 v36, v44
    v_permlane32_swap_b32 v37, v45
    v_permlane32_swap_b32 v38, v46
    ds_read_b128 v[96:99], v6 offset:16384
    ds_read_b128 v[100:103], v6 offset:17408
    v_permlane32_swap_b32 v39, v47
    v_add_f32 v36, v36, v44
    v_add_f32 v37, v37, v45
    v_add_f32 v38, v38, v46
    s_waitcnt lgkmcnt(4)
    v_smfmac_f32_16x16x64_bf16 v[52:55], v[68:71], v[80:87], v4
    v_add_f32 v39, v39, v47
    v_cvt_pk_bf16_f32 v60, v32, v33
    v_cvt_pk_bf16_f32 v61, v34, v35
    s_waitcnt lgkmcnt(2)
    v_smfmac_f32_16x16x64_bf16 v[52:55], v[72:75], v[88:95], v4
    v_cvt_pk_bf16_f32 v62, v36, v37
    v_cvt_pk_bf16_f32 v63, v38, v39
    s_waitcnt lgkmcnt(0)
    v_smfmac_f32_16x16x64_bf16 v[52:55], v[76:79], v[96:103], v4
    v_permlane16_swap_b32 v60, v62
    v_permlane16_swap_b32 v61, v63
    v_min_u32 v60, -2, v60
    v_min_u32 v61, -2, v61
    v_min_u32 v62, -2, v62
    v_min_u32 v63, -2, v63
    buffer_store_dwordx4 v[60:63], v14, s[8:11], s49 offen sc1
    s_nop 0
    v_permlane32_swap_b32 v48, v52
    v_permlane32_swap_b32 v49, v53
    v_permlane32_swap_b32 v50, v54
    v_permlane32_swap_b32 v51, v55
    v_add_f32 v48, v48, v52
    v_add_f32 v49, v49, v53
    v_add_f32 v50, v50, v54
    v_add_f32 v51, v51, v55
    v_cvt_pk_bf16_f32 v64, v48, v49
    v_cvt_pk_bf16_f32 v65, v50, v51
    v_mov_b32 v66, v64
    v_mov_b32 v67, v65
    s_nop 0
    v_permlane16_swap_b32 v64, v66
    v_permlane16_swap_b32 v65, v67
    v_min_u32 v64, -2, v64
    v_min_u32 v65, -2, v65
    v_min_u32 v66, -2, v66
    v_min_u32 v67, -2, v67
    buffer_store_dwordx4 v[64:67], v15, s[8:11], s43 offen sc1
    s_add_u32 s40, s40, 1
    s_add_u32 s47, s37, 704512
    s_add_u32 s45, s37, 737280
    s_lshl_b32 s24, s40, 12
    s_and_b32 s24, s24, 0x2000
    s_xor_b32 s24, s24, s36
    s_lshl_b32 s37, s40, 20
    s_add_u32 s37, s37, s24
    s_add_u32 s37, s37, 117440512
    s_add_u32 s43, s37, 0
    s_cmp_lt_u32 s40, 64
    s_cbranch_scc1 interleave_layers__linear_attn_block__memory_aug_recurrent_mem_tr__prompt_kernel_v_stepw1
    s_branch interleave_layers__linear_attn_block__memory_aug_recurrent_mem_tr__prompt_kernel_v_end
interleave_layers__linear_attn_block__memory_aug_recurrent_mem_tr__prompt_kernel_v_stepw2:
    v_mov_b32 v16, 0
    v_mov_b32 v17, 0
    v_mov_b32 v18, 0
    v_mov_b32 v19, 0
    v_mov_b32 v20, 0
    v_mov_b32 v21, 0
    v_mov_b32 v22, 0
    v_mov_b32 v23, 0
    v_mov_b32 v24, 0
    v_mov_b32 v25, 0
    v_mov_b32 v26, 0
    v_mov_b32 v27, 0
    v_mov_b32 v28, 0
    v_mov_b32 v29, 0
    v_mov_b32 v30, 0
    v_mov_b32 v31, 0
    v_mov_b32 v32, 0
    v_mov_b32 v33, 0
    v_mov_b32 v34, 0
    v_mov_b32 v35, 0
    v_mov_b32 v36, 0
    v_mov_b32 v37, 0
    v_mov_b32 v38, 0
    v_mov_b32 v39, 0
    v_mov_b32 v40, 0
    v_mov_b32 v41, 0
    v_mov_b32 v42, 0
    v_mov_b32 v43, 0
    v_mov_b32 v44, 0
    v_mov_b32 v45, 0
    v_mov_b32 v46, 0
    v_mov_b32 v47, 0
    v_mov_b32 v48, 0
    v_mov_b32 v49, 0
    v_mov_b32 v50, 0
    v_mov_b32 v51, 0
    v_mov_b32 v52, 0
    v_mov_b32 v53, 0
    v_mov_b32 v54, 0
    v_mov_b32 v55, 0
    v_mov_b32 v56, 0
    v_mov_b32 v57, 0
    v_mov_b32 v58, 0
    v_mov_b32 v59, 0
    v_mov_b32 v60, 0
    v_mov_b32 v61, 0
    v_mov_b32 v62, 0
    v_mov_b32 v63, 0
    v_mov_b32 v64, 0
    v_mov_b32 v65, 0
    v_mov_b32 v66, 0
    v_mov_b32 v67, 0
    s_add_u32 s48, s47, 4096
    s_add_u32 s50, s47, 8192
    s_lshl_b32 s95, s92, 6
    s_add_u32 s95, s95, s40
    s_add_u32 s95, s95, 1
    s_cmp_ge_i32 s59, s95
    s_cbranch_scc1 interleave_layers__linear_attn_block__memory_aug_recurrent_mem_tr__prompt_kernel_v_ecw2_ok
    s_and_b32 s24, s2, 7
    s_lshl_b32 s24, s24, 7
    s_add_u32 s24, s24, 23109632
    v_and_b32 v79, 3, v1
    v_lshl_add_u32 v79, v79, 2, s24
    s_mov_b32 s61, 0
interleave_layers__linear_attn_block__memory_aug_recurrent_mem_tr__prompt_kernel_v_ecw2:
    buffer_load_dword v78, v79, s[8:11], 0 offen sc1
    s_waitcnt vmcnt(0)
    v_readlane_b32 s59, v78, 0
    v_readlane_b32 s24, v78, 1
    s_min_i32 s59, s59, s24
    v_readlane_b32 s24, v78, 2
    s_min_i32 s59, s59, s24
    s_cmp_ge_i32 s59, s95
    s_cbranch_scc1 interleave_layers__linear_attn_block__memory_aug_recurrent_mem_tr__prompt_kernel_v_ecw2_ok
    s_add_u32 s61, s61, 1
    s_cmp_ge_u32 s61, s60
    s_cbranch_scc1 interleave_layers__linear_attn_block__memory_aug_recurrent_mem_tr__prompt_kernel_v_ecw2_to
    s_sleep 2
    s_branch interleave_layers__linear_attn_block__memory_aug_recurrent_mem_tr__prompt_kernel_v_ecw2
interleave_layers__linear_attn_block__memory_aug_recurrent_mem_tr__prompt_kernel_v_ecw2_to:
    s_mov_b32 s60, 1
interleave_layers__linear_attn_block__memory_aug_recurrent_mem_tr__prompt_kernel_v_ecw2_ok:
    s_sleep 20
    s_mov_b64 exec, 1
    s_mov_b32 s61, 0
    v_mov_b32 v81, 0
    buffer_atomic_add v81, v12, s[8:11], s45 offen sc0
    s_sleep 2
    v_mov_b32 v82, 0
    buffer_atomic_add v82, v12, s[8:11], s45 offen sc0
    s_sleep 2
    v_mov_b32 v83, 0
    buffer_atomic_add v83, v12, s[8:11], s45 offen sc0
    s_sleep 2
interleave_layers__linear_attn_block__memory_aug_recurrent_mem_tr__prompt_kernel_v_prw2:
    v_mov_b32 v80, 0
    buffer_atomic_add v80, v12, s[8:11], s45 offen sc0
    s_waitcnt vmcnt(3)
    v_cmp_le_i32 vcc, 9, v81
    s_add_u32 s61, s61, 1
    s_cbranch_vccnz interleave_layers__linear_attn_block__memory_aug_recurrent_mem_tr__prompt_kernel_v_prw2_out
    s_sleep 2
    v_mov_b32 v81, 0
    buffer_atomic_add v81, v12, s[8:11], s45 offen sc0
    s_waitcnt vmcnt(3)
    v_cmp_le_i32 vcc, 9, v82
    s_add_u32 s61, s61, 1
    s_cbranch_vccnz interleave_layers__linear_attn_block__memory_aug_recurrent_mem_tr__prompt_kernel_v_prw2_out
    s_sleep 2
    v_mov_b32 v82, 0
    buffer_atomic_add v82, v12, s[8:11], s45 offen sc0
    s_waitcnt vmcnt(3)
    v_cmp_le_i32 vcc, 9, v83
    s_add_u32 s61, s61, 1
    s_cbranch_vccnz interleave_layers__linear_attn_block__memory_aug_recurrent_mem_tr__prompt_kernel_v_prw2_out
    s_sleep 2
    v_mov_b32 v83, 0
    buffer_atomic_add v83, v12, s[8:11], s45 offen sc0
    s_waitcnt vmcnt(3)
    v_cmp_le_i32 vcc, 9, v80
    s_add_u32 s61, s61, 1
    s_cbranch_vccnz interleave_layers__linear_attn_block__memory_aug_recurrent_mem_tr__prompt_kernel_v_prw2_out
    s_sleep 2
    s_cmp_ge_u32 s61, s60
    s_cbranch_scc0 interleave_layers__linear_attn_block__memory_aug_recurrent_mem_tr__prompt_kernel_v_prw2
    s_mov_b32 s60, 1
interleave_layers__linear_attn_block__memory_aug_recurrent_mem_tr__prompt_kernel_v_prw2_out:
    s_mov_b64 exec, -1
    buffer_load_dwordx4 v[68:71], v7, s[8:11], s47 offen sc1
    buffer_load_dwordx4 v[72:75], v7, s[8:11], s48 offen sc1
    buffer_load_dwordx2 v[76:77], v8, s[8:11], s50 offen sc1
    s_waitcnt vmcnt(0)
    v_max3_u32 v103, v68, v69, v70
    v_max3_u32 v103, v103, v71, v72
    v_max3_u32 v103, v103, v73, v74
    v_max3_u32 v103, v103, v75, v76
    v_max_u32 v103, v103, v77
    v_cmp_eq_u32 vcc, -1, v103
    s_cbranch_vccz interleave_layers__linear_attn_block__memory_aug_recurrent_mem_tr__prompt_kernel_v_pmw2_out
    s_mov_b32 s61, 0
interleave_layers__linear_attn_block__memory_aug_recurrent_mem_tr__prompt_kernel_v_pmw2:
    buffer_load_dwordx4 v[68:71], v7, s[8:11], s47 offen sc1
    buffer_load_dwordx4 v[72:75], v7, s[8:11], s48 offen sc1
    buffer_load_dwordx2 v[76:77], v8, s[8:11], s50 offen sc1
    s_waitcnt vmcnt(0)
    v_max3_u32 v103, v68, v69, v70
    v_max3_u32 v103, v103, v71, v72
    v_max3_u32 v103, v103, v73, v74
    v_max3_u32 v103, v103, v75, v76
    v_max_u32 v103, v103, v77
    v_cmp_eq_u32 vcc, -1, v103
    s_add_u32 s61, s61, 1
    s_cbranch_vccz interleave_layers__linear_attn_block__memory_aug_recurrent_mem_tr__prompt_kernel_v_pmw2_out
    s_cmp_ge_u32 s61, s60
    s_cbranch_scc1 interleave_layers__linear_attn_block__memory_aug_recurrent_mem_tr__prompt_kernel_v_pmw2_to
    s_sleep 1
    s_branch interleave_layers__linear_attn_block__memory_aug_recurrent_mem_tr__prompt_kernel_v_pmw2
interleave_layers__linear_attn_block__memory_aug_recurrent_mem_tr__prompt_kernel_v_pmw2_to:
    s_mov_b32 s60, 1
interleave_layers__linear_attn_block__memory_aug_recurrent_mem_tr__prompt_kernel_v_pmw2_out:
    ds_write_b128 v7, v[68:71]
    ds_write_b128 v7, v[72:75] offset:4096
    ds_write_b64 v8, v[76:77]
interleave_layers__linear_attn_block__memory_aug_recurrent_mem_tr__prompt_kernel_v_gow2:
    v_smfmac_f32_16x16x64_bf16 v[56:59], v[68:71], a[16:23], v4
    v_smfmac_f32_16x16x64_bf16 v[60:63], v[68:71], a[96:103], v4
    v_smfmac_f32_16x16x64_bf16 v[64:67], v[68:71], a[176:183], v4
    s_waitcnt lgkmcnt(0)
    s_barrier
    ds_read_b128 v[80:83], v5 offset:0
    ds_read_b128 v[84:87], v5 offset:1024
    ds_read_b128 v[88:91], v5 offset:3072
    ds_read_b128 v[92:95], v5 offset:4096
    ds_read_b128 v[96:99], v5 offset:5120
    ds_read_b128 v[100:103], v5 offset:7168
    ds_read_b128 v[76:79], v5 offset:8192
    ds_read_b128 v[68:71], v5 offset:9216
    v_smfmac_f32_16x16x64_bf16 v[64:67], v[72:75], a[208:215], v4
    v_smfmac_f32_16x16x64_bf16 v[56:59], v[72:75], a[48:55], v4
    v_smfmac_f32_16x16x64_bf16 v[60:63], v[72:75], a[128:135], v4
    s_waitcnt lgkmcnt(7)
    v_smfmac_f32_16x16x64_bf16 v[64:67], v[80:83], a[160:167], v4
    s_waitcnt lgkmcnt(6)
    v_smfmac_f32_16x16x64_bf16 v[64:67], v[84:87], a[168:175], v4
    s_waitcnt lgkmcnt(5)
    v_smfmac_f32_16x16x64_bf16 v[64:67], v[88:91], a[184:191], v4
    s_waitcnt lgkmcnt(4)
    v_smfmac_f32_16x16x64_bf16 v[64:67], v[92:95], a[192:199], v4
    s_waitcnt lgkmcnt(3)
    v_smfmac_f32_16x16x64_bf16 v[64:67], v[96:99], a[200:207], v4
    s_waitcnt lgkmcnt(2)
    v_smfmac_f32_16x16x64_bf16 v[64:67], v[100:103], a[216:223], v4
    s_waitcnt lgkmcnt(1)
    v_smfmac_f32_16x16x64_bf16 v[64:67], v[76:79], a[224:231], v4
    s_waitcnt lgkmcnt(0)
    v_smfmac_f32_16x16x64_bf16 v[64:67], v[68:71], a[232:239], v4
    v_smfmac_f32_16x16x64_bf16 v[56:59], v[80:83], a[0:7], v4
    v_smfmac_f32_16x16x64_bf16 v[60:63], v[80:83], a[80:87], v4
    v_smfmac_f32_16x16x64_bf16 v[56:59], v[84:87], a[8:15], v4
    s_nop 4
    v_mov_b32 v72, v64
    v_smfmac_f32_16x16x64_bf16 v[60:63], v[84:87], a[88:95], v4
    v_mov_b32 v73, v65
    v_mov_b32 v74, v66
    v_smfmac_f32_16x16x64_bf16 v[56:59], v[88:91], a[24:31], v4
    v_mov_b32 v75, v67
    v_smfmac_f32_16x16x64_bf16 v[60:63], v[88:91], a[104:111], v4
    v_permlane32_swap_b32 v64, v72
    v_permlane32_swap_b32 v65, v73
    v_smfmac_f32_16x16x64_bf16 v[56:59], v[92:95], a[32:39], v4
    v_permlane32_swap_b32 v66, v74
    v_permlane32_swap_b32 v67, v75
    v_smfmac_f32_16x16x64_bf16 v[60:63], v[92:95], a[112:119], v4
    v_add_f32 v64, v64, v72
    v_add_f32 v65, v65, v73
    v_smfmac_f32_16x16x64_bf16 v[56:59], v[96:99], a[40:47], v4
    v_add_f32 v66, v66, v74
    v_add_f32 v67, v67, v75
    v_smfmac_f32_16x16x64_bf16 v[60:63], v[96:99], a[120:127], v4
    v_cvt_pk_bf16_f32 v72, v64, v65
    v_cvt_pk_bf16_f32 v73, v66, v67
    v_smfmac_f32_16x16x64_bf16 v[56:59], v[100:103], a[56:63], v4
    ds_write_b64 v9, v[72:73] offset:512
    v_smfmac_f32_16x16x64_bf16 v[60:63], v[100:103], a[136:143], v4
    v_smfmac_f32_16x16x64_bf16 v[56:59], v[76:79], a[64:71], v4
    v_smfmac_f32_16x16x64_bf16 v[60:63], v[76:79], a[144:151], v4
    v_smfmac_f32_16x16x64_bf16 v[56:59], v[68:71], a[72:79], v4
    v_smfmac_f32_16x16x64_bf16 v[60:63], v[68:71], a[152:159], v4
    s_nop 7
    v_permlane32_swap_b32 v56, v60
    v_permlane32_swap_b32 v57, v61
    v_permlane32_swap_b32 v58, v62
    v_permlane32_swap_b32 v59, v63
    v_add_f32 v56, v56, v60
    v_add_f32 v57, v57, v61
    v_add_f32 v58, v58, v62
    v_add_f32 v59, v59, v63
    v_cvt_pk_bf16_f32 v68, v56, v57
    v_cvt_pk_bf16_f32 v69, v58, v59
    ds_write_b64 v10, v[68:69]
    s_waitcnt lgkmcnt(0)
    s_barrier
    ds_read_b64_tr_b16 v[68:69], v11 offset:0
    ds_read_b64_tr_b16 v[70:71], v11 offset:128
    ds_read_b64_tr_b16 v[72:73], v11 offset:1024
    ds_read_b64_tr_b16 v[74:75], v11 offset:1152
    ds_read_b64_tr_b16 v[76:77], v11 offset:2048
    ds_read_b64_tr_b16 v[78:79], v11 offset:2176
    ds_read_b128 v[80:83], v6 offset:0
    ds_read_b128 v[84:87], v6 offset:1024
    ds_read_b128 v[88:91], v6 offset:2048
    ds_read_b128 v[92:95], v6 offset:3072
    ds_read_b128 v[96:99], v6 offset:4096
    ds_read_b128 v[100:103], v6 offset:5120
    s_waitcnt lgkmcnt(10)
    v_smfmac_f32_16x16x64_bf16 v[16:19], v[68:71], a[240:247], v4
    v_smfmac_f32_16x16x64_bf16 v[20:23], v[68:71], v[112:119], v4
    v_smfmac_f32_16x16x64_bf16 v[24:27], v[68:71], v[136:143], v4
    v_smfmac_f32_16x16x64_bf16 v[28:31], v[68:71], v[160:167], v4
    s_waitcnt lgkmcnt(8)
    v_smfmac_f32_16x16x64_bf16 v[16:19], v[72:75], a[248:255], v4
    v_smfmac_f32_16x16x64_bf16 v[20:23], v[72:75], v[120:127], v4
    v_smfmac_f32_16x16x64_bf16 v[24:27], v[72:75], v[144:151], v4
    v_smfmac_f32_16x16x64_bf16 v[28:31], v[72:75], v[168:175], v4
    s_waitcnt lgkmcnt(6)
    v_smfmac_f32_16x16x64_bf16 v[16:19], v[76:79], v[104:111], v4
    v_smfmac_f32_16x16x64_bf16 v[20:23], v[76:79], v[128:135], v4
    v_smfmac_f32_16x16x64_bf16 v[24:27], v[76:79], v[152:159], v4
    v_smfmac_f32_16x16x64_bf16 v[28:31], v[76:79], v[176:183], v4
    v_smfmac_f32_16x16x64_bf16 v[32:35], v[68:71], v[184:191], v4
    v_smfmac_f32_16x16x64_bf16 v[36:39], v[68:71], v[208:215], v4
    s_nop 4
    v_permlane32_swap_b32 v16, v24
    v_permlane32_swap_b32 v17, v25
    v_smfmac_f32_16x16x64_bf16 v[40:43], v[68:71], v[232:239], v4
    v_permlane32_swap_b32 v18, v26
    v_permlane32_swap_b32 v19, v27
    s_waitcnt lgkmcnt(4)
    v_smfmac_f32_16x16x64_bf16 v[44:47], v[68:71], v[80:87], v4
    v_add_f32 v16, v16, v24
    v_add_f32 v17, v17, v25
    ds_read_b128 v[80:83], v6 offset:6144
    ds_read_b128 v[84:87], v6 offset:7168
    v_smfmac_f32_16x16x64_bf16 v[32:35], v[72:75], v[192:199], v4
    v_add_f32 v18, v18, v26
    v_add_f32 v19, v19, v27
    v_smfmac_f32_16x16x64_bf16 v[36:39], v[72:75], v[216:223], v4
    v_permlane32_swap_b32 v20, v28
    v_permlane32_swap_b32 v21, v29
    v_smfmac_f32_16x16x64_bf16 v[40:43], v[72:75], v[240:247], v4
    v_permlane32_swap_b32 v22, v30
    v_permlane32_swap_b32 v23, v31
    s_waitcnt lgkmcnt(4)
    v_smfmac_f32_16x16x64_bf16 v[44:47], v[72:75], v[88:95], v4
    v_add_f32 v20, v20, v28
    v_add_f32 v21, v21, v29
    ds_read_b128 v[88:91], v6 offset:8192
    ds_read_b128 v[92:95], v6 offset:9216
    v_smfmac_f32_16x16x64_bf16 v[32:35], v[76:79], v[200:207], v4
    v_add_f32 v22, v22, v30
    v_add_f32 v23, v23, v31
    v_smfmac_f32_16x16x64_bf16 v[36:39], v[76:79], v[224:231], v4
    v_cvt_pk_bf16_f32 v56, v16, v17
    v_cvt_pk_bf16_f32 v57, v18, v19
    v_smfmac_f32_16x16x64_bf16 v[40:43], v[76:79], v[248:255], v4
    v_cvt_pk_bf16_f32 v58, v20, v21
    v_cvt_pk_bf16_f32 v59, v22, v23
    s_waitcnt lgkmcnt(4)
    v_smfmac_f32_16x16x64_bf16 v[44:47], v[76:79], v[96:103], v4
    v_permlane16_swap_b32 v56, v58
    ds_read_b128 v[96:99], v6 offset:10240
    ds_read_b128 v[100:103], v6 offset:11264
    v_permlane16_swap_b32 v57, v59
    v_min_u32 v56, -2, v56
    v_min_u32 v57, -2, v57
    v_min_u32 v58, -2, v58
    v_min_u32 v59, -2, v59
    buffer_store_dwordx4 v[56:59], v14, s[8:11], s43 offen sc1
    s_add_u32 s49, s43, 65536
    s_waitcnt lgkmcnt(4)
    v_smfmac_f32_16x16x64_bf16 v[48:51], v[68:71], v[80:87], v4
    v_permlane32_swap_b32 v32, v40
    v_permlane32_swap_b32 v33, v41
    v_permlane32_swap_b32 v34, v42
    ds_read_b128 v[80:83], v6 offset:12288
    ds_read_b128 v[84:87], v6 offset:13312
    s_waitcnt lgkmcnt(4)
    v_smfmac_f32_16x16x64_bf16 v[48:51], v[72:75], v[88:95], v4
    v_permlane32_swap_b32 v35, v43
    v_add_f32 v32, v32, v40
    v_add_f32 v33, v33, v41
    v_add_f32 v34, v34, v42
    ds_read_b128 v[88:91], v6 offset:14336
    ds_read_b128 v[92:95], v6 offset:15360
    s_waitcnt lgkmcnt(4)
    v_smfmac_f32_16x16x64_bf16 v[48:51], v[76:79], v[96:103], v4
    v_add_f32 v35, v35, v43
    v_permlane32_swap_b32 v36, v44
    v_permlane32_swap_b32 v37, v45
    v_permlane32_swap_b32 v38, v46
    ds_read_b128 v[96:99], v6 offset:16384
    ds_read_b128 v[100:103], v6 offset:17408
    v_permlane32_swap_b32 v39, v47
    v_add_f32 v36, v36, v44
    v_add_f32 v37, v37, v45
    v_add_f32 v38, v38, v46
    s_waitcnt lgkmcnt(4)
    v_smfmac_f32_16x16x64_bf16 v[52:55], v[68:71], v[80:87], v4
    v_add_f32 v39, v39, v47
    v_cvt_pk_bf16_f32 v60, v32, v33
    v_cvt_pk_bf16_f32 v61, v34, v35
    s_waitcnt lgkmcnt(2)
    v_smfmac_f32_16x16x64_bf16 v[52:55], v[72:75], v[88:95], v4
    v_cvt_pk_bf16_f32 v62, v36, v37
    v_cvt_pk_bf16_f32 v63, v38, v39
    s_waitcnt lgkmcnt(0)
    v_smfmac_f32_16x16x64_bf16 v[52:55], v[76:79], v[96:103], v4
    v_permlane16_swap_b32 v60, v62
    v_permlane16_swap_b32 v61, v63
    v_min_u32 v60, -2, v60
    v_min_u32 v61, -2, v61
    v_min_u32 v62, -2, v62
    v_min_u32 v63, -2, v63
    buffer_store_dwordx4 v[60:63], v14, s[8:11], s49 offen sc1
    s_nop 0
    v_permlane32_swap_b32 v48, v52
    v_permlane32_swap_b32 v49, v53
    v_permlane32_swap_b32 v50, v54
    v_permlane32_swap_b32 v51, v55
    v_add_f32 v48, v48, v52
    v_add_f32 v49, v49, v53
    v_add_f32 v50, v50, v54
    v_add_f32 v51, v51, v55
    v_cvt_pk_bf16_f32 v64, v48, v49
    v_cvt_pk_bf16_f32 v65, v50, v51
    v_mov_b32 v66, v64
    v_mov_b32 v67, v65
    s_nop 0
    v_permlane16_swap_b32 v64, v66
    v_permlane16_swap_b32 v65, v67
    v_min_u32 v64, -2, v64
    v_min_u32 v65, -2, v65
    v_min_u32 v66, -2, v66
    v_min_u32 v67, -2, v67
    buffer_store_dwordx4 v[64:67], v15, s[8:11], s43 offen sc1
    s_add_u32 s40, s40, 1
    s_add_u32 s47, s37, 704512
    s_add_u32 s45, s37, 737280
    s_lshl_b32 s24, s40, 12
    s_and_b32 s24, s24, 0x2000
    s_xor_b32 s24, s24, s36
    s_lshl_b32 s37, s40, 20
    s_add_u32 s37, s37, s24
    s_add_u32 s37, s37, 117440512
    s_add_u32 s43, s37, 0
    s_cmp_lt_u32 s40, 64
    s_cbranch_scc1 interleave_layers__linear_attn_block__memory_aug_recurrent_mem_tr__prompt_kernel_v_stepw2
    s_branch interleave_layers__linear_attn_block__memory_aug_recurrent_mem_tr__prompt_kernel_v_end
interleave_layers__linear_attn_block__memory_aug_recurrent_mem_tr__prompt_kernel_v_stepw3:
    v_mov_b32 v16, 0
    v_mov_b32 v17, 0
    v_mov_b32 v18, 0
    v_mov_b32 v19, 0
    v_mov_b32 v20, 0
    v_mov_b32 v21, 0
    v_mov_b32 v22, 0
    v_mov_b32 v23, 0
    v_mov_b32 v24, 0
    v_mov_b32 v25, 0
    v_mov_b32 v26, 0
    v_mov_b32 v27, 0
    v_mov_b32 v28, 0
    v_mov_b32 v29, 0
    v_mov_b32 v30, 0
    v_mov_b32 v31, 0
    v_mov_b32 v32, 0
    v_mov_b32 v33, 0
    v_mov_b32 v34, 0
    v_mov_b32 v35, 0
    v_mov_b32 v36, 0
    v_mov_b32 v37, 0
    v_mov_b32 v38, 0
    v_mov_b32 v39, 0
    v_mov_b32 v40, 0
    v_mov_b32 v41, 0
    v_mov_b32 v42, 0
    v_mov_b32 v43, 0
    v_mov_b32 v44, 0
    v_mov_b32 v45, 0
    v_mov_b32 v46, 0
    v_mov_b32 v47, 0
    v_mov_b32 v48, 0
    v_mov_b32 v49, 0
    v_mov_b32 v50, 0
    v_mov_b32 v51, 0
    v_mov_b32 v52, 0
    v_mov_b32 v53, 0
    v_mov_b32 v54, 0
    v_mov_b32 v55, 0
    v_mov_b32 v56, 0
    v_mov_b32 v57, 0
    v_mov_b32 v58, 0
    v_mov_b32 v59, 0
    v_mov_b32 v60, 0
    v_mov_b32 v61, 0
    v_mov_b32 v62, 0
    v_mov_b32 v63, 0
    v_mov_b32 v64, 0
    v_mov_b32 v65, 0
    v_mov_b32 v66, 0
    v_mov_b32 v67, 0
    s_add_u32 s48, s47, 4096
    s_add_u32 s50, s47, 8192
    s_lshl_b32 s95, s92, 6
    s_add_u32 s95, s95, s40
    s_add_u32 s95, s95, 1
    s_cmp_ge_i32 s59, s95
    s_cbranch_scc1 interleave_layers__linear_attn_block__memory_aug_recurrent_mem_tr__prompt_kernel_v_ecw3_ok
    s_and_b32 s24, s2, 7
    s_lshl_b32 s24, s24, 7
    s_add_u32 s24, s24, 23109632
    v_and_b32 v79, 3, v1
    v_lshl_add_u32 v79, v79, 2, s24
    s_mov_b32 s61, 0
interleave_layers__linear_attn_block__memory_aug_recurrent_mem_tr__prompt_kernel_v_ecw3:
    buffer_load_dword v78, v79, s[8:11], 0 offen sc1
    s_waitcnt vmcnt(0)
    v_readlane_b32 s59, v78, 0
    v_readlane_b32 s24, v78, 1
    s_min_i32 s59, s59, s24
    v_readlane_b32 s24, v78, 2
    s_min_i32 s59, s59, s24
    s_cmp_ge_i32 s59, s95
    s_cbranch_scc1 interleave_layers__linear_attn_block__memory_aug_recurrent_mem_tr__prompt_kernel_v_ecw3_ok
    s_add_u32 s61, s61, 1
    s_cmp_ge_u32 s61, s60
    s_cbranch_scc1 interleave_layers__linear_attn_block__memory_aug_recurrent_mem_tr__prompt_kernel_v_ecw3_to
    s_sleep 2
    s_branch interleave_layers__linear_attn_block__memory_aug_recurrent_mem_tr__prompt_kernel_v_ecw3
interleave_layers__linear_attn_block__memory_aug_recurrent_mem_tr__prompt_kernel_v_ecw3_to:
    s_mov_b32 s60, 1
interleave_layers__linear_attn_block__memory_aug_recurrent_mem_tr__prompt_kernel_v_ecw3_ok:
    s_sleep 20
    s_mov_b64 exec, 1
    s_mov_b32 s61, 0
    v_mov_b32 v81, 0
    buffer_atomic_add v81, v12, s[8:11], s45 offen sc0
    s_sleep 2
    v_mov_b32 v82, 0
    buffer_atomic_add v82, v12, s[8:11], s45 offen sc0
    s_sleep 2
    v_mov_b32 v83, 0
    buffer_atomic_add v83, v12, s[8:11], s45 offen sc0
    s_sleep 2
interleave_layers__linear_attn_block__memory_aug_recurrent_mem_tr__prompt_kernel_v_prw3:
    v_mov_b32 v80, 0
    buffer_atomic_add v80, v12, s[8:11], s45 offen sc0
    s_waitcnt vmcnt(3)
    v_cmp_le_i32 vcc, 9, v81
    s_add_u32 s61, s61, 1
    s_cbranch_vccnz interleave_layers__linear_attn_block__memory_aug_recurrent_mem_tr__prompt_kernel_v_prw3_out
    s_sleep 2
    v_mov_b32 v81, 0
    buffer_atomic_add v81, v12, s[8:11], s45 offen sc0
    s_waitcnt vmcnt(3)
    v_cmp_le_i32 vcc, 9, v82
    s_add_u32 s61, s61, 1
    s_cbranch_vccnz interleave_layers__linear_attn_block__memory_aug_recurrent_mem_tr__prompt_kernel_v_prw3_out
    s_sleep 2
    v_mov_b32 v82, 0
    buffer_atomic_add v82, v12, s[8:11], s45 offen sc0
    s_waitcnt vmcnt(3)
    v_cmp_le_i32 vcc, 9, v83
    s_add_u32 s61, s61, 1
    s_cbranch_vccnz interleave_layers__linear_attn_block__memory_aug_recurrent_mem_tr__prompt_kernel_v_prw3_out
    s_sleep 2
    v_mov_b32 v83, 0
    buffer_atomic_add v83, v12, s[8:11], s45 offen sc0
    s_waitcnt vmcnt(3)
    v_cmp_le_i32 vcc, 9, v80
    s_add_u32 s61, s61, 1
    s_cbranch_vccnz interleave_layers__linear_attn_block__memory_aug_recurrent_mem_tr__prompt_kernel_v_prw3_out
    s_sleep 2
    s_cmp_ge_u32 s61, s60
    s_cbranch_scc0 interleave_layers__linear_attn_block__memory_aug_recurrent_mem_tr__prompt_kernel_v_prw3
    s_mov_b32 s60, 1
interleave_layers__linear_attn_block__memory_aug_recurrent_mem_tr__prompt_kernel_v_prw3_out:
    s_mov_b64 exec, -1
    buffer_load_dwordx4 v[68:71], v7, s[8:11], s47 offen sc1
    buffer_load_dwordx4 v[72:75], v7, s[8:11], s48 offen sc1
    buffer_load_dwordx2 v[76:77], v8, s[8:11], s50 offen sc1
    s_waitcnt vmcnt(0)
    v_max3_u32 v103, v68, v69, v70
    v_max3_u32 v103, v103, v71, v72
    v_max3_u32 v103, v103, v73, v74
    v_max3_u32 v103, v103, v75, v76
    v_max_u32 v103, v103, v77
    v_cmp_eq_u32 vcc, -1, v103
    s_cbranch_vccz interleave_layers__linear_attn_block__memory_aug_recurrent_mem_tr__prompt_kernel_v_pmw3_out
    s_mov_b32 s61, 0
interleave_layers__linear_attn_block__memory_aug_recurrent_mem_tr__prompt_kernel_v_pmw3:
    buffer_load_dwordx4 v[68:71], v7, s[8:11], s47 offen sc1
    buffer_load_dwordx4 v[72:75], v7, s[8:11], s48 offen sc1
    buffer_load_dwordx2 v[76:77], v8, s[8:11], s50 offen sc1
    s_waitcnt vmcnt(0)
    v_max3_u32 v103, v68, v69, v70
    v_max3_u32 v103, v103, v71, v72
    v_max3_u32 v103, v103, v73, v74
    v_max3_u32 v103, v103, v75, v76
    v_max_u32 v103, v103, v77
    v_cmp_eq_u32 vcc, -1, v103
    s_add_u32 s61, s61, 1
    s_cbranch_vccz interleave_layers__linear_attn_block__memory_aug_recurrent_mem_tr__prompt_kernel_v_pmw3_out
    s_cmp_ge_u32 s61, s60
    s_cbranch_scc1 interleave_layers__linear_attn_block__memory_aug_recurrent_mem_tr__prompt_kernel_v_pmw3_to
    s_sleep 1
    s_branch interleave_layers__linear_attn_block__memory_aug_recurrent_mem_tr__prompt_kernel_v_pmw3
interleave_layers__linear_attn_block__memory_aug_recurrent_mem_tr__prompt_kernel_v_pmw3_to:
    s_mov_b32 s60, 1
interleave_layers__linear_attn_block__memory_aug_recurrent_mem_tr__prompt_kernel_v_pmw3_out:
    ds_write_b128 v7, v[68:71]
    ds_write_b128 v7, v[72:75] offset:4096
    ds_write_b64 v8, v[76:77]
interleave_layers__linear_attn_block__memory_aug_recurrent_mem_tr__prompt_kernel_v_gow3:
    v_smfmac_f32_16x16x64_bf16 v[56:59], v[68:71], a[24:31], v4
    v_smfmac_f32_16x16x64_bf16 v[60:63], v[68:71], a[104:111], v4
    v_smfmac_f32_16x16x64_bf16 v[64:67], v[68:71], a[184:191], v4
    s_waitcnt lgkmcnt(0)
    s_barrier
    ds_read_b128 v[80:83], v5 offset:0
    ds_read_b128 v[84:87], v5 offset:1024
    ds_read_b128 v[88:91], v5 offset:2048
    ds_read_b128 v[92:95], v5 offset:4096
    ds_read_b128 v[96:99], v5 offset:5120
    ds_read_b128 v[100:103], v5 offset:6144
    ds_read_b128 v[76:79], v5 offset:8192
    ds_read_b128 v[68:71], v5 offset:9216
    v_smfmac_f32_16x16x64_bf16 v[64:67], v[72:75], a[216:223], v4
    v_smfmac_f32_16x16x64_bf16 v[56:59], v[72:75], a[56:63], v4
    v_smfmac_f32_16x16x64_bf16 v[60:63], v[72:75], a[136:143], v4
    s_waitcnt lgkmcnt(7)
    v_smfmac_f32_16x16x64_bf16 v[64:67], v[80:83], a[160:167], v4
    s_waitcnt lgkmcnt(6)
    v_smfmac_f32_16x16x64_bf16 v[64:67], v[84:87], a[168:175], v4
    s_waitcnt lgkmcnt(5)
    v_smfmac_f32_16x16x64_bf16 v[64:67], v[88:91], a[176:183], v4
    s_waitcnt lgkmcnt(4)
    v_smfmac_f32_16x16x64_bf16 v[64:67], v[92:95], a[192:199], v4
    s_waitcnt lgkmcnt(3)
    v_smfmac_f32_16x16x64_bf16 v[64:67], v[96:99], a[200:207], v4
    s_waitcnt lgkmcnt(2)
    v_smfmac_f32_16x16x64_bf16 v[64:67], v[100:103], a[208:215], v4
    s_waitcnt lgkmcnt(1)
    v_smfmac_f32_16x16x64_bf16 v[64:67], v[76:79], a[224:231], v4
    s_waitcnt lgkmcnt(0)
    v_smfmac_f32_16x16x64_bf16 v[64:67], v[68:71], a[232:239], v4
    v_smfmac_f32_16x16x64_bf16 v[56:59], v[80:83], a[0:7], v4
    v_smfmac_f32_16x16x64_bf16 v[60:63], v[80:83], a[80:87], v4
    v_smfmac_f32_16x16x64_bf16 v[56:59], v[84:87], a[8:15], v4
    s_nop 4
    v_mov_b32 v72, v64
    v_smfmac_f32_16x16x64_bf16 v[60:63], v[84:87], a[88:95], v4
    v_mov_b32 v73, v65
    v_mov_b32 v74, v66
    v_smfmac_f32_16x16x64_bf16 v[56:59], v[88:91], a[16:23], v4
    v_mov_b32 v75, v67
    v_smfmac_f32_16x16x64_bf16 v[60:63], v[88:91], a[96:103], v4
    v_permlane32_swap_b32 v64, v72
    v_permlane32_swap_b32 v65, v73
    v_smfmac_f32_16x16x64_bf16 v[56:59], v[92:95], a[32:39], v4
    v_permlane32_swap_b32 v66, v74
    v_permlane32_swap_b32 v67, v75
    v_smfmac_f32_16x16x64_bf16 v[60:63], v[92:95], a[112:119], v4
    v_add_f32 v64, v64, v72
    v_add_f32 v65, v65, v73
    v_smfmac_f32_16x16x64_bf16 v[56:59], v[96:99], a[40:47], v4
    v_add_f32 v66, v66, v74
    v_add_f32 v67, v67, v75
    v_smfmac_f32_16x16x64_bf16 v[60:63], v[96:99], a[120:127], v4
    v_cvt_pk_bf16_f32 v72, v64, v65
    v_cvt_pk_bf16_f32 v73, v66, v67
    v_smfmac_f32_16x16x64_bf16 v[56:59], v[100:103], a[48:55], v4
    ds_write_b64 v9, v[72:73] offset:512
    v_smfmac_f32_16x16x64_bf16 v[60:63], v[100:103], a[128:135], v4
    v_smfmac_f32_16x16x64_bf16 v[56:59], v[76:79], a[64:71], v4
    v_smfmac_f32_16x16x64_bf16 v[60:63], v[76:79], a[144:151], v4
    v_smfmac_f32_16x16x64_bf16 v[56:59], v[68:71], a[72:79], v4
    v_smfmac_f32_16x16x64_bf16 v[60:63], v[68:71], a[152:159], v4
    s_nop 7
    v_permlane32_swap_b32 v56, v60
    v_permlane32_swap_b32 v57, v61
    v_permlane32_swap_b32 v58, v62
    v_permlane32_swap_b32 v59, v63
    v_add_f32 v56, v56, v60
    v_add_f32 v57, v57, v61
    v_add_f32 v58, v58, v62
    v_add_f32 v59, v59, v63
    v_cvt_pk_bf16_f32 v68, v56, v57
    v_cvt_pk_bf16_f32 v69, v58, v59
    ds_write_b64 v10, v[68:69]
    s_waitcnt lgkmcnt(0)
    s_barrier
    ds_read_b64_tr_b16 v[68:69], v11 offset:0
    ds_read_b64_tr_b16 v[70:71], v11 offset:128
    ds_read_b64_tr_b16 v[72:73], v11 offset:1024
    ds_read_b64_tr_b16 v[74:75], v11 offset:1152
    ds_read_b64_tr_b16 v[76:77], v11 offset:2048
    ds_read_b64_tr_b16 v[78:79], v11 offset:2176
    ds_read_b128 v[80:83], v6 offset:0
    ds_read_b128 v[84:87], v6 offset:1024
    ds_read_b128 v[88:91], v6 offset:2048
    ds_read_b128 v[92:95], v6 offset:3072
    ds_read_b128 v[96:99], v6 offset:4096
    ds_read_b128 v[100:103], v6 offset:5120
    s_waitcnt lgkmcnt(10)
    v_smfmac_f32_16x16x64_bf16 v[16:19], v[68:71], a[240:247], v4
    v_smfmac_f32_16x16x64_bf16 v[20:23], v[68:71], v[112:119], v4
    v_smfmac_f32_16x16x64_bf16 v[24:27], v[68:71], v[136:143], v4
    v_smfmac_f32_16x16x64_bf16 v[28:31], v[68:71], v[160:167], v4
    s_waitcnt lgkmcnt(8)
    v_smfmac_f32_16x16x64_bf16 v[16:19], v[72:75], a[248:255], v4
    v_smfmac_f32_16x16x64_bf16 v[20:23], v[72:75], v[120:127], v4
    v_smfmac_f32_16x16x64_bf16 v[24:27], v[72:75], v[144:151], v4
    v_smfmac_f32_16x16x64_bf16 v[28:31], v[72:75], v[168:175], v4
    s_waitcnt lgkmcnt(6)
    v_smfmac_f32_16x16x64_bf16 v[16:19], v[76:79], v[104:111], v4
    v_smfmac_f32_16x16x64_bf16 v[20:23], v[76:79], v[128:135], v4
    v_smfmac_f32_16x16x64_bf16 v[24:27], v[76:79], v[152:159], v4
    v_smfmac_f32_16x16x64_bf16 v[28:31], v[76:79], v[176:183], v4
    v_smfmac_f32_16x16x64_bf16 v[32:35], v[68:71], v[184:191], v4
    v_smfmac_f32_16x16x64_bf16 v[36:39], v[68:71], v[208:215], v4
    s_nop 4
    v_permlane32_swap_b32 v16, v24
    v_permlane32_swap_b32 v17, v25
    v_smfmac_f32_16x16x64_bf16 v[40:43], v[68:71], v[232:239], v4
    v_permlane32_swap_b32 v18, v26
    v_permlane32_swap_b32 v19, v27
    s_waitcnt lgkmcnt(4)
    v_smfmac_f32_16x16x64_bf16 v[44:47], v[68:71], v[80:87], v4
    v_add_f32 v16, v16, v24
    v_add_f32 v17, v17, v25
    ds_read_b128 v[80:83], v6 offset:6144
    ds_read_b128 v[84:87], v6 offset:7168
    v_smfmac_f32_16x16x64_bf16 v[32:35], v[72:75], v[192:199], v4
    v_add_f32 v18, v18, v26
    v_add_f32 v19, v19, v27
    v_smfmac_f32_16x16x64_bf16 v[36:39], v[72:75], v[216:223], v4
    v_permlane32_swap_b32 v20, v28
    v_permlane32_swap_b32 v21, v29
    v_smfmac_f32_16x16x64_bf16 v[40:43], v[72:75], v[240:247], v4
    v_permlane32_swap_b32 v22, v30
    v_permlane32_swap_b32 v23, v31
    s_waitcnt lgkmcnt(4)
    v_smfmac_f32_16x16x64_bf16 v[44:47], v[72:75], v[88:95], v4
    v_add_f32 v20, v20, v28
    v_add_f32 v21, v21, v29
    ds_read_b128 v[88:91], v6 offset:8192
    ds_read_b128 v[92:95], v6 offset:9216
    v_smfmac_f32_16x16x64_bf16 v[32:35], v[76:79], v[200:207], v4
    v_add_f32 v22, v22, v30
    v_add_f32 v23, v23, v31
    v_smfmac_f32_16x16x64_bf16 v[36:39], v[76:79], v[224:231], v4
    v_cvt_pk_bf16_f32 v56, v16, v17
    v_cvt_pk_bf16_f32 v57, v18, v19
    v_smfmac_f32_16x16x64_bf16 v[40:43], v[76:79], v[248:255], v4
    v_cvt_pk_bf16_f32 v58, v20, v21
    v_cvt_pk_bf16_f32 v59, v22, v23
    s_waitcnt lgkmcnt(4)
    v_smfmac_f32_16x16x64_bf16 v[44:47], v[76:79], v[96:103], v4
    v_permlane16_swap_b32 v56, v58
    ds_read_b128 v[96:99], v6 offset:10240
    ds_read_b128 v[100:103], v6 offset:11264
    v_permlane16_swap_b32 v57, v59
    v_min_u32 v56, -2, v56
    v_min_u32 v57, -2, v57
    v_min_u32 v58, -2, v58
    v_min_u32 v59, -2, v59
    buffer_store_dwordx4 v[56:59], v14, s[8:11], s43 offen sc1
    s_add_u32 s49, s43, 65536
    s_waitcnt lgkmcnt(4)
    v_smfmac_f32_16x16x64_bf16 v[48:51], v[68:71], v[80:87], v4
    v_permlane32_swap_b32 v32, v40
    v_permlane32_swap_b32 v33, v41
    v_permlane32_swap_b32 v34, v42
    ds_read_b128 v[80:83], v6 offset:12288
    ds_read_b128 v[84:87], v6 offset:13312
    s_waitcnt lgkmcnt(4)
    v_smfmac_f32_16x16x64_bf16 v[48:51], v[72:75], v[88:95], v4
    v_permlane32_swap_b32 v35, v43
    v_add_f32 v32, v32, v40
    v_add_f32 v33, v33, v41
    v_add_f32 v34, v34, v42
    ds_read_b128 v[88:91], v6 offset:14336
    ds_read_b128 v[92:95], v6 offset:15360
    s_waitcnt lgkmcnt(4)
    v_smfmac_f32_16x16x64_bf16 v[48:51], v[76:79], v[96:103], v4
    v_add_f32 v35, v35, v43
    v_permlane32_swap_b32 v36, v44
    v_permlane32_swap_b32 v37, v45
    v_permlane32_swap_b32 v38, v46
    ds_read_b128 v[96:99], v6 offset:16384
    ds_read_b128 v[100:103], v6 offset:17408
    v_permlane32_swap_b32 v39, v47
    v_add_f32 v36, v36, v44
    v_add_f32 v37, v37, v45
    v_add_f32 v38, v38, v46
    s_waitcnt lgkmcnt(4)
    v_smfmac_f32_16x16x64_bf16 v[52:55], v[68:71], v[80:87], v4
    v_add_f32 v39, v39, v47
    v_cvt_pk_bf16_f32 v60, v32, v33
    v_cvt_pk_bf16_f32 v61, v34, v35
    s_waitcnt lgkmcnt(2)
    v_smfmac_f32_16x16x64_bf16 v[52:55], v[72:75], v[88:95], v4
    v_cvt_pk_bf16_f32 v62, v36, v37
    v_cvt_pk_bf16_f32 v63, v38, v39
    s_waitcnt lgkmcnt(0)
    v_smfmac_f32_16x16x64_bf16 v[52:55], v[76:79], v[96:103], v4
    v_permlane16_swap_b32 v60, v62
    v_permlane16_swap_b32 v61, v63
    v_min_u32 v60, -2, v60
    v_min_u32 v61, -2, v61
    v_min_u32 v62, -2, v62
    v_min_u32 v63, -2, v63
    buffer_store_dwordx4 v[60:63], v14, s[8:11], s49 offen sc1
    s_nop 0
    v_permlane32_swap_b32 v48, v52
    v_permlane32_swap_b32 v49, v53
    v_permlane32_swap_b32 v50, v54
    v_permlane32_swap_b32 v51, v55
    v_add_f32 v48, v48, v52
    v_add_f32 v49, v49, v53
    v_add_f32 v50, v50, v54
    v_add_f32 v51, v51, v55
    v_cvt_pk_bf16_f32 v64, v48, v49
    v_cvt_pk_bf16_f32 v65, v50, v51
    v_mov_b32 v66, v64
    v_mov_b32 v67, v65
    s_nop 0
    v_permlane16_swap_b32 v64, v66
    v_permlane16_swap_b32 v65, v67
    v_min_u32 v64, -2, v64
    v_min_u32 v65, -2, v65
    v_min_u32 v66, -2, v66
    v_min_u32 v67, -2, v67
    buffer_store_dwordx4 v[64:67], v15, s[8:11], s43 offen sc1
    s_add_u32 s40, s40, 1
    s_add_u32 s47, s37, 704512
    s_add_u32 s45, s37, 737280
    s_lshl_b32 s24, s40, 12
    s_and_b32 s24, s24, 0x2000
    s_xor_b32 s24, s24, s36
    s_lshl_b32 s37, s40, 20
    s_add_u32 s37, s37, s24
    s_add_u32 s37, s37, 117440512
    s_add_u32 s43, s37, 0
    s_cmp_lt_u32 s40, 64
    s_cbranch_scc1 interleave_layers__linear_attn_block__memory_aug_recurrent_mem_tr__prompt_kernel_v_stepw3
interleave_layers__linear_attn_block__memory_aug_recurrent_mem_tr__prompt_kernel_v_end:
    s_cmp_eq_u32 s92, 0
    s_cbranch_scc0 interleave_layers__linear_attn_block__memory_aug_recurrent_mem_tr__prompt_kernel_end
    s_mov_b32 s92, 1
    s_branch interleave_layers__linear_attn_block__memory_aug_recurrent_mem_tr__prompt_kernel_v_layer
interleave_layers__linear_attn_block__memory_aug_recurrent_mem_tr__prompt_kernel_roleR:
interleave_layers__linear_attn_block__memory_aug_recurrent_mem_tr__prompt_kernel_r_top:
    s_barrier
    s_sub_u32 s24, s2, 64
    s_cmp_ge_u32 s24, 24
    s_cbranch_scc1 interleave_layers__linear_attn_block__memory_aug_recurrent_mem_tr__prompt_kernel_rk25
    s_and_b32 s44, s24, 7
    s_lshr_b32 s45, s24, 3
    s_cmp_eq_u32 s92, 0
    s_cselect_b32 s46, 32, 2
    v_lshlrev_b32 v5, 4, v1
    s_mov_b32 s64, 12288
    s_cmp_eq_u32 s45, 1
    s_cselect_b32 s64, 5120, s64
    s_cmp_eq_u32 s45, 2
    s_cselect_b32 s64, 17408, s64
    s_mov_b32 s65, 1024
    s_cmp_eq_u32 s45, 1
    s_cselect_b32 s65, 7168, s65
    s_cmp_eq_u32 s45, 2
    s_cselect_b32 s65, 13312, s65
    s_mov_b32 s66, 0
    s_cmp_eq_u32 s45, 1
    s_cselect_b32 s66, 6144, s66
    s_cmp_eq_u32 s45, 2
    s_cselect_b32 s66, 14336, s66
    s_mov_b32 s67, 2048
    s_cmp_eq_u32 s45, 1
    s_cselect_b32 s67, 8192, s67
    s_cmp_eq_u32 s45, 2
    s_cselect_b32 s67, 15360, s67
    s_mov_b32 s68, 4096
    s_cmp_eq_u32 s45, 1
    s_cselect_b32 s68, 10240, s68
    s_cmp_eq_u32 s45, 2
    s_cselect_b32 s68, 16384, s68
    s_mov_b32 s69, 3072
    s_cmp_eq_u32 s45, 1
    s_cselect_b32 s69, 9216, s69
    s_cmp_eq_u32 s45, 2
    s_cselect_b32 s69, 16384, s69
    s_mov_b32 s70, 3072
    s_cmp_eq_u32 s45, 1
    s_cselect_b32 s70, 11264, s70
    s_cmp_eq_u32 s45, 2
    s_cselect_b32 s70, 16384, s70
    s_lshl_b32 s24, s92, 3
    s_add_u32 s24, s24, s44
    s_lshl_b32 s24, s24, 7
    s_add_u32 s24, s24, 23101440
    v_lshlrev_b32 v15, 2, v1
    v_add_u32 v15, s24, v15
    s_cmp_eq_u32 s92, 0
    s_cselect_b32 s26, -1, 3
    s_mov_b32 s61, 0
interleave_layers__linear_attn_block__memory_aug_recurrent_mem_tr__prompt_kernel_k2_w:
    buffer_load_dword v14, v15, s[8:11], 0 offen sc1
    s_waitcnt vmcnt(0)
    v_cmp_le_i32 vcc, 1, v14
    s_and_b32 s24, vcc_lo, s26
    s_cmp_eq_u32 s24, s26
    s_cbranch_scc1 interleave_layers__linear_attn_block__memory_aug_recurrent_mem_tr__prompt_kernel_k2_w_ok
    s_add_u32 s61, s61, 1
    s_cmp_ge_u32 s61, s60
    s_cbranch_scc1 interleave_layers__linear_attn_block__memory_aug_recurrent_mem_tr__prompt_kernel_k2_w_to
    s_sleep 2
    s_branch interleave_layers__linear_attn_block__memory_aug_recurrent_mem_tr__prompt_kernel_k2_w
interleave_layers__linear_attn_block__memory_aug_recurrent_mem_tr__prompt_kernel_k2_w_to:
    s_mov_b32 s60, 1
interleave_layers__linear_attn_block__memory_aug_recurrent_mem_tr__prompt_kernel_k2_w_ok:
    s_add_u32 s25, s3, 0
    s_mul_i32 s24, s25, 147456
    s_mul_i32 s26, s44, 18432
    s_add_u32 s24, s24, s26
    s_add_u32 s24, s24, 16777216
    s_cmp_lt_u32 s25, s46
    s_cselect_b32 s24, s24, 2146435072
    s_add_u32 s26, s24, s64
    buffer_load_dwordx4 v[16:19], v5, s[8:11], s26 offen sc1
    s_add_u32 s26, s24, s65
    buffer_load_dwordx4 v[20:23], v5, s[8:11], s26 offen sc1
    s_add_u32 s26, s24, s66
    buffer_load_dwordx4 v[24:27], v5, s[8:11], s26 offen sc1
    s_add_u32 s26, s24, s67
    buffer_load_dwordx4 v[28:31], v5, s[8:11], s26 offen sc1
    s_add_u32 s26, s24, s68
    buffer_load_dwordx4 v[32:35], v5, s[8:11], s26 offen sc1
    s_add_u32 s26, s24, s69
    buffer_load_dwordx4 v[36:39], v5, s[8:11], s26 offen sc1
    s_add_u32 s26, s24, s70
    buffer_load_dwordx4 v[40:43], v5, s[8:11], s26 offen sc1
    s_add_u32 s25, s3, 4
    s_mul_i32 s24, s25, 147456
    s_mul_i32 s26, s44, 18432
    s_add_u32 s24, s24, s26
    s_add_u32 s24, s24, 16777216
    s_cmp_lt_u32 s25, s46
    s_cselect_b32 s24, s24, 2146435072
    s_add_u32 s26, s24, s64
    buffer_load_dwordx4 v[44:47], v5, s[8:11], s26 offen sc1
    s_add_u32 s26, s24, s65
    buffer_load_dwordx4 v[48:51], v5, s[8:11], s26 offen sc1
    s_add_u32 s26, s24, s66
    buffer_load_dwordx4 v[52:55], v5, s[8:11], s26 offen sc1
    s_add_u32 s26, s24, s67
    buffer_load_dwordx4 v[56:59], v5, s[8:11], s26 offen sc1
    s_add_u32 s26, s24, s68
    buffer_load_dwordx4 v[60:63], v5, s[8:11], s26 offen sc1
    s_add_u32 s26, s24, s69
    buffer_load_dwordx4 v[64:67], v5, s[8:11], s26 offen sc1
    s_add_u32 s26, s24, s70
    buffer_load_dwordx4 v[68:71], v5, s[8:11], s26 offen sc1
    s_add_u32 s25, s3, 8
    s_mul_i32 s24, s25, 147456
    s_mul_i32 s26, s44, 18432
    s_add_u32 s24, s24, s26
    s_add_u32 s24, s24, 16777216
    s_cmp_lt_u32 s25, s46
    s_cselect_b32 s24, s24, 2146435072
    s_add_u32 s26, s24, s64
    buffer_load_dwordx4 v[72:75], v5, s[8:11], s26 offen sc1
    s_add_u32 s26, s24, s65
    buffer_load_dwordx4 v[76:79], v5, s[8:11], s26 offen sc1
    s_add_u32 s26, s24, s66
    buffer_load_dwordx4 v[80:83], v5, s[8:11], s26 offen sc1
    s_add_u32 s26, s24, s67
    buffer_load_dwordx4 v[84:87], v5, s[8:11], s26 offen sc1
    s_add_u32 s26, s24, s68
    buffer_load_dwordx4 v[88:91], v5, s[8:11], s26 offen sc1
    s_add_u32 s26, s24, s69
    buffer_load_dwordx4 v[92:95], v5, s[8:11], s26 offen sc1
    s_add_u32 s26, s24, s70
    buffer_load_dwordx4 v[96:99], v5, s[8:11], s26 offen sc1
    s_add_u32 s25, s3, 12
    s_mul_i32 s24, s25, 147456
    s_mul_i32 s26, s44, 18432
    s_add_u32 s24, s24, s26
    s_add_u32 s24, s24, 16777216
    s_cmp_lt_u32 s25, s46
    s_cselect_b32 s24, s24, 2146435072
    s_add_u32 s26, s24, s64
    buffer_load_dwordx4 v[100:103], v5, s[8:11], s26 offen sc1
    s_add_u32 s26, s24, s65
    buffer_load_dwordx4 v[104:107], v5, s[8:11], s26 offen sc1
    s_add_u32 s26, s24, s66
    buffer_load_dwordx4 v[108:111], v5, s[8:11], s26 offen sc1
    s_add_u32 s26, s24, s67
    buffer_load_dwordx4 v[112:115], v5, s[8:11], s26 offen sc1
    s_add_u32 s26, s24, s68
    buffer_load_dwordx4 v[116:119], v5, s[8:11], s26 offen sc1
    s_add_u32 s26, s24, s69
    buffer_load_dwordx4 v[120:123], v5, s[8:11], s26 offen sc1
    s_add_u32 s26, s24, s70
    buffer_load_dwordx4 v[124:127], v5, s[8:11], s26 offen sc1
    s_add_u32 s25, s3, 16
    s_mul_i32 s24, s25, 147456
    s_mul_i32 s26, s44, 18432
    s_add_u32 s24, s24, s26
    s_add_u32 s24, s24, 16777216
    s_cmp_lt_u32 s25, s46
    s_cselect_b32 s24, s24, 2146435072
    s_add_u32 s26, s24, s64
    buffer_load_dwordx4 v[128:131], v5, s[8:11], s26 offen sc1
    s_add_u32 s26, s24, s65
    buffer_load_dwordx4 v[132:135], v5, s[8:11], s26 offen sc1
    s_add_u32 s26, s24, s66
    buffer_load_dwordx4 v[136:139], v5, s[8:11], s26 offen sc1
    s_add_u32 s26, s24, s67
    buffer_load_dwordx4 v[140:143], v5, s[8:11], s26 offen sc1
    s_add_u32 s26, s24, s68
    buffer_load_dwordx4 v[144:147], v5, s[8:11], s26 offen sc1
    s_add_u32 s26, s24, s69
    buffer_load_dwordx4 v[148:151], v5, s[8:11], s26 offen sc1
    s_add_u32 s26, s24, s70
    buffer_load_dwordx4 v[152:155], v5, s[8:11], s26 offen sc1
    s_add_u32 s25, s3, 20
    s_mul_i32 s24, s25, 147456
    s_mul_i32 s26, s44, 18432
    s_add_u32 s24, s24, s26
    s_add_u32 s24, s24, 16777216
    s_cmp_lt_u32 s25, s46
    s_cselect_b32 s24, s24, 2146435072
    s_add_u32 s26, s24, s64
    buffer_load_dwordx4 v[156:159], v5, s[8:11], s26 offen sc1
    s_add_u32 s26, s24, s65
    buffer_load_dwordx4 v[160:163], v5, s[8:11], s26 offen sc1
    s_add_u32 s26, s24, s66
    buffer_load_dwordx4 v[164:167], v5, s[8:11], s26 offen sc1
    s_add_u32 s26, s24, s67
    buffer_load_dwordx4 v[168:171], v5, s[8:11], s26 offen sc1
    s_add_u32 s26, s24, s68
    buffer_load_dwordx4 v[172:175], v5, s[8:11], s26 offen sc1
    s_add_u32 s26, s24, s69
    buffer_load_dwordx4 v[176:179], v5, s[8:11], s26 offen sc1
    s_add_u32 s26, s24, s70
    buffer_load_dwordx4 v[180:183], v5, s[8:11], s26 offen sc1
    s_add_u32 s25, s3, 24
    s_mul_i32 s24, s25, 147456
    s_mul_i32 s26, s44, 18432
    s_add_u32 s24, s24, s26
    s_add_u32 s24, s24, 16777216
    s_cmp_lt_u32 s25, s46
    s_cselect_b32 s24, s24, 2146435072
    s_add_u32 s26, s24, s64
    buffer_load_dwordx4 v[184:187], v5, s[8:11], s26 offen sc1
    s_add_u32 s26, s24, s65
    buffer_load_dwordx4 v[188:191], v5, s[8:11], s26 offen sc1
    s_add_u32 s26, s24, s66
    buffer_load_dwordx4 v[192:195], v5, s[8:11], s26 offen sc1
    s_add_u32 s26, s24, s67
    buffer_load_dwordx4 v[196:199], v5, s[8:11], s26 offen sc1
    s_add_u32 s26, s24, s68
    buffer_load_dwordx4 v[200:203], v5, s[8:11], s26 offen sc1
    s_add_u32 s26, s24, s69
    buffer_load_dwordx4 v[204:207], v5, s[8:11], s26 offen sc1
    s_add_u32 s26, s24, s70
    buffer_load_dwordx4 v[208:211], v5, s[8:11], s26 offen sc1
    s_add_u32 s25, s3, 28
    s_mul_i32 s24, s25, 147456
    s_mul_i32 s26, s44, 18432
    s_add_u32 s24, s24, s26
    s_add_u32 s24, s24, 16777216
    s_cmp_lt_u32 s25, s46
    s_cselect_b32 s24, s24, 2146435072
    s_add_u32 s26, s24, s64
    buffer_load_dwordx4 v[212:215], v5, s[8:11], s26 offen sc1
    s_add_u32 s26, s24, s65
    buffer_load_dwordx4 v[216:219], v5, s[8:11], s26 offen sc1
    s_add_u32 s26, s24, s66
    buffer_load_dwordx4 v[220:223], v5, s[8:11], s26 offen sc1
    s_add_u32 s26, s24, s67
    buffer_load_dwordx4 v[224:227], v5, s[8:11], s26 offen sc1
    s_add_u32 s26, s24, s68
    buffer_load_dwordx4 v[228:231], v5, s[8:11], s26 offen sc1
    s_add_u32 s26, s24, s69
    buffer_load_dwordx4 v[232:235], v5, s[8:11], s26 offen sc1
    s_add_u32 s26, s24, s70
    buffer_load_dwordx4 v[236:239], v5, s[8:11], s26 offen sc1
    s_waitcnt vmcnt(42)
    v_pk_add_f32 v[16:17], v[16:17], v[44:45]
    v_pk_add_f32 v[18:19], v[18:19], v[46:47]
    v_pk_add_f32 v[20:21], v[20:21], v[48:49]
    v_pk_add_f32 v[22:23], v[22:23], v[50:51]
    v_pk_add_f32 v[24:25], v[24:25], v[52:53]
    v_pk_add_f32 v[26:27], v[26:27], v[54:55]
    v_pk_add_f32 v[28:29], v[28:29], v[56:57]
    v_pk_add_f32 v[30:31], v[30:31], v[58:59]
    v_pk_add_f32 v[32:33], v[32:33], v[60:61]
    v_pk_add_f32 v[34:35], v[34:35], v[62:63]
    v_pk_add_f32 v[36:37], v[36:37], v[64:65]
    v_pk_add_f32 v[38:39], v[38:39], v[66:67]
    v_pk_add_f32 v[40:41], v[40:41], v[68:69]
    v_pk_add_f32 v[42:43], v[42:43], v[70:71]
    s_waitcnt vmcnt(35)
    v_pk_add_f32 v[16:17], v[16:17], v[72:73]
    v_pk_add_f32 v[18:19], v[18:19], v[74:75]
    v_pk_add_f32 v[20:21], v[20:21], v[76:77]
    v_pk_add_f32 v[22:23], v[22:23], v[78:79]
    v_pk_add_f32 v[24:25], v[24:25], v[80:81]
    v_pk_add_f32 v[26:27], v[26:27], v[82:83]
    v_pk_add_f32 v[28:29], v[28:29], v[84:85]
    v_pk_add_f32 v[30:31], v[30:31], v[86:87]
    v_pk_add_f32 v[32:33], v[32:33], v[88:89]
    v_pk_add_f32 v[34:35], v[34:35], v[90:91]
    v_pk_add_f32 v[36:37], v[36:37], v[92:93]
    v_pk_add_f32 v[38:39], v[38:39], v[94:95]
    v_pk_add_f32 v[40:41], v[40:41], v[96:97]
    v_pk_add_f32 v[42:43], v[42:43], v[98:99]
    s_waitcnt vmcnt(28)
    v_pk_add_f32 v[16:17], v[16:17], v[100:101]
    v_pk_add_f32 v[18:19], v[18:19], v[102:103]
    v_pk_add_f32 v[20:21], v[20:21], v[104:105]
    v_pk_add_f32 v[22:23], v[22:23], v[106:107]
    v_pk_add_f32 v[24:25], v[24:25], v[108:109]
    v_pk_add_f32 v[26:27], v[26:27], v[110:111]
    v_pk_add_f32 v[28:29], v[28:29], v[112:113]
    v_pk_add_f32 v[30:31], v[30:31], v[114:115]
    v_pk_add_f32 v[32:33], v[32:33], v[116:117]
    v_pk_add_f32 v[34:35], v[34:35], v[118:119]
    v_pk_add_f32 v[36:37], v[36:37], v[120:121]
    v_pk_add_f32 v[38:39], v[38:39], v[122:123]
    v_pk_add_f32 v[40:41], v[40:41], v[124:125]
    v_pk_add_f32 v[42:43], v[42:43], v[126:127]
    s_waitcnt vmcnt(21)
    v_pk_add_f32 v[16:17], v[16:17], v[128:129]
    v_pk_add_f32 v[18:19], v[18:19], v[130:131]
    v_pk_add_f32 v[20:21], v[20:21], v[132:133]
    v_pk_add_f32 v[22:23], v[22:23], v[134:135]
    v_pk_add_f32 v[24:25], v[24:25], v[136:137]
    v_pk_add_f32 v[26:27], v[26:27], v[138:139]
    v_pk_add_f32 v[28:29], v[28:29], v[140:141]
    v_pk_add_f32 v[30:31], v[30:31], v[142:143]
    v_pk_add_f32 v[32:33], v[32:33], v[144:145]
    v_pk_add_f32 v[34:35], v[34:35], v[146:147]
    v_pk_add_f32 v[36:37], v[36:37], v[148:149]
    v_pk_add_f32 v[38:39], v[38:39], v[150:151]
    v_pk_add_f32 v[40:41], v[40:41], v[152:153]
    v_pk_add_f32 v[42:43], v[42:43], v[154:155]
    s_waitcnt vmcnt(14)
    v_pk_add_f32 v[16:17], v[16:17], v[156:157]
    v_pk_add_f32 v[18:19], v[18:19], v[158:159]
    v_pk_add_f32 v[20:21], v[20:21], v[160:161]
    v_pk_add_f32 v[22:23], v[22:23], v[162:163]
    v_pk_add_f32 v[24:25], v[24:25], v[164:165]
    v_pk_add_f32 v[26:27], v[26:27], v[166:167]
    v_pk_add_f32 v[28:29], v[28:29], v[168:169]
    v_pk_add_f32 v[30:31], v[30:31], v[170:171]
    v_pk_add_f32 v[32:33], v[32:33], v[172:173]
    v_pk_add_f32 v[34:35], v[34:35], v[174:175]
    v_pk_add_f32 v[36:37], v[36:37], v[176:177]
    v_pk_add_f32 v[38:39], v[38:39], v[178:179]
    v_pk_add_f32 v[40:41], v[40:41], v[180:181]
    v_pk_add_f32 v[42:43], v[42:43], v[182:183]
    s_waitcnt vmcnt(7)
    v_pk_add_f32 v[16:17], v[16:17], v[184:185]
    v_pk_add_f32 v[18:19], v[18:19], v[186:187]
    v_pk_add_f32 v[20:21], v[20:21], v[188:189]
    v_pk_add_f32 v[22:23], v[22:23], v[190:191]
    v_pk_add_f32 v[24:25], v[24:25], v[192:193]
    v_pk_add_f32 v[26:27], v[26:27], v[194:195]
    v_pk_add_f32 v[28:29], v[28:29], v[196:197]
    v_pk_add_f32 v[30:31], v[30:31], v[198:199]
    v_pk_add_f32 v[32:33], v[32:33], v[200:201]
    v_pk_add_f32 v[34:35], v[34:35], v[202:203]
    v_pk_add_f32 v[36:37], v[36:37], v[204:205]
    v_pk_add_f32 v[38:39], v[38:39], v[206:207]
    v_pk_add_f32 v[40:41], v[40:41], v[208:209]
    v_pk_add_f32 v[42:43], v[42:43], v[210:211]
    s_waitcnt vmcnt(0)
    v_pk_add_f32 v[16:17], v[16:17], v[212:213]
    v_pk_add_f32 v[18:19], v[18:19], v[214:215]
    v_pk_add_f32 v[20:21], v[20:21], v[216:217]
    v_pk_add_f32 v[22:23], v[22:23], v[218:219]
    v_pk_add_f32 v[24:25], v[24:25], v[220:221]
    v_pk_add_f32 v[26:27], v[26:27], v[222:223]
    v_pk_add_f32 v[28:29], v[28:29], v[224:225]
    v_pk_add_f32 v[30:31], v[30:31], v[226:227]
    v_pk_add_f32 v[32:33], v[32:33], v[228:229]
    v_pk_add_f32 v[34:35], v[34:35], v[230:231]
    v_pk_add_f32 v[36:37], v[36:37], v[232:233]
    v_pk_add_f32 v[38:39], v[38:39], v[234:235]
    v_pk_add_f32 v[40:41], v[40:41], v[236:237]
    v_pk_add_f32 v[42:43], v[42:43], v[238:239]
    s_mul_i32 s24, s3, 7168
    v_add_u32 v6, s24, v5
    ds_write_b128 v6, v[16:19] offset:0
    ds_write_b128 v6, v[20:23] offset:1024
    ds_write_b128 v6, v[24:27] offset:2048
    ds_write_b128 v6, v[28:31] offset:3072
    ds_write_b128 v6, v[32:35] offset:4096
    ds_write_b128 v6, v[36:39] offset:5120
    ds_write_b128 v6, v[40:43] offset:6144
    s_waitcnt lgkmcnt(0)
    s_barrier
    s_mov_b32 s41, 0
    s_cmp_eq_u32 s45, 1
    s_cselect_b32 s41, 4, s41
    s_cmp_eq_u32 s45, 2
    s_cselect_b32 s41, 9, s41
    s_mov_b32 s42, 4
    s_cmp_eq_u32 s45, 1
    s_cselect_b32 s42, 5, s42
    s_cmp_eq_u32 s45, 2
    s_cselect_b32 s42, 5, s42
    s_mul_i32 s43, s92, 131072
    s_mul_i32 s24, s44, 14336
    s_add_u32 s43, s43, s24
    s_add_u32 s43, s43, 22020096
    v_and_b32 v7, 3, v2
    v_lshrrev_b32 v8, 2, v2
    s_add_u32 s40, s3, 0
    s_cmp_lt_u32 s40, s42
    s_cbranch_scc0 interleave_layers__linear_attn_block__memory_aug_recurrent_mem_tr__prompt_kernel_k2f26
    s_add_u32 s40, s40, s41
    s_mov_b32 s47, 67633672
    s_cmp_eq_u32 s40, 1
    s_cselect_b32 s47, 67699226, s47
    s_cmp_eq_u32 s40, 2
    s_cselect_b32 s47, 67702404, s47
    s_cmp_eq_u32 s40, 3
    s_cselect_b32 s47, 67765224, s47
    s_cmp_eq_u32 s40, 4
    s_cselect_b32 s47, 67765896, s47
    s_cmp_eq_u32 s40, 5
    s_cselect_b32 s47, 67831450, s47
    s_cmp_eq_u32 s40, 6
    s_cselect_b32 s47, 67833604, s47
    s_cmp_eq_u32 s40, 7
    s_cselect_b32 s47, 67897320, s47
    s_cmp_eq_u32 s40, 8
    s_cselect_b32 s47, 67899142, s47
    s_cmp_eq_u32 s40, 9
    s_cselect_b32 s47, 75497992, s47
    s_cmp_eq_u32 s40, 10
    s_cselect_b32 s47, 75499162, s47
    s_cmp_eq_u32 s40, 11
    s_cselect_b32 s47, 75501316, s47
    s_cmp_eq_u32 s40, 12
    s_cselect_b32 s47, 247768, s47
    s_cmp_eq_u32 s40, 13
    s_cselect_b32 s47, 249604, s47
    s_bfe_u32 s24, s47, 0x7000c
    s_bfe_u32 s25, s47, 0x50013
    s_bfe_u32 s26, s47, 0x30018
    v_mul_u32_u24 v9, s25, v7
    v_mul_u32_u24 v10, s26, v8
    v_add3_u32 v9, v9, v10, s24
    v_mul_u32_u24 v9, 205, v9
    v_lshrrev_b32 v9, 12, v9
    s_bfe_u32 s24, s47, 196608
    s_lshl_b32 s24, s24, 10
    v_add_u32 v10, s24, v5
    ds_read_b128 v[160:163], v10 offset:0
    ds_read_b128 v[164:167], v10 offset:7168
    ds_read_b128 v[168:171], v10 offset:14336
    ds_read_b128 v[172:175], v10 offset:21504
    s_bfe_u32 s25, s47, 196614
    s_lshl_b32 s25, s25, 4
    v_lshl_add_u32 v11, v3, 2, s25
    v_mul_u32_u24 v11, 205, v11
    v_lshrrev_b32 v11, 12, v11
    v_cmp_eq_u32 vcc, v9, v11
    s_waitcnt lgkmcnt(0)
    v_pk_add_f32 v[160:161], v[160:161], v[164:165]
    v_pk_add_f32 v[168:169], v[168:169], v[172:173]
    v_pk_add_f32 v[162:163], v[162:163], v[166:167]
    v_pk_add_f32 v[170:171], v[170:171], v[174:175]
    v_pk_add_f32 v[160:161], v[160:161], v[168:169]
    v_pk_add_f32 v[162:163], v[162:163], v[170:171]
    v_cvt_pk_bf16_f32 v176, v160, v161
    v_cvt_pk_bf16_f32 v177, v162, v163
    v_cndmask_b32 v176, 0, v176, vcc
    v_cndmask_b32 v177, 0, v177, vcc
    s_bfe_u32 s24, s47, 196611
    s_lshl_b32 s24, s24, 10
    v_add_u32 v10, s24, v5
    ds_read_b128 v[160:163], v10 offset:0
    ds_read_b128 v[164:167], v10 offset:7168
    ds_read_b128 v[168:171], v10 offset:14336
    ds_read_b128 v[172:175], v10 offset:21504
    s_bfe_u32 s25, s47, 196617
    s_lshl_b32 s25, s25, 4
    v_lshl_add_u32 v11, v3, 2, s25
    v_mul_u32_u24 v11, 205, v11
    v_lshrrev_b32 v11, 12, v11
    v_cmp_eq_u32 vcc, v9, v11
    s_waitcnt lgkmcnt(0)
    v_pk_add_f32 v[160:161], v[160:161], v[164:165]
    v_pk_add_f32 v[168:169], v[168:169], v[172:173]
    v_pk_add_f32 v[162:163], v[162:163], v[166:167]
    v_pk_add_f32 v[170:171], v[170:171], v[174:175]
    v_pk_add_f32 v[160:161], v[160:161], v[168:169]
    v_pk_add_f32 v[162:163], v[162:163], v[170:171]
    v_cvt_pk_bf16_f32 v178, v160, v161
    v_cvt_pk_bf16_f32 v179, v162, v163
    v_cndmask_b32 v178, 0, v178, vcc
    v_cndmask_b32 v179, 0, v179, vcc
    s_lshl_b32 s24, s40, 10
    s_add_u32 s24, s24, s43
    buffer_store_dwordx4 v[176:179], v5, s[8:11], s24 offen sc1
interleave_layers__linear_attn_block__memory_aug_recurrent_mem_tr__prompt_kernel_k2f26:
    s_add_u32 s40, s3, 4
    s_cmp_lt_u32 s40, s42
    s_cbranch_scc0 interleave_layers__linear_attn_block__memory_aug_recurrent_mem_tr__prompt_kernel_k2f27
    s_add_u32 s40, s40, s41
    s_mov_b32 s47, 67633672
    s_cmp_eq_u32 s40, 1
    s_cselect_b32 s47, 67699226, s47
    s_cmp_eq_u32 s40, 2
    s_cselect_b32 s47, 67702404, s47
    s_cmp_eq_u32 s40, 3
    s_cselect_b32 s47, 67765224, s47
    s_cmp_eq_u32 s40, 4
    s_cselect_b32 s47, 67765896, s47
    s_cmp_eq_u32 s40, 5
    s_cselect_b32 s47, 67831450, s47
    s_cmp_eq_u32 s40, 6
    s_cselect_b32 s47, 67833604, s47
    s_cmp_eq_u32 s40, 7
    s_cselect_b32 s47, 67897320, s47
    s_cmp_eq_u32 s40, 8
    s_cselect_b32 s47, 67899142, s47
    s_cmp_eq_u32 s40, 9
    s_cselect_b32 s47, 75497992, s47
    s_cmp_eq_u32 s40, 10
    s_cselect_b32 s47, 75499162, s47
    s_cmp_eq_u32 s40, 11
    s_cselect_b32 s47, 75501316, s47
    s_cmp_eq_u32 s40, 12
    s_cselect_b32 s47, 247768, s47
    s_cmp_eq_u32 s40, 13
    s_cselect_b32 s47, 249604, s47
    s_bfe_u32 s24, s47, 0x7000c
    s_bfe_u32 s25, s47, 0x50013
    s_bfe_u32 s26, s47, 0x30018
    v_mul_u32_u24 v9, s25, v7
    v_mul_u32_u24 v10, s26, v8
    v_add3_u32 v9, v9, v10, s24
    v_mul_u32_u24 v9, 205, v9
    v_lshrrev_b32 v9, 12, v9
    s_bfe_u32 s24, s47, 196608
    s_lshl_b32 s24, s24, 10
    v_add_u32 v10, s24, v5
    ds_read_b128 v[160:163], v10 offset:0
    ds_read_b128 v[164:167], v10 offset:7168
    ds_read_b128 v[168:171], v10 offset:14336
    ds_read_b128 v[172:175], v10 offset:21504
    s_bfe_u32 s25, s47, 196614
    s_lshl_b32 s25, s25, 4
    v_lshl_add_u32 v11, v3, 2, s25
    v_mul_u32_u24 v11, 205, v11
    v_lshrrev_b32 v11, 12, v11
    v_cmp_eq_u32 vcc, v9, v11
    s_waitcnt lgkmcnt(0)
    v_pk_add_f32 v[160:161], v[160:161], v[164:165]
    v_pk_add_f32 v[168:169], v[168:169], v[172:173]
    v_pk_add_f32 v[162:163], v[162:163], v[166:167]
    v_pk_add_f32 v[170:171], v[170:171], v[174:175]
    v_pk_add_f32 v[160:161], v[160:161], v[168:169]
    v_pk_add_f32 v[162:163], v[162:163], v[170:171]
    v_cvt_pk_bf16_f32 v176, v160, v161
    v_cvt_pk_bf16_f32 v177, v162, v163
    v_cndmask_b32 v176, 0, v176, vcc
    v_cndmask_b32 v177, 0, v177, vcc
    s_bfe_u32 s24, s47, 196611
    s_lshl_b32 s24, s24, 10
    v_add_u32 v10, s24, v5
    ds_read_b128 v[160:163], v10 offset:0
    ds_read_b128 v[164:167], v10 offset:7168
    ds_read_b128 v[168:171], v10 offset:14336
    ds_read_b128 v[172:175], v10 offset:21504
    s_bfe_u32 s25, s47, 196617
    s_lshl_b32 s25, s25, 4
    v_lshl_add_u32 v11, v3, 2, s25
    v_mul_u32_u24 v11, 205, v11
    v_lshrrev_b32 v11, 12, v11
    v_cmp_eq_u32 vcc, v9, v11
    s_waitcnt lgkmcnt(0)
    v_pk_add_f32 v[160:161], v[160:161], v[164:165]
    v_pk_add_f32 v[168:169], v[168:169], v[172:173]
    v_pk_add_f32 v[162:163], v[162:163], v[166:167]
    v_pk_add_f32 v[170:171], v[170:171], v[174:175]
    v_pk_add_f32 v[160:161], v[160:161], v[168:169]
    v_pk_add_f32 v[162:163], v[162:163], v[170:171]
    v_cvt_pk_bf16_f32 v178, v160, v161
    v_cvt_pk_bf16_f32 v179, v162, v163
    v_cndmask_b32 v178, 0, v178, vcc
    v_cndmask_b32 v179, 0, v179, vcc
    s_lshl_b32 s24, s40, 10
    s_add_u32 s24, s24, s43
    buffer_store_dwordx4 v[176:179], v5, s[8:11], s24 offen sc1
interleave_layers__linear_attn_block__memory_aug_recurrent_mem_tr__prompt_kernel_k2f27:
    s_waitcnt vmcnt(0)
    s_barrier
    s_lshl_b32 s24, s92, 7
    s_sub_u32 s25, s2, 64
    s_lshl_b32 s25, s25, 2
    s_add_u32 s24, s24, s25
    s_add_u32 s24, s24, 23103488
    s_cmp_eq_u32 s3, 0
    s_cbranch_scc0 interleave_layers__linear_attn_block__memory_aug_recurrent_mem_tr__prompt_kernel_pb28
    v_lshlrev_b32 v14, 7, v1
    v_add_u32 v14, s24, v14
    v_mov_b32 v15, 2146435072
    v_cmp_le_u32 vcc, 1, v1
    s_nop 1
    v_cndmask_b32 v14, v14, v15, vcc
    v_mov_b32 v15, 1
    buffer_store_dword v15, v14, s[8:11], 0 offen sc1
interleave_layers__linear_attn_block__memory_aug_recurrent_mem_tr__prompt_kernel_pb28:
interleave_layers__linear_attn_block__memory_aug_recurrent_mem_tr__prompt_kernel_rk25:
    s_sub_u32 s44, s2, 64
    v_lshlrev_b32 v5, 4, v1
    s_lshl_b32 s24, s44, 15
    s_lshl_b32 s25, s3, 13
    s_add_u32 s24, s24, s25
    v_add_u32 v6, s24, v5
    v_add_u32 v7, 4096, v6
    s_lshl_b32 s24, s3, 12
    s_and_b32 s25, s24, 0x2000
    s_add_u32 s24, s24, s25
    v_add_u32 v8, s24, v5
    s_lshl_b32 s24, s3, 10
    s_add_u32 s24, s24, 32768
    v_add_u32 v9, s24, v5
    s_lshl_b32 s24, s44, 14
    s_lshl_b32 s25, s3, 11
    s_add_u32 s24, s24, s25
    v_add_u32 v10, s24, v5
    v_and_b32 v204, 7, v2
    v_mul_u32_u24 v11, 80, v204
    v_lshl_add_u32 v11, v3, 4, v11
    s_mul_i32 s24, s3, 640
    v_add_u32 v11, s24, v11
    v_add_u32 v204, 8192, v5
    v_cmp_gt_u32 vcc, 8, v2
    s_nop 1
    v_cndmask_b32 v11, v204, v11, vcc
    v_and_b32 v204, 7, v2
    v_mul_u32_u24 v12, 80, v204
    v_lshrrev_b32 v204, 3, v2
    v_lshl_add_u32 v12, v204, 5, v12
    v_lshlrev_b32 v13, 4, v2
    s_lshl_b32 s24, s44, 8
    s_and_b32 s25, s24, 0x2000
    s_add_u32 s24, s24, s25
    v_add_u32 v13, s24, v13
    v_mov_b32 v204, 2146435072
    v_cmp_gt_u32 vcc, 1, v3
    s_nop 1
    v_cndmask_b32 v13, v204, v13, vcc
    v_cmp_le_u32 s[50:51], 8, v2
    s_and_b32 s25, s44, 15
    s_lshr_b32 s25, s25, 2
    s_sub_u32 s26, s44, 32
    s_lshr_b32 s26, s26, 1
    s_cmp_ge_u32 s44, 32
    s_cselect_b32 s25, s26, s25
    s_mul_i32 s24, s25, 16
    v_add_u32 v120, s24, v1
    v_lshlrev_b32 v120, 7, v120
    v_mov_b32 v204, 2146435072
    v_cmp_le_u32 vcc, 16, v1
    s_nop 1
    v_cndmask_b32 v120, v120, v204, vcc
    s_and_b32 s24, s44, 7
    s_mul_i32 s25, s3, 8
    s_add_u32 s24, s24, s25
    s_lshl_b32 s24, s24, 7
    v_mov_b32 v125, s24
    v_mov_b32 v122, 12288
    v_mov_b32 v123, 0
    s_barrier
    ds_write_b32 v122, v123
    v_mov_b32 v123, 1
    s_waitcnt lgkmcnt(0)
    s_barrier
    s_mov_b32 s93, 0
    s_lshl_b32 s24, s93, 12
    s_and_b32 s24, s24, 0x2000
    s_xor_b32 s24, s24, s36
    s_lshl_b32 s93, s93, 20
    s_add_u32 s93, s93, s24
    s_add_u32 s93, s93, 117440512
    s_mul_i32 s94, s92, 16384
    s_add_u32 s94, s94, 23068672
    s_mov_b32 s40, 0
    s_mov_b32 s41, 184549376
    s_add_u32 s45, s93, 753664
    s_add_u32 s46, s93, 737280
    s_add_u32 s43, s93, 655360
    s_add_u32 s42, s93, 0
    s_add_u32 s47, s93, 704512
    v_and_b32 v252, 7, v1
    v_lshlrev_b32 v252, 7, v252
    s_lshl_b32 s24, s3, 10
    s_add_u32 s24, s24, 12288
    s_add_u32 s24, s24, s94
    v_add_u32 v252, s24, v252
    s_mov_b32 s62, -1
    s_mov_b32 s63, 1
    s_cmp_ge_i32 s62, s63
    s_cbranch_scc1 interleave_layers__linear_attn_block__memory_aug_recurrent_mem_tr__prompt_kernel_r_en0_ok
    s_mov_b32 s61, 0
interleave_layers__linear_attn_block__memory_aug_recurrent_mem_tr__prompt_kernel_r_en0:
    buffer_load_dword v253, v252, s[8:11], 0 offen sc1
    s_waitcnt vmcnt(0)
    v_readlane_b32 s62, v253, 0
    v_readlane_b32 s24, v253, 1
    s_min_i32 s62, s62, s24
    v_readlane_b32 s24, v253, 2
    s_min_i32 s62, s62, s24
    v_readlane_b32 s24, v253, 3
    s_min_i32 s62, s62, s24
    v_readlane_b32 s24, v253, 4
    s_min_i32 s62, s62, s24
    v_readlane_b32 s24, v253, 5
    s_min_i32 s62, s62, s24
    v_readlane_b32 s24, v253, 6
    s_min_i32 s62, s62, s24
    v_readlane_b32 s24, v253, 7
    s_min_i32 s62, s62, s24
    s_cmp_ge_i32 s62, s63
    s_cbranch_scc1 interleave_layers__linear_attn_block__memory_aug_recurrent_mem_tr__prompt_kernel_r_en0_ok
    s_add_u32 s61, s61, 1
    s_cmp_ge_u32 s61, s60
    s_cbranch_scc1 interleave_layers__linear_attn_block__memory_aug_recurrent_mem_tr__prompt_kernel_r_en0_to
    s_sleep 2
    s_branch interleave_layers__linear_attn_block__memory_aug_recurrent_mem_tr__prompt_kernel_r_en0
interleave_layers__linear_attn_block__memory_aug_recurrent_mem_tr__prompt_kernel_r_en0_to:
    s_mov_b32 s60, 1
interleave_layers__linear_attn_block__memory_aug_recurrent_mem_tr__prompt_kernel_r_en0_ok:
    buffer_load_dwordx4 v[48:51], v6, s[8:11], s41 offen offset:0 sc1
    buffer_load_dwordx4 v[52:55], v6, s[8:11], s41 offen offset:1024 sc1
    buffer_load_dwordx4 v[56:59], v6, s[8:11], s41 offen offset:2048 sc1
    buffer_load_dwordx4 v[60:63], v6, s[8:11], s41 offen offset:3072 sc1
    buffer_load_dwordx4 v[64:67], v7, s[8:11], s41 offen offset:0 sc1
    buffer_load_dwordx4 v[68:71], v7, s[8:11], s41 offen offset:1024 sc1
    buffer_load_dwordx4 v[72:75], v7, s[8:11], s41 offen offset:2048 sc1
    buffer_load_dwordx4 v[76:79], v7, s[8:11], s41 offen offset:3072 sc1
    s_add_u32 s41, s41, 1310720
interleave_layers__linear_attn_block__memory_aug_recurrent_mem_tr__prompt_kernel_r_step:
    s_waitcnt vmcnt(0)
    v_mov_b32 v16, v48
    v_mov_b32 v17, v49
    v_mov_b32 v18, v50
    v_mov_b32 v19, v51
    v_mov_b32 v20, v52
    v_mov_b32 v21, v53
    v_mov_b32 v22, v54
    v_mov_b32 v23, v55
    v_mov_b32 v24, v56
    v_mov_b32 v25, v57
    v_mov_b32 v26, v58
    v_mov_b32 v27, v59
    v_mov_b32 v28, v60
    v_mov_b32 v29, v61
    v_mov_b32 v30, v62
    v_mov_b32 v31, v63
    v_mov_b32 v32, v64
    v_mov_b32 v33, v65
    v_mov_b32 v34, v66
    v_mov_b32 v35, v67
    v_mov_b32 v36, v68
    v_mov_b32 v37, v69
    v_mov_b32 v38, v70
    v_mov_b32 v39, v71
    v_mov_b32 v40, v72
    v_mov_b32 v41, v73
    v_mov_b32 v42, v74
    v_mov_b32 v43, v75
    v_mov_b32 v44, v76
    v_mov_b32 v45, v77
    v_mov_b32 v46, v78
    v_mov_b32 v47, v79
    s_lshl_b32 s95, s92, 6
    s_add_u32 s95, s95, s40
    s_add_u32 s95, s95, 1
    s_cmp_ge_i32 s59, s95
    s_cbranch_scc1 interleave_layers__linear_attn_block__memory_aug_recurrent_mem_tr__prompt_kernel_r_ec_ok
    s_and_b32 s24, s2, 7
    s_lshl_b32 s24, s24, 7
    s_add_u32 s24, s24, 23109632
    v_and_b32 v254, 3, v1
    v_lshl_add_u32 v254, v254, 2, s24
    s_mov_b32 s61, 0
interleave_layers__linear_attn_block__memory_aug_recurrent_mem_tr__prompt_kernel_r_ec:
    buffer_load_dword v253, v254, s[8:11], 0 offen sc1
    s_waitcnt vmcnt(0)
    v_readlane_b32 s59, v253, 0
    v_readlane_b32 s24, v253, 1
    s_min_i32 s59, s59, s24
    v_readlane_b32 s24, v253, 2
    s_min_i32 s59, s59, s24
    s_cmp_ge_i32 s59, s95
    s_cbranch_scc1 interleave_layers__linear_attn_block__memory_aug_recurrent_mem_tr__prompt_kernel_r_ec_ok
    s_add_u32 s61, s61, 1
    s_cmp_ge_u32 s61, s60
    s_cbranch_scc1 interleave_layers__linear_attn_block__memory_aug_recurrent_mem_tr__prompt_kernel_r_ec_to
    s_sleep 2
    s_branch interleave_layers__linear_attn_block__memory_aug_recurrent_mem_tr__prompt_kernel_r_ec
interleave_layers__linear_attn_block__memory_aug_recurrent_mem_tr__prompt_kernel_r_ec_to:
    s_mov_b32 s60, 1
interleave_layers__linear_attn_block__memory_aug_recurrent_mem_tr__prompt_kernel_r_ec_ok:
    s_mov_b64 exec, 1
    s_mov_b32 s61, 0
    v_mov_b32 v117, 0
    buffer_atomic_add v117, v125, s[8:11], s45 offen sc0
    s_sleep 1
    v_mov_b32 v118, 0
    buffer_atomic_add v118, v125, s[8:11], s45 offen sc0
    s_sleep 1
    v_mov_b32 v119, 0
    buffer_atomic_add v119, v125, s[8:11], s45 offen sc0
    s_sleep 1
interleave_layers__linear_attn_block__memory_aug_recurrent_mem_tr__prompt_kernel_r_pr:
    v_mov_b32 v116, 0
    buffer_atomic_add v116, v125, s[8:11], s45 offen sc0
    s_waitcnt vmcnt(3)
    v_cmp_le_i32 vcc, 7, v117
    s_add_u32 s61, s61, 1
    s_cbranch_vccnz interleave_layers__linear_attn_block__memory_aug_recurrent_mem_tr__prompt_kernel_r_pr_out
    s_sleep 1
    v_mov_b32 v117, 0
    buffer_atomic_add v117, v125, s[8:11], s45 offen sc0
    s_waitcnt vmcnt(3)
    v_cmp_le_i32 vcc, 7, v118
    s_add_u32 s61, s61, 1
    s_cbranch_vccnz interleave_layers__linear_attn_block__memory_aug_recurrent_mem_tr__prompt_kernel_r_pr_out
    s_sleep 1
    v_mov_b32 v118, 0
    buffer_atomic_add v118, v125, s[8:11], s45 offen sc0
    s_waitcnt vmcnt(3)
    v_cmp_le_i32 vcc, 7, v119
    s_add_u32 s61, s61, 1
    s_cbranch_vccnz interleave_layers__linear_attn_block__memory_aug_recurrent_mem_tr__prompt_kernel_r_pr_out
    s_sleep 1
    v_mov_b32 v119, 0
    buffer_atomic_add v119, v125, s[8:11], s45 offen sc0
    s_waitcnt vmcnt(3)
    v_cmp_le_i32 vcc, 7, v116
    s_add_u32 s61, s61, 1
    s_cbranch_vccnz interleave_layers__linear_attn_block__memory_aug_recurrent_mem_tr__prompt_kernel_r_pr_out
    s_sleep 1
    s_cmp_ge_u32 s61, s60
    s_cbranch_scc0 interleave_layers__linear_attn_block__memory_aug_recurrent_mem_tr__prompt_kernel_r_pr
    s_mov_b32 s60, 1
interleave_layers__linear_attn_block__memory_aug_recurrent_mem_tr__prompt_kernel_r_pr_out:
    s_mov_b64 exec, -1
    buffer_load_dwordx4 v[100:103], v10, s[8:11], s42 offen offset:0 sc1
    buffer_load_dwordx4 v[104:107], v10, s[8:11], s42 offen offset:1024 sc1
    buffer_load_dwordx4 v[80:83], v8, s[8:11], s43 offen offset:0 sc1
    buffer_load_dwordx4 v[84:87], v8, s[8:11], s43 offen offset:1024 sc1
    buffer_load_dwordx4 v[88:91], v8, s[8:11], s43 offen offset:2048 sc1
    buffer_load_dwordx4 v[92:95], v8, s[8:11], s43 offen offset:3072 sc1
    buffer_load_dwordx4 v[96:99], v9, s[8:11], s43 offen sc1
    s_waitcnt vmcnt(0)
    v_max3_u32 v204, v80, v81, v82
    v_max3_u32 v204, v204, v83, v84
    v_max3_u32 v204, v204, v85, v86
    v_max3_u32 v204, v204, v87, v88
    v_max3_u32 v204, v204, v89, v90
    v_max3_u32 v204, v204, v91, v92
    v_max3_u32 v204, v204, v93, v94
    v_max3_u32 v204, v204, v95, v96
    v_max3_u32 v204, v204, v97, v98
    v_max3_u32 v204, v204, v99, v100
    v_max3_u32 v204, v204, v101, v102
    v_max3_u32 v204, v204, v103, v104
    v_max3_u32 v204, v204, v105, v106
    v_max_u32 v204, v204, v107
    v_cmp_eq_u32 vcc, -1, v204
    s_cbranch_vccz interleave_layers__linear_attn_block__memory_aug_recurrent_mem_tr__prompt_kernel_r_p_out
    s_mov_b32 s61, 0
interleave_layers__linear_attn_block__memory_aug_recurrent_mem_tr__prompt_kernel_r_p:
    buffer_load_dwordx4 v[100:103], v10, s[8:11], s42 offen offset:0 sc1
    buffer_load_dwordx4 v[104:107], v10, s[8:11], s42 offen offset:1024 sc1
    buffer_load_dwordx4 v[80:83], v8, s[8:11], s43 offen offset:0 sc1
    buffer_load_dwordx4 v[84:87], v8, s[8:11], s43 offen offset:1024 sc1
    buffer_load_dwordx4 v[88:91], v8, s[8:11], s43 offen offset:2048 sc1
    buffer_load_dwordx4 v[92:95], v8, s[8:11], s43 offen offset:3072 sc1
    buffer_load_dwordx4 v[96:99], v9, s[8:11], s43 offen sc1
    s_waitcnt vmcnt(0)
    v_max3_u32 v204, v80, v81, v82
    v_max3_u32 v204, v204, v83, v84
    v_max3_u32 v204, v204, v85, v86
    v_max3_u32 v204, v204, v87, v88
    v_max3_u32 v204, v204, v89, v90
    v_max3_u32 v204, v204, v91, v92
    v_max3_u32 v204, v204, v93, v94
    v_max3_u32 v204, v204, v95, v96
    v_max3_u32 v204, v204, v97, v98
    v_max3_u32 v204, v204, v99, v100
    v_max3_u32 v204, v204, v101, v102
    v_max3_u32 v204, v204, v103, v104
    v_max3_u32 v204, v204, v105, v106
    v_max_u32 v204, v204, v107
    v_cmp_eq_u32 vcc, -1, v204
    s_add_u32 s61, s61, 1
    s_cbranch_vccz interleave_layers__linear_attn_block__memory_aug_recurrent_mem_tr__prompt_kernel_r_p_out
    s_cmp_ge_u32 s61, s60
    s_cbranch_scc1 interleave_layers__linear_attn_block__memory_aug_recurrent_mem_tr__prompt_kernel_r_p_to
    s_sleep 1
    s_branch interleave_layers__linear_attn_block__memory_aug_recurrent_mem_tr__prompt_kernel_r_p
interleave_layers__linear_attn_block__memory_aug_recurrent_mem_tr__prompt_kernel_r_p_to:
    s_mov_b32 s60, 1
interleave_layers__linear_attn_block__memory_aug_recurrent_mem_tr__prompt_kernel_r_p_out:
    s_mov_b64 exec, 1
    ds_add_rtn_u32 v124, v122, v123
    s_mov_b64 exec, -1
    v_mfma_f32_16x16x32_bf16 v[108:111], v[100:103], v[96:99], 0
    v_mfma_f32_16x16x32_bf16 v[112:115], v[104:107], v[96:99], 0
    v_mfma_f32_16x16x32_bf16 v[108:111], v[16:19], v[80:83], v[108:111]
    v_mfma_f32_16x16x32_bf16 v[112:115], v[20:23], v[80:83], v[112:115]
    s_waitcnt lgkmcnt(0)
    v_readfirstlane_b32 s24, v124
    s_and_b32 s24, s24, 3
    s_cmp_eq_u32 s24, 3
    s_cbranch_scc0 interleave_layers__linear_attn_block__memory_aug_recurrent_mem_tr__prompt_kernel_nh29
    buffer_atomic_add v123, v120, s[8:11], s46 offen
interleave_layers__linear_attn_block__memory_aug_recurrent_mem_tr__prompt_kernel_nh29:
    v_mfma_f32_16x16x32_bf16 v[108:111], v[24:27], v[84:87], v[108:111]
    v_mfma_f32_16x16x32_bf16 v[112:115], v[28:31], v[84:87], v[112:115]
    v_mfma_f32_16x16x32_bf16 v[108:111], v[32:35], v[88:91], v[108:111]
    v_mfma_f32_16x16x32_bf16 v[112:115], v[36:39], v[88:91], v[112:115]
    v_mfma_f32_16x16x32_bf16 v[108:111], v[40:43], v[92:95], v[108:111]
    v_mfma_f32_16x16x32_bf16 v[112:115], v[44:47], v[92:95], v[112:115]
    s_and_b32 s24, s40, 1
    s_mul_i32 s24, s24, 2560
    v_add_u32 v14, s24, v11
    v_add_u32 v15, s24, v12
    s_nop 3
    v_cndmask_b32 v108, v108, v112, s[50:51]
    v_cndmask_b32 v109, v109, v113, s[50:51]
    v_cndmask_b32 v110, v110, v114, s[50:51]
    v_cndmask_b32 v111, v111, v115, s[50:51]
    v_add_f32 v108, v108, v108 row_ror:8 row_mask:0xf bank_mask:0xf
    v_add_f32 v109, v109, v109 row_ror:8 row_mask:0xf bank_mask:0xf
    v_add_f32 v110, v110, v110 row_ror:8 row_mask:0xf bank_mask:0xf
    v_add_f32 v111, v111, v111 row_ror:8 row_mask:0xf bank_mask:0xf
    ds_write_b128 v14, v[108:111]
    s_waitcnt lgkmcnt(0)
    s_barrier
    s_cmp_eq_u32 s3, 0
    s_cbranch_scc0 interleave_layers__linear_attn_block__memory_aug_recurrent_mem_tr__prompt_kernel_np30
    ds_read_b128 v[220:223], v15 offset:0
    ds_read_b128 v[224:227], v15 offset:16
    ds_read_b128 v[228:231], v15 offset:640
    ds_read_b128 v[232:235], v15 offset:656
    ds_read_b128 v[236:239], v15 offset:1280
    ds_read_b128 v[240:243], v15 offset:1296
    ds_read_b128 v[244:247], v15 offset:1920
    ds_read_b128 v[248:251], v15 offset:1936
    s_waitcnt lgkmcnt(4)
    v_pk_add_f32 v[220:221], v[220:221], v[228:229]
    v_pk_add_f32 v[222:223], v[222:223], v[230:231]
    v_pk_add_f32 v[224:225], v[224:225], v[232:233]
    v_pk_add_f32 v[226:227], v[226:227], v[234:235]
    s_waitcnt lgkmcnt(0)
    v_pk_add_f32 v[236:237], v[236:237], v[244:245]
    v_pk_add_f32 v[238:239], v[238:239], v[246:247]
    v_pk_add_f32 v[240:241], v[240:241], v[248:249]
    v_pk_add_f32 v[242:243], v[242:243], v[250:251]
    v_pk_add_f32 v[220:221], v[220:221], v[236:237]
    v_pk_add_f32 v[222:223], v[222:223], v[238:239]
    v_pk_add_f32 v[224:225], v[224:225], v[240:241]
    v_pk_add_f32 v[226:227], v[226:227], v[242:243]
    v_cvt_pk_bf16_f32 v228, v220, v221
    v_cvt_pk_bf16_f32 v229, v222, v223
    v_cvt_pk_bf16_f32 v230, v224, v225
    v_cvt_pk_bf16_f32 v231, v226, v227
    v_min_u32 v228, -2, v228
    v_min_u32 v229, -2, v229
    v_min_u32 v230, -2, v230
    v_min_u32 v231, -2, v231
    buffer_store_dwordx4 v[228:231], v13, s[8:11], s47 offen sc1
interleave_layers__linear_attn_block__memory_aug_recurrent_mem_tr__prompt_kernel_np30:
    s_cmp_eq_u32 s3, 1
    s_cbranch_scc0 interleave_layers__linear_attn_block__memory_aug_recurrent_mem_tr__prompt_kernel_xf31
    s_cmp_eq_u32 s44, 39
    s_cbranch_scc0 interleave_layers__linear_attn_block__memory_aug_recurrent_mem_tr__prompt_kernel_xf31
    s_lshl_b32 s24, s92, 6
    s_add_u32 s24, s24, s40
    s_add_u32 s24, s24, 1
    v_lshlrev_b32 v204, 7, v1
    v_add_u32 v204, 23111680, v204
    v_mov_b32 v205, 2146435072
    v_cmp_le_u32 vcc, 8, v1
    s_nop 1
    v_cndmask_b32 v204, v204, v205, vcc
    v_mov_b32 v205, s24
    buffer_store_dword v205, v204, s[8:11], 0 offen sc1
interleave_layers__linear_attn_block__memory_aug_recurrent_mem_tr__prompt_kernel_xf31:
    s_add_u32 s63, s40, 2
    s_min_u32 s63, s63, 64
    s_cmp_ge_i32 s62, s63
    s_cselect_b32 s58, 1, 0
    s_cmp_eq_u32 s58, 1
    s_cbranch_scc1 interleave_layers__linear_attn_block__memory_aug_recurrent_mem_tr__prompt_kernel_rq32
    buffer_load_dword v253, v252, s[8:11], 0 offen sc1
interleave_layers__linear_attn_block__memory_aug_recurrent_mem_tr__prompt_kernel_rq32:
    s_sleep 18
    s_cmp_eq_u32 s58, 1
    s_cbranch_scc1 interleave_layers__linear_attn_block__memory_aug_recurrent_mem_tr__prompt_kernel_rq33
    s_waitcnt vmcnt(0)
    v_readlane_b32 s58, v253, 0
    v_readlane_b32 s24, v253, 1
    s_min_i32 s58, s58, s24
    v_readlane_b32 s24, v253, 2
    s_min_i32 s58, s58, s24
    v_readlane_b32 s24, v253, 3
    s_min_i32 s58, s58, s24
    v_readlane_b32 s24, v253, 4
    s_min_i32 s58, s58, s24
    v_readlane_b32 s24, v253, 5
    s_min_i32 s58, s58, s24
    v_readlane_b32 s24, v253, 6
    s_min_i32 s58, s58, s24
    v_readlane_b32 s24, v253, 7
    s_min_i32 s58, s58, s24
    s_max_i32 s62, s62, s58
interleave_layers__linear_attn_block__memory_aug_recurrent_mem_tr__prompt_kernel_rq33:
    s_cmp_ge_i32 s62, s63
    s_cbranch_scc1 interleave_layers__linear_attn_block__memory_aug_recurrent_mem_tr__prompt_kernel_r_en_ok
    s_mov_b32 s61, 0
interleave_layers__linear_attn_block__memory_aug_recurrent_mem_tr__prompt_kernel_r_en:
    buffer_load_dword v253, v252, s[8:11], 0 offen sc1
    s_waitcnt vmcnt(0)
    v_readlane_b32 s62, v253, 0
    v_readlane_b32 s24, v253, 1
    s_min_i32 s62, s62, s24
    v_readlane_b32 s24, v253, 2
    s_min_i32 s62, s62, s24
    v_readlane_b32 s24, v253, 3
    s_min_i32 s62, s62, s24
    v_readlane_b32 s24, v253, 4
    s_min_i32 s62, s62, s24
    v_readlane_b32 s24, v253, 5
    s_min_i32 s62, s62, s24
    v_readlane_b32 s24, v253, 6
    s_min_i32 s62, s62, s24
    v_readlane_b32 s24, v253, 7
    s_min_i32 s62, s62, s24
    s_cmp_ge_i32 s62, s63
    s_cbranch_scc1 interleave_layers__linear_attn_block__memory_aug_recurrent_mem_tr__prompt_kernel_r_en_ok
    s_add_u32 s61, s61, 1
    s_cmp_ge_u32 s61, s60
    s_cbranch_scc1 interleave_layers__linear_attn_block__memory_aug_recurrent_mem_tr__prompt_kernel_r_en_to
    s_sleep 2
    s_branch interleave_layers__linear_attn_block__memory_aug_recurrent_mem_tr__prompt_kernel_r_en
interleave_layers__linear_attn_block__memory_aug_recurrent_mem_tr__prompt_kernel_r_en_to:
    s_mov_b32 s60, 1
interleave_layers__linear_attn_block__memory_aug_recurrent_mem_tr__prompt_kernel_r_en_ok:
    buffer_load_dwordx4 v[48:51], v6, s[8:11], s41 offen offset:0 sc1
    buffer_load_dwordx4 v[52:55], v6, s[8:11], s41 offen offset:1024 sc1
    buffer_load_dwordx4 v[56:59], v6, s[8:11], s41 offen offset:2048 sc1
    buffer_load_dwordx4 v[60:63], v6, s[8:11], s41 offen offset:3072 sc1
    buffer_load_dwordx4 v[64:67], v7, s[8:11], s41 offen offset:0 sc1
    buffer_load_dwordx4 v[68:71], v7, s[8:11], s41 offen offset:1024 sc1
    buffer_load_dwordx4 v[72:75], v7, s[8:11], s41 offen offset:2048 sc1
    buffer_load_dwordx4 v[76:79], v7, s[8:11], s41 offen offset:3072 sc1
    s_add_u32 s41, s41, 1310720
    s_add_u32 s40, s40, 1
    s_lshl_b32 s24, s40, 12
    s_and_b32 s24, s24, 0x2000
    s_xor_b32 s24, s24, s36
    s_lshl_b32 s37, s40, 20
    s_add_u32 s37, s37, s24
    s_add_u32 s37, s37, 117440512
    s_add_u32 s42, s37, 0
    s_add_u32 s43, s37, 655360
    s_add_u32 s47, s37, 704512
    s_add_u32 s45, s37, 753664
    s_add_u32 s46, s37, 737280
    s_cmp_lt_u32 s40, 64
    s_cbranch_scc1 interleave_layers__linear_attn_block__memory_aug_recurrent_mem_tr__prompt_kernel_r_step
    s_waitcnt vmcnt(0)
    s_cmp_eq_u32 s92, 0
    s_cbranch_scc0 interleave_layers__linear_attn_block__memory_aug_recurrent_mem_tr__prompt_kernel_end
    s_mov_b32 s92, 1
    s_branch interleave_layers__linear_attn_block__memory_aug_recurrent_mem_tr__prompt_kernel_r_top
interleave_layers__linear_attn_block__memory_aug_recurrent_mem_tr__prompt_kernel_roleP:
    s_sub_u32 s44, s2, 104
    s_lshr_b32 s46, s44, 5
    s_and_b32 s44, s44, 31
    s_load_dwordx2 s[6:7], s[0:1], 40
    s_load_dwordx2 s[24:25], s[0:1], 48
    s_load_dwordx2 s[26:27], s[0:1], 56
    s_waitcnt lgkmcnt(0)
    s_cmp_eq_u32 s46, 1
    s_cselect_b32 s6, s24, s6
    s_cselect_b32 s7, s25, s7
    s_cmp_eq_u32 s46, 2
    s_cselect_b32 s6, s26, s6
    s_cselect_b32 s7, s27, s7
    s_mov_b32 s12, s6
    s_mov_b32 s13, s7
    s_mov_b32 s14, 7864320
    s_mov_b32 s15, 0x00020000
    v_add_u32 v16, 0, v0
    s_mov_b32 s24, 683
    v_mul_lo_u32 v17, v16, s24
    v_lshrrev_b32 v17, 14, v17
    v_mul_u32_u24 v18, 24, v17
    v_sub_u32 v18, v16, v18
    s_mov_b32 s24, 12288
    v_mul_lo_u32 v4, v17, s24
    v_lshl_add_u32 v4, v18, 4, v4
    v_mul_u32_u24 v10, 400, v17
    v_lshl_add_u32 v10, v18, 4, v10
    v_add_u32 v10, 81920, v10
    v_add_u32 v16, 256, v0
    s_mov_b32 s24, 683
    v_mul_lo_u32 v17, v16, s24
    v_lshrrev_b32 v17, 14, v17
    v_mul_u32_u24 v18, 24, v17
    v_sub_u32 v18, v16, v18
    s_mov_b32 s24, 12288
    v_mul_lo_u32 v5, v17, s24
    v_lshl_add_u32 v5, v18, 4, v5
    v_mul_u32_u24 v11, 400, v17
    v_lshl_add_u32 v11, v18, 4, v11
    v_add_u32 v11, 81920, v11
    v_add_u32 v16, 512, v0
    s_mov_b32 s24, 683
    v_mul_lo_u32 v17, v16, s24
    v_lshrrev_b32 v17, 14, v17
    v_mul_u32_u24 v18, 24, v17
    v_sub_u32 v18, v16, v18
    s_mov_b32 s24, 12288
    v_mul_lo_u32 v6, v17, s24
    v_lshl_add_u32 v6, v18, 4, v6
    v_mul_u32_u24 v12, 400, v17
    v_lshl_add_u32 v12, v18, 4, v12
    v_add_u32 v12, 81920, v12
    v_add_u32 v16, 768, v0
    s_mov_b32 s24, 683
    v_mul_lo_u32 v17, v16, s24
    v_lshrrev_b32 v17, 14, v17
    v_mul_u32_u24 v18, 24, v17
    v_sub_u32 v18, v16, v18
    s_mov_b32 s24, 12288
    v_mul_lo_u32 v7, v17, s24
    v_lshl_add_u32 v7, v18, 4, v7
    v_mul_u32_u24 v13, 400, v17
    v_lshl_add_u32 v13, v18, 4, v13
    v_add_u32 v13, 81920, v13
    v_add_u32 v16, 1024, v0
    s_mov_b32 s24, 683
    v_mul_lo_u32 v17, v16, s24
    v_lshrrev_b32 v17, 14, v17
    v_mul_u32_u24 v18, 24, v17
    v_sub_u32 v18, v16, v18
    s_mov_b32 s24, 12288
    v_mul_lo_u32 v8, v17, s24
    v_lshl_add_u32 v8, v18, 4, v8
    v_mul_u32_u24 v14, 400, v17
    v_lshl_add_u32 v14, v18, 4, v14
    v_add_u32 v14, 81920, v14
    v_add_u32 v16, 1280, v0
    s_mov_b32 s24, 683
    v_mul_lo_u32 v17, v16, s24
    v_lshrrev_b32 v17, 14, v17
    v_mul_u32_u24 v18, 24, v17
    v_sub_u32 v18, v16, v18
    s_mov_b32 s24, 12288
    v_mul_lo_u32 v9, v17, s24
    v_lshl_add_u32 v9, v18, 4, v9
    v_mul_u32_u24 v15, 400, v17
    v_lshl_add_u32 v15, v18, 4, v15
    v_add_u32 v15, 81920, v15
    v_lshrrev_b32 v16, 2, v2
    v_lshl_add_u32 v16, v3, 2, v16
    v_mul_u32_u24 v32, 400, v16
    v_and_b32 v16, 3, v2
    v_lshl_add_u32 v32, v16, 3, v32
    s_mul_i32 s24, s3, 96
    s_add_u32 s24, s24, 81920
    v_add_u32 v32, s24, v32
    s_mul_i32 s45, s44, 384
    s_add_u32 s47, s45, 0
    buffer_load_dwordx4 v[56:59], v4, s[12:15], s47 offen
    buffer_load_dwordx4 v[60:63], v5, s[12:15], s47 offen
    buffer_load_dwordx4 v[64:67], v6, s[12:15], s47 offen
    buffer_load_dwordx4 v[68:71], v7, s[12:15], s47 offen
    buffer_load_dwordx4 v[72:75], v8, s[12:15], s47 offen
    buffer_load_dwordx4 v[76:79], v9, s[12:15], s47 offen
    s_add_u32 s47, s45, 786432
    buffer_load_dwordx4 v[80:83], v4, s[12:15], s47 offen
    buffer_load_dwordx4 v[84:87], v5, s[12:15], s47 offen
    buffer_load_dwordx4 v[88:91], v6, s[12:15], s47 offen
    buffer_load_dwordx4 v[92:95], v7, s[12:15], s47 offen
    buffer_load_dwordx4 v[96:99], v8, s[12:15], s47 offen
    buffer_load_dwordx4 v[100:103], v9, s[12:15], s47 offen
    s_add_u32 s47, s45, 1572864
    buffer_load_dwordx4 v[104:107], v4, s[12:15], s47 offen
    buffer_load_dwordx4 v[108:111], v5, s[12:15], s47 offen
    buffer_load_dwordx4 v[112:115], v6, s[12:15], s47 offen
    buffer_load_dwordx4 v[116:119], v7, s[12:15], s47 offen
    buffer_load_dwordx4 v[120:123], v8, s[12:15], s47 offen
    buffer_load_dwordx4 v[124:127], v9, s[12:15], s47 offen
    s_add_u32 s47, s45, 2359296
    buffer_load_dwordx4 v[128:131], v4, s[12:15], s47 offen
    buffer_load_dwordx4 v[132:135], v5, s[12:15], s47 offen
    buffer_load_dwordx4 v[136:139], v6, s[12:15], s47 offen
    buffer_load_dwordx4 v[140:143], v7, s[12:15], s47 offen
    buffer_load_dwordx4 v[144:147], v8, s[12:15], s47 offen
    buffer_load_dwordx4 v[148:151], v9, s[12:15], s47 offen
    s_add_u32 s47, s45, 3145728
    buffer_load_dwordx4 v[152:155], v4, s[12:15], s47 offen
    buffer_load_dwordx4 v[156:159], v5, s[12:15], s47 offen
    buffer_load_dwordx4 v[160:163], v6, s[12:15], s47 offen
    buffer_load_dwordx4 v[164:167], v7, s[12:15], s47 offen
    buffer_load_dwordx4 v[168:171], v8, s[12:15], s47 offen
    buffer_load_dwordx4 v[172:175], v9, s[12:15], s47 offen
    s_add_u32 s47, s45, 3932160
    buffer_load_dwordx4 v[176:179], v4, s[12:15], s47 offen
    buffer_load_dwordx4 v[180:183], v5, s[12:15], s47 offen
    buffer_load_dwordx4 v[184:187], v6, s[12:15], s47 offen
    buffer_load_dwordx4 v[188:191], v7, s[12:15], s47 offen
    buffer_load_dwordx4 v[192:195], v8, s[12:15], s47 offen
    buffer_load_dwordx4 v[196:199], v9, s[12:15], s47 offen
    s_add_u32 s47, s45, 4718592
    buffer_load_dwordx4 v[200:203], v4, s[12:15], s47 offen
    buffer_load_dwordx4 v[204:207], v5, s[12:15], s47 offen
    buffer_load_dwordx4 v[208:211], v6, s[12:15], s47 offen
    buffer_load_dwordx4 v[212:215], v7, s[12:15], s47 offen
    buffer_load_dwordx4 v[216:219], v8, s[12:15], s47 offen
    buffer_load_dwordx4 v[220:223], v9, s[12:15], s47 offen
    s_add_u32 s47, s45, 5505024
    buffer_load_dwordx4 v[224:227], v4, s[12:15], s47 offen
    buffer_load_dwordx4 v[228:231], v5, s[12:15], s47 offen
    buffer_load_dwordx4 v[232:235], v6, s[12:15], s47 offen
    buffer_load_dwordx4 v[236:239], v7, s[12:15], s47 offen
    buffer_load_dwordx4 v[240:243], v8, s[12:15], s47 offen
    buffer_load_dwordx4 v[244:247], v9, s[12:15], s47 offen
    v_mov_b32 v28, 0x3f803f80
    v_mov_b32 v29, 0x3f803f80
    v_mov_b32 v30, 0x3f803f80
    v_mov_b32 v31, 0x3f803f80
    s_waitcnt vmcnt(42)
    ds_write_b128 v10, v[56:59] offset:0
    ds_write_b128 v11, v[60:63] offset:0
    ds_write_b128 v12, v[64:67] offset:0
    ds_write_b128 v13, v[68:71] offset:0
    ds_write_b128 v14, v[72:75] offset:0
    ds_write_b128 v15, v[76:79] offset:0
    s_waitcnt lgkmcnt(0)
    s_add_u32 s47, s45, 6291456
    buffer_load_dwordx4 v[56:59], v4, s[12:15], s47 offen
    buffer_load_dwordx4 v[60:63], v5, s[12:15], s47 offen
    buffer_load_dwordx4 v[64:67], v6, s[12:15], s47 offen
    buffer_load_dwordx4 v[68:71], v7, s[12:15], s47 offen
    buffer_load_dwordx4 v[72:75], v8, s[12:15], s47 offen
    buffer_load_dwordx4 v[76:79], v9, s[12:15], s47 offen
    s_barrier
    ds_read_b64_tr_b16 a[0:1], v32 offset:0
    ds_read_b64_tr_b16 a[2:3], v32 offset:6400
    ds_read_b64_tr_b16 a[4:5], v32 offset:12800
    ds_read_b64_tr_b16 a[6:7], v32 offset:19200
    ds_read_b64_tr_b16 a[80:81], v32 offset:32
    ds_read_b64_tr_b16 a[82:83], v32 offset:6432
    ds_read_b64_tr_b16 a[84:85], v32 offset:12832
    ds_read_b64_tr_b16 a[86:87], v32 offset:19232
    ds_read_b64_tr_b16 a[160:161], v32 offset:64
    ds_read_b64_tr_b16 a[162:163], v32 offset:6464
    ds_read_b64_tr_b16 a[164:165], v32 offset:12864
    ds_read_b64_tr_b16 a[166:167], v32 offset:19264
    s_waitcnt vmcnt(42)
    ds_write_b128 v10, v[80:83] offset:25600
    ds_write_b128 v11, v[84:87] offset:25600
    ds_write_b128 v12, v[88:91] offset:25600
    ds_write_b128 v13, v[92:95] offset:25600
    ds_write_b128 v14, v[96:99] offset:25600
    ds_write_b128 v15, v[100:103] offset:25600
    s_waitcnt lgkmcnt(0)
    s_add_u32 s47, s45, 7077888
    buffer_load_dwordx4 v[80:83], v4, s[12:15], s47 offen
    buffer_load_dwordx4 v[84:87], v5, s[12:15], s47 offen
    buffer_load_dwordx4 v[88:91], v6, s[12:15], s47 offen
    buffer_load_dwordx4 v[92:95], v7, s[12:15], s47 offen
    buffer_load_dwordx4 v[96:99], v8, s[12:15], s47 offen
    buffer_load_dwordx4 v[100:103], v9, s[12:15], s47 offen
    v_mfma_f32_16x16x32_bf16 v[16:19], a[0:3], v[28:31], 0
    v_mfma_f32_16x16x32_bf16 v[20:23], a[80:83], v[28:31], 0
    v_mfma_f32_16x16x32_bf16 v[24:27], a[160:163], v[28:31], 0
    v_mfma_f32_16x16x32_bf16 v[16:19], a[4:7], v[28:31], v[16:19]
    v_mfma_f32_16x16x32_bf16 v[20:23], a[84:87], v[28:31], v[20:23]
    v_mfma_f32_16x16x32_bf16 v[24:27], a[164:167], v[28:31], v[24:27]
    s_barrier
    ds_read_b64_tr_b16 a[8:9], v32 offset:25600
    ds_read_b64_tr_b16 a[10:11], v32 offset:32000
    ds_read_b64_tr_b16 a[12:13], v32 offset:38400
    ds_read_b64_tr_b16 a[14:15], v32 offset:44800
    ds_read_b64_tr_b16 a[88:89], v32 offset:25632
    ds_read_b64_tr_b16 a[90:91], v32 offset:32032
    ds_read_b64_tr_b16 a[92:93], v32 offset:38432
    ds_read_b64_tr_b16 a[94:95], v32 offset:44832
    ds_read_b64_tr_b16 a[168:169], v32 offset:25664
    ds_read_b64_tr_b16 a[170:171], v32 offset:32064
    ds_read_b64_tr_b16 a[172:173], v32 offset:38464
    ds_read_b64_tr_b16 a[174:175], v32 offset:44864
    s_waitcnt vmcnt(42)
    ds_write_b128 v10, v[104:107] offset:0
    ds_write_b128 v11, v[108:111] offset:0
    ds_write_b128 v12, v[112:115] offset:0
    ds_write_b128 v13, v[116:119] offset:0
    ds_write_b128 v14, v[120:123] offset:0
    ds_write_b128 v15, v[124:127] offset:0
    s_waitcnt lgkmcnt(0)
    v_mfma_f32_16x16x32_bf16 v[16:19], a[8:11], v[28:31], v[16:19]
    v_mfma_f32_16x16x32_bf16 v[20:23], a[88:91], v[28:31], v[20:23]
    v_mfma_f32_16x16x32_bf16 v[24:27], a[168:171], v[28:31], v[24:27]
    v_mfma_f32_16x16x32_bf16 v[16:19], a[12:15], v[28:31], v[16:19]
    v_mfma_f32_16x16x32_bf16 v[20:23], a[92:95], v[28:31], v[20:23]
    v_mfma_f32_16x16x32_bf16 v[24:27], a[172:175], v[28:31], v[24:27]
    s_barrier
    ds_read_b64_tr_b16 a[16:17], v32 offset:0
    ds_read_b64_tr_b16 a[18:19], v32 offset:6400
    ds_read_b64_tr_b16 a[20:21], v32 offset:12800
    ds_read_b64_tr_b16 a[22:23], v32 offset:19200
    ds_read_b64_tr_b16 a[96:97], v32 offset:32
    ds_read_b64_tr_b16 a[98:99], v32 offset:6432
    ds_read_b64_tr_b16 a[100:101], v32 offset:12832
    ds_read_b64_tr_b16 a[102:103], v32 offset:19232
    ds_read_b64_tr_b16 a[176:177], v32 offset:64
    ds_read_b64_tr_b16 a[178:179], v32 offset:6464
    ds_read_b64_tr_b16 a[180:181], v32 offset:12864
    ds_read_b64_tr_b16 a[182:183], v32 offset:19264
    s_waitcnt vmcnt(36)
    ds_write_b128 v10, v[128:131] offset:25600
    ds_write_b128 v11, v[132:135] offset:25600
    ds_write_b128 v12, v[136:139] offset:25600
    ds_write_b128 v13, v[140:143] offset:25600
    ds_write_b128 v14, v[144:147] offset:25600
    ds_write_b128 v15, v[148:151] offset:25600
    s_waitcnt lgkmcnt(0)
    v_mfma_f32_16x16x32_bf16 v[16:19], a[16:19], v[28:31], v[16:19]
    v_mfma_f32_16x16x32_bf16 v[20:23], a[96:99], v[28:31], v[20:23]
    v_mfma_f32_16x16x32_bf16 v[24:27], a[176:179], v[28:31], v[24:27]
    v_mfma_f32_16x16x32_bf16 v[16:19], a[20:23], v[28:31], v[16:19]
    v_mfma_f32_16x16x32_bf16 v[20:23], a[100:103], v[28:31], v[20:23]
    v_mfma_f32_16x16x32_bf16 v[24:27], a[180:183], v[28:31], v[24:27]
    s_barrier
    ds_read_b64_tr_b16 a[24:25], v32 offset:25600
    ds_read_b64_tr_b16 a[26:27], v32 offset:32000
    ds_read_b64_tr_b16 a[28:29], v32 offset:38400
    ds_read_b64_tr_b16 a[30:31], v32 offset:44800
    ds_read_b64_tr_b16 a[104:105], v32 offset:25632
    ds_read_b64_tr_b16 a[106:107], v32 offset:32032
    ds_read_b64_tr_b16 a[108:109], v32 offset:38432
    ds_read_b64_tr_b16 a[110:111], v32 offset:44832
    ds_read_b64_tr_b16 a[184:185], v32 offset:25664
    ds_read_b64_tr_b16 a[186:187], v32 offset:32064
    ds_read_b64_tr_b16 a[188:189], v32 offset:38464
    ds_read_b64_tr_b16 a[190:191], v32 offset:44864
    s_waitcnt vmcnt(30)
    ds_write_b128 v10, v[152:155] offset:0
    ds_write_b128 v11, v[156:159] offset:0
    ds_write_b128 v12, v[160:163] offset:0
    ds_write_b128 v13, v[164:167] offset:0
    ds_write_b128 v14, v[168:171] offset:0
    ds_write_b128 v15, v[172:175] offset:0
    s_waitcnt lgkmcnt(0)
    v_mfma_f32_16x16x32_bf16 v[16:19], a[24:27], v[28:31], v[16:19]
    v_mfma_f32_16x16x32_bf16 v[20:23], a[104:107], v[28:31], v[20:23]
    v_mfma_f32_16x16x32_bf16 v[24:27], a[184:187], v[28:31], v[24:27]
    v_mfma_f32_16x16x32_bf16 v[16:19], a[28:31], v[28:31], v[16:19]
    v_mfma_f32_16x16x32_bf16 v[20:23], a[108:111], v[28:31], v[20:23]
    v_mfma_f32_16x16x32_bf16 v[24:27], a[188:191], v[28:31], v[24:27]
    s_barrier
    ds_read_b64_tr_b16 a[32:33], v32 offset:0
    ds_read_b64_tr_b16 a[34:35], v32 offset:6400
    ds_read_b64_tr_b16 a[36:37], v32 offset:12800
    ds_read_b64_tr_b16 a[38:39], v32 offset:19200
    ds_read_b64_tr_b16 a[112:113], v32 offset:32
    ds_read_b64_tr_b16 a[114:115], v32 offset:6432
    ds_read_b64_tr_b16 a[116:117], v32 offset:12832
    ds_read_b64_tr_b16 a[118:119], v32 offset:19232
    ds_read_b64_tr_b16 a[192:193], v32 offset:64
    ds_read_b64_tr_b16 a[194:195], v32 offset:6464
    ds_read_b64_tr_b16 a[196:197], v32 offset:12864
    ds_read_b64_tr_b16 a[198:199], v32 offset:19264
    s_waitcnt vmcnt(24)
    ds_write_b128 v10, v[176:179] offset:25600
    ds_write_b128 v11, v[180:183] offset:25600
    ds_write_b128 v12, v[184:187] offset:25600
    ds_write_b128 v13, v[188:191] offset:25600
    ds_write_b128 v14, v[192:195] offset:25600
    ds_write_b128 v15, v[196:199] offset:25600
    s_waitcnt lgkmcnt(0)
    v_mfma_f32_16x16x32_bf16 v[16:19], a[32:35], v[28:31], v[16:19]
    v_mfma_f32_16x16x32_bf16 v[20:23], a[112:115], v[28:31], v[20:23]
    v_mfma_f32_16x16x32_bf16 v[24:27], a[192:195], v[28:31], v[24:27]
    v_mfma_f32_16x16x32_bf16 v[16:19], a[36:39], v[28:31], v[16:19]
    v_mfma_f32_16x16x32_bf16 v[20:23], a[116:119], v[28:31], v[20:23]
    v_mfma_f32_16x16x32_bf16 v[24:27], a[196:199], v[28:31], v[24:27]
    s_barrier
    ds_read_b64_tr_b16 a[40:41], v32 offset:25600
    ds_read_b64_tr_b16 a[42:43], v32 offset:32000
    ds_read_b64_tr_b16 a[44:45], v32 offset:38400
    ds_read_b64_tr_b16 a[46:47], v32 offset:44800
    ds_read_b64_tr_b16 a[120:121], v32 offset:25632
    ds_read_b64_tr_b16 a[122:123], v32 offset:32032
    ds_read_b64_tr_b16 a[124:125], v32 offset:38432
    ds_read_b64_tr_b16 a[126:127], v32 offset:44832
    ds_read_b64_tr_b16 a[200:201], v32 offset:25664
    ds_read_b64_tr_b16 a[202:203], v32 offset:32064
    ds_read_b64_tr_b16 a[204:205], v32 offset:38464
    ds_read_b64_tr_b16 a[206:207], v32 offset:44864
    s_waitcnt vmcnt(18)
    ds_write_b128 v10, v[200:203] offset:0
    ds_write_b128 v11, v[204:207] offset:0
    ds_write_b128 v12, v[208:211] offset:0
    ds_write_b128 v13, v[212:215] offset:0
    ds_write_b128 v14, v[216:219] offset:0
    ds_write_b128 v15, v[220:223] offset:0
    s_waitcnt lgkmcnt(0)
    v_mfma_f32_16x16x32_bf16 v[16:19], a[40:43], v[28:31], v[16:19]
    v_mfma_f32_16x16x32_bf16 v[20:23], a[120:123], v[28:31], v[20:23]
    v_mfma_f32_16x16x32_bf16 v[24:27], a[200:203], v[28:31], v[24:27]
    v_mfma_f32_16x16x32_bf16 v[16:19], a[44:47], v[28:31], v[16:19]
    v_mfma_f32_16x16x32_bf16 v[20:23], a[124:127], v[28:31], v[20:23]
    v_mfma_f32_16x16x32_bf16 v[24:27], a[204:207], v[28:31], v[24:27]
    s_barrier
    ds_read_b64_tr_b16 a[48:49], v32 offset:0
    ds_read_b64_tr_b16 a[50:51], v32 offset:6400
    ds_read_b64_tr_b16 a[52:53], v32 offset:12800
    ds_read_b64_tr_b16 a[54:55], v32 offset:19200
    ds_read_b64_tr_b16 a[128:129], v32 offset:32
    ds_read_b64_tr_b16 a[130:131], v32 offset:6432
    ds_read_b64_tr_b16 a[132:133], v32 offset:12832
    ds_read_b64_tr_b16 a[134:135], v32 offset:19232
    ds_read_b64_tr_b16 a[208:209], v32 offset:64
    ds_read_b64_tr_b16 a[210:211], v32 offset:6464
    ds_read_b64_tr_b16 a[212:213], v32 offset:12864
    ds_read_b64_tr_b16 a[214:215], v32 offset:19264
    s_waitcnt vmcnt(12)
    ds_write_b128 v10, v[224:227] offset:25600
    ds_write_b128 v11, v[228:231] offset:25600
    ds_write_b128 v12, v[232:235] offset:25600
    ds_write_b128 v13, v[236:239] offset:25600
    ds_write_b128 v14, v[240:243] offset:25600
    ds_write_b128 v15, v[244:247] offset:25600
    s_waitcnt lgkmcnt(0)
    v_mfma_f32_16x16x32_bf16 v[16:19], a[48:51], v[28:31], v[16:19]
    v_mfma_f32_16x16x32_bf16 v[20:23], a[128:131], v[28:31], v[20:23]
    v_mfma_f32_16x16x32_bf16 v[24:27], a[208:211], v[28:31], v[24:27]
    v_mfma_f32_16x16x32_bf16 v[16:19], a[52:55], v[28:31], v[16:19]
    v_mfma_f32_16x16x32_bf16 v[20:23], a[132:135], v[28:31], v[20:23]
    v_mfma_f32_16x16x32_bf16 v[24:27], a[212:215], v[28:31], v[24:27]
    s_barrier
    ds_read_b64_tr_b16 a[56:57], v32 offset:25600
    ds_read_b64_tr_b16 a[58:59], v32 offset:32000
    ds_read_b64_tr_b16 a[60:61], v32 offset:38400
    ds_read_b64_tr_b16 a[62:63], v32 offset:44800
    ds_read_b64_tr_b16 a[136:137], v32 offset:25632
    ds_read_b64_tr_b16 a[138:139], v32 offset:32032
    ds_read_b64_tr_b16 a[140:141], v32 offset:38432
    ds_read_b64_tr_b16 a[142:143], v32 offset:44832
    ds_read_b64_tr_b16 a[216:217], v32 offset:25664
    ds_read_b64_tr_b16 a[218:219], v32 offset:32064
    ds_read_b64_tr_b16 a[220:221], v32 offset:38464
    ds_read_b64_tr_b16 a[222:223], v32 offset:44864
    s_waitcnt vmcnt(6)
    ds_write_b128 v10, v[56:59] offset:0
    ds_write_b128 v11, v[60:63] offset:0
    ds_write_b128 v12, v[64:67] offset:0
    ds_write_b128 v13, v[68:71] offset:0
    ds_write_b128 v14, v[72:75] offset:0
    ds_write_b128 v15, v[76:79] offset:0
    s_waitcnt lgkmcnt(0)
    v_mfma_f32_16x16x32_bf16 v[16:19], a[56:59], v[28:31], v[16:19]
    v_mfma_f32_16x16x32_bf16 v[20:23], a[136:139], v[28:31], v[20:23]
    v_mfma_f32_16x16x32_bf16 v[24:27], a[216:219], v[28:31], v[24:27]
    v_mfma_f32_16x16x32_bf16 v[16:19], a[60:63], v[28:31], v[16:19]
    v_mfma_f32_16x16x32_bf16 v[20:23], a[140:143], v[28:31], v[20:23]
    v_mfma_f32_16x16x32_bf16 v[24:27], a[220:223], v[28:31], v[24:27]
    s_barrier
    ds_read_b64_tr_b16 a[64:65], v32 offset:0
    ds_read_b64_tr_b16 a[66:67], v32 offset:6400
    ds_read_b64_tr_b16 a[68:69], v32 offset:12800
    ds_read_b64_tr_b16 a[70:71], v32 offset:19200
    ds_read_b64_tr_b16 a[144:145], v32 offset:32
    ds_read_b64_tr_b16 a[146:147], v32 offset:6432
    ds_read_b64_tr_b16 a[148:149], v32 offset:12832
    ds_read_b64_tr_b16 a[150:151], v32 offset:19232
    ds_read_b64_tr_b16 a[224:225], v32 offset:64
    ds_read_b64_tr_b16 a[226:227], v32 offset:6464
    ds_read_b64_tr_b16 a[228:229], v32 offset:12864
    ds_read_b64_tr_b16 a[230:231], v32 offset:19264
    s_waitcnt vmcnt(0)
    ds_write_b128 v10, v[80:83] offset:25600
    ds_write_b128 v11, v[84:87] offset:25600
    ds_write_b128 v12, v[88:91] offset:25600
    ds_write_b128 v13, v[92:95] offset:25600
    ds_write_b128 v14, v[96:99] offset:25600
    ds_write_b128 v15, v[100:103] offset:25600
    s_waitcnt lgkmcnt(0)
    v_mfma_f32_16x16x32_bf16 v[16:19], a[64:67], v[28:31], v[16:19]
    v_mfma_f32_16x16x32_bf16 v[20:23], a[144:147], v[28:31], v[20:23]
    v_mfma_f32_16x16x32_bf16 v[24:27], a[224:227], v[28:31], v[24:27]
    v_mfma_f32_16x16x32_bf16 v[16:19], a[68:71], v[28:31], v[16:19]
    v_mfma_f32_16x16x32_bf16 v[20:23], a[148:151], v[28:31], v[20:23]
    v_mfma_f32_16x16x32_bf16 v[24:27], a[228:231], v[28:31], v[24:27]
    s_barrier
    ds_read_b64_tr_b16 a[72:73], v32 offset:25600
    ds_read_b64_tr_b16 a[74:75], v32 offset:32000
    ds_read_b64_tr_b16 a[76:77], v32 offset:38400
    ds_read_b64_tr_b16 a[78:79], v32 offset:44800
    ds_read_b64_tr_b16 a[152:153], v32 offset:25632
    ds_read_b64_tr_b16 a[154:155], v32 offset:32032
    ds_read_b64_tr_b16 a[156:157], v32 offset:38432
    ds_read_b64_tr_b16 a[158:159], v32 offset:44832
    ds_read_b64_tr_b16 a[232:233], v32 offset:25664
    ds_read_b64_tr_b16 a[234:235], v32 offset:32064
    ds_read_b64_tr_b16 a[236:237], v32 offset:38464
    ds_read_b64_tr_b16 a[238:239], v32 offset:44864
    s_waitcnt lgkmcnt(0)
    v_mfma_f32_16x16x32_bf16 v[16:19], a[72:75], v[28:31], v[16:19]
    v_mfma_f32_16x16x32_bf16 v[20:23], a[152:155], v[28:31], v[20:23]
    v_mfma_f32_16x16x32_bf16 v[24:27], a[232:235], v[28:31], v[24:27]
    v_mfma_f32_16x16x32_bf16 v[16:19], a[76:79], v[28:31], v[16:19]
    v_mfma_f32_16x16x32_bf16 v[20:23], a[156:159], v[28:31], v[20:23]
    v_mfma_f32_16x16x32_bf16 v[24:27], a[236:239], v[28:31], v[24:27]
    s_nop 5
    v_mov_b32 v224, v16
    v_mov_b32 v225, v17
    v_mov_b32 v226, v18
    v_mov_b32 v227, v19
    v_mov_b32 v228, v20
    v_mov_b32 v229, v21
    v_mov_b32 v230, v22
    v_mov_b32 v231, v23
    v_mov_b32 v232, v24
    v_mov_b32 v233, v25
    v_mov_b32 v234, v26
    v_mov_b32 v235, v27
    v_mov_b32 v236, v28
    v_mov_b32 v237, v29
    v_mov_b32 v238, v30
    v_mov_b32 v239, v31
    s_barrier
interleave_layers__linear_attn_block__memory_aug_recurrent_mem_tr__prompt_kernel_p_layer:
    s_mov_b32 s93, 0
    s_lshl_b32 s24, s93, 12
    s_and_b32 s24, s24, 0x2000
    s_xor_b32 s24, s24, s36
    s_lshl_b32 s93, s93, 20
    s_add_u32 s93, s93, s24
    s_add_u32 s93, s93, 117440512
    s_mul_i32 s94, s92, 16384
    s_add_u32 s94, s94, 23068672
    s_sub_u32 s44, s2, 104
    s_lshr_b32 s46, s44, 5
    s_and_b32 s44, s44, 31
    s_mov_b32 s43, 67108864
    s_cmp_eq_u32 s46, 1
    s_cselect_b32 s43, 92274688, s43
    s_cmp_eq_u32 s46, 2
    s_cselect_b32 s43, 33554432, s43
    s_cmp_eq_u32 s92, 0
    s_cselect_b32 s73, 0, 8388608
    v_lshlrev_b32 v5, 4, v1
    s_mul_i32 s24, s3, 10240
    v_add_u32 v6, s24, v5
    v_add_u32 v7, 4096, v6
    v_add_u32 v8, 8192, v6
    s_mul_i32 s24, s44, 12288
    s_mul_i32 s25, s3, 3072
    s_add_u32 s24, s24, s25
    v_add_u32 v11, s24, v5
    s_lshr_b32 s24, s3, 1
    s_lshl_b32 s24, s24, 8
    s_and_b32 s25, s3, 1
    s_lshl_b32 s25, s25, 3
    s_add_u32 s24, s24, s25
    s_add_u32 s24, s24, 81920
    v_lshlrev_b32 v13, 4, v2
    v_add_u32 v12, s24, v13
    v_add_u32 v13, 81920, v13
    v_lshrrev_b32 v15, 2, v2
    v_cmp_eq_u32 vcc, v15, v3
    v_lshlrev_b32 v15, 3, v1
    v_add_u32 v15, 82944, v15
    v_cndmask_b32 v12, v15, v12, vcc
    v_and_b32 v15, 3, v2
    v_cmp_eq_u32 s[48:49], 1, v15
    v_cmp_eq_u32 s[50:51], 2, v15
    v_cmp_eq_u32 s[54:55], 3, v15
    s_and_b32 s24, s2, 7
    s_lshl_b32 s24, s24, 7
    s_lshl_b32 s25, s92, 10
    s_add_u32 s24, s24, s25
    s_add_u32 s24, s24, 23105536
    s_mov_b32 s25, 20
    s_mov_b32 s75, 2
    s_mov_b32 s74, 16
    v_cmp_gt_u32 vcc, s25, v1
    s_nop 1
    v_cndmask_b32 v4, 0, v1, vcc
    v_lshlrev_b32 v4, 2, v4
    v_add_u32 v4, s24, v4
    s_lshl_b32 s24, s46, 12
    s_lshl_b32 s25, s44, 7
    s_add_u32 s24, s24, s25
    s_add_u32 s24, s24, s94
    v_mov_b32 v14, s24
    v_mov_b32 v15, 2146435072
    v_cmp_eq_u32 vcc, 0, v1
    s_nop 1
    v_cndmask_b32 v14, v15, v14, vcc
    s_cmp_eq_u32 s3, 0
    s_cselect_b32 s24, 0, 2146435072
    v_or_b32 v14, s24, v14
    s_sub_u32 s70, s2, 104
    s_mul_i32 s71, s70, 205
    s_lshr_b32 s71, s71, 12
    s_mul_i32 s24, s71, 20
    s_sub_u32 s70, s70, s24
    s_cmp_lt_u32 s71, 4
    s_cselect_b32 s64, s71, 64
    s_lshl_b32 s24, s70, 16
    s_lshl_b32 s25, s3, 13
    s_add_u32 s24, s24, s25
    v_add_u32 v240, s24, v5
    v_add_u32 v241, 4096, v240
    s_lshl_b32 s24, s70, 15
    s_lshl_b32 s25, s3, 11
    s_add_u32 s24, s24, s25
    v_add_u32 v242, s24, v5
    s_lshl_b32 s24, s3, 15
    v_add_u32 v193, s24, v5
    v_add_u32 v212, 0, v193
    v_add_u32 v213, 4096, v193
    v_add_u32 v214, 16384, v193
    v_add_u32 v215, 20480, v193
    s_lshl_b32 s24, s3, 12
    s_and_b32 s25, s24, 0x2000
    s_add_u32 s24, s24, s25
    s_add_u32 s24, s24, 131072
    v_add_u32 v216, s24, v5
    s_lshl_b32 s24, s3, 12
    s_add_u32 s24, s24, 83968
    v_add_u32 v217, s24, v5
    s_and_b32 s24, s3, 1
    s_lshl_b32 s24, s24, 10
    s_add_u32 s24, s24, 83968
    v_add_u32 v218, s24, v5
    s_and_b32 s24, s3, 1
    s_mul_i32 s24, s24, 20480
    s_lshl_b32 s25, s70, 10
    s_add_u32 s24, s24, s25
    v_add_u32 v219, s24, v5
    s_and_b32 s24, s3, 1
    s_lshl_b32 s24, s24, 4
    v_add_u32 v243, s24, v2
    v_mul_u32_u24 v243, 1280, v243
    v_lshl_add_u32 v243, v3, 3, v243
    s_lshl_b32 s24, s70, 6
    v_add_u32 v243, s24, v243
    s_load_dwordx2 s[26:27], s[0:1], 80
    s_waitcnt lgkmcnt(0)
    s_mov_b32 s12, s26
    s_mov_b32 s13, s27
    s_mov_b32 s14, 2621440
    s_mov_b32 s15, 0x00020000
    s_mul_i32 s65, s71, 1310720
    s_add_u32 s65, s65, 184549376
    s_lshl_b32 s24, s71, 12
    s_and_b32 s24, s24, 0x2000
    s_xor_b32 s24, s24, s36
    s_lshl_b32 s66, s71, 20
    s_add_u32 s66, s66, s24
    s_add_u32 s66, s66, 117440512
    s_xor_b32 s67, s66, 0x2000
    s_mul_i32 s68, s71, 40960
    v_and_b32 v252, 7, v1
    v_lshlrev_b32 v252, 7, v252
    s_lshl_b32 s24, s3, 10
    s_add_u32 s24, s24, 12288
    s_add_u32 s24, s24, s94
    v_add_u32 v252, s24, v252
    s_mov_b32 s69, -1
    s_lshl_b32 s24, s71, 7
    s_lshl_b32 s25, s70, 2
    s_add_u32 s24, s24, s25
    s_add_u32 s24, s24, 23107584
    s_cmp_eq_u32 s3, 0
    s_cselect_b32 s24, s24, 2146435072
    v_mov_b32 v245, s24
    v_mov_b32 v246, 2146435072
    v_cmp_eq_u32 vcc, 0, v1
    s_nop 1
    v_cndmask_b32 v245, v246, v245, vcc
    s_mov_b32 s79, -1
    s_mov_b32 s76, -1
    s_mov_b32 s62, -1
    s_mov_b32 s63, 1
    s_mov_b32 s39, -1
    s_cmp_ge_i32 s39, s63
    s_cbranch_scc1 interleave_layers__linear_attn_block__memory_aug_recurrent_mem_tr__prompt_kernel_p_en0_ok
    s_mov_b32 s61, 0
interleave_layers__linear_attn_block__memory_aug_recurrent_mem_tr__prompt_kernel_p_en0:
    buffer_load_dword v16, v4, s[8:11], 0 offen sc1
    s_waitcnt vmcnt(0)
    v_readlane_b32 s39, v16, 0
    v_readlane_b32 s24, v16, 1
    s_min_i32 s39, s39, s24
    v_readlane_b32 s24, v16, 2
    s_min_i32 s39, s39, s24
    v_readlane_b32 s24, v16, 3
    s_min_i32 s39, s39, s24
    v_readlane_b32 s24, v16, 4
    s_min_i32 s39, s39, s24
    s_cmp_ge_i32 s39, s63
    s_cbranch_scc1 interleave_layers__linear_attn_block__memory_aug_recurrent_mem_tr__prompt_kernel_p_en0_ok
    s_add_u32 s61, s61, 1
    s_cmp_ge_u32 s61, s60
    s_cbranch_scc1 interleave_layers__linear_attn_block__memory_aug_recurrent_mem_tr__prompt_kernel_p_en0_to
    s_sleep 2
    s_branch interleave_layers__linear_attn_block__memory_aug_recurrent_mem_tr__prompt_kernel_p_en0
interleave_layers__linear_attn_block__memory_aug_recurrent_mem_tr__prompt_kernel_p_en0_to:
    s_mov_b32 s60, 1
interleave_layers__linear_attn_block__memory_aug_recurrent_mem_tr__prompt_kernel_p_en0_ok:
    s_mov_b32 s41, s73
    buffer_load_dwordx4 v[16:19], v6, s[8:11], s41 offen offset:0
    buffer_load_dwordx4 v[20:23], v6, s[8:11], s41 offen offset:1024
    buffer_load_dwordx4 v[24:27], v6, s[8:11], s41 offen offset:2048
    buffer_load_dwordx4 v[28:31], v6, s[8:11], s41 offen offset:3072
    buffer_load_dwordx4 v[32:35], v7, s[8:11], s41 offen offset:0
    buffer_load_dwordx4 v[36:39], v7, s[8:11], s41 offen offset:1024
    buffer_load_dwordx4 v[40:43], v7, s[8:11], s41 offen offset:2048
    buffer_load_dwordx4 v[44:47], v7, s[8:11], s41 offen offset:3072
    buffer_load_dwordx4 v[48:51], v8, s[8:11], s41 offen offset:0
    buffer_load_dwordx4 v[52:55], v8, s[8:11], s41 offen offset:1024
    s_mov_b32 s40, 0
    s_mov_b32 s42, 0
    s_waitcnt vmcnt(0)
    v_mfma_f32_16x16x32_bf16 v[148:151], v[16:19], v[16:19], 0
    v_mfma_f32_16x16x32_bf16 v[144:147], v[236:239], v[16:19], 0
    v_mfma_f32_16x16x32_bf16 v[148:151], v[20:23], v[20:23], v[148:151]
    v_mfma_f32_16x16x32_bf16 v[144:147], v[236:239], v[20:23], v[144:147]
    v_mfma_f32_16x16x32_bf16 v[148:151], v[24:27], v[24:27], v[148:151]
    v_mfma_f32_16x16x32_bf16 v[144:147], v[236:239], v[24:27], v[144:147]
    v_mfma_f32_16x16x32_bf16 v[148:151], v[28:31], v[28:31], v[148:151]
    v_mfma_f32_16x16x32_bf16 v[144:147], v[236:239], v[28:31], v[144:147]
    v_mfma_f32_16x16x32_bf16 v[148:151], v[32:35], v[32:35], v[148:151]
    v_mfma_f32_16x16x32_bf16 v[144:147], v[236:239], v[32:35], v[144:147]
    v_mfma_f32_16x16x32_bf16 v[148:151], v[36:39], v[36:39], v[148:151]
    v_mfma_f32_16x16x32_bf16 v[144:147], v[236:239], v[36:39], v[144:147]
    v_mfma_f32_16x16x32_bf16 v[148:151], v[40:43], v[40:43], v[148:151]
    v_mfma_f32_16x16x32_bf16 v[144:147], v[236:239], v[40:43], v[144:147]
    v_mfma_f32_16x16x32_bf16 v[148:151], v[44:47], v[44:47], v[148:151]
    v_mfma_f32_16x16x32_bf16 v[144:147], v[236:239], v[44:47], v[144:147]
    v_mfma_f32_16x16x32_bf16 v[148:151], v[48:51], v[48:51], v[148:151]
    v_mfma_f32_16x16x32_bf16 v[144:147], v[236:239], v[48:51], v[144:147]
    v_mfma_f32_16x16x32_bf16 v[148:151], v[52:55], v[52:55], v[148:151]
    v_mfma_f32_16x16x32_bf16 v[144:147], v[236:239], v[52:55], v[144:147]
    ds_write_b128 v6, v[16:19] offset:0
    ds_write_b128 v6, v[20:23] offset:1024
    ds_write_b128 v6, v[24:27] offset:2048
    ds_write_b128 v6, v[28:31] offset:3072
    ds_write_b128 v6, v[32:35] offset:4096
    ds_write_b128 v6, v[36:39] offset:5120
    ds_write_b128 v6, v[40:43] offset:6144
    ds_write_b128 v6, v[44:47] offset:7168
    ds_write_b128 v6, v[48:51] offset:8192
    ds_write_b128 v6, v[52:55] offset:9216
    v_cndmask_b32 v145, v148, v149, s[48:49]
    v_cndmask_b32 v145, v145, v150, s[50:51]
    v_cndmask_b32 v145, v145, v151, s[54:55]
    ds_write_b64 v12, v[144:145]
    s_waitcnt lgkmcnt(0)
    s_barrier
    s_branch interleave_layers__linear_attn_block__memory_aug_recurrent_mem_tr__prompt_kernel_p_segA
interleave_layers__linear_attn_block__memory_aug_recurrent_mem_tr__prompt_kernel_p_pubA:
    s_waitcnt vmcnt(0)
    s_barrier
    s_cmp_eq_u32 s3, 0
    s_cbranch_scc0 interleave_layers__linear_attn_block__memory_aug_recurrent_mem_tr__prompt_kernel_fp34
    v_mov_b32 v15, s40
    buffer_store_dword v15, v14, s[8:11], 0 offen sc1
interleave_layers__linear_attn_block__memory_aug_recurrent_mem_tr__prompt_kernel_fp34:
interleave_layers__linear_attn_block__memory_aug_recurrent_mem_tr__prompt_kernel_p_segA:
    v_add_u32 v9, s42, v5
    s_xor_b32 s42, s42, 40960
    v_add_u32 v10, s42, v6
    s_and_b32 s24, s40, 1
    s_lshl_b32 s24, s24, 9
    v_add_u32 v124, s24, v13
    s_xor_b32 s24, s24, 512
    v_add_u32 v140, s24, v12
    ds_read_b128 v[112:115], v124
    ds_read_b128 v[116:119], v124 offset:256
    ds_read_b128 v[56:59], v9 offset:0
    ds_read_b128 v[60:63], v9 offset:20480
    ds_read_b128 v[64:67], v9 offset:1024
    ds_read_b128 v[68:71], v9 offset:21504
    ds_read_b128 v[72:75], v9 offset:2048
    ds_read_b128 v[76:79], v9 offset:22528
    ds_read_b128 v[80:83], v9 offset:3072
    ds_read_b128 v[84:87], v9 offset:23552
    s_waitcnt lgkmcnt(6)
    v_mfma_f32_16x16x32_bf16 v[88:91], a[0:3], v[56:59], 0
    v_add_f32 v112, v112, v114
    v_mfma_f32_16x16x32_bf16 v[92:95], a[80:83], v[56:59], 0
    v_add_f32 v113, v113, v115
    v_mfma_f32_16x16x32_bf16 v[96:99], a[160:163], v[56:59], 0
    v_mul_f32 v112, 0x3acccccd, v112
    v_mfma_f32_16x16x32_bf16 v[100:103], a[0:3], v[60:63], 0
    v_mul_f32 v114, v112, v112
    v_mfma_f32_16x16x32_bf16 v[104:107], a[80:83], v[60:63], 0
    v_mov_b32 v115, 0x3acccccd
    v_mfma_f32_16x16x32_bf16 v[108:111], a[160:163], v[60:63], 0
    v_fma_f32 v113, v113, v115, -v114
    ds_read_b128 v[56:59], v9 offset:4096
    ds_read_b128 v[60:63], v9 offset:24576
    s_waitcnt lgkmcnt(6)
    v_mfma_f32_16x16x32_bf16 v[88:91], a[4:7], v[64:67], v[88:91]
    v_max_f32 v113, 0, v113
    v_mfma_f32_16x16x32_bf16 v[92:95], a[84:87], v[64:67], v[92:95]
    v_add_f32 v113, 0x3727c5ac, v113
    v_mfma_f32_16x16x32_bf16 v[96:99], a[164:167], v[64:67], v[96:99]
    v_rsq_f32 v132, v113
    v_mfma_f32_16x16x32_bf16 v[100:103], a[4:7], v[68:71], v[100:103]
    v_mul_f32 v133, v112, v132
    v_mfma_f32_16x16x32_bf16 v[104:107], a[84:87], v[68:71], v[104:107]
    v_sub_f32 v133, 0, v133
    v_mfma_f32_16x16x32_bf16 v[108:111], a[164:167], v[68:71], v[108:111]
    v_add_f32 v116, v116, v118
    ds_read_b128 v[64:67], v9 offset:5120
    ds_read_b128 v[68:71], v9 offset:25600
    s_waitcnt lgkmcnt(6)
    v_mfma_f32_16x16x32_bf16 v[88:91], a[8:11], v[72:75], v[88:91]
    v_add_f32 v117, v117, v119
    v_mfma_f32_16x16x32_bf16 v[92:95], a[88:91], v[72:75], v[92:95]
    v_mul_f32 v116, 0x3acccccd, v116
    v_mfma_f32_16x16x32_bf16 v[96:99], a[168:171], v[72:75], v[96:99]
    v_mul_f32 v118, v116, v116
    v_mfma_f32_16x16x32_bf16 v[100:103], a[8:11], v[76:79], v[100:103]
    v_mov_b32 v119, 0x3acccccd
    v_mfma_f32_16x16x32_bf16 v[104:107], a[88:91], v[76:79], v[104:107]
    v_fma_f32 v117, v117, v119, -v118
    v_mfma_f32_16x16x32_bf16 v[108:111], a[168:171], v[76:79], v[108:111]
    v_max_f32 v117, 0, v117
    ds_read_b128 v[72:75], v9 offset:6144
    ds_read_b128 v[76:79], v9 offset:26624
    s_waitcnt lgkmcnt(6)
    v_mfma_f32_16x16x32_bf16 v[88:91], a[12:15], v[80:83], v[88:91]
    v_add_f32 v117, 0x3727c5ac, v117
    v_mfma_f32_16x16x32_bf16 v[92:95], a[92:95], v[80:83], v[92:95]
    v_rsq_f32 v134, v117
    v_mfma_f32_16x16x32_bf16 v[96:99], a[172:175], v[80:83], v[96:99]
    v_mul_f32 v135, v116, v134
    v_mfma_f32_16x16x32_bf16 v[100:103], a[12:15], v[84:87], v[100:103]
    v_sub_f32 v135, 0, v135
    v_mfma_f32_16x16x32_bf16 v[104:107], a[92:95], v[84:87], v[104:107]
    v_mfma_f32_16x16x32_bf16 v[108:111], a[172:175], v[84:87], v[108:111]
    ds_read_b128 v[80:83], v9 offset:7168
    ds_read_b128 v[84:87], v9 offset:27648
    s_waitcnt lgkmcnt(6)
    v_mfma_f32_16x16x32_bf16 v[88:91], a[16:19], v[56:59], v[88:91]
    v_mfma_f32_16x16x32_bf16 v[92:95], a[96:99], v[56:59], v[92:95]
    v_mfma_f32_16x16x32_bf16 v[96:99], a[176:179], v[56:59], v[96:99]
    v_mfma_f32_16x16x32_bf16 v[100:103], a[16:19], v[60:63], v[100:103]
    v_mfma_f32_16x16x32_bf16 v[104:107], a[96:99], v[60:63], v[104:107]
    v_mfma_f32_16x16x32_bf16 v[108:111], a[176:179], v[60:63], v[108:111]
    buffer_load_dword v152, v4, s[8:11], 0 offen sc1
    ds_read_b128 v[56:59], v9 offset:8192
    ds_read_b128 v[60:63], v9 offset:28672
    s_waitcnt lgkmcnt(6)
    v_mfma_f32_16x16x32_bf16 v[88:91], a[20:23], v[64:67], v[88:91]
    v_mfma_f32_16x16x32_bf16 v[92:95], a[100:103], v[64:67], v[92:95]
    v_mfma_f32_16x16x32_bf16 v[96:99], a[180:183], v[64:67], v[96:99]
    v_mfma_f32_16x16x32_bf16 v[100:103], a[20:23], v[68:71], v[100:103]
    v_mfma_f32_16x16x32_bf16 v[104:107], a[100:103], v[68:71], v[104:107]
    v_mfma_f32_16x16x32_bf16 v[108:111], a[180:183], v[68:71], v[108:111]
    ds_read_b128 v[64:67], v9 offset:9216
    ds_read_b128 v[68:71], v9 offset:29696
    s_waitcnt lgkmcnt(6)
    v_mfma_f32_16x16x32_bf16 v[88:91], a[24:27], v[72:75], v[88:91]
    v_mfma_f32_16x16x32_bf16 v[92:95], a[104:107], v[72:75], v[92:95]
    v_mfma_f32_16x16x32_bf16 v[96:99], a[184:187], v[72:75], v[96:99]
    v_mfma_f32_16x16x32_bf16 v[100:103], a[24:27], v[76:79], v[100:103]
    v_mfma_f32_16x16x32_bf16 v[104:107], a[104:107], v[76:79], v[104:107]
    v_mfma_f32_16x16x32_bf16 v[108:111], a[184:187], v[76:79], v[108:111]
    ds_read_b128 v[72:75], v9 offset:10240
    ds_read_b128 v[76:79], v9 offset:30720
    s_waitcnt lgkmcnt(6)
    v_mfma_f32_16x16x32_bf16 v[88:91], a[28:31], v[80:83], v[88:91]
    v_mfma_f32_16x16x32_bf16 v[92:95], a[108:111], v[80:83], v[92:95]
    v_mfma_f32_16x16x32_bf16 v[96:99], a[188:191], v[80:83], v[96:99]
    v_mfma_f32_16x16x32_bf16 v[100:103], a[28:31], v[84:87], v[100:103]
    v_mfma_f32_16x16x32_bf16 v[104:107], a[108:111], v[84:87], v[104:107]
    v_mfma_f32_16x16x32_bf16 v[108:111], a[188:191], v[84:87], v[108:111]
    ds_read_b128 v[80:83], v9 offset:11264
    ds_read_b128 v[84:87], v9 offset:31744
    s_waitcnt lgkmcnt(6)
    v_mfma_f32_16x16x32_bf16 v[88:91], a[32:35], v[56:59], v[88:91]
    v_mfma_f32_16x16x32_bf16 v[92:95], a[112:115], v[56:59], v[92:95]
    v_mfma_f32_16x16x32_bf16 v[96:99], a[192:195], v[56:59], v[96:99]
    v_mfma_f32_16x16x32_bf16 v[100:103], a[32:35], v[60:63], v[100:103]
    v_mfma_f32_16x16x32_bf16 v[104:107], a[112:115], v[60:63], v[104:107]
    v_mfma_f32_16x16x32_bf16 v[108:111], a[192:195], v[60:63], v[108:111]
    ds_read_b128 v[56:59], v9 offset:12288
    ds_read_b128 v[60:63], v9 offset:32768
    s_waitcnt lgkmcnt(6)
    v_mfma_f32_16x16x32_bf16 v[88:91], a[36:39], v[64:67], v[88:91]
    v_mfma_f32_16x16x32_bf16 v[92:95], a[116:119], v[64:67], v[92:95]
    v_mfma_f32_16x16x32_bf16 v[96:99], a[196:199], v[64:67], v[96:99]
    v_mfma_f32_16x16x32_bf16 v[100:103], a[36:39], v[68:71], v[100:103]
    v_mfma_f32_16x16x32_bf16 v[104:107], a[116:119], v[68:71], v[104:107]
    v_mfma_f32_16x16x32_bf16 v[108:111], a[196:199], v[68:71], v[108:111]
    ds_read_b128 v[64:67], v9 offset:13312
    ds_read_b128 v[68:71], v9 offset:33792
    s_waitcnt lgkmcnt(6)
    v_mfma_f32_16x16x32_bf16 v[88:91], a[40:43], v[72:75], v[88:91]
    v_mfma_f32_16x16x32_bf16 v[92:95], a[120:123], v[72:75], v[92:95]
    v_mfma_f32_16x16x32_bf16 v[96:99], a[200:203], v[72:75], v[96:99]
    v_mfma_f32_16x16x32_bf16 v[100:103], a[40:43], v[76:79], v[100:103]
    v_mfma_f32_16x16x32_bf16 v[104:107], a[120:123], v[76:79], v[104:107]
    v_mfma_f32_16x16x32_bf16 v[108:111], a[200:203], v[76:79], v[108:111]
    ds_read_b128 v[72:75], v9 offset:14336
    ds_read_b128 v[76:79], v9 offset:34816
    s_waitcnt lgkmcnt(6)
    v_mfma_f32_16x16x32_bf16 v[88:91], a[44:47], v[80:83], v[88:91]
    v_mfma_f32_16x16x32_bf16 v[92:95], a[124:127], v[80:83], v[92:95]
    v_mfma_f32_16x16x32_bf16 v[96:99], a[204:207], v[80:83], v[96:99]
    v_mfma_f32_16x16x32_bf16 v[100:103], a[44:47], v[84:87], v[100:103]
    v_mfma_f32_16x16x32_bf16 v[104:107], a[124:127], v[84:87], v[104:107]
    v_mfma_f32_16x16x32_bf16 v[108:111], a[204:207], v[84:87], v[108:111]
    ds_read_b128 v[80:83], v9 offset:15360
    ds_read_b128 v[84:87], v9 offset:35840
    s_waitcnt lgkmcnt(6)
    v_mfma_f32_16x16x32_bf16 v[88:91], a[48:51], v[56:59], v[88:91]
    v_mfma_f32_16x16x32_bf16 v[92:95], a[128:131], v[56:59], v[92:95]
    v_mfma_f32_16x16x32_bf16 v[96:99], a[208:211], v[56:59], v[96:99]
    v_mfma_f32_16x16x32_bf16 v[100:103], a[48:51], v[60:63], v[100:103]
    v_mfma_f32_16x16x32_bf16 v[104:107], a[128:131], v[60:63], v[104:107]
    v_mfma_f32_16x16x32_bf16 v[108:111], a[208:211], v[60:63], v[108:111]
    ds_read_b128 v[56:59], v9 offset:16384
    ds_read_b128 v[60:63], v9 offset:36864
    s_waitcnt lgkmcnt(6)
    v_mfma_f32_16x16x32_bf16 v[88:91], a[52:55], v[64:67], v[88:91]
    v_mfma_f32_16x16x32_bf16 v[92:95], a[132:135], v[64:67], v[92:95]
    v_mfma_f32_16x16x32_bf16 v[96:99], a[212:215], v[64:67], v[96:99]
    v_mfma_f32_16x16x32_bf16 v[100:103], a[52:55], v[68:71], v[100:103]
    v_mfma_f32_16x16x32_bf16 v[104:107], a[132:135], v[68:71], v[104:107]
    v_mfma_f32_16x16x32_bf16 v[108:111], a[212:215], v[68:71], v[108:111]
    ds_read_b128 v[64:67], v9 offset:17408
    ds_read_b128 v[68:71], v9 offset:37888
    s_waitcnt lgkmcnt(6)
    v_mfma_f32_16x16x32_bf16 v[88:91], a[56:59], v[72:75], v[88:91]
    v_mfma_f32_16x16x32_bf16 v[92:95], a[136:139], v[72:75], v[92:95]
    v_mfma_f32_16x16x32_bf16 v[96:99], a[216:219], v[72:75], v[96:99]
    v_mfma_f32_16x16x32_bf16 v[100:103], a[56:59], v[76:79], v[100:103]
    v_mfma_f32_16x16x32_bf16 v[104:107], a[136:139], v[76:79], v[104:107]
    v_mfma_f32_16x16x32_bf16 v[108:111], a[216:219], v[76:79], v[108:111]
    ds_read_b128 v[72:75], v9 offset:18432
    ds_read_b128 v[76:79], v9 offset:38912
    s_waitcnt lgkmcnt(6)
    v_mfma_f32_16x16x32_bf16 v[88:91], a[60:63], v[80:83], v[88:91]
    v_mfma_f32_16x16x32_bf16 v[92:95], a[140:143], v[80:83], v[92:95]
    v_mfma_f32_16x16x32_bf16 v[96:99], a[220:223], v[80:83], v[96:99]
    v_mfma_f32_16x16x32_bf16 v[100:103], a[60:63], v[84:87], v[100:103]
    v_mfma_f32_16x16x32_bf16 v[104:107], a[140:143], v[84:87], v[104:107]
    v_mfma_f32_16x16x32_bf16 v[108:111], a[220:223], v[84:87], v[108:111]
    ds_read_b128 v[80:83], v9 offset:19456
    ds_read_b128 v[84:87], v9 offset:39936
    s_waitcnt lgkmcnt(6)
    v_mfma_f32_16x16x32_bf16 v[88:91], a[64:67], v[56:59], v[88:91]
    v_mfma_f32_16x16x32_bf16 v[92:95], a[144:147], v[56:59], v[92:95]
    v_mfma_f32_16x16x32_bf16 v[96:99], a[224:227], v[56:59], v[96:99]
    v_mfma_f32_16x16x32_bf16 v[100:103], a[64:67], v[60:63], v[100:103]
    v_mfma_f32_16x16x32_bf16 v[104:107], a[144:147], v[60:63], v[104:107]
    v_mfma_f32_16x16x32_bf16 v[108:111], a[224:227], v[60:63], v[108:111]
    s_waitcnt lgkmcnt(4)
    v_mfma_f32_16x16x32_bf16 v[88:91], a[68:71], v[64:67], v[88:91]
    v_mfma_f32_16x16x32_bf16 v[92:95], a[148:151], v[64:67], v[92:95]
    v_mfma_f32_16x16x32_bf16 v[96:99], a[228:231], v[64:67], v[96:99]
    v_mfma_f32_16x16x32_bf16 v[100:103], a[68:71], v[68:71], v[100:103]
    v_mfma_f32_16x16x32_bf16 v[104:107], a[148:151], v[68:71], v[104:107]
    v_mfma_f32_16x16x32_bf16 v[108:111], a[228:231], v[68:71], v[108:111]
    s_waitcnt lgkmcnt(2)
    v_mfma_f32_16x16x32_bf16 v[88:91], a[72:75], v[72:75], v[88:91]
    v_mfma_f32_16x16x32_bf16 v[92:95], a[152:155], v[72:75], v[92:95]
    v_mfma_f32_16x16x32_bf16 v[96:99], a[232:235], v[72:75], v[96:99]
    v_mfma_f32_16x16x32_bf16 v[100:103], a[72:75], v[76:79], v[100:103]
    v_mfma_f32_16x16x32_bf16 v[104:107], a[152:155], v[76:79], v[104:107]
    v_mfma_f32_16x16x32_bf16 v[108:111], a[232:235], v[76:79], v[108:111]
    s_waitcnt lgkmcnt(0)
    v_mfma_f32_16x16x32_bf16 v[88:91], a[76:79], v[80:83], v[88:91]
    v_mfma_f32_16x16x32_bf16 v[92:95], a[156:159], v[80:83], v[92:95]
    v_mfma_f32_16x16x32_bf16 v[96:99], a[236:239], v[80:83], v[96:99]
    v_mfma_f32_16x16x32_bf16 v[100:103], a[76:79], v[84:87], v[100:103]
    v_mfma_f32_16x16x32_bf16 v[104:107], a[156:159], v[84:87], v[104:107]
    v_mfma_f32_16x16x32_bf16 v[108:111], a[236:239], v[84:87], v[108:111]
    v_pk_mul_f32 v[124:125], v[224:225], v[132:133] op_sel:[0,1] op_sel_hi:[1,1]
    v_pk_mul_f32 v[126:127], v[226:227], v[132:133] op_sel:[0,1] op_sel_hi:[1,1]
    s_nop 0
    v_pk_fma_f32 v[88:89], v[88:89], v[132:133], v[124:125] op_sel:[0,0,0] op_sel_hi:[1,0,1]
    v_pk_fma_f32 v[90:91], v[90:91], v[132:133], v[126:127] op_sel:[0,0,0] op_sel_hi:[1,0,1]
    v_pk_mul_f32 v[124:125], v[228:229], v[132:133] op_sel:[0,1] op_sel_hi:[1,1]
    v_pk_mul_f32 v[126:127], v[230:231], v[132:133] op_sel:[0,1] op_sel_hi:[1,1]
    v_pk_fma_f32 v[92:93], v[92:93], v[132:133], v[124:125] op_sel:[0,0,0] op_sel_hi:[1,0,1]
    v_pk_fma_f32 v[94:95], v[94:95], v[132:133], v[126:127] op_sel:[0,0,0] op_sel_hi:[1,0,1]
    v_pk_mul_f32 v[124:125], v[232:233], v[132:133] op_sel:[0,1] op_sel_hi:[1,1]
    v_pk_mul_f32 v[126:127], v[234:235], v[132:133] op_sel:[0,1] op_sel_hi:[1,1]
    v_pk_fma_f32 v[96:97], v[96:97], v[132:133], v[124:125] op_sel:[0,0,0] op_sel_hi:[1,0,1]
    v_pk_fma_f32 v[98:99], v[98:99], v[132:133], v[126:127] op_sel:[0,0,0] op_sel_hi:[1,0,1]
    v_pk_mul_f32 v[124:125], v[224:225], v[134:135] op_sel:[0,1] op_sel_hi:[1,1]
    v_pk_mul_f32 v[126:127], v[226:227], v[134:135] op_sel:[0,1] op_sel_hi:[1,1]
    v_pk_fma_f32 v[100:101], v[100:101], v[134:135], v[124:125] op_sel:[0,0,0] op_sel_hi:[1,0,1]
    v_pk_fma_f32 v[102:103], v[102:103], v[134:135], v[126:127] op_sel:[0,0,0] op_sel_hi:[1,0,1]
    v_pk_mul_f32 v[124:125], v[228:229], v[134:135] op_sel:[0,1] op_sel_hi:[1,1]
    v_pk_mul_f32 v[126:127], v[230:231], v[134:135] op_sel:[0,1] op_sel_hi:[1,1]
    v_pk_fma_f32 v[104:105], v[104:105], v[134:135], v[124:125] op_sel:[0,0,0] op_sel_hi:[1,0,1]
    v_pk_fma_f32 v[106:107], v[106:107], v[134:135], v[126:127] op_sel:[0,0,0] op_sel_hi:[1,0,1]
    v_pk_mul_f32 v[124:125], v[232:233], v[134:135] op_sel:[0,1] op_sel_hi:[1,1]
    v_pk_mul_f32 v[126:127], v[234:235], v[134:135] op_sel:[0,1] op_sel_hi:[1,1]
    v_pk_fma_f32 v[108:109], v[108:109], v[134:135], v[124:125] op_sel:[0,0,0] op_sel_hi:[1,0,1]
    v_pk_fma_f32 v[110:111], v[110:111], v[134:135], v[126:127] op_sel:[0,0,0] op_sel_hi:[1,0,1]
    v_cvt_pk_bf16_f32 v112, v88, v89
    v_cvt_pk_bf16_f32 v113, v90, v91
    v_cvt_pk_bf16_f32 v114, v92, v93
    v_cvt_pk_bf16_f32 v115, v94, v95
    v_cvt_pk_bf16_f32 v116, v100, v101
    v_cvt_pk_bf16_f32 v117, v102, v103
    v_cvt_pk_bf16_f32 v118, v104, v105
    v_cvt_pk_bf16_f32 v119, v106, v107
    v_cvt_pk_bf16_f32 v120, v96, v97
    v_cvt_pk_bf16_f32 v121, v98, v99
    v_cvt_pk_bf16_f32 v122, v108, v109
    v_cvt_pk_bf16_f32 v123, v110, v111
    buffer_store_dwordx4 v[112:115], v11, s[8:11], s43 offen offset:0 sc1
    buffer_store_dwordx4 v[116:119], v11, s[8:11], s43 offen offset:1024 sc1
    buffer_store_dwordx4 v[120:123], v11, s[8:11], s43 offen offset:2048 sc1
    s_add_u32 s43, s43, 393216
    s_waitcnt vmcnt(3)
    s_add_u32 s63, s40, 1
    s_lshr_b32 s63, s63, s75
    s_add_u32 s63, s63, 1
    s_min_u32 s63, s63, s74
    v_cmp_le_i32 vcc, s63, v152
    s_cmp_eq_u64 vcc, -1
    s_cselect_b32 s24, 1, 0
    s_cmp_ge_i32 s62, s63
    s_cselect_b32 s24, 1, s24
    s_cmp_eq_u32 s24, 1
    s_cbranch_scc0 interleave_layers__linear_attn_block__memory_aug_recurrent_mem_tr__prompt_kernel_po36
    s_max_i32 s62, s62, s63
    s_add_u32 s41, s41, 40960
    buffer_load_dwordx4 v[16:19], v6, s[8:11], s41 offen offset:0
    buffer_load_dwordx4 v[20:23], v6, s[8:11], s41 offen offset:1024
    buffer_load_dwordx4 v[24:27], v6, s[8:11], s41 offen offset:2048
    buffer_load_dwordx4 v[28:31], v6, s[8:11], s41 offen offset:3072
    buffer_load_dwordx4 v[32:35], v7, s[8:11], s41 offen offset:0
    buffer_load_dwordx4 v[36:39], v7, s[8:11], s41 offen offset:1024
    buffer_load_dwordx4 v[40:43], v7, s[8:11], s41 offen offset:2048
    buffer_load_dwordx4 v[44:47], v7, s[8:11], s41 offen offset:3072
    buffer_load_dwordx4 v[48:51], v8, s[8:11], s41 offen offset:0
    buffer_load_dwordx4 v[52:55], v8, s[8:11], s41 offen offset:1024
    buffer_load_dword v152, v4, s[8:11], 0 offen sc1
    s_waitcnt vmcnt(11)
    s_barrier
    s_add_u32 s24, s40, 1
    v_mov_b32 v15, s24
    buffer_store_dword v15, v14, s[8:11], 0 offen sc1
    s_branch interleave_layers__linear_attn_block__memory_aug_recurrent_mem_tr__prompt_kernel_po35
interleave_layers__linear_attn_block__memory_aug_recurrent_mem_tr__prompt_kernel_po36:
    s_waitcnt vmcnt(0)
    s_barrier
    s_add_u32 s24, s40, 1
    v_mov_b32 v15, s24
    buffer_store_dword v15, v14, s[8:11], 0 offen sc1
    s_add_u32 s63, s40, 1
    s_lshr_b32 s63, s63, s75
    s_add_u32 s63, s63, 1
    s_min_u32 s63, s63, s74
    s_cmp_ge_i32 s62, s63
    s_cbranch_scc1 interleave_layers__linear_attn_block__memory_aug_recurrent_mem_tr__prompt_kernel_p_enA_ok
    s_mov_b32 s61, 0
interleave_layers__linear_attn_block__memory_aug_recurrent_mem_tr__prompt_kernel_p_enA:
    buffer_load_dword v16, v4, s[8:11], 0 offen sc1
    s_waitcnt vmcnt(0)
    v_readlane_b32 s62, v16, 0
    v_readlane_b32 s24, v16, 1
    s_min_i32 s62, s62, s24
    v_readlane_b32 s24, v16, 2
    s_min_i32 s62, s62, s24
    v_readlane_b32 s24, v16, 3
    s_min_i32 s62, s62, s24
    v_readlane_b32 s24, v16, 4
    s_min_i32 s62, s62, s24
    v_readlane_b32 s24, v16, 5
    s_min_i32 s62, s62, s24
    v_readlane_b32 s24, v16, 6
    s_min_i32 s62, s62, s24
    v_readlane_b32 s24, v16, 7
    s_min_i32 s62, s62, s24
    v_readlane_b32 s24, v16, 8
    s_min_i32 s62, s62, s24
    v_readlane_b32 s24, v16, 9
    s_min_i32 s62, s62, s24
    v_readlane_b32 s24, v16, 10
    s_min_i32 s62, s62, s24
    v_readlane_b32 s24, v16, 11
    s_min_i32 s62, s62, s24
    v_readlane_b32 s24, v16, 12
    s_min_i32 s62, s62, s24
    v_readlane_b32 s24, v16, 13
    s_min_i32 s62, s62, s24
    v_readlane_b32 s24, v16, 14
    s_min_i32 s62, s62, s24
    v_readlane_b32 s24, v16, 15
    s_min_i32 s62, s62, s24
    v_readlane_b32 s24, v16, 16
    s_min_i32 s62, s62, s24
    v_readlane_b32 s24, v16, 17
    s_min_i32 s62, s62, s24
    v_readlane_b32 s24, v16, 18
    s_min_i32 s62, s62, s24
    v_readlane_b32 s24, v16, 19
    s_min_i32 s62, s62, s24
    s_cmp_ge_i32 s62, s63
    s_cbranch_scc1 interleave_layers__linear_attn_block__memory_aug_recurrent_mem_tr__prompt_kernel_p_enA_ok
    s_add_u32 s61, s61, 1
    s_cmp_ge_u32 s61, s60
    s_cbranch_scc1 interleave_layers__linear_attn_block__memory_aug_recurrent_mem_tr__prompt_kernel_p_enA_to
    s_sleep 2
    s_branch interleave_layers__linear_attn_block__memory_aug_recurrent_mem_tr__prompt_kernel_p_enA
interleave_layers__linear_attn_block__memory_aug_recurrent_mem_tr__prompt_kernel_p_enA_to:
    s_mov_b32 s60, 1
interleave_layers__linear_attn_block__memory_aug_recurrent_mem_tr__prompt_kernel_p_enA_ok:
    s_add_u32 s41, s41, 40960
    buffer_load_dwordx4 v[16:19], v6, s[8:11], s41 offen offset:0
    buffer_load_dwordx4 v[20:23], v6, s[8:11], s41 offen offset:1024
    buffer_load_dwordx4 v[24:27], v6, s[8:11], s41 offen offset:2048
    buffer_load_dwordx4 v[28:31], v6, s[8:11], s41 offen offset:3072
    buffer_load_dwordx4 v[32:35], v7, s[8:11], s41 offen offset:0
    buffer_load_dwordx4 v[36:39], v7, s[8:11], s41 offen offset:1024
    buffer_load_dwordx4 v[40:43], v7, s[8:11], s41 offen offset:2048
    buffer_load_dwordx4 v[44:47], v7, s[8:11], s41 offen offset:3072
    buffer_load_dwordx4 v[48:51], v8, s[8:11], s41 offen offset:0
    buffer_load_dwordx4 v[52:55], v8, s[8:11], s41 offen offset:1024
    buffer_load_dword v152, v4, s[8:11], 0 offen sc1
interleave_layers__linear_attn_block__memory_aug_recurrent_mem_tr__prompt_kernel_po35:
    s_waitcnt vmcnt(0)
    v_mfma_f32_16x16x32_bf16 v[148:151], v[16:19], v[16:19], 0
    v_mfma_f32_16x16x32_bf16 v[144:147], v[236:239], v[16:19], 0
    v_mfma_f32_16x16x32_bf16 v[148:151], v[20:23], v[20:23], v[148:151]
    v_mfma_f32_16x16x32_bf16 v[144:147], v[236:239], v[20:23], v[144:147]
    v_mfma_f32_16x16x32_bf16 v[148:151], v[24:27], v[24:27], v[148:151]
    v_mfma_f32_16x16x32_bf16 v[144:147], v[236:239], v[24:27], v[144:147]
    v_mfma_f32_16x16x32_bf16 v[148:151], v[28:31], v[28:31], v[148:151]
    v_mfma_f32_16x16x32_bf16 v[144:147], v[236:239], v[28:31], v[144:147]
    v_mfma_f32_16x16x32_bf16 v[148:151], v[32:35], v[32:35], v[148:151]
    v_mfma_f32_16x16x32_bf16 v[144:147], v[236:239], v[32:35], v[144:147]
    v_mfma_f32_16x16x32_bf16 v[148:151], v[36:39], v[36:39], v[148:151]
    v_mfma_f32_16x16x32_bf16 v[144:147], v[236:239], v[36:39], v[144:147]
    v_mfma_f32_16x16x32_bf16 v[148:151], v[40:43], v[40:43], v[148:151]
    v_mfma_f32_16x16x32_bf16 v[144:147], v[236:239], v[40:43], v[144:147]
    v_mfma_f32_16x16x32_bf16 v[148:151], v[44:47], v[44:47], v[148:151]
    v_mfma_f32_16x16x32_bf16 v[144:147], v[236:239], v[44:47], v[144:147]
    v_mfma_f32_16x16x32_bf16 v[148:151], v[48:51], v[48:51], v[148:151]
    v_mfma_f32_16x16x32_bf16 v[144:147], v[236:239], v[48:51], v[144:147]
    v_mfma_f32_16x16x32_bf16 v[148:151], v[52:55], v[52:55], v[148:151]
    v_mfma_f32_16x16x32_bf16 v[144:147], v[236:239], v[52:55], v[144:147]
    ds_write_b128 v10, v[16:19] offset:0
    ds_write_b128 v10, v[20:23] offset:1024
    ds_write_b128 v10, v[24:27] offset:2048
    ds_write_b128 v10, v[28:31] offset:3072
    ds_write_b128 v10, v[32:35] offset:4096
    ds_write_b128 v10, v[36:39] offset:5120
    ds_write_b128 v10, v[40:43] offset:6144
    ds_write_b128 v10, v[44:47] offset:7168
    ds_write_b128 v10, v[48:51] offset:8192
    ds_write_b128 v10, v[52:55] offset:9216
    v_cndmask_b32 v145, v148, v149, s[48:49]
    v_cndmask_b32 v145, v145, v150, s[50:51]
    v_cndmask_b32 v145, v145, v151, s[54:55]
    ds_write_b64 v140, v[144:145]
    s_add_u32 s40, s40, 1
    s_add_u32 s63, s40, 1
    s_lshr_b32 s63, s63, s75
    s_add_u32 s63, s63, 1
    s_min_u32 s63, s63, s74
    v_cmp_le_i32 vcc, s63, v152
    s_cmp_eq_u64 vcc, -1
    s_cselect_b32 s58, 1, 0
    s_cmp_ge_i32 s62, s63
    s_cselect_b32 s58, 1, s58
    s_and_b32 s24, s40, 1
    s_lshl_b32 s24, s24, 2
    s_add_u32 s24, s24, 83456
    s_lshl_b32 s25, s3, 4
    s_add_u32 s25, s25, s24
    v_mov_b32 v15, s25
    v_mov_b32 v152, s58
    ds_write_b32 v15, v152
    v_mov_b32 v15, s24
    s_waitcnt lgkmcnt(0)
    s_barrier
    ds_read_b32 v152, v15
    s_waitcnt lgkmcnt(0)
    v_readfirstlane_b32 s58, v152
    s_cmp_eq_u32 s58, 1
    s_cselect_b32 s24, s63, s62
    s_max_i32 s62, s62, s24
    s_branch interleave_layers__linear_attn_block__memory_aug_recurrent_mem_tr__prompt_kernel_p_next
interleave_layers__linear_attn_block__memory_aug_recurrent_mem_tr__prompt_kernel_p_seg:
    v_add_u32 v9, s42, v5
    s_xor_b32 s42, s42, 40960
    v_add_u32 v10, s42, v6
    s_add_u32 s63, s40, 1
    s_lshr_b32 s63, s63, s75
    s_add_u32 s63, s63, 1
    s_min_u32 s63, s63, s74
    s_cmp_ge_i32 s62, s63
    s_cbranch_scc1 interleave_layers__linear_attn_block__memory_aug_recurrent_mem_tr__prompt_kernel_p_en_ok
    s_mov_b32 s61, 0
interleave_layers__linear_attn_block__memory_aug_recurrent_mem_tr__prompt_kernel_p_en:
    buffer_load_dword v16, v4, s[8:11], 0 offen sc1
    s_waitcnt vmcnt(0)
    v_readlane_b32 s62, v16, 0
    v_readlane_b32 s24, v16, 1
    s_min_i32 s62, s62, s24
    v_readlane_b32 s24, v16, 2
    s_min_i32 s62, s62, s24
    v_readlane_b32 s24, v16, 3
    s_min_i32 s62, s62, s24
    v_readlane_b32 s24, v16, 4
    s_min_i32 s62, s62, s24
    v_readlane_b32 s24, v16, 5
    s_min_i32 s62, s62, s24
    v_readlane_b32 s24, v16, 6
    s_min_i32 s62, s62, s24
    v_readlane_b32 s24, v16, 7
    s_min_i32 s62, s62, s24
    v_readlane_b32 s24, v16, 8
    s_min_i32 s62, s62, s24
    v_readlane_b32 s24, v16, 9
    s_min_i32 s62, s62, s24
    v_readlane_b32 s24, v16, 10
    s_min_i32 s62, s62, s24
    v_readlane_b32 s24, v16, 11
    s_min_i32 s62, s62, s24
    v_readlane_b32 s24, v16, 12
    s_min_i32 s62, s62, s24
    v_readlane_b32 s24, v16, 13
    s_min_i32 s62, s62, s24
    v_readlane_b32 s24, v16, 14
    s_min_i32 s62, s62, s24
    v_readlane_b32 s24, v16, 15
    s_min_i32 s62, s62, s24
    v_readlane_b32 s24, v16, 16
    s_min_i32 s62, s62, s24
    v_readlane_b32 s24, v16, 17
    s_min_i32 s62, s62, s24
    v_readlane_b32 s24, v16, 18
    s_min_i32 s62, s62, s24
    v_readlane_b32 s24, v16, 19
    s_min_i32 s62, s62, s24
    s_cmp_ge_i32 s62, s63
    s_cbranch_scc1 interleave_layers__linear_attn_block__memory_aug_recurrent_mem_tr__prompt_kernel_p_en_ok
    s_add_u32 s61, s61, 1
    s_cmp_ge_u32 s61, s60
    s_cbranch_scc1 interleave_layers__linear_attn_block__memory_aug_recurrent_mem_tr__prompt_kernel_p_en_to
    s_sleep 2
    s_branch interleave_layers__linear_attn_block__memory_aug_recurrent_mem_tr__prompt_kernel_p_en
interleave_layers__linear_attn_block__memory_aug_recurrent_mem_tr__prompt_kernel_p_en_to:
    s_mov_b32 s60, 1
interleave_layers__linear_attn_block__memory_aug_recurrent_mem_tr__prompt_kernel_p_en_ok:
    s_add_u32 s41, s41, 40960
    buffer_load_dwordx4 v[16:19], v6, s[8:11], s41 offen offset:0
    buffer_load_dwordx4 v[20:23], v6, s[8:11], s41 offen offset:1024
    buffer_load_dwordx4 v[24:27], v6, s[8:11], s41 offen offset:2048
    buffer_load_dwordx4 v[28:31], v6, s[8:11], s41 offen offset:3072
    buffer_load_dwordx4 v[32:35], v7, s[8:11], s41 offen offset:0
    buffer_load_dwordx4 v[36:39], v7, s[8:11], s41 offen offset:1024
    buffer_load_dwordx4 v[40:43], v7, s[8:11], s41 offen offset:2048
    buffer_load_dwordx4 v[44:47], v7, s[8:11], s41 offen offset:3072
    buffer_load_dwordx4 v[48:51], v8, s[8:11], s41 offen offset:0
    buffer_load_dwordx4 v[52:55], v8, s[8:11], s41 offen offset:1024
    s_and_b32 s24, s40, 1
    s_lshl_b32 s24, s24, 9
    v_add_u32 v124, s24, v13
    s_xor_b32 s24, s24, 512
    v_add_u32 v140, s24, v12
    ds_read_b128 v[112:115], v124
    ds_read_b128 v[116:119], v124 offset:256
    ds_read_b128 v[56:59], v9 offset:0
    ds_read_b128 v[60:63], v9 offset:20480
    ds_read_b128 v[64:67], v9 offset:1024
    ds_read_b128 v[68:71], v9 offset:21504
    ds_read_b128 v[72:75], v9 offset:2048
    ds_read_b128 v[76:79], v9 offset:22528
    ds_read_b128 v[80:83], v9 offset:3072
    ds_read_b128 v[84:87], v9 offset:23552
    s_waitcnt lgkmcnt(6)
    v_mfma_f32_16x16x32_bf16 v[88:91], a[0:3], v[56:59], 0
    v_add_f32 v112, v112, v114
    v_mfma_f32_16x16x32_bf16 v[92:95], a[80:83], v[56:59], 0
    v_add_f32 v113, v113, v115
    v_mfma_f32_16x16x32_bf16 v[96:99], a[160:163], v[56:59], 0
    v_mul_f32 v112, 0x3acccccd, v112
    v_mfma_f32_16x16x32_bf16 v[100:103], a[0:3], v[60:63], 0
    v_mul_f32 v114, v112, v112
    v_mfma_f32_16x16x32_bf16 v[104:107], a[80:83], v[60:63], 0
    v_mov_b32 v115, 0x3acccccd
    v_mfma_f32_16x16x32_bf16 v[108:111], a[160:163], v[60:63], 0
    v_fma_f32 v113, v113, v115, -v114
    ds_read_b128 v[56:59], v9 offset:4096
    ds_read_b128 v[60:63], v9 offset:24576
    s_waitcnt lgkmcnt(6)
    v_mfma_f32_16x16x32_bf16 v[88:91], a[4:7], v[64:67], v[88:91]
    v_max_f32 v113, 0, v113
    v_mfma_f32_16x16x32_bf16 v[92:95], a[84:87], v[64:67], v[92:95]
    v_add_f32 v113, 0x3727c5ac, v113
    v_mfma_f32_16x16x32_bf16 v[96:99], a[164:167], v[64:67], v[96:99]
    v_rsq_f32 v132, v113
    v_mfma_f32_16x16x32_bf16 v[100:103], a[4:7], v[68:71], v[100:103]
    v_mul_f32 v133, v112, v132
    v_mfma_f32_16x16x32_bf16 v[104:107], a[84:87], v[68:71], v[104:107]
    v_sub_f32 v133, 0, v133
    v_mfma_f32_16x16x32_bf16 v[108:111], a[164:167], v[68:71], v[108:111]
    v_add_f32 v116, v116, v118
    ds_read_b128 v[64:67], v9 offset:5120
    ds_read_b128 v[68:71], v9 offset:25600
    s_waitcnt lgkmcnt(6)
    v_mfma_f32_16x16x32_bf16 v[88:91], a[8:11], v[72:75], v[88:91]
    v_add_f32 v117, v117, v119
    v_mfma_f32_16x16x32_bf16 v[92:95], a[88:91], v[72:75], v[92:95]
    v_mul_f32 v116, 0x3acccccd, v116
    v_mfma_f32_16x16x32_bf16 v[96:99], a[168:171], v[72:75], v[96:99]
    v_mul_f32 v118, v116, v116
    v_mfma_f32_16x16x32_bf16 v[100:103], a[8:11], v[76:79], v[100:103]
    v_mov_b32 v119, 0x3acccccd
    v_mfma_f32_16x16x32_bf16 v[104:107], a[88:91], v[76:79], v[104:107]
    v_fma_f32 v117, v117, v119, -v118
    v_mfma_f32_16x16x32_bf16 v[108:111], a[168:171], v[76:79], v[108:111]
    v_max_f32 v117, 0, v117
    ds_read_b128 v[72:75], v9 offset:6144
    ds_read_b128 v[76:79], v9 offset:26624
    s_waitcnt lgkmcnt(6)
    v_mfma_f32_16x16x32_bf16 v[88:91], a[12:15], v[80:83], v[88:91]
    v_add_f32 v117, 0x3727c5ac, v117
    v_mfma_f32_16x16x32_bf16 v[92:95], a[92:95], v[80:83], v[92:95]
    v_rsq_f32 v134, v117
    v_mfma_f32_16x16x32_bf16 v[96:99], a[172:175], v[80:83], v[96:99]
    v_mul_f32 v135, v116, v134
    v_mfma_f32_16x16x32_bf16 v[100:103], a[12:15], v[84:87], v[100:103]
    v_sub_f32 v135, 0, v135
    v_mfma_f32_16x16x32_bf16 v[104:107], a[92:95], v[84:87], v[104:107]
    v_mfma_f32_16x16x32_bf16 v[108:111], a[172:175], v[84:87], v[108:111]
    ds_read_b128 v[80:83], v9 offset:7168
    ds_read_b128 v[84:87], v9 offset:27648
    s_waitcnt lgkmcnt(6)
    v_mfma_f32_16x16x32_bf16 v[88:91], a[16:19], v[56:59], v[88:91]
    v_mfma_f32_16x16x32_bf16 v[92:95], a[96:99], v[56:59], v[92:95]
    v_mfma_f32_16x16x32_bf16 v[96:99], a[176:179], v[56:59], v[96:99]
    v_mfma_f32_16x16x32_bf16 v[100:103], a[16:19], v[60:63], v[100:103]
    v_mfma_f32_16x16x32_bf16 v[104:107], a[96:99], v[60:63], v[104:107]
    v_mfma_f32_16x16x32_bf16 v[108:111], a[176:179], v[60:63], v[108:111]
    ds_read_b128 v[56:59], v9 offset:8192
    ds_read_b128 v[60:63], v9 offset:28672
    s_waitcnt lgkmcnt(6)
    v_mfma_f32_16x16x32_bf16 v[88:91], a[20:23], v[64:67], v[88:91]
    v_mfma_f32_16x16x32_bf16 v[92:95], a[100:103], v[64:67], v[92:95]
    v_mfma_f32_16x16x32_bf16 v[96:99], a[180:183], v[64:67], v[96:99]
    v_mfma_f32_16x16x32_bf16 v[100:103], a[20:23], v[68:71], v[100:103]
    v_mfma_f32_16x16x32_bf16 v[104:107], a[100:103], v[68:71], v[104:107]
    v_mfma_f32_16x16x32_bf16 v[108:111], a[180:183], v[68:71], v[108:111]
    ds_read_b128 v[64:67], v9 offset:9216
    ds_read_b128 v[68:71], v9 offset:29696
    s_waitcnt lgkmcnt(6)
    v_mfma_f32_16x16x32_bf16 v[88:91], a[24:27], v[72:75], v[88:91]
    v_mfma_f32_16x16x32_bf16 v[92:95], a[104:107], v[72:75], v[92:95]
    v_mfma_f32_16x16x32_bf16 v[96:99], a[184:187], v[72:75], v[96:99]
    v_mfma_f32_16x16x32_bf16 v[100:103], a[24:27], v[76:79], v[100:103]
    v_mfma_f32_16x16x32_bf16 v[104:107], a[104:107], v[76:79], v[104:107]
    v_mfma_f32_16x16x32_bf16 v[108:111], a[184:187], v[76:79], v[108:111]
    ds_read_b128 v[72:75], v9 offset:10240
    ds_read_b128 v[76:79], v9 offset:30720
    s_waitcnt lgkmcnt(6)
    v_mfma_f32_16x16x32_bf16 v[88:91], a[28:31], v[80:83], v[88:91]
    v_mfma_f32_16x16x32_bf16 v[92:95], a[108:111], v[80:83], v[92:95]
    v_mfma_f32_16x16x32_bf16 v[96:99], a[188:191], v[80:83], v[96:99]
    v_mfma_f32_16x16x32_bf16 v[100:103], a[28:31], v[84:87], v[100:103]
    v_mfma_f32_16x16x32_bf16 v[104:107], a[108:111], v[84:87], v[104:107]
    v_mfma_f32_16x16x32_bf16 v[108:111], a[188:191], v[84:87], v[108:111]
    ds_read_b128 v[80:83], v9 offset:11264
    ds_read_b128 v[84:87], v9 offset:31744
    s_waitcnt lgkmcnt(6)
    v_mfma_f32_16x16x32_bf16 v[88:91], a[32:35], v[56:59], v[88:91]
    v_mfma_f32_16x16x32_bf16 v[92:95], a[112:115], v[56:59], v[92:95]
    v_mfma_f32_16x16x32_bf16 v[96:99], a[192:195], v[56:59], v[96:99]
    v_mfma_f32_16x16x32_bf16 v[100:103], a[32:35], v[60:63], v[100:103]
    v_mfma_f32_16x16x32_bf16 v[104:107], a[112:115], v[60:63], v[104:107]
    v_mfma_f32_16x16x32_bf16 v[108:111], a[192:195], v[60:63], v[108:111]
    ds_read_b128 v[56:59], v9 offset:12288
    ds_read_b128 v[60:63], v9 offset:32768
    s_waitcnt lgkmcnt(6)
    v_mfma_f32_16x16x32_bf16 v[88:91], a[36:39], v[64:67], v[88:91]
    v_mfma_f32_16x16x32_bf16 v[92:95], a[116:119], v[64:67], v[92:95]
    v_mfma_f32_16x16x32_bf16 v[96:99], a[196:199], v[64:67], v[96:99]
    v_mfma_f32_16x16x32_bf16 v[100:103], a[36:39], v[68:71], v[100:103]
    v_mfma_f32_16x16x32_bf16 v[104:107], a[116:119], v[68:71], v[104:107]
    v_mfma_f32_16x16x32_bf16 v[108:111], a[196:199], v[68:71], v[108:111]
    s_waitcnt vmcnt(10)
    s_barrier
    v_mov_b32 v15, s40
    buffer_store_dword v15, v14, s[8:11], 0 offen sc1
    s_cmp_ge_i32 s79, 0
    s_cselect_b32 s24, 0, 2146435072
    v_or_b32 v246, s24, v245
    v_mov_b32 v247, s79
    buffer_store_dword v247, v246, s[8:11], 0 offen sc1
    s_mov_b32 s79, -1
    buffer_load_dword v152, v4, s[8:11], 0 offen sc1
    ds_read_b128 v[64:67], v9 offset:13312
    ds_read_b128 v[68:71], v9 offset:33792
    s_waitcnt lgkmcnt(6)
    v_mfma_f32_16x16x32_bf16 v[88:91], a[40:43], v[72:75], v[88:91]
    v_mfma_f32_16x16x32_bf16 v[92:95], a[120:123], v[72:75], v[92:95]
    v_mfma_f32_16x16x32_bf16 v[96:99], a[200:203], v[72:75], v[96:99]
    v_mfma_f32_16x16x32_bf16 v[100:103], a[40:43], v[76:79], v[100:103]
    v_mfma_f32_16x16x32_bf16 v[104:107], a[120:123], v[76:79], v[104:107]
    v_mfma_f32_16x16x32_bf16 v[108:111], a[200:203], v[76:79], v[108:111]
    ds_read_b128 v[72:75], v9 offset:14336
    ds_read_b128 v[76:79], v9 offset:34816
    s_waitcnt lgkmcnt(6)
    s_waitcnt vmcnt(3)
    v_mfma_f32_16x16x32_bf16 v[88:91], a[44:47], v[80:83], v[88:91]
    v_mfma_f32_16x16x32_bf16 v[92:95], a[124:127], v[80:83], v[92:95]
    ds_write_b128 v10, v[16:19] offset:0
    v_mfma_f32_16x16x32_bf16 v[96:99], a[204:207], v[80:83], v[96:99]
    v_mfma_f32_16x16x32_bf16 v[100:103], a[44:47], v[84:87], v[100:103]
    v_mfma_f32_16x16x32_bf16 v[104:107], a[124:127], v[84:87], v[104:107]
    v_mfma_f32_16x16x32_bf16 v[108:111], a[204:207], v[84:87], v[108:111]
    v_mfma_f32_16x16x32_bf16 v[148:151], v[16:19], v[16:19], 0
    v_mfma_f32_16x16x32_bf16 v[144:147], v[236:239], v[16:19], 0
    v_mfma_f32_16x16x32_bf16 v[148:151], v[20:23], v[20:23], v[148:151]
    ds_read_b128 v[80:83], v9 offset:15360
    ds_read_b128 v[84:87], v9 offset:35840
    s_waitcnt lgkmcnt(7)
    v_mfma_f32_16x16x32_bf16 v[88:91], a[48:51], v[56:59], v[88:91]
    v_mfma_f32_16x16x32_bf16 v[92:95], a[128:131], v[56:59], v[92:95]
    ds_write_b128 v10, v[20:23] offset:1024
    v_mfma_f32_16x16x32_bf16 v[96:99], a[208:211], v[56:59], v[96:99]
    v_mfma_f32_16x16x32_bf16 v[100:103], a[48:51], v[60:63], v[100:103]
    v_mfma_f32_16x16x32_bf16 v[104:107], a[128:131], v[60:63], v[104:107]
    v_mfma_f32_16x16x32_bf16 v[108:111], a[208:211], v[60:63], v[108:111]
    v_mfma_f32_16x16x32_bf16 v[144:147], v[236:239], v[20:23], v[144:147]
    v_mfma_f32_16x16x32_bf16 v[148:151], v[24:27], v[24:27], v[148:151]
    v_mfma_f32_16x16x32_bf16 v[144:147], v[236:239], v[24:27], v[144:147]
    ds_read_b128 v[56:59], v9 offset:16384
    ds_read_b128 v[60:63], v9 offset:36864
    s_waitcnt lgkmcnt(8)
    v_mfma_f32_16x16x32_bf16 v[88:91], a[52:55], v[64:67], v[88:91]
    v_mfma_f32_16x16x32_bf16 v[92:95], a[132:135], v[64:67], v[92:95]
    ds_write_b128 v10, v[24:27] offset:2048
    v_mfma_f32_16x16x32_bf16 v[96:99], a[212:215], v[64:67], v[96:99]
    v_mfma_f32_16x16x32_bf16 v[100:103], a[52:55], v[68:71], v[100:103]
    v_mfma_f32_16x16x32_bf16 v[104:107], a[132:135], v[68:71], v[104:107]
    v_mfma_f32_16x16x32_bf16 v[108:111], a[212:215], v[68:71], v[108:111]
    v_mfma_f32_16x16x32_bf16 v[148:151], v[28:31], v[28:31], v[148:151]
    v_mfma_f32_16x16x32_bf16 v[144:147], v[236:239], v[28:31], v[144:147]
    v_mfma_f32_16x16x32_bf16 v[148:151], v[32:35], v[32:35], v[148:151]
    ds_read_b128 v[64:67], v9 offset:17408
    ds_read_b128 v[68:71], v9 offset:37888
    s_waitcnt lgkmcnt(9)
    v_mfma_f32_16x16x32_bf16 v[88:91], a[56:59], v[72:75], v[88:91]
    v_mfma_f32_16x16x32_bf16 v[92:95], a[136:139], v[72:75], v[92:95]
    ds_write_b128 v10, v[28:31] offset:3072
    v_mfma_f32_16x16x32_bf16 v[96:99], a[216:219], v[72:75], v[96:99]
    v_mfma_f32_16x16x32_bf16 v[100:103], a[56:59], v[76:79], v[100:103]
    v_mfma_f32_16x16x32_bf16 v[104:107], a[136:139], v[76:79], v[104:107]
    v_mfma_f32_16x16x32_bf16 v[108:111], a[216:219], v[76:79], v[108:111]
    v_mfma_f32_16x16x32_bf16 v[144:147], v[236:239], v[32:35], v[144:147]
    v_mfma_f32_16x16x32_bf16 v[148:151], v[36:39], v[36:39], v[148:151]
    v_mfma_f32_16x16x32_bf16 v[144:147], v[236:239], v[36:39], v[144:147]
    ds_read_b128 v[72:75], v9 offset:18432
    ds_read_b128 v[76:79], v9 offset:38912
    s_waitcnt lgkmcnt(9)
    v_mfma_f32_16x16x32_bf16 v[88:91], a[60:63], v[80:83], v[88:91]
    v_mfma_f32_16x16x32_bf16 v[92:95], a[140:143], v[80:83], v[92:95]
    ds_write_b128 v10, v[32:35] offset:4096
    v_mfma_f32_16x16x32_bf16 v[96:99], a[220:223], v[80:83], v[96:99]
    v_mfma_f32_16x16x32_bf16 v[100:103], a[60:63], v[84:87], v[100:103]
    v_mfma_f32_16x16x32_bf16 v[104:107], a[140:143], v[84:87], v[104:107]
    v_mfma_f32_16x16x32_bf16 v[108:111], a[220:223], v[84:87], v[108:111]
    v_mfma_f32_16x16x32_bf16 v[148:151], v[40:43], v[40:43], v[148:151]
    v_mfma_f32_16x16x32_bf16 v[144:147], v[236:239], v[40:43], v[144:147]
    v_mfma_f32_16x16x32_bf16 v[148:151], v[44:47], v[44:47], v[148:151]
    ds_read_b128 v[80:83], v9 offset:19456
    ds_read_b128 v[84:87], v9 offset:39936
    s_waitcnt lgkmcnt(9)
    v_mfma_f32_16x16x32_bf16 v[88:91], a[64:67], v[56:59], v[88:91]
    v_mfma_f32_16x16x32_bf16 v[92:95], a[144:147], v[56:59], v[92:95]
    ds_write_b128 v10, v[36:39] offset:5120
    v_mfma_f32_16x16x32_bf16 v[96:99], a[224:227], v[56:59], v[96:99]
    v_mfma_f32_16x16x32_bf16 v[100:103], a[64:67], v[60:63], v[100:103]
    v_mfma_f32_16x16x32_bf16 v[104:107], a[144:147], v[60:63], v[104:107]
    v_mfma_f32_16x16x32_bf16 v[108:111], a[224:227], v[60:63], v[108:111]
    v_mfma_f32_16x16x32_bf16 v[144:147], v[236:239], v[44:47], v[144:147]
    v_mfma_f32_16x16x32_bf16 v[148:151], v[48:51], v[48:51], v[148:151]
    v_mfma_f32_16x16x32_bf16 v[144:147], v[236:239], v[48:51], v[144:147]
    s_waitcnt lgkmcnt(7)
    v_mfma_f32_16x16x32_bf16 v[88:91], a[68:71], v[64:67], v[88:91]
    v_mfma_f32_16x16x32_bf16 v[92:95], a[148:151], v[64:67], v[92:95]
    ds_write_b128 v10, v[40:43] offset:6144
    v_mfma_f32_16x16x32_bf16 v[96:99], a[228:231], v[64:67], v[96:99]
    v_mfma_f32_16x16x32_bf16 v[100:103], a[68:71], v[68:71], v[100:103]
    v_mfma_f32_16x16x32_bf16 v[104:107], a[148:151], v[68:71], v[104:107]
    v_mfma_f32_16x16x32_bf16 v[108:111], a[228:231], v[68:71], v[108:111]
    v_mfma_f32_16x16x32_bf16 v[148:151], v[52:55], v[52:55], v[148:151]
    v_mfma_f32_16x16x32_bf16 v[144:147], v[236:239], v[52:55], v[144:147]
    s_waitcnt lgkmcnt(5)
    v_mfma_f32_16x16x32_bf16 v[88:91], a[72:75], v[72:75], v[88:91]
    v_mfma_f32_16x16x32_bf16 v[92:95], a[152:155], v[72:75], v[92:95]
    ds_write_b128 v10, v[44:47] offset:7168
    v_mfma_f32_16x16x32_bf16 v[96:99], a[232:235], v[72:75], v[96:99]
    v_mfma_f32_16x16x32_bf16 v[100:103], a[72:75], v[76:79], v[100:103]
    v_mfma_f32_16x16x32_bf16 v[104:107], a[152:155], v[76:79], v[104:107]
    v_mfma_f32_16x16x32_bf16 v[108:111], a[232:235], v[76:79], v[108:111]
    s_waitcnt lgkmcnt(3)
    v_mfma_f32_16x16x32_bf16 v[88:91], a[76:79], v[80:83], v[88:91]
    v_mfma_f32_16x16x32_bf16 v[92:95], a[156:159], v[80:83], v[92:95]
    ds_write_b128 v10, v[48:51] offset:8192
    v_mfma_f32_16x16x32_bf16 v[96:99], a[236:239], v[80:83], v[96:99]
    v_mfma_f32_16x16x32_bf16 v[100:103], a[76:79], v[84:87], v[100:103]
    v_mfma_f32_16x16x32_bf16 v[104:107], a[156:159], v[84:87], v[104:107]
    v_mfma_f32_16x16x32_bf16 v[108:111], a[236:239], v[84:87], v[108:111]
    v_cndmask_b32 v145, v148, v149, s[48:49]
    v_cndmask_b32 v145, v145, v150, s[50:51]
    v_cndmask_b32 v145, v145, v151, s[54:55]
    ds_write_b128 v10, v[52:55] offset:9216
    ds_write_b64 v140, v[144:145]
    v_pk_mul_f32 v[124:125], v[224:225], v[132:133] op_sel:[0,1] op_sel_hi:[1,1]
    v_pk_mul_f32 v[126:127], v[226:227], v[132:133] op_sel:[0,1] op_sel_hi:[1,1]
    v_pk_fma_f32 v[88:89], v[88:89], v[132:133], v[124:125] op_sel:[0,0,0] op_sel_hi:[1,0,1]
    v_pk_fma_f32 v[90:91], v[90:91], v[132:133], v[126:127] op_sel:[0,0,0] op_sel_hi:[1,0,1]
    v_pk_mul_f32 v[124:125], v[228:229], v[132:133] op_sel:[0,1] op_sel_hi:[1,1]
    v_pk_mul_f32 v[126:127], v[230:231], v[132:133] op_sel:[0,1] op_sel_hi:[1,1]
    v_pk_fma_f32 v[92:93], v[92:93], v[132:133], v[124:125] op_sel:[0,0,0] op_sel_hi:[1,0,1]
    v_pk_fma_f32 v[94:95], v[94:95], v[132:133], v[126:127] op_sel:[0,0,0] op_sel_hi:[1,0,1]
    v_pk_mul_f32 v[124:125], v[232:233], v[132:133] op_sel:[0,1] op_sel_hi:[1,1]
    v_pk_mul_f32 v[126:127], v[234:235], v[132:133] op_sel:[0,1] op_sel_hi:[1,1]
    v_pk_fma_f32 v[96:97], v[96:97], v[132:133], v[124:125] op_sel:[0,0,0] op_sel_hi:[1,0,1]
    v_pk_fma_f32 v[98:99], v[98:99], v[132:133], v[126:127] op_sel:[0,0,0] op_sel_hi:[1,0,1]
    v_pk_mul_f32 v[124:125], v[224:225], v[134:135] op_sel:[0,1] op_sel_hi:[1,1]
    v_pk_mul_f32 v[126:127], v[226:227], v[134:135] op_sel:[0,1] op_sel_hi:[1,1]
    v_pk_fma_f32 v[100:101], v[100:101], v[134:135], v[124:125] op_sel:[0,0,0] op_sel_hi:[1,0,1]
    v_pk_fma_f32 v[102:103], v[102:103], v[134:135], v[126:127] op_sel:[0,0,0] op_sel_hi:[1,0,1]
    v_pk_mul_f32 v[124:125], v[228:229], v[134:135] op_sel:[0,1] op_sel_hi:[1,1]
    v_pk_mul_f32 v[126:127], v[230:231], v[134:135] op_sel:[0,1] op_sel_hi:[1,1]
    v_pk_fma_f32 v[104:105], v[104:105], v[134:135], v[124:125] op_sel:[0,0,0] op_sel_hi:[1,0,1]
    v_pk_fma_f32 v[106:107], v[106:107], v[134:135], v[126:127] op_sel:[0,0,0] op_sel_hi:[1,0,1]
    v_pk_mul_f32 v[124:125], v[232:233], v[134:135] op_sel:[0,1] op_sel_hi:[1,1]
    v_pk_mul_f32 v[126:127], v[234:235], v[134:135] op_sel:[0,1] op_sel_hi:[1,1]
    v_pk_fma_f32 v[108:109], v[108:109], v[134:135], v[124:125] op_sel:[0,0,0] op_sel_hi:[1,0,1]
    v_pk_fma_f32 v[110:111], v[110:111], v[134:135], v[126:127] op_sel:[0,0,0] op_sel_hi:[1,0,1]
    v_cvt_pk_bf16_f32 v112, v88, v89
    v_cvt_pk_bf16_f32 v113, v90, v91
    v_cvt_pk_bf16_f32 v114, v92, v93
    v_cvt_pk_bf16_f32 v115, v94, v95
    v_cvt_pk_bf16_f32 v116, v100, v101
    v_cvt_pk_bf16_f32 v117, v102, v103
    v_cvt_pk_bf16_f32 v118, v104, v105
    v_cvt_pk_bf16_f32 v119, v106, v107
    v_cvt_pk_bf16_f32 v120, v96, v97
    v_cvt_pk_bf16_f32 v121, v98, v99
    v_cvt_pk_bf16_f32 v122, v108, v109
    v_cvt_pk_bf16_f32 v123, v110, v111
    buffer_store_dwordx4 v[112:115], v11, s[8:11], s43 offen offset:0 sc1
    buffer_store_dwordx4 v[116:119], v11, s[8:11], s43 offen offset:1024 sc1
    buffer_store_dwordx4 v[120:123], v11, s[8:11], s43 offen offset:2048 sc1
    s_add_u32 s43, s43, 393216
    s_waitcnt vmcnt(3)
    s_add_u32 s40, s40, 1
    s_add_u32 s63, s40, 1
    s_lshr_b32 s63, s63, s75
    s_add_u32 s63, s63, 1
    s_min_u32 s63, s63, s74
    v_cmp_le_i32 vcc, s63, v152
    s_cmp_eq_u64 vcc, -1
    s_cselect_b32 s58, 1, 0
    s_cmp_ge_i32 s62, s63
    s_cselect_b32 s58, 1, s58
    s_and_b32 s24, s40, 1
    s_lshl_b32 s24, s24, 2
    s_add_u32 s24, s24, 83456
    s_lshl_b32 s25, s3, 4
    s_add_u32 s25, s25, s24
    v_mov_b32 v15, s25
    v_mov_b32 v152, s58
    ds_write_b32 v15, v152
    v_mov_b32 v15, s24
    s_waitcnt lgkmcnt(0)
    s_barrier
    ds_read_b32 v152, v15
    s_waitcnt lgkmcnt(0)
    v_readfirstlane_b32 s58, v152
    s_cmp_eq_u32 s58, 1
    s_cselect_b32 s24, s63, s62
    s_max_i32 s62, s62, s24
interleave_layers__linear_attn_block__memory_aug_recurrent_mem_tr__prompt_kernel_p_next:
    s_add_u32 s24, s64, 8
    s_cmp_le_u32 s24, s40
    s_cbranch_scc1 interleave_layers__linear_attn_block__memory_aug_recurrent_mem_tr__prompt_kernel_p_pub
    s_cmp_lt_u32 s40, 64
    s_cbranch_scc0 interleave_layers__linear_attn_block__memory_aug_recurrent_mem_tr__prompt_kernel_pg37
    s_cmp_eq_u32 s58, 1
    s_cbranch_scc1 interleave_layers__linear_attn_block__memory_aug_recurrent_mem_tr__prompt_kernel_p_seg
    s_branch interleave_layers__linear_attn_block__memory_aug_recurrent_mem_tr__prompt_kernel_p_pubA
interleave_layers__linear_attn_block__memory_aug_recurrent_mem_tr__prompt_kernel_pg37:
interleave_layers__linear_attn_block__memory_aug_recurrent_mem_tr__prompt_kernel_p_pub:
    s_waitcnt vmcnt(0)
    s_barrier
    s_cmp_eq_u32 s3, 0
    s_cbranch_scc0 interleave_layers__linear_attn_block__memory_aug_recurrent_mem_tr__prompt_kernel_fp38
    v_mov_b32 v15, s40
    buffer_store_dword v15, v14, s[8:11], 0 offen sc1
interleave_layers__linear_attn_block__memory_aug_recurrent_mem_tr__prompt_kernel_fp38:
    s_add_u32 s24, s64, 8
    s_cmp_le_u32 s24, s40
    s_cbranch_scc1 interleave_layers__linear_attn_block__memory_aug_recurrent_mem_tr__prompt_kernel_p_x
    s_cmp_lt_u32 s40, 64
    s_cbranch_scc0 interleave_layers__linear_attn_block__memory_aug_recurrent_mem_tr__prompt_kernel_pg39
    s_cmp_eq_u32 s58, 1
    s_cbranch_scc1 interleave_layers__linear_attn_block__memory_aug_recurrent_mem_tr__prompt_kernel_p_seg
    s_branch interleave_layers__linear_attn_block__memory_aug_recurrent_mem_tr__prompt_kernel_p_pubA
interleave_layers__linear_attn_block__memory_aug_recurrent_mem_tr__prompt_kernel_pg39:
    s_cmp_ge_u32 s64, 64
    s_cbranch_scc1 interleave_layers__linear_attn_block__memory_aug_recurrent_mem_tr__prompt_kernel_p_done
interleave_layers__linear_attn_block__memory_aug_recurrent_mem_tr__prompt_kernel_p_x:
    s_add_u32 s63, s64, 1
    s_cmp_ge_i32 s69, s63
    s_cbranch_scc1 interleave_layers__linear_attn_block__memory_aug_recurrent_mem_tr__prompt_kernel_x_en_ok
    s_mov_b32 s61, 0
interleave_layers__linear_attn_block__memory_aug_recurrent_mem_tr__prompt_kernel_x_en:
    buffer_load_dword v253, v252, s[8:11], 0 offen sc1
    s_waitcnt vmcnt(0)
    v_readlane_b32 s69, v253, 0
    v_readlane_b32 s24, v253, 1
    s_min_i32 s69, s69, s24
    v_readlane_b32 s24, v253, 2
    s_min_i32 s69, s69, s24
    v_readlane_b32 s24, v253, 3
    s_min_i32 s69, s69, s24
    v_readlane_b32 s24, v253, 4
    s_min_i32 s69, s69, s24
    v_readlane_b32 s24, v253, 5
    s_min_i32 s69, s69, s24
    v_readlane_b32 s24, v253, 6
    s_min_i32 s69, s69, s24
    v_readlane_b32 s24, v253, 7
    s_min_i32 s69, s69, s24
    s_cmp_ge_i32 s69, s63
    s_cbranch_scc1 interleave_layers__linear_attn_block__memory_aug_recurrent_mem_tr__prompt_kernel_x_en_ok
    s_add_u32 s61, s61, 1
    s_cmp_ge_u32 s61, s60
    s_cbranch_scc1 interleave_layers__linear_attn_block__memory_aug_recurrent_mem_tr__prompt_kernel_x_en_to
    s_sleep 2
    s_branch interleave_layers__linear_attn_block__memory_aug_recurrent_mem_tr__prompt_kernel_x_en
interleave_layers__linear_attn_block__memory_aug_recurrent_mem_tr__prompt_kernel_x_en_to:
    s_mov_b32 s60, 1
interleave_layers__linear_attn_block__memory_aug_recurrent_mem_tr__prompt_kernel_x_en_ok:
    s_lshl_b32 s95, s92, 6
    s_add_u32 s95, s95, s64
    s_add_u32 s95, s95, 1
    s_cmp_ge_i32 s59, s95
    s_cbranch_scc1 interleave_layers__linear_attn_block__memory_aug_recurrent_mem_tr__prompt_kernel_x_ec_ok
    s_and_b32 s24, s2, 7
    s_lshl_b32 s24, s24, 7
    s_add_u32 s24, s24, 23109632
    v_and_b32 v254, 3, v1
    v_lshl_add_u32 v254, v254, 2, s24
    s_mov_b32 s61, 0
interleave_layers__linear_attn_block__memory_aug_recurrent_mem_tr__prompt_kernel_x_ec:
    buffer_load_dword v253, v254, s[8:11], 0 offen sc1
    s_waitcnt vmcnt(0)
    v_readlane_b32 s59, v253, 0
    v_readlane_b32 s24, v253, 1
    s_min_i32 s59, s59, s24
    v_readlane_b32 s24, v253, 2
    s_min_i32 s59, s59, s24
    s_cmp_ge_i32 s59, s95
    s_cbranch_scc1 interleave_layers__linear_attn_block__memory_aug_recurrent_mem_tr__prompt_kernel_x_ec_ok
    s_add_u32 s61, s61, 1
    s_cmp_ge_u32 s61, s60
    s_cbranch_scc1 interleave_layers__linear_attn_block__memory_aug_recurrent_mem_tr__prompt_kernel_x_ec_to
    s_sleep 2
    s_branch interleave_layers__linear_attn_block__memory_aug_recurrent_mem_tr__prompt_kernel_x_ec
interleave_layers__linear_attn_block__memory_aug_recurrent_mem_tr__prompt_kernel_x_ec_to:
    s_mov_b32 s60, 1
interleave_layers__linear_attn_block__memory_aug_recurrent_mem_tr__prompt_kernel_x_ec_ok:
    s_add_u32 s52, s65, 32768
    buffer_load_dwordx4 v[16:19], v240, s[8:11], s65 offen offset:0 sc1
    buffer_load_dwordx4 v[20:23], v240, s[8:11], s65 offen offset:1024 sc1
    buffer_load_dwordx4 v[24:27], v240, s[8:11], s65 offen offset:2048 sc1
    buffer_load_dwordx4 v[28:31], v240, s[8:11], s65 offen offset:3072 sc1
    buffer_load_dwordx4 v[32:35], v241, s[8:11], s65 offen offset:0 sc1
    buffer_load_dwordx4 v[36:39], v241, s[8:11], s65 offen offset:1024 sc1
    buffer_load_dwordx4 v[40:43], v241, s[8:11], s65 offen offset:2048 sc1
    buffer_load_dwordx4 v[44:47], v241, s[8:11], s65 offen offset:3072 sc1
    buffer_load_dwordx4 v[48:51], v240, s[8:11], s52 offen offset:0 sc1
    buffer_load_dwordx4 v[52:55], v240, s[8:11], s52 offen offset:1024 sc1
    buffer_load_dwordx4 v[56:59], v240, s[8:11], s52 offen offset:2048 sc1
    buffer_load_dwordx4 v[60:63], v240, s[8:11], s52 offen offset:3072 sc1
    buffer_load_dwordx4 v[64:67], v241, s[8:11], s52 offen offset:0 sc1
    buffer_load_dwordx4 v[68:71], v241, s[8:11], s52 offen offset:1024 sc1
    buffer_load_dwordx4 v[72:75], v241, s[8:11], s52 offen offset:2048 sc1
    buffer_load_dwordx4 v[76:79], v241, s[8:11], s52 offen offset:3072 sc1
    s_add_u32 s24, s68, s73
    buffer_load_dwordx4 v[196:199], v219, s[8:11], s24 offen sc1
    s_lshl_b32 s77, s92, 6
    s_add_u32 s77, s77, s64
    s_add_u32 s77, s77, 1
    s_cmp_ge_i32 s76, s77
    s_cbranch_scc1 interleave_layers__linear_attn_block__memory_aug_recurrent_mem_tr__prompt_kernel_x_cs_ok
    s_and_b32 s24, s2, 7
    s_lshl_b32 s24, s24, 7
    s_add_u32 s24, s24, 23111680
    v_mov_b32 v254, s24
    s_mov_b32 s61, 0
interleave_layers__linear_attn_block__memory_aug_recurrent_mem_tr__prompt_kernel_x_cs:
    buffer_load_dword v253, v254, s[8:11], 0 offen sc1
    s_waitcnt vmcnt(0)
    v_readlane_b32 s76, v253, 0
    s_cmp_ge_i32 s76, s77
    s_cbranch_scc1 interleave_layers__linear_attn_block__memory_aug_recurrent_mem_tr__prompt_kernel_x_cs_ok
    s_add_u32 s61, s61, 1
    s_cmp_ge_u32 s61, s60
    s_cbranch_scc1 interleave_layers__linear_attn_block__memory_aug_recurrent_mem_tr__prompt_kernel_x_cs_to
    s_sleep 16
    s_branch interleave_layers__linear_attn_block__memory_aug_recurrent_mem_tr__prompt_kernel_x_cs
interleave_layers__linear_attn_block__memory_aug_recurrent_mem_tr__prompt_kernel_x_cs_to:
    s_mov_b32 s60, 1
interleave_layers__linear_attn_block__memory_aug_recurrent_mem_tr__prompt_kernel_x_cs_ok:
    s_add_u32 s53, s66, 16384
    s_mov_b32 s61, 0
interleave_layers__linear_attn_block__memory_aug_recurrent_mem_tr__prompt_kernel_x_p1:
    buffer_load_dwordx4 v[80:83], v212, s[8:11], s67 offen offset:0 sc1
    buffer_load_dwordx4 v[84:87], v212, s[8:11], s67 offen offset:1024 sc1
    buffer_load_dwordx4 v[88:91], v212, s[8:11], s67 offen offset:2048 sc1
    buffer_load_dwordx4 v[92:95], v212, s[8:11], s67 offen offset:3072 sc1
    buffer_load_dwordx4 v[96:99], v213, s[8:11], s67 offen offset:0 sc1
    buffer_load_dwordx4 v[100:103], v213, s[8:11], s67 offen offset:1024 sc1
    buffer_load_dwordx4 v[104:107], v213, s[8:11], s67 offen offset:2048 sc1
    buffer_load_dwordx4 v[108:111], v213, s[8:11], s67 offen offset:3072 sc1
    buffer_load_dwordx4 v[112:115], v214, s[8:11], s67 offen offset:0 sc1
    buffer_load_dwordx4 v[116:119], v214, s[8:11], s67 offen offset:1024 sc1
    buffer_load_dwordx4 v[120:123], v214, s[8:11], s67 offen offset:2048 sc1
    buffer_load_dwordx4 v[124:127], v214, s[8:11], s67 offen offset:3072 sc1
    buffer_load_dwordx4 v[128:131], v215, s[8:11], s67 offen offset:0 sc1
    buffer_load_dwordx4 v[132:135], v215, s[8:11], s67 offen offset:1024 sc1
    buffer_load_dwordx4 v[136:139], v215, s[8:11], s67 offen offset:2048 sc1
    buffer_load_dwordx4 v[140:143], v215, s[8:11], s67 offen offset:3072 sc1
    buffer_load_dwordx4 v[144:147], v216, s[8:11], s67 offen offset:0 sc1
    buffer_load_dwordx4 v[148:151], v216, s[8:11], s67 offen offset:1024 sc1
    buffer_load_dwordx4 v[152:155], v216, s[8:11], s67 offen offset:2048 sc1
    buffer_load_dwordx4 v[156:159], v216, s[8:11], s67 offen offset:3072 sc1
    buffer_load_dwordx4 v[160:163], v242, s[8:11], s66 offen offset:0 sc1
    buffer_load_dwordx4 v[164:167], v242, s[8:11], s66 offen offset:1024 sc1
    buffer_load_dwordx4 v[168:171], v242, s[8:11], s53 offen offset:0 sc1
    buffer_load_dwordx4 v[172:175], v242, s[8:11], s53 offen offset:1024 sc1
    s_waitcnt vmcnt(0)
    v_max3_u32 v192, v80, v81, v82
    v_max3_u32 v192, v192, v83, v84
    v_max3_u32 v192, v192, v85, v86
    v_max3_u32 v192, v192, v87, v88
    v_max3_u32 v192, v192, v89, v90
    v_max3_u32 v192, v192, v91, v92
    v_max3_u32 v192, v192, v93, v94
    v_max3_u32 v192, v192, v95, v96
    v_max3_u32 v192, v192, v97, v98
    v_max3_u32 v192, v192, v99, v100
    v_max3_u32 v192, v192, v101, v102
    v_max3_u32 v192, v192, v103, v104
    v_max3_u32 v192, v192, v105, v106
    v_max3_u32 v192, v192, v107, v108
    v_max3_u32 v192, v192, v109, v110
    v_max3_u32 v192, v192, v111, v112
    v_max3_u32 v192, v192, v113, v114
    v_max3_u32 v192, v192, v115, v116
    v_max3_u32 v192, v192, v117, v118
    v_max3_u32 v192, v192, v119, v120
    v_max3_u32 v192, v192, v121, v122
    v_max3_u32 v192, v192, v123, v124
    v_max3_u32 v192, v192, v125, v126
    v_max3_u32 v192, v192, v127, v128
    v_max3_u32 v192, v192, v129, v130
    v_max3_u32 v192, v192, v131, v132
    v_max3_u32 v192, v192, v133, v134
    v_max3_u32 v192, v192, v135, v136
    v_max3_u32 v192, v192, v137, v138
    v_max3_u32 v192, v192, v139, v140
    v_max3_u32 v192, v192, v141, v142
    v_max3_u32 v192, v192, v143, v144
    v_max3_u32 v192, v192, v145, v146
    v_max3_u32 v192, v192, v147, v148
    v_max3_u32 v192, v192, v149, v150
    v_max3_u32 v192, v192, v151, v152
    v_max3_u32 v192, v192, v153, v154
    v_max3_u32 v192, v192, v155, v156
    v_max3_u32 v192, v192, v157, v158
    v_max3_u32 v192, v192, v159, v160
    v_max3_u32 v192, v192, v161, v162
    v_max3_u32 v192, v192, v163, v164
    v_max3_u32 v192, v192, v165, v166
    v_max3_u32 v192, v192, v167, v168
    v_max3_u32 v192, v192, v169, v170
    v_max3_u32 v192, v192, v171, v172
    v_max3_u32 v192, v192, v173, v174
    v_max_u32 v192, v192, v175
    v_cmp_eq_u32 vcc, -1, v192
    s_add_u32 s61, s61, 1
    s_cbranch_vccz interleave_layers__linear_attn_block__memory_aug_recurrent_mem_tr__prompt_kernel_x_p1_out
    s_cmp_ge_u32 s61, s60
    s_cbranch_scc1 interleave_layers__linear_attn_block__memory_aug_recurrent_mem_tr__prompt_kernel_x_p1_to
    s_sleep 2
    s_branch interleave_layers__linear_attn_block__memory_aug_recurrent_mem_tr__prompt_kernel_x_p1
interleave_layers__linear_attn_block__memory_aug_recurrent_mem_tr__prompt_kernel_x_p1_to:
    s_mov_b32 s60, 1
interleave_layers__linear_attn_block__memory_aug_recurrent_mem_tr__prompt_kernel_x_p1_out:
    v_mfma_f32_16x16x32_bf16 v[176:179], v[16:19], v[80:83], 0
    v_mfma_f32_16x16x32_bf16 v[180:183], v[16:19], v[84:87], 0
    v_mfma_f32_16x16x32_bf16 v[184:187], v[48:51], v[80:83], 0
    v_mfma_f32_16x16x32_bf16 v[188:191], v[48:51], v[84:87], 0
    v_mfma_f32_16x16x32_bf16 v[176:179], v[20:23], v[88:91], v[176:179]
    v_mfma_f32_16x16x32_bf16 v[180:183], v[20:23], v[92:95], v[180:183]
    v_mfma_f32_16x16x32_bf16 v[184:187], v[52:55], v[88:91], v[184:187]
    v_mfma_f32_16x16x32_bf16 v[188:191], v[52:55], v[92:95], v[188:191]
    v_mfma_f32_16x16x32_bf16 v[176:179], v[24:27], v[96:99], v[176:179]
    v_mfma_f32_16x16x32_bf16 v[180:183], v[24:27], v[100:103], v[180:183]
    v_mfma_f32_16x16x32_bf16 v[184:187], v[56:59], v[96:99], v[184:187]
    v_mfma_f32_16x16x32_bf16 v[188:191], v[56:59], v[100:103], v[188:191]
    v_mfma_f32_16x16x32_bf16 v[176:179], v[28:31], v[104:107], v[176:179]
    v_mfma_f32_16x16x32_bf16 v[180:183], v[28:31], v[108:111], v[180:183]
    v_mfma_f32_16x16x32_bf16 v[184:187], v[60:63], v[104:107], v[184:187]
    v_mfma_f32_16x16x32_bf16 v[188:191], v[60:63], v[108:111], v[188:191]
    v_mfma_f32_16x16x32_bf16 v[176:179], v[32:35], v[112:115], v[176:179]
    v_mfma_f32_16x16x32_bf16 v[180:183], v[32:35], v[116:119], v[180:183]
    v_mfma_f32_16x16x32_bf16 v[184:187], v[64:67], v[112:115], v[184:187]
    v_mfma_f32_16x16x32_bf16 v[188:191], v[64:67], v[116:119], v[188:191]
    v_mfma_f32_16x16x32_bf16 v[176:179], v[36:39], v[120:123], v[176:179]
    v_mfma_f32_16x16x32_bf16 v[180:183], v[36:39], v[124:127], v[180:183]
    v_mfma_f32_16x16x32_bf16 v[184:187], v[68:71], v[120:123], v[184:187]
    v_mfma_f32_16x16x32_bf16 v[188:191], v[68:71], v[124:127], v[188:191]
    v_mfma_f32_16x16x32_bf16 v[176:179], v[40:43], v[128:131], v[176:179]
    v_mfma_f32_16x16x32_bf16 v[180:183], v[40:43], v[132:135], v[180:183]
    v_mfma_f32_16x16x32_bf16 v[184:187], v[72:75], v[128:131], v[184:187]
    v_mfma_f32_16x16x32_bf16 v[188:191], v[72:75], v[132:135], v[188:191]
    v_mfma_f32_16x16x32_bf16 v[176:179], v[44:47], v[136:139], v[176:179]
    v_mfma_f32_16x16x32_bf16 v[180:183], v[44:47], v[140:143], v[180:183]
    v_mfma_f32_16x16x32_bf16 v[184:187], v[76:79], v[136:139], v[184:187]
    v_mfma_f32_16x16x32_bf16 v[188:191], v[76:79], v[140:143], v[188:191]
    v_mfma_f32_16x16x32_bf16 v[176:179], v[160:163], v[144:147], v[176:179]
    v_mfma_f32_16x16x32_bf16 v[180:183], v[160:163], v[148:151], v[180:183]
    v_mfma_f32_16x16x32_bf16 v[184:187], v[168:171], v[144:147], v[184:187]
    v_mfma_f32_16x16x32_bf16 v[188:191], v[168:171], v[148:151], v[188:191]
    v_mfma_f32_16x16x32_bf16 v[176:179], v[164:167], v[152:155], v[176:179]
    v_mfma_f32_16x16x32_bf16 v[180:183], v[164:167], v[156:159], v[180:183]
    v_mfma_f32_16x16x32_bf16 v[184:187], v[172:175], v[152:155], v[184:187]
    v_mfma_f32_16x16x32_bf16 v[188:191], v[172:175], v[156:159], v[188:191]
    s_nop 4
    ds_write_b128 v217, v[176:179] offset:0
    ds_write_b128 v217, v[180:183] offset:1024
    ds_write_b128 v217, v[184:187] offset:2048
    ds_write_b128 v217, v[188:191] offset:3072
    s_waitcnt lgkmcnt(0)
    s_barrier
    s_cmp_ge_u32 s3, 2
    s_cbranch_scc1 interleave_layers__linear_attn_block__memory_aug_recurrent_mem_tr__prompt_kernel_xs40
    ds_read_b128 v[16:19], v218 offset:0
    ds_read_b128 v[20:23], v218 offset:4096
    ds_read_b128 v[24:27], v218 offset:8192
    ds_read_b128 v[28:31], v218 offset:12288
    ds_read_b128 v[32:35], v218 offset:2048
    ds_read_b128 v[36:39], v218 offset:6144
    ds_read_b128 v[40:43], v218 offset:10240
    ds_read_b128 v[44:47], v218 offset:14336
    s_waitcnt lgkmcnt(4)
    v_pk_add_f32 v[16:17], v[16:17], v[20:21]
    v_pk_add_f32 v[24:25], v[24:25], v[28:29]
    v_pk_add_f32 v[18:19], v[18:19], v[22:23]
    v_pk_add_f32 v[26:27], v[26:27], v[30:31]
    v_pk_add_f32 v[16:17], v[16:17], v[24:25]
    v_pk_add_f32 v[18:19], v[18:19], v[26:27]
    v_cvt_pk_bf16_f32 v20, v16, v17
    v_cvt_pk_bf16_f32 v21, v18, v19
    v_lshlrev_b32 v16, 16, v20
    v_and_b32 v17, 0xffff0000, v20
    v_lshlrev_b32 v22, 16, v196
    v_and_b32 v23, 0xffff0000, v196
    v_pk_add_f32 v[16:17], v[16:17], v[22:23]
    v_cvt_pk_bf16_f32 v48, v16, v17
    v_lshlrev_b32 v16, 16, v21
    v_and_b32 v17, 0xffff0000, v21
    v_lshlrev_b32 v22, 16, v197
    v_and_b32 v23, 0xffff0000, v197
    v_pk_add_f32 v[16:17], v[16:17], v[22:23]
    v_cvt_pk_bf16_f32 v49, v16, v17
    s_waitcnt lgkmcnt(0)
    v_pk_add_f32 v[32:33], v[32:33], v[36:37]
    v_pk_add_f32 v[40:41], v[40:41], v[44:45]
    v_pk_add_f32 v[34:35], v[34:35], v[38:39]
    v_pk_add_f32 v[42:43], v[42:43], v[46:47]
    v_pk_add_f32 v[32:33], v[32:33], v[40:41]
    v_pk_add_f32 v[34:35], v[34:35], v[42:43]
    v_cvt_pk_bf16_f32 v36, v32, v33
    v_cvt_pk_bf16_f32 v37, v34, v35
    v_lshlrev_b32 v32, 16, v36
    v_and_b32 v33, 0xffff0000, v36
    v_lshlrev_b32 v38, 16, v198
    v_and_b32 v39, 0xffff0000, v198
    v_pk_add_f32 v[32:33], v[32:33], v[38:39]
    v_cvt_pk_bf16_f32 v50, v32, v33
    v_lshlrev_b32 v32, 16, v37
    v_and_b32 v33, 0xffff0000, v37
    v_lshlrev_b32 v38, 16, v199
    v_and_b32 v39, 0xffff0000, v199
    v_pk_add_f32 v[32:33], v[32:33], v[38:39]
    v_cvt_pk_bf16_f32 v51, v32, v33
    s_cmp_eq_u32 s92, 0
    s_cbranch_scc0 interleave_layers__linear_attn_block__memory_aug_recurrent_mem_tr__prompt_kernel_xo41
    s_add_u32 s24, s68, 4194304
    buffer_store_dwordx4 v[48:51], v219, s[8:11], s24 offen sc1
    s_branch interleave_layers__linear_attn_block__memory_aug_recurrent_mem_tr__prompt_kernel_xs40
interleave_layers__linear_attn_block__memory_aug_recurrent_mem_tr__prompt_kernel_xo41:
    buffer_store_dwordx2 v[48:49], v243, s[12:15], s68 offen
    buffer_store_dwordx2 v[50:51], v243, s[12:15], s68 offen offset:32
interleave_layers__linear_attn_block__memory_aug_recurrent_mem_tr__prompt_kernel_xs40:
    s_lshr_b32 s25, s64, 2
    s_add_u32 s25, s25, 1
    s_cmp_eq_u32 s92, 0
    s_cselect_b32 s79, s25, -1
    s_cmp_lt_u32 s40, 64
    s_cbranch_scc1 interleave_layers__linear_attn_block__memory_aug_recurrent_mem_tr__prompt_kernel_xp42
    s_waitcnt vmcnt(0)
    s_barrier
    s_cmp_ge_i32 s79, 0
    s_cselect_b32 s24, 0, 2146435072
    v_or_b32 v246, s24, v245
    v_mov_b32 v247, s79
    buffer_store_dword v247, v246, s[8:11], 0 offen sc1
    s_mov_b32 s79, -1
interleave_layers__linear_attn_block__memory_aug_recurrent_mem_tr__prompt_kernel_xp42:
    s_add_u32 s64, s64, 4
    s_add_u32 s65, s65, 5242880
    s_add_u32 s66, s66, 4194304
    s_add_u32 s67, s67, 4194304
    s_add_u32 s68, s68, 163840
    s_branch interleave_layers__linear_attn_block__memory_aug_recurrent_mem_tr__prompt_kernel_p_next
interleave_layers__linear_attn_block__memory_aug_recurrent_mem_tr__prompt_kernel_p_done:
    s_cmp_eq_u32 s92, 0
    s_cbranch_scc0 interleave_layers__linear_attn_block__memory_aug_recurrent_mem_tr__prompt_kernel_end
    s_mov_b32 s92, 1
    s_branch interleave_layers__linear_attn_block__memory_aug_recurrent_mem_tr__prompt_kernel_p_layer
interleave_layers__linear_attn_block__memory_aug_recurrent_mem_tr__prompt_kernel_roleO:
    s_sub_u32 s44, s2, 200
    s_load_dwordx2 s[6:7], s[0:1], 64
    s_waitcnt lgkmcnt(0)
    s_mov_b32 s12, s6
    s_mov_b32 s13, s7
    s_mov_b32 s14, 7864320
    s_mov_b32 s15, 0x00020000
    v_add_u32 v8, 0, v0
    s_mov_b32 s24, 3277
    v_mul_lo_u32 v9, v8, s24
    v_lshrrev_b32 v9, 18, v9
    v_mul_u32_u24 v10, 80, v9
    v_sub_u32 v10, v8, v10
    v_mul_u32_u24 v16, 1312, v9
    v_lshl_add_u32 v16, v10, 4, v16
    v_add_u32 v8, 256, v0
    s_mov_b32 s24, 3277
    v_mul_lo_u32 v9, v8, s24
    v_lshrrev_b32 v9, 18, v9
    v_mul_u32_u24 v10, 80, v9
    v_sub_u32 v10, v8, v10
    v_mul_u32_u24 v17, 1312, v9
    v_lshl_add_u32 v17, v10, 4, v17
    v_add_u32 v8, 512, v0
    s_mov_b32 s24, 3277
    v_mul_lo_u32 v9, v8, s24
    v_lshrrev_b32 v9, 18, v9
    v_mul_u32_u24 v10, 80, v9
    v_sub_u32 v10, v8, v10
    v_mul_u32_u24 v18, 1312, v9
    v_lshl_add_u32 v18, v10, 4, v18
    v_add_u32 v8, 768, v0
    s_mov_b32 s24, 3277
    v_mul_lo_u32 v9, v8, s24
    v_lshrrev_b32 v9, 18, v9
    v_mul_u32_u24 v10, 80, v9
    v_sub_u32 v10, v8, v10
    v_mul_u32_u24 v19, 1312, v9
    v_lshl_add_u32 v19, v10, 4, v19
    v_add_u32 v8, 1024, v0
    s_mov_b32 s24, 3277
    v_mul_lo_u32 v9, v8, s24
    v_lshrrev_b32 v9, 18, v9
    v_mul_u32_u24 v10, 80, v9
    v_sub_u32 v10, v8, v10
    v_mul_u32_u24 v20, 1312, v9
    v_lshl_add_u32 v20, v10, 4, v20
    v_add_u32 v8, 1280, v0
    s_mov_b32 s24, 3277
    v_mul_lo_u32 v9, v8, s24
    v_lshrrev_b32 v9, 18, v9
    v_mul_u32_u24 v10, 80, v9
    v_sub_u32 v10, v8, v10
    v_mul_u32_u24 v21, 1312, v9
    v_lshl_add_u32 v21, v10, 4, v21
    v_add_u32 v8, 1536, v0
    s_mov_b32 s24, 3277
    v_mul_lo_u32 v9, v8, s24
    v_lshrrev_b32 v9, 18, v9
    v_mul_u32_u24 v10, 80, v9
    v_sub_u32 v10, v8, v10
    v_mul_u32_u24 v22, 1312, v9
    v_lshl_add_u32 v22, v10, 4, v22
    v_add_u32 v8, 1792, v0
    s_mov_b32 s24, 3277
    v_mul_lo_u32 v9, v8, s24
    v_lshrrev_b32 v9, 18, v9
    v_mul_u32_u24 v10, 80, v9
    v_sub_u32 v10, v8, v10
    v_mul_u32_u24 v23, 1312, v9
    v_lshl_add_u32 v23, v10, 4, v23
    v_add_u32 v8, 2048, v0
    s_mov_b32 s24, 3277
    v_mul_lo_u32 v9, v8, s24
    v_lshrrev_b32 v9, 18, v9
    v_mul_u32_u24 v10, 80, v9
    v_sub_u32 v10, v8, v10
    v_mul_u32_u24 v24, 1312, v9
    v_lshl_add_u32 v24, v10, 4, v24
    v_add_u32 v8, 2304, v0
    s_mov_b32 s24, 3277
    v_mul_lo_u32 v9, v8, s24
    v_lshrrev_b32 v9, 18, v9
    v_mul_u32_u24 v10, 80, v9
    v_sub_u32 v10, v8, v10
    v_mul_u32_u24 v25, 1312, v9
    v_lshl_add_u32 v25, v10, 4, v25
    v_add_u32 v8, 2560, v0
    s_mov_b32 s24, 3277
    v_mul_lo_u32 v9, v8, s24
    v_lshrrev_b32 v9, 18, v9
    v_mul_u32_u24 v10, 80, v9
    v_sub_u32 v10, v8, v10
    v_mul_u32_u24 v26, 1312, v9
    v_lshl_add_u32 v26, v10, 4, v26
    v_add_u32 v8, 2816, v0
    s_mov_b32 s24, 3277
    v_mul_lo_u32 v9, v8, s24
    v_lshrrev_b32 v9, 18, v9
    v_mul_u32_u24 v10, 80, v9
    v_sub_u32 v10, v8, v10
    v_mul_u32_u24 v27, 1312, v9
    v_lshl_add_u32 v27, v10, 4, v27
    v_add_u32 v8, 3072, v0
    s_mov_b32 s24, 3277
    v_mul_lo_u32 v9, v8, s24
    v_lshrrev_b32 v9, 18, v9
    v_mul_u32_u24 v10, 80, v9
    v_sub_u32 v10, v8, v10
    v_mul_u32_u24 v28, 1312, v9
    v_lshl_add_u32 v28, v10, 4, v28
    v_add_u32 v8, 3328, v0
    s_mov_b32 s24, 3277
    v_mul_lo_u32 v9, v8, s24
    v_lshrrev_b32 v9, 18, v9
    v_mul_u32_u24 v10, 80, v9
    v_sub_u32 v10, v8, v10
    v_mul_u32_u24 v29, 1312, v9
    v_lshl_add_u32 v29, v10, 4, v29
    v_add_u32 v8, 3584, v0
    s_mov_b32 s24, 3277
    v_mul_lo_u32 v9, v8, s24
    v_lshrrev_b32 v9, 18, v9
    v_mul_u32_u24 v10, 80, v9
    v_sub_u32 v10, v8, v10
    v_mul_u32_u24 v30, 1312, v9
    v_lshl_add_u32 v30, v10, 4, v30
    v_add_u32 v8, 3840, v0
    s_mov_b32 s24, 3277
    v_mul_lo_u32 v9, v8, s24
    v_lshrrev_b32 v9, 18, v9
    v_mul_u32_u24 v10, 80, v9
    v_sub_u32 v10, v8, v10
    v_mul_u32_u24 v31, 1312, v9
    v_lshl_add_u32 v31, v10, 4, v31
    v_add_u32 v8, 4096, v0
    s_mov_b32 s24, 3277
    v_mul_lo_u32 v9, v8, s24
    v_lshrrev_b32 v9, 18, v9
    v_mul_u32_u24 v10, 80, v9
    v_sub_u32 v10, v8, v10
    v_mul_u32_u24 v32, 1312, v9
    v_lshl_add_u32 v32, v10, 4, v32
    v_add_u32 v8, 4352, v0
    s_mov_b32 s24, 3277
    v_mul_lo_u32 v9, v8, s24
    v_lshrrev_b32 v9, 18, v9
    v_mul_u32_u24 v10, 80, v9
    v_sub_u32 v10, v8, v10
    v_mul_u32_u24 v33, 1312, v9
    v_lshl_add_u32 v33, v10, 4, v33
    v_add_u32 v8, 4608, v0
    s_mov_b32 s24, 3277
    v_mul_lo_u32 v9, v8, s24
    v_lshrrev_b32 v9, 18, v9
    v_mul_u32_u24 v10, 80, v9
    v_sub_u32 v10, v8, v10
    v_mul_u32_u24 v34, 1312, v9
    v_lshl_add_u32 v34, v10, 4, v34
    v_add_u32 v8, 4864, v0
    s_mov_b32 s24, 3277
    v_mul_lo_u32 v9, v8, s24
    v_lshrrev_b32 v9, 18, v9
    v_mul_u32_u24 v10, 80, v9
    v_sub_u32 v10, v8, v10
    v_mul_u32_u24 v35, 1312, v9
    v_lshl_add_u32 v35, v10, 4, v35
    v_add_u32 v8, 5120, v0
    s_mov_b32 s24, 3277
    v_mul_lo_u32 v9, v8, s24
    v_lshrrev_b32 v9, 18, v9
    v_mul_u32_u24 v10, 80, v9
    v_sub_u32 v10, v8, v10
    v_mul_u32_u24 v36, 1312, v9
    v_lshl_add_u32 v36, v10, 4, v36
    v_add_u32 v8, 5376, v0
    s_mov_b32 s24, 3277
    v_mul_lo_u32 v9, v8, s24
    v_lshrrev_b32 v9, 18, v9
    v_mul_u32_u24 v10, 80, v9
    v_sub_u32 v10, v8, v10
    v_mul_u32_u24 v37, 1312, v9
    v_lshl_add_u32 v37, v10, 4, v37
    v_add_u32 v8, 5632, v0
    s_mov_b32 s24, 3277
    v_mul_lo_u32 v9, v8, s24
    v_lshrrev_b32 v9, 18, v9
    v_mul_u32_u24 v10, 80, v9
    v_sub_u32 v10, v8, v10
    v_mul_u32_u24 v38, 1312, v9
    v_lshl_add_u32 v38, v10, 4, v38
    v_add_u32 v8, 5888, v0
    s_mov_b32 s24, 3277
    v_mul_lo_u32 v9, v8, s24
    v_lshrrev_b32 v9, 18, v9
    v_mul_u32_u24 v10, 80, v9
    v_sub_u32 v10, v8, v10
    v_mul_u32_u24 v39, 1312, v9
    v_lshl_add_u32 v39, v10, 4, v39
    v_add_u32 v8, 6144, v0
    s_mov_b32 s24, 3277
    v_mul_lo_u32 v9, v8, s24
    v_lshrrev_b32 v9, 18, v9
    v_mul_u32_u24 v10, 80, v9
    v_sub_u32 v10, v8, v10
    v_mul_u32_u24 v40, 1312, v9
    v_lshl_add_u32 v40, v10, 4, v40
    v_add_u32 v8, 6400, v0
    s_mov_b32 s24, 3277
    v_mul_lo_u32 v9, v8, s24
    v_lshrrev_b32 v9, 18, v9
    v_mul_u32_u24 v10, 80, v9
    v_sub_u32 v10, v8, v10
    v_mul_u32_u24 v41, 1312, v9
    v_lshl_add_u32 v41, v10, 4, v41
    v_add_u32 v8, 6656, v0
    s_mov_b32 s24, 3277
    v_mul_lo_u32 v9, v8, s24
    v_lshrrev_b32 v9, 18, v9
    v_mul_u32_u24 v10, 80, v9
    v_sub_u32 v10, v8, v10
    v_mul_u32_u24 v42, 1312, v9
    v_lshl_add_u32 v42, v10, 4, v42
    v_add_u32 v8, 6912, v0
    s_mov_b32 s24, 3277
    v_mul_lo_u32 v9, v8, s24
    v_lshrrev_b32 v9, 18, v9
    v_mul_u32_u24 v10, 80, v9
    v_sub_u32 v10, v8, v10
    v_mul_u32_u24 v43, 1312, v9
    v_lshl_add_u32 v43, v10, 4, v43
    v_add_u32 v8, 7168, v0
    s_mov_b32 s24, 3277
    v_mul_lo_u32 v9, v8, s24
    v_lshrrev_b32 v9, 18, v9
    v_mul_u32_u24 v10, 80, v9
    v_sub_u32 v10, v8, v10
    v_mul_u32_u24 v44, 1312, v9
    v_lshl_add_u32 v44, v10, 4, v44
    v_add_u32 v8, 7424, v0
    s_mov_b32 s24, 3277
    v_mul_lo_u32 v9, v8, s24
    v_lshrrev_b32 v9, 18, v9
    v_mul_u32_u24 v10, 80, v9
    v_sub_u32 v10, v8, v10
    v_mul_u32_u24 v45, 1312, v9
    v_lshl_add_u32 v45, v10, 4, v45
    v_lshlrev_b32 v4, 4, v0
    s_mul_i32 s45, s44, 245760
    s_add_u32 s46, s45, 0
    buffer_load_dwordx4 v[48:51], v4, s[12:15], s46 offen
    s_add_u32 s46, s45, 4096
    buffer_load_dwordx4 v[52:55], v4, s[12:15], s46 offen
    s_add_u32 s46, s45, 8192
    buffer_load_dwordx4 v[56:59], v4, s[12:15], s46 offen
    s_add_u32 s46, s45, 12288
    buffer_load_dwordx4 v[60:63], v4, s[12:15], s46 offen
    s_add_u32 s46, s45, 16384
    buffer_load_dwordx4 v[64:67], v4, s[12:15], s46 offen
    s_add_u32 s46, s45, 20480
    buffer_load_dwordx4 v[68:71], v4, s[12:15], s46 offen
    s_add_u32 s46, s45, 24576
    buffer_load_dwordx4 v[72:75], v4, s[12:15], s46 offen
    s_add_u32 s46, s45, 28672
    buffer_load_dwordx4 v[76:79], v4, s[12:15], s46 offen
    s_add_u32 s46, s45, 32768
    buffer_load_dwordx4 v[80:83], v4, s[12:15], s46 offen
    s_add_u32 s46, s45, 36864
    buffer_load_dwordx4 v[84:87], v4, s[12:15], s46 offen
    s_add_u32 s46, s45, 40960
    buffer_load_dwordx4 v[88:91], v4, s[12:15], s46 offen
    s_add_u32 s46, s45, 45056
    buffer_load_dwordx4 v[92:95], v4, s[12:15], s46 offen
    s_add_u32 s46, s45, 49152
    buffer_load_dwordx4 v[96:99], v4, s[12:15], s46 offen
    s_add_u32 s46, s45, 53248
    buffer_load_dwordx4 v[100:103], v4, s[12:15], s46 offen
    s_add_u32 s46, s45, 57344
    buffer_load_dwordx4 v[104:107], v4, s[12:15], s46 offen
    s_add_u32 s46, s45, 61440
    buffer_load_dwordx4 v[108:111], v4, s[12:15], s46 offen
    s_add_u32 s46, s45, 65536
    buffer_load_dwordx4 v[112:115], v4, s[12:15], s46 offen
    s_add_u32 s46, s45, 69632
    buffer_load_dwordx4 v[116:119], v4, s[12:15], s46 offen
    s_add_u32 s46, s45, 73728
    buffer_load_dwordx4 v[120:123], v4, s[12:15], s46 offen
    s_add_u32 s46, s45, 77824
    buffer_load_dwordx4 v[124:127], v4, s[12:15], s46 offen
    s_add_u32 s46, s45, 81920
    buffer_load_dwordx4 v[128:131], v4, s[12:15], s46 offen
    s_add_u32 s46, s45, 86016
    buffer_load_dwordx4 v[132:135], v4, s[12:15], s46 offen
    s_add_u32 s46, s45, 90112
    buffer_load_dwordx4 v[136:139], v4, s[12:15], s46 offen
    s_add_u32 s46, s45, 94208
    buffer_load_dwordx4 v[140:143], v4, s[12:15], s46 offen
    s_add_u32 s46, s45, 98304
    buffer_load_dwordx4 v[144:147], v4, s[12:15], s46 offen
    s_add_u32 s46, s45, 102400
    buffer_load_dwordx4 v[148:151], v4, s[12:15], s46 offen
    s_add_u32 s46, s45, 106496
    buffer_load_dwordx4 v[152:155], v4, s[12:15], s46 offen
    s_add_u32 s46, s45, 110592
    buffer_load_dwordx4 v[156:159], v4, s[12:15], s46 offen
    s_add_u32 s46, s45, 114688
    buffer_load_dwordx4 v[160:163], v4, s[12:15], s46 offen
    s_add_u32 s46, s45, 118784
    buffer_load_dwordx4 v[164:167], v4, s[12:15], s46 offen
    s_add_u32 s46, s45, 122880
    buffer_load_dwordx4 v[168:171], v4, s[12:15], s46 offen
    s_add_u32 s46, s45, 126976
    buffer_load_dwordx4 v[172:175], v4, s[12:15], s46 offen
    s_add_u32 s46, s45, 131072
    buffer_load_dwordx4 v[176:179], v4, s[12:15], s46 offen
    s_add_u32 s46, s45, 135168
    buffer_load_dwordx4 v[180:183], v4, s[12:15], s46 offen
    s_add_u32 s46, s45, 139264
    buffer_load_dwordx4 v[184:187], v4, s[12:15], s46 offen
    s_add_u32 s46, s45, 143360
    buffer_load_dwordx4 v[188:191], v4, s[12:15], s46 offen
    s_add_u32 s46, s45, 147456
    buffer_load_dwordx4 v[192:195], v4, s[12:15], s46 offen
    s_add_u32 s46, s45, 151552
    buffer_load_dwordx4 v[196:199], v4, s[12:15], s46 offen
    s_add_u32 s46, s45, 155648
    buffer_load_dwordx4 v[200:203], v4, s[12:15], s46 offen
    s_add_u32 s46, s45, 159744
    buffer_load_dwordx4 v[204:207], v4, s[12:15], s46 offen
    s_add_u32 s46, s45, 163840
    buffer_load_dwordx4 v[208:211], v4, s[12:15], s46 offen
    s_add_u32 s46, s45, 167936
    buffer_load_dwordx4 v[212:215], v4, s[12:15], s46 offen
    s_add_u32 s46, s45, 172032
    buffer_load_dwordx4 v[216:219], v4, s[12:15], s46 offen
    s_add_u32 s46, s45, 176128
    buffer_load_dwordx4 v[220:223], v4, s[12:15], s46 offen
    s_add_u32 s46, s45, 180224
    buffer_load_dwordx4 v[224:227], v4, s[12:15], s46 offen
    s_add_u32 s46, s45, 184320
    buffer_load_dwordx4 v[228:231], v4, s[12:15], s46 offen
    s_add_u32 s46, s45, 188416
    buffer_load_dwordx4 v[232:235], v4, s[12:15], s46 offen
    s_add_u32 s46, s45, 192512
    buffer_load_dwordx4 v[236:239], v4, s[12:15], s46 offen
    s_add_u32 s46, s45, 196608
    buffer_load_dwordx4 v[240:243], v4, s[12:15], s46 offen
    s_add_u32 s46, s45, 200704
    buffer_load_dwordx4 v[244:247], v4, s[12:15], s46 offen
    s_add_u32 s46, s45, 204800
    buffer_load_dwordx4 v[248:251], v4, s[12:15], s46 offen
    s_add_u32 s46, s45, 208896
    buffer_load_dwordx4 v[252:255], v4, s[12:15], s46 offen
    v_lshrrev_b32 v8, 2, v2
    v_lshl_add_u32 v8, v3, 2, v8
    v_mul_u32_u24 v5, 1312, v8
    v_and_b32 v8, 3, v2
    v_lshl_add_u32 v5, v8, 3, v5
    s_mul_i32 s24, s3, 320
    v_add_u32 v5, s24, v5
    v_add_u32 v6, 62976, v5
    s_waitcnt vmcnt(22)
    ds_write_b128 v16, v[48:51]
    ds_write_b128 v17, v[52:55]
    ds_write_b128 v18, v[56:59]
    ds_write_b128 v19, v[60:63]
    ds_write_b128 v20, v[64:67]
    ds_write_b128 v21, v[68:71]
    ds_write_b128 v22, v[72:75]
    ds_write_b128 v23, v[76:79]
    ds_write_b128 v24, v[80:83]
    ds_write_b128 v25, v[84:87]
    ds_write_b128 v26, v[88:91]
    ds_write_b128 v27, v[92:95]
    ds_write_b128 v28, v[96:99]
    ds_write_b128 v29, v[100:103]
    ds_write_b128 v30, v[104:107]
    ds_write_b128 v31, v[108:111]
    ds_write_b128 v32, v[112:115]
    ds_write_b128 v33, v[116:119]
    ds_write_b128 v34, v[120:123]
    ds_write_b128 v35, v[124:127]
    ds_write_b128 v36, v[128:131]
    ds_write_b128 v37, v[132:135]
    ds_write_b128 v38, v[136:139]
    ds_write_b128 v39, v[140:143]
    ds_write_b128 v40, v[144:147]
    ds_write_b128 v41, v[148:151]
    ds_write_b128 v42, v[152:155]
    ds_write_b128 v43, v[156:159]
    ds_write_b128 v44, v[160:163]
    ds_write_b128 v45, v[164:167]
    s_waitcnt lgkmcnt(0)
    s_add_u32 s46, s45, 212992
    buffer_load_dwordx4 v[48:51], v4, s[12:15], s46 offen
    s_add_u32 s46, s45, 217088
    buffer_load_dwordx4 v[52:55], v4, s[12:15], s46 offen
    s_add_u32 s46, s45, 221184
    buffer_load_dwordx4 v[56:59], v4, s[12:15], s46 offen
    s_add_u32 s46, s45, 225280
    buffer_load_dwordx4 v[60:63], v4, s[12:15], s46 offen
    s_add_u32 s46, s45, 229376
    buffer_load_dwordx4 v[64:67], v4, s[12:15], s46 offen
    s_add_u32 s46, s45, 233472
    buffer_load_dwordx4 v[68:71], v4, s[12:15], s46 offen
    s_add_u32 s46, s45, 237568
    buffer_load_dwordx4 v[72:75], v4, s[12:15], s46 offen
    s_add_u32 s46, s45, 241664
    buffer_load_dwordx4 v[76:79], v4, s[12:15], s46 offen
    s_barrier
    ds_read_b64_tr_b16 a[0:1], v5 offset:0
    ds_read_b64_tr_b16 a[2:3], v5 offset:20992
    ds_read_b64_tr_b16 a[4:5], v6 offset:0
    ds_read_b64_tr_b16 a[6:7], v6 offset:20992
    ds_read_b64_tr_b16 a[16:17], v5 offset:41984
    ds_read_b64_tr_b16 a[18:19], v6 offset:41984
    ds_read_b64_tr_b16 a[24:25], v5 offset:32
    ds_read_b64_tr_b16 a[26:27], v5 offset:21024
    ds_read_b64_tr_b16 a[28:29], v6 offset:32
    ds_read_b64_tr_b16 a[30:31], v6 offset:21024
    ds_read_b64_tr_b16 a[40:41], v5 offset:42016
    ds_read_b64_tr_b16 a[42:43], v6 offset:42016
    ds_read_b64_tr_b16 a[48:49], v5 offset:64
    ds_read_b64_tr_b16 a[50:51], v5 offset:21056
    ds_read_b64_tr_b16 a[52:53], v6 offset:64
    ds_read_b64_tr_b16 a[54:55], v6 offset:21056
    ds_read_b64_tr_b16 a[64:65], v5 offset:42048
    ds_read_b64_tr_b16 a[66:67], v6 offset:42048
    ds_read_b64_tr_b16 a[72:73], v5 offset:96
    ds_read_b64_tr_b16 a[74:75], v5 offset:21088
    ds_read_b64_tr_b16 a[76:77], v6 offset:96
    ds_read_b64_tr_b16 a[78:79], v6 offset:21088
    ds_read_b64_tr_b16 a[88:89], v5 offset:42080
    ds_read_b64_tr_b16 a[90:91], v6 offset:42080
    ds_read_b64_tr_b16 a[96:97], v5 offset:128
    ds_read_b64_tr_b16 a[98:99], v5 offset:21120
    ds_read_b64_tr_b16 a[100:101], v6 offset:128
    ds_read_b64_tr_b16 a[102:103], v6 offset:21120
    ds_read_b64_tr_b16 a[112:113], v5 offset:42112
    ds_read_b64_tr_b16 a[114:115], v6 offset:42112
    ds_read_b64_tr_b16 a[120:121], v5 offset:160
    ds_read_b64_tr_b16 a[122:123], v5 offset:21152
    ds_read_b64_tr_b16 a[124:125], v6 offset:160
    ds_read_b64_tr_b16 a[126:127], v6 offset:21152
    ds_read_b64_tr_b16 a[136:137], v5 offset:42144
    ds_read_b64_tr_b16 a[138:139], v6 offset:42144
    ds_read_b64_tr_b16 a[144:145], v5 offset:192
    ds_read_b64_tr_b16 a[146:147], v5 offset:21184
    ds_read_b64_tr_b16 a[148:149], v6 offset:192
    ds_read_b64_tr_b16 a[150:151], v6 offset:21184
    ds_read_b64_tr_b16 a[160:161], v5 offset:42176
    ds_read_b64_tr_b16 a[162:163], v6 offset:42176
    ds_read_b64_tr_b16 a[168:169], v5 offset:224
    ds_read_b64_tr_b16 a[170:171], v5 offset:21216
    ds_read_b64_tr_b16 a[172:173], v6 offset:224
    ds_read_b64_tr_b16 a[174:175], v6 offset:21216
    ds_read_b64_tr_b16 a[184:185], v5 offset:42208
    ds_read_b64_tr_b16 a[186:187], v6 offset:42208
    ds_read_b64_tr_b16 a[192:193], v5 offset:256
    ds_read_b64_tr_b16 a[194:195], v5 offset:21248
    ds_read_b64_tr_b16 a[196:197], v6 offset:256
    ds_read_b64_tr_b16 a[198:199], v6 offset:21248
    ds_read_b64_tr_b16 a[208:209], v5 offset:42240
    ds_read_b64_tr_b16 a[210:211], v6 offset:42240
    ds_read_b64_tr_b16 a[216:217], v5 offset:288
    ds_read_b64_tr_b16 a[218:219], v5 offset:21280
    ds_read_b64_tr_b16 a[220:221], v6 offset:288
    ds_read_b64_tr_b16 a[222:223], v6 offset:21280
    ds_read_b64_tr_b16 a[232:233], v5 offset:42272
    ds_read_b64_tr_b16 a[234:235], v6 offset:42272
    s_waitcnt lgkmcnt(0)
    s_barrier
    s_waitcnt vmcnt(0)
    ds_write_b128 v16, v[168:171]
    ds_write_b128 v17, v[172:175]
    ds_write_b128 v18, v[176:179]
    ds_write_b128 v19, v[180:183]
    ds_write_b128 v20, v[184:187]
    ds_write_b128 v21, v[188:191]
    ds_write_b128 v22, v[192:195]
    ds_write_b128 v23, v[196:199]
    ds_write_b128 v24, v[200:203]
    ds_write_b128 v25, v[204:207]
    ds_write_b128 v26, v[208:211]
    ds_write_b128 v27, v[212:215]
    ds_write_b128 v28, v[216:219]
    ds_write_b128 v29, v[220:223]
    ds_write_b128 v30, v[224:227]
    ds_write_b128 v31, v[228:231]
    ds_write_b128 v32, v[232:235]
    ds_write_b128 v33, v[236:239]
    ds_write_b128 v34, v[240:243]
    ds_write_b128 v35, v[244:247]
    ds_write_b128 v36, v[248:251]
    ds_write_b128 v37, v[252:255]
    ds_write_b128 v38, v[48:51]
    ds_write_b128 v39, v[52:55]
    ds_write_b128 v40, v[56:59]
    ds_write_b128 v41, v[60:63]
    ds_write_b128 v42, v[64:67]
    ds_write_b128 v43, v[68:71]
    ds_write_b128 v44, v[72:75]
    ds_write_b128 v45, v[76:79]
    s_waitcnt lgkmcnt(0)
    s_barrier
    ds_read_b64_tr_b16 a[8:9], v5 offset:0
    ds_read_b64_tr_b16 a[10:11], v5 offset:20992
    ds_read_b64_tr_b16 a[12:13], v6 offset:0
    ds_read_b64_tr_b16 a[14:15], v6 offset:20992
    ds_read_b64_tr_b16 a[20:21], v5 offset:41984
    ds_read_b64_tr_b16 a[22:23], v6 offset:41984
    ds_read_b64_tr_b16 a[32:33], v5 offset:32
    ds_read_b64_tr_b16 a[34:35], v5 offset:21024
    ds_read_b64_tr_b16 a[36:37], v6 offset:32
    ds_read_b64_tr_b16 a[38:39], v6 offset:21024
    ds_read_b64_tr_b16 a[44:45], v5 offset:42016
    ds_read_b64_tr_b16 a[46:47], v6 offset:42016
    ds_read_b64_tr_b16 a[56:57], v5 offset:64
    ds_read_b64_tr_b16 a[58:59], v5 offset:21056
    ds_read_b64_tr_b16 a[60:61], v6 offset:64
    ds_read_b64_tr_b16 a[62:63], v6 offset:21056
    ds_read_b64_tr_b16 a[68:69], v5 offset:42048
    ds_read_b64_tr_b16 a[70:71], v6 offset:42048
    ds_read_b64_tr_b16 a[80:81], v5 offset:96
    ds_read_b64_tr_b16 a[82:83], v5 offset:21088
    ds_read_b64_tr_b16 a[84:85], v6 offset:96
    ds_read_b64_tr_b16 a[86:87], v6 offset:21088
    ds_read_b64_tr_b16 a[92:93], v5 offset:42080
    ds_read_b64_tr_b16 a[94:95], v6 offset:42080
    ds_read_b64_tr_b16 a[104:105], v5 offset:128
    ds_read_b64_tr_b16 a[106:107], v5 offset:21120
    ds_read_b64_tr_b16 a[108:109], v6 offset:128
    ds_read_b64_tr_b16 a[110:111], v6 offset:21120
    ds_read_b64_tr_b16 a[116:117], v5 offset:42112
    ds_read_b64_tr_b16 a[118:119], v6 offset:42112
    ds_read_b64_tr_b16 a[128:129], v5 offset:160
    ds_read_b64_tr_b16 a[130:131], v5 offset:21152
    ds_read_b64_tr_b16 a[132:133], v6 offset:160
    ds_read_b64_tr_b16 a[134:135], v6 offset:21152
    ds_read_b64_tr_b16 a[140:141], v5 offset:42144
    ds_read_b64_tr_b16 a[142:143], v6 offset:42144
    ds_read_b64_tr_b16 a[152:153], v5 offset:192
    ds_read_b64_tr_b16 a[154:155], v5 offset:21184
    ds_read_b64_tr_b16 a[156:157], v6 offset:192
    ds_read_b64_tr_b16 a[158:159], v6 offset:21184
    ds_read_b64_tr_b16 a[164:165], v5 offset:42176
    ds_read_b64_tr_b16 a[166:167], v6 offset:42176
    ds_read_b64_tr_b16 a[176:177], v5 offset:224
    ds_read_b64_tr_b16 a[178:179], v5 offset:21216
    ds_read_b64_tr_b16 a[180:181], v6 offset:224
    ds_read_b64_tr_b16 a[182:183], v6 offset:21216
    ds_read_b64_tr_b16 a[188:189], v5 offset:42208
    ds_read_b64_tr_b16 a[190:191], v6 offset:42208
    ds_read_b64_tr_b16 a[200:201], v5 offset:256
    ds_read_b64_tr_b16 a[202:203], v5 offset:21248
    ds_read_b64_tr_b16 a[204:205], v6 offset:256
    ds_read_b64_tr_b16 a[206:207], v6 offset:21248
    ds_read_b64_tr_b16 a[212:213], v5 offset:42240
    ds_read_b64_tr_b16 a[214:215], v6 offset:42240
    ds_read_b64_tr_b16 a[224:225], v5 offset:288
    ds_read_b64_tr_b16 a[226:227], v5 offset:21280
    ds_read_b64_tr_b16 a[228:229], v6 offset:288
    ds_read_b64_tr_b16 a[230:231], v6 offset:21280
    ds_read_b64_tr_b16 a[236:237], v5 offset:42272
    ds_read_b64_tr_b16 a[238:239], v6 offset:42272
    s_waitcnt lgkmcnt(0)
    s_barrier
    v_lshlrev_b32 v5, 4, v1
    s_mul_i32 s24, s44, 12288
    v_add_u32 v6, s24, v5
    v_add_u32 v7, 4096, v6
    v_add_u32 v8, 8192, v6
    s_mul_i32 s24, s3, 327680
    s_lshl_b32 s25, s44, 10
    s_add_u32 s24, s24, s25
    v_add_u32 v9, s24, v5
interleave_layers__linear_attn_block__memory_aug_recurrent_mem_tr__prompt_kernel_o_layer:
    s_mov_b32 s93, 0
    s_lshl_b32 s24, s93, 12
    s_and_b32 s24, s24, 0x2000
    s_xor_b32 s24, s24, s36
    s_lshl_b32 s93, s93, 20
    s_add_u32 s93, s93, s24
    s_add_u32 s93, s93, 117440512
    s_mul_i32 s94, s92, 16384
    s_add_u32 s94, s94, 23068672
    s_mov_b32 s24, 12288
    s_lshl_b32 s25, s44, 7
    s_add_u32 s24, s24, s25
    s_add_u32 s24, s24, s94
    v_mov_b32 v14, s24
    v_mov_b32 v15, 2146435072
    v_cmp_eq_u32 vcc, 0, v1
    s_nop 1
    v_cndmask_b32 v14, v15, v14, vcc
    s_lshl_b32 s24, s44, 7
    s_add_u32 s24, s24, 8192
    s_add_u32 s24, s24, s94
    v_mov_b32 v10, s24
    s_mov_b32 s41, 33554432
    s_mov_b32 s43, 184549376
    s_mov_b32 s40, 0
    s_mov_b32 s62, -1
    s_mov_b32 s63, 1
    s_cmp_ge_i32 s62, s63
    s_cbranch_scc1 interleave_layers__linear_attn_block__memory_aug_recurrent_mem_tr__prompt_kernel_o_en0_ok
    s_mov_b32 s61, 0
interleave_layers__linear_attn_block__memory_aug_recurrent_mem_tr__prompt_kernel_o_en0:
    buffer_load_dword v11, v10, s[8:11], 0 offen sc1
    s_waitcnt vmcnt(0)
    v_readlane_b32 s62, v11, 0
    s_cmp_ge_i32 s62, s63
    s_cbranch_scc1 interleave_layers__linear_attn_block__memory_aug_recurrent_mem_tr__prompt_kernel_o_en0_ok
    s_add_u32 s61, s61, 1
    s_cmp_ge_u32 s61, s60
    s_cbranch_scc1 interleave_layers__linear_attn_block__memory_aug_recurrent_mem_tr__prompt_kernel_o_en0_to
    s_sleep 2
    s_branch interleave_layers__linear_attn_block__memory_aug_recurrent_mem_tr__prompt_kernel_o_en0
interleave_layers__linear_attn_block__memory_aug_recurrent_mem_tr__prompt_kernel_o_en0_to:
    s_mov_b32 s60, 1
interleave_layers__linear_attn_block__memory_aug_recurrent_mem_tr__prompt_kernel_o_en0_ok:
    buffer_load_dwordx4 v[16:19], v6, s[8:11], s41 offen offset:0 sc1
    buffer_load_dwordx4 v[20:23], v6, s[8:11], s41 offen offset:1024 sc1
    buffer_load_dwordx4 v[24:27], v6, s[8:11], s41 offen offset:2048 sc1
    buffer_load_dwordx4 v[28:31], v6, s[8:11], s41 offen offset:3072 sc1
    buffer_load_dwordx4 v[32:35], v7, s[8:11], s41 offen offset:0 sc1
    buffer_load_dwordx4 v[36:39], v7, s[8:11], s41 offen offset:1024 sc1
    buffer_load_dwordx4 v[40:43], v7, s[8:11], s41 offen offset:2048 sc1
    buffer_load_dwordx4 v[44:47], v7, s[8:11], s41 offen offset:3072 sc1
    buffer_load_dwordx4 v[48:51], v8, s[8:11], s41 offen offset:0 sc1
    buffer_load_dwordx4 v[52:55], v8, s[8:11], s41 offen offset:1024 sc1
    buffer_load_dwordx4 v[56:59], v8, s[8:11], s41 offen offset:2048 sc1
    buffer_load_dwordx4 v[60:63], v8, s[8:11], s41 offen offset:3072 sc1
    s_add_u32 s41, s41, 393216
    s_waitcnt vmcnt(0)
interleave_layers__linear_attn_block__memory_aug_recurrent_mem_tr__prompt_kernel_o_seg:
    v_swap_b32 v26, v36
    v_swap_b32 v27, v37
    v_swap_b32 v50, v60
    v_swap_b32 v51, v61
    buffer_load_dword v232, v10, s[8:11], 0 offen sc1
    v_mfma_f32_16x16x32_bf16 v[112:115], v[16:19], a[0:3], 0
    v_mfma_f32_16x16x32_bf16 v[116:119], v[20:23], a[0:3], 0
    v_mfma_f32_16x16x32_bf16 v[120:123], v[16:19], a[24:27], 0
    v_mfma_f32_16x16x32_bf16 v[124:127], v[20:23], a[24:27], 0
    v_mfma_f32_16x16x32_bf16 v[128:131], v[16:19], a[48:51], 0
    v_mfma_f32_16x16x32_bf16 v[132:135], v[20:23], a[48:51], 0
    v_mfma_f32_16x16x32_bf16 v[136:139], v[16:19], a[72:75], 0
    v_mfma_f32_16x16x32_bf16 v[140:143], v[20:23], a[72:75], 0
    v_mfma_f32_16x16x32_bf16 v[144:147], v[16:19], a[96:99], 0
    v_mfma_f32_16x16x32_bf16 v[148:151], v[20:23], a[96:99], 0
    v_mfma_f32_16x16x32_bf16 v[152:155], v[16:19], a[120:123], 0
    v_mfma_f32_16x16x32_bf16 v[156:159], v[20:23], a[120:123], 0
    v_mfma_f32_16x16x32_bf16 v[160:163], v[16:19], a[144:147], 0
    v_mfma_f32_16x16x32_bf16 v[164:167], v[20:23], a[144:147], 0
    v_mfma_f32_16x16x32_bf16 v[168:171], v[16:19], a[168:171], 0
    v_mfma_f32_16x16x32_bf16 v[172:175], v[20:23], a[168:171], 0
    v_mfma_f32_16x16x32_bf16 v[176:179], v[16:19], a[192:195], 0
    v_mfma_f32_16x16x32_bf16 v[180:183], v[20:23], a[192:195], 0
    v_mfma_f32_16x16x32_bf16 v[184:187], v[16:19], a[216:219], 0
    v_mfma_f32_16x16x32_bf16 v[188:191], v[20:23], a[216:219], 0
    v_mfma_f32_16x16x32_bf16 v[112:115], v[28:31], a[4:7], v[112:115]
    v_mfma_f32_16x16x32_bf16 v[116:119], v[32:35], a[4:7], v[116:119]
    v_mfma_f32_16x16x32_bf16 v[120:123], v[28:31], a[28:31], v[120:123]
    v_mfma_f32_16x16x32_bf16 v[124:127], v[32:35], a[28:31], v[124:127]
    v_mfma_f32_16x16x32_bf16 v[128:131], v[28:31], a[52:55], v[128:131]
    v_mfma_f32_16x16x32_bf16 v[132:135], v[32:35], a[52:55], v[132:135]
    v_mfma_f32_16x16x32_bf16 v[136:139], v[28:31], a[76:79], v[136:139]
    v_mfma_f32_16x16x32_bf16 v[140:143], v[32:35], a[76:79], v[140:143]
    v_mfma_f32_16x16x32_bf16 v[144:147], v[28:31], a[100:103], v[144:147]
    v_mfma_f32_16x16x32_bf16 v[148:151], v[32:35], a[100:103], v[148:151]
    v_mfma_f32_16x16x32_bf16 v[152:155], v[28:31], a[124:127], v[152:155]
    v_mfma_f32_16x16x32_bf16 v[156:159], v[32:35], a[124:127], v[156:159]
    v_mfma_f32_16x16x32_bf16 v[160:163], v[28:31], a[148:151], v[160:163]
    v_mfma_f32_16x16x32_bf16 v[164:167], v[32:35], a[148:151], v[164:167]
    v_mfma_f32_16x16x32_bf16 v[168:171], v[28:31], a[172:175], v[168:171]
    v_mfma_f32_16x16x32_bf16 v[172:175], v[32:35], a[172:175], v[172:175]
    v_mfma_f32_16x16x32_bf16 v[176:179], v[28:31], a[196:199], v[176:179]
    v_mfma_f32_16x16x32_bf16 v[180:183], v[32:35], a[196:199], v[180:183]
    v_mfma_f32_16x16x32_bf16 v[184:187], v[28:31], a[220:223], v[184:187]
    v_mfma_f32_16x16x32_bf16 v[188:191], v[32:35], a[220:223], v[188:191]
    v_mfma_f32_16x16x32_bf16 v[112:115], v[40:43], a[8:11], v[112:115]
    v_mfma_f32_16x16x32_bf16 v[116:119], v[44:47], a[8:11], v[116:119]
    v_mfma_f32_16x16x32_bf16 v[120:123], v[40:43], a[32:35], v[120:123]
    v_mfma_f32_16x16x32_bf16 v[124:127], v[44:47], a[32:35], v[124:127]
    v_mfma_f32_16x16x32_bf16 v[128:131], v[40:43], a[56:59], v[128:131]
    v_mfma_f32_16x16x32_bf16 v[132:135], v[44:47], a[56:59], v[132:135]
    v_mfma_f32_16x16x32_bf16 v[136:139], v[40:43], a[80:83], v[136:139]
    v_mfma_f32_16x16x32_bf16 v[140:143], v[44:47], a[80:83], v[140:143]
    v_mfma_f32_16x16x32_bf16 v[144:147], v[40:43], a[104:107], v[144:147]
    v_mfma_f32_16x16x32_bf16 v[148:151], v[44:47], a[104:107], v[148:151]
    v_mfma_f32_16x16x32_bf16 v[152:155], v[40:43], a[128:131], v[152:155]
    v_mfma_f32_16x16x32_bf16 v[156:159], v[44:47], a[128:131], v[156:159]
    v_mfma_f32_16x16x32_bf16 v[160:163], v[40:43], a[152:155], v[160:163]
    v_mfma_f32_16x16x32_bf16 v[164:167], v[44:47], a[152:155], v[164:167]
    v_mfma_f32_16x16x32_bf16 v[168:171], v[40:43], a[176:179], v[168:171]
    v_mfma_f32_16x16x32_bf16 v[172:175], v[44:47], a[176:179], v[172:175]
    v_mfma_f32_16x16x32_bf16 v[176:179], v[40:43], a[200:203], v[176:179]
    v_mfma_f32_16x16x32_bf16 v[180:183], v[44:47], a[200:203], v[180:183]
    v_mfma_f32_16x16x32_bf16 v[184:187], v[40:43], a[224:227], v[184:187]
    v_mfma_f32_16x16x32_bf16 v[188:191], v[44:47], a[224:227], v[188:191]
    s_waitcnt vmcnt(0)
    v_readfirstlane_b32 s24, v232
    s_max_i32 s62, s62, s24
    s_add_u32 s63, s40, 2
    s_min_u32 s63, s63, 64
    s_cmp_ge_i32 s62, s63
    s_cselect_b32 s24, 1, 0
    s_lshl_b32 s25, s3, 4
    s_add_u32 s25, s25, 0
    v_mov_b32 v12, s25
    v_mov_b32 v13, s24
    ds_write_b32 v12, v13
    v_mov_b32 v12, 0
    s_waitcnt lgkmcnt(0)
    s_barrier
    ds_read_b32 v13, v12
    s_cmp_eq_u32 s3, 0
    s_cbranch_scc0 interleave_layers__linear_attn_block__memory_aug_recurrent_mem_tr__prompt_kernel_fp44
    v_mov_b32 v15, s40
    buffer_store_dword v15, v14, s[8:11], 0 offen sc1
interleave_layers__linear_attn_block__memory_aug_recurrent_mem_tr__prompt_kernel_fp44:
    s_waitcnt lgkmcnt(0)
    v_readfirstlane_b32 s58, v13
    s_cmp_eq_u32 s58, 1
    s_cbranch_scc0 interleave_layers__linear_attn_block__memory_aug_recurrent_mem_tr__prompt_kernel_of43
    s_max_i32 s62, s62, s63
    buffer_load_dwordx4 v[64:67], v6, s[8:11], s41 offen offset:0 sc1
    buffer_load_dwordx4 v[68:71], v6, s[8:11], s41 offen offset:1024 sc1
    buffer_load_dwordx4 v[72:75], v6, s[8:11], s41 offen offset:2048 sc1
    buffer_load_dwordx4 v[76:79], v6, s[8:11], s41 offen offset:3072 sc1
    buffer_load_dwordx4 v[80:83], v7, s[8:11], s41 offen offset:0 sc1
    buffer_load_dwordx4 v[84:87], v7, s[8:11], s41 offen offset:1024 sc1
    buffer_load_dwordx4 v[88:91], v7, s[8:11], s41 offen offset:2048 sc1
    buffer_load_dwordx4 v[92:95], v7, s[8:11], s41 offen offset:3072 sc1
    buffer_load_dwordx4 v[96:99], v8, s[8:11], s41 offen offset:0 sc1
    buffer_load_dwordx4 v[100:103], v8, s[8:11], s41 offen offset:1024 sc1
    buffer_load_dwordx4 v[104:107], v8, s[8:11], s41 offen offset:2048 sc1
    buffer_load_dwordx4 v[108:111], v8, s[8:11], s41 offen offset:3072 sc1
    s_add_u32 s41, s41, 393216
interleave_layers__linear_attn_block__memory_aug_recurrent_mem_tr__prompt_kernel_of43:
    v_mfma_f32_16x16x32_bf16 v[112:115], v[52:55], a[12:15], v[112:115]
    v_mfma_f32_16x16x32_bf16 v[116:119], v[56:59], a[12:15], v[116:119]
    v_mfma_f32_16x16x32_bf16 v[120:123], v[52:55], a[36:39], v[120:123]
    v_mfma_f32_16x16x32_bf16 v[124:127], v[56:59], a[36:39], v[124:127]
    v_mfma_f32_16x16x32_bf16 v[128:131], v[52:55], a[60:63], v[128:131]
    v_mfma_f32_16x16x32_bf16 v[132:135], v[56:59], a[60:63], v[132:135]
    v_mfma_f32_16x16x32_bf16 v[136:139], v[52:55], a[84:87], v[136:139]
    v_mfma_f32_16x16x32_bf16 v[140:143], v[56:59], a[84:87], v[140:143]
    v_mfma_f32_16x16x32_bf16 v[144:147], v[52:55], a[108:111], v[144:147]
    v_mfma_f32_16x16x32_bf16 v[148:151], v[56:59], a[108:111], v[148:151]
    v_mfma_f32_16x16x32_bf16 v[152:155], v[52:55], a[132:135], v[152:155]
    v_mfma_f32_16x16x32_bf16 v[156:159], v[56:59], a[132:135], v[156:159]
    v_mfma_f32_16x16x32_bf16 v[160:163], v[52:55], a[156:159], v[160:163]
    v_mfma_f32_16x16x32_bf16 v[164:167], v[56:59], a[156:159], v[164:167]
    v_mfma_f32_16x16x32_bf16 v[168:171], v[52:55], a[180:183], v[168:171]
    v_mfma_f32_16x16x32_bf16 v[172:175], v[56:59], a[180:183], v[172:175]
    v_mfma_f32_16x16x32_bf16 v[176:179], v[52:55], a[204:207], v[176:179]
    v_mfma_f32_16x16x32_bf16 v[180:183], v[56:59], a[204:207], v[180:183]
    v_mfma_f32_16x16x32_bf16 v[184:187], v[52:55], a[228:231], v[184:187]
    v_mfma_f32_16x16x32_bf16 v[188:191], v[56:59], a[228:231], v[188:191]
    v_mfma_f32_16x16x32_bf16 v[112:115], v[24:27], a[16:19], v[112:115]
    v_mfma_f32_16x16x32_bf16 v[116:119], v[36:39], a[16:19], v[116:119]
    v_mfma_f32_16x16x32_bf16 v[120:123], v[24:27], a[40:43], v[120:123]
    v_mfma_f32_16x16x32_bf16 v[124:127], v[36:39], a[40:43], v[124:127]
    v_mfma_f32_16x16x32_bf16 v[128:131], v[24:27], a[64:67], v[128:131]
    v_mfma_f32_16x16x32_bf16 v[132:135], v[36:39], a[64:67], v[132:135]
    v_mfma_f32_16x16x32_bf16 v[136:139], v[24:27], a[88:91], v[136:139]
    v_mfma_f32_16x16x32_bf16 v[140:143], v[36:39], a[88:91], v[140:143]
    v_mfma_f32_16x16x32_bf16 v[144:147], v[24:27], a[112:115], v[144:147]
    v_mfma_f32_16x16x32_bf16 v[148:151], v[36:39], a[112:115], v[148:151]
    v_mfma_f32_16x16x32_bf16 v[152:155], v[24:27], a[136:139], v[152:155]
    v_mfma_f32_16x16x32_bf16 v[156:159], v[36:39], a[136:139], v[156:159]
    v_mfma_f32_16x16x32_bf16 v[160:163], v[24:27], a[160:163], v[160:163]
    v_mfma_f32_16x16x32_bf16 v[164:167], v[36:39], a[160:163], v[164:167]
    v_mfma_f32_16x16x32_bf16 v[168:171], v[24:27], a[184:187], v[168:171]
    v_mfma_f32_16x16x32_bf16 v[172:175], v[36:39], a[184:187], v[172:175]
    v_mfma_f32_16x16x32_bf16 v[176:179], v[24:27], a[208:211], v[176:179]
    v_mfma_f32_16x16x32_bf16 v[180:183], v[36:39], a[208:211], v[180:183]
    v_mfma_f32_16x16x32_bf16 v[184:187], v[24:27], a[232:235], v[184:187]
    v_mfma_f32_16x16x32_bf16 v[188:191], v[36:39], a[232:235], v[188:191]
    buffer_load_dword v233, v10, s[8:11], 0 offen sc1
    v_mfma_f32_16x16x32_bf16 v[112:115], v[48:51], a[20:23], v[112:115]
    v_mfma_f32_16x16x32_bf16 v[116:119], v[60:63], a[20:23], v[116:119]
    v_mfma_f32_16x16x32_bf16 v[120:123], v[48:51], a[44:47], v[120:123]
    v_mfma_f32_16x16x32_bf16 v[124:127], v[60:63], a[44:47], v[124:127]
    v_mfma_f32_16x16x32_bf16 v[128:131], v[48:51], a[68:71], v[128:131]
    v_mfma_f32_16x16x32_bf16 v[132:135], v[60:63], a[68:71], v[132:135]
    v_mfma_f32_16x16x32_bf16 v[136:139], v[48:51], a[92:95], v[136:139]
    v_mfma_f32_16x16x32_bf16 v[140:143], v[60:63], a[92:95], v[140:143]
    v_mfma_f32_16x16x32_bf16 v[144:147], v[48:51], a[116:119], v[144:147]
    v_mfma_f32_16x16x32_bf16 v[148:151], v[60:63], a[116:119], v[148:151]
    v_mfma_f32_16x16x32_bf16 v[152:155], v[48:51], a[140:143], v[152:155]
    v_mfma_f32_16x16x32_bf16 v[156:159], v[60:63], a[140:143], v[156:159]
    v_mfma_f32_16x16x32_bf16 v[160:163], v[48:51], a[164:167], v[160:163]
    v_mfma_f32_16x16x32_bf16 v[164:167], v[60:63], a[164:167], v[164:167]
    v_mfma_f32_16x16x32_bf16 v[168:171], v[48:51], a[188:191], v[168:171]
    v_mfma_f32_16x16x32_bf16 v[172:175], v[60:63], a[188:191], v[172:175]
    v_mfma_f32_16x16x32_bf16 v[176:179], v[48:51], a[212:215], v[176:179]
    v_mfma_f32_16x16x32_bf16 v[180:183], v[60:63], a[212:215], v[180:183]
    v_mfma_f32_16x16x32_bf16 v[184:187], v[48:51], a[236:239], v[184:187]
    v_mfma_f32_16x16x32_bf16 v[188:191], v[60:63], a[236:239], v[188:191]
    s_mov_b32 s46, s43
    v_cvt_pk_bf16_f32 v192, v112, v113
    v_cvt_pk_bf16_f32 v193, v114, v115
    v_cvt_pk_bf16_f32 v194, v116, v117
    v_cvt_pk_bf16_f32 v195, v118, v119
    buffer_store_dwordx4 v[192:195], v9, s[8:11], s46 offen sc1
    s_add_u32 s46, s46, 32768
    v_cvt_pk_bf16_f32 v196, v120, v121
    v_cvt_pk_bf16_f32 v197, v122, v123
    v_cvt_pk_bf16_f32 v198, v124, v125
    v_cvt_pk_bf16_f32 v199, v126, v127
    buffer_store_dwordx4 v[196:199], v9, s[8:11], s46 offen sc1
    s_add_u32 s46, s46, 32768
    v_cvt_pk_bf16_f32 v200, v128, v129
    v_cvt_pk_bf16_f32 v201, v130, v131
    v_cvt_pk_bf16_f32 v202, v132, v133
    v_cvt_pk_bf16_f32 v203, v134, v135
    buffer_store_dwordx4 v[200:203], v9, s[8:11], s46 offen sc1
    s_add_u32 s46, s46, 32768
    v_cvt_pk_bf16_f32 v204, v136, v137
    v_cvt_pk_bf16_f32 v205, v138, v139
    v_cvt_pk_bf16_f32 v206, v140, v141
    v_cvt_pk_bf16_f32 v207, v142, v143
    buffer_store_dwordx4 v[204:207], v9, s[8:11], s46 offen sc1
    s_add_u32 s46, s46, 32768
    v_cvt_pk_bf16_f32 v208, v144, v145
    v_cvt_pk_bf16_f32 v209, v146, v147
    v_cvt_pk_bf16_f32 v210, v148, v149
    v_cvt_pk_bf16_f32 v211, v150, v151
    buffer_store_dwordx4 v[208:211], v9, s[8:11], s46 offen sc1
    s_add_u32 s46, s46, 32768
    v_cvt_pk_bf16_f32 v212, v152, v153
    v_cvt_pk_bf16_f32 v213, v154, v155
    v_cvt_pk_bf16_f32 v214, v156, v157
    v_cvt_pk_bf16_f32 v215, v158, v159
    buffer_store_dwordx4 v[212:215], v9, s[8:11], s46 offen sc1
    s_add_u32 s46, s46, 32768
    v_cvt_pk_bf16_f32 v216, v160, v161
    v_cvt_pk_bf16_f32 v217, v162, v163
    v_cvt_pk_bf16_f32 v218, v164, v165
    v_cvt_pk_bf16_f32 v219, v166, v167
    buffer_store_dwordx4 v[216:219], v9, s[8:11], s46 offen sc1
    s_add_u32 s46, s46, 32768
    v_cvt_pk_bf16_f32 v220, v168, v169
    v_cvt_pk_bf16_f32 v221, v170, v171
    v_cvt_pk_bf16_f32 v222, v172, v173
    v_cvt_pk_bf16_f32 v223, v174, v175
    buffer_store_dwordx4 v[220:223], v9, s[8:11], s46 offen sc1
    s_add_u32 s46, s46, 32768
    v_cvt_pk_bf16_f32 v224, v176, v177
    v_cvt_pk_bf16_f32 v225, v178, v179
    v_cvt_pk_bf16_f32 v226, v180, v181
    v_cvt_pk_bf16_f32 v227, v182, v183
    buffer_store_dwordx4 v[224:227], v9, s[8:11], s46 offen sc1
    s_add_u32 s46, s46, 32768
    v_cvt_pk_bf16_f32 v228, v184, v185
    v_cvt_pk_bf16_f32 v229, v186, v187
    v_cvt_pk_bf16_f32 v230, v188, v189
    v_cvt_pk_bf16_f32 v231, v190, v191
    buffer_store_dwordx4 v[228:231], v9, s[8:11], s46 offen sc1
    s_cmp_eq_u32 s58, 1
    s_cbranch_scc1 interleave_layers__linear_attn_block__memory_aug_recurrent_mem_tr__prompt_kernel_of45
    s_waitcnt vmcnt(10)
    v_readfirstlane_b32 s24, v233
    s_max_i32 s62, s62, s24
    s_add_u32 s63, s40, 2
    s_min_u32 s63, s63, 64
    s_cmp_ge_i32 s62, s63
    s_cbranch_scc0 interleave_layers__linear_attn_block__memory_aug_recurrent_mem_tr__prompt_kernel_oo46
    buffer_load_dwordx4 v[64:67], v6, s[8:11], s41 offen offset:0 sc1
    buffer_load_dwordx4 v[68:71], v6, s[8:11], s41 offen offset:1024 sc1
    buffer_load_dwordx4 v[72:75], v6, s[8:11], s41 offen offset:2048 sc1
    buffer_load_dwordx4 v[76:79], v6, s[8:11], s41 offen offset:3072 sc1
    buffer_load_dwordx4 v[80:83], v7, s[8:11], s41 offen offset:0 sc1
    buffer_load_dwordx4 v[84:87], v7, s[8:11], s41 offen offset:1024 sc1
    buffer_load_dwordx4 v[88:91], v7, s[8:11], s41 offen offset:2048 sc1
    buffer_load_dwordx4 v[92:95], v7, s[8:11], s41 offen offset:3072 sc1
    buffer_load_dwordx4 v[96:99], v8, s[8:11], s41 offen offset:0 sc1
    buffer_load_dwordx4 v[100:103], v8, s[8:11], s41 offen offset:1024 sc1
    buffer_load_dwordx4 v[104:107], v8, s[8:11], s41 offen offset:2048 sc1
    buffer_load_dwordx4 v[108:111], v8, s[8:11], s41 offen offset:3072 sc1
    s_add_u32 s41, s41, 393216
    s_waitcnt vmcnt(12)
    s_barrier
    s_add_u32 s24, s40, 1
    s_cmp_eq_u32 s3, 0
    s_cbranch_scc0 interleave_layers__linear_attn_block__memory_aug_recurrent_mem_tr__prompt_kernel_fp47
    v_mov_b32 v15, s24
    buffer_store_dword v15, v14, s[8:11], 0 offen sc1
interleave_layers__linear_attn_block__memory_aug_recurrent_mem_tr__prompt_kernel_fp47:
    s_waitcnt vmcnt(0)
    s_branch interleave_layers__linear_attn_block__memory_aug_recurrent_mem_tr__prompt_kernel_of45
interleave_layers__linear_attn_block__memory_aug_recurrent_mem_tr__prompt_kernel_oo46:
    s_waitcnt vmcnt(0)
    s_barrier
    s_add_u32 s24, s40, 1
    s_cmp_eq_u32 s3, 0
    s_cbranch_scc0 interleave_layers__linear_attn_block__memory_aug_recurrent_mem_tr__prompt_kernel_fp48
    v_mov_b32 v15, s24
    buffer_store_dword v15, v14, s[8:11], 0 offen sc1
interleave_layers__linear_attn_block__memory_aug_recurrent_mem_tr__prompt_kernel_fp48:
    s_add_u32 s63, s40, 2
    s_min_u32 s63, s63, 64
    s_cmp_ge_i32 s62, s63
    s_cbranch_scc1 interleave_layers__linear_attn_block__memory_aug_recurrent_mem_tr__prompt_kernel_o_en3_ok
    s_mov_b32 s61, 0
interleave_layers__linear_attn_block__memory_aug_recurrent_mem_tr__prompt_kernel_o_en3:
    buffer_load_dword v11, v10, s[8:11], 0 offen sc1
    s_waitcnt vmcnt(0)
    v_readlane_b32 s62, v11, 0
    s_cmp_ge_i32 s62, s63
    s_cbranch_scc1 interleave_layers__linear_attn_block__memory_aug_recurrent_mem_tr__prompt_kernel_o_en3_ok
    s_add_u32 s61, s61, 1
    s_cmp_ge_u32 s61, s60
    s_cbranch_scc1 interleave_layers__linear_attn_block__memory_aug_recurrent_mem_tr__prompt_kernel_o_en3_to
    s_sleep 2
    s_branch interleave_layers__linear_attn_block__memory_aug_recurrent_mem_tr__prompt_kernel_o_en3
interleave_layers__linear_attn_block__memory_aug_recurrent_mem_tr__prompt_kernel_o_en3_to:
    s_mov_b32 s60, 1
interleave_layers__linear_attn_block__memory_aug_recurrent_mem_tr__prompt_kernel_o_en3_ok:
    buffer_load_dwordx4 v[64:67], v6, s[8:11], s41 offen offset:0 sc1
    buffer_load_dwordx4 v[68:71], v6, s[8:11], s41 offen offset:1024 sc1
    buffer_load_dwordx4 v[72:75], v6, s[8:11], s41 offen offset:2048 sc1
    buffer_load_dwordx4 v[76:79], v6, s[8:11], s41 offen offset:3072 sc1
    buffer_load_dwordx4 v[80:83], v7, s[8:11], s41 offen offset:0 sc1
    buffer_load_dwordx4 v[84:87], v7, s[8:11], s41 offen offset:1024 sc1
    buffer_load_dwordx4 v[88:91], v7, s[8:11], s41 offen offset:2048 sc1
    buffer_load_dwordx4 v[92:95], v7, s[8:11], s41 offen offset:3072 sc1
    buffer_load_dwordx4 v[96:99], v8, s[8:11], s41 offen offset:0 sc1
    buffer_load_dwordx4 v[100:103], v8, s[8:11], s41 offen offset:1024 sc1
    buffer_load_dwordx4 v[104:107], v8, s[8:11], s41 offen offset:2048 sc1
    buffer_load_dwordx4 v[108:111], v8, s[8:11], s41 offen offset:3072 sc1
    s_add_u32 s41, s41, 393216
    s_waitcnt vmcnt(0)
interleave_layers__linear_attn_block__memory_aug_recurrent_mem_tr__prompt_kernel_of45:
    s_waitcnt vmcnt(10)
    s_add_u32 s40, s40, 1
    s_add_u32 s43, s43, 1310720
    v_swap_b32 v74, v84
    v_swap_b32 v75, v85
    v_swap_b32 v98, v108
    v_swap_b32 v99, v109
    buffer_load_dword v232, v10, s[8:11], 0 offen sc1
    v_mfma_f32_16x16x32_bf16 v[112:115], v[64:67], a[0:3], 0
    v_mfma_f32_16x16x32_bf16 v[116:119], v[68:71], a[0:3], 0
    v_mfma_f32_16x16x32_bf16 v[120:123], v[64:67], a[24:27], 0
    v_mfma_f32_16x16x32_bf16 v[124:127], v[68:71], a[24:27], 0
    v_mfma_f32_16x16x32_bf16 v[128:131], v[64:67], a[48:51], 0
    v_mfma_f32_16x16x32_bf16 v[132:135], v[68:71], a[48:51], 0
    v_mfma_f32_16x16x32_bf16 v[136:139], v[64:67], a[72:75], 0
    v_mfma_f32_16x16x32_bf16 v[140:143], v[68:71], a[72:75], 0
    v_mfma_f32_16x16x32_bf16 v[144:147], v[64:67], a[96:99], 0
    v_mfma_f32_16x16x32_bf16 v[148:151], v[68:71], a[96:99], 0
    v_mfma_f32_16x16x32_bf16 v[152:155], v[64:67], a[120:123], 0
    v_mfma_f32_16x16x32_bf16 v[156:159], v[68:71], a[120:123], 0
    v_mfma_f32_16x16x32_bf16 v[160:163], v[64:67], a[144:147], 0
    v_mfma_f32_16x16x32_bf16 v[164:167], v[68:71], a[144:147], 0
    v_mfma_f32_16x16x32_bf16 v[168:171], v[64:67], a[168:171], 0
    v_mfma_f32_16x16x32_bf16 v[172:175], v[68:71], a[168:171], 0
    v_mfma_f32_16x16x32_bf16 v[176:179], v[64:67], a[192:195], 0
    v_mfma_f32_16x16x32_bf16 v[180:183], v[68:71], a[192:195], 0
    v_mfma_f32_16x16x32_bf16 v[184:187], v[64:67], a[216:219], 0
    v_mfma_f32_16x16x32_bf16 v[188:191], v[68:71], a[216:219], 0
    v_mfma_f32_16x16x32_bf16 v[112:115], v[76:79], a[4:7], v[112:115]
    v_mfma_f32_16x16x32_bf16 v[116:119], v[80:83], a[4:7], v[116:119]
    v_mfma_f32_16x16x32_bf16 v[120:123], v[76:79], a[28:31], v[120:123]
    v_mfma_f32_16x16x32_bf16 v[124:127], v[80:83], a[28:31], v[124:127]
    v_mfma_f32_16x16x32_bf16 v[128:131], v[76:79], a[52:55], v[128:131]
    v_mfma_f32_16x16x32_bf16 v[132:135], v[80:83], a[52:55], v[132:135]
    v_mfma_f32_16x16x32_bf16 v[136:139], v[76:79], a[76:79], v[136:139]
    v_mfma_f32_16x16x32_bf16 v[140:143], v[80:83], a[76:79], v[140:143]
    v_mfma_f32_16x16x32_bf16 v[144:147], v[76:79], a[100:103], v[144:147]
    v_mfma_f32_16x16x32_bf16 v[148:151], v[80:83], a[100:103], v[148:151]
    v_mfma_f32_16x16x32_bf16 v[152:155], v[76:79], a[124:127], v[152:155]
    v_mfma_f32_16x16x32_bf16 v[156:159], v[80:83], a[124:127], v[156:159]
    v_mfma_f32_16x16x32_bf16 v[160:163], v[76:79], a[148:151], v[160:163]
    v_mfma_f32_16x16x32_bf16 v[164:167], v[80:83], a[148:151], v[164:167]
    v_mfma_f32_16x16x32_bf16 v[168:171], v[76:79], a[172:175], v[168:171]
    v_mfma_f32_16x16x32_bf16 v[172:175], v[80:83], a[172:175], v[172:175]
    v_mfma_f32_16x16x32_bf16 v[176:179], v[76:79], a[196:199], v[176:179]
    v_mfma_f32_16x16x32_bf16 v[180:183], v[80:83], a[196:199], v[180:183]
    v_mfma_f32_16x16x32_bf16 v[184:187], v[76:79], a[220:223], v[184:187]
    v_mfma_f32_16x16x32_bf16 v[188:191], v[80:83], a[220:223], v[188:191]
    v_mfma_f32_16x16x32_bf16 v[112:115], v[88:91], a[8:11], v[112:115]
    v_mfma_f32_16x16x32_bf16 v[116:119], v[92:95], a[8:11], v[116:119]
    v_mfma_f32_16x16x32_bf16 v[120:123], v[88:91], a[32:35], v[120:123]
    v_mfma_f32_16x16x32_bf16 v[124:127], v[92:95], a[32:35], v[124:127]
    v_mfma_f32_16x16x32_bf16 v[128:131], v[88:91], a[56:59], v[128:131]
    v_mfma_f32_16x16x32_bf16 v[132:135], v[92:95], a[56:59], v[132:135]
    v_mfma_f32_16x16x32_bf16 v[136:139], v[88:91], a[80:83], v[136:139]
    v_mfma_f32_16x16x32_bf16 v[140:143], v[92:95], a[80:83], v[140:143]
    v_mfma_f32_16x16x32_bf16 v[144:147], v[88:91], a[104:107], v[144:147]
    v_mfma_f32_16x16x32_bf16 v[148:151], v[92:95], a[104:107], v[148:151]
    v_mfma_f32_16x16x32_bf16 v[152:155], v[88:91], a[128:131], v[152:155]
    v_mfma_f32_16x16x32_bf16 v[156:159], v[92:95], a[128:131], v[156:159]
    v_mfma_f32_16x16x32_bf16 v[160:163], v[88:91], a[152:155], v[160:163]
    v_mfma_f32_16x16x32_bf16 v[164:167], v[92:95], a[152:155], v[164:167]
    v_mfma_f32_16x16x32_bf16 v[168:171], v[88:91], a[176:179], v[168:171]
    v_mfma_f32_16x16x32_bf16 v[172:175], v[92:95], a[176:179], v[172:175]
    v_mfma_f32_16x16x32_bf16 v[176:179], v[88:91], a[200:203], v[176:179]
    v_mfma_f32_16x16x32_bf16 v[180:183], v[92:95], a[200:203], v[180:183]
    v_mfma_f32_16x16x32_bf16 v[184:187], v[88:91], a[224:227], v[184:187]
    v_mfma_f32_16x16x32_bf16 v[188:191], v[92:95], a[224:227], v[188:191]
    s_waitcnt vmcnt(0)
    v_readfirstlane_b32 s24, v232
    s_max_i32 s62, s62, s24
    s_add_u32 s63, s40, 2
    s_min_u32 s63, s63, 64
    s_cmp_ge_i32 s62, s63
    s_cselect_b32 s24, 1, 0
    s_lshl_b32 s25, s3, 4
    s_add_u32 s25, s25, 4
    v_mov_b32 v12, s25
    v_mov_b32 v13, s24
    ds_write_b32 v12, v13
    v_mov_b32 v12, 4
    s_waitcnt lgkmcnt(0)
    s_barrier
    ds_read_b32 v13, v12
    s_cmp_eq_u32 s3, 0
    s_cbranch_scc0 interleave_layers__linear_attn_block__memory_aug_recurrent_mem_tr__prompt_kernel_fp50
    v_mov_b32 v15, s40
    buffer_store_dword v15, v14, s[8:11], 0 offen sc1
interleave_layers__linear_attn_block__memory_aug_recurrent_mem_tr__prompt_kernel_fp50:
    s_waitcnt lgkmcnt(0)
    v_readfirstlane_b32 s58, v13
    s_cmp_eq_u32 s58, 1
    s_cbranch_scc0 interleave_layers__linear_attn_block__memory_aug_recurrent_mem_tr__prompt_kernel_of49
    s_max_i32 s62, s62, s63
    buffer_load_dwordx4 v[16:19], v6, s[8:11], s41 offen offset:0 sc1
    buffer_load_dwordx4 v[20:23], v6, s[8:11], s41 offen offset:1024 sc1
    buffer_load_dwordx4 v[24:27], v6, s[8:11], s41 offen offset:2048 sc1
    buffer_load_dwordx4 v[28:31], v6, s[8:11], s41 offen offset:3072 sc1
    buffer_load_dwordx4 v[32:35], v7, s[8:11], s41 offen offset:0 sc1
    buffer_load_dwordx4 v[36:39], v7, s[8:11], s41 offen offset:1024 sc1
    buffer_load_dwordx4 v[40:43], v7, s[8:11], s41 offen offset:2048 sc1
    buffer_load_dwordx4 v[44:47], v7, s[8:11], s41 offen offset:3072 sc1
    buffer_load_dwordx4 v[48:51], v8, s[8:11], s41 offen offset:0 sc1
    buffer_load_dwordx4 v[52:55], v8, s[8:11], s41 offen offset:1024 sc1
    buffer_load_dwordx4 v[56:59], v8, s[8:11], s41 offen offset:2048 sc1
    buffer_load_dwordx4 v[60:63], v8, s[8:11], s41 offen offset:3072 sc1
    s_add_u32 s41, s41, 393216
interleave_layers__linear_attn_block__memory_aug_recurrent_mem_tr__prompt_kernel_of49:
    v_mfma_f32_16x16x32_bf16 v[112:115], v[100:103], a[12:15], v[112:115]
    v_mfma_f32_16x16x32_bf16 v[116:119], v[104:107], a[12:15], v[116:119]
    v_mfma_f32_16x16x32_bf16 v[120:123], v[100:103], a[36:39], v[120:123]
    v_mfma_f32_16x16x32_bf16 v[124:127], v[104:107], a[36:39], v[124:127]
    v_mfma_f32_16x16x32_bf16 v[128:131], v[100:103], a[60:63], v[128:131]
    v_mfma_f32_16x16x32_bf16 v[132:135], v[104:107], a[60:63], v[132:135]
    v_mfma_f32_16x16x32_bf16 v[136:139], v[100:103], a[84:87], v[136:139]
    v_mfma_f32_16x16x32_bf16 v[140:143], v[104:107], a[84:87], v[140:143]
    v_mfma_f32_16x16x32_bf16 v[144:147], v[100:103], a[108:111], v[144:147]
    v_mfma_f32_16x16x32_bf16 v[148:151], v[104:107], a[108:111], v[148:151]
    v_mfma_f32_16x16x32_bf16 v[152:155], v[100:103], a[132:135], v[152:155]
    v_mfma_f32_16x16x32_bf16 v[156:159], v[104:107], a[132:135], v[156:159]
    v_mfma_f32_16x16x32_bf16 v[160:163], v[100:103], a[156:159], v[160:163]
    v_mfma_f32_16x16x32_bf16 v[164:167], v[104:107], a[156:159], v[164:167]
    v_mfma_f32_16x16x32_bf16 v[168:171], v[100:103], a[180:183], v[168:171]
    v_mfma_f32_16x16x32_bf16 v[172:175], v[104:107], a[180:183], v[172:175]
    v_mfma_f32_16x16x32_bf16 v[176:179], v[100:103], a[204:207], v[176:179]
    v_mfma_f32_16x16x32_bf16 v[180:183], v[104:107], a[204:207], v[180:183]
    v_mfma_f32_16x16x32_bf16 v[184:187], v[100:103], a[228:231], v[184:187]
    v_mfma_f32_16x16x32_bf16 v[188:191], v[104:107], a[228:231], v[188:191]
    v_mfma_f32_16x16x32_bf16 v[112:115], v[72:75], a[16:19], v[112:115]
    v_mfma_f32_16x16x32_bf16 v[116:119], v[84:87], a[16:19], v[116:119]
    v_mfma_f32_16x16x32_bf16 v[120:123], v[72:75], a[40:43], v[120:123]
    v_mfma_f32_16x16x32_bf16 v[124:127], v[84:87], a[40:43], v[124:127]
    v_mfma_f32_16x16x32_bf16 v[128:131], v[72:75], a[64:67], v[128:131]
    v_mfma_f32_16x16x32_bf16 v[132:135], v[84:87], a[64:67], v[132:135]
    v_mfma_f32_16x16x32_bf16 v[136:139], v[72:75], a[88:91], v[136:139]
    v_mfma_f32_16x16x32_bf16 v[140:143], v[84:87], a[88:91], v[140:143]
    v_mfma_f32_16x16x32_bf16 v[144:147], v[72:75], a[112:115], v[144:147]
    v_mfma_f32_16x16x32_bf16 v[148:151], v[84:87], a[112:115], v[148:151]
    v_mfma_f32_16x16x32_bf16 v[152:155], v[72:75], a[136:139], v[152:155]
    v_mfma_f32_16x16x32_bf16 v[156:159], v[84:87], a[136:139], v[156:159]
    v_mfma_f32_16x16x32_bf16 v[160:163], v[72:75], a[160:163], v[160:163]
    v_mfma_f32_16x16x32_bf16 v[164:167], v[84:87], a[160:163], v[164:167]
    v_mfma_f32_16x16x32_bf16 v[168:171], v[72:75], a[184:187], v[168:171]
    v_mfma_f32_16x16x32_bf16 v[172:175], v[84:87], a[184:187], v[172:175]
    v_mfma_f32_16x16x32_bf16 v[176:179], v[72:75], a[208:211], v[176:179]
    v_mfma_f32_16x16x32_bf16 v[180:183], v[84:87], a[208:211], v[180:183]
    v_mfma_f32_16x16x32_bf16 v[184:187], v[72:75], a[232:235], v[184:187]
    v_mfma_f32_16x16x32_bf16 v[188:191], v[84:87], a[232:235], v[188:191]
    buffer_load_dword v233, v10, s[8:11], 0 offen sc1
    v_mfma_f32_16x16x32_bf16 v[112:115], v[96:99], a[20:23], v[112:115]
    v_mfma_f32_16x16x32_bf16 v[116:119], v[108:111], a[20:23], v[116:119]
    v_mfma_f32_16x16x32_bf16 v[120:123], v[96:99], a[44:47], v[120:123]
    v_mfma_f32_16x16x32_bf16 v[124:127], v[108:111], a[44:47], v[124:127]
    v_mfma_f32_16x16x32_bf16 v[128:131], v[96:99], a[68:71], v[128:131]
    v_mfma_f32_16x16x32_bf16 v[132:135], v[108:111], a[68:71], v[132:135]
    v_mfma_f32_16x16x32_bf16 v[136:139], v[96:99], a[92:95], v[136:139]
    v_mfma_f32_16x16x32_bf16 v[140:143], v[108:111], a[92:95], v[140:143]
    v_mfma_f32_16x16x32_bf16 v[144:147], v[96:99], a[116:119], v[144:147]
    v_mfma_f32_16x16x32_bf16 v[148:151], v[108:111], a[116:119], v[148:151]
    v_mfma_f32_16x16x32_bf16 v[152:155], v[96:99], a[140:143], v[152:155]
    v_mfma_f32_16x16x32_bf16 v[156:159], v[108:111], a[140:143], v[156:159]
    v_mfma_f32_16x16x32_bf16 v[160:163], v[96:99], a[164:167], v[160:163]
    v_mfma_f32_16x16x32_bf16 v[164:167], v[108:111], a[164:167], v[164:167]
    v_mfma_f32_16x16x32_bf16 v[168:171], v[96:99], a[188:191], v[168:171]
    v_mfma_f32_16x16x32_bf16 v[172:175], v[108:111], a[188:191], v[172:175]
    v_mfma_f32_16x16x32_bf16 v[176:179], v[96:99], a[212:215], v[176:179]
    v_mfma_f32_16x16x32_bf16 v[180:183], v[108:111], a[212:215], v[180:183]
    v_mfma_f32_16x16x32_bf16 v[184:187], v[96:99], a[236:239], v[184:187]
    v_mfma_f32_16x16x32_bf16 v[188:191], v[108:111], a[236:239], v[188:191]
    s_mov_b32 s46, s43
    v_cvt_pk_bf16_f32 v192, v112, v113
    v_cvt_pk_bf16_f32 v193, v114, v115
    v_cvt_pk_bf16_f32 v194, v116, v117
    v_cvt_pk_bf16_f32 v195, v118, v119
    buffer_store_dwordx4 v[192:195], v9, s[8:11], s46 offen sc1
    s_add_u32 s46, s46, 32768
    v_cvt_pk_bf16_f32 v196, v120, v121
    v_cvt_pk_bf16_f32 v197, v122, v123
    v_cvt_pk_bf16_f32 v198, v124, v125
    v_cvt_pk_bf16_f32 v199, v126, v127
    buffer_store_dwordx4 v[196:199], v9, s[8:11], s46 offen sc1
    s_add_u32 s46, s46, 32768
    v_cvt_pk_bf16_f32 v200, v128, v129
    v_cvt_pk_bf16_f32 v201, v130, v131
    v_cvt_pk_bf16_f32 v202, v132, v133
    v_cvt_pk_bf16_f32 v203, v134, v135
    buffer_store_dwordx4 v[200:203], v9, s[8:11], s46 offen sc1
    s_add_u32 s46, s46, 32768
    v_cvt_pk_bf16_f32 v204, v136, v137
    v_cvt_pk_bf16_f32 v205, v138, v139
    v_cvt_pk_bf16_f32 v206, v140, v141
    v_cvt_pk_bf16_f32 v207, v142, v143
    buffer_store_dwordx4 v[204:207], v9, s[8:11], s46 offen sc1
    s_add_u32 s46, s46, 32768
    v_cvt_pk_bf16_f32 v208, v144, v145
    v_cvt_pk_bf16_f32 v209, v146, v147
    v_cvt_pk_bf16_f32 v210, v148, v149
    v_cvt_pk_bf16_f32 v211, v150, v151
    buffer_store_dwordx4 v[208:211], v9, s[8:11], s46 offen sc1
    s_add_u32 s46, s46, 32768
    v_cvt_pk_bf16_f32 v212, v152, v153
    v_cvt_pk_bf16_f32 v213, v154, v155
    v_cvt_pk_bf16_f32 v214, v156, v157
    v_cvt_pk_bf16_f32 v215, v158, v159
    buffer_store_dwordx4 v[212:215], v9, s[8:11], s46 offen sc1
    s_add_u32 s46, s46, 32768
    v_cvt_pk_bf16_f32 v216, v160, v161
    v_cvt_pk_bf16_f32 v217, v162, v163
    v_cvt_pk_bf16_f32 v218, v164, v165
    v_cvt_pk_bf16_f32 v219, v166, v167
    buffer_store_dwordx4 v[216:219], v9, s[8:11], s46 offen sc1
    s_add_u32 s46, s46, 32768
    v_cvt_pk_bf16_f32 v220, v168, v169
    v_cvt_pk_bf16_f32 v221, v170, v171
    v_cvt_pk_bf16_f32 v222, v172, v173
    v_cvt_pk_bf16_f32 v223, v174, v175
    buffer_store_dwordx4 v[220:223], v9, s[8:11], s46 offen sc1
    s_add_u32 s46, s46, 32768
    v_cvt_pk_bf16_f32 v224, v176, v177
    v_cvt_pk_bf16_f32 v225, v178, v179
    v_cvt_pk_bf16_f32 v226, v180, v181
    v_cvt_pk_bf16_f32 v227, v182, v183
    buffer_store_dwordx4 v[224:227], v9, s[8:11], s46 offen sc1
    s_add_u32 s46, s46, 32768
    v_cvt_pk_bf16_f32 v228, v184, v185
    v_cvt_pk_bf16_f32 v229, v186, v187
    v_cvt_pk_bf16_f32 v230, v188, v189
    v_cvt_pk_bf16_f32 v231, v190, v191
    buffer_store_dwordx4 v[228:231], v9, s[8:11], s46 offen sc1
    s_cmp_eq_u32 s58, 1
    s_cbranch_scc1 interleave_layers__linear_attn_block__memory_aug_recurrent_mem_tr__prompt_kernel_of51
    s_waitcnt vmcnt(10)
    v_readfirstlane_b32 s24, v233
    s_max_i32 s62, s62, s24
    s_add_u32 s63, s40, 2
    s_min_u32 s63, s63, 64
    s_cmp_ge_i32 s62, s63
    s_cbranch_scc0 interleave_layers__linear_attn_block__memory_aug_recurrent_mem_tr__prompt_kernel_oo52
    buffer_load_dwordx4 v[16:19], v6, s[8:11], s41 offen offset:0 sc1
    buffer_load_dwordx4 v[20:23], v6, s[8:11], s41 offen offset:1024 sc1
    buffer_load_dwordx4 v[24:27], v6, s[8:11], s41 offen offset:2048 sc1
    buffer_load_dwordx4 v[28:31], v6, s[8:11], s41 offen offset:3072 sc1
    buffer_load_dwordx4 v[32:35], v7, s[8:11], s41 offen offset:0 sc1
    buffer_load_dwordx4 v[36:39], v7, s[8:11], s41 offen offset:1024 sc1
    buffer_load_dwordx4 v[40:43], v7, s[8:11], s41 offen offset:2048 sc1
    buffer_load_dwordx4 v[44:47], v7, s[8:11], s41 offen offset:3072 sc1
    buffer_load_dwordx4 v[48:51], v8, s[8:11], s41 offen offset:0 sc1
    buffer_load_dwordx4 v[52:55], v8, s[8:11], s41 offen offset:1024 sc1
    buffer_load_dwordx4 v[56:59], v8, s[8:11], s41 offen offset:2048 sc1
    buffer_load_dwordx4 v[60:63], v8, s[8:11], s41 offen offset:3072 sc1
    s_add_u32 s41, s41, 393216
    s_waitcnt vmcnt(12)
    s_barrier
    s_add_u32 s24, s40, 1
    s_cmp_eq_u32 s3, 0
    s_cbranch_scc0 interleave_layers__linear_attn_block__memory_aug_recurrent_mem_tr__prompt_kernel_fp53
    v_mov_b32 v15, s24
    buffer_store_dword v15, v14, s[8:11], 0 offen sc1
interleave_layers__linear_attn_block__memory_aug_recurrent_mem_tr__prompt_kernel_fp53:
    s_waitcnt vmcnt(0)
    s_branch interleave_layers__linear_attn_block__memory_aug_recurrent_mem_tr__prompt_kernel_of51
interleave_layers__linear_attn_block__memory_aug_recurrent_mem_tr__prompt_kernel_oo52:
    s_waitcnt vmcnt(0)
    s_barrier
    s_add_u32 s24, s40, 1
    s_cmp_eq_u32 s3, 0
    s_cbranch_scc0 interleave_layers__linear_attn_block__memory_aug_recurrent_mem_tr__prompt_kernel_fp54
    v_mov_b32 v15, s24
    buffer_store_dword v15, v14, s[8:11], 0 offen sc1
interleave_layers__linear_attn_block__memory_aug_recurrent_mem_tr__prompt_kernel_fp54:
    s_add_u32 s63, s40, 2
    s_min_u32 s63, s63, 64
    s_cmp_ge_i32 s62, s63
    s_cbranch_scc1 interleave_layers__linear_attn_block__memory_aug_recurrent_mem_tr__prompt_kernel_o_en4_ok
    s_mov_b32 s61, 0
interleave_layers__linear_attn_block__memory_aug_recurrent_mem_tr__prompt_kernel_o_en4:
    buffer_load_dword v11, v10, s[8:11], 0 offen sc1
    s_waitcnt vmcnt(0)
    v_readlane_b32 s62, v11, 0
    s_cmp_ge_i32 s62, s63
    s_cbranch_scc1 interleave_layers__linear_attn_block__memory_aug_recurrent_mem_tr__prompt_kernel_o_en4_ok
    s_add_u32 s61, s61, 1
    s_cmp_ge_u32 s61, s60
    s_cbranch_scc1 interleave_layers__linear_attn_block__memory_aug_recurrent_mem_tr__prompt_kernel_o_en4_to
    s_sleep 2
    s_branch interleave_layers__linear_attn_block__memory_aug_recurrent_mem_tr__prompt_kernel_o_en4
interleave_layers__linear_attn_block__memory_aug_recurrent_mem_tr__prompt_kernel_o_en4_to:
    s_mov_b32 s60, 1
interleave_layers__linear_attn_block__memory_aug_recurrent_mem_tr__prompt_kernel_o_en4_ok:
    buffer_load_dwordx4 v[16:19], v6, s[8:11], s41 offen offset:0 sc1
    buffer_load_dwordx4 v[20:23], v6, s[8:11], s41 offen offset:1024 sc1
    buffer_load_dwordx4 v[24:27], v6, s[8:11], s41 offen offset:2048 sc1
    buffer_load_dwordx4 v[28:31], v6, s[8:11], s41 offen offset:3072 sc1
    buffer_load_dwordx4 v[32:35], v7, s[8:11], s41 offen offset:0 sc1
    buffer_load_dwordx4 v[36:39], v7, s[8:11], s41 offen offset:1024 sc1
    buffer_load_dwordx4 v[40:43], v7, s[8:11], s41 offen offset:2048 sc1
    buffer_load_dwordx4 v[44:47], v7, s[8:11], s41 offen offset:3072 sc1
    buffer_load_dwordx4 v[48:51], v8, s[8:11], s41 offen offset:0 sc1
    buffer_load_dwordx4 v[52:55], v8, s[8:11], s41 offen offset:1024 sc1
    buffer_load_dwordx4 v[56:59], v8, s[8:11], s41 offen offset:2048 sc1
    buffer_load_dwordx4 v[60:63], v8, s[8:11], s41 offen offset:3072 sc1
    s_add_u32 s41, s41, 393216
    s_waitcnt vmcnt(0)
interleave_layers__linear_attn_block__memory_aug_recurrent_mem_tr__prompt_kernel_of51:
    s_waitcnt vmcnt(10)
    s_add_u32 s40, s40, 1
    s_add_u32 s43, s43, 1310720
    s_cmp_lt_u32 s40, 64
    s_cbranch_scc1 interleave_layers__linear_attn_block__memory_aug_recurrent_mem_tr__prompt_kernel_o_seg
    s_waitcnt vmcnt(0)
    s_barrier
    s_cmp_eq_u32 s3, 0
    s_cbranch_scc0 interleave_layers__linear_attn_block__memory_aug_recurrent_mem_tr__prompt_kernel_fp55
    v_mov_b32 v15, s40
    buffer_store_dword v15, v14, s[8:11], 0 offen sc1
interleave_layers__linear_attn_block__memory_aug_recurrent_mem_tr__prompt_kernel_fp55:
    s_cmp_eq_u32 s92, 0
    s_cbranch_scc0 interleave_layers__linear_attn_block__memory_aug_recurrent_mem_tr__prompt_kernel_end
    s_mov_b32 s92, 1
    s_branch interleave_layers__linear_attn_block__memory_aug_recurrent_mem_tr__prompt_kernel_o_layer
interleave_layers__linear_attn_block__memory_aug_recurrent_mem_tr__prompt_kernel_end:
    s_endpgm
.section .rodata,"a"
.p2align 6
.amdhsa_kernel interleave_layers__linear_attn_block__memory_aug_recurrent_mem_tr__prompt_kernel
  .amdhsa_next_free_vgpr 512
  .amdhsa_next_free_sgpr 100
  .amdhsa_accum_offset 256
  .amdhsa_group_segment_fixed_size 0
  .amdhsa_kernarg_size 104
  .amdhsa_user_sgpr_count 2
  .amdhsa_user_sgpr_kernarg_segment_ptr 1
  .amdhsa_system_sgpr_workgroup_id_x 1
.end_amdhsa_kernel
```

```asm
; @launch kernel=interleave_layers__linear_attn_block__memory_aug_recurrent_mem_tr__prompt_kernel grid=(256,1,1) block=(256,1,1) lds=135168
.amdgcn_target "amdgcn-amd-amdhsa--gfx950"
.text
.globl interleave_layers__linear_attn_block__memory_aug_recurrent_mem_tr__prompt_kernel
.p2align 8
.type interleave_layers__linear_attn_block__memory_aug_recurrent_mem_tr__prompt_kernel,@function
interleave_layers__linear_attn_block__memory_aug_recurrent_mem_tr__prompt_kernel:
    s_cmp_ge_u32 s2, 256
    s_cbranch_scc1 interleave_layers__linear_attn_block__memory_aug_recurrent_mem_tr__prompt_kernel_end
    s_load_dwordx2 s[4:5], s[0:1], 96
    s_load_dwordx2 s[6:7], s[0:1], 88
    s_load_dwordx2 s[24:25], s[0:1], 0
    s_load_dwordx2 s[98:99], s[0:1], 8
    s_and_b32 s44, s2, 7
    s_lshr_b32 s45, s2, 3
    s_and_b32 s26, s44, 3
    s_lshl_b32 s27, s45, 2
    s_add_u32 s26, s26, s27
    s_add_u32 s27, s26, 128
    s_cmp_lt_u32 s26, 104
    s_cselect_b32 s27, s26, s27
    s_add_u32 s26, s26, 104
    s_cmp_lt_u32 s44, 4
    s_cselect_b32 s2, s27, s26
    v_and_b32 v1, 63, v0
    v_lshrrev_b32 v4, 6, v0
    v_and_b32 v2, 15, v1
    v_lshrrev_b32 v3, 4, v1
    v_readfirstlane_b32 s3, v4
    s_mov_b32 s60, 131072
    s_mov_b32 s59, -1
    s_mov_b32 s92, 0
    s_mov_b32 s36, 0
    s_waitcnt lgkmcnt(0)
    s_mov_b32 s8, s4
    s_mov_b32 s9, s5
    s_mov_b32 s10, 268435456
    s_mov_b32 s11, 0x00020000
    s_mov_b32 s72, s6
    s_mov_b32 s73, s7
    s_mov_b32 s74, 256
    s_mov_b32 s75, 0x00020000
    s_mov_b32 s16, s24
    s_mov_b32 s17, s25
    s_mov_b32 s18, 2621440
    s_mov_b32 s19, 0x00020000
    s_cmp_eq_u32 s2, 255
    s_cbranch_scc0 interleave_layers__linear_attn_block__memory_aug_recurrent_mem_tr__prompt_kernel_cf1
    v_lshlrev_b32 v5, 4, v0
    v_mov_b32 v8, -1
    v_mov_b32 v9, -1
    v_mov_b32 v10, -1
    v_mov_b32 v11, -1
    s_mov_b32 s24, 23068672
    buffer_store_dwordx4 v[8:11], v5, s[8:11], s24 offen sc1
    s_add_u32 s24, s24, 4096
    buffer_store_dwordx4 v[8:11], v5, s[8:11], s24 offen sc1
    s_add_u32 s24, s24, 4096
    buffer_store_dwordx4 v[8:11], v5, s[8:11], s24 offen sc1
    s_add_u32 s24, s24, 4096
    buffer_store_dwordx4 v[8:11], v5, s[8:11], s24 offen sc1
    s_add_u32 s24, s24, 4096
    buffer_store_dwordx4 v[8:11], v5, s[8:11], s24 offen sc1
    s_add_u32 s24, s24, 4096
    buffer_store_dwordx4 v[8:11], v5, s[8:11], s24 offen sc1
    s_add_u32 s24, s24, 4096
    buffer_store_dwordx4 v[8:11], v5, s[8:11], s24 offen sc1
    s_add_u32 s24, s24, 4096
    buffer_store_dwordx4 v[8:11], v5, s[8:11], s24 offen sc1
    s_add_u32 s24, s24, 4096
    buffer_store_dwordx4 v[8:11], v5, s[8:11], s24 offen sc1
    s_add_u32 s24, s24, 4096
    buffer_store_dwordx4 v[8:11], v5, s[8:11], s24 offen sc1
    s_add_u32 s24, s24, 4096
    buffer_store_dwordx4 v[8:11], v5, s[8:11], s24 offen sc1
    s_add_u32 s24, s24, 4096
    buffer_store_dwordx4 v[8:11], v5, s[8:11], s24 offen sc1
    s_add_u32 s24, s24, 4096
    buffer_store_dwordx4 v[8:11], v5, s[8:11], s24 offen sc1
    s_add_u32 s24, s24, 4096
    buffer_store_dwordx4 v[8:11], v5, s[8:11], s24 offen sc1
    s_add_u32 s24, s24, 4096
    buffer_store_dwordx4 v[8:11], v5, s[8:11], s24 offen sc1
    s_add_u32 s24, s24, 4096
    buffer_store_dwordx4 v[8:11], v5, s[8:11], s24 offen sc1
    s_add_u32 s24, s24, 4096
interleave_layers__linear_attn_block__memory_aug_recurrent_mem_tr__prompt_kernel_cf1:
    s_mov_b32 s46, 64
    s_mov_b32 s47, 32
    s_mov_b32 s50, 0
    s_lshl_b32 s48, s45, 1
    s_mov_b32 s49, 1
    s_mov_b32 s40, 2
interleave_layers__linear_attn_block__memory_aug_recurrent_mem_tr__prompt_kernel_k1_entry:
    v_and_b32 v7, 31, v0
    v_lshrrev_b32 v8, 5, v0
    v_mul_u32_u24 v152, 3840, v8
    v_lshlrev_b32 v9, 4, v7
    v_add_u32 v152, v152, v9
    v_cmp_le_u32 vcc, 10, v7
    s_nop 1
    v_cndmask_b32 v10, 0, 1, vcc
    v_cmp_le_u32 vcc, 20, v7
    s_nop 1
    v_cndmask_b32 v11, 0, 1, vcc
    v_add_u32 v10, v10, v11
    v_mul_u32_u24 v10, 1120, v10
    v_add_u32 v152, v152, v10
    v_mov_b32 v10, 2146435072
    v_cmp_le_u32 vcc, 30, v7
    s_nop 1
    v_cndmask_b32 v152, v152, v10, vcc
    v_mul_u32_u24 v153, 544, v8
    v_add_u32 v153, v153, v9
    v_add_u32 v153, 40960, v153
    s_mov_b32 s12, s98
    s_mov_b32 s13, s99
    s_mov_b32 s14, 2457600
    s_mov_b32 s15, 0x00020000
    s_mul_i32 s52, s44, 160
    v_lshrrev_b32 v10, 2, v0
    v_mul_u32_u24 v10, 3840, v10
    v_and_b32 v11, 3, v0
    v_lshlrev_b32 v11, 6, v11
    v_min_u32 v11, 156, v11
    v_add_u32 v10, v10, v11
    s_mul_i32 s24, s45, 205
    s_lshr_b32 s24, s24, 11
    s_mul_i32 s24, s24, 10
    s_sub_u32 s24, s45, s24
    s_mul_i32 s24, s24, 245760
    s_add_u32 s24, s24, s52
    buffer_load_dword a254, v10, s[12:15], s24 offen
    s_add_u32 s24, s24, 1280
    buffer_load_dword a254, v10, s[12:15], s24 offen
    s_add_u32 s24, s24, 1280
    buffer_load_dword a254, v10, s[12:15], s24 offen
    s_add_u32 s24, s52, 0
    buffer_load_dwordx4 v[56:59], v152, s[12:15], s24 offen
    s_add_u32 s24, s24, 30720
    buffer_load_dwordx4 v[60:63], v152, s[12:15], s24 offen
    s_add_u32 s24, s24, 30720
    buffer_load_dwordx4 v[64:67], v152, s[12:15], s24 offen
    s_add_u32 s24, s24, 30720
    buffer_load_dwordx4 v[68:71], v152, s[12:15], s24 offen
    s_add_u32 s24, s24, 30720
    buffer_load_dwordx4 v[72:75], v152, s[12:15], s24 offen
    s_add_u32 s24, s24, 30720
    buffer_load_dwordx4 v[76:79], v152, s[12:15], s24 offen
    s_add_u32 s24, s24, 30720
    buffer_load_dwordx4 v[80:83], v152, s[12:15], s24 offen
    s_add_u32 s24, s24, 30720
    buffer_load_dwordx4 v[84:87], v152, s[12:15], s24 offen
    s_add_u32 s24, s52, 245760
    buffer_load_dwordx4 v[88:91], v152, s[12:15], s24 offen
    s_add_u32 s24, s24, 30720
    buffer_load_dwordx4 v[92:95], v152, s[12:15], s24 offen
    s_add_u32 s24, s24, 30720
    buffer_load_dwordx4 v[96:99], v152, s[12:15], s24 offen
    s_add_u32 s24, s24, 30720
    buffer_load_dwordx4 v[100:103], v152, s[12:15], s24 offen
    s_add_u32 s24, s24, 30720
    buffer_load_dwordx4 v[104:107], v152, s[12:15], s24 offen
    s_add_u32 s24, s24, 30720
    buffer_load_dwordx4 v[108:111], v152, s[12:15], s24 offen
    s_add_u32 s24, s24, 30720
    buffer_load_dwordx4 v[112:115], v152, s[12:15], s24 offen
    s_add_u32 s24, s24, 30720
    buffer_load_dwordx4 v[116:119], v152, s[12:15], s24 offen
    s_add_u32 s24, s52, 491520
    buffer_load_dwordx4 v[120:123], v152, s[12:15], s24 offen
    s_add_u32 s24, s24, 30720
    buffer_load_dwordx4 v[124:127], v152, s[12:15], s24 offen
    s_add_u32 s24, s24, 30720
    buffer_load_dwordx4 v[128:131], v152, s[12:15], s24 offen
    s_add_u32 s24, s24, 30720
    buffer_load_dwordx4 v[132:135], v152, s[12:15], s24 offen
    s_add_u32 s24, s24, 30720
    buffer_load_dwordx4 v[136:139], v152, s[12:15], s24 offen
    s_add_u32 s24, s24, 30720
    buffer_load_dwordx4 v[140:143], v152, s[12:15], s24 offen
    s_add_u32 s24, s24, 30720
    buffer_load_dwordx4 v[144:147], v152, s[12:15], s24 offen
    s_add_u32 s24, s24, 30720
    buffer_load_dwordx4 v[148:151], v152, s[12:15], s24 offen
    s_lshr_b32 s24, s3, 1
    s_mul_i32 s24, s24, 20480
    s_and_b32 s25, s3, 1
    s_mul_i32 s25, s25, 10
    s_mul_i32 s25, s25, s46
    s_add_u32 s24, s24, s25
    s_cmp_eq_u32 s50, 1
    s_cselect_b32 s25, 16, 1280
    s_cselect_b32 s26, 256, 8
    v_mul_u32_u24 v4, s25, v2
    v_mul_u32_u24 v5, s26, v3
    v_add3_u32 v4, v4, v5, s24
    v_add_u32 v5, s47, v4
    s_mul_i32 s43, s48, 40960
    s_mul_i32 s42, s49, 40960
    s_cmp_eq_u32 s92, 0
    s_cselect_b32 s51, 1, 0
    s_cselect_b32 s41, s43, 2146435072
    s_mov_b32 s24, s41
    buffer_load_dwordx2 v[16:17], v4, s[16:19], s24 offen
    buffer_load_dwordx2 v[18:19], v5, s[16:19], s24 offen
    s_add_u32 s24, s24, s46
    buffer_load_dwordx2 v[20:21], v4, s[16:19], s24 offen
    buffer_load_dwordx2 v[22:23], v5, s[16:19], s24 offen
    s_add_u32 s24, s24, s46
    buffer_load_dwordx2 v[24:25], v4, s[16:19], s24 offen
    buffer_load_dwordx2 v[26:27], v5, s[16:19], s24 offen
    s_add_u32 s24, s24, s46
    buffer_load_dwordx2 v[28:29], v4, s[16:19], s24 offen
    buffer_load_dwordx2 v[30:31], v5, s[16:19], s24 offen
    s_add_u32 s24, s24, s46
    buffer_load_dwordx2 v[32:33], v4, s[16:19], s24 offen
    buffer_load_dwordx2 v[34:35], v5, s[16:19], s24 offen
    s_add_u32 s24, s24, s46
    buffer_load_dwordx2 v[36:37], v4, s[16:19], s24 offen
    buffer_load_dwordx2 v[38:39], v5, s[16:19], s24 offen
    s_add_u32 s24, s24, s46
    buffer_load_dwordx2 v[40:41], v4, s[16:19], s24 offen
    buffer_load_dwordx2 v[42:43], v5, s[16:19], s24 offen
    s_add_u32 s24, s24, s46
    buffer_load_dwordx2 v[44:45], v4, s[16:19], s24 offen
    buffer_load_dwordx2 v[46:47], v5, s[16:19], s24 offen
    s_add_u32 s24, s24, s46
    buffer_load_dwordx2 v[48:49], v4, s[16:19], s24 offen
    buffer_load_dwordx2 v[50:51], v5, s[16:19], s24 offen
    s_add_u32 s24, s24, s46
    buffer_load_dwordx2 v[52:53], v4, s[16:19], s24 offen
    buffer_load_dwordx2 v[54:55], v5, s[16:19], s24 offen
    v_lshrrev_b32 v6, 2, v2
    v_lshl_add_u32 v6, v3, 2, v6
    v_mul_u32_u24 v6, 544, v6
    v_and_b32 v7, 3, v2
    v_lshl_add_u32 v6, v7, 3, v6
    v_add_u32 v6, 40960, v6
    s_mov_b32 s24, 0
    s_cmp_eq_u32 s3, 1
    s_cselect_b32 s24, 64, s24
    s_cmp_eq_u32 s3, 2
    s_cselect_b32 s24, 128, s24
    s_cmp_eq_u32 s3, 3
    s_cselect_b32 s24, 224, s24
    v_add_u32 v12, s24, v6
    s_mov_b32 s24, 32
    s_cmp_eq_u32 s3, 1
    s_cselect_b32 s24, 96, s24
    s_cmp_eq_u32 s3, 2
    s_cselect_b32 s24, 160, s24
    s_cmp_eq_u32 s3, 3
    s_cselect_b32 s24, 256, s24
    v_add_u32 v13, s24, v6
    s_mov_b32 s24, 320
    s_cmp_eq_u32 s3, 1
    s_cselect_b32 s24, 384, s24
    s_cmp_eq_u32 s3, 2
    s_cselect_b32 s24, 192, s24
    s_cmp_eq_u32 s3, 3
    s_cselect_b32 s24, 288, s24
    v_add_u32 v14, s24, v6
    s_mov_b32 s24, 352
    s_cmp_eq_u32 s3, 1
    s_cselect_b32 s24, 416, s24
    s_cmp_eq_u32 s3, 2
    s_cselect_b32 s24, 448, s24
    s_cmp_eq_u32 s3, 3
    s_cselect_b32 s24, 288, s24
    v_add_u32 v15, s24, v6
    v_mov_b32 v172, 0x3f803f80
    v_mov_b32 v173, 0x3f803f80
    v_mov_b32 v174, 0x3f803f80
    v_mov_b32 v175, 0x3f803f80
    s_waitcnt vmcnt(36)
    ds_write_b128 v153, v[56:59] offset:0
    ds_write_b128 v153, v[60:63] offset:4352
    ds_write_b128 v153, v[64:67] offset:8704
    ds_write_b128 v153, v[68:71] offset:13056
    ds_write_b128 v153, v[72:75] offset:17408
    ds_write_b128 v153, v[76:79] offset:21760
    ds_write_b128 v153, v[80:83] offset:26112
    ds_write_b128 v153, v[84:87] offset:30464
    s_waitcnt lgkmcnt(0)
    s_add_u32 s24, s52, 737280
    buffer_load_dwordx4 v[56:59], v152, s[12:15], s24 offen
    s_add_u32 s24, s24, 30720
    buffer_load_dwordx4 v[60:63], v152, s[12:15], s24 offen
    s_add_u32 s24, s24, 30720
    buffer_load_dwordx4 v[64:67], v152, s[12:15], s24 offen
    s_add_u32 s24, s24, 30720
    buffer_load_dwordx4 v[68:71], v152, s[12:15], s24 offen
    s_add_u32 s24, s24, 30720
    buffer_load_dwordx4 v[72:75], v152, s[12:15], s24 offen
    s_add_u32 s24, s24, 30720
    buffer_load_dwordx4 v[76:79], v152, s[12:15], s24 offen
    s_add_u32 s24, s24, 30720
    buffer_load_dwordx4 v[80:83], v152, s[12:15], s24 offen
    s_add_u32 s24, s24, 30720
    buffer_load_dwordx4 v[84:87], v152, s[12:15], s24 offen
    s_barrier
    ds_read_b64_tr_b16 a[0:1], v12 offset:0
    ds_read_b64_tr_b16 a[2:3], v12 offset:8704
    ds_read_b64_tr_b16 a[4:5], v12 offset:17408
    ds_read_b64_tr_b16 a[6:7], v12 offset:26112
    ds_read_b64_tr_b16 a[80:81], v13 offset:0
    ds_read_b64_tr_b16 a[82:83], v13 offset:8704
    ds_read_b64_tr_b16 a[84:85], v13 offset:17408
    ds_read_b64_tr_b16 a[86:87], v13 offset:26112
    ds_read_b64_tr_b16 a[160:161], v14 offset:0
    ds_read_b64_tr_b16 a[162:163], v14 offset:8704
    ds_read_b64_tr_b16 a[164:165], v14 offset:17408
    ds_read_b64_tr_b16 a[166:167], v14 offset:26112
    ds_read_b64_tr_b16 v[176:177], v15 offset:0
    ds_read_b64_tr_b16 v[178:179], v15 offset:8704
    ds_read_b64_tr_b16 v[180:181], v15 offset:17408
    ds_read_b64_tr_b16 v[182:183], v15 offset:26112
    s_waitcnt vmcnt(36)
    ds_write_b128 v153, v[88:91] offset:34816
    ds_write_b128 v153, v[92:95] offset:39168
    ds_write_b128 v153, v[96:99] offset:43520
    ds_write_b128 v153, v[100:103] offset:47872
    ds_write_b128 v153, v[104:107] offset:52224
    ds_write_b128 v153, v[108:111] offset:56576
    ds_write_b128 v153, v[112:115] offset:60928
    ds_write_b128 v153, v[116:119] offset:65280
    s_waitcnt lgkmcnt(0)
    s_add_u32 s24, s52, 983040
    buffer_load_dwordx4 v[88:91], v152, s[12:15], s24 offen
    s_add_u32 s24, s24, 30720
    buffer_load_dwordx4 v[92:95], v152, s[12:15], s24 offen
    s_add_u32 s24, s24, 30720
    buffer_load_dwordx4 v[96:99], v152, s[12:15], s24 offen
    s_add_u32 s24, s24, 30720
    buffer_load_dwordx4 v[100:103], v152, s[12:15], s24 offen
    s_add_u32 s24, s24, 30720
    buffer_load_dwordx4 v[104:107], v152, s[12:15], s24 offen
    s_add_u32 s24, s24, 30720
    buffer_load_dwordx4 v[108:111], v152, s[12:15], s24 offen
    s_add_u32 s24, s24, 30720
    buffer_load_dwordx4 v[112:115], v152, s[12:15], s24 offen
    s_add_u32 s24, s24, 30720
    buffer_load_dwordx4 v[116:119], v152, s[12:15], s24 offen
    v_mfma_f32_16x16x32_bf16 v[156:159], a[0:3], v[172:175], 0
    v_mfma_f32_16x16x32_bf16 v[160:163], a[80:83], v[172:175], 0
    v_mfma_f32_16x16x32_bf16 v[164:167], a[160:163], v[172:175], 0
    v_mfma_f32_16x16x32_bf16 v[168:171], v[176:179], v[172:175], 0
    v_mfma_f32_16x16x32_bf16 v[156:159], a[4:7], v[172:175], v[156:159]
    v_mfma_f32_16x16x32_bf16 v[160:163], a[84:87], v[172:175], v[160:163]
    v_mfma_f32_16x16x32_bf16 v[164:167], a[164:167], v[172:175], v[164:167]
    v_mfma_f32_16x16x32_bf16 v[168:171], v[180:183], v[172:175], v[168:171]
    s_barrier
    ds_read_b64_tr_b16 a[8:9], v12 offset:34816
    ds_read_b64_tr_b16 a[10:11], v12 offset:43520
    ds_read_b64_tr_b16 a[12:13], v12 offset:52224
    ds_read_b64_tr_b16 a[14:15], v12 offset:60928
    ds_read_b64_tr_b16 a[88:89], v13 offset:34816
    ds_read_b64_tr_b16 a[90:91], v13 offset:43520
    ds_read_b64_tr_b16 a[92:93], v13 offset:52224
    ds_read_b64_tr_b16 a[94:95], v13 offset:60928
    ds_read_b64_tr_b16 a[168:169], v14 offset:34816
    ds_read_b64_tr_b16 a[170:171], v14 offset:43520
    ds_read_b64_tr_b16 a[172:173], v14 offset:52224
    ds_read_b64_tr_b16 a[174:175], v14 offset:60928
    ds_read_b64_tr_b16 v[184:185], v15 offset:34816
    ds_read_b64_tr_b16 v[186:187], v15 offset:43520
    ds_read_b64_tr_b16 v[188:189], v15 offset:52224
    ds_read_b64_tr_b16 v[190:191], v15 offset:60928
    s_waitcnt vmcnt(36)
    ds_write_b128 v153, v[120:123] offset:0
    ds_write_b128 v153, v[124:127] offset:4352
    ds_write_b128 v153, v[128:131] offset:8704
    ds_write_b128 v153, v[132:135] offset:13056
    ds_write_b128 v153, v[136:139] offset:17408
    ds_write_b128 v153, v[140:143] offset:21760
    ds_write_b128 v153, v[144:147] offset:26112
    ds_write_b128 v153, v[148:151] offset:30464
    s_waitcnt lgkmcnt(0)
    s_add_u32 s24, s52, 1228800
    buffer_load_dwordx4 v[120:123], v152, s[12:15], s24 offen
    s_add_u32 s24, s24, 30720
    buffer_load_dwordx4 v[124:127], v152, s[12:15], s24 offen
    s_add_u32 s24, s24, 30720
    buffer_load_dwordx4 v[128:131], v152, s[12:15], s24 offen
    s_add_u32 s24, s24, 30720
    buffer_load_dwordx4 v[132:135], v152, s[12:15], s24 offen
    s_add_u32 s24, s24, 30720
    buffer_load_dwordx4 v[136:139], v152, s[12:15], s24 offen
    s_add_u32 s24, s24, 30720
    buffer_load_dwordx4 v[140:143], v152, s[12:15], s24 offen
    s_add_u32 s24, s24, 30720
    buffer_load_dwordx4 v[144:147], v152, s[12:15], s24 offen
    s_add_u32 s24, s24, 30720
    buffer_load_dwordx4 v[148:151], v152, s[12:15], s24 offen
    v_mfma_f32_16x16x32_bf16 v[156:159], a[8:11], v[172:175], v[156:159]
    v_mfma_f32_16x16x32_bf16 v[160:163], a[88:91], v[172:175], v[160:163]
    v_mfma_f32_16x16x32_bf16 v[164:167], a[168:171], v[172:175], v[164:167]
    v_mfma_f32_16x16x32_bf16 v[168:171], v[184:187], v[172:175], v[168:171]
    v_mfma_f32_16x16x32_bf16 v[156:159], a[12:15], v[172:175], v[156:159]
    v_mfma_f32_16x16x32_bf16 v[160:163], a[92:95], v[172:175], v[160:163]
    v_mfma_f32_16x16x32_bf16 v[164:167], a[172:175], v[172:175], v[164:167]
    v_mfma_f32_16x16x32_bf16 v[168:171], v[188:191], v[172:175], v[168:171]
    s_barrier
    ds_read_b64_tr_b16 a[16:17], v12 offset:0
    ds_read_b64_tr_b16 a[18:19], v12 offset:8704
    ds_read_b64_tr_b16 a[20:21], v12 offset:17408
    ds_read_b64_tr_b16 a[22:23], v12 offset:26112
    ds_read_b64_tr_b16 a[96:97], v13 offset:0
    ds_read_b64_tr_b16 a[98:99], v13 offset:8704
    ds_read_b64_tr_b16 a[100:101], v13 offset:17408
    ds_read_b64_tr_b16 a[102:103], v13 offset:26112
    ds_read_b64_tr_b16 a[176:177], v14 offset:0
    ds_read_b64_tr_b16 a[178:179], v14 offset:8704
    ds_read_b64_tr_b16 a[180:181], v14 offset:17408
    ds_read_b64_tr_b16 a[182:183], v14 offset:26112
    ds_read_b64_tr_b16 v[192:193], v15 offset:0
    ds_read_b64_tr_b16 v[194:195], v15 offset:8704
    ds_read_b64_tr_b16 v[196:197], v15 offset:17408
    ds_read_b64_tr_b16 v[198:199], v15 offset:26112
    s_waitcnt vmcnt(16)
    ds_write_b128 v153, v[56:59] offset:34816
    ds_write_b128 v153, v[60:63] offset:39168
    ds_write_b128 v153, v[64:67] offset:43520
    ds_write_b128 v153, v[68:71] offset:47872
    ds_write_b128 v153, v[72:75] offset:52224
    ds_write_b128 v153, v[76:79] offset:56576
    ds_write_b128 v153, v[80:83] offset:60928
    ds_write_b128 v153, v[84:87] offset:65280
    s_waitcnt lgkmcnt(0)
    s_add_u32 s24, s52, 1474560
    buffer_load_dwordx4 v[56:59], v152, s[12:15], s24 offen
    s_add_u32 s24, s24, 30720
    buffer_load_dwordx4 v[60:63], v152, s[12:15], s24 offen
    s_add_u32 s24, s24, 30720
    buffer_load_dwordx4 v[64:67], v152, s[12:15], s24 offen
    s_add_u32 s24, s24, 30720
    buffer_load_dwordx4 v[68:71], v152, s[12:15], s24 offen
    s_add_u32 s24, s24, 30720
    buffer_load_dwordx4 v[72:75], v152, s[12:15], s24 offen
    s_add_u32 s24, s24, 30720
    buffer_load_dwordx4 v[76:79], v152, s[12:15], s24 offen
    s_add_u32 s24, s24, 30720
    buffer_load_dwordx4 v[80:83], v152, s[12:15], s24 offen
    s_add_u32 s24, s24, 30720
    buffer_load_dwordx4 v[84:87], v152, s[12:15], s24 offen
    v_mfma_f32_16x16x32_bf16 v[156:159], a[16:19], v[172:175], v[156:159]
    v_mfma_f32_16x16x32_bf16 v[160:163], a[96:99], v[172:175], v[160:163]
    v_mfma_f32_16x16x32_bf16 v[164:167], a[176:179], v[172:175], v[164:167]
    v_mfma_f32_16x16x32_bf16 v[168:171], v[192:195], v[172:175], v[168:171]
    v_mfma_f32_16x16x32_bf16 v[156:159], a[20:23], v[172:175], v[156:159]
    v_mfma_f32_16x16x32_bf16 v[160:163], a[100:103], v[172:175], v[160:163]
    v_mfma_f32_16x16x32_bf16 v[164:167], a[180:183], v[172:175], v[164:167]
    v_mfma_f32_16x16x32_bf16 v[168:171], v[196:199], v[172:175], v[168:171]
    s_barrier
    ds_read_b64_tr_b16 a[24:25], v12 offset:34816
    ds_read_b64_tr_b16 a[26:27], v12 offset:43520
    ds_read_b64_tr_b16 a[28:29], v12 offset:52224
    ds_read_b64_tr_b16 a[30:31], v12 offset:60928
    ds_read_b64_tr_b16 a[104:105], v13 offset:34816
    ds_read_b64_tr_b16 a[106:107], v13 offset:43520
    ds_read_b64_tr_b16 a[108:109], v13 offset:52224
    ds_read_b64_tr_b16 a[110:111], v13 offset:60928
    ds_read_b64_tr_b16 a[184:185], v14 offset:34816
    ds_read_b64_tr_b16 a[186:187], v14 offset:43520
    ds_read_b64_tr_b16 a[188:189], v14 offset:52224
    ds_read_b64_tr_b16 a[190:191], v14 offset:60928
    ds_read_b64_tr_b16 v[200:201], v15 offset:34816
    ds_read_b64_tr_b16 v[202:203], v15 offset:43520
    ds_read_b64_tr_b16 v[204:205], v15 offset:52224
    ds_read_b64_tr_b16 v[206:207], v15 offset:60928
    s_waitcnt vmcnt(16)
    ds_write_b128 v153, v[88:91] offset:0
    ds_write_b128 v153, v[92:95] offset:4352
    ds_write_b128 v153, v[96:99] offset:8704
    ds_write_b128 v153, v[100:103] offset:13056
    ds_write_b128 v153, v[104:107] offset:17408
    ds_write_b128 v153, v[108:111] offset:21760
    ds_write_b128 v153, v[112:115] offset:26112
    ds_write_b128 v153, v[116:119] offset:30464
    s_waitcnt lgkmcnt(0)
    s_add_u32 s24, s52, 1720320
    buffer_load_dwordx4 v[88:91], v152, s[12:15], s24 offen
    s_add_u32 s24, s24, 30720
    buffer_load_dwordx4 v[92:95], v152, s[12:15], s24 offen
    s_add_u32 s24, s24, 30720
    buffer_load_dwordx4 v[96:99], v152, s[12:15], s24 offen
    s_add_u32 s24, s24, 30720
    buffer_load_dwordx4 v[100:103], v152, s[12:15], s24 offen
    s_add_u32 s24, s24, 30720
    buffer_load_dwordx4 v[104:107], v152, s[12:15], s24 offen
    s_add_u32 s24, s24, 30720
    buffer_load_dwordx4 v[108:111], v152, s[12:15], s24 offen
    s_add_u32 s24, s24, 30720
    buffer_load_dwordx4 v[112:115], v152, s[12:15], s24 offen
    s_add_u32 s24, s24, 30720
    buffer_load_dwordx4 v[116:119], v152, s[12:15], s24 offen
    v_mfma_f32_16x16x32_bf16 v[156:159], a[24:27], v[172:175], v[156:159]
    v_mfma_f32_16x16x32_bf16 v[160:163], a[104:107], v[172:175], v[160:163]
    v_mfma_f32_16x16x32_bf16 v[164:167], a[184:187], v[172:175], v[164:167]
    v_mfma_f32_16x16x32_bf16 v[168:171], v[200:203], v[172:175], v[168:171]
    v_mfma_f32_16x16x32_bf16 v[156:159], a[28:31], v[172:175], v[156:159]
    v_mfma_f32_16x16x32_bf16 v[160:163], a[108:111], v[172:175], v[160:163]
    v_mfma_f32_16x16x32_bf16 v[164:167], a[188:191], v[172:175], v[164:167]
    v_mfma_f32_16x16x32_bf16 v[168:171], v[204:207], v[172:175], v[168:171]
    s_barrier
    ds_read_b64_tr_b16 a[32:33], v12 offset:0
    ds_read_b64_tr_b16 a[34:35], v12 offset:8704
    ds_read_b64_tr_b16 a[36:37], v12 offset:17408
    ds_read_b64_tr_b16 a[38:39], v12 offset:26112
    ds_read_b64_tr_b16 a[112:113], v13 offset:0
    ds_read_b64_tr_b16 a[114:115], v13 offset:8704
    ds_read_b64_tr_b16 a[116:117], v13 offset:17408
    ds_read_b64_tr_b16 a[118:119], v13 offset:26112
    ds_read_b64_tr_b16 a[192:193], v14 offset:0
    ds_read_b64_tr_b16 a[194:195], v14 offset:8704
    ds_read_b64_tr_b16 a[196:197], v14 offset:17408
    ds_read_b64_tr_b16 a[198:199], v14 offset:26112
    ds_read_b64_tr_b16 v[208:209], v15 offset:0
    ds_read_b64_tr_b16 v[210:211], v15 offset:8704
    ds_read_b64_tr_b16 v[212:213], v15 offset:17408
    ds_read_b64_tr_b16 v[214:215], v15 offset:26112
    s_waitcnt vmcnt(16)
    ds_write_b128 v153, v[120:123] offset:34816
    ds_write_b128 v153, v[124:127] offset:39168
    ds_write_b128 v153, v[128:131] offset:43520
    ds_write_b128 v153, v[132:135] offset:47872
    ds_write_b128 v153, v[136:139] offset:52224
    ds_write_b128 v153, v[140:143] offset:56576
    ds_write_b128 v153, v[144:147] offset:60928
    ds_write_b128 v153, v[148:151] offset:65280
    s_waitcnt lgkmcnt(0)
    s_add_u32 s24, s52, 1966080
    buffer_load_dwordx4 v[120:123], v152, s[12:15], s24 offen
    s_add_u32 s24, s24, 30720
    buffer_load_dwordx4 v[124:127], v152, s[12:15], s24 offen
    s_add_u32 s24, s24, 30720
    buffer_load_dwordx4 v[128:131], v152, s[12:15], s24 offen
    s_add_u32 s24, s24, 30720
    buffer_load_dwordx4 v[132:135], v152, s[12:15], s24 offen
    s_add_u32 s24, s24, 30720
    buffer_load_dwordx4 v[136:139], v152, s[12:15], s24 offen
    s_add_u32 s24, s24, 30720
    buffer_load_dwordx4 v[140:143], v152, s[12:15], s24 offen
    s_add_u32 s24, s24, 30720
    buffer_load_dwordx4 v[144:147], v152, s[12:15], s24 offen
    s_add_u32 s24, s24, 30720
    buffer_load_dwordx4 v[148:151], v152, s[12:15], s24 offen
    v_mfma_f32_16x16x32_bf16 v[156:159], a[32:35], v[172:175], v[156:159]
    v_mfma_f32_16x16x32_bf16 v[160:163], a[112:115], v[172:175], v[160:163]
    v_mfma_f32_16x16x32_bf16 v[164:167], a[192:195], v[172:175], v[164:167]
    v_mfma_f32_16x16x32_bf16 v[168:171], v[208:211], v[172:175], v[168:171]
    v_mfma_f32_16x16x32_bf16 v[156:159], a[36:39], v[172:175], v[156:159]
    v_mfma_f32_16x16x32_bf16 v[160:163], a[116:119], v[172:175], v[160:163]
    v_mfma_f32_16x16x32_bf16 v[164:167], a[196:199], v[172:175], v[164:167]
    v_mfma_f32_16x16x32_bf16 v[168:171], v[212:215], v[172:175], v[168:171]
    s_barrier
    ds_read_b64_tr_b16 a[40:41], v12 offset:34816
    ds_read_b64_tr_b16 a[42:43], v12 offset:43520
    ds_read_b64_tr_b16 a[44:45], v12 offset:52224
    ds_read_b64_tr_b16 a[46:47], v12 offset:60928
    ds_read_b64_tr_b16 a[120:121], v13 offset:34816
    ds_read_b64_tr_b16 a[122:123], v13 offset:43520
    ds_read_b64_tr_b16 a[124:125], v13 offset:52224
    ds_read_b64_tr_b16 a[126:127], v13 offset:60928
    ds_read_b64_tr_b16 a[200:201], v14 offset:34816
    ds_read_b64_tr_b16 a[202:203], v14 offset:43520
    ds_read_b64_tr_b16 a[204:205], v14 offset:52224
    ds_read_b64_tr_b16 a[206:207], v14 offset:60928
    ds_read_b64_tr_b16 v[216:217], v15 offset:34816
    ds_read_b64_tr_b16 v[218:219], v15 offset:43520
    ds_read_b64_tr_b16 v[220:221], v15 offset:52224
    ds_read_b64_tr_b16 v[222:223], v15 offset:60928
    s_waitcnt vmcnt(16)
    ds_write_b128 v153, v[56:59] offset:0
    ds_write_b128 v153, v[60:63] offset:4352
    ds_write_b128 v153, v[64:67] offset:8704
    ds_write_b128 v153, v[68:71] offset:13056
    ds_write_b128 v153, v[72:75] offset:17408
    ds_write_b128 v153, v[76:79] offset:21760
    ds_write_b128 v153, v[80:83] offset:26112
    ds_write_b128 v153, v[84:87] offset:30464
    s_waitcnt lgkmcnt(0)
    s_add_u32 s24, s52, 2211840
    buffer_load_dwordx4 v[56:59], v152, s[12:15], s24 offen
    s_add_u32 s24, s24, 30720
    buffer_load_dwordx4 v[60:63], v152, s[12:15], s24 offen
    s_add_u32 s24, s24, 30720
    buffer_load_dwordx4 v[64:67], v152, s[12:15], s24 offen
    s_add_u32 s24, s24, 30720
    buffer_load_dwordx4 v[68:71], v152, s[12:15], s24 offen
    s_add_u32 s24, s24, 30720
    buffer_load_dwordx4 v[72:75], v152, s[12:15], s24 offen
    s_add_u32 s24, s24, 30720
    buffer_load_dwordx4 v[76:79], v152, s[12:15], s24 offen
    s_add_u32 s24, s24, 30720
    buffer_load_dwordx4 v[80:83], v152, s[12:15], s24 offen
    s_add_u32 s24, s24, 30720
    buffer_load_dwordx4 v[84:87], v152, s[12:15], s24 offen
    v_mfma_f32_16x16x32_bf16 v[156:159], a[40:43], v[172:175], v[156:159]
    v_mfma_f32_16x16x32_bf16 v[160:163], a[120:123], v[172:175], v[160:163]
    v_mfma_f32_16x16x32_bf16 v[164:167], a[200:203], v[172:175], v[164:167]
    v_mfma_f32_16x16x32_bf16 v[168:171], v[216:219], v[172:175], v[168:171]
    v_mfma_f32_16x16x32_bf16 v[156:159], a[44:47], v[172:175], v[156:159]
    v_mfma_f32_16x16x32_bf16 v[160:163], a[124:127], v[172:175], v[160:163]
    v_mfma_f32_16x16x32_bf16 v[164:167], a[204:207], v[172:175], v[164:167]
    v_mfma_f32_16x16x32_bf16 v[168:171], v[220:223], v[172:175], v[168:171]
    s_barrier
    ds_read_b64_tr_b16 a[48:49], v12 offset:0
    ds_read_b64_tr_b16 a[50:51], v12 offset:8704
    ds_read_b64_tr_b16 a[52:53], v12 offset:17408
    ds_read_b64_tr_b16 a[54:55], v12 offset:26112
    ds_read_b64_tr_b16 a[128:129], v13 offset:0
    ds_read_b64_tr_b16 a[130:131], v13 offset:8704
    ds_read_b64_tr_b16 a[132:133], v13 offset:17408
    ds_read_b64_tr_b16 a[134:135], v13 offset:26112
    ds_read_b64_tr_b16 a[208:209], v14 offset:0
    ds_read_b64_tr_b16 a[210:211], v14 offset:8704
    ds_read_b64_tr_b16 a[212:213], v14 offset:17408
    ds_read_b64_tr_b16 a[214:215], v14 offset:26112
    ds_read_b64_tr_b16 v[224:225], v15 offset:0
    ds_read_b64_tr_b16 v[226:227], v15 offset:8704
    ds_read_b64_tr_b16 v[228:229], v15 offset:17408
    ds_read_b64_tr_b16 v[230:231], v15 offset:26112
    s_waitcnt vmcnt(16)
    ds_write_b128 v153, v[88:91] offset:34816
    ds_write_b128 v153, v[92:95] offset:39168
    ds_write_b128 v153, v[96:99] offset:43520
    ds_write_b128 v153, v[100:103] offset:47872
    ds_write_b128 v153, v[104:107] offset:52224
    ds_write_b128 v153, v[108:111] offset:56576
    ds_write_b128 v153, v[112:115] offset:60928
    ds_write_b128 v153, v[116:119] offset:65280
    s_waitcnt lgkmcnt(0)
    v_mfma_f32_16x16x32_bf16 v[156:159], a[48:51], v[172:175], v[156:159]
    v_mfma_f32_16x16x32_bf16 v[160:163], a[128:131], v[172:175], v[160:163]
    v_mfma_f32_16x16x32_bf16 v[164:167], a[208:211], v[172:175], v[164:167]
    v_mfma_f32_16x16x32_bf16 v[168:171], v[224:227], v[172:175], v[168:171]
    v_mfma_f32_16x16x32_bf16 v[156:159], a[52:55], v[172:175], v[156:159]
    v_mfma_f32_16x16x32_bf16 v[160:163], a[132:135], v[172:175], v[160:163]
    v_mfma_f32_16x16x32_bf16 v[164:167], a[212:215], v[172:175], v[164:167]
    v_mfma_f32_16x16x32_bf16 v[168:171], v[228:231], v[172:175], v[168:171]
    s_barrier
    ds_read_b64_tr_b16 a[56:57], v12 offset:34816
    ds_read_b64_tr_b16 a[58:59], v12 offset:43520
    ds_read_b64_tr_b16 a[60:61], v12 offset:52224
    ds_read_b64_tr_b16 a[62:63], v12 offset:60928
    ds_read_b64_tr_b16 a[136:137], v13 offset:34816
    ds_read_b64_tr_b16 a[138:139], v13 offset:43520
    ds_read_b64_tr_b16 a[140:141], v13 offset:52224
    ds_read_b64_tr_b16 a[142:143], v13 offset:60928
    ds_read_b64_tr_b16 a[216:217], v14 offset:34816
    ds_read_b64_tr_b16 a[218:219], v14 offset:43520
    ds_read_b64_tr_b16 a[220:221], v14 offset:52224
    ds_read_b64_tr_b16 a[222:223], v14 offset:60928
    ds_read_b64_tr_b16 v[232:233], v15 offset:34816
    ds_read_b64_tr_b16 v[234:235], v15 offset:43520
    ds_read_b64_tr_b16 v[236:237], v15 offset:52224
    ds_read_b64_tr_b16 v[238:239], v15 offset:60928
    s_waitcnt vmcnt(8)
    ds_write_b128 v153, v[120:123] offset:0
    ds_write_b128 v153, v[124:127] offset:4352
    ds_write_b128 v153, v[128:131] offset:8704
    ds_write_b128 v153, v[132:135] offset:13056
    ds_write_b128 v153, v[136:139] offset:17408
    ds_write_b128 v153, v[140:143] offset:21760
    ds_write_b128 v153, v[144:147] offset:26112
    ds_write_b128 v153, v[148:151] offset:30464
    s_waitcnt lgkmcnt(0)
    v_mfma_f32_16x16x32_bf16 v[156:159], a[56:59], v[172:175], v[156:159]
    v_mfma_f32_16x16x32_bf16 v[160:163], a[136:139], v[172:175], v[160:163]
    v_mfma_f32_16x16x32_bf16 v[164:167], a[216:219], v[172:175], v[164:167]
    v_mfma_f32_16x16x32_bf16 v[168:171], v[232:235], v[172:175], v[168:171]
    v_mfma_f32_16x16x32_bf16 v[156:159], a[60:63], v[172:175], v[156:159]
    v_mfma_f32_16x16x32_bf16 v[160:163], a[140:143], v[172:175], v[160:163]
    v_mfma_f32_16x16x32_bf16 v[164:167], a[220:223], v[172:175], v[164:167]
    v_mfma_f32_16x16x32_bf16 v[168:171], v[236:239], v[172:175], v[168:171]
    s_barrier
    ds_read_b64_tr_b16 a[64:65], v12 offset:0
    ds_read_b64_tr_b16 a[66:67], v12 offset:8704
    ds_read_b64_tr_b16 a[68:69], v12 offset:17408
    ds_read_b64_tr_b16 a[70:71], v12 offset:26112
    ds_read_b64_tr_b16 a[144:145], v13 offset:0
    ds_read_b64_tr_b16 a[146:147], v13 offset:8704
    ds_read_b64_tr_b16 a[148:149], v13 offset:17408
    ds_read_b64_tr_b16 a[150:151], v13 offset:26112
    ds_read_b64_tr_b16 a[224:225], v14 offset:0
    ds_read_b64_tr_b16 a[226:227], v14 offset:8704
    ds_read_b64_tr_b16 a[228:229], v14 offset:17408
    ds_read_b64_tr_b16 a[230:231], v14 offset:26112
    ds_read_b64_tr_b16 v[240:241], v15 offset:0
    ds_read_b64_tr_b16 v[242:243], v15 offset:8704
    ds_read_b64_tr_b16 v[244:245], v15 offset:17408
    ds_read_b64_tr_b16 v[246:247], v15 offset:26112
    s_waitcnt vmcnt(0)
    ds_write_b128 v153, v[56:59] offset:34816
    ds_write_b128 v153, v[60:63] offset:39168
    ds_write_b128 v153, v[64:67] offset:43520
    ds_write_b128 v153, v[68:71] offset:47872
    ds_write_b128 v153, v[72:75] offset:52224
    ds_write_b128 v153, v[76:79] offset:56576
    ds_write_b128 v153, v[80:83] offset:60928
    ds_write_b128 v153, v[84:87] offset:65280
    s_waitcnt lgkmcnt(0)
    v_mfma_f32_16x16x32_bf16 v[156:159], a[64:67], v[172:175], v[156:159]
    v_mfma_f32_16x16x32_bf16 v[160:163], a[144:147], v[172:175], v[160:163]
    v_mfma_f32_16x16x32_bf16 v[164:167], a[224:227], v[172:175], v[164:167]
    v_mfma_f32_16x16x32_bf16 v[168:171], v[240:243], v[172:175], v[168:171]
    v_mfma_f32_16x16x32_bf16 v[156:159], a[68:71], v[172:175], v[156:159]
    v_mfma_f32_16x16x32_bf16 v[160:163], a[148:151], v[172:175], v[160:163]
    v_mfma_f32_16x16x32_bf16 v[164:167], a[228:231], v[172:175], v[164:167]
    v_mfma_f32_16x16x32_bf16 v[168:171], v[244:247], v[172:175], v[168:171]
    s_barrier
    ds_read_b64_tr_b16 a[72:73], v12 offset:34816
    ds_read_b64_tr_b16 a[74:75], v12 offset:43520
    ds_read_b64_tr_b16 a[76:77], v12 offset:52224
    ds_read_b64_tr_b16 a[78:79], v12 offset:60928
    ds_read_b64_tr_b16 a[152:153], v13 offset:34816
    ds_read_b64_tr_b16 a[154:155], v13 offset:43520
    ds_read_b64_tr_b16 a[156:157], v13 offset:52224
    ds_read_b64_tr_b16 a[158:159], v13 offset:60928
    ds_read_b64_tr_b16 a[232:233], v14 offset:34816
    ds_read_b64_tr_b16 a[234:235], v14 offset:43520
    ds_read_b64_tr_b16 a[236:237], v14 offset:52224
    ds_read_b64_tr_b16 a[238:239], v14 offset:60928
    ds_read_b64_tr_b16 v[248:249], v15 offset:34816
    ds_read_b64_tr_b16 v[250:251], v15 offset:43520
    ds_read_b64_tr_b16 v[252:253], v15 offset:52224
    ds_read_b64_tr_b16 v[254:255], v15 offset:60928
    s_cmp_eq_u32 s2, 255
    s_cbranch_scc0 interleave_layers__linear_attn_block__memory_aug_recurrent_mem_tr__prompt_kernel_fb2
    s_cmp_eq_u32 s92, 0
    s_cbranch_scc0 interleave_layers__linear_attn_block__memory_aug_recurrent_mem_tr__prompt_kernel_fb2
    s_waitcnt vmcnt(0)
    s_lshl_b32 s24, s3, 9
    s_add_u32 s24, s24, 118423552
    v_mov_b32 v154, 0
    s_lshl_b32 s27, s3, 3
    s_add_u32 s27, s27, 131072
    s_barrier
    s_mov_b32 s25, -1
    s_mov_b64 exec, 1
    v_mov_b32 v155, 0
    s_memtime s[28:29]
    s_waitcnt lgkmcnt(0)
    buffer_atomic_add v155, v154, s[8:11], s24 offen offset:0 sc0
    s_waitcnt vmcnt(0)
    s_memtime s[30:31]
    s_waitcnt lgkmcnt(0)
    s_sub_u32 s30, s30, s28
    s_min_u32 s25, s25, s30
    v_mov_b32 v155, 0
    s_memtime s[28:29]
    s_waitcnt lgkmcnt(0)
    buffer_atomic_add v155, v154, s[8:11], s24 offen offset:128 sc0
    s_waitcnt vmcnt(0)
    s_memtime s[30:31]
    s_waitcnt lgkmcnt(0)
    s_sub_u32 s30, s30, s28
    s_min_u32 s25, s25, s30
    v_mov_b32 v155, 0
    s_memtime s[28:29]
    s_waitcnt lgkmcnt(0)
    buffer_atomic_add v155, v154, s[8:11], s24 offen offset:256 sc0
    s_waitcnt vmcnt(0)
    s_memtime s[30:31]
    s_waitcnt lgkmcnt(0)
    s_sub_u32 s30, s30, s28
    s_min_u32 s25, s25, s30
    v_mov_b32 v148, s27
    v_mov_b32 v155, s25
    ds_write_b32 v148, v155 offset:0
    s_mov_b64 exec, -1
    s_add_u32 s24, s24, 0x2000
    s_barrier
    s_mov_b32 s25, -1
    s_mov_b64 exec, 1
    v_mov_b32 v155, 0
    s_memtime s[28:29]
    s_waitcnt lgkmcnt(0)
    buffer_atomic_add v155, v154, s[8:11], s24 offen offset:0 sc0
    s_waitcnt vmcnt(0)
    s_memtime s[30:31]
    s_waitcnt lgkmcnt(0)
    s_sub_u32 s30, s30, s28
    s_min_u32 s25, s25, s30
    v_mov_b32 v155, 0
    s_memtime s[28:29]
    s_waitcnt lgkmcnt(0)
    buffer_atomic_add v155, v154, s[8:11], s24 offen offset:128 sc0
    s_waitcnt vmcnt(0)
    s_memtime s[30:31]
    s_waitcnt lgkmcnt(0)
    s_sub_u32 s30, s30, s28
    s_min_u32 s25, s25, s30
    v_mov_b32 v155, 0
    s_memtime s[28:29]
    s_waitcnt lgkmcnt(0)
    buffer_atomic_add v155, v154, s[8:11], s24 offen offset:256 sc0
    s_waitcnt vmcnt(0)
    s_memtime s[30:31]
    s_waitcnt lgkmcnt(0)
    s_sub_u32 s30, s30, s28
    s_min_u32 s25, s25, s30
    v_mov_b32 v148, s27
    v_mov_b32 v155, s25
    ds_write_b32 v148, v155 offset:4
    s_mov_b64 exec, -1
    s_add_u32 s24, s24, 0x2000
    s_waitcnt lgkmcnt(0)
    s_barrier
    v_mov_b32 v154, 131072
    ds_read_b128 v[148:151], v154
    ds_read_b128 v[152:155], v154 offset:16
    s_waitcnt lgkmcnt(0)
    v_min_u32 v148, v148, v152
    v_min_u32 v149, v149, v153
    v_min_u32 v150, v150, v154
    v_min_u32 v151, v151, v155
    v_min_u32 v148, v148, v150
    v_min_u32 v149, v149, v151
    v_cmp_lt_u32 vcc, v149, v148
    s_nop 1
    v_cndmask_b32 v155, 1, 2, vcc
    s_cmp_eq_u32 s3, 0
    s_cbranch_scc0 interleave_layers__linear_attn_block__memory_aug_recurrent_mem_tr__prompt_kernel_fb2
    v_mov_b32 v154, 2146435072
    v_cmp_eq_u32 vcc, 0, v1
    s_nop 1
    v_cndmask_b32 v154, v154, 0, vcc
    buffer_store_dword v155, v154, s[72:75], 0 offen sc1
interleave_layers__linear_attn_block__memory_aug_recurrent_mem_tr__prompt_kernel_fb2:
    v_lshlrev_b32 v7, 4, v1
    s_lshr_b32 s24, s3, 1
    s_mul_i32 s24, s24, 20
    s_and_b32 s25, s3, 1
    s_mul_i32 s25, s25, 10
    s_add_u32 s24, s24, s25
    s_lshl_b32 s24, s24, 10
    v_add_u32 v6, s24, v7
    s_lshr_b32 s24, s3, 1
    s_lshl_b32 s24, s24, 8
    s_and_b32 s25, s3, 1
    s_lshl_b32 s25, s25, 3
    s_add_u32 s24, s24, s25
    s_add_u32 s24, s24, 51712
    v_lshlrev_b32 v9, 4, v2
    v_add_u32 v8, s24, v9
    v_add_u32 v9, 51712, v9
    v_mul_u32_u24 v10, 336, v2
    v_lshl_add_u32 v10, v3, 3, v10
    v_add_u32 v10, 40960, v10
    v_lshrrev_b32 v11, 2, v2
    v_lshl_add_u32 v11, v3, 3, v11
    v_mul_u32_u24 v11, 336, v11
    v_and_b32 v15, 3, v2
    v_lshl_add_u32 v11, v15, 3, v11
    s_lshl_b32 s24, s3, 5
    s_add_u32 s24, s24, 40960
    v_add_u32 v11, s24, v11
    s_lshl_b32 s24, s3, 10
    v_add_u32 v12, s24, v7
    v_lshlrev_b32 v15, 3, v1
    v_add_u32 v15, 2048, v15
    s_cmp_eq_u32 s3, 2
    s_cselect_b64 vcc, -1, 0
    v_cndmask_b32 v12, v12, v15, vcc
    s_mul_i32 s24, s44, 2560
    s_add_u32 s24, s24, 12582912
    v_add_u32 v12, s24, v12
    s_mov_b32 s52, 0x3fb8aa3b
    s_mov_b32 s53, s52
    s_mov_b32 s54, 0x358637bd
    s_mov_b32 s55, s54
    v_mov_b32 v120, 0
    v_mov_b32 v121, 0
    v_mov_b32 v122, 0
    v_mov_b32 v123, 0
    v_mov_b32 v124, 0
    v_mov_b32 v125, 0
    v_mov_b32 v126, 0
    v_mov_b32 v127, 0
    v_mov_b32 v128, 0
    v_mov_b32 v129, 0
    v_mov_b32 v130, 0
    v_mov_b32 v131, 0
    v_mov_b32 v132, 0
    v_mov_b32 v133, 0
    v_mov_b32 v134, 0
    v_mov_b32 v135, 0
    v_mov_b32 v136, 0
    v_mov_b32 v137, 0
    v_mov_b32 v138, 0
    v_mov_b32 v139, 0
    v_mov_b32 v140, 0
    v_mov_b32 v141, 0
    v_mov_b32 v142, 0
    v_mov_b32 v143, 0
    s_waitcnt lgkmcnt(0)
    v_mfma_f32_16x16x32_bf16 v[156:159], a[72:75], v[172:175], v[156:159]
    v_mfma_f32_16x16x32_bf16 v[160:163], a[152:155], v[172:175], v[160:163]
    v_mfma_f32_16x16x32_bf16 v[164:167], a[232:235], v[172:175], v[164:167]
    v_mfma_f32_16x16x32_bf16 v[168:171], v[248:251], v[172:175], v[168:171]
    v_mfma_f32_16x16x32_bf16 v[156:159], a[76:79], v[172:175], v[156:159]
    v_mfma_f32_16x16x32_bf16 v[160:163], a[156:159], v[172:175], v[160:163]
    v_mfma_f32_16x16x32_bf16 v[164:167], a[236:239], v[172:175], v[164:167]
    v_mfma_f32_16x16x32_bf16 v[168:171], v[252:255], v[172:175], v[168:171]
    s_mov_b32 s56, 1
interleave_layers__linear_attn_block__memory_aug_recurrent_mem_tr__prompt_kernel_k1_seg:
    s_cmp_eq_u32 s51, 1
    s_cbranch_scc1 interleave_layers__linear_attn_block__memory_aug_recurrent_mem_tr__prompt_kernel_k13
    s_and_b32 s24, s48, 3
    s_lshl_b32 s24, s24, 7
    s_add_u32 s24, s24, 23107584
    v_lshlrev_b32 v15, 2, v1
    v_add_u32 v15, s24, v15
    s_lshr_b32 s95, s48, 2
    s_add_u32 s95, s95, 1
    s_mov_b32 s61, 0
interleave_layers__linear_attn_block__memory_aug_recurrent_mem_tr__prompt_kernel_k1_wx:
    buffer_load_dword v14, v15, s[8:11], 0 offen sc1
    s_waitcnt vmcnt(0)
    v_cmp_le_i32 vcc, s95, v14
    s_mov_b32 s25, 0xfffff
    s_and_b32 s24, vcc_lo, s25
    s_cmp_eq_u32 s24, s25
    s_cbranch_scc1 interleave_layers__linear_attn_block__memory_aug_recurrent_mem_tr__prompt_kernel_k1_wx_ok
    s_add_u32 s61, s61, 1
    s_cmp_ge_u32 s61, s60
    s_cbranch_scc1 interleave_layers__linear_attn_block__memory_aug_recurrent_mem_tr__prompt_kernel_k1_wx_to
    s_sleep 4
    s_branch interleave_layers__linear_attn_block__memory_aug_recurrent_mem_tr__prompt_kernel_k1_wx
interleave_layers__linear_attn_block__memory_aug_recurrent_mem_tr__prompt_kernel_k1_wx_to:
    s_mov_b32 s60, 1
interleave_layers__linear_attn_block__memory_aug_recurrent_mem_tr__prompt_kernel_k1_wx_ok:
    s_mov_b32 s41, s43
    s_mov_b32 s24, s41
    buffer_load_dwordx4 v[16:19], v4, s[16:19], s24 offen sc1
    s_add_u32 s24, s24, s46
    buffer_load_dwordx4 v[20:23], v4, s[16:19], s24 offen sc1
    s_add_u32 s24, s24, s46
    buffer_load_dwordx4 v[24:27], v4, s[16:19], s24 offen sc1
    s_add_u32 s24, s24, s46
    buffer_load_dwordx4 v[28:31], v4, s[16:19], s24 offen sc1
    s_add_u32 s24, s24, s46
    buffer_load_dwordx4 v[32:35], v4, s[16:19], s24 offen sc1
    s_add_u32 s24, s24, s46
    buffer_load_dwordx4 v[36:39], v4, s[16:19], s24 offen sc1
    s_add_u32 s24, s24, s46
    buffer_load_dwordx4 v[40:43], v4, s[16:19], s24 offen sc1
    s_add_u32 s24, s24, s46
    buffer_load_dwordx4 v[44:47], v4, s[16:19], s24 offen sc1
    s_add_u32 s24, s24, s46
    buffer_load_dwordx4 v[48:51], v4, s[16:19], s24 offen sc1
    s_add_u32 s24, s24, s46
    buffer_load_dwordx4 v[52:55], v4, s[16:19], s24 offen sc1
    s_mul_i32 s24, s49, 1
    s_add_u32 s24, s24, s48
    s_and_b32 s24, s24, 3
    s_lshl_b32 s24, s24, 7
    s_add_u32 s24, s24, 23107584
    v_lshlrev_b32 v15, 2, v1
    v_add_u32 v15, s24, v15
    buffer_load_dword v13, v15, s[8:11], 0 offen sc1
interleave_layers__linear_attn_block__memory_aug_recurrent_mem_tr__prompt_kernel_k13:
    s_cmp_eq_u32 s92, 0
    s_cselect_b32 s24, s56, 0
    s_cmp_eq_u32 s24, 1
    s_cbranch_scc1 interleave_layers__linear_attn_block__memory_aug_recurrent_mem_tr__prompt_kernel_k1w4
    s_waitcnt vmcnt(0)
interleave_layers__linear_attn_block__memory_aug_recurrent_mem_tr__prompt_kernel_k1w4:
    s_mov_b32 s56, 0
    v_mov_b32 v148, 0
    v_mov_b32 v149, 0
    v_mov_b32 v150, 0
    v_mov_b32 v151, 0
    v_dot2c_f32_bf16 v148, v16, v172
    v_dot2c_f32_bf16 v149, v16, v16
    v_dot2c_f32_bf16 v150, v17, v172
    v_dot2c_f32_bf16 v151, v17, v17
    v_dot2c_f32_bf16 v148, v18, v172
    v_dot2c_f32_bf16 v149, v18, v18
    v_dot2c_f32_bf16 v150, v19, v172
    v_dot2c_f32_bf16 v151, v19, v19
    v_dot2c_f32_bf16 v148, v20, v172
    v_dot2c_f32_bf16 v149, v20, v20
    v_dot2c_f32_bf16 v150, v21, v172
    v_dot2c_f32_bf16 v151, v21, v21
    v_dot2c_f32_bf16 v148, v22, v172
    v_dot2c_f32_bf16 v149, v22, v22
    v_dot2c_f32_bf16 v150, v23, v172
    v_dot2c_f32_bf16 v151, v23, v23
    v_dot2c_f32_bf16 v148, v24, v172
    v_dot2c_f32_bf16 v149, v24, v24
    v_dot2c_f32_bf16 v150, v25, v172
    v_dot2c_f32_bf16 v151, v25, v25
    v_dot2c_f32_bf16 v148, v26, v172
    v_dot2c_f32_bf16 v149, v26, v26
    v_dot2c_f32_bf16 v150, v27, v172
    v_dot2c_f32_bf16 v151, v27, v27
    v_dot2c_f32_bf16 v148, v28, v172
    v_dot2c_f32_bf16 v149, v28, v28
    v_dot2c_f32_bf16 v150, v29, v172
    v_dot2c_f32_bf16 v151, v29, v29
    v_dot2c_f32_bf16 v148, v30, v172
    v_dot2c_f32_bf16 v149, v30, v30
    v_dot2c_f32_bf16 v150, v31, v172
    v_dot2c_f32_bf16 v151, v31, v31
    v_dot2c_f32_bf16 v148, v32, v172
    v_dot2c_f32_bf16 v149, v32, v32
    v_dot2c_f32_bf16 v150, v33, v172
    v_dot2c_f32_bf16 v151, v33, v33
    v_dot2c_f32_bf16 v148, v34, v172
    v_dot2c_f32_bf16 v149, v34, v34
    v_dot2c_f32_bf16 v150, v35, v172
    v_dot2c_f32_bf16 v151, v35, v35
    v_dot2c_f32_bf16 v148, v36, v172
    v_dot2c_f32_bf16 v149, v36, v36
    v_dot2c_f32_bf16 v150, v37, v172
    v_dot2c_f32_bf16 v151, v37, v37
    v_dot2c_f32_bf16 v148, v38, v172
    v_dot2c_f32_bf16 v149, v38, v38
    v_dot2c_f32_bf16 v150, v39, v172
    v_dot2c_f32_bf16 v151, v39, v39
    v_dot2c_f32_bf16 v148, v40, v172
    v_dot2c_f32_bf16 v149, v40, v40
    v_dot2c_f32_bf16 v150, v41, v172
    v_dot2c_f32_bf16 v151, v41, v41
    v_dot2c_f32_bf16 v148, v42, v172
    v_dot2c_f32_bf16 v149, v42, v42
    v_dot2c_f32_bf16 v150, v43, v172
    v_dot2c_f32_bf16 v151, v43, v43
    v_dot2c_f32_bf16 v148, v44, v172
    v_dot2c_f32_bf16 v149, v44, v44
    v_dot2c_f32_bf16 v150, v45, v172
    v_dot2c_f32_bf16 v151, v45, v45
    v_dot2c_f32_bf16 v148, v46, v172
    v_dot2c_f32_bf16 v149, v46, v46
    v_dot2c_f32_bf16 v150, v47, v172
    v_dot2c_f32_bf16 v151, v47, v47
    v_dot2c_f32_bf16 v148, v48, v172
    v_dot2c_f32_bf16 v149, v48, v48
    v_dot2c_f32_bf16 v150, v49, v172
    v_dot2c_f32_bf16 v151, v49, v49
    v_dot2c_f32_bf16 v148, v50, v172
    v_dot2c_f32_bf16 v149, v50, v50
    v_dot2c_f32_bf16 v150, v51, v172
    v_dot2c_f32_bf16 v151, v51, v51
    v_dot2c_f32_bf16 v148, v52, v172
    v_dot2c_f32_bf16 v149, v52, v52
    v_dot2c_f32_bf16 v150, v53, v172
    v_dot2c_f32_bf16 v151, v53, v53
    v_dot2c_f32_bf16 v148, v54, v172
    v_dot2c_f32_bf16 v149, v54, v54
    v_dot2c_f32_bf16 v150, v55, v172
    v_dot2c_f32_bf16 v151, v55, v55
    s_nop 1
    v_add_f32 v148, v148, v150
    v_add_f32 v149, v149, v151
    v_mov_b32 v150, v148
    v_mov_b32 v151, v149
    s_nop 0
    v_permlane16_swap_b32 v148, v150
    v_permlane16_swap_b32 v149, v151
    v_add_f32 v148, v148, v150
    v_add_f32 v149, v149, v151
    v_mov_b32 v150, v148
    v_mov_b32 v151, v149
    s_nop 0
    v_permlane32_swap_b32 v148, v150
    v_permlane32_swap_b32 v149, v151
    v_add_f32 v148, v148, v150
    v_add_f32 v149, v149, v151
    ds_write_b128 v6, v[16:19] offset:0
    ds_write_b128 v6, v[20:23] offset:1024
    ds_write_b128 v6, v[24:27] offset:2048
    ds_write_b128 v6, v[28:31] offset:3072
    ds_write_b128 v6, v[32:35] offset:4096
    ds_write_b128 v6, v[36:39] offset:5120
    ds_write_b128 v6, v[40:43] offset:6144
    ds_write_b128 v6, v[44:47] offset:7168
    ds_write_b128 v6, v[48:51] offset:8192
    ds_write_b128 v6, v[52:55] offset:9216
    ds_write_b64 v8, v[148:149]
    s_mov_b32 s51, 0
    s_waitcnt lgkmcnt(0)
    s_cmp_gt_u32 s40, 1
    s_cbranch_scc0 interleave_layers__linear_attn_block__memory_aug_recurrent_mem_tr__prompt_kernel_k15
    s_cmp_eq_u32 s92, 0
    s_cbranch_scc1 interleave_layers__linear_attn_block__memory_aug_recurrent_mem_tr__prompt_kernel_k16
    s_add_u32 s24, s48, s49
    s_lshr_b32 s24, s24, 2
    s_add_u32 s24, s24, 1
    v_cmp_le_i32 vcc, s24, v13
    s_and_b32 s24, vcc_lo, 0xfffff
    s_cmp_eq_u32 s24, 0xfffff
    s_cbranch_scc0 interleave_layers__linear_attn_block__memory_aug_recurrent_mem_tr__prompt_kernel_k15
    s_add_u32 s41, s43, s42
    s_mov_b32 s24, s41
    buffer_load_dwordx4 v[16:19], v4, s[16:19], s24 offen sc1
    s_add_u32 s24, s24, s46
    buffer_load_dwordx4 v[20:23], v4, s[16:19], s24 offen sc1
    s_add_u32 s24, s24, s46
    buffer_load_dwordx4 v[24:27], v4, s[16:19], s24 offen sc1
    s_add_u32 s24, s24, s46
    buffer_load_dwordx4 v[28:31], v4, s[16:19], s24 offen sc1
    s_add_u32 s24, s24, s46
    buffer_load_dwordx4 v[32:35], v4, s[16:19], s24 offen sc1
    s_add_u32 s24, s24, s46
    buffer_load_dwordx4 v[36:39], v4, s[16:19], s24 offen sc1
    s_add_u32 s24, s24, s46
    buffer_load_dwordx4 v[40:43], v4, s[16:19], s24 offen sc1
    s_add_u32 s24, s24, s46
    buffer_load_dwordx4 v[44:47], v4, s[16:19], s24 offen sc1
    s_add_u32 s24, s24, s46
    buffer_load_dwordx4 v[48:51], v4, s[16:19], s24 offen sc1
    s_add_u32 s24, s24, s46
    buffer_load_dwordx4 v[52:55], v4, s[16:19], s24 offen sc1
    s_mov_b32 s51, 1
    s_mul_i32 s24, s49, 2
    s_add_u32 s24, s24, s48
    s_and_b32 s24, s24, 3
    s_lshl_b32 s24, s24, 7
    s_add_u32 s24, s24, 23107584
    v_lshlrev_b32 v15, 2, v1
    v_add_u32 v15, s24, v15
    buffer_load_dword v13, v15, s[8:11], 0 offen sc1
    s_branch interleave_layers__linear_attn_block__memory_aug_recurrent_mem_tr__prompt_kernel_k15
interleave_layers__linear_attn_block__memory_aug_recurrent_mem_tr__prompt_kernel_k16:
    s_add_u32 s41, s43, s42
    s_mov_b32 s24, s41
    buffer_load_dwordx2 v[16:17], v4, s[16:19], s24 offen
    buffer_load_dwordx2 v[18:19], v5, s[16:19], s24 offen
    s_add_u32 s24, s24, s46
    buffer_load_dwordx2 v[20:21], v4, s[16:19], s24 offen
    buffer_load_dwordx2 v[22:23], v5, s[16:19], s24 offen
    s_add_u32 s24, s24, s46
    buffer_load_dwordx2 v[24:25], v4, s[16:19], s24 offen
    buffer_load_dwordx2 v[26:27], v5, s[16:19], s24 offen
    s_add_u32 s24, s24, s46
    buffer_load_dwordx2 v[28:29], v4, s[16:19], s24 offen
    buffer_load_dwordx2 v[30:31], v5, s[16:19], s24 offen
    s_add_u32 s24, s24, s46
    buffer_load_dwordx2 v[32:33], v4, s[16:19], s24 offen
    buffer_load_dwordx2 v[34:35], v5, s[16:19], s24 offen
    s_add_u32 s24, s24, s46
    buffer_load_dwordx2 v[36:37], v4, s[16:19], s24 offen
    buffer_load_dwordx2 v[38:39], v5, s[16:19], s24 offen
    s_add_u32 s24, s24, s46
    buffer_load_dwordx2 v[40:41], v4, s[16:19], s24 offen
    buffer_load_dwordx2 v[42:43], v5, s[16:19], s24 offen
    s_add_u32 s24, s24, s46
    buffer_load_dwordx2 v[44:45], v4, s[16:19], s24 offen
    buffer_load_dwordx2 v[46:47], v5, s[16:19], s24 offen
    s_add_u32 s24, s24, s46
    buffer_load_dwordx2 v[48:49], v4, s[16:19], s24 offen
    buffer_load_dwordx2 v[50:51], v5, s[16:19], s24 offen
    s_add_u32 s24, s24, s46
    buffer_load_dwordx2 v[52:53], v4, s[16:19], s24 offen
    buffer_load_dwordx2 v[54:55], v5, s[16:19], s24 offen
    s_mov_b32 s51, 1
interleave_layers__linear_attn_block__memory_aug_recurrent_mem_tr__prompt_kernel_k15:
    s_barrier
    ds_read_b128 v[148:151], v9
    ds_read_b128 v[152:155], v9 offset:256
    ds_read_b128 v[56:59], v7 offset:0
    ds_read_b128 v[60:63], v7 offset:20480
    ds_read_b128 v[64:67], v7 offset:1024
    ds_read_b128 v[68:71], v7 offset:21504
    ds_read_b128 v[72:75], v7 offset:2048
    ds_read_b128 v[76:79], v7 offset:22528
    s_waitcnt lgkmcnt(6)
    v_add_f32 v148, v148, v150
    v_add_f32 v149, v149, v151
    v_mul_f32 v148, 0x3acccccd, v148
    v_mul_f32 v150, v148, v148
    v_mov_b32 v151, 0x3acccccd
    v_fma_f32 v149, v149, v151, -v150
    v_max_f32 v149, 0, v149
    v_add_f32 v149, 0x3727c5ac, v149
    v_rsq_f32 v144, v149
    s_nop 0
    v_mul_f32 v145, v148, v144
    v_sub_f32 v145, 0, v145
    v_add_f32 v152, v152, v154
    v_add_f32 v153, v153, v155
    v_mul_f32 v152, 0x3acccccd, v152
    v_mul_f32 v154, v152, v152
    v_mov_b32 v155, 0x3acccccd
    v_fma_f32 v153, v153, v155, -v154
    v_max_f32 v153, 0, v153
    v_add_f32 v153, 0x3727c5ac, v153
    v_rsq_f32 v146, v153
    s_nop 0
    v_mul_f32 v147, v152, v146
    v_sub_f32 v147, 0, v147
    ds_read_b128 v[80:83], v7 offset:3072
    ds_read_b128 v[84:87], v7 offset:23552
    s_waitcnt lgkmcnt(6)
    v_mfma_f32_16x16x32_bf16 v[88:91], a[0:3], v[56:59], 0
    v_mfma_f32_16x16x32_bf16 v[96:99], a[80:83], v[56:59], 0
    v_mfma_f32_16x16x32_bf16 v[104:107], a[160:163], v[56:59], 0
    v_mfma_f32_16x16x32_bf16 v[112:115], v[176:179], v[56:59], 0
    v_mfma_f32_16x16x32_bf16 v[92:95], a[0:3], v[60:63], 0
    v_mfma_f32_16x16x32_bf16 v[100:103], a[80:83], v[60:63], 0
    v_mfma_f32_16x16x32_bf16 v[108:111], a[160:163], v[60:63], 0
    v_mfma_f32_16x16x32_bf16 v[116:119], v[176:179], v[60:63], 0
    ds_read_b128 v[56:59], v7 offset:4096
    ds_read_b128 v[60:63], v7 offset:24576
    s_waitcnt lgkmcnt(6)
    v_mfma_f32_16x16x32_bf16 v[88:91], a[4:7], v[64:67], v[88:91]
    v_mfma_f32_16x16x32_bf16 v[96:99], a[84:87], v[64:67], v[96:99]
    v_mfma_f32_16x16x32_bf16 v[104:107], a[164:167], v[64:67], v[104:107]
    v_mfma_f32_16x16x32_bf16 v[112:115], v[180:183], v[64:67], v[112:115]
    v_mfma_f32_16x16x32_bf16 v[92:95], a[4:7], v[68:71], v[92:95]
    v_mfma_f32_16x16x32_bf16 v[100:103], a[84:87], v[68:71], v[100:103]
    v_mfma_f32_16x16x32_bf16 v[108:111], a[164:167], v[68:71], v[108:111]
    v_mfma_f32_16x16x32_bf16 v[116:119], v[180:183], v[68:71], v[116:119]
    ds_read_b128 v[64:67], v7 offset:5120
    ds_read_b128 v[68:71], v7 offset:25600
    s_waitcnt lgkmcnt(6)
    v_mfma_f32_16x16x32_bf16 v[88:91], a[8:11], v[72:75], v[88:91]
    v_mfma_f32_16x16x32_bf16 v[96:99], a[88:91], v[72:75], v[96:99]
    v_mfma_f32_16x16x32_bf16 v[104:107], a[168:171], v[72:75], v[104:107]
    v_mfma_f32_16x16x32_bf16 v[112:115], v[184:187], v[72:75], v[112:115]
    v_mfma_f32_16x16x32_bf16 v[92:95], a[8:11], v[76:79], v[92:95]
    v_mfma_f32_16x16x32_bf16 v[100:103], a[88:91], v[76:79], v[100:103]
    v_mfma_f32_16x16x32_bf16 v[108:111], a[168:171], v[76:79], v[108:111]
    v_mfma_f32_16x16x32_bf16 v[116:119], v[184:187], v[76:79], v[116:119]
    ds_read_b128 v[72:75], v7 offset:6144
    ds_read_b128 v[76:79], v7 offset:26624
    s_waitcnt lgkmcnt(6)
    v_mfma_f32_16x16x32_bf16 v[88:91], a[12:15], v[80:83], v[88:91]
    v_mfma_f32_16x16x32_bf16 v[96:99], a[92:95], v[80:83], v[96:99]
    v_mfma_f32_16x16x32_bf16 v[104:107], a[172:175], v[80:83], v[104:107]
    v_mfma_f32_16x16x32_bf16 v[112:115], v[188:191], v[80:83], v[112:115]
    v_mfma_f32_16x16x32_bf16 v[92:95], a[12:15], v[84:87], v[92:95]
    v_mfma_f32_16x16x32_bf16 v[100:103], a[92:95], v[84:87], v[100:103]
    v_mfma_f32_16x16x32_bf16 v[108:111], a[172:175], v[84:87], v[108:111]
    v_mfma_f32_16x16x32_bf16 v[116:119], v[188:191], v[84:87], v[116:119]
    ds_read_b128 v[80:83], v7 offset:7168
    ds_read_b128 v[84:87], v7 offset:27648
    s_waitcnt lgkmcnt(6)
    v_mfma_f32_16x16x32_bf16 v[88:91], a[16:19], v[56:59], v[88:91]
    v_mfma_f32_16x16x32_bf16 v[96:99], a[96:99], v[56:59], v[96:99]
    v_mfma_f32_16x16x32_bf16 v[104:107], a[176:179], v[56:59], v[104:107]
    v_mfma_f32_16x16x32_bf16 v[112:115], v[192:195], v[56:59], v[112:115]
    v_mfma_f32_16x16x32_bf16 v[92:95], a[16:19], v[60:63], v[92:95]
    v_mfma_f32_16x16x32_bf16 v[100:103], a[96:99], v[60:63], v[100:103]
    v_mfma_f32_16x16x32_bf16 v[108:111], a[176:179], v[60:63], v[108:111]
    v_mfma_f32_16x16x32_bf16 v[116:119], v[192:195], v[60:63], v[116:119]
    ds_read_b128 v[56:59], v7 offset:8192
    ds_read_b128 v[60:63], v7 offset:28672
    s_waitcnt lgkmcnt(6)
    v_mfma_f32_16x16x32_bf16 v[88:91], a[20:23], v[64:67], v[88:91]
    v_mfma_f32_16x16x32_bf16 v[96:99], a[100:103], v[64:67], v[96:99]
    v_mfma_f32_16x16x32_bf16 v[104:107], a[180:183], v[64:67], v[104:107]
    v_mfma_f32_16x16x32_bf16 v[112:115], v[196:199], v[64:67], v[112:115]
    v_mfma_f32_16x16x32_bf16 v[92:95], a[20:23], v[68:71], v[92:95]
    v_mfma_f32_16x16x32_bf16 v[100:103], a[100:103], v[68:71], v[100:103]
    v_mfma_f32_16x16x32_bf16 v[108:111], a[180:183], v[68:71], v[108:111]
    v_mfma_f32_16x16x32_bf16 v[116:119], v[196:199], v[68:71], v[116:119]
    ds_read_b128 v[64:67], v7 offset:9216
    ds_read_b128 v[68:71], v7 offset:29696
    s_waitcnt lgkmcnt(6)
    v_mfma_f32_16x16x32_bf16 v[88:91], a[24:27], v[72:75], v[88:91]
    v_mfma_f32_16x16x32_bf16 v[96:99], a[104:107], v[72:75], v[96:99]
    v_mfma_f32_16x16x32_bf16 v[104:107], a[184:187], v[72:75], v[104:107]
    v_mfma_f32_16x16x32_bf16 v[112:115], v[200:203], v[72:75], v[112:115]
    v_mfma_f32_16x16x32_bf16 v[92:95], a[24:27], v[76:79], v[92:95]
    v_mfma_f32_16x16x32_bf16 v[100:103], a[104:107], v[76:79], v[100:103]
    v_mfma_f32_16x16x32_bf16 v[108:111], a[184:187], v[76:79], v[108:111]
    v_mfma_f32_16x16x32_bf16 v[116:119], v[200:203], v[76:79], v[116:119]
    ds_read_b128 v[72:75], v7 offset:10240
    ds_read_b128 v[76:79], v7 offset:30720
    s_waitcnt lgkmcnt(6)
    v_mfma_f32_16x16x32_bf16 v[88:91], a[28:31], v[80:83], v[88:91]
    v_mfma_f32_16x16x32_bf16 v[96:99], a[108:111], v[80:83], v[96:99]
    v_mfma_f32_16x16x32_bf16 v[104:107], a[188:191], v[80:83], v[104:107]
    v_mfma_f32_16x16x32_bf16 v[112:115], v[204:207], v[80:83], v[112:115]
    v_mfma_f32_16x16x32_bf16 v[92:95], a[28:31], v[84:87], v[92:95]
    v_mfma_f32_16x16x32_bf16 v[100:103], a[108:111], v[84:87], v[100:103]
    v_mfma_f32_16x16x32_bf16 v[108:111], a[188:191], v[84:87], v[108:111]
    v_mfma_f32_16x16x32_bf16 v[116:119], v[204:207], v[84:87], v[116:119]
    ds_read_b128 v[80:83], v7 offset:11264
    ds_read_b128 v[84:87], v7 offset:31744
    s_waitcnt lgkmcnt(6)
    v_mfma_f32_16x16x32_bf16 v[88:91], a[32:35], v[56:59], v[88:91]
    v_mfma_f32_16x16x32_bf16 v[96:99], a[112:115], v[56:59], v[96:99]
    v_mfma_f32_16x16x32_bf16 v[104:107], a[192:195], v[56:59], v[104:107]
    v_mfma_f32_16x16x32_bf16 v[112:115], v[208:211], v[56:59], v[112:115]
    v_mfma_f32_16x16x32_bf16 v[92:95], a[32:35], v[60:63], v[92:95]
    v_mfma_f32_16x16x32_bf16 v[100:103], a[112:115], v[60:63], v[100:103]
    v_mfma_f32_16x16x32_bf16 v[108:111], a[192:195], v[60:63], v[108:111]
    v_mfma_f32_16x16x32_bf16 v[116:119], v[208:211], v[60:63], v[116:119]
    ds_read_b128 v[56:59], v7 offset:12288
    ds_read_b128 v[60:63], v7 offset:32768
    s_waitcnt lgkmcnt(6)
    v_mfma_f32_16x16x32_bf16 v[88:91], a[36:39], v[64:67], v[88:91]
    v_mfma_f32_16x16x32_bf16 v[96:99], a[116:119], v[64:67], v[96:99]
    v_mfma_f32_16x16x32_bf16 v[104:107], a[196:199], v[64:67], v[104:107]
    v_mfma_f32_16x16x32_bf16 v[112:115], v[212:215], v[64:67], v[112:115]
    v_mfma_f32_16x16x32_bf16 v[92:95], a[36:39], v[68:71], v[92:95]
    v_mfma_f32_16x16x32_bf16 v[100:103], a[116:119], v[68:71], v[100:103]
    v_mfma_f32_16x16x32_bf16 v[108:111], a[196:199], v[68:71], v[108:111]
    v_mfma_f32_16x16x32_bf16 v[116:119], v[212:215], v[68:71], v[116:119]
    ds_read_b128 v[64:67], v7 offset:13312
    ds_read_b128 v[68:71], v7 offset:33792
    s_waitcnt lgkmcnt(6)
    v_mfma_f32_16x16x32_bf16 v[88:91], a[40:43], v[72:75], v[88:91]
    v_mfma_f32_16x16x32_bf16 v[96:99], a[120:123], v[72:75], v[96:99]
    v_mfma_f32_16x16x32_bf16 v[104:107], a[200:203], v[72:75], v[104:107]
    v_mfma_f32_16x16x32_bf16 v[112:115], v[216:219], v[72:75], v[112:115]
    v_mfma_f32_16x16x32_bf16 v[92:95], a[40:43], v[76:79], v[92:95]
    v_mfma_f32_16x16x32_bf16 v[100:103], a[120:123], v[76:79], v[100:103]
    v_mfma_f32_16x16x32_bf16 v[108:111], a[200:203], v[76:79], v[108:111]
    v_mfma_f32_16x16x32_bf16 v[116:119], v[216:219], v[76:79], v[116:119]
    ds_read_b128 v[72:75], v7 offset:14336
    ds_read_b128 v[76:79], v7 offset:34816
    s_waitcnt lgkmcnt(6)
    v_mfma_f32_16x16x32_bf16 v[88:91], a[44:47], v[80:83], v[88:91]
    v_mfma_f32_16x16x32_bf16 v[96:99], a[124:127], v[80:83], v[96:99]
    v_mfma_f32_16x16x32_bf16 v[104:107], a[204:207], v[80:83], v[104:107]
    v_mfma_f32_16x16x32_bf16 v[112:115], v[220:223], v[80:83], v[112:115]
    v_mfma_f32_16x16x32_bf16 v[92:95], a[44:47], v[84:87], v[92:95]
    v_mfma_f32_16x16x32_bf16 v[100:103], a[124:127], v[84:87], v[100:103]
    v_mfma_f32_16x16x32_bf16 v[108:111], a[204:207], v[84:87], v[108:111]
    v_mfma_f32_16x16x32_bf16 v[116:119], v[220:223], v[84:87], v[116:119]
    ds_read_b128 v[80:83], v7 offset:15360
    ds_read_b128 v[84:87], v7 offset:35840
    s_waitcnt lgkmcnt(6)
    v_mfma_f32_16x16x32_bf16 v[88:91], a[48:51], v[56:59], v[88:91]
    v_mfma_f32_16x16x32_bf16 v[96:99], a[128:131], v[56:59], v[96:99]
    v_mfma_f32_16x16x32_bf16 v[104:107], a[208:211], v[56:59], v[104:107]
    v_mfma_f32_16x16x32_bf16 v[112:115], v[224:227], v[56:59], v[112:115]
    v_mfma_f32_16x16x32_bf16 v[92:95], a[48:51], v[60:63], v[92:95]
    v_mfma_f32_16x16x32_bf16 v[100:103], a[128:131], v[60:63], v[100:103]
    v_mfma_f32_16x16x32_bf16 v[108:111], a[208:211], v[60:63], v[108:111]
    v_mfma_f32_16x16x32_bf16 v[116:119], v[224:227], v[60:63], v[116:119]
    ds_read_b128 v[56:59], v7 offset:16384
    ds_read_b128 v[60:63], v7 offset:36864
    s_waitcnt lgkmcnt(6)
    v_mfma_f32_16x16x32_bf16 v[88:91], a[52:55], v[64:67], v[88:91]
    v_mfma_f32_16x16x32_bf16 v[96:99], a[132:135], v[64:67], v[96:99]
    v_mfma_f32_16x16x32_bf16 v[104:107], a[212:215], v[64:67], v[104:107]
    v_mfma_f32_16x16x32_bf16 v[112:115], v[228:231], v[64:67], v[112:115]
    v_mfma_f32_16x16x32_bf16 v[92:95], a[52:55], v[68:71], v[92:95]
    v_mfma_f32_16x16x32_bf16 v[100:103], a[132:135], v[68:71], v[100:103]
    v_mfma_f32_16x16x32_bf16 v[108:111], a[212:215], v[68:71], v[108:111]
    v_mfma_f32_16x16x32_bf16 v[116:119], v[228:231], v[68:71], v[116:119]
    ds_read_b128 v[64:67], v7 offset:17408
    ds_read_b128 v[68:71], v7 offset:37888
    s_waitcnt lgkmcnt(6)
    v_mfma_f32_16x16x32_bf16 v[88:91], a[56:59], v[72:75], v[88:91]
    v_mfma_f32_16x16x32_bf16 v[96:99], a[136:139], v[72:75], v[96:99]
    v_mfma_f32_16x16x32_bf16 v[104:107], a[216:219], v[72:75], v[104:107]
    v_mfma_f32_16x16x32_bf16 v[112:115], v[232:235], v[72:75], v[112:115]
    v_mfma_f32_16x16x32_bf16 v[92:95], a[56:59], v[76:79], v[92:95]
    v_mfma_f32_16x16x32_bf16 v[100:103], a[136:139], v[76:79], v[100:103]
    v_mfma_f32_16x16x32_bf16 v[108:111], a[216:219], v[76:79], v[108:111]
    v_mfma_f32_16x16x32_bf16 v[116:119], v[232:235], v[76:79], v[116:119]
    ds_read_b128 v[72:75], v7 offset:18432
    ds_read_b128 v[76:79], v7 offset:38912
    s_waitcnt lgkmcnt(6)
    v_mfma_f32_16x16x32_bf16 v[88:91], a[60:63], v[80:83], v[88:91]
    v_mfma_f32_16x16x32_bf16 v[96:99], a[140:143], v[80:83], v[96:99]
    v_mfma_f32_16x16x32_bf16 v[104:107], a[220:223], v[80:83], v[104:107]
    v_mfma_f32_16x16x32_bf16 v[112:115], v[236:239], v[80:83], v[112:115]
    v_mfma_f32_16x16x32_bf16 v[92:95], a[60:63], v[84:87], v[92:95]
    v_mfma_f32_16x16x32_bf16 v[100:103], a[140:143], v[84:87], v[100:103]
    v_mfma_f32_16x16x32_bf16 v[108:111], a[220:223], v[84:87], v[108:111]
    v_mfma_f32_16x16x32_bf16 v[116:119], v[236:239], v[84:87], v[116:119]
    ds_read_b128 v[80:83], v7 offset:19456
    ds_read_b128 v[84:87], v7 offset:39936
    s_waitcnt lgkmcnt(6)
    v_mfma_f32_16x16x32_bf16 v[88:91], a[64:67], v[56:59], v[88:91]
    v_mfma_f32_16x16x32_bf16 v[96:99], a[144:147], v[56:59], v[96:99]
    v_mfma_f32_16x16x32_bf16 v[104:107], a[224:227], v[56:59], v[104:107]
    v_mfma_f32_16x16x32_bf16 v[112:115], v[240:243], v[56:59], v[112:115]
    v_mfma_f32_16x16x32_bf16 v[92:95], a[64:67], v[60:63], v[92:95]
    v_mfma_f32_16x16x32_bf16 v[100:103], a[144:147], v[60:63], v[100:103]
    v_mfma_f32_16x16x32_bf16 v[108:111], a[224:227], v[60:63], v[108:111]
    v_mfma_f32_16x16x32_bf16 v[116:119], v[240:243], v[60:63], v[116:119]
    s_waitcnt lgkmcnt(4)
    v_mfma_f32_16x16x32_bf16 v[88:91], a[68:71], v[64:67], v[88:91]
    v_mfma_f32_16x16x32_bf16 v[96:99], a[148:151], v[64:67], v[96:99]
    v_mfma_f32_16x16x32_bf16 v[104:107], a[228:231], v[64:67], v[104:107]
    v_mfma_f32_16x16x32_bf16 v[112:115], v[244:247], v[64:67], v[112:115]
    v_mfma_f32_16x16x32_bf16 v[92:95], a[68:71], v[68:71], v[92:95]
    v_mfma_f32_16x16x32_bf16 v[100:103], a[148:151], v[68:71], v[100:103]
    v_mfma_f32_16x16x32_bf16 v[108:111], a[228:231], v[68:71], v[108:111]
    v_mfma_f32_16x16x32_bf16 v[116:119], v[244:247], v[68:71], v[116:119]
    s_waitcnt lgkmcnt(2)
    v_mfma_f32_16x16x32_bf16 v[88:91], a[72:75], v[72:75], v[88:91]
    v_mfma_f32_16x16x32_bf16 v[96:99], a[152:155], v[72:75], v[96:99]
    v_mfma_f32_16x16x32_bf16 v[104:107], a[232:235], v[72:75], v[104:107]
    v_mfma_f32_16x16x32_bf16 v[112:115], v[248:251], v[72:75], v[112:115]
    v_mfma_f32_16x16x32_bf16 v[92:95], a[72:75], v[76:79], v[92:95]
    v_mfma_f32_16x16x32_bf16 v[100:103], a[152:155], v[76:79], v[100:103]
    v_mfma_f32_16x16x32_bf16 v[108:111], a[232:235], v[76:79], v[108:111]
    v_mfma_f32_16x16x32_bf16 v[116:119], v[248:251], v[76:79], v[116:119]
    s_waitcnt lgkmcnt(0)
    v_mfma_f32_16x16x32_bf16 v[88:91], a[76:79], v[80:83], v[88:91]
    v_mfma_f32_16x16x32_bf16 v[96:99], a[156:159], v[80:83], v[96:99]
    v_mfma_f32_16x16x32_bf16 v[104:107], a[236:239], v[80:83], v[104:107]
    v_mfma_f32_16x16x32_bf16 v[112:115], v[252:255], v[80:83], v[112:115]
    v_mfma_f32_16x16x32_bf16 v[92:95], a[76:79], v[84:87], v[92:95]
    v_mfma_f32_16x16x32_bf16 v[100:103], a[156:159], v[84:87], v[100:103]
    v_mfma_f32_16x16x32_bf16 v[108:111], a[236:239], v[84:87], v[108:111]
    v_mfma_f32_16x16x32_bf16 v[116:119], v[252:255], v[84:87], v[116:119]
    v_pk_mul_f32 v[148:149], v[156:157], v[144:145] op_sel:[0,1] op_sel_hi:[1,1]
    v_pk_mul_f32 v[150:151], v[158:159], v[144:145] op_sel:[0,1] op_sel_hi:[1,1]
    v_pk_fma_f32 v[88:89], v[88:89], v[144:145], v[148:149] op_sel:[0,0,0] op_sel_hi:[1,0,1]
    v_pk_fma_f32 v[90:91], v[90:91], v[144:145], v[150:151] op_sel:[0,0,0] op_sel_hi:[1,0,1]
    v_pk_mul_f32 v[148:149], v[156:157], v[146:147] op_sel:[0,1] op_sel_hi:[1,1]
    v_pk_mul_f32 v[150:151], v[158:159], v[146:147] op_sel:[0,1] op_sel_hi:[1,1]
    v_pk_fma_f32 v[92:93], v[92:93], v[146:147], v[148:149] op_sel:[0,0,0] op_sel_hi:[1,0,1]
    v_pk_fma_f32 v[94:95], v[94:95], v[146:147], v[150:151] op_sel:[0,0,0] op_sel_hi:[1,0,1]
    v_pk_mul_f32 v[148:149], v[160:161], v[144:145] op_sel:[0,1] op_sel_hi:[1,1]
    v_pk_mul_f32 v[150:151], v[162:163], v[144:145] op_sel:[0,1] op_sel_hi:[1,1]
    v_pk_fma_f32 v[96:97], v[96:97], v[144:145], v[148:149] op_sel:[0,0,0] op_sel_hi:[1,0,1]
    v_pk_fma_f32 v[98:99], v[98:99], v[144:145], v[150:151] op_sel:[0,0,0] op_sel_hi:[1,0,1]
    v_pk_mul_f32 v[148:149], v[160:161], v[146:147] op_sel:[0,1] op_sel_hi:[1,1]
    v_pk_mul_f32 v[150:151], v[162:163], v[146:147] op_sel:[0,1] op_sel_hi:[1,1]
    v_pk_fma_f32 v[100:101], v[100:101], v[146:147], v[148:149] op_sel:[0,0,0] op_sel_hi:[1,0,1]
    v_pk_fma_f32 v[102:103], v[102:103], v[146:147], v[150:151] op_sel:[0,0,0] op_sel_hi:[1,0,1]
    v_pk_mul_f32 v[148:149], v[164:165], v[144:145] op_sel:[0,1] op_sel_hi:[1,1]
    v_pk_mul_f32 v[150:151], v[166:167], v[144:145] op_sel:[0,1] op_sel_hi:[1,1]
    v_pk_fma_f32 v[104:105], v[104:105], v[144:145], v[148:149] op_sel:[0,0,0] op_sel_hi:[1,0,1]
    v_pk_fma_f32 v[106:107], v[106:107], v[144:145], v[150:151] op_sel:[0,0,0] op_sel_hi:[1,0,1]
    v_pk_mul_f32 v[148:149], v[164:165], v[146:147] op_sel:[0,1] op_sel_hi:[1,1]
    v_pk_mul_f32 v[150:151], v[166:167], v[146:147] op_sel:[0,1] op_sel_hi:[1,1]
    v_pk_fma_f32 v[108:109], v[108:109], v[146:147], v[148:149] op_sel:[0,0,0] op_sel_hi:[1,0,1]
    v_pk_fma_f32 v[110:111], v[110:111], v[146:147], v[150:151] op_sel:[0,0,0] op_sel_hi:[1,0,1]
    v_pk_mul_f32 v[148:149], v[168:169], v[144:145] op_sel:[0,1] op_sel_hi:[1,1]
    v_pk_mul_f32 v[150:151], v[170:171], v[144:145] op_sel:[0,1] op_sel_hi:[1,1]
    v_pk_fma_f32 v[112:113], v[112:113], v[144:145], v[148:149] op_sel:[0,0,0] op_sel_hi:[1,0,1]
    v_pk_fma_f32 v[114:115], v[114:115], v[144:145], v[150:151] op_sel:[0,0,0] op_sel_hi:[1,0,1]
    v_pk_mul_f32 v[148:149], v[168:169], v[146:147] op_sel:[0,1] op_sel_hi:[1,1]
    v_pk_mul_f32 v[150:151], v[170:171], v[146:147] op_sel:[0,1] op_sel_hi:[1,1]
    v_pk_fma_f32 v[116:117], v[116:117], v[146:147], v[148:149] op_sel:[0,0,0] op_sel_hi:[1,0,1]
    v_pk_fma_f32 v[118:119], v[118:119], v[146:147], v[150:151] op_sel:[0,0,0] op_sel_hi:[1,0,1]
    s_add_u32 s25, s43, 20480
    s_cmp_ge_u32 s3, 2
    s_cbranch_scc1 interleave_layers__linear_attn_block__memory_aug_recurrent_mem_tr__prompt_kernel_k1_e2
    s_lshl_b32 s24, s3, 6
    v_add_u32 v15, s24, v10
    v_cvt_pk_bf16_f32 v64, v104, v105
    v_cvt_pk_bf16_f32 v65, v106, v107
    ds_write_b64 v15, v[64:65] offset:160
    v_cvt_pk_bf16_f32 v66, v108, v109
    v_cvt_pk_bf16_f32 v67, v110, v111
    ds_write_b64 v15, v[66:67] offset:5536
    v_cvt_pk_bf16_f32 v68, v112, v113
    v_cvt_pk_bf16_f32 v69, v114, v115
    ds_write_b64 v15, v[68:69] offset:192
    v_cvt_pk_bf16_f32 v70, v116, v117
    v_cvt_pk_bf16_f32 v71, v118, v119
    ds_write_b64 v15, v[70:71] offset:5568
    v_min_f32 v148, 0, v88
    v_min_f32 v149, 0, v89
    v_pk_mul_f32 v[148:149], v[148:149], s[52:53]
    v_min_f32 v150, 0, v90
    v_min_f32 v151, 0, v91
    v_pk_mul_f32 v[150:151], v[150:151], s[52:53]
    v_exp_f32 v148, v148
    v_exp_f32 v149, v149
    v_exp_f32 v150, v150
    v_exp_f32 v151, v151
    v_max_f32 v88, 0, v88
    v_max_f32 v89, 0, v89
    v_max_f32 v90, 0, v90
    v_max_f32 v91, 0, v91
    v_pk_add_f32 v[88:89], v[88:89], v[148:149]
    v_pk_add_f32 v[90:91], v[90:91], v[150:151]
    v_pk_add_f32 v[88:89], v[88:89], s[54:55]
    v_pk_add_f32 v[90:91], v[90:91], s[54:55]
    v_min_f32 v148, 0, v96
    v_min_f32 v149, 0, v97
    v_pk_mul_f32 v[148:149], v[148:149], s[52:53]
    v_min_f32 v150, 0, v98
    v_min_f32 v151, 0, v99
    v_pk_mul_f32 v[150:151], v[150:151], s[52:53]
    v_exp_f32 v148, v148
    v_exp_f32 v149, v149
    v_exp_f32 v150, v150
    v_exp_f32 v151, v151
    v_max_f32 v96, 0, v96
    v_max_f32 v97, 0, v97
    v_max_f32 v98, 0, v98
    v_max_f32 v99, 0, v99
    v_pk_add_f32 v[96:97], v[96:97], v[148:149]
    v_pk_add_f32 v[98:99], v[98:99], v[150:151]
    v_pk_add_f32 v[96:97], v[96:97], s[54:55]
    v_pk_add_f32 v[98:99], v[98:99], s[54:55]
    v_cvt_pk_bf16_f32 v56, v88, v89
    v_cvt_pk_bf16_f32 v57, v90, v91
    v_cvt_pk_bf16_f32 v58, v96, v97
    v_cvt_pk_bf16_f32 v59, v98, v99
    buffer_store_dwordx4 v[56:59], v12, s[8:11], s43 offen sc1
    v_min_f32 v148, 0, v92
    v_min_f32 v149, 0, v93
    v_pk_mul_f32 v[148:149], v[148:149], s[52:53]
    v_min_f32 v150, 0, v94
    v_min_f32 v151, 0, v95
    v_pk_mul_f32 v[150:151], v[150:151], s[52:53]
    v_exp_f32 v148, v148
    v_exp_f32 v149, v149
    v_exp_f32 v150, v150
    v_exp_f32 v151, v151
    v_max_f32 v92, 0, v92
    v_max_f32 v93, 0, v93
    v_max_f32 v94, 0, v94
    v_max_f32 v95, 0, v95
    v_pk_add_f32 v[92:93], v[92:93], v[148:149]
    v_pk_add_f32 v[94:95], v[94:95], v[150:151]
    v_pk_add_f32 v[92:93], v[92:93], s[54:55]
    v_pk_add_f32 v[94:95], v[94:95], s[54:55]
    v_min_f32 v148, 0, v100
    v_min_f32 v149, 0, v101
    v_pk_mul_f32 v[148:149], v[148:149], s[52:53]
    v_min_f32 v150, 0, v102
    v_min_f32 v151, 0, v103
    v_pk_mul_f32 v[150:151], v[150:151], s[52:53]
    v_exp_f32 v148, v148
    v_exp_f32 v149, v149
    v_exp_f32 v150, v150
    v_exp_f32 v151, v151
    v_max_f32 v100, 0, v100
    v_max_f32 v101, 0, v101
    v_max_f32 v102, 0, v102
    v_max_f32 v103, 0, v103
    v_pk_add_f32 v[100:101], v[100:101], v[148:149]
    v_pk_add_f32 v[102:103], v[102:103], v[150:151]
    v_pk_add_f32 v[100:101], v[100:101], s[54:55]
    v_pk_add_f32 v[102:103], v[102:103], s[54:55]
    v_cvt_pk_bf16_f32 v60, v92, v93
    v_cvt_pk_bf16_f32 v61, v94, v95
    v_cvt_pk_bf16_f32 v62, v100, v101
    v_cvt_pk_bf16_f32 v63, v102, v103
    buffer_store_dwordx4 v[60:63], v12, s[8:11], s25 offen sc1
    s_branch interleave_layers__linear_attn_block__memory_aug_recurrent_mem_tr__prompt_kernel_k1_ej
interleave_layers__linear_attn_block__memory_aug_recurrent_mem_tr__prompt_kernel_k1_e2:
    s_cmp_eq_u32 s3, 3
    s_cbranch_scc1 interleave_layers__linear_attn_block__memory_aug_recurrent_mem_tr__prompt_kernel_k1_e3
    v_cvt_pk_bf16_f32 v68, v112, v113
    v_cvt_pk_bf16_f32 v69, v114, v115
    ds_write_b64 v10, v[68:69] offset:288
    v_cvt_pk_bf16_f32 v70, v116, v117
    v_cvt_pk_bf16_f32 v71, v118, v119
    ds_write_b64 v10, v[70:71] offset:5664
    v_min_f32 v148, 0, v96
    v_min_f32 v149, 0, v97
    v_pk_mul_f32 v[148:149], v[148:149], s[52:53]
    v_min_f32 v150, 0, v98
    v_min_f32 v151, 0, v99
    v_pk_mul_f32 v[150:151], v[150:151], s[52:53]
    v_exp_f32 v148, v148
    v_exp_f32 v149, v149
    v_exp_f32 v150, v150
    v_exp_f32 v151, v151
    v_max_f32 v96, 0, v96
    v_max_f32 v97, 0, v97
    v_max_f32 v98, 0, v98
    v_max_f32 v99, 0, v99
    v_pk_add_f32 v[96:97], v[96:97], v[148:149]
    v_pk_add_f32 v[98:99], v[98:99], v[150:151]
    v_pk_add_f32 v[96:97], v[96:97], s[54:55]
    v_pk_add_f32 v[98:99], v[98:99], s[54:55]
    v_min_f32 v148, 0, v104
    v_min_f32 v149, 0, v105
    v_pk_mul_f32 v[148:149], v[148:149], s[52:53]
    v_min_f32 v150, 0, v106
    v_min_f32 v151, 0, v107
    v_pk_mul_f32 v[150:151], v[150:151], s[52:53]
    v_exp_f32 v148, v148
    v_exp_f32 v149, v149
    v_exp_f32 v150, v150
    v_exp_f32 v151, v151
    v_max_f32 v104, 0, v104
    v_max_f32 v105, 0, v105
    v_max_f32 v106, 0, v106
    v_max_f32 v107, 0, v107
    v_pk_add_f32 v[104:105], v[104:105], v[148:149]
    v_pk_add_f32 v[106:107], v[106:107], v[150:151]
    v_pk_add_f32 v[104:105], v[104:105], s[54:55]
    v_pk_add_f32 v[106:107], v[106:107], s[54:55]
    v_min_f32 v148, 0, v100
    v_min_f32 v149, 0, v101
    v_pk_mul_f32 v[148:149], v[148:149], s[52:53]
    v_min_f32 v150, 0, v102
    v_min_f32 v151, 0, v103
    v_pk_mul_f32 v[150:151], v[150:151], s[52:53]
    v_exp_f32 v148, v148
    v_exp_f32 v149, v149
    v_exp_f32 v150, v150
    v_exp_f32 v151, v151
    v_max_f32 v100, 0, v100
    v_max_f32 v101, 0, v101
    v_max_f32 v102, 0, v102
    v_max_f32 v103, 0, v103
    v_pk_add_f32 v[100:101], v[100:101], v[148:149]
    v_pk_add_f32 v[102:103], v[102:103], v[150:151]
    v_pk_add_f32 v[100:101], v[100:101], s[54:55]
    v_pk_add_f32 v[102:103], v[102:103], s[54:55]
    v_min_f32 v148, 0, v108
    v_min_f32 v149, 0, v109
    v_pk_mul_f32 v[148:149], v[148:149], s[52:53]
    v_min_f32 v150, 0, v110
    v_min_f32 v151, 0, v111
    v_pk_mul_f32 v[150:151], v[150:151], s[52:53]
    v_exp_f32 v148, v148
    v_exp_f32 v149, v149
    v_exp_f32 v150, v150
    v_exp_f32 v151, v151
    v_max_f32 v108, 0, v108
    v_max_f32 v109, 0, v109
    v_max_f32 v110, 0, v110
    v_max_f32 v111, 0, v111
    v_pk_add_f32 v[108:109], v[108:109], v[148:149]
    v_pk_add_f32 v[110:111], v[110:111], v[150:151]
    v_pk_add_f32 v[108:109], v[108:109], s[54:55]
    v_pk_add_f32 v[110:111], v[110:111], s[54:55]
    v_cvt_pk_bf16_f32 v60, v96, v97
    v_cvt_pk_bf16_f32 v61, v98, v99
    ds_write_b64 v10, v[60:61] offset:0
    v_cvt_pk_bf16_f32 v62, v100, v101
    v_cvt_pk_bf16_f32 v63, v102, v103
    ds_write_b64 v10, v[62:63] offset:5376
    v_cvt_pk_bf16_f32 v64, v104, v105
    v_cvt_pk_bf16_f32 v65, v106, v107
    ds_write_b64 v10, v[64:65] offset:32
    v_cvt_pk_bf16_f32 v66, v108, v109
    v_cvt_pk_bf16_f32 v67, v110, v111
    ds_write_b64 v10, v[66:67] offset:5408
    v_min_f32 v148, 0, v88
    v_min_f32 v149, 0, v89
    v_pk_mul_f32 v[148:149], v[148:149], s[52:53]
    v_min_f32 v150, 0, v90
    v_min_f32 v151, 0, v91
    v_pk_mul_f32 v[150:151], v[150:151], s[52:53]
    v_exp_f32 v148, v148
    v_exp_f32 v149, v149
    v_exp_f32 v150, v150
    v_exp_f32 v151, v151
    v_max_f32 v88, 0, v88
    v_max_f32 v89, 0, v89
    v_max_f32 v90, 0, v90
    v_max_f32 v91, 0, v91
    v_pk_add_f32 v[88:89], v[88:89], v[148:149]
    v_pk_add_f32 v[90:91], v[90:91], v[150:151]
    v_pk_add_f32 v[88:89], v[88:89], s[54:55]
    v_pk_add_f32 v[90:91], v[90:91], s[54:55]
    v_cvt_pk_bf16_f32 v56, v88, v89
    v_cvt_pk_bf16_f32 v57, v90, v91
    buffer_store_dwordx2 v[56:57], v12, s[8:11], s43 offen sc1
    v_min_f32 v148, 0, v92
    v_min_f32 v149, 0, v93
    v_pk_mul_f32 v[148:149], v[148:149], s[52:53]
    v_min_f32 v150, 0, v94
    v_min_f32 v151, 0, v95
    v_pk_mul_f32 v[150:151], v[150:151], s[52:53]
    v_exp_f32 v148, v148
    v_exp_f32 v149, v149
    v_exp_f32 v150, v150
    v_exp_f32 v151, v151
    v_max_f32 v92, 0, v92
    v_max_f32 v93, 0, v93
    v_max_f32 v94, 0, v94
    v_max_f32 v95, 0, v95
    v_pk_add_f32 v[92:93], v[92:93], v[148:149]
    v_pk_add_f32 v[94:95], v[94:95], v[150:151]
    v_pk_add_f32 v[92:93], v[92:93], s[54:55]
    v_pk_add_f32 v[94:95], v[94:95], s[54:55]
    v_cvt_pk_bf16_f32 v58, v92, v93
    v_cvt_pk_bf16_f32 v59, v94, v95
    buffer_store_dwordx2 v[58:59], v12, s[8:11], s25 offen sc1
    s_branch interleave_layers__linear_attn_block__memory_aug_recurrent_mem_tr__prompt_kernel_k1_ej
interleave_layers__linear_attn_block__memory_aug_recurrent_mem_tr__prompt_kernel_k1_e3:
    v_min_f32 v148, 0, v88
    v_min_f32 v149, 0, v89
    v_pk_mul_f32 v[148:149], v[148:149], s[52:53]
    v_min_f32 v150, 0, v90
    v_min_f32 v151, 0, v91
    v_pk_mul_f32 v[150:151], v[150:151], s[52:53]
    v_exp_f32 v148, v148
    v_exp_f32 v149, v149
    v_exp_f32 v150, v150
    v_exp_f32 v151, v151
    v_max_f32 v88, 0, v88
    v_max_f32 v89, 0, v89
    v_max_f32 v90, 0, v90
    v_max_f32 v91, 0, v91
    v_pk_add_f32 v[88:89], v[88:89], v[148:149]
    v_pk_add_f32 v[90:91], v[90:91], v[150:151]
    v_pk_add_f32 v[88:89], v[88:89], s[54:55]
    v_pk_add_f32 v[90:91], v[90:91], s[54:55]
    v_min_f32 v148, 0, v92
    v_min_f32 v149, 0, v93
    v_pk_mul_f32 v[148:149], v[148:149], s[52:53]
    v_min_f32 v150, 0, v94
    v_min_f32 v151, 0, v95
    v_pk_mul_f32 v[150:151], v[150:151], s[52:53]
    v_exp_f32 v148, v148
    v_exp_f32 v149, v149
    v_exp_f32 v150, v150
    v_exp_f32 v151, v151
    v_max_f32 v92, 0, v92
    v_max_f32 v93, 0, v93
    v_max_f32 v94, 0, v94
    v_max_f32 v95, 0, v95
    v_pk_add_f32 v[92:93], v[92:93], v[148:149]
    v_pk_add_f32 v[94:95], v[94:95], v[150:151]
    v_pk_add_f32 v[92:93], v[92:93], s[54:55]
    v_pk_add_f32 v[94:95], v[94:95], s[54:55]
    v_cvt_pk_bf16_f32 v56, v88, v89
    v_cvt_pk_bf16_f32 v57, v90, v91
    ds_write_b64 v10, v[56:57] offset:64
    v_cvt_pk_bf16_f32 v58, v92, v93
    v_cvt_pk_bf16_f32 v59, v94, v95
    ds_write_b64 v10, v[58:59] offset:5440
    v_min_f32 v148, 0, v96
    v_min_f32 v149, 0, v97
    v_pk_mul_f32 v[148:149], v[148:149], s[52:53]
    v_min_f32 v150, 0, v98
    v_min_f32 v151, 0, v99
    v_pk_mul_f32 v[150:151], v[150:151], s[52:53]
    v_exp_f32 v148, v148
    v_exp_f32 v149, v149
    v_exp_f32 v150, v150
    v_exp_f32 v151, v151
    v_max_f32 v96, 0, v96
    v_max_f32 v97, 0, v97
    v_max_f32 v98, 0, v98
    v_max_f32 v99, 0, v99
    v_pk_add_f32 v[96:97], v[96:97], v[148:149]
    v_pk_add_f32 v[98:99], v[98:99], v[150:151]
    v_pk_add_f32 v[96:97], v[96:97], s[54:55]
    v_pk_add_f32 v[98:99], v[98:99], s[54:55]
    v_min_f32 v148, 0, v100
    v_min_f32 v149, 0, v101
    v_pk_mul_f32 v[148:149], v[148:149], s[52:53]
    v_min_f32 v150, 0, v102
    v_min_f32 v151, 0, v103
    v_pk_mul_f32 v[150:151], v[150:151], s[52:53]
    v_exp_f32 v148, v148
    v_exp_f32 v149, v149
    v_exp_f32 v150, v150
    v_exp_f32 v151, v151
    v_max_f32 v100, 0, v100
    v_max_f32 v101, 0, v101
    v_max_f32 v102, 0, v102
    v_max_f32 v103, 0, v103
    v_pk_add_f32 v[100:101], v[100:101], v[148:149]
    v_pk_add_f32 v[102:103], v[102:103], v[150:151]
    v_pk_add_f32 v[100:101], v[100:101], s[54:55]
    v_pk_add_f32 v[102:103], v[102:103], s[54:55]
    v_cvt_pk_bf16_f32 v60, v96, v97
    v_cvt_pk_bf16_f32 v61, v98, v99
    ds_write_b64 v10, v[60:61] offset:96
    v_cvt_pk_bf16_f32 v62, v100, v101
    v_cvt_pk_bf16_f32 v63, v102, v103
    ds_write_b64 v10, v[62:63] offset:5472
    v_min_f32 v148, 0, v104
    v_min_f32 v149, 0, v105
    v_pk_mul_f32 v[148:149], v[148:149], s[52:53]
    v_min_f32 v150, 0, v106
    v_min_f32 v151, 0, v107
    v_pk_mul_f32 v[150:151], v[150:151], s[52:53]
    v_exp_f32 v148, v148
    v_exp_f32 v149, v149
    v_exp_f32 v150, v150
    v_exp_f32 v151, v151
    v_max_f32 v104, 0, v104
    v_max_f32 v105, 0, v105
    v_max_f32 v106, 0, v106
    v_max_f32 v107, 0, v107
    v_pk_add_f32 v[104:105], v[104:105], v[148:149]
    v_pk_add_f32 v[106:107], v[106:107], v[150:151]
    v_pk_add_f32 v[104:105], v[104:105], s[54:55]
    v_pk_add_f32 v[106:107], v[106:107], s[54:55]
    v_min_f32 v148, 0, v108
    v_min_f32 v149, 0, v109
    v_pk_mul_f32 v[148:149], v[148:149], s[52:53]
    v_min_f32 v150, 0, v110
    v_min_f32 v151, 0, v111
    v_pk_mul_f32 v[150:151], v[150:151], s[52:53]
    v_exp_f32 v148, v148
    v_exp_f32 v149, v149
    v_exp_f32 v150, v150
    v_exp_f32 v151, v151
    v_max_f32 v108, 0, v108
    v_max_f32 v109, 0, v109
    v_max_f32 v110, 0, v110
    v_max_f32 v111, 0, v111
    v_pk_add_f32 v[108:109], v[108:109], v[148:149]
    v_pk_add_f32 v[110:111], v[110:111], v[150:151]
    v_pk_add_f32 v[108:109], v[108:109], s[54:55]
    v_pk_add_f32 v[110:111], v[110:111], s[54:55]
    v_cvt_pk_bf16_f32 v64, v104, v105
    v_cvt_pk_bf16_f32 v65, v106, v107
    ds_write_b64 v10, v[64:65] offset:128
    v_cvt_pk_bf16_f32 v66, v108, v109
    v_cvt_pk_bf16_f32 v67, v110, v111
    ds_write_b64 v10, v[66:67] offset:5504
interleave_layers__linear_attn_block__memory_aug_recurrent_mem_tr__prompt_kernel_k1_ej:
    s_waitcnt lgkmcnt(0)
    s_barrier
    ds_read_b64_tr_b16 v[72:73], v11 offset:0
    ds_read_b64_tr_b16 v[74:75], v11 offset:1344
    ds_read_b64_tr_b16 v[76:77], v11 offset:32
    ds_read_b64_tr_b16 v[78:79], v11 offset:1376
    ds_read_b64_tr_b16 v[80:81], v11 offset:160
    ds_read_b64_tr_b16 v[82:83], v11 offset:1504
    ds_read_b64_tr_b16 v[84:85], v11 offset:192
    ds_read_b64_tr_b16 v[86:87], v11 offset:1536
    s_waitcnt lgkmcnt(0)
    v_mfma_f32_16x16x32_bf16 v[120:123], v[72:75], v[84:87], v[120:123]
    v_mfma_f32_16x16x32_bf16 v[124:127], v[76:79], v[80:83], v[124:127]
    v_mfma_f32_16x16x32_bf16 v[128:131], v[76:79], v[84:87], v[128:131]
    v_mfma_f32_16x16x32_bf16 v[132:135], v[76:79], v[172:175], v[132:135]
    v_mfma_f32_16x16x32_bf16 v[136:139], v[72:75], v[80:83], v[136:139]
    v_mfma_f32_16x16x32_bf16 v[140:143], v[72:75], v[172:175], v[140:143]
    s_add_u32 s43, s43, s42
    s_add_u32 s48, s48, s49
    s_sub_u32 s40, s40, 1
    s_cmp_gt_u32 s40, 0
    s_cbranch_scc1 interleave_layers__linear_attn_block__memory_aug_recurrent_mem_tr__prompt_kernel_k1_seg
    s_cmp_eq_u32 s92, 0
    s_cbranch_scc0 interleave_layers__linear_attn_block__memory_aug_recurrent_mem_tr__prompt_kernel_ri7
    v_mov_b32 v15, 0
    buffer_load_dword v14, v15, s[72:75], 0 offen sc1
interleave_layers__linear_attn_block__memory_aug_recurrent_mem_tr__prompt_kernel_ri7:
    s_mul_i32 s24, s45, 147456
    s_mul_i32 s25, s44, 18432
    s_add_u32 s24, s24, s25
    s_add_u32 s24, s24, 16777216
    s_mul_i32 s25, s3, 3072
    s_add_u32 s25, s25, s24
    s_lshl_b32 s26, s3, 10
    s_add_u32 s26, s26, s24
    s_add_u32 s26, s26, 13312
    s_cmp_eq_u32 s3, 0
    s_cselect_b32 s27, 0, 2146435072
    s_add_u32 s27, s27, s24
    s_add_u32 s28, s27, 17408
    s_add_u32 s27, s27, 12288
    buffer_store_dwordx4 v[120:123], v7, s[8:11], s25 offen offset:0 sc1
    buffer_store_dwordx4 v[124:127], v7, s[8:11], s25 offen offset:1024 sc1
    buffer_store_dwordx4 v[128:131], v7, s[8:11], s25 offen offset:2048 sc1
    buffer_store_dwordx4 v[132:135], v7, s[8:11], s26 offen sc1
    buffer_store_dwordx4 v[136:139], v7, s[8:11], s27 offen sc1
    buffer_store_dwordx4 v[140:143], v7, s[8:11], s28 offen sc1
    s_waitcnt vmcnt(0)
    s_cmp_eq_u32 s92, 0
    s_cbranch_scc0 interleave_layers__linear_attn_block__memory_aug_recurrent_mem_tr__prompt_kernel_rc8_ok
    s_mov_b32 s61, 0
interleave_layers__linear_attn_block__memory_aug_recurrent_mem_tr__prompt_kernel_rc8:
    s_waitcnt vmcnt(0)
    v_readfirstlane_b32 s24, v14
    s_sub_u32 s36, s24, 1
    s_and_b32 s36, s36, 1
    s_lshl_b32 s36, s36, 13
    s_cmp_ge_u32 s24, 1
    s_cbranch_scc1 interleave_layers__linear_attn_block__memory_aug_recurrent_mem_tr__prompt_kernel_rc8_ok
    s_add_u32 s61, s61, 1
    s_cmp_ge_u32 s61, s60
    s_cbranch_scc1 interleave_layers__linear_attn_block__memory_aug_recurrent_mem_tr__prompt_kernel_rc8_to
    s_sleep 2
    v_mov_b32 v15, 0
    buffer_load_dword v14, v15, s[72:75], 0 offen sc1
    s_branch interleave_layers__linear_attn_block__memory_aug_recurrent_mem_tr__prompt_kernel_rc8
interleave_layers__linear_attn_block__memory_aug_recurrent_mem_tr__prompt_kernel_rc8_to:
    s_mov_b32 s60, 1
interleave_layers__linear_attn_block__memory_aug_recurrent_mem_tr__prompt_kernel_rc8_ok:
    s_barrier
    s_cmp_eq_u32 s3, 0
    s_cbranch_scc0 interleave_layers__linear_attn_block__memory_aug_recurrent_mem_tr__prompt_kernel_ka9
    s_lshl_b32 s24, s92, 3
    s_add_u32 s24, s24, s44
    s_lshl_b32 s24, s24, 7
    s_add_u32 s24, s24, 23101440
    v_mov_b32 v14, s24
    v_mov_b32 v15, 2146435072
    v_cmp_eq_u32 vcc, 0, v1
    s_nop 1
    v_cndmask_b32 v14, v15, v14, vcc
    v_mov_b32 v15, 1
    buffer_atomic_add v15, v14, s[8:11], 0 offen sc1
interleave_layers__linear_attn_block__memory_aug_recurrent_mem_tr__prompt_kernel_ka9:
    s_cmp_eq_u32 s92, 0
    s_cbranch_scc1 interleave_layers__linear_attn_block__memory_aug_recurrent_mem_tr__prompt_kernel_k3w10
    s_cmp_eq_u32 s2, 247
    s_cbranch_scc1 interleave_layers__linear_attn_block__memory_aug_recurrent_mem_tr__prompt_kernel_end
    s_branch interleave_layers__linear_attn_block__memory_aug_recurrent_mem_tr__prompt_kernel_helper
interleave_layers__linear_attn_block__memory_aug_recurrent_mem_tr__prompt_kernel_k3w10:
    s_cmp_ge_u32 s2, 232
    s_cbranch_scc1 interleave_layers__linear_attn_block__memory_aug_recurrent_mem_tr__prompt_kernel_helper
    s_cmp_ge_u32 s2, 200
    s_cbranch_scc1 interleave_layers__linear_attn_block__memory_aug_recurrent_mem_tr__prompt_kernel_toO
    s_cmp_ge_u32 s2, 104
    s_cbranch_scc1 interleave_layers__linear_attn_block__memory_aug_recurrent_mem_tr__prompt_kernel_toP
    s_cmp_ge_u32 s2, 64
    s_cbranch_scc1 interleave_layers__linear_attn_block__memory_aug_recurrent_mem_tr__prompt_kernel_toR
    s_cmp_ge_u32 s2, 32
    s_cbranch_scc1 interleave_layers__linear_attn_block__memory_aug_recurrent_mem_tr__prompt_kernel_toV
    s_branch interleave_layers__linear_attn_block__memory_aug_recurrent_mem_tr__prompt_kernel_roleS
interleave_layers__linear_attn_block__memory_aug_recurrent_mem_tr__prompt_kernel_toV:
    s_branch interleave_layers__linear_attn_block__memory_aug_recurrent_mem_tr__prompt_kernel_roleV
interleave_layers__linear_attn_block__memory_aug_recurrent_mem_tr__prompt_kernel_toR:
    s_branch interleave_layers__linear_attn_block__memory_aug_recurrent_mem_tr__prompt_kernel_roleR
interleave_layers__linear_attn_block__memory_aug_recurrent_mem_tr__prompt_kernel_toP:
    s_branch interleave_layers__linear_attn_block__memory_aug_recurrent_mem_tr__prompt_kernel_roleP
interleave_layers__linear_attn_block__memory_aug_recurrent_mem_tr__prompt_kernel_toO:
    s_branch interleave_layers__linear_attn_block__memory_aug_recurrent_mem_tr__prompt_kernel_roleO
interleave_layers__linear_attn_block__memory_aug_recurrent_mem_tr__prompt_kernel_helper:
    s_sub_u32 s24, s2, 232
    s_cmp_ge_u32 s24, 21
    s_cbranch_scc1 interleave_layers__linear_attn_block__memory_aug_recurrent_mem_tr__prompt_kernel_helper_clr
    s_cmp_eq_u32 s24, 15
    s_cbranch_scc1 interleave_layers__linear_attn_block__memory_aug_recurrent_mem_tr__prompt_kernel_helper_k1
    s_mul_i32 s57, s24, 52
    s_lshr_b32 s57, s57, 8
    s_mul_i32 s56, s57, 5
    s_sub_u32 s56, s24, s56
    s_add_u32 s57, s57, 1
    s_sub_u32 s25, s24, 16
    s_cmp_ge_u32 s24, 16
    s_cselect_b32 s56, s25, s56
    s_cselect_b32 s57, 0, s57
    s_mul_i32 s78, s57, 5
    s_add_u32 s78, s78, s56
    s_load_dwordx2 s[6:7], s[0:1], 16
    v_lshrrev_b32 v12, 4, v0
    v_mul_u32_u24 v12, 1280, v12
    v_and_b32 v13, 15, v0
    v_lshl_add_u32 v12, v13, 4, v12
    s_waitcnt lgkmcnt(0)
    s_mov_b32 s12, s6
    s_mov_b32 s13, s7
    s_mov_b32 s14, 819200
    s_mov_b32 s15, 0x00020000
    s_lshl_b32 s52, s56, 8
    s_add_u32 s24, s52, 0
    buffer_load_dwordx4 a[0:3], v12, s[12:15], s24 offen
    s_add_u32 s24, s52, 20480
    buffer_load_dwordx4 a[4:7], v12, s[12:15], s24 offen
    s_add_u32 s24, s52, 40960
    buffer_load_dwordx4 a[8:11], v12, s[12:15], s24 offen
    s_add_u32 s24, s52, 61440
    buffer_load_dwordx4 a[12:15], v12, s[12:15], s24 offen
    s_add_u32 s24, s52, 81920
    buffer_load_dwordx4 a[16:19], v12, s[12:15], s24 offen
    s_add_u32 s24, s52, 102400
    buffer_load_dwordx4 a[20:23], v12, s[12:15], s24 offen
    s_add_u32 s24, s52, 122880
    buffer_load_dwordx4 a[24:27], v12, s[12:15], s24 offen
    s_add_u32 s24, s52, 143360
    buffer_load_dwordx4 a[28:31], v12, s[12:15], s24 offen
    s_add_u32 s24, s52, 163840
    buffer_load_dwordx4 a[32:35], v12, s[12:15], s24 offen
    s_add_u32 s24, s52, 184320
    buffer_load_dwordx4 a[36:39], v12, s[12:15], s24 offen
    s_add_u32 s24, s52, 204800
    buffer_load_dwordx4 a[40:43], v12, s[12:15], s24 offen
    s_add_u32 s24, s52, 225280
    buffer_load_dwordx4 a[44:47], v12, s[12:15], s24 offen
    s_add_u32 s24, s52, 245760
    buffer_load_dwordx4 a[48:51], v12, s[12:15], s24 offen
    s_add_u32 s24, s52, 266240
    buffer_load_dwordx4 a[52:55], v12, s[12:15], s24 offen
    s_add_u32 s24, s52, 286720
    buffer_load_dwordx4 a[56:59], v12, s[12:15], s24 offen
    s_add_u32 s24, s52, 307200
    buffer_load_dwordx4 a[60:63], v12, s[12:15], s24 offen
    s_add_u32 s24, s52, 327680
    buffer_load_dwordx4 a[64:67], v12, s[12:15], s24 offen
    s_add_u32 s24, s52, 348160
    buffer_load_dwordx4 a[68:71], v12, s[12:15], s24 offen
    s_add_u32 s24, s52, 368640
    buffer_load_dwordx4 a[72:75], v12, s[12:15], s24 offen
    s_add_u32 s24, s52, 389120
    buffer_load_dwordx4 a[76:79], v12, s[12:15], s24 offen
    s_add_u32 s24, s52, 409600
    buffer_load_dwordx4 a[80:83], v12, s[12:15], s24 offen
    s_add_u32 s24, s52, 430080
    buffer_load_dwordx4 a[84:87], v12, s[12:15], s24 offen
    s_add_u32 s24, s52, 450560
    buffer_load_dwordx4 a[88:91], v12, s[12:15], s24 offen
    s_add_u32 s24, s52, 471040
    buffer_load_dwordx4 a[92:95], v12, s[12:15], s24 offen
    s_add_u32 s24, s52, 491520
    buffer_load_dwordx4 a[96:99], v12, s[12:15], s24 offen
    s_add_u32 s24, s52, 512000
    buffer_load_dwordx4 a[100:103], v12, s[12:15], s24 offen
    s_add_u32 s24, s52, 532480
    buffer_load_dwordx4 a[104:107], v12, s[12:15], s24 offen
    s_add_u32 s24, s52, 552960
    buffer_load_dwordx4 a[108:111], v12, s[12:15], s24 offen
    s_add_u32 s24, s52, 573440
    buffer_load_dwordx4 a[112:115], v12, s[12:15], s24 offen
    s_add_u32 s24, s52, 593920
    buffer_load_dwordx4 a[116:119], v12, s[12:15], s24 offen
    s_add_u32 s24, s52, 614400
    buffer_load_dwordx4 a[120:123], v12, s[12:15], s24 offen
    s_add_u32 s24, s52, 634880
    buffer_load_dwordx4 a[124:127], v12, s[12:15], s24 offen
    s_add_u32 s24, s52, 655360
    buffer_load_dwordx4 a[128:131], v12, s[12:15], s24 offen
    s_add_u32 s24, s52, 675840
    buffer_load_dwordx4 a[132:135], v12, s[12:15], s24 offen
    s_add_u32 s24, s52, 696320
    buffer_load_dwordx4 a[136:139], v12, s[12:15], s24 offen
    s_add_u32 s24, s52, 716800
    buffer_load_dwordx4 a[140:143], v12, s[12:15], s24 offen
    s_add_u32 s24, s52, 737280
    buffer_load_dwordx4 a[144:147], v12, s[12:15], s24 offen
    s_add_u32 s24, s52, 757760
    buffer_load_dwordx4 a[148:151], v12, s[12:15], s24 offen
    s_add_u32 s24, s52, 778240
    buffer_load_dwordx4 a[152:155], v12, s[12:15], s24 offen
    s_add_u32 s24, s52, 798720
    buffer_load_dwordx4 a[156:159], v12, s[12:15], s24 offen
    v_lshrrev_b32 v6, 4, v0
    v_mul_u32_u24 v6, 288, v6
    v_and_b32 v7, 15, v0
    v_lshl_add_u32 v6, v7, 4, v6
    v_add_u32 v6, 81920, v6
    v_lshrrev_b32 v7, 2, v2
    v_lshl_add_u32 v7, v3, 2, v7
    v_mul_u32_u24 v7, 288, v7
    v_and_b32 v8, 3, v2
    v_lshl_add_u32 v7, v8, 3, v7
    s_lshl_b32 s24, s3, 6
    s_add_u32 s24, s24, 81920
    v_add_u32 v7, s24, v7
    s_waitcnt vmcnt(36)
    ds_write_b128 v6, a[0:3] offset:0
    ds_write_b128 v6, a[4:7] offset:4608
    ds_write_b128 v6, a[8:11] offset:9216
    ds_write_b128 v6, a[12:15] offset:13824
    s_waitcnt lgkmcnt(0)
    s_barrier
    ds_read_b64_tr_b16 a[0:1], v7 offset:0
    ds_read_b64_tr_b16 a[2:3], v7 offset:4608
    ds_read_b64_tr_b16 a[4:5], v7 offset:32
    ds_read_b64_tr_b16 a[6:7], v7 offset:4640
    ds_read_b64_tr_b16 a[8:9], v7 offset:9216
    ds_read_b64_tr_b16 a[10:11], v7 offset:13824
    ds_read_b64_tr_b16 a[12:13], v7 offset:9248
    ds_read_b64_tr_b16 a[14:15], v7 offset:13856
    s_waitcnt vmcnt(32)
    ds_write_b128 v6, a[16:19] offset:18432
    ds_write_b128 v6, a[20:23] offset:23040
    ds_write_b128 v6, a[24:27] offset:27648
    ds_write_b128 v6, a[28:31] offset:32256
    s_waitcnt lgkmcnt(0)
    s_barrier
    ds_read_b64_tr_b16 a[16:17], v7 offset:18432
    ds_read_b64_tr_b16 a[18:19], v7 offset:23040
    ds_read_b64_tr_b16 a[20:21], v7 offset:18464
    ds_read_b64_tr_b16 a[22:23], v7 offset:23072
    ds_read_b64_tr_b16 a[24:25], v7 offset:27648
    ds_read_b64_tr_b16 a[26:27], v7 offset:32256
    ds_read_b64_tr_b16 a[28:29], v7 offset:27680
    ds_read_b64_tr_b16 a[30:31], v7 offset:32288
    s_waitcnt vmcnt(28)
    ds_write_b128 v6, a[32:35] offset:0
    ds_write_b128 v6, a[36:39] offset:4608
    ds_write_b128 v6, a[40:43] offset:9216
    ds_write_b128 v6, a[44:47] offset:13824
    s_waitcnt lgkmcnt(0)
    s_barrier
    ds_read_b64_tr_b16 a[32:33], v7 offset:0
    ds_read_b64_tr_b16 a[34:35], v7 offset:4608
    ds_read_b64_tr_b16 a[36:37], v7 offset:32
    ds_read_b64_tr_b16 a[38:39], v7 offset:4640
    ds_read_b64_tr_b16 a[40:41], v7 offset:9216
    ds_read_b64_tr_b16 a[42:43], v7 offset:13824
    ds_read_b64_tr_b16 a[44:45], v7 offset:9248
    ds_read_b64_tr_b16 a[46:47], v7 offset:13856
    s_waitcnt vmcnt(24)
    ds_write_b128 v6, a[48:51] offset:18432
    ds_write_b128 v6, a[52:55] offset:23040
    ds_write_b128 v6, a[56:59] offset:27648
    ds_write_b128 v6, a[60:63] offset:32256
    s_waitcnt lgkmcnt(0)
    s_barrier
    ds_read_b64_tr_b16 a[48:49], v7 offset:18432
    ds_read_b64_tr_b16 a[50:51], v7 offset:23040
    ds_read_b64_tr_b16 a[52:53], v7 offset:18464
    ds_read_b64_tr_b16 a[54:55], v7 offset:23072
    ds_read_b64_tr_b16 a[56:57], v7 offset:27648
    ds_read_b64_tr_b16 a[58:59], v7 offset:32256
    ds_read_b64_tr_b16 a[60:61], v7 offset:27680
    ds_read_b64_tr_b16 a[62:63], v7 offset:32288
    s_waitcnt vmcnt(20)
    ds_write_b128 v6, a[64:67] offset:0
    ds_write_b128 v6, a[68:71] offset:4608
    ds_write_b128 v6, a[72:75] offset:9216
    ds_write_b128 v6, a[76:79] offset:13824
    s_waitcnt lgkmcnt(0)
    s_barrier
    ds_read_b64_tr_b16 a[64:65], v7 offset:0
    ds_read_b64_tr_b16 a[66:67], v7 offset:4608
    ds_read_b64_tr_b16 a[68:69], v7 offset:32
    ds_read_b64_tr_b16 a[70:71], v7 offset:4640
    ds_read_b64_tr_b16 a[72:73], v7 offset:9216
    ds_read_b64_tr_b16 a[74:75], v7 offset:13824
    ds_read_b64_tr_b16 a[76:77], v7 offset:9248
    ds_read_b64_tr_b16 a[78:79], v7 offset:13856
    s_waitcnt vmcnt(16)
    ds_write_b128 v6, a[80:83] offset:18432
    ds_write_b128 v6, a[84:87] offset:23040
    ds_write_b128 v6, a[88:91] offset:27648
    ds_write_b128 v6, a[92:95] offset:32256
    s_waitcnt lgkmcnt(0)
    s_barrier
    ds_read_b64_tr_b16 a[80:81], v7 offset:18432
    ds_read_b64_tr_b16 a[82:83], v7 offset:23040
    ds_read_b64_tr_b16 a[84:85], v7 offset:18464
    ds_read_b64_tr_b16 a[86:87], v7 offset:23072
    ds_read_b64_tr_b16 a[88:89], v7 offset:27648
    ds_read_b64_tr_b16 a[90:91], v7 offset:32256
    ds_read_b64_tr_b16 a[92:93], v7 offset:27680
    ds_read_b64_tr_b16 a[94:95], v7 offset:32288
    s_waitcnt vmcnt(12)
    ds_write_b128 v6, a[96:99] offset:0
    ds_write_b128 v6, a[100:103] offset:4608
    ds_write_b128 v6, a[104:107] offset:9216
    ds_write_b128 v6, a[108:111] offset:13824
    s_waitcnt lgkmcnt(0)
    s_barrier
    ds_read_b64_tr_b16 a[96:97], v7 offset:0
    ds_read_b64_tr_b16 a[98:99], v7 offset:4608
    ds_read_b64_tr_b16 a[100:101], v7 offset:32
    ds_read_b64_tr_b16 a[102:103], v7 offset:4640
    ds_read_b64_tr_b16 a[104:105], v7 offset:9216
    ds_read_b64_tr_b16 a[106:107], v7 offset:13824
    ds_read_b64_tr_b16 a[108:109], v7 offset:9248
    ds_read_b64_tr_b16 a[110:111], v7 offset:13856
    s_waitcnt vmcnt(8)
    ds_write_b128 v6, a[112:115] offset:18432
    ds_write_b128 v6, a[116:119] offset:23040
    ds_write_b128 v6, a[120:123] offset:27648
    ds_write_b128 v6, a[124:127] offset:32256
    s_waitcnt lgkmcnt(0)
    s_barrier
    ds_read_b64_tr_b16 a[112:113], v7 offset:18432
    ds_read_b64_tr_b16 a[114:115], v7 offset:23040
    ds_read_b64_tr_b16 a[116:117], v7 offset:18464
    ds_read_b64_tr_b16 a[118:119], v7 offset:23072
    ds_read_b64_tr_b16 a[120:121], v7 offset:27648
    ds_read_b64_tr_b16 a[122:123], v7 offset:32256
    ds_read_b64_tr_b16 a[124:125], v7 offset:27680
    ds_read_b64_tr_b16 a[126:127], v7 offset:32288
    s_waitcnt vmcnt(4)
    ds_write_b128 v6, a[128:131] offset:0
    ds_write_b128 v6, a[132:135] offset:4608
    ds_write_b128 v6, a[136:139] offset:9216
    ds_write_b128 v6, a[140:143] offset:13824
    s_waitcnt lgkmcnt(0)
    s_barrier
    ds_read_b64_tr_b16 a[128:129], v7 offset:0
    ds_read_b64_tr_b16 a[130:131], v7 offset:4608
    ds_read_b64_tr_b16 a[132:133], v7 offset:32
    ds_read_b64_tr_b16 a[134:135], v7 offset:4640
    ds_read_b64_tr_b16 a[136:137], v7 offset:9216
    ds_read_b64_tr_b16 a[138:139], v7 offset:13824
    ds_read_b64_tr_b16 a[140:141], v7 offset:9248
    ds_read_b64_tr_b16 a[142:143], v7 offset:13856
    s_waitcnt vmcnt(0)
    ds_write_b128 v6, a[144:147] offset:18432
    ds_write_b128 v6, a[148:151] offset:23040
    ds_write_b128 v6, a[152:155] offset:27648
    ds_write_b128 v6, a[156:159] offset:32256
    s_waitcnt lgkmcnt(0)
    s_barrier
    ds_read_b64_tr_b16 a[144:145], v7 offset:18432
    ds_read_b64_tr_b16 a[146:147], v7 offset:23040
    ds_read_b64_tr_b16 a[148:149], v7 offset:18464
    ds_read_b64_tr_b16 a[150:151], v7 offset:23072
    ds_read_b64_tr_b16 a[152:153], v7 offset:27648
    ds_read_b64_tr_b16 a[154:155], v7 offset:32256
    ds_read_b64_tr_b16 a[156:157], v7 offset:27680
    ds_read_b64_tr_b16 a[158:159], v7 offset:32288
    s_waitcnt lgkmcnt(0)
    s_cmp_eq_u32 s92, 1
    s_cbranch_scc1 interleave_layers__linear_attn_block__memory_aug_recurrent_mem_tr__prompt_kernel_k3_l1
    s_load_dwordx2 s[6:7], s[0:1], 0
    s_waitcnt lgkmcnt(0)
    s_mov_b32 s16, s6
    s_mov_b32 s17, s7
    s_mov_b32 s18, 2621440
    s_mov_b32 s19, 0x00020000
    s_mov_b32 s46, 64
    s_mov_b32 s47, 32
    s_mov_b32 s50, 0
    s_mov_b32 s58, 0
    s_mov_b32 s76, 16
    s_mov_b32 s77, 163840
interleave_layers__linear_attn_block__memory_aug_recurrent_mem_tr__prompt_kernel_k3_entry:
    v_lshlrev_b32 v5, 4, v1
    s_mul_i32 s24, s3, 5120
    s_add_u32 s24, s24, 12582912
    v_add_u32 v8, s24, v5
    v_lshlrev_b32 v9, 3, v1
    s_add_u32 s24, s24, 2048
    v_add_u32 v9, s24, v9
    s_cmp_eq_u32 s50, 1
    s_cselect_b32 s25, 16, 1280
    s_cselect_b32 s26, 256, 8
    v_mul_u32_u24 v10, s25, v2
    v_mul_u32_u24 v11, s26, v3
    s_lshl_b32 s24, s56, 2
    s_add_u32 s24, s24, s3
    s_mul_i32 s25, s24, s46
    v_add3_u32 v10, v10, v11, s25
    v_add_u32 v11, s47, v10
    s_lshl_b32 s24, s24, 10
    s_add_u32 s24, s24, s58
    v_add_u32 v12, s24, v5
    s_mul_i32 s24, s3, 5120
    s_add_u32 s24, s24, 0
    v_add_u32 v13, s24, v5
    s_mov_b32 s54, 0x358637bd
    s_mul_i32 s43, s57, 40960
    s_mov_b32 s40, 0
    s_mov_b32 s42, 0
    s_cmp_eq_u32 s3, 0
    s_cbranch_scc0 interleave_layers__linear_attn_block__memory_aug_recurrent_mem_tr__prompt_kernel_kw11
    s_lshl_b32 s24, s92, 10
    s_add_u32 s24, s24, 23101440
    v_and_b32 v15, 7, v1
    v_lshlrev_b32 v15, 7, v15
    v_add_u32 v15, s24, v15
    s_cmp_eq_u32 s92, 0
    s_cselect_b32 s26, 31, 1
    s_mov_b64 exec, 255
    s_mov_b32 s61, 0
interleave_layers__linear_attn_block__memory_aug_recurrent_mem_tr__prompt_kernel_k3_w0:
    v_mov_b32 v14, 0
    buffer_atomic_add v14, v15, s[8:11], 0 offen sc0 sc1
    s_waitcnt vmcnt(0)
    v_cmp_gt_i32 vcc, s26, v14
    s_cbranch_vccz interleave_layers__linear_attn_block__memory_aug_recurrent_mem_tr__prompt_kernel_k3_w0_ok
    s_add_u32 s61, s61, 1
    s_cmp_ge_u32 s61, s60
    s_cbranch_scc1 interleave_layers__linear_attn_block__memory_aug_recurrent_mem_tr__prompt_kernel_k3_w0_to
    s_sleep 6
    s_branch interleave_layers__linear_attn_block__memory_aug_recurrent_mem_tr__prompt_kernel_k3_w0
interleave_layers__linear_attn_block__memory_aug_recurrent_mem_tr__prompt_kernel_k3_w0_to:
    s_mov_b32 s60, 1
interleave_layers__linear_attn_block__memory_aug_recurrent_mem_tr__prompt_kernel_k3_w0_ok:
    s_mov_b64 exec, -1
interleave_layers__linear_attn_block__memory_aug_recurrent_mem_tr__prompt_kernel_kw11:
    s_barrier
    s_mov_b32 s41, s43
    s_add_u32 s25, s41, 20480
    buffer_load_dwordx4 v[16:19], v8, s[8:11], s41 offen offset:0 sc1
    buffer_load_dwordx4 v[20:23], v8, s[8:11], s41 offen offset:1024 sc1
    buffer_load_dwordx2 v[24:25], v9, s[8:11], s41 offen offset:0 sc1
    buffer_load_dwordx4 v[26:29], v8, s[8:11], s41 offen offset:2560 sc1
    buffer_load_dwordx4 v[30:33], v8, s[8:11], s41 offen offset:3584 sc1
    buffer_load_dwordx2 v[34:35], v9, s[8:11], s41 offen offset:2560 sc1
    buffer_load_dwordx4 v[36:39], v8, s[8:11], s25 offen offset:0 sc1
    buffer_load_dwordx4 v[40:43], v8, s[8:11], s25 offen offset:1024 sc1
    buffer_load_dwordx2 v[44:45], v9, s[8:11], s25 offen offset:0 sc1
    buffer_load_dwordx4 v[46:49], v8, s[8:11], s25 offen offset:2560 sc1
    buffer_load_dwordx4 v[50:53], v8, s[8:11], s25 offen offset:3584 sc1
    buffer_load_dwordx2 v[54:55], v9, s[8:11], s25 offen offset:2560 sc1
    buffer_load_dwordx2 v[96:97], v10, s[16:19], s41 offen sc1
    buffer_load_dwordx2 v[98:99], v11, s[16:19], s41 offen sc1
    buffer_load_dwordx2 v[100:101], v10, s[16:19], s25 offen sc1
    buffer_load_dwordx2 v[102:103], v11, s[16:19], s25 offen sc1
    s_add_u32 s41, s43, s77
    s_add_u32 s25, s41, 20480
    buffer_load_dwordx4 v[56:59], v8, s[8:11], s41 offen offset:0 sc1
    buffer_load_dwordx4 v[60:63], v8, s[8:11], s41 offen offset:1024 sc1
    buffer_load_dwordx2 v[64:65], v9, s[8:11], s41 offen offset:0 sc1
    buffer_load_dwordx4 v[66:69], v8, s[8:11], s41 offen offset:2560 sc1
    buffer_load_dwordx4 v[70:73], v8, s[8:11], s41 offen offset:3584 sc1
    buffer_load_dwordx2 v[74:75], v9, s[8:11], s41 offen offset:2560 sc1
    buffer_load_dwordx4 v[76:79], v8, s[8:11], s25 offen offset:0 sc1
    buffer_load_dwordx4 v[80:83], v8, s[8:11], s25 offen offset:1024 sc1
    buffer_load_dwordx2 v[84:85], v9, s[8:11], s25 offen offset:0 sc1
    buffer_load_dwordx4 v[86:89], v8, s[8:11], s25 offen offset:2560 sc1
    buffer_load_dwordx4 v[90:93], v8, s[8:11], s25 offen offset:3584 sc1
    buffer_load_dwordx2 v[94:95], v9, s[8:11], s25 offen offset:2560 sc1
    buffer_load_dwordx2 v[104:105], v10, s[16:19], s41 offen sc1
    buffer_load_dwordx2 v[106:107], v11, s[16:19], s41 offen sc1
    buffer_load_dwordx2 v[108:109], v10, s[16:19], s25 offen sc1
    buffer_load_dwordx2 v[110:111], v11, s[16:19], s25 offen sc1
    s_lshl_b32 s24, s92, 7
    s_add_u32 s24, s24, 23103488
    v_lshlrev_b32 v15, 2, v1
    v_add_u32 v15, s24, v15
    s_mov_b32 s61, 0
interleave_layers__linear_attn_block__memory_aug_recurrent_mem_tr__prompt_kernel_k3_w:
    buffer_load_dword v14, v15, s[8:11], 0 offen sc1
    s_waitcnt vmcnt(0)
    v_cmp_le_i32 vcc, 1, v14
    s_mov_b32 s25, 0xffffff
    s_and_b32 s24, vcc_lo, s25
    s_cmp_eq_u32 s24, s25
    s_cbranch_scc1 interleave_layers__linear_attn_block__memory_aug_recurrent_mem_tr__prompt_kernel_k3_w_ok
    s_add_u32 s61, s61, 1
    s_cmp_ge_u32 s61, s60
    s_cbranch_scc1 interleave_layers__linear_attn_block__memory_aug_recurrent_mem_tr__prompt_kernel_k3_w_to
    s_sleep 2
    s_branch interleave_layers__linear_attn_block__memory_aug_recurrent_mem_tr__prompt_kernel_k3_w
interleave_layers__linear_attn_block__memory_aug_recurrent_mem_tr__prompt_kernel_k3_w_to:
    s_mov_b32 s60, 1
interleave_layers__linear_attn_block__memory_aug_recurrent_mem_tr__prompt_kernel_k3_w_ok:
    s_mul_i32 s24, s92, 131072
    s_mul_i32 s25, s3, 28672
    s_add_u32 s24, s24, s25
    s_add_u32 s24, s24, 22020096
    s_add_u32 s25, s24, 0
    buffer_load_dwordx4 a[160:163], v5, s[8:11], s25 offen sc1
    s_add_u32 s25, s24, 1024
    buffer_load_dwordx4 a[164:167], v5, s[8:11], s25 offen sc1
    s_add_u32 s25, s24, 2048
    buffer_load_dwordx4 a[168:171], v5, s[8:11], s25 offen sc1
    s_add_u32 s25, s24, 3072
    buffer_load_dwordx4 a[172:175], v5, s[8:11], s25 offen sc1
    s_add_u32 s25, s24, 4096
    buffer_load_dwordx4 a[176:179], v5, s[8:11], s25 offen sc1
    s_add_u32 s25, s24, 5120
    buffer_load_dwordx4 a[180:183], v5, s[8:11], s25 offen sc1
    s_add_u32 s25, s24, 6144
    buffer_load_dwordx2 a[184:185], v5, s[8:11], s25 offen sc1
    s_add_u32 s25, s24, 7168
    buffer_load_dwordx4 a[186:189], v5, s[8:11], s25 offen sc1
    s_add_u32 s25, s24, 8192
    buffer_load_dwordx2 a[190:191], v5, s[8:11], s25 offen sc1
    s_add_u32 s25, s24, 9216
    buffer_load_dwordx4 a[192:195], v5, s[8:11], s25 offen sc1
    s_add_u32 s25, s24, 10240
    buffer_load_dwordx4 a[196:199], v5, s[8:11], s25 offen sc1
    s_add_u32 s25, s24, 11264
    buffer_load_dwordx2 a[200:201], v5, s[8:11], s25 offen sc1
    s_add_u32 s25, s24, 12288
    buffer_load_dwordx4 a[202:205], v5, s[8:11], s25 offen sc1
    s_add_u32 s25, s24, 13312
    buffer_load_dwordx2 a[206:207], v5, s[8:11], s25 offen sc1
    s_add_u32 s25, s24, 14336
    buffer_load_dwordx4 a[208:211], v5, s[8:11], s25 offen sc1
    s_add_u32 s25, s24, 15360
    buffer_load_dwordx4 a[212:215], v5, s[8:11], s25 offen sc1
    s_add_u32 s25, s24, 16384
    buffer_load_dwordx4 a[216:219], v5, s[8:11], s25 offen sc1
    s_add_u32 s25, s24, 17408
    buffer_load_dwordx4 a[220:223], v5, s[8:11], s25 offen sc1
    s_add_u32 s25, s24, 18432
    buffer_load_dwordx4 a[224:227], v5, s[8:11], s25 offen sc1
    s_add_u32 s25, s24, 19456
    buffer_load_dwordx4 a[228:231], v5, s[8:11], s25 offen sc1
    s_add_u32 s25, s24, 20480
    buffer_load_dwordx2 a[232:233], v5, s[8:11], s25 offen sc1
    s_add_u32 s25, s24, 21504
    buffer_load_dwordx4 a[234:237], v5, s[8:11], s25 offen sc1
    s_add_u32 s25, s24, 22528
    buffer_load_dwordx2 a[238:239], v5, s[8:11], s25 offen sc1
    s_add_u32 s25, s24, 23552
    buffer_load_dwordx4 a[240:243], v5, s[8:11], s25 offen sc1
    s_add_u32 s25, s24, 24576
    buffer_load_dwordx4 a[244:247], v5, s[8:11], s25 offen sc1
    s_add_u32 s25, s24, 25600
    buffer_load_dwordx2 a[248:249], v5, s[8:11], s25 offen sc1
    s_add_u32 s25, s24, 26624
    buffer_load_dwordx4 a[250:253], v5, s[8:11], s25 offen sc1
    s_add_u32 s25, s24, 27648
    buffer_load_dwordx2 a[254:255], v5, s[8:11], s25 offen sc1
    s_waitcnt vmcnt(0)
    v_mfma_f32_16x16x32_bf16 v[132:135], a[192:195], v[16:19], 0
    v_mfma_f32_16x16x32_bf16 v[136:139], a[202:205], v[20:23], 0
    v_mfma_f32_16x16x32_bf16 v[112:115], a[160:163], v[16:19], 0
    v_mfma_f32_16x16x32_bf16 v[116:119], a[164:167], v[16:19], 0
    v_mfma_f32_16x16x32_bf16 v[120:123], a[172:175], v[16:19], 0
    v_mfma_f32_16x16x32_bf16 v[124:127], a[180:183], v[20:23], 0
    v_mfma_f32_16x16x32_bf16 v[128:131], a[186:189], v[20:23], 0
    v_mfma_f32_16x16x32_bf16 v[132:135], a[196:199], v[20:23], v[132:135]
    v_mfma_f32_16x16x32_bf16 v[116:119], a[168:171], v[20:23], v[116:119]
    v_mfma_f32_16x16x32_bf16 v[120:123], a[176:179], v[20:23], v[120:123]
    v_mfma_f32_16x16x16_bf16 v[136:139], a[206:207], v[24:25], v[136:139]
    s_nop 0
    v_mfma_f32_16x16x16_bf16 v[124:127], a[184:185], v[24:25], v[124:127]
    v_mfma_f32_16x16x16_bf16 v[128:131], a[190:191], v[24:25], v[128:131]
    v_mfma_f32_16x16x16_bf16 v[132:135], a[200:201], v[24:25], v[132:135]
    v_mfma_f32_16x16x32_bf16 v[160:163], a[240:243], v[26:29], 0
    v_mfma_f32_16x16x32_bf16 v[164:167], a[250:253], v[30:33], 0
    v_mfma_f32_16x16x32_bf16 v[140:143], a[208:211], v[26:29], 0
    v_mfma_f32_16x16x32_bf16 v[144:147], a[212:215], v[26:29], 0
    v_mfma_f32_16x16x32_bf16 v[148:151], a[220:223], v[26:29], 0
    v_mfma_f32_16x16x32_bf16 v[152:155], a[228:231], v[30:33], 0
    v_mfma_f32_16x16x32_bf16 v[156:159], a[234:237], v[30:33], 0
    v_mfma_f32_16x16x32_bf16 v[160:163], a[244:247], v[30:33], v[160:163]
    v_mfma_f32_16x16x32_bf16 v[144:147], a[216:219], v[30:33], v[144:147]
    v_mfma_f32_16x16x32_bf16 v[148:151], a[224:227], v[30:33], v[148:151]
    v_mfma_f32_16x16x16_bf16 v[164:167], a[254:255], v[34:35], v[164:167]
    s_nop 0
    v_mfma_f32_16x16x16_bf16 v[152:155], a[232:233], v[34:35], v[152:155]
    v_mfma_f32_16x16x16_bf16 v[156:159], a[238:239], v[34:35], v[156:159]
    v_mfma_f32_16x16x16_bf16 v[160:163], a[248:249], v[34:35], v[160:163]
    v_add_f32 v132, s54, v132
    v_add_f32 v133, s54, v133
    v_add_f32 v134, s54, v134
    v_add_f32 v135, s54, v135
    v_add_f32 v136, s54, v136
    v_rcp_f32 v132, v132
    v_rcp_f32 v133, v133
    v_rcp_f32 v134, v134
    v_rcp_f32 v135, v135
    v_rcp_f32 v136, v136
    v_mul_f32 v112, v112, v132
    v_mul_f32 v113, v113, v132
    v_mul_f32 v114, v114, v132
    v_mul_f32 v115, v115, v132
    v_cvt_pk_bf16_f32 v168, v112, v113
    v_cvt_pk_bf16_f32 v169, v114, v115
    v_mul_f32 v116, v116, v133
    v_mul_f32 v117, v117, v133
    v_mul_f32 v118, v118, v133
    v_mul_f32 v119, v119, v133
    v_cvt_pk_bf16_f32 v170, v116, v117
    v_cvt_pk_bf16_f32 v171, v118, v119
    v_mul_f32 v120, v120, v134
    v_mul_f32 v121, v121, v134
    v_mul_f32 v122, v122, v134
    v_mul_f32 v123, v123, v134
    v_cvt_pk_bf16_f32 v172, v120, v121
    v_cvt_pk_bf16_f32 v173, v122, v123
    v_mul_f32 v124, v124, v135
    v_mul_f32 v125, v125, v135
    v_mul_f32 v126, v126, v135
    v_mul_f32 v127, v127, v135
    v_cvt_pk_bf16_f32 v174, v124, v125
    v_cvt_pk_bf16_f32 v175, v126, v127
    v_mul_f32 v128, v128, v136
    v_mul_f32 v129, v129, v136
    v_mul_f32 v130, v130, v136
    v_mul_f32 v131, v131, v136
    v_cvt_pk_bf16_f32 v176, v128, v129
    v_cvt_pk_bf16_f32 v177, v130, v131
    v_add_f32 v160, s54, v160
    v_add_f32 v161, s54, v161
    v_add_f32 v162, s54, v162
    v_add_f32 v163, s54, v163
    v_add_f32 v164, s54, v164
    v_rcp_f32 v160, v160
    v_rcp_f32 v161, v161
    v_rcp_f32 v162, v162
    v_rcp_f32 v163, v163
    v_rcp_f32 v164, v164
    v_mul_f32 v140, v140, v160
    v_mul_f32 v141, v141, v160
    v_mul_f32 v142, v142, v160
    v_mul_f32 v143, v143, v160
    v_cvt_pk_bf16_f32 v178, v140, v141
    v_cvt_pk_bf16_f32 v179, v142, v143
    v_mul_f32 v144, v144, v161
    v_mul_f32 v145, v145, v161
    v_mul_f32 v146, v146, v161
    v_mul_f32 v147, v147, v161
    v_cvt_pk_bf16_f32 v180, v144, v145
    v_cvt_pk_bf16_f32 v181, v146, v147
    v_mul_f32 v148, v148, v162
    v_mul_f32 v149, v149, v162
    v_mul_f32 v150, v150, v162
    v_mul_f32 v151, v151, v162
    v_cvt_pk_bf16_f32 v182, v148, v149
    v_cvt_pk_bf16_f32 v183, v150, v151
    v_mul_f32 v152, v152, v163
    v_mul_f32 v153, v153, v163
    v_mul_f32 v154, v154, v163
    v_mul_f32 v155, v155, v163
    v_cvt_pk_bf16_f32 v184, v152, v153
    v_cvt_pk_bf16_f32 v185, v154, v155
    v_mul_f32 v156, v156, v164
    v_mul_f32 v157, v157, v164
    v_mul_f32 v158, v158, v164
    v_mul_f32 v159, v159, v164
    v_cvt_pk_bf16_f32 v186, v156, v157
    v_cvt_pk_bf16_f32 v187, v158, v159
    v_mfma_f32_16x16x32_bf16 v[132:135], a[192:195], v[36:39], 0
    v_mfma_f32_16x16x32_bf16 v[136:139], a[202:205], v[40:43], 0
    v_mfma_f32_16x16x32_bf16 v[112:115], a[160:163], v[36:39], 0
    v_mfma_f32_16x16x32_bf16 v[116:119], a[164:167], v[36:39], 0
    v_mfma_f32_16x16x32_bf16 v[120:123], a[172:175], v[36:39], 0
    v_mfma_f32_16x16x32_bf16 v[124:127], a[180:183], v[40:43], 0
    v_mfma_f32_16x16x32_bf16 v[128:131], a[186:189], v[40:43], 0
    v_mfma_f32_16x16x32_bf16 v[132:135], a[196:199], v[40:43], v[132:135]
    v_mfma_f32_16x16x32_bf16 v[116:119], a[168:171], v[40:43], v[116:119]
    v_mfma_f32_16x16x32_bf16 v[120:123], a[176:179], v[40:43], v[120:123]
    v_mfma_f32_16x16x16_bf16 v[136:139], a[206:207], v[44:45], v[136:139]
    s_nop 0
    v_mfma_f32_16x16x16_bf16 v[124:127], a[184:185], v[44:45], v[124:127]
    v_mfma_f32_16x16x16_bf16 v[128:131], a[190:191], v[44:45], v[128:131]
    v_mfma_f32_16x16x16_bf16 v[132:135], a[200:201], v[44:45], v[132:135]
    v_mfma_f32_16x16x32_bf16 v[160:163], a[240:243], v[46:49], 0
    v_mfma_f32_16x16x32_bf16 v[164:167], a[250:253], v[50:53], 0
    v_mfma_f32_16x16x32_bf16 v[140:143], a[208:211], v[46:49], 0
    v_mfma_f32_16x16x32_bf16 v[144:147], a[212:215], v[46:49], 0
    v_mfma_f32_16x16x32_bf16 v[148:151], a[220:223], v[46:49], 0
    v_mfma_f32_16x16x32_bf16 v[152:155], a[228:231], v[50:53], 0
    v_mfma_f32_16x16x32_bf16 v[156:159], a[234:237], v[50:53], 0
    v_mfma_f32_16x16x32_bf16 v[160:163], a[244:247], v[50:53], v[160:163]
    v_mfma_f32_16x16x32_bf16 v[144:147], a[216:219], v[50:53], v[144:147]
    v_mfma_f32_16x16x32_bf16 v[148:151], a[224:227], v[50:53], v[148:151]
    v_mfma_f32_16x16x16_bf16 v[164:167], a[254:255], v[54:55], v[164:167]
    s_nop 0
    v_mfma_f32_16x16x16_bf16 v[152:155], a[232:233], v[54:55], v[152:155]
    v_mfma_f32_16x16x16_bf16 v[156:159], a[238:239], v[54:55], v[156:159]
    v_mfma_f32_16x16x16_bf16 v[160:163], a[248:249], v[54:55], v[160:163]
    v_add_f32 v132, s54, v132
    v_add_f32 v133, s54, v133
    v_add_f32 v134, s54, v134
    v_add_f32 v135, s54, v135
    v_add_f32 v136, s54, v136
    v_rcp_f32 v132, v132
    v_rcp_f32 v133, v133
    v_rcp_f32 v134, v134
    v_rcp_f32 v135, v135
    v_rcp_f32 v136, v136
    v_mul_f32 v112, v112, v132
    v_mul_f32 v113, v113, v132
    v_mul_f32 v114, v114, v132
    v_mul_f32 v115, v115, v132
    v_cvt_pk_bf16_f32 v188, v112, v113
    v_cvt_pk_bf16_f32 v189, v114, v115
    v_mul_f32 v116, v116, v133
    v_mul_f32 v117, v117, v133
    v_mul_f32 v118, v118, v133
    v_mul_f32 v119, v119, v133
    v_cvt_pk_bf16_f32 v190, v116, v117
    v_cvt_pk_bf16_f32 v191, v118, v119
    v_mul_f32 v120, v120, v134
    v_mul_f32 v121, v121, v134
    v_mul_f32 v122, v122, v134
    v_mul_f32 v123, v123, v134
    v_cvt_pk_bf16_f32 v192, v120, v121
    v_cvt_pk_bf16_f32 v193, v122, v123
    v_mul_f32 v124, v124, v135
    v_mul_f32 v125, v125, v135
    v_mul_f32 v126, v126, v135
    v_mul_f32 v127, v127, v135
    v_cvt_pk_bf16_f32 v194, v124, v125
    v_cvt_pk_bf16_f32 v195, v126, v127
    v_mul_f32 v128, v128, v136
    v_mul_f32 v129, v129, v136
    v_mul_f32 v130, v130, v136
    v_mul_f32 v131, v131, v136
    v_cvt_pk_bf16_f32 v196, v128, v129
    v_cvt_pk_bf16_f32 v197, v130, v131
    v_add_f32 v160, s54, v160
    v_add_f32 v161, s54, v161
    v_add_f32 v162, s54, v162
    v_add_f32 v163, s54, v163
    v_add_f32 v164, s54, v164
    v_rcp_f32 v160, v160
    v_rcp_f32 v161, v161
    v_rcp_f32 v162, v162
    v_rcp_f32 v163, v163
    v_rcp_f32 v164, v164
    v_mul_f32 v140, v140, v160
    v_mul_f32 v141, v141, v160
    v_mul_f32 v142, v142, v160
    v_mul_f32 v143, v143, v160
    v_cvt_pk_bf16_f32 v198, v140, v141
    v_cvt_pk_bf16_f32 v199, v142, v143
    v_mul_f32 v144, v144, v161
    v_mul_f32 v145, v145, v161
    v_mul_f32 v146, v146, v161
    v_mul_f32 v147, v147, v161
    v_cvt_pk_bf16_f32 v200, v144, v145
    v_cvt_pk_bf16_f32 v201, v146, v147
    v_mul_f32 v148, v148, v162
    v_mul_f32 v149, v149, v162
    v_mul_f32 v150, v150, v162
    v_mul_f32 v151, v151, v162
    v_cvt_pk_bf16_f32 v202, v148, v149
    v_cvt_pk_bf16_f32 v203, v150, v151
    v_mul_f32 v152, v152, v163
    v_mul_f32 v153, v153, v163
    v_mul_f32 v154, v154, v163
    v_mul_f32 v155, v155, v163
    v_cvt_pk_bf16_f32 v204, v152, v153
    v_cvt_pk_bf16_f32 v205, v154, v155
    v_mul_f32 v156, v156, v164
    v_mul_f32 v157, v157, v164
    v_mul_f32 v158, v158, v164
    v_mul_f32 v159, v159, v164
    v_cvt_pk_bf16_f32 v206, v156, v157
    v_cvt_pk_bf16_f32 v207, v158, v159
    v_add_u32 v14, s42, v13
    ds_write_b128 v14, v[168:171] offset:0
    ds_write_b128 v14, v[172:175] offset:1024
    ds_write_b128 v14, v[176:179] offset:2048
    ds_write_b128 v14, v[180:183] offset:3072
    ds_write_b128 v14, v[184:187] offset:4096
    ds_write_b128 v14, v[188:191] offset:20480
    ds_write_b128 v14, v[192:195] offset:21504
    ds_write_b128 v14, v[196:199] offset:22528
    ds_write_b128 v14, v[200:203] offset:23552
    ds_write_b128 v14, v[204:207] offset:24576
    s_waitcnt lgkmcnt(0)
    s_barrier
interleave_layers__linear_attn_block__memory_aug_recurrent_mem_tr__prompt_kernel_k3_seg:
    v_add_u32 v15, s42, v5
    ds_read_b128 v[208:211], v15 offset:0
    ds_read_b128 v[212:215], v15 offset:20480
    ds_read_b128 v[216:219], v15 offset:1024
    ds_read_b128 v[220:223], v15 offset:21504
    ds_read_b128 v[224:227], v15 offset:2048
    ds_read_b128 v[228:231], v15 offset:22528
    ds_read_b128 v[232:235], v15 offset:3072
    ds_read_b128 v[236:239], v15 offset:23552
    s_waitcnt lgkmcnt(6)
    v_mfma_f32_16x16x32_bf16 v[240:243], a[0:3], v[208:211], 0
    v_mfma_f32_16x16x32_bf16 v[244:247], a[4:7], v[208:211], 0
    v_mfma_f32_16x16x32_bf16 v[248:251], a[0:3], v[212:215], 0
    v_mfma_f32_16x16x32_bf16 v[252:255], a[4:7], v[212:215], 0
    ds_read_b128 v[208:211], v15 offset:4096
    ds_read_b128 v[212:215], v15 offset:24576
    s_waitcnt lgkmcnt(6)
    v_mfma_f32_16x16x32_bf16 v[240:243], a[8:11], v[216:219], v[240:243]
    v_mfma_f32_16x16x32_bf16 v[244:247], a[12:15], v[216:219], v[244:247]
    v_mfma_f32_16x16x32_bf16 v[248:251], a[8:11], v[220:223], v[248:251]
    v_mfma_f32_16x16x32_bf16 v[252:255], a[12:15], v[220:223], v[252:255]
    ds_read_b128 v[216:219], v15 offset:5120
    ds_read_b128 v[220:223], v15 offset:25600
    s_waitcnt lgkmcnt(6)
    v_mfma_f32_16x16x32_bf16 v[240:243], a[16:19], v[224:227], v[240:243]
    v_mfma_f32_16x16x32_bf16 v[244:247], a[20:23], v[224:227], v[244:247]
    v_mfma_f32_16x16x32_bf16 v[248:251], a[16:19], v[228:231], v[248:251]
    v_mfma_f32_16x16x32_bf16 v[252:255], a[20:23], v[228:231], v[252:255]
    ds_read_b128 v[224:227], v15 offset:6144
    ds_read_b128 v[228:231], v15 offset:26624
    s_waitcnt lgkmcnt(6)
    v_mfma_f32_16x16x32_bf16 v[240:243], a[24:27], v[232:235], v[240:243]
    v_mfma_f32_16x16x32_bf16 v[244:247], a[28:31], v[232:235], v[244:247]
    v_mfma_f32_16x16x32_bf16 v[248:251], a[24:27], v[236:239], v[248:251]
    v_mfma_f32_16x16x32_bf16 v[252:255], a[28:31], v[236:239], v[252:255]
    ds_read_b128 v[232:235], v15 offset:7168
    ds_read_b128 v[236:239], v15 offset:27648
    s_waitcnt lgkmcnt(6)
    v_mfma_f32_16x16x32_bf16 v[240:243], a[32:35], v[208:211], v[240:243]
    v_mfma_f32_16x16x32_bf16 v[244:247], a[36:39], v[208:211], v[244:247]
    v_mfma_f32_16x16x32_bf16 v[248:251], a[32:35], v[212:215], v[248:251]
    v_mfma_f32_16x16x32_bf16 v[252:255], a[36:39], v[212:215], v[252:255]
    ds_read_b128 v[208:211], v15 offset:8192
    ds_read_b128 v[212:215], v15 offset:28672
    s_waitcnt lgkmcnt(6)
    v_mfma_f32_16x16x32_bf16 v[240:243], a[40:43], v[216:219], v[240:243]
    v_mfma_f32_16x16x32_bf16 v[244:247], a[44:47], v[216:219], v[244:247]
    v_mfma_f32_16x16x32_bf16 v[248:251], a[40:43], v[220:223], v[248:251]
    v_mfma_f32_16x16x32_bf16 v[252:255], a[44:47], v[220:223], v[252:255]
    ds_read_b128 v[216:219], v15 offset:9216
    ds_read_b128 v[220:223], v15 offset:29696
    s_waitcnt lgkmcnt(6)
    v_mfma_f32_16x16x32_bf16 v[240:243], a[48:51], v[224:227], v[240:243]
    v_mfma_f32_16x16x32_bf16 v[244:247], a[52:55], v[224:227], v[244:247]
    v_mfma_f32_16x16x32_bf16 v[248:251], a[48:51], v[228:231], v[248:251]
    v_mfma_f32_16x16x32_bf16 v[252:255], a[52:55], v[228:231], v[252:255]
    ds_read_b128 v[224:227], v15 offset:10240
    ds_read_b128 v[228:231], v15 offset:30720
    s_waitcnt lgkmcnt(6)
    v_mfma_f32_16x16x32_bf16 v[240:243], a[56:59], v[232:235], v[240:243]
    v_mfma_f32_16x16x32_bf16 v[244:247], a[60:63], v[232:235], v[244:247]
    v_mfma_f32_16x16x32_bf16 v[248:251], a[56:59], v[236:239], v[248:251]
    v_mfma_f32_16x16x32_bf16 v[252:255], a[60:63], v[236:239], v[252:255]
    ds_read_b128 v[232:235], v15 offset:11264
    ds_read_b128 v[236:239], v15 offset:31744
    s_waitcnt lgkmcnt(6)
    v_mfma_f32_16x16x32_bf16 v[240:243], a[64:67], v[208:211], v[240:243]
    v_mfma_f32_16x16x32_bf16 v[244:247], a[68:71], v[208:211], v[244:247]
    v_mfma_f32_16x16x32_bf16 v[248:251], a[64:67], v[212:215], v[248:251]
    v_mfma_f32_16x16x32_bf16 v[252:255], a[68:71], v[212:215], v[252:255]
    ds_read_b128 v[208:211], v15 offset:12288
    ds_read_b128 v[212:215], v15 offset:32768
    s_waitcnt lgkmcnt(6)
    v_mfma_f32_16x16x32_bf16 v[240:243], a[72:75], v[216:219], v[240:243]
    v_mfma_f32_16x16x32_bf16 v[244:247], a[76:79], v[216:219], v[244:247]
    v_mfma_f32_16x16x32_bf16 v[248:251], a[72:75], v[220:223], v[248:251]
    v_mfma_f32_16x16x32_bf16 v[252:255], a[76:79], v[220:223], v[252:255]
    ds_read_b128 v[216:219], v15 offset:13312
    ds_read_b128 v[220:223], v15 offset:33792
    s_waitcnt lgkmcnt(6)
    v_mfma_f32_16x16x32_bf16 v[240:243], a[80:83], v[224:227], v[240:243]
    v_mfma_f32_16x16x32_bf16 v[244:247], a[84:87], v[224:227], v[244:247]
    v_mfma_f32_16x16x32_bf16 v[248:251], a[80:83], v[228:231], v[248:251]
    v_mfma_f32_16x16x32_bf16 v[252:255], a[84:87], v[228:231], v[252:255]
    ds_read_b128 v[224:227], v15 offset:14336
    ds_read_b128 v[228:231], v15 offset:34816
    s_waitcnt lgkmcnt(6)
    v_mfma_f32_16x16x32_bf16 v[240:243], a[88:91], v[232:235], v[240:243]
    v_mfma_f32_16x16x32_bf16 v[244:247], a[92:95], v[232:235], v[244:247]
    v_mfma_f32_16x16x32_bf16 v[248:251], a[88:91], v[236:239], v[248:251]
    v_mfma_f32_16x16x32_bf16 v[252:255], a[92:95], v[236:239], v[252:255]
    ds_read_b128 v[232:235], v15 offset:15360
    ds_read_b128 v[236:239], v15 offset:35840
    s_waitcnt lgkmcnt(6)
    v_mfma_f32_16x16x32_bf16 v[240:243], a[96:99], v[208:211], v[240:243]
    v_mfma_f32_16x16x32_bf16 v[244:247], a[100:103], v[208:211], v[244:247]
    v_mfma_f32_16x16x32_bf16 v[248:251], a[96:99], v[212:215], v[248:251]
    v_mfma_f32_16x16x32_bf16 v[252:255], a[100:103], v[212:215], v[252:255]
    ds_read_b128 v[208:211], v15 offset:16384
    ds_read_b128 v[212:215], v15 offset:36864
    s_waitcnt lgkmcnt(6)
    v_mfma_f32_16x16x32_bf16 v[240:243], a[104:107], v[216:219], v[240:243]
    v_mfma_f32_16x16x32_bf16 v[244:247], a[108:111], v[216:219], v[244:247]
    v_mfma_f32_16x16x32_bf16 v[248:251], a[104:107], v[220:223], v[248:251]
    v_mfma_f32_16x16x32_bf16 v[252:255], a[108:111], v[220:223], v[252:255]
    ds_read_b128 v[216:219], v15 offset:17408
    ds_read_b128 v[220:223], v15 offset:37888
    s_waitcnt lgkmcnt(6)
    v_mfma_f32_16x16x32_bf16 v[240:243], a[112:115], v[224:227], v[240:243]
    v_mfma_f32_16x16x32_bf16 v[244:247], a[116:119], v[224:227], v[244:247]
    v_mfma_f32_16x16x32_bf16 v[248:251], a[112:115], v[228:231], v[248:251]
    v_mfma_f32_16x16x32_bf16 v[252:255], a[116:119], v[228:231], v[252:255]
    ds_read_b128 v[224:227], v15 offset:18432
    ds_read_b128 v[228:231], v15 offset:38912
    s_waitcnt lgkmcnt(6)
    v_mfma_f32_16x16x32_bf16 v[240:243], a[120:123], v[232:235], v[240:243]
    v_mfma_f32_16x16x32_bf16 v[244:247], a[124:127], v[232:235], v[244:247]
    v_mfma_f32_16x16x32_bf16 v[248:251], a[120:123], v[236:239], v[248:251]
    v_mfma_f32_16x16x32_bf16 v[252:255], a[124:127], v[236:239], v[252:255]
    ds_read_b128 v[232:235], v15 offset:19456
    ds_read_b128 v[236:239], v15 offset:39936
    s_waitcnt lgkmcnt(6)
    v_mfma_f32_16x16x32_bf16 v[240:243], a[128:131], v[208:211], v[240:243]
    v_mfma_f32_16x16x32_bf16 v[244:247], a[132:135], v[208:211], v[244:247]
    v_mfma_f32_16x16x32_bf16 v[248:251], a[128:131], v[212:215], v[248:251]
    v_mfma_f32_16x16x32_bf16 v[252:255], a[132:135], v[212:215], v[252:255]
    s_waitcnt lgkmcnt(4)
    v_mfma_f32_16x16x32_bf16 v[240:243], a[136:139], v[216:219], v[240:243]
    v_mfma_f32_16x16x32_bf16 v[244:247], a[140:143], v[216:219], v[244:247]
    v_mfma_f32_16x16x32_bf16 v[248:251], a[136:139], v[220:223], v[248:251]
    v_mfma_f32_16x16x32_bf16 v[252:255], a[140:143], v[220:223], v[252:255]
    s_waitcnt lgkmcnt(2)
    v_mfma_f32_16x16x32_bf16 v[240:243], a[144:147], v[224:227], v[240:243]
    v_mfma_f32_16x16x32_bf16 v[244:247], a[148:151], v[224:227], v[244:247]
    v_mfma_f32_16x16x32_bf16 v[248:251], a[144:147], v[228:231], v[248:251]
    v_mfma_f32_16x16x32_bf16 v[252:255], a[148:151], v[228:231], v[252:255]
    s_waitcnt lgkmcnt(0)
    v_mfma_f32_16x16x32_bf16 v[240:243], a[152:155], v[232:235], v[240:243]
    v_mfma_f32_16x16x32_bf16 v[244:247], a[156:159], v[232:235], v[244:247]
    v_mfma_f32_16x16x32_bf16 v[248:251], a[152:155], v[236:239], v[248:251]
    v_mfma_f32_16x16x32_bf16 v[252:255], a[156:159], v[236:239], v[252:255]
    s_nop 4
    v_cvt_pk_bf16_f32 v208, v240, v241
    v_cvt_pk_bf16_f32 v209, v242, v243
    v_lshlrev_b32 v210, 16, v208
    v_and_b32 v211, 0xffff0000, v208
    v_lshlrev_b32 v212, 16, v96
    v_and_b32 v213, 0xffff0000, v96
    v_pk_add_f32 v[210:211], v[210:211], v[212:213]
    v_cvt_pk_bf16_f32 v216, v210, v211
    v_lshlrev_b32 v210, 16, v209
    v_and_b32 v211, 0xffff0000, v209
    v_lshlrev_b32 v212, 16, v97
    v_and_b32 v213, 0xffff0000, v97
    v_pk_add_f32 v[210:211], v[210:211], v[212:213]
    v_cvt_pk_bf16_f32 v217, v210, v211
    v_cvt_pk_bf16_f32 v208, v244, v245
    v_cvt_pk_bf16_f32 v209, v246, v247
    v_lshlrev_b32 v210, 16, v208
    v_and_b32 v211, 0xffff0000, v208
    v_lshlrev_b32 v212, 16, v98
    v_and_b32 v213, 0xffff0000, v98
    v_pk_add_f32 v[210:211], v[210:211], v[212:213]
    v_cvt_pk_bf16_f32 v218, v210, v211
    v_lshlrev_b32 v210, 16, v209
    v_and_b32 v211, 0xffff0000, v209
    v_lshlrev_b32 v212, 16, v99
    v_and_b32 v213, 0xffff0000, v99
    v_pk_add_f32 v[210:211], v[210:211], v[212:213]
    v_cvt_pk_bf16_f32 v219, v210, v211
    v_cvt_pk_bf16_f32 v208, v248, v249
    v_cvt_pk_bf16_f32 v209, v250, v251
    v_lshlrev_b32 v210, 16, v208
    v_and_b32 v211, 0xffff0000, v208
    v_lshlrev_b32 v212, 16, v100
    v_and_b32 v213, 0xffff0000, v100
    v_pk_add_f32 v[210:211], v[210:211], v[212:213]
    v_cvt_pk_bf16_f32 v220, v210, v211
    v_lshlrev_b32 v210, 16, v209
    v_and_b32 v211, 0xffff0000, v209
    v_lshlrev_b32 v212, 16, v101
    v_and_b32 v213, 0xffff0000, v101
    v_pk_add_f32 v[210:211], v[210:211], v[212:213]
    v_cvt_pk_bf16_f32 v221, v210, v211
    v_cvt_pk_bf16_f32 v208, v252, v253
    v_cvt_pk_bf16_f32 v209, v254, v255
    v_lshlrev_b32 v210, 16, v208
    v_and_b32 v211, 0xffff0000, v208
    v_lshlrev_b32 v212, 16, v102
    v_and_b32 v213, 0xffff0000, v102
    v_pk_add_f32 v[210:211], v[210:211], v[212:213]
    v_cvt_pk_bf16_f32 v222, v210, v211
    v_lshlrev_b32 v210, 16, v209
    v_and_b32 v211, 0xffff0000, v209
    v_lshlrev_b32 v212, 16, v103
    v_and_b32 v213, 0xffff0000, v103
    v_pk_add_f32 v[210:211], v[210:211], v[212:213]
    v_cvt_pk_bf16_f32 v223, v210, v211
    s_add_u32 s25, s43, 20480
    buffer_store_dwordx4 v[216:219], v12, s[8:11], s43 offen sc1
    buffer_store_dwordx4 v[220:223], v12, s[8:11], s25 offen sc1
    s_add_u32 s40, s40, 1
    s_add_u32 s43, s43, s77
    s_cmp_ge_u32 s40, s76
    s_cbranch_scc1 interleave_layers__linear_attn_block__memory_aug_recurrent_mem_tr__prompt_kernel_k3_done
    s_cmp_eq_u32 s40, 1
    s_cbranch_scc0 interleave_layers__linear_attn_block__memory_aug_recurrent_mem_tr__prompt_kernel_k3q12
    s_waitcnt vmcnt(0)
    s_barrier
    s_lshl_b32 s24, s92, 10
    s_lshl_b32 s25, s78, 2
    s_add_u32 s24, s24, s25
    s_add_u32 s24, s24, 23105536
    s_cmp_eq_u32 s3, 0
    s_cbranch_scc0 interleave_layers__linear_attn_block__memory_aug_recurrent_mem_tr__prompt_kernel_pb13
    v_lshlrev_b32 v14, 7, v1
    v_add_u32 v14, s24, v14
    v_mov_b32 v15, 2146435072
    v_cmp_le_u32 vcc, 8, v1
    s_nop 1
    v_cndmask_b32 v14, v14, v15, vcc
    v_mov_b32 v15, s40
    buffer_store_dword v15, v14, s[8:11], 0 offen sc1
interleave_layers__linear_attn_block__memory_aug_recurrent_mem_tr__prompt_kernel_pb13:
interleave_layers__linear_attn_block__memory_aug_recurrent_mem_tr__prompt_kernel_k3q12:
    s_xor_b32 s42, s42, 40960
    s_waitcnt vmcnt(2)
    v_mfma_f32_16x16x32_bf16 v[132:135], a[192:195], v[56:59], 0
    v_mfma_f32_16x16x32_bf16 v[136:139], a[202:205], v[60:63], 0
    v_mfma_f32_16x16x32_bf16 v[112:115], a[160:163], v[56:59], 0
    v_mfma_f32_16x16x32_bf16 v[116:119], a[164:167], v[56:59], 0
    v_mfma_f32_16x16x32_bf16 v[120:123], a[172:175], v[56:59], 0
    v_mfma_f32_16x16x32_bf16 v[124:127], a[180:183], v[60:63], 0
    v_mfma_f32_16x16x32_bf16 v[128:131], a[186:189], v[60:63], 0
    v_mfma_f32_16x16x32_bf16 v[132:135], a[196:199], v[60:63], v[132:135]
    v_mfma_f32_16x16x32_bf16 v[116:119], a[168:171], v[60:63], v[116:119]
    v_mfma_f32_16x16x32_bf16 v[120:123], a[176:179], v[60:63], v[120:123]
    v_mfma_f32_16x16x16_bf16 v[136:139], a[206:207], v[64:65], v[136:139]
    s_nop 0
    v_mfma_f32_16x16x16_bf16 v[124:127], a[184:185], v[64:65], v[124:127]
    v_mfma_f32_16x16x16_bf16 v[128:131], a[190:191], v[64:65], v[128:131]
    v_mfma_f32_16x16x16_bf16 v[132:135], a[200:201], v[64:65], v[132:135]
    v_mfma_f32_16x16x32_bf16 v[160:163], a[240:243], v[66:69], 0
    v_mfma_f32_16x16x32_bf16 v[164:167], a[250:253], v[70:73], 0
    v_mfma_f32_16x16x32_bf16 v[140:143], a[208:211], v[66:69], 0
    v_mfma_f32_16x16x32_bf16 v[144:147], a[212:215], v[66:69], 0
    v_mfma_f32_16x16x32_bf16 v[148:151], a[220:223], v[66:69], 0
    v_mfma_f32_16x16x32_bf16 v[152:155], a[228:231], v[70:73], 0
    v_mfma_f32_16x16x32_bf16 v[156:159], a[234:237], v[70:73], 0
    v_mfma_f32_16x16x32_bf16 v[160:163], a[244:247], v[70:73], v[160:163]
    v_mfma_f32_16x16x32_bf16 v[144:147], a[216:219], v[70:73], v[144:147]
    v_mfma_f32_16x16x32_bf16 v[148:151], a[224:227], v[70:73], v[148:151]
    v_mfma_f32_16x16x16_bf16 v[164:167], a[254:255], v[74:75], v[164:167]
    s_nop 0
    v_mfma_f32_16x16x16_bf16 v[152:155], a[232:233], v[74:75], v[152:155]
    v_mfma_f32_16x16x16_bf16 v[156:159], a[238:239], v[74:75], v[156:159]
    v_mfma_f32_16x16x16_bf16 v[160:163], a[248:249], v[74:75], v[160:163]
    v_add_f32 v132, s54, v132
    v_add_f32 v133, s54, v133
    v_add_f32 v134, s54, v134
    v_add_f32 v135, s54, v135
    v_add_f32 v136, s54, v136
    v_rcp_f32 v132, v132
    v_rcp_f32 v133, v133
    v_rcp_f32 v134, v134
    v_rcp_f32 v135, v135
    v_rcp_f32 v136, v136
    v_mul_f32 v112, v112, v132
    v_mul_f32 v113, v113, v132
    v_mul_f32 v114, v114, v132
    v_mul_f32 v115, v115, v132
    v_cvt_pk_bf16_f32 v168, v112, v113
    v_cvt_pk_bf16_f32 v169, v114, v115
    v_mul_f32 v116, v116, v133
    v_mul_f32 v117, v117, v133
    v_mul_f32 v118, v118, v133
    v_mul_f32 v119, v119, v133
    v_cvt_pk_bf16_f32 v170, v116, v117
    v_cvt_pk_bf16_f32 v171, v118, v119
    v_mul_f32 v120, v120, v134
    v_mul_f32 v121, v121, v134
    v_mul_f32 v122, v122, v134
    v_mul_f32 v123, v123, v134
    v_cvt_pk_bf16_f32 v172, v120, v121
    v_cvt_pk_bf16_f32 v173, v122, v123
    v_mul_f32 v124, v124, v135
    v_mul_f32 v125, v125, v135
    v_mul_f32 v126, v126, v135
    v_mul_f32 v127, v127, v135
    v_cvt_pk_bf16_f32 v174, v124, v125
    v_cvt_pk_bf16_f32 v175, v126, v127
    v_mul_f32 v128, v128, v136
    v_mul_f32 v129, v129, v136
    v_mul_f32 v130, v130, v136
    v_mul_f32 v131, v131, v136
    v_cvt_pk_bf16_f32 v176, v128, v129
    v_cvt_pk_bf16_f32 v177, v130, v131
    v_add_f32 v160, s54, v160
    v_add_f32 v161, s54, v161
    v_add_f32 v162, s54, v162
    v_add_f32 v163, s54, v163
    v_add_f32 v164, s54, v164
    v_rcp_f32 v160, v160
    v_rcp_f32 v161, v161
    v_rcp_f32 v162, v162
    v_rcp_f32 v163, v163
    v_rcp_f32 v164, v164
    v_mul_f32 v140, v140, v160
    v_mul_f32 v141, v141, v160
    v_mul_f32 v142, v142, v160
    v_mul_f32 v143, v143, v160
    v_cvt_pk_bf16_f32 v178, v140, v141
    v_cvt_pk_bf16_f32 v179, v142, v143
    v_mul_f32 v144, v144, v161
    v_mul_f32 v145, v145, v161
    v_mul_f32 v146, v146, v161
    v_mul_f32 v147, v147, v161
    v_cvt_pk_bf16_f32 v180, v144, v145
    v_cvt_pk_bf16_f32 v181, v146, v147
    v_mul_f32 v148, v148, v162
    v_mul_f32 v149, v149, v162
    v_mul_f32 v150, v150, v162
    v_mul_f32 v151, v151, v162
    v_cvt_pk_bf16_f32 v182, v148, v149
    v_cvt_pk_bf16_f32 v183, v150, v151
    v_mul_f32 v152, v152, v163
    v_mul_f32 v153, v153, v163
    v_mul_f32 v154, v154, v163
    v_mul_f32 v155, v155, v163
    v_cvt_pk_bf16_f32 v184, v152, v153
    v_cvt_pk_bf16_f32 v185, v154, v155
    v_mul_f32 v156, v156, v164
    v_mul_f32 v157, v157, v164
    v_mul_f32 v158, v158, v164
    v_mul_f32 v159, v159, v164
    v_cvt_pk_bf16_f32 v186, v156, v157
    v_cvt_pk_bf16_f32 v187, v158, v159
    v_mfma_f32_16x16x32_bf16 v[132:135], a[192:195], v[76:79], 0
    v_mfma_f32_16x16x32_bf16 v[136:139], a[202:205], v[80:83], 0
    v_mfma_f32_16x16x32_bf16 v[112:115], a[160:163], v[76:79], 0
    v_mfma_f32_16x16x32_bf16 v[116:119], a[164:167], v[76:79], 0
    v_mfma_f32_16x16x32_bf16 v[120:123], a[172:175], v[76:79], 0
    v_mfma_f32_16x16x32_bf16 v[124:127], a[180:183], v[80:83], 0
    v_mfma_f32_16x16x32_bf16 v[128:131], a[186:189], v[80:83], 0
    v_mfma_f32_16x16x32_bf16 v[132:135], a[196:199], v[80:83], v[132:135]
    v_mfma_f32_16x16x32_bf16 v[116:119], a[168:171], v[80:83], v[116:119]
    v_mfma_f32_16x16x32_bf16 v[120:123], a[176:179], v[80:83], v[120:123]
    v_mfma_f32_16x16x16_bf16 v[136:139], a[206:207], v[84:85], v[136:139]
    s_nop 0
    v_mfma_f32_16x16x16_bf16 v[124:127], a[184:185], v[84:85], v[124:127]
    v_mfma_f32_16x16x16_bf16 v[128:131], a[190:191], v[84:85], v[128:131]
    v_mfma_f32_16x16x16_bf16 v[132:135], a[200:201], v[84:85], v[132:135]
    v_mfma_f32_16x16x32_bf16 v[160:163], a[240:243], v[86:89], 0
    v_mfma_f32_16x16x32_bf16 v[164:167], a[250:253], v[90:93], 0
    v_mfma_f32_16x16x32_bf16 v[140:143], a[208:211], v[86:89], 0
    v_mfma_f32_16x16x32_bf16 v[144:147], a[212:215], v[86:89], 0
    v_mfma_f32_16x16x32_bf16 v[148:151], a[220:223], v[86:89], 0
    v_mfma_f32_16x16x32_bf16 v[152:155], a[228:231], v[90:93], 0
    v_mfma_f32_16x16x32_bf16 v[156:159], a[234:237], v[90:93], 0
    v_mfma_f32_16x16x32_bf16 v[160:163], a[244:247], v[90:93], v[160:163]
    v_mfma_f32_16x16x32_bf16 v[144:147], a[216:219], v[90:93], v[144:147]
    v_mfma_f32_16x16x32_bf16 v[148:151], a[224:227], v[90:93], v[148:151]
    v_mfma_f32_16x16x16_bf16 v[164:167], a[254:255], v[94:95], v[164:167]
    s_nop 0
    v_mfma_f32_16x16x16_bf16 v[152:155], a[232:233], v[94:95], v[152:155]
    v_mfma_f32_16x16x16_bf16 v[156:159], a[238:239], v[94:95], v[156:159]
    v_mfma_f32_16x16x16_bf16 v[160:163], a[248:249], v[94:95], v[160:163]
    v_add_f32 v132, s54, v132
    v_add_f32 v133, s54, v133
    v_add_f32 v134, s54, v134
    v_add_f32 v135, s54, v135
    v_add_f32 v136, s54, v136
    v_rcp_f32 v132, v132
    v_rcp_f32 v133, v133
    v_rcp_f32 v134, v134
    v_rcp_f32 v135, v135
    v_rcp_f32 v136, v136
    v_mul_f32 v112, v112, v132
    v_mul_f32 v113, v113, v132
    v_mul_f32 v114, v114, v132
    v_mul_f32 v115, v115, v132
    v_cvt_pk_bf16_f32 v188, v112, v113
    v_cvt_pk_bf16_f32 v189, v114, v115
    v_mul_f32 v116, v116, v133
    v_mul_f32 v117, v117, v133
    v_mul_f32 v118, v118, v133
    v_mul_f32 v119, v119, v133
    v_cvt_pk_bf16_f32 v190, v116, v117
    v_cvt_pk_bf16_f32 v191, v118, v119
    v_mul_f32 v120, v120, v134
    v_mul_f32 v121, v121, v134
    v_mul_f32 v122, v122, v134
    v_mul_f32 v123, v123, v134
    v_cvt_pk_bf16_f32 v192, v120, v121
    v_cvt_pk_bf16_f32 v193, v122, v123
    v_mul_f32 v124, v124, v135
    v_mul_f32 v125, v125, v135
    v_mul_f32 v126, v126, v135
    v_mul_f32 v127, v127, v135
    v_cvt_pk_bf16_f32 v194, v124, v125
    v_cvt_pk_bf16_f32 v195, v126, v127
    v_mul_f32 v128, v128, v136
    v_mul_f32 v129, v129, v136
    v_mul_f32 v130, v130, v136
    v_mul_f32 v131, v131, v136
    v_cvt_pk_bf16_f32 v196, v128, v129
    v_cvt_pk_bf16_f32 v197, v130, v131
    v_add_f32 v160, s54, v160
    v_add_f32 v161, s54, v161
    v_add_f32 v162, s54, v162
    v_add_f32 v163, s54, v163
    v_add_f32 v164, s54, v164
    v_rcp_f32 v160, v160
    v_rcp_f32 v161, v161
    v_rcp_f32 v162, v162
    v_rcp_f32 v163, v163
    v_rcp_f32 v164, v164
    v_mul_f32 v140, v140, v160
    v_mul_f32 v141, v141, v160
    v_mul_f32 v142, v142, v160
    v_mul_f32 v143, v143, v160
    v_cvt_pk_bf16_f32 v198, v140, v141
    v_cvt_pk_bf16_f32 v199, v142, v143
    v_mul_f32 v144, v144, v161
    v_mul_f32 v145, v145, v161
    v_mul_f32 v146, v146, v161
    v_mul_f32 v147, v147, v161
    v_cvt_pk_bf16_f32 v200, v144, v145
    v_cvt_pk_bf16_f32 v201, v146, v147
    v_mul_f32 v148, v148, v162
    v_mul_f32 v149, v149, v162
    v_mul_f32 v150, v150, v162
    v_mul_f32 v151, v151, v162
    v_cvt_pk_bf16_f32 v202, v148, v149
    v_cvt_pk_bf16_f32 v203, v150, v151
    v_mul_f32 v152, v152, v163
    v_mul_f32 v153, v153, v163
    v_mul_f32 v154, v154, v163
    v_mul_f32 v155, v155, v163
    v_cvt_pk_bf16_f32 v204, v152, v153
    v_cvt_pk_bf16_f32 v205, v154, v155
    v_mul_f32 v156, v156, v164
    v_mul_f32 v157, v157, v164
    v_mul_f32 v158, v158, v164
    v_mul_f32 v159, v159, v164
    v_cvt_pk_bf16_f32 v206, v156, v157
    v_cvt_pk_bf16_f32 v207, v158, v159
    v_add_u32 v14, s42, v13
    ds_write_b128 v14, v[168:171] offset:0
    ds_write_b128 v14, v[172:175] offset:1024
    ds_write_b128 v14, v[176:179] offset:2048
    ds_write_b128 v14, v[180:183] offset:3072
    ds_write_b128 v14, v[184:187] offset:4096
    ds_write_b128 v14, v[188:191] offset:20480
    ds_write_b128 v14, v[192:195] offset:21504
    ds_write_b128 v14, v[196:199] offset:22528
    ds_write_b128 v14, v[200:203] offset:23552
    ds_write_b128 v14, v[204:207] offset:24576
    s_add_u32 s41, s43, s77
    s_add_u32 s24, s40, 1
    s_cmp_lt_u32 s24, s76
    s_cselect_b32 s41, s41, 2146435072
    s_waitcnt vmcnt(0)
    s_add_u32 s25, s41, 20480
    buffer_load_dwordx4 v[16:19], v8, s[8:11], s41 offen offset:0 sc1
    buffer_load_dwordx4 v[20:23], v8, s[8:11], s41 offen offset:1024 sc1
    buffer_load_dwordx2 v[24:25], v9, s[8:11], s41 offen offset:0 sc1
    buffer_load_dwordx4 v[26:29], v8, s[8:11], s41 offen offset:2560 sc1
    buffer_load_dwordx4 v[30:33], v8, s[8:11], s41 offen offset:3584 sc1
    buffer_load_dwordx2 v[34:35], v9, s[8:11], s41 offen offset:2560 sc1
    buffer_load_dwordx4 v[36:39], v8, s[8:11], s25 offen offset:0 sc1
    buffer_load_dwordx4 v[40:43], v8, s[8:11], s25 offen offset:1024 sc1
    buffer_load_dwordx2 v[44:45], v9, s[8:11], s25 offen offset:0 sc1
    buffer_load_dwordx4 v[46:49], v8, s[8:11], s25 offen offset:2560 sc1
    buffer_load_dwordx4 v[50:53], v8, s[8:11], s25 offen offset:3584 sc1
    buffer_load_dwordx2 v[54:55], v9, s[8:11], s25 offen offset:2560 sc1
    buffer_load_dwordx2 v[96:97], v10, s[16:19], s41 offen sc1
    buffer_load_dwordx2 v[98:99], v11, s[16:19], s41 offen sc1
    buffer_load_dwordx2 v[100:101], v10, s[16:19], s25 offen sc1
    buffer_load_dwordx2 v[102:103], v11, s[16:19], s25 offen sc1
    s_waitcnt lgkmcnt(0)
    s_barrier
    s_lshl_b32 s24, s92, 10
    s_lshl_b32 s25, s78, 2
    s_add_u32 s24, s24, s25
    s_add_u32 s24, s24, 23105536
    s_cmp_eq_u32 s3, 0
    s_cbranch_scc0 interleave_layers__linear_attn_block__memory_aug_recurrent_mem_tr__prompt_kernel_pb14
    v_lshlrev_b32 v14, 7, v1
    v_add_u32 v14, s24, v14
    v_mov_b32 v15, 2146435072
    v_cmp_le_u32 vcc, 8, v1
    s_nop 1
    v_cndmask_b32 v14, v14, v15, vcc
    v_mov_b32 v15, s40
    buffer_store_dword v15, v14, s[8:11], 0 offen sc1
interleave_layers__linear_attn_block__memory_aug_recurrent_mem_tr__prompt_kernel_pb14:
    v_add_u32 v15, s42, v5
    ds_read_b128 v[208:211], v15 offset:0
    ds_read_b128 v[212:215], v15 offset:20480
    ds_read_b128 v[216:219], v15 offset:1024
    ds_read_b128 v[220:223], v15 offset:21504
    ds_read_b128 v[224:227], v15 offset:2048
    ds_read_b128 v[228:231], v15 offset:22528
    ds_read_b128 v[232:235], v15 offset:3072
    ds_read_b128 v[236:239], v15 offset:23552
    s_waitcnt lgkmcnt(6)
    v_mfma_f32_16x16x32_bf16 v[240:243], a[0:3], v[208:211], 0
    v_mfma_f32_16x16x32_bf16 v[244:247], a[4:7], v[208:211], 0
    v_mfma_f32_16x16x32_bf16 v[248:251], a[0:3], v[212:215], 0
    v_mfma_f32_16x16x32_bf16 v[252:255], a[4:7], v[212:215], 0
    ds_read_b128 v[208:211], v15 offset:4096
    ds_read_b128 v[212:215], v15 offset:24576
    s_waitcnt lgkmcnt(6)
    v_mfma_f32_16x16x32_bf16 v[240:243], a[8:11], v[216:219], v[240:243]
    v_mfma_f32_16x16x32_bf16 v[244:247], a[12:15], v[216:219], v[244:247]
    v_mfma_f32_16x16x32_bf16 v[248:251], a[8:11], v[220:223], v[248:251]
    v_mfma_f32_16x16x32_bf16 v[252:255], a[12:15], v[220:223], v[252:255]
    ds_read_b128 v[216:219], v15 offset:5120
    ds_read_b128 v[220:223], v15 offset:25600
    s_waitcnt lgkmcnt(6)
    v_mfma_f32_16x16x32_bf16 v[240:243], a[16:19], v[224:227], v[240:243]
    v_mfma_f32_16x16x32_bf16 v[244:247], a[20:23], v[224:227], v[244:247]
    v_mfma_f32_16x16x32_bf16 v[248:251], a[16:19], v[228:231], v[248:251]
    v_mfma_f32_16x16x32_bf16 v[252:255], a[20:23], v[228:231], v[252:255]
    ds_read_b128 v[224:227], v15 offset:6144
    ds_read_b128 v[228:231], v15 offset:26624
    s_waitcnt lgkmcnt(6)
    v_mfma_f32_16x16x32_bf16 v[240:243], a[24:27], v[232:235], v[240:243]
    v_mfma_f32_16x16x32_bf16 v[244:247], a[28:31], v[232:235], v[244:247]
    v_mfma_f32_16x16x32_bf16 v[248:251], a[24:27], v[236:239], v[248:251]
    v_mfma_f32_16x16x32_bf16 v[252:255], a[28:31], v[236:239], v[252:255]
    ds_read_b128 v[232:235], v15 offset:7168
    ds_read_b128 v[236:239], v15 offset:27648
    s_waitcnt lgkmcnt(6)
    v_mfma_f32_16x16x32_bf16 v[240:243], a[32:35], v[208:211], v[240:243]
    v_mfma_f32_16x16x32_bf16 v[244:247], a[36:39], v[208:211], v[244:247]
    v_mfma_f32_16x16x32_bf16 v[248:251], a[32:35], v[212:215], v[248:251]
    v_mfma_f32_16x16x32_bf16 v[252:255], a[36:39], v[212:215], v[252:255]
    ds_read_b128 v[208:211], v15 offset:8192
    ds_read_b128 v[212:215], v15 offset:28672
    s_waitcnt lgkmcnt(6)
    v_mfma_f32_16x16x32_bf16 v[240:243], a[40:43], v[216:219], v[240:243]
    v_mfma_f32_16x16x32_bf16 v[244:247], a[44:47], v[216:219], v[244:247]
    v_mfma_f32_16x16x32_bf16 v[248:251], a[40:43], v[220:223], v[248:251]
    v_mfma_f32_16x16x32_bf16 v[252:255], a[44:47], v[220:223], v[252:255]
    ds_read_b128 v[216:219], v15 offset:9216
    ds_read_b128 v[220:223], v15 offset:29696
    s_waitcnt lgkmcnt(6)
    v_mfma_f32_16x16x32_bf16 v[240:243], a[48:51], v[224:227], v[240:243]
    v_mfma_f32_16x16x32_bf16 v[244:247], a[52:55], v[224:227], v[244:247]
    v_mfma_f32_16x16x32_bf16 v[248:251], a[48:51], v[228:231], v[248:251]
    v_mfma_f32_16x16x32_bf16 v[252:255], a[52:55], v[228:231], v[252:255]
    ds_read_b128 v[224:227], v15 offset:10240
    ds_read_b128 v[228:231], v15 offset:30720
    s_waitcnt lgkmcnt(6)
    v_mfma_f32_16x16x32_bf16 v[240:243], a[56:59], v[232:235], v[240:243]
    v_mfma_f32_16x16x32_bf16 v[244:247], a[60:63], v[232:235], v[244:247]
    v_mfma_f32_16x16x32_bf16 v[248:251], a[56:59], v[236:239], v[248:251]
    v_mfma_f32_16x16x32_bf16 v[252:255], a[60:63], v[236:239], v[252:255]
    ds_read_b128 v[232:235], v15 offset:11264
    ds_read_b128 v[236:239], v15 offset:31744
    s_waitcnt lgkmcnt(6)
    v_mfma_f32_16x16x32_bf16 v[240:243], a[64:67], v[208:211], v[240:243]
    v_mfma_f32_16x16x32_bf16 v[244:247], a[68:71], v[208:211], v[244:247]
    v_mfma_f32_16x16x32_bf16 v[248:251], a[64:67], v[212:215], v[248:251]
    v_mfma_f32_16x16x32_bf16 v[252:255], a[68:71], v[212:215], v[252:255]
    ds_read_b128 v[208:211], v15 offset:12288
    ds_read_b128 v[212:215], v15 offset:32768
    s_waitcnt lgkmcnt(6)
    v_mfma_f32_16x16x32_bf16 v[240:243], a[72:75], v[216:219], v[240:243]
    v_mfma_f32_16x16x32_bf16 v[244:247], a[76:79], v[216:219], v[244:247]
    v_mfma_f32_16x16x32_bf16 v[248:251], a[72:75], v[220:223], v[248:251]
    v_mfma_f32_16x16x32_bf16 v[252:255], a[76:79], v[220:223], v[252:255]
    ds_read_b128 v[216:219], v15 offset:13312
    ds_read_b128 v[220:223], v15 offset:33792
    s_waitcnt lgkmcnt(6)
    v_mfma_f32_16x16x32_bf16 v[240:243], a[80:83], v[224:227], v[240:243]
    v_mfma_f32_16x16x32_bf16 v[244:247], a[84:87], v[224:227], v[244:247]
    v_mfma_f32_16x16x32_bf16 v[248:251], a[80:83], v[228:231], v[248:251]
    v_mfma_f32_16x16x32_bf16 v[252:255], a[84:87], v[228:231], v[252:255]
    ds_read_b128 v[224:227], v15 offset:14336
    ds_read_b128 v[228:231], v15 offset:34816
    s_waitcnt lgkmcnt(6)
    v_mfma_f32_16x16x32_bf16 v[240:243], a[88:91], v[232:235], v[240:243]
    v_mfma_f32_16x16x32_bf16 v[244:247], a[92:95], v[232:235], v[244:247]
    v_mfma_f32_16x16x32_bf16 v[248:251], a[88:91], v[236:239], v[248:251]
    v_mfma_f32_16x16x32_bf16 v[252:255], a[92:95], v[236:239], v[252:255]
    ds_read_b128 v[232:235], v15 offset:15360
    ds_read_b128 v[236:239], v15 offset:35840
    s_waitcnt lgkmcnt(6)
    v_mfma_f32_16x16x32_bf16 v[240:243], a[96:99], v[208:211], v[240:243]
    v_mfma_f32_16x16x32_bf16 v[244:247], a[100:103], v[208:211], v[244:247]
    v_mfma_f32_16x16x32_bf16 v[248:251], a[96:99], v[212:215], v[248:251]
    v_mfma_f32_16x16x32_bf16 v[252:255], a[100:103], v[212:215], v[252:255]
    ds_read_b128 v[208:211], v15 offset:16384
    ds_read_b128 v[212:215], v15 offset:36864
    s_waitcnt lgkmcnt(6)
    v_mfma_f32_16x16x32_bf16 v[240:243], a[104:107], v[216:219], v[240:243]
    v_mfma_f32_16x16x32_bf16 v[244:247], a[108:111], v[216:219], v[244:247]
    v_mfma_f32_16x16x32_bf16 v[248:251], a[104:107], v[220:223], v[248:251]
    v_mfma_f32_16x16x32_bf16 v[252:255], a[108:111], v[220:223], v[252:255]
    ds_read_b128 v[216:219], v15 offset:17408
    ds_read_b128 v[220:223], v15 offset:37888
    s_waitcnt lgkmcnt(6)
    v_mfma_f32_16x16x32_bf16 v[240:243], a[112:115], v[224:227], v[240:243]
    v_mfma_f32_16x16x32_bf16 v[244:247], a[116:119], v[224:227], v[244:247]
    v_mfma_f32_16x16x32_bf16 v[248:251], a[112:115], v[228:231], v[248:251]
    v_mfma_f32_16x16x32_bf16 v[252:255], a[116:119], v[228:231], v[252:255]
    ds_read_b128 v[224:227], v15 offset:18432
    ds_read_b128 v[228:231], v15 offset:38912
    s_waitcnt lgkmcnt(6)
    v_mfma_f32_16x16x32_bf16 v[240:243], a[120:123], v[232:235], v[240:243]
    v_mfma_f32_16x16x32_bf16 v[244:247], a[124:127], v[232:235], v[244:247]
    v_mfma_f32_16x16x32_bf16 v[248:251], a[120:123], v[236:239], v[248:251]
    v_mfma_f32_16x16x32_bf16 v[252:255], a[124:127], v[236:239], v[252:255]
    ds_read_b128 v[232:235], v15 offset:19456
    ds_read_b128 v[236:239], v15 offset:39936
    s_waitcnt lgkmcnt(6)
    v_mfma_f32_16x16x32_bf16 v[240:243], a[128:131], v[208:211], v[240:243]
    v_mfma_f32_16x16x32_bf16 v[244:247], a[132:135], v[208:211], v[244:247]
    v_mfma_f32_16x16x32_bf16 v[248:251], a[128:131], v[212:215], v[248:251]
    v_mfma_f32_16x16x32_bf16 v[252:255], a[132:135], v[212:215], v[252:255]
    s_waitcnt lgkmcnt(4)
    v_mfma_f32_16x16x32_bf16 v[240:243], a[136:139], v[216:219], v[240:243]
    v_mfma_f32_16x16x32_bf16 v[244:247], a[140:143], v[216:219], v[244:247]
    v_mfma_f32_16x16x32_bf16 v[248:251], a[136:139], v[220:223], v[248:251]
    v_mfma_f32_16x16x32_bf16 v[252:255], a[140:143], v[220:223], v[252:255]
    s_waitcnt lgkmcnt(2)
    v_mfma_f32_16x16x32_bf16 v[240:243], a[144:147], v[224:227], v[240:243]
    v_mfma_f32_16x16x32_bf16 v[244:247], a[148:151], v[224:227], v[244:247]
    v_mfma_f32_16x16x32_bf16 v[248:251], a[144:147], v[228:231], v[248:251]
    v_mfma_f32_16x16x32_bf16 v[252:255], a[148:151], v[228:231], v[252:255]
    s_waitcnt lgkmcnt(0)
    v_mfma_f32_16x16x32_bf16 v[240:243], a[152:155], v[232:235], v[240:243]
    v_mfma_f32_16x16x32_bf16 v[244:247], a[156:159], v[232:235], v[244:247]
    v_mfma_f32_16x16x32_bf16 v[248:251], a[152:155], v[236:239], v[248:251]
    v_mfma_f32_16x16x32_bf16 v[252:255], a[156:159], v[236:239], v[252:255]
    s_nop 4
    v_cvt_pk_bf16_f32 v208, v240, v241
    v_cvt_pk_bf16_f32 v209, v242, v243
    v_lshlrev_b32 v210, 16, v208
    v_and_b32 v211, 0xffff0000, v208
    v_lshlrev_b32 v212, 16, v104
    v_and_b32 v213, 0xffff0000, v104
    v_pk_add_f32 v[210:211], v[210:211], v[212:213]
    v_cvt_pk_bf16_f32 v216, v210, v211
    v_lshlrev_b32 v210, 16, v209
    v_and_b32 v211, 0xffff0000, v209
    v_lshlrev_b32 v212, 16, v105
    v_and_b32 v213, 0xffff0000, v105
    v_pk_add_f32 v[210:211], v[210:211], v[212:213]
    v_cvt_pk_bf16_f32 v217, v210, v211
    v_cvt_pk_bf16_f32 v208, v244, v245
    v_cvt_pk_bf16_f32 v209, v246, v247
    v_lshlrev_b32 v210, 16, v208
    v_and_b32 v211, 0xffff0000, v208
    v_lshlrev_b32 v212, 16, v106
    v_and_b32 v213, 0xffff0000, v106
    v_pk_add_f32 v[210:211], v[210:211], v[212:213]
    v_cvt_pk_bf16_f32 v218, v210, v211
    v_lshlrev_b32 v210, 16, v209
    v_and_b32 v211, 0xffff0000, v209
    v_lshlrev_b32 v212, 16, v107
    v_and_b32 v213, 0xffff0000, v107
    v_pk_add_f32 v[210:211], v[210:211], v[212:213]
    v_cvt_pk_bf16_f32 v219, v210, v211
    v_cvt_pk_bf16_f32 v208, v248, v249
    v_cvt_pk_bf16_f32 v209, v250, v251
    v_lshlrev_b32 v210, 16, v208
    v_and_b32 v211, 0xffff0000, v208
    v_lshlrev_b32 v212, 16, v108
    v_and_b32 v213, 0xffff0000, v108
    v_pk_add_f32 v[210:211], v[210:211], v[212:213]
    v_cvt_pk_bf16_f32 v220, v210, v211
    v_lshlrev_b32 v210, 16, v209
    v_and_b32 v211, 0xffff0000, v209
    v_lshlrev_b32 v212, 16, v109
    v_and_b32 v213, 0xffff0000, v109
    v_pk_add_f32 v[210:211], v[210:211], v[212:213]
    v_cvt_pk_bf16_f32 v221, v210, v211
    v_cvt_pk_bf16_f32 v208, v252, v253
    v_cvt_pk_bf16_f32 v209, v254, v255
    v_lshlrev_b32 v210, 16, v208
    v_and_b32 v211, 0xffff0000, v208
    v_lshlrev_b32 v212, 16, v110
    v_and_b32 v213, 0xffff0000, v110
    v_pk_add_f32 v[210:211], v[210:211], v[212:213]
    v_cvt_pk_bf16_f32 v222, v210, v211
    v_lshlrev_b32 v210, 16, v209
    v_and_b32 v211, 0xffff0000, v209
    v_lshlrev_b32 v212, 16, v111
    v_and_b32 v213, 0xffff0000, v111
    v_pk_add_f32 v[210:211], v[210:211], v[212:213]
    v_cvt_pk_bf16_f32 v223, v210, v211
    s_add_u32 s25, s43, 20480
    buffer_store_dwordx4 v[216:219], v12, s[8:11], s43 offen sc1
    buffer_store_dwordx4 v[220:223], v12, s[8:11], s25 offen sc1
    s_add_u32 s40, s40, 1
    s_add_u32 s43, s43, s77
    s_cmp_ge_u32 s40, s76
    s_cbranch_scc1 interleave_layers__linear_attn_block__memory_aug_recurrent_mem_tr__prompt_kernel_k3_done
    s_xor_b32 s42, s42, 40960
    s_waitcnt vmcnt(2)
    v_mfma_f32_16x16x32_bf16 v[132:135], a[192:195], v[16:19], 0
    v_mfma_f32_16x16x32_bf16 v[136:139], a[202:205], v[20:23], 0
    v_mfma_f32_16x16x32_bf16 v[112:115], a[160:163], v[16:19], 0
    v_mfma_f32_16x16x32_bf16 v[116:119], a[164:167], v[16:19], 0
    v_mfma_f32_16x16x32_bf16 v[120:123], a[172:175], v[16:19], 0
    v_mfma_f32_16x16x32_bf16 v[124:127], a[180:183], v[20:23], 0
    v_mfma_f32_16x16x32_bf16 v[128:131], a[186:189], v[20:23], 0
    v_mfma_f32_16x16x32_bf16 v[132:135], a[196:199], v[20:23], v[132:135]
    v_mfma_f32_16x16x32_bf16 v[116:119], a[168:171], v[20:23], v[116:119]
    v_mfma_f32_16x16x32_bf16 v[120:123], a[176:179], v[20:23], v[120:123]
    v_mfma_f32_16x16x16_bf16 v[136:139], a[206:207], v[24:25], v[136:139]
    s_nop 0
    v_mfma_f32_16x16x16_bf16 v[124:127], a[184:185], v[24:25], v[124:127]
    v_mfma_f32_16x16x16_bf16 v[128:131], a[190:191], v[24:25], v[128:131]
    v_mfma_f32_16x16x16_bf16 v[132:135], a[200:201], v[24:25], v[132:135]
    v_mfma_f32_16x16x32_bf16 v[160:163], a[240:243], v[26:29], 0
    v_mfma_f32_16x16x32_bf16 v[164:167], a[250:253], v[30:33], 0
    v_mfma_f32_16x16x32_bf16 v[140:143], a[208:211], v[26:29], 0
    v_mfma_f32_16x16x32_bf16 v[144:147], a[212:215], v[26:29], 0
    v_mfma_f32_16x16x32_bf16 v[148:151], a[220:223], v[26:29], 0
    v_mfma_f32_16x16x32_bf16 v[152:155], a[228:231], v[30:33], 0
    v_mfma_f32_16x16x32_bf16 v[156:159], a[234:237], v[30:33], 0
    v_mfma_f32_16x16x32_bf16 v[160:163], a[244:247], v[30:33], v[160:163]
    v_mfma_f32_16x16x32_bf16 v[144:147], a[216:219], v[30:33], v[144:147]
    v_mfma_f32_16x16x32_bf16 v[148:151], a[224:227], v[30:33], v[148:151]
    v_mfma_f32_16x16x16_bf16 v[164:167], a[254:255], v[34:35], v[164:167]
    s_nop 0
    v_mfma_f32_16x16x16_bf16 v[152:155], a[232:233], v[34:35], v[152:155]
    v_mfma_f32_16x16x16_bf16 v[156:159], a[238:239], v[34:35], v[156:159]
    v_mfma_f32_16x16x16_bf16 v[160:163], a[248:249], v[34:35], v[160:163]
    v_add_f32 v132, s54, v132
    v_add_f32 v133, s54, v133
    v_add_f32 v134, s54, v134
    v_add_f32 v135, s54, v135
    v_add_f32 v136, s54, v136
    v_rcp_f32 v132, v132
    v_rcp_f32 v133, v133
    v_rcp_f32 v134, v134
    v_rcp_f32 v135, v135
    v_rcp_f32 v136, v136
    v_mul_f32 v112, v112, v132
    v_mul_f32 v113, v113, v132
    v_mul_f32 v114, v114, v132
    v_mul_f32 v115, v115, v132
    v_cvt_pk_bf16_f32 v168, v112, v113
    v_cvt_pk_bf16_f32 v169, v114, v115
    v_mul_f32 v116, v116, v133
    v_mul_f32 v117, v117, v133
    v_mul_f32 v118, v118, v133
    v_mul_f32 v119, v119, v133
    v_cvt_pk_bf16_f32 v170, v116, v117
    v_cvt_pk_bf16_f32 v171, v118, v119
    v_mul_f32 v120, v120, v134
    v_mul_f32 v121, v121, v134
    v_mul_f32 v122, v122, v134
    v_mul_f32 v123, v123, v134
    v_cvt_pk_bf16_f32 v172, v120, v121
    v_cvt_pk_bf16_f32 v173, v122, v123
    v_mul_f32 v124, v124, v135
    v_mul_f32 v125, v125, v135
    v_mul_f32 v126, v126, v135
    v_mul_f32 v127, v127, v135
    v_cvt_pk_bf16_f32 v174, v124, v125
    v_cvt_pk_bf16_f32 v175, v126, v127
    v_mul_f32 v128, v128, v136
    v_mul_f32 v129, v129, v136
    v_mul_f32 v130, v130, v136
    v_mul_f32 v131, v131, v136
    v_cvt_pk_bf16_f32 v176, v128, v129
    v_cvt_pk_bf16_f32 v177, v130, v131
    v_add_f32 v160, s54, v160
    v_add_f32 v161, s54, v161
    v_add_f32 v162, s54, v162
    v_add_f32 v163, s54, v163
    v_add_f32 v164, s54, v164
    v_rcp_f32 v160, v160
    v_rcp_f32 v161, v161
    v_rcp_f32 v162, v162
    v_rcp_f32 v163, v163
    v_rcp_f32 v164, v164
    v_mul_f32 v140, v140, v160
    v_mul_f32 v141, v141, v160
    v_mul_f32 v142, v142, v160
    v_mul_f32 v143, v143, v160
    v_cvt_pk_bf16_f32 v178, v140, v141
    v_cvt_pk_bf16_f32 v179, v142, v143
    v_mul_f32 v144, v144, v161
    v_mul_f32 v145, v145, v161
    v_mul_f32 v146, v146, v161
    v_mul_f32 v147, v147, v161
    v_cvt_pk_bf16_f32 v180, v144, v145
    v_cvt_pk_bf16_f32 v181, v146, v147
    v_mul_f32 v148, v148, v162
    v_mul_f32 v149, v149, v162
    v_mul_f32 v150, v150, v162
    v_mul_f32 v151, v151, v162
    v_cvt_pk_bf16_f32 v182, v148, v149
    v_cvt_pk_bf16_f32 v183, v150, v151
    v_mul_f32 v152, v152, v163
    v_mul_f32 v153, v153, v163
    v_mul_f32 v154, v154, v163
    v_mul_f32 v155, v155, v163
    v_cvt_pk_bf16_f32 v184, v152, v153
    v_cvt_pk_bf16_f32 v185, v154, v155
    v_mul_f32 v156, v156, v164
    v_mul_f32 v157, v157, v164
    v_mul_f32 v158, v158, v164
    v_mul_f32 v159, v159, v164
    v_cvt_pk_bf16_f32 v186, v156, v157
    v_cvt_pk_bf16_f32 v187, v158, v159
    v_mfma_f32_16x16x32_bf16 v[132:135], a[192:195], v[36:39], 0
    v_mfma_f32_16x16x32_bf16 v[136:139], a[202:205], v[40:43], 0
    v_mfma_f32_16x16x32_bf16 v[112:115], a[160:163], v[36:39], 0
    v_mfma_f32_16x16x32_bf16 v[116:119], a[164:167], v[36:39], 0
    v_mfma_f32_16x16x32_bf16 v[120:123], a[172:175], v[36:39], 0
    v_mfma_f32_16x16x32_bf16 v[124:127], a[180:183], v[40:43], 0
    v_mfma_f32_16x16x32_bf16 v[128:131], a[186:189], v[40:43], 0
    v_mfma_f32_16x16x32_bf16 v[132:135], a[196:199], v[40:43], v[132:135]
    v_mfma_f32_16x16x32_bf16 v[116:119], a[168:171], v[40:43], v[116:119]
    v_mfma_f32_16x16x32_bf16 v[120:123], a[176:179], v[40:43], v[120:123]
    v_mfma_f32_16x16x16_bf16 v[136:139], a[206:207], v[44:45], v[136:139]
    s_nop 0
    v_mfma_f32_16x16x16_bf16 v[124:127], a[184:185], v[44:45], v[124:127]
    v_mfma_f32_16x16x16_bf16 v[128:131], a[190:191], v[44:45], v[128:131]
    v_mfma_f32_16x16x16_bf16 v[132:135], a[200:201], v[44:45], v[132:135]
    v_mfma_f32_16x16x32_bf16 v[160:163], a[240:243], v[46:49], 0
    v_mfma_f32_16x16x32_bf16 v[164:167], a[250:253], v[50:53], 0
    v_mfma_f32_16x16x32_bf16 v[140:143], a[208:211], v[46:49], 0
    v_mfma_f32_16x16x32_bf16 v[144:147], a[212:215], v[46:49], 0
    v_mfma_f32_16x16x32_bf16 v[148:151], a[220:223], v[46:49], 0
    v_mfma_f32_16x16x32_bf16 v[152:155], a[228:231], v[50:53], 0
    v_mfma_f32_16x16x32_bf16 v[156:159], a[234:237], v[50:53], 0
    v_mfma_f32_16x16x32_bf16 v[160:163], a[244:247], v[50:53], v[160:163]
    v_mfma_f32_16x16x32_bf16 v[144:147], a[216:219], v[50:53], v[144:147]
    v_mfma_f32_16x16x32_bf16 v[148:151], a[224:227], v[50:53], v[148:151]
    v_mfma_f32_16x16x16_bf16 v[164:167], a[254:255], v[54:55], v[164:167]
    s_nop 0
    v_mfma_f32_16x16x16_bf16 v[152:155], a[232:233], v[54:55], v[152:155]
    v_mfma_f32_16x16x16_bf16 v[156:159], a[238:239], v[54:55], v[156:159]
    v_mfma_f32_16x16x16_bf16 v[160:163], a[248:249], v[54:55], v[160:163]
    v_add_f32 v132, s54, v132
    v_add_f32 v133, s54, v133
    v_add_f32 v134, s54, v134
    v_add_f32 v135, s54, v135
    v_add_f32 v136, s54, v136
    v_rcp_f32 v132, v132
    v_rcp_f32 v133, v133
    v_rcp_f32 v134, v134
    v_rcp_f32 v135, v135
    v_rcp_f32 v136, v136
    v_mul_f32 v112, v112, v132
    v_mul_f32 v113, v113, v132
    v_mul_f32 v114, v114, v132
    v_mul_f32 v115, v115, v132
    v_cvt_pk_bf16_f32 v188, v112, v113
    v_cvt_pk_bf16_f32 v189, v114, v115
    v_mul_f32 v116, v116, v133
    v_mul_f32 v117, v117, v133
    v_mul_f32 v118, v118, v133
    v_mul_f32 v119, v119, v133
    v_cvt_pk_bf16_f32 v190, v116, v117
    v_cvt_pk_bf16_f32 v191, v118, v119
    v_mul_f32 v120, v120, v134
    v_mul_f32 v121, v121, v134
    v_mul_f32 v122, v122, v134
    v_mul_f32 v123, v123, v134
    v_cvt_pk_bf16_f32 v192, v120, v121
    v_cvt_pk_bf16_f32 v193, v122, v123
    v_mul_f32 v124, v124, v135
    v_mul_f32 v125, v125, v135
    v_mul_f32 v126, v126, v135
    v_mul_f32 v127, v127, v135
    v_cvt_pk_bf16_f32 v194, v124, v125
    v_cvt_pk_bf16_f32 v195, v126, v127
    v_mul_f32 v128, v128, v136
    v_mul_f32 v129, v129, v136
    v_mul_f32 v130, v130, v136
    v_mul_f32 v131, v131, v136
    v_cvt_pk_bf16_f32 v196, v128, v129
    v_cvt_pk_bf16_f32 v197, v130, v131
    v_add_f32 v160, s54, v160
    v_add_f32 v161, s54, v161
    v_add_f32 v162, s54, v162
    v_add_f32 v163, s54, v163
    v_add_f32 v164, s54, v164
    v_rcp_f32 v160, v160
    v_rcp_f32 v161, v161
    v_rcp_f32 v162, v162
    v_rcp_f32 v163, v163
    v_rcp_f32 v164, v164
    v_mul_f32 v140, v140, v160
    v_mul_f32 v141, v141, v160
    v_mul_f32 v142, v142, v160
    v_mul_f32 v143, v143, v160
    v_cvt_pk_bf16_f32 v198, v140, v141
    v_cvt_pk_bf16_f32 v199, v142, v143
    v_mul_f32 v144, v144, v161
    v_mul_f32 v145, v145, v161
    v_mul_f32 v146, v146, v161
    v_mul_f32 v147, v147, v161
    v_cvt_pk_bf16_f32 v200, v144, v145
    v_cvt_pk_bf16_f32 v201, v146, v147
    v_mul_f32 v148, v148, v162
    v_mul_f32 v149, v149, v162
    v_mul_f32 v150, v150, v162
    v_mul_f32 v151, v151, v162
    v_cvt_pk_bf16_f32 v202, v148, v149
    v_cvt_pk_bf16_f32 v203, v150, v151
    v_mul_f32 v152, v152, v163
    v_mul_f32 v153, v153, v163
    v_mul_f32 v154, v154, v163
    v_mul_f32 v155, v155, v163
    v_cvt_pk_bf16_f32 v204, v152, v153
    v_cvt_pk_bf16_f32 v205, v154, v155
    v_mul_f32 v156, v156, v164
    v_mul_f32 v157, v157, v164
    v_mul_f32 v158, v158, v164
    v_mul_f32 v159, v159, v164
    v_cvt_pk_bf16_f32 v206, v156, v157
    v_cvt_pk_bf16_f32 v207, v158, v159
    v_add_u32 v14, s42, v13
    ds_write_b128 v14, v[168:171] offset:0
    ds_write_b128 v14, v[172:175] offset:1024
    ds_write_b128 v14, v[176:179] offset:2048
    ds_write_b128 v14, v[180:183] offset:3072
    ds_write_b128 v14, v[184:187] offset:4096
    ds_write_b128 v14, v[188:191] offset:20480
    ds_write_b128 v14, v[192:195] offset:21504
    ds_write_b128 v14, v[196:199] offset:22528
    ds_write_b128 v14, v[200:203] offset:23552
    ds_write_b128 v14, v[204:207] offset:24576
    s_add_u32 s41, s43, s77
    s_add_u32 s24, s40, 1
    s_cmp_lt_u32 s24, s76
    s_cselect_b32 s41, s41, 2146435072
    s_waitcnt vmcnt(0)
    s_add_u32 s25, s41, 20480
    buffer_load_dwordx4 v[56:59], v8, s[8:11], s41 offen offset:0 sc1
    buffer_load_dwordx4 v[60:63], v8, s[8:11], s41 offen offset:1024 sc1
    buffer_load_dwordx2 v[64:65], v9, s[8:11], s41 offen offset:0 sc1
    buffer_load_dwordx4 v[66:69], v8, s[8:11], s41 offen offset:2560 sc1
    buffer_load_dwordx4 v[70:73], v8, s[8:11], s41 offen offset:3584 sc1
    buffer_load_dwordx2 v[74:75], v9, s[8:11], s41 offen offset:2560 sc1
    buffer_load_dwordx4 v[76:79], v8, s[8:11], s25 offen offset:0 sc1
    buffer_load_dwordx4 v[80:83], v8, s[8:11], s25 offen offset:1024 sc1
    buffer_load_dwordx2 v[84:85], v9, s[8:11], s25 offen offset:0 sc1
    buffer_load_dwordx4 v[86:89], v8, s[8:11], s25 offen offset:2560 sc1
    buffer_load_dwordx4 v[90:93], v8, s[8:11], s25 offen offset:3584 sc1
    buffer_load_dwordx2 v[94:95], v9, s[8:11], s25 offen offset:2560 sc1
    buffer_load_dwordx2 v[104:105], v10, s[16:19], s41 offen sc1
    buffer_load_dwordx2 v[106:107], v11, s[16:19], s41 offen sc1
    buffer_load_dwordx2 v[108:109], v10, s[16:19], s25 offen sc1
    buffer_load_dwordx2 v[110:111], v11, s[16:19], s25 offen sc1
    s_waitcnt lgkmcnt(0)
    s_barrier
    s_lshl_b32 s24, s92, 10
    s_lshl_b32 s25, s78, 2
    s_add_u32 s24, s24, s25
    s_add_u32 s24, s24, 23105536
    s_cmp_eq_u32 s3, 0
    s_cbranch_scc0 interleave_layers__linear_attn_block__memory_aug_recurrent_mem_tr__prompt_kernel_pb15
    v_lshlrev_b32 v14, 7, v1
    v_add_u32 v14, s24, v14
    v_mov_b32 v15, 2146435072
    v_cmp_le_u32 vcc, 8, v1
    s_nop 1
    v_cndmask_b32 v14, v14, v15, vcc
    v_mov_b32 v15, s40
    buffer_store_dword v15, v14, s[8:11], 0 offen sc1
interleave_layers__linear_attn_block__memory_aug_recurrent_mem_tr__prompt_kernel_pb15:
    s_branch interleave_layers__linear_attn_block__memory_aug_recurrent_mem_tr__prompt_kernel_k3_seg
interleave_layers__linear_attn_block__memory_aug_recurrent_mem_tr__prompt_kernel_k3_done:
    s_waitcnt vmcnt(0)
    s_barrier
    s_lshl_b32 s24, s92, 10
    s_lshl_b32 s25, s78, 2
    s_add_u32 s24, s24, s25
    s_add_u32 s24, s24, 23105536
    s_cmp_eq_u32 s3, 0
    s_cbranch_scc0 interleave_layers__linear_attn_block__memory_aug_recurrent_mem_tr__prompt_kernel_pb16
    v_lshlrev_b32 v14, 7, v1
    v_add_u32 v14, s24, v14
    v_mov_b32 v15, 2146435072
    v_cmp_le_u32 vcc, 8, v1
    s_nop 1
    v_cndmask_b32 v14, v14, v15, vcc
    v_mov_b32 v15, s40
    buffer_store_dword v15, v14, s[8:11], 0 offen sc1
interleave_layers__linear_attn_block__memory_aug_recurrent_mem_tr__prompt_kernel_pb16:
    s_cmp_eq_u32 s92, 0
    s_cbranch_scc0 interleave_layers__linear_attn_block__memory_aug_recurrent_mem_tr__prompt_kernel_end
    s_mov_b32 s92, 1
    s_cmp_lt_u32 s2, 248
    s_cbranch_scc1 interleave_layers__linear_attn_block__memory_aug_recurrent_mem_tr__prompt_kernel_helper_k1
interleave_layers__linear_attn_block__memory_aug_recurrent_mem_tr__prompt_kernel_k3_l1:
    s_add_u32 s16, s4, 4194304
    s_addc_u32 s17, s5, 0
    s_mov_b32 s18, 2621440
    s_mov_b32 s19, 0x00020000
    s_mov_b32 s46, 1024
    s_mov_b32 s47, 8
    s_mov_b32 s50, 1
    s_mov_b32 s58, 8388608
    s_mov_b32 s76, 16
    s_mov_b32 s77, 163840
    s_branch interleave_layers__linear_attn_block__memory_aug_recurrent_mem_tr__prompt_kernel_k3_entry
interleave_layers__linear_attn_block__memory_aug_recurrent_mem_tr__prompt_kernel_helper_k1:
    s_mov_b32 s92, 1
    s_sub_u32 s24, s2, 232
    s_add_u32 s16, s4, 4194304
    s_addc_u32 s17, s5, 0
    s_mov_b32 s18, 2621440
    s_mov_b32 s19, 0x00020000
    s_mov_b32 s46, 1024
    s_mov_b32 s47, 8
    s_mov_b32 s50, 1
    s_and_b32 s44, s24, 7
    s_lshr_b32 s45, s24, 3
    s_mov_b32 s48, s45
    s_mov_b32 s49, 2
    s_mov_b32 s40, 32
    s_branch interleave_layers__linear_attn_block__memory_aug_recurrent_mem_tr__prompt_kernel_k1_entry
interleave_layers__linear_attn_block__memory_aug_recurrent_mem_tr__prompt_kernel_helper_clr:
    s_sub_u32 s44, s2, 253
    s_lshl_b32 s24, s44, 2
    s_add_u32 s24, s24, s3
    s_mul_i32 s45, s24, 5
    s_add_u32 s24, s45, 0
    s_min_u32 s24, s24, 56
    s_sub_u32 s25, s24, 47
    s_cmp_ge_u32 s24, 47
    s_cselect_b32 s24, s25, s24
    s_cselect_b32 s69, 0x2000, 0
    s_lshl_b32 s64, s24, 14
    s_add_u32 s24, s45, 1
    s_min_u32 s24, s24, 56
    s_sub_u32 s25, s24, 47
    s_cmp_ge_u32 s24, 47
    s_cselect_b32 s24, s25, s24
    s_cselect_b32 s70, 0x2000, 0
    s_lshl_b32 s65, s24, 14
    s_add_u32 s24, s45, 2
    s_min_u32 s24, s24, 56
    s_sub_u32 s25, s24, 47
    s_cmp_ge_u32 s24, 47
    s_cselect_b32 s24, s25, s24
    s_cselect_b32 s71, 0x2000, 0
    s_lshl_b32 s66, s24, 14
    s_add_u32 s24, s45, 3
    s_min_u32 s24, s24, 56
    s_sub_u32 s25, s24, 47
    s_cmp_ge_u32 s24, 47
    s_cselect_b32 s24, s25, s24
    s_cselect_b32 s72, 0x2000, 0
    s_lshl_b32 s67, s24, 14
    s_add_u32 s24, s45, 4
    s_min_u32 s24, s24, 56
    s_sub_u32 s25, s24, 47
    s_cmp_ge_u32 s24, 47
    s_cselect_b32 s24, s25, s24
    s_cselect_b32 s73, 0x2000, 0
    s_lshl_b32 s68, s24, 14
    v_lshlrev_b32 v5, 4, v1
    v_mov_b32 v8, -1
    v_mov_b32 v9, -1
    v_mov_b32 v10, -1
    v_mov_b32 v11, -1
    s_lshl_b32 s24, s44, 2
    s_add_u32 s42, s24, 23109632
    s_mov_b32 s40, 0
interleave_layers__linear_attn_block__memory_aug_recurrent_mem_tr__prompt_kernel_clr_blk:
    s_lshl_b32 s24, s40, 12
    s_and_b32 s24, s24, 0x2000
    s_xor_b32 s24, s24, s36
    s_lshl_b32 s41, s40, 20
    s_add_u32 s41, s41, s24
    s_add_u32 s41, s41, 117440512
    s_add_u32 s43, s41, s64
    s_xor_b32 s43, s43, s69
    s_add_u32 s46, s43, 4096
    buffer_store_dwordx4 v[8:11], v5, s[8:11], s43 offen offset:0 sc1
    buffer_store_dwordx4 v[8:11], v5, s[8:11], s43 offen offset:1024 sc1
    buffer_store_dwordx4 v[8:11], v5, s[8:11], s43 offen offset:2048 sc1
    buffer_store_dwordx4 v[8:11], v5, s[8:11], s43 offen offset:3072 sc1
    buffer_store_dwordx4 v[8:11], v5, s[8:11], s46 offen offset:0 sc1
    buffer_store_dwordx4 v[8:11], v5, s[8:11], s46 offen offset:1024 sc1
    buffer_store_dwordx4 v[8:11], v5, s[8:11], s46 offen offset:2048 sc1
    buffer_store_dwordx4 v[8:11], v5, s[8:11], s46 offen offset:3072 sc1
    s_add_u32 s43, s41, s65
    s_xor_b32 s43, s43, s70
    s_add_u32 s46, s43, 4096
    buffer_store_dwordx4 v[8:11], v5, s[8:11], s43 offen offset:0 sc1
    buffer_store_dwordx4 v[8:11], v5, s[8:11], s43 offen offset:1024 sc1
    buffer_store_dwordx4 v[8:11], v5, s[8:11], s43 offen offset:2048 sc1
    buffer_store_dwordx4 v[8:11], v5, s[8:11], s43 offen offset:3072 sc1
    buffer_store_dwordx4 v[8:11], v5, s[8:11], s46 offen offset:0 sc1
    buffer_store_dwordx4 v[8:11], v5, s[8:11], s46 offen offset:1024 sc1
    buffer_store_dwordx4 v[8:11], v5, s[8:11], s46 offen offset:2048 sc1
    buffer_store_dwordx4 v[8:11], v5, s[8:11], s46 offen offset:3072 sc1
    s_add_u32 s43, s41, s66
    s_xor_b32 s43, s43, s71
    s_add_u32 s46, s43, 4096
    buffer_store_dwordx4 v[8:11], v5, s[8:11], s43 offen offset:0 sc1
    buffer_store_dwordx4 v[8:11], v5, s[8:11], s43 offen offset:1024 sc1
    buffer_store_dwordx4 v[8:11], v5, s[8:11], s43 offen offset:2048 sc1
    buffer_store_dwordx4 v[8:11], v5, s[8:11], s43 offen offset:3072 sc1
    buffer_store_dwordx4 v[8:11], v5, s[8:11], s46 offen offset:0 sc1
    buffer_store_dwordx4 v[8:11], v5, s[8:11], s46 offen offset:1024 sc1
    buffer_store_dwordx4 v[8:11], v5, s[8:11], s46 offen offset:2048 sc1
    buffer_store_dwordx4 v[8:11], v5, s[8:11], s46 offen offset:3072 sc1
    s_add_u32 s43, s41, s67
    s_xor_b32 s43, s43, s72
    s_add_u32 s46, s43, 4096
    buffer_store_dwordx4 v[8:11], v5, s[8:11], s43 offen offset:0 sc1
    buffer_store_dwordx4 v[8:11], v5, s[8:11], s43 offen offset:1024 sc1
    buffer_store_dwordx4 v[8:11], v5, s[8:11], s43 offen offset:2048 sc1
    buffer_store_dwordx4 v[8:11], v5, s[8:11], s43 offen offset:3072 sc1
    buffer_store_dwordx4 v[8:11], v5, s[8:11], s46 offen offset:0 sc1
    buffer_store_dwordx4 v[8:11], v5, s[8:11], s46 offen offset:1024 sc1
    buffer_store_dwordx4 v[8:11], v5, s[8:11], s46 offen offset:2048 sc1
    buffer_store_dwordx4 v[8:11], v5, s[8:11], s46 offen offset:3072 sc1
    s_add_u32 s43, s41, s68
    s_xor_b32 s43, s43, s73
    s_add_u32 s46, s43, 4096
    buffer_store_dwordx4 v[8:11], v5, s[8:11], s43 offen offset:0 sc1
    buffer_store_dwordx4 v[8:11], v5, s[8:11], s43 offen offset:1024 sc1
    buffer_store_dwordx4 v[8:11], v5, s[8:11], s43 offen offset:2048 sc1
    buffer_store_dwordx4 v[8:11], v5, s[8:11], s43 offen offset:3072 sc1
    buffer_store_dwordx4 v[8:11], v5, s[8:11], s46 offen offset:0 sc1
    buffer_store_dwordx4 v[8:11], v5, s[8:11], s46 offen offset:1024 sc1
    buffer_store_dwordx4 v[8:11], v5, s[8:11], s46 offen offset:2048 sc1
    buffer_store_dwordx4 v[8:11], v5, s[8:11], s46 offen offset:3072 sc1
    s_waitcnt vmcnt(40)
    s_barrier
    s_cmp_eq_u32 s3, 0
    s_cbranch_scc0 interleave_layers__linear_attn_block__memory_aug_recurrent_mem_tr__prompt_kernel_pb17
    v_lshlrev_b32 v14, 7, v1
    v_add_u32 v14, s42, v14
    v_mov_b32 v15, 2146435072
    v_cmp_le_u32 vcc, 8, v1
    s_nop 1
    v_cndmask_b32 v14, v14, v15, vcc
    v_mov_b32 v15, s40
    buffer_store_dword v15, v14, s[8:11], 0 offen sc1
interleave_layers__linear_attn_block__memory_aug_recurrent_mem_tr__prompt_kernel_pb17:
    s_add_u32 s40, s40, 1
    s_cmp_lt_u32 s40, 64
    s_cbranch_scc1 interleave_layers__linear_attn_block__memory_aug_recurrent_mem_tr__prompt_kernel_clr_blk
    s_waitcnt vmcnt(0)
    s_barrier
    s_cmp_eq_u32 s3, 0
    s_cbranch_scc0 interleave_layers__linear_attn_block__memory_aug_recurrent_mem_tr__prompt_kernel_pb18
    v_lshlrev_b32 v14, 7, v1
    v_add_u32 v14, s42, v14
    v_mov_b32 v15, 2146435072
    v_cmp_le_u32 vcc, 8, v1
    s_nop 1
    v_cndmask_b32 v14, v14, v15, vcc
    v_mov_b32 v15, s40
    buffer_store_dword v15, v14, s[8:11], 0 offen sc1
interleave_layers__linear_attn_block__memory_aug_recurrent_mem_tr__prompt_kernel_pb18:
interleave_layers__linear_attn_block__memory_aug_recurrent_mem_tr__prompt_kernel_clr_blk2:
    s_sub_u32 s47, s40, 64
    s_cmp_ge_u32 s47, 60
    s_cbranch_scc1 interleave_layers__linear_attn_block__memory_aug_recurrent_mem_tr__prompt_kernel_clr_last
    s_and_b32 s24, s47, 3
    s_lshl_b32 s24, s24, 7
    s_add_u32 s24, s24, 23107584
    v_lshlrev_b32 v15, 2, v1
    v_add_u32 v15, s24, v15
    s_lshr_b32 s95, s47, 2
    s_add_u32 s95, s95, 2
    s_mov_b32 s61, 0
interleave_layers__linear_attn_block__memory_aug_recurrent_mem_tr__prompt_kernel_clr_wx:
    buffer_load_dword v14, v15, s[8:11], 0 offen sc1
    s_waitcnt vmcnt(0)
    v_cmp_le_i32 vcc, s95, v14
    s_mov_b32 s25, 0xfffff
    s_and_b32 s24, vcc_lo, s25
    s_cmp_eq_u32 s24, s25
    s_cbranch_scc1 interleave_layers__linear_attn_block__memory_aug_recurrent_mem_tr__prompt_kernel_clr_wx_ok
    s_add_u32 s61, s61, 1
    s_cmp_ge_u32 s61, s60
    s_cbranch_scc1 interleave_layers__linear_attn_block__memory_aug_recurrent_mem_tr__prompt_kernel_clr_wx_to
    s_sleep 32
    s_branch interleave_layers__linear_attn_block__memory_aug_recurrent_mem_tr__prompt_kernel_clr_wx
interleave_layers__linear_attn_block__memory_aug_recurrent_mem_tr__prompt_kernel_clr_wx_to:
    s_mov_b32 s60, 1
interleave_layers__linear_attn_block__memory_aug_recurrent_mem_tr__prompt_kernel_clr_wx_ok:
    s_branch interleave_layers__linear_attn_block__memory_aug_recurrent_mem_tr__prompt_kernel_clr_go
interleave_layers__linear_attn_block__memory_aug_recurrent_mem_tr__prompt_kernel_clr_last:
    v_mov_b32 v15, 23111680
    s_mov_b32 s95, 66
    s_mov_b32 s61, 0
interleave_layers__linear_attn_block__memory_aug_recurrent_mem_tr__prompt_kernel_clr_ws:
    buffer_load_dword v14, v15, s[8:11], 0 offen sc1
    s_waitcnt vmcnt(0)
    v_cmp_le_i32 vcc, s95, v14
    s_mov_b32 s25, 0x1
    s_and_b32 s24, vcc_lo, s25
    s_cmp_eq_u32 s24, s25
    s_cbranch_scc1 interleave_layers__linear_attn_block__memory_aug_recurrent_mem_tr__prompt_kernel_clr_ws_ok
    s_add_u32 s61, s61, 1
    s_cmp_ge_u32 s61, s60
    s_cbranch_scc1 interleave_layers__linear_attn_block__memory_aug_recurrent_mem_tr__prompt_kernel_clr_ws_to
    s_sleep 32
    s_branch interleave_layers__linear_attn_block__memory_aug_recurrent_mem_tr__prompt_kernel_clr_ws
interleave_layers__linear_attn_block__memory_aug_recurrent_mem_tr__prompt_kernel_clr_ws_to:
    s_mov_b32 s60, 1
interleave_layers__linear_attn_block__memory_aug_recurrent_mem_tr__prompt_kernel_clr_ws_ok:
interleave_layers__linear_attn_block__memory_aug_recurrent_mem_tr__prompt_kernel_clr_go:
    s_lshl_b32 s24, s47, 12
    s_and_b32 s24, s24, 0x2000
    s_xor_b32 s24, s24, s36
    s_lshl_b32 s41, s47, 20
    s_add_u32 s41, s41, s24
    s_add_u32 s41, s41, 117440512
    s_add_u32 s43, s41, s64
    s_xor_b32 s43, s43, s69
    s_add_u32 s46, s43, 4096
    buffer_store_dwordx4 v[8:11], v5, s[8:11], s43 offen offset:0 sc1
    buffer_store_dwordx4 v[8:11], v5, s[8:11], s43 offen offset:1024 sc1
    buffer_store_dwordx4 v[8:11], v5, s[8:11], s43 offen offset:2048 sc1
    buffer_store_dwordx4 v[8:11], v5, s[8:11], s43 offen offset:3072 sc1
    buffer_store_dwordx4 v[8:11], v5, s[8:11], s46 offen offset:0 sc1
    buffer_store_dwordx4 v[8:11], v5, s[8:11], s46 offen offset:1024 sc1
    buffer_store_dwordx4 v[8:11], v5, s[8:11], s46 offen offset:2048 sc1
    buffer_store_dwordx4 v[8:11], v5, s[8:11], s46 offen offset:3072 sc1
    s_add_u32 s43, s41, s65
    s_xor_b32 s43, s43, s70
    s_add_u32 s46, s43, 4096
    buffer_store_dwordx4 v[8:11], v5, s[8:11], s43 offen offset:0 sc1
    buffer_store_dwordx4 v[8:11], v5, s[8:11], s43 offen offset:1024 sc1
    buffer_store_dwordx4 v[8:11], v5, s[8:11], s43 offen offset:2048 sc1
    buffer_store_dwordx4 v[8:11], v5, s[8:11], s43 offen offset:3072 sc1
    buffer_store_dwordx4 v[8:11], v5, s[8:11], s46 offen offset:0 sc1
    buffer_store_dwordx4 v[8:11], v5, s[8:11], s46 offen offset:1024 sc1
    buffer_store_dwordx4 v[8:11], v5, s[8:11], s46 offen offset:2048 sc1
    buffer_store_dwordx4 v[8:11], v5, s[8:11], s46 offen offset:3072 sc1
    s_add_u32 s43, s41, s66
    s_xor_b32 s43, s43, s71
    s_add_u32 s46, s43, 4096
    buffer_store_dwordx4 v[8:11], v5, s[8:11], s43 offen offset:0 sc1
    buffer_store_dwordx4 v[8:11], v5, s[8:11], s43 offen offset:1024 sc1
    buffer_store_dwordx4 v[8:11], v5, s[8:11], s43 offen offset:2048 sc1
    buffer_store_dwordx4 v[8:11], v5, s[8:11], s43 offen offset:3072 sc1
    buffer_store_dwordx4 v[8:11], v5, s[8:11], s46 offen offset:0 sc1
    buffer_store_dwordx4 v[8:11], v5, s[8:11], s46 offen offset:1024 sc1
    buffer_store_dwordx4 v[8:11], v5, s[8:11], s46 offen offset:2048 sc1
    buffer_store_dwordx4 v[8:11], v5, s[8:11], s46 offen offset:3072 sc1
    s_add_u32 s43, s41, s67
    s_xor_b32 s43, s43, s72
    s_add_u32 s46, s43, 4096
    buffer_store_dwordx4 v[8:11], v5, s[8:11], s43 offen offset:0 sc1
    buffer_store_dwordx4 v[8:11], v5, s[8:11], s43 offen offset:1024 sc1
    buffer_store_dwordx4 v[8:11], v5, s[8:11], s43 offen offset:2048 sc1
    buffer_store_dwordx4 v[8:11], v5, s[8:11], s43 offen offset:3072 sc1
    buffer_store_dwordx4 v[8:11], v5, s[8:11], s46 offen offset:0 sc1
    buffer_store_dwordx4 v[8:11], v5, s[8:11], s46 offen offset:1024 sc1
    buffer_store_dwordx4 v[8:11], v5, s[8:11], s46 offen offset:2048 sc1
    buffer_store_dwordx4 v[8:11], v5, s[8:11], s46 offen offset:3072 sc1
    s_add_u32 s43, s41, s68
    s_xor_b32 s43, s43, s73
    s_add_u32 s46, s43, 4096
    buffer_store_dwordx4 v[8:11], v5, s[8:11], s43 offen offset:0 sc1
    buffer_store_dwordx4 v[8:11], v5, s[8:11], s43 offen offset:1024 sc1
    buffer_store_dwordx4 v[8:11], v5, s[8:11], s43 offen offset:2048 sc1
    buffer_store_dwordx4 v[8:11], v5, s[8:11], s43 offen offset:3072 sc1
    buffer_store_dwordx4 v[8:11], v5, s[8:11], s46 offen offset:0 sc1
    buffer_store_dwordx4 v[8:11], v5, s[8:11], s46 offen offset:1024 sc1
    buffer_store_dwordx4 v[8:11], v5, s[8:11], s46 offen offset:2048 sc1
    buffer_store_dwordx4 v[8:11], v5, s[8:11], s46 offen offset:3072 sc1
    s_waitcnt vmcnt(0)
    s_barrier
    s_add_u32 s40, s40, 1
    s_cmp_eq_u32 s3, 0
    s_cbranch_scc0 interleave_layers__linear_attn_block__memory_aug_recurrent_mem_tr__prompt_kernel_pb19
    v_lshlrev_b32 v14, 7, v1
    v_add_u32 v14, s42, v14
    v_mov_b32 v15, 2146435072
    v_cmp_le_u32 vcc, 8, v1
    s_nop 1
    v_cndmask_b32 v14, v14, v15, vcc
    v_mov_b32 v15, s40
    buffer_store_dword v15, v14, s[8:11], 0 offen sc1
interleave_layers__linear_attn_block__memory_aug_recurrent_mem_tr__prompt_kernel_pb19:
    s_cmp_lt_u32 s40, 128
    s_cbranch_scc1 interleave_layers__linear_attn_block__memory_aug_recurrent_mem_tr__prompt_kernel_clr_blk2
    s_waitcnt vmcnt(0)
    s_branch interleave_layers__linear_attn_block__memory_aug_recurrent_mem_tr__prompt_kernel_end
interleave_layers__linear_attn_block__memory_aug_recurrent_mem_tr__prompt_kernel_roleS:
    s_mov_b32 s44, s2
    s_load_dwordx2 s[6:7], s[0:1], 40
    s_load_dwordx2 s[24:25], s[0:1], 48
    s_load_dwordx2 s[26:27], s[0:1], 32
    s_waitcnt lgkmcnt(0)
    s_mov_b32 s12, s6
    s_mov_b32 s13, s7
    s_mov_b32 s14, 7864320
    s_mov_b32 s15, 0x00020000
    s_mov_b32 s16, s24
    s_mov_b32 s17, s25
    s_mov_b32 s18, 7864320
    s_mov_b32 s19, 0x00020000
    s_mov_b32 s20, s26
    s_mov_b32 s21, s27
    s_mov_b32 s22, 10240
    s_mov_b32 s23, 0x00020000
    v_add_u32 v16, 0, v0
    s_mov_b32 s24, 683
    v_mul_lo_u32 v17, v16, s24
    v_lshrrev_b32 v17, 14, v17
    v_mul_u32_u24 v18, 24, v17
    v_sub_u32 v18, v16, v18
    s_mov_b32 s24, 12288
    v_mul_lo_u32 v4, v17, s24
    v_lshl_add_u32 v4, v18, 4, v4
    v_mul_u32_u24 v10, 400, v17
    v_lshl_add_u32 v10, v18, 4, v10
    v_add_u32 v10, 106496, v10
    v_add_u32 v16, 256, v0
    s_mov_b32 s24, 683
    v_mul_lo_u32 v17, v16, s24
    v_lshrrev_b32 v17, 14, v17
    v_mul_u32_u24 v18, 24, v17
    v_sub_u32 v18, v16, v18
    s_mov_b32 s24, 12288
    v_mul_lo_u32 v5, v17, s24
    v_lshl_add_u32 v5, v18, 4, v5
    v_mul_u32_u24 v11, 400, v17
    v_lshl_add_u32 v11, v18, 4, v11
    v_add_u32 v11, 106496, v11
    v_add_u32 v16, 512, v0
    s_mov_b32 s24, 683
    v_mul_lo_u32 v17, v16, s24
    v_lshrrev_b32 v17, 14, v17
    v_mul_u32_u24 v18, 24, v17
    v_sub_u32 v18, v16, v18
    s_mov_b32 s24, 12288
    v_mul_lo_u32 v6, v17, s24
    v_lshl_add_u32 v6, v18, 4, v6
    v_mul_u32_u24 v12, 400, v17
    v_lshl_add_u32 v12, v18, 4, v12
    v_add_u32 v12, 106496, v12
    v_add_u32 v16, 768, v0
    s_mov_b32 s24, 683
    v_mul_lo_u32 v17, v16, s24
    v_lshrrev_b32 v17, 14, v17
    v_mul_u32_u24 v18, 24, v17
    v_sub_u32 v18, v16, v18
    s_mov_b32 s24, 12288
    v_mul_lo_u32 v7, v17, s24
    v_lshl_add_u32 v7, v18, 4, v7
    v_mul_u32_u24 v13, 400, v17
    v_lshl_add_u32 v13, v18, 4, v13
    v_add_u32 v13, 106496, v13
    v_add_u32 v16, 1024, v0
    s_mov_b32 s24, 683
    v_mul_lo_u32 v17, v16, s24
    v_lshrrev_b32 v17, 14, v17
    v_mul_u32_u24 v18, 24, v17
    v_sub_u32 v18, v16, v18
    s_mov_b32 s24, 12288
    v_mul_lo_u32 v8, v17, s24
    v_lshl_add_u32 v8, v18, 4, v8
    v_mul_u32_u24 v14, 400, v17
    v_lshl_add_u32 v14, v18, 4, v14
    v_add_u32 v14, 106496, v14
    v_add_u32 v16, 1280, v0
    s_mov_b32 s24, 683
    v_mul_lo_u32 v17, v16, s24
    v_lshrrev_b32 v17, 14, v17
    v_mul_u32_u24 v18, 24, v17
    v_sub_u32 v18, v16, v18
    s_mov_b32 s24, 12288
    v_mul_lo_u32 v9, v17, s24
    v_lshl_add_u32 v9, v18, 4, v9
    v_mul_u32_u24 v15, 400, v17
    v_lshl_add_u32 v15, v18, 4, v15
    v_add_u32 v15, 106496, v15
    v_lshrrev_b32 v17, 1, v3
    v_lshlrev_b32 v17, 4, v17
    v_and_b32 v18, 1, v3
    v_lshl_add_u32 v17, v18, 2, v17
    v_lshrrev_b32 v18, 2, v2
    v_and_b32 v19, 1, v18
    v_add_u32 v17, v17, v19
    v_lshrrev_b32 v18, 1, v18
    v_lshl_add_u32 v17, v18, 3, v17
    v_mul_u32_u24 v16, 400, v17
    v_and_b32 v18, 3, v2
    v_lshl_add_u32 v16, v18, 3, v16
    v_add_u32 v16, 106496, v16
    s_mul_i32 s24, s3, 96
    v_add_u32 v16, s24, v16
    v_lshlrev_b32 v17, 4, v1
    s_mul_i32 s24, s3, 20480
    s_add_u32 s24, s24, 24576
    v_add_u32 v17, s24, v17
    s_mul_i32 s45, s44, 384
    s_add_u32 s46, s45, 0
    buffer_load_dwordx4 v[24:27], v4, s[12:15], s46 offen
    buffer_load_dwordx4 v[28:31], v5, s[12:15], s46 offen
    buffer_load_dwordx4 v[32:35], v6, s[12:15], s46 offen
    buffer_load_dwordx4 v[36:39], v7, s[12:15], s46 offen
    buffer_load_dwordx4 v[40:43], v8, s[12:15], s46 offen
    buffer_load_dwordx4 v[44:47], v9, s[12:15], s46 offen
    s_add_u32 s46, s45, 0
    buffer_load_dwordx4 v[48:51], v4, s[16:19], s46 offen
    buffer_load_dwordx4 v[52:55], v5, s[16:19], s46 offen
    buffer_load_dwordx4 v[56:59], v6, s[16:19], s46 offen
    buffer_load_dwordx4 v[60:63], v7, s[16:19], s46 offen
    buffer_load_dwordx4 v[64:67], v8, s[16:19], s46 offen
    buffer_load_dwordx4 v[68:71], v9, s[16:19], s46 offen
    s_waitcnt vmcnt(6)
    ds_write_b128 v10, v[24:27]
    ds_write_b128 v11, v[28:31]
    ds_write_b128 v12, v[32:35]
    ds_write_b128 v13, v[36:39]
    ds_write_b128 v14, v[40:43]
    ds_write_b128 v15, v[44:47]
    s_add_u32 s46, s45, 786432
    buffer_load_dwordx4 v[72:75], v4, s[12:15], s46 offen
    buffer_load_dwordx4 v[76:79], v5, s[12:15], s46 offen
    buffer_load_dwordx4 v[80:83], v6, s[12:15], s46 offen
    buffer_load_dwordx4 v[84:87], v7, s[12:15], s46 offen
    buffer_load_dwordx4 v[88:91], v8, s[12:15], s46 offen
    buffer_load_dwordx4 v[92:95], v9, s[12:15], s46 offen
    s_waitcnt lgkmcnt(0)
    s_barrier
    ds_read_b64_tr_b16 a[0:1], v16 offset:0
    ds_read_b64_tr_b16 a[2:3], v16 offset:800
    ds_read_b64_tr_b16 a[4:5], v16 offset:12800
    ds_read_b64_tr_b16 a[6:7], v16 offset:13600
    ds_read_b64_tr_b16 a[80:81], v16 offset:32
    ds_read_b64_tr_b16 a[82:83], v16 offset:832
    ds_read_b64_tr_b16 a[84:85], v16 offset:12832
    ds_read_b64_tr_b16 a[86:87], v16 offset:13632
    ds_read_b64_tr_b16 a[160:161], v16 offset:64
    ds_read_b64_tr_b16 a[162:163], v16 offset:864
    ds_read_b64_tr_b16 a[164:165], v16 offset:12864
    ds_read_b64_tr_b16 a[166:167], v16 offset:13664
    s_waitcnt lgkmcnt(0)
    s_barrier
    s_waitcnt vmcnt(6)
    ds_write_b128 v10, v[48:51]
    ds_write_b128 v11, v[52:55]
    ds_write_b128 v12, v[56:59]
    ds_write_b128 v13, v[60:63]
    ds_write_b128 v14, v[64:67]
    ds_write_b128 v15, v[68:71]
    s_add_u32 s46, s45, 786432
    buffer_load_dwordx4 v[24:27], v4, s[16:19], s46 offen
    buffer_load_dwordx4 v[28:31], v5, s[16:19], s46 offen
    buffer_load_dwordx4 v[32:35], v6, s[16:19], s46 offen
    buffer_load_dwordx4 v[36:39], v7, s[16:19], s46 offen
    buffer_load_dwordx4 v[40:43], v8, s[16:19], s46 offen
    buffer_load_dwordx4 v[44:47], v9, s[16:19], s46 offen
    s_waitcnt lgkmcnt(0)
    s_barrier
    ds_read_b64_tr_b16 v[96:97], v16 offset:32
    ds_read_b64_tr_b16 v[98:99], v16 offset:832
    ds_read_b64_tr_b16 v[100:101], v16 offset:12832
    ds_read_b64_tr_b16 v[102:103], v16 offset:13632
    ds_read_b64_tr_b16 v[176:177], v16 offset:64
    ds_read_b64_tr_b16 v[178:179], v16 offset:864
    ds_read_b64_tr_b16 v[180:181], v16 offset:12864
    ds_read_b64_tr_b16 v[182:183], v16 offset:13664
    ds_read_b64_tr_b16 v[48:49], v16 offset:0
    ds_read_b64_tr_b16 v[50:51], v16 offset:800
    ds_read_b64_tr_b16 v[52:53], v16 offset:12800
    ds_read_b64_tr_b16 v[54:55], v16 offset:13600
    s_waitcnt lgkmcnt(0)
    ds_write_b128 v17, v[48:51] offset:0
    ds_write_b128 v17, v[52:55] offset:1024
    s_waitcnt lgkmcnt(0)
    s_barrier
    s_waitcnt vmcnt(6)
    ds_write_b128 v10, v[72:75]
    ds_write_b128 v11, v[76:79]
    ds_write_b128 v12, v[80:83]
    ds_write_b128 v13, v[84:87]
    ds_write_b128 v14, v[88:91]
    ds_write_b128 v15, v[92:95]
    s_add_u32 s46, s45, 1572864
    buffer_load_dwordx4 v[48:51], v4, s[12:15], s46 offen
    buffer_load_dwordx4 v[52:55], v5, s[12:15], s46 offen
    buffer_load_dwordx4 v[56:59], v6, s[12:15], s46 offen
    buffer_load_dwordx4 v[60:63], v7, s[12:15], s46 offen
    buffer_load_dwordx4 v[64:67], v8, s[12:15], s46 offen
    buffer_load_dwordx4 v[68:71], v9, s[12:15], s46 offen
    s_waitcnt lgkmcnt(0)
    s_barrier
    ds_read_b64_tr_b16 a[8:9], v16 offset:0
    ds_read_b64_tr_b16 a[10:11], v16 offset:800
    ds_read_b64_tr_b16 a[12:13], v16 offset:12800
    ds_read_b64_tr_b16 a[14:15], v16 offset:13600
    ds_read_b64_tr_b16 a[88:89], v16 offset:32
    ds_read_b64_tr_b16 a[90:91], v16 offset:832
    ds_read_b64_tr_b16 a[92:93], v16 offset:12832
    ds_read_b64_tr_b16 a[94:95], v16 offset:13632
    ds_read_b64_tr_b16 a[168:169], v16 offset:64
    ds_read_b64_tr_b16 a[170:171], v16 offset:864
    ds_read_b64_tr_b16 a[172:173], v16 offset:12864
    ds_read_b64_tr_b16 a[174:175], v16 offset:13664
    s_waitcnt lgkmcnt(0)
    s_barrier
    s_waitcnt vmcnt(6)
    ds_write_b128 v10, v[24:27]
    ds_write_b128 v11, v[28:31]
    ds_write_b128 v12, v[32:35]
    ds_write_b128 v13, v[36:39]
    ds_write_b128 v14, v[40:43]
    ds_write_b128 v15, v[44:47]
    s_add_u32 s46, s45, 1572864
    buffer_load_dwordx4 v[72:75], v4, s[16:19], s46 offen
    buffer_load_dwordx4 v[76:79], v5, s[16:19], s46 offen
    buffer_load_dwordx4 v[80:83], v6, s[16:19], s46 offen
    buffer_load_dwordx4 v[84:87], v7, s[16:19], s46 offen
    buffer_load_dwordx4 v[88:91], v8, s[16:19], s46 offen
    buffer_load_dwordx4 v[92:95], v9, s[16:19], s46 offen
    s_waitcnt lgkmcnt(0)
    s_barrier
    ds_read_b64_tr_b16 v[104:105], v16 offset:32
    ds_read_b64_tr_b16 v[106:107], v16 offset:832
    ds_read_b64_tr_b16 v[108:109], v16 offset:12832
    ds_read_b64_tr_b16 v[110:111], v16 offset:13632
    ds_read_b64_tr_b16 v[184:185], v16 offset:64
    ds_read_b64_tr_b16 v[186:187], v16 offset:864
    ds_read_b64_tr_b16 v[188:189], v16 offset:12864
    ds_read_b64_tr_b16 v[190:191], v16 offset:13664
    ds_read_b64_tr_b16 v[24:25], v16 offset:0
    ds_read_b64_tr_b16 v[26:27], v16 offset:800
    ds_read_b64_tr_b16 v[28:29], v16 offset:12800
    ds_read_b64_tr_b16 v[30:31], v16 offset:13600
    s_waitcnt lgkmcnt(0)
    ds_write_b128 v17, v[24:27] offset:2048
    ds_write_b128 v17, v[28:31] offset:3072
    s_waitcnt lgkmcnt(0)
    s_barrier
    s_waitcnt vmcnt(6)
    ds_write_b128 v10, v[48:51]
    ds_write_b128 v11, v[52:55]
    ds_write_b128 v12, v[56:59]
    ds_write_b128 v13, v[60:63]
    ds_write_b128 v14, v[64:67]
    ds_write_b128 v15, v[68:71]
    s_add_u32 s46, s45, 2359296
    buffer_load_dwordx4 v[24:27], v4, s[12:15], s46 offen
    buffer_load_dwordx4 v[28:31], v5, s[12:15], s46 offen
    buffer_load_dwordx4 v[32:35], v6, s[12:15], s46 offen
    buffer_load_dwordx4 v[36:39], v7, s[12:15], s46 offen
    buffer_load_dwordx4 v[40:43], v8, s[12:15], s46 offen
    buffer_load_dwordx4 v[44:47], v9, s[12:15], s46 offen
    s_waitcnt lgkmcnt(0)
    s_barrier
    ds_read_b64_tr_b16 a[16:17], v16 offset:0
    ds_read_b64_tr_b16 a[18:19], v16 offset:800
    ds_read_b64_tr_b16 a[20:21], v16 offset:12800
    ds_read_b64_tr_b16 a[22:23], v16 offset:13600
    ds_read_b64_tr_b16 a[96:97], v16 offset:32
    ds_read_b64_tr_b16 a[98:99], v16 offset:832
    ds_read_b64_tr_b16 a[100:101], v16 offset:12832
    ds_read_b64_tr_b16 a[102:103], v16 offset:13632
    ds_read_b64_tr_b16 a[176:177], v16 offset:64
    ds_read_b64_tr_b16 a[178:179], v16 offset:864
    ds_read_b64_tr_b16 a[180:181], v16 offset:12864
    ds_read_b64_tr_b16 a[182:183], v16 offset:13664
    s_waitcnt lgkmcnt(0)
    s_barrier
    s_waitcnt vmcnt(6)
    ds_write_b128 v10, v[72:75]
    ds_write_b128 v11, v[76:79]
    ds_write_b128 v12, v[80:83]
    ds_write_b128 v13, v[84:87]
    ds_write_b128 v14, v[88:91]
    ds_write_b128 v15, v[92:95]
    s_add_u32 s46, s45, 2359296
    buffer_load_dwordx4 v[48:51], v4, s[16:19], s46 offen
    buffer_load_dwordx4 v[52:55], v5, s[16:19], s46 offen
    buffer_load_dwordx4 v[56:59], v6, s[16:19], s46 offen
    buffer_load_dwordx4 v[60:63], v7, s[16:19], s46 offen
    buffer_load_dwordx4 v[64:67], v8, s[16:19], s46 offen
    buffer_load_dwordx4 v[68:71], v9, s[16:19], s46 offen
    s_waitcnt lgkmcnt(0)
    s_barrier
    ds_read_b64_tr_b16 v[112:113], v16 offset:32
    ds_read_b64_tr_b16 v[114:115], v16 offset:832
    ds_read_b64_tr_b16 v[116:117], v16 offset:12832
    ds_read_b64_tr_b16 v[118:119], v16 offset:13632
    ds_read_b64_tr_b16 v[192:193], v16 offset:64
    ds_read_b64_tr_b16 v[194:195], v16 offset:864
    ds_read_b64_tr_b16 v[196:197], v16 offset:12864
    ds_read_b64_tr_b16 v[198:199], v16 offset:13664
    ds_read_b64_tr_b16 v[72:73], v16 offset:0
    ds_read_b64_tr_b16 v[74:75], v16 offset:800
    ds_read_b64_tr_b16 v[76:77], v16 offset:12800
    ds_read_b64_tr_b16 v[78:79], v16 offset:13600
    s_waitcnt lgkmcnt(0)
    ds_write_b128 v17, v[72:75] offset:4096
    ds_write_b128 v17, v[76:79] offset:5120
    s_waitcnt lgkmcnt(0)
    s_barrier
    s_waitcnt vmcnt(6)
    ds_write_b128 v10, v[24:27]
    ds_write_b128 v11, v[28:31]
    ds_write_b128 v12, v[32:35]
    ds_write_b128 v13, v[36:39]
    ds_write_b128 v14, v[40:43]
    ds_write_b128 v15, v[44:47]
    s_add_u32 s46, s45, 3145728
    buffer_load_dwordx4 v[72:75], v4, s[12:15], s46 offen
    buffer_load_dwordx4 v[76:79], v5, s[12:15], s46 offen
    buffer_load_dwordx4 v[80:83], v6, s[12:15], s46 offen
    buffer_load_dwordx4 v[84:87], v7, s[12:15], s46 offen
    buffer_load_dwordx4 v[88:91], v8, s[12:15], s46 offen
    buffer_load_dwordx4 v[92:95], v9, s[12:15], s46 offen
    s_waitcnt lgkmcnt(0)
    s_barrier
    ds_read_b64_tr_b16 a[24:25], v16 offset:0
    ds_read_b64_tr_b16 a[26:27], v16 offset:800
    ds_read_b64_tr_b16 a[28:29], v16 offset:12800
    ds_read_b64_tr_b16 a[30:31], v16 offset:13600
    ds_read_b64_tr_b16 a[104:105], v16 offset:32
    ds_read_b64_tr_b16 a[106:107], v16 offset:832
    ds_read_b64_tr_b16 a[108:109], v16 offset:12832
    ds_read_b64_tr_b16 a[110:111], v16 offset:13632
    ds_read_b64_tr_b16 a[184:185], v16 offset:64
    ds_read_b64_tr_b16 a[186:187], v16 offset:864
    ds_read_b64_tr_b16 a[188:189], v16 offset:12864
    ds_read_b64_tr_b16 a[190:191], v16 offset:13664
    s_waitcnt lgkmcnt(0)
    s_barrier
    s_waitcnt vmcnt(6)
    ds_write_b128 v10, v[48:51]
    ds_write_b128 v11, v[52:55]
    ds_write_b128 v12, v[56:59]
    ds_write_b128 v13, v[60:63]
    ds_write_b128 v14, v[64:67]
    ds_write_b128 v15, v[68:71]
    s_add_u32 s46, s45, 3145728
    buffer_load_dwordx4 v[24:27], v4, s[16:19], s46 offen
    buffer_load_dwordx4 v[28:31], v5, s[16:19], s46 offen
    buffer_load_dwordx4 v[32:35], v6, s[16:19], s46 offen
    buffer_load_dwordx4 v[36:39], v7, s[16:19], s46 offen
    buffer_load_dwordx4 v[40:43], v8, s[16:19], s46 offen
    buffer_load_dwordx4 v[44:47], v9, s[16:19], s46 offen
    s_waitcnt lgkmcnt(0)
    s_barrier
    ds_read_b64_tr_b16 v[120:121], v16 offset:32
    ds_read_b64_tr_b16 v[122:123], v16 offset:832
    ds_read_b64_tr_b16 v[124:125], v16 offset:12832
    ds_read_b64_tr_b16 v[126:127], v16 offset:13632
    ds_read_b64_tr_b16 v[200:201], v16 offset:64
    ds_read_b64_tr_b16 v[202:203], v16 offset:864
    ds_read_b64_tr_b16 v[204:205], v16 offset:12864
    ds_read_b64_tr_b16 v[206:207], v16 offset:13664
    ds_read_b64_tr_b16 v[48:49], v16 offset:0
    ds_read_b64_tr_b16 v[50:51], v16 offset:800
    ds_read_b64_tr_b16 v[52:53], v16 offset:12800
    ds_read_b64_tr_b16 v[54:55], v16 offset:13600
    s_waitcnt lgkmcnt(0)
    ds_write_b128 v17, v[48:51] offset:6144
    ds_write_b128 v17, v[52:55] offset:7168
    s_waitcnt lgkmcnt(0)
    s_barrier
    s_waitcnt vmcnt(6)
    ds_write_b128 v10, v[72:75]
    ds_write_b128 v11, v[76:79]
    ds_write_b128 v12, v[80:83]
    ds_write_b128 v13, v[84:87]
    ds_write_b128 v14, v[88:91]
    ds_write_b128 v15, v[92:95]
    s_add_u32 s46, s45, 3932160
    buffer_load_dwordx4 v[48:51], v4, s[12:15], s46 offen
    buffer_load_dwordx4 v[52:55], v5, s[12:15], s46 offen
    buffer_load_dwordx4 v[56:59], v6, s[12:15], s46 offen
    buffer_load_dwordx4 v[60:63], v7, s[12:15], s46 offen
    buffer_load_dwordx4 v[64:67], v8, s[12:15], s46 offen
    buffer_load_dwordx4 v[68:71], v9, s[12:15], s46 offen
    s_waitcnt lgkmcnt(0)
    s_barrier
    ds_read_b64_tr_b16 a[32:33], v16 offset:0
    ds_read_b64_tr_b16 a[34:35], v16 offset:800
    ds_read_b64_tr_b16 a[36:37], v16 offset:12800
    ds_read_b64_tr_b16 a[38:39], v16 offset:13600
    ds_read_b64_tr_b16 a[112:113], v16 offset:32
    ds_read_b64_tr_b16 a[114:115], v16 offset:832
    ds_read_b64_tr_b16 a[116:117], v16 offset:12832
    ds_read_b64_tr_b16 a[118:119], v16 offset:13632
    ds_read_b64_tr_b16 a[192:193], v16 offset:64
    ds_read_b64_tr_b16 a[194:195], v16 offset:864
    ds_read_b64_tr_b16 a[196:197], v16 offset:12864
    ds_read_b64_tr_b16 a[198:199], v16 offset:13664
    s_waitcnt lgkmcnt(0)
    s_barrier
    s_waitcnt vmcnt(6)
    ds_write_b128 v10, v[24:27]
    ds_write_b128 v11, v[28:31]
    ds_write_b128 v12, v[32:35]
    ds_write_b128 v13, v[36:39]
    ds_write_b128 v14, v[40:43]
    ds_write_b128 v15, v[44:47]
    s_add_u32 s46, s45, 3932160
    buffer_load_dwordx4 v[72:75], v4, s[16:19], s46 offen
    buffer_load_dwordx4 v[76:79], v5, s[16:19], s46 offen
    buffer_load_dwordx4 v[80:83], v6, s[16:19], s46 offen
    buffer_load_dwordx4 v[84:87], v7, s[16:19], s46 offen
    buffer_load_dwordx4 v[88:91], v8, s[16:19], s46 offen
    buffer_load_dwordx4 v[92:95], v9, s[16:19], s46 offen
    s_waitcnt lgkmcnt(0)
    s_barrier
    ds_read_b64_tr_b16 v[128:129], v16 offset:32
    ds_read_b64_tr_b16 v[130:131], v16 offset:832
    ds_read_b64_tr_b16 v[132:133], v16 offset:12832
    ds_read_b64_tr_b16 v[134:135], v16 offset:13632
    ds_read_b64_tr_b16 v[208:209], v16 offset:64
    ds_read_b64_tr_b16 v[210:211], v16 offset:864
    ds_read_b64_tr_b16 v[212:213], v16 offset:12864
    ds_read_b64_tr_b16 v[214:215], v16 offset:13664
    ds_read_b64_tr_b16 v[24:25], v16 offset:0
    ds_read_b64_tr_b16 v[26:27], v16 offset:800
    ds_read_b64_tr_b16 v[28:29], v16 offset:12800
    ds_read_b64_tr_b16 v[30:31], v16 offset:13600
    s_waitcnt lgkmcnt(0)
    ds_write_b128 v17, v[24:27] offset:8192
    ds_write_b128 v17, v[28:31] offset:9216
    s_waitcnt lgkmcnt(0)
    s_barrier
    s_waitcnt vmcnt(6)
    ds_write_b128 v10, v[48:51]
    ds_write_b128 v11, v[52:55]
    ds_write_b128 v12, v[56:59]
    ds_write_b128 v13, v[60:63]
    ds_write_b128 v14, v[64:67]
    ds_write_b128 v15, v[68:71]
    s_add_u32 s46, s45, 4718592
    buffer_load_dwordx4 v[24:27], v4, s[12:15], s46 offen
    buffer_load_dwordx4 v[28:31], v5, s[12:15], s46 offen
    buffer_load_dwordx4 v[32:35], v6, s[12:15], s46 offen
    buffer_load_dwordx4 v[36:39], v7, s[12:15], s46 offen
    buffer_load_dwordx4 v[40:43], v8, s[12:15], s46 offen
    buffer_load_dwordx4 v[44:47], v9, s[12:15], s46 offen
    s_waitcnt lgkmcnt(0)
    s_barrier
    ds_read_b64_tr_b16 a[40:41], v16 offset:0
    ds_read_b64_tr_b16 a[42:43], v16 offset:800
    ds_read_b64_tr_b16 a[44:45], v16 offset:12800
    ds_read_b64_tr_b16 a[46:47], v16 offset:13600
    ds_read_b64_tr_b16 a[120:121], v16 offset:32
    ds_read_b64_tr_b16 a[122:123], v16 offset:832
    ds_read_b64_tr_b16 a[124:125], v16 offset:12832
    ds_read_b64_tr_b16 a[126:127], v16 offset:13632
    ds_read_b64_tr_b16 a[200:201], v16 offset:64
    ds_read_b64_tr_b16 a[202:203], v16 offset:864
    ds_read_b64_tr_b16 a[204:205], v16 offset:12864
    ds_read_b64_tr_b16 a[206:207], v16 offset:13664
    s_waitcnt lgkmcnt(0)
    s_barrier
    s_waitcnt vmcnt(6)
    ds_write_b128 v10, v[72:75]
    ds_write_b128 v11, v[76:79]
    ds_write_b128 v12, v[80:83]
    ds_write_b128 v13, v[84:87]
    ds_write_b128 v14, v[88:91]
    ds_write_b128 v15, v[92:95]
    s_add_u32 s46, s45, 4718592
    buffer_load_dwordx4 v[48:51], v4, s[16:19], s46 offen
    buffer_load_dwordx4 v[52:55], v5, s[16:19], s46 offen
    buffer_load_dwordx4 v[56:59], v6, s[16:19], s46 offen
    buffer_load_dwordx4 v[60:63], v7, s[16:19], s46 offen
    buffer_load_dwordx4 v[64:67], v8, s[16:19], s46 offen
    buffer_load_dwordx4 v[68:71], v9, s[16:19], s46 offen
    s_waitcnt lgkmcnt(0)
    s_barrier
    ds_read_b64_tr_b16 v[136:137], v16 offset:32
    ds_read_b64_tr_b16 v[138:139], v16 offset:832
    ds_read_b64_tr_b16 v[140:141], v16 offset:12832
    ds_read_b64_tr_b16 v[142:143], v16 offset:13632
    ds_read_b64_tr_b16 v[216:217], v16 offset:64
    ds_read_b64_tr_b16 v[218:219], v16 offset:864
    ds_read_b64_tr_b16 v[220:221], v16 offset:12864
    ds_read_b64_tr_b16 v[222:223], v16 offset:13664
    ds_read_b64_tr_b16 v[72:73], v16 offset:0
    ds_read_b64_tr_b16 v[74:75], v16 offset:800
    ds_read_b64_tr_b16 v[76:77], v16 offset:12800
    ds_read_b64_tr_b16 v[78:79], v16 offset:13600
    s_waitcnt lgkmcnt(0)
    ds_write_b128 v17, v[72:75] offset:10240
    ds_write_b128 v17, v[76:79] offset:11264
    s_waitcnt lgkmcnt(0)
    s_barrier
    s_waitcnt vmcnt(6)
    ds_write_b128 v10, v[24:27]
    ds_write_b128 v11, v[28:31]
    ds_write_b128 v12, v[32:35]
    ds_write_b128 v13, v[36:39]
    ds_write_b128 v14, v[40:43]
    ds_write_b128 v15, v[44:47]
    s_add_u32 s46, s45, 5505024
    buffer_load_dwordx4 v[72:75], v4, s[12:15], s46 offen
    buffer_load_dwordx4 v[76:79], v5, s[12:15], s46 offen
    buffer_load_dwordx4 v[80:83], v6, s[12:15], s46 offen
    buffer_load_dwordx4 v[84:87], v7, s[12:15], s46 offen
    buffer_load_dwordx4 v[88:91], v8, s[12:15], s46 offen
    buffer_load_dwordx4 v[92:95], v9, s[12:15], s46 offen
    s_waitcnt lgkmcnt(0)
    s_barrier
    ds_read_b64_tr_b16 a[48:49], v16 offset:0
    ds_read_b64_tr_b16 a[50:51], v16 offset:800
    ds_read_b64_tr_b16 a[52:53], v16 offset:12800
    ds_read_b64_tr_b16 a[54:55], v16 offset:13600
    ds_read_b64_tr_b16 a[128:129], v16 offset:32
    ds_read_b64_tr_b16 a[130:131], v16 offset:832
    ds_read_b64_tr_b16 a[132:133], v16 offset:12832
    ds_read_b64_tr_b16 a[134:135], v16 offset:13632
    ds_read_b64_tr_b16 a[208:209], v16 offset:64
    ds_read_b64_tr_b16 a[210:211], v16 offset:864
    ds_read_b64_tr_b16 a[212:213], v16 offset:12864
    ds_read_b64_tr_b16 a[214:215], v16 offset:13664
    s_waitcnt lgkmcnt(0)
    s_barrier
    s_waitcnt vmcnt(6)
    ds_write_b128 v10, v[48:51]
    ds_write_b128 v11, v[52:55]
    ds_write_b128 v12, v[56:59]
    ds_write_b128 v13, v[60:63]
    ds_write_b128 v14, v[64:67]
    ds_write_b128 v15, v[68:71]
    s_add_u32 s46, s45, 5505024
    buffer_load_dwordx4 v[24:27], v4, s[16:19], s46 offen
    buffer_load_dwordx4 v[28:31], v5, s[16:19], s46 offen
    buffer_load_dwordx4 v[32:35], v6, s[16:19], s46 offen
    buffer_load_dwordx4 v[36:39], v7, s[16:19], s46 offen
    buffer_load_dwordx4 v[40:43], v8, s[16:19], s46 offen
    buffer_load_dwordx4 v[44:47], v9, s[16:19], s46 offen
    s_waitcnt lgkmcnt(0)
    s_barrier
    ds_read_b64_tr_b16 v[144:145], v16 offset:32
    ds_read_b64_tr_b16 v[146:147], v16 offset:832
    ds_read_b64_tr_b16 v[148:149], v16 offset:12832
    ds_read_b64_tr_b16 v[150:151], v16 offset:13632
    ds_read_b64_tr_b16 v[224:225], v16 offset:64
    ds_read_b64_tr_b16 v[226:227], v16 offset:864
    ds_read_b64_tr_b16 v[228:229], v16 offset:12864
    ds_read_b64_tr_b16 v[230:231], v16 offset:13664
    ds_read_b64_tr_b16 v[48:49], v16 offset:0
    ds_read_b64_tr_b16 v[50:51], v16 offset:800
    ds_read_b64_tr_b16 v[52:53], v16 offset:12800
    ds_read_b64_tr_b16 v[54:55], v16 offset:13600
    s_waitcnt lgkmcnt(0)
    ds_write_b128 v17, v[48:51] offset:12288
    ds_write_b128 v17, v[52:55] offset:13312
    s_waitcnt lgkmcnt(0)
    s_barrier
    s_waitcnt vmcnt(6)
    ds_write_b128 v10, v[72:75]
    ds_write_b128 v11, v[76:79]
    ds_write_b128 v12, v[80:83]
    ds_write_b128 v13, v[84:87]
    ds_write_b128 v14, v[88:91]
    ds_write_b128 v15, v[92:95]
    s_add_u32 s46, s45, 6291456
    buffer_load_dwordx4 v[48:51], v4, s[12:15], s46 offen
    buffer_load_dwordx4 v[52:55], v5, s[12:15], s46 offen
    buffer_load_dwordx4 v[56:59], v6, s[12:15], s46 offen
    buffer_load_dwordx4 v[60:63], v7, s[12:15], s46 offen
    buffer_load_dwordx4 v[64:67], v8, s[12:15], s46 offen
    buffer_load_dwordx4 v[68:71], v9, s[12:15], s46 offen
    s_waitcnt lgkmcnt(0)
    s_barrier
    ds_read_b64_tr_b16 a[56:57], v16 offset:0
    ds_read_b64_tr_b16 a[58:59], v16 offset:800
    ds_read_b64_tr_b16 a[60:61], v16 offset:12800
    ds_read_b64_tr_b16 a[62:63], v16 offset:13600
    ds_read_b64_tr_b16 a[136:137], v16 offset:32
    ds_read_b64_tr_b16 a[138:139], v16 offset:832
    ds_read_b64_tr_b16 a[140:141], v16 offset:12832
    ds_read_b64_tr_b16 a[142:143], v16 offset:13632
    ds_read_b64_tr_b16 a[216:217], v16 offset:64
    ds_read_b64_tr_b16 a[218:219], v16 offset:864
    ds_read_b64_tr_b16 a[220:221], v16 offset:12864
    ds_read_b64_tr_b16 a[222:223], v16 offset:13664
    s_waitcnt lgkmcnt(0)
    s_barrier
    s_waitcnt vmcnt(6)
    ds_write_b128 v10, v[24:27]
    ds_write_b128 v11, v[28:31]
    ds_write_b128 v12, v[32:35]
    ds_write_b128 v13, v[36:39]
    ds_write_b128 v14, v[40:43]
    ds_write_b128 v15, v[44:47]
    s_add_u32 s46, s45, 6291456
    buffer_load_dwordx4 v[72:75], v4, s[16:19], s46 offen
    buffer_load_dwordx4 v[76:79], v5, s[16:19], s46 offen
    buffer_load_dwordx4 v[80:83], v6, s[16:19], s46 offen
    buffer_load_dwordx4 v[84:87], v7, s[16:19], s46 offen
    buffer_load_dwordx4 v[88:91], v8, s[16:19], s46 offen
    buffer_load_dwordx4 v[92:95], v9, s[16:19], s46 offen
    s_waitcnt lgkmcnt(0)
    s_barrier
    ds_read_b64_tr_b16 v[152:153], v16 offset:32
    ds_read_b64_tr_b16 v[154:155], v16 offset:832
    ds_read_b64_tr_b16 v[156:157], v16 offset:12832
    ds_read_b64_tr_b16 v[158:159], v16 offset:13632
    ds_read_b64_tr_b16 v[232:233], v16 offset:64
    ds_read_b64_tr_b16 v[234:235], v16 offset:864
    ds_read_b64_tr_b16 v[236:237], v16 offset:12864
    ds_read_b64_tr_b16 v[238:239], v16 offset:13664
    ds_read_b64_tr_b16 v[24:25], v16 offset:0
    ds_read_b64_tr_b16 v[26:27], v16 offset:800
    ds_read_b64_tr_b16 v[28:29], v16 offset:12800
    ds_read_b64_tr_b16 v[30:31], v16 offset:13600
    s_waitcnt lgkmcnt(0)
    ds_write_b128 v17, v[24:27] offset:14336
    ds_write_b128 v17, v[28:31] offset:15360
    s_waitcnt lgkmcnt(0)
    s_barrier
    s_waitcnt vmcnt(6)
    ds_write_b128 v10, v[48:51]
    ds_write_b128 v11, v[52:55]
    ds_write_b128 v12, v[56:59]
    ds_write_b128 v13, v[60:63]
    ds_write_b128 v14, v[64:67]
    ds_write_b128 v15, v[68:71]
    s_add_u32 s46, s45, 7077888
    buffer_load_dwordx4 v[24:27], v4, s[12:15], s46 offen
    buffer_load_dwordx4 v[28:31], v5, s[12:15], s46 offen
    buffer_load_dwordx4 v[32:35], v6, s[12:15], s46 offen
    buffer_load_dwordx4 v[36:39], v7, s[12:15], s46 offen
    buffer_load_dwordx4 v[40:43], v8, s[12:15], s46 offen
    buffer_load_dwordx4 v[44:47], v9, s[12:15], s46 offen
    s_waitcnt lgkmcnt(0)
    s_barrier
    ds_read_b64_tr_b16 a[64:65], v16 offset:0
    ds_read_b64_tr_b16 a[66:67], v16 offset:800
    ds_read_b64_tr_b16 a[68:69], v16 offset:12800
    ds_read_b64_tr_b16 a[70:71], v16 offset:13600
    ds_read_b64_tr_b16 a[144:145], v16 offset:32
    ds_read_b64_tr_b16 a[146:147], v16 offset:832
    ds_read_b64_tr_b16 a[148:149], v16 offset:12832
    ds_read_b64_tr_b16 a[150:151], v16 offset:13632
    ds_read_b64_tr_b16 a[224:225], v16 offset:64
    ds_read_b64_tr_b16 a[226:227], v16 offset:864
    ds_read_b64_tr_b16 a[228:229], v16 offset:12864
    ds_read_b64_tr_b16 a[230:231], v16 offset:13664
    s_waitcnt lgkmcnt(0)
    s_barrier
    s_waitcnt vmcnt(6)
    ds_write_b128 v10, v[72:75]
    ds_write_b128 v11, v[76:79]
    ds_write_b128 v12, v[80:83]
    ds_write_b128 v13, v[84:87]
    ds_write_b128 v14, v[88:91]
    ds_write_b128 v15, v[92:95]
    s_add_u32 s46, s45, 7077888
    buffer_load_dwordx4 v[48:51], v4, s[16:19], s46 offen
    buffer_load_dwordx4 v[52:55], v5, s[16:19], s46 offen
    buffer_load_dwordx4 v[56:59], v6, s[16:19], s46 offen
    buffer_load_dwordx4 v[60:63], v7, s[16:19], s46 offen
    buffer_load_dwordx4 v[64:67], v8, s[16:19], s46 offen
    buffer_load_dwordx4 v[68:71], v9, s[16:19], s46 offen
    s_waitcnt lgkmcnt(0)
    s_barrier
    ds_read_b64_tr_b16 v[160:161], v16 offset:32
    ds_read_b64_tr_b16 v[162:163], v16 offset:832
    ds_read_b64_tr_b16 v[164:165], v16 offset:12832
    ds_read_b64_tr_b16 v[166:167], v16 offset:13632
    ds_read_b64_tr_b16 v[240:241], v16 offset:64
    ds_read_b64_tr_b16 v[242:243], v16 offset:864
    ds_read_b64_tr_b16 v[244:245], v16 offset:12864
    ds_read_b64_tr_b16 v[246:247], v16 offset:13664
    ds_read_b64_tr_b16 v[72:73], v16 offset:0
    ds_read_b64_tr_b16 v[74:75], v16 offset:800
    ds_read_b64_tr_b16 v[76:77], v16 offset:12800
    ds_read_b64_tr_b16 v[78:79], v16 offset:13600
    s_waitcnt lgkmcnt(0)
    ds_write_b128 v17, v[72:75] offset:16384
    ds_write_b128 v17, v[76:79] offset:17408
    s_waitcnt lgkmcnt(0)
    s_barrier
    s_waitcnt vmcnt(6)
    ds_write_b128 v10, v[24:27]
    ds_write_b128 v11, v[28:31]
    ds_write_b128 v12, v[32:35]
    ds_write_b128 v13, v[36:39]
    ds_write_b128 v14, v[40:43]
    ds_write_b128 v15, v[44:47]
    s_waitcnt lgkmcnt(0)
    s_barrier
    ds_read_b64_tr_b16 a[72:73], v16 offset:0
    ds_read_b64_tr_b16 a[74:75], v16 offset:800
    ds_read_b64_tr_b16 a[76:77], v16 offset:12800
    ds_read_b64_tr_b16 a[78:79], v16 offset:13600
    ds_read_b64_tr_b16 a[152:153], v16 offset:32
    ds_read_b64_tr_b16 a[154:155], v16 offset:832
    ds_read_b64_tr_b16 a[156:157], v16 offset:12832
    ds_read_b64_tr_b16 a[158:159], v16 offset:13632
    ds_read_b64_tr_b16 a[232:233], v16 offset:64
    ds_read_b64_tr_b16 a[234:235], v16 offset:864
    ds_read_b64_tr_b16 a[236:237], v16 offset:12864
    ds_read_b64_tr_b16 a[238:239], v16 offset:13664
    s_waitcnt lgkmcnt(0)
    s_barrier
    s_waitcnt vmcnt(0)
    ds_write_b128 v10, v[48:51]
    ds_write_b128 v11, v[52:55]
    ds_write_b128 v12, v[56:59]
    ds_write_b128 v13, v[60:63]
    ds_write_b128 v14, v[64:67]
    ds_write_b128 v15, v[68:71]
    s_waitcnt lgkmcnt(0)
    s_barrier
    ds_read_b64_tr_b16 v[168:169], v16 offset:32
    ds_read_b64_tr_b16 v[170:171], v16 offset:832
    ds_read_b64_tr_b16 v[172:173], v16 offset:12832
    ds_read_b64_tr_b16 v[174:175], v16 offset:13632
    ds_read_b64_tr_b16 v[248:249], v16 offset:64
    ds_read_b64_tr_b16 v[250:251], v16 offset:864
    ds_read_b64_tr_b16 v[252:253], v16 offset:12864
    ds_read_b64_tr_b16 v[254:255], v16 offset:13664
    ds_read_b64_tr_b16 v[48:49], v16 offset:0
    ds_read_b64_tr_b16 v[50:51], v16 offset:800
    ds_read_b64_tr_b16 v[52:53], v16 offset:12800
    ds_read_b64_tr_b16 v[54:55], v16 offset:13600
    s_waitcnt lgkmcnt(0)
    ds_write_b128 v17, v[48:51] offset:18432
    ds_write_b128 v17, v[52:55] offset:19456
    s_waitcnt lgkmcnt(0)
    s_barrier
    v_mov_b32 v6, v17
    v_mov_b32 v30, 0xeeee
    v_mov_b32 v4, 0x4444
    v_cmp_gt_u32 vcc, 8, v2
    s_nop 1
    v_cndmask_b32 v4, v30, v4, vcc
    v_lshlrev_b32 v5, 4, v1
    s_lshl_b32 s24, s3, 10
    v_add_u32 v7, s24, v5
    s_lshl_b32 s24, s3, 9
    s_add_u32 s24, s24, 8192
    v_lshlrev_b32 v8, 3, v1
    v_add_u32 v8, s24, v8
    v_and_b32 v30, 1, v2
    v_lshlrev_b32 v30, 4, v30
    v_mov_b32 v31, 0x3f80
    v_lshlrev_b32 v31, v30, v31
    v_lshrrev_b32 v30, 2, v2
    v_cmp_eq_u32 vcc, v30, v3
    s_nop 1
    v_cndmask_b32 v31, 0, v31, vcc
    v_and_b32 v30, 2, v2
    v_cmp_eq_u32 vcc, 0, v30
    s_nop 1
    v_cndmask_b32 v10, 0, v31, vcc
    v_cndmask_b32 v11, v31, 0, vcc
    v_add_u32 v33, 22528, v5
    s_mul_i32 s24, s3, 1408
    s_add_u32 s24, s24, 16384
    v_mul_u32_u24 v30, 176, v2
    v_add_u32 v30, s24, v30
    v_lshl_add_u32 v12, v3, 5, v30
    v_cmp_gt_u32 vcc, 8, v2
    s_nop 1
    v_cndmask_b32 v12, v33, v12, vcc
    v_lshl_add_u32 v13, v3, 4, v30
    v_add_u32 v13, 96, v13
    v_cmp_le_u32 s[24:25], 2, v3
    s_and_b64 vcc, vcc, s[24:25]
    v_cndmask_b32 v13, v33, v13, vcc
    s_mul_i32 s24, s3, 5632
    s_add_u32 s24, s24, 106496
    v_mul_u32_u24 v30, 176, v2
    v_add_u32 v30, s24, v30
    v_lshl_add_u32 v16, v3, 5, v30
    v_lshl_add_u32 v17, v3, 4, v30
    v_add_u32 v17, 96, v17
    v_add_u32 v18, 2816, v17
    v_cmp_le_u32 vcc, 2, v3
    s_nop 1
    v_cndmask_b32 v17, v33, v17, vcc
    v_cndmask_b32 v18, v33, v18, vcc
    v_lshrrev_b32 v30, 3, v1
    v_and_b32 v31, 7, v1
    v_min_u32 v32, 4, v31
    v_mul_u32_u24 v14, 176, v30
    v_lshl_add_u32 v14, v32, 5, v14
    s_mul_i32 s24, s3, 1408
    s_add_u32 s24, s24, 106496
    v_add_u32 v21, s24, v14
    v_add_u32 v14, 16384, v14
    v_cmp_gt_u32 s[50:51], 5, v31
    s_lshl_b32 s24, s3, 3
    v_add_u32 v32, s24, v30
    v_lshlrev_b32 v33, 2, v31
    v_sub_u32 v32, v32, v33
    v_mov_b32 v33, 100
    v_cmp_gt_u32 vcc, 4, v31
    s_nop 1
    v_cndmask_b32 v32, v33, v32, vcc
    v_cmp_le_i32 s[64:65], 0, v32
    v_cmp_le_i32 s[66:67], 1, v32
    v_cmp_le_i32 s[68:69], 2, v32
    v_cmp_le_i32 s[70:71], 3, v32
    v_cmp_le_i32 s[72:73], 16, v32
    v_cmp_le_i32 s[74:75], 17, v32
    v_cmp_le_i32 s[76:77], 18, v32
    v_cmp_le_i32 s[78:79], 19, v32
    s_lshr_b32 s24, s44, 1
    s_lshl_b32 s24, s24, 10
    s_and_b32 s25, s44, 1
    s_lshl_b32 s25, s25, 7
    s_add_u32 s24, s24, s25
    v_lshlrev_b32 v15, 8, v31
    v_lshl_add_u32 v15, v30, 4, v15
    v_add_u32 v15, s24, v15
    s_lshr_b32 s24, s44, 3
    s_lshl_b32 s24, s24, 10
    s_and_b32 s25, s44, 3
    s_lshl_b32 s25, s25, 8
    s_add_u32 s24, s24, s25
    s_lshr_b32 s25, s44, 2
    s_and_b32 s25, s25, 1
    s_lshl_b32 s25, s25, 7
    s_add_u32 s24, s24, s25
    s_add_u32 s24, s24, 16384
    v_lshlrev_b32 v32, 4, v30
    v_add_u32 v32, s24, v32
    v_cmp_eq_u32 vcc, 4, v31
    s_nop 1
    v_cndmask_b32 v15, v15, v32, vcc
    v_and_b32 v32, 0xffffe000, v15
    v_add_u32 v15, v15, v32
    v_mov_b32 v32, 2146435072
    v_cndmask_b32 v15, v32, v15, s[50:51]
    s_cmp_lt_u32 s3, 1
    s_cselect_b32 s24, 0, 2146435072
    v_or_b32 v15, s24, v15
    s_and_b32 s24, s3, 1
    s_lshl_b32 s24, s24, 7
    s_lshr_b32 s25, s3, 1
    s_lshl_b32 s25, s25, 10
    s_add_u32 s24, s24, s25
    s_lshl_b32 s25, s44, 11
    s_add_u32 s25, s25, s24
    v_lshlrev_b32 v22, 8, v31
    v_lshl_add_u32 v22, v30, 4, v22
    v_add_u32 v22, s25, v22
    s_lshr_b32 s25, s44, 2
    s_lshl_b32 s25, s25, 11
    s_add_u32 s25, s25, s24
    s_and_b32 s26, s44, 3
    s_lshl_b32 s26, s26, 8
    s_add_u32 s25, s25, s26
    s_add_u32 s25, s25, 65536
    v_lshlrev_b32 v32, 4, v30
    v_add_u32 v32, s25, v32
    v_cmp_eq_u32 vcc, 4, v31
    s_nop 1
    v_cndmask_b32 v22, v22, v32, vcc
    v_and_b32 v32, 0xffffe000, v22
    v_add_u32 v22, v22, v32
    v_mov_b32 v32, 2146435072
    v_cndmask_b32 v22, v32, v22, s[50:51]
    s_mul_i32 s24, s44, 12288
    s_mul_i32 s25, s3, 3072
    s_add_u32 s24, s24, s25
    v_add_u32 v19, s24, v5
    s_and_b32 s24, s2, 15
    s_mul_i32 s25, s3, 16
    s_add_u32 s24, s24, s25
    s_lshl_b32 s24, s24, 7
    v_mov_b32 v23, s24
    s_lshr_b32 s25, s44, 3
    s_mul_i32 s24, s25, 8
    v_add_u32 v20, s24, v1
    v_lshlrev_b32 v20, 7, v20
    v_mov_b32 v30, 2146435072
    v_cmp_le_u32 vcc, 8, v1
    s_nop 1
    v_cndmask_b32 v20, v20, v30, vcc
    s_cmp_eq_u32 s3, 0
    s_cselect_b32 s24, 0, 2146435072
    v_or_b32 v20, s24, v20
    v_mov_b32 v0, 1
interleave_layers__linear_attn_block__memory_aug_recurrent_mem_tr__prompt_kernel_s_layer:
    s_mov_b32 s93, 0
    s_lshl_b32 s24, s93, 12
    s_and_b32 s24, s24, 0x2000
    s_xor_b32 s24, s24, s36
    s_lshl_b32 s93, s93, 20
    s_add_u32 s93, s93, s24
    s_add_u32 s93, s93, 117440512
    s_mul_i32 s94, s92, 16384
    s_add_u32 s94, s94, 23068672
    v_and_b32 v9, 1, v1
    v_lshlrev_b32 v9, 12, v9
    s_lshl_b32 s24, s44, 7
    s_add_u32 s24, s24, s94
    v_add_u32 v9, s24, v9
    s_lshl_b32 s24, s3, 6
    s_add_u32 s24, s24, 0
    v_add_u32 v48, s24, v1
    v_and_b32 v49, 7, v48
    v_mul_u32_u24 v49, 1280, v49
    v_lshrrev_b32 v50, 3, v48
    v_lshl_add_u32 v49, v50, 4, v49
    v_cmp_gt_u32 vcc, 640, v48
    v_mov_b32 v51, 2146435072
    s_nop 0
    v_cndmask_b32 v49, v51, v49, vcc
    buffer_load_dwordx4 v[52:55], v49, s[20:23], 0 offen
    v_lshlrev_b32 v48, 4, v48
    s_waitcnt vmcnt(0)
    s_and_saveexec_b64 s[30:31], vcc
    ds_write_b128 v48, v[52:55]
    s_mov_b64 exec, s[30:31]
    s_lshl_b32 s24, s3, 6
    s_add_u32 s24, s24, 256
    v_add_u32 v48, s24, v1
    v_and_b32 v49, 7, v48
    v_mul_u32_u24 v49, 1280, v49
    v_lshrrev_b32 v50, 3, v48
    v_lshl_add_u32 v49, v50, 4, v49
    v_cmp_gt_u32 vcc, 640, v48
    v_mov_b32 v51, 2146435072
    s_nop 0
    v_cndmask_b32 v49, v51, v49, vcc
    buffer_load_dwordx4 v[52:55], v49, s[20:23], 0 offen
    v_lshlrev_b32 v48, 4, v48
    s_waitcnt vmcnt(0)
    s_and_saveexec_b64 s[30:31], vcc
    ds_write_b128 v48, v[52:55]
    s_mov_b64 exec, s[30:31]
    s_lshl_b32 s24, s3, 6
    s_add_u32 s24, s24, 512
    v_add_u32 v48, s24, v1
    v_and_b32 v49, 7, v48
    v_mul_u32_u24 v49, 1280, v49
    v_lshrrev_b32 v50, 3, v48
    v_lshl_add_u32 v49, v50, 4, v49
    v_cmp_gt_u32 vcc, 640, v48
    v_mov_b32 v51, 2146435072
    s_nop 0
    v_cndmask_b32 v49, v51, v49, vcc
    buffer_load_dwordx4 v[52:55], v49, s[20:23], 0 offen
    v_lshlrev_b32 v48, 4, v48
    s_waitcnt vmcnt(0)
    s_and_saveexec_b64 s[30:31], vcc
    ds_write_b128 v48, v[52:55]
    s_mov_b64 exec, s[30:31]
    s_mov_b32 s40, 0
    s_mov_b32 s41, 92274688
    s_mov_b32 s37, s93
    s_add_u32 s43, s93, 655360
    s_mov_b32 s45, 67108864
    s_add_u32 s49, s93, 753664
    s_lshl_b32 s95, s92, 6
    s_add_u32 s95, s95, s40
    s_add_u32 s95, s95, 1
    s_cmp_ge_i32 s59, s95
    s_cbranch_scc1 interleave_layers__linear_attn_block__memory_aug_recurrent_mem_tr__prompt_kernel_s_ec0_ok
    s_and_b32 s24, s2, 7
    s_lshl_b32 s24, s24, 7
    s_add_u32 s24, s24, 23109632
    v_and_b32 v49, 3, v1
    v_lshl_add_u32 v49, v49, 2, s24
    s_mov_b32 s61, 0
interleave_layers__linear_attn_block__memory_aug_recurrent_mem_tr__prompt_kernel_s_ec0:
    buffer_load_dword v48, v49, s[8:11], 0 offen sc1
    s_waitcnt vmcnt(0)
    v_readlane_b32 s59, v48, 0
    v_readlane_b32 s24, v48, 1
    s_min_i32 s59, s59, s24
    v_readlane_b32 s24, v48, 2
    s_min_i32 s59, s59, s24
    s_cmp_ge_i32 s59, s95
    s_cbranch_scc1 interleave_layers__linear_attn_block__memory_aug_recurrent_mem_tr__prompt_kernel_s_ec0_ok
    s_add_u32 s61, s61, 1
    s_cmp_ge_u32 s61, s60
    s_cbranch_scc1 interleave_layers__linear_attn_block__memory_aug_recurrent_mem_tr__prompt_kernel_s_ec0_to
    s_sleep 2
    s_branch interleave_layers__linear_attn_block__memory_aug_recurrent_mem_tr__prompt_kernel_s_ec0
interleave_layers__linear_attn_block__memory_aug_recurrent_mem_tr__prompt_kernel_s_ec0_to:
    s_mov_b32 s60, 1
interleave_layers__linear_attn_block__memory_aug_recurrent_mem_tr__prompt_kernel_s_ec0_ok:
    s_mov_b32 s62, -1
    s_mov_b32 s63, 1
    s_cmp_ge_i32 s62, s63
    s_cbranch_scc1 interleave_layers__linear_attn_block__memory_aug_recurrent_mem_tr__prompt_kernel_s_en0_ok
    s_mov_b32 s61, 0
interleave_layers__linear_attn_block__memory_aug_recurrent_mem_tr__prompt_kernel_s_en0:
    buffer_load_dword v48, v9, s[8:11], 0 offen sc1
    s_waitcnt vmcnt(0)
    v_readlane_b32 s62, v48, 0
    v_readlane_b32 s24, v48, 1
    s_min_i32 s62, s62, s24
    s_cmp_ge_i32 s62, s63
    s_cbranch_scc1 interleave_layers__linear_attn_block__memory_aug_recurrent_mem_tr__prompt_kernel_s_en0_ok
    s_add_u32 s61, s61, 1
    s_cmp_ge_u32 s61, s60
    s_cbranch_scc1 interleave_layers__linear_attn_block__memory_aug_recurrent_mem_tr__prompt_kernel_s_en0_to
    s_sleep 2
    s_branch interleave_layers__linear_attn_block__memory_aug_recurrent_mem_tr__prompt_kernel_s_en0
interleave_layers__linear_attn_block__memory_aug_recurrent_mem_tr__prompt_kernel_s_en0_to:
    s_mov_b32 s60, 1
interleave_layers__linear_attn_block__memory_aug_recurrent_mem_tr__prompt_kernel_s_en0_ok:
    buffer_load_dwordx4 a[240:243], v19, s[8:11], s41 offen offset:0 sc1
    buffer_load_dwordx4 a[244:247], v19, s[8:11], s41 offen offset:1024 sc1
    buffer_load_dwordx4 a[248:251], v19, s[8:11], s41 offen offset:2048 sc1
    s_waitcnt lgkmcnt(0)
    v_mov_b32 v24, 0
    v_mov_b32 v25, 0
    v_mov_b32 v26, 0
    v_mov_b32 v27, 0
    v_mov_b32 v28, 0
    v_mov_b32 v29, 0
    v_mov_b32 v30, 0
    v_mov_b32 v31, 0
    v_mov_b32 v32, 0
    v_mov_b32 v33, 0
    v_mov_b32 v34, 0
    v_mov_b32 v35, 0
    v_mov_b32 v36, 0
    v_mov_b32 v37, 0
    v_mov_b32 v38, 0
    v_mov_b32 v39, 0
    v_mov_b32 v40, 0
    v_mov_b32 v41, 0
    v_mov_b32 v42, 0
    v_mov_b32 v43, 0
    v_mov_b32 v44, 0
    v_mov_b32 v45, 0
    v_mov_b32 v46, 0
    v_mov_b32 v47, 0
    s_barrier
    ds_read_b128 v[84:87], v7
    ds_read_b128 v[88:91], v7 offset:4096
    s_waitcnt vmcnt(0) lgkmcnt(0)
    s_cmp_eq_u32 s3, 0
    s_cbranch_scc1 interleave_layers__linear_attn_block__memory_aug_recurrent_mem_tr__prompt_kernel_s_gow0
    s_cmp_eq_u32 s3, 1
    s_cbranch_scc1 interleave_layers__linear_attn_block__memory_aug_recurrent_mem_tr__prompt_kernel_s_gow1
    s_cmp_eq_u32 s3, 2
    s_cbranch_scc1 interleave_layers__linear_attn_block__memory_aug_recurrent_mem_tr__prompt_kernel_s_gow2
    s_branch interleave_layers__linear_attn_block__memory_aug_recurrent_mem_tr__prompt_kernel_s_gow3
interleave_layers__linear_attn_block__memory_aug_recurrent_mem_tr__prompt_kernel_s_stepw0:
    v_mov_b32 v24, 0
    v_mov_b32 v25, 0
    v_mov_b32 v26, 0
    v_mov_b32 v27, 0
    v_mov_b32 v28, 0
    v_mov_b32 v29, 0
    v_mov_b32 v30, 0
    v_mov_b32 v31, 0
    v_mov_b32 v32, 0
    v_mov_b32 v33, 0
    v_mov_b32 v34, 0
    v_mov_b32 v35, 0
    v_mov_b32 v36, 0
    v_mov_b32 v37, 0
    v_mov_b32 v38, 0
    v_mov_b32 v39, 0
    v_mov_b32 v40, 0
    v_mov_b32 v41, 0
    v_mov_b32 v42, 0
    v_mov_b32 v43, 0
    v_mov_b32 v44, 0
    v_mov_b32 v45, 0
    v_mov_b32 v46, 0
    v_mov_b32 v47, 0
    s_add_u32 s46, s47, 4096
    s_add_u32 s52, s47, 8192
    s_lshl_b32 s95, s92, 6
    s_add_u32 s95, s95, s40
    s_add_u32 s95, s95, 1
    s_cmp_ge_i32 s59, s95
    s_cbranch_scc1 interleave_layers__linear_attn_block__memory_aug_recurrent_mem_tr__prompt_kernel_s_ecw0_ok
    s_and_b32 s24, s2, 7
    s_lshl_b32 s24, s24, 7
    s_add_u32 s24, s24, 23109632
    v_and_b32 v49, 3, v1
    v_lshl_add_u32 v49, v49, 2, s24
    s_mov_b32 s61, 0
interleave_layers__linear_attn_block__memory_aug_recurrent_mem_tr__prompt_kernel_s_ecw0:
    buffer_load_dword v48, v49, s[8:11], 0 offen sc1
    s_waitcnt vmcnt(0)
    v_readlane_b32 s59, v48, 0
    v_readlane_b32 s24, v48, 1
    s_min_i32 s59, s59, s24
    v_readlane_b32 s24, v48, 2
    s_min_i32 s59, s59, s24
    s_cmp_ge_i32 s59, s95
    s_cbranch_scc1 interleave_layers__linear_attn_block__memory_aug_recurrent_mem_tr__prompt_kernel_s_ecw0_ok
    s_add_u32 s61, s61, 1
    s_cmp_ge_u32 s61, s60
    s_cbranch_scc1 interleave_layers__linear_attn_block__memory_aug_recurrent_mem_tr__prompt_kernel_s_ecw0_to
    s_sleep 2
    s_branch interleave_layers__linear_attn_block__memory_aug_recurrent_mem_tr__prompt_kernel_s_ecw0
interleave_layers__linear_attn_block__memory_aug_recurrent_mem_tr__prompt_kernel_s_ecw0_to:
    s_mov_b32 s60, 1
interleave_layers__linear_attn_block__memory_aug_recurrent_mem_tr__prompt_kernel_s_ecw0_ok:
    s_add_u32 s63, s40, 1
    s_cmp_ge_i32 s62, s63
    s_cbranch_scc1 interleave_layers__linear_attn_block__memory_aug_recurrent_mem_tr__prompt_kernel_s_enw0_ok
    s_mov_b32 s61, 0
interleave_layers__linear_attn_block__memory_aug_recurrent_mem_tr__prompt_kernel_s_enw0:
    buffer_load_dword v48, v9, s[8:11], 0 offen sc1
    s_waitcnt vmcnt(0)
    v_readlane_b32 s62, v48, 0
    v_readlane_b32 s24, v48, 1
    s_min_i32 s62, s62, s24
    s_cmp_ge_i32 s62, s63
    s_cbranch_scc1 interleave_layers__linear_attn_block__memory_aug_recurrent_mem_tr__prompt_kernel_s_enw0_ok
    s_add_u32 s61, s61, 1
    s_cmp_ge_u32 s61, s60
    s_cbranch_scc1 interleave_layers__linear_attn_block__memory_aug_recurrent_mem_tr__prompt_kernel_s_enw0_to
    s_sleep 2
    s_branch interleave_layers__linear_attn_block__memory_aug_recurrent_mem_tr__prompt_kernel_s_enw0
interleave_layers__linear_attn_block__memory_aug_recurrent_mem_tr__prompt_kernel_s_enw0_to:
    s_mov_b32 s60, 1
interleave_layers__linear_attn_block__memory_aug_recurrent_mem_tr__prompt_kernel_s_enw0_ok:
    buffer_load_dwordx4 a[240:243], v19, s[8:11], s41 offen offset:0 sc1
    buffer_load_dwordx4 a[244:247], v19, s[8:11], s41 offen offset:1024 sc1
    buffer_load_dwordx4 a[248:251], v19, s[8:11], s41 offen offset:2048 sc1
    s_sleep 5
    s_mov_b64 exec, 1
    s_mov_b32 s61, 0
    v_mov_b32 v83, 0
    buffer_atomic_add v83, v23, s[8:11], s48 offen sc0
    s_sleep 2
    v_mov_b32 v94, 0
    buffer_atomic_add v94, v23, s[8:11], s48 offen sc0
    s_sleep 2
    v_mov_b32 v95, 0
    buffer_atomic_add v95, v23, s[8:11], s48 offen sc0
    s_sleep 2
interleave_layers__linear_attn_block__memory_aug_recurrent_mem_tr__prompt_kernel_s_prw0:
    v_mov_b32 v82, 0
    buffer_atomic_add v82, v23, s[8:11], s48 offen sc0
    s_waitcnt vmcnt(3)
    v_cmp_le_i32 vcc, 9, v83
    s_add_u32 s61, s61, 1
    s_cbranch_vccnz interleave_layers__linear_attn_block__memory_aug_recurrent_mem_tr__prompt_kernel_s_prw0_out
    s_sleep 2
    v_mov_b32 v83, 0
    buffer_atomic_add v83, v23, s[8:11], s48 offen sc0
    s_waitcnt vmcnt(3)
    v_cmp_le_i32 vcc, 9, v94
    s_add_u32 s61, s61, 1
    s_cbranch_vccnz interleave_layers__linear_attn_block__memory_aug_recurrent_mem_tr__prompt_kernel_s_prw0_out
    s_sleep 2
    v_mov_b32 v94, 0
    buffer_atomic_add v94, v23, s[8:11], s48 offen sc0
    s_waitcnt vmcnt(3)
    v_cmp_le_i32 vcc, 9, v95
    s_add_u32 s61, s61, 1
    s_cbranch_vccnz interleave_layers__linear_attn_block__memory_aug_recurrent_mem_tr__prompt_kernel_s_prw0_out
    s_sleep 2
    v_mov_b32 v95, 0
    buffer_atomic_add v95, v23, s[8:11], s48 offen sc0
    s_waitcnt vmcnt(3)
    v_cmp_le_i32 vcc, 9, v82
    s_add_u32 s61, s61, 1
    s_cbranch_vccnz interleave_layers__linear_attn_block__memory_aug_recurrent_mem_tr__prompt_kernel_s_prw0_out
    s_sleep 2
    s_cmp_ge_u32 s61, s60
    s_cbranch_scc0 interleave_layers__linear_attn_block__memory_aug_recurrent_mem_tr__prompt_kernel_s_prw0
    s_mov_b32 s60, 1
interleave_layers__linear_attn_block__memory_aug_recurrent_mem_tr__prompt_kernel_s_prw0_out:
    s_mov_b64 exec, -1
    buffer_load_dwordx4 v[84:87], v7, s[8:11], s47 offen sc1
    buffer_load_dwordx4 v[88:91], v7, s[8:11], s46 offen sc1
    buffer_load_dwordx2 v[92:93], v8, s[8:11], s52 offen sc1
    ds_read_b128 v[48:51], v21 offset:0
    ds_read_b128 v[52:55], v21 offset:16
    ds_read_b128 v[56:59], v21 offset:5632
    ds_read_b128 v[60:63], v21 offset:5648
    ds_read_b128 v[64:67], v21 offset:11264
    ds_read_b128 v[68:71], v21 offset:11280
    ds_read_b128 v[72:75], v21 offset:16896
    ds_read_b128 v[76:79], v21 offset:16912
    s_waitcnt lgkmcnt(4)
    v_pk_add_f32 v[48:49], v[48:49], v[56:57]
    v_pk_add_f32 v[50:51], v[50:51], v[58:59]
    v_pk_add_f32 v[52:53], v[52:53], v[60:61]
    v_pk_add_f32 v[54:55], v[54:55], v[62:63]
    s_waitcnt lgkmcnt(0)
    v_pk_add_f32 v[64:65], v[64:65], v[72:73]
    v_pk_add_f32 v[66:67], v[66:67], v[74:75]
    v_pk_add_f32 v[68:69], v[68:69], v[76:77]
    v_pk_add_f32 v[70:71], v[70:71], v[78:79]
    v_pk_add_f32 v[48:49], v[48:49], v[64:65]
    v_pk_add_f32 v[50:51], v[50:51], v[66:67]
    v_pk_add_f32 v[52:53], v[52:53], v[68:69]
    v_pk_add_f32 v[54:55], v[54:55], v[70:71]
    v_mov_b32 v81, 0xff800000
    v_cndmask_b32 v48, v81, v48, s[64:65]
    v_cndmask_b32 v49, v81, v49, s[66:67]
    v_cndmask_b32 v50, v81, v50, s[68:69]
    v_cndmask_b32 v51, v81, v51, s[70:71]
    v_cndmask_b32 v52, v81, v52, s[72:73]
    v_cndmask_b32 v53, v81, v53, s[74:75]
    v_cndmask_b32 v54, v81, v54, s[76:77]
    v_cndmask_b32 v55, v81, v55, s[78:79]
    v_max3_f32 v80, v48, v49, v50
    v_max3_f32 v80, v80, v51, v52
    v_max3_f32 v80, v80, v53, v54
    v_max_f32 v80, v80, v55
    v_mov_b32 v81, 0xff800000
    v_cndmask_b32 v80, v81, v80, s[50:51]
    s_nop 1
    v_max_f32 v80, v80, v80 quad_perm:[1,0,3,2] row_mask:0xf bank_mask:0xf
    s_nop 1
    v_max_f32 v80, v80, v80 quad_perm:[2,3,0,1] row_mask:0xf bank_mask:0xf
    s_nop 1
    v_max_f32 v80, v80, v80 row_half_mirror row_mask:0xf bank_mask:0xf
    s_mov_b32 s24, 0x3dd53b95
    v_mul_f32 v80, s24, v80
    v_pk_fma_f32 v[48:49], v[48:49], s[24:25], v[80:81] op_sel_hi:[1,0,0] neg_lo:[0,0,1] neg_hi:[0,0,1]
    v_pk_fma_f32 v[50:51], v[50:51], s[24:25], v[80:81] op_sel_hi:[1,0,0] neg_lo:[0,0,1] neg_hi:[0,0,1]
    v_pk_fma_f32 v[52:53], v[52:53], s[24:25], v[80:81] op_sel_hi:[1,0,0] neg_lo:[0,0,1] neg_hi:[0,0,1]
    v_pk_fma_f32 v[54:55], v[54:55], s[24:25], v[80:81] op_sel_hi:[1,0,0] neg_lo:[0,0,1] neg_hi:[0,0,1]
    v_exp_f32 v48, v48
    v_exp_f32 v49, v49
    v_exp_f32 v50, v50
    v_exp_f32 v51, v51
    v_exp_f32 v52, v52
    v_exp_f32 v53, v53
    v_exp_f32 v54, v54
    v_exp_f32 v55, v55
    v_pk_add_f32 v[56:57], v[48:49], v[50:51]
    v_pk_add_f32 v[58:59], v[52:53], v[54:55]
    v_pk_add_f32 v[56:57], v[56:57], v[58:59]
    v_add_f32 v80, v56, v57
    v_cndmask_b32 v80, 0, v80, s[50:51]
    s_nop 1
    v_add_f32 v80, v80, v80 quad_perm:[1,0,3,2] row_mask:0xf bank_mask:0xf
    s_nop 1
    v_add_f32 v80, v80, v80 quad_perm:[2,3,0,1] row_mask:0xf bank_mask:0xf
    s_nop 1
    v_add_f32 v80, v80, v80 row_half_mirror row_mask:0xf bank_mask:0xf
    v_rcp_f32 v80, v80
    s_nop 0
    v_pk_mul_f32 v[48:49], v[48:49], v[80:81] op_sel_hi:[1,0]
    v_pk_mul_f32 v[50:51], v[50:51], v[80:81] op_sel_hi:[1,0]
    v_pk_mul_f32 v[52:53], v[52:53], v[80:81] op_sel_hi:[1,0]
    v_pk_mul_f32 v[54:55], v[54:55], v[80:81] op_sel_hi:[1,0]
    v_cvt_pk_bf16_f32 v56, v48, v49
    v_cvt_pk_bf16_f32 v57, v50, v51
    v_cvt_pk_bf16_f32 v58, v52, v53
    v_cvt_pk_bf16_f32 v59, v54, v55
    v_min_u32 v56, -2, v56
    v_min_u32 v57, -2, v57
    v_min_u32 v58, -2, v58
    v_min_u32 v59, -2, v59
    buffer_store_dwordx4 v[56:59], v22, s[8:11], s42 offen sc1
    s_waitcnt vmcnt(1)
    s_nop 0
    v_max3_u32 v58, v84, v85, v86
    v_max3_u32 v58, v58, v87, v88
    v_max3_u32 v58, v58, v89, v90
    v_max3_u32 v58, v58, v91, v92
    v_max_u32 v58, v58, v93
    v_cmp_eq_u32 vcc, -1, v58
    s_cbranch_vccz interleave_layers__linear_attn_block__memory_aug_recurrent_mem_tr__prompt_kernel_s_pmw0_out
    s_mov_b32 s61, 0
interleave_layers__linear_attn_block__memory_aug_recurrent_mem_tr__prompt_kernel_s_pmw0:
    buffer_load_dwordx4 v[84:87], v7, s[8:11], s47 offen sc1
    buffer_load_dwordx4 v[88:91], v7, s[8:11], s46 offen sc1
    buffer_load_dwordx2 v[92:93], v8, s[8:11], s52 offen sc1
    s_waitcnt vmcnt(0)
    v_max3_u32 v58, v84, v85, v86
    v_max3_u32 v58, v58, v87, v88
    v_max3_u32 v58, v58, v89, v90
    v_max3_u32 v58, v58, v91, v92
    v_max_u32 v58, v58, v93
    v_cmp_eq_u32 vcc, -1, v58
    s_add_u32 s61, s61, 1
    s_cbranch_vccz interleave_layers__linear_attn_block__memory_aug_recurrent_mem_tr__prompt_kernel_s_pmw0_out
    s_cmp_ge_u32 s61, s60
    s_cbranch_scc1 interleave_layers__linear_attn_block__memory_aug_recurrent_mem_tr__prompt_kernel_s_pmw0_to
    s_sleep 1
    s_branch interleave_layers__linear_attn_block__memory_aug_recurrent_mem_tr__prompt_kernel_s_pmw0
interleave_layers__linear_attn_block__memory_aug_recurrent_mem_tr__prompt_kernel_s_pmw0_to:
    s_mov_b32 s60, 1
interleave_layers__linear_attn_block__memory_aug_recurrent_mem_tr__prompt_kernel_s_pmw0_out:
    ds_write_b128 v7, v[84:87]
    ds_write_b128 v7, v[88:91] offset:4096
    ds_write_b64 v8, v[92:93]
interleave_layers__linear_attn_block__memory_aug_recurrent_mem_tr__prompt_kernel_s_gow0:
    ds_read_b128 v[68:71], v6 offset:0
    ds_read_b128 v[72:75], v6 offset:1024
    ds_read_b128 v[76:79], v6 offset:8192
    ds_read_b128 v[80:83], v6 offset:9216
    v_smfmac_f32_16x16x64_bf16 v[24:27], v[84:87], a[0:7], v4
    v_smfmac_f32_16x16x64_bf16 v[28:31], v[84:87], a[80:87], v4
    v_smfmac_f32_16x16x64_bf16 v[32:35], v[84:87], a[160:167], v4
    v_smfmac_f32_16x16x64_bf16 v[40:43], v[84:87], v[96:103], v4
    v_smfmac_f32_16x16x64_bf16 v[44:47], v[84:87], v[176:183], v4
    s_waitcnt lgkmcnt(2)
    v_smfmac_f32_16x16x64_bf16 v[36:39], v[84:87], v[68:75], v4
    ds_read_b128 v[68:71], v6 offset:2048
    ds_read_b128 v[72:75], v6 offset:3072
    s_barrier
    ds_read_b128 v[48:51], v5 offset:1024
    ds_read_b128 v[52:55], v5 offset:2048
    ds_read_b128 v[56:59], v5 offset:3072
    ds_read_b128 v[60:63], v5 offset:5120
    ds_read_b128 v[64:67], v5 offset:6144
    v_smfmac_f32_16x16x64_bf16 v[24:27], v[88:91], a[32:39], v4
    v_smfmac_f32_16x16x64_bf16 v[28:31], v[88:91], a[112:119], v4
    v_smfmac_f32_16x16x64_bf16 v[32:35], v[88:91], a[192:199], v4
    v_smfmac_f32_16x16x64_bf16 v[40:43], v[88:91], v[128:135], v4
    v_smfmac_f32_16x16x64_bf16 v[44:47], v[88:91], v[208:215], v4
    s_waitcnt lgkmcnt(7)
    v_smfmac_f32_16x16x64_bf16 v[36:39], v[88:91], v[76:83], v4
    ds_read_b128 v[76:79], v6 offset:4096
    ds_read_b128 v[80:83], v6 offset:5120
    s_waitcnt lgkmcnt(6)
    v_smfmac_f32_16x16x64_bf16 v[24:27], v[48:51], a[8:15], v4
    v_smfmac_f32_16x16x64_bf16 v[28:31], v[48:51], a[88:95], v4
    v_smfmac_f32_16x16x64_bf16 v[40:43], v[48:51], v[104:111], v4
    v_smfmac_f32_16x16x64_bf16 v[36:39], v[48:51], v[68:75], v4
    ds_read_b128 v[68:71], v6 offset:6144
    ds_read_b128 v[72:75], v6 offset:7168
    ds_read_b128 v[48:51], v5 offset:7168
    s_waitcnt lgkmcnt(8)
    v_smfmac_f32_16x16x64_bf16 v[24:27], v[52:55], a[16:23], v4
    v_smfmac_f32_16x16x64_bf16 v[28:31], v[52:55], a[96:103], v4
    v_smfmac_f32_16x16x64_bf16 v[40:43], v[52:55], v[112:119], v4
    s_waitcnt lgkmcnt(3)
    v_smfmac_f32_16x16x64_bf16 v[36:39], v[52:55], v[76:83], v4
    ds_read_b128 v[76:79], v6 offset:10240
    ds_read_b128 v[80:83], v6 offset:11264
    ds_read_b128 v[52:55], v5 offset:8192
    v_smfmac_f32_16x16x64_bf16 v[24:27], v[56:59], a[24:31], v4
    v_smfmac_f32_16x16x64_bf16 v[28:31], v[56:59], a[104:111], v4
    v_smfmac_f32_16x16x64_bf16 v[40:43], v[56:59], v[120:127], v4
    s_waitcnt lgkmcnt(4)
    v_smfmac_f32_16x16x64_bf16 v[36:39], v[56:59], v[68:75], v4
    ds_read_b128 v[68:71], v6 offset:12288
    ds_read_b128 v[72:75], v6 offset:13312
    ds_read_b128 v[56:59], v5 offset:9216
    v_smfmac_f32_16x16x64_bf16 v[24:27], v[60:63], a[40:47], v4
    v_smfmac_f32_16x16x64_bf16 v[28:31], v[60:63], a[120:127], v4
    v_smfmac_f32_16x16x64_bf16 v[40:43], v[60:63], v[136:143], v4
    s_waitcnt lgkmcnt(4)
    v_smfmac_f32_16x16x64_bf16 v[36:39], v[60:63], v[76:83], v4
    ds_read_b128 v[76:79], v6 offset:14336
    ds_read_b128 v[80:83], v6 offset:15360
    ds_read_b128 v[60:63], v5 offset:1024
    v_smfmac_f32_16x16x64_bf16 v[24:27], v[64:67], a[48:55], v4
    v_smfmac_f32_16x16x64_bf16 v[28:31], v[64:67], a[128:135], v4
    v_smfmac_f32_16x16x64_bf16 v[40:43], v[64:67], v[144:151], v4
    s_waitcnt lgkmcnt(4)
    v_smfmac_f32_16x16x64_bf16 v[36:39], v[64:67], v[68:75], v4
    ds_read_b128 v[68:71], v6 offset:16384
    ds_read_b128 v[72:75], v6 offset:17408
    ds_read_b128 v[64:67], v5 offset:2048
    v_smfmac_f32_16x16x64_bf16 v[24:27], v[48:51], a[56:63], v4
    v_smfmac_f32_16x16x64_bf16 v[28:31], v[48:51], a[136:143], v4
    v_smfmac_f32_16x16x64_bf16 v[40:43], v[48:51], v[152:159], v4
    s_waitcnt lgkmcnt(4)
    v_smfmac_f32_16x16x64_bf16 v[36:39], v[48:51], v[76:83], v4
    ds_read_b128 v[76:79], v6 offset:18432
    ds_read_b128 v[80:83], v6 offset:19456
    ds_read_b128 v[48:51], v5 offset:3072
    v_smfmac_f32_16x16x64_bf16 v[24:27], v[52:55], a[64:71], v4
    v_smfmac_f32_16x16x64_bf16 v[28:31], v[52:55], a[144:151], v4
    v_smfmac_f32_16x16x64_bf16 v[40:43], v[52:55], v[160:167], v4
    s_waitcnt lgkmcnt(4)
    v_smfmac_f32_16x16x64_bf16 v[36:39], v[52:55], v[68:75], v4
    ds_read_b128 v[52:55], v5 offset:5120
    v_smfmac_f32_16x16x64_bf16 v[24:27], v[56:59], a[72:79], v4
    v_smfmac_f32_16x16x64_bf16 v[28:31], v[56:59], a[152:159], v4
    v_smfmac_f32_16x16x64_bf16 v[40:43], v[56:59], v[168:175], v4
    s_waitcnt lgkmcnt(2)
    v_smfmac_f32_16x16x64_bf16 v[36:39], v[56:59], v[76:83], v4
    ds_read_b128 v[56:59], v5 offset:6144
    buffer_load_dwordx4 v[80:83], v19, s[8:11], s45 offen offset:0 sc1
    buffer_load_dwordx4 v[84:87], v19, s[8:11], s45 offen offset:1024 sc1
    buffer_load_dwordx4 v[88:91], v19, s[8:11], s45 offen offset:2048 sc1
    v_smfmac_f32_16x16x64_bf16 v[32:35], v[60:63], a[168:175], v4
    v_smfmac_f32_16x16x64_bf16 v[44:47], v[60:63], v[184:191], v4
    v_permlane32_swap_b32 v28, v40
    v_permlane32_swap_b32 v29, v41
    ds_read_b128 v[60:63], v5 offset:7168
    v_smfmac_f32_16x16x64_bf16 v[32:35], v[64:67], a[176:183], v4
    v_permlane32_swap_b32 v30, v42
    v_permlane32_swap_b32 v31, v43
    v_smfmac_f32_16x16x64_bf16 v[44:47], v[64:67], v[192:199], v4
    v_add_f32 v28, v28, v40
    v_add_f32 v29, v29, v41
    ds_read_b128 v[64:67], v5 offset:8192
    s_waitcnt lgkmcnt(4)
    v_smfmac_f32_16x16x64_bf16 v[32:35], v[48:51], a[184:191], v4
    v_add_f32 v30, v30, v42
    v_add_f32 v31, v31, v43
    v_smfmac_f32_16x16x64_bf16 v[44:47], v[48:51], v[200:207], v4
    v_cvt_pk_bf16_f32 v40, v28, v29
    v_cvt_pk_bf16_f32 v41, v30, v31
    ds_read_b128 v[48:51], v5 offset:9216
    s_waitcnt lgkmcnt(4)
    v_smfmac_f32_16x16x64_bf16 v[32:35], v[52:55], a[200:207], v4
    v_mfma_f32_16x16x16_bf16 v[28:31], v[40:41], v[10:11], 0
    v_permlane32_swap_b32 v24, v36
    v_smfmac_f32_16x16x64_bf16 v[44:47], v[52:55], v[216:223], v4
    v_permlane32_swap_b32 v25, v37
    v_permlane32_swap_b32 v26, v38
    s_waitcnt lgkmcnt(3)
    v_smfmac_f32_16x16x64_bf16 v[32:35], v[56:59], a[208:215], v4
    v_permlane32_swap_b32 v27, v39
    v_add_f32 v24, v24, v36
    v_smfmac_f32_16x16x64_bf16 v[44:47], v[56:59], v[224:231], v4
    v_add_f32 v25, v25, v37
    v_add_f32 v26, v26, v38
    s_waitcnt lgkmcnt(2)
    v_smfmac_f32_16x16x64_bf16 v[32:35], v[60:63], a[216:223], v4
    v_add_f32 v27, v27, v39
    v_cvt_pk_bf16_f32 v36, v24, v25
    v_smfmac_f32_16x16x64_bf16 v[44:47], v[60:63], v[232:239], v4
    v_cvt_pk_bf16_f32 v37, v26, v27
    s_nop 1
    v_mfma_f32_16x16x16_bf16 v[24:27], v[36:37], v[10:11], 0
    s_waitcnt lgkmcnt(1)
    v_smfmac_f32_16x16x64_bf16 v[32:35], v[64:67], a[224:231], v4
    s_nop 5
    v_cvt_pk_bf16_f32 v24, v24, v25
    v_smfmac_f32_16x16x64_bf16 v[44:47], v[64:67], v[240:247], v4
    v_cvt_pk_bf16_f32 v25, v26, v27
    v_cvt_pk_bf16_f32 v26, v28, v29
    s_waitcnt lgkmcnt(0)
    v_smfmac_f32_16x16x64_bf16 v[32:35], v[48:51], a[232:239], v4
    v_cvt_pk_bf16_f32 v27, v30, v31
    s_waitcnt vmcnt(3)
    v_smfmac_f32_16x16x64_bf16 v[44:47], v[48:51], v[248:255], v4
    v_mfma_f32_16x16x32_bf16 v[28:31], a[240:243], v[24:27], 0
    v_mfma_f32_16x16x32_bf16 v[36:39], a[244:247], v[24:27], 0
    v_mfma_f32_16x16x32_bf16 v[40:43], v[24:27], v[24:27], 0
    s_nop 4
    v_permlane32_swap_b32 v32, v44
    v_permlane32_swap_b32 v33, v45
    v_permlane32_swap_b32 v34, v46
    v_permlane32_swap_b32 v35, v47
    v_add_f32 v32, v32, v44
    v_add_f32 v33, v33, v45
    v_add_f32 v34, v34, v46
    v_add_f32 v35, v35, v47
    v_cvt_pk_bf16_f32 v44, v32, v33
    v_cvt_pk_bf16_f32 v45, v34, v35
    s_nop 1
    v_mfma_f32_16x16x16_bf16 v[32:35], v[44:45], v[10:11], 0
    s_nop 7
    v_cvt_pk_bf16_f32 v32, v32, v33
    v_cvt_pk_bf16_f32 v33, v34, v35
    s_nop 1
    v_mfma_f32_16x16x16_bf16 v[28:31], a[248:249], v[32:33], v[28:31]
    v_mfma_f32_16x16x16_bf16 v[36:39], a[250:251], v[32:33], v[36:39]
    v_mfma_f32_16x16x16_bf16 v[40:43], v[32:33], v[32:33], v[40:43]
    s_nop 5
    ds_write_b128 v12, v[28:31]
    ds_write_b128 v12, v[36:39] offset:16
    ds_write_b128 v13, v[40:43]
    buffer_atomic_add v0, v20, s[8:11], s49 offen
    s_waitcnt lgkmcnt(0)
    s_barrier
    ds_read_b128 v[48:51], v14 offset:0
    ds_read_b128 v[52:55], v14 offset:16
    ds_read_b128 v[56:59], v14 offset:1408
    ds_read_b128 v[60:63], v14 offset:1424
    ds_read_b128 v[64:67], v14 offset:2816
    ds_read_b128 v[68:71], v14 offset:2832
    ds_read_b128 v[72:75], v14 offset:4224
    ds_read_b128 v[76:79], v14 offset:4240
    s_waitcnt lgkmcnt(4)
    v_pk_add_f32 v[48:49], v[48:49], v[56:57]
    v_pk_add_f32 v[50:51], v[50:51], v[58:59]
    v_pk_add_f32 v[52:53], v[52:53], v[60:61]
    v_pk_add_f32 v[54:55], v[54:55], v[62:63]
    s_waitcnt lgkmcnt(0)
    v_pk_add_f32 v[64:65], v[64:65], v[72:73]
    v_pk_add_f32 v[66:67], v[66:67], v[74:75]
    v_pk_add_f32 v[68:69], v[68:69], v[76:77]
    v_pk_add_f32 v[70:71], v[70:71], v[78:79]
    v_pk_add_f32 v[48:49], v[48:49], v[64:65]
    v_pk_add_f32 v[50:51], v[50:51], v[66:67]
    v_pk_add_f32 v[52:53], v[52:53], v[68:69]
    v_pk_add_f32 v[54:55], v[54:55], v[70:71]
    v_max3_f32 v92, v48, v49, v50
    v_max3_f32 v92, v92, v51, v52
    v_max3_f32 v92, v92, v53, v54
    v_max_f32 v92, v92, v55
    v_mov_b32 v93, 0xff800000
    v_cndmask_b32 v92, v93, v92, s[50:51]
    s_nop 1
    v_max_f32 v92, v92, v92 quad_perm:[1,0,3,2] row_mask:0xf bank_mask:0xf
    s_nop 1
    v_max_f32 v92, v92, v92 quad_perm:[2,3,0,1] row_mask:0xf bank_mask:0xf
    s_nop 1
    v_max_f32 v92, v92, v92 row_half_mirror row_mask:0xf bank_mask:0xf
    s_mov_b32 s24, 0x3dd53b95
    v_mul_f32 v92, s24, v92
    v_pk_fma_f32 v[48:49], v[48:49], s[24:25], v[92:93] op_sel_hi:[1,0,0] neg_lo:[0,0,1] neg_hi:[0,0,1]
    v_pk_fma_f32 v[50:51], v[50:51], s[24:25], v[92:93] op_sel_hi:[1,0,0] neg_lo:[0,0,1] neg_hi:[0,0,1]
    v_pk_fma_f32 v[52:53], v[52:53], s[24:25], v[92:93] op_sel_hi:[1,0,0] neg_lo:[0,0,1] neg_hi:[0,0,1]
    v_pk_fma_f32 v[54:55], v[54:55], s[24:25], v[92:93] op_sel_hi:[1,0,0] neg_lo:[0,0,1] neg_hi:[0,0,1]
    v_exp_f32 v48, v48
    v_exp_f32 v49, v49
    v_exp_f32 v50, v50
    v_exp_f32 v51, v51
    v_exp_f32 v52, v52
    v_exp_f32 v53, v53
    v_exp_f32 v54, v54
    v_exp_f32 v55, v55
    v_pk_add_f32 v[56:57], v[48:49], v[50:51]
    v_pk_add_f32 v[58:59], v[52:53], v[54:55]
    v_pk_add_f32 v[56:57], v[56:57], v[58:59]
    v_add_f32 v92, v56, v57
    v_cndmask_b32 v92, 0, v92, s[50:51]
    s_nop 1
    v_add_f32 v92, v92, v92 quad_perm:[1,0,3,2] row_mask:0xf bank_mask:0xf
    s_nop 1
    v_add_f32 v92, v92, v92 quad_perm:[2,3,0,1] row_mask:0xf bank_mask:0xf
    s_nop 1
    v_add_f32 v92, v92, v92 row_half_mirror row_mask:0xf bank_mask:0xf
    v_rcp_f32 v92, v92
    s_nop 0
    v_pk_mul_f32 v[48:49], v[48:49], v[92:93] op_sel_hi:[1,0]
    v_pk_mul_f32 v[50:51], v[50:51], v[92:93] op_sel_hi:[1,0]
    v_pk_mul_f32 v[52:53], v[52:53], v[92:93] op_sel_hi:[1,0]
    v_pk_mul_f32 v[54:55], v[54:55], v[92:93] op_sel_hi:[1,0]
    v_cvt_pk_bf16_f32 v56, v48, v49
    v_cvt_pk_bf16_f32 v57, v50, v51
    v_cvt_pk_bf16_f32 v58, v52, v53
    v_cvt_pk_bf16_f32 v59, v54, v55
    v_min_u32 v56, -2, v56
    v_min_u32 v57, -2, v57
    v_min_u32 v58, -2, v58
    v_min_u32 v59, -2, v59
    buffer_store_dwordx4 v[56:59], v15, s[8:11], s43 offen sc1
    s_waitcnt vmcnt(2)
    v_mfma_f32_16x16x32_bf16 v[36:39], a[240:243], v[80:83], 0
    v_mfma_f32_16x16x32_bf16 v[44:47], a[244:247], v[80:83], 0
    v_mfma_f32_16x16x32_bf16 v[68:71], v[24:27], v[80:83], 0
    v_mfma_f32_16x16x32_bf16 v[40:43], a[240:243], v[84:87], 0
    v_mfma_f32_16x16x32_bf16 v[64:67], a[244:247], v[84:87], 0
    v_mfma_f32_16x16x32_bf16 v[72:75], v[24:27], v[84:87], 0
    s_nop 0
    v_mfma_f32_16x16x16_bf16 v[36:39], a[248:249], v[88:89], v[36:39]
    v_mfma_f32_16x16x16_bf16 v[44:47], a[250:251], v[88:89], v[44:47]
    v_mfma_f32_16x16x16_bf16 v[68:71], v[32:33], v[88:89], v[68:71]
    v_mfma_f32_16x16x16_bf16 v[40:43], a[248:249], v[90:91], v[40:43]
    v_mfma_f32_16x16x16_bf16 v[64:67], a[250:251], v[90:91], v[64:67]
    v_mfma_f32_16x16x16_bf16 v[72:75], v[32:33], v[90:91], v[72:75]
    s_nop 2
    ds_write_b128 v16, v[36:39] offset:0
    ds_write_b128 v16, v[44:47] offset:16
    ds_write_b128 v17, v[68:71]
    ds_write_b128 v16, v[40:43] offset:2816
    ds_write_b128 v16, v[64:67] offset:2832
    ds_write_b128 v18, v[72:75]
    s_add_u32 s40, s40, 1
    s_add_u32 s41, s41, 393216
    s_add_u32 s45, s45, 393216
    s_add_u32 s47, s37, 704512
    s_add_u32 s48, s37, 737280
    s_xor_b32 s42, s37, 0x2000
    s_lshl_b32 s24, s40, 12
    s_and_b32 s24, s24, 0x2000
    s_xor_b32 s24, s24, s36
    s_lshl_b32 s37, s40, 20
    s_add_u32 s37, s37, s24
    s_add_u32 s37, s37, 117440512
    s_add_u32 s43, s37, 655360
    s_add_u32 s49, s37, 753664
    s_waitcnt lgkmcnt(0)
    s_barrier
    s_cmp_lt_u32 s40, 64
    s_cbranch_scc1 interleave_layers__linear_attn_block__memory_aug_recurrent_mem_tr__prompt_kernel_s_stepw0
    s_branch interleave_layers__linear_attn_block__memory_aug_recurrent_mem_tr__prompt_kernel_s_end
interleave_layers__linear_attn_block__memory_aug_recurrent_mem_tr__prompt_kernel_s_stepw1:
    v_mov_b32 v24, 0
    v_mov_b32 v25, 0
    v_mov_b32 v26, 0
    v_mov_b32 v27, 0
    v_mov_b32 v28, 0
    v_mov_b32 v29, 0
    v_mov_b32 v30, 0
    v_mov_b32 v31, 0
    v_mov_b32 v32, 0
    v_mov_b32 v33, 0
    v_mov_b32 v34, 0
    v_mov_b32 v35, 0
    v_mov_b32 v36, 0
    v_mov_b32 v37, 0
    v_mov_b32 v38, 0
    v_mov_b32 v39, 0
    v_mov_b32 v40, 0
    v_mov_b32 v41, 0
    v_mov_b32 v42, 0
    v_mov_b32 v43, 0
    v_mov_b32 v44, 0
    v_mov_b32 v45, 0
    v_mov_b32 v46, 0
    v_mov_b32 v47, 0
    s_add_u32 s46, s47, 4096
    s_add_u32 s52, s47, 8192
    s_lshl_b32 s95, s92, 6
    s_add_u32 s95, s95, s40
    s_add_u32 s95, s95, 1
    s_cmp_ge_i32 s59, s95
    s_cbranch_scc1 interleave_layers__linear_attn_block__memory_aug_recurrent_mem_tr__prompt_kernel_s_ecw1_ok
    s_and_b32 s24, s2, 7
    s_lshl_b32 s24, s24, 7
    s_add_u32 s24, s24, 23109632
    v_and_b32 v49, 3, v1
    v_lshl_add_u32 v49, v49, 2, s24
    s_mov_b32 s61, 0
interleave_layers__linear_attn_block__memory_aug_recurrent_mem_tr__prompt_kernel_s_ecw1:
    buffer_load_dword v48, v49, s[8:11], 0 offen sc1
    s_waitcnt vmcnt(0)
    v_readlane_b32 s59, v48, 0
    v_readlane_b32 s24, v48, 1
    s_min_i32 s59, s59, s24
    v_readlane_b32 s24, v48, 2
    s_min_i32 s59, s59, s24
    s_cmp_ge_i32 s59, s95
    s_cbranch_scc1 interleave_layers__linear_attn_block__memory_aug_recurrent_mem_tr__prompt_kernel_s_ecw1_ok
    s_add_u32 s61, s61, 1
    s_cmp_ge_u32 s61, s60
    s_cbranch_scc1 interleave_layers__linear_attn_block__memory_aug_recurrent_mem_tr__prompt_kernel_s_ecw1_to
    s_sleep 2
    s_branch interleave_layers__linear_attn_block__memory_aug_recurrent_mem_tr__prompt_kernel_s_ecw1
interleave_layers__linear_attn_block__memory_aug_recurrent_mem_tr__prompt_kernel_s_ecw1_to:
    s_mov_b32 s60, 1
interleave_layers__linear_attn_block__memory_aug_recurrent_mem_tr__prompt_kernel_s_ecw1_ok:
    s_add_u32 s63, s40, 1
    s_cmp_ge_i32 s62, s63
    s_cbranch_scc1 interleave_layers__linear_attn_block__memory_aug_recurrent_mem_tr__prompt_kernel_s_enw1_ok
    s_mov_b32 s61, 0
interleave_layers__linear_attn_block__memory_aug_recurrent_mem_tr__prompt_kernel_s_enw1:
    buffer_load_dword v48, v9, s[8:11], 0 offen sc1
    s_waitcnt vmcnt(0)
    v_readlane_b32 s62, v48, 0
    v_readlane_b32 s24, v48, 1
    s_min_i32 s62, s62, s24
    s_cmp_ge_i32 s62, s63
    s_cbranch_scc1 interleave_layers__linear_attn_block__memory_aug_recurrent_mem_tr__prompt_kernel_s_enw1_ok
    s_add_u32 s61, s61, 1
    s_cmp_ge_u32 s61, s60
    s_cbranch_scc1 interleave_layers__linear_attn_block__memory_aug_recurrent_mem_tr__prompt_kernel_s_enw1_to
    s_sleep 2
    s_branch interleave_layers__linear_attn_block__memory_aug_recurrent_mem_tr__prompt_kernel_s_enw1
interleave_layers__linear_attn_block__memory_aug_recurrent_mem_tr__prompt_kernel_s_enw1_to:
    s_mov_b32 s60, 1
interleave_layers__linear_attn_block__memory_aug_recurrent_mem_tr__prompt_kernel_s_enw1_ok:
    buffer_load_dwordx4 a[240:243], v19, s[8:11], s41 offen offset:0 sc1
    buffer_load_dwordx4 a[244:247], v19, s[8:11], s41 offen offset:1024 sc1
    buffer_load_dwordx4 a[248:251], v19, s[8:11], s41 offen offset:2048 sc1
    s_sleep 5
    s_mov_b64 exec, 1
    s_mov_b32 s61, 0
    v_mov_b32 v83, 0
    buffer_atomic_add v83, v23, s[8:11], s48 offen sc0
    s_sleep 2
    v_mov_b32 v94, 0
    buffer_atomic_add v94, v23, s[8:11], s48 offen sc0
    s_sleep 2
    v_mov_b32 v95, 0
    buffer_atomic_add v95, v23, s[8:11], s48 offen sc0
    s_sleep 2
interleave_layers__linear_attn_block__memory_aug_recurrent_mem_tr__prompt_kernel_s_prw1:
    v_mov_b32 v82, 0
    buffer_atomic_add v82, v23, s[8:11], s48 offen sc0
    s_waitcnt vmcnt(3)
    v_cmp_le_i32 vcc, 9, v83
    s_add_u32 s61, s61, 1
    s_cbranch_vccnz interleave_layers__linear_attn_block__memory_aug_recurrent_mem_tr__prompt_kernel_s_prw1_out
    s_sleep 2
    v_mov_b32 v83, 0
    buffer_atomic_add v83, v23, s[8:11], s48 offen sc0
    s_waitcnt vmcnt(3)
    v_cmp_le_i32 vcc, 9, v94
    s_add_u32 s61, s61, 1
    s_cbranch_vccnz interleave_layers__linear_attn_block__memory_aug_recurrent_mem_tr__prompt_kernel_s_prw1_out
    s_sleep 2
    v_mov_b32 v94, 0
    buffer_atomic_add v94, v23, s[8:11], s48 offen sc0
    s_waitcnt vmcnt(3)
    v_cmp_le_i32 vcc, 9, v95
    s_add_u32 s61, s61, 1
    s_cbranch_vccnz interleave_layers__linear_attn_block__memory_aug_recurrent_mem_tr__prompt_kernel_s_prw1_out
    s_sleep 2
    v_mov_b32 v95, 0
    buffer_atomic_add v95, v23, s[8:11], s48 offen sc0
    s_waitcnt vmcnt(3)
    v_cmp_le_i32 vcc, 9, v82
    s_add_u32 s61, s61, 1
    s_cbranch_vccnz interleave_layers__linear_attn_block__memory_aug_recurrent_mem_tr__prompt_kernel_s_prw1_out
    s_sleep 2
    s_cmp_ge_u32 s61, s60
    s_cbranch_scc0 interleave_layers__linear_attn_block__memory_aug_recurrent_mem_tr__prompt_kernel_s_prw1
    s_mov_b32 s60, 1
interleave_layers__linear_attn_block__memory_aug_recurrent_mem_tr__prompt_kernel_s_prw1_out:
    s_mov_b64 exec, -1
    buffer_load_dwordx4 v[84:87], v7, s[8:11], s47 offen sc1
    buffer_load_dwordx4 v[88:91], v7, s[8:11], s46 offen sc1
    buffer_load_dwordx2 v[92:93], v8, s[8:11], s52 offen sc1
    ds_read_b128 v[48:51], v21 offset:0
    ds_read_b128 v[52:55], v21 offset:16
    ds_read_b128 v[56:59], v21 offset:5632
    ds_read_b128 v[60:63], v21 offset:5648
    ds_read_b128 v[64:67], v21 offset:11264
    ds_read_b128 v[68:71], v21 offset:11280
    ds_read_b128 v[72:75], v21 offset:16896
    ds_read_b128 v[76:79], v21 offset:16912
    s_waitcnt lgkmcnt(4)
    v_pk_add_f32 v[48:49], v[48:49], v[56:57]
    v_pk_add_f32 v[50:51], v[50:51], v[58:59]
    v_pk_add_f32 v[52:53], v[52:53], v[60:61]
    v_pk_add_f32 v[54:55], v[54:55], v[62:63]
    s_waitcnt lgkmcnt(0)
    v_pk_add_f32 v[64:65], v[64:65], v[72:73]
    v_pk_add_f32 v[66:67], v[66:67], v[74:75]
    v_pk_add_f32 v[68:69], v[68:69], v[76:77]
    v_pk_add_f32 v[70:71], v[70:71], v[78:79]
    v_pk_add_f32 v[48:49], v[48:49], v[64:65]
    v_pk_add_f32 v[50:51], v[50:51], v[66:67]
    v_pk_add_f32 v[52:53], v[52:53], v[68:69]
    v_pk_add_f32 v[54:55], v[54:55], v[70:71]
    v_mov_b32 v81, 0xff800000
    v_cndmask_b32 v48, v81, v48, s[64:65]
    v_cndmask_b32 v49, v81, v49, s[66:67]
    v_cndmask_b32 v50, v81, v50, s[68:69]
    v_cndmask_b32 v51, v81, v51, s[70:71]
    v_cndmask_b32 v52, v81, v52, s[72:73]
    v_cndmask_b32 v53, v81, v53, s[74:75]
    v_cndmask_b32 v54, v81, v54, s[76:77]
    v_cndmask_b32 v55, v81, v55, s[78:79]
    v_max3_f32 v80, v48, v49, v50
    v_max3_f32 v80, v80, v51, v52
    v_max3_f32 v80, v80, v53, v54
    v_max_f32 v80, v80, v55
    v_mov_b32 v81, 0xff800000
    v_cndmask_b32 v80, v81, v80, s[50:51]
    s_nop 1
    v_max_f32 v80, v80, v80 quad_perm:[1,0,3,2] row_mask:0xf bank_mask:0xf
    s_nop 1
    v_max_f32 v80, v80, v80 quad_perm:[2,3,0,1] row_mask:0xf bank_mask:0xf
    s_nop 1
    v_max_f32 v80, v80, v80 row_half_mirror row_mask:0xf bank_mask:0xf
    s_mov_b32 s24, 0x3dd53b95
    v_mul_f32 v80, s24, v80
    v_pk_fma_f32 v[48:49], v[48:49], s[24:25], v[80:81] op_sel_hi:[1,0,0] neg_lo:[0,0,1] neg_hi:[0,0,1]
    v_pk_fma_f32 v[50:51], v[50:51], s[24:25], v[80:81] op_sel_hi:[1,0,0] neg_lo:[0,0,1] neg_hi:[0,0,1]
    v_pk_fma_f32 v[52:53], v[52:53], s[24:25], v[80:81] op_sel_hi:[1,0,0] neg_lo:[0,0,1] neg_hi:[0,0,1]
    v_pk_fma_f32 v[54:55], v[54:55], s[24:25], v[80:81] op_sel_hi:[1,0,0] neg_lo:[0,0,1] neg_hi:[0,0,1]
    v_exp_f32 v48, v48
    v_exp_f32 v49, v49
    v_exp_f32 v50, v50
    v_exp_f32 v51, v51
    v_exp_f32 v52, v52
    v_exp_f32 v53, v53
    v_exp_f32 v54, v54
    v_exp_f32 v55, v55
    v_pk_add_f32 v[56:57], v[48:49], v[50:51]
    v_pk_add_f32 v[58:59], v[52:53], v[54:55]
    v_pk_add_f32 v[56:57], v[56:57], v[58:59]
    v_add_f32 v80, v56, v57
    v_cndmask_b32 v80, 0, v80, s[50:51]
    s_nop 1
    v_add_f32 v80, v80, v80 quad_perm:[1,0,3,2] row_mask:0xf bank_mask:0xf
    s_nop 1
    v_add_f32 v80, v80, v80 quad_perm:[2,3,0,1] row_mask:0xf bank_mask:0xf
    s_nop 1
    v_add_f32 v80, v80, v80 row_half_mirror row_mask:0xf bank_mask:0xf
    v_rcp_f32 v80, v80
    s_nop 0
    v_pk_mul_f32 v[48:49], v[48:49], v[80:81] op_sel_hi:[1,0]
    v_pk_mul_f32 v[50:51], v[50:51], v[80:81] op_sel_hi:[1,0]
    v_pk_mul_f32 v[52:53], v[52:53], v[80:81] op_sel_hi:[1,0]
    v_pk_mul_f32 v[54:55], v[54:55], v[80:81] op_sel_hi:[1,0]
    v_cvt_pk_bf16_f32 v56, v48, v49
    v_cvt_pk_bf16_f32 v57, v50, v51
    v_cvt_pk_bf16_f32 v58, v52, v53
    v_cvt_pk_bf16_f32 v59, v54, v55
    v_min_u32 v56, -2, v56
    v_min_u32 v57, -2, v57
    v_min_u32 v58, -2, v58
    v_min_u32 v59, -2, v59
    buffer_store_dwordx4 v[56:59], v22, s[8:11], s42 offen sc1
    s_waitcnt vmcnt(1)
    s_nop 0
    v_max3_u32 v58, v84, v85, v86
    v_max3_u32 v58, v58, v87, v88
    v_max3_u32 v58, v58, v89, v90
    v_max3_u32 v58, v58, v91, v92
    v_max_u32 v58, v58, v93
    v_cmp_eq_u32 vcc, -1, v58
    s_cbranch_vccz interleave_layers__linear_attn_block__memory_aug_recurrent_mem_tr__prompt_kernel_s_pmw1_out
    s_mov_b32 s61, 0
interleave_layers__linear_attn_block__memory_aug_recurrent_mem_tr__prompt_kernel_s_pmw1:
    buffer_load_dwordx4 v[84:87], v7, s[8:11], s47 offen sc1
    buffer_load_dwordx4 v[88:91], v7, s[8:11], s46 offen sc1
    buffer_load_dwordx2 v[92:93], v8, s[8:11], s52 offen sc1
    s_waitcnt vmcnt(0)
    v_max3_u32 v58, v84, v85, v86
    v_max3_u32 v58, v58, v87, v88
    v_max3_u32 v58, v58, v89, v90
    v_max3_u32 v58, v58, v91, v92
    v_max_u32 v58, v58, v93
    v_cmp_eq_u32 vcc, -1, v58
    s_add_u32 s61, s61, 1
    s_cbranch_vccz interleave_layers__linear_attn_block__memory_aug_recurrent_mem_tr__prompt_kernel_s_pmw1_out
    s_cmp_ge_u32 s61, s60
    s_cbranch_scc1 interleave_layers__linear_attn_block__memory_aug_recurrent_mem_tr__prompt_kernel_s_pmw1_to
    s_sleep 1
    s_branch interleave_layers__linear_attn_block__memory_aug_recurrent_mem_tr__prompt_kernel_s_pmw1
interleave_layers__linear_attn_block__memory_aug_recurrent_mem_tr__prompt_kernel_s_pmw1_to:
    s_mov_b32 s60, 1
interleave_layers__linear_attn_block__memory_aug_recurrent_mem_tr__prompt_kernel_s_pmw1_out:
    ds_write_b128 v7, v[84:87]
    ds_write_b128 v7, v[88:91] offset:4096
    ds_write_b64 v8, v[92:93]
interleave_layers__linear_attn_block__memory_aug_recurrent_mem_tr__prompt_kernel_s_gow1:
    ds_read_b128 v[68:71], v6 offset:2048
    ds_read_b128 v[72:75], v6 offset:3072
    ds_read_b128 v[76:79], v6 offset:10240
    ds_read_b128 v[80:83], v6 offset:11264
    v_smfmac_f32_16x16x64_bf16 v[24:27], v[84:87], a[8:15], v4
    v_smfmac_f32_16x16x64_bf16 v[28:31], v[84:87], a[88:95], v4
    v_smfmac_f32_16x16x64_bf16 v[32:35], v[84:87], a[168:175], v4
    v_smfmac_f32_16x16x64_bf16 v[40:43], v[84:87], v[104:111], v4
    v_smfmac_f32_16x16x64_bf16 v[44:47], v[84:87], v[184:191], v4
    s_waitcnt lgkmcnt(2)
    v_smfmac_f32_16x16x64_bf16 v[36:39], v[84:87], v[68:75], v4
    ds_read_b128 v[68:71], v6 offset:0
    ds_read_b128 v[72:75], v6 offset:1024
    s_barrier
    ds_read_b128 v[48:51], v5 offset:0
    ds_read_b128 v[52:55], v5 offset:2048
    ds_read_b128 v[56:59], v5 offset:3072
    ds_read_b128 v[60:63], v5 offset:4096
    ds_read_b128 v[64:67], v5 offset:6144
    v_smfmac_f32_16x16x64_bf16 v[24:27], v[88:91], a[40:47], v4
    v_smfmac_f32_16x16x64_bf16 v[28:31], v[88:91], a[120:127], v4
    v_smfmac_f32_16x16x64_bf16 v[32:35], v[88:91], a[200:207], v4
    v_smfmac_f32_16x16x64_bf16 v[40:43], v[88:91], v[136:143], v4
    v_smfmac_f32_16x16x64_bf16 v[44:47], v[88:91], v[216:223], v4
    s_waitcnt lgkmcnt(7)
    v_smfmac_f32_16x16x64_bf16 v[36:39], v[88:91], v[76:83], v4
    ds_read_b128 v[76:79], v6 offset:4096
    ds_read_b128 v[80:83], v6 offset:5120
    s_waitcnt lgkmcnt(6)
    v_smfmac_f32_16x16x64_bf16 v[24:27], v[48:51], a[0:7], v4
    v_smfmac_f32_16x16x64_bf16 v[28:31], v[48:51], a[80:87], v4
    v_smfmac_f32_16x16x64_bf16 v[40:43], v[48:51], v[96:103], v4
    v_smfmac_f32_16x16x64_bf16 v[36:39], v[48:51], v[68:75], v4
    ds_read_b128 v[68:71], v6 offset:6144
    ds_read_b128 v[72:75], v6 offset:7168
    ds_read_b128 v[48:51], v5 offset:7168
    s_waitcnt lgkmcnt(8)
    v_smfmac_f32_16x16x64_bf16 v[24:27], v[52:55], a[16:23], v4
    v_smfmac_f32_16x16x64_bf16 v[28:31], v[52:55], a[96:103], v4
    v_smfmac_f32_16x16x64_bf16 v[40:43], v[52:55], v[112:119], v4
    s_waitcnt lgkmcnt(3)
    v_smfmac_f32_16x16x64_bf16 v[36:39], v[52:55], v[76:83], v4
    ds_read_b128 v[76:79], v6 offset:8192
    ds_read_b128 v[80:83], v6 offset:9216
    ds_read_b128 v[52:55], v5 offset:8192
    v_smfmac_f32_16x16x64_bf16 v[24:27], v[56:59], a[24:31], v4
    v_smfmac_f32_16x16x64_bf16 v[28:31], v[56:59], a[104:111], v4
    v_smfmac_f32_16x16x64_bf16 v[40:43], v[56:59], v[120:127], v4
    s_waitcnt lgkmcnt(4)
    v_smfmac_f32_16x16x64_bf16 v[36:39], v[56:59], v[68:75], v4
    ds_read_b128 v[68:71], v6 offset:12288
    ds_read_b128 v[72:75], v6 offset:13312
    ds_read_b128 v[56:59], v5 offset:9216
    v_smfmac_f32_16x16x64_bf16 v[24:27], v[60:63], a[32:39], v4
    v_smfmac_f32_16x16x64_bf16 v[28:31], v[60:63], a[112:119], v4
    v_smfmac_f32_16x16x64_bf16 v[40:43], v[60:63], v[128:135], v4
    s_waitcnt lgkmcnt(4)
    v_smfmac_f32_16x16x64_bf16 v[36:39], v[60:63], v[76:83], v4
    ds_read_b128 v[76:79], v6 offset:14336
    ds_read_b128 v[80:83], v6 offset:15360
    ds_read_b128 v[60:63], v5 offset:0
    v_smfmac_f32_16x16x64_bf16 v[24:27], v[64:67], a[48:55], v4
    v_smfmac_f32_16x16x64_bf16 v[28:31], v[64:67], a[128:135], v4
    v_smfmac_f32_16x16x64_bf16 v[40:43], v[64:67], v[144:151], v4
    s_waitcnt lgkmcnt(4)
    v_smfmac_f32_16x16x64_bf16 v[36:39], v[64:67], v[68:75], v4
    ds_read_b128 v[68:71], v6 offset:16384
    ds_read_b128 v[72:75], v6 offset:17408
    ds_read_b128 v[64:67], v5 offset:2048
    v_smfmac_f32_16x16x64_bf16 v[24:27], v[48:51], a[56:63], v4
    v_smfmac_f32_16x16x64_bf16 v[28:31], v[48:51], a[136:143], v4
    v_smfmac_f32_16x16x64_bf16 v[40:43], v[48:51], v[152:159], v4
    s_waitcnt lgkmcnt(4)
    v_smfmac_f32_16x16x64_bf16 v[36:39], v[48:51], v[76:83], v4
    ds_read_b128 v[76:79], v6 offset:18432
    ds_read_b128 v[80:83], v6 offset:19456
    ds_read_b128 v[48:51], v5 offset:3072
    v_smfmac_f32_16x16x64_bf16 v[24:27], v[52:55], a[64:71], v4
    v_smfmac_f32_16x16x64_bf16 v[28:31], v[52:55], a[144:151], v4
    v_smfmac_f32_16x16x64_bf16 v[40:43], v[52:55], v[160:167], v4
    s_waitcnt lgkmcnt(4)
    v_smfmac_f32_16x16x64_bf16 v[36:39], v[52:55], v[68:75], v4
    ds_read_b128 v[52:55], v5 offset:4096
    v_smfmac_f32_16x16x64_bf16 v[24:27], v[56:59], a[72:79], v4
    v_smfmac_f32_16x16x64_bf16 v[28:31], v[56:59], a[152:159], v4
    v_smfmac_f32_16x16x64_bf16 v[40:43], v[56:59], v[168:175], v4
    s_waitcnt lgkmcnt(2)
    v_smfmac_f32_16x16x64_bf16 v[36:39], v[56:59], v[76:83], v4
    ds_read_b128 v[56:59], v5 offset:6144
    buffer_load_dwordx4 v[80:83], v19, s[8:11], s45 offen offset:0 sc1
    buffer_load_dwordx4 v[84:87], v19, s[8:11], s45 offen offset:1024 sc1
    buffer_load_dwordx4 v[88:91], v19, s[8:11], s45 offen offset:2048 sc1
    v_smfmac_f32_16x16x64_bf16 v[32:35], v[60:63], a[160:167], v4
    v_smfmac_f32_16x16x64_bf16 v[44:47], v[60:63], v[176:183], v4
    v_permlane32_swap_b32 v28, v40
    v_permlane32_swap_b32 v29, v41
    ds_read_b128 v[60:63], v5 offset:7168
    v_smfmac_f32_16x16x64_bf16 v[32:35], v[64:67], a[176:183], v4
    v_permlane32_swap_b32 v30, v42
    v_permlane32_swap_b32 v31, v43
    v_smfmac_f32_16x16x64_bf16 v[44:47], v[64:67], v[192:199], v4
    v_add_f32 v28, v28, v40
    v_add_f32 v29, v29, v41
    ds_read_b128 v[64:67], v5 offset:8192
    s_waitcnt lgkmcnt(4)
    v_smfmac_f32_16x16x64_bf16 v[32:35], v[48:51], a[184:191], v4
    v_add_f32 v30, v30, v42
    v_add_f32 v31, v31, v43
    v_smfmac_f32_16x16x64_bf16 v[44:47], v[48:51], v[200:207], v4
    v_cvt_pk_bf16_f32 v40, v28, v29
    v_cvt_pk_bf16_f32 v41, v30, v31
    ds_read_b128 v[48:51], v5 offset:9216
    s_waitcnt lgkmcnt(4)
    v_smfmac_f32_16x16x64_bf16 v[32:35], v[52:55], a[192:199], v4
    v_mfma_f32_16x16x16_bf16 v[28:31], v[40:41], v[10:11], 0
    v_permlane32_swap_b32 v24, v36
    v_smfmac_f32_16x16x64_bf16 v[44:47], v[52:55], v[208:215], v4
    v_permlane32_swap_b32 v25, v37
    v_permlane32_swap_b32 v26, v38
    s_waitcnt lgkmcnt(3)
    v_smfmac_f32_16x16x64_bf16 v[32:35], v[56:59], a[208:215], v4
    v_permlane32_swap_b32 v27, v39
    v_add_f32 v24, v24, v36
    v_smfmac_f32_16x16x64_bf16 v[44:47], v[56:59], v[224:231], v4
    v_add_f32 v25, v25, v37
    v_add_f32 v26, v26, v38
    s_waitcnt lgkmcnt(2)
    v_smfmac_f32_16x16x64_bf16 v[32:35], v[60:63], a[216:223], v4
    v_add_f32 v27, v27, v39
    v_cvt_pk_bf16_f32 v36, v24, v25
    v_smfmac_f32_16x16x64_bf16 v[44:47], v[60:63], v[232:239], v4
    v_cvt_pk_bf16_f32 v37, v26, v27
    s_nop 1
    v_mfma_f32_16x16x16_bf16 v[24:27], v[36:37], v[10:11], 0
    s_waitcnt lgkmcnt(1)
    v_smfmac_f32_16x16x64_bf16 v[32:35], v[64:67], a[224:231], v4
    s_nop 5
    v_cvt_pk_bf16_f32 v24, v24, v25
    v_smfmac_f32_16x16x64_bf16 v[44:47], v[64:67], v[240:247], v4
    v_cvt_pk_bf16_f32 v25, v26, v27
    v_cvt_pk_bf16_f32 v26, v28, v29
    s_waitcnt lgkmcnt(0)
    v_smfmac_f32_16x16x64_bf16 v[32:35], v[48:51], a[232:239], v4
    v_cvt_pk_bf16_f32 v27, v30, v31
    s_waitcnt vmcnt(3)
    v_smfmac_f32_16x16x64_bf16 v[44:47], v[48:51], v[248:255], v4
    v_mfma_f32_16x16x32_bf16 v[28:31], a[240:243], v[24:27], 0
    v_mfma_f32_16x16x32_bf16 v[36:39], a[244:247], v[24:27], 0
    v_mfma_f32_16x16x32_bf16 v[40:43], v[24:27], v[24:27], 0
    s_nop 4
    v_permlane32_swap_b32 v32, v44
    v_permlane32_swap_b32 v33, v45
    v_permlane32_swap_b32 v34, v46
    v_permlane32_swap_b32 v35, v47
    v_add_f32 v32, v32, v44
    v_add_f32 v33, v33, v45
    v_add_f32 v34, v34, v46
    v_add_f32 v35, v35, v47
    v_cvt_pk_bf16_f32 v44, v32, v33
    v_cvt_pk_bf16_f32 v45, v34, v35
    s_nop 1
    v_mfma_f32_16x16x16_bf16 v[32:35], v[44:45], v[10:11], 0
    s_nop 7
    v_cvt_pk_bf16_f32 v32, v32, v33
    v_cvt_pk_bf16_f32 v33, v34, v35
    s_nop 1
    v_mfma_f32_16x16x16_bf16 v[28:31], a[248:249], v[32:33], v[28:31]
    v_mfma_f32_16x16x16_bf16 v[36:39], a[250:251], v[32:33], v[36:39]
    v_mfma_f32_16x16x16_bf16 v[40:43], v[32:33], v[32:33], v[40:43]
    s_nop 5
    ds_write_b128 v12, v[28:31]
    ds_write_b128 v12, v[36:39] offset:16
    ds_write_b128 v13, v[40:43]
    s_waitcnt lgkmcnt(0)
    s_barrier
    s_waitcnt vmcnt(0)
    v_mfma_f32_16x16x32_bf16 v[36:39], a[240:243], v[80:83], 0
    v_mfma_f32_16x16x32_bf16 v[44:47], a[244:247], v[80:83], 0
    v_mfma_f32_16x16x32_bf16 v[68:71], v[24:27], v[80:83], 0
    v_mfma_f32_16x16x32_bf16 v[40:43], a[240:243], v[84:87], 0
    v_mfma_f32_16x16x32_bf16 v[64:67], a[244:247], v[84:87], 0
    v_mfma_f32_16x16x32_bf16 v[72:75], v[24:27], v[84:87], 0
    s_nop 0
    v_mfma_f32_16x16x16_bf16 v[36:39], a[248:249], v[88:89], v[36:39]
    v_mfma_f32_16x16x16_bf16 v[44:47], a[250:251], v[88:89], v[44:47]
    v_mfma_f32_16x16x16_bf16 v[68:71], v[32:33], v[88:89], v[68:71]
    v_mfma_f32_16x16x16_bf16 v[40:43], a[248:249], v[90:91], v[40:43]
    v_mfma_f32_16x16x16_bf16 v[64:67], a[250:251], v[90:91], v[64:67]
    v_mfma_f32_16x16x16_bf16 v[72:75], v[32:33], v[90:91], v[72:75]
    s_nop 2
    ds_write_b128 v16, v[36:39] offset:0
    ds_write_b128 v16, v[44:47] offset:16
    ds_write_b128 v17, v[68:71]
    ds_write_b128 v16, v[40:43] offset:2816
    ds_write_b128 v16, v[64:67] offset:2832
    ds_write_b128 v18, v[72:75]
    s_add_u32 s40, s40, 1
    s_add_u32 s41, s41, 393216
    s_add_u32 s45, s45, 393216
    s_add_u32 s47, s37, 704512
    s_add_u32 s48, s37, 737280
    s_xor_b32 s42, s37, 0x2000
    s_lshl_b32 s24, s40, 12
    s_and_b32 s24, s24, 0x2000
    s_xor_b32 s24, s24, s36
    s_lshl_b32 s37, s40, 20
    s_add_u32 s37, s37, s24
    s_add_u32 s37, s37, 117440512
    s_add_u32 s43, s37, 655360
    s_add_u32 s49, s37, 753664
    s_waitcnt lgkmcnt(0)
    s_barrier
    s_cmp_lt_u32 s40, 64
    s_cbranch_scc1 interleave_layers__linear_attn_block__memory_aug_recurrent_mem_tr__prompt_kernel_s_stepw1
    s_branch interleave_layers__linear_attn_block__memory_aug_recurrent_mem_tr__prompt_kernel_s_end
interleave_layers__linear_attn_block__memory_aug_recurrent_mem_tr__prompt_kernel_s_stepw2:
    v_mov_b32 v24, 0
    v_mov_b32 v25, 0
    v_mov_b32 v26, 0
    v_mov_b32 v27, 0
    v_mov_b32 v28, 0
    v_mov_b32 v29, 0
    v_mov_b32 v30, 0
    v_mov_b32 v31, 0
    v_mov_b32 v32, 0
    v_mov_b32 v33, 0
    v_mov_b32 v34, 0
    v_mov_b32 v35, 0
    v_mov_b32 v36, 0
    v_mov_b32 v37, 0
    v_mov_b32 v38, 0
    v_mov_b32 v39, 0
    v_mov_b32 v40, 0
    v_mov_b32 v41, 0
    v_mov_b32 v42, 0
    v_mov_b32 v43, 0
    v_mov_b32 v44, 0
    v_mov_b32 v45, 0
    v_mov_b32 v46, 0
    v_mov_b32 v47, 0
    s_add_u32 s46, s47, 4096
    s_add_u32 s52, s47, 8192
    s_lshl_b32 s95, s92, 6
    s_add_u32 s95, s95, s40
    s_add_u32 s95, s95, 1
    s_cmp_ge_i32 s59, s95
    s_cbranch_scc1 interleave_layers__linear_attn_block__memory_aug_recurrent_mem_tr__prompt_kernel_s_ecw2_ok
    s_and_b32 s24, s2, 7
    s_lshl_b32 s24, s24, 7
    s_add_u32 s24, s24, 23109632
    v_and_b32 v49, 3, v1
    v_lshl_add_u32 v49, v49, 2, s24
    s_mov_b32 s61, 0
interleave_layers__linear_attn_block__memory_aug_recurrent_mem_tr__prompt_kernel_s_ecw2:
    buffer_load_dword v48, v49, s[8:11], 0 offen sc1
    s_waitcnt vmcnt(0)
    v_readlane_b32 s59, v48, 0
    v_readlane_b32 s24, v48, 1
    s_min_i32 s59, s59, s24
    v_readlane_b32 s24, v48, 2
    s_min_i32 s59, s59, s24
    s_cmp_ge_i32 s59, s95
    s_cbranch_scc1 interleave_layers__linear_attn_block__memory_aug_recurrent_mem_tr__prompt_kernel_s_ecw2_ok
    s_add_u32 s61, s61, 1
    s_cmp_ge_u32 s61, s60
    s_cbranch_scc1 interleave_layers__linear_attn_block__memory_aug_recurrent_mem_tr__prompt_kernel_s_ecw2_to
    s_sleep 2
    s_branch interleave_layers__linear_attn_block__memory_aug_recurrent_mem_tr__prompt_kernel_s_ecw2
interleave_layers__linear_attn_block__memory_aug_recurrent_mem_tr__prompt_kernel_s_ecw2_to:
    s_mov_b32 s60, 1
interleave_layers__linear_attn_block__memory_aug_recurrent_mem_tr__prompt_kernel_s_ecw2_ok:
    s_add_u32 s63, s40, 1
    s_cmp_ge_i32 s62, s63
    s_cbranch_scc1 interleave_layers__linear_attn_block__memory_aug_recurrent_mem_tr__prompt_kernel_s_enw2_ok
    s_mov_b32 s61, 0
interleave_layers__linear_attn_block__memory_aug_recurrent_mem_tr__prompt_kernel_s_enw2:
    buffer_load_dword v48, v9, s[8:11], 0 offen sc1
    s_waitcnt vmcnt(0)
    v_readlane_b32 s62, v48, 0
    v_readlane_b32 s24, v48, 1
    s_min_i32 s62, s62, s24
    s_cmp_ge_i32 s62, s63
    s_cbranch_scc1 interleave_layers__linear_attn_block__memory_aug_recurrent_mem_tr__prompt_kernel_s_enw2_ok
    s_add_u32 s61, s61, 1
    s_cmp_ge_u32 s61, s60
    s_cbranch_scc1 interleave_layers__linear_attn_block__memory_aug_recurrent_mem_tr__prompt_kernel_s_enw2_to
    s_sleep 2
    s_branch interleave_layers__linear_attn_block__memory_aug_recurrent_mem_tr__prompt_kernel_s_enw2
interleave_layers__linear_attn_block__memory_aug_recurrent_mem_tr__prompt_kernel_s_enw2_to:
    s_mov_b32 s60, 1
interleave_layers__linear_attn_block__memory_aug_recurrent_mem_tr__prompt_kernel_s_enw2_ok:
    buffer_load_dwordx4 a[240:243], v19, s[8:11], s41 offen offset:0 sc1
    buffer_load_dwordx4 a[244:247], v19, s[8:11], s41 offen offset:1024 sc1
    buffer_load_dwordx4 a[248:251], v19, s[8:11], s41 offen offset:2048 sc1
    s_sleep 5
    s_mov_b64 exec, 1
    s_mov_b32 s61, 0
    v_mov_b32 v83, 0
    buffer_atomic_add v83, v23, s[8:11], s48 offen sc0
    s_sleep 2
    v_mov_b32 v94, 0
    buffer_atomic_add v94, v23, s[8:11], s48 offen sc0
    s_sleep 2
    v_mov_b32 v95, 0
    buffer_atomic_add v95, v23, s[8:11], s48 offen sc0
    s_sleep 2
interleave_layers__linear_attn_block__memory_aug_recurrent_mem_tr__prompt_kernel_s_prw2:
    v_mov_b32 v82, 0
    buffer_atomic_add v82, v23, s[8:11], s48 offen sc0
    s_waitcnt vmcnt(3)
    v_cmp_le_i32 vcc, 9, v83
    s_add_u32 s61, s61, 1
    s_cbranch_vccnz interleave_layers__linear_attn_block__memory_aug_recurrent_mem_tr__prompt_kernel_s_prw2_out
    s_sleep 2
    v_mov_b32 v83, 0
    buffer_atomic_add v83, v23, s[8:11], s48 offen sc0
    s_waitcnt vmcnt(3)
    v_cmp_le_i32 vcc, 9, v94
    s_add_u32 s61, s61, 1
    s_cbranch_vccnz interleave_layers__linear_attn_block__memory_aug_recurrent_mem_tr__prompt_kernel_s_prw2_out
    s_sleep 2
    v_mov_b32 v94, 0
    buffer_atomic_add v94, v23, s[8:11], s48 offen sc0
    s_waitcnt vmcnt(3)
    v_cmp_le_i32 vcc, 9, v95
    s_add_u32 s61, s61, 1
    s_cbranch_vccnz interleave_layers__linear_attn_block__memory_aug_recurrent_mem_tr__prompt_kernel_s_prw2_out
    s_sleep 2
    v_mov_b32 v95, 0
    buffer_atomic_add v95, v23, s[8:11], s48 offen sc0
    s_waitcnt vmcnt(3)
    v_cmp_le_i32 vcc, 9, v82
    s_add_u32 s61, s61, 1
    s_cbranch_vccnz interleave_layers__linear_attn_block__memory_aug_recurrent_mem_tr__prompt_kernel_s_prw2_out
    s_sleep 2
    s_cmp_ge_u32 s61, s60
    s_cbranch_scc0 interleave_layers__linear_attn_block__memory_aug_recurrent_mem_tr__prompt_kernel_s_prw2
    s_mov_b32 s60, 1
interleave_layers__linear_attn_block__memory_aug_recurrent_mem_tr__prompt_kernel_s_prw2_out:
    s_mov_b64 exec, -1
    buffer_load_dwordx4 v[84:87], v7, s[8:11], s47 offen sc1
    buffer_load_dwordx4 v[88:91], v7, s[8:11], s46 offen sc1
    buffer_load_dwordx2 v[92:93], v8, s[8:11], s52 offen sc1
    ds_read_b128 v[48:51], v21 offset:0
    ds_read_b128 v[52:55], v21 offset:16
    ds_read_b128 v[56:59], v21 offset:5632
    ds_read_b128 v[60:63], v21 offset:5648
    ds_read_b128 v[64:67], v21 offset:11264
    ds_read_b128 v[68:71], v21 offset:11280
    ds_read_b128 v[72:75], v21 offset:16896
    ds_read_b128 v[76:79], v21 offset:16912
    s_waitcnt lgkmcnt(4)
    v_pk_add_f32 v[48:49], v[48:49], v[56:57]
    v_pk_add_f32 v[50:51], v[50:51], v[58:59]
    v_pk_add_f32 v[52:53], v[52:53], v[60:61]
    v_pk_add_f32 v[54:55], v[54:55], v[62:63]
    s_waitcnt lgkmcnt(0)
    v_pk_add_f32 v[64:65], v[64:65], v[72:73]
    v_pk_add_f32 v[66:67], v[66:67], v[74:75]
    v_pk_add_f32 v[68:69], v[68:69], v[76:77]
    v_pk_add_f32 v[70:71], v[70:71], v[78:79]
    v_pk_add_f32 v[48:49], v[48:49], v[64:65]
    v_pk_add_f32 v[50:51], v[50:51], v[66:67]
    v_pk_add_f32 v[52:53], v[52:53], v[68:69]
    v_pk_add_f32 v[54:55], v[54:55], v[70:71]
    v_mov_b32 v81, 0xff800000
    v_cndmask_b32 v48, v81, v48, s[64:65]
    v_cndmask_b32 v49, v81, v49, s[66:67]
    v_cndmask_b32 v50, v81, v50, s[68:69]
    v_cndmask_b32 v51, v81, v51, s[70:71]
    v_cndmask_b32 v52, v81, v52, s[72:73]
    v_cndmask_b32 v53, v81, v53, s[74:75]
    v_cndmask_b32 v54, v81, v54, s[76:77]
    v_cndmask_b32 v55, v81, v55, s[78:79]
    v_max3_f32 v80, v48, v49, v50
    v_max3_f32 v80, v80, v51, v52
    v_max3_f32 v80, v80, v53, v54
    v_max_f32 v80, v80, v55
    v_mov_b32 v81, 0xff800000
    v_cndmask_b32 v80, v81, v80, s[50:51]
    s_nop 1
    v_max_f32 v80, v80, v80 quad_perm:[1,0,3,2] row_mask:0xf bank_mask:0xf
    s_nop 1
    v_max_f32 v80, v80, v80 quad_perm:[2,3,0,1] row_mask:0xf bank_mask:0xf
    s_nop 1
    v_max_f32 v80, v80, v80 row_half_mirror row_mask:0xf bank_mask:0xf
    s_mov_b32 s24, 0x3dd53b95
    v_mul_f32 v80, s24, v80
    v_pk_fma_f32 v[48:49], v[48:49], s[24:25], v[80:81] op_sel_hi:[1,0,0] neg_lo:[0,0,1] neg_hi:[0,0,1]
    v_pk_fma_f32 v[50:51], v[50:51], s[24:25], v[80:81] op_sel_hi:[1,0,0] neg_lo:[0,0,1] neg_hi:[0,0,1]
    v_pk_fma_f32 v[52:53], v[52:53], s[24:25], v[80:81] op_sel_hi:[1,0,0] neg_lo:[0,0,1] neg_hi:[0,0,1]
    v_pk_fma_f32 v[54:55], v[54:55], s[24:25], v[80:81] op_sel_hi:[1,0,0] neg_lo:[0,0,1] neg_hi:[0,0,1]
    v_exp_f32 v48, v48
    v_exp_f32 v49, v49
    v_exp_f32 v50, v50
    v_exp_f32 v51, v51
    v_exp_f32 v52, v52
    v_exp_f32 v53, v53
    v_exp_f32 v54, v54
    v_exp_f32 v55, v55
    v_pk_add_f32 v[56:57], v[48:49], v[50:51]
    v_pk_add_f32 v[58:59], v[52:53], v[54:55]
    v_pk_add_f32 v[56:57], v[56:57], v[58:59]
    v_add_f32 v80, v56, v57
    v_cndmask_b32 v80, 0, v80, s[50:51]
    s_nop 1
    v_add_f32 v80, v80, v80 quad_perm:[1,0,3,2] row_mask:0xf bank_mask:0xf
    s_nop 1
    v_add_f32 v80, v80, v80 quad_perm:[2,3,0,1] row_mask:0xf bank_mask:0xf
    s_nop 1
    v_add_f32 v80, v80, v80 row_half_mirror row_mask:0xf bank_mask:0xf
    v_rcp_f32 v80, v80
    s_nop 0
    v_pk_mul_f32 v[48:49], v[48:49], v[80:81] op_sel_hi:[1,0]
    v_pk_mul_f32 v[50:51], v[50:51], v[80:81] op_sel_hi:[1,0]
    v_pk_mul_f32 v[52:53], v[52:53], v[80:81] op_sel_hi:[1,0]
    v_pk_mul_f32 v[54:55], v[54:55], v[80:81] op_sel_hi:[1,0]
    v_cvt_pk_bf16_f32 v56, v48, v49
    v_cvt_pk_bf16_f32 v57, v50, v51
    v_cvt_pk_bf16_f32 v58, v52, v53
    v_cvt_pk_bf16_f32 v59, v54, v55
    v_min_u32 v56, -2, v56
    v_min_u32 v57, -2, v57
    v_min_u32 v58, -2, v58
    v_min_u32 v59, -2, v59
    buffer_store_dwordx4 v[56:59], v22, s[8:11], s42 offen sc1
    s_waitcnt vmcnt(1)
    s_nop 0
    v_max3_u32 v58, v84, v85, v86
    v_max3_u32 v58, v58, v87, v88
    v_max3_u32 v58, v58, v89, v90
    v_max3_u32 v58, v58, v91, v92
    v_max_u32 v58, v58, v93
    v_cmp_eq_u32 vcc, -1, v58
    s_cbranch_vccz interleave_layers__linear_attn_block__memory_aug_recurrent_mem_tr__prompt_kernel_s_pmw2_out
    s_mov_b32 s61, 0
interleave_layers__linear_attn_block__memory_aug_recurrent_mem_tr__prompt_kernel_s_pmw2:
    buffer_load_dwordx4 v[84:87], v7, s[8:11], s47 offen sc1
    buffer_load_dwordx4 v[88:91], v7, s[8:11], s46 offen sc1
    buffer_load_dwordx2 v[92:93], v8, s[8:11], s52 offen sc1
    s_waitcnt vmcnt(0)
    v_max3_u32 v58, v84, v85, v86
    v_max3_u32 v58, v58, v87, v88
    v_max3_u32 v58, v58, v89, v90
    v_max3_u32 v58, v58, v91, v92
    v_max_u32 v58, v58, v93
    v_cmp_eq_u32 vcc, -1, v58
    s_add_u32 s61, s61, 1
    s_cbranch_vccz interleave_layers__linear_attn_block__memory_aug_recurrent_mem_tr__prompt_kernel_s_pmw2_out
    s_cmp_ge_u32 s61, s60
    s_cbranch_scc1 interleave_layers__linear_attn_block__memory_aug_recurrent_mem_tr__prompt_kernel_s_pmw2_to
    s_sleep 1
    s_branch interleave_layers__linear_attn_block__memory_aug_recurrent_mem_tr__prompt_kernel_s_pmw2
interleave_layers__linear_attn_block__memory_aug_recurrent_mem_tr__prompt_kernel_s_pmw2_to:
    s_mov_b32 s60, 1
interleave_layers__linear_attn_block__memory_aug_recurrent_mem_tr__prompt_kernel_s_pmw2_out:
    ds_write_b128 v7, v[84:87]
    ds_write_b128 v7, v[88:91] offset:4096
    ds_write_b64 v8, v[92:93]
interleave_layers__linear_attn_block__memory_aug_recurrent_mem_tr__prompt_kernel_s_gow2:
    ds_read_b128 v[68:71], v6 offset:4096
    ds_read_b128 v[72:75], v6 offset:5120
    ds_read_b128 v[76:79], v6 offset:12288
    ds_read_b128 v[80:83], v6 offset:13312
    v_smfmac_f32_16x16x64_bf16 v[24:27], v[84:87], a[16:23], v4
    v_smfmac_f32_16x16x64_bf16 v[28:31], v[84:87], a[96:103], v4
    v_smfmac_f32_16x16x64_bf16 v[32:35], v[84:87], a[176:183], v4
    v_smfmac_f32_16x16x64_bf16 v[40:43], v[84:87], v[112:119], v4
    v_smfmac_f32_16x16x64_bf16 v[44:47], v[84:87], v[192:199], v4
    s_waitcnt lgkmcnt(2)
    v_smfmac_f32_16x16x64_bf16 v[36:39], v[84:87], v[68:75], v4
    ds_read_b128 v[68:71], v6 offset:0
    ds_read_b128 v[72:75], v6 offset:1024
    s_barrier
    ds_read_b128 v[48:51], v5 offset:0
    ds_read_b128 v[52:55], v5 offset:1024
    ds_read_b128 v[56:59], v5 offset:3072
    ds_read_b128 v[60:63], v5 offset:4096
    ds_read_b128 v[64:67], v5 offset:5120
    v_smfmac_f32_16x16x64_bf16 v[24:27], v[88:91], a[48:55], v4
    v_smfmac_f32_16x16x64_bf16 v[28:31], v[88:91], a[128:135], v4
    v_smfmac_f32_16x16x64_bf16 v[32:35], v[88:91], a[208:215], v4
    v_smfmac_f32_16x16x64_bf16 v[40:43], v[88:91], v[144:151], v4
    v_smfmac_f32_16x16x64_bf16 v[44:47], v[88:91], v[224:231], v4
    s_waitcnt lgkmcnt(7)
    v_smfmac_f32_16x16x64_bf16 v[36:39], v[88:91], v[76:83], v4
    ds_read_b128 v[76:79], v6 offset:2048
    ds_read_b128 v[80:83], v6 offset:3072
    s_waitcnt lgkmcnt(6)
    v_smfmac_f32_16x16x64_bf16 v[24:27], v[48:51], a[0:7], v4
    v_smfmac_f32_16x16x64_bf16 v[28:31], v[48:51], a[80:87], v4
    v_smfmac_f32_16x16x64_bf16 v[40:43], v[48:51], v[96:103], v4
    v_smfmac_f32_16x16x64_bf16 v[36:39], v[48:51], v[68:75], v4
    ds_read_b128 v[68:71], v6 offset:6144
    ds_read_b128 v[72:75], v6 offset:7168
    ds_read_b128 v[48:51], v5 offset:7168
    s_waitcnt lgkmcnt(8)
    v_smfmac_f32_16x16x64_bf16 v[24:27], v[52:55], a[8:15], v4
    v_smfmac_f32_16x16x64_bf16 v[28:31], v[52:55], a[88:95], v4
    v_smfmac_f32_16x16x64_bf16 v[40:43], v[52:55], v[104:111], v4
    s_waitcnt lgkmcnt(3)
    v_smfmac_f32_16x16x64_bf16 v[36:39], v[52:55], v[76:83], v4
    ds_read_b128 v[76:79], v6 offset:8192
    ds_read_b128 v[80:83], v6 offset:9216
    ds_read_b128 v[52:55], v5 offset:8192
    v_smfmac_f32_16x16x64_bf16 v[24:27], v[56:59], a[24:31], v4
    v_smfmac_f32_16x16x64_bf16 v[28:31], v[56:59], a[104:111], v4
    v_smfmac_f32_16x16x64_bf16 v[40:43], v[56:59], v[120:127], v4
    s_waitcnt lgkmcnt(4)
    v_smfmac_f32_16x16x64_bf16 v[36:39], v[56:59], v[68:75], v4
    ds_read_b128 v[68:71], v6 offset:10240
    ds_read_b128 v[72:75], v6 offset:11264
    ds_read_b128 v[56:59], v5 offset:9216
    v_smfmac_f32_16x16x64_bf16 v[24:27], v[60:63], a[32:39], v4
    v_smfmac_f32_16x16x64_bf16 v[28:31], v[60:63], a[112:119], v4
    v_smfmac_f32_16x16x64_bf16 v[40:43], v[60:63], v[128:135], v4
    s_waitcnt lgkmcnt(4)
    v_smfmac_f32_16x16x64_bf16 v[36:39], v[60:63], v[76:83], v4
    ds_read_b128 v[76:79], v6 offset:14336
    ds_read_b128 v[80:83], v6 offset:15360
    ds_read_b128 v[60:63], v5 offset:0
    v_smfmac_f32_16x16x64_bf16 v[24:27], v[64:67], a[40:47], v4
    v_smfmac_f32_16x16x64_bf16 v[28:31], v[64:67], a[120:127], v4
    v_smfmac_f32_16x16x64_bf16 v[40:43], v[64:67], v[136:143], v4
    s_waitcnt lgkmcnt(4)
    v_smfmac_f32_16x16x64_bf16 v[36:39], v[64:67], v[68:75], v4
    ds_read_b128 v[68:71], v6 offset:16384
    ds_read_b128 v[72:75], v6 offset:17408
    ds_read_b128 v[64:67], v5 offset:1024
    v_smfmac_f32_16x16x64_bf16 v[24:27], v[48:51], a[56:63], v4
    v_smfmac_f32_16x16x64_bf16 v[28:31], v[48:51], a[136:143], v4
    v_smfmac_f32_16x16x64_bf16 v[40:43], v[48:51], v[152:159], v4
    s_waitcnt lgkmcnt(4)
    v_smfmac_f32_16x16x64_bf16 v[36:39], v[48:51], v[76:83], v4
    ds_read_b128 v[76:79], v6 offset:18432
    ds_read_b128 v[80:83], v6 offset:19456
    ds_read_b128 v[48:51], v5 offset:3072
    v_smfmac_f32_16x16x64_bf16 v[24:27], v[52:55], a[64:71], v4
    v_smfmac_f32_16x16x64_bf16 v[28:31], v[52:55], a[144:151], v4
    v_smfmac_f32_16x16x64_bf16 v[40:43], v[52:55], v[160:167], v4
    s_waitcnt lgkmcnt(4)
    v_smfmac_f32_16x16x64_bf16 v[36:39], v[52:55], v[68:75], v4
    ds_read_b128 v[52:55], v5 offset:4096
    v_smfmac_f32_16x16x64_bf16 v[24:27], v[56:59], a[72:79], v4
    v_smfmac_f32_16x16x64_bf16 v[28:31], v[56:59], a[152:159], v4
    v_smfmac_f32_16x16x64_bf16 v[40:43], v[56:59], v[168:175], v4
    s_waitcnt lgkmcnt(2)
    v_smfmac_f32_16x16x64_bf16 v[36:39], v[56:59], v[76:83], v4
    ds_read_b128 v[56:59], v5 offset:5120
    buffer_load_dwordx4 v[80:83], v19, s[8:11], s45 offen offset:0 sc1
    buffer_load_dwordx4 v[84:87], v19, s[8:11], s45 offen offset:1024 sc1
    buffer_load_dwordx4 v[88:91], v19, s[8:11], s45 offen offset:2048 sc1
    v_smfmac_f32_16x16x64_bf16 v[32:35], v[60:63], a[160:167], v4
    v_smfmac_f32_16x16x64_bf16 v[44:47], v[60:63], v[176:183], v4
    v_permlane32_swap_b32 v28, v40
    v_permlane32_swap_b32 v29, v41
    ds_read_b128 v[60:63], v5 offset:7168
    v_smfmac_f32_16x16x64_bf16 v[32:35], v[64:67], a[168:175], v4
    v_permlane32_swap_b32 v30, v42
    v_permlane32_swap_b32 v31, v43
    v_smfmac_f32_16x16x64_bf16 v[44:47], v[64:67], v[184:191], v4
    v_add_f32 v28, v28, v40
    v_add_f32 v29, v29, v41
    ds_read_b128 v[64:67], v5 offset:8192
    s_waitcnt lgkmcnt(4)
    v_smfmac_f32_16x16x64_bf16 v[32:35], v[48:51], a[184:191], v4
    v_add_f32 v30, v30, v42
    v_add_f32 v31, v31, v43
    v_smfmac_f32_16x16x64_bf16 v[44:47], v[48:51], v[200:207], v4
    v_cvt_pk_bf16_f32 v40, v28, v29
    v_cvt_pk_bf16_f32 v41, v30, v31
    ds_read_b128 v[48:51], v5 offset:9216
    s_waitcnt lgkmcnt(4)
    v_smfmac_f32_16x16x64_bf16 v[32:35], v[52:55], a[192:199], v4
    v_mfma_f32_16x16x16_bf16 v[28:31], v[40:41], v[10:11], 0
    v_permlane32_swap_b32 v24, v36
    v_smfmac_f32_16x16x64_bf16 v[44:47], v[52:55], v[208:215], v4
    v_permlane32_swap_b32 v25, v37
    v_permlane32_swap_b32 v26, v38
    s_waitcnt lgkmcnt(3)
    v_smfmac_f32_16x16x64_bf16 v[32:35], v[56:59], a[200:207], v4
    v_permlane32_swap_b32 v27, v39
    v_add_f32 v24, v24, v36
    v_smfmac_f32_16x16x64_bf16 v[44:47], v[56:59], v[216:223], v4
    v_add_f32 v25, v25, v37
    v_add_f32 v26, v26, v38
    s_waitcnt lgkmcnt(2)
    v_smfmac_f32_16x16x64_bf16 v[32:35], v[60:63], a[216:223], v4
    v_add_f32 v27, v27, v39
    v_cvt_pk_bf16_f32 v36, v24, v25
    v_smfmac_f32_16x16x64_bf16 v[44:47], v[60:63], v[232:239], v4
    v_cvt_pk_bf16_f32 v37, v26, v27
    s_nop 1
    v_mfma_f32_16x16x16_bf16 v[24:27], v[36:37], v[10:11], 0
    s_waitcnt lgkmcnt(1)
    v_smfmac_f32_16x16x64_bf16 v[32:35], v[64:67], a[224:231], v4
    s_nop 5
    v_cvt_pk_bf16_f32 v24, v24, v25
    v_smfmac_f32_16x16x64_bf16 v[44:47], v[64:67], v[240:247], v4
    v_cvt_pk_bf16_f32 v25, v26, v27
    v_cvt_pk_bf16_f32 v26, v28, v29
    s_waitcnt lgkmcnt(0)
    v_smfmac_f32_16x16x64_bf16 v[32:35], v[48:51], a[232:239], v4
    v_cvt_pk_bf16_f32 v27, v30, v31
    s_waitcnt vmcnt(3)
    v_smfmac_f32_16x16x64_bf16 v[44:47], v[48:51], v[248:255], v4
    v_mfma_f32_16x16x32_bf16 v[28:31], a[240:243], v[24:27], 0
    v_mfma_f32_16x16x32_bf16 v[36:39], a[244:247], v[24:27], 0
    v_mfma_f32_16x16x32_bf16 v[40:43], v[24:27], v[24:27], 0
    s_nop 4
    v_permlane32_swap_b32 v32, v44
    v_permlane32_swap_b32 v33, v45
    v_permlane32_swap_b32 v34, v46
    v_permlane32_swap_b32 v35, v47
    v_add_f32 v32, v32, v44
    v_add_f32 v33, v33, v45
    v_add_f32 v34, v34, v46
    v_add_f32 v35, v35, v47
    v_cvt_pk_bf16_f32 v44, v32, v33
    v_cvt_pk_bf16_f32 v45, v34, v35
    s_nop 1
    v_mfma_f32_16x16x16_bf16 v[32:35], v[44:45], v[10:11], 0
    s_nop 7
    v_cvt_pk_bf16_f32 v32, v32, v33
    v_cvt_pk_bf16_f32 v33, v34, v35
    s_nop 1
    v_mfma_f32_16x16x16_bf16 v[28:31], a[248:249], v[32:33], v[28:31]
    v_mfma_f32_16x16x16_bf16 v[36:39], a[250:251], v[32:33], v[36:39]
    v_mfma_f32_16x16x16_bf16 v[40:43], v[32:33], v[32:33], v[40:43]
    s_nop 5
    ds_write_b128 v12, v[28:31]
    ds_write_b128 v12, v[36:39] offset:16
    ds_write_b128 v13, v[40:43]
    s_waitcnt lgkmcnt(0)
    s_barrier
    s_waitcnt vmcnt(0)
    v_mfma_f32_16x16x32_bf16 v[36:39], a[240:243], v[80:83], 0
    v_mfma_f32_16x16x32_bf16 v[44:47], a[244:247], v[80:83], 0
    v_mfma_f32_16x16x32_bf16 v[68:71], v[24:27], v[80:83], 0
    v_mfma_f32_16x16x32_bf16 v[40:43], a[240:243], v[84:87], 0
    v_mfma_f32_16x16x32_bf16 v[64:67], a[244:247], v[84:87], 0
    v_mfma_f32_16x16x32_bf16 v[72:75], v[24:27], v[84:87], 0
    s_nop 0
    v_mfma_f32_16x16x16_bf16 v[36:39], a[248:249], v[88:89], v[36:39]
    v_mfma_f32_16x16x16_bf16 v[44:47], a[250:251], v[88:89], v[44:47]
    v_mfma_f32_16x16x16_bf16 v[68:71], v[32:33], v[88:89], v[68:71]
    v_mfma_f32_16x16x16_bf16 v[40:43], a[248:249], v[90:91], v[40:43]
    v_mfma_f32_16x16x16_bf16 v[64:67], a[250:251], v[90:91], v[64:67]
    v_mfma_f32_16x16x16_bf16 v[72:75], v[32:33], v[90:91], v[72:75]
    s_nop 2
    ds_write_b128 v16, v[36:39] offset:0
    ds_write_b128 v16, v[44:47] offset:16
    ds_write_b128 v17, v[68:71]
    ds_write_b128 v16, v[40:43] offset:2816
    ds_write_b128 v16, v[64:67] offset:2832
    ds_write_b128 v18, v[72:75]
    s_add_u32 s40, s40, 1
    s_add_u32 s41, s41, 393216
    s_add_u32 s45, s45, 393216
    s_add_u32 s47, s37, 704512
    s_add_u32 s48, s37, 737280
    s_xor_b32 s42, s37, 0x2000
    s_lshl_b32 s24, s40, 12
    s_and_b32 s24, s24, 0x2000
    s_xor_b32 s24, s24, s36
    s_lshl_b32 s37, s40, 20
    s_add_u32 s37, s37, s24
    s_add_u32 s37, s37, 117440512
    s_add_u32 s43, s37, 655360
    s_add_u32 s49, s37, 753664
    s_waitcnt lgkmcnt(0)
    s_barrier
    s_cmp_lt_u32 s40, 64
    s_cbranch_scc1 interleave_layers__linear_attn_block__memory_aug_recurrent_mem_tr__prompt_kernel_s_stepw2
    s_branch interleave_layers__linear_attn_block__memory_aug_recurrent_mem_tr__prompt_kernel_s_end
interleave_layers__linear_attn_block__memory_aug_recurrent_mem_tr__prompt_kernel_s_stepw3:
    v_mov_b32 v24, 0
    v_mov_b32 v25, 0
    v_mov_b32 v26, 0
    v_mov_b32 v27, 0
    v_mov_b32 v28, 0
    v_mov_b32 v29, 0
    v_mov_b32 v30, 0
    v_mov_b32 v31, 0
    v_mov_b32 v32, 0
    v_mov_b32 v33, 0
    v_mov_b32 v34, 0
    v_mov_b32 v35, 0
    v_mov_b32 v36, 0
    v_mov_b32 v37, 0
    v_mov_b32 v38, 0
    v_mov_b32 v39, 0
    v_mov_b32 v40, 0
    v_mov_b32 v41, 0
    v_mov_b32 v42, 0
    v_mov_b32 v43, 0
    v_mov_b32 v44, 0
    v_mov_b32 v45, 0
    v_mov_b32 v46, 0
    v_mov_b32 v47, 0
    s_add_u32 s46, s47, 4096
    s_add_u32 s52, s47, 8192
    s_lshl_b32 s95, s92, 6
    s_add_u32 s95, s95, s40
    s_add_u32 s95, s95, 1
    s_cmp_ge_i32 s59, s95
    s_cbranch_scc1 interleave_layers__linear_attn_block__memory_aug_recurrent_mem_tr__prompt_kernel_s_ecw3_ok
    s_and_b32 s24, s2, 7
    s_lshl_b32 s24, s24, 7
    s_add_u32 s24, s24, 23109632
    v_and_b32 v49, 3, v1
    v_lshl_add_u32 v49, v49, 2, s24
    s_mov_b32 s61, 0
interleave_layers__linear_attn_block__memory_aug_recurrent_mem_tr__prompt_kernel_s_ecw3:
    buffer_load_dword v48, v49, s[8:11], 0 offen sc1
    s_waitcnt vmcnt(0)
    v_readlane_b32 s59, v48, 0
    v_readlane_b32 s24, v48, 1
    s_min_i32 s59, s59, s24
    v_readlane_b32 s24, v48, 2
    s_min_i32 s59, s59, s24
    s_cmp_ge_i32 s59, s95
    s_cbranch_scc1 interleave_layers__linear_attn_block__memory_aug_recurrent_mem_tr__prompt_kernel_s_ecw3_ok
    s_add_u32 s61, s61, 1
    s_cmp_ge_u32 s61, s60
    s_cbranch_scc1 interleave_layers__linear_attn_block__memory_aug_recurrent_mem_tr__prompt_kernel_s_ecw3_to
    s_sleep 2
    s_branch interleave_layers__linear_attn_block__memory_aug_recurrent_mem_tr__prompt_kernel_s_ecw3
interleave_layers__linear_attn_block__memory_aug_recurrent_mem_tr__prompt_kernel_s_ecw3_to:
    s_mov_b32 s60, 1
interleave_layers__linear_attn_block__memory_aug_recurrent_mem_tr__prompt_kernel_s_ecw3_ok:
    s_add_u32 s63, s40, 1
    s_cmp_ge_i32 s62, s63
    s_cbranch_scc1 interleave_layers__linear_attn_block__memory_aug_recurrent_mem_tr__prompt_kernel_s_enw3_ok
    s_mov_b32 s61, 0
interleave_layers__linear_attn_block__memory_aug_recurrent_mem_tr__prompt_kernel_s_enw3:
    buffer_load_dword v48, v9, s[8:11], 0 offen sc1
    s_waitcnt vmcnt(0)
    v_readlane_b32 s62, v48, 0
    v_readlane_b32 s24, v48, 1
    s_min_i32 s62, s62, s24
    s_cmp_ge_i32 s62, s63
    s_cbranch_scc1 interleave_layers__linear_attn_block__memory_aug_recurrent_mem_tr__prompt_kernel_s_enw3_ok
    s_add_u32 s61, s61, 1
    s_cmp_ge_u32 s61, s60
    s_cbranch_scc1 interleave_layers__linear_attn_block__memory_aug_recurrent_mem_tr__prompt_kernel_s_enw3_to
    s_sleep 2
    s_branch interleave_layers__linear_attn_block__memory_aug_recurrent_mem_tr__prompt_kernel_s_enw3
interleave_layers__linear_attn_block__memory_aug_recurrent_mem_tr__prompt_kernel_s_enw3_to:
    s_mov_b32 s60, 1
interleave_layers__linear_attn_block__memory_aug_recurrent_mem_tr__prompt_kernel_s_enw3_ok:
    buffer_load_dwordx4 a[240:243], v19, s[8:11], s41 offen offset:0 sc1
    buffer_load_dwordx4 a[244:247], v19, s[8:11], s41 offen offset:1024 sc1
    buffer_load_dwordx4 a[248:251], v19, s[8:11], s41 offen offset:2048 sc1
    s_sleep 5
    s_mov_b64 exec, 1
    s_mov_b32 s61, 0
    v_mov_b32 v83, 0
    buffer_atomic_add v83, v23, s[8:11], s48 offen sc0
    s_sleep 2
    v_mov_b32 v94, 0
    buffer_atomic_add v94, v23, s[8:11], s48 offen sc0
    s_sleep 2
    v_mov_b32 v95, 0
    buffer_atomic_add v95, v23, s[8:11], s48 offen sc0
    s_sleep 2
interleave_layers__linear_attn_block__memory_aug_recurrent_mem_tr__prompt_kernel_s_prw3:
    v_mov_b32 v82, 0
    buffer_atomic_add v82, v23, s[8:11], s48 offen sc0
    s_waitcnt vmcnt(3)
    v_cmp_le_i32 vcc, 9, v83
    s_add_u32 s61, s61, 1
    s_cbranch_vccnz interleave_layers__linear_attn_block__memory_aug_recurrent_mem_tr__prompt_kernel_s_prw3_out
    s_sleep 2
    v_mov_b32 v83, 0
    buffer_atomic_add v83, v23, s[8:11], s48 offen sc0
    s_waitcnt vmcnt(3)
    v_cmp_le_i32 vcc, 9, v94
    s_add_u32 s61, s61, 1
    s_cbranch_vccnz interleave_layers__linear_attn_block__memory_aug_recurrent_mem_tr__prompt_kernel_s_prw3_out
    s_sleep 2
    v_mov_b32 v94, 0
    buffer_atomic_add v94, v23, s[8:11], s48 offen sc0
    s_waitcnt vmcnt(3)
    v_cmp_le_i32 vcc, 9, v95
    s_add_u32 s61, s61, 1
    s_cbranch_vccnz interleave_layers__linear_attn_block__memory_aug_recurrent_mem_tr__prompt_kernel_s_prw3_out
    s_sleep 2
    v_mov_b32 v95, 0
    buffer_atomic_add v95, v23, s[8:11], s48 offen sc0
    s_waitcnt vmcnt(3)
    v_cmp_le_i32 vcc, 9, v82
    s_add_u32 s61, s61, 1
    s_cbranch_vccnz interleave_layers__linear_attn_block__memory_aug_recurrent_mem_tr__prompt_kernel_s_prw3_out
    s_sleep 2
    s_cmp_ge_u32 s61, s60
    s_cbranch_scc0 interleave_layers__linear_attn_block__memory_aug_recurrent_mem_tr__prompt_kernel_s_prw3
    s_mov_b32 s60, 1
interleave_layers__linear_attn_block__memory_aug_recurrent_mem_tr__prompt_kernel_s_prw3_out:
    s_mov_b64 exec, -1
    buffer_load_dwordx4 v[84:87], v7, s[8:11], s47 offen sc1
    buffer_load_dwordx4 v[88:91], v7, s[8:11], s46 offen sc1
    buffer_load_dwordx2 v[92:93], v8, s[8:11], s52 offen sc1
    ds_read_b128 v[48:51], v21 offset:0
    ds_read_b128 v[52:55], v21 offset:16
    ds_read_b128 v[56:59], v21 offset:5632
    ds_read_b128 v[60:63], v21 offset:5648
    ds_read_b128 v[64:67], v21 offset:11264
    ds_read_b128 v[68:71], v21 offset:11280
    ds_read_b128 v[72:75], v21 offset:16896
    ds_read_b128 v[76:79], v21 offset:16912
    s_waitcnt lgkmcnt(4)
    v_pk_add_f32 v[48:49], v[48:49], v[56:57]
    v_pk_add_f32 v[50:51], v[50:51], v[58:59]
    v_pk_add_f32 v[52:53], v[52:53], v[60:61]
    v_pk_add_f32 v[54:55], v[54:55], v[62:63]
    s_waitcnt lgkmcnt(0)
    v_pk_add_f32 v[64:65], v[64:65], v[72:73]
    v_pk_add_f32 v[66:67], v[66:67], v[74:75]
    v_pk_add_f32 v[68:69], v[68:69], v[76:77]
    v_pk_add_f32 v[70:71], v[70:71], v[78:79]
    v_pk_add_f32 v[48:49], v[48:49], v[64:65]
    v_pk_add_f32 v[50:51], v[50:51], v[66:67]
    v_pk_add_f32 v[52:53], v[52:53], v[68:69]
    v_pk_add_f32 v[54:55], v[54:55], v[70:71]
    v_mov_b32 v81, 0xff800000
    v_cndmask_b32 v48, v81, v48, s[64:65]
    v_cndmask_b32 v49, v81, v49, s[66:67]
    v_cndmask_b32 v50, v81, v50, s[68:69]
    v_cndmask_b32 v51, v81, v51, s[70:71]
    v_cndmask_b32 v52, v81, v52, s[72:73]
    v_cndmask_b32 v53, v81, v53, s[74:75]
    v_cndmask_b32 v54, v81, v54, s[76:77]
    v_cndmask_b32 v55, v81, v55, s[78:79]
    v_max3_f32 v80, v48, v49, v50
    v_max3_f32 v80, v80, v51, v52
    v_max3_f32 v80, v80, v53, v54
    v_max_f32 v80, v80, v55
    v_mov_b32 v81, 0xff800000
    v_cndmask_b32 v80, v81, v80, s[50:51]
    s_nop 1
    v_max_f32 v80, v80, v80 quad_perm:[1,0,3,2] row_mask:0xf bank_mask:0xf
    s_nop 1
    v_max_f32 v80, v80, v80 quad_perm:[2,3,0,1] row_mask:0xf bank_mask:0xf
    s_nop 1
    v_max_f32 v80, v80, v80 row_half_mirror row_mask:0xf bank_mask:0xf
    s_mov_b32 s24, 0x3dd53b95
    v_mul_f32 v80, s24, v80
    v_pk_fma_f32 v[48:49], v[48:49], s[24:25], v[80:81] op_sel_hi:[1,0,0] neg_lo:[0,0,1] neg_hi:[0,0,1]
    v_pk_fma_f32 v[50:51], v[50:51], s[24:25], v[80:81] op_sel_hi:[1,0,0] neg_lo:[0,0,1] neg_hi:[0,0,1]
    v_pk_fma_f32 v[52:53], v[52:53], s[24:25], v[80:81] op_sel_hi:[1,0,0] neg_lo:[0,0,1] neg_hi:[0,0,1]
    v_pk_fma_f32 v[54:55], v[54:55], s[24:25], v[80:81] op_sel_hi:[1,0,0] neg_lo:[0,0,1] neg_hi:[0,0,1]
    v_exp_f32 v48, v48
    v_exp_f32 v49, v49
    v_exp_f32 v50, v50
    v_exp_f32 v51, v51
    v_exp_f32 v52, v52
    v_exp_f32 v53, v53
    v_exp_f32 v54, v54
    v_exp_f32 v55, v55
    v_pk_add_f32 v[56:57], v[48:49], v[50:51]
    v_pk_add_f32 v[58:59], v[52:53], v[54:55]
    v_pk_add_f32 v[56:57], v[56:57], v[58:59]
    v_add_f32 v80, v56, v57
    v_cndmask_b32 v80, 0, v80, s[50:51]
    s_nop 1
    v_add_f32 v80, v80, v80 quad_perm:[1,0,3,2] row_mask:0xf bank_mask:0xf
    s_nop 1
    v_add_f32 v80, v80, v80 quad_perm:[2,3,0,1] row_mask:0xf bank_mask:0xf
    s_nop 1
    v_add_f32 v80, v80, v80 row_half_mirror row_mask:0xf bank_mask:0xf
    v_rcp_f32 v80, v80
    s_nop 0
    v_pk_mul_f32 v[48:49], v[48:49], v[80:81] op_sel_hi:[1,0]
    v_pk_mul_f32 v[50:51], v[50:51], v[80:81] op_sel_hi:[1,0]
    v_pk_mul_f32 v[52:53], v[52:53], v[80:81] op_sel_hi:[1,0]
    v_pk_mul_f32 v[54:55], v[54:55], v[80:81] op_sel_hi:[1,0]
    v_cvt_pk_bf16_f32 v56, v48, v49
    v_cvt_pk_bf16_f32 v57, v50, v51
    v_cvt_pk_bf16_f32 v58, v52, v53
    v_cvt_pk_bf16_f32 v59, v54, v55
    v_min_u32 v56, -2, v56
    v_min_u32 v57, -2, v57
    v_min_u32 v58, -2, v58
    v_min_u32 v59, -2, v59
    buffer_store_dwordx4 v[56:59], v22, s[8:11], s42 offen sc1
    s_waitcnt vmcnt(1)
    s_nop 0
    v_max3_u32 v58, v84, v85, v86
    v_max3_u32 v58, v58, v87, v88
    v_max3_u32 v58, v58, v89, v90
    v_max3_u32 v58, v58, v91, v92
    v_max_u32 v58, v58, v93
    v_cmp_eq_u32 vcc, -1, v58
    s_cbranch_vccz interleave_layers__linear_attn_block__memory_aug_recurrent_mem_tr__prompt_kernel_s_pmw3_out
    s_mov_b32 s61, 0
interleave_layers__linear_attn_block__memory_aug_recurrent_mem_tr__prompt_kernel_s_pmw3:
    buffer_load_dwordx4 v[84:87], v7, s[8:11], s47 offen sc1
    buffer_load_dwordx4 v[88:91], v7, s[8:11], s46 offen sc1
    buffer_load_dwordx2 v[92:93], v8, s[8:11], s52 offen sc1
    s_waitcnt vmcnt(0)
    v_max3_u32 v58, v84, v85, v86
    v_max3_u32 v58, v58, v87, v88
    v_max3_u32 v58, v58, v89, v90
    v_max3_u32 v58, v58, v91, v92
    v_max_u32 v58, v58, v93
    v_cmp_eq_u32 vcc, -1, v58
    s_add_u32 s61, s61, 1
    s_cbranch_vccz interleave_layers__linear_attn_block__memory_aug_recurrent_mem_tr__prompt_kernel_s_pmw3_out
    s_cmp_ge_u32 s61, s60
    s_cbranch_scc1 interleave_layers__linear_attn_block__memory_aug_recurrent_mem_tr__prompt_kernel_s_pmw3_to
    s_sleep 1
    s_branch interleave_layers__linear_attn_block__memory_aug_recurrent_mem_tr__prompt_kernel_s_pmw3
interleave_layers__linear_attn_block__memory_aug_recurrent_mem_tr__prompt_kernel_s_pmw3_to:
    s_mov_b32 s60, 1
interleave_layers__linear_attn_block__memory_aug_recurrent_mem_tr__prompt_kernel_s_pmw3_out:
    ds_write_b128 v7, v[84:87]
    ds_write_b128 v7, v[88:91] offset:4096
    ds_write_b64 v8, v[92:93]
interleave_layers__linear_attn_block__memory_aug_recurrent_mem_tr__prompt_kernel_s_gow3:
    ds_read_b128 v[68:71], v6 offset:6144
    ds_read_b128 v[72:75], v6 offset:7168
    ds_read_b128 v[76:79], v6 offset:14336
    ds_read_b128 v[80:83], v6 offset:15360
    v_smfmac_f32_16x16x64_bf16 v[24:27], v[84:87], a[24:31], v4
    v_smfmac_f32_16x16x64_bf16 v[28:31], v[84:87], a[104:111], v4
    v_smfmac_f32_16x16x64_bf16 v[32:35], v[84:87], a[184:191], v4
    v_smfmac_f32_16x16x64_bf16 v[40:43], v[84:87], v[120:127], v4
    v_smfmac_f32_16x16x64_bf16 v[44:47], v[84:87], v[200:207], v4
    s_waitcnt lgkmcnt(2)
    v_smfmac_f32_16x16x64_bf16 v[36:39], v[84:87], v[68:75], v4
    ds_read_b128 v[68:71], v6 offset:0
    ds_read_b128 v[72:75], v6 offset:1024
    s_barrier
    ds_read_b128 v[48:51], v5 offset:0
    ds_read_b128 v[52:55], v5 offset:1024
    ds_read_b128 v[56:59], v5 offset:2048
    ds_read_b128 v[60:63], v5 offset:4096
    ds_read_b128 v[64:67], v5 offset:5120
    v_smfmac_f32_16x16x64_bf16 v[24:27], v[88:91], a[56:63], v4
    v_smfmac_f32_16x16x64_bf16 v[28:31], v[88:91], a[136:143], v4
    v_smfmac_f32_16x16x64_bf16 v[32:35], v[88:91], a[216:223], v4
    v_smfmac_f32_16x16x64_bf16 v[40:43], v[88:91], v[152:159], v4
    v_smfmac_f32_16x16x64_bf16 v[44:47], v[88:91], v[232:239], v4
    s_waitcnt lgkmcnt(7)
    v_smfmac_f32_16x16x64_bf16 v[36:39], v[88:91], v[76:83], v4
    ds_read_b128 v[76:79], v6 offset:2048
    ds_read_b128 v[80:83], v6 offset:3072
    s_waitcnt lgkmcnt(6)
    v_smfmac_f32_16x16x64_bf16 v[24:27], v[48:51], a[0:7], v4
    v_smfmac_f32_16x16x64_bf16 v[28:31], v[48:51], a[80:87], v4
    v_smfmac_f32_16x16x64_bf16 v[40:43], v[48:51], v[96:103], v4
    v_smfmac_f32_16x16x64_bf16 v[36:39], v[48:51], v[68:75], v4
    ds_read_b128 v[68:71], v6 offset:4096
    ds_read_b128 v[72:75], v6 offset:5120
    ds_read_b128 v[48:51], v5 offset:6144
    s_waitcnt lgkmcnt(8)
    v_smfmac_f32_16x16x64_bf16 v[24:27], v[52:55], a[8:15], v4
    v_smfmac_f32_16x16x64_bf16 v[28:31], v[52:55], a[88:95], v4
    v_smfmac_f32_16x16x64_bf16 v[40:43], v[52:55], v[104:111], v4
    s_waitcnt lgkmcnt(3)
    v_smfmac_f32_16x16x64_bf16 v[36:39], v[52:55], v[76:83], v4
    ds_read_b128 v[76:79], v6 offset:8192
    ds_read_b128 v[80:83], v6 offset:9216
    ds_read_b128 v[52:55], v5 offset:8192
    v_smfmac_f32_16x16x64_bf16 v[24:27], v[56:59], a[16:23], v4
    v_smfmac_f32_16x16x64_bf16 v[28:31], v[56:59], a[96:103], v4
    v_smfmac_f32_16x16x64_bf16 v[40:43], v[56:59], v[112:119], v4
    s_waitcnt lgkmcnt(4)
    v_smfmac_f32_16x16x64_bf16 v[36:39], v[56:59], v[68:75], v4
    ds_read_b128 v[68:71], v6 offset:10240
    ds_read_b128 v[72:75], v6 offset:11264
    ds_read_b128 v[56:59], v5 offset:9216
    v_smfmac_f32_16x16x64_bf16 v[24:27], v[60:63], a[32:39], v4
    v_smfmac_f32_16x16x64_bf16 v[28:31], v[60:63], a[112:119], v4
    v_smfmac_f32_16x16x64_bf16 v[40:43], v[60:63], v[128:135], v4
    s_waitcnt lgkmcnt(4)
    v_smfmac_f32_16x16x64_bf16 v[36:39], v[60:63], v[76:83], v4
    ds_read_b128 v[76:79], v6 offset:12288
    ds_read_b128 v[80:83], v6 offset:13312
    ds_read_b128 v[60:63], v5 offset:0
    v_smfmac_f32_16x16x64_bf16 v[24:27], v[64:67], a[40:47], v4
    v_smfmac_f32_16x16x64_bf16 v[28:31], v[64:67], a[120:127], v4
    v_smfmac_f32_16x16x64_bf16 v[40:43], v[64:67], v[136:143], v4
    s_waitcnt lgkmcnt(4)
    v_smfmac_f32_16x16x64_bf16 v[36:39], v[64:67], v[68:75], v4
    ds_read_b128 v[68:71], v6 offset:16384
    ds_read_b128 v[72:75], v6 offset:17408
    ds_read_b128 v[64:67], v5 offset:1024
    v_smfmac_f32_16x16x64_bf16 v[24:27], v[48:51], a[48:55], v4
    v_smfmac_f32_16x16x64_bf16 v[28:31], v[48:51], a[128:135], v4
    v_smfmac_f32_16x16x64_bf16 v[40:43], v[48:51], v[144:151], v4
    s_waitcnt lgkmcnt(4)
    v_smfmac_f32_16x16x64_bf16 v[36:39], v[48:51], v[76:83], v4
    ds_read_b128 v[76:79], v6 offset:18432
    ds_read_b128 v[80:83], v6 offset:19456
    ds_read_b128 v[48:51], v5 offset:2048
    v_smfmac_f32_16x16x64_bf16 v[24:27], v[52:55], a[64:71], v4
    v_smfmac_f32_16x16x64_bf16 v[28:31], v[52:55], a[144:151], v4
    v_smfmac_f32_16x16x64_bf16 v[40:43], v[52:55], v[160:167], v4
    s_waitcnt lgkmcnt(4)
    v_smfmac_f32_16x16x64_bf16 v[36:39], v[52:55], v[68:75], v4
    ds_read_b128 v[52:55], v5 offset:4096
    v_smfmac_f32_16x16x64_bf16 v[24:27], v[56:59], a[72:79], v4
    v_smfmac_f32_16x16x64_bf16 v[28:31], v[56:59], a[152:159], v4
    v_smfmac_f32_16x16x64_bf16 v[40:43], v[56:59], v[168:175], v4
    s_waitcnt lgkmcnt(2)
    v_smfmac_f32_16x16x64_bf16 v[36:39], v[56:59], v[76:83], v4
    ds_read_b128 v[56:59], v5 offset:5120
    buffer_load_dwordx4 v[80:83], v19, s[8:11], s45 offen offset:0 sc1
    buffer_load_dwordx4 v[84:87], v19, s[8:11], s45 offen offset:1024 sc1
    buffer_load_dwordx4 v[88:91], v19, s[8:11], s45 offen offset:2048 sc1
    v_smfmac_f32_16x16x64_bf16 v[32:35], v[60:63], a[160:167], v4
    v_smfmac_f32_16x16x64_bf16 v[44:47], v[60:63], v[176:183], v4
    v_permlane32_swap_b32 v28, v40
    v_permlane32_swap_b32 v29, v41
    ds_read_b128 v[60:63], v5 offset:6144
    v_smfmac_f32_16x16x64_bf16 v[32:35], v[64:67], a[168:175], v4
    v_permlane32_swap_b32 v30, v42
    v_permlane32_swap_b32 v31, v43
    v_smfmac_f32_16x16x64_bf16 v[44:47], v[64:67], v[184:191], v4
    v_add_f32 v28, v28, v40
    v_add_f32 v29, v29, v41
    ds_read_b128 v[64:67], v5 offset:8192
    s_waitcnt lgkmcnt(4)
    v_smfmac_f32_16x16x64_bf16 v[32:35], v[48:51], a[176:183], v4
    v_add_f32 v30, v30, v42
    v_add_f32 v31, v31, v43
    v_smfmac_f32_16x16x64_bf16 v[44:47], v[48:51], v[192:199], v4
    v_cvt_pk_bf16_f32 v40, v28, v29
    v_cvt_pk_bf16_f32 v41, v30, v31
    ds_read_b128 v[48:51], v5 offset:9216
    s_waitcnt lgkmcnt(4)
    v_smfmac_f32_16x16x64_bf16 v[32:35], v[52:55], a[192:199], v4
    v_mfma_f32_16x16x16_bf16 v[28:31], v[40:41], v[10:11], 0
    v_permlane32_swap_b32 v24, v36
    v_smfmac_f32_16x16x64_bf16 v[44:47], v[52:55], v[208:215], v4
    v_permlane32_swap_b32 v25, v37
    v_permlane32_swap_b32 v26, v38
    s_waitcnt lgkmcnt(3)
    v_smfmac_f32_16x16x64_bf16 v[32:35], v[56:59], a[200:207], v4
    v_permlane32_swap_b32 v27, v39
    v_add_f32 v24, v24, v36
    v_smfmac_f32_16x16x64_bf16 v[44:47], v[56:59], v[216:223], v4
    v_add_f32 v25, v25, v37
    v_add_f32 v26, v26, v38
    s_waitcnt lgkmcnt(2)
    v_smfmac_f32_16x16x64_bf16 v[32:35], v[60:63], a[208:215], v4
    v_add_f32 v27, v27, v39
    v_cvt_pk_bf16_f32 v36, v24, v25
    v_smfmac_f32_16x16x64_bf16 v[44:47], v[60:63], v[224:231], v4
    v_cvt_pk_bf16_f32 v37, v26, v27
    s_nop 1
    v_mfma_f32_16x16x16_bf16 v[24:27], v[36:37], v[10:11], 0
    s_waitcnt lgkmcnt(1)
    v_smfmac_f32_16x16x64_bf16 v[32:35], v[64:67], a[224:231], v4
    s_nop 5
    v_cvt_pk_bf16_f32 v24, v24, v25
    v_smfmac_f32_16x16x64_bf16 v[44:47], v[64:67], v[240:247], v4
    v_cvt_pk_bf16_f32 v25, v26, v27
    v_cvt_pk_bf16_f32 v26, v28, v29
    s_waitcnt lgkmcnt(0)
    v_smfmac_f32_16x16x64_bf16 v[32:35], v[48:51], a[232:239], v4
    v_cvt_pk_bf16_f32 v27, v30, v31
    s_waitcnt vmcnt(3)
    v_smfmac_f32_16x16x64_bf16 v[44:47], v[48:51], v[248:255], v4
    v_mfma_f32_16x16x32_bf16 v[28:31], a[240:243], v[24:27], 0
    v_mfma_f32_16x16x32_bf16 v[36:39], a[244:247], v[24:27], 0
    v_mfma_f32_16x16x32_bf16 v[40:43], v[24:27], v[24:27], 0
    s_nop 4
    v_permlane32_swap_b32 v32, v44
    v_permlane32_swap_b32 v33, v45
    v_permlane32_swap_b32 v34, v46
    v_permlane32_swap_b32 v35, v47
    v_add_f32 v32, v32, v44
    v_add_f32 v33, v33, v45
    v_add_f32 v34, v34, v46
    v_add_f32 v35, v35, v47
    v_cvt_pk_bf16_f32 v44, v32, v33
    v_cvt_pk_bf16_f32 v45, v34, v35
    s_nop 1
    v_mfma_f32_16x16x16_bf16 v[32:35], v[44:45], v[10:11], 0
    s_nop 7
    v_cvt_pk_bf16_f32 v32, v32, v33
    v_cvt_pk_bf16_f32 v33, v34, v35
    s_nop 1
    v_mfma_f32_16x16x16_bf16 v[28:31], a[248:249], v[32:33], v[28:31]
    v_mfma_f32_16x16x16_bf16 v[36:39], a[250:251], v[32:33], v[36:39]
    v_mfma_f32_16x16x16_bf16 v[40:43], v[32:33], v[32:33], v[40:43]
    s_nop 5
    ds_write_b128 v12, v[28:31]
    ds_write_b128 v12, v[36:39] offset:16
    ds_write_b128 v13, v[40:43]
    s_waitcnt lgkmcnt(0)
    s_barrier
    s_waitcnt vmcnt(0)
    v_mfma_f32_16x16x32_bf16 v[36:39], a[240:243], v[80:83], 0
    v_mfma_f32_16x16x32_bf16 v[44:47], a[244:247], v[80:83], 0
    v_mfma_f32_16x16x32_bf16 v[68:71], v[24:27], v[80:83], 0
    v_mfma_f32_16x16x32_bf16 v[40:43], a[240:243], v[84:87], 0
    v_mfma_f32_16x16x32_bf16 v[64:67], a[244:247], v[84:87], 0
    v_mfma_f32_16x16x32_bf16 v[72:75], v[24:27], v[84:87], 0
    s_nop 0
    v_mfma_f32_16x16x16_bf16 v[36:39], a[248:249], v[88:89], v[36:39]
    v_mfma_f32_16x16x16_bf16 v[44:47], a[250:251], v[88:89], v[44:47]
    v_mfma_f32_16x16x16_bf16 v[68:71], v[32:33], v[88:89], v[68:71]
    v_mfma_f32_16x16x16_bf16 v[40:43], a[248:249], v[90:91], v[40:43]
    v_mfma_f32_16x16x16_bf16 v[64:67], a[250:251], v[90:91], v[64:67]
    v_mfma_f32_16x16x16_bf16 v[72:75], v[32:33], v[90:91], v[72:75]
    s_nop 2
    ds_write_b128 v16, v[36:39] offset:0
    ds_write_b128 v16, v[44:47] offset:16
    ds_write_b128 v17, v[68:71]
    ds_write_b128 v16, v[40:43] offset:2816
    ds_write_b128 v16, v[64:67] offset:2832
    ds_write_b128 v18, v[72:75]
    s_add_u32 s40, s40, 1
    s_add_u32 s41, s41, 393216
    s_add_u32 s45, s45, 393216
    s_add_u32 s47, s37, 704512
    s_add_u32 s48, s37, 737280
    s_xor_b32 s42, s37, 0x2000
    s_lshl_b32 s24, s40, 12
    s_and_b32 s24, s24, 0x2000
    s_xor_b32 s24, s24, s36
    s_lshl_b32 s37, s40, 20
    s_add_u32 s37, s37, s24
    s_add_u32 s37, s37, 117440512
    s_add_u32 s43, s37, 655360
    s_add_u32 s49, s37, 753664
    s_waitcnt lgkmcnt(0)
    s_barrier
    s_cmp_lt_u32 s40, 64
    s_cbranch_scc1 interleave_layers__linear_attn_block__memory_aug_recurrent_mem_tr__prompt_kernel_s_stepw3
interleave_layers__linear_attn_block__memory_aug_recurrent_mem_tr__prompt_kernel_s_end:
    ds_read_b128 v[48:51], v21 offset:0
    ds_read_b128 v[52:55], v21 offset:16
    ds_read_b128 v[56:59], v21 offset:5632
    ds_read_b128 v[60:63], v21 offset:5648
    ds_read_b128 v[64:67], v21 offset:11264
    ds_read_b128 v[68:71], v21 offset:11280
    ds_read_b128 v[72:75], v21 offset:16896
    ds_read_b128 v[76:79], v21 offset:16912
    s_waitcnt lgkmcnt(4)
    v_pk_add_f32 v[48:49], v[48:49], v[56:57]
    v_pk_add_f32 v[50:51], v[50:51], v[58:59]
    v_pk_add_f32 v[52:53], v[52:53], v[60:61]
    v_pk_add_f32 v[54:55], v[54:55], v[62:63]
    s_waitcnt lgkmcnt(0)
    v_pk_add_f32 v[64:65], v[64:65], v[72:73]
    v_pk_add_f32 v[66:67], v[66:67], v[74:75]
    v_pk_add_f32 v[68:69], v[68:69], v[76:77]
    v_pk_add_f32 v[70:71], v[70:71], v[78:79]
    v_pk_add_f32 v[48:49], v[48:49], v[64:65]
    v_pk_add_f32 v[50:51], v[50:51], v[66:67]
    v_pk_add_f32 v[52:53], v[52:53], v[68:69]
    v_pk_add_f32 v[54:55], v[54:55], v[70:71]
    v_mov_b32 v81, 0xff800000
    v_cndmask_b32 v48, v81, v48, s[64:65]
    v_cndmask_b32 v49, v81, v49, s[66:67]
    v_cndmask_b32 v50, v81, v50, s[68:69]
    v_cndmask_b32 v51, v81, v51, s[70:71]
    v_cndmask_b32 v52, v81, v52, s[72:73]
    v_cndmask_b32 v53, v81, v53, s[74:75]
    v_cndmask_b32 v54, v81, v54, s[76:77]
    v_cndmask_b32 v55, v81, v55, s[78:79]
    v_max3_f32 v80, v48, v49, v50
    v_max3_f32 v80, v80, v51, v52
    v_max3_f32 v80, v80, v53, v54
    v_max_f32 v80, v80, v55
    v_mov_b32 v81, 0xff800000
    v_cndmask_b32 v80, v81, v80, s[50:51]
    s_nop 1
    v_max_f32 v80, v80, v80 quad_perm:[1,0,3,2] row_mask:0xf bank_mask:0xf
    s_nop 1
    v_max_f32 v80, v80, v80 quad_perm:[2,3,0,1] row_mask:0xf bank_mask:0xf
    s_nop 1
    v_max_f32 v80, v80, v80 row_half_mirror row_mask:0xf bank_mask:0xf
    s_mov_b32 s24, 0x3dd53b95
    v_mul_f32 v80, s24, v80
    v_pk_fma_f32 v[48:49], v[48:49], s[24:25], v[80:81] op_sel_hi:[1,0,0] neg_lo:[0,0,1] neg_hi:[0,0,1]
    v_pk_fma_f32 v[50:51], v[50:51], s[24:25], v[80:81] op_sel_hi:[1,0,0] neg_lo:[0,0,1] neg_hi:[0,0,1]
    v_pk_fma_f32 v[52:53], v[52:53], s[24:25], v[80:81] op_sel_hi:[1,0,0] neg_lo:[0,0,1] neg_hi:[0,0,1]
    v_pk_fma_f32 v[54:55], v[54:55], s[24:25], v[80:81] op_sel_hi:[1,0,0] neg_lo:[0,0,1] neg_hi:[0,0,1]
    v_exp_f32 v48, v48
    v_exp_f32 v49, v49
    v_exp_f32 v50, v50
    v_exp_f32 v51, v51
    v_exp_f32 v52, v52
    v_exp_f32 v53, v53
    v_exp_f32 v54, v54
    v_exp_f32 v55, v55
    v_pk_add_f32 v[56:57], v[48:49], v[50:51]
    v_pk_add_f32 v[58:59], v[52:53], v[54:55]
    v_pk_add_f32 v[56:57], v[56:57], v[58:59]
    v_add_f32 v80, v56, v57
    v_cndmask_b32 v80, 0, v80, s[50:51]
    s_nop 1
    v_add_f32 v80, v80, v80 quad_perm:[1,0,3,2] row_mask:0xf bank_mask:0xf
    s_nop 1
    v_add_f32 v80, v80, v80 quad_perm:[2,3,0,1] row_mask:0xf bank_mask:0xf
    s_nop 1
    v_add_f32 v80, v80, v80 row_half_mirror row_mask:0xf bank_mask:0xf
    v_rcp_f32 v80, v80
    s_nop 0
    v_pk_mul_f32 v[48:49], v[48:49], v[80:81] op_sel_hi:[1,0]
    v_pk_mul_f32 v[50:51], v[50:51], v[80:81] op_sel_hi:[1,0]
    v_pk_mul_f32 v[52:53], v[52:53], v[80:81] op_sel_hi:[1,0]
    v_pk_mul_f32 v[54:55], v[54:55], v[80:81] op_sel_hi:[1,0]
    v_cvt_pk_bf16_f32 v56, v48, v49
    v_cvt_pk_bf16_f32 v57, v50, v51
    v_cvt_pk_bf16_f32 v58, v52, v53
    v_cvt_pk_bf16_f32 v59, v54, v55
    v_min_u32 v56, -2, v56
    v_min_u32 v57, -2, v57
    v_min_u32 v58, -2, v58
    v_min_u32 v59, -2, v59
    buffer_store_dwordx4 v[56:59], v22, s[8:11], s42 offen sc1
    s_cmp_eq_u32 s92, 0
    s_cbranch_scc0 interleave_layers__linear_attn_block__memory_aug_recurrent_mem_tr__prompt_kernel_end
    s_mov_b32 s92, 1
    s_branch interleave_layers__linear_attn_block__memory_aug_recurrent_mem_tr__prompt_kernel_s_layer
interleave_layers__linear_attn_block__memory_aug_recurrent_mem_tr__prompt_kernel_roleV:
    s_sub_u32 s44, s2, 32
    s_load_dwordx2 s[6:7], s[0:1], 56
    s_load_dwordx2 s[24:25], s[0:1], 64
    s_load_dwordx2 s[26:27], s[0:1], 32
    s_waitcnt lgkmcnt(0)
    s_mov_b32 s12, s6
    s_mov_b32 s13, s7
    s_mov_b32 s14, 7864320
    s_mov_b32 s15, 0x00020000
    s_mov_b32 s16, s24
    s_mov_b32 s17, s25
    s_mov_b32 s18, 7864320
    s_mov_b32 s19, 0x00020000
    s_mov_b32 s20, s26
    s_mov_b32 s21, s27
    s_mov_b32 s22, 10240
    s_mov_b32 s23, 0x00020000
    v_add_u32 v16, 0, v0
    s_mov_b32 s24, 683
    v_mul_lo_u32 v17, v16, s24
    v_lshrrev_b32 v17, 14, v17
    v_mul_u32_u24 v18, 24, v17
    v_sub_u32 v18, v16, v18
    s_mov_b32 s24, 12288
    v_mul_lo_u32 v4, v17, s24
    v_lshl_add_u32 v4, v18, 4, v4
    v_mul_u32_u24 v10, 400, v17
    v_lshl_add_u32 v10, v18, 4, v10
    v_add_u32 v10, 90112, v10
    v_add_u32 v16, 256, v0
    s_mov_b32 s24, 683
    v_mul_lo_u32 v17, v16, s24
    v_lshrrev_b32 v17, 14, v17
    v_mul_u32_u24 v18, 24, v17
    v_sub_u32 v18, v16, v18
    s_mov_b32 s24, 12288
    v_mul_lo_u32 v5, v17, s24
    v_lshl_add_u32 v5, v18, 4, v5
    v_mul_u32_u24 v11, 400, v17
    v_lshl_add_u32 v11, v18, 4, v11
    v_add_u32 v11, 90112, v11
    v_add_u32 v16, 512, v0
    s_mov_b32 s24, 683
    v_mul_lo_u32 v17, v16, s24
    v_lshrrev_b32 v17, 14, v17
    v_mul_u32_u24 v18, 24, v17
    v_sub_u32 v18, v16, v18
    s_mov_b32 s24, 12288
    v_mul_lo_u32 v6, v17, s24
    v_lshl_add_u32 v6, v18, 4, v6
    v_mul_u32_u24 v12, 400, v17
    v_lshl_add_u32 v12, v18, 4, v12
    v_add_u32 v12, 90112, v12
    v_add_u32 v16, 768, v0
    s_mov_b32 s24, 683
    v_mul_lo_u32 v17, v16, s24
    v_lshrrev_b32 v17, 14, v17
    v_mul_u32_u24 v18, 24, v17
    v_sub_u32 v18, v16, v18
    s_mov_b32 s24, 12288
    v_mul_lo_u32 v7, v17, s24
    v_lshl_add_u32 v7, v18, 4, v7
    v_mul_u32_u24 v13, 400, v17
    v_lshl_add_u32 v13, v18, 4, v13
    v_add_u32 v13, 90112, v13
    v_add_u32 v16, 1024, v0
    s_mov_b32 s24, 683
    v_mul_lo_u32 v17, v16, s24
    v_lshrrev_b32 v17, 14, v17
    v_mul_u32_u24 v18, 24, v17
    v_sub_u32 v18, v16, v18
    s_mov_b32 s24, 12288
    v_mul_lo_u32 v8, v17, s24
    v_lshl_add_u32 v8, v18, 4, v8
    v_mul_u32_u24 v14, 400, v17
    v_lshl_add_u32 v14, v18, 4, v14
    v_add_u32 v14, 90112, v14
    v_add_u32 v16, 1280, v0
    s_mov_b32 s24, 683
    v_mul_lo_u32 v17, v16, s24
    v_lshrrev_b32 v17, 14, v17
    v_mul_u32_u24 v18, 24, v17
    v_sub_u32 v18, v16, v18
    s_mov_b32 s24, 12288
    v_mul_lo_u32 v9, v17, s24
    v_lshl_add_u32 v9, v18, 4, v9
    v_mul_u32_u24 v15, 400, v17
    v_lshl_add_u32 v15, v18, 4, v15
    v_add_u32 v15, 90112, v15
    v_lshrrev_b32 v17, 1, v3
    v_lshlrev_b32 v17, 4, v17
    v_and_b32 v18, 1, v3
    v_lshl_add_u32 v17, v18, 2, v17
    v_lshrrev_b32 v18, 2, v2
    v_and_b32 v19, 1, v18
    v_add_u32 v17, v17, v19
    v_lshrrev_b32 v18, 1, v18
    v_lshl_add_u32 v17, v18, 3, v17
    v_mul_u32_u24 v16, 400, v17
    v_and_b32 v18, 3, v2
    v_lshl_add_u32 v16, v18, 3, v16
    v_add_u32 v16, 90112, v16
    s_mul_i32 s24, s3, 96
    v_add_u32 v16, s24, v16
    s_mul_i32 s45, s44, 384
    s_add_u32 s46, s45, 0
    buffer_load_dwordx4 v[24:27], v4, s[12:15], s46 offen
    buffer_load_dwordx4 v[28:31], v5, s[12:15], s46 offen
    buffer_load_dwordx4 v[32:35], v6, s[12:15], s46 offen
    buffer_load_dwordx4 v[36:39], v7, s[12:15], s46 offen
    buffer_load_dwordx4 v[40:43], v8, s[12:15], s46 offen
    buffer_load_dwordx4 v[44:47], v9, s[12:15], s46 offen
    s_add_u32 s46, s45, 786432
    buffer_load_dwordx4 v[48:51], v4, s[12:15], s46 offen
    buffer_load_dwordx4 v[52:55], v5, s[12:15], s46 offen
    buffer_load_dwordx4 v[56:59], v6, s[12:15], s46 offen
    buffer_load_dwordx4 v[60:63], v7, s[12:15], s46 offen
    buffer_load_dwordx4 v[64:67], v8, s[12:15], s46 offen
    buffer_load_dwordx4 v[68:71], v9, s[12:15], s46 offen
    s_waitcnt vmcnt(6)
    ds_write_b128 v10, v[24:27]
    ds_write_b128 v11, v[28:31]
    ds_write_b128 v12, v[32:35]
    ds_write_b128 v13, v[36:39]
    ds_write_b128 v14, v[40:43]
    ds_write_b128 v15, v[44:47]
    s_add_u32 s46, s45, 1572864
    buffer_load_dwordx4 v[72:75], v4, s[12:15], s46 offen
    buffer_load_dwordx4 v[76:79], v5, s[12:15], s46 offen
    buffer_load_dwordx4 v[80:83], v6, s[12:15], s46 offen
    buffer_load_dwordx4 v[84:87], v7, s[12:15], s46 offen
    buffer_load_dwordx4 v[88:91], v8, s[12:15], s46 offen
    buffer_load_dwordx4 v[92:95], v9, s[12:15], s46 offen
    s_waitcnt lgkmcnt(0)
    s_barrier
    ds_read_b64_tr_b16 a[0:1], v16 offset:0
    ds_read_b64_tr_b16 a[2:3], v16 offset:800
    ds_read_b64_tr_b16 a[4:5], v16 offset:12800
    ds_read_b64_tr_b16 a[6:7], v16 offset:13600
    ds_read_b64_tr_b16 a[80:81], v16 offset:32
    ds_read_b64_tr_b16 a[82:83], v16 offset:832
    ds_read_b64_tr_b16 a[84:85], v16 offset:12832
    ds_read_b64_tr_b16 a[86:87], v16 offset:13632
    ds_read_b64_tr_b16 a[160:161], v16 offset:64
    ds_read_b64_tr_b16 a[162:163], v16 offset:864
    ds_read_b64_tr_b16 a[164:165], v16 offset:12864
    ds_read_b64_tr_b16 a[166:167], v16 offset:13664
    s_waitcnt lgkmcnt(0)
    s_barrier
    s_waitcnt vmcnt(6)
    ds_write_b128 v10, v[48:51]
    ds_write_b128 v11, v[52:55]
    ds_write_b128 v12, v[56:59]
    ds_write_b128 v13, v[60:63]
    ds_write_b128 v14, v[64:67]
    ds_write_b128 v15, v[68:71]
    s_add_u32 s46, s45, 2359296
    buffer_load_dwordx4 v[24:27], v4, s[12:15], s46 offen
    buffer_load_dwordx4 v[28:31], v5, s[12:15], s46 offen
    buffer_load_dwordx4 v[32:35], v6, s[12:15], s46 offen
    buffer_load_dwordx4 v[36:39], v7, s[12:15], s46 offen
    buffer_load_dwordx4 v[40:43], v8, s[12:15], s46 offen
    buffer_load_dwordx4 v[44:47], v9, s[12:15], s46 offen
    s_waitcnt lgkmcnt(0)
    s_barrier
    ds_read_b64_tr_b16 a[8:9], v16 offset:0
    ds_read_b64_tr_b16 a[10:11], v16 offset:800
    ds_read_b64_tr_b16 a[12:13], v16 offset:12800
    ds_read_b64_tr_b16 a[14:15], v16 offset:13600
    ds_read_b64_tr_b16 a[88:89], v16 offset:32
    ds_read_b64_tr_b16 a[90:91], v16 offset:832
    ds_read_b64_tr_b16 a[92:93], v16 offset:12832
    ds_read_b64_tr_b16 a[94:95], v16 offset:13632
    ds_read_b64_tr_b16 a[168:169], v16 offset:64
    ds_read_b64_tr_b16 a[170:171], v16 offset:864
    ds_read_b64_tr_b16 a[172:173], v16 offset:12864
    ds_read_b64_tr_b16 a[174:175], v16 offset:13664
    s_waitcnt lgkmcnt(0)
    s_barrier
    s_waitcnt vmcnt(6)
    ds_write_b128 v10, v[72:75]
    ds_write_b128 v11, v[76:79]
    ds_write_b128 v12, v[80:83]
    ds_write_b128 v13, v[84:87]
    ds_write_b128 v14, v[88:91]
    ds_write_b128 v15, v[92:95]
    s_add_u32 s46, s45, 3145728
    buffer_load_dwordx4 v[48:51], v4, s[12:15], s46 offen
    buffer_load_dwordx4 v[52:55], v5, s[12:15], s46 offen
    buffer_load_dwordx4 v[56:59], v6, s[12:15], s46 offen
    buffer_load_dwordx4 v[60:63], v7, s[12:15], s46 offen
    buffer_load_dwordx4 v[64:67], v8, s[12:15], s46 offen
    buffer_load_dwordx4 v[68:71], v9, s[12:15], s46 offen
    s_waitcnt lgkmcnt(0)
    s_barrier
    ds_read_b64_tr_b16 a[16:17], v16 offset:0
    ds_read_b64_tr_b16 a[18:19], v16 offset:800
    ds_read_b64_tr_b16 a[20:21], v16 offset:12800
    ds_read_b64_tr_b16 a[22:23], v16 offset:13600
    ds_read_b64_tr_b16 a[96:97], v16 offset:32
    ds_read_b64_tr_b16 a[98:99], v16 offset:832
    ds_read_b64_tr_b16 a[100:101], v16 offset:12832
    ds_read_b64_tr_b16 a[102:103], v16 offset:13632
    ds_read_b64_tr_b16 a[176:177], v16 offset:64
    ds_read_b64_tr_b16 a[178:179], v16 offset:864
    ds_read_b64_tr_b16 a[180:181], v16 offset:12864
    ds_read_b64_tr_b16 a[182:183], v16 offset:13664
    s_waitcnt lgkmcnt(0)
    s_barrier
    s_waitcnt vmcnt(6)
    ds_write_b128 v10, v[24:27]
    ds_write_b128 v11, v[28:31]
    ds_write_b128 v12, v[32:35]
    ds_write_b128 v13, v[36:39]
    ds_write_b128 v14, v[40:43]
    ds_write_b128 v15, v[44:47]
    s_add_u32 s46, s45, 3932160
    buffer_load_dwordx4 v[72:75], v4, s[12:15], s46 offen
    buffer_load_dwordx4 v[76:79], v5, s[12:15], s46 offen
    buffer_load_dwordx4 v[80:83], v6, s[12:15], s46 offen
    buffer_load_dwordx4 v[84:87], v7, s[12:15], s46 offen
    buffer_load_dwordx4 v[88:91], v8, s[12:15], s46 offen
    buffer_load_dwordx4 v[92:95], v9, s[12:15], s46 offen
    s_waitcnt lgkmcnt(0)
    s_barrier
    ds_read_b64_tr_b16 a[24:25], v16 offset:0
    ds_read_b64_tr_b16 a[26:27], v16 offset:800
    ds_read_b64_tr_b16 a[28:29], v16 offset:12800
    ds_read_b64_tr_b16 a[30:31], v16 offset:13600
    ds_read_b64_tr_b16 a[104:105], v16 offset:32
    ds_read_b64_tr_b16 a[106:107], v16 offset:832
    ds_read_b64_tr_b16 a[108:109], v16 offset:12832
    ds_read_b64_tr_b16 a[110:111], v16 offset:13632
    ds_read_b64_tr_b16 a[184:185], v16 offset:64
    ds_read_b64_tr_b16 a[186:187], v16 offset:864
    ds_read_b64_tr_b16 a[188:189], v16 offset:12864
    ds_read_b64_tr_b16 a[190:191], v16 offset:13664
    s_waitcnt lgkmcnt(0)
    s_barrier
    s_waitcnt vmcnt(6)
    ds_write_b128 v10, v[48:51]
    ds_write_b128 v11, v[52:55]
    ds_write_b128 v12, v[56:59]
    ds_write_b128 v13, v[60:63]
    ds_write_b128 v14, v[64:67]
    ds_write_b128 v15, v[68:71]
    s_add_u32 s46, s45, 4718592
    buffer_load_dwordx4 v[24:27], v4, s[12:15], s46 offen
    buffer_load_dwordx4 v[28:31], v5, s[12:15], s46 offen
    buffer_load_dwordx4 v[32:35], v6, s[12:15], s46 offen
    buffer_load_dwordx4 v[36:39], v7, s[12:15], s46 offen
    buffer_load_dwordx4 v[40:43], v8, s[12:15], s46 offen
    buffer_load_dwordx4 v[44:47], v9, s[12:15], s46 offen
    s_waitcnt lgkmcnt(0)
    s_barrier
    ds_read_b64_tr_b16 a[32:33], v16 offset:0
    ds_read_b64_tr_b16 a[34:35], v16 offset:800
    ds_read_b64_tr_b16 a[36:37], v16 offset:12800
    ds_read_b64_tr_b16 a[38:39], v16 offset:13600
    ds_read_b64_tr_b16 a[112:113], v16 offset:32
    ds_read_b64_tr_b16 a[114:115], v16 offset:832
    ds_read_b64_tr_b16 a[116:117], v16 offset:12832
    ds_read_b64_tr_b16 a[118:119], v16 offset:13632
    ds_read_b64_tr_b16 a[192:193], v16 offset:64
    ds_read_b64_tr_b16 a[194:195], v16 offset:864
    ds_read_b64_tr_b16 a[196:197], v16 offset:12864
    ds_read_b64_tr_b16 a[198:199], v16 offset:13664
    s_waitcnt lgkmcnt(0)
    s_barrier
    s_waitcnt vmcnt(6)
    ds_write_b128 v10, v[72:75]
    ds_write_b128 v11, v[76:79]
    ds_write_b128 v12, v[80:83]
    ds_write_b128 v13, v[84:87]
    ds_write_b128 v14, v[88:91]
    ds_write_b128 v15, v[92:95]
    s_add_u32 s46, s45, 5505024
    buffer_load_dwordx4 v[48:51], v4, s[12:15], s46 offen
    buffer_load_dwordx4 v[52:55], v5, s[12:15], s46 offen
    buffer_load_dwordx4 v[56:59], v6, s[12:15], s46 offen
    buffer_load_dwordx4 v[60:63], v7, s[12:15], s46 offen
    buffer_load_dwordx4 v[64:67], v8, s[12:15], s46 offen
    buffer_load_dwordx4 v[68:71], v9, s[12:15], s46 offen
    s_waitcnt lgkmcnt(0)
    s_barrier
    ds_read_b64_tr_b16 a[40:41], v16 offset:0
    ds_read_b64_tr_b16 a[42:43], v16 offset:800
    ds_read_b64_tr_b16 a[44:45], v16 offset:12800
    ds_read_b64_tr_b16 a[46:47], v16 offset:13600
    ds_read_b64_tr_b16 a[120:121], v16 offset:32
    ds_read_b64_tr_b16 a[122:123], v16 offset:832
    ds_read_b64_tr_b16 a[124:125], v16 offset:12832
    ds_read_b64_tr_b16 a[126:127], v16 offset:13632
    ds_read_b64_tr_b16 a[200:201], v16 offset:64
    ds_read_b64_tr_b16 a[202:203], v16 offset:864
    ds_read_b64_tr_b16 a[204:205], v16 offset:12864
    ds_read_b64_tr_b16 a[206:207], v16 offset:13664
    s_waitcnt lgkmcnt(0)
    s_barrier
    s_waitcnt vmcnt(6)
    ds_write_b128 v10, v[24:27]
    ds_write_b128 v11, v[28:31]
    ds_write_b128 v12, v[32:35]
    ds_write_b128 v13, v[36:39]
    ds_write_b128 v14, v[40:43]
    ds_write_b128 v15, v[44:47]
    s_add_u32 s46, s45, 6291456
    buffer_load_dwordx4 v[72:75], v4, s[12:15], s46 offen
    buffer_load_dwordx4 v[76:79], v5, s[12:15], s46 offen
    buffer_load_dwordx4 v[80:83], v6, s[12:15], s46 offen
    buffer_load_dwordx4 v[84:87], v7, s[12:15], s46 offen
    buffer_load_dwordx4 v[88:91], v8, s[12:15], s46 offen
    buffer_load_dwordx4 v[92:95], v9, s[12:15], s46 offen
    s_waitcnt lgkmcnt(0)
    s_barrier
    ds_read_b64_tr_b16 a[48:49], v16 offset:0
    ds_read_b64_tr_b16 a[50:51], v16 offset:800
    ds_read_b64_tr_b16 a[52:53], v16 offset:12800
    ds_read_b64_tr_b16 a[54:55], v16 offset:13600
    ds_read_b64_tr_b16 a[128:129], v16 offset:32
    ds_read_b64_tr_b16 a[130:131], v16 offset:832
    ds_read_b64_tr_b16 a[132:133], v16 offset:12832
    ds_read_b64_tr_b16 a[134:135], v16 offset:13632
    ds_read_b64_tr_b16 a[208:209], v16 offset:64
    ds_read_b64_tr_b16 a[210:211], v16 offset:864
    ds_read_b64_tr_b16 a[212:213], v16 offset:12864
    ds_read_b64_tr_b16 a[214:215], v16 offset:13664
    s_waitcnt lgkmcnt(0)
    s_barrier
    s_waitcnt vmcnt(6)
    ds_write_b128 v10, v[48:51]
    ds_write_b128 v11, v[52:55]
    ds_write_b128 v12, v[56:59]
    ds_write_b128 v13, v[60:63]
    ds_write_b128 v14, v[64:67]
    ds_write_b128 v15, v[68:71]
    s_add_u32 s46, s45, 7077888
    buffer_load_dwordx4 v[24:27], v4, s[12:15], s46 offen
    buffer_load_dwordx4 v[28:31], v5, s[12:15], s46 offen
    buffer_load_dwordx4 v[32:35], v6, s[12:15], s46 offen
    buffer_load_dwordx4 v[36:39], v7, s[12:15], s46 offen
    buffer_load_dwordx4 v[40:43], v8, s[12:15], s46 offen
    buffer_load_dwordx4 v[44:47], v9, s[12:15], s46 offen
    s_waitcnt lgkmcnt(0)
    s_barrier
    ds_read_b64_tr_b16 a[56:57], v16 offset:0
    ds_read_b64_tr_b16 a[58:59], v16 offset:800
    ds_read_b64_tr_b16 a[60:61], v16 offset:12800
    ds_read_b64_tr_b16 a[62:63], v16 offset:13600
    ds_read_b64_tr_b16 a[136:137], v16 offset:32
    ds_read_b64_tr_b16 a[138:139], v16 offset:832
    ds_read_b64_tr_b16 a[140:141], v16 offset:12832
    ds_read_b64_tr_b16 a[142:143], v16 offset:13632
    ds_read_b64_tr_b16 a[216:217], v16 offset:64
    ds_read_b64_tr_b16 a[218:219], v16 offset:864
    ds_read_b64_tr_b16 a[220:221], v16 offset:12864
    ds_read_b64_tr_b16 a[222:223], v16 offset:13664
    s_waitcnt lgkmcnt(0)
    s_barrier
    s_waitcnt vmcnt(6)
    ds_write_b128 v10, v[72:75]
    ds_write_b128 v11, v[76:79]
    ds_write_b128 v12, v[80:83]
    ds_write_b128 v13, v[84:87]
    ds_write_b128 v14, v[88:91]
    ds_write_b128 v15, v[92:95]
    s_waitcnt lgkmcnt(0)
    s_barrier
    ds_read_b64_tr_b16 a[64:65], v16 offset:0
    ds_read_b64_tr_b16 a[66:67], v16 offset:800
    ds_read_b64_tr_b16 a[68:69], v16 offset:12800
    ds_read_b64_tr_b16 a[70:71], v16 offset:13600
    ds_read_b64_tr_b16 a[144:145], v16 offset:32
    ds_read_b64_tr_b16 a[146:147], v16 offset:832
    ds_read_b64_tr_b16 a[148:149], v16 offset:12832
    ds_read_b64_tr_b16 a[150:151], v16 offset:13632
    ds_read_b64_tr_b16 a[224:225], v16 offset:64
    ds_read_b64_tr_b16 a[226:227], v16 offset:864
    ds_read_b64_tr_b16 a[228:229], v16 offset:12864
    ds_read_b64_tr_b16 a[230:231], v16 offset:13664
    s_waitcnt lgkmcnt(0)
    s_barrier
    s_waitcnt vmcnt(0)
    ds_write_b128 v10, v[24:27]
    ds_write_b128 v11, v[28:31]
    ds_write_b128 v12, v[32:35]
    ds_write_b128 v13, v[36:39]
    ds_write_b128 v14, v[40:43]
    ds_write_b128 v15, v[44:47]
    s_waitcnt lgkmcnt(0)
    s_barrier
    ds_read_b64_tr_b16 a[72:73], v16 offset:0
    ds_read_b64_tr_b16 a[74:75], v16 offset:800
    ds_read_b64_tr_b16 a[76:77], v16 offset:12800
    ds_read_b64_tr_b16 a[78:79], v16 offset:13600
    ds_read_b64_tr_b16 a[152:153], v16 offset:32
    ds_read_b64_tr_b16 a[154:155], v16 offset:832
    ds_read_b64_tr_b16 a[156:157], v16 offset:12832
    ds_read_b64_tr_b16 a[158:159], v16 offset:13632
    ds_read_b64_tr_b16 a[232:233], v16 offset:64
    ds_read_b64_tr_b16 a[234:235], v16 offset:864
    ds_read_b64_tr_b16 a[236:237], v16 offset:12864
    ds_read_b64_tr_b16 a[238:239], v16 offset:13664
    s_waitcnt lgkmcnt(0)
    s_barrier
    v_add_u32 v64, 0, v0
    s_mov_b32 s24, 1639
    v_mul_lo_u32 v65, v64, s24
    v_lshrrev_b32 v65, 16, v65
    v_mul_u32_u24 v66, 40, v65
    v_sub_u32 v66, v64, v66
    s_mov_b32 s24, 1280
    v_mul_lo_u32 v4, v65, s24
    v_lshl_add_u32 v4, v66, 4, v4
    v_mul_u32_u24 v14, 656, v65
    v_lshl_add_u32 v14, v66, 4, v14
    v_add_u32 v14, 90112, v14
    v_add_u32 v64, 256, v0
    s_mov_b32 s24, 1639
    v_mul_lo_u32 v65, v64, s24
    v_lshrrev_b32 v65, 16, v65
    v_mul_u32_u24 v66, 40, v65
    v_sub_u32 v66, v64, v66
    s_mov_b32 s24, 1280
    v_mul_lo_u32 v5, v65, s24
    v_lshl_add_u32 v5, v66, 4, v5
    v_mul_u32_u24 v15, 656, v65
    v_lshl_add_u32 v15, v66, 4, v15
    v_add_u32 v15, 90112, v15
    v_add_u32 v64, 512, v0
    s_mov_b32 s24, 1639
    v_mul_lo_u32 v65, v64, s24
    v_lshrrev_b32 v65, 16, v65
    v_mul_u32_u24 v66, 40, v65
    v_sub_u32 v66, v64, v66
    s_mov_b32 s24, 1280
    v_mul_lo_u32 v6, v65, s24
    v_lshl_add_u32 v6, v66, 4, v6
    v_mul_u32_u24 v16, 656, v65
    v_lshl_add_u32 v16, v66, 4, v16
    v_add_u32 v16, 90112, v16
    v_add_u32 v64, 768, v0
    s_mov_b32 s24, 1639
    v_mul_lo_u32 v65, v64, s24
    v_lshrrev_b32 v65, 16, v65
    v_mul_u32_u24 v66, 40, v65
    v_sub_u32 v66, v64, v66
    s_mov_b32 s24, 1280
    v_mul_lo_u32 v7, v65, s24
    v_lshl_add_u32 v7, v66, 4, v7
    v_mul_u32_u24 v17, 656, v65
    v_lshl_add_u32 v17, v66, 4, v17
    v_add_u32 v17, 90112, v17
    v_add_u32 v64, 1024, v0
    s_mov_b32 s24, 1639
    v_mul_lo_u32 v65, v64, s24
    v_lshrrev_b32 v65, 16, v65
    v_mul_u32_u24 v66, 40, v65
    v_sub_u32 v66, v64, v66
    s_mov_b32 s24, 1280
    v_mul_lo_u32 v8, v65, s24
    v_lshl_add_u32 v8, v66, 4, v8
    v_mul_u32_u24 v18, 656, v65
    v_lshl_add_u32 v18, v66, 4, v18
    v_add_u32 v18, 90112, v18
    v_add_u32 v64, 1280, v0
    s_mov_b32 s24, 1639
    v_mul_lo_u32 v65, v64, s24
    v_lshrrev_b32 v65, 16, v65
    v_mul_u32_u24 v66, 40, v65
    v_sub_u32 v66, v64, v66
    s_mov_b32 s24, 1280
    v_mul_lo_u32 v9, v65, s24
    v_lshl_add_u32 v9, v66, 4, v9
    v_mul_u32_u24 v19, 656, v65
    v_lshl_add_u32 v19, v66, 4, v19
    v_add_u32 v19, 90112, v19
    v_add_u32 v64, 1536, v0
    s_mov_b32 s24, 1639
    v_mul_lo_u32 v65, v64, s24
    v_lshrrev_b32 v65, 16, v65
    v_mul_u32_u24 v66, 40, v65
    v_sub_u32 v66, v64, v66
    s_mov_b32 s24, 1280
    v_mul_lo_u32 v10, v65, s24
    v_lshl_add_u32 v10, v66, 4, v10
    v_mul_u32_u24 v20, 656, v65
    v_lshl_add_u32 v20, v66, 4, v20
    v_add_u32 v20, 90112, v20
    v_add_u32 v64, 1792, v0
    s_mov_b32 s24, 1639
    v_mul_lo_u32 v65, v64, s24
    v_lshrrev_b32 v65, 16, v65
    v_mul_u32_u24 v66, 40, v65
    v_sub_u32 v66, v64, v66
    s_mov_b32 s24, 1280
    v_mul_lo_u32 v11, v65, s24
    v_lshl_add_u32 v11, v66, 4, v11
    v_mul_u32_u24 v21, 656, v65
    v_lshl_add_u32 v21, v66, 4, v21
    v_add_u32 v21, 90112, v21
    v_add_u32 v64, 2048, v0
    s_mov_b32 s24, 1639
    v_mul_lo_u32 v65, v64, s24
    v_lshrrev_b32 v65, 16, v65
    v_mul_u32_u24 v66, 40, v65
    v_sub_u32 v66, v64, v66
    s_mov_b32 s24, 1280
    v_mul_lo_u32 v12, v65, s24
    v_lshl_add_u32 v12, v66, 4, v12
    v_mul_u32_u24 v22, 656, v65
    v_lshl_add_u32 v22, v66, 4, v22
    v_add_u32 v22, 90112, v22
    v_add_u32 v64, 2304, v0
    s_mov_b32 s24, 1639
    v_mul_lo_u32 v65, v64, s24
    v_lshrrev_b32 v65, 16, v65
    v_mul_u32_u24 v66, 40, v65
    v_sub_u32 v66, v64, v66
    s_mov_b32 s24, 1280
    v_mul_lo_u32 v13, v65, s24
    v_lshl_add_u32 v13, v66, 4, v13
    v_mul_u32_u24 v23, 656, v65
    v_lshl_add_u32 v23, v66, 4, v23
    v_add_u32 v23, 90112, v23
    v_lshrrev_b32 v64, 1, v3
    v_lshlrev_b32 v64, 4, v64
    v_and_b32 v65, 1, v3
    v_lshl_add_u32 v64, v65, 2, v64
    v_lshrrev_b32 v65, 2, v2
    v_and_b32 v66, 1, v65
    v_add_u32 v64, v64, v66
    v_lshrrev_b32 v65, 1, v65
    v_lshl_add_u32 v64, v65, 3, v64
    v_mul_u32_u24 v72, 656, v64
    v_and_b32 v65, 3, v2
    v_lshl_add_u32 v72, v65, 3, v72
    v_add_u32 v72, 90112, v72
    s_and_b32 s24, s3, 1
    s_mul_i32 s24, s24, 320
    v_add_u32 v72, s24, v72
    v_lshlrev_b32 v73, 4, v1
    s_mul_i32 s24, s3, 18432
    s_add_u32 s24, s24, 16384
    v_add_u32 v73, s24, v73
    s_mul_i32 s45, s44, 245760
    s_add_u32 s46, s45, 0
    buffer_load_dwordx4 v[24:27], v4, s[16:19], s46 offen
    buffer_load_dwordx4 v[28:31], v5, s[16:19], s46 offen
    buffer_load_dwordx4 v[32:35], v6, s[16:19], s46 offen
    buffer_load_dwordx4 v[36:39], v7, s[16:19], s46 offen
    buffer_load_dwordx4 v[40:43], v8, s[16:19], s46 offen
    buffer_load_dwordx4 v[44:47], v9, s[16:19], s46 offen
    buffer_load_dwordx4 v[48:51], v10, s[16:19], s46 offen
    buffer_load_dwordx4 v[52:55], v11, s[16:19], s46 offen
    buffer_load_dwordx4 v[56:59], v12, s[16:19], s46 offen
    buffer_load_dwordx4 v[60:63], v13, s[16:19], s46 offen
    s_waitcnt vmcnt(0)
    ds_write_b128 v14, v[24:27]
    ds_write_b128 v15, v[28:31]
    ds_write_b128 v16, v[32:35]
    ds_write_b128 v17, v[36:39]
    ds_write_b128 v18, v[40:43]
    ds_write_b128 v19, v[44:47]
    ds_write_b128 v20, v[48:51]
    ds_write_b128 v21, v[52:55]
    ds_write_b128 v22, v[56:59]
    ds_write_b128 v23, v[60:63]
    s_waitcnt lgkmcnt(0)
    s_barrier
    s_lshr_b32 s24, s3, 1
    s_cmp_eq_u32 s24, 0
    s_cbranch_scc0 interleave_layers__linear_attn_block__memory_aug_recurrent_mem_tr__prompt_kernel_wo20
    ds_read_b64_tr_b16 a[240:241], v72 offset:0
    ds_read_b64_tr_b16 a[242:243], v72 offset:1312
    ds_read_b64_tr_b16 a[244:245], v72 offset:20992
    ds_read_b64_tr_b16 a[246:247], v72 offset:22304
    ds_read_b64_tr_b16 v[112:113], v72 offset:32
    ds_read_b64_tr_b16 v[114:115], v72 offset:1344
    ds_read_b64_tr_b16 v[116:117], v72 offset:21024
    ds_read_b64_tr_b16 v[118:119], v72 offset:22336
    ds_read_b64_tr_b16 v[136:137], v72 offset:64
    ds_read_b64_tr_b16 v[138:139], v72 offset:1376
    ds_read_b64_tr_b16 v[140:141], v72 offset:21056
    ds_read_b64_tr_b16 v[142:143], v72 offset:22368
    ds_read_b64_tr_b16 v[160:161], v72 offset:96
    ds_read_b64_tr_b16 v[162:163], v72 offset:1408
    ds_read_b64_tr_b16 v[164:165], v72 offset:21088
    ds_read_b64_tr_b16 v[166:167], v72 offset:22400
    ds_read_b64_tr_b16 v[184:185], v72 offset:128
    ds_read_b64_tr_b16 v[186:187], v72 offset:1440
    ds_read_b64_tr_b16 v[188:189], v72 offset:21120
    ds_read_b64_tr_b16 v[190:191], v72 offset:22432
    ds_read_b64_tr_b16 v[208:209], v72 offset:160
    ds_read_b64_tr_b16 v[210:211], v72 offset:1472
    ds_read_b64_tr_b16 v[212:213], v72 offset:21152
    ds_read_b64_tr_b16 v[214:215], v72 offset:22464
    ds_read_b64_tr_b16 v[232:233], v72 offset:192
    ds_read_b64_tr_b16 v[234:235], v72 offset:1504
    ds_read_b64_tr_b16 v[236:237], v72 offset:21184
    ds_read_b64_tr_b16 v[238:239], v72 offset:22496
    ds_read_b64_tr_b16 v[64:65], v72 offset:224
    ds_read_b64_tr_b16 v[66:67], v72 offset:1536
    ds_read_b64_tr_b16 v[68:69], v72 offset:21216
    ds_read_b64_tr_b16 v[70:71], v72 offset:22528
    s_waitcnt lgkmcnt(0)
    ds_write_b128 v73, v[64:67] offset:0
    ds_write_b128 v73, v[68:71] offset:1024
    s_waitcnt lgkmcnt(0)
    ds_read_b64_tr_b16 v[64:65], v72 offset:256
    ds_read_b64_tr_b16 v[66:67], v72 offset:1568
    ds_read_b64_tr_b16 v[68:69], v72 offset:21248
    ds_read_b64_tr_b16 v[70:71], v72 offset:22560
    s_waitcnt lgkmcnt(0)
    ds_write_b128 v73, v[64:67] offset:6144
    ds_write_b128 v73, v[68:71] offset:7168
    s_waitcnt lgkmcnt(0)
    ds_read_b64_tr_b16 v[64:65], v72 offset:288
    ds_read_b64_tr_b16 v[66:67], v72 offset:1600
    ds_read_b64_tr_b16 v[68:69], v72 offset:21280
    ds_read_b64_tr_b16 v[70:71], v72 offset:22592
    s_waitcnt lgkmcnt(0)
    ds_write_b128 v73, v[64:67] offset:12288
    ds_write_b128 v73, v[68:71] offset:13312
    s_waitcnt lgkmcnt(0)
    s_waitcnt lgkmcnt(0)
interleave_layers__linear_attn_block__memory_aug_recurrent_mem_tr__prompt_kernel_wo20:
    s_barrier
    s_add_u32 s46, s45, 640
    buffer_load_dwordx4 v[24:27], v4, s[16:19], s46 offen
    buffer_load_dwordx4 v[28:31], v5, s[16:19], s46 offen
    buffer_load_dwordx4 v[32:35], v6, s[16:19], s46 offen
    buffer_load_dwordx4 v[36:39], v7, s[16:19], s46 offen
    buffer_load_dwordx4 v[40:43], v8, s[16:19], s46 offen
    buffer_load_dwordx4 v[44:47], v9, s[16:19], s46 offen
    buffer_load_dwordx4 v[48:51], v10, s[16:19], s46 offen
    buffer_load_dwordx4 v[52:55], v11, s[16:19], s46 offen
    buffer_load_dwordx4 v[56:59], v12, s[16:19], s46 offen
    buffer_load_dwordx4 v[60:63], v13, s[16:19], s46 offen
    s_waitcnt vmcnt(0)
    ds_write_b128 v14, v[24:27]
    ds_write_b128 v15, v[28:31]
    ds_write_b128 v16, v[32:35]
    ds_write_b128 v17, v[36:39]
    ds_write_b128 v18, v[40:43]
    ds_write_b128 v19, v[44:47]
    ds_write_b128 v20, v[48:51]
    ds_write_b128 v21, v[52:55]
    ds_write_b128 v22, v[56:59]
    ds_write_b128 v23, v[60:63]
    s_waitcnt lgkmcnt(0)
    s_barrier
    s_lshr_b32 s24, s3, 1
    s_cmp_eq_u32 s24, 1
    s_cbranch_scc0 interleave_layers__linear_attn_block__memory_aug_recurrent_mem_tr__prompt_kernel_wo21
    ds_read_b64_tr_b16 a[240:241], v72 offset:0
    ds_read_b64_tr_b16 a[242:243], v72 offset:1312
    ds_read_b64_tr_b16 a[244:245], v72 offset:20992
    ds_read_b64_tr_b16 a[246:247], v72 offset:22304
    ds_read_b64_tr_b16 v[112:113], v72 offset:32
    ds_read_b64_tr_b16 v[114:115], v72 offset:1344
    ds_read_b64_tr_b16 v[116:117], v72 offset:21024
    ds_read_b64_tr_b16 v[118:119], v72 offset:22336
    ds_read_b64_tr_b16 v[136:137], v72 offset:64
    ds_read_b64_tr_b16 v[138:139], v72 offset:1376
    ds_read_b64_tr_b16 v[140:141], v72 offset:21056
    ds_read_b64_tr_b16 v[142:143], v72 offset:22368
    ds_read_b64_tr_b16 v[160:161], v72 offset:96
    ds_read_b64_tr_b16 v[162:163], v72 offset:1408
    ds_read_b64_tr_b16 v[164:165], v72 offset:21088
    ds_read_b64_tr_b16 v[166:167], v72 offset:22400
    ds_read_b64_tr_b16 v[184:185], v72 offset:128
    ds_read_b64_tr_b16 v[186:187], v72 offset:1440
    ds_read_b64_tr_b16 v[188:189], v72 offset:21120
    ds_read_b64_tr_b16 v[190:191], v72 offset:22432
    ds_read_b64_tr_b16 v[208:209], v72 offset:160
    ds_read_b64_tr_b16 v[210:211], v72 offset:1472
    ds_read_b64_tr_b16 v[212:213], v72 offset:21152
    ds_read_b64_tr_b16 v[214:215], v72 offset:22464
    ds_read_b64_tr_b16 v[232:233], v72 offset:192
    ds_read_b64_tr_b16 v[234:235], v72 offset:1504
    ds_read_b64_tr_b16 v[236:237], v72 offset:21184
    ds_read_b64_tr_b16 v[238:239], v72 offset:22496
    ds_read_b64_tr_b16 v[64:65], v72 offset:224
    ds_read_b64_tr_b16 v[66:67], v72 offset:1536
    ds_read_b64_tr_b16 v[68:69], v72 offset:21216
    ds_read_b64_tr_b16 v[70:71], v72 offset:22528
    s_waitcnt lgkmcnt(0)
    ds_write_b128 v73, v[64:67] offset:0
    ds_write_b128 v73, v[68:71] offset:1024
    s_waitcnt lgkmcnt(0)
    ds_read_b64_tr_b16 v[64:65], v72 offset:256
    ds_read_b64_tr_b16 v[66:67], v72 offset:1568
    ds_read_b64_tr_b16 v[68:69], v72 offset:21248
    ds_read_b64_tr_b16 v[70:71], v72 offset:22560
    s_waitcnt lgkmcnt(0)
    ds_write_b128 v73, v[64:67] offset:6144
    ds_write_b128 v73, v[68:71] offset:7168
    s_waitcnt lgkmcnt(0)
    ds_read_b64_tr_b16 v[64:65], v72 offset:288
    ds_read_b64_tr_b16 v[66:67], v72 offset:1600
    ds_read_b64_tr_b16 v[68:69], v72 offset:21280
    ds_read_b64_tr_b16 v[70:71], v72 offset:22592
    s_waitcnt lgkmcnt(0)
    ds_write_b128 v73, v[64:67] offset:12288
    ds_write_b128 v73, v[68:71] offset:13312
    s_waitcnt lgkmcnt(0)
    s_waitcnt lgkmcnt(0)
interleave_layers__linear_attn_block__memory_aug_recurrent_mem_tr__prompt_kernel_wo21:
    s_barrier
    s_add_u32 s46, s45, 81920
    buffer_load_dwordx4 v[24:27], v4, s[16:19], s46 offen
    buffer_load_dwordx4 v[28:31], v5, s[16:19], s46 offen
    buffer_load_dwordx4 v[32:35], v6, s[16:19], s46 offen
    buffer_load_dwordx4 v[36:39], v7, s[16:19], s46 offen
    buffer_load_dwordx4 v[40:43], v8, s[16:19], s46 offen
    buffer_load_dwordx4 v[44:47], v9, s[16:19], s46 offen
    buffer_load_dwordx4 v[48:51], v10, s[16:19], s46 offen
    buffer_load_dwordx4 v[52:55], v11, s[16:19], s46 offen
    buffer_load_dwordx4 v[56:59], v12, s[16:19], s46 offen
    buffer_load_dwordx4 v[60:63], v13, s[16:19], s46 offen
    s_waitcnt vmcnt(0)
    ds_write_b128 v14, v[24:27]
    ds_write_b128 v15, v[28:31]
    ds_write_b128 v16, v[32:35]
    ds_write_b128 v17, v[36:39]
    ds_write_b128 v18, v[40:43]
    ds_write_b128 v19, v[44:47]
    ds_write_b128 v20, v[48:51]
    ds_write_b128 v21, v[52:55]
    ds_write_b128 v22, v[56:59]
    ds_write_b128 v23, v[60:63]
    s_waitcnt lgkmcnt(0)
    s_barrier
    s_lshr_b32 s24, s3, 1
    s_cmp_eq_u32 s24, 0
    s_cbranch_scc0 interleave_layers__linear_attn_block__memory_aug_recurrent_mem_tr__prompt_kernel_wo22
    ds_read_b64_tr_b16 a[248:249], v72 offset:0
    ds_read_b64_tr_b16 a[250:251], v72 offset:1312
    ds_read_b64_tr_b16 a[252:253], v72 offset:20992
    ds_read_b64_tr_b16 a[254:255], v72 offset:22304
    ds_read_b64_tr_b16 v[120:121], v72 offset:32
    ds_read_b64_tr_b16 v[122:123], v72 offset:1344
    ds_read_b64_tr_b16 v[124:125], v72 offset:21024
    ds_read_b64_tr_b16 v[126:127], v72 offset:22336
    ds_read_b64_tr_b16 v[144:145], v72 offset:64
    ds_read_b64_tr_b16 v[146:147], v72 offset:1376
    ds_read_b64_tr_b16 v[148:149], v72 offset:21056
    ds_read_b64_tr_b16 v[150:151], v72 offset:22368
    ds_read_b64_tr_b16 v[168:169], v72 offset:96
    ds_read_b64_tr_b16 v[170:171], v72 offset:1408
    ds_read_b64_tr_b16 v[172:173], v72 offset:21088
    ds_read_b64_tr_b16 v[174:175], v72 offset:22400
    ds_read_b64_tr_b16 v[192:193], v72 offset:128
    ds_read_b64_tr_b16 v[194:195], v72 offset:1440
    ds_read_b64_tr_b16 v[196:197], v72 offset:21120
    ds_read_b64_tr_b16 v[198:199], v72 offset:22432
    ds_read_b64_tr_b16 v[216:217], v72 offset:160
    ds_read_b64_tr_b16 v[218:219], v72 offset:1472
    ds_read_b64_tr_b16 v[220:221], v72 offset:21152
    ds_read_b64_tr_b16 v[222:223], v72 offset:22464
    ds_read_b64_tr_b16 v[240:241], v72 offset:192
    ds_read_b64_tr_b16 v[242:243], v72 offset:1504
    ds_read_b64_tr_b16 v[244:245], v72 offset:21184
    ds_read_b64_tr_b16 v[246:247], v72 offset:22496
    ds_read_b64_tr_b16 v[64:65], v72 offset:224
    ds_read_b64_tr_b16 v[66:67], v72 offset:1536
    ds_read_b64_tr_b16 v[68:69], v72 offset:21216
    ds_read_b64_tr_b16 v[70:71], v72 offset:22528
    s_waitcnt lgkmcnt(0)
    ds_write_b128 v73, v[64:67] offset:2048
    ds_write_b128 v73, v[68:71] offset:3072
    s_waitcnt lgkmcnt(0)
    ds_read_b64_tr_b16 v[64:65], v72 offset:256
    ds_read_b64_tr_b16 v[66:67], v72 offset:1568
    ds_read_b64_tr_b16 v[68:69], v72 offset:21248
    ds_read_b64_tr_b16 v[70:71], v72 offset:22560
    s_waitcnt lgkmcnt(0)
    ds_write_b128 v73, v[64:67] offset:8192
    ds_write_b128 v73, v[68:71] offset:9216
    s_waitcnt lgkmcnt(0)
    ds_read_b64_tr_b16 v[64:65], v72 offset:288
    ds_read_b64_tr_b16 v[66:67], v72 offset:1600
    ds_read_b64_tr_b16 v[68:69], v72 offset:21280
    ds_read_b64_tr_b16 v[70:71], v72 offset:22592
    s_waitcnt lgkmcnt(0)
    ds_write_b128 v73, v[64:67] offset:14336
    ds_write_b128 v73, v[68:71] offset:15360
    s_waitcnt lgkmcnt(0)
    s_waitcnt lgkmcnt(0)
interleave_layers__linear_attn_block__memory_aug_recurrent_mem_tr__prompt_kernel_wo22:
    s_barrier
    s_add_u32 s46, s45, 82560
    buffer_load_dwordx4 v[24:27], v4, s[16:19], s46 offen
    buffer_load_dwordx4 v[28:31], v5, s[16:19], s46 offen
    buffer_load_dwordx4 v[32:35], v6, s[16:19], s46 offen
    buffer_load_dwordx4 v[36:39], v7, s[16:19], s46 offen
    buffer_load_dwordx4 v[40:43], v8, s[16:19], s46 offen
    buffer_load_dwordx4 v[44:47], v9, s[16:19], s46 offen
    buffer_load_dwordx4 v[48:51], v10, s[16:19], s46 offen
    buffer_load_dwordx4 v[52:55], v11, s[16:19], s46 offen
    buffer_load_dwordx4 v[56:59], v12, s[16:19], s46 offen
    buffer_load_dwordx4 v[60:63], v13, s[16:19], s46 offen
    s_waitcnt vmcnt(0)
    ds_write_b128 v14, v[24:27]
    ds_write_b128 v15, v[28:31]
    ds_write_b128 v16, v[32:35]
    ds_write_b128 v17, v[36:39]
    ds_write_b128 v18, v[40:43]
    ds_write_b128 v19, v[44:47]
    ds_write_b128 v20, v[48:51]
    ds_write_b128 v21, v[52:55]
    ds_write_b128 v22, v[56:59]
    ds_write_b128 v23, v[60:63]
    s_waitcnt lgkmcnt(0)
    s_barrier
    s_lshr_b32 s24, s3, 1
    s_cmp_eq_u32 s24, 1
    s_cbranch_scc0 interleave_layers__linear_attn_block__memory_aug_recurrent_mem_tr__prompt_kernel_wo23
    ds_read_b64_tr_b16 a[248:249], v72 offset:0
    ds_read_b64_tr_b16 a[250:251], v72 offset:1312
    ds_read_b64_tr_b16 a[252:253], v72 offset:20992
    ds_read_b64_tr_b16 a[254:255], v72 offset:22304
    ds_read_b64_tr_b16 v[120:121], v72 offset:32
    ds_read_b64_tr_b16 v[122:123], v72 offset:1344
    ds_read_b64_tr_b16 v[124:125], v72 offset:21024
    ds_read_b64_tr_b16 v[126:127], v72 offset:22336
    ds_read_b64_tr_b16 v[144:145], v72 offset:64
    ds_read_b64_tr_b16 v[146:147], v72 offset:1376
    ds_read_b64_tr_b16 v[148:149], v72 offset:21056
    ds_read_b64_tr_b16 v[150:151], v72 offset:22368
    ds_read_b64_tr_b16 v[168:169], v72 offset:96
    ds_read_b64_tr_b16 v[170:171], v72 offset:1408
    ds_read_b64_tr_b16 v[172:173], v72 offset:21088
    ds_read_b64_tr_b16 v[174:175], v72 offset:22400
    ds_read_b64_tr_b16 v[192:193], v72 offset:128
    ds_read_b64_tr_b16 v[194:195], v72 offset:1440
    ds_read_b64_tr_b16 v[196:197], v72 offset:21120
    ds_read_b64_tr_b16 v[198:199], v72 offset:22432
    ds_read_b64_tr_b16 v[216:217], v72 offset:160
    ds_read_b64_tr_b16 v[218:219], v72 offset:1472
    ds_read_b64_tr_b16 v[220:221], v72 offset:21152
    ds_read_b64_tr_b16 v[222:223], v72 offset:22464
    ds_read_b64_tr_b16 v[240:241], v72 offset:192
    ds_read_b64_tr_b16 v[242:243], v72 offset:1504
    ds_read_b64_tr_b16 v[244:245], v72 offset:21184
    ds_read_b64_tr_b16 v[246:247], v72 offset:22496
    ds_read_b64_tr_b16 v[64:65], v72 offset:224
    ds_read_b64_tr_b16 v[66:67], v72 offset:1536
    ds_read_b64_tr_b16 v[68:69], v72 offset:21216
    ds_read_b64_tr_b16 v[70:71], v72 offset:22528
    s_waitcnt lgkmcnt(0)
    ds_write_b128 v73, v[64:67] offset:2048
    ds_write_b128 v73, v[68:71] offset:3072
    s_waitcnt lgkmcnt(0)
    ds_read_b64_tr_b16 v[64:65], v72 offset:256
    ds_read_b64_tr_b16 v[66:67], v72 offset:1568
    ds_read_b64_tr_b16 v[68:69], v72 offset:21248
    ds_read_b64_tr_b16 v[70:71], v72 offset:22560
    s_waitcnt lgkmcnt(0)
    ds_write_b128 v73, v[64:67] offset:8192
    ds_write_b128 v73, v[68:71] offset:9216
    s_waitcnt lgkmcnt(0)
    ds_read_b64_tr_b16 v[64:65], v72 offset:288
    ds_read_b64_tr_b16 v[66:67], v72 offset:1600
    ds_read_b64_tr_b16 v[68:69], v72 offset:21280
    ds_read_b64_tr_b16 v[70:71], v72 offset:22592
    s_waitcnt lgkmcnt(0)
    ds_write_b128 v73, v[64:67] offset:14336
    ds_write_b128 v73, v[68:71] offset:15360
    s_waitcnt lgkmcnt(0)
    s_waitcnt lgkmcnt(0)
interleave_layers__linear_attn_block__memory_aug_recurrent_mem_tr__prompt_kernel_wo23:
    s_barrier
    s_add_u32 s46, s45, 163840
    buffer_load_dwordx4 v[24:27], v4, s[16:19], s46 offen
    buffer_load_dwordx4 v[28:31], v5, s[16:19], s46 offen
    buffer_load_dwordx4 v[32:35], v6, s[16:19], s46 offen
    buffer_load_dwordx4 v[36:39], v7, s[16:19], s46 offen
    buffer_load_dwordx4 v[40:43], v8, s[16:19], s46 offen
    buffer_load_dwordx4 v[44:47], v9, s[16:19], s46 offen
    buffer_load_dwordx4 v[48:51], v10, s[16:19], s46 offen
    buffer_load_dwordx4 v[52:55], v11, s[16:19], s46 offen
    buffer_load_dwordx4 v[56:59], v12, s[16:19], s46 offen
    buffer_load_dwordx4 v[60:63], v13, s[16:19], s46 offen
    s_waitcnt vmcnt(0)
    ds_write_b128 v14, v[24:27]
    ds_write_b128 v15, v[28:31]
    ds_write_b128 v16, v[32:35]
    ds_write_b128 v17, v[36:39]
    ds_write_b128 v18, v[40:43]
    ds_write_b128 v19, v[44:47]
    ds_write_b128 v20, v[48:51]
    ds_write_b128 v21, v[52:55]
    ds_write_b128 v22, v[56:59]
    ds_write_b128 v23, v[60:63]
    s_waitcnt lgkmcnt(0)
    s_barrier
    s_lshr_b32 s24, s3, 1
    s_cmp_eq_u32 s24, 0
    s_cbranch_scc0 interleave_layers__linear_attn_block__memory_aug_recurrent_mem_tr__prompt_kernel_wo24
    ds_read_b64_tr_b16 v[104:105], v72 offset:0
    ds_read_b64_tr_b16 v[106:107], v72 offset:1312
    ds_read_b64_tr_b16 v[108:109], v72 offset:20992
    ds_read_b64_tr_b16 v[110:111], v72 offset:22304
    ds_read_b64_tr_b16 v[128:129], v72 offset:32
    ds_read_b64_tr_b16 v[130:131], v72 offset:1344
    ds_read_b64_tr_b16 v[132:133], v72 offset:21024
    ds_read_b64_tr_b16 v[134:135], v72 offset:22336
    ds_read_b64_tr_b16 v[152:153], v72 offset:64
    ds_read_b64_tr_b16 v[154:155], v72 offset:1376
    ds_read_b64_tr_b16 v[156:157], v72 offset:21056
    ds_read_b64_tr_b16 v[158:159], v72 offset:22368
    ds_read_b64_tr_b16 v[176:177], v72 offset:96
    ds_read_b64_tr_b16 v[178:179], v72 offset:1408
    ds_read_b64_tr_b16 v[180:181], v72 offset:21088
    ds_read_b64_tr_b16 v[182:183], v72 offset:22400
    ds_read_b64_tr_b16 v[200:201], v72 offset:128
    ds_read_b64_tr_b16 v[202:203], v72 offset:1440
    ds_read_b64_tr_b16 v[204:205], v72 offset:21120
    ds_read_b64_tr_b16 v[206:207], v72 offset:22432
    ds_read_b64_tr_b16 v[224:225], v72 offset:160
    ds_read_b64_tr_b16 v[226:227], v72 offset:1472
    ds_read_b64_tr_b16 v[228:229], v72 offset:21152
    ds_read_b64_tr_b16 v[230:231], v72 offset:22464
    ds_read_b64_tr_b16 v[248:249], v72 offset:192
    ds_read_b64_tr_b16 v[250:251], v72 offset:1504
    ds_read_b64_tr_b16 v[252:253], v72 offset:21184
    ds_read_b64_tr_b16 v[254:255], v72 offset:22496
    ds_read_b64_tr_b16 v[64:65], v72 offset:224
    ds_read_b64_tr_b16 v[66:67], v72 offset:1536
    ds_read_b64_tr_b16 v[68:69], v72 offset:21216
    ds_read_b64_tr_b16 v[70:71], v72 offset:22528
    s_waitcnt lgkmcnt(0)
    ds_write_b128 v73, v[64:67] offset:4096
    ds_write_b128 v73, v[68:71] offset:5120
    s_waitcnt lgkmcnt(0)
    ds_read_b64_tr_b16 v[64:65], v72 offset:256
    ds_read_b64_tr_b16 v[66:67], v72 offset:1568
    ds_read_b64_tr_b16 v[68:69], v72 offset:21248
    ds_read_b64_tr_b16 v[70:71], v72 offset:22560
    s_waitcnt lgkmcnt(0)
    ds_write_b128 v73, v[64:67] offset:10240
    ds_write_b128 v73, v[68:71] offset:11264
    s_waitcnt lgkmcnt(0)
    ds_read_b64_tr_b16 v[64:65], v72 offset:288
    ds_read_b64_tr_b16 v[66:67], v72 offset:1600
    ds_read_b64_tr_b16 v[68:69], v72 offset:21280
    ds_read_b64_tr_b16 v[70:71], v72 offset:22592
    s_waitcnt lgkmcnt(0)
    ds_write_b128 v73, v[64:67] offset:16384
    ds_write_b128 v73, v[68:71] offset:17408
    s_waitcnt lgkmcnt(0)
    s_waitcnt lgkmcnt(0)
interleave_layers__linear_attn_block__memory_aug_recurrent_mem_tr__prompt_kernel_wo24:
    s_barrier
    s_add_u32 s46, s45, 164480
    buffer_load_dwordx4 v[24:27], v4, s[16:19], s46 offen
    buffer_load_dwordx4 v[28:31], v5, s[16:19], s46 offen
    buffer_load_dwordx4 v[32:35], v6, s[16:19], s46 offen
    buffer_load_dwordx4 v[36:39], v7, s[16:19], s46 offen
    buffer_load_dwordx4 v[40:43], v8, s[16:19], s46 offen
    buffer_load_dwordx4 v[44:47], v9, s[16:19], s46 offen
    buffer_load_dwordx4 v[48:51], v10, s[16:19], s46 offen
    buffer_load_dwordx4 v[52:55], v11, s[16:19], s46 offen
    buffer_load_dwordx4 v[56:59], v12, s[16:19], s46 offen
    buffer_load_dwordx4 v[60:63], v13, s[16:19], s46 offen
    s_waitcnt vmcnt(0)
    ds_write_b128 v14, v[24:27]
    ds_write_b128 v15, v[28:31]
    ds_write_b128 v16, v[32:35]
    ds_write_b128 v17, v[36:39]
    ds_write_b128 v18, v[40:43]
    ds_write_b128 v19, v[44:47]
    ds_write_b128 v20, v[48:51]
    ds_write_b128 v21, v[52:55]
    ds_write_b128 v22, v[56:59]
    ds_write_b128 v23, v[60:63]
    s_waitcnt lgkmcnt(0)
    s_barrier
    s_lshr_b32 s24, s3, 1
    s_cmp_eq_u32 s24, 1
    s_cbranch_scc0 interleave_layers__linear_attn_block__memory_aug_recurrent_mem_tr__prompt_kernel_wo25
    ds_read_b64_tr_b16 v[104:105], v72 offset:0
    ds_read_b64_tr_b16 v[106:107], v72 offset:1312
    ds_read_b64_tr_b16 v[108:109], v72 offset:20992
    ds_read_b64_tr_b16 v[110:111], v72 offset:22304
    ds_read_b64_tr_b16 v[128:129], v72 offset:32
    ds_read_b64_tr_b16 v[130:131], v72 offset:1344
    ds_read_b64_tr_b16 v[132:133], v72 offset:21024
    ds_read_b64_tr_b16 v[134:135], v72 offset:22336
    ds_read_b64_tr_b16 v[152:153], v72 offset:64
    ds_read_b64_tr_b16 v[154:155], v72 offset:1376
    ds_read_b64_tr_b16 v[156:157], v72 offset:21056
    ds_read_b64_tr_b16 v[158:159], v72 offset:22368
    ds_read_b64_tr_b16 v[176:177], v72 offset:96
    ds_read_b64_tr_b16 v[178:179], v72 offset:1408
    ds_read_b64_tr_b16 v[180:181], v72 offset:21088
    ds_read_b64_tr_b16 v[182:183], v72 offset:22400
    ds_read_b64_tr_b16 v[200:201], v72 offset:128
    ds_read_b64_tr_b16 v[202:203], v72 offset:1440
    ds_read_b64_tr_b16 v[204:205], v72 offset:21120
    ds_read_b64_tr_b16 v[206:207], v72 offset:22432
    ds_read_b64_tr_b16 v[224:225], v72 offset:160
    ds_read_b64_tr_b16 v[226:227], v72 offset:1472
    ds_read_b64_tr_b16 v[228:229], v72 offset:21152
    ds_read_b64_tr_b16 v[230:231], v72 offset:22464
    ds_read_b64_tr_b16 v[248:249], v72 offset:192
    ds_read_b64_tr_b16 v[250:251], v72 offset:1504
    ds_read_b64_tr_b16 v[252:253], v72 offset:21184
    ds_read_b64_tr_b16 v[254:255], v72 offset:22496
    ds_read_b64_tr_b16 v[64:65], v72 offset:224
    ds_read_b64_tr_b16 v[66:67], v72 offset:1536
    ds_read_b64_tr_b16 v[68:69], v72 offset:21216
    ds_read_b64_tr_b16 v[70:71], v72 offset:22528
    s_waitcnt lgkmcnt(0)
    ds_write_b128 v73, v[64:67] offset:4096
    ds_write_b128 v73, v[68:71] offset:5120
    s_waitcnt lgkmcnt(0)
    ds_read_b64_tr_b16 v[64:65], v72 offset:256
    ds_read_b64_tr_b16 v[66:67], v72 offset:1568
    ds_read_b64_tr_b16 v[68:69], v72 offset:21248
    ds_read_b64_tr_b16 v[70:71], v72 offset:22560
    s_waitcnt lgkmcnt(0)
    ds_write_b128 v73, v[64:67] offset:10240
    ds_write_b128 v73, v[68:71] offset:11264
    s_waitcnt lgkmcnt(0)
    ds_read_b64_tr_b16 v[64:65], v72 offset:288
    ds_read_b64_tr_b16 v[66:67], v72 offset:1600
    ds_read_b64_tr_b16 v[68:69], v72 offset:21280
    ds_read_b64_tr_b16 v[70:71], v72 offset:22592
    s_waitcnt lgkmcnt(0)
    ds_write_b128 v73, v[64:67] offset:16384
    ds_write_b128 v73, v[68:71] offset:17408
    s_waitcnt lgkmcnt(0)
    s_waitcnt lgkmcnt(0)
interleave_layers__linear_attn_block__memory_aug_recurrent_mem_tr__prompt_kernel_wo25:
    s_barrier
    v_mov_b32 v6, v73
    v_mov_b32 v4, 0x4444
    v_mov_b32 v5, 0xeeee
    v_cmp_gt_u32 vcc, 8, v2
    s_nop 1
    v_cndmask_b32 v4, v5, v4, vcc
    v_lshlrev_b32 v5, 4, v1
    s_lshl_b32 s24, s3, 10
    v_add_u32 v7, s24, v5
    s_lshl_b32 s24, s3, 9
    s_add_u32 s24, s24, 8192
    v_lshlrev_b32 v8, 3, v1
    v_add_u32 v8, s24, v8
    v_and_b32 v64, 7, v2
    v_lshlrev_b32 v9, 5, v64
    v_lshrrev_b32 v64, 3, v2
    v_lshl_add_u32 v9, v64, 4, v9
    v_and_b32 v64, 1, v3
    v_lshl_add_u32 v9, v64, 3, v9
    s_mul_i32 s24, s3, 768
    s_add_u32 s24, s24, 10240
    v_add_u32 v9, s24, v9
    v_lshrrev_b32 v65, 1, v3
    v_lshl_add_u32 v10, v65, 8, v9
    v_lshrrev_b32 v64, 2, v2
    v_lshlrev_b32 v11, 5, v64
    v_and_b32 v64, 3, v2
    v_lshl_add_u32 v11, v64, 3, v11
    v_lshl_add_u32 v11, v3, 8, v11
    v_add_u32 v11, 10240, v11
    s_mul_i32 s24, s3, 10
    s_lshl_b32 s24, s24, 14
    s_lshl_b32 s25, s44, 8
    s_add_u32 s24, s24, s25
    v_lshlrev_b32 v14, 14, v3
    v_lshl_add_u32 v14, v2, 4, v14
    v_add_u32 v14, s24, v14
    v_lshrrev_b32 v64, 1, v3
    v_lshlrev_b32 v15, 14, v64
    v_lshl_add_u32 v15, v2, 4, v15
    v_add_u32 v15, s24, v15
    v_add_u32 v15, 131072, v15
    v_and_b32 v64, 1, v3
    v_cmp_eq_u32 vcc, 0, v64
    v_mov_b32 v64, 2146435072
    s_nop 0
    v_cndmask_b32 v15, v64, v15, vcc
    s_and_b32 s24, s2, 15
    s_mul_i32 s25, s3, 16
    s_add_u32 s24, s24, s25
    s_lshl_b32 s24, s24, 7
    v_mov_b32 v12, s24
    v_mov_b32 v0, 1
interleave_layers__linear_attn_block__memory_aug_recurrent_mem_tr__prompt_kernel_v_layer:
    s_mov_b32 s93, 0
    s_lshl_b32 s24, s93, 12
    s_and_b32 s24, s24, 0x2000
    s_xor_b32 s24, s24, s36
    s_lshl_b32 s93, s93, 20
    s_add_u32 s93, s93, s24
    s_add_u32 s93, s93, 117440512
    s_mul_i32 s94, s92, 16384
    s_add_u32 s94, s94, 23068672
    s_lshl_b32 s24, s3, 6
    s_add_u32 s24, s24, 0
    v_add_u32 v64, s24, v1
    v_and_b32 v65, 7, v64
    v_mul_u32_u24 v65, 1280, v65
    v_lshrrev_b32 v66, 3, v64
    v_lshl_add_u32 v65, v66, 4, v65
    v_cmp_gt_u32 vcc, 640, v64
    v_mov_b32 v67, 2146435072
    s_nop 0
    v_cndmask_b32 v65, v67, v65, vcc
    buffer_load_dwordx4 v[68:71], v65, s[20:23], 0 offen
    v_lshlrev_b32 v64, 4, v64
    s_waitcnt vmcnt(0)
    s_and_saveexec_b64 s[30:31], vcc
    ds_write_b128 v64, v[68:71]
    s_mov_b64 exec, s[30:31]
    s_lshl_b32 s24, s3, 6
    s_add_u32 s24, s24, 256
    v_add_u32 v64, s24, v1
    v_and_b32 v65, 7, v64
    v_mul_u32_u24 v65, 1280, v65
    v_lshrrev_b32 v66, 3, v64
    v_lshl_add_u32 v65, v66, 4, v65
    v_cmp_gt_u32 vcc, 640, v64
    v_mov_b32 v67, 2146435072
    s_nop 0
    v_cndmask_b32 v65, v67, v65, vcc
    buffer_load_dwordx4 v[68:71], v65, s[20:23], 0 offen
    v_lshlrev_b32 v64, 4, v64
    s_waitcnt vmcnt(0)
    s_and_saveexec_b64 s[30:31], vcc
    ds_write_b128 v64, v[68:71]
    s_mov_b64 exec, s[30:31]
    s_lshl_b32 s24, s3, 6
    s_add_u32 s24, s24, 512
    v_add_u32 v64, s24, v1
    v_and_b32 v65, 7, v64
    v_mul_u32_u24 v65, 1280, v65
    v_lshrrev_b32 v66, 3, v64
    v_lshl_add_u32 v65, v66, 4, v65
    v_cmp_gt_u32 vcc, 640, v64
    v_mov_b32 v67, 2146435072
    s_nop 0
    v_cndmask_b32 v65, v67, v65, vcc
    buffer_load_dwordx4 v[68:71], v65, s[20:23], 0 offen
    v_lshlrev_b32 v64, 4, v64
    s_waitcnt vmcnt(0)
    s_and_saveexec_b64 s[30:31], vcc
    ds_write_b128 v64, v[68:71]
    s_mov_b64 exec, s[30:31]
    s_mov_b32 s40, 0
    s_mov_b32 s37, s93
    s_add_u32 s43, s93, 0
    s_lshl_b32 s95, s92, 6
    s_add_u32 s95, s95, s40
    s_add_u32 s95, s95, 1
    s_cmp_ge_i32 s59, s95
    s_cbranch_scc1 interleave_layers__linear_attn_block__memory_aug_recurrent_mem_tr__prompt_kernel_v_ec0_ok
    s_and_b32 s24, s2, 7
    s_lshl_b32 s24, s24, 7
    s_add_u32 s24, s24, 23109632
    v_and_b32 v65, 3, v1
    v_lshl_add_u32 v65, v65, 2, s24
    s_mov_b32 s61, 0
interleave_layers__linear_attn_block__memory_aug_recurrent_mem_tr__prompt_kernel_v_ec0:
    buffer_load_dword v64, v65, s[8:11], 0 offen sc1
    s_waitcnt vmcnt(0)
    v_readlane_b32 s59, v64, 0
    v_readlane_b32 s24, v64, 1
    s_min_i32 s59, s59, s24
    v_readlane_b32 s24, v64, 2
    s_min_i32 s59, s59, s24
    s_cmp_ge_i32 s59, s95
    s_cbranch_scc1 interleave_layers__linear_attn_block__memory_aug_recurrent_mem_tr__prompt_kernel_v_ec0_ok
    s_add_u32 s61, s61, 1
    s_cmp_ge_u32 s61, s60
    s_cbranch_scc1 interleave_layers__linear_attn_block__memory_aug_recurrent_mem_tr__prompt_kernel_v_ec0_to
    s_sleep 2
    s_branch interleave_layers__linear_attn_block__memory_aug_recurrent_mem_tr__prompt_kernel_v_ec0
interleave_layers__linear_attn_block__memory_aug_recurrent_mem_tr__prompt_kernel_v_ec0_to:
    s_mov_b32 s60, 1
interleave_layers__linear_attn_block__memory_aug_recurrent_mem_tr__prompt_kernel_v_ec0_ok:
    v_mov_b32 v16, 0
    v_mov_b32 v17, 0
    v_mov_b32 v18, 0
    v_mov_b32 v19, 0
    v_mov_b32 v20, 0
    v_mov_b32 v21, 0
    v_mov_b32 v22, 0
    v_mov_b32 v23, 0
    v_mov_b32 v24, 0
    v_mov_b32 v25, 0
    v_mov_b32 v26, 0
    v_mov_b32 v27, 0
    v_mov_b32 v28, 0
    v_mov_b32 v29, 0
    v_mov_b32 v30, 0
    v_mov_b32 v31, 0
    v_mov_b32 v32, 0
    v_mov_b32 v33, 0
    v_mov_b32 v34, 0
    v_mov_b32 v35, 0
    v_mov_b32 v36, 0
    v_mov_b32 v37, 0
    v_mov_b32 v38, 0
    v_mov_b32 v39, 0
    v_mov_b32 v40, 0
    v_mov_b32 v41, 0
    v_mov_b32 v42, 0
    v_mov_b32 v43, 0
    v_mov_b32 v44, 0
    v_mov_b32 v45, 0
    v_mov_b32 v46, 0
    v_mov_b32 v47, 0
    v_mov_b32 v48, 0
    v_mov_b32 v49, 0
    v_mov_b32 v50, 0
    v_mov_b32 v51, 0
    v_mov_b32 v52, 0
    v_mov_b32 v53, 0
    v_mov_b32 v54, 0
    v_mov_b32 v55, 0
    v_mov_b32 v56, 0
    v_mov_b32 v57, 0
    v_mov_b32 v58, 0
    v_mov_b32 v59, 0
    v_mov_b32 v60, 0
    v_mov_b32 v61, 0
    v_mov_b32 v62, 0
    v_mov_b32 v63, 0
    v_mov_b32 v64, 0
    v_mov_b32 v65, 0
    v_mov_b32 v66, 0
    v_mov_b32 v67, 0
    s_waitcnt lgkmcnt(0)
    s_barrier
    ds_read_b128 v[68:71], v7
    ds_read_b128 v[72:75], v7 offset:4096
    s_waitcnt lgkmcnt(0)
    s_cmp_eq_u32 s3, 0
    s_cbranch_scc1 interleave_layers__linear_attn_block__memory_aug_recurrent_mem_tr__prompt_kernel_v_gow0
    s_cmp_eq_u32 s3, 1
    s_cbranch_scc1 interleave_layers__linear_attn_block__memory_aug_recurrent_mem_tr__prompt_kernel_v_gow1
    s_cmp_eq_u32 s3, 2
    s_cbranch_scc1 interleave_layers__linear_attn_block__memory_aug_recurrent_mem_tr__prompt_kernel_v_gow2
    s_branch interleave_layers__linear_attn_block__memory_aug_recurrent_mem_tr__prompt_kernel_v_gow3
interleave_layers__linear_attn_block__memory_aug_recurrent_mem_tr__prompt_kernel_v_stepw0:
    v_mov_b32 v16, 0
    v_mov_b32 v17, 0
    v_mov_b32 v18, 0
    v_mov_b32 v19, 0
    v_mov_b32 v20, 0
    v_mov_b32 v21, 0
    v_mov_b32 v22, 0
    v_mov_b32 v23, 0
    v_mov_b32 v24, 0
    v_mov_b32 v25, 0
    v_mov_b32 v26, 0
    v_mov_b32 v27, 0
    v_mov_b32 v28, 0
    v_mov_b32 v29, 0
    v_mov_b32 v30, 0
    v_mov_b32 v31, 0
    v_mov_b32 v32, 0
    v_mov_b32 v33, 0
    v_mov_b32 v34, 0
    v_mov_b32 v35, 0
    v_mov_b32 v36, 0
    v_mov_b32 v37, 0
    v_mov_b32 v38, 0
    v_mov_b32 v39, 0
    v_mov_b32 v40, 0
    v_mov_b32 v41, 0
    v_mov_b32 v42, 0
    v_mov_b32 v43, 0
    v_mov_b32 v44, 0
    v_mov_b32 v45, 0
    v_mov_b32 v46, 0
    v_mov_b32 v47, 0
    v_mov_b32 v48, 0
    v_mov_b32 v49, 0
    v_mov_b32 v50, 0
    v_mov_b32 v51, 0
    v_mov_b32 v52, 0
    v_mov_b32 v53, 0
    v_mov_b32 v54, 0
    v_mov_b32 v55, 0
    v_mov_b32 v56, 0
    v_mov_b32 v57, 0
    v_mov_b32 v58, 0
    v_mov_b32 v59, 0
    v_mov_b32 v60, 0
    v_mov_b32 v61, 0
    v_mov_b32 v62, 0
    v_mov_b32 v63, 0
    v_mov_b32 v64, 0
    v_mov_b32 v65, 0
    v_mov_b32 v66, 0
    v_mov_b32 v67, 0
    s_add_u32 s48, s47, 4096
    s_add_u32 s50, s47, 8192
    s_lshl_b32 s95, s92, 6
    s_add_u32 s95, s95, s40
    s_add_u32 s95, s95, 1
    s_cmp_ge_i32 s59, s95
    s_cbranch_scc1 interleave_layers__linear_attn_block__memory_aug_recurrent_mem_tr__prompt_kernel_v_ecw0_ok
    s_and_b32 s24, s2, 7
    s_lshl_b32 s24, s24, 7
    s_add_u32 s24, s24, 23109632
    v_and_b32 v79, 3, v1
    v_lshl_add_u32 v79, v79, 2, s24
    s_mov_b32 s61, 0
interleave_layers__linear_attn_block__memory_aug_recurrent_mem_tr__prompt_kernel_v_ecw0:
    buffer_load_dword v78, v79, s[8:11], 0 offen sc1
    s_waitcnt vmcnt(0)
    v_readlane_b32 s59, v78, 0
    v_readlane_b32 s24, v78, 1
    s_min_i32 s59, s59, s24
    v_readlane_b32 s24, v78, 2
    s_min_i32 s59, s59, s24
    s_cmp_ge_i32 s59, s95
    s_cbranch_scc1 interleave_layers__linear_attn_block__memory_aug_recurrent_mem_tr__prompt_kernel_v_ecw0_ok
    s_add_u32 s61, s61, 1
    s_cmp_ge_u32 s61, s60
    s_cbranch_scc1 interleave_layers__linear_attn_block__memory_aug_recurrent_mem_tr__prompt_kernel_v_ecw0_to
    s_sleep 2
    s_branch interleave_layers__linear_attn_block__memory_aug_recurrent_mem_tr__prompt_kernel_v_ecw0
interleave_layers__linear_attn_block__memory_aug_recurrent_mem_tr__prompt_kernel_v_ecw0_to:
    s_mov_b32 s60, 1
interleave_layers__linear_attn_block__memory_aug_recurrent_mem_tr__prompt_kernel_v_ecw0_ok:
    s_sleep 20
    s_mov_b64 exec, 1
    s_mov_b32 s61, 0
    v_mov_b32 v81, 0
    buffer_atomic_add v81, v12, s[8:11], s45 offen sc0
    s_sleep 2
    v_mov_b32 v82, 0
    buffer_atomic_add v82, v12, s[8:11], s45 offen sc0
    s_sleep 2
    v_mov_b32 v83, 0
    buffer_atomic_add v83, v12, s[8:11], s45 offen sc0
    s_sleep 2
interleave_layers__linear_attn_block__memory_aug_recurrent_mem_tr__prompt_kernel_v_prw0:
    v_mov_b32 v80, 0
    buffer_atomic_add v80, v12, s[8:11], s45 offen sc0
    s_waitcnt vmcnt(3)
    v_cmp_le_i32 vcc, 9, v81
    s_add_u32 s61, s61, 1
    s_cbranch_vccnz interleave_layers__linear_attn_block__memory_aug_recurrent_mem_tr__prompt_kernel_v_prw0_out
    s_sleep 2
    v_mov_b32 v81, 0
    buffer_atomic_add v81, v12, s[8:11], s45 offen sc0
    s_waitcnt vmcnt(3)
    v_cmp_le_i32 vcc, 9, v82
    s_add_u32 s61, s61, 1
    s_cbranch_vccnz interleave_layers__linear_attn_block__memory_aug_recurrent_mem_tr__prompt_kernel_v_prw0_out
    s_sleep 2
    v_mov_b32 v82, 0
    buffer_atomic_add v82, v12, s[8:11], s45 offen sc0
    s_waitcnt vmcnt(3)
    v_cmp_le_i32 vcc, 9, v83
    s_add_u32 s61, s61, 1
    s_cbranch_vccnz interleave_layers__linear_attn_block__memory_aug_recurrent_mem_tr__prompt_kernel_v_prw0_out
    s_sleep 2
    v_mov_b32 v83, 0
    buffer_atomic_add v83, v12, s[8:11], s45 offen sc0
    s_waitcnt vmcnt(3)
    v_cmp_le_i32 vcc, 9, v80
    s_add_u32 s61, s61, 1
    s_cbranch_vccnz interleave_layers__linear_attn_block__memory_aug_recurrent_mem_tr__prompt_kernel_v_prw0_out
    s_sleep 2
    s_cmp_ge_u32 s61, s60
    s_cbranch_scc0 interleave_layers__linear_attn_block__memory_aug_recurrent_mem_tr__prompt_kernel_v_prw0
    s_mov_b32 s60, 1
interleave_layers__linear_attn_block__memory_aug_recurrent_mem_tr__prompt_kernel_v_prw0_out:
    s_mov_b64 exec, -1
    buffer_load_dwordx4 v[68:71], v7, s[8:11], s47 offen sc1
    buffer_load_dwordx4 v[72:75], v7, s[8:11], s48 offen sc1
    buffer_load_dwordx2 v[76:77], v8, s[8:11], s50 offen sc1
    s_waitcnt vmcnt(0)
    v_max3_u32 v103, v68, v69, v70
    v_max3_u32 v103, v103, v71, v72
    v_max3_u32 v103, v103, v73, v74
    v_max3_u32 v103, v103, v75, v76
    v_max_u32 v103, v103, v77
    v_cmp_eq_u32 vcc, -1, v103
    s_cbranch_vccz interleave_layers__linear_attn_block__memory_aug_recurrent_mem_tr__prompt_kernel_v_pmw0_out
    s_mov_b32 s61, 0
interleave_layers__linear_attn_block__memory_aug_recurrent_mem_tr__prompt_kernel_v_pmw0:
    buffer_load_dwordx4 v[68:71], v7, s[8:11], s47 offen sc1
    buffer_load_dwordx4 v[72:75], v7, s[8:11], s48 offen sc1
    buffer_load_dwordx2 v[76:77], v8, s[8:11], s50 offen sc1
    s_waitcnt vmcnt(0)
    v_max3_u32 v103, v68, v69, v70
    v_max3_u32 v103, v103, v71, v72
    v_max3_u32 v103, v103, v73, v74
    v_max3_u32 v103, v103, v75, v76
    v_max_u32 v103, v103, v77
    v_cmp_eq_u32 vcc, -1, v103
    s_add_u32 s61, s61, 1
    s_cbranch_vccz interleave_layers__linear_attn_block__memory_aug_recurrent_mem_tr__prompt_kernel_v_pmw0_out
    s_cmp_ge_u32 s61, s60
    s_cbranch_scc1 interleave_layers__linear_attn_block__memory_aug_recurrent_mem_tr__prompt_kernel_v_pmw0_to
    s_sleep 1
    s_branch interleave_layers__linear_attn_block__memory_aug_recurrent_mem_tr__prompt_kernel_v_pmw0
interleave_layers__linear_attn_block__memory_aug_recurrent_mem_tr__prompt_kernel_v_pmw0_to:
    s_mov_b32 s60, 1
interleave_layers__linear_attn_block__memory_aug_recurrent_mem_tr__prompt_kernel_v_pmw0_out:
    ds_write_b128 v7, v[68:71]
    ds_write_b128 v7, v[72:75] offset:4096
    ds_write_b64 v8, v[76:77]
interleave_layers__linear_attn_block__memory_aug_recurrent_mem_tr__prompt_kernel_v_gow0:
    v_smfmac_f32_16x16x64_bf16 v[56:59], v[68:71], a[0:7], v4
    v_smfmac_f32_16x16x64_bf16 v[60:63], v[68:71], a[80:87], v4
    v_smfmac_f32_16x16x64_bf16 v[64:67], v[68:71], a[160:167], v4
    s_waitcnt lgkmcnt(0)
    s_barrier
    ds_read_b128 v[80:83], v5 offset:1024
    ds_read_b128 v[84:87], v5 offset:2048
    ds_read_b128 v[88:91], v5 offset:3072
    ds_read_b128 v[92:95], v5 offset:5120
    ds_read_b128 v[96:99], v5 offset:6144
    ds_read_b128 v[100:103], v5 offset:7168
    ds_read_b128 v[76:79], v5 offset:8192
    ds_read_b128 v[68:71], v5 offset:9216
    v_smfmac_f32_16x16x64_bf16 v[64:67], v[72:75], a[192:199], v4
    v_smfmac_f32_16x16x64_bf16 v[56:59], v[72:75], a[32:39], v4
    v_smfmac_f32_16x16x64_bf16 v[60:63], v[72:75], a[112:119], v4
    s_waitcnt lgkmcnt(7)
    v_smfmac_f32_16x16x64_bf16 v[64:67], v[80:83], a[168:175], v4
    s_waitcnt lgkmcnt(6)
    v_smfmac_f32_16x16x64_bf16 v[64:67], v[84:87], a[176:183], v4
    s_waitcnt lgkmcnt(5)
    v_smfmac_f32_16x16x64_bf16 v[64:67], v[88:91], a[184:191], v4
    s_waitcnt lgkmcnt(4)
    v_smfmac_f32_16x16x64_bf16 v[64:67], v[92:95], a[200:207], v4
    s_waitcnt lgkmcnt(3)
    v_smfmac_f32_16x16x64_bf16 v[64:67], v[96:99], a[208:215], v4
    s_waitcnt lgkmcnt(2)
    v_smfmac_f32_16x16x64_bf16 v[64:67], v[100:103], a[216:223], v4
    s_waitcnt lgkmcnt(1)
    v_smfmac_f32_16x16x64_bf16 v[64:67], v[76:79], a[224:231], v4
    s_waitcnt lgkmcnt(0)
    v_smfmac_f32_16x16x64_bf16 v[64:67], v[68:71], a[232:239], v4
    v_smfmac_f32_16x16x64_bf16 v[56:59], v[80:83], a[8:15], v4
    v_smfmac_f32_16x16x64_bf16 v[60:63], v[80:83], a[88:95], v4
    v_smfmac_f32_16x16x64_bf16 v[56:59], v[84:87], a[16:23], v4
    s_nop 4
    v_mov_b32 v72, v64
    v_smfmac_f32_16x16x64_bf16 v[60:63], v[84:87], a[96:103], v4
    v_mov_b32 v73, v65
    v_mov_b32 v74, v66
    v_smfmac_f32_16x16x64_bf16 v[56:59], v[88:91], a[24:31], v4
    v_mov_b32 v75, v67
    v_smfmac_f32_16x16x64_bf16 v[60:63], v[88:91], a[104:111], v4
    v_permlane32_swap_b32 v64, v72
    v_permlane32_swap_b32 v65, v73
    v_smfmac_f32_16x16x64_bf16 v[56:59], v[92:95], a[40:47], v4
    v_permlane32_swap_b32 v66, v74
    v_permlane32_swap_b32 v67, v75
    v_smfmac_f32_16x16x64_bf16 v[60:63], v[92:95], a[120:127], v4
    v_add_f32 v64, v64, v72
    v_add_f32 v65, v65, v73
    v_smfmac_f32_16x16x64_bf16 v[56:59], v[96:99], a[48:55], v4
    v_add_f32 v66, v66, v74
    v_add_f32 v67, v67, v75
    v_smfmac_f32_16x16x64_bf16 v[60:63], v[96:99], a[128:135], v4
    v_cvt_pk_bf16_f32 v72, v64, v65
    v_cvt_pk_bf16_f32 v73, v66, v67
    v_smfmac_f32_16x16x64_bf16 v[56:59], v[100:103], a[56:63], v4
    ds_write_b64 v9, v[72:73] offset:512
    v_smfmac_f32_16x16x64_bf16 v[60:63], v[100:103], a[136:143], v4
    v_smfmac_f32_16x16x64_bf16 v[56:59], v[76:79], a[64:71], v4
    v_smfmac_f32_16x16x64_bf16 v[60:63], v[76:79], a[144:151], v4
    v_smfmac_f32_16x16x64_bf16 v[56:59], v[68:71], a[72:79], v4
    v_smfmac_f32_16x16x64_bf16 v[60:63], v[68:71], a[152:159], v4
    s_nop 7
    v_permlane32_swap_b32 v56, v60
    v_permlane32_swap_b32 v57, v61
    v_permlane32_swap_b32 v58, v62
    v_permlane32_swap_b32 v59, v63
    v_add_f32 v56, v56, v60
    v_add_f32 v57, v57, v61
    v_add_f32 v58, v58, v62
    v_add_f32 v59, v59, v63
    v_cvt_pk_bf16_f32 v68, v56, v57
    v_cvt_pk_bf16_f32 v69, v58, v59
    ds_write_b64 v10, v[68:69]
    s_waitcnt lgkmcnt(0)
    s_barrier
    ds_read_b64_tr_b16 v[68:69], v11 offset:0
    ds_read_b64_tr_b16 v[70:71], v11 offset:128
    ds_read_b64_tr_b16 v[72:73], v11 offset:1024
    ds_read_b64_tr_b16 v[74:75], v11 offset:1152
    ds_read_b64_tr_b16 v[76:77], v11 offset:2048
    ds_read_b64_tr_b16 v[78:79], v11 offset:2176
    ds_read_b128 v[80:83], v6 offset:0
    ds_read_b128 v[84:87], v6 offset:1024
    ds_read_b128 v[88:91], v6 offset:2048
    ds_read_b128 v[92:95], v6 offset:3072
    ds_read_b128 v[96:99], v6 offset:4096
    ds_read_b128 v[100:103], v6 offset:5120
    s_waitcnt lgkmcnt(10)
    v_smfmac_f32_16x16x64_bf16 v[16:19], v[68:71], a[240:247], v4
    v_smfmac_f32_16x16x64_bf16 v[20:23], v[68:71], v[112:119], v4
    v_smfmac_f32_16x16x64_bf16 v[24:27], v[68:71], v[136:143], v4
    v_smfmac_f32_16x16x64_bf16 v[28:31], v[68:71], v[160:167], v4
    s_waitcnt lgkmcnt(8)
    v_smfmac_f32_16x16x64_bf16 v[16:19], v[72:75], a[248:255], v4
    v_smfmac_f32_16x16x64_bf16 v[20:23], v[72:75], v[120:127], v4
    v_smfmac_f32_16x16x64_bf16 v[24:27], v[72:75], v[144:151], v4
    v_smfmac_f32_16x16x64_bf16 v[28:31], v[72:75], v[168:175], v4
    s_waitcnt lgkmcnt(6)
    v_smfmac_f32_16x16x64_bf16 v[16:19], v[76:79], v[104:111], v4
    v_smfmac_f32_16x16x64_bf16 v[20:23], v[76:79], v[128:135], v4
    v_smfmac_f32_16x16x64_bf16 v[24:27], v[76:79], v[152:159], v4
    v_smfmac_f32_16x16x64_bf16 v[28:31], v[76:79], v[176:183], v4
    v_smfmac_f32_16x16x64_bf16 v[32:35], v[68:71], v[184:191], v4
    v_smfmac_f32_16x16x64_bf16 v[36:39], v[68:71], v[208:215], v4
    s_nop 4
    v_permlane32_swap_b32 v16, v24
    v_permlane32_swap_b32 v17, v25
    v_smfmac_f32_16x16x64_bf16 v[40:43], v[68:71], v[232:239], v4
    v_permlane32_swap_b32 v18, v26
    v_permlane32_swap_b32 v19, v27
    s_waitcnt lgkmcnt(4)
    v_smfmac_f32_16x16x64_bf16 v[44:47], v[68:71], v[80:87], v4
    v_add_f32 v16, v16, v24
    v_add_f32 v17, v17, v25
    ds_read_b128 v[80:83], v6 offset:6144
    ds_read_b128 v[84:87], v6 offset:7168
    v_smfmac_f32_16x16x64_bf16 v[32:35], v[72:75], v[192:199], v4
    v_add_f32 v18, v18, v26
    v_add_f32 v19, v19, v27
    v_smfmac_f32_16x16x64_bf16 v[36:39], v[72:75], v[216:223], v4
    v_permlane32_swap_b32 v20, v28
    v_permlane32_swap_b32 v21, v29
    v_smfmac_f32_16x16x64_bf16 v[40:43], v[72:75], v[240:247], v4
    v_permlane32_swap_b32 v22, v30
    v_permlane32_swap_b32 v23, v31
    s_waitcnt lgkmcnt(4)
    v_smfmac_f32_16x16x64_bf16 v[44:47], v[72:75], v[88:95], v4
    v_add_f32 v20, v20, v28
    v_add_f32 v21, v21, v29
    ds_read_b128 v[88:91], v6 offset:8192
    ds_read_b128 v[92:95], v6 offset:9216
    v_smfmac_f32_16x16x64_bf16 v[32:35], v[76:79], v[200:207], v4
    v_add_f32 v22, v22, v30
    v_add_f32 v23, v23, v31
    v_smfmac_f32_16x16x64_bf16 v[36:39], v[76:79], v[224:231], v4
    v_cvt_pk_bf16_f32 v56, v16, v17
    v_cvt_pk_bf16_f32 v57, v18, v19
    v_smfmac_f32_16x16x64_bf16 v[40:43], v[76:79], v[248:255], v4
    v_cvt_pk_bf16_f32 v58, v20, v21
    v_cvt_pk_bf16_f32 v59, v22, v23
    s_waitcnt lgkmcnt(4)
    v_smfmac_f32_16x16x64_bf16 v[44:47], v[76:79], v[96:103], v4
    v_permlane16_swap_b32 v56, v58
    ds_read_b128 v[96:99], v6 offset:10240
    ds_read_b128 v[100:103], v6 offset:11264
    v_permlane16_swap_b32 v57, v59
    v_min_u32 v56, -2, v56
    v_min_u32 v57, -2, v57
    v_min_u32 v58, -2, v58
    v_min_u32 v59, -2, v59
    buffer_store_dwordx4 v[56:59], v14, s[8:11], s43 offen sc1
    s_add_u32 s49, s43, 65536
    s_waitcnt lgkmcnt(4)
    v_smfmac_f32_16x16x64_bf16 v[48:51], v[68:71], v[80:87], v4
    v_permlane32_swap_b32 v32, v40
    v_permlane32_swap_b32 v33, v41
    v_permlane32_swap_b32 v34, v42
    ds_read_b128 v[80:83], v6 offset:12288
    ds_read_b128 v[84:87], v6 offset:13312
    s_waitcnt lgkmcnt(4)
    v_smfmac_f32_16x16x64_bf16 v[48:51], v[72:75], v[88:95], v4
    v_permlane32_swap_b32 v35, v43
    v_add_f32 v32, v32, v40
    v_add_f32 v33, v33, v41
    v_add_f32 v34, v34, v42
    ds_read_b128 v[88:91], v6 offset:14336
    ds_read_b128 v[92:95], v6 offset:15360
    s_waitcnt lgkmcnt(4)
    v_smfmac_f32_16x16x64_bf16 v[48:51], v[76:79], v[96:103], v4
    v_add_f32 v35, v35, v43
    v_permlane32_swap_b32 v36, v44
    v_permlane32_swap_b32 v37, v45
    v_permlane32_swap_b32 v38, v46
    ds_read_b128 v[96:99], v6 offset:16384
    ds_read_b128 v[100:103], v6 offset:17408
    v_permlane32_swap_b32 v39, v47
    v_add_f32 v36, v36, v44
    v_add_f32 v37, v37, v45
    v_add_f32 v38, v38, v46
    s_waitcnt lgkmcnt(4)
    v_smfmac_f32_16x16x64_bf16 v[52:55], v[68:71], v[80:87], v4
    v_add_f32 v39, v39, v47
    v_cvt_pk_bf16_f32 v60, v32, v33
    v_cvt_pk_bf16_f32 v61, v34, v35
    s_waitcnt lgkmcnt(2)
    v_smfmac_f32_16x16x64_bf16 v[52:55], v[72:75], v[88:95], v4
    v_cvt_pk_bf16_f32 v62, v36, v37
    v_cvt_pk_bf16_f32 v63, v38, v39
    s_waitcnt lgkmcnt(0)
    v_smfmac_f32_16x16x64_bf16 v[52:55], v[76:79], v[96:103], v4
    v_permlane16_swap_b32 v60, v62
    v_permlane16_swap_b32 v61, v63
    v_min_u32 v60, -2, v60
    v_min_u32 v61, -2, v61
    v_min_u32 v62, -2, v62
    v_min_u32 v63, -2, v63
    buffer_store_dwordx4 v[60:63], v14, s[8:11], s49 offen sc1
    s_nop 0
    v_permlane32_swap_b32 v48, v52
    v_permlane32_swap_b32 v49, v53
    v_permlane32_swap_b32 v50, v54
    v_permlane32_swap_b32 v51, v55
    v_add_f32 v48, v48, v52
    v_add_f32 v49, v49, v53
    v_add_f32 v50, v50, v54
    v_add_f32 v51, v51, v55
    v_cvt_pk_bf16_f32 v64, v48, v49
    v_cvt_pk_bf16_f32 v65, v50, v51
    v_mov_b32 v66, v64
    v_mov_b32 v67, v65
    s_nop 0
    v_permlane16_swap_b32 v64, v66
    v_permlane16_swap_b32 v65, v67
    v_min_u32 v64, -2, v64
    v_min_u32 v65, -2, v65
    v_min_u32 v66, -2, v66
    v_min_u32 v67, -2, v67
    buffer_store_dwordx4 v[64:67], v15, s[8:11], s43 offen sc1
    s_add_u32 s40, s40, 1
    s_add_u32 s47, s37, 704512
    s_add_u32 s45, s37, 737280
    s_lshl_b32 s24, s40, 12
    s_and_b32 s24, s24, 0x2000
    s_xor_b32 s24, s24, s36
    s_lshl_b32 s37, s40, 20
    s_add_u32 s37, s37, s24
    s_add_u32 s37, s37, 117440512
    s_add_u32 s43, s37, 0
    s_cmp_lt_u32 s40, 64
    s_cbranch_scc1 interleave_layers__linear_attn_block__memory_aug_recurrent_mem_tr__prompt_kernel_v_stepw0
    s_branch interleave_layers__linear_attn_block__memory_aug_recurrent_mem_tr__prompt_kernel_v_end
interleave_layers__linear_attn_block__memory_aug_recurrent_mem_tr__prompt_kernel_v_stepw1:
    v_mov_b32 v16, 0
    v_mov_b32 v17, 0
    v_mov_b32 v18, 0
    v_mov_b32 v19, 0
    v_mov_b32 v20, 0
    v_mov_b32 v21, 0
    v_mov_b32 v22, 0
    v_mov_b32 v23, 0
    v_mov_b32 v24, 0
    v_mov_b32 v25, 0
    v_mov_b32 v26, 0
    v_mov_b32 v27, 0
    v_mov_b32 v28, 0
    v_mov_b32 v29, 0
    v_mov_b32 v30, 0
    v_mov_b32 v31, 0
    v_mov_b32 v32, 0
    v_mov_b32 v33, 0
    v_mov_b32 v34, 0
    v_mov_b32 v35, 0
    v_mov_b32 v36, 0
    v_mov_b32 v37, 0
    v_mov_b32 v38, 0
    v_mov_b32 v39, 0
    v_mov_b32 v40, 0
    v_mov_b32 v41, 0
    v_mov_b32 v42, 0
    v_mov_b32 v43, 0
    v_mov_b32 v44, 0
    v_mov_b32 v45, 0
    v_mov_b32 v46, 0
    v_mov_b32 v47, 0
    v_mov_b32 v48, 0
    v_mov_b32 v49, 0
    v_mov_b32 v50, 0
    v_mov_b32 v51, 0
    v_mov_b32 v52, 0
    v_mov_b32 v53, 0
    v_mov_b32 v54, 0
    v_mov_b32 v55, 0
    v_mov_b32 v56, 0
    v_mov_b32 v57, 0
    v_mov_b32 v58, 0
    v_mov_b32 v59, 0
    v_mov_b32 v60, 0
    v_mov_b32 v61, 0
    v_mov_b32 v62, 0
    v_mov_b32 v63, 0
    v_mov_b32 v64, 0
    v_mov_b32 v65, 0
    v_mov_b32 v66, 0
    v_mov_b32 v67, 0
    s_add_u32 s48, s47, 4096
    s_add_u32 s50, s47, 8192
    s_lshl_b32 s95, s92, 6
    s_add_u32 s95, s95, s40
    s_add_u32 s95, s95, 1
    s_cmp_ge_i32 s59, s95
    s_cbranch_scc1 interleave_layers__linear_attn_block__memory_aug_recurrent_mem_tr__prompt_kernel_v_ecw1_ok
    s_and_b32 s24, s2, 7
    s_lshl_b32 s24, s24, 7
    s_add_u32 s24, s24, 23109632
    v_and_b32 v79, 3, v1
    v_lshl_add_u32 v79, v79, 2, s24
    s_mov_b32 s61, 0
interleave_layers__linear_attn_block__memory_aug_recurrent_mem_tr__prompt_kernel_v_ecw1:
    buffer_load_dword v78, v79, s[8:11], 0 offen sc1
    s_waitcnt vmcnt(0)
    v_readlane_b32 s59, v78, 0
    v_readlane_b32 s24, v78, 1
    s_min_i32 s59, s59, s24
    v_readlane_b32 s24, v78, 2
    s_min_i32 s59, s59, s24
    s_cmp_ge_i32 s59, s95
    s_cbranch_scc1 interleave_layers__linear_attn_block__memory_aug_recurrent_mem_tr__prompt_kernel_v_ecw1_ok
    s_add_u32 s61, s61, 1
    s_cmp_ge_u32 s61, s60
    s_cbranch_scc1 interleave_layers__linear_attn_block__memory_aug_recurrent_mem_tr__prompt_kernel_v_ecw1_to
    s_sleep 2
    s_branch interleave_layers__linear_attn_block__memory_aug_recurrent_mem_tr__prompt_kernel_v_ecw1
interleave_layers__linear_attn_block__memory_aug_recurrent_mem_tr__prompt_kernel_v_ecw1_to:
    s_mov_b32 s60, 1
interleave_layers__linear_attn_block__memory_aug_recurrent_mem_tr__prompt_kernel_v_ecw1_ok:
    s_sleep 20
    s_mov_b64 exec, 1
    s_mov_b32 s61, 0
    v_mov_b32 v81, 0
    buffer_atomic_add v81, v12, s[8:11], s45 offen sc0
    s_sleep 2
    v_mov_b32 v82, 0
    buffer_atomic_add v82, v12, s[8:11], s45 offen sc0
    s_sleep 2
    v_mov_b32 v83, 0
    buffer_atomic_add v83, v12, s[8:11], s45 offen sc0
    s_sleep 2
interleave_layers__linear_attn_block__memory_aug_recurrent_mem_tr__prompt_kernel_v_prw1:
    v_mov_b32 v80, 0
    buffer_atomic_add v80, v12, s[8:11], s45 offen sc0
    s_waitcnt vmcnt(3)
    v_cmp_le_i32 vcc, 9, v81
    s_add_u32 s61, s61, 1
    s_cbranch_vccnz interleave_layers__linear_attn_block__memory_aug_recurrent_mem_tr__prompt_kernel_v_prw1_out
    s_sleep 2
    v_mov_b32 v81, 0
    buffer_atomic_add v81, v12, s[8:11], s45 offen sc0
    s_waitcnt vmcnt(3)
    v_cmp_le_i32 vcc, 9, v82
    s_add_u32 s61, s61, 1
    s_cbranch_vccnz interleave_layers__linear_attn_block__memory_aug_recurrent_mem_tr__prompt_kernel_v_prw1_out
    s_sleep 2
    v_mov_b32 v82, 0
    buffer_atomic_add v82, v12, s[8:11], s45 offen sc0
    s_waitcnt vmcnt(3)
    v_cmp_le_i32 vcc, 9, v83
    s_add_u32 s61, s61, 1
    s_cbranch_vccnz interleave_layers__linear_attn_block__memory_aug_recurrent_mem_tr__prompt_kernel_v_prw1_out
    s_sleep 2
    v_mov_b32 v83, 0
    buffer_atomic_add v83, v12, s[8:11], s45 offen sc0
    s_waitcnt vmcnt(3)
    v_cmp_le_i32 vcc, 9, v80
    s_add_u32 s61, s61, 1
    s_cbranch_vccnz interleave_layers__linear_attn_block__memory_aug_recurrent_mem_tr__prompt_kernel_v_prw1_out
    s_sleep 2
    s_cmp_ge_u32 s61, s60
    s_cbranch_scc0 interleave_layers__linear_attn_block__memory_aug_recurrent_mem_tr__prompt_kernel_v_prw1
    s_mov_b32 s60, 1
interleave_layers__linear_attn_block__memory_aug_recurrent_mem_tr__prompt_kernel_v_prw1_out:
    s_mov_b64 exec, -1
    buffer_load_dwordx4 v[68:71], v7, s[8:11], s47 offen sc1
    buffer_load_dwordx4 v[72:75], v7, s[8:11], s48 offen sc1
    buffer_load_dwordx2 v[76:77], v8, s[8:11], s50 offen sc1
    s_waitcnt vmcnt(0)
    v_max3_u32 v103, v68, v69, v70
    v_max3_u32 v103, v103, v71, v72
    v_max3_u32 v103, v103, v73, v74
    v_max3_u32 v103, v103, v75, v76
    v_max_u32 v103, v103, v77
    v_cmp_eq_u32 vcc, -1, v103
    s_cbranch_vccz interleave_layers__linear_attn_block__memory_aug_recurrent_mem_tr__prompt_kernel_v_pmw1_out
    s_mov_b32 s61, 0
interleave_layers__linear_attn_block__memory_aug_recurrent_mem_tr__prompt_kernel_v_pmw1:
    buffer_load_dwordx4 v[68:71], v7, s[8:11], s47 offen sc1
    buffer_load_dwordx4 v[72:75], v7, s[8:11], s48 offen sc1
    buffer_load_dwordx2 v[76:77], v8, s[8:11], s50 offen sc1
    s_waitcnt vmcnt(0)
    v_max3_u32 v103, v68, v69, v70
    v_max3_u32 v103, v103, v71, v72
    v_max3_u32 v103, v103, v73, v74
    v_max3_u32 v103, v103, v75, v76
    v_max_u32 v103, v103, v77
    v_cmp_eq_u32 vcc, -1, v103
    s_add_u32 s61, s61, 1
    s_cbranch_vccz interleave_layers__linear_attn_block__memory_aug_recurrent_mem_tr__prompt_kernel_v_pmw1_out
    s_cmp_ge_u32 s61, s60
    s_cbranch_scc1 interleave_layers__linear_attn_block__memory_aug_recurrent_mem_tr__prompt_kernel_v_pmw1_to
    s_sleep 1
    s_branch interleave_layers__linear_attn_block__memory_aug_recurrent_mem_tr__prompt_kernel_v_pmw1
interleave_layers__linear_attn_block__memory_aug_recurrent_mem_tr__prompt_kernel_v_pmw1_to:
    s_mov_b32 s60, 1
interleave_layers__linear_attn_block__memory_aug_recurrent_mem_tr__prompt_kernel_v_pmw1_out:
    ds_write_b128 v7, v[68:71]
    ds_write_b128 v7, v[72:75] offset:4096
    ds_write_b64 v8, v[76:77]
interleave_layers__linear_attn_block__memory_aug_recurrent_mem_tr__prompt_kernel_v_gow1:
    v_smfmac_f32_16x16x64_bf16 v[56:59], v[68:71], a[8:15], v4
    v_smfmac_f32_16x16x64_bf16 v[60:63], v[68:71], a[88:95], v4
    v_smfmac_f32_16x16x64_bf16 v[64:67], v[68:71], a[168:175], v4
    s_waitcnt lgkmcnt(0)
    s_barrier
    ds_read_b128 v[80:83], v5 offset:0
    ds_read_b128 v[84:87], v5 offset:2048
    ds_read_b128 v[88:91], v5 offset:3072
    ds_read_b128 v[92:95], v5 offset:4096
    ds_read_b128 v[96:99], v5 offset:6144
    ds_read_b128 v[100:103], v5 offset:7168
    ds_read_b128 v[76:79], v5 offset:8192
    ds_read_b128 v[68:71], v5 offset:9216
    v_smfmac_f32_16x16x64_bf16 v[64:67], v[72:75], a[200:207], v4
    v_smfmac_f32_16x16x64_bf16 v[56:59], v[72:75], a[40:47], v4
    v_smfmac_f32_16x16x64_bf16 v[60:63], v[72:75], a[120:127], v4
    s_waitcnt lgkmcnt(7)
    v_smfmac_f32_16x16x64_bf16 v[64:67], v[80:83], a[160:167], v4
    s_waitcnt lgkmcnt(6)
    v_smfmac_f32_16x16x64_bf16 v[64:67], v[84:87], a[176:183], v4
    s_waitcnt lgkmcnt(5)
    v_smfmac_f32_16x16x64_bf16 v[64:67], v[88:91], a[184:191], v4
    s_waitcnt lgkmcnt(4)
    v_smfmac_f32_16x16x64_bf16 v[64:67], v[92:95], a[192:199], v4
    s_waitcnt lgkmcnt(3)
    v_smfmac_f32_16x16x64_bf16 v[64:67], v[96:99], a[208:215], v4
    s_waitcnt lgkmcnt(2)
    v_smfmac_f32_16x16x64_bf16 v[64:67], v[100:103], a[216:223], v4
    s_waitcnt lgkmcnt(1)
    v_smfmac_f32_16x16x64_bf16 v[64:67], v[76:79], a[224:231], v4
    s_waitcnt lgkmcnt(0)
    v_smfmac_f32_16x16x64_bf16 v[64:67], v[68:71], a[232:239], v4
    v_smfmac_f32_16x16x64_bf16 v[56:59], v[80:83], a[0:7], v4
    v_smfmac_f32_16x16x64_bf16 v[60:63], v[80:83], a[80:87], v4
    v_smfmac_f32_16x16x64_bf16 v[56:59], v[84:87], a[16:23], v4
    s_nop 4
    v_mov_b32 v72, v64
    v_smfmac_f32_16x16x64_bf16 v[60:63], v[84:87], a[96:103], v4
    v_mov_b32 v73, v65
    v_mov_b32 v74, v66
    v_smfmac_f32_16x16x64_bf16 v[56:59], v[88:91], a[24:31], v4
    v_mov_b32 v75, v67
    v_smfmac_f32_16x16x64_bf16 v[60:63], v[88:91], a[104:111], v4
    v_permlane32_swap_b32 v64, v72
    v_permlane32_swap_b32 v65, v73
    v_smfmac_f32_16x16x64_bf16 v[56:59], v[92:95], a[32:39], v4
    v_permlane32_swap_b32 v66, v74
    v_permlane32_swap_b32 v67, v75
    v_smfmac_f32_16x16x64_bf16 v[60:63], v[92:95], a[112:119], v4
    v_add_f32 v64, v64, v72
    v_add_f32 v65, v65, v73
    v_smfmac_f32_16x16x64_bf16 v[56:59], v[96:99], a[48:55], v4
    v_add_f32 v66, v66, v74
    v_add_f32 v67, v67, v75
    v_smfmac_f32_16x16x64_bf16 v[60:63], v[96:99], a[128:135], v4
    v_cvt_pk_bf16_f32 v72, v64, v65
    v_cvt_pk_bf16_f32 v73, v66, v67
    v_smfmac_f32_16x16x64_bf16 v[56:59], v[100:103], a[56:63], v4
    ds_write_b64 v9, v[72:73] offset:512
    v_smfmac_f32_16x16x64_bf16 v[60:63], v[100:103], a[136:143], v4
    v_smfmac_f32_16x16x64_bf16 v[56:59], v[76:79], a[64:71], v4
    v_smfmac_f32_16x16x64_bf16 v[60:63], v[76:79], a[144:151], v4
    v_smfmac_f32_16x16x64_bf16 v[56:59], v[68:71], a[72:79], v4
    v_smfmac_f32_16x16x64_bf16 v[60:63], v[68:71], a[152:159], v4
    s_nop 7
    v_permlane32_swap_b32 v56, v60
    v_permlane32_swap_b32 v57, v61
    v_permlane32_swap_b32 v58, v62
    v_permlane32_swap_b32 v59, v63
    v_add_f32 v56, v56, v60
    v_add_f32 v57, v57, v61
    v_add_f32 v58, v58, v62
    v_add_f32 v59, v59, v63
    v_cvt_pk_bf16_f32 v68, v56, v57
    v_cvt_pk_bf16_f32 v69, v58, v59
    ds_write_b64 v10, v[68:69]
    s_waitcnt lgkmcnt(0)
    s_barrier
    ds_read_b64_tr_b16 v[68:69], v11 offset:0
    ds_read_b64_tr_b16 v[70:71], v11 offset:128
    ds_read_b64_tr_b16 v[72:73], v11 offset:1024
    ds_read_b64_tr_b16 v[74:75], v11 offset:1152
    ds_read_b64_tr_b16 v[76:77], v11 offset:2048
    ds_read_b64_tr_b16 v[78:79], v11 offset:2176
    ds_read_b128 v[80:83], v6 offset:0
    ds_read_b128 v[84:87], v6 offset:1024
    ds_read_b128 v[88:91], v6 offset:2048
    ds_read_b128 v[92:95], v6 offset:3072
    ds_read_b128 v[96:99], v6 offset:4096
    ds_read_b128 v[100:103], v6 offset:5120
    s_waitcnt lgkmcnt(10)
    v_smfmac_f32_16x16x64_bf16 v[16:19], v[68:71], a[240:247], v4
    v_smfmac_f32_16x16x64_bf16 v[20:23], v[68:71], v[112:119], v4
    v_smfmac_f32_16x16x64_bf16 v[24:27], v[68:71], v[136:143], v4
    v_smfmac_f32_16x16x64_bf16 v[28:31], v[68:71], v[160:167], v4
    s_waitcnt lgkmcnt(8)
    v_smfmac_f32_16x16x64_bf16 v[16:19], v[72:75], a[248:255], v4
    v_smfmac_f32_16x16x64_bf16 v[20:23], v[72:75], v[120:127], v4
    v_smfmac_f32_16x16x64_bf16 v[24:27], v[72:75], v[144:151], v4
    v_smfmac_f32_16x16x64_bf16 v[28:31], v[72:75], v[168:175], v4
    s_waitcnt lgkmcnt(6)
    v_smfmac_f32_16x16x64_bf16 v[16:19], v[76:79], v[104:111], v4
    v_smfmac_f32_16x16x64_bf16 v[20:23], v[76:79], v[128:135], v4
    v_smfmac_f32_16x16x64_bf16 v[24:27], v[76:79], v[152:159], v4
    v_smfmac_f32_16x16x64_bf16 v[28:31], v[76:79], v[176:183], v4
    v_smfmac_f32_16x16x64_bf16 v[32:35], v[68:71], v[184:191], v4
    v_smfmac_f32_16x16x64_bf16 v[36:39], v[68:71], v[208:215], v4
    s_nop 4
    v_permlane32_swap_b32 v16, v24
    v_permlane32_swap_b32 v17, v25
    v_smfmac_f32_16x16x64_bf16 v[40:43], v[68:71], v[232:239], v4
    v_permlane32_swap_b32 v18, v26
    v_permlane32_swap_b32 v19, v27
    s_waitcnt lgkmcnt(4)
    v_smfmac_f32_16x16x64_bf16 v[44:47], v[68:71], v[80:87], v4
    v_add_f32 v16, v16, v24
    v_add_f32 v17, v17, v25
    ds_read_b128 v[80:83], v6 offset:6144
    ds_read_b128 v[84:87], v6 offset:7168
    v_smfmac_f32_16x16x64_bf16 v[32:35], v[72:75], v[192:199], v4
    v_add_f32 v18, v18, v26
    v_add_f32 v19, v19, v27
    v_smfmac_f32_16x16x64_bf16 v[36:39], v[72:75], v[216:223], v4
    v_permlane32_swap_b32 v20, v28
    v_permlane32_swap_b32 v21, v29
    v_smfmac_f32_16x16x64_bf16 v[40:43], v[72:75], v[240:247], v4
    v_permlane32_swap_b32 v22, v30
    v_permlane32_swap_b32 v23, v31
    s_waitcnt lgkmcnt(4)
    v_smfmac_f32_16x16x64_bf16 v[44:47], v[72:75], v[88:95], v4
    v_add_f32 v20, v20, v28
    v_add_f32 v21, v21, v29
    ds_read_b128 v[88:91], v6 offset:8192
    ds_read_b128 v[92:95], v6 offset:9216
    v_smfmac_f32_16x16x64_bf16 v[32:35], v[76:79], v[200:207], v4
    v_add_f32 v22, v22, v30
    v_add_f32 v23, v23, v31
    v_smfmac_f32_16x16x64_bf16 v[36:39], v[76:79], v[224:231], v4
    v_cvt_pk_bf16_f32 v56, v16, v17
    v_cvt_pk_bf16_f32 v57, v18, v19
    v_smfmac_f32_16x16x64_bf16 v[40:43], v[76:79], v[248:255], v4
    v_cvt_pk_bf16_f32 v58, v20, v21
    v_cvt_pk_bf16_f32 v59, v22, v23
    s_waitcnt lgkmcnt(4)
    v_smfmac_f32_16x16x64_bf16 v[44:47], v[76:79], v[96:103], v4
    v_permlane16_swap_b32 v56, v58
    ds_read_b128 v[96:99], v6 offset:10240
    ds_read_b128 v[100:103], v6 offset:11264
    v_permlane16_swap_b32 v57, v59
    v_min_u32 v56, -2, v56
    v_min_u32 v57, -2, v57
    v_min_u32 v58, -2, v58
    v_min_u32 v59, -2, v59
    buffer_store_dwordx4 v[56:59], v14, s[8:11], s43 offen sc1
    s_add_u32 s49, s43, 65536
    s_waitcnt lgkmcnt(4)
    v_smfmac_f32_16x16x64_bf16 v[48:51], v[68:71], v[80:87], v4
    v_permlane32_swap_b32 v32, v40
    v_permlane32_swap_b32 v33, v41
    v_permlane32_swap_b32 v34, v42
    ds_read_b128 v[80:83], v6 offset:12288
    ds_read_b128 v[84:87], v6 offset:13312
    s_waitcnt lgkmcnt(4)
    v_smfmac_f32_16x16x64_bf16 v[48:51], v[72:75], v[88:95], v4
    v_permlane32_swap_b32 v35, v43
    v_add_f32 v32, v32, v40
    v_add_f32 v33, v33, v41
    v_add_f32 v34, v34, v42
    ds_read_b128 v[88:91], v6 offset:14336
    ds_read_b128 v[92:95], v6 offset:15360
    s_waitcnt lgkmcnt(4)
    v_smfmac_f32_16x16x64_bf16 v[48:51], v[76:79], v[96:103], v4
    v_add_f32 v35, v35, v43
    v_permlane32_swap_b32 v36, v44
    v_permlane32_swap_b32 v37, v45
    v_permlane32_swap_b32 v38, v46
    ds_read_b128 v[96:99], v6 offset:16384
    ds_read_b128 v[100:103], v6 offset:17408
    v_permlane32_swap_b32 v39, v47
    v_add_f32 v36, v36, v44
    v_add_f32 v37, v37, v45
    v_add_f32 v38, v38, v46
    s_waitcnt lgkmcnt(4)
    v_smfmac_f32_16x16x64_bf16 v[52:55], v[68:71], v[80:87], v4
    v_add_f32 v39, v39, v47
    v_cvt_pk_bf16_f32 v60, v32, v33
    v_cvt_pk_bf16_f32 v61, v34, v35
    s_waitcnt lgkmcnt(2)
    v_smfmac_f32_16x16x64_bf16 v[52:55], v[72:75], v[88:95], v4
    v_cvt_pk_bf16_f32 v62, v36, v37
    v_cvt_pk_bf16_f32 v63, v38, v39
    s_waitcnt lgkmcnt(0)
    v_smfmac_f32_16x16x64_bf16 v[52:55], v[76:79], v[96:103], v4
    v_permlane16_swap_b32 v60, v62
    v_permlane16_swap_b32 v61, v63
    v_min_u32 v60, -2, v60
    v_min_u32 v61, -2, v61
    v_min_u32 v62, -2, v62
    v_min_u32 v63, -2, v63
    buffer_store_dwordx4 v[60:63], v14, s[8:11], s49 offen sc1
    s_nop 0
    v_permlane32_swap_b32 v48, v52
    v_permlane32_swap_b32 v49, v53
    v_permlane32_swap_b32 v50, v54
    v_permlane32_swap_b32 v51, v55
    v_add_f32 v48, v48, v52
    v_add_f32 v49, v49, v53
    v_add_f32 v50, v50, v54
    v_add_f32 v51, v51, v55
    v_cvt_pk_bf16_f32 v64, v48, v49
    v_cvt_pk_bf16_f32 v65, v50, v51
    v_mov_b32 v66, v64
    v_mov_b32 v67, v65
    s_nop 0
    v_permlane16_swap_b32 v64, v66
    v_permlane16_swap_b32 v65, v67
    v_min_u32 v64, -2, v64
    v_min_u32 v65, -2, v65
    v_min_u32 v66, -2, v66
    v_min_u32 v67, -2, v67
    buffer_store_dwordx4 v[64:67], v15, s[8:11], s43 offen sc1
    s_add_u32 s40, s40, 1
    s_add_u32 s47, s37, 704512
    s_add_u32 s45, s37, 737280
    s_lshl_b32 s24, s40, 12
    s_and_b32 s24, s24, 0x2000
    s_xor_b32 s24, s24, s36
    s_lshl_b32 s37, s40, 20
    s_add_u32 s37, s37, s24
    s_add_u32 s37, s37, 117440512
    s_add_u32 s43, s37, 0
    s_cmp_lt_u32 s40, 64
    s_cbranch_scc1 interleave_layers__linear_attn_block__memory_aug_recurrent_mem_tr__prompt_kernel_v_stepw1
    s_branch interleave_layers__linear_attn_block__memory_aug_recurrent_mem_tr__prompt_kernel_v_end
interleave_layers__linear_attn_block__memory_aug_recurrent_mem_tr__prompt_kernel_v_stepw2:
    v_mov_b32 v16, 0
    v_mov_b32 v17, 0
    v_mov_b32 v18, 0
    v_mov_b32 v19, 0
    v_mov_b32 v20, 0
    v_mov_b32 v21, 0
    v_mov_b32 v22, 0
    v_mov_b32 v23, 0
    v_mov_b32 v24, 0
    v_mov_b32 v25, 0
    v_mov_b32 v26, 0
    v_mov_b32 v27, 0
    v_mov_b32 v28, 0
    v_mov_b32 v29, 0
    v_mov_b32 v30, 0
    v_mov_b32 v31, 0
    v_mov_b32 v32, 0
    v_mov_b32 v33, 0
    v_mov_b32 v34, 0
    v_mov_b32 v35, 0
    v_mov_b32 v36, 0
    v_mov_b32 v37, 0
    v_mov_b32 v38, 0
    v_mov_b32 v39, 0
    v_mov_b32 v40, 0
    v_mov_b32 v41, 0
    v_mov_b32 v42, 0
    v_mov_b32 v43, 0
    v_mov_b32 v44, 0
    v_mov_b32 v45, 0
    v_mov_b32 v46, 0
    v_mov_b32 v47, 0
    v_mov_b32 v48, 0
    v_mov_b32 v49, 0
    v_mov_b32 v50, 0
    v_mov_b32 v51, 0
    v_mov_b32 v52, 0
    v_mov_b32 v53, 0
    v_mov_b32 v54, 0
    v_mov_b32 v55, 0
    v_mov_b32 v56, 0
    v_mov_b32 v57, 0
    v_mov_b32 v58, 0
    v_mov_b32 v59, 0
    v_mov_b32 v60, 0
    v_mov_b32 v61, 0
    v_mov_b32 v62, 0
    v_mov_b32 v63, 0
    v_mov_b32 v64, 0
    v_mov_b32 v65, 0
    v_mov_b32 v66, 0
    v_mov_b32 v67, 0
    s_add_u32 s48, s47, 4096
    s_add_u32 s50, s47, 8192
    s_lshl_b32 s95, s92, 6
    s_add_u32 s95, s95, s40
    s_add_u32 s95, s95, 1
    s_cmp_ge_i32 s59, s95
    s_cbranch_scc1 interleave_layers__linear_attn_block__memory_aug_recurrent_mem_tr__prompt_kernel_v_ecw2_ok
    s_and_b32 s24, s2, 7
    s_lshl_b32 s24, s24, 7
    s_add_u32 s24, s24, 23109632
    v_and_b32 v79, 3, v1
    v_lshl_add_u32 v79, v79, 2, s24
    s_mov_b32 s61, 0
interleave_layers__linear_attn_block__memory_aug_recurrent_mem_tr__prompt_kernel_v_ecw2:
    buffer_load_dword v78, v79, s[8:11], 0 offen sc1
    s_waitcnt vmcnt(0)
    v_readlane_b32 s59, v78, 0
    v_readlane_b32 s24, v78, 1
    s_min_i32 s59, s59, s24
    v_readlane_b32 s24, v78, 2
    s_min_i32 s59, s59, s24
    s_cmp_ge_i32 s59, s95
    s_cbranch_scc1 interleave_layers__linear_attn_block__memory_aug_recurrent_mem_tr__prompt_kernel_v_ecw2_ok
    s_add_u32 s61, s61, 1
    s_cmp_ge_u32 s61, s60
    s_cbranch_scc1 interleave_layers__linear_attn_block__memory_aug_recurrent_mem_tr__prompt_kernel_v_ecw2_to
    s_sleep 2
    s_branch interleave_layers__linear_attn_block__memory_aug_recurrent_mem_tr__prompt_kernel_v_ecw2
interleave_layers__linear_attn_block__memory_aug_recurrent_mem_tr__prompt_kernel_v_ecw2_to:
    s_mov_b32 s60, 1
interleave_layers__linear_attn_block__memory_aug_recurrent_mem_tr__prompt_kernel_v_ecw2_ok:
    s_sleep 20
    s_mov_b64 exec, 1
    s_mov_b32 s61, 0
    v_mov_b32 v81, 0
    buffer_atomic_add v81, v12, s[8:11], s45 offen sc0
    s_sleep 2
    v_mov_b32 v82, 0
    buffer_atomic_add v82, v12, s[8:11], s45 offen sc0
    s_sleep 2
    v_mov_b32 v83, 0
    buffer_atomic_add v83, v12, s[8:11], s45 offen sc0
    s_sleep 2
interleave_layers__linear_attn_block__memory_aug_recurrent_mem_tr__prompt_kernel_v_prw2:
    v_mov_b32 v80, 0
    buffer_atomic_add v80, v12, s[8:11], s45 offen sc0
    s_waitcnt vmcnt(3)
    v_cmp_le_i32 vcc, 9, v81
    s_add_u32 s61, s61, 1
    s_cbranch_vccnz interleave_layers__linear_attn_block__memory_aug_recurrent_mem_tr__prompt_kernel_v_prw2_out
    s_sleep 2
    v_mov_b32 v81, 0
    buffer_atomic_add v81, v12, s[8:11], s45 offen sc0
    s_waitcnt vmcnt(3)
    v_cmp_le_i32 vcc, 9, v82
    s_add_u32 s61, s61, 1
    s_cbranch_vccnz interleave_layers__linear_attn_block__memory_aug_recurrent_mem_tr__prompt_kernel_v_prw2_out
    s_sleep 2
    v_mov_b32 v82, 0
    buffer_atomic_add v82, v12, s[8:11], s45 offen sc0
    s_waitcnt vmcnt(3)
    v_cmp_le_i32 vcc, 9, v83
    s_add_u32 s61, s61, 1
    s_cbranch_vccnz interleave_layers__linear_attn_block__memory_aug_recurrent_mem_tr__prompt_kernel_v_prw2_out
    s_sleep 2
    v_mov_b32 v83, 0
    buffer_atomic_add v83, v12, s[8:11], s45 offen sc0
    s_waitcnt vmcnt(3)
    v_cmp_le_i32 vcc, 9, v80
    s_add_u32 s61, s61, 1
    s_cbranch_vccnz interleave_layers__linear_attn_block__memory_aug_recurrent_mem_tr__prompt_kernel_v_prw2_out
    s_sleep 2
    s_cmp_ge_u32 s61, s60
    s_cbranch_scc0 interleave_layers__linear_attn_block__memory_aug_recurrent_mem_tr__prompt_kernel_v_prw2
    s_mov_b32 s60, 1
interleave_layers__linear_attn_block__memory_aug_recurrent_mem_tr__prompt_kernel_v_prw2_out:
    s_mov_b64 exec, -1
    buffer_load_dwordx4 v[68:71], v7, s[8:11], s47 offen sc1
    buffer_load_dwordx4 v[72:75], v7, s[8:11], s48 offen sc1
    buffer_load_dwordx2 v[76:77], v8, s[8:11], s50 offen sc1
    s_waitcnt vmcnt(0)
    v_max3_u32 v103, v68, v69, v70
    v_max3_u32 v103, v103, v71, v72
    v_max3_u32 v103, v103, v73, v74
    v_max3_u32 v103, v103, v75, v76
    v_max_u32 v103, v103, v77
    v_cmp_eq_u32 vcc, -1, v103
    s_cbranch_vccz interleave_layers__linear_attn_block__memory_aug_recurrent_mem_tr__prompt_kernel_v_pmw2_out
    s_mov_b32 s61, 0
interleave_layers__linear_attn_block__memory_aug_recurrent_mem_tr__prompt_kernel_v_pmw2:
    buffer_load_dwordx4 v[68:71], v7, s[8:11], s47 offen sc1
    buffer_load_dwordx4 v[72:75], v7, s[8:11], s48 offen sc1
    buffer_load_dwordx2 v[76:77], v8, s[8:11], s50 offen sc1
    s_waitcnt vmcnt(0)
    v_max3_u32 v103, v68, v69, v70
    v_max3_u32 v103, v103, v71, v72
    v_max3_u32 v103, v103, v73, v74
    v_max3_u32 v103, v103, v75, v76
    v_max_u32 v103, v103, v77
    v_cmp_eq_u32 vcc, -1, v103
    s_add_u32 s61, s61, 1
    s_cbranch_vccz interleave_layers__linear_attn_block__memory_aug_recurrent_mem_tr__prompt_kernel_v_pmw2_out
    s_cmp_ge_u32 s61, s60
    s_cbranch_scc1 interleave_layers__linear_attn_block__memory_aug_recurrent_mem_tr__prompt_kernel_v_pmw2_to
    s_sleep 1
    s_branch interleave_layers__linear_attn_block__memory_aug_recurrent_mem_tr__prompt_kernel_v_pmw2
interleave_layers__linear_attn_block__memory_aug_recurrent_mem_tr__prompt_kernel_v_pmw2_to:
    s_mov_b32 s60, 1
interleave_layers__linear_attn_block__memory_aug_recurrent_mem_tr__prompt_kernel_v_pmw2_out:
    ds_write_b128 v7, v[68:71]
    ds_write_b128 v7, v[72:75] offset:4096
    ds_write_b64 v8, v[76:77]
interleave_layers__linear_attn_block__memory_aug_recurrent_mem_tr__prompt_kernel_v_gow2:
    v_smfmac_f32_16x16x64_bf16 v[56:59], v[68:71], a[16:23], v4
    v_smfmac_f32_16x16x64_bf16 v[60:63], v[68:71], a[96:103], v4
    v_smfmac_f32_16x16x64_bf16 v[64:67], v[68:71], a[176:183], v4
    s_waitcnt lgkmcnt(0)
    s_barrier
    ds_read_b128 v[80:83], v5 offset:0
    ds_read_b128 v[84:87], v5 offset:1024
    ds_read_b128 v[88:91], v5 offset:3072
    ds_read_b128 v[92:95], v5 offset:4096
    ds_read_b128 v[96:99], v5 offset:5120
    ds_read_b128 v[100:103], v5 offset:7168
    ds_read_b128 v[76:79], v5 offset:8192
    ds_read_b128 v[68:71], v5 offset:9216
    v_smfmac_f32_16x16x64_bf16 v[64:67], v[72:75], a[208:215], v4
    v_smfmac_f32_16x16x64_bf16 v[56:59], v[72:75], a[48:55], v4
    v_smfmac_f32_16x16x64_bf16 v[60:63], v[72:75], a[128:135], v4
    s_waitcnt lgkmcnt(7)
    v_smfmac_f32_16x16x64_bf16 v[64:67], v[80:83], a[160:167], v4
    s_waitcnt lgkmcnt(6)
    v_smfmac_f32_16x16x64_bf16 v[64:67], v[84:87], a[168:175], v4
    s_waitcnt lgkmcnt(5)
    v_smfmac_f32_16x16x64_bf16 v[64:67], v[88:91], a[184:191], v4
    s_waitcnt lgkmcnt(4)
    v_smfmac_f32_16x16x64_bf16 v[64:67], v[92:95], a[192:199], v4
    s_waitcnt lgkmcnt(3)
    v_smfmac_f32_16x16x64_bf16 v[64:67], v[96:99], a[200:207], v4
    s_waitcnt lgkmcnt(2)
    v_smfmac_f32_16x16x64_bf16 v[64:67], v[100:103], a[216:223], v4
    s_waitcnt lgkmcnt(1)
    v_smfmac_f32_16x16x64_bf16 v[64:67], v[76:79], a[224:231], v4
    s_waitcnt lgkmcnt(0)
    v_smfmac_f32_16x16x64_bf16 v[64:67], v[68:71], a[232:239], v4
    v_smfmac_f32_16x16x64_bf16 v[56:59], v[80:83], a[0:7], v4
    v_smfmac_f32_16x16x64_bf16 v[60:63], v[80:83], a[80:87], v4
    v_smfmac_f32_16x16x64_bf16 v[56:59], v[84:87], a[8:15], v4
    s_nop 4
    v_mov_b32 v72, v64
    v_smfmac_f32_16x16x64_bf16 v[60:63], v[84:87], a[88:95], v4
    v_mov_b32 v73, v65
    v_mov_b32 v74, v66
    v_smfmac_f32_16x16x64_bf16 v[56:59], v[88:91], a[24:31], v4
    v_mov_b32 v75, v67
    v_smfmac_f32_16x16x64_bf16 v[60:63], v[88:91], a[104:111], v4
    v_permlane32_swap_b32 v64, v72
    v_permlane32_swap_b32 v65, v73
    v_smfmac_f32_16x16x64_bf16 v[56:59], v[92:95], a[32:39], v4
    v_permlane32_swap_b32 v66, v74
    v_permlane32_swap_b32 v67, v75
    v_smfmac_f32_16x16x64_bf16 v[60:63], v[92:95], a[112:119], v4
    v_add_f32 v64, v64, v72
    v_add_f32 v65, v65, v73
    v_smfmac_f32_16x16x64_bf16 v[56:59], v[96:99], a[40:47], v4
    v_add_f32 v66, v66, v74
    v_add_f32 v67, v67, v75
    v_smfmac_f32_16x16x64_bf16 v[60:63], v[96:99], a[120:127], v4
    v_cvt_pk_bf16_f32 v72, v64, v65
    v_cvt_pk_bf16_f32 v73, v66, v67
    v_smfmac_f32_16x16x64_bf16 v[56:59], v[100:103], a[56:63], v4
    ds_write_b64 v9, v[72:73] offset:512
    v_smfmac_f32_16x16x64_bf16 v[60:63], v[100:103], a[136:143], v4
    v_smfmac_f32_16x16x64_bf16 v[56:59], v[76:79], a[64:71], v4
    v_smfmac_f32_16x16x64_bf16 v[60:63], v[76:79], a[144:151], v4
    v_smfmac_f32_16x16x64_bf16 v[56:59], v[68:71], a[72:79], v4
    v_smfmac_f32_16x16x64_bf16 v[60:63], v[68:71], a[152:159], v4
    s_nop 7
    v_permlane32_swap_b32 v56, v60
    v_permlane32_swap_b32 v57, v61
    v_permlane32_swap_b32 v58, v62
    v_permlane32_swap_b32 v59, v63
    v_add_f32 v56, v56, v60
    v_add_f32 v57, v57, v61
    v_add_f32 v58, v58, v62
    v_add_f32 v59, v59, v63
    v_cvt_pk_bf16_f32 v68, v56, v57
    v_cvt_pk_bf16_f32 v69, v58, v59
    ds_write_b64 v10, v[68:69]
    s_waitcnt lgkmcnt(0)
    s_barrier
    ds_read_b64_tr_b16 v[68:69], v11 offset:0
    ds_read_b64_tr_b16 v[70:71], v11 offset:128
    ds_read_b64_tr_b16 v[72:73], v11 offset:1024
    ds_read_b64_tr_b16 v[74:75], v11 offset:1152
    ds_read_b64_tr_b16 v[76:77], v11 offset:2048
    ds_read_b64_tr_b16 v[78:79], v11 offset:2176
    ds_read_b128 v[80:83], v6 offset:0
    ds_read_b128 v[84:87], v6 offset:1024
    ds_read_b128 v[88:91], v6 offset:2048
    ds_read_b128 v[92:95], v6 offset:3072
    ds_read_b128 v[96:99], v6 offset:4096
    ds_read_b128 v[100:103], v6 offset:5120
    s_waitcnt lgkmcnt(10)
    v_smfmac_f32_16x16x64_bf16 v[16:19], v[68:71], a[240:247], v4
    v_smfmac_f32_16x16x64_bf16 v[20:23], v[68:71], v[112:119], v4
    v_smfmac_f32_16x16x64_bf16 v[24:27], v[68:71], v[136:143], v4
    v_smfmac_f32_16x16x64_bf16 v[28:31], v[68:71], v[160:167], v4
    s_waitcnt lgkmcnt(8)
    v_smfmac_f32_16x16x64_bf16 v[16:19], v[72:75], a[248:255], v4
    v_smfmac_f32_16x16x64_bf16 v[20:23], v[72:75], v[120:127], v4
    v_smfmac_f32_16x16x64_bf16 v[24:27], v[72:75], v[144:151], v4
    v_smfmac_f32_16x16x64_bf16 v[28:31], v[72:75], v[168:175], v4
    s_waitcnt lgkmcnt(6)
    v_smfmac_f32_16x16x64_bf16 v[16:19], v[76:79], v[104:111], v4
    v_smfmac_f32_16x16x64_bf16 v[20:23], v[76:79], v[128:135], v4
    v_smfmac_f32_16x16x64_bf16 v[24:27], v[76:79], v[152:159], v4
    v_smfmac_f32_16x16x64_bf16 v[28:31], v[76:79], v[176:183], v4
    v_smfmac_f32_16x16x64_bf16 v[32:35], v[68:71], v[184:191], v4
    v_smfmac_f32_16x16x64_bf16 v[36:39], v[68:71], v[208:215], v4
    s_nop 4
    v_permlane32_swap_b32 v16, v24
    v_permlane32_swap_b32 v17, v25
    v_smfmac_f32_16x16x64_bf16 v[40:43], v[68:71], v[232:239], v4
    v_permlane32_swap_b32 v18, v26
    v_permlane32_swap_b32 v19, v27
    s_waitcnt lgkmcnt(4)
    v_smfmac_f32_16x16x64_bf16 v[44:47], v[68:71], v[80:87], v4
    v_add_f32 v16, v16, v24
    v_add_f32 v17, v17, v25
    ds_read_b128 v[80:83], v6 offset:6144
    ds_read_b128 v[84:87], v6 offset:7168
    v_smfmac_f32_16x16x64_bf16 v[32:35], v[72:75], v[192:199], v4
    v_add_f32 v18, v18, v26
    v_add_f32 v19, v19, v27
    v_smfmac_f32_16x16x64_bf16 v[36:39], v[72:75], v[216:223], v4
    v_permlane32_swap_b32 v20, v28
    v_permlane32_swap_b32 v21, v29
    v_smfmac_f32_16x16x64_bf16 v[40:43], v[72:75], v[240:247], v4
    v_permlane32_swap_b32 v22, v30
    v_permlane32_swap_b32 v23, v31
    s_waitcnt lgkmcnt(4)
    v_smfmac_f32_16x16x64_bf16 v[44:47], v[72:75], v[88:95], v4
    v_add_f32 v20, v20, v28
    v_add_f32 v21, v21, v29
    ds_read_b128 v[88:91], v6 offset:8192
    ds_read_b128 v[92:95], v6 offset:9216
    v_smfmac_f32_16x16x64_bf16 v[32:35], v[76:79], v[200:207], v4
    v_add_f32 v22, v22, v30
    v_add_f32 v23, v23, v31
    v_smfmac_f32_16x16x64_bf16 v[36:39], v[76:79], v[224:231], v4
    v_cvt_pk_bf16_f32 v56, v16, v17
    v_cvt_pk_bf16_f32 v57, v18, v19
    v_smfmac_f32_16x16x64_bf16 v[40:43], v[76:79], v[248:255], v4
    v_cvt_pk_bf16_f32 v58, v20, v21
    v_cvt_pk_bf16_f32 v59, v22, v23
    s_waitcnt lgkmcnt(4)
    v_smfmac_f32_16x16x64_bf16 v[44:47], v[76:79], v[96:103], v4
    v_permlane16_swap_b32 v56, v58
    ds_read_b128 v[96:99], v6 offset:10240
    ds_read_b128 v[100:103], v6 offset:11264
    v_permlane16_swap_b32 v57, v59
    v_min_u32 v56, -2, v56
    v_min_u32 v57, -2, v57
    v_min_u32 v58, -2, v58
    v_min_u32 v59, -2, v59
    buffer_store_dwordx4 v[56:59], v14, s[8:11], s43 offen sc1
    s_add_u32 s49, s43, 65536
    s_waitcnt lgkmcnt(4)
    v_smfmac_f32_16x16x64_bf16 v[48:51], v[68:71], v[80:87], v4
    v_permlane32_swap_b32 v32, v40
    v_permlane32_swap_b32 v33, v41
    v_permlane32_swap_b32 v34, v42
    ds_read_b128 v[80:83], v6 offset:12288
    ds_read_b128 v[84:87], v6 offset:13312
    s_waitcnt lgkmcnt(4)
    v_smfmac_f32_16x16x64_bf16 v[48:51], v[72:75], v[88:95], v4
    v_permlane32_swap_b32 v35, v43
    v_add_f32 v32, v32, v40
    v_add_f32 v33, v33, v41
    v_add_f32 v34, v34, v42
    ds_read_b128 v[88:91], v6 offset:14336
    ds_read_b128 v[92:95], v6 offset:15360
    s_waitcnt lgkmcnt(4)
    v_smfmac_f32_16x16x64_bf16 v[48:51], v[76:79], v[96:103], v4
    v_add_f32 v35, v35, v43
    v_permlane32_swap_b32 v36, v44
    v_permlane32_swap_b32 v37, v45
    v_permlane32_swap_b32 v38, v46
    ds_read_b128 v[96:99], v6 offset:16384
    ds_read_b128 v[100:103], v6 offset:17408
    v_permlane32_swap_b32 v39, v47
    v_add_f32 v36, v36, v44
    v_add_f32 v37, v37, v45
    v_add_f32 v38, v38, v46
    s_waitcnt lgkmcnt(4)
    v_smfmac_f32_16x16x64_bf16 v[52:55], v[68:71], v[80:87], v4
    v_add_f32 v39, v39, v47
    v_cvt_pk_bf16_f32 v60, v32, v33
    v_cvt_pk_bf16_f32 v61, v34, v35
    s_waitcnt lgkmcnt(2)
    v_smfmac_f32_16x16x64_bf16 v[52:55], v[72:75], v[88:95], v4
    v_cvt_pk_bf16_f32 v62, v36, v37
    v_cvt_pk_bf16_f32 v63, v38, v39
    s_waitcnt lgkmcnt(0)
    v_smfmac_f32_16x16x64_bf16 v[52:55], v[76:79], v[96:103], v4
    v_permlane16_swap_b32 v60, v62
    v_permlane16_swap_b32 v61, v63
    v_min_u32 v60, -2, v60
    v_min_u32 v61, -2, v61
    v_min_u32 v62, -2, v62
    v_min_u32 v63, -2, v63
    buffer_store_dwordx4 v[60:63], v14, s[8:11], s49 offen sc1
    s_nop 0
    v_permlane32_swap_b32 v48, v52
    v_permlane32_swap_b32 v49, v53
    v_permlane32_swap_b32 v50, v54
    v_permlane32_swap_b32 v51, v55
    v_add_f32 v48, v48, v52
    v_add_f32 v49, v49, v53
    v_add_f32 v50, v50, v54
    v_add_f32 v51, v51, v55
    v_cvt_pk_bf16_f32 v64, v48, v49
    v_cvt_pk_bf16_f32 v65, v50, v51
    v_mov_b32 v66, v64
    v_mov_b32 v67, v65
    s_nop 0
    v_permlane16_swap_b32 v64, v66
    v_permlane16_swap_b32 v65, v67
    v_min_u32 v64, -2, v64
    v_min_u32 v65, -2, v65
    v_min_u32 v66, -2, v66
    v_min_u32 v67, -2, v67
    buffer_store_dwordx4 v[64:67], v15, s[8:11], s43 offen sc1
    s_add_u32 s40, s40, 1
    s_add_u32 s47, s37, 704512
    s_add_u32 s45, s37, 737280
    s_lshl_b32 s24, s40, 12
    s_and_b32 s24, s24, 0x2000
    s_xor_b32 s24, s24, s36
    s_lshl_b32 s37, s40, 20
    s_add_u32 s37, s37, s24
    s_add_u32 s37, s37, 117440512
    s_add_u32 s43, s37, 0
    s_cmp_lt_u32 s40, 64
    s_cbranch_scc1 interleave_layers__linear_attn_block__memory_aug_recurrent_mem_tr__prompt_kernel_v_stepw2
    s_branch interleave_layers__linear_attn_block__memory_aug_recurrent_mem_tr__prompt_kernel_v_end
interleave_layers__linear_attn_block__memory_aug_recurrent_mem_tr__prompt_kernel_v_stepw3:
    v_mov_b32 v16, 0
    v_mov_b32 v17, 0
    v_mov_b32 v18, 0
    v_mov_b32 v19, 0
    v_mov_b32 v20, 0
    v_mov_b32 v21, 0
    v_mov_b32 v22, 0
    v_mov_b32 v23, 0
    v_mov_b32 v24, 0
    v_mov_b32 v25, 0
    v_mov_b32 v26, 0
    v_mov_b32 v27, 0
    v_mov_b32 v28, 0
    v_mov_b32 v29, 0
    v_mov_b32 v30, 0
    v_mov_b32 v31, 0
    v_mov_b32 v32, 0
    v_mov_b32 v33, 0
    v_mov_b32 v34, 0
    v_mov_b32 v35, 0
    v_mov_b32 v36, 0
    v_mov_b32 v37, 0
    v_mov_b32 v38, 0
    v_mov_b32 v39, 0
    v_mov_b32 v40, 0
    v_mov_b32 v41, 0
    v_mov_b32 v42, 0
    v_mov_b32 v43, 0
    v_mov_b32 v44, 0
    v_mov_b32 v45, 0
    v_mov_b32 v46, 0
    v_mov_b32 v47, 0
    v_mov_b32 v48, 0
    v_mov_b32 v49, 0
    v_mov_b32 v50, 0
    v_mov_b32 v51, 0
    v_mov_b32 v52, 0
    v_mov_b32 v53, 0
    v_mov_b32 v54, 0
    v_mov_b32 v55, 0
    v_mov_b32 v56, 0
    v_mov_b32 v57, 0
    v_mov_b32 v58, 0
    v_mov_b32 v59, 0
    v_mov_b32 v60, 0
    v_mov_b32 v61, 0
    v_mov_b32 v62, 0
    v_mov_b32 v63, 0
    v_mov_b32 v64, 0
    v_mov_b32 v65, 0
    v_mov_b32 v66, 0
    v_mov_b32 v67, 0
    s_add_u32 s48, s47, 4096
    s_add_u32 s50, s47, 8192
    s_lshl_b32 s95, s92, 6
    s_add_u32 s95, s95, s40
    s_add_u32 s95, s95, 1
    s_cmp_ge_i32 s59, s95
    s_cbranch_scc1 interleave_layers__linear_attn_block__memory_aug_recurrent_mem_tr__prompt_kernel_v_ecw3_ok
    s_and_b32 s24, s2, 7
    s_lshl_b32 s24, s24, 7
    s_add_u32 s24, s24, 23109632
    v_and_b32 v79, 3, v1
    v_lshl_add_u32 v79, v79, 2, s24
    s_mov_b32 s61, 0
interleave_layers__linear_attn_block__memory_aug_recurrent_mem_tr__prompt_kernel_v_ecw3:
    buffer_load_dword v78, v79, s[8:11], 0 offen sc1
    s_waitcnt vmcnt(0)
    v_readlane_b32 s59, v78, 0
    v_readlane_b32 s24, v78, 1
    s_min_i32 s59, s59, s24
    v_readlane_b32 s24, v78, 2
    s_min_i32 s59, s59, s24
    s_cmp_ge_i32 s59, s95
    s_cbranch_scc1 interleave_layers__linear_attn_block__memory_aug_recurrent_mem_tr__prompt_kernel_v_ecw3_ok
    s_add_u32 s61, s61, 1
    s_cmp_ge_u32 s61, s60
    s_cbranch_scc1 interleave_layers__linear_attn_block__memory_aug_recurrent_mem_tr__prompt_kernel_v_ecw3_to
    s_sleep 2
    s_branch interleave_layers__linear_attn_block__memory_aug_recurrent_mem_tr__prompt_kernel_v_ecw3
interleave_layers__linear_attn_block__memory_aug_recurrent_mem_tr__prompt_kernel_v_ecw3_to:
    s_mov_b32 s60, 1
interleave_layers__linear_attn_block__memory_aug_recurrent_mem_tr__prompt_kernel_v_ecw3_ok:
    s_sleep 20
    s_mov_b64 exec, 1
    s_mov_b32 s61, 0
    v_mov_b32 v81, 0
    buffer_atomic_add v81, v12, s[8:11], s45 offen sc0
    s_sleep 2
    v_mov_b32 v82, 0
    buffer_atomic_add v82, v12, s[8:11], s45 offen sc0
    s_sleep 2
    v_mov_b32 v83, 0
    buffer_atomic_add v83, v12, s[8:11], s45 offen sc0
    s_sleep 2
interleave_layers__linear_attn_block__memory_aug_recurrent_mem_tr__prompt_kernel_v_prw3:
    v_mov_b32 v80, 0
    buffer_atomic_add v80, v12, s[8:11], s45 offen sc0
    s_waitcnt vmcnt(3)
    v_cmp_le_i32 vcc, 9, v81
    s_add_u32 s61, s61, 1
    s_cbranch_vccnz interleave_layers__linear_attn_block__memory_aug_recurrent_mem_tr__prompt_kernel_v_prw3_out
    s_sleep 2
    v_mov_b32 v81, 0
    buffer_atomic_add v81, v12, s[8:11], s45 offen sc0
    s_waitcnt vmcnt(3)
    v_cmp_le_i32 vcc, 9, v82
    s_add_u32 s61, s61, 1
    s_cbranch_vccnz interleave_layers__linear_attn_block__memory_aug_recurrent_mem_tr__prompt_kernel_v_prw3_out
    s_sleep 2
    v_mov_b32 v82, 0
    buffer_atomic_add v82, v12, s[8:11], s45 offen sc0
    s_waitcnt vmcnt(3)
    v_cmp_le_i32 vcc, 9, v83
    s_add_u32 s61, s61, 1
    s_cbranch_vccnz interleave_layers__linear_attn_block__memory_aug_recurrent_mem_tr__prompt_kernel_v_prw3_out
    s_sleep 2
    v_mov_b32 v83, 0
    buffer_atomic_add v83, v12, s[8:11], s45 offen sc0
    s_waitcnt vmcnt(3)
    v_cmp_le_i32 vcc, 9, v80
    s_add_u32 s61, s61, 1
    s_cbranch_vccnz interleave_layers__linear_attn_block__memory_aug_recurrent_mem_tr__prompt_kernel_v_prw3_out
    s_sleep 2
    s_cmp_ge_u32 s61, s60
    s_cbranch_scc0 interleave_layers__linear_attn_block__memory_aug_recurrent_mem_tr__prompt_kernel_v_prw3
    s_mov_b32 s60, 1
interleave_layers__linear_attn_block__memory_aug_recurrent_mem_tr__prompt_kernel_v_prw3_out:
    s_mov_b64 exec, -1
    buffer_load_dwordx4 v[68:71], v7, s[8:11], s47 offen sc1
    buffer_load_dwordx4 v[72:75], v7, s[8:11], s48 offen sc1
    buffer_load_dwordx2 v[76:77], v8, s[8:11], s50 offen sc1
    s_waitcnt vmcnt(0)
    v_max3_u32 v103, v68, v69, v70
    v_max3_u32 v103, v103, v71, v72
    v_max3_u32 v103, v103, v73, v74
    v_max3_u32 v103, v103, v75, v76
    v_max_u32 v103, v103, v77
    v_cmp_eq_u32 vcc, -1, v103
    s_cbranch_vccz interleave_layers__linear_attn_block__memory_aug_recurrent_mem_tr__prompt_kernel_v_pmw3_out
    s_mov_b32 s61, 0
interleave_layers__linear_attn_block__memory_aug_recurrent_mem_tr__prompt_kernel_v_pmw3:
    buffer_load_dwordx4 v[68:71], v7, s[8:11], s47 offen sc1
    buffer_load_dwordx4 v[72:75], v7, s[8:11], s48 offen sc1
    buffer_load_dwordx2 v[76:77], v8, s[8:11], s50 offen sc1
    s_waitcnt vmcnt(0)
    v_max3_u32 v103, v68, v69, v70
    v_max3_u32 v103, v103, v71, v72
    v_max3_u32 v103, v103, v73, v74
    v_max3_u32 v103, v103, v75, v76
    v_max_u32 v103, v103, v77
    v_cmp_eq_u32 vcc, -1, v103
    s_add_u32 s61, s61, 1
    s_cbranch_vccz interleave_layers__linear_attn_block__memory_aug_recurrent_mem_tr__prompt_kernel_v_pmw3_out
    s_cmp_ge_u32 s61, s60
    s_cbranch_scc1 interleave_layers__linear_attn_block__memory_aug_recurrent_mem_tr__prompt_kernel_v_pmw3_to
    s_sleep 1
    s_branch interleave_layers__linear_attn_block__memory_aug_recurrent_mem_tr__prompt_kernel_v_pmw3
interleave_layers__linear_attn_block__memory_aug_recurrent_mem_tr__prompt_kernel_v_pmw3_to:
    s_mov_b32 s60, 1
interleave_layers__linear_attn_block__memory_aug_recurrent_mem_tr__prompt_kernel_v_pmw3_out:
    ds_write_b128 v7, v[68:71]
    ds_write_b128 v7, v[72:75] offset:4096
    ds_write_b64 v8, v[76:77]
interleave_layers__linear_attn_block__memory_aug_recurrent_mem_tr__prompt_kernel_v_gow3:
    v_smfmac_f32_16x16x64_bf16 v[56:59], v[68:71], a[24:31], v4
    v_smfmac_f32_16x16x64_bf16 v[60:63], v[68:71], a[104:111], v4
    v_smfmac_f32_16x16x64_bf16 v[64:67], v[68:71], a[184:191], v4
    s_waitcnt lgkmcnt(0)
    s_barrier
    ds_read_b128 v[80:83], v5 offset:0
    ds_read_b128 v[84:87], v5 offset:1024
    ds_read_b128 v[88:91], v5 offset:2048
    ds_read_b128 v[92:95], v5 offset:4096
    ds_read_b128 v[96:99], v5 offset:5120
    ds_read_b128 v[100:103], v5 offset:6144
    ds_read_b128 v[76:79], v5 offset:8192
    ds_read_b128 v[68:71], v5 offset:9216
    v_smfmac_f32_16x16x64_bf16 v[64:67], v[72:75], a[216:223], v4
    v_smfmac_f32_16x16x64_bf16 v[56:59], v[72:75], a[56:63], v4
    v_smfmac_f32_16x16x64_bf16 v[60:63], v[72:75], a[136:143], v4
    s_waitcnt lgkmcnt(7)
    v_smfmac_f32_16x16x64_bf16 v[64:67], v[80:83], a[160:167], v4
    s_waitcnt lgkmcnt(6)
    v_smfmac_f32_16x16x64_bf16 v[64:67], v[84:87], a[168:175], v4
    s_waitcnt lgkmcnt(5)
    v_smfmac_f32_16x16x64_bf16 v[64:67], v[88:91], a[176:183], v4
    s_waitcnt lgkmcnt(4)
    v_smfmac_f32_16x16x64_bf16 v[64:67], v[92:95], a[192:199], v4
    s_waitcnt lgkmcnt(3)
    v_smfmac_f32_16x16x64_bf16 v[64:67], v[96:99], a[200:207], v4
    s_waitcnt lgkmcnt(2)
    v_smfmac_f32_16x16x64_bf16 v[64:67], v[100:103], a[208:215], v4
    s_waitcnt lgkmcnt(1)
    v_smfmac_f32_16x16x64_bf16 v[64:67], v[76:79], a[224:231], v4
    s_waitcnt lgkmcnt(0)
    v_smfmac_f32_16x16x64_bf16 v[64:67], v[68:71], a[232:239], v4
    v_smfmac_f32_16x16x64_bf16 v[56:59], v[80:83], a[0:7], v4
    v_smfmac_f32_16x16x64_bf16 v[60:63], v[80:83], a[80:87], v4
    v_smfmac_f32_16x16x64_bf16 v[56:59], v[84:87], a[8:15], v4
    s_nop 4
    v_mov_b32 v72, v64
    v_smfmac_f32_16x16x64_bf16 v[60:63], v[84:87], a[88:95], v4
    v_mov_b32 v73, v65
    v_mov_b32 v74, v66
    v_smfmac_f32_16x16x64_bf16 v[56:59], v[88:91], a[16:23], v4
    v_mov_b32 v75, v67
    v_smfmac_f32_16x16x64_bf16 v[60:63], v[88:91], a[96:103], v4
    v_permlane32_swap_b32 v64, v72
    v_permlane32_swap_b32 v65, v73
    v_smfmac_f32_16x16x64_bf16 v[56:59], v[92:95], a[32:39], v4
    v_permlane32_swap_b32 v66, v74
    v_permlane32_swap_b32 v67, v75
    v_smfmac_f32_16x16x64_bf16 v[60:63], v[92:95], a[112:119], v4
    v_add_f32 v64, v64, v72
    v_add_f32 v65, v65, v73
    v_smfmac_f32_16x16x64_bf16 v[56:59], v[96:99], a[40:47], v4
    v_add_f32 v66, v66, v74
    v_add_f32 v67, v67, v75
    v_smfmac_f32_16x16x64_bf16 v[60:63], v[96:99], a[120:127], v4
    v_cvt_pk_bf16_f32 v72, v64, v65
    v_cvt_pk_bf16_f32 v73, v66, v67
    v_smfmac_f32_16x16x64_bf16 v[56:59], v[100:103], a[48:55], v4
    ds_write_b64 v9, v[72:73] offset:512
    v_smfmac_f32_16x16x64_bf16 v[60:63], v[100:103], a[128:135], v4
    v_smfmac_f32_16x16x64_bf16 v[56:59], v[76:79], a[64:71], v4
    v_smfmac_f32_16x16x64_bf16 v[60:63], v[76:79], a[144:151], v4
    v_smfmac_f32_16x16x64_bf16 v[56:59], v[68:71], a[72:79], v4
    v_smfmac_f32_16x16x64_bf16 v[60:63], v[68:71], a[152:159], v4
    s_nop 7
    v_permlane32_swap_b32 v56, v60
    v_permlane32_swap_b32 v57, v61
    v_permlane32_swap_b32 v58, v62
    v_permlane32_swap_b32 v59, v63
    v_add_f32 v56, v56, v60
    v_add_f32 v57, v57, v61
    v_add_f32 v58, v58, v62
    v_add_f32 v59, v59, v63
    v_cvt_pk_bf16_f32 v68, v56, v57
    v_cvt_pk_bf16_f32 v69, v58, v59
    ds_write_b64 v10, v[68:69]
    s_waitcnt lgkmcnt(0)
    s_barrier
    ds_read_b64_tr_b16 v[68:69], v11 offset:0
    ds_read_b64_tr_b16 v[70:71], v11 offset:128
    ds_read_b64_tr_b16 v[72:73], v11 offset:1024
    ds_read_b64_tr_b16 v[74:75], v11 offset:1152
    ds_read_b64_tr_b16 v[76:77], v11 offset:2048
    ds_read_b64_tr_b16 v[78:79], v11 offset:2176
    ds_read_b128 v[80:83], v6 offset:0
    ds_read_b128 v[84:87], v6 offset:1024
    ds_read_b128 v[88:91], v6 offset:2048
    ds_read_b128 v[92:95], v6 offset:3072
    ds_read_b128 v[96:99], v6 offset:4096
    ds_read_b128 v[100:103], v6 offset:5120
    s_waitcnt lgkmcnt(10)
    v_smfmac_f32_16x16x64_bf16 v[16:19], v[68:71], a[240:247], v4
    v_smfmac_f32_16x16x64_bf16 v[20:23], v[68:71], v[112:119], v4
    v_smfmac_f32_16x16x64_bf16 v[24:27], v[68:71], v[136:143], v4
    v_smfmac_f32_16x16x64_bf16 v[28:31], v[68:71], v[160:167], v4
    s_waitcnt lgkmcnt(8)
    v_smfmac_f32_16x16x64_bf16 v[16:19], v[72:75], a[248:255], v4
    v_smfmac_f32_16x16x64_bf16 v[20:23], v[72:75], v[120:127], v4
    v_smfmac_f32_16x16x64_bf16 v[24:27], v[72:75], v[144:151], v4
    v_smfmac_f32_16x16x64_bf16 v[28:31], v[72:75], v[168:175], v4
    s_waitcnt lgkmcnt(6)
    v_smfmac_f32_16x16x64_bf16 v[16:19], v[76:79], v[104:111], v4
    v_smfmac_f32_16x16x64_bf16 v[20:23], v[76:79], v[128:135], v4
    v_smfmac_f32_16x16x64_bf16 v[24:27], v[76:79], v[152:159], v4
    v_smfmac_f32_16x16x64_bf16 v[28:31], v[76:79], v[176:183], v4
    v_smfmac_f32_16x16x64_bf16 v[32:35], v[68:71], v[184:191], v4
    v_smfmac_f32_16x16x64_bf16 v[36:39], v[68:71], v[208:215], v4
    s_nop 4
    v_permlane32_swap_b32 v16, v24
    v_permlane32_swap_b32 v17, v25
    v_smfmac_f32_16x16x64_bf16 v[40:43], v[68:71], v[232:239], v4
    v_permlane32_swap_b32 v18, v26
    v_permlane32_swap_b32 v19, v27
    s_waitcnt lgkmcnt(4)
    v_smfmac_f32_16x16x64_bf16 v[44:47], v[68:71], v[80:87], v4
    v_add_f32 v16, v16, v24
    v_add_f32 v17, v17, v25
    ds_read_b128 v[80:83], v6 offset:6144
    ds_read_b128 v[84:87], v6 offset:7168
    v_smfmac_f32_16x16x64_bf16 v[32:35], v[72:75], v[192:199], v4
    v_add_f32 v18, v18, v26
    v_add_f32 v19, v19, v27
    v_smfmac_f32_16x16x64_bf16 v[36:39], v[72:75], v[216:223], v4
    v_permlane32_swap_b32 v20, v28
    v_permlane32_swap_b32 v21, v29
    v_smfmac_f32_16x16x64_bf16 v[40:43], v[72:75], v[240:247], v4
    v_permlane32_swap_b32 v22, v30
    v_permlane32_swap_b32 v23, v31
    s_waitcnt lgkmcnt(4)
    v_smfmac_f32_16x16x64_bf16 v[44:47], v[72:75], v[88:95], v4
    v_add_f32 v20, v20, v28
    v_add_f32 v21, v21, v29
    ds_read_b128 v[88:91], v6 offset:8192
    ds_read_b128 v[92:95], v6 offset:9216
    v_smfmac_f32_16x16x64_bf16 v[32:35], v[76:79], v[200:207], v4
    v_add_f32 v22, v22, v30
    v_add_f32 v23, v23, v31
    v_smfmac_f32_16x16x64_bf16 v[36:39], v[76:79], v[224:231], v4
    v_cvt_pk_bf16_f32 v56, v16, v17
    v_cvt_pk_bf16_f32 v57, v18, v19
    v_smfmac_f32_16x16x64_bf16 v[40:43], v[76:79], v[248:255], v4
    v_cvt_pk_bf16_f32 v58, v20, v21
    v_cvt_pk_bf16_f32 v59, v22, v23
    s_waitcnt lgkmcnt(4)
    v_smfmac_f32_16x16x64_bf16 v[44:47], v[76:79], v[96:103], v4
    v_permlane16_swap_b32 v56, v58
    ds_read_b128 v[96:99], v6 offset:10240
    ds_read_b128 v[100:103], v6 offset:11264
    v_permlane16_swap_b32 v57, v59
    v_min_u32 v56, -2, v56
    v_min_u32 v57, -2, v57
    v_min_u32 v58, -2, v58
    v_min_u32 v59, -2, v59
    buffer_store_dwordx4 v[56:59], v14, s[8:11], s43 offen sc1
    s_add_u32 s49, s43, 65536
    s_waitcnt lgkmcnt(4)
    v_smfmac_f32_16x16x64_bf16 v[48:51], v[68:71], v[80:87], v4
    v_permlane32_swap_b32 v32, v40
    v_permlane32_swap_b32 v33, v41
    v_permlane32_swap_b32 v34, v42
    ds_read_b128 v[80:83], v6 offset:12288
    ds_read_b128 v[84:87], v6 offset:13312
    s_waitcnt lgkmcnt(4)
    v_smfmac_f32_16x16x64_bf16 v[48:51], v[72:75], v[88:95], v4
    v_permlane32_swap_b32 v35, v43
    v_add_f32 v32, v32, v40
    v_add_f32 v33, v33, v41
    v_add_f32 v34, v34, v42
    ds_read_b128 v[88:91], v6 offset:14336
    ds_read_b128 v[92:95], v6 offset:15360
    s_waitcnt lgkmcnt(4)
    v_smfmac_f32_16x16x64_bf16 v[48:51], v[76:79], v[96:103], v4
    v_add_f32 v35, v35, v43
    v_permlane32_swap_b32 v36, v44
    v_permlane32_swap_b32 v37, v45
    v_permlane32_swap_b32 v38, v46
    ds_read_b128 v[96:99], v6 offset:16384
    ds_read_b128 v[100:103], v6 offset:17408
    v_permlane32_swap_b32 v39, v47
    v_add_f32 v36, v36, v44
    v_add_f32 v37, v37, v45
    v_add_f32 v38, v38, v46
    s_waitcnt lgkmcnt(4)
    v_smfmac_f32_16x16x64_bf16 v[52:55], v[68:71], v[80:87], v4
    v_add_f32 v39, v39, v47
    v_cvt_pk_bf16_f32 v60, v32, v33
    v_cvt_pk_bf16_f32 v61, v34, v35
    s_waitcnt lgkmcnt(2)
    v_smfmac_f32_16x16x64_bf16 v[52:55], v[72:75], v[88:95], v4
    v_cvt_pk_bf16_f32 v62, v36, v37
    v_cvt_pk_bf16_f32 v63, v38, v39
    s_waitcnt lgkmcnt(0)
    v_smfmac_f32_16x16x64_bf16 v[52:55], v[76:79], v[96:103], v4
    v_permlane16_swap_b32 v60, v62
    v_permlane16_swap_b32 v61, v63
    v_min_u32 v60, -2, v60
    v_min_u32 v61, -2, v61
    v_min_u32 v62, -2, v62
    v_min_u32 v63, -2, v63
    buffer_store_dwordx4 v[60:63], v14, s[8:11], s49 offen sc1
    s_nop 0
    v_permlane32_swap_b32 v48, v52
    v_permlane32_swap_b32 v49, v53
    v_permlane32_swap_b32 v50, v54
    v_permlane32_swap_b32 v51, v55
    v_add_f32 v48, v48, v52
    v_add_f32 v49, v49, v53
    v_add_f32 v50, v50, v54
    v_add_f32 v51, v51, v55
    v_cvt_pk_bf16_f32 v64, v48, v49
    v_cvt_pk_bf16_f32 v65, v50, v51
    v_mov_b32 v66, v64
    v_mov_b32 v67, v65
    s_nop 0
    v_permlane16_swap_b32 v64, v66
    v_permlane16_swap_b32 v65, v67
    v_min_u32 v64, -2, v64
    v_min_u32 v65, -2, v65
    v_min_u32 v66, -2, v66
    v_min_u32 v67, -2, v67
    buffer_store_dwordx4 v[64:67], v15, s[8:11], s43 offen sc1
    s_add_u32 s40, s40, 1
    s_add_u32 s47, s37, 704512
    s_add_u32 s45, s37, 737280
    s_lshl_b32 s24, s40, 12
    s_and_b32 s24, s24, 0x2000
    s_xor_b32 s24, s24, s36
    s_lshl_b32 s37, s40, 20
    s_add_u32 s37, s37, s24
    s_add_u32 s37, s37, 117440512
    s_add_u32 s43, s37, 0
    s_cmp_lt_u32 s40, 64
    s_cbranch_scc1 interleave_layers__linear_attn_block__memory_aug_recurrent_mem_tr__prompt_kernel_v_stepw3
interleave_layers__linear_attn_block__memory_aug_recurrent_mem_tr__prompt_kernel_v_end:
    s_cmp_eq_u32 s92, 0
    s_cbranch_scc0 interleave_layers__linear_attn_block__memory_aug_recurrent_mem_tr__prompt_kernel_end
    s_mov_b32 s92, 1
    s_branch interleave_layers__linear_attn_block__memory_aug_recurrent_mem_tr__prompt_kernel_v_layer
interleave_layers__linear_attn_block__memory_aug_recurrent_mem_tr__prompt_kernel_roleR:
interleave_layers__linear_attn_block__memory_aug_recurrent_mem_tr__prompt_kernel_r_top:
    s_barrier
    s_sub_u32 s24, s2, 64
    s_cmp_ge_u32 s24, 24
    s_cbranch_scc1 interleave_layers__linear_attn_block__memory_aug_recurrent_mem_tr__prompt_kernel_rk26
    s_and_b32 s44, s24, 7
    s_lshr_b32 s45, s24, 3
    s_cmp_eq_u32 s92, 0
    s_cselect_b32 s46, 32, 2
    v_lshlrev_b32 v5, 4, v1
    s_mov_b32 s64, 12288
    s_cmp_eq_u32 s45, 1
    s_cselect_b32 s64, 5120, s64
    s_cmp_eq_u32 s45, 2
    s_cselect_b32 s64, 17408, s64
    s_mov_b32 s65, 1024
    s_cmp_eq_u32 s45, 1
    s_cselect_b32 s65, 7168, s65
    s_cmp_eq_u32 s45, 2
    s_cselect_b32 s65, 13312, s65
    s_mov_b32 s66, 0
    s_cmp_eq_u32 s45, 1
    s_cselect_b32 s66, 6144, s66
    s_cmp_eq_u32 s45, 2
    s_cselect_b32 s66, 14336, s66
    s_mov_b32 s67, 2048
    s_cmp_eq_u32 s45, 1
    s_cselect_b32 s67, 8192, s67
    s_cmp_eq_u32 s45, 2
    s_cselect_b32 s67, 15360, s67
    s_mov_b32 s68, 4096
    s_cmp_eq_u32 s45, 1
    s_cselect_b32 s68, 10240, s68
    s_cmp_eq_u32 s45, 2
    s_cselect_b32 s68, 16384, s68
    s_mov_b32 s69, 3072
    s_cmp_eq_u32 s45, 1
    s_cselect_b32 s69, 9216, s69
    s_cmp_eq_u32 s45, 2
    s_cselect_b32 s69, 16384, s69
    s_mov_b32 s70, 3072
    s_cmp_eq_u32 s45, 1
    s_cselect_b32 s70, 11264, s70
    s_cmp_eq_u32 s45, 2
    s_cselect_b32 s70, 16384, s70
    s_lshl_b32 s24, s92, 3
    s_add_u32 s24, s24, s44
    s_lshl_b32 s24, s24, 7
    s_add_u32 s24, s24, 23101440
    v_mov_b32 v15, s24
    s_cmp_eq_u32 s92, 0
    s_cselect_b32 s26, 31, 1
    s_mov_b64 exec, 1
    s_mov_b32 s61, 0
interleave_layers__linear_attn_block__memory_aug_recurrent_mem_tr__prompt_kernel_k2_w:
    v_mov_b32 v14, 0
    buffer_atomic_add v14, v15, s[8:11], 0 offen sc0 sc1
    s_waitcnt vmcnt(0)
    v_cmp_gt_i32 vcc, s26, v14
    s_cbranch_vccz interleave_layers__linear_attn_block__memory_aug_recurrent_mem_tr__prompt_kernel_k2_w_ok
    s_add_u32 s61, s61, 1
    s_cmp_ge_u32 s61, s60
    s_cbranch_scc1 interleave_layers__linear_attn_block__memory_aug_recurrent_mem_tr__prompt_kernel_k2_w_to
    s_sleep 2
    s_branch interleave_layers__linear_attn_block__memory_aug_recurrent_mem_tr__prompt_kernel_k2_w
interleave_layers__linear_attn_block__memory_aug_recurrent_mem_tr__prompt_kernel_k2_w_to:
    s_mov_b32 s60, 1
interleave_layers__linear_attn_block__memory_aug_recurrent_mem_tr__prompt_kernel_k2_w_ok:
    s_mov_b64 exec, -1
    s_add_u32 s25, s3, 0
    s_mul_i32 s24, s25, 147456
    s_mul_i32 s26, s44, 18432
    s_add_u32 s24, s24, s26
    s_add_u32 s24, s24, 16777216
    s_cmp_lt_u32 s25, s46
    s_cselect_b32 s24, s24, 2146435072
    s_add_u32 s26, s24, s64
    buffer_load_dwordx4 v[16:19], v5, s[8:11], s26 offen sc1
    s_add_u32 s26, s24, s65
    buffer_load_dwordx4 v[20:23], v5, s[8:11], s26 offen sc1
    s_add_u32 s26, s24, s66
    buffer_load_dwordx4 v[24:27], v5, s[8:11], s26 offen sc1
    s_add_u32 s26, s24, s67
    buffer_load_dwordx4 v[28:31], v5, s[8:11], s26 offen sc1
    s_add_u32 s26, s24, s68
    buffer_load_dwordx4 v[32:35], v5, s[8:11], s26 offen sc1
    s_add_u32 s26, s24, s69
    buffer_load_dwordx4 v[36:39], v5, s[8:11], s26 offen sc1
    s_add_u32 s26, s24, s70
    buffer_load_dwordx4 v[40:43], v5, s[8:11], s26 offen sc1
    s_add_u32 s25, s3, 4
    s_mul_i32 s24, s25, 147456
    s_mul_i32 s26, s44, 18432
    s_add_u32 s24, s24, s26
    s_add_u32 s24, s24, 16777216
    s_cmp_lt_u32 s25, s46
    s_cselect_b32 s24, s24, 2146435072
    s_add_u32 s26, s24, s64
    buffer_load_dwordx4 v[44:47], v5, s[8:11], s26 offen sc1
    s_add_u32 s26, s24, s65
    buffer_load_dwordx4 v[48:51], v5, s[8:11], s26 offen sc1
    s_add_u32 s26, s24, s66
    buffer_load_dwordx4 v[52:55], v5, s[8:11], s26 offen sc1
    s_add_u32 s26, s24, s67
    buffer_load_dwordx4 v[56:59], v5, s[8:11], s26 offen sc1
    s_add_u32 s26, s24, s68
    buffer_load_dwordx4 v[60:63], v5, s[8:11], s26 offen sc1
    s_add_u32 s26, s24, s69
    buffer_load_dwordx4 v[64:67], v5, s[8:11], s26 offen sc1
    s_add_u32 s26, s24, s70
    buffer_load_dwordx4 v[68:71], v5, s[8:11], s26 offen sc1
    s_add_u32 s25, s3, 8
    s_mul_i32 s24, s25, 147456
    s_mul_i32 s26, s44, 18432
    s_add_u32 s24, s24, s26
    s_add_u32 s24, s24, 16777216
    s_cmp_lt_u32 s25, s46
    s_cselect_b32 s24, s24, 2146435072
    s_add_u32 s26, s24, s64
    buffer_load_dwordx4 v[72:75], v5, s[8:11], s26 offen sc1
    s_add_u32 s26, s24, s65
    buffer_load_dwordx4 v[76:79], v5, s[8:11], s26 offen sc1
    s_add_u32 s26, s24, s66
    buffer_load_dwordx4 v[80:83], v5, s[8:11], s26 offen sc1
    s_add_u32 s26, s24, s67
    buffer_load_dwordx4 v[84:87], v5, s[8:11], s26 offen sc1
    s_add_u32 s26, s24, s68
    buffer_load_dwordx4 v[88:91], v5, s[8:11], s26 offen sc1
    s_add_u32 s26, s24, s69
    buffer_load_dwordx4 v[92:95], v5, s[8:11], s26 offen sc1
    s_add_u32 s26, s24, s70
    buffer_load_dwordx4 v[96:99], v5, s[8:11], s26 offen sc1
    s_add_u32 s25, s3, 12
    s_mul_i32 s24, s25, 147456
    s_mul_i32 s26, s44, 18432
    s_add_u32 s24, s24, s26
    s_add_u32 s24, s24, 16777216
    s_cmp_lt_u32 s25, s46
    s_cselect_b32 s24, s24, 2146435072
    s_add_u32 s26, s24, s64
    buffer_load_dwordx4 v[100:103], v5, s[8:11], s26 offen sc1
    s_add_u32 s26, s24, s65
    buffer_load_dwordx4 v[104:107], v5, s[8:11], s26 offen sc1
    s_add_u32 s26, s24, s66
    buffer_load_dwordx4 v[108:111], v5, s[8:11], s26 offen sc1
    s_add_u32 s26, s24, s67
    buffer_load_dwordx4 v[112:115], v5, s[8:11], s26 offen sc1
    s_add_u32 s26, s24, s68
    buffer_load_dwordx4 v[116:119], v5, s[8:11], s26 offen sc1
    s_add_u32 s26, s24, s69
    buffer_load_dwordx4 v[120:123], v5, s[8:11], s26 offen sc1
    s_add_u32 s26, s24, s70
    buffer_load_dwordx4 v[124:127], v5, s[8:11], s26 offen sc1
    s_add_u32 s25, s3, 16
    s_mul_i32 s24, s25, 147456
    s_mul_i32 s26, s44, 18432
    s_add_u32 s24, s24, s26
    s_add_u32 s24, s24, 16777216
    s_cmp_lt_u32 s25, s46
    s_cselect_b32 s24, s24, 2146435072
    s_add_u32 s26, s24, s64
    buffer_load_dwordx4 v[128:131], v5, s[8:11], s26 offen sc1
    s_add_u32 s26, s24, s65
    buffer_load_dwordx4 v[132:135], v5, s[8:11], s26 offen sc1
    s_add_u32 s26, s24, s66
    buffer_load_dwordx4 v[136:139], v5, s[8:11], s26 offen sc1
    s_add_u32 s26, s24, s67
    buffer_load_dwordx4 v[140:143], v5, s[8:11], s26 offen sc1
    s_add_u32 s26, s24, s68
    buffer_load_dwordx4 v[144:147], v5, s[8:11], s26 offen sc1
    s_add_u32 s26, s24, s69
    buffer_load_dwordx4 v[148:151], v5, s[8:11], s26 offen sc1
    s_add_u32 s26, s24, s70
    buffer_load_dwordx4 v[152:155], v5, s[8:11], s26 offen sc1
    s_add_u32 s25, s3, 20
    s_mul_i32 s24, s25, 147456
    s_mul_i32 s26, s44, 18432
    s_add_u32 s24, s24, s26
    s_add_u32 s24, s24, 16777216
    s_cmp_lt_u32 s25, s46
    s_cselect_b32 s24, s24, 2146435072
    s_add_u32 s26, s24, s64
    buffer_load_dwordx4 v[156:159], v5, s[8:11], s26 offen sc1
    s_add_u32 s26, s24, s65
    buffer_load_dwordx4 v[160:163], v5, s[8:11], s26 offen sc1
    s_add_u32 s26, s24, s66
    buffer_load_dwordx4 v[164:167], v5, s[8:11], s26 offen sc1
    s_add_u32 s26, s24, s67
    buffer_load_dwordx4 v[168:171], v5, s[8:11], s26 offen sc1
    s_add_u32 s26, s24, s68
    buffer_load_dwordx4 v[172:175], v5, s[8:11], s26 offen sc1
    s_add_u32 s26, s24, s69
    buffer_load_dwordx4 v[176:179], v5, s[8:11], s26 offen sc1
    s_add_u32 s26, s24, s70
    buffer_load_dwordx4 v[180:183], v5, s[8:11], s26 offen sc1
    s_add_u32 s25, s3, 24
    s_mul_i32 s24, s25, 147456
    s_mul_i32 s26, s44, 18432
    s_add_u32 s24, s24, s26
    s_add_u32 s24, s24, 16777216
    s_cmp_lt_u32 s25, s46
    s_cselect_b32 s24, s24, 2146435072
    s_add_u32 s26, s24, s64
    buffer_load_dwordx4 v[184:187], v5, s[8:11], s26 offen sc1
    s_add_u32 s26, s24, s65
    buffer_load_dwordx4 v[188:191], v5, s[8:11], s26 offen sc1
    s_add_u32 s26, s24, s66
    buffer_load_dwordx4 v[192:195], v5, s[8:11], s26 offen sc1
    s_add_u32 s26, s24, s67
    buffer_load_dwordx4 v[196:199], v5, s[8:11], s26 offen sc1
    s_add_u32 s26, s24, s68
    buffer_load_dwordx4 v[200:203], v5, s[8:11], s26 offen sc1
    s_add_u32 s26, s24, s69
    buffer_load_dwordx4 v[204:207], v5, s[8:11], s26 offen sc1
    s_add_u32 s26, s24, s70
    buffer_load_dwordx4 v[208:211], v5, s[8:11], s26 offen sc1
    s_add_u32 s25, s3, 28
    s_mul_i32 s24, s25, 147456
    s_mul_i32 s26, s44, 18432
    s_add_u32 s24, s24, s26
    s_add_u32 s24, s24, 16777216
    s_cmp_lt_u32 s25, s46
    s_cselect_b32 s24, s24, 2146435072
    s_add_u32 s26, s24, s64
    buffer_load_dwordx4 v[212:215], v5, s[8:11], s26 offen sc1
    s_add_u32 s26, s24, s65
    buffer_load_dwordx4 v[216:219], v5, s[8:11], s26 offen sc1
    s_add_u32 s26, s24, s66
    buffer_load_dwordx4 v[220:223], v5, s[8:11], s26 offen sc1
    s_add_u32 s26, s24, s67
    buffer_load_dwordx4 v[224:227], v5, s[8:11], s26 offen sc1
    s_add_u32 s26, s24, s68
    buffer_load_dwordx4 v[228:231], v5, s[8:11], s26 offen sc1
    s_add_u32 s26, s24, s69
    buffer_load_dwordx4 v[232:235], v5, s[8:11], s26 offen sc1
    s_add_u32 s26, s24, s70
    buffer_load_dwordx4 v[236:239], v5, s[8:11], s26 offen sc1
    s_waitcnt vmcnt(42)
    v_pk_add_f32 v[16:17], v[16:17], v[44:45]
    v_pk_add_f32 v[18:19], v[18:19], v[46:47]
    v_pk_add_f32 v[20:21], v[20:21], v[48:49]
    v_pk_add_f32 v[22:23], v[22:23], v[50:51]
    v_pk_add_f32 v[24:25], v[24:25], v[52:53]
    v_pk_add_f32 v[26:27], v[26:27], v[54:55]
    v_pk_add_f32 v[28:29], v[28:29], v[56:57]
    v_pk_add_f32 v[30:31], v[30:31], v[58:59]
    v_pk_add_f32 v[32:33], v[32:33], v[60:61]
    v_pk_add_f32 v[34:35], v[34:35], v[62:63]
    v_pk_add_f32 v[36:37], v[36:37], v[64:65]
    v_pk_add_f32 v[38:39], v[38:39], v[66:67]
    v_pk_add_f32 v[40:41], v[40:41], v[68:69]
    v_pk_add_f32 v[42:43], v[42:43], v[70:71]
    s_waitcnt vmcnt(35)
    v_pk_add_f32 v[16:17], v[16:17], v[72:73]
    v_pk_add_f32 v[18:19], v[18:19], v[74:75]
    v_pk_add_f32 v[20:21], v[20:21], v[76:77]
    v_pk_add_f32 v[22:23], v[22:23], v[78:79]
    v_pk_add_f32 v[24:25], v[24:25], v[80:81]
    v_pk_add_f32 v[26:27], v[26:27], v[82:83]
    v_pk_add_f32 v[28:29], v[28:29], v[84:85]
    v_pk_add_f32 v[30:31], v[30:31], v[86:87]
    v_pk_add_f32 v[32:33], v[32:33], v[88:89]
    v_pk_add_f32 v[34:35], v[34:35], v[90:91]
    v_pk_add_f32 v[36:37], v[36:37], v[92:93]
    v_pk_add_f32 v[38:39], v[38:39], v[94:95]
    v_pk_add_f32 v[40:41], v[40:41], v[96:97]
    v_pk_add_f32 v[42:43], v[42:43], v[98:99]
    s_waitcnt vmcnt(28)
    v_pk_add_f32 v[16:17], v[16:17], v[100:101]
    v_pk_add_f32 v[18:19], v[18:19], v[102:103]
    v_pk_add_f32 v[20:21], v[20:21], v[104:105]
    v_pk_add_f32 v[22:23], v[22:23], v[106:107]
    v_pk_add_f32 v[24:25], v[24:25], v[108:109]
    v_pk_add_f32 v[26:27], v[26:27], v[110:111]
    v_pk_add_f32 v[28:29], v[28:29], v[112:113]
    v_pk_add_f32 v[30:31], v[30:31], v[114:115]
    v_pk_add_f32 v[32:33], v[32:33], v[116:117]
    v_pk_add_f32 v[34:35], v[34:35], v[118:119]
    v_pk_add_f32 v[36:37], v[36:37], v[120:121]
    v_pk_add_f32 v[38:39], v[38:39], v[122:123]
    v_pk_add_f32 v[40:41], v[40:41], v[124:125]
    v_pk_add_f32 v[42:43], v[42:43], v[126:127]
    s_waitcnt vmcnt(21)
    v_pk_add_f32 v[16:17], v[16:17], v[128:129]
    v_pk_add_f32 v[18:19], v[18:19], v[130:131]
    v_pk_add_f32 v[20:21], v[20:21], v[132:133]
    v_pk_add_f32 v[22:23], v[22:23], v[134:135]
    v_pk_add_f32 v[24:25], v[24:25], v[136:137]
    v_pk_add_f32 v[26:27], v[26:27], v[138:139]
    v_pk_add_f32 v[28:29], v[28:29], v[140:141]
    v_pk_add_f32 v[30:31], v[30:31], v[142:143]
    v_pk_add_f32 v[32:33], v[32:33], v[144:145]
    v_pk_add_f32 v[34:35], v[34:35], v[146:147]
    v_pk_add_f32 v[36:37], v[36:37], v[148:149]
    v_pk_add_f32 v[38:39], v[38:39], v[150:151]
    v_pk_add_f32 v[40:41], v[40:41], v[152:153]
    v_pk_add_f32 v[42:43], v[42:43], v[154:155]
    s_waitcnt vmcnt(14)
    v_pk_add_f32 v[16:17], v[16:17], v[156:157]
    v_pk_add_f32 v[18:19], v[18:19], v[158:159]
    v_pk_add_f32 v[20:21], v[20:21], v[160:161]
    v_pk_add_f32 v[22:23], v[22:23], v[162:163]
    v_pk_add_f32 v[24:25], v[24:25], v[164:165]
    v_pk_add_f32 v[26:27], v[26:27], v[166:167]
    v_pk_add_f32 v[28:29], v[28:29], v[168:169]
    v_pk_add_f32 v[30:31], v[30:31], v[170:171]
    v_pk_add_f32 v[32:33], v[32:33], v[172:173]
    v_pk_add_f32 v[34:35], v[34:35], v[174:175]
    v_pk_add_f32 v[36:37], v[36:37], v[176:177]
    v_pk_add_f32 v[38:39], v[38:39], v[178:179]
    v_pk_add_f32 v[40:41], v[40:41], v[180:181]
    v_pk_add_f32 v[42:43], v[42:43], v[182:183]
    s_waitcnt vmcnt(7)
    v_pk_add_f32 v[16:17], v[16:17], v[184:185]
    v_pk_add_f32 v[18:19], v[18:19], v[186:187]
    v_pk_add_f32 v[20:21], v[20:21], v[188:189]
    v_pk_add_f32 v[22:23], v[22:23], v[190:191]
    v_pk_add_f32 v[24:25], v[24:25], v[192:193]
    v_pk_add_f32 v[26:27], v[26:27], v[194:195]
    v_pk_add_f32 v[28:29], v[28:29], v[196:197]
    v_pk_add_f32 v[30:31], v[30:31], v[198:199]
    v_pk_add_f32 v[32:33], v[32:33], v[200:201]
    v_pk_add_f32 v[34:35], v[34:35], v[202:203]
    v_pk_add_f32 v[36:37], v[36:37], v[204:205]
    v_pk_add_f32 v[38:39], v[38:39], v[206:207]
    v_pk_add_f32 v[40:41], v[40:41], v[208:209]
    v_pk_add_f32 v[42:43], v[42:43], v[210:211]
    s_waitcnt vmcnt(0)
    v_pk_add_f32 v[16:17], v[16:17], v[212:213]
    v_pk_add_f32 v[18:19], v[18:19], v[214:215]
    v_pk_add_f32 v[20:21], v[20:21], v[216:217]
    v_pk_add_f32 v[22:23], v[22:23], v[218:219]
    v_pk_add_f32 v[24:25], v[24:25], v[220:221]
    v_pk_add_f32 v[26:27], v[26:27], v[222:223]
    v_pk_add_f32 v[28:29], v[28:29], v[224:225]
    v_pk_add_f32 v[30:31], v[30:31], v[226:227]
    v_pk_add_f32 v[32:33], v[32:33], v[228:229]
    v_pk_add_f32 v[34:35], v[34:35], v[230:231]
    v_pk_add_f32 v[36:37], v[36:37], v[232:233]
    v_pk_add_f32 v[38:39], v[38:39], v[234:235]
    v_pk_add_f32 v[40:41], v[40:41], v[236:237]
    v_pk_add_f32 v[42:43], v[42:43], v[238:239]
    s_mul_i32 s24, s3, 7168
    v_add_u32 v6, s24, v5
    ds_write_b128 v6, v[16:19] offset:0
    ds_write_b128 v6, v[20:23] offset:1024
    ds_write_b128 v6, v[24:27] offset:2048
    ds_write_b128 v6, v[28:31] offset:3072
    ds_write_b128 v6, v[32:35] offset:4096
    ds_write_b128 v6, v[36:39] offset:5120
    ds_write_b128 v6, v[40:43] offset:6144
    s_waitcnt lgkmcnt(0)
    s_barrier
    s_mov_b32 s41, 0
    s_cmp_eq_u32 s45, 1
    s_cselect_b32 s41, 4, s41
    s_cmp_eq_u32 s45, 2
    s_cselect_b32 s41, 9, s41
    s_mov_b32 s42, 4
    s_cmp_eq_u32 s45, 1
    s_cselect_b32 s42, 5, s42
    s_cmp_eq_u32 s45, 2
    s_cselect_b32 s42, 5, s42
    s_mul_i32 s43, s92, 131072
    s_mul_i32 s24, s44, 14336
    s_add_u32 s43, s43, s24
    s_add_u32 s43, s43, 22020096
    v_and_b32 v7, 3, v2
    v_lshrrev_b32 v8, 2, v2
    s_add_u32 s40, s3, 0
    s_cmp_lt_u32 s40, s42
    s_cbranch_scc0 interleave_layers__linear_attn_block__memory_aug_recurrent_mem_tr__prompt_kernel_k2f27
    s_add_u32 s40, s40, s41
    s_mov_b32 s47, 67633672
    s_cmp_eq_u32 s40, 1
    s_cselect_b32 s47, 67699226, s47
    s_cmp_eq_u32 s40, 2
    s_cselect_b32 s47, 67702404, s47
    s_cmp_eq_u32 s40, 3
    s_cselect_b32 s47, 67765224, s47
    s_cmp_eq_u32 s40, 4
    s_cselect_b32 s47, 67765896, s47
    s_cmp_eq_u32 s40, 5
    s_cselect_b32 s47, 67831450, s47
    s_cmp_eq_u32 s40, 6
    s_cselect_b32 s47, 67833604, s47
    s_cmp_eq_u32 s40, 7
    s_cselect_b32 s47, 67897320, s47
    s_cmp_eq_u32 s40, 8
    s_cselect_b32 s47, 67899142, s47
    s_cmp_eq_u32 s40, 9
    s_cselect_b32 s47, 75497992, s47
    s_cmp_eq_u32 s40, 10
    s_cselect_b32 s47, 75499162, s47
    s_cmp_eq_u32 s40, 11
    s_cselect_b32 s47, 75501316, s47
    s_cmp_eq_u32 s40, 12
    s_cselect_b32 s47, 247768, s47
    s_cmp_eq_u32 s40, 13
    s_cselect_b32 s47, 249604, s47
    s_bfe_u32 s24, s47, 0x7000c
    s_bfe_u32 s25, s47, 0x50013
    s_bfe_u32 s26, s47, 0x30018
    v_mul_u32_u24 v9, s25, v7
    v_mul_u32_u24 v10, s26, v8
    v_add3_u32 v9, v9, v10, s24
    v_mul_u32_u24 v9, 205, v9
    v_lshrrev_b32 v9, 12, v9
    s_bfe_u32 s24, s47, 196608
    s_lshl_b32 s24, s24, 10
    v_add_u32 v10, s24, v5
    ds_read_b128 v[160:163], v10 offset:0
    ds_read_b128 v[164:167], v10 offset:7168
    ds_read_b128 v[168:171], v10 offset:14336
    ds_read_b128 v[172:175], v10 offset:21504
    s_bfe_u32 s25, s47, 196614
    s_lshl_b32 s25, s25, 4
    v_lshl_add_u32 v11, v3, 2, s25
    v_mul_u32_u24 v11, 205, v11
    v_lshrrev_b32 v11, 12, v11
    v_cmp_eq_u32 vcc, v9, v11
    s_waitcnt lgkmcnt(0)
    v_pk_add_f32 v[160:161], v[160:161], v[164:165]
    v_pk_add_f32 v[168:169], v[168:169], v[172:173]
    v_pk_add_f32 v[162:163], v[162:163], v[166:167]
    v_pk_add_f32 v[170:171], v[170:171], v[174:175]
    v_pk_add_f32 v[160:161], v[160:161], v[168:169]
    v_pk_add_f32 v[162:163], v[162:163], v[170:171]
    v_cvt_pk_bf16_f32 v176, v160, v161
    v_cvt_pk_bf16_f32 v177, v162, v163
    v_cndmask_b32 v176, 0, v176, vcc
    v_cndmask_b32 v177, 0, v177, vcc
    s_bfe_u32 s24, s47, 196611
    s_lshl_b32 s24, s24, 10
    v_add_u32 v10, s24, v5
    ds_read_b128 v[160:163], v10 offset:0
    ds_read_b128 v[164:167], v10 offset:7168
    ds_read_b128 v[168:171], v10 offset:14336
    ds_read_b128 v[172:175], v10 offset:21504
    s_bfe_u32 s25, s47, 196617
    s_lshl_b32 s25, s25, 4
    v_lshl_add_u32 v11, v3, 2, s25
    v_mul_u32_u24 v11, 205, v11
    v_lshrrev_b32 v11, 12, v11
    v_cmp_eq_u32 vcc, v9, v11
    s_waitcnt lgkmcnt(0)
    v_pk_add_f32 v[160:161], v[160:161], v[164:165]
    v_pk_add_f32 v[168:169], v[168:169], v[172:173]
    v_pk_add_f32 v[162:163], v[162:163], v[166:167]
    v_pk_add_f32 v[170:171], v[170:171], v[174:175]
    v_pk_add_f32 v[160:161], v[160:161], v[168:169]
    v_pk_add_f32 v[162:163], v[162:163], v[170:171]
    v_cvt_pk_bf16_f32 v178, v160, v161
    v_cvt_pk_bf16_f32 v179, v162, v163
    v_cndmask_b32 v178, 0, v178, vcc
    v_cndmask_b32 v179, 0, v179, vcc
    s_lshl_b32 s24, s40, 10
    s_add_u32 s24, s24, s43
    buffer_store_dwordx4 v[176:179], v5, s[8:11], s24 offen sc1
interleave_layers__linear_attn_block__memory_aug_recurrent_mem_tr__prompt_kernel_k2f27:
    s_add_u32 s40, s3, 4
    s_cmp_lt_u32 s40, s42
    s_cbranch_scc0 interleave_layers__linear_attn_block__memory_aug_recurrent_mem_tr__prompt_kernel_k2f28
    s_add_u32 s40, s40, s41
    s_mov_b32 s47, 67633672
    s_cmp_eq_u32 s40, 1
    s_cselect_b32 s47, 67699226, s47
    s_cmp_eq_u32 s40, 2
    s_cselect_b32 s47, 67702404, s47
    s_cmp_eq_u32 s40, 3
    s_cselect_b32 s47, 67765224, s47
    s_cmp_eq_u32 s40, 4
    s_cselect_b32 s47, 67765896, s47
    s_cmp_eq_u32 s40, 5
    s_cselect_b32 s47, 67831450, s47
    s_cmp_eq_u32 s40, 6
    s_cselect_b32 s47, 67833604, s47
    s_cmp_eq_u32 s40, 7
    s_cselect_b32 s47, 67897320, s47
    s_cmp_eq_u32 s40, 8
    s_cselect_b32 s47, 67899142, s47
    s_cmp_eq_u32 s40, 9
    s_cselect_b32 s47, 75497992, s47
    s_cmp_eq_u32 s40, 10
    s_cselect_b32 s47, 75499162, s47
    s_cmp_eq_u32 s40, 11
    s_cselect_b32 s47, 75501316, s47
    s_cmp_eq_u32 s40, 12
    s_cselect_b32 s47, 247768, s47
    s_cmp_eq_u32 s40, 13
    s_cselect_b32 s47, 249604, s47
    s_bfe_u32 s24, s47, 0x7000c
    s_bfe_u32 s25, s47, 0x50013
    s_bfe_u32 s26, s47, 0x30018
    v_mul_u32_u24 v9, s25, v7
    v_mul_u32_u24 v10, s26, v8
    v_add3_u32 v9, v9, v10, s24
    v_mul_u32_u24 v9, 205, v9
    v_lshrrev_b32 v9, 12, v9
    s_bfe_u32 s24, s47, 196608
    s_lshl_b32 s24, s24, 10
    v_add_u32 v10, s24, v5
    ds_read_b128 v[160:163], v10 offset:0
    ds_read_b128 v[164:167], v10 offset:7168
    ds_read_b128 v[168:171], v10 offset:14336
    ds_read_b128 v[172:175], v10 offset:21504
    s_bfe_u32 s25, s47, 196614
    s_lshl_b32 s25, s25, 4
    v_lshl_add_u32 v11, v3, 2, s25
    v_mul_u32_u24 v11, 205, v11
    v_lshrrev_b32 v11, 12, v11
    v_cmp_eq_u32 vcc, v9, v11
    s_waitcnt lgkmcnt(0)
    v_pk_add_f32 v[160:161], v[160:161], v[164:165]
    v_pk_add_f32 v[168:169], v[168:169], v[172:173]
    v_pk_add_f32 v[162:163], v[162:163], v[166:167]
    v_pk_add_f32 v[170:171], v[170:171], v[174:175]
    v_pk_add_f32 v[160:161], v[160:161], v[168:169]
    v_pk_add_f32 v[162:163], v[162:163], v[170:171]
    v_cvt_pk_bf16_f32 v176, v160, v161
    v_cvt_pk_bf16_f32 v177, v162, v163
    v_cndmask_b32 v176, 0, v176, vcc
    v_cndmask_b32 v177, 0, v177, vcc
    s_bfe_u32 s24, s47, 196611
    s_lshl_b32 s24, s24, 10
    v_add_u32 v10, s24, v5
    ds_read_b128 v[160:163], v10 offset:0
    ds_read_b128 v[164:167], v10 offset:7168
    ds_read_b128 v[168:171], v10 offset:14336
    ds_read_b128 v[172:175], v10 offset:21504
    s_bfe_u32 s25, s47, 196617
    s_lshl_b32 s25, s25, 4
    v_lshl_add_u32 v11, v3, 2, s25
    v_mul_u32_u24 v11, 205, v11
    v_lshrrev_b32 v11, 12, v11
    v_cmp_eq_u32 vcc, v9, v11
    s_waitcnt lgkmcnt(0)
    v_pk_add_f32 v[160:161], v[160:161], v[164:165]
    v_pk_add_f32 v[168:169], v[168:169], v[172:173]
    v_pk_add_f32 v[162:163], v[162:163], v[166:167]
    v_pk_add_f32 v[170:171], v[170:171], v[174:175]
    v_pk_add_f32 v[160:161], v[160:161], v[168:169]
    v_pk_add_f32 v[162:163], v[162:163], v[170:171]
    v_cvt_pk_bf16_f32 v178, v160, v161
    v_cvt_pk_bf16_f32 v179, v162, v163
    v_cndmask_b32 v178, 0, v178, vcc
    v_cndmask_b32 v179, 0, v179, vcc
    s_lshl_b32 s24, s40, 10
    s_add_u32 s24, s24, s43
    buffer_store_dwordx4 v[176:179], v5, s[8:11], s24 offen sc1
interleave_layers__linear_attn_block__memory_aug_recurrent_mem_tr__prompt_kernel_k2f28:
    s_waitcnt vmcnt(0)
    s_barrier
    s_lshl_b32 s24, s92, 7
    s_sub_u32 s25, s2, 64
    s_lshl_b32 s25, s25, 2
    s_add_u32 s24, s24, s25
    s_add_u32 s24, s24, 23103488
    s_cmp_eq_u32 s3, 0
    s_cbranch_scc0 interleave_layers__linear_attn_block__memory_aug_recurrent_mem_tr__prompt_kernel_pb29
    v_lshlrev_b32 v14, 7, v1
    v_add_u32 v14, s24, v14
    v_mov_b32 v15, 2146435072
    v_cmp_le_u32 vcc, 1, v1
    s_nop 1
    v_cndmask_b32 v14, v14, v15, vcc
    v_mov_b32 v15, 1
    buffer_store_dword v15, v14, s[8:11], 0 offen sc1
interleave_layers__linear_attn_block__memory_aug_recurrent_mem_tr__prompt_kernel_pb29:
interleave_layers__linear_attn_block__memory_aug_recurrent_mem_tr__prompt_kernel_rk26:
    s_sub_u32 s44, s2, 64
    v_lshlrev_b32 v5, 4, v1
    s_lshl_b32 s24, s44, 15
    s_lshl_b32 s25, s3, 13
    s_add_u32 s24, s24, s25
    v_add_u32 v6, s24, v5
    v_add_u32 v7, 4096, v6
    s_lshl_b32 s24, s3, 12
    s_and_b32 s25, s24, 0x2000
    s_add_u32 s24, s24, s25
    v_add_u32 v8, s24, v5
    s_lshl_b32 s24, s3, 10
    s_add_u32 s24, s24, 32768
    v_add_u32 v9, s24, v5
    s_lshl_b32 s24, s44, 14
    s_lshl_b32 s25, s3, 11
    s_add_u32 s24, s24, s25
    v_add_u32 v10, s24, v5
    v_and_b32 v204, 7, v2
    v_mul_u32_u24 v11, 80, v204
    v_lshl_add_u32 v11, v3, 4, v11
    s_mul_i32 s24, s3, 640
    v_add_u32 v11, s24, v11
    v_add_u32 v204, 8192, v5
    v_cmp_gt_u32 vcc, 8, v2
    s_nop 1
    v_cndmask_b32 v11, v204, v11, vcc
    v_and_b32 v204, 7, v2
    v_mul_u32_u24 v12, 80, v204
    v_lshrrev_b32 v204, 3, v2
    v_lshl_add_u32 v12, v204, 5, v12
    v_lshlrev_b32 v13, 4, v2
    s_lshl_b32 s24, s44, 8
    s_and_b32 s25, s24, 0x2000
    s_add_u32 s24, s24, s25
    v_add_u32 v13, s24, v13
    v_mov_b32 v204, 2146435072
    v_cmp_gt_u32 vcc, 1, v3
    s_nop 1
    v_cndmask_b32 v13, v204, v13, vcc
    v_cmp_le_u32 s[50:51], 8, v2
    s_and_b32 s25, s44, 15
    s_lshr_b32 s25, s25, 2
    s_sub_u32 s26, s44, 32
    s_lshr_b32 s26, s26, 1
    s_cmp_ge_u32 s44, 32
    s_cselect_b32 s25, s26, s25
    s_mul_i32 s24, s25, 16
    v_add_u32 v120, s24, v1
    v_lshlrev_b32 v120, 7, v120
    v_mov_b32 v204, 2146435072
    v_cmp_le_u32 vcc, 16, v1
    s_nop 1
    v_cndmask_b32 v120, v120, v204, vcc
    s_and_b32 s24, s44, 7
    s_mul_i32 s25, s3, 8
    s_add_u32 s24, s24, s25
    s_lshl_b32 s24, s24, 7
    v_mov_b32 v125, s24
    v_mov_b32 v122, 12288
    v_mov_b32 v123, 0
    s_barrier
    ds_write_b32 v122, v123
    v_mov_b32 v123, 1
    s_waitcnt lgkmcnt(0)
    s_barrier
    s_mov_b32 s93, 0
    s_lshl_b32 s24, s93, 12
    s_and_b32 s24, s24, 0x2000
    s_xor_b32 s24, s24, s36
    s_lshl_b32 s93, s93, 20
    s_add_u32 s93, s93, s24
    s_add_u32 s93, s93, 117440512
    s_mul_i32 s94, s92, 16384
    s_add_u32 s94, s94, 23068672
    s_mov_b32 s40, 0
    s_mov_b32 s41, 184549376
    s_add_u32 s45, s93, 753664
    s_add_u32 s46, s93, 737280
    s_add_u32 s43, s93, 655360
    s_add_u32 s42, s93, 0
    s_add_u32 s47, s93, 704512
    v_and_b32 v252, 7, v1
    v_lshlrev_b32 v252, 7, v252
    s_lshl_b32 s24, s3, 10
    s_add_u32 s24, s24, 12288
    s_add_u32 s24, s24, s94
    v_add_u32 v252, s24, v252
    s_mov_b32 s62, -1
    s_mov_b32 s63, 1
    s_cmp_ge_i32 s62, s63
    s_cbranch_scc1 interleave_layers__linear_attn_block__memory_aug_recurrent_mem_tr__prompt_kernel_r_en0_ok
    s_mov_b32 s61, 0
interleave_layers__linear_attn_block__memory_aug_recurrent_mem_tr__prompt_kernel_r_en0:
    buffer_load_dword v253, v252, s[8:11], 0 offen sc1
    s_waitcnt vmcnt(0)
    v_readlane_b32 s62, v253, 0
    v_readlane_b32 s24, v253, 1
    s_min_i32 s62, s62, s24
    v_readlane_b32 s24, v253, 2
    s_min_i32 s62, s62, s24
    v_readlane_b32 s24, v253, 3
    s_min_i32 s62, s62, s24
    v_readlane_b32 s24, v253, 4
    s_min_i32 s62, s62, s24
    v_readlane_b32 s24, v253, 5
    s_min_i32 s62, s62, s24
    v_readlane_b32 s24, v253, 6
    s_min_i32 s62, s62, s24
    v_readlane_b32 s24, v253, 7
    s_min_i32 s62, s62, s24
    s_cmp_ge_i32 s62, s63
    s_cbranch_scc1 interleave_layers__linear_attn_block__memory_aug_recurrent_mem_tr__prompt_kernel_r_en0_ok
    s_add_u32 s61, s61, 1
    s_cmp_ge_u32 s61, s60
    s_cbranch_scc1 interleave_layers__linear_attn_block__memory_aug_recurrent_mem_tr__prompt_kernel_r_en0_to
    s_sleep 2
    s_branch interleave_layers__linear_attn_block__memory_aug_recurrent_mem_tr__prompt_kernel_r_en0
interleave_layers__linear_attn_block__memory_aug_recurrent_mem_tr__prompt_kernel_r_en0_to:
    s_mov_b32 s60, 1
interleave_layers__linear_attn_block__memory_aug_recurrent_mem_tr__prompt_kernel_r_en0_ok:
    buffer_load_dwordx4 v[48:51], v6, s[8:11], s41 offen offset:0 sc1
    buffer_load_dwordx4 v[52:55], v6, s[8:11], s41 offen offset:1024 sc1
    buffer_load_dwordx4 v[56:59], v6, s[8:11], s41 offen offset:2048 sc1
    buffer_load_dwordx4 v[60:63], v6, s[8:11], s41 offen offset:3072 sc1
    buffer_load_dwordx4 v[64:67], v7, s[8:11], s41 offen offset:0 sc1
    buffer_load_dwordx4 v[68:71], v7, s[8:11], s41 offen offset:1024 sc1
    buffer_load_dwordx4 v[72:75], v7, s[8:11], s41 offen offset:2048 sc1
    buffer_load_dwordx4 v[76:79], v7, s[8:11], s41 offen offset:3072 sc1
    s_add_u32 s41, s41, 1310720
    s_mov_b32 s58, 0
interleave_layers__linear_attn_block__memory_aug_recurrent_mem_tr__prompt_kernel_r_step:
    s_waitcnt vmcnt(0)
    v_mov_b32 v16, v48
    v_mov_b32 v17, v49
    v_mov_b32 v18, v50
    v_mov_b32 v19, v51
    v_mov_b32 v20, v52
    v_mov_b32 v21, v53
    v_mov_b32 v22, v54
    v_mov_b32 v23, v55
    v_mov_b32 v24, v56
    v_mov_b32 v25, v57
    v_mov_b32 v26, v58
    v_mov_b32 v27, v59
    v_mov_b32 v28, v60
    v_mov_b32 v29, v61
    v_mov_b32 v30, v62
    v_mov_b32 v31, v63
    v_mov_b32 v32, v64
    v_mov_b32 v33, v65
    v_mov_b32 v34, v66
    v_mov_b32 v35, v67
    v_mov_b32 v36, v68
    v_mov_b32 v37, v69
    v_mov_b32 v38, v70
    v_mov_b32 v39, v71
    v_mov_b32 v40, v72
    v_mov_b32 v41, v73
    v_mov_b32 v42, v74
    v_mov_b32 v43, v75
    v_mov_b32 v44, v76
    v_mov_b32 v45, v77
    v_mov_b32 v46, v78
    v_mov_b32 v47, v79
    s_lshl_b32 s95, s92, 6
    s_add_u32 s95, s95, s40
    s_add_u32 s95, s95, 1
    s_cmp_ge_i32 s59, s95
    s_cbranch_scc1 interleave_layers__linear_attn_block__memory_aug_recurrent_mem_tr__prompt_kernel_r_ec_ok
    s_and_b32 s24, s2, 7
    s_lshl_b32 s24, s24, 7
    s_add_u32 s24, s24, 23109632
    v_and_b32 v254, 3, v1
    v_lshl_add_u32 v254, v254, 2, s24
    s_mov_b32 s61, 0
interleave_layers__linear_attn_block__memory_aug_recurrent_mem_tr__prompt_kernel_r_ec:
    buffer_load_dword v253, v254, s[8:11], 0 offen sc1
    s_waitcnt vmcnt(0)
    v_readlane_b32 s59, v253, 0
    v_readlane_b32 s24, v253, 1
    s_min_i32 s59, s59, s24
    v_readlane_b32 s24, v253, 2
    s_min_i32 s59, s59, s24
    s_cmp_ge_i32 s59, s95
    s_cbranch_scc1 interleave_layers__linear_attn_block__memory_aug_recurrent_mem_tr__prompt_kernel_r_ec_ok
    s_add_u32 s61, s61, 1
    s_cmp_ge_u32 s61, s60
    s_cbranch_scc1 interleave_layers__linear_attn_block__memory_aug_recurrent_mem_tr__prompt_kernel_r_ec_to
    s_sleep 2
    s_branch interleave_layers__linear_attn_block__memory_aug_recurrent_mem_tr__prompt_kernel_r_ec
interleave_layers__linear_attn_block__memory_aug_recurrent_mem_tr__prompt_kernel_r_ec_to:
    s_mov_b32 s60, 1
interleave_layers__linear_attn_block__memory_aug_recurrent_mem_tr__prompt_kernel_r_ec_ok:
    s_mov_b64 exec, 1
    s_mov_b32 s61, 0
    v_mov_b32 v117, 0
    buffer_atomic_add v117, v125, s[8:11], s45 offen sc0
    s_sleep 1
    v_mov_b32 v118, 0
    buffer_atomic_add v118, v125, s[8:11], s45 offen sc0
    s_sleep 1
    v_mov_b32 v119, 0
    buffer_atomic_add v119, v125, s[8:11], s45 offen sc0
    s_sleep 1
interleave_layers__linear_attn_block__memory_aug_recurrent_mem_tr__prompt_kernel_r_pr:
    v_mov_b32 v116, 0
    buffer_atomic_add v116, v125, s[8:11], s45 offen sc0
    s_waitcnt vmcnt(3)
    v_cmp_le_i32 vcc, 7, v117
    s_add_u32 s61, s61, 1
    s_cbranch_vccnz interleave_layers__linear_attn_block__memory_aug_recurrent_mem_tr__prompt_kernel_r_pr_out
    s_sleep 1
    v_mov_b32 v117, 0
    buffer_atomic_add v117, v125, s[8:11], s45 offen sc0
    s_waitcnt vmcnt(3)
    v_cmp_le_i32 vcc, 7, v118
    s_add_u32 s61, s61, 1
    s_cbranch_vccnz interleave_layers__linear_attn_block__memory_aug_recurrent_mem_tr__prompt_kernel_r_pr_out
    s_sleep 1
    v_mov_b32 v118, 0
    buffer_atomic_add v118, v125, s[8:11], s45 offen sc0
    s_waitcnt vmcnt(3)
    v_cmp_le_i32 vcc, 7, v119
    s_add_u32 s61, s61, 1
    s_cbranch_vccnz interleave_layers__linear_attn_block__memory_aug_recurrent_mem_tr__prompt_kernel_r_pr_out
    s_sleep 1
    v_mov_b32 v119, 0
    buffer_atomic_add v119, v125, s[8:11], s45 offen sc0
    s_waitcnt vmcnt(3)
    v_cmp_le_i32 vcc, 7, v116
    s_add_u32 s61, s61, 1
    s_cbranch_vccnz interleave_layers__linear_attn_block__memory_aug_recurrent_mem_tr__prompt_kernel_r_pr_out
    s_sleep 1
    s_cmp_ge_u32 s61, s60
    s_cbranch_scc0 interleave_layers__linear_attn_block__memory_aug_recurrent_mem_tr__prompt_kernel_r_pr
    s_mov_b32 s60, 1
interleave_layers__linear_attn_block__memory_aug_recurrent_mem_tr__prompt_kernel_r_pr_out:
    s_mov_b64 exec, -1
    buffer_load_dwordx4 v[100:103], v10, s[8:11], s42 offen offset:0 sc1
    buffer_load_dwordx4 v[104:107], v10, s[8:11], s42 offen offset:1024 sc1
    buffer_load_dwordx4 v[80:83], v8, s[8:11], s43 offen offset:0 sc1
    buffer_load_dwordx4 v[84:87], v8, s[8:11], s43 offen offset:1024 sc1
    buffer_load_dwordx4 v[88:91], v8, s[8:11], s43 offen offset:2048 sc1
    buffer_load_dwordx4 v[92:95], v8, s[8:11], s43 offen offset:3072 sc1
    buffer_load_dwordx4 v[96:99], v9, s[8:11], s43 offen sc1
    s_waitcnt vmcnt(0)
    v_max3_u32 v204, v80, v81, v82
    v_max3_u32 v204, v204, v83, v84
    v_max3_u32 v204, v204, v85, v86
    v_max3_u32 v204, v204, v87, v88
    v_max3_u32 v204, v204, v89, v90
    v_max3_u32 v204, v204, v91, v92
    v_max3_u32 v204, v204, v93, v94
    v_max3_u32 v204, v204, v95, v96
    v_max3_u32 v204, v204, v97, v98
    v_max3_u32 v204, v204, v99, v100
    v_max3_u32 v204, v204, v101, v102
    v_max3_u32 v204, v204, v103, v104
    v_max3_u32 v204, v204, v105, v106
    v_max_u32 v204, v204, v107
    v_cmp_eq_u32 vcc, -1, v204
    s_cbranch_vccz interleave_layers__linear_attn_block__memory_aug_recurrent_mem_tr__prompt_kernel_r_p_out
    s_mov_b32 s61, 0
interleave_layers__linear_attn_block__memory_aug_recurrent_mem_tr__prompt_kernel_r_p:
    buffer_load_dwordx4 v[100:103], v10, s[8:11], s42 offen offset:0 sc1
    buffer_load_dwordx4 v[104:107], v10, s[8:11], s42 offen offset:1024 sc1
    buffer_load_dwordx4 v[80:83], v8, s[8:11], s43 offen offset:0 sc1
    buffer_load_dwordx4 v[84:87], v8, s[8:11], s43 offen offset:1024 sc1
    buffer_load_dwordx4 v[88:91], v8, s[8:11], s43 offen offset:2048 sc1
    buffer_load_dwordx4 v[92:95], v8, s[8:11], s43 offen offset:3072 sc1
    buffer_load_dwordx4 v[96:99], v9, s[8:11], s43 offen sc1
    s_waitcnt vmcnt(0)
    v_max3_u32 v204, v80, v81, v82
    v_max3_u32 v204, v204, v83, v84
    v_max3_u32 v204, v204, v85, v86
    v_max3_u32 v204, v204, v87, v88
    v_max3_u32 v204, v204, v89, v90
    v_max3_u32 v204, v204, v91, v92
    v_max3_u32 v204, v204, v93, v94
    v_max3_u32 v204, v204, v95, v96
    v_max3_u32 v204, v204, v97, v98
    v_max3_u32 v204, v204, v99, v100
    v_max3_u32 v204, v204, v101, v102
    v_max3_u32 v204, v204, v103, v104
    v_max3_u32 v204, v204, v105, v106
    v_max_u32 v204, v204, v107
    v_cmp_eq_u32 vcc, -1, v204
    s_add_u32 s61, s61, 1
    s_cbranch_vccz interleave_layers__linear_attn_block__memory_aug_recurrent_mem_tr__prompt_kernel_r_p_out
    s_cmp_ge_u32 s61, s60
    s_cbranch_scc1 interleave_layers__linear_attn_block__memory_aug_recurrent_mem_tr__prompt_kernel_r_p_to
    s_sleep 1
    s_branch interleave_layers__linear_attn_block__memory_aug_recurrent_mem_tr__prompt_kernel_r_p
interleave_layers__linear_attn_block__memory_aug_recurrent_mem_tr__prompt_kernel_r_p_to:
    s_mov_b32 s60, 1
interleave_layers__linear_attn_block__memory_aug_recurrent_mem_tr__prompt_kernel_r_p_out:
    s_mov_b64 exec, 1
    ds_add_rtn_u32 v124, v122, v123
    s_mov_b64 exec, -1
    v_mfma_f32_16x16x32_bf16 v[108:111], v[100:103], v[96:99], 0
    v_mfma_f32_16x16x32_bf16 v[112:115], v[104:107], v[96:99], 0
    v_mfma_f32_16x16x32_bf16 v[108:111], v[16:19], v[80:83], v[108:111]
    v_mfma_f32_16x16x32_bf16 v[112:115], v[20:23], v[80:83], v[112:115]
    s_waitcnt lgkmcnt(0)
    v_readfirstlane_b32 s24, v124
    s_and_b32 s24, s24, 3
    s_cmp_eq_u32 s24, 3
    s_cbranch_scc0 interleave_layers__linear_attn_block__memory_aug_recurrent_mem_tr__prompt_kernel_nh30
    buffer_atomic_add v123, v120, s[8:11], s46 offen
interleave_layers__linear_attn_block__memory_aug_recurrent_mem_tr__prompt_kernel_nh30:
    v_mfma_f32_16x16x32_bf16 v[108:111], v[24:27], v[84:87], v[108:111]
    v_mfma_f32_16x16x32_bf16 v[112:115], v[28:31], v[84:87], v[112:115]
    v_mfma_f32_16x16x32_bf16 v[108:111], v[32:35], v[88:91], v[108:111]
    v_mfma_f32_16x16x32_bf16 v[112:115], v[36:39], v[88:91], v[112:115]
    v_mfma_f32_16x16x32_bf16 v[108:111], v[40:43], v[92:95], v[108:111]
    v_mfma_f32_16x16x32_bf16 v[112:115], v[44:47], v[92:95], v[112:115]
    s_and_b32 s24, s40, 1
    s_mul_i32 s24, s24, 2560
    v_add_u32 v14, s24, v11
    v_add_u32 v15, s24, v12
    s_nop 3
    v_cndmask_b32 v108, v108, v112, s[50:51]
    v_cndmask_b32 v109, v109, v113, s[50:51]
    v_cndmask_b32 v110, v110, v114, s[50:51]
    v_cndmask_b32 v111, v111, v115, s[50:51]
    v_add_f32 v108, v108, v108 row_ror:8 row_mask:0xf bank_mask:0xf
    v_add_f32 v109, v109, v109 row_ror:8 row_mask:0xf bank_mask:0xf
    v_add_f32 v110, v110, v110 row_ror:8 row_mask:0xf bank_mask:0xf
    v_add_f32 v111, v111, v111 row_ror:8 row_mask:0xf bank_mask:0xf
    ds_write_b128 v14, v[108:111]
    s_waitcnt lgkmcnt(0)
    s_barrier
    s_cmp_eq_u32 s3, 0
    s_cbranch_scc0 interleave_layers__linear_attn_block__memory_aug_recurrent_mem_tr__prompt_kernel_np31
    ds_read_b128 v[220:223], v15 offset:0
    ds_read_b128 v[224:227], v15 offset:16
    ds_read_b128 v[228:231], v15 offset:640
    ds_read_b128 v[232:235], v15 offset:656
    ds_read_b128 v[236:239], v15 offset:1280
    ds_read_b128 v[240:243], v15 offset:1296
    ds_read_b128 v[244:247], v15 offset:1920
    ds_read_b128 v[248:251], v15 offset:1936
    s_waitcnt lgkmcnt(4)
    v_pk_add_f32 v[220:221], v[220:221], v[228:229]
    v_pk_add_f32 v[222:223], v[222:223], v[230:231]
    v_pk_add_f32 v[224:225], v[224:225], v[232:233]
    v_pk_add_f32 v[226:227], v[226:227], v[234:235]
    s_waitcnt lgkmcnt(0)
    v_pk_add_f32 v[236:237], v[236:237], v[244:245]
    v_pk_add_f32 v[238:239], v[238:239], v[246:247]
    v_pk_add_f32 v[240:241], v[240:241], v[248:249]
    v_pk_add_f32 v[242:243], v[242:243], v[250:251]
    v_pk_add_f32 v[220:221], v[220:221], v[236:237]
    v_pk_add_f32 v[222:223], v[222:223], v[238:239]
    v_pk_add_f32 v[224:225], v[224:225], v[240:241]
    v_pk_add_f32 v[226:227], v[226:227], v[242:243]
    v_cvt_pk_bf16_f32 v228, v220, v221
    v_cvt_pk_bf16_f32 v229, v222, v223
    v_cvt_pk_bf16_f32 v230, v224, v225
    v_cvt_pk_bf16_f32 v231, v226, v227
    v_min_u32 v228, -2, v228
    v_min_u32 v229, -2, v229
    v_min_u32 v230, -2, v230
    v_min_u32 v231, -2, v231
    buffer_store_dwordx4 v[228:231], v13, s[8:11], s47 offen sc1
interleave_layers__linear_attn_block__memory_aug_recurrent_mem_tr__prompt_kernel_np31:
    s_cmp_eq_u32 s3, 1
    s_cbranch_scc0 interleave_layers__linear_attn_block__memory_aug_recurrent_mem_tr__prompt_kernel_xf32
    s_cmp_eq_u32 s44, 39
    s_cbranch_scc0 interleave_layers__linear_attn_block__memory_aug_recurrent_mem_tr__prompt_kernel_xf32
    s_lshl_b32 s24, s92, 6
    s_add_u32 s24, s24, s40
    s_add_u32 s24, s24, 1
    v_lshlrev_b32 v204, 7, v1
    v_add_u32 v204, 23111680, v204
    v_mov_b32 v205, 2146435072
    v_cmp_le_u32 vcc, 8, v1
    s_nop 1
    v_cndmask_b32 v204, v204, v205, vcc
    v_mov_b32 v205, s24
    buffer_store_dword v205, v204, s[8:11], 0 offen sc1
interleave_layers__linear_attn_block__memory_aug_recurrent_mem_tr__prompt_kernel_xf32:
    s_add_u32 s63, s40, 2
    s_min_u32 s63, s63, 64
    s_cmp_ge_i32 s62, s63
    s_cselect_b32 s58, 1, 0
    s_cmp_eq_u32 s58, 1
    s_cbranch_scc1 interleave_layers__linear_attn_block__memory_aug_recurrent_mem_tr__prompt_kernel_rq33
    buffer_load_dword v253, v252, s[8:11], 0 offen sc1
interleave_layers__linear_attn_block__memory_aug_recurrent_mem_tr__prompt_kernel_rq33:
    s_sleep 18
    s_cmp_eq_u32 s58, 1
    s_cbranch_scc1 interleave_layers__linear_attn_block__memory_aug_recurrent_mem_tr__prompt_kernel_rq34
    s_waitcnt vmcnt(0)
    v_readlane_b32 s58, v253, 0
    v_readlane_b32 s24, v253, 1
    s_min_i32 s58, s58, s24
    v_readlane_b32 s24, v253, 2
    s_min_i32 s58, s58, s24
    v_readlane_b32 s24, v253, 3
    s_min_i32 s58, s58, s24
    v_readlane_b32 s24, v253, 4
    s_min_i32 s58, s58, s24
    v_readlane_b32 s24, v253, 5
    s_min_i32 s58, s58, s24
    v_readlane_b32 s24, v253, 6
    s_min_i32 s58, s58, s24
    v_readlane_b32 s24, v253, 7
    s_min_i32 s58, s58, s24
    s_max_i32 s62, s62, s58
interleave_layers__linear_attn_block__memory_aug_recurrent_mem_tr__prompt_kernel_rq34:
    s_cmp_ge_i32 s62, s63
    s_cbranch_scc1 interleave_layers__linear_attn_block__memory_aug_recurrent_mem_tr__prompt_kernel_r_en_ok
    s_mov_b32 s61, 0
interleave_layers__linear_attn_block__memory_aug_recurrent_mem_tr__prompt_kernel_r_en:
    buffer_load_dword v253, v252, s[8:11], 0 offen sc1
    s_waitcnt vmcnt(0)
    v_readlane_b32 s62, v253, 0
    v_readlane_b32 s24, v253, 1
    s_min_i32 s62, s62, s24
    v_readlane_b32 s24, v253, 2
    s_min_i32 s62, s62, s24
    v_readlane_b32 s24, v253, 3
    s_min_i32 s62, s62, s24
    v_readlane_b32 s24, v253, 4
    s_min_i32 s62, s62, s24
    v_readlane_b32 s24, v253, 5
    s_min_i32 s62, s62, s24
    v_readlane_b32 s24, v253, 6
    s_min_i32 s62, s62, s24
    v_readlane_b32 s24, v253, 7
    s_min_i32 s62, s62, s24
    s_cmp_ge_i32 s62, s63
    s_cbranch_scc1 interleave_layers__linear_attn_block__memory_aug_recurrent_mem_tr__prompt_kernel_r_en_ok
    s_add_u32 s61, s61, 1
    s_cmp_ge_u32 s61, s60
    s_cbranch_scc1 interleave_layers__linear_attn_block__memory_aug_recurrent_mem_tr__prompt_kernel_r_en_to
    s_sleep 2
    s_branch interleave_layers__linear_attn_block__memory_aug_recurrent_mem_tr__prompt_kernel_r_en
interleave_layers__linear_attn_block__memory_aug_recurrent_mem_tr__prompt_kernel_r_en_to:
    s_mov_b32 s60, 1
interleave_layers__linear_attn_block__memory_aug_recurrent_mem_tr__prompt_kernel_r_en_ok:
    buffer_load_dwordx4 v[48:51], v6, s[8:11], s41 offen offset:0 sc1
    buffer_load_dwordx4 v[52:55], v6, s[8:11], s41 offen offset:1024 sc1
    buffer_load_dwordx4 v[56:59], v6, s[8:11], s41 offen offset:2048 sc1
    buffer_load_dwordx4 v[60:63], v6, s[8:11], s41 offen offset:3072 sc1
    buffer_load_dwordx4 v[64:67], v7, s[8:11], s41 offen offset:0 sc1
    buffer_load_dwordx4 v[68:71], v7, s[8:11], s41 offen offset:1024 sc1
    buffer_load_dwordx4 v[72:75], v7, s[8:11], s41 offen offset:2048 sc1
    buffer_load_dwordx4 v[76:79], v7, s[8:11], s41 offen offset:3072 sc1
    s_add_u32 s41, s41, 1310720
    s_add_u32 s40, s40, 1
    s_lshl_b32 s24, s40, 12
    s_and_b32 s24, s24, 0x2000
    s_xor_b32 s24, s24, s36
    s_lshl_b32 s37, s40, 20
    s_add_u32 s37, s37, s24
    s_add_u32 s37, s37, 117440512
    s_add_u32 s42, s37, 0
    s_add_u32 s43, s37, 655360
    s_add_u32 s47, s37, 704512
    s_add_u32 s45, s37, 753664
    s_add_u32 s46, s37, 737280
    s_cmp_lt_u32 s40, 64
    s_cbranch_scc1 interleave_layers__linear_attn_block__memory_aug_recurrent_mem_tr__prompt_kernel_r_step
    s_waitcnt vmcnt(0)
    s_cmp_eq_u32 s92, 0
    s_cbranch_scc0 interleave_layers__linear_attn_block__memory_aug_recurrent_mem_tr__prompt_kernel_end
    s_mov_b32 s92, 1
    s_branch interleave_layers__linear_attn_block__memory_aug_recurrent_mem_tr__prompt_kernel_r_top
interleave_layers__linear_attn_block__memory_aug_recurrent_mem_tr__prompt_kernel_roleP:
    s_sub_u32 s44, s2, 104
    s_lshr_b32 s46, s44, 5
    s_and_b32 s44, s44, 31
    s_load_dwordx2 s[6:7], s[0:1], 40
    s_load_dwordx2 s[24:25], s[0:1], 48
    s_load_dwordx2 s[26:27], s[0:1], 56
    s_waitcnt lgkmcnt(0)
    s_cmp_eq_u32 s46, 1
    s_cselect_b32 s6, s24, s6
    s_cselect_b32 s7, s25, s7
    s_cmp_eq_u32 s46, 2
    s_cselect_b32 s6, s26, s6
    s_cselect_b32 s7, s27, s7
    s_mov_b32 s12, s6
    s_mov_b32 s13, s7
    s_mov_b32 s14, 7864320
    s_mov_b32 s15, 0x00020000
    v_add_u32 v16, 0, v0
    s_mov_b32 s24, 683
    v_mul_lo_u32 v17, v16, s24
    v_lshrrev_b32 v17, 14, v17
    v_mul_u32_u24 v18, 24, v17
    v_sub_u32 v18, v16, v18
    s_mov_b32 s24, 12288
    v_mul_lo_u32 v4, v17, s24
    v_lshl_add_u32 v4, v18, 4, v4
    v_mul_u32_u24 v10, 400, v17
    v_lshl_add_u32 v10, v18, 4, v10
    v_add_u32 v10, 81920, v10
    v_add_u32 v16, 256, v0
    s_mov_b32 s24, 683
    v_mul_lo_u32 v17, v16, s24
    v_lshrrev_b32 v17, 14, v17
    v_mul_u32_u24 v18, 24, v17
    v_sub_u32 v18, v16, v18
    s_mov_b32 s24, 12288
    v_mul_lo_u32 v5, v17, s24
    v_lshl_add_u32 v5, v18, 4, v5
    v_mul_u32_u24 v11, 400, v17
    v_lshl_add_u32 v11, v18, 4, v11
    v_add_u32 v11, 81920, v11
    v_add_u32 v16, 512, v0
    s_mov_b32 s24, 683
    v_mul_lo_u32 v17, v16, s24
    v_lshrrev_b32 v17, 14, v17
    v_mul_u32_u24 v18, 24, v17
    v_sub_u32 v18, v16, v18
    s_mov_b32 s24, 12288
    v_mul_lo_u32 v6, v17, s24
    v_lshl_add_u32 v6, v18, 4, v6
    v_mul_u32_u24 v12, 400, v17
    v_lshl_add_u32 v12, v18, 4, v12
    v_add_u32 v12, 81920, v12
    v_add_u32 v16, 768, v0
    s_mov_b32 s24, 683
    v_mul_lo_u32 v17, v16, s24
    v_lshrrev_b32 v17, 14, v17
    v_mul_u32_u24 v18, 24, v17
    v_sub_u32 v18, v16, v18
    s_mov_b32 s24, 12288
    v_mul_lo_u32 v7, v17, s24
    v_lshl_add_u32 v7, v18, 4, v7
    v_mul_u32_u24 v13, 400, v17
    v_lshl_add_u32 v13, v18, 4, v13
    v_add_u32 v13, 81920, v13
    v_add_u32 v16, 1024, v0
    s_mov_b32 s24, 683
    v_mul_lo_u32 v17, v16, s24
    v_lshrrev_b32 v17, 14, v17
    v_mul_u32_u24 v18, 24, v17
    v_sub_u32 v18, v16, v18
    s_mov_b32 s24, 12288
    v_mul_lo_u32 v8, v17, s24
    v_lshl_add_u32 v8, v18, 4, v8
    v_mul_u32_u24 v14, 400, v17
    v_lshl_add_u32 v14, v18, 4, v14
    v_add_u32 v14, 81920, v14
    v_add_u32 v16, 1280, v0
    s_mov_b32 s24, 683
    v_mul_lo_u32 v17, v16, s24
    v_lshrrev_b32 v17, 14, v17
    v_mul_u32_u24 v18, 24, v17
    v_sub_u32 v18, v16, v18
    s_mov_b32 s24, 12288
    v_mul_lo_u32 v9, v17, s24
    v_lshl_add_u32 v9, v18, 4, v9
    v_mul_u32_u24 v15, 400, v17
    v_lshl_add_u32 v15, v18, 4, v15
    v_add_u32 v15, 81920, v15
    v_lshrrev_b32 v16, 2, v2
    v_lshl_add_u32 v16, v3, 2, v16
    v_mul_u32_u24 v32, 400, v16
    v_and_b32 v16, 3, v2
    v_lshl_add_u32 v32, v16, 3, v32
    s_mul_i32 s24, s3, 96
    s_add_u32 s24, s24, 81920
    v_add_u32 v32, s24, v32
    s_mul_i32 s45, s44, 384
    s_add_u32 s47, s45, 0
    buffer_load_dwordx4 v[56:59], v4, s[12:15], s47 offen
    buffer_load_dwordx4 v[60:63], v5, s[12:15], s47 offen
    buffer_load_dwordx4 v[64:67], v6, s[12:15], s47 offen
    buffer_load_dwordx4 v[68:71], v7, s[12:15], s47 offen
    buffer_load_dwordx4 v[72:75], v8, s[12:15], s47 offen
    buffer_load_dwordx4 v[76:79], v9, s[12:15], s47 offen
    s_add_u32 s47, s45, 786432
    buffer_load_dwordx4 v[80:83], v4, s[12:15], s47 offen
    buffer_load_dwordx4 v[84:87], v5, s[12:15], s47 offen
    buffer_load_dwordx4 v[88:91], v6, s[12:15], s47 offen
    buffer_load_dwordx4 v[92:95], v7, s[12:15], s47 offen
    buffer_load_dwordx4 v[96:99], v8, s[12:15], s47 offen
    buffer_load_dwordx4 v[100:103], v9, s[12:15], s47 offen
    s_add_u32 s47, s45, 1572864
    buffer_load_dwordx4 v[104:107], v4, s[12:15], s47 offen
    buffer_load_dwordx4 v[108:111], v5, s[12:15], s47 offen
    buffer_load_dwordx4 v[112:115], v6, s[12:15], s47 offen
    buffer_load_dwordx4 v[116:119], v7, s[12:15], s47 offen
    buffer_load_dwordx4 v[120:123], v8, s[12:15], s47 offen
    buffer_load_dwordx4 v[124:127], v9, s[12:15], s47 offen
    s_add_u32 s47, s45, 2359296
    buffer_load_dwordx4 v[128:131], v4, s[12:15], s47 offen
    buffer_load_dwordx4 v[132:135], v5, s[12:15], s47 offen
    buffer_load_dwordx4 v[136:139], v6, s[12:15], s47 offen
    buffer_load_dwordx4 v[140:143], v7, s[12:15], s47 offen
    buffer_load_dwordx4 v[144:147], v8, s[12:15], s47 offen
    buffer_load_dwordx4 v[148:151], v9, s[12:15], s47 offen
    s_add_u32 s47, s45, 3145728
    buffer_load_dwordx4 v[152:155], v4, s[12:15], s47 offen
    buffer_load_dwordx4 v[156:159], v5, s[12:15], s47 offen
    buffer_load_dwordx4 v[160:163], v6, s[12:15], s47 offen
    buffer_load_dwordx4 v[164:167], v7, s[12:15], s47 offen
    buffer_load_dwordx4 v[168:171], v8, s[12:15], s47 offen
    buffer_load_dwordx4 v[172:175], v9, s[12:15], s47 offen
    s_add_u32 s47, s45, 3932160
    buffer_load_dwordx4 v[176:179], v4, s[12:15], s47 offen
    buffer_load_dwordx4 v[180:183], v5, s[12:15], s47 offen
    buffer_load_dwordx4 v[184:187], v6, s[12:15], s47 offen
    buffer_load_dwordx4 v[188:191], v7, s[12:15], s47 offen
    buffer_load_dwordx4 v[192:195], v8, s[12:15], s47 offen
    buffer_load_dwordx4 v[196:199], v9, s[12:15], s47 offen
    s_add_u32 s47, s45, 4718592
    buffer_load_dwordx4 v[200:203], v4, s[12:15], s47 offen
    buffer_load_dwordx4 v[204:207], v5, s[12:15], s47 offen
    buffer_load_dwordx4 v[208:211], v6, s[12:15], s47 offen
    buffer_load_dwordx4 v[212:215], v7, s[12:15], s47 offen
    buffer_load_dwordx4 v[216:219], v8, s[12:15], s47 offen
    buffer_load_dwordx4 v[220:223], v9, s[12:15], s47 offen
    s_add_u32 s47, s45, 5505024
    buffer_load_dwordx4 v[224:227], v4, s[12:15], s47 offen
    buffer_load_dwordx4 v[228:231], v5, s[12:15], s47 offen
    buffer_load_dwordx4 v[232:235], v6, s[12:15], s47 offen
    buffer_load_dwordx4 v[236:239], v7, s[12:15], s47 offen
    buffer_load_dwordx4 v[240:243], v8, s[12:15], s47 offen
    buffer_load_dwordx4 v[244:247], v9, s[12:15], s47 offen
    v_mov_b32 v28, 0x3f803f80
    v_mov_b32 v29, 0x3f803f80
    v_mov_b32 v30, 0x3f803f80
    v_mov_b32 v31, 0x3f803f80
    s_waitcnt vmcnt(42)
    ds_write_b128 v10, v[56:59] offset:0
    ds_write_b128 v11, v[60:63] offset:0
    ds_write_b128 v12, v[64:67] offset:0
    ds_write_b128 v13, v[68:71] offset:0
    ds_write_b128 v14, v[72:75] offset:0
    ds_write_b128 v15, v[76:79] offset:0
    s_waitcnt lgkmcnt(0)
    s_add_u32 s47, s45, 6291456
    buffer_load_dwordx4 v[56:59], v4, s[12:15], s47 offen
    buffer_load_dwordx4 v[60:63], v5, s[12:15], s47 offen
    buffer_load_dwordx4 v[64:67], v6, s[12:15], s47 offen
    buffer_load_dwordx4 v[68:71], v7, s[12:15], s47 offen
    buffer_load_dwordx4 v[72:75], v8, s[12:15], s47 offen
    buffer_load_dwordx4 v[76:79], v9, s[12:15], s47 offen
    s_barrier
    ds_read_b64_tr_b16 a[0:1], v32 offset:0
    ds_read_b64_tr_b16 a[2:3], v32 offset:6400
    ds_read_b64_tr_b16 a[4:5], v32 offset:12800
    ds_read_b64_tr_b16 a[6:7], v32 offset:19200
    ds_read_b64_tr_b16 a[80:81], v32 offset:32
    ds_read_b64_tr_b16 a[82:83], v32 offset:6432
    ds_read_b64_tr_b16 a[84:85], v32 offset:12832
    ds_read_b64_tr_b16 a[86:87], v32 offset:19232
    ds_read_b64_tr_b16 a[160:161], v32 offset:64
    ds_read_b64_tr_b16 a[162:163], v32 offset:6464
    ds_read_b64_tr_b16 a[164:165], v32 offset:12864
    ds_read_b64_tr_b16 a[166:167], v32 offset:19264
    s_waitcnt vmcnt(42)
    ds_write_b128 v10, v[80:83] offset:25600
    ds_write_b128 v11, v[84:87] offset:25600
    ds_write_b128 v12, v[88:91] offset:25600
    ds_write_b128 v13, v[92:95] offset:25600
    ds_write_b128 v14, v[96:99] offset:25600
    ds_write_b128 v15, v[100:103] offset:25600
    s_waitcnt lgkmcnt(0)
    s_add_u32 s47, s45, 7077888
    buffer_load_dwordx4 v[80:83], v4, s[12:15], s47 offen
    buffer_load_dwordx4 v[84:87], v5, s[12:15], s47 offen
    buffer_load_dwordx4 v[88:91], v6, s[12:15], s47 offen
    buffer_load_dwordx4 v[92:95], v7, s[12:15], s47 offen
    buffer_load_dwordx4 v[96:99], v8, s[12:15], s47 offen
    buffer_load_dwordx4 v[100:103], v9, s[12:15], s47 offen
    v_mfma_f32_16x16x32_bf16 v[16:19], a[0:3], v[28:31], 0
    v_mfma_f32_16x16x32_bf16 v[20:23], a[80:83], v[28:31], 0
    v_mfma_f32_16x16x32_bf16 v[24:27], a[160:163], v[28:31], 0
    v_mfma_f32_16x16x32_bf16 v[16:19], a[4:7], v[28:31], v[16:19]
    v_mfma_f32_16x16x32_bf16 v[20:23], a[84:87], v[28:31], v[20:23]
    v_mfma_f32_16x16x32_bf16 v[24:27], a[164:167], v[28:31], v[24:27]
    s_barrier
    ds_read_b64_tr_b16 a[8:9], v32 offset:25600
    ds_read_b64_tr_b16 a[10:11], v32 offset:32000
    ds_read_b64_tr_b16 a[12:13], v32 offset:38400
    ds_read_b64_tr_b16 a[14:15], v32 offset:44800
    ds_read_b64_tr_b16 a[88:89], v32 offset:25632
    ds_read_b64_tr_b16 a[90:91], v32 offset:32032
    ds_read_b64_tr_b16 a[92:93], v32 offset:38432
    ds_read_b64_tr_b16 a[94:95], v32 offset:44832
    ds_read_b64_tr_b16 a[168:169], v32 offset:25664
    ds_read_b64_tr_b16 a[170:171], v32 offset:32064
    ds_read_b64_tr_b16 a[172:173], v32 offset:38464
    ds_read_b64_tr_b16 a[174:175], v32 offset:44864
    s_waitcnt vmcnt(42)
    ds_write_b128 v10, v[104:107] offset:0
    ds_write_b128 v11, v[108:111] offset:0
    ds_write_b128 v12, v[112:115] offset:0
    ds_write_b128 v13, v[116:119] offset:0
    ds_write_b128 v14, v[120:123] offset:0
    ds_write_b128 v15, v[124:127] offset:0
    s_waitcnt lgkmcnt(0)
    v_mfma_f32_16x16x32_bf16 v[16:19], a[8:11], v[28:31], v[16:19]
    v_mfma_f32_16x16x32_bf16 v[20:23], a[88:91], v[28:31], v[20:23]
    v_mfma_f32_16x16x32_bf16 v[24:27], a[168:171], v[28:31], v[24:27]
    v_mfma_f32_16x16x32_bf16 v[16:19], a[12:15], v[28:31], v[16:19]
    v_mfma_f32_16x16x32_bf16 v[20:23], a[92:95], v[28:31], v[20:23]
    v_mfma_f32_16x16x32_bf16 v[24:27], a[172:175], v[28:31], v[24:27]
    s_barrier
    ds_read_b64_tr_b16 a[16:17], v32 offset:0
    ds_read_b64_tr_b16 a[18:19], v32 offset:6400
    ds_read_b64_tr_b16 a[20:21], v32 offset:12800
    ds_read_b64_tr_b16 a[22:23], v32 offset:19200
    ds_read_b64_tr_b16 a[96:97], v32 offset:32
    ds_read_b64_tr_b16 a[98:99], v32 offset:6432
    ds_read_b64_tr_b16 a[100:101], v32 offset:12832
    ds_read_b64_tr_b16 a[102:103], v32 offset:19232
    ds_read_b64_tr_b16 a[176:177], v32 offset:64
    ds_read_b64_tr_b16 a[178:179], v32 offset:6464
    ds_read_b64_tr_b16 a[180:181], v32 offset:12864
    ds_read_b64_tr_b16 a[182:183], v32 offset:19264
    s_waitcnt vmcnt(36)
    ds_write_b128 v10, v[128:131] offset:25600
    ds_write_b128 v11, v[132:135] offset:25600
    ds_write_b128 v12, v[136:139] offset:25600
    ds_write_b128 v13, v[140:143] offset:25600
    ds_write_b128 v14, v[144:147] offset:25600
    ds_write_b128 v15, v[148:151] offset:25600
    s_waitcnt lgkmcnt(0)
    v_mfma_f32_16x16x32_bf16 v[16:19], a[16:19], v[28:31], v[16:19]
    v_mfma_f32_16x16x32_bf16 v[20:23], a[96:99], v[28:31], v[20:23]
    v_mfma_f32_16x16x32_bf16 v[24:27], a[176:179], v[28:31], v[24:27]
    v_mfma_f32_16x16x32_bf16 v[16:19], a[20:23], v[28:31], v[16:19]
    v_mfma_f32_16x16x32_bf16 v[20:23], a[100:103], v[28:31], v[20:23]
    v_mfma_f32_16x16x32_bf16 v[24:27], a[180:183], v[28:31], v[24:27]
    s_barrier
    ds_read_b64_tr_b16 a[24:25], v32 offset:25600
    ds_read_b64_tr_b16 a[26:27], v32 offset:32000
    ds_read_b64_tr_b16 a[28:29], v32 offset:38400
    ds_read_b64_tr_b16 a[30:31], v32 offset:44800
    ds_read_b64_tr_b16 a[104:105], v32 offset:25632
    ds_read_b64_tr_b16 a[106:107], v32 offset:32032
    ds_read_b64_tr_b16 a[108:109], v32 offset:38432
    ds_read_b64_tr_b16 a[110:111], v32 offset:44832
    ds_read_b64_tr_b16 a[184:185], v32 offset:25664
    ds_read_b64_tr_b16 a[186:187], v32 offset:32064
    ds_read_b64_tr_b16 a[188:189], v32 offset:38464
    ds_read_b64_tr_b16 a[190:191], v32 offset:44864
    s_waitcnt vmcnt(30)
    ds_write_b128 v10, v[152:155] offset:0
    ds_write_b128 v11, v[156:159] offset:0
    ds_write_b128 v12, v[160:163] offset:0
    ds_write_b128 v13, v[164:167] offset:0
    ds_write_b128 v14, v[168:171] offset:0
    ds_write_b128 v15, v[172:175] offset:0
    s_waitcnt lgkmcnt(0)
    v_mfma_f32_16x16x32_bf16 v[16:19], a[24:27], v[28:31], v[16:19]
    v_mfma_f32_16x16x32_bf16 v[20:23], a[104:107], v[28:31], v[20:23]
    v_mfma_f32_16x16x32_bf16 v[24:27], a[184:187], v[28:31], v[24:27]
    v_mfma_f32_16x16x32_bf16 v[16:19], a[28:31], v[28:31], v[16:19]
    v_mfma_f32_16x16x32_bf16 v[20:23], a[108:111], v[28:31], v[20:23]
    v_mfma_f32_16x16x32_bf16 v[24:27], a[188:191], v[28:31], v[24:27]
    s_barrier
    ds_read_b64_tr_b16 a[32:33], v32 offset:0
    ds_read_b64_tr_b16 a[34:35], v32 offset:6400
    ds_read_b64_tr_b16 a[36:37], v32 offset:12800
    ds_read_b64_tr_b16 a[38:39], v32 offset:19200
    ds_read_b64_tr_b16 a[112:113], v32 offset:32
    ds_read_b64_tr_b16 a[114:115], v32 offset:6432
    ds_read_b64_tr_b16 a[116:117], v32 offset:12832
    ds_read_b64_tr_b16 a[118:119], v32 offset:19232
    ds_read_b64_tr_b16 a[192:193], v32 offset:64
    ds_read_b64_tr_b16 a[194:195], v32 offset:6464
    ds_read_b64_tr_b16 a[196:197], v32 offset:12864
    ds_read_b64_tr_b16 a[198:199], v32 offset:19264
    s_waitcnt vmcnt(24)
    ds_write_b128 v10, v[176:179] offset:25600
    ds_write_b128 v11, v[180:183] offset:25600
    ds_write_b128 v12, v[184:187] offset:25600
    ds_write_b128 v13, v[188:191] offset:25600
    ds_write_b128 v14, v[192:195] offset:25600
    ds_write_b128 v15, v[196:199] offset:25600
    s_waitcnt lgkmcnt(0)
    v_mfma_f32_16x16x32_bf16 v[16:19], a[32:35], v[28:31], v[16:19]
    v_mfma_f32_16x16x32_bf16 v[20:23], a[112:115], v[28:31], v[20:23]
    v_mfma_f32_16x16x32_bf16 v[24:27], a[192:195], v[28:31], v[24:27]
    v_mfma_f32_16x16x32_bf16 v[16:19], a[36:39], v[28:31], v[16:19]
    v_mfma_f32_16x16x32_bf16 v[20:23], a[116:119], v[28:31], v[20:23]
    v_mfma_f32_16x16x32_bf16 v[24:27], a[196:199], v[28:31], v[24:27]
    s_barrier
    ds_read_b64_tr_b16 a[40:41], v32 offset:25600
    ds_read_b64_tr_b16 a[42:43], v32 offset:32000
    ds_read_b64_tr_b16 a[44:45], v32 offset:38400
    ds_read_b64_tr_b16 a[46:47], v32 offset:44800
    ds_read_b64_tr_b16 a[120:121], v32 offset:25632
    ds_read_b64_tr_b16 a[122:123], v32 offset:32032
    ds_read_b64_tr_b16 a[124:125], v32 offset:38432
    ds_read_b64_tr_b16 a[126:127], v32 offset:44832
    ds_read_b64_tr_b16 a[200:201], v32 offset:25664
    ds_read_b64_tr_b16 a[202:203], v32 offset:32064
    ds_read_b64_tr_b16 a[204:205], v32 offset:38464
    ds_read_b64_tr_b16 a[206:207], v32 offset:44864
    s_waitcnt vmcnt(18)
    ds_write_b128 v10, v[200:203] offset:0
    ds_write_b128 v11, v[204:207] offset:0
    ds_write_b128 v12, v[208:211] offset:0
    ds_write_b128 v13, v[212:215] offset:0
    ds_write_b128 v14, v[216:219] offset:0
    ds_write_b128 v15, v[220:223] offset:0
    s_waitcnt lgkmcnt(0)
    v_mfma_f32_16x16x32_bf16 v[16:19], a[40:43], v[28:31], v[16:19]
    v_mfma_f32_16x16x32_bf16 v[20:23], a[120:123], v[28:31], v[20:23]
    v_mfma_f32_16x16x32_bf16 v[24:27], a[200:203], v[28:31], v[24:27]
    v_mfma_f32_16x16x32_bf16 v[16:19], a[44:47], v[28:31], v[16:19]
    v_mfma_f32_16x16x32_bf16 v[20:23], a[124:127], v[28:31], v[20:23]
    v_mfma_f32_16x16x32_bf16 v[24:27], a[204:207], v[28:31], v[24:27]
    s_barrier
    ds_read_b64_tr_b16 a[48:49], v32 offset:0
    ds_read_b64_tr_b16 a[50:51], v32 offset:6400
    ds_read_b64_tr_b16 a[52:53], v32 offset:12800
    ds_read_b64_tr_b16 a[54:55], v32 offset:19200
    ds_read_b64_tr_b16 a[128:129], v32 offset:32
    ds_read_b64_tr_b16 a[130:131], v32 offset:6432
    ds_read_b64_tr_b16 a[132:133], v32 offset:12832
    ds_read_b64_tr_b16 a[134:135], v32 offset:19232
    ds_read_b64_tr_b16 a[208:209], v32 offset:64
    ds_read_b64_tr_b16 a[210:211], v32 offset:6464
    ds_read_b64_tr_b16 a[212:213], v32 offset:12864
    ds_read_b64_tr_b16 a[214:215], v32 offset:19264
    s_waitcnt vmcnt(12)
    ds_write_b128 v10, v[224:227] offset:25600
    ds_write_b128 v11, v[228:231] offset:25600
    ds_write_b128 v12, v[232:235] offset:25600
    ds_write_b128 v13, v[236:239] offset:25600
    ds_write_b128 v14, v[240:243] offset:25600
    ds_write_b128 v15, v[244:247] offset:25600
    s_waitcnt lgkmcnt(0)
    v_mfma_f32_16x16x32_bf16 v[16:19], a[48:51], v[28:31], v[16:19]
    v_mfma_f32_16x16x32_bf16 v[20:23], a[128:131], v[28:31], v[20:23]
    v_mfma_f32_16x16x32_bf16 v[24:27], a[208:211], v[28:31], v[24:27]
    v_mfma_f32_16x16x32_bf16 v[16:19], a[52:55], v[28:31], v[16:19]
    v_mfma_f32_16x16x32_bf16 v[20:23], a[132:135], v[28:31], v[20:23]
    v_mfma_f32_16x16x32_bf16 v[24:27], a[212:215], v[28:31], v[24:27]
    s_barrier
    ds_read_b64_tr_b16 a[56:57], v32 offset:25600
    ds_read_b64_tr_b16 a[58:59], v32 offset:32000
    ds_read_b64_tr_b16 a[60:61], v32 offset:38400
    ds_read_b64_tr_b16 a[62:63], v32 offset:44800
    ds_read_b64_tr_b16 a[136:137], v32 offset:25632
    ds_read_b64_tr_b16 a[138:139], v32 offset:32032
    ds_read_b64_tr_b16 a[140:141], v32 offset:38432
    ds_read_b64_tr_b16 a[142:143], v32 offset:44832
    ds_read_b64_tr_b16 a[216:217], v32 offset:25664
    ds_read_b64_tr_b16 a[218:219], v32 offset:32064
    ds_read_b64_tr_b16 a[220:221], v32 offset:38464
    ds_read_b64_tr_b16 a[222:223], v32 offset:44864
    s_waitcnt vmcnt(6)
    ds_write_b128 v10, v[56:59] offset:0
    ds_write_b128 v11, v[60:63] offset:0
    ds_write_b128 v12, v[64:67] offset:0
    ds_write_b128 v13, v[68:71] offset:0
    ds_write_b128 v14, v[72:75] offset:0
    ds_write_b128 v15, v[76:79] offset:0
    s_waitcnt lgkmcnt(0)
    v_mfma_f32_16x16x32_bf16 v[16:19], a[56:59], v[28:31], v[16:19]
    v_mfma_f32_16x16x32_bf16 v[20:23], a[136:139], v[28:31], v[20:23]
    v_mfma_f32_16x16x32_bf16 v[24:27], a[216:219], v[28:31], v[24:27]
    v_mfma_f32_16x16x32_bf16 v[16:19], a[60:63], v[28:31], v[16:19]
    v_mfma_f32_16x16x32_bf16 v[20:23], a[140:143], v[28:31], v[20:23]
    v_mfma_f32_16x16x32_bf16 v[24:27], a[220:223], v[28:31], v[24:27]
    s_barrier
    ds_read_b64_tr_b16 a[64:65], v32 offset:0
    ds_read_b64_tr_b16 a[66:67], v32 offset:6400
    ds_read_b64_tr_b16 a[68:69], v32 offset:12800
    ds_read_b64_tr_b16 a[70:71], v32 offset:19200
    ds_read_b64_tr_b16 a[144:145], v32 offset:32
    ds_read_b64_tr_b16 a[146:147], v32 offset:6432
    ds_read_b64_tr_b16 a[148:149], v32 offset:12832
    ds_read_b64_tr_b16 a[150:151], v32 offset:19232
    ds_read_b64_tr_b16 a[224:225], v32 offset:64
    ds_read_b64_tr_b16 a[226:227], v32 offset:6464
    ds_read_b64_tr_b16 a[228:229], v32 offset:12864
    ds_read_b64_tr_b16 a[230:231], v32 offset:19264
    s_waitcnt vmcnt(0)
    ds_write_b128 v10, v[80:83] offset:25600
    ds_write_b128 v11, v[84:87] offset:25600
    ds_write_b128 v12, v[88:91] offset:25600
    ds_write_b128 v13, v[92:95] offset:25600
    ds_write_b128 v14, v[96:99] offset:25600
    ds_write_b128 v15, v[100:103] offset:25600
    s_waitcnt lgkmcnt(0)
    v_mfma_f32_16x16x32_bf16 v[16:19], a[64:67], v[28:31], v[16:19]
    v_mfma_f32_16x16x32_bf16 v[20:23], a[144:147], v[28:31], v[20:23]
    v_mfma_f32_16x16x32_bf16 v[24:27], a[224:227], v[28:31], v[24:27]
    v_mfma_f32_16x16x32_bf16 v[16:19], a[68:71], v[28:31], v[16:19]
    v_mfma_f32_16x16x32_bf16 v[20:23], a[148:151], v[28:31], v[20:23]
    v_mfma_f32_16x16x32_bf16 v[24:27], a[228:231], v[28:31], v[24:27]
    s_barrier
    ds_read_b64_tr_b16 a[72:73], v32 offset:25600
    ds_read_b64_tr_b16 a[74:75], v32 offset:32000
    ds_read_b64_tr_b16 a[76:77], v32 offset:38400
    ds_read_b64_tr_b16 a[78:79], v32 offset:44800
    ds_read_b64_tr_b16 a[152:153], v32 offset:25632
    ds_read_b64_tr_b16 a[154:155], v32 offset:32032
    ds_read_b64_tr_b16 a[156:157], v32 offset:38432
    ds_read_b64_tr_b16 a[158:159], v32 offset:44832
    ds_read_b64_tr_b16 a[232:233], v32 offset:25664
    ds_read_b64_tr_b16 a[234:235], v32 offset:32064
    ds_read_b64_tr_b16 a[236:237], v32 offset:38464
    ds_read_b64_tr_b16 a[238:239], v32 offset:44864
    s_waitcnt lgkmcnt(0)
    v_mfma_f32_16x16x32_bf16 v[16:19], a[72:75], v[28:31], v[16:19]
    v_mfma_f32_16x16x32_bf16 v[20:23], a[152:155], v[28:31], v[20:23]
    v_mfma_f32_16x16x32_bf16 v[24:27], a[232:235], v[28:31], v[24:27]
    v_mfma_f32_16x16x32_bf16 v[16:19], a[76:79], v[28:31], v[16:19]
    v_mfma_f32_16x16x32_bf16 v[20:23], a[156:159], v[28:31], v[20:23]
    v_mfma_f32_16x16x32_bf16 v[24:27], a[236:239], v[28:31], v[24:27]
    s_nop 5
    v_mov_b32 v224, v16
    v_mov_b32 v225, v17
    v_mov_b32 v226, v18
    v_mov_b32 v227, v19
    v_mov_b32 v228, v20
    v_mov_b32 v229, v21
    v_mov_b32 v230, v22
    v_mov_b32 v231, v23
    v_mov_b32 v232, v24
    v_mov_b32 v233, v25
    v_mov_b32 v234, v26
    v_mov_b32 v235, v27
    v_mov_b32 v236, v28
    v_mov_b32 v237, v29
    v_mov_b32 v238, v30
    v_mov_b32 v239, v31
    s_barrier
interleave_layers__linear_attn_block__memory_aug_recurrent_mem_tr__prompt_kernel_p_layer:
    s_mov_b32 s93, 0
    s_lshl_b32 s24, s93, 12
    s_and_b32 s24, s24, 0x2000
    s_xor_b32 s24, s24, s36
    s_lshl_b32 s93, s93, 20
    s_add_u32 s93, s93, s24
    s_add_u32 s93, s93, 117440512
    s_mul_i32 s94, s92, 16384
    s_add_u32 s94, s94, 23068672
    s_sub_u32 s44, s2, 104
    s_lshr_b32 s46, s44, 5
    s_and_b32 s44, s44, 31
    s_mov_b32 s43, 67108864
    s_cmp_eq_u32 s46, 1
    s_cselect_b32 s43, 92274688, s43
    s_cmp_eq_u32 s46, 2
    s_cselect_b32 s43, 33554432, s43
    s_cmp_eq_u32 s92, 0
    s_cselect_b32 s73, 0, 8388608
    v_lshlrev_b32 v5, 4, v1
    s_mul_i32 s24, s3, 10240
    v_add_u32 v6, s24, v5
    v_add_u32 v7, 4096, v6
    v_add_u32 v8, 8192, v6
    s_mul_i32 s24, s44, 12288
    s_mul_i32 s25, s3, 3072
    s_add_u32 s24, s24, s25
    v_add_u32 v11, s24, v5
    s_lshr_b32 s24, s3, 1
    s_lshl_b32 s24, s24, 8
    s_and_b32 s25, s3, 1
    s_lshl_b32 s25, s25, 3
    s_add_u32 s24, s24, s25
    s_add_u32 s24, s24, 81920
    v_lshlrev_b32 v13, 4, v2
    v_add_u32 v12, s24, v13
    v_add_u32 v13, 81920, v13
    v_lshrrev_b32 v15, 2, v2
    v_cmp_eq_u32 vcc, v15, v3
    v_lshlrev_b32 v15, 3, v1
    v_add_u32 v15, 82944, v15
    v_cndmask_b32 v12, v15, v12, vcc
    v_and_b32 v15, 3, v2
    v_cmp_eq_u32 s[48:49], 1, v15
    v_cmp_eq_u32 s[50:51], 2, v15
    v_cmp_eq_u32 s[54:55], 3, v15
    s_and_b32 s24, s2, 7
    s_lshl_b32 s24, s24, 7
    s_lshl_b32 s25, s92, 10
    s_add_u32 s24, s24, s25
    s_add_u32 s24, s24, 23105536
    s_mov_b32 s25, 20
    s_mov_b32 s75, 2
    s_mov_b32 s74, 16
    v_cmp_gt_u32 vcc, s25, v1
    s_nop 1
    v_cndmask_b32 v4, 0, v1, vcc
    v_lshlrev_b32 v4, 2, v4
    v_add_u32 v4, s24, v4
    s_lshl_b32 s24, s46, 12
    s_lshl_b32 s25, s44, 7
    s_add_u32 s24, s24, s25
    s_add_u32 s24, s24, s94
    v_mov_b32 v14, s24
    v_mov_b32 v15, 2146435072
    v_cmp_eq_u32 vcc, 0, v1
    s_nop 1
    v_cndmask_b32 v14, v15, v14, vcc
    s_cmp_eq_u32 s3, 0
    s_cselect_b32 s24, 0, 2146435072
    v_or_b32 v14, s24, v14
    s_sub_u32 s70, s2, 104
    s_mul_i32 s71, s70, 205
    s_lshr_b32 s71, s71, 12
    s_mul_i32 s24, s71, 20
    s_sub_u32 s70, s70, s24
    s_cmp_lt_u32 s71, 4
    s_cselect_b32 s64, s71, 64
    s_lshl_b32 s24, s70, 16
    s_lshl_b32 s25, s3, 13
    s_add_u32 s24, s24, s25
    v_add_u32 v240, s24, v5
    v_add_u32 v241, 4096, v240
    s_lshl_b32 s24, s70, 15
    s_lshl_b32 s25, s3, 11
    s_add_u32 s24, s24, s25
    v_add_u32 v242, s24, v5
    s_lshl_b32 s24, s3, 15
    v_add_u32 v193, s24, v5
    v_add_u32 v212, 0, v193
    v_add_u32 v213, 4096, v193
    v_add_u32 v214, 16384, v193
    v_add_u32 v215, 20480, v193
    s_lshl_b32 s24, s3, 12
    s_and_b32 s25, s24, 0x2000
    s_add_u32 s24, s24, s25
    s_add_u32 s24, s24, 131072
    v_add_u32 v216, s24, v5
    s_lshl_b32 s24, s3, 12
    s_add_u32 s24, s24, 83968
    v_add_u32 v217, s24, v5
    s_and_b32 s24, s3, 1
    s_lshl_b32 s24, s24, 10
    s_add_u32 s24, s24, 83968
    v_add_u32 v218, s24, v5
    s_and_b32 s24, s3, 1
    s_mul_i32 s24, s24, 20480
    s_lshl_b32 s25, s70, 10
    s_add_u32 s24, s24, s25
    v_add_u32 v219, s24, v5
    s_and_b32 s24, s3, 1
    s_lshl_b32 s24, s24, 4
    v_add_u32 v243, s24, v2
    v_mul_u32_u24 v243, 1280, v243
    v_lshl_add_u32 v243, v3, 3, v243
    s_lshl_b32 s24, s70, 6
    v_add_u32 v243, s24, v243
    s_load_dwordx2 s[26:27], s[0:1], 80
    s_waitcnt lgkmcnt(0)
    s_mov_b32 s12, s26
    s_mov_b32 s13, s27
    s_mov_b32 s14, 2621440
    s_mov_b32 s15, 0x00020000
    s_mul_i32 s65, s71, 1310720
    s_add_u32 s65, s65, 184549376
    s_lshl_b32 s24, s71, 12
    s_and_b32 s24, s24, 0x2000
    s_xor_b32 s24, s24, s36
    s_lshl_b32 s66, s71, 20
    s_add_u32 s66, s66, s24
    s_add_u32 s66, s66, 117440512
    s_xor_b32 s67, s66, 0x2000
    s_mul_i32 s68, s71, 40960
    v_and_b32 v252, 7, v1
    v_lshlrev_b32 v252, 7, v252
    s_lshl_b32 s24, s3, 10
    s_add_u32 s24, s24, 12288
    s_add_u32 s24, s24, s94
    v_add_u32 v252, s24, v252
    s_mov_b32 s69, -1
    s_lshl_b32 s24, s71, 7
    s_lshl_b32 s25, s70, 2
    s_add_u32 s24, s24, s25
    s_add_u32 s24, s24, 23107584
    s_cmp_eq_u32 s3, 0
    s_cselect_b32 s24, s24, 2146435072
    v_mov_b32 v245, s24
    v_mov_b32 v246, 2146435072
    v_cmp_eq_u32 vcc, 0, v1
    s_nop 1
    v_cndmask_b32 v245, v246, v245, vcc
    s_mov_b32 s79, -1
    s_mov_b32 s76, -1
    s_mov_b32 s62, -1
    s_mov_b32 s63, 1
    s_mov_b32 s39, -1
    s_cmp_ge_i32 s39, s63
    s_cbranch_scc1 interleave_layers__linear_attn_block__memory_aug_recurrent_mem_tr__prompt_kernel_p_en0_ok
    s_mov_b32 s61, 0
interleave_layers__linear_attn_block__memory_aug_recurrent_mem_tr__prompt_kernel_p_en0:
    buffer_load_dword v16, v4, s[8:11], 0 offen sc1
    s_waitcnt vmcnt(0)
    v_readlane_b32 s39, v16, 0
    v_readlane_b32 s24, v16, 1
    s_min_i32 s39, s39, s24
    v_readlane_b32 s24, v16, 2
    s_min_i32 s39, s39, s24
    v_readlane_b32 s24, v16, 3
    s_min_i32 s39, s39, s24
    v_readlane_b32 s24, v16, 4
    s_min_i32 s39, s39, s24
    s_cmp_ge_i32 s39, s63
    s_cbranch_scc1 interleave_layers__linear_attn_block__memory_aug_recurrent_mem_tr__prompt_kernel_p_en0_ok
    s_add_u32 s61, s61, 1
    s_cmp_ge_u32 s61, s60
    s_cbranch_scc1 interleave_layers__linear_attn_block__memory_aug_recurrent_mem_tr__prompt_kernel_p_en0_to
    s_sleep 2
    s_branch interleave_layers__linear_attn_block__memory_aug_recurrent_mem_tr__prompt_kernel_p_en0
interleave_layers__linear_attn_block__memory_aug_recurrent_mem_tr__prompt_kernel_p_en0_to:
    s_mov_b32 s60, 1
interleave_layers__linear_attn_block__memory_aug_recurrent_mem_tr__prompt_kernel_p_en0_ok:
    s_mov_b32 s41, s73
    buffer_load_dwordx4 v[16:19], v6, s[8:11], s41 offen offset:0
    buffer_load_dwordx4 v[20:23], v6, s[8:11], s41 offen offset:1024
    buffer_load_dwordx4 v[24:27], v6, s[8:11], s41 offen offset:2048
    buffer_load_dwordx4 v[28:31], v6, s[8:11], s41 offen offset:3072
    buffer_load_dwordx4 v[32:35], v7, s[8:11], s41 offen offset:0
    buffer_load_dwordx4 v[36:39], v7, s[8:11], s41 offen offset:1024
    buffer_load_dwordx4 v[40:43], v7, s[8:11], s41 offen offset:2048
    buffer_load_dwordx4 v[44:47], v7, s[8:11], s41 offen offset:3072
    buffer_load_dwordx4 v[48:51], v8, s[8:11], s41 offen offset:0
    buffer_load_dwordx4 v[52:55], v8, s[8:11], s41 offen offset:1024
    s_mov_b32 s40, 0
    s_mov_b32 s42, 0
    s_waitcnt vmcnt(0)
    v_mfma_f32_16x16x32_bf16 v[148:151], v[16:19], v[16:19], 0
    v_mfma_f32_16x16x32_bf16 v[144:147], v[236:239], v[16:19], 0
    v_mfma_f32_16x16x32_bf16 v[148:151], v[20:23], v[20:23], v[148:151]
    v_mfma_f32_16x16x32_bf16 v[144:147], v[236:239], v[20:23], v[144:147]
    v_mfma_f32_16x16x32_bf16 v[148:151], v[24:27], v[24:27], v[148:151]
    v_mfma_f32_16x16x32_bf16 v[144:147], v[236:239], v[24:27], v[144:147]
    v_mfma_f32_16x16x32_bf16 v[148:151], v[28:31], v[28:31], v[148:151]
    v_mfma_f32_16x16x32_bf16 v[144:147], v[236:239], v[28:31], v[144:147]
    v_mfma_f32_16x16x32_bf16 v[148:151], v[32:35], v[32:35], v[148:151]
    v_mfma_f32_16x16x32_bf16 v[144:147], v[236:239], v[32:35], v[144:147]
    v_mfma_f32_16x16x32_bf16 v[148:151], v[36:39], v[36:39], v[148:151]
    v_mfma_f32_16x16x32_bf16 v[144:147], v[236:239], v[36:39], v[144:147]
    v_mfma_f32_16x16x32_bf16 v[148:151], v[40:43], v[40:43], v[148:151]
    v_mfma_f32_16x16x32_bf16 v[144:147], v[236:239], v[40:43], v[144:147]
    v_mfma_f32_16x16x32_bf16 v[148:151], v[44:47], v[44:47], v[148:151]
    v_mfma_f32_16x16x32_bf16 v[144:147], v[236:239], v[44:47], v[144:147]
    v_mfma_f32_16x16x32_bf16 v[148:151], v[48:51], v[48:51], v[148:151]
    v_mfma_f32_16x16x32_bf16 v[144:147], v[236:239], v[48:51], v[144:147]
    v_mfma_f32_16x16x32_bf16 v[148:151], v[52:55], v[52:55], v[148:151]
    v_mfma_f32_16x16x32_bf16 v[144:147], v[236:239], v[52:55], v[144:147]
    ds_write_b128 v6, v[16:19] offset:0
    ds_write_b128 v6, v[20:23] offset:1024
    ds_write_b128 v6, v[24:27] offset:2048
    ds_write_b128 v6, v[28:31] offset:3072
    ds_write_b128 v6, v[32:35] offset:4096
    ds_write_b128 v6, v[36:39] offset:5120
    ds_write_b128 v6, v[40:43] offset:6144
    ds_write_b128 v6, v[44:47] offset:7168
    ds_write_b128 v6, v[48:51] offset:8192
    ds_write_b128 v6, v[52:55] offset:9216
    v_cndmask_b32 v145, v148, v149, s[48:49]
    v_cndmask_b32 v145, v145, v150, s[50:51]
    v_cndmask_b32 v145, v145, v151, s[54:55]
    ds_write_b64 v12, v[144:145]
    s_waitcnt lgkmcnt(0)
    s_barrier
    s_branch interleave_layers__linear_attn_block__memory_aug_recurrent_mem_tr__prompt_kernel_p_segA
interleave_layers__linear_attn_block__memory_aug_recurrent_mem_tr__prompt_kernel_p_pubA:
    s_waitcnt vmcnt(0)
    s_barrier
    s_cmp_eq_u32 s3, 0
    s_cbranch_scc0 interleave_layers__linear_attn_block__memory_aug_recurrent_mem_tr__prompt_kernel_fp35
    v_mov_b32 v15, s40
    buffer_store_dword v15, v14, s[8:11], 0 offen sc1
interleave_layers__linear_attn_block__memory_aug_recurrent_mem_tr__prompt_kernel_fp35:
interleave_layers__linear_attn_block__memory_aug_recurrent_mem_tr__prompt_kernel_p_segA:
    v_add_u32 v9, s42, v5
    s_xor_b32 s42, s42, 40960
    v_add_u32 v10, s42, v6
    s_and_b32 s24, s40, 1
    s_lshl_b32 s24, s24, 9
    v_add_u32 v124, s24, v13
    s_xor_b32 s24, s24, 512
    v_add_u32 v140, s24, v12
    ds_read_b128 v[112:115], v124
    ds_read_b128 v[116:119], v124 offset:256
    ds_read_b128 v[56:59], v9 offset:0
    ds_read_b128 v[60:63], v9 offset:20480
    ds_read_b128 v[64:67], v9 offset:1024
    ds_read_b128 v[68:71], v9 offset:21504
    ds_read_b128 v[72:75], v9 offset:2048
    ds_read_b128 v[76:79], v9 offset:22528
    ds_read_b128 v[80:83], v9 offset:3072
    ds_read_b128 v[84:87], v9 offset:23552
    s_waitcnt lgkmcnt(6)
    v_mfma_f32_16x16x32_bf16 v[88:91], a[0:3], v[56:59], 0
    v_add_f32 v112, v112, v114
    v_mfma_f32_16x16x32_bf16 v[92:95], a[80:83], v[56:59], 0
    v_add_f32 v113, v113, v115
    v_mfma_f32_16x16x32_bf16 v[96:99], a[160:163], v[56:59], 0
    v_mul_f32 v112, 0x3acccccd, v112
    v_mfma_f32_16x16x32_bf16 v[100:103], a[0:3], v[60:63], 0
    v_mul_f32 v114, v112, v112
    v_mfma_f32_16x16x32_bf16 v[104:107], a[80:83], v[60:63], 0
    v_mov_b32 v115, 0x3acccccd
    v_mfma_f32_16x16x32_bf16 v[108:111], a[160:163], v[60:63], 0
    v_fma_f32 v113, v113, v115, -v114
    ds_read_b128 v[56:59], v9 offset:4096
    ds_read_b128 v[60:63], v9 offset:24576
    s_waitcnt lgkmcnt(6)
    v_mfma_f32_16x16x32_bf16 v[88:91], a[4:7], v[64:67], v[88:91]
    v_max_f32 v113, 0, v113
    v_mfma_f32_16x16x32_bf16 v[92:95], a[84:87], v[64:67], v[92:95]
    v_add_f32 v113, 0x3727c5ac, v113
    v_mfma_f32_16x16x32_bf16 v[96:99], a[164:167], v[64:67], v[96:99]
    v_rsq_f32 v132, v113
    v_mfma_f32_16x16x32_bf16 v[100:103], a[4:7], v[68:71], v[100:103]
    v_mul_f32 v133, v112, v132
    v_mfma_f32_16x16x32_bf16 v[104:107], a[84:87], v[68:71], v[104:107]
    v_sub_f32 v133, 0, v133
    v_mfma_f32_16x16x32_bf16 v[108:111], a[164:167], v[68:71], v[108:111]
    v_add_f32 v116, v116, v118
    ds_read_b128 v[64:67], v9 offset:5120
    ds_read_b128 v[68:71], v9 offset:25600
    s_waitcnt lgkmcnt(6)
    v_mfma_f32_16x16x32_bf16 v[88:91], a[8:11], v[72:75], v[88:91]
    v_add_f32 v117, v117, v119
    v_mfma_f32_16x16x32_bf16 v[92:95], a[88:91], v[72:75], v[92:95]
    v_mul_f32 v116, 0x3acccccd, v116
    v_mfma_f32_16x16x32_bf16 v[96:99], a[168:171], v[72:75], v[96:99]
    v_mul_f32 v118, v116, v116
    v_mfma_f32_16x16x32_bf16 v[100:103], a[8:11], v[76:79], v[100:103]
    v_mov_b32 v119, 0x3acccccd
    v_mfma_f32_16x16x32_bf16 v[104:107], a[88:91], v[76:79], v[104:107]
    v_fma_f32 v117, v117, v119, -v118
    v_mfma_f32_16x16x32_bf16 v[108:111], a[168:171], v[76:79], v[108:111]
    v_max_f32 v117, 0, v117
    ds_read_b128 v[72:75], v9 offset:6144
    ds_read_b128 v[76:79], v9 offset:26624
    s_waitcnt lgkmcnt(6)
    v_mfma_f32_16x16x32_bf16 v[88:91], a[12:15], v[80:83], v[88:91]
    v_add_f32 v117, 0x3727c5ac, v117
    v_mfma_f32_16x16x32_bf16 v[92:95], a[92:95], v[80:83], v[92:95]
    v_rsq_f32 v134, v117
    v_mfma_f32_16x16x32_bf16 v[96:99], a[172:175], v[80:83], v[96:99]
    v_mul_f32 v135, v116, v134
    v_mfma_f32_16x16x32_bf16 v[100:103], a[12:15], v[84:87], v[100:103]
    v_sub_f32 v135, 0, v135
    v_mfma_f32_16x16x32_bf16 v[104:107], a[92:95], v[84:87], v[104:107]
    v_mfma_f32_16x16x32_bf16 v[108:111], a[172:175], v[84:87], v[108:111]
    ds_read_b128 v[80:83], v9 offset:7168
    ds_read_b128 v[84:87], v9 offset:27648
    s_waitcnt lgkmcnt(6)
    v_mfma_f32_16x16x32_bf16 v[88:91], a[16:19], v[56:59], v[88:91]
    v_mfma_f32_16x16x32_bf16 v[92:95], a[96:99], v[56:59], v[92:95]
    v_mfma_f32_16x16x32_bf16 v[96:99], a[176:179], v[56:59], v[96:99]
    v_mfma_f32_16x16x32_bf16 v[100:103], a[16:19], v[60:63], v[100:103]
    v_mfma_f32_16x16x32_bf16 v[104:107], a[96:99], v[60:63], v[104:107]
    v_mfma_f32_16x16x32_bf16 v[108:111], a[176:179], v[60:63], v[108:111]
    buffer_load_dword v152, v4, s[8:11], 0 offen sc1
    ds_read_b128 v[56:59], v9 offset:8192
    ds_read_b128 v[60:63], v9 offset:28672
    s_waitcnt lgkmcnt(6)
    v_mfma_f32_16x16x32_bf16 v[88:91], a[20:23], v[64:67], v[88:91]
    v_mfma_f32_16x16x32_bf16 v[92:95], a[100:103], v[64:67], v[92:95]
    v_mfma_f32_16x16x32_bf16 v[96:99], a[180:183], v[64:67], v[96:99]
    v_mfma_f32_16x16x32_bf16 v[100:103], a[20:23], v[68:71], v[100:103]
    v_mfma_f32_16x16x32_bf16 v[104:107], a[100:103], v[68:71], v[104:107]
    v_mfma_f32_16x16x32_bf16 v[108:111], a[180:183], v[68:71], v[108:111]
    ds_read_b128 v[64:67], v9 offset:9216
    ds_read_b128 v[68:71], v9 offset:29696
    s_waitcnt lgkmcnt(6)
    v_mfma_f32_16x16x32_bf16 v[88:91], a[24:27], v[72:75], v[88:91]
    v_mfma_f32_16x16x32_bf16 v[92:95], a[104:107], v[72:75], v[92:95]
    v_mfma_f32_16x16x32_bf16 v[96:99], a[184:187], v[72:75], v[96:99]
    v_mfma_f32_16x16x32_bf16 v[100:103], a[24:27], v[76:79], v[100:103]
    v_mfma_f32_16x16x32_bf16 v[104:107], a[104:107], v[76:79], v[104:107]
    v_mfma_f32_16x16x32_bf16 v[108:111], a[184:187], v[76:79], v[108:111]
    ds_read_b128 v[72:75], v9 offset:10240
    ds_read_b128 v[76:79], v9 offset:30720
    s_waitcnt lgkmcnt(6)
    v_mfma_f32_16x16x32_bf16 v[88:91], a[28:31], v[80:83], v[88:91]
    v_mfma_f32_16x16x32_bf16 v[92:95], a[108:111], v[80:83], v[92:95]
    v_mfma_f32_16x16x32_bf16 v[96:99], a[188:191], v[80:83], v[96:99]
    v_mfma_f32_16x16x32_bf16 v[100:103], a[28:31], v[84:87], v[100:103]
    v_mfma_f32_16x16x32_bf16 v[104:107], a[108:111], v[84:87], v[104:107]
    v_mfma_f32_16x16x32_bf16 v[108:111], a[188:191], v[84:87], v[108:111]
    ds_read_b128 v[80:83], v9 offset:11264
    ds_read_b128 v[84:87], v9 offset:31744
    s_waitcnt lgkmcnt(6)
    v_mfma_f32_16x16x32_bf16 v[88:91], a[32:35], v[56:59], v[88:91]
    v_mfma_f32_16x16x32_bf16 v[92:95], a[112:115], v[56:59], v[92:95]
    v_mfma_f32_16x16x32_bf16 v[96:99], a[192:195], v[56:59], v[96:99]
    v_mfma_f32_16x16x32_bf16 v[100:103], a[32:35], v[60:63], v[100:103]
    v_mfma_f32_16x16x32_bf16 v[104:107], a[112:115], v[60:63], v[104:107]
    v_mfma_f32_16x16x32_bf16 v[108:111], a[192:195], v[60:63], v[108:111]
    ds_read_b128 v[56:59], v9 offset:12288
    ds_read_b128 v[60:63], v9 offset:32768
    s_waitcnt lgkmcnt(6)
    v_mfma_f32_16x16x32_bf16 v[88:91], a[36:39], v[64:67], v[88:91]
    v_mfma_f32_16x16x32_bf16 v[92:95], a[116:119], v[64:67], v[92:95]
    v_mfma_f32_16x16x32_bf16 v[96:99], a[196:199], v[64:67], v[96:99]
    v_mfma_f32_16x16x32_bf16 v[100:103], a[36:39], v[68:71], v[100:103]
    v_mfma_f32_16x16x32_bf16 v[104:107], a[116:119], v[68:71], v[104:107]
    v_mfma_f32_16x16x32_bf16 v[108:111], a[196:199], v[68:71], v[108:111]
    ds_read_b128 v[64:67], v9 offset:13312
    ds_read_b128 v[68:71], v9 offset:33792
    s_waitcnt lgkmcnt(6)
    v_mfma_f32_16x16x32_bf16 v[88:91], a[40:43], v[72:75], v[88:91]
    v_mfma_f32_16x16x32_bf16 v[92:95], a[120:123], v[72:75], v[92:95]
    v_mfma_f32_16x16x32_bf16 v[96:99], a[200:203], v[72:75], v[96:99]
    v_mfma_f32_16x16x32_bf16 v[100:103], a[40:43], v[76:79], v[100:103]
    v_mfma_f32_16x16x32_bf16 v[104:107], a[120:123], v[76:79], v[104:107]
    v_mfma_f32_16x16x32_bf16 v[108:111], a[200:203], v[76:79], v[108:111]
    ds_read_b128 v[72:75], v9 offset:14336
    ds_read_b128 v[76:79], v9 offset:34816
    s_waitcnt lgkmcnt(6)
    v_mfma_f32_16x16x32_bf16 v[88:91], a[44:47], v[80:83], v[88:91]
    v_mfma_f32_16x16x32_bf16 v[92:95], a[124:127], v[80:83], v[92:95]
    v_mfma_f32_16x16x32_bf16 v[96:99], a[204:207], v[80:83], v[96:99]
    v_mfma_f32_16x16x32_bf16 v[100:103], a[44:47], v[84:87], v[100:103]
    v_mfma_f32_16x16x32_bf16 v[104:107], a[124:127], v[84:87], v[104:107]
    v_mfma_f32_16x16x32_bf16 v[108:111], a[204:207], v[84:87], v[108:111]
    ds_read_b128 v[80:83], v9 offset:15360
    ds_read_b128 v[84:87], v9 offset:35840
    s_waitcnt lgkmcnt(6)
    v_mfma_f32_16x16x32_bf16 v[88:91], a[48:51], v[56:59], v[88:91]
    v_mfma_f32_16x16x32_bf16 v[92:95], a[128:131], v[56:59], v[92:95]
    v_mfma_f32_16x16x32_bf16 v[96:99], a[208:211], v[56:59], v[96:99]
    v_mfma_f32_16x16x32_bf16 v[100:103], a[48:51], v[60:63], v[100:103]
    v_mfma_f32_16x16x32_bf16 v[104:107], a[128:131], v[60:63], v[104:107]
    v_mfma_f32_16x16x32_bf16 v[108:111], a[208:211], v[60:63], v[108:111]
    ds_read_b128 v[56:59], v9 offset:16384
    ds_read_b128 v[60:63], v9 offset:36864
    s_waitcnt lgkmcnt(6)
    v_mfma_f32_16x16x32_bf16 v[88:91], a[52:55], v[64:67], v[88:91]
    v_mfma_f32_16x16x32_bf16 v[92:95], a[132:135], v[64:67], v[92:95]
    v_mfma_f32_16x16x32_bf16 v[96:99], a[212:215], v[64:67], v[96:99]
    v_mfma_f32_16x16x32_bf16 v[100:103], a[52:55], v[68:71], v[100:103]
    v_mfma_f32_16x16x32_bf16 v[104:107], a[132:135], v[68:71], v[104:107]
    v_mfma_f32_16x16x32_bf16 v[108:111], a[212:215], v[68:71], v[108:111]
    ds_read_b128 v[64:67], v9 offset:17408
    ds_read_b128 v[68:71], v9 offset:37888
    s_waitcnt lgkmcnt(6)
    v_mfma_f32_16x16x32_bf16 v[88:91], a[56:59], v[72:75], v[88:91]
    v_mfma_f32_16x16x32_bf16 v[92:95], a[136:139], v[72:75], v[92:95]
    v_mfma_f32_16x16x32_bf16 v[96:99], a[216:219], v[72:75], v[96:99]
    v_mfma_f32_16x16x32_bf16 v[100:103], a[56:59], v[76:79], v[100:103]
    v_mfma_f32_16x16x32_bf16 v[104:107], a[136:139], v[76:79], v[104:107]
    v_mfma_f32_16x16x32_bf16 v[108:111], a[216:219], v[76:79], v[108:111]
    ds_read_b128 v[72:75], v9 offset:18432
    ds_read_b128 v[76:79], v9 offset:38912
    s_waitcnt lgkmcnt(6)
    v_mfma_f32_16x16x32_bf16 v[88:91], a[60:63], v[80:83], v[88:91]
    v_mfma_f32_16x16x32_bf16 v[92:95], a[140:143], v[80:83], v[92:95]
    v_mfma_f32_16x16x32_bf16 v[96:99], a[220:223], v[80:83], v[96:99]
    v_mfma_f32_16x16x32_bf16 v[100:103], a[60:63], v[84:87], v[100:103]
    v_mfma_f32_16x16x32_bf16 v[104:107], a[140:143], v[84:87], v[104:107]
    v_mfma_f32_16x16x32_bf16 v[108:111], a[220:223], v[84:87], v[108:111]
    ds_read_b128 v[80:83], v9 offset:19456
    ds_read_b128 v[84:87], v9 offset:39936
    s_waitcnt lgkmcnt(6)
    v_mfma_f32_16x16x32_bf16 v[88:91], a[64:67], v[56:59], v[88:91]
    v_mfma_f32_16x16x32_bf16 v[92:95], a[144:147], v[56:59], v[92:95]
    v_mfma_f32_16x16x32_bf16 v[96:99], a[224:227], v[56:59], v[96:99]
    v_mfma_f32_16x16x32_bf16 v[100:103], a[64:67], v[60:63], v[100:103]
    v_mfma_f32_16x16x32_bf16 v[104:107], a[144:147], v[60:63], v[104:107]
    v_mfma_f32_16x16x32_bf16 v[108:111], a[224:227], v[60:63], v[108:111]
    s_waitcnt lgkmcnt(4)
    v_mfma_f32_16x16x32_bf16 v[88:91], a[68:71], v[64:67], v[88:91]
    v_mfma_f32_16x16x32_bf16 v[92:95], a[148:151], v[64:67], v[92:95]
    v_mfma_f32_16x16x32_bf16 v[96:99], a[228:231], v[64:67], v[96:99]
    v_mfma_f32_16x16x32_bf16 v[100:103], a[68:71], v[68:71], v[100:103]
    v_mfma_f32_16x16x32_bf16 v[104:107], a[148:151], v[68:71], v[104:107]
    v_mfma_f32_16x16x32_bf16 v[108:111], a[228:231], v[68:71], v[108:111]
    s_waitcnt lgkmcnt(2)
    v_mfma_f32_16x16x32_bf16 v[88:91], a[72:75], v[72:75], v[88:91]
    v_mfma_f32_16x16x32_bf16 v[92:95], a[152:155], v[72:75], v[92:95]
    v_mfma_f32_16x16x32_bf16 v[96:99], a[232:235], v[72:75], v[96:99]
    v_mfma_f32_16x16x32_bf16 v[100:103], a[72:75], v[76:79], v[100:103]
    v_mfma_f32_16x16x32_bf16 v[104:107], a[152:155], v[76:79], v[104:107]
    v_mfma_f32_16x16x32_bf16 v[108:111], a[232:235], v[76:79], v[108:111]
    s_waitcnt lgkmcnt(0)
    v_mfma_f32_16x16x32_bf16 v[88:91], a[76:79], v[80:83], v[88:91]
    v_mfma_f32_16x16x32_bf16 v[92:95], a[156:159], v[80:83], v[92:95]
    v_mfma_f32_16x16x32_bf16 v[96:99], a[236:239], v[80:83], v[96:99]
    v_mfma_f32_16x16x32_bf16 v[100:103], a[76:79], v[84:87], v[100:103]
    v_mfma_f32_16x16x32_bf16 v[104:107], a[156:159], v[84:87], v[104:107]
    v_mfma_f32_16x16x32_bf16 v[108:111], a[236:239], v[84:87], v[108:111]
    v_pk_mul_f32 v[124:125], v[224:225], v[132:133] op_sel:[0,1] op_sel_hi:[1,1]
    v_pk_mul_f32 v[126:127], v[226:227], v[132:133] op_sel:[0,1] op_sel_hi:[1,1]
    s_nop 0
    v_pk_fma_f32 v[88:89], v[88:89], v[132:133], v[124:125] op_sel:[0,0,0] op_sel_hi:[1,0,1]
    v_pk_fma_f32 v[90:91], v[90:91], v[132:133], v[126:127] op_sel:[0,0,0] op_sel_hi:[1,0,1]
    v_pk_mul_f32 v[124:125], v[228:229], v[132:133] op_sel:[0,1] op_sel_hi:[1,1]
    v_pk_mul_f32 v[126:127], v[230:231], v[132:133] op_sel:[0,1] op_sel_hi:[1,1]
    v_pk_fma_f32 v[92:93], v[92:93], v[132:133], v[124:125] op_sel:[0,0,0] op_sel_hi:[1,0,1]
    v_pk_fma_f32 v[94:95], v[94:95], v[132:133], v[126:127] op_sel:[0,0,0] op_sel_hi:[1,0,1]
    v_pk_mul_f32 v[124:125], v[232:233], v[132:133] op_sel:[0,1] op_sel_hi:[1,1]
    v_pk_mul_f32 v[126:127], v[234:235], v[132:133] op_sel:[0,1] op_sel_hi:[1,1]
    v_pk_fma_f32 v[96:97], v[96:97], v[132:133], v[124:125] op_sel:[0,0,0] op_sel_hi:[1,0,1]
    v_pk_fma_f32 v[98:99], v[98:99], v[132:133], v[126:127] op_sel:[0,0,0] op_sel_hi:[1,0,1]
    v_pk_mul_f32 v[124:125], v[224:225], v[134:135] op_sel:[0,1] op_sel_hi:[1,1]
    v_pk_mul_f32 v[126:127], v[226:227], v[134:135] op_sel:[0,1] op_sel_hi:[1,1]
    v_pk_fma_f32 v[100:101], v[100:101], v[134:135], v[124:125] op_sel:[0,0,0] op_sel_hi:[1,0,1]
    v_pk_fma_f32 v[102:103], v[102:103], v[134:135], v[126:127] op_sel:[0,0,0] op_sel_hi:[1,0,1]
    v_pk_mul_f32 v[124:125], v[228:229], v[134:135] op_sel:[0,1] op_sel_hi:[1,1]
    v_pk_mul_f32 v[126:127], v[230:231], v[134:135] op_sel:[0,1] op_sel_hi:[1,1]
    v_pk_fma_f32 v[104:105], v[104:105], v[134:135], v[124:125] op_sel:[0,0,0] op_sel_hi:[1,0,1]
    v_pk_fma_f32 v[106:107], v[106:107], v[134:135], v[126:127] op_sel:[0,0,0] op_sel_hi:[1,0,1]
    v_pk_mul_f32 v[124:125], v[232:233], v[134:135] op_sel:[0,1] op_sel_hi:[1,1]
    v_pk_mul_f32 v[126:127], v[234:235], v[134:135] op_sel:[0,1] op_sel_hi:[1,1]
    v_pk_fma_f32 v[108:109], v[108:109], v[134:135], v[124:125] op_sel:[0,0,0] op_sel_hi:[1,0,1]
    v_pk_fma_f32 v[110:111], v[110:111], v[134:135], v[126:127] op_sel:[0,0,0] op_sel_hi:[1,0,1]
    v_cvt_pk_bf16_f32 v112, v88, v89
    v_cvt_pk_bf16_f32 v113, v90, v91
    v_cvt_pk_bf16_f32 v114, v92, v93
    v_cvt_pk_bf16_f32 v115, v94, v95
    v_cvt_pk_bf16_f32 v116, v100, v101
    v_cvt_pk_bf16_f32 v117, v102, v103
    v_cvt_pk_bf16_f32 v118, v104, v105
    v_cvt_pk_bf16_f32 v119, v106, v107
    v_cvt_pk_bf16_f32 v120, v96, v97
    v_cvt_pk_bf16_f32 v121, v98, v99
    v_cvt_pk_bf16_f32 v122, v108, v109
    v_cvt_pk_bf16_f32 v123, v110, v111
    buffer_store_dwordx4 v[112:115], v11, s[8:11], s43 offen offset:0 sc1
    buffer_store_dwordx4 v[116:119], v11, s[8:11], s43 offen offset:1024 sc1
    buffer_store_dwordx4 v[120:123], v11, s[8:11], s43 offen offset:2048 sc1
    s_add_u32 s43, s43, 393216
    s_waitcnt vmcnt(3)
    s_add_u32 s63, s40, 1
    s_lshr_b32 s63, s63, s75
    s_add_u32 s63, s63, 1
    s_min_u32 s63, s63, s74
    v_cmp_le_i32 vcc, s63, v152
    s_cmp_eq_u64 vcc, -1
    s_cselect_b32 s24, 1, 0
    s_cmp_ge_i32 s62, s63
    s_cselect_b32 s24, 1, s24
    s_cmp_eq_u32 s24, 1
    s_cbranch_scc0 interleave_layers__linear_attn_block__memory_aug_recurrent_mem_tr__prompt_kernel_po37
    s_max_i32 s62, s62, s63
    s_add_u32 s41, s41, 40960
    buffer_load_dwordx4 v[16:19], v6, s[8:11], s41 offen offset:0
    buffer_load_dwordx4 v[20:23], v6, s[8:11], s41 offen offset:1024
    buffer_load_dwordx4 v[24:27], v6, s[8:11], s41 offen offset:2048
    buffer_load_dwordx4 v[28:31], v6, s[8:11], s41 offen offset:3072
    buffer_load_dwordx4 v[32:35], v7, s[8:11], s41 offen offset:0
    buffer_load_dwordx4 v[36:39], v7, s[8:11], s41 offen offset:1024
    buffer_load_dwordx4 v[40:43], v7, s[8:11], s41 offen offset:2048
    buffer_load_dwordx4 v[44:47], v7, s[8:11], s41 offen offset:3072
    buffer_load_dwordx4 v[48:51], v8, s[8:11], s41 offen offset:0
    buffer_load_dwordx4 v[52:55], v8, s[8:11], s41 offen offset:1024
    buffer_load_dword v152, v4, s[8:11], 0 offen sc1
    s_waitcnt vmcnt(11)
    s_barrier
    s_add_u32 s24, s40, 1
    v_mov_b32 v15, s24
    buffer_store_dword v15, v14, s[8:11], 0 offen sc1
    s_branch interleave_layers__linear_attn_block__memory_aug_recurrent_mem_tr__prompt_kernel_po36
interleave_layers__linear_attn_block__memory_aug_recurrent_mem_tr__prompt_kernel_po37:
    s_waitcnt vmcnt(0)
    s_barrier
    s_add_u32 s24, s40, 1
    v_mov_b32 v15, s24
    buffer_store_dword v15, v14, s[8:11], 0 offen sc1
    s_add_u32 s63, s40, 1
    s_lshr_b32 s63, s63, s75
    s_add_u32 s63, s63, 1
    s_min_u32 s63, s63, s74
    s_cmp_ge_i32 s62, s63
    s_cbranch_scc1 interleave_layers__linear_attn_block__memory_aug_recurrent_mem_tr__prompt_kernel_p_enA_ok
    s_mov_b32 s61, 0
interleave_layers__linear_attn_block__memory_aug_recurrent_mem_tr__prompt_kernel_p_enA:
    buffer_load_dword v16, v4, s[8:11], 0 offen sc1
    s_waitcnt vmcnt(0)
    v_readlane_b32 s62, v16, 0
    v_readlane_b32 s24, v16, 1
    s_min_i32 s62, s62, s24
    v_readlane_b32 s24, v16, 2
    s_min_i32 s62, s62, s24
    v_readlane_b32 s24, v16, 3
    s_min_i32 s62, s62, s24
    v_readlane_b32 s24, v16, 4
    s_min_i32 s62, s62, s24
    v_readlane_b32 s24, v16, 5
    s_min_i32 s62, s62, s24
    v_readlane_b32 s24, v16, 6
    s_min_i32 s62, s62, s24
    v_readlane_b32 s24, v16, 7
    s_min_i32 s62, s62, s24
    v_readlane_b32 s24, v16, 8
    s_min_i32 s62, s62, s24
    v_readlane_b32 s24, v16, 9
    s_min_i32 s62, s62, s24
    v_readlane_b32 s24, v16, 10
    s_min_i32 s62, s62, s24
    v_readlane_b32 s24, v16, 11
    s_min_i32 s62, s62, s24
    v_readlane_b32 s24, v16, 12
    s_min_i32 s62, s62, s24
    v_readlane_b32 s24, v16, 13
    s_min_i32 s62, s62, s24
    v_readlane_b32 s24, v16, 14
    s_min_i32 s62, s62, s24
    v_readlane_b32 s24, v16, 15
    s_min_i32 s62, s62, s24
    v_readlane_b32 s24, v16, 16
    s_min_i32 s62, s62, s24
    v_readlane_b32 s24, v16, 17
    s_min_i32 s62, s62, s24
    v_readlane_b32 s24, v16, 18
    s_min_i32 s62, s62, s24
    v_readlane_b32 s24, v16, 19
    s_min_i32 s62, s62, s24
    s_cmp_ge_i32 s62, s63
    s_cbranch_scc1 interleave_layers__linear_attn_block__memory_aug_recurrent_mem_tr__prompt_kernel_p_enA_ok
    s_add_u32 s61, s61, 1
    s_cmp_ge_u32 s61, s60
    s_cbranch_scc1 interleave_layers__linear_attn_block__memory_aug_recurrent_mem_tr__prompt_kernel_p_enA_to
    s_sleep 2
    s_branch interleave_layers__linear_attn_block__memory_aug_recurrent_mem_tr__prompt_kernel_p_enA
interleave_layers__linear_attn_block__memory_aug_recurrent_mem_tr__prompt_kernel_p_enA_to:
    s_mov_b32 s60, 1
interleave_layers__linear_attn_block__memory_aug_recurrent_mem_tr__prompt_kernel_p_enA_ok:
    s_add_u32 s41, s41, 40960
    buffer_load_dwordx4 v[16:19], v6, s[8:11], s41 offen offset:0
    buffer_load_dwordx4 v[20:23], v6, s[8:11], s41 offen offset:1024
    buffer_load_dwordx4 v[24:27], v6, s[8:11], s41 offen offset:2048
    buffer_load_dwordx4 v[28:31], v6, s[8:11], s41 offen offset:3072
    buffer_load_dwordx4 v[32:35], v7, s[8:11], s41 offen offset:0
    buffer_load_dwordx4 v[36:39], v7, s[8:11], s41 offen offset:1024
    buffer_load_dwordx4 v[40:43], v7, s[8:11], s41 offen offset:2048
    buffer_load_dwordx4 v[44:47], v7, s[8:11], s41 offen offset:3072
    buffer_load_dwordx4 v[48:51], v8, s[8:11], s41 offen offset:0
    buffer_load_dwordx4 v[52:55], v8, s[8:11], s41 offen offset:1024
    buffer_load_dword v152, v4, s[8:11], 0 offen sc1
interleave_layers__linear_attn_block__memory_aug_recurrent_mem_tr__prompt_kernel_po36:
    s_waitcnt vmcnt(0)
    v_mfma_f32_16x16x32_bf16 v[148:151], v[16:19], v[16:19], 0
    v_mfma_f32_16x16x32_bf16 v[144:147], v[236:239], v[16:19], 0
    v_mfma_f32_16x16x32_bf16 v[148:151], v[20:23], v[20:23], v[148:151]
    v_mfma_f32_16x16x32_bf16 v[144:147], v[236:239], v[20:23], v[144:147]
    v_mfma_f32_16x16x32_bf16 v[148:151], v[24:27], v[24:27], v[148:151]
    v_mfma_f32_16x16x32_bf16 v[144:147], v[236:239], v[24:27], v[144:147]
    v_mfma_f32_16x16x32_bf16 v[148:151], v[28:31], v[28:31], v[148:151]
    v_mfma_f32_16x16x32_bf16 v[144:147], v[236:239], v[28:31], v[144:147]
    v_mfma_f32_16x16x32_bf16 v[148:151], v[32:35], v[32:35], v[148:151]
    v_mfma_f32_16x16x32_bf16 v[144:147], v[236:239], v[32:35], v[144:147]
    v_mfma_f32_16x16x32_bf16 v[148:151], v[36:39], v[36:39], v[148:151]
    v_mfma_f32_16x16x32_bf16 v[144:147], v[236:239], v[36:39], v[144:147]
    v_mfma_f32_16x16x32_bf16 v[148:151], v[40:43], v[40:43], v[148:151]
    v_mfma_f32_16x16x32_bf16 v[144:147], v[236:239], v[40:43], v[144:147]
    v_mfma_f32_16x16x32_bf16 v[148:151], v[44:47], v[44:47], v[148:151]
    v_mfma_f32_16x16x32_bf16 v[144:147], v[236:239], v[44:47], v[144:147]
    v_mfma_f32_16x16x32_bf16 v[148:151], v[48:51], v[48:51], v[148:151]
    v_mfma_f32_16x16x32_bf16 v[144:147], v[236:239], v[48:51], v[144:147]
    v_mfma_f32_16x16x32_bf16 v[148:151], v[52:55], v[52:55], v[148:151]
    v_mfma_f32_16x16x32_bf16 v[144:147], v[236:239], v[52:55], v[144:147]
    ds_write_b128 v10, v[16:19] offset:0
    ds_write_b128 v10, v[20:23] offset:1024
    ds_write_b128 v10, v[24:27] offset:2048
    ds_write_b128 v10, v[28:31] offset:3072
    ds_write_b128 v10, v[32:35] offset:4096
    ds_write_b128 v10, v[36:39] offset:5120
    ds_write_b128 v10, v[40:43] offset:6144
    ds_write_b128 v10, v[44:47] offset:7168
    ds_write_b128 v10, v[48:51] offset:8192
    ds_write_b128 v10, v[52:55] offset:9216
    v_cndmask_b32 v145, v148, v149, s[48:49]
    v_cndmask_b32 v145, v145, v150, s[50:51]
    v_cndmask_b32 v145, v145, v151, s[54:55]
    ds_write_b64 v140, v[144:145]
    s_add_u32 s40, s40, 1
    s_add_u32 s63, s40, 1
    s_lshr_b32 s63, s63, s75
    s_add_u32 s63, s63, 1
    s_min_u32 s63, s63, s74
    v_cmp_le_i32 vcc, s63, v152
    s_cmp_eq_u64 vcc, -1
    s_cselect_b32 s58, 1, 0
    s_cmp_ge_i32 s62, s63
    s_cselect_b32 s58, 1, s58
    s_and_b32 s24, s40, 1
    s_lshl_b32 s24, s24, 2
    s_add_u32 s24, s24, 83456
    s_lshl_b32 s25, s3, 4
    s_add_u32 s25, s25, s24
    v_mov_b32 v15, s25
    v_mov_b32 v152, s58
    ds_write_b32 v15, v152
    v_mov_b32 v15, s24
    s_waitcnt lgkmcnt(0)
    s_barrier
    ds_read_b32 v152, v15
    s_waitcnt lgkmcnt(0)
    v_readfirstlane_b32 s58, v152
    s_cmp_eq_u32 s58, 1
    s_cselect_b32 s24, s63, s62
    s_max_i32 s62, s62, s24
    s_branch interleave_layers__linear_attn_block__memory_aug_recurrent_mem_tr__prompt_kernel_p_next
interleave_layers__linear_attn_block__memory_aug_recurrent_mem_tr__prompt_kernel_p_seg:
    v_add_u32 v9, s42, v5
    s_xor_b32 s42, s42, 40960
    v_add_u32 v10, s42, v6
    s_add_u32 s63, s40, 1
    s_lshr_b32 s63, s63, s75
    s_add_u32 s63, s63, 1
    s_min_u32 s63, s63, s74
    s_cmp_ge_i32 s62, s63
    s_cbranch_scc1 interleave_layers__linear_attn_block__memory_aug_recurrent_mem_tr__prompt_kernel_p_en_ok
    s_mov_b32 s61, 0
interleave_layers__linear_attn_block__memory_aug_recurrent_mem_tr__prompt_kernel_p_en:
    buffer_load_dword v16, v4, s[8:11], 0 offen sc1
    s_waitcnt vmcnt(0)
    v_readlane_b32 s62, v16, 0
    v_readlane_b32 s24, v16, 1
    s_min_i32 s62, s62, s24
    v_readlane_b32 s24, v16, 2
    s_min_i32 s62, s62, s24
    v_readlane_b32 s24, v16, 3
    s_min_i32 s62, s62, s24
    v_readlane_b32 s24, v16, 4
    s_min_i32 s62, s62, s24
    v_readlane_b32 s24, v16, 5
    s_min_i32 s62, s62, s24
    v_readlane_b32 s24, v16, 6
    s_min_i32 s62, s62, s24
    v_readlane_b32 s24, v16, 7
    s_min_i32 s62, s62, s24
    v_readlane_b32 s24, v16, 8
    s_min_i32 s62, s62, s24
    v_readlane_b32 s24, v16, 9
    s_min_i32 s62, s62, s24
    v_readlane_b32 s24, v16, 10
    s_min_i32 s62, s62, s24
    v_readlane_b32 s24, v16, 11
    s_min_i32 s62, s62, s24
    v_readlane_b32 s24, v16, 12
    s_min_i32 s62, s62, s24
    v_readlane_b32 s24, v16, 13
    s_min_i32 s62, s62, s24
    v_readlane_b32 s24, v16, 14
    s_min_i32 s62, s62, s24
    v_readlane_b32 s24, v16, 15
    s_min_i32 s62, s62, s24
    v_readlane_b32 s24, v16, 16
    s_min_i32 s62, s62, s24
    v_readlane_b32 s24, v16, 17
    s_min_i32 s62, s62, s24
    v_readlane_b32 s24, v16, 18
    s_min_i32 s62, s62, s24
    v_readlane_b32 s24, v16, 19
    s_min_i32 s62, s62, s24
    s_cmp_ge_i32 s62, s63
    s_cbranch_scc1 interleave_layers__linear_attn_block__memory_aug_recurrent_mem_tr__prompt_kernel_p_en_ok
    s_add_u32 s61, s61, 1
    s_cmp_ge_u32 s61, s60
    s_cbranch_scc1 interleave_layers__linear_attn_block__memory_aug_recurrent_mem_tr__prompt_kernel_p_en_to
    s_sleep 2
    s_branch interleave_layers__linear_attn_block__memory_aug_recurrent_mem_tr__prompt_kernel_p_en
interleave_layers__linear_attn_block__memory_aug_recurrent_mem_tr__prompt_kernel_p_en_to:
    s_mov_b32 s60, 1
interleave_layers__linear_attn_block__memory_aug_recurrent_mem_tr__prompt_kernel_p_en_ok:
    s_add_u32 s41, s41, 40960
    buffer_load_dwordx4 v[16:19], v6, s[8:11], s41 offen offset:0
    buffer_load_dwordx4 v[20:23], v6, s[8:11], s41 offen offset:1024
    buffer_load_dwordx4 v[24:27], v6, s[8:11], s41 offen offset:2048
    buffer_load_dwordx4 v[28:31], v6, s[8:11], s41 offen offset:3072
    buffer_load_dwordx4 v[32:35], v7, s[8:11], s41 offen offset:0
    buffer_load_dwordx4 v[36:39], v7, s[8:11], s41 offen offset:1024
    buffer_load_dwordx4 v[40:43], v7, s[8:11], s41 offen offset:2048
    buffer_load_dwordx4 v[44:47], v7, s[8:11], s41 offen offset:3072
    buffer_load_dwordx4 v[48:51], v8, s[8:11], s41 offen offset:0
    buffer_load_dwordx4 v[52:55], v8, s[8:11], s41 offen offset:1024
    s_and_b32 s24, s40, 1
    s_lshl_b32 s24, s24, 9
    v_add_u32 v124, s24, v13
    s_xor_b32 s24, s24, 512
    v_add_u32 v140, s24, v12
    ds_read_b128 v[112:115], v124
    ds_read_b128 v[116:119], v124 offset:256
    ds_read_b128 v[56:59], v9 offset:0
    ds_read_b128 v[60:63], v9 offset:20480
    ds_read_b128 v[64:67], v9 offset:1024
    ds_read_b128 v[68:71], v9 offset:21504
    ds_read_b128 v[72:75], v9 offset:2048
    ds_read_b128 v[76:79], v9 offset:22528
    ds_read_b128 v[80:83], v9 offset:3072
    ds_read_b128 v[84:87], v9 offset:23552
    s_waitcnt lgkmcnt(6)
    v_mfma_f32_16x16x32_bf16 v[88:91], a[0:3], v[56:59], 0
    v_add_f32 v112, v112, v114
    v_mfma_f32_16x16x32_bf16 v[92:95], a[80:83], v[56:59], 0
    v_add_f32 v113, v113, v115
    v_mfma_f32_16x16x32_bf16 v[96:99], a[160:163], v[56:59], 0
    v_mul_f32 v112, 0x3acccccd, v112
    v_mfma_f32_16x16x32_bf16 v[100:103], a[0:3], v[60:63], 0
    v_mul_f32 v114, v112, v112
    v_mfma_f32_16x16x32_bf16 v[104:107], a[80:83], v[60:63], 0
    v_mov_b32 v115, 0x3acccccd
    v_mfma_f32_16x16x32_bf16 v[108:111], a[160:163], v[60:63], 0
    v_fma_f32 v113, v113, v115, -v114
    ds_read_b128 v[56:59], v9 offset:4096
    ds_read_b128 v[60:63], v9 offset:24576
    s_waitcnt lgkmcnt(6)
    v_mfma_f32_16x16x32_bf16 v[88:91], a[4:7], v[64:67], v[88:91]
    v_max_f32 v113, 0, v113
    v_mfma_f32_16x16x32_bf16 v[92:95], a[84:87], v[64:67], v[92:95]
    v_add_f32 v113, 0x3727c5ac, v113
    v_mfma_f32_16x16x32_bf16 v[96:99], a[164:167], v[64:67], v[96:99]
    v_rsq_f32 v132, v113
    v_mfma_f32_16x16x32_bf16 v[100:103], a[4:7], v[68:71], v[100:103]
    v_mul_f32 v133, v112, v132
    v_mfma_f32_16x16x32_bf16 v[104:107], a[84:87], v[68:71], v[104:107]
    v_sub_f32 v133, 0, v133
    v_mfma_f32_16x16x32_bf16 v[108:111], a[164:167], v[68:71], v[108:111]
    v_add_f32 v116, v116, v118
    ds_read_b128 v[64:67], v9 offset:5120
    ds_read_b128 v[68:71], v9 offset:25600
    s_waitcnt lgkmcnt(6)
    v_mfma_f32_16x16x32_bf16 v[88:91], a[8:11], v[72:75], v[88:91]
    v_add_f32 v117, v117, v119
    v_mfma_f32_16x16x32_bf16 v[92:95], a[88:91], v[72:75], v[92:95]
    v_mul_f32 v116, 0x3acccccd, v116
    v_mfma_f32_16x16x32_bf16 v[96:99], a[168:171], v[72:75], v[96:99]
    v_mul_f32 v118, v116, v116
    v_mfma_f32_16x16x32_bf16 v[100:103], a[8:11], v[76:79], v[100:103]
    v_mov_b32 v119, 0x3acccccd
    v_mfma_f32_16x16x32_bf16 v[104:107], a[88:91], v[76:79], v[104:107]
    v_fma_f32 v117, v117, v119, -v118
    v_mfma_f32_16x16x32_bf16 v[108:111], a[168:171], v[76:79], v[108:111]
    v_max_f32 v117, 0, v117
    ds_read_b128 v[72:75], v9 offset:6144
    ds_read_b128 v[76:79], v9 offset:26624
    s_waitcnt lgkmcnt(6)
    v_mfma_f32_16x16x32_bf16 v[88:91], a[12:15], v[80:83], v[88:91]
    v_add_f32 v117, 0x3727c5ac, v117
    v_mfma_f32_16x16x32_bf16 v[92:95], a[92:95], v[80:83], v[92:95]
    v_rsq_f32 v134, v117
    v_mfma_f32_16x16x32_bf16 v[96:99], a[172:175], v[80:83], v[96:99]
    v_mul_f32 v135, v116, v134
    v_mfma_f32_16x16x32_bf16 v[100:103], a[12:15], v[84:87], v[100:103]
    v_sub_f32 v135, 0, v135
    v_mfma_f32_16x16x32_bf16 v[104:107], a[92:95], v[84:87], v[104:107]
    v_mfma_f32_16x16x32_bf16 v[108:111], a[172:175], v[84:87], v[108:111]
    ds_read_b128 v[80:83], v9 offset:7168
    ds_read_b128 v[84:87], v9 offset:27648
    s_waitcnt lgkmcnt(6)
    v_mfma_f32_16x16x32_bf16 v[88:91], a[16:19], v[56:59], v[88:91]
    v_mfma_f32_16x16x32_bf16 v[92:95], a[96:99], v[56:59], v[92:95]
    v_mfma_f32_16x16x32_bf16 v[96:99], a[176:179], v[56:59], v[96:99]
    v_mfma_f32_16x16x32_bf16 v[100:103], a[16:19], v[60:63], v[100:103]
    v_mfma_f32_16x16x32_bf16 v[104:107], a[96:99], v[60:63], v[104:107]
    v_mfma_f32_16x16x32_bf16 v[108:111], a[176:179], v[60:63], v[108:111]
    ds_read_b128 v[56:59], v9 offset:8192
    ds_read_b128 v[60:63], v9 offset:28672
    s_waitcnt lgkmcnt(6)
    v_mfma_f32_16x16x32_bf16 v[88:91], a[20:23], v[64:67], v[88:91]
    v_mfma_f32_16x16x32_bf16 v[92:95], a[100:103], v[64:67], v[92:95]
    v_mfma_f32_16x16x32_bf16 v[96:99], a[180:183], v[64:67], v[96:99]
    v_mfma_f32_16x16x32_bf16 v[100:103], a[20:23], v[68:71], v[100:103]
    v_mfma_f32_16x16x32_bf16 v[104:107], a[100:103], v[68:71], v[104:107]
    v_mfma_f32_16x16x32_bf16 v[108:111], a[180:183], v[68:71], v[108:111]
    ds_read_b128 v[64:67], v9 offset:9216
    ds_read_b128 v[68:71], v9 offset:29696
    s_waitcnt lgkmcnt(6)
    v_mfma_f32_16x16x32_bf16 v[88:91], a[24:27], v[72:75], v[88:91]
    v_mfma_f32_16x16x32_bf16 v[92:95], a[104:107], v[72:75], v[92:95]
    v_mfma_f32_16x16x32_bf16 v[96:99], a[184:187], v[72:75], v[96:99]
    v_mfma_f32_16x16x32_bf16 v[100:103], a[24:27], v[76:79], v[100:103]
    v_mfma_f32_16x16x32_bf16 v[104:107], a[104:107], v[76:79], v[104:107]
    v_mfma_f32_16x16x32_bf16 v[108:111], a[184:187], v[76:79], v[108:111]
    ds_read_b128 v[72:75], v9 offset:10240
    ds_read_b128 v[76:79], v9 offset:30720
    s_waitcnt lgkmcnt(6)
    v_mfma_f32_16x16x32_bf16 v[88:91], a[28:31], v[80:83], v[88:91]
    v_mfma_f32_16x16x32_bf16 v[92:95], a[108:111], v[80:83], v[92:95]
    v_mfma_f32_16x16x32_bf16 v[96:99], a[188:191], v[80:83], v[96:99]
    v_mfma_f32_16x16x32_bf16 v[100:103], a[28:31], v[84:87], v[100:103]
    v_mfma_f32_16x16x32_bf16 v[104:107], a[108:111], v[84:87], v[104:107]
    v_mfma_f32_16x16x32_bf16 v[108:111], a[188:191], v[84:87], v[108:111]
    ds_read_b128 v[80:83], v9 offset:11264
    ds_read_b128 v[84:87], v9 offset:31744
    s_waitcnt lgkmcnt(6)
    v_mfma_f32_16x16x32_bf16 v[88:91], a[32:35], v[56:59], v[88:91]
    v_mfma_f32_16x16x32_bf16 v[92:95], a[112:115], v[56:59], v[92:95]
    v_mfma_f32_16x16x32_bf16 v[96:99], a[192:195], v[56:59], v[96:99]
    v_mfma_f32_16x16x32_bf16 v[100:103], a[32:35], v[60:63], v[100:103]
    v_mfma_f32_16x16x32_bf16 v[104:107], a[112:115], v[60:63], v[104:107]
    v_mfma_f32_16x16x32_bf16 v[108:111], a[192:195], v[60:63], v[108:111]
    ds_read_b128 v[56:59], v9 offset:12288
    ds_read_b128 v[60:63], v9 offset:32768
    s_waitcnt lgkmcnt(6)
    v_mfma_f32_16x16x32_bf16 v[88:91], a[36:39], v[64:67], v[88:91]
    v_mfma_f32_16x16x32_bf16 v[92:95], a[116:119], v[64:67], v[92:95]
    v_mfma_f32_16x16x32_bf16 v[96:99], a[196:199], v[64:67], v[96:99]
    v_mfma_f32_16x16x32_bf16 v[100:103], a[36:39], v[68:71], v[100:103]
    v_mfma_f32_16x16x32_bf16 v[104:107], a[116:119], v[68:71], v[104:107]
    v_mfma_f32_16x16x32_bf16 v[108:111], a[196:199], v[68:71], v[108:111]
    s_waitcnt vmcnt(10)
    s_barrier
    v_mov_b32 v15, s40
    buffer_store_dword v15, v14, s[8:11], 0 offen sc1
    s_cmp_ge_i32 s79, 0
    s_cselect_b32 s24, 0, 2146435072
    v_or_b32 v246, s24, v245
    v_mov_b32 v247, s79
    buffer_store_dword v247, v246, s[8:11], 0 offen sc1
    s_mov_b32 s79, -1
    buffer_load_dword v152, v4, s[8:11], 0 offen sc1
    ds_read_b128 v[64:67], v9 offset:13312
    ds_read_b128 v[68:71], v9 offset:33792
    s_waitcnt lgkmcnt(6)
    v_mfma_f32_16x16x32_bf16 v[88:91], a[40:43], v[72:75], v[88:91]
    v_mfma_f32_16x16x32_bf16 v[92:95], a[120:123], v[72:75], v[92:95]
    v_mfma_f32_16x16x32_bf16 v[96:99], a[200:203], v[72:75], v[96:99]
    v_mfma_f32_16x16x32_bf16 v[100:103], a[40:43], v[76:79], v[100:103]
    v_mfma_f32_16x16x32_bf16 v[104:107], a[120:123], v[76:79], v[104:107]
    v_mfma_f32_16x16x32_bf16 v[108:111], a[200:203], v[76:79], v[108:111]
    ds_read_b128 v[72:75], v9 offset:14336
    ds_read_b128 v[76:79], v9 offset:34816
    s_waitcnt lgkmcnt(6)
    s_waitcnt vmcnt(3)
    v_mfma_f32_16x16x32_bf16 v[88:91], a[44:47], v[80:83], v[88:91]
    v_mfma_f32_16x16x32_bf16 v[92:95], a[124:127], v[80:83], v[92:95]
    ds_write_b128 v10, v[16:19] offset:0
    v_mfma_f32_16x16x32_bf16 v[96:99], a[204:207], v[80:83], v[96:99]
    v_mfma_f32_16x16x32_bf16 v[100:103], a[44:47], v[84:87], v[100:103]
    v_mfma_f32_16x16x32_bf16 v[104:107], a[124:127], v[84:87], v[104:107]
    v_mfma_f32_16x16x32_bf16 v[108:111], a[204:207], v[84:87], v[108:111]
    v_mfma_f32_16x16x32_bf16 v[148:151], v[16:19], v[16:19], 0
    v_mfma_f32_16x16x32_bf16 v[144:147], v[236:239], v[16:19], 0
    v_mfma_f32_16x16x32_bf16 v[148:151], v[20:23], v[20:23], v[148:151]
    ds_read_b128 v[80:83], v9 offset:15360
    ds_read_b128 v[84:87], v9 offset:35840
    s_waitcnt lgkmcnt(7)
    v_mfma_f32_16x16x32_bf16 v[88:91], a[48:51], v[56:59], v[88:91]
    v_mfma_f32_16x16x32_bf16 v[92:95], a[128:131], v[56:59], v[92:95]
    ds_write_b128 v10, v[20:23] offset:1024
    v_mfma_f32_16x16x32_bf16 v[96:99], a[208:211], v[56:59], v[96:99]
    v_mfma_f32_16x16x32_bf16 v[100:103], a[48:51], v[60:63], v[100:103]
    v_mfma_f32_16x16x32_bf16 v[104:107], a[128:131], v[60:63], v[104:107]
    v_mfma_f32_16x16x32_bf16 v[108:111], a[208:211], v[60:63], v[108:111]
    v_mfma_f32_16x16x32_bf16 v[144:147], v[236:239], v[20:23], v[144:147]
    v_mfma_f32_16x16x32_bf16 v[148:151], v[24:27], v[24:27], v[148:151]
    v_mfma_f32_16x16x32_bf16 v[144:147], v[236:239], v[24:27], v[144:147]
    ds_read_b128 v[56:59], v9 offset:16384
    ds_read_b128 v[60:63], v9 offset:36864
    s_waitcnt lgkmcnt(8)
    v_mfma_f32_16x16x32_bf16 v[88:91], a[52:55], v[64:67], v[88:91]
    v_mfma_f32_16x16x32_bf16 v[92:95], a[132:135], v[64:67], v[92:95]
    ds_write_b128 v10, v[24:27] offset:2048
    v_mfma_f32_16x16x32_bf16 v[96:99], a[212:215], v[64:67], v[96:99]
    v_mfma_f32_16x16x32_bf16 v[100:103], a[52:55], v[68:71], v[100:103]
    v_mfma_f32_16x16x32_bf16 v[104:107], a[132:135], v[68:71], v[104:107]
    v_mfma_f32_16x16x32_bf16 v[108:111], a[212:215], v[68:71], v[108:111]
    v_mfma_f32_16x16x32_bf16 v[148:151], v[28:31], v[28:31], v[148:151]
    v_mfma_f32_16x16x32_bf16 v[144:147], v[236:239], v[28:31], v[144:147]
    v_mfma_f32_16x16x32_bf16 v[148:151], v[32:35], v[32:35], v[148:151]
    ds_read_b128 v[64:67], v9 offset:17408
    ds_read_b128 v[68:71], v9 offset:37888
    s_waitcnt lgkmcnt(9)
    v_mfma_f32_16x16x32_bf16 v[88:91], a[56:59], v[72:75], v[88:91]
    v_mfma_f32_16x16x32_bf16 v[92:95], a[136:139], v[72:75], v[92:95]
    ds_write_b128 v10, v[28:31] offset:3072
    v_mfma_f32_16x16x32_bf16 v[96:99], a[216:219], v[72:75], v[96:99]
    v_mfma_f32_16x16x32_bf16 v[100:103], a[56:59], v[76:79], v[100:103]
    v_mfma_f32_16x16x32_bf16 v[104:107], a[136:139], v[76:79], v[104:107]
    v_mfma_f32_16x16x32_bf16 v[108:111], a[216:219], v[76:79], v[108:111]
    v_mfma_f32_16x16x32_bf16 v[144:147], v[236:239], v[32:35], v[144:147]
    v_mfma_f32_16x16x32_bf16 v[148:151], v[36:39], v[36:39], v[148:151]
    v_mfma_f32_16x16x32_bf16 v[144:147], v[236:239], v[36:39], v[144:147]
    ds_read_b128 v[72:75], v9 offset:18432
    ds_read_b128 v[76:79], v9 offset:38912
    s_waitcnt lgkmcnt(9)
    v_mfma_f32_16x16x32_bf16 v[88:91], a[60:63], v[80:83], v[88:91]
    v_mfma_f32_16x16x32_bf16 v[92:95], a[140:143], v[80:83], v[92:95]
    ds_write_b128 v10, v[32:35] offset:4096
    v_mfma_f32_16x16x32_bf16 v[96:99], a[220:223], v[80:83], v[96:99]
    v_mfma_f32_16x16x32_bf16 v[100:103], a[60:63], v[84:87], v[100:103]
    v_mfma_f32_16x16x32_bf16 v[104:107], a[140:143], v[84:87], v[104:107]
    v_mfma_f32_16x16x32_bf16 v[108:111], a[220:223], v[84:87], v[108:111]
    v_mfma_f32_16x16x32_bf16 v[148:151], v[40:43], v[40:43], v[148:151]
    v_mfma_f32_16x16x32_bf16 v[144:147], v[236:239], v[40:43], v[144:147]
    v_mfma_f32_16x16x32_bf16 v[148:151], v[44:47], v[44:47], v[148:151]
    ds_read_b128 v[80:83], v9 offset:19456
    ds_read_b128 v[84:87], v9 offset:39936
    s_waitcnt lgkmcnt(9)
    v_mfma_f32_16x16x32_bf16 v[88:91], a[64:67], v[56:59], v[88:91]
    v_mfma_f32_16x16x32_bf16 v[92:95], a[144:147], v[56:59], v[92:95]
    ds_write_b128 v10, v[36:39] offset:5120
    v_mfma_f32_16x16x32_bf16 v[96:99], a[224:227], v[56:59], v[96:99]
    v_mfma_f32_16x16x32_bf16 v[100:103], a[64:67], v[60:63], v[100:103]
    v_mfma_f32_16x16x32_bf16 v[104:107], a[144:147], v[60:63], v[104:107]
    v_mfma_f32_16x16x32_bf16 v[108:111], a[224:227], v[60:63], v[108:111]
    v_mfma_f32_16x16x32_bf16 v[144:147], v[236:239], v[44:47], v[144:147]
    v_mfma_f32_16x16x32_bf16 v[148:151], v[48:51], v[48:51], v[148:151]
    v_mfma_f32_16x16x32_bf16 v[144:147], v[236:239], v[48:51], v[144:147]
    s_waitcnt lgkmcnt(7)
    v_mfma_f32_16x16x32_bf16 v[88:91], a[68:71], v[64:67], v[88:91]
    v_mfma_f32_16x16x32_bf16 v[92:95], a[148:151], v[64:67], v[92:95]
    ds_write_b128 v10, v[40:43] offset:6144
    v_mfma_f32_16x16x32_bf16 v[96:99], a[228:231], v[64:67], v[96:99]
    v_mfma_f32_16x16x32_bf16 v[100:103], a[68:71], v[68:71], v[100:103]
    v_mfma_f32_16x16x32_bf16 v[104:107], a[148:151], v[68:71], v[104:107]
    v_mfma_f32_16x16x32_bf16 v[108:111], a[228:231], v[68:71], v[108:111]
    v_mfma_f32_16x16x32_bf16 v[148:151], v[52:55], v[52:55], v[148:151]
    v_mfma_f32_16x16x32_bf16 v[144:147], v[236:239], v[52:55], v[144:147]
    s_waitcnt lgkmcnt(5)
    v_mfma_f32_16x16x32_bf16 v[88:91], a[72:75], v[72:75], v[88:91]
    v_mfma_f32_16x16x32_bf16 v[92:95], a[152:155], v[72:75], v[92:95]
    ds_write_b128 v10, v[44:47] offset:7168
    v_mfma_f32_16x16x32_bf16 v[96:99], a[232:235], v[72:75], v[96:99]
    v_mfma_f32_16x16x32_bf16 v[100:103], a[72:75], v[76:79], v[100:103]
    v_mfma_f32_16x16x32_bf16 v[104:107], a[152:155], v[76:79], v[104:107]
    v_mfma_f32_16x16x32_bf16 v[108:111], a[232:235], v[76:79], v[108:111]
    s_waitcnt lgkmcnt(3)
    v_mfma_f32_16x16x32_bf16 v[88:91], a[76:79], v[80:83], v[88:91]
    v_mfma_f32_16x16x32_bf16 v[92:95], a[156:159], v[80:83], v[92:95]
    ds_write_b128 v10, v[48:51] offset:8192
    v_mfma_f32_16x16x32_bf16 v[96:99], a[236:239], v[80:83], v[96:99]
    v_mfma_f32_16x16x32_bf16 v[100:103], a[76:79], v[84:87], v[100:103]
    v_mfma_f32_16x16x32_bf16 v[104:107], a[156:159], v[84:87], v[104:107]
    v_mfma_f32_16x16x32_bf16 v[108:111], a[236:239], v[84:87], v[108:111]
    v_cndmask_b32 v145, v148, v149, s[48:49]
    v_cndmask_b32 v145, v145, v150, s[50:51]
    v_cndmask_b32 v145, v145, v151, s[54:55]
    ds_write_b128 v10, v[52:55] offset:9216
    ds_write_b64 v140, v[144:145]
    v_pk_mul_f32 v[124:125], v[224:225], v[132:133] op_sel:[0,1] op_sel_hi:[1,1]
    v_pk_mul_f32 v[126:127], v[226:227], v[132:133] op_sel:[0,1] op_sel_hi:[1,1]
    v_pk_fma_f32 v[88:89], v[88:89], v[132:133], v[124:125] op_sel:[0,0,0] op_sel_hi:[1,0,1]
    v_pk_fma_f32 v[90:91], v[90:91], v[132:133], v[126:127] op_sel:[0,0,0] op_sel_hi:[1,0,1]
    v_pk_mul_f32 v[124:125], v[228:229], v[132:133] op_sel:[0,1] op_sel_hi:[1,1]
    v_pk_mul_f32 v[126:127], v[230:231], v[132:133] op_sel:[0,1] op_sel_hi:[1,1]
    v_pk_fma_f32 v[92:93], v[92:93], v[132:133], v[124:125] op_sel:[0,0,0] op_sel_hi:[1,0,1]
    v_pk_fma_f32 v[94:95], v[94:95], v[132:133], v[126:127] op_sel:[0,0,0] op_sel_hi:[1,0,1]
    v_pk_mul_f32 v[124:125], v[232:233], v[132:133] op_sel:[0,1] op_sel_hi:[1,1]
    v_pk_mul_f32 v[126:127], v[234:235], v[132:133] op_sel:[0,1] op_sel_hi:[1,1]
    v_pk_fma_f32 v[96:97], v[96:97], v[132:133], v[124:125] op_sel:[0,0,0] op_sel_hi:[1,0,1]
    v_pk_fma_f32 v[98:99], v[98:99], v[132:133], v[126:127] op_sel:[0,0,0] op_sel_hi:[1,0,1]
    v_pk_mul_f32 v[124:125], v[224:225], v[134:135] op_sel:[0,1] op_sel_hi:[1,1]
    v_pk_mul_f32 v[126:127], v[226:227], v[134:135] op_sel:[0,1] op_sel_hi:[1,1]
    v_pk_fma_f32 v[100:101], v[100:101], v[134:135], v[124:125] op_sel:[0,0,0] op_sel_hi:[1,0,1]
    v_pk_fma_f32 v[102:103], v[102:103], v[134:135], v[126:127] op_sel:[0,0,0] op_sel_hi:[1,0,1]
    v_pk_mul_f32 v[124:125], v[228:229], v[134:135] op_sel:[0,1] op_sel_hi:[1,1]
    v_pk_mul_f32 v[126:127], v[230:231], v[134:135] op_sel:[0,1] op_sel_hi:[1,1]
    v_pk_fma_f32 v[104:105], v[104:105], v[134:135], v[124:125] op_sel:[0,0,0] op_sel_hi:[1,0,1]
    v_pk_fma_f32 v[106:107], v[106:107], v[134:135], v[126:127] op_sel:[0,0,0] op_sel_hi:[1,0,1]
    v_pk_mul_f32 v[124:125], v[232:233], v[134:135] op_sel:[0,1] op_sel_hi:[1,1]
    v_pk_mul_f32 v[126:127], v[234:235], v[134:135] op_sel:[0,1] op_sel_hi:[1,1]
    v_pk_fma_f32 v[108:109], v[108:109], v[134:135], v[124:125] op_sel:[0,0,0] op_sel_hi:[1,0,1]
    v_pk_fma_f32 v[110:111], v[110:111], v[134:135], v[126:127] op_sel:[0,0,0] op_sel_hi:[1,0,1]
    v_cvt_pk_bf16_f32 v112, v88, v89
    v_cvt_pk_bf16_f32 v113, v90, v91
    v_cvt_pk_bf16_f32 v114, v92, v93
    v_cvt_pk_bf16_f32 v115, v94, v95
    v_cvt_pk_bf16_f32 v116, v100, v101
    v_cvt_pk_bf16_f32 v117, v102, v103
    v_cvt_pk_bf16_f32 v118, v104, v105
    v_cvt_pk_bf16_f32 v119, v106, v107
    v_cvt_pk_bf16_f32 v120, v96, v97
    v_cvt_pk_bf16_f32 v121, v98, v99
    v_cvt_pk_bf16_f32 v122, v108, v109
    v_cvt_pk_bf16_f32 v123, v110, v111
    buffer_store_dwordx4 v[112:115], v11, s[8:11], s43 offen offset:0 sc1
    buffer_store_dwordx4 v[116:119], v11, s[8:11], s43 offen offset:1024 sc1
    buffer_store_dwordx4 v[120:123], v11, s[8:11], s43 offen offset:2048 sc1
    s_add_u32 s43, s43, 393216
    s_waitcnt vmcnt(3)
    s_add_u32 s40, s40, 1
    s_add_u32 s63, s40, 1
    s_lshr_b32 s63, s63, s75
    s_add_u32 s63, s63, 1
    s_min_u32 s63, s63, s74
    v_cmp_le_i32 vcc, s63, v152
    s_cmp_eq_u64 vcc, -1
    s_cselect_b32 s58, 1, 0
    s_cmp_ge_i32 s62, s63
    s_cselect_b32 s58, 1, s58
    s_and_b32 s24, s40, 1
    s_lshl_b32 s24, s24, 2
    s_add_u32 s24, s24, 83456
    s_lshl_b32 s25, s3, 4
    s_add_u32 s25, s25, s24
    v_mov_b32 v15, s25
    v_mov_b32 v152, s58
    ds_write_b32 v15, v152
    v_mov_b32 v15, s24
    s_waitcnt lgkmcnt(0)
    s_barrier
    ds_read_b32 v152, v15
    s_waitcnt lgkmcnt(0)
    v_readfirstlane_b32 s58, v152
    s_cmp_eq_u32 s58, 1
    s_cselect_b32 s24, s63, s62
    s_max_i32 s62, s62, s24
interleave_layers__linear_attn_block__memory_aug_recurrent_mem_tr__prompt_kernel_p_next:
    s_add_u32 s24, s64, 8
    s_cmp_le_u32 s24, s40
    s_cbranch_scc1 interleave_layers__linear_attn_block__memory_aug_recurrent_mem_tr__prompt_kernel_p_pub
    s_cmp_lt_u32 s40, 64
    s_cbranch_scc0 interleave_layers__linear_attn_block__memory_aug_recurrent_mem_tr__prompt_kernel_pg38
    s_cmp_eq_u32 s58, 1
    s_cbranch_scc1 interleave_layers__linear_attn_block__memory_aug_recurrent_mem_tr__prompt_kernel_p_seg
    s_branch interleave_layers__linear_attn_block__memory_aug_recurrent_mem_tr__prompt_kernel_p_pubA
interleave_layers__linear_attn_block__memory_aug_recurrent_mem_tr__prompt_kernel_pg38:
interleave_layers__linear_attn_block__memory_aug_recurrent_mem_tr__prompt_kernel_p_pub:
    s_waitcnt vmcnt(0)
    s_barrier
    s_cmp_eq_u32 s3, 0
    s_cbranch_scc0 interleave_layers__linear_attn_block__memory_aug_recurrent_mem_tr__prompt_kernel_fp39
    v_mov_b32 v15, s40
    buffer_store_dword v15, v14, s[8:11], 0 offen sc1
interleave_layers__linear_attn_block__memory_aug_recurrent_mem_tr__prompt_kernel_fp39:
    s_add_u32 s24, s64, 8
    s_cmp_le_u32 s24, s40
    s_cbranch_scc1 interleave_layers__linear_attn_block__memory_aug_recurrent_mem_tr__prompt_kernel_p_x
    s_cmp_lt_u32 s40, 64
    s_cbranch_scc0 interleave_layers__linear_attn_block__memory_aug_recurrent_mem_tr__prompt_kernel_pg40
    s_cmp_eq_u32 s58, 1
    s_cbranch_scc1 interleave_layers__linear_attn_block__memory_aug_recurrent_mem_tr__prompt_kernel_p_seg
    s_branch interleave_layers__linear_attn_block__memory_aug_recurrent_mem_tr__prompt_kernel_p_pubA
interleave_layers__linear_attn_block__memory_aug_recurrent_mem_tr__prompt_kernel_pg40:
    s_cmp_ge_u32 s64, 64
    s_cbranch_scc1 interleave_layers__linear_attn_block__memory_aug_recurrent_mem_tr__prompt_kernel_p_done
interleave_layers__linear_attn_block__memory_aug_recurrent_mem_tr__prompt_kernel_p_x:
    s_add_u32 s63, s64, 1
    s_cmp_ge_i32 s69, s63
    s_cbranch_scc1 interleave_layers__linear_attn_block__memory_aug_recurrent_mem_tr__prompt_kernel_x_en_ok
    s_mov_b32 s61, 0
interleave_layers__linear_attn_block__memory_aug_recurrent_mem_tr__prompt_kernel_x_en:
    buffer_load_dword v253, v252, s[8:11], 0 offen sc1
    s_waitcnt vmcnt(0)
    v_readlane_b32 s69, v253, 0
    v_readlane_b32 s24, v253, 1
    s_min_i32 s69, s69, s24
    v_readlane_b32 s24, v253, 2
    s_min_i32 s69, s69, s24
    v_readlane_b32 s24, v253, 3
    s_min_i32 s69, s69, s24
    v_readlane_b32 s24, v253, 4
    s_min_i32 s69, s69, s24
    v_readlane_b32 s24, v253, 5
    s_min_i32 s69, s69, s24
    v_readlane_b32 s24, v253, 6
    s_min_i32 s69, s69, s24
    v_readlane_b32 s24, v253, 7
    s_min_i32 s69, s69, s24
    s_cmp_ge_i32 s69, s63
    s_cbranch_scc1 interleave_layers__linear_attn_block__memory_aug_recurrent_mem_tr__prompt_kernel_x_en_ok
    s_add_u32 s61, s61, 1
    s_cmp_ge_u32 s61, s60
    s_cbranch_scc1 interleave_layers__linear_attn_block__memory_aug_recurrent_mem_tr__prompt_kernel_x_en_to
    s_sleep 2
    s_branch interleave_layers__linear_attn_block__memory_aug_recurrent_mem_tr__prompt_kernel_x_en
interleave_layers__linear_attn_block__memory_aug_recurrent_mem_tr__prompt_kernel_x_en_to:
    s_mov_b32 s60, 1
interleave_layers__linear_attn_block__memory_aug_recurrent_mem_tr__prompt_kernel_x_en_ok:
    s_lshl_b32 s95, s92, 6
    s_add_u32 s95, s95, s64
    s_add_u32 s95, s95, 1
    s_cmp_ge_i32 s59, s95
    s_cbranch_scc1 interleave_layers__linear_attn_block__memory_aug_recurrent_mem_tr__prompt_kernel_x_ec_ok
    s_and_b32 s24, s2, 7
    s_lshl_b32 s24, s24, 7
    s_add_u32 s24, s24, 23109632
    v_and_b32 v254, 3, v1
    v_lshl_add_u32 v254, v254, 2, s24
    s_mov_b32 s61, 0
interleave_layers__linear_attn_block__memory_aug_recurrent_mem_tr__prompt_kernel_x_ec:
    buffer_load_dword v253, v254, s[8:11], 0 offen sc1
    s_waitcnt vmcnt(0)
    v_readlane_b32 s59, v253, 0
    v_readlane_b32 s24, v253, 1
    s_min_i32 s59, s59, s24
    v_readlane_b32 s24, v253, 2
    s_min_i32 s59, s59, s24
    s_cmp_ge_i32 s59, s95
    s_cbranch_scc1 interleave_layers__linear_attn_block__memory_aug_recurrent_mem_tr__prompt_kernel_x_ec_ok
    s_add_u32 s61, s61, 1
    s_cmp_ge_u32 s61, s60
    s_cbranch_scc1 interleave_layers__linear_attn_block__memory_aug_recurrent_mem_tr__prompt_kernel_x_ec_to
    s_sleep 2
    s_branch interleave_layers__linear_attn_block__memory_aug_recurrent_mem_tr__prompt_kernel_x_ec
interleave_layers__linear_attn_block__memory_aug_recurrent_mem_tr__prompt_kernel_x_ec_to:
    s_mov_b32 s60, 1
interleave_layers__linear_attn_block__memory_aug_recurrent_mem_tr__prompt_kernel_x_ec_ok:
    s_add_u32 s52, s65, 32768
    buffer_load_dwordx4 v[16:19], v240, s[8:11], s65 offen offset:0 sc1
    buffer_load_dwordx4 v[20:23], v240, s[8:11], s65 offen offset:1024 sc1
    buffer_load_dwordx4 v[24:27], v240, s[8:11], s65 offen offset:2048 sc1
    buffer_load_dwordx4 v[28:31], v240, s[8:11], s65 offen offset:3072 sc1
    buffer_load_dwordx4 v[32:35], v241, s[8:11], s65 offen offset:0 sc1
    buffer_load_dwordx4 v[36:39], v241, s[8:11], s65 offen offset:1024 sc1
    buffer_load_dwordx4 v[40:43], v241, s[8:11], s65 offen offset:2048 sc1
    buffer_load_dwordx4 v[44:47], v241, s[8:11], s65 offen offset:3072 sc1
    buffer_load_dwordx4 v[48:51], v240, s[8:11], s52 offen offset:0 sc1
    buffer_load_dwordx4 v[52:55], v240, s[8:11], s52 offen offset:1024 sc1
    buffer_load_dwordx4 v[56:59], v240, s[8:11], s52 offen offset:2048 sc1
    buffer_load_dwordx4 v[60:63], v240, s[8:11], s52 offen offset:3072 sc1
    buffer_load_dwordx4 v[64:67], v241, s[8:11], s52 offen offset:0 sc1
    buffer_load_dwordx4 v[68:71], v241, s[8:11], s52 offen offset:1024 sc1
    buffer_load_dwordx4 v[72:75], v241, s[8:11], s52 offen offset:2048 sc1
    buffer_load_dwordx4 v[76:79], v241, s[8:11], s52 offen offset:3072 sc1
    s_add_u32 s24, s68, s73
    buffer_load_dwordx4 v[196:199], v219, s[8:11], s24 offen sc1
    s_lshl_b32 s77, s92, 6
    s_add_u32 s77, s77, s64
    s_add_u32 s77, s77, 1
    s_cmp_ge_i32 s76, s77
    s_cbranch_scc1 interleave_layers__linear_attn_block__memory_aug_recurrent_mem_tr__prompt_kernel_x_cs_ok
    s_and_b32 s24, s2, 7
    s_lshl_b32 s24, s24, 7
    s_add_u32 s24, s24, 23111680
    v_mov_b32 v254, s24
    s_mov_b32 s61, 0
interleave_layers__linear_attn_block__memory_aug_recurrent_mem_tr__prompt_kernel_x_cs:
    buffer_load_dword v253, v254, s[8:11], 0 offen sc1
    s_waitcnt vmcnt(0)
    v_readlane_b32 s76, v253, 0
    s_cmp_ge_i32 s76, s77
    s_cbranch_scc1 interleave_layers__linear_attn_block__memory_aug_recurrent_mem_tr__prompt_kernel_x_cs_ok
    s_add_u32 s61, s61, 1
    s_cmp_ge_u32 s61, s60
    s_cbranch_scc1 interleave_layers__linear_attn_block__memory_aug_recurrent_mem_tr__prompt_kernel_x_cs_to
    s_sleep 16
    s_branch interleave_layers__linear_attn_block__memory_aug_recurrent_mem_tr__prompt_kernel_x_cs
interleave_layers__linear_attn_block__memory_aug_recurrent_mem_tr__prompt_kernel_x_cs_to:
    s_mov_b32 s60, 1
interleave_layers__linear_attn_block__memory_aug_recurrent_mem_tr__prompt_kernel_x_cs_ok:
    s_add_u32 s53, s66, 16384
    s_mov_b32 s61, 0
interleave_layers__linear_attn_block__memory_aug_recurrent_mem_tr__prompt_kernel_x_p1:
    buffer_load_dwordx4 v[80:83], v212, s[8:11], s67 offen offset:0 sc1
    buffer_load_dwordx4 v[84:87], v212, s[8:11], s67 offen offset:1024 sc1
    buffer_load_dwordx4 v[88:91], v212, s[8:11], s67 offen offset:2048 sc1
    buffer_load_dwordx4 v[92:95], v212, s[8:11], s67 offen offset:3072 sc1
    buffer_load_dwordx4 v[96:99], v213, s[8:11], s67 offen offset:0 sc1
    buffer_load_dwordx4 v[100:103], v213, s[8:11], s67 offen offset:1024 sc1
    buffer_load_dwordx4 v[104:107], v213, s[8:11], s67 offen offset:2048 sc1
    buffer_load_dwordx4 v[108:111], v213, s[8:11], s67 offen offset:3072 sc1
    buffer_load_dwordx4 v[112:115], v214, s[8:11], s67 offen offset:0 sc1
    buffer_load_dwordx4 v[116:119], v214, s[8:11], s67 offen offset:1024 sc1
    buffer_load_dwordx4 v[120:123], v214, s[8:11], s67 offen offset:2048 sc1
    buffer_load_dwordx4 v[124:127], v214, s[8:11], s67 offen offset:3072 sc1
    buffer_load_dwordx4 v[128:131], v215, s[8:11], s67 offen offset:0 sc1
    buffer_load_dwordx4 v[132:135], v215, s[8:11], s67 offen offset:1024 sc1
    buffer_load_dwordx4 v[136:139], v215, s[8:11], s67 offen offset:2048 sc1
    buffer_load_dwordx4 v[140:143], v215, s[8:11], s67 offen offset:3072 sc1
    buffer_load_dwordx4 v[144:147], v216, s[8:11], s67 offen offset:0 sc1
    buffer_load_dwordx4 v[148:151], v216, s[8:11], s67 offen offset:1024 sc1
    buffer_load_dwordx4 v[152:155], v216, s[8:11], s67 offen offset:2048 sc1
    buffer_load_dwordx4 v[156:159], v216, s[8:11], s67 offen offset:3072 sc1
    buffer_load_dwordx4 v[160:163], v242, s[8:11], s66 offen offset:0 sc1
    buffer_load_dwordx4 v[164:167], v242, s[8:11], s66 offen offset:1024 sc1
    buffer_load_dwordx4 v[168:171], v242, s[8:11], s53 offen offset:0 sc1
    buffer_load_dwordx4 v[172:175], v242, s[8:11], s53 offen offset:1024 sc1
    s_waitcnt vmcnt(0)
    v_max3_u32 v192, v80, v81, v82
    v_max3_u32 v192, v192, v83, v84
    v_max3_u32 v192, v192, v85, v86
    v_max3_u32 v192, v192, v87, v88
    v_max3_u32 v192, v192, v89, v90
    v_max3_u32 v192, v192, v91, v92
    v_max3_u32 v192, v192, v93, v94
    v_max3_u32 v192, v192, v95, v96
    v_max3_u32 v192, v192, v97, v98
    v_max3_u32 v192, v192, v99, v100
    v_max3_u32 v192, v192, v101, v102
    v_max3_u32 v192, v192, v103, v104
    v_max3_u32 v192, v192, v105, v106
    v_max3_u32 v192, v192, v107, v108
    v_max3_u32 v192, v192, v109, v110
    v_max3_u32 v192, v192, v111, v112
    v_max3_u32 v192, v192, v113, v114
    v_max3_u32 v192, v192, v115, v116
    v_max3_u32 v192, v192, v117, v118
    v_max3_u32 v192, v192, v119, v120
    v_max3_u32 v192, v192, v121, v122
    v_max3_u32 v192, v192, v123, v124
    v_max3_u32 v192, v192, v125, v126
    v_max3_u32 v192, v192, v127, v128
    v_max3_u32 v192, v192, v129, v130
    v_max3_u32 v192, v192, v131, v132
    v_max3_u32 v192, v192, v133, v134
    v_max3_u32 v192, v192, v135, v136
    v_max3_u32 v192, v192, v137, v138
    v_max3_u32 v192, v192, v139, v140
    v_max3_u32 v192, v192, v141, v142
    v_max3_u32 v192, v192, v143, v144
    v_max3_u32 v192, v192, v145, v146
    v_max3_u32 v192, v192, v147, v148
    v_max3_u32 v192, v192, v149, v150
    v_max3_u32 v192, v192, v151, v152
    v_max3_u32 v192, v192, v153, v154
    v_max3_u32 v192, v192, v155, v156
    v_max3_u32 v192, v192, v157, v158
    v_max3_u32 v192, v192, v159, v160
    v_max3_u32 v192, v192, v161, v162
    v_max3_u32 v192, v192, v163, v164
    v_max3_u32 v192, v192, v165, v166
    v_max3_u32 v192, v192, v167, v168
    v_max3_u32 v192, v192, v169, v170
    v_max3_u32 v192, v192, v171, v172
    v_max3_u32 v192, v192, v173, v174
    v_max_u32 v192, v192, v175
    v_cmp_eq_u32 vcc, -1, v192
    s_add_u32 s61, s61, 1
    s_cbranch_vccz interleave_layers__linear_attn_block__memory_aug_recurrent_mem_tr__prompt_kernel_x_p1_out
    s_cmp_ge_u32 s61, s60
    s_cbranch_scc1 interleave_layers__linear_attn_block__memory_aug_recurrent_mem_tr__prompt_kernel_x_p1_to
    s_sleep 2
    s_branch interleave_layers__linear_attn_block__memory_aug_recurrent_mem_tr__prompt_kernel_x_p1
interleave_layers__linear_attn_block__memory_aug_recurrent_mem_tr__prompt_kernel_x_p1_to:
    s_mov_b32 s60, 1
interleave_layers__linear_attn_block__memory_aug_recurrent_mem_tr__prompt_kernel_x_p1_out:
    v_mfma_f32_16x16x32_bf16 v[176:179], v[16:19], v[80:83], 0
    v_mfma_f32_16x16x32_bf16 v[180:183], v[16:19], v[84:87], 0
    v_mfma_f32_16x16x32_bf16 v[184:187], v[48:51], v[80:83], 0
    v_mfma_f32_16x16x32_bf16 v[188:191], v[48:51], v[84:87], 0
    v_mfma_f32_16x16x32_bf16 v[176:179], v[20:23], v[88:91], v[176:179]
    v_mfma_f32_16x16x32_bf16 v[180:183], v[20:23], v[92:95], v[180:183]
    v_mfma_f32_16x16x32_bf16 v[184:187], v[52:55], v[88:91], v[184:187]
    v_mfma_f32_16x16x32_bf16 v[188:191], v[52:55], v[92:95], v[188:191]
    v_mfma_f32_16x16x32_bf16 v[176:179], v[24:27], v[96:99], v[176:179]
    v_mfma_f32_16x16x32_bf16 v[180:183], v[24:27], v[100:103], v[180:183]
    v_mfma_f32_16x16x32_bf16 v[184:187], v[56:59], v[96:99], v[184:187]
    v_mfma_f32_16x16x32_bf16 v[188:191], v[56:59], v[100:103], v[188:191]
    v_mfma_f32_16x16x32_bf16 v[176:179], v[28:31], v[104:107], v[176:179]
    v_mfma_f32_16x16x32_bf16 v[180:183], v[28:31], v[108:111], v[180:183]
    v_mfma_f32_16x16x32_bf16 v[184:187], v[60:63], v[104:107], v[184:187]
    v_mfma_f32_16x16x32_bf16 v[188:191], v[60:63], v[108:111], v[188:191]
    v_mfma_f32_16x16x32_bf16 v[176:179], v[32:35], v[112:115], v[176:179]
    v_mfma_f32_16x16x32_bf16 v[180:183], v[32:35], v[116:119], v[180:183]
    v_mfma_f32_16x16x32_bf16 v[184:187], v[64:67], v[112:115], v[184:187]
    v_mfma_f32_16x16x32_bf16 v[188:191], v[64:67], v[116:119], v[188:191]
    v_mfma_f32_16x16x32_bf16 v[176:179], v[36:39], v[120:123], v[176:179]
    v_mfma_f32_16x16x32_bf16 v[180:183], v[36:39], v[124:127], v[180:183]
    v_mfma_f32_16x16x32_bf16 v[184:187], v[68:71], v[120:123], v[184:187]
    v_mfma_f32_16x16x32_bf16 v[188:191], v[68:71], v[124:127], v[188:191]
    v_mfma_f32_16x16x32_bf16 v[176:179], v[40:43], v[128:131], v[176:179]
    v_mfma_f32_16x16x32_bf16 v[180:183], v[40:43], v[132:135], v[180:183]
    v_mfma_f32_16x16x32_bf16 v[184:187], v[72:75], v[128:131], v[184:187]
    v_mfma_f32_16x16x32_bf16 v[188:191], v[72:75], v[132:135], v[188:191]
    v_mfma_f32_16x16x32_bf16 v[176:179], v[44:47], v[136:139], v[176:179]
    v_mfma_f32_16x16x32_bf16 v[180:183], v[44:47], v[140:143], v[180:183]
    v_mfma_f32_16x16x32_bf16 v[184:187], v[76:79], v[136:139], v[184:187]
    v_mfma_f32_16x16x32_bf16 v[188:191], v[76:79], v[140:143], v[188:191]
    v_mfma_f32_16x16x32_bf16 v[176:179], v[160:163], v[144:147], v[176:179]
    v_mfma_f32_16x16x32_bf16 v[180:183], v[160:163], v[148:151], v[180:183]
    v_mfma_f32_16x16x32_bf16 v[184:187], v[168:171], v[144:147], v[184:187]
    v_mfma_f32_16x16x32_bf16 v[188:191], v[168:171], v[148:151], v[188:191]
    v_mfma_f32_16x16x32_bf16 v[176:179], v[164:167], v[152:155], v[176:179]
    v_mfma_f32_16x16x32_bf16 v[180:183], v[164:167], v[156:159], v[180:183]
    v_mfma_f32_16x16x32_bf16 v[184:187], v[172:175], v[152:155], v[184:187]
    v_mfma_f32_16x16x32_bf16 v[188:191], v[172:175], v[156:159], v[188:191]
    s_nop 4
    ds_write_b128 v217, v[176:179] offset:0
    ds_write_b128 v217, v[180:183] offset:1024
    ds_write_b128 v217, v[184:187] offset:2048
    ds_write_b128 v217, v[188:191] offset:3072
    s_waitcnt lgkmcnt(0)
    s_barrier
    s_cmp_ge_u32 s3, 2
    s_cbranch_scc1 interleave_layers__linear_attn_block__memory_aug_recurrent_mem_tr__prompt_kernel_xs41
    ds_read_b128 v[16:19], v218 offset:0
    ds_read_b128 v[20:23], v218 offset:4096
    ds_read_b128 v[24:27], v218 offset:8192
    ds_read_b128 v[28:31], v218 offset:12288
    ds_read_b128 v[32:35], v218 offset:2048
    ds_read_b128 v[36:39], v218 offset:6144
    ds_read_b128 v[40:43], v218 offset:10240
    ds_read_b128 v[44:47], v218 offset:14336
    s_waitcnt lgkmcnt(4)
    v_pk_add_f32 v[16:17], v[16:17], v[20:21]
    v_pk_add_f32 v[24:25], v[24:25], v[28:29]
    v_pk_add_f32 v[18:19], v[18:19], v[22:23]
    v_pk_add_f32 v[26:27], v[26:27], v[30:31]
    v_pk_add_f32 v[16:17], v[16:17], v[24:25]
    v_pk_add_f32 v[18:19], v[18:19], v[26:27]
    v_cvt_pk_bf16_f32 v20, v16, v17
    v_cvt_pk_bf16_f32 v21, v18, v19
    v_lshlrev_b32 v16, 16, v20
    v_and_b32 v17, 0xffff0000, v20
    v_lshlrev_b32 v22, 16, v196
    v_and_b32 v23, 0xffff0000, v196
    v_pk_add_f32 v[16:17], v[16:17], v[22:23]
    v_cvt_pk_bf16_f32 v48, v16, v17
    v_lshlrev_b32 v16, 16, v21
    v_and_b32 v17, 0xffff0000, v21
    v_lshlrev_b32 v22, 16, v197
    v_and_b32 v23, 0xffff0000, v197
    v_pk_add_f32 v[16:17], v[16:17], v[22:23]
    v_cvt_pk_bf16_f32 v49, v16, v17
    s_waitcnt lgkmcnt(0)
    v_pk_add_f32 v[32:33], v[32:33], v[36:37]
    v_pk_add_f32 v[40:41], v[40:41], v[44:45]
    v_pk_add_f32 v[34:35], v[34:35], v[38:39]
    v_pk_add_f32 v[42:43], v[42:43], v[46:47]
    v_pk_add_f32 v[32:33], v[32:33], v[40:41]
    v_pk_add_f32 v[34:35], v[34:35], v[42:43]
    v_cvt_pk_bf16_f32 v36, v32, v33
    v_cvt_pk_bf16_f32 v37, v34, v35
    v_lshlrev_b32 v32, 16, v36
    v_and_b32 v33, 0xffff0000, v36
    v_lshlrev_b32 v38, 16, v198
    v_and_b32 v39, 0xffff0000, v198
    v_pk_add_f32 v[32:33], v[32:33], v[38:39]
    v_cvt_pk_bf16_f32 v50, v32, v33
    v_lshlrev_b32 v32, 16, v37
    v_and_b32 v33, 0xffff0000, v37
    v_lshlrev_b32 v38, 16, v199
    v_and_b32 v39, 0xffff0000, v199
    v_pk_add_f32 v[32:33], v[32:33], v[38:39]
    v_cvt_pk_bf16_f32 v51, v32, v33
    s_cmp_eq_u32 s92, 0
    s_cbranch_scc0 interleave_layers__linear_attn_block__memory_aug_recurrent_mem_tr__prompt_kernel_xo42
    s_add_u32 s24, s68, 4194304
    buffer_store_dwordx4 v[48:51], v219, s[8:11], s24 offen sc1
    s_branch interleave_layers__linear_attn_block__memory_aug_recurrent_mem_tr__prompt_kernel_xs41
interleave_layers__linear_attn_block__memory_aug_recurrent_mem_tr__prompt_kernel_xo42:
    buffer_store_dwordx2 v[48:49], v243, s[12:15], s68 offen
    buffer_store_dwordx2 v[50:51], v243, s[12:15], s68 offen offset:32
interleave_layers__linear_attn_block__memory_aug_recurrent_mem_tr__prompt_kernel_xs41:
    s_lshr_b32 s25, s64, 2
    s_add_u32 s25, s25, 1
    s_cmp_eq_u32 s92, 0
    s_cselect_b32 s79, s25, -1
    s_cmp_lt_u32 s40, 64
    s_cbranch_scc1 interleave_layers__linear_attn_block__memory_aug_recurrent_mem_tr__prompt_kernel_xp43
    s_waitcnt vmcnt(0)
    s_barrier
    s_cmp_ge_i32 s79, 0
    s_cselect_b32 s24, 0, 2146435072
    v_or_b32 v246, s24, v245
    v_mov_b32 v247, s79
    buffer_store_dword v247, v246, s[8:11], 0 offen sc1
    s_mov_b32 s79, -1
interleave_layers__linear_attn_block__memory_aug_recurrent_mem_tr__prompt_kernel_xp43:
    s_add_u32 s64, s64, 4
    s_add_u32 s65, s65, 5242880
    s_add_u32 s66, s66, 4194304
    s_add_u32 s67, s67, 4194304
    s_add_u32 s68, s68, 163840
    s_branch interleave_layers__linear_attn_block__memory_aug_recurrent_mem_tr__prompt_kernel_p_next
interleave_layers__linear_attn_block__memory_aug_recurrent_mem_tr__prompt_kernel_p_done:
    s_cmp_eq_u32 s92, 0
    s_cbranch_scc0 interleave_layers__linear_attn_block__memory_aug_recurrent_mem_tr__prompt_kernel_end
    s_mov_b32 s92, 1
    s_branch interleave_layers__linear_attn_block__memory_aug_recurrent_mem_tr__prompt_kernel_p_layer
interleave_layers__linear_attn_block__memory_aug_recurrent_mem_tr__prompt_kernel_roleO:
    s_sub_u32 s44, s2, 200
    s_load_dwordx2 s[6:7], s[0:1], 64
    s_waitcnt lgkmcnt(0)
    s_mov_b32 s12, s6
    s_mov_b32 s13, s7
    s_mov_b32 s14, 7864320
    s_mov_b32 s15, 0x00020000
    v_add_u32 v8, 0, v0
    s_mov_b32 s24, 3277
    v_mul_lo_u32 v9, v8, s24
    v_lshrrev_b32 v9, 18, v9
    v_mul_u32_u24 v10, 80, v9
    v_sub_u32 v10, v8, v10
    v_mul_u32_u24 v16, 1312, v9
    v_lshl_add_u32 v16, v10, 4, v16
    v_add_u32 v8, 256, v0
    s_mov_b32 s24, 3277
    v_mul_lo_u32 v9, v8, s24
    v_lshrrev_b32 v9, 18, v9
    v_mul_u32_u24 v10, 80, v9
    v_sub_u32 v10, v8, v10
    v_mul_u32_u24 v17, 1312, v9
    v_lshl_add_u32 v17, v10, 4, v17
    v_add_u32 v8, 512, v0
    s_mov_b32 s24, 3277
    v_mul_lo_u32 v9, v8, s24
    v_lshrrev_b32 v9, 18, v9
    v_mul_u32_u24 v10, 80, v9
    v_sub_u32 v10, v8, v10
    v_mul_u32_u24 v18, 1312, v9
    v_lshl_add_u32 v18, v10, 4, v18
    v_add_u32 v8, 768, v0
    s_mov_b32 s24, 3277
    v_mul_lo_u32 v9, v8, s24
    v_lshrrev_b32 v9, 18, v9
    v_mul_u32_u24 v10, 80, v9
    v_sub_u32 v10, v8, v10
    v_mul_u32_u24 v19, 1312, v9
    v_lshl_add_u32 v19, v10, 4, v19
    v_add_u32 v8, 1024, v0
    s_mov_b32 s24, 3277
    v_mul_lo_u32 v9, v8, s24
    v_lshrrev_b32 v9, 18, v9
    v_mul_u32_u24 v10, 80, v9
    v_sub_u32 v10, v8, v10
    v_mul_u32_u24 v20, 1312, v9
    v_lshl_add_u32 v20, v10, 4, v20
    v_add_u32 v8, 1280, v0
    s_mov_b32 s24, 3277
    v_mul_lo_u32 v9, v8, s24
    v_lshrrev_b32 v9, 18, v9
    v_mul_u32_u24 v10, 80, v9
    v_sub_u32 v10, v8, v10
    v_mul_u32_u24 v21, 1312, v9
    v_lshl_add_u32 v21, v10, 4, v21
    v_add_u32 v8, 1536, v0
    s_mov_b32 s24, 3277
    v_mul_lo_u32 v9, v8, s24
    v_lshrrev_b32 v9, 18, v9
    v_mul_u32_u24 v10, 80, v9
    v_sub_u32 v10, v8, v10
    v_mul_u32_u24 v22, 1312, v9
    v_lshl_add_u32 v22, v10, 4, v22
    v_add_u32 v8, 1792, v0
    s_mov_b32 s24, 3277
    v_mul_lo_u32 v9, v8, s24
    v_lshrrev_b32 v9, 18, v9
    v_mul_u32_u24 v10, 80, v9
    v_sub_u32 v10, v8, v10
    v_mul_u32_u24 v23, 1312, v9
    v_lshl_add_u32 v23, v10, 4, v23
    v_add_u32 v8, 2048, v0
    s_mov_b32 s24, 3277
    v_mul_lo_u32 v9, v8, s24
    v_lshrrev_b32 v9, 18, v9
    v_mul_u32_u24 v10, 80, v9
    v_sub_u32 v10, v8, v10
    v_mul_u32_u24 v24, 1312, v9
    v_lshl_add_u32 v24, v10, 4, v24
    v_add_u32 v8, 2304, v0
    s_mov_b32 s24, 3277
    v_mul_lo_u32 v9, v8, s24
    v_lshrrev_b32 v9, 18, v9
    v_mul_u32_u24 v10, 80, v9
    v_sub_u32 v10, v8, v10
    v_mul_u32_u24 v25, 1312, v9
    v_lshl_add_u32 v25, v10, 4, v25
    v_add_u32 v8, 2560, v0
    s_mov_b32 s24, 3277
    v_mul_lo_u32 v9, v8, s24
    v_lshrrev_b32 v9, 18, v9
    v_mul_u32_u24 v10, 80, v9
    v_sub_u32 v10, v8, v10
    v_mul_u32_u24 v26, 1312, v9
    v_lshl_add_u32 v26, v10, 4, v26
    v_add_u32 v8, 2816, v0
    s_mov_b32 s24, 3277
    v_mul_lo_u32 v9, v8, s24
    v_lshrrev_b32 v9, 18, v9
    v_mul_u32_u24 v10, 80, v9
    v_sub_u32 v10, v8, v10
    v_mul_u32_u24 v27, 1312, v9
    v_lshl_add_u32 v27, v10, 4, v27
    v_add_u32 v8, 3072, v0
    s_mov_b32 s24, 3277
    v_mul_lo_u32 v9, v8, s24
    v_lshrrev_b32 v9, 18, v9
    v_mul_u32_u24 v10, 80, v9
    v_sub_u32 v10, v8, v10
    v_mul_u32_u24 v28, 1312, v9
    v_lshl_add_u32 v28, v10, 4, v28
    v_add_u32 v8, 3328, v0
    s_mov_b32 s24, 3277
    v_mul_lo_u32 v9, v8, s24
    v_lshrrev_b32 v9, 18, v9
    v_mul_u32_u24 v10, 80, v9
    v_sub_u32 v10, v8, v10
    v_mul_u32_u24 v29, 1312, v9
    v_lshl_add_u32 v29, v10, 4, v29
    v_add_u32 v8, 3584, v0
    s_mov_b32 s24, 3277
    v_mul_lo_u32 v9, v8, s24
    v_lshrrev_b32 v9, 18, v9
    v_mul_u32_u24 v10, 80, v9
    v_sub_u32 v10, v8, v10
    v_mul_u32_u24 v30, 1312, v9
    v_lshl_add_u32 v30, v10, 4, v30
    v_add_u32 v8, 3840, v0
    s_mov_b32 s24, 3277
    v_mul_lo_u32 v9, v8, s24
    v_lshrrev_b32 v9, 18, v9
    v_mul_u32_u24 v10, 80, v9
    v_sub_u32 v10, v8, v10
    v_mul_u32_u24 v31, 1312, v9
    v_lshl_add_u32 v31, v10, 4, v31
    v_add_u32 v8, 4096, v0
    s_mov_b32 s24, 3277
    v_mul_lo_u32 v9, v8, s24
    v_lshrrev_b32 v9, 18, v9
    v_mul_u32_u24 v10, 80, v9
    v_sub_u32 v10, v8, v10
    v_mul_u32_u24 v32, 1312, v9
    v_lshl_add_u32 v32, v10, 4, v32
    v_add_u32 v8, 4352, v0
    s_mov_b32 s24, 3277
    v_mul_lo_u32 v9, v8, s24
    v_lshrrev_b32 v9, 18, v9
    v_mul_u32_u24 v10, 80, v9
    v_sub_u32 v10, v8, v10
    v_mul_u32_u24 v33, 1312, v9
    v_lshl_add_u32 v33, v10, 4, v33
    v_add_u32 v8, 4608, v0
    s_mov_b32 s24, 3277
    v_mul_lo_u32 v9, v8, s24
    v_lshrrev_b32 v9, 18, v9
    v_mul_u32_u24 v10, 80, v9
    v_sub_u32 v10, v8, v10
    v_mul_u32_u24 v34, 1312, v9
    v_lshl_add_u32 v34, v10, 4, v34
    v_add_u32 v8, 4864, v0
    s_mov_b32 s24, 3277
    v_mul_lo_u32 v9, v8, s24
    v_lshrrev_b32 v9, 18, v9
    v_mul_u32_u24 v10, 80, v9
    v_sub_u32 v10, v8, v10
    v_mul_u32_u24 v35, 1312, v9
    v_lshl_add_u32 v35, v10, 4, v35
    v_add_u32 v8, 5120, v0
    s_mov_b32 s24, 3277
    v_mul_lo_u32 v9, v8, s24
    v_lshrrev_b32 v9, 18, v9
    v_mul_u32_u24 v10, 80, v9
    v_sub_u32 v10, v8, v10
    v_mul_u32_u24 v36, 1312, v9
    v_lshl_add_u32 v36, v10, 4, v36
    v_add_u32 v8, 5376, v0
    s_mov_b32 s24, 3277
    v_mul_lo_u32 v9, v8, s24
    v_lshrrev_b32 v9, 18, v9
    v_mul_u32_u24 v10, 80, v9
    v_sub_u32 v10, v8, v10
    v_mul_u32_u24 v37, 1312, v9
    v_lshl_add_u32 v37, v10, 4, v37
    v_add_u32 v8, 5632, v0
    s_mov_b32 s24, 3277
    v_mul_lo_u32 v9, v8, s24
    v_lshrrev_b32 v9, 18, v9
    v_mul_u32_u24 v10, 80, v9
    v_sub_u32 v10, v8, v10
    v_mul_u32_u24 v38, 1312, v9
    v_lshl_add_u32 v38, v10, 4, v38
    v_add_u32 v8, 5888, v0
    s_mov_b32 s24, 3277
    v_mul_lo_u32 v9, v8, s24
    v_lshrrev_b32 v9, 18, v9
    v_mul_u32_u24 v10, 80, v9
    v_sub_u32 v10, v8, v10
    v_mul_u32_u24 v39, 1312, v9
    v_lshl_add_u32 v39, v10, 4, v39
    v_add_u32 v8, 6144, v0
    s_mov_b32 s24, 3277
    v_mul_lo_u32 v9, v8, s24
    v_lshrrev_b32 v9, 18, v9
    v_mul_u32_u24 v10, 80, v9
    v_sub_u32 v10, v8, v10
    v_mul_u32_u24 v40, 1312, v9
    v_lshl_add_u32 v40, v10, 4, v40
    v_add_u32 v8, 6400, v0
    s_mov_b32 s24, 3277
    v_mul_lo_u32 v9, v8, s24
    v_lshrrev_b32 v9, 18, v9
    v_mul_u32_u24 v10, 80, v9
    v_sub_u32 v10, v8, v10
    v_mul_u32_u24 v41, 1312, v9
    v_lshl_add_u32 v41, v10, 4, v41
    v_add_u32 v8, 6656, v0
    s_mov_b32 s24, 3277
    v_mul_lo_u32 v9, v8, s24
    v_lshrrev_b32 v9, 18, v9
    v_mul_u32_u24 v10, 80, v9
    v_sub_u32 v10, v8, v10
    v_mul_u32_u24 v42, 1312, v9
    v_lshl_add_u32 v42, v10, 4, v42
    v_add_u32 v8, 6912, v0
    s_mov_b32 s24, 3277
    v_mul_lo_u32 v9, v8, s24
    v_lshrrev_b32 v9, 18, v9
    v_mul_u32_u24 v10, 80, v9
    v_sub_u32 v10, v8, v10
    v_mul_u32_u24 v43, 1312, v9
    v_lshl_add_u32 v43, v10, 4, v43
    v_add_u32 v8, 7168, v0
    s_mov_b32 s24, 3277
    v_mul_lo_u32 v9, v8, s24
    v_lshrrev_b32 v9, 18, v9
    v_mul_u32_u24 v10, 80, v9
    v_sub_u32 v10, v8, v10
    v_mul_u32_u24 v44, 1312, v9
    v_lshl_add_u32 v44, v10, 4, v44
    v_add_u32 v8, 7424, v0
    s_mov_b32 s24, 3277
    v_mul_lo_u32 v9, v8, s24
    v_lshrrev_b32 v9, 18, v9
    v_mul_u32_u24 v10, 80, v9
    v_sub_u32 v10, v8, v10
    v_mul_u32_u24 v45, 1312, v9
    v_lshl_add_u32 v45, v10, 4, v45
    v_lshlrev_b32 v4, 4, v0
    s_mul_i32 s45, s44, 245760
    s_add_u32 s46, s45, 0
    buffer_load_dwordx4 v[48:51], v4, s[12:15], s46 offen
    s_add_u32 s46, s45, 4096
    buffer_load_dwordx4 v[52:55], v4, s[12:15], s46 offen
    s_add_u32 s46, s45, 8192
    buffer_load_dwordx4 v[56:59], v4, s[12:15], s46 offen
    s_add_u32 s46, s45, 12288
    buffer_load_dwordx4 v[60:63], v4, s[12:15], s46 offen
    s_add_u32 s46, s45, 16384
    buffer_load_dwordx4 v[64:67], v4, s[12:15], s46 offen
    s_add_u32 s46, s45, 20480
    buffer_load_dwordx4 v[68:71], v4, s[12:15], s46 offen
    s_add_u32 s46, s45, 24576
    buffer_load_dwordx4 v[72:75], v4, s[12:15], s46 offen
    s_add_u32 s46, s45, 28672
    buffer_load_dwordx4 v[76:79], v4, s[12:15], s46 offen
    s_add_u32 s46, s45, 32768
    buffer_load_dwordx4 v[80:83], v4, s[12:15], s46 offen
    s_add_u32 s46, s45, 36864
    buffer_load_dwordx4 v[84:87], v4, s[12:15], s46 offen
    s_add_u32 s46, s45, 40960
    buffer_load_dwordx4 v[88:91], v4, s[12:15], s46 offen
    s_add_u32 s46, s45, 45056
    buffer_load_dwordx4 v[92:95], v4, s[12:15], s46 offen
    s_add_u32 s46, s45, 49152
    buffer_load_dwordx4 v[96:99], v4, s[12:15], s46 offen
    s_add_u32 s46, s45, 53248
    buffer_load_dwordx4 v[100:103], v4, s[12:15], s46 offen
    s_add_u32 s46, s45, 57344
    buffer_load_dwordx4 v[104:107], v4, s[12:15], s46 offen
    s_add_u32 s46, s45, 61440
    buffer_load_dwordx4 v[108:111], v4, s[12:15], s46 offen
    s_add_u32 s46, s45, 65536
    buffer_load_dwordx4 v[112:115], v4, s[12:15], s46 offen
    s_add_u32 s46, s45, 69632
    buffer_load_dwordx4 v[116:119], v4, s[12:15], s46 offen
    s_add_u32 s46, s45, 73728
    buffer_load_dwordx4 v[120:123], v4, s[12:15], s46 offen
    s_add_u32 s46, s45, 77824
    buffer_load_dwordx4 v[124:127], v4, s[12:15], s46 offen
    s_add_u32 s46, s45, 81920
    buffer_load_dwordx4 v[128:131], v4, s[12:15], s46 offen
    s_add_u32 s46, s45, 86016
    buffer_load_dwordx4 v[132:135], v4, s[12:15], s46 offen
    s_add_u32 s46, s45, 90112
    buffer_load_dwordx4 v[136:139], v4, s[12:15], s46 offen
    s_add_u32 s46, s45, 94208
    buffer_load_dwordx4 v[140:143], v4, s[12:15], s46 offen
    s_add_u32 s46, s45, 98304
    buffer_load_dwordx4 v[144:147], v4, s[12:15], s46 offen
    s_add_u32 s46, s45, 102400
    buffer_load_dwordx4 v[148:151], v4, s[12:15], s46 offen
    s_add_u32 s46, s45, 106496
    buffer_load_dwordx4 v[152:155], v4, s[12:15], s46 offen
    s_add_u32 s46, s45, 110592
    buffer_load_dwordx4 v[156:159], v4, s[12:15], s46 offen
    s_add_u32 s46, s45, 114688
    buffer_load_dwordx4 v[160:163], v4, s[12:15], s46 offen
    s_add_u32 s46, s45, 118784
    buffer_load_dwordx4 v[164:167], v4, s[12:15], s46 offen
    s_add_u32 s46, s45, 122880
    buffer_load_dwordx4 v[168:171], v4, s[12:15], s46 offen
    s_add_u32 s46, s45, 126976
    buffer_load_dwordx4 v[172:175], v4, s[12:15], s46 offen
    s_add_u32 s46, s45, 131072
    buffer_load_dwordx4 v[176:179], v4, s[12:15], s46 offen
    s_add_u32 s46, s45, 135168
    buffer_load_dwordx4 v[180:183], v4, s[12:15], s46 offen
    s_add_u32 s46, s45, 139264
    buffer_load_dwordx4 v[184:187], v4, s[12:15], s46 offen
    s_add_u32 s46, s45, 143360
    buffer_load_dwordx4 v[188:191], v4, s[12:15], s46 offen
    s_add_u32 s46, s45, 147456
    buffer_load_dwordx4 v[192:195], v4, s[12:15], s46 offen
    s_add_u32 s46, s45, 151552
    buffer_load_dwordx4 v[196:199], v4, s[12:15], s46 offen
    s_add_u32 s46, s45, 155648
    buffer_load_dwordx4 v[200:203], v4, s[12:15], s46 offen
    s_add_u32 s46, s45, 159744
    buffer_load_dwordx4 v[204:207], v4, s[12:15], s46 offen
    s_add_u32 s46, s45, 163840
    buffer_load_dwordx4 v[208:211], v4, s[12:15], s46 offen
    s_add_u32 s46, s45, 167936
    buffer_load_dwordx4 v[212:215], v4, s[12:15], s46 offen
    s_add_u32 s46, s45, 172032
    buffer_load_dwordx4 v[216:219], v4, s[12:15], s46 offen
    s_add_u32 s46, s45, 176128
    buffer_load_dwordx4 v[220:223], v4, s[12:15], s46 offen
    s_add_u32 s46, s45, 180224
    buffer_load_dwordx4 v[224:227], v4, s[12:15], s46 offen
    s_add_u32 s46, s45, 184320
    buffer_load_dwordx4 v[228:231], v4, s[12:15], s46 offen
    s_add_u32 s46, s45, 188416
    buffer_load_dwordx4 v[232:235], v4, s[12:15], s46 offen
    s_add_u32 s46, s45, 192512
    buffer_load_dwordx4 v[236:239], v4, s[12:15], s46 offen
    s_add_u32 s46, s45, 196608
    buffer_load_dwordx4 v[240:243], v4, s[12:15], s46 offen
    s_add_u32 s46, s45, 200704
    buffer_load_dwordx4 v[244:247], v4, s[12:15], s46 offen
    s_add_u32 s46, s45, 204800
    buffer_load_dwordx4 v[248:251], v4, s[12:15], s46 offen
    s_add_u32 s46, s45, 208896
    buffer_load_dwordx4 v[252:255], v4, s[12:15], s46 offen
    v_lshrrev_b32 v8, 2, v2
    v_lshl_add_u32 v8, v3, 2, v8
    v_mul_u32_u24 v5, 1312, v8
    v_and_b32 v8, 3, v2
    v_lshl_add_u32 v5, v8, 3, v5
    s_mul_i32 s24, s3, 320
    v_add_u32 v5, s24, v5
    v_add_u32 v6, 62976, v5
    s_waitcnt vmcnt(22)
    ds_write_b128 v16, v[48:51]
    ds_write_b128 v17, v[52:55]
    ds_write_b128 v18, v[56:59]
    ds_write_b128 v19, v[60:63]
    ds_write_b128 v20, v[64:67]
    ds_write_b128 v21, v[68:71]
    ds_write_b128 v22, v[72:75]
    ds_write_b128 v23, v[76:79]
    ds_write_b128 v24, v[80:83]
    ds_write_b128 v25, v[84:87]
    ds_write_b128 v26, v[88:91]
    ds_write_b128 v27, v[92:95]
    ds_write_b128 v28, v[96:99]
    ds_write_b128 v29, v[100:103]
    ds_write_b128 v30, v[104:107]
    ds_write_b128 v31, v[108:111]
    ds_write_b128 v32, v[112:115]
    ds_write_b128 v33, v[116:119]
    ds_write_b128 v34, v[120:123]
    ds_write_b128 v35, v[124:127]
    ds_write_b128 v36, v[128:131]
    ds_write_b128 v37, v[132:135]
    ds_write_b128 v38, v[136:139]
    ds_write_b128 v39, v[140:143]
    ds_write_b128 v40, v[144:147]
    ds_write_b128 v41, v[148:151]
    ds_write_b128 v42, v[152:155]
    ds_write_b128 v43, v[156:159]
    ds_write_b128 v44, v[160:163]
    ds_write_b128 v45, v[164:167]
    s_waitcnt lgkmcnt(0)
    s_add_u32 s46, s45, 212992
    buffer_load_dwordx4 v[48:51], v4, s[12:15], s46 offen
    s_add_u32 s46, s45, 217088
    buffer_load_dwordx4 v[52:55], v4, s[12:15], s46 offen
    s_add_u32 s46, s45, 221184
    buffer_load_dwordx4 v[56:59], v4, s[12:15], s46 offen
    s_add_u32 s46, s45, 225280
    buffer_load_dwordx4 v[60:63], v4, s[12:15], s46 offen
    s_add_u32 s46, s45, 229376
    buffer_load_dwordx4 v[64:67], v4, s[12:15], s46 offen
    s_add_u32 s46, s45, 233472
    buffer_load_dwordx4 v[68:71], v4, s[12:15], s46 offen
    s_add_u32 s46, s45, 237568
    buffer_load_dwordx4 v[72:75], v4, s[12:15], s46 offen
    s_add_u32 s46, s45, 241664
    buffer_load_dwordx4 v[76:79], v4, s[12:15], s46 offen
    s_barrier
    ds_read_b64_tr_b16 a[0:1], v5 offset:0
    ds_read_b64_tr_b16 a[2:3], v5 offset:20992
    ds_read_b64_tr_b16 a[4:5], v6 offset:0
    ds_read_b64_tr_b16 a[6:7], v6 offset:20992
    ds_read_b64_tr_b16 a[16:17], v5 offset:41984
    ds_read_b64_tr_b16 a[18:19], v6 offset:41984
    ds_read_b64_tr_b16 a[24:25], v5 offset:32
    ds_read_b64_tr_b16 a[26:27], v5 offset:21024
    ds_read_b64_tr_b16 a[28:29], v6 offset:32
    ds_read_b64_tr_b16 a[30:31], v6 offset:21024
    ds_read_b64_tr_b16 a[40:41], v5 offset:42016
    ds_read_b64_tr_b16 a[42:43], v6 offset:42016
    ds_read_b64_tr_b16 a[48:49], v5 offset:64
    ds_read_b64_tr_b16 a[50:51], v5 offset:21056
    ds_read_b64_tr_b16 a[52:53], v6 offset:64
    ds_read_b64_tr_b16 a[54:55], v6 offset:21056
    ds_read_b64_tr_b16 a[64:65], v5 offset:42048
    ds_read_b64_tr_b16 a[66:67], v6 offset:42048
    ds_read_b64_tr_b16 a[72:73], v5 offset:96
    ds_read_b64_tr_b16 a[74:75], v5 offset:21088
    ds_read_b64_tr_b16 a[76:77], v6 offset:96
    ds_read_b64_tr_b16 a[78:79], v6 offset:21088
    ds_read_b64_tr_b16 a[88:89], v5 offset:42080
    ds_read_b64_tr_b16 a[90:91], v6 offset:42080
    ds_read_b64_tr_b16 a[96:97], v5 offset:128
    ds_read_b64_tr_b16 a[98:99], v5 offset:21120
    ds_read_b64_tr_b16 a[100:101], v6 offset:128
    ds_read_b64_tr_b16 a[102:103], v6 offset:21120
    ds_read_b64_tr_b16 a[112:113], v5 offset:42112
    ds_read_b64_tr_b16 a[114:115], v6 offset:42112
    ds_read_b64_tr_b16 a[120:121], v5 offset:160
    ds_read_b64_tr_b16 a[122:123], v5 offset:21152
    ds_read_b64_tr_b16 a[124:125], v6 offset:160
    ds_read_b64_tr_b16 a[126:127], v6 offset:21152
    ds_read_b64_tr_b16 a[136:137], v5 offset:42144
    ds_read_b64_tr_b16 a[138:139], v6 offset:42144
    ds_read_b64_tr_b16 a[144:145], v5 offset:192
    ds_read_b64_tr_b16 a[146:147], v5 offset:21184
    ds_read_b64_tr_b16 a[148:149], v6 offset:192
    ds_read_b64_tr_b16 a[150:151], v6 offset:21184
    ds_read_b64_tr_b16 a[160:161], v5 offset:42176
    ds_read_b64_tr_b16 a[162:163], v6 offset:42176
    ds_read_b64_tr_b16 a[168:169], v5 offset:224
    ds_read_b64_tr_b16 a[170:171], v5 offset:21216
    ds_read_b64_tr_b16 a[172:173], v6 offset:224
    ds_read_b64_tr_b16 a[174:175], v6 offset:21216
    ds_read_b64_tr_b16 a[184:185], v5 offset:42208
    ds_read_b64_tr_b16 a[186:187], v6 offset:42208
    ds_read_b64_tr_b16 a[192:193], v5 offset:256
    ds_read_b64_tr_b16 a[194:195], v5 offset:21248
    ds_read_b64_tr_b16 a[196:197], v6 offset:256
    ds_read_b64_tr_b16 a[198:199], v6 offset:21248
    ds_read_b64_tr_b16 a[208:209], v5 offset:42240
    ds_read_b64_tr_b16 a[210:211], v6 offset:42240
    ds_read_b64_tr_b16 a[216:217], v5 offset:288
    ds_read_b64_tr_b16 a[218:219], v5 offset:21280
    ds_read_b64_tr_b16 a[220:221], v6 offset:288
    ds_read_b64_tr_b16 a[222:223], v6 offset:21280
    ds_read_b64_tr_b16 a[232:233], v5 offset:42272
    ds_read_b64_tr_b16 a[234:235], v6 offset:42272
    s_waitcnt lgkmcnt(0)
    s_barrier
    s_waitcnt vmcnt(0)
    ds_write_b128 v16, v[168:171]
    ds_write_b128 v17, v[172:175]
    ds_write_b128 v18, v[176:179]
    ds_write_b128 v19, v[180:183]
    ds_write_b128 v20, v[184:187]
    ds_write_b128 v21, v[188:191]
    ds_write_b128 v22, v[192:195]
    ds_write_b128 v23, v[196:199]
    ds_write_b128 v24, v[200:203]
    ds_write_b128 v25, v[204:207]
    ds_write_b128 v26, v[208:211]
    ds_write_b128 v27, v[212:215]
    ds_write_b128 v28, v[216:219]
    ds_write_b128 v29, v[220:223]
    ds_write_b128 v30, v[224:227]
    ds_write_b128 v31, v[228:231]
    ds_write_b128 v32, v[232:235]
    ds_write_b128 v33, v[236:239]
    ds_write_b128 v34, v[240:243]
    ds_write_b128 v35, v[244:247]
    ds_write_b128 v36, v[248:251]
    ds_write_b128 v37, v[252:255]
    ds_write_b128 v38, v[48:51]
    ds_write_b128 v39, v[52:55]
    ds_write_b128 v40, v[56:59]
    ds_write_b128 v41, v[60:63]
    ds_write_b128 v42, v[64:67]
    ds_write_b128 v43, v[68:71]
    ds_write_b128 v44, v[72:75]
    ds_write_b128 v45, v[76:79]
    s_waitcnt lgkmcnt(0)
    s_barrier
    ds_read_b64_tr_b16 a[8:9], v5 offset:0
    ds_read_b64_tr_b16 a[10:11], v5 offset:20992
    ds_read_b64_tr_b16 a[12:13], v6 offset:0
    ds_read_b64_tr_b16 a[14:15], v6 offset:20992
    ds_read_b64_tr_b16 a[20:21], v5 offset:41984
    ds_read_b64_tr_b16 a[22:23], v6 offset:41984
    ds_read_b64_tr_b16 a[32:33], v5 offset:32
    ds_read_b64_tr_b16 a[34:35], v5 offset:21024
    ds_read_b64_tr_b16 a[36:37], v6 offset:32
    ds_read_b64_tr_b16 a[38:39], v6 offset:21024
    ds_read_b64_tr_b16 a[44:45], v5 offset:42016
    ds_read_b64_tr_b16 a[46:47], v6 offset:42016
    ds_read_b64_tr_b16 a[56:57], v5 offset:64
    ds_read_b64_tr_b16 a[58:59], v5 offset:21056
    ds_read_b64_tr_b16 a[60:61], v6 offset:64
    ds_read_b64_tr_b16 a[62:63], v6 offset:21056
    ds_read_b64_tr_b16 a[68:69], v5 offset:42048
    ds_read_b64_tr_b16 a[70:71], v6 offset:42048
    ds_read_b64_tr_b16 a[80:81], v5 offset:96
    ds_read_b64_tr_b16 a[82:83], v5 offset:21088
    ds_read_b64_tr_b16 a[84:85], v6 offset:96
    ds_read_b64_tr_b16 a[86:87], v6 offset:21088
    ds_read_b64_tr_b16 a[92:93], v5 offset:42080
    ds_read_b64_tr_b16 a[94:95], v6 offset:42080
    ds_read_b64_tr_b16 a[104:105], v5 offset:128
    ds_read_b64_tr_b16 a[106:107], v5 offset:21120
    ds_read_b64_tr_b16 a[108:109], v6 offset:128
    ds_read_b64_tr_b16 a[110:111], v6 offset:21120
    ds_read_b64_tr_b16 a[116:117], v5 offset:42112
    ds_read_b64_tr_b16 a[118:119], v6 offset:42112
    ds_read_b64_tr_b16 a[128:129], v5 offset:160
    ds_read_b64_tr_b16 a[130:131], v5 offset:21152
    ds_read_b64_tr_b16 a[132:133], v6 offset:160
    ds_read_b64_tr_b16 a[134:135], v6 offset:21152
    ds_read_b64_tr_b16 a[140:141], v5 offset:42144
    ds_read_b64_tr_b16 a[142:143], v6 offset:42144
    ds_read_b64_tr_b16 a[152:153], v5 offset:192
    ds_read_b64_tr_b16 a[154:155], v5 offset:21184
    ds_read_b64_tr_b16 a[156:157], v6 offset:192
    ds_read_b64_tr_b16 a[158:159], v6 offset:21184
    ds_read_b64_tr_b16 a[164:165], v5 offset:42176
    ds_read_b64_tr_b16 a[166:167], v6 offset:42176
    ds_read_b64_tr_b16 a[176:177], v5 offset:224
    ds_read_b64_tr_b16 a[178:179], v5 offset:21216
    ds_read_b64_tr_b16 a[180:181], v6 offset:224
    ds_read_b64_tr_b16 a[182:183], v6 offset:21216
    ds_read_b64_tr_b16 a[188:189], v5 offset:42208
    ds_read_b64_tr_b16 a[190:191], v6 offset:42208
    ds_read_b64_tr_b16 a[200:201], v5 offset:256
    ds_read_b64_tr_b16 a[202:203], v5 offset:21248
    ds_read_b64_tr_b16 a[204:205], v6 offset:256
    ds_read_b64_tr_b16 a[206:207], v6 offset:21248
    ds_read_b64_tr_b16 a[212:213], v5 offset:42240
    ds_read_b64_tr_b16 a[214:215], v6 offset:42240
    ds_read_b64_tr_b16 a[224:225], v5 offset:288
    ds_read_b64_tr_b16 a[226:227], v5 offset:21280
    ds_read_b64_tr_b16 a[228:229], v6 offset:288
    ds_read_b64_tr_b16 a[230:231], v6 offset:21280
    ds_read_b64_tr_b16 a[236:237], v5 offset:42272
    ds_read_b64_tr_b16 a[238:239], v6 offset:42272
    s_waitcnt lgkmcnt(0)
    s_barrier
    v_lshlrev_b32 v5, 4, v1
    s_mul_i32 s24, s44, 12288
    v_add_u32 v6, s24, v5
    v_add_u32 v7, 4096, v6
    v_add_u32 v8, 8192, v6
    s_mul_i32 s24, s3, 327680
    s_lshl_b32 s25, s44, 10
    s_add_u32 s24, s24, s25
    v_add_u32 v9, s24, v5
interleave_layers__linear_attn_block__memory_aug_recurrent_mem_tr__prompt_kernel_o_layer:
    s_mov_b32 s93, 0
    s_lshl_b32 s24, s93, 12
    s_and_b32 s24, s24, 0x2000
    s_xor_b32 s24, s24, s36
    s_lshl_b32 s93, s93, 20
    s_add_u32 s93, s93, s24
    s_add_u32 s93, s93, 117440512
    s_mul_i32 s94, s92, 16384
    s_add_u32 s94, s94, 23068672
    s_mov_b32 s24, 12288
    s_lshl_b32 s25, s44, 7
    s_add_u32 s24, s24, s25
    s_add_u32 s24, s24, s94
    v_mov_b32 v14, s24
    v_mov_b32 v15, 2146435072
    v_cmp_eq_u32 vcc, 0, v1
    s_nop 1
    v_cndmask_b32 v14, v15, v14, vcc
    s_lshl_b32 s24, s44, 7
    s_add_u32 s24, s24, 8192
    s_add_u32 s24, s24, s94
    v_mov_b32 v10, s24
    s_mov_b32 s41, 33554432
    s_mov_b32 s43, 184549376
    s_mov_b32 s40, 0
    s_mov_b32 s62, -1
    s_mov_b32 s63, 1
    s_cmp_ge_i32 s62, s63
    s_cbranch_scc1 interleave_layers__linear_attn_block__memory_aug_recurrent_mem_tr__prompt_kernel_o_en0_ok
    s_mov_b32 s61, 0
interleave_layers__linear_attn_block__memory_aug_recurrent_mem_tr__prompt_kernel_o_en0:
    buffer_load_dword v11, v10, s[8:11], 0 offen sc1
    s_waitcnt vmcnt(0)
    v_readlane_b32 s62, v11, 0
    s_cmp_ge_i32 s62, s63
    s_cbranch_scc1 interleave_layers__linear_attn_block__memory_aug_recurrent_mem_tr__prompt_kernel_o_en0_ok
    s_add_u32 s61, s61, 1
    s_cmp_ge_u32 s61, s60
    s_cbranch_scc1 interleave_layers__linear_attn_block__memory_aug_recurrent_mem_tr__prompt_kernel_o_en0_to
    s_sleep 2
    s_branch interleave_layers__linear_attn_block__memory_aug_recurrent_mem_tr__prompt_kernel_o_en0
interleave_layers__linear_attn_block__memory_aug_recurrent_mem_tr__prompt_kernel_o_en0_to:
    s_mov_b32 s60, 1
interleave_layers__linear_attn_block__memory_aug_recurrent_mem_tr__prompt_kernel_o_en0_ok:
    buffer_load_dwordx4 v[16:19], v6, s[8:11], s41 offen offset:0 sc1
    buffer_load_dwordx4 v[20:23], v6, s[8:11], s41 offen offset:1024 sc1
    buffer_load_dwordx4 v[24:27], v6, s[8:11], s41 offen offset:2048 sc1
    buffer_load_dwordx4 v[28:31], v6, s[8:11], s41 offen offset:3072 sc1
    buffer_load_dwordx4 v[32:35], v7, s[8:11], s41 offen offset:0 sc1
    buffer_load_dwordx4 v[36:39], v7, s[8:11], s41 offen offset:1024 sc1
    buffer_load_dwordx4 v[40:43], v7, s[8:11], s41 offen offset:2048 sc1
    buffer_load_dwordx4 v[44:47], v7, s[8:11], s41 offen offset:3072 sc1
    buffer_load_dwordx4 v[48:51], v8, s[8:11], s41 offen offset:0 sc1
    buffer_load_dwordx4 v[52:55], v8, s[8:11], s41 offen offset:1024 sc1
    buffer_load_dwordx4 v[56:59], v8, s[8:11], s41 offen offset:2048 sc1
    buffer_load_dwordx4 v[60:63], v8, s[8:11], s41 offen offset:3072 sc1
    s_add_u32 s41, s41, 393216
    s_waitcnt vmcnt(0)
interleave_layers__linear_attn_block__memory_aug_recurrent_mem_tr__prompt_kernel_o_seg:
    v_swap_b32 v26, v36
    v_swap_b32 v27, v37
    v_swap_b32 v50, v60
    v_swap_b32 v51, v61
    buffer_load_dword v232, v10, s[8:11], 0 offen sc1
    v_mfma_f32_16x16x32_bf16 v[112:115], v[16:19], a[0:3], 0
    v_mfma_f32_16x16x32_bf16 v[116:119], v[20:23], a[0:3], 0
    v_mfma_f32_16x16x32_bf16 v[120:123], v[16:19], a[24:27], 0
    v_mfma_f32_16x16x32_bf16 v[124:127], v[20:23], a[24:27], 0
    v_mfma_f32_16x16x32_bf16 v[128:131], v[16:19], a[48:51], 0
    v_mfma_f32_16x16x32_bf16 v[132:135], v[20:23], a[48:51], 0
    v_mfma_f32_16x16x32_bf16 v[136:139], v[16:19], a[72:75], 0
    v_mfma_f32_16x16x32_bf16 v[140:143], v[20:23], a[72:75], 0
    v_mfma_f32_16x16x32_bf16 v[144:147], v[16:19], a[96:99], 0
    v_mfma_f32_16x16x32_bf16 v[148:151], v[20:23], a[96:99], 0
    v_mfma_f32_16x16x32_bf16 v[152:155], v[16:19], a[120:123], 0
    v_mfma_f32_16x16x32_bf16 v[156:159], v[20:23], a[120:123], 0
    v_mfma_f32_16x16x32_bf16 v[160:163], v[16:19], a[144:147], 0
    v_mfma_f32_16x16x32_bf16 v[164:167], v[20:23], a[144:147], 0
    v_mfma_f32_16x16x32_bf16 v[168:171], v[16:19], a[168:171], 0
    v_mfma_f32_16x16x32_bf16 v[172:175], v[20:23], a[168:171], 0
    v_mfma_f32_16x16x32_bf16 v[176:179], v[16:19], a[192:195], 0
    v_mfma_f32_16x16x32_bf16 v[180:183], v[20:23], a[192:195], 0
    v_mfma_f32_16x16x32_bf16 v[184:187], v[16:19], a[216:219], 0
    v_mfma_f32_16x16x32_bf16 v[188:191], v[20:23], a[216:219], 0
    v_mfma_f32_16x16x32_bf16 v[112:115], v[28:31], a[4:7], v[112:115]
    v_mfma_f32_16x16x32_bf16 v[116:119], v[32:35], a[4:7], v[116:119]
    v_mfma_f32_16x16x32_bf16 v[120:123], v[28:31], a[28:31], v[120:123]
    v_mfma_f32_16x16x32_bf16 v[124:127], v[32:35], a[28:31], v[124:127]
    v_mfma_f32_16x16x32_bf16 v[128:131], v[28:31], a[52:55], v[128:131]
    v_mfma_f32_16x16x32_bf16 v[132:135], v[32:35], a[52:55], v[132:135]
    v_mfma_f32_16x16x32_bf16 v[136:139], v[28:31], a[76:79], v[136:139]
    v_mfma_f32_16x16x32_bf16 v[140:143], v[32:35], a[76:79], v[140:143]
    v_mfma_f32_16x16x32_bf16 v[144:147], v[28:31], a[100:103], v[144:147]
    v_mfma_f32_16x16x32_bf16 v[148:151], v[32:35], a[100:103], v[148:151]
    v_mfma_f32_16x16x32_bf16 v[152:155], v[28:31], a[124:127], v[152:155]
    v_mfma_f32_16x16x32_bf16 v[156:159], v[32:35], a[124:127], v[156:159]
    v_mfma_f32_16x16x32_bf16 v[160:163], v[28:31], a[148:151], v[160:163]
    v_mfma_f32_16x16x32_bf16 v[164:167], v[32:35], a[148:151], v[164:167]
    v_mfma_f32_16x16x32_bf16 v[168:171], v[28:31], a[172:175], v[168:171]
    v_mfma_f32_16x16x32_bf16 v[172:175], v[32:35], a[172:175], v[172:175]
    v_mfma_f32_16x16x32_bf16 v[176:179], v[28:31], a[196:199], v[176:179]
    v_mfma_f32_16x16x32_bf16 v[180:183], v[32:35], a[196:199], v[180:183]
    v_mfma_f32_16x16x32_bf16 v[184:187], v[28:31], a[220:223], v[184:187]
    v_mfma_f32_16x16x32_bf16 v[188:191], v[32:35], a[220:223], v[188:191]
    v_mfma_f32_16x16x32_bf16 v[112:115], v[40:43], a[8:11], v[112:115]
    v_mfma_f32_16x16x32_bf16 v[116:119], v[44:47], a[8:11], v[116:119]
    v_mfma_f32_16x16x32_bf16 v[120:123], v[40:43], a[32:35], v[120:123]
    v_mfma_f32_16x16x32_bf16 v[124:127], v[44:47], a[32:35], v[124:127]
    v_mfma_f32_16x16x32_bf16 v[128:131], v[40:43], a[56:59], v[128:131]
    v_mfma_f32_16x16x32_bf16 v[132:135], v[44:47], a[56:59], v[132:135]
    v_mfma_f32_16x16x32_bf16 v[136:139], v[40:43], a[80:83], v[136:139]
    v_mfma_f32_16x16x32_bf16 v[140:143], v[44:47], a[80:83], v[140:143]
    v_mfma_f32_16x16x32_bf16 v[144:147], v[40:43], a[104:107], v[144:147]
    v_mfma_f32_16x16x32_bf16 v[148:151], v[44:47], a[104:107], v[148:151]
    v_mfma_f32_16x16x32_bf16 v[152:155], v[40:43], a[128:131], v[152:155]
    v_mfma_f32_16x16x32_bf16 v[156:159], v[44:47], a[128:131], v[156:159]
    v_mfma_f32_16x16x32_bf16 v[160:163], v[40:43], a[152:155], v[160:163]
    v_mfma_f32_16x16x32_bf16 v[164:167], v[44:47], a[152:155], v[164:167]
    v_mfma_f32_16x16x32_bf16 v[168:171], v[40:43], a[176:179], v[168:171]
    v_mfma_f32_16x16x32_bf16 v[172:175], v[44:47], a[176:179], v[172:175]
    v_mfma_f32_16x16x32_bf16 v[176:179], v[40:43], a[200:203], v[176:179]
    v_mfma_f32_16x16x32_bf16 v[180:183], v[44:47], a[200:203], v[180:183]
    v_mfma_f32_16x16x32_bf16 v[184:187], v[40:43], a[224:227], v[184:187]
    v_mfma_f32_16x16x32_bf16 v[188:191], v[44:47], a[224:227], v[188:191]
    s_waitcnt vmcnt(0)
    v_readfirstlane_b32 s24, v232
    s_max_i32 s62, s62, s24
    s_add_u32 s63, s40, 2
    s_min_u32 s63, s63, 64
    s_cmp_ge_i32 s62, s63
    s_cselect_b32 s24, 1, 0
    s_lshl_b32 s25, s3, 4
    s_add_u32 s25, s25, 0
    v_mov_b32 v12, s25
    v_mov_b32 v13, s24
    ds_write_b32 v12, v13
    v_mov_b32 v12, 0
    s_waitcnt lgkmcnt(0)
    s_barrier
    ds_read_b32 v13, v12
    s_cmp_eq_u32 s3, 0
    s_cbranch_scc0 interleave_layers__linear_attn_block__memory_aug_recurrent_mem_tr__prompt_kernel_fp45
    v_mov_b32 v15, s40
    buffer_store_dword v15, v14, s[8:11], 0 offen sc1
interleave_layers__linear_attn_block__memory_aug_recurrent_mem_tr__prompt_kernel_fp45:
    s_waitcnt lgkmcnt(0)
    v_readfirstlane_b32 s58, v13
    s_cmp_eq_u32 s58, 1
    s_cbranch_scc0 interleave_layers__linear_attn_block__memory_aug_recurrent_mem_tr__prompt_kernel_of44
    s_max_i32 s62, s62, s63
    buffer_load_dwordx4 v[64:67], v6, s[8:11], s41 offen offset:0 sc1
    buffer_load_dwordx4 v[68:71], v6, s[8:11], s41 offen offset:1024 sc1
    buffer_load_dwordx4 v[72:75], v6, s[8:11], s41 offen offset:2048 sc1
    buffer_load_dwordx4 v[76:79], v6, s[8:11], s41 offen offset:3072 sc1
    buffer_load_dwordx4 v[80:83], v7, s[8:11], s41 offen offset:0 sc1
    buffer_load_dwordx4 v[84:87], v7, s[8:11], s41 offen offset:1024 sc1
    buffer_load_dwordx4 v[88:91], v7, s[8:11], s41 offen offset:2048 sc1
    buffer_load_dwordx4 v[92:95], v7, s[8:11], s41 offen offset:3072 sc1
    buffer_load_dwordx4 v[96:99], v8, s[8:11], s41 offen offset:0 sc1
    buffer_load_dwordx4 v[100:103], v8, s[8:11], s41 offen offset:1024 sc1
    buffer_load_dwordx4 v[104:107], v8, s[8:11], s41 offen offset:2048 sc1
    buffer_load_dwordx4 v[108:111], v8, s[8:11], s41 offen offset:3072 sc1
    s_add_u32 s41, s41, 393216
interleave_layers__linear_attn_block__memory_aug_recurrent_mem_tr__prompt_kernel_of44:
    v_mfma_f32_16x16x32_bf16 v[112:115], v[52:55], a[12:15], v[112:115]
    v_mfma_f32_16x16x32_bf16 v[116:119], v[56:59], a[12:15], v[116:119]
    v_mfma_f32_16x16x32_bf16 v[120:123], v[52:55], a[36:39], v[120:123]
    v_mfma_f32_16x16x32_bf16 v[124:127], v[56:59], a[36:39], v[124:127]
    v_mfma_f32_16x16x32_bf16 v[128:131], v[52:55], a[60:63], v[128:131]
    v_mfma_f32_16x16x32_bf16 v[132:135], v[56:59], a[60:63], v[132:135]
    v_mfma_f32_16x16x32_bf16 v[136:139], v[52:55], a[84:87], v[136:139]
    v_mfma_f32_16x16x32_bf16 v[140:143], v[56:59], a[84:87], v[140:143]
    v_mfma_f32_16x16x32_bf16 v[144:147], v[52:55], a[108:111], v[144:147]
    v_mfma_f32_16x16x32_bf16 v[148:151], v[56:59], a[108:111], v[148:151]
    v_mfma_f32_16x16x32_bf16 v[152:155], v[52:55], a[132:135], v[152:155]
    v_mfma_f32_16x16x32_bf16 v[156:159], v[56:59], a[132:135], v[156:159]
    v_mfma_f32_16x16x32_bf16 v[160:163], v[52:55], a[156:159], v[160:163]
    v_mfma_f32_16x16x32_bf16 v[164:167], v[56:59], a[156:159], v[164:167]
    v_mfma_f32_16x16x32_bf16 v[168:171], v[52:55], a[180:183], v[168:171]
    v_mfma_f32_16x16x32_bf16 v[172:175], v[56:59], a[180:183], v[172:175]
    v_mfma_f32_16x16x32_bf16 v[176:179], v[52:55], a[204:207], v[176:179]
    v_mfma_f32_16x16x32_bf16 v[180:183], v[56:59], a[204:207], v[180:183]
    v_mfma_f32_16x16x32_bf16 v[184:187], v[52:55], a[228:231], v[184:187]
    v_mfma_f32_16x16x32_bf16 v[188:191], v[56:59], a[228:231], v[188:191]
    v_mfma_f32_16x16x32_bf16 v[112:115], v[24:27], a[16:19], v[112:115]
    v_mfma_f32_16x16x32_bf16 v[116:119], v[36:39], a[16:19], v[116:119]
    v_mfma_f32_16x16x32_bf16 v[120:123], v[24:27], a[40:43], v[120:123]
    v_mfma_f32_16x16x32_bf16 v[124:127], v[36:39], a[40:43], v[124:127]
    v_mfma_f32_16x16x32_bf16 v[128:131], v[24:27], a[64:67], v[128:131]
    v_mfma_f32_16x16x32_bf16 v[132:135], v[36:39], a[64:67], v[132:135]
    v_mfma_f32_16x16x32_bf16 v[136:139], v[24:27], a[88:91], v[136:139]
    v_mfma_f32_16x16x32_bf16 v[140:143], v[36:39], a[88:91], v[140:143]
    v_mfma_f32_16x16x32_bf16 v[144:147], v[24:27], a[112:115], v[144:147]
    v_mfma_f32_16x16x32_bf16 v[148:151], v[36:39], a[112:115], v[148:151]
    v_mfma_f32_16x16x32_bf16 v[152:155], v[24:27], a[136:139], v[152:155]
    v_mfma_f32_16x16x32_bf16 v[156:159], v[36:39], a[136:139], v[156:159]
    v_mfma_f32_16x16x32_bf16 v[160:163], v[24:27], a[160:163], v[160:163]
    v_mfma_f32_16x16x32_bf16 v[164:167], v[36:39], a[160:163], v[164:167]
    v_mfma_f32_16x16x32_bf16 v[168:171], v[24:27], a[184:187], v[168:171]
    v_mfma_f32_16x16x32_bf16 v[172:175], v[36:39], a[184:187], v[172:175]
    v_mfma_f32_16x16x32_bf16 v[176:179], v[24:27], a[208:211], v[176:179]
    v_mfma_f32_16x16x32_bf16 v[180:183], v[36:39], a[208:211], v[180:183]
    v_mfma_f32_16x16x32_bf16 v[184:187], v[24:27], a[232:235], v[184:187]
    v_mfma_f32_16x16x32_bf16 v[188:191], v[36:39], a[232:235], v[188:191]
    buffer_load_dword v233, v10, s[8:11], 0 offen sc1
    v_mfma_f32_16x16x32_bf16 v[112:115], v[48:51], a[20:23], v[112:115]
    v_mfma_f32_16x16x32_bf16 v[116:119], v[60:63], a[20:23], v[116:119]
    v_mfma_f32_16x16x32_bf16 v[120:123], v[48:51], a[44:47], v[120:123]
    v_mfma_f32_16x16x32_bf16 v[124:127], v[60:63], a[44:47], v[124:127]
    v_mfma_f32_16x16x32_bf16 v[128:131], v[48:51], a[68:71], v[128:131]
    v_mfma_f32_16x16x32_bf16 v[132:135], v[60:63], a[68:71], v[132:135]
    v_mfma_f32_16x16x32_bf16 v[136:139], v[48:51], a[92:95], v[136:139]
    v_mfma_f32_16x16x32_bf16 v[140:143], v[60:63], a[92:95], v[140:143]
    v_mfma_f32_16x16x32_bf16 v[144:147], v[48:51], a[116:119], v[144:147]
    v_mfma_f32_16x16x32_bf16 v[148:151], v[60:63], a[116:119], v[148:151]
    v_mfma_f32_16x16x32_bf16 v[152:155], v[48:51], a[140:143], v[152:155]
    v_mfma_f32_16x16x32_bf16 v[156:159], v[60:63], a[140:143], v[156:159]
    v_mfma_f32_16x16x32_bf16 v[160:163], v[48:51], a[164:167], v[160:163]
    v_mfma_f32_16x16x32_bf16 v[164:167], v[60:63], a[164:167], v[164:167]
    v_mfma_f32_16x16x32_bf16 v[168:171], v[48:51], a[188:191], v[168:171]
    v_mfma_f32_16x16x32_bf16 v[172:175], v[60:63], a[188:191], v[172:175]
    v_mfma_f32_16x16x32_bf16 v[176:179], v[48:51], a[212:215], v[176:179]
    v_mfma_f32_16x16x32_bf16 v[180:183], v[60:63], a[212:215], v[180:183]
    v_mfma_f32_16x16x32_bf16 v[184:187], v[48:51], a[236:239], v[184:187]
    v_mfma_f32_16x16x32_bf16 v[188:191], v[60:63], a[236:239], v[188:191]
    s_mov_b32 s46, s43
    v_cvt_pk_bf16_f32 v192, v112, v113
    v_cvt_pk_bf16_f32 v193, v114, v115
    v_cvt_pk_bf16_f32 v194, v116, v117
    v_cvt_pk_bf16_f32 v195, v118, v119
    buffer_store_dwordx4 v[192:195], v9, s[8:11], s46 offen sc1
    s_add_u32 s46, s46, 32768
    v_cvt_pk_bf16_f32 v196, v120, v121
    v_cvt_pk_bf16_f32 v197, v122, v123
    v_cvt_pk_bf16_f32 v198, v124, v125
    v_cvt_pk_bf16_f32 v199, v126, v127
    buffer_store_dwordx4 v[196:199], v9, s[8:11], s46 offen sc1
    s_add_u32 s46, s46, 32768
    v_cvt_pk_bf16_f32 v200, v128, v129
    v_cvt_pk_bf16_f32 v201, v130, v131
    v_cvt_pk_bf16_f32 v202, v132, v133
    v_cvt_pk_bf16_f32 v203, v134, v135
    buffer_store_dwordx4 v[200:203], v9, s[8:11], s46 offen sc1
    s_add_u32 s46, s46, 32768
    v_cvt_pk_bf16_f32 v204, v136, v137
    v_cvt_pk_bf16_f32 v205, v138, v139
    v_cvt_pk_bf16_f32 v206, v140, v141
    v_cvt_pk_bf16_f32 v207, v142, v143
    buffer_store_dwordx4 v[204:207], v9, s[8:11], s46 offen sc1
    s_add_u32 s46, s46, 32768
    v_cvt_pk_bf16_f32 v208, v144, v145
    v_cvt_pk_bf16_f32 v209, v146, v147
    v_cvt_pk_bf16_f32 v210, v148, v149
    v_cvt_pk_bf16_f32 v211, v150, v151
    buffer_store_dwordx4 v[208:211], v9, s[8:11], s46 offen sc1
    s_add_u32 s46, s46, 32768
    v_cvt_pk_bf16_f32 v212, v152, v153
    v_cvt_pk_bf16_f32 v213, v154, v155
    v_cvt_pk_bf16_f32 v214, v156, v157
    v_cvt_pk_bf16_f32 v215, v158, v159
    buffer_store_dwordx4 v[212:215], v9, s[8:11], s46 offen sc1
    s_add_u32 s46, s46, 32768
    v_cvt_pk_bf16_f32 v216, v160, v161
    v_cvt_pk_bf16_f32 v217, v162, v163
    v_cvt_pk_bf16_f32 v218, v164, v165
    v_cvt_pk_bf16_f32 v219, v166, v167
    buffer_store_dwordx4 v[216:219], v9, s[8:11], s46 offen sc1
    s_add_u32 s46, s46, 32768
    v_cvt_pk_bf16_f32 v220, v168, v169
    v_cvt_pk_bf16_f32 v221, v170, v171
    v_cvt_pk_bf16_f32 v222, v172, v173
    v_cvt_pk_bf16_f32 v223, v174, v175
    buffer_store_dwordx4 v[220:223], v9, s[8:11], s46 offen sc1
    s_add_u32 s46, s46, 32768
    v_cvt_pk_bf16_f32 v224, v176, v177
    v_cvt_pk_bf16_f32 v225, v178, v179
    v_cvt_pk_bf16_f32 v226, v180, v181
    v_cvt_pk_bf16_f32 v227, v182, v183
    buffer_store_dwordx4 v[224:227], v9, s[8:11], s46 offen sc1
    s_add_u32 s46, s46, 32768
    v_cvt_pk_bf16_f32 v228, v184, v185
    v_cvt_pk_bf16_f32 v229, v186, v187
    v_cvt_pk_bf16_f32 v230, v188, v189
    v_cvt_pk_bf16_f32 v231, v190, v191
    buffer_store_dwordx4 v[228:231], v9, s[8:11], s46 offen sc1
    s_cmp_eq_u32 s58, 1
    s_cbranch_scc1 interleave_layers__linear_attn_block__memory_aug_recurrent_mem_tr__prompt_kernel_of46
    s_waitcnt vmcnt(10)
    v_readfirstlane_b32 s24, v233
    s_max_i32 s62, s62, s24
    s_add_u32 s63, s40, 2
    s_min_u32 s63, s63, 64
    s_cmp_ge_i32 s62, s63
    s_cbranch_scc0 interleave_layers__linear_attn_block__memory_aug_recurrent_mem_tr__prompt_kernel_oo47
    buffer_load_dwordx4 v[64:67], v6, s[8:11], s41 offen offset:0 sc1
    buffer_load_dwordx4 v[68:71], v6, s[8:11], s41 offen offset:1024 sc1
    buffer_load_dwordx4 v[72:75], v6, s[8:11], s41 offen offset:2048 sc1
    buffer_load_dwordx4 v[76:79], v6, s[8:11], s41 offen offset:3072 sc1
    buffer_load_dwordx4 v[80:83], v7, s[8:11], s41 offen offset:0 sc1
    buffer_load_dwordx4 v[84:87], v7, s[8:11], s41 offen offset:1024 sc1
    buffer_load_dwordx4 v[88:91], v7, s[8:11], s41 offen offset:2048 sc1
    buffer_load_dwordx4 v[92:95], v7, s[8:11], s41 offen offset:3072 sc1
    buffer_load_dwordx4 v[96:99], v8, s[8:11], s41 offen offset:0 sc1
    buffer_load_dwordx4 v[100:103], v8, s[8:11], s41 offen offset:1024 sc1
    buffer_load_dwordx4 v[104:107], v8, s[8:11], s41 offen offset:2048 sc1
    buffer_load_dwordx4 v[108:111], v8, s[8:11], s41 offen offset:3072 sc1
    s_add_u32 s41, s41, 393216
    s_waitcnt vmcnt(12)
    s_barrier
    s_add_u32 s24, s40, 1
    s_cmp_eq_u32 s3, 0
    s_cbranch_scc0 interleave_layers__linear_attn_block__memory_aug_recurrent_mem_tr__prompt_kernel_fp48
    v_mov_b32 v15, s24
    buffer_store_dword v15, v14, s[8:11], 0 offen sc1
interleave_layers__linear_attn_block__memory_aug_recurrent_mem_tr__prompt_kernel_fp48:
    s_waitcnt vmcnt(0)
    s_branch interleave_layers__linear_attn_block__memory_aug_recurrent_mem_tr__prompt_kernel_of46
interleave_layers__linear_attn_block__memory_aug_recurrent_mem_tr__prompt_kernel_oo47:
    s_waitcnt vmcnt(0)
    s_barrier
    s_add_u32 s24, s40, 1
    s_cmp_eq_u32 s3, 0
    s_cbranch_scc0 interleave_layers__linear_attn_block__memory_aug_recurrent_mem_tr__prompt_kernel_fp49
    v_mov_b32 v15, s24
    buffer_store_dword v15, v14, s[8:11], 0 offen sc1
interleave_layers__linear_attn_block__memory_aug_recurrent_mem_tr__prompt_kernel_fp49:
    s_add_u32 s63, s40, 2
    s_min_u32 s63, s63, 64
    s_cmp_ge_i32 s62, s63
    s_cbranch_scc1 interleave_layers__linear_attn_block__memory_aug_recurrent_mem_tr__prompt_kernel_o_en3_ok
    s_mov_b32 s61, 0
interleave_layers__linear_attn_block__memory_aug_recurrent_mem_tr__prompt_kernel_o_en3:
    buffer_load_dword v11, v10, s[8:11], 0 offen sc1
    s_waitcnt vmcnt(0)
    v_readlane_b32 s62, v11, 0
    s_cmp_ge_i32 s62, s63
    s_cbranch_scc1 interleave_layers__linear_attn_block__memory_aug_recurrent_mem_tr__prompt_kernel_o_en3_ok
    s_add_u32 s61, s61, 1
    s_cmp_ge_u32 s61, s60
    s_cbranch_scc1 interleave_layers__linear_attn_block__memory_aug_recurrent_mem_tr__prompt_kernel_o_en3_to
    s_sleep 2
    s_branch interleave_layers__linear_attn_block__memory_aug_recurrent_mem_tr__prompt_kernel_o_en3
interleave_layers__linear_attn_block__memory_aug_recurrent_mem_tr__prompt_kernel_o_en3_to:
    s_mov_b32 s60, 1
interleave_layers__linear_attn_block__memory_aug_recurrent_mem_tr__prompt_kernel_o_en3_ok:
    buffer_load_dwordx4 v[64:67], v6, s[8:11], s41 offen offset:0 sc1
    buffer_load_dwordx4 v[68:71], v6, s[8:11], s41 offen offset:1024 sc1
    buffer_load_dwordx4 v[72:75], v6, s[8:11], s41 offen offset:2048 sc1
    buffer_load_dwordx4 v[76:79], v6, s[8:11], s41 offen offset:3072 sc1
    buffer_load_dwordx4 v[80:83], v7, s[8:11], s41 offen offset:0 sc1
    buffer_load_dwordx4 v[84:87], v7, s[8:11], s41 offen offset:1024 sc1
    buffer_load_dwordx4 v[88:91], v7, s[8:11], s41 offen offset:2048 sc1
    buffer_load_dwordx4 v[92:95], v7, s[8:11], s41 offen offset:3072 sc1
    buffer_load_dwordx4 v[96:99], v8, s[8:11], s41 offen offset:0 sc1
    buffer_load_dwordx4 v[100:103], v8, s[8:11], s41 offen offset:1024 sc1
    buffer_load_dwordx4 v[104:107], v8, s[8:11], s41 offen offset:2048 sc1
    buffer_load_dwordx4 v[108:111], v8, s[8:11], s41 offen offset:3072 sc1
    s_add_u32 s41, s41, 393216
    s_waitcnt vmcnt(0)
interleave_layers__linear_attn_block__memory_aug_recurrent_mem_tr__prompt_kernel_of46:
    s_waitcnt vmcnt(10)
    s_add_u32 s40, s40, 1
    s_add_u32 s43, s43, 1310720
    v_swap_b32 v74, v84
    v_swap_b32 v75, v85
    v_swap_b32 v98, v108
    v_swap_b32 v99, v109
    buffer_load_dword v232, v10, s[8:11], 0 offen sc1
    v_mfma_f32_16x16x32_bf16 v[112:115], v[64:67], a[0:3], 0
    v_mfma_f32_16x16x32_bf16 v[116:119], v[68:71], a[0:3], 0
    v_mfma_f32_16x16x32_bf16 v[120:123], v[64:67], a[24:27], 0
    v_mfma_f32_16x16x32_bf16 v[124:127], v[68:71], a[24:27], 0
    v_mfma_f32_16x16x32_bf16 v[128:131], v[64:67], a[48:51], 0
    v_mfma_f32_16x16x32_bf16 v[132:135], v[68:71], a[48:51], 0
    v_mfma_f32_16x16x32_bf16 v[136:139], v[64:67], a[72:75], 0
    v_mfma_f32_16x16x32_bf16 v[140:143], v[68:71], a[72:75], 0
    v_mfma_f32_16x16x32_bf16 v[144:147], v[64:67], a[96:99], 0
    v_mfma_f32_16x16x32_bf16 v[148:151], v[68:71], a[96:99], 0
    v_mfma_f32_16x16x32_bf16 v[152:155], v[64:67], a[120:123], 0
    v_mfma_f32_16x16x32_bf16 v[156:159], v[68:71], a[120:123], 0
    v_mfma_f32_16x16x32_bf16 v[160:163], v[64:67], a[144:147], 0
    v_mfma_f32_16x16x32_bf16 v[164:167], v[68:71], a[144:147], 0
    v_mfma_f32_16x16x32_bf16 v[168:171], v[64:67], a[168:171], 0
    v_mfma_f32_16x16x32_bf16 v[172:175], v[68:71], a[168:171], 0
    v_mfma_f32_16x16x32_bf16 v[176:179], v[64:67], a[192:195], 0
    v_mfma_f32_16x16x32_bf16 v[180:183], v[68:71], a[192:195], 0
    v_mfma_f32_16x16x32_bf16 v[184:187], v[64:67], a[216:219], 0
    v_mfma_f32_16x16x32_bf16 v[188:191], v[68:71], a[216:219], 0
    v_mfma_f32_16x16x32_bf16 v[112:115], v[76:79], a[4:7], v[112:115]
    v_mfma_f32_16x16x32_bf16 v[116:119], v[80:83], a[4:7], v[116:119]
    v_mfma_f32_16x16x32_bf16 v[120:123], v[76:79], a[28:31], v[120:123]
    v_mfma_f32_16x16x32_bf16 v[124:127], v[80:83], a[28:31], v[124:127]
    v_mfma_f32_16x16x32_bf16 v[128:131], v[76:79], a[52:55], v[128:131]
    v_mfma_f32_16x16x32_bf16 v[132:135], v[80:83], a[52:55], v[132:135]
    v_mfma_f32_16x16x32_bf16 v[136:139], v[76:79], a[76:79], v[136:139]
    v_mfma_f32_16x16x32_bf16 v[140:143], v[80:83], a[76:79], v[140:143]
    v_mfma_f32_16x16x32_bf16 v[144:147], v[76:79], a[100:103], v[144:147]
    v_mfma_f32_16x16x32_bf16 v[148:151], v[80:83], a[100:103], v[148:151]
    v_mfma_f32_16x16x32_bf16 v[152:155], v[76:79], a[124:127], v[152:155]
    v_mfma_f32_16x16x32_bf16 v[156:159], v[80:83], a[124:127], v[156:159]
    v_mfma_f32_16x16x32_bf16 v[160:163], v[76:79], a[148:151], v[160:163]
    v_mfma_f32_16x16x32_bf16 v[164:167], v[80:83], a[148:151], v[164:167]
    v_mfma_f32_16x16x32_bf16 v[168:171], v[76:79], a[172:175], v[168:171]
    v_mfma_f32_16x16x32_bf16 v[172:175], v[80:83], a[172:175], v[172:175]
    v_mfma_f32_16x16x32_bf16 v[176:179], v[76:79], a[196:199], v[176:179]
    v_mfma_f32_16x16x32_bf16 v[180:183], v[80:83], a[196:199], v[180:183]
    v_mfma_f32_16x16x32_bf16 v[184:187], v[76:79], a[220:223], v[184:187]
    v_mfma_f32_16x16x32_bf16 v[188:191], v[80:83], a[220:223], v[188:191]
    v_mfma_f32_16x16x32_bf16 v[112:115], v[88:91], a[8:11], v[112:115]
    v_mfma_f32_16x16x32_bf16 v[116:119], v[92:95], a[8:11], v[116:119]
    v_mfma_f32_16x16x32_bf16 v[120:123], v[88:91], a[32:35], v[120:123]
    v_mfma_f32_16x16x32_bf16 v[124:127], v[92:95], a[32:35], v[124:127]
    v_mfma_f32_16x16x32_bf16 v[128:131], v[88:91], a[56:59], v[128:131]
    v_mfma_f32_16x16x32_bf16 v[132:135], v[92:95], a[56:59], v[132:135]
    v_mfma_f32_16x16x32_bf16 v[136:139], v[88:91], a[80:83], v[136:139]
    v_mfma_f32_16x16x32_bf16 v[140:143], v[92:95], a[80:83], v[140:143]
    v_mfma_f32_16x16x32_bf16 v[144:147], v[88:91], a[104:107], v[144:147]
    v_mfma_f32_16x16x32_bf16 v[148:151], v[92:95], a[104:107], v[148:151]
    v_mfma_f32_16x16x32_bf16 v[152:155], v[88:91], a[128:131], v[152:155]
    v_mfma_f32_16x16x32_bf16 v[156:159], v[92:95], a[128:131], v[156:159]
    v_mfma_f32_16x16x32_bf16 v[160:163], v[88:91], a[152:155], v[160:163]
    v_mfma_f32_16x16x32_bf16 v[164:167], v[92:95], a[152:155], v[164:167]
    v_mfma_f32_16x16x32_bf16 v[168:171], v[88:91], a[176:179], v[168:171]
    v_mfma_f32_16x16x32_bf16 v[172:175], v[92:95], a[176:179], v[172:175]
    v_mfma_f32_16x16x32_bf16 v[176:179], v[88:91], a[200:203], v[176:179]
    v_mfma_f32_16x16x32_bf16 v[180:183], v[92:95], a[200:203], v[180:183]
    v_mfma_f32_16x16x32_bf16 v[184:187], v[88:91], a[224:227], v[184:187]
    v_mfma_f32_16x16x32_bf16 v[188:191], v[92:95], a[224:227], v[188:191]
    s_waitcnt vmcnt(0)
    v_readfirstlane_b32 s24, v232
    s_max_i32 s62, s62, s24
    s_add_u32 s63, s40, 2
    s_min_u32 s63, s63, 64
    s_cmp_ge_i32 s62, s63
    s_cselect_b32 s24, 1, 0
    s_lshl_b32 s25, s3, 4
    s_add_u32 s25, s25, 4
    v_mov_b32 v12, s25
    v_mov_b32 v13, s24
    ds_write_b32 v12, v13
    v_mov_b32 v12, 4
    s_waitcnt lgkmcnt(0)
    s_barrier
    ds_read_b32 v13, v12
    s_cmp_eq_u32 s3, 0
    s_cbranch_scc0 interleave_layers__linear_attn_block__memory_aug_recurrent_mem_tr__prompt_kernel_fp51
    v_mov_b32 v15, s40
    buffer_store_dword v15, v14, s[8:11], 0 offen sc1
interleave_layers__linear_attn_block__memory_aug_recurrent_mem_tr__prompt_kernel_fp51:
    s_waitcnt lgkmcnt(0)
    v_readfirstlane_b32 s58, v13
    s_cmp_eq_u32 s58, 1
    s_cbranch_scc0 interleave_layers__linear_attn_block__memory_aug_recurrent_mem_tr__prompt_kernel_of50
    s_max_i32 s62, s62, s63
    buffer_load_dwordx4 v[16:19], v6, s[8:11], s41 offen offset:0 sc1
    buffer_load_dwordx4 v[20:23], v6, s[8:11], s41 offen offset:1024 sc1
    buffer_load_dwordx4 v[24:27], v6, s[8:11], s41 offen offset:2048 sc1
    buffer_load_dwordx4 v[28:31], v6, s[8:11], s41 offen offset:3072 sc1
    buffer_load_dwordx4 v[32:35], v7, s[8:11], s41 offen offset:0 sc1
    buffer_load_dwordx4 v[36:39], v7, s[8:11], s41 offen offset:1024 sc1
    buffer_load_dwordx4 v[40:43], v7, s[8:11], s41 offen offset:2048 sc1
    buffer_load_dwordx4 v[44:47], v7, s[8:11], s41 offen offset:3072 sc1
    buffer_load_dwordx4 v[48:51], v8, s[8:11], s41 offen offset:0 sc1
    buffer_load_dwordx4 v[52:55], v8, s[8:11], s41 offen offset:1024 sc1
    buffer_load_dwordx4 v[56:59], v8, s[8:11], s41 offen offset:2048 sc1
    buffer_load_dwordx4 v[60:63], v8, s[8:11], s41 offen offset:3072 sc1
    s_add_u32 s41, s41, 393216
interleave_layers__linear_attn_block__memory_aug_recurrent_mem_tr__prompt_kernel_of50:
    v_mfma_f32_16x16x32_bf16 v[112:115], v[100:103], a[12:15], v[112:115]
    v_mfma_f32_16x16x32_bf16 v[116:119], v[104:107], a[12:15], v[116:119]
    v_mfma_f32_16x16x32_bf16 v[120:123], v[100:103], a[36:39], v[120:123]
    v_mfma_f32_16x16x32_bf16 v[124:127], v[104:107], a[36:39], v[124:127]
    v_mfma_f32_16x16x32_bf16 v[128:131], v[100:103], a[60:63], v[128:131]
    v_mfma_f32_16x16x32_bf16 v[132:135], v[104:107], a[60:63], v[132:135]
    v_mfma_f32_16x16x32_bf16 v[136:139], v[100:103], a[84:87], v[136:139]
    v_mfma_f32_16x16x32_bf16 v[140:143], v[104:107], a[84:87], v[140:143]
    v_mfma_f32_16x16x32_bf16 v[144:147], v[100:103], a[108:111], v[144:147]
    v_mfma_f32_16x16x32_bf16 v[148:151], v[104:107], a[108:111], v[148:151]
    v_mfma_f32_16x16x32_bf16 v[152:155], v[100:103], a[132:135], v[152:155]
    v_mfma_f32_16x16x32_bf16 v[156:159], v[104:107], a[132:135], v[156:159]
    v_mfma_f32_16x16x32_bf16 v[160:163], v[100:103], a[156:159], v[160:163]
    v_mfma_f32_16x16x32_bf16 v[164:167], v[104:107], a[156:159], v[164:167]
    v_mfma_f32_16x16x32_bf16 v[168:171], v[100:103], a[180:183], v[168:171]
    v_mfma_f32_16x16x32_bf16 v[172:175], v[104:107], a[180:183], v[172:175]
    v_mfma_f32_16x16x32_bf16 v[176:179], v[100:103], a[204:207], v[176:179]
    v_mfma_f32_16x16x32_bf16 v[180:183], v[104:107], a[204:207], v[180:183]
    v_mfma_f32_16x16x32_bf16 v[184:187], v[100:103], a[228:231], v[184:187]
    v_mfma_f32_16x16x32_bf16 v[188:191], v[104:107], a[228:231], v[188:191]
    v_mfma_f32_16x16x32_bf16 v[112:115], v[72:75], a[16:19], v[112:115]
    v_mfma_f32_16x16x32_bf16 v[116:119], v[84:87], a[16:19], v[116:119]
    v_mfma_f32_16x16x32_bf16 v[120:123], v[72:75], a[40:43], v[120:123]
    v_mfma_f32_16x16x32_bf16 v[124:127], v[84:87], a[40:43], v[124:127]
    v_mfma_f32_16x16x32_bf16 v[128:131], v[72:75], a[64:67], v[128:131]
    v_mfma_f32_16x16x32_bf16 v[132:135], v[84:87], a[64:67], v[132:135]
    v_mfma_f32_16x16x32_bf16 v[136:139], v[72:75], a[88:91], v[136:139]
    v_mfma_f32_16x16x32_bf16 v[140:143], v[84:87], a[88:91], v[140:143]
    v_mfma_f32_16x16x32_bf16 v[144:147], v[72:75], a[112:115], v[144:147]
    v_mfma_f32_16x16x32_bf16 v[148:151], v[84:87], a[112:115], v[148:151]
    v_mfma_f32_16x16x32_bf16 v[152:155], v[72:75], a[136:139], v[152:155]
    v_mfma_f32_16x16x32_bf16 v[156:159], v[84:87], a[136:139], v[156:159]
    v_mfma_f32_16x16x32_bf16 v[160:163], v[72:75], a[160:163], v[160:163]
    v_mfma_f32_16x16x32_bf16 v[164:167], v[84:87], a[160:163], v[164:167]
    v_mfma_f32_16x16x32_bf16 v[168:171], v[72:75], a[184:187], v[168:171]
    v_mfma_f32_16x16x32_bf16 v[172:175], v[84:87], a[184:187], v[172:175]
    v_mfma_f32_16x16x32_bf16 v[176:179], v[72:75], a[208:211], v[176:179]
    v_mfma_f32_16x16x32_bf16 v[180:183], v[84:87], a[208:211], v[180:183]
    v_mfma_f32_16x16x32_bf16 v[184:187], v[72:75], a[232:235], v[184:187]
    v_mfma_f32_16x16x32_bf16 v[188:191], v[84:87], a[232:235], v[188:191]
    buffer_load_dword v233, v10, s[8:11], 0 offen sc1
    v_mfma_f32_16x16x32_bf16 v[112:115], v[96:99], a[20:23], v[112:115]
    v_mfma_f32_16x16x32_bf16 v[116:119], v[108:111], a[20:23], v[116:119]
    v_mfma_f32_16x16x32_bf16 v[120:123], v[96:99], a[44:47], v[120:123]
    v_mfma_f32_16x16x32_bf16 v[124:127], v[108:111], a[44:47], v[124:127]
    v_mfma_f32_16x16x32_bf16 v[128:131], v[96:99], a[68:71], v[128:131]
    v_mfma_f32_16x16x32_bf16 v[132:135], v[108:111], a[68:71], v[132:135]
    v_mfma_f32_16x16x32_bf16 v[136:139], v[96:99], a[92:95], v[136:139]
    v_mfma_f32_16x16x32_bf16 v[140:143], v[108:111], a[92:95], v[140:143]
    v_mfma_f32_16x16x32_bf16 v[144:147], v[96:99], a[116:119], v[144:147]
    v_mfma_f32_16x16x32_bf16 v[148:151], v[108:111], a[116:119], v[148:151]
    v_mfma_f32_16x16x32_bf16 v[152:155], v[96:99], a[140:143], v[152:155]
    v_mfma_f32_16x16x32_bf16 v[156:159], v[108:111], a[140:143], v[156:159]
    v_mfma_f32_16x16x32_bf16 v[160:163], v[96:99], a[164:167], v[160:163]
    v_mfma_f32_16x16x32_bf16 v[164:167], v[108:111], a[164:167], v[164:167]
    v_mfma_f32_16x16x32_bf16 v[168:171], v[96:99], a[188:191], v[168:171]
    v_mfma_f32_16x16x32_bf16 v[172:175], v[108:111], a[188:191], v[172:175]
    v_mfma_f32_16x16x32_bf16 v[176:179], v[96:99], a[212:215], v[176:179]
    v_mfma_f32_16x16x32_bf16 v[180:183], v[108:111], a[212:215], v[180:183]
    v_mfma_f32_16x16x32_bf16 v[184:187], v[96:99], a[236:239], v[184:187]
    v_mfma_f32_16x16x32_bf16 v[188:191], v[108:111], a[236:239], v[188:191]
    s_mov_b32 s46, s43
    v_cvt_pk_bf16_f32 v192, v112, v113
    v_cvt_pk_bf16_f32 v193, v114, v115
    v_cvt_pk_bf16_f32 v194, v116, v117
    v_cvt_pk_bf16_f32 v195, v118, v119
    buffer_store_dwordx4 v[192:195], v9, s[8:11], s46 offen sc1
    s_add_u32 s46, s46, 32768
    v_cvt_pk_bf16_f32 v196, v120, v121
    v_cvt_pk_bf16_f32 v197, v122, v123
    v_cvt_pk_bf16_f32 v198, v124, v125
    v_cvt_pk_bf16_f32 v199, v126, v127
    buffer_store_dwordx4 v[196:199], v9, s[8:11], s46 offen sc1
    s_add_u32 s46, s46, 32768
    v_cvt_pk_bf16_f32 v200, v128, v129
    v_cvt_pk_bf16_f32 v201, v130, v131
    v_cvt_pk_bf16_f32 v202, v132, v133
    v_cvt_pk_bf16_f32 v203, v134, v135
    buffer_store_dwordx4 v[200:203], v9, s[8:11], s46 offen sc1
    s_add_u32 s46, s46, 32768
    v_cvt_pk_bf16_f32 v204, v136, v137
    v_cvt_pk_bf16_f32 v205, v138, v139
    v_cvt_pk_bf16_f32 v206, v140, v141
    v_cvt_pk_bf16_f32 v207, v142, v143
    buffer_store_dwordx4 v[204:207], v9, s[8:11], s46 offen sc1
    s_add_u32 s46, s46, 32768
    v_cvt_pk_bf16_f32 v208, v144, v145
    v_cvt_pk_bf16_f32 v209, v146, v147
    v_cvt_pk_bf16_f32 v210, v148, v149
    v_cvt_pk_bf16_f32 v211, v150, v151
    buffer_store_dwordx4 v[208:211], v9, s[8:11], s46 offen sc1
    s_add_u32 s46, s46, 32768
    v_cvt_pk_bf16_f32 v212, v152, v153
    v_cvt_pk_bf16_f32 v213, v154, v155
    v_cvt_pk_bf16_f32 v214, v156, v157
    v_cvt_pk_bf16_f32 v215, v158, v159
    buffer_store_dwordx4 v[212:215], v9, s[8:11], s46 offen sc1
    s_add_u32 s46, s46, 32768
    v_cvt_pk_bf16_f32 v216, v160, v161
    v_cvt_pk_bf16_f32 v217, v162, v163
    v_cvt_pk_bf16_f32 v218, v164, v165
    v_cvt_pk_bf16_f32 v219, v166, v167
    buffer_store_dwordx4 v[216:219], v9, s[8:11], s46 offen sc1
    s_add_u32 s46, s46, 32768
    v_cvt_pk_bf16_f32 v220, v168, v169
    v_cvt_pk_bf16_f32 v221, v170, v171
    v_cvt_pk_bf16_f32 v222, v172, v173
    v_cvt_pk_bf16_f32 v223, v174, v175
    buffer_store_dwordx4 v[220:223], v9, s[8:11], s46 offen sc1
    s_add_u32 s46, s46, 32768
    v_cvt_pk_bf16_f32 v224, v176, v177
    v_cvt_pk_bf16_f32 v225, v178, v179
    v_cvt_pk_bf16_f32 v226, v180, v181
    v_cvt_pk_bf16_f32 v227, v182, v183
    buffer_store_dwordx4 v[224:227], v9, s[8:11], s46 offen sc1
    s_add_u32 s46, s46, 32768
    v_cvt_pk_bf16_f32 v228, v184, v185
    v_cvt_pk_bf16_f32 v229, v186, v187
    v_cvt_pk_bf16_f32 v230, v188, v189
    v_cvt_pk_bf16_f32 v231, v190, v191
    buffer_store_dwordx4 v[228:231], v9, s[8:11], s46 offen sc1
    s_cmp_eq_u32 s58, 1
    s_cbranch_scc1 interleave_layers__linear_attn_block__memory_aug_recurrent_mem_tr__prompt_kernel_of52
    s_waitcnt vmcnt(10)
    v_readfirstlane_b32 s24, v233
    s_max_i32 s62, s62, s24
    s_add_u32 s63, s40, 2
    s_min_u32 s63, s63, 64
    s_cmp_ge_i32 s62, s63
    s_cbranch_scc0 interleave_layers__linear_attn_block__memory_aug_recurrent_mem_tr__prompt_kernel_oo53
    buffer_load_dwordx4 v[16:19], v6, s[8:11], s41 offen offset:0 sc1
    buffer_load_dwordx4 v[20:23], v6, s[8:11], s41 offen offset:1024 sc1
    buffer_load_dwordx4 v[24:27], v6, s[8:11], s41 offen offset:2048 sc1
    buffer_load_dwordx4 v[28:31], v6, s[8:11], s41 offen offset:3072 sc1
    buffer_load_dwordx4 v[32:35], v7, s[8:11], s41 offen offset:0 sc1
    buffer_load_dwordx4 v[36:39], v7, s[8:11], s41 offen offset:1024 sc1
    buffer_load_dwordx4 v[40:43], v7, s[8:11], s41 offen offset:2048 sc1
    buffer_load_dwordx4 v[44:47], v7, s[8:11], s41 offen offset:3072 sc1
    buffer_load_dwordx4 v[48:51], v8, s[8:11], s41 offen offset:0 sc1
    buffer_load_dwordx4 v[52:55], v8, s[8:11], s41 offen offset:1024 sc1
    buffer_load_dwordx4 v[56:59], v8, s[8:11], s41 offen offset:2048 sc1
    buffer_load_dwordx4 v[60:63], v8, s[8:11], s41 offen offset:3072 sc1
    s_add_u32 s41, s41, 393216
    s_waitcnt vmcnt(12)
    s_barrier
    s_add_u32 s24, s40, 1
    s_cmp_eq_u32 s3, 0
    s_cbranch_scc0 interleave_layers__linear_attn_block__memory_aug_recurrent_mem_tr__prompt_kernel_fp54
    v_mov_b32 v15, s24
    buffer_store_dword v15, v14, s[8:11], 0 offen sc1
interleave_layers__linear_attn_block__memory_aug_recurrent_mem_tr__prompt_kernel_fp54:
    s_waitcnt vmcnt(0)
    s_branch interleave_layers__linear_attn_block__memory_aug_recurrent_mem_tr__prompt_kernel_of52
interleave_layers__linear_attn_block__memory_aug_recurrent_mem_tr__prompt_kernel_oo53:
    s_waitcnt vmcnt(0)
    s_barrier
    s_add_u32 s24, s40, 1
    s_cmp_eq_u32 s3, 0
    s_cbranch_scc0 interleave_layers__linear_attn_block__memory_aug_recurrent_mem_tr__prompt_kernel_fp55
    v_mov_b32 v15, s24
    buffer_store_dword v15, v14, s[8:11], 0 offen sc1
interleave_layers__linear_attn_block__memory_aug_recurrent_mem_tr__prompt_kernel_fp55:
    s_add_u32 s63, s40, 2
    s_min_u32 s63, s63, 64
    s_cmp_ge_i32 s62, s63
    s_cbranch_scc1 interleave_layers__linear_attn_block__memory_aug_recurrent_mem_tr__prompt_kernel_o_en4_ok
    s_mov_b32 s61, 0
interleave_layers__linear_attn_block__memory_aug_recurrent_mem_tr__prompt_kernel_o_en4:
    buffer_load_dword v11, v10, s[8:11], 0 offen sc1
    s_waitcnt vmcnt(0)
    v_readlane_b32 s62, v11, 0
    s_cmp_ge_i32 s62, s63
    s_cbranch_scc1 interleave_layers__linear_attn_block__memory_aug_recurrent_mem_tr__prompt_kernel_o_en4_ok
    s_add_u32 s61, s61, 1
    s_cmp_ge_u32 s61, s60
    s_cbranch_scc1 interleave_layers__linear_attn_block__memory_aug_recurrent_mem_tr__prompt_kernel_o_en4_to
    s_sleep 2
    s_branch interleave_layers__linear_attn_block__memory_aug_recurrent_mem_tr__prompt_kernel_o_en4
interleave_layers__linear_attn_block__memory_aug_recurrent_mem_tr__prompt_kernel_o_en4_to:
    s_mov_b32 s60, 1
interleave_layers__linear_attn_block__memory_aug_recurrent_mem_tr__prompt_kernel_o_en4_ok:
    buffer_load_dwordx4 v[16:19], v6, s[8:11], s41 offen offset:0 sc1
    buffer_load_dwordx4 v[20:23], v6, s[8:11], s41 offen offset:1024 sc1
    buffer_load_dwordx4 v[24:27], v6, s[8:11], s41 offen offset:2048 sc1
    buffer_load_dwordx4 v[28:31], v6, s[8:11], s41 offen offset:3072 sc1
    buffer_load_dwordx4 v[32:35], v7, s[8:11], s41 offen offset:0 sc1
    buffer_load_dwordx4 v[36:39], v7, s[8:11], s41 offen offset:1024 sc1
    buffer_load_dwordx4 v[40:43], v7, s[8:11], s41 offen offset:2048 sc1
    buffer_load_dwordx4 v[44:47], v7, s[8:11], s41 offen offset:3072 sc1
    buffer_load_dwordx4 v[48:51], v8, s[8:11], s41 offen offset:0 sc1
    buffer_load_dwordx4 v[52:55], v8, s[8:11], s41 offen offset:1024 sc1
    buffer_load_dwordx4 v[56:59], v8, s[8:11], s41 offen offset:2048 sc1
    buffer_load_dwordx4 v[60:63], v8, s[8:11], s41 offen offset:3072 sc1
    s_add_u32 s41, s41, 393216
    s_waitcnt vmcnt(0)
interleave_layers__linear_attn_block__memory_aug_recurrent_mem_tr__prompt_kernel_of52:
    s_waitcnt vmcnt(10)
    s_add_u32 s40, s40, 1
    s_add_u32 s43, s43, 1310720
    s_cmp_lt_u32 s40, 64
    s_cbranch_scc1 interleave_layers__linear_attn_block__memory_aug_recurrent_mem_tr__prompt_kernel_o_seg
    s_waitcnt vmcnt(0)
    s_barrier
    s_cmp_eq_u32 s3, 0
    s_cbranch_scc0 interleave_layers__linear_attn_block__memory_aug_recurrent_mem_tr__prompt_kernel_fp56
    v_mov_b32 v15, s40
    buffer_store_dword v15, v14, s[8:11], 0 offen sc1
interleave_layers__linear_attn_block__memory_aug_recurrent_mem_tr__prompt_kernel_fp56:
    s_cmp_eq_u32 s92, 0
    s_cbranch_scc0 interleave_layers__linear_attn_block__memory_aug_recurrent_mem_tr__prompt_kernel_end
    s_mov_b32 s92, 1
    s_branch interleave_layers__linear_attn_block__memory_aug_recurrent_mem_tr__prompt_kernel_o_layer
interleave_layers__linear_attn_block__memory_aug_recurrent_mem_tr__prompt_kernel_end:
    s_endpgm
.section .rodata,"a"
.p2align 6
.amdhsa_kernel interleave_layers__linear_attn_block__memory_aug_recurrent_mem_tr__prompt_kernel
  .amdhsa_next_free_vgpr 512
  .amdhsa_next_free_sgpr 100
  .amdhsa_accum_offset 256
  .amdhsa_group_segment_fixed_size 0
  .amdhsa_kernarg_size 104
  .amdhsa_user_sgpr_count 2
  .amdhsa_user_sgpr_kernarg_segment_ptr 1
  .amdhsa_system_sgpr_workgroup_id_x 1
.end_amdhsa_kernel
```

```asm
; @launch kernel=interleave_layers__linear_attn_block__memory_aug_recurrent_mem_tr__prompt_kernel grid=(256,1,1) block=(256,1,1) lds=135168
.amdgcn_target "amdgcn-amd-amdhsa--gfx950"
.text
.globl interleave_layers__linear_attn_block__memory_aug_recurrent_mem_tr__prompt_kernel
.p2align 8
.type interleave_layers__linear_attn_block__memory_aug_recurrent_mem_tr__prompt_kernel,@function
interleave_layers__linear_attn_block__memory_aug_recurrent_mem_tr__prompt_kernel:
    s_cmp_ge_u32 s2, 256
    s_cbranch_scc1 interleave_layers__linear_attn_block__memory_aug_recurrent_mem_tr__prompt_kernel_end
    s_load_dwordx2 s[4:5], s[0:1], 96
    s_load_dwordx2 s[6:7], s[0:1], 88
    s_load_dwordx2 s[24:25], s[0:1], 0
    s_load_dwordx2 s[98:99], s[0:1], 8
    s_and_b32 s44, s2, 7
    s_lshr_b32 s45, s2, 3
    s_and_b32 s26, s44, 3
    s_lshl_b32 s27, s45, 2
    s_add_u32 s26, s26, s27
    s_add_u32 s27, s26, 128
    s_cmp_lt_u32 s26, 104
    s_cselect_b32 s27, s26, s27
    s_add_u32 s26, s26, 104
    s_cmp_lt_u32 s44, 4
    s_cselect_b32 s2, s27, s26
    v_and_b32 v1, 63, v0
    v_lshrrev_b32 v4, 6, v0
    v_and_b32 v2, 15, v1
    v_lshrrev_b32 v3, 4, v1
    v_readfirstlane_b32 s3, v4
    s_mov_b32 s60, 131072
    s_mov_b32 s59, -1
    s_mov_b32 s92, 0
    s_mov_b32 s36, 0
    s_waitcnt lgkmcnt(0)
    s_mov_b32 s8, s4
    s_mov_b32 s9, s5
    s_mov_b32 s10, 268435456
    s_mov_b32 s11, 0x00020000
    s_mov_b32 s72, s6
    s_mov_b32 s73, s7
    s_mov_b32 s74, 256
    s_mov_b32 s75, 0x00020000
    s_mov_b32 s16, s24
    s_mov_b32 s17, s25
    s_mov_b32 s18, 2621440
    s_mov_b32 s19, 0x00020000
    s_cmp_eq_u32 s2, 255
    s_cbranch_scc0 interleave_layers__linear_attn_block__memory_aug_recurrent_mem_tr__prompt_kernel_cf1
    v_lshlrev_b32 v5, 4, v0
    v_mov_b32 v8, -1
    v_mov_b32 v9, -1
    v_mov_b32 v10, -1
    v_mov_b32 v11, -1
    s_mov_b32 s24, 23068672
    buffer_store_dwordx4 v[8:11], v5, s[8:11], s24 offen sc1
    s_add_u32 s24, s24, 4096
    buffer_store_dwordx4 v[8:11], v5, s[8:11], s24 offen sc1
    s_add_u32 s24, s24, 4096
    buffer_store_dwordx4 v[8:11], v5, s[8:11], s24 offen sc1
    s_add_u32 s24, s24, 4096
    buffer_store_dwordx4 v[8:11], v5, s[8:11], s24 offen sc1
    s_add_u32 s24, s24, 4096
    buffer_store_dwordx4 v[8:11], v5, s[8:11], s24 offen sc1
    s_add_u32 s24, s24, 4096
    buffer_store_dwordx4 v[8:11], v5, s[8:11], s24 offen sc1
    s_add_u32 s24, s24, 4096
    buffer_store_dwordx4 v[8:11], v5, s[8:11], s24 offen sc1
    s_add_u32 s24, s24, 4096
    buffer_store_dwordx4 v[8:11], v5, s[8:11], s24 offen sc1
    s_add_u32 s24, s24, 4096
    buffer_store_dwordx4 v[8:11], v5, s[8:11], s24 offen sc1
    s_add_u32 s24, s24, 4096
    buffer_store_dwordx4 v[8:11], v5, s[8:11], s24 offen sc1
    s_add_u32 s24, s24, 4096
    buffer_store_dwordx4 v[8:11], v5, s[8:11], s24 offen sc1
    s_add_u32 s24, s24, 4096
    buffer_store_dwordx4 v[8:11], v5, s[8:11], s24 offen sc1
    s_add_u32 s24, s24, 4096
    buffer_store_dwordx4 v[8:11], v5, s[8:11], s24 offen sc1
    s_add_u32 s24, s24, 4096
    buffer_store_dwordx4 v[8:11], v5, s[8:11], s24 offen sc1
    s_add_u32 s24, s24, 4096
    buffer_store_dwordx4 v[8:11], v5, s[8:11], s24 offen sc1
    s_add_u32 s24, s24, 4096
    buffer_store_dwordx4 v[8:11], v5, s[8:11], s24 offen sc1
    s_add_u32 s24, s24, 4096
interleave_layers__linear_attn_block__memory_aug_recurrent_mem_tr__prompt_kernel_cf1:
    s_mov_b32 s46, 64
    s_mov_b32 s47, 32
    s_mov_b32 s50, 0
    s_lshl_b32 s48, s45, 1
    s_mov_b32 s49, 1
    s_mov_b32 s40, 2
interleave_layers__linear_attn_block__memory_aug_recurrent_mem_tr__prompt_kernel_k1_entry:
    v_and_b32 v7, 31, v0
    v_lshrrev_b32 v8, 5, v0
    v_mul_u32_u24 v152, 3840, v8
    v_lshlrev_b32 v9, 4, v7
    v_add_u32 v152, v152, v9
    v_cmp_le_u32 vcc, 10, v7
    s_nop 1
    v_cndmask_b32 v10, 0, 1, vcc
    v_cmp_le_u32 vcc, 20, v7
    s_nop 1
    v_cndmask_b32 v11, 0, 1, vcc
    v_add_u32 v10, v10, v11
    v_mul_u32_u24 v10, 1120, v10
    v_add_u32 v152, v152, v10
    v_mov_b32 v10, 2146435072
    v_cmp_le_u32 vcc, 30, v7
    s_nop 1
    v_cndmask_b32 v152, v152, v10, vcc
    v_mul_u32_u24 v153, 544, v8
    v_add_u32 v153, v153, v9
    v_add_u32 v153, 40960, v153
    s_mov_b32 s12, s98
    s_mov_b32 s13, s99
    s_mov_b32 s14, 2457600
    s_mov_b32 s15, 0x00020000
    s_mul_i32 s52, s44, 160
    v_lshrrev_b32 v10, 2, v0
    v_mul_u32_u24 v10, 3840, v10
    v_and_b32 v11, 3, v0
    v_lshlrev_b32 v11, 6, v11
    v_min_u32 v11, 156, v11
    v_add_u32 v10, v10, v11
    s_mul_i32 s24, s45, 205
    s_lshr_b32 s24, s24, 11
    s_mul_i32 s24, s24, 10
    s_sub_u32 s24, s45, s24
    s_mul_i32 s24, s24, 245760
    s_add_u32 s24, s24, s52
    buffer_load_dword a254, v10, s[12:15], s24 offen
    s_add_u32 s24, s24, 1280
    buffer_load_dword a254, v10, s[12:15], s24 offen
    s_add_u32 s24, s24, 1280
    buffer_load_dword a254, v10, s[12:15], s24 offen
    s_add_u32 s24, s52, 0
    buffer_load_dwordx4 v[56:59], v152, s[12:15], s24 offen
    s_add_u32 s24, s24, 30720
    buffer_load_dwordx4 v[60:63], v152, s[12:15], s24 offen
    s_add_u32 s24, s24, 30720
    buffer_load_dwordx4 v[64:67], v152, s[12:15], s24 offen
    s_add_u32 s24, s24, 30720
    buffer_load_dwordx4 v[68:71], v152, s[12:15], s24 offen
    s_add_u32 s24, s24, 30720
    buffer_load_dwordx4 v[72:75], v152, s[12:15], s24 offen
    s_add_u32 s24, s24, 30720
    buffer_load_dwordx4 v[76:79], v152, s[12:15], s24 offen
    s_add_u32 s24, s24, 30720
    buffer_load_dwordx4 v[80:83], v152, s[12:15], s24 offen
    s_add_u32 s24, s24, 30720
    buffer_load_dwordx4 v[84:87], v152, s[12:15], s24 offen
    s_add_u32 s24, s52, 245760
    buffer_load_dwordx4 v[88:91], v152, s[12:15], s24 offen
    s_add_u32 s24, s24, 30720
    buffer_load_dwordx4 v[92:95], v152, s[12:15], s24 offen
    s_add_u32 s24, s24, 30720
    buffer_load_dwordx4 v[96:99], v152, s[12:15], s24 offen
    s_add_u32 s24, s24, 30720
    buffer_load_dwordx4 v[100:103], v152, s[12:15], s24 offen
    s_add_u32 s24, s24, 30720
    buffer_load_dwordx4 v[104:107], v152, s[12:15], s24 offen
    s_add_u32 s24, s24, 30720
    buffer_load_dwordx4 v[108:111], v152, s[12:15], s24 offen
    s_add_u32 s24, s24, 30720
    buffer_load_dwordx4 v[112:115], v152, s[12:15], s24 offen
    s_add_u32 s24, s24, 30720
    buffer_load_dwordx4 v[116:119], v152, s[12:15], s24 offen
    s_add_u32 s24, s52, 491520
    buffer_load_dwordx4 v[120:123], v152, s[12:15], s24 offen
    s_add_u32 s24, s24, 30720
    buffer_load_dwordx4 v[124:127], v152, s[12:15], s24 offen
    s_add_u32 s24, s24, 30720
    buffer_load_dwordx4 v[128:131], v152, s[12:15], s24 offen
    s_add_u32 s24, s24, 30720
    buffer_load_dwordx4 v[132:135], v152, s[12:15], s24 offen
    s_add_u32 s24, s24, 30720
    buffer_load_dwordx4 v[136:139], v152, s[12:15], s24 offen
    s_add_u32 s24, s24, 30720
    buffer_load_dwordx4 v[140:143], v152, s[12:15], s24 offen
    s_add_u32 s24, s24, 30720
    buffer_load_dwordx4 v[144:147], v152, s[12:15], s24 offen
    s_add_u32 s24, s24, 30720
    buffer_load_dwordx4 v[148:151], v152, s[12:15], s24 offen
    s_lshr_b32 s24, s3, 1
    s_mul_i32 s24, s24, 20480
    s_and_b32 s25, s3, 1
    s_mul_i32 s25, s25, 10
    s_mul_i32 s25, s25, s46
    s_add_u32 s24, s24, s25
    s_cmp_eq_u32 s50, 1
    s_cselect_b32 s25, 16, 1280
    s_cselect_b32 s26, 256, 8
    v_mul_u32_u24 v4, s25, v2
    v_mul_u32_u24 v5, s26, v3
    v_add3_u32 v4, v4, v5, s24
    v_add_u32 v5, s47, v4
    s_mul_i32 s43, s48, 40960
    s_mul_i32 s42, s49, 40960
    s_cmp_eq_u32 s92, 0
    s_cselect_b32 s51, 1, 0
    s_cselect_b32 s41, s43, 2146435072
    s_mov_b32 s24, s41
    buffer_load_dwordx2 v[16:17], v4, s[16:19], s24 offen
    buffer_load_dwordx2 v[18:19], v5, s[16:19], s24 offen
    s_add_u32 s24, s24, s46
    buffer_load_dwordx2 v[20:21], v4, s[16:19], s24 offen
    buffer_load_dwordx2 v[22:23], v5, s[16:19], s24 offen
    s_add_u32 s24, s24, s46
    buffer_load_dwordx2 v[24:25], v4, s[16:19], s24 offen
    buffer_load_dwordx2 v[26:27], v5, s[16:19], s24 offen
    s_add_u32 s24, s24, s46
    buffer_load_dwordx2 v[28:29], v4, s[16:19], s24 offen
    buffer_load_dwordx2 v[30:31], v5, s[16:19], s24 offen
    s_add_u32 s24, s24, s46
    buffer_load_dwordx2 v[32:33], v4, s[16:19], s24 offen
    buffer_load_dwordx2 v[34:35], v5, s[16:19], s24 offen
    s_add_u32 s24, s24, s46
    buffer_load_dwordx2 v[36:37], v4, s[16:19], s24 offen
    buffer_load_dwordx2 v[38:39], v5, s[16:19], s24 offen
    s_add_u32 s24, s24, s46
    buffer_load_dwordx2 v[40:41], v4, s[16:19], s24 offen
    buffer_load_dwordx2 v[42:43], v5, s[16:19], s24 offen
    s_add_u32 s24, s24, s46
    buffer_load_dwordx2 v[44:45], v4, s[16:19], s24 offen
    buffer_load_dwordx2 v[46:47], v5, s[16:19], s24 offen
    s_add_u32 s24, s24, s46
    buffer_load_dwordx2 v[48:49], v4, s[16:19], s24 offen
    buffer_load_dwordx2 v[50:51], v5, s[16:19], s24 offen
    s_add_u32 s24, s24, s46
    buffer_load_dwordx2 v[52:53], v4, s[16:19], s24 offen
    buffer_load_dwordx2 v[54:55], v5, s[16:19], s24 offen
    v_lshrrev_b32 v6, 2, v2
    v_lshl_add_u32 v6, v3, 2, v6
    v_mul_u32_u24 v6, 544, v6
    v_and_b32 v7, 3, v2
    v_lshl_add_u32 v6, v7, 3, v6
    v_add_u32 v6, 40960, v6
    s_mov_b32 s24, 0
    s_cmp_eq_u32 s3, 1
    s_cselect_b32 s24, 64, s24
    s_cmp_eq_u32 s3, 2
    s_cselect_b32 s24, 128, s24
    s_cmp_eq_u32 s3, 3
    s_cselect_b32 s24, 224, s24
    v_add_u32 v12, s24, v6
    s_mov_b32 s24, 32
    s_cmp_eq_u32 s3, 1
    s_cselect_b32 s24, 96, s24
    s_cmp_eq_u32 s3, 2
    s_cselect_b32 s24, 160, s24
    s_cmp_eq_u32 s3, 3
    s_cselect_b32 s24, 256, s24
    v_add_u32 v13, s24, v6
    s_mov_b32 s24, 320
    s_cmp_eq_u32 s3, 1
    s_cselect_b32 s24, 384, s24
    s_cmp_eq_u32 s3, 2
    s_cselect_b32 s24, 192, s24
    s_cmp_eq_u32 s3, 3
    s_cselect_b32 s24, 288, s24
    v_add_u32 v14, s24, v6
    s_mov_b32 s24, 352
    s_cmp_eq_u32 s3, 1
    s_cselect_b32 s24, 416, s24
    s_cmp_eq_u32 s3, 2
    s_cselect_b32 s24, 448, s24
    s_cmp_eq_u32 s3, 3
    s_cselect_b32 s24, 288, s24
    v_add_u32 v15, s24, v6
    v_mov_b32 v172, 0x3f803f80
    v_mov_b32 v173, 0x3f803f80
    v_mov_b32 v174, 0x3f803f80
    v_mov_b32 v175, 0x3f803f80
    s_waitcnt vmcnt(36)
    ds_write_b128 v153, v[56:59] offset:0
    ds_write_b128 v153, v[60:63] offset:4352
    ds_write_b128 v153, v[64:67] offset:8704
    ds_write_b128 v153, v[68:71] offset:13056
    ds_write_b128 v153, v[72:75] offset:17408
    ds_write_b128 v153, v[76:79] offset:21760
    ds_write_b128 v153, v[80:83] offset:26112
    ds_write_b128 v153, v[84:87] offset:30464
    s_waitcnt lgkmcnt(0)
    s_add_u32 s24, s52, 737280
    buffer_load_dwordx4 v[56:59], v152, s[12:15], s24 offen
    s_add_u32 s24, s24, 30720
    buffer_load_dwordx4 v[60:63], v152, s[12:15], s24 offen
    s_add_u32 s24, s24, 30720
    buffer_load_dwordx4 v[64:67], v152, s[12:15], s24 offen
    s_add_u32 s24, s24, 30720
    buffer_load_dwordx4 v[68:71], v152, s[12:15], s24 offen
    s_add_u32 s24, s24, 30720
    buffer_load_dwordx4 v[72:75], v152, s[12:15], s24 offen
    s_add_u32 s24, s24, 30720
    buffer_load_dwordx4 v[76:79], v152, s[12:15], s24 offen
    s_add_u32 s24, s24, 30720
    buffer_load_dwordx4 v[80:83], v152, s[12:15], s24 offen
    s_add_u32 s24, s24, 30720
    buffer_load_dwordx4 v[84:87], v152, s[12:15], s24 offen
    s_barrier
    ds_read_b64_tr_b16 a[0:1], v12 offset:0
    ds_read_b64_tr_b16 a[2:3], v12 offset:8704
    ds_read_b64_tr_b16 a[4:5], v12 offset:17408
    ds_read_b64_tr_b16 a[6:7], v12 offset:26112
    ds_read_b64_tr_b16 a[80:81], v13 offset:0
    ds_read_b64_tr_b16 a[82:83], v13 offset:8704
    ds_read_b64_tr_b16 a[84:85], v13 offset:17408
    ds_read_b64_tr_b16 a[86:87], v13 offset:26112
    ds_read_b64_tr_b16 a[160:161], v14 offset:0
    ds_read_b64_tr_b16 a[162:163], v14 offset:8704
    ds_read_b64_tr_b16 a[164:165], v14 offset:17408
    ds_read_b64_tr_b16 a[166:167], v14 offset:26112
    ds_read_b64_tr_b16 v[176:177], v15 offset:0
    ds_read_b64_tr_b16 v[178:179], v15 offset:8704
    ds_read_b64_tr_b16 v[180:181], v15 offset:17408
    ds_read_b64_tr_b16 v[182:183], v15 offset:26112
    s_waitcnt vmcnt(36)
    ds_write_b128 v153, v[88:91] offset:34816
    ds_write_b128 v153, v[92:95] offset:39168
    ds_write_b128 v153, v[96:99] offset:43520
    ds_write_b128 v153, v[100:103] offset:47872
    ds_write_b128 v153, v[104:107] offset:52224
    ds_write_b128 v153, v[108:111] offset:56576
    ds_write_b128 v153, v[112:115] offset:60928
    ds_write_b128 v153, v[116:119] offset:65280
    s_waitcnt lgkmcnt(0)
    s_add_u32 s24, s52, 983040
    buffer_load_dwordx4 v[88:91], v152, s[12:15], s24 offen
    s_add_u32 s24, s24, 30720
    buffer_load_dwordx4 v[92:95], v152, s[12:15], s24 offen
    s_add_u32 s24, s24, 30720
    buffer_load_dwordx4 v[96:99], v152, s[12:15], s24 offen
    s_add_u32 s24, s24, 30720
    buffer_load_dwordx4 v[100:103], v152, s[12:15], s24 offen
    s_add_u32 s24, s24, 30720
    buffer_load_dwordx4 v[104:107], v152, s[12:15], s24 offen
    s_add_u32 s24, s24, 30720
    buffer_load_dwordx4 v[108:111], v152, s[12:15], s24 offen
    s_add_u32 s24, s24, 30720
    buffer_load_dwordx4 v[112:115], v152, s[12:15], s24 offen
    s_add_u32 s24, s24, 30720
    buffer_load_dwordx4 v[116:119], v152, s[12:15], s24 offen
    v_mfma_f32_16x16x32_bf16 v[156:159], a[0:3], v[172:175], 0
    v_mfma_f32_16x16x32_bf16 v[160:163], a[80:83], v[172:175], 0
    v_mfma_f32_16x16x32_bf16 v[164:167], a[160:163], v[172:175], 0
    v_mfma_f32_16x16x32_bf16 v[168:171], v[176:179], v[172:175], 0
    v_mfma_f32_16x16x32_bf16 v[156:159], a[4:7], v[172:175], v[156:159]
    v_mfma_f32_16x16x32_bf16 v[160:163], a[84:87], v[172:175], v[160:163]
    v_mfma_f32_16x16x32_bf16 v[164:167], a[164:167], v[172:175], v[164:167]
    v_mfma_f32_16x16x32_bf16 v[168:171], v[180:183], v[172:175], v[168:171]
    s_barrier
    ds_read_b64_tr_b16 a[8:9], v12 offset:34816
    ds_read_b64_tr_b16 a[10:11], v12 offset:43520
    ds_read_b64_tr_b16 a[12:13], v12 offset:52224
    ds_read_b64_tr_b16 a[14:15], v12 offset:60928
    ds_read_b64_tr_b16 a[88:89], v13 offset:34816
    ds_read_b64_tr_b16 a[90:91], v13 offset:43520
    ds_read_b64_tr_b16 a[92:93], v13 offset:52224
    ds_read_b64_tr_b16 a[94:95], v13 offset:60928
    ds_read_b64_tr_b16 a[168:169], v14 offset:34816
    ds_read_b64_tr_b16 a[170:171], v14 offset:43520
    ds_read_b64_tr_b16 a[172:173], v14 offset:52224
    ds_read_b64_tr_b16 a[174:175], v14 offset:60928
    ds_read_b64_tr_b16 v[184:185], v15 offset:34816
    ds_read_b64_tr_b16 v[186:187], v15 offset:43520
    ds_read_b64_tr_b16 v[188:189], v15 offset:52224
    ds_read_b64_tr_b16 v[190:191], v15 offset:60928
    s_waitcnt vmcnt(36)
    ds_write_b128 v153, v[120:123] offset:0
    ds_write_b128 v153, v[124:127] offset:4352
    ds_write_b128 v153, v[128:131] offset:8704
    ds_write_b128 v153, v[132:135] offset:13056
    ds_write_b128 v153, v[136:139] offset:17408
    ds_write_b128 v153, v[140:143] offset:21760
    ds_write_b128 v153, v[144:147] offset:26112
    ds_write_b128 v153, v[148:151] offset:30464
    s_waitcnt lgkmcnt(0)
    s_add_u32 s24, s52, 1228800
    buffer_load_dwordx4 v[120:123], v152, s[12:15], s24 offen
    s_add_u32 s24, s24, 30720
    buffer_load_dwordx4 v[124:127], v152, s[12:15], s24 offen
    s_add_u32 s24, s24, 30720
    buffer_load_dwordx4 v[128:131], v152, s[12:15], s24 offen
    s_add_u32 s24, s24, 30720
    buffer_load_dwordx4 v[132:135], v152, s[12:15], s24 offen
    s_add_u32 s24, s24, 30720
    buffer_load_dwordx4 v[136:139], v152, s[12:15], s24 offen
    s_add_u32 s24, s24, 30720
    buffer_load_dwordx4 v[140:143], v152, s[12:15], s24 offen
    s_add_u32 s24, s24, 30720
    buffer_load_dwordx4 v[144:147], v152, s[12:15], s24 offen
    s_add_u32 s24, s24, 30720
    buffer_load_dwordx4 v[148:151], v152, s[12:15], s24 offen
    v_mfma_f32_16x16x32_bf16 v[156:159], a[8:11], v[172:175], v[156:159]
    v_mfma_f32_16x16x32_bf16 v[160:163], a[88:91], v[172:175], v[160:163]
    v_mfma_f32_16x16x32_bf16 v[164:167], a[168:171], v[172:175], v[164:167]
    v_mfma_f32_16x16x32_bf16 v[168:171], v[184:187], v[172:175], v[168:171]
    v_mfma_f32_16x16x32_bf16 v[156:159], a[12:15], v[172:175], v[156:159]
    v_mfma_f32_16x16x32_bf16 v[160:163], a[92:95], v[172:175], v[160:163]
    v_mfma_f32_16x16x32_bf16 v[164:167], a[172:175], v[172:175], v[164:167]
    v_mfma_f32_16x16x32_bf16 v[168:171], v[188:191], v[172:175], v[168:171]
    s_barrier
    ds_read_b64_tr_b16 a[16:17], v12 offset:0
    ds_read_b64_tr_b16 a[18:19], v12 offset:8704
    ds_read_b64_tr_b16 a[20:21], v12 offset:17408
    ds_read_b64_tr_b16 a[22:23], v12 offset:26112
    ds_read_b64_tr_b16 a[96:97], v13 offset:0
    ds_read_b64_tr_b16 a[98:99], v13 offset:8704
    ds_read_b64_tr_b16 a[100:101], v13 offset:17408
    ds_read_b64_tr_b16 a[102:103], v13 offset:26112
    ds_read_b64_tr_b16 a[176:177], v14 offset:0
    ds_read_b64_tr_b16 a[178:179], v14 offset:8704
    ds_read_b64_tr_b16 a[180:181], v14 offset:17408
    ds_read_b64_tr_b16 a[182:183], v14 offset:26112
    ds_read_b64_tr_b16 v[192:193], v15 offset:0
    ds_read_b64_tr_b16 v[194:195], v15 offset:8704
    ds_read_b64_tr_b16 v[196:197], v15 offset:17408
    ds_read_b64_tr_b16 v[198:199], v15 offset:26112
    s_waitcnt vmcnt(16)
    ds_write_b128 v153, v[56:59] offset:34816
    ds_write_b128 v153, v[60:63] offset:39168
    ds_write_b128 v153, v[64:67] offset:43520
    ds_write_b128 v153, v[68:71] offset:47872
    ds_write_b128 v153, v[72:75] offset:52224
    ds_write_b128 v153, v[76:79] offset:56576
    ds_write_b128 v153, v[80:83] offset:60928
    ds_write_b128 v153, v[84:87] offset:65280
    s_waitcnt lgkmcnt(0)
    s_add_u32 s24, s52, 1474560
    buffer_load_dwordx4 v[56:59], v152, s[12:15], s24 offen
    s_add_u32 s24, s24, 30720
    buffer_load_dwordx4 v[60:63], v152, s[12:15], s24 offen
    s_add_u32 s24, s24, 30720
    buffer_load_dwordx4 v[64:67], v152, s[12:15], s24 offen
    s_add_u32 s24, s24, 30720
    buffer_load_dwordx4 v[68:71], v152, s[12:15], s24 offen
    s_add_u32 s24, s24, 30720
    buffer_load_dwordx4 v[72:75], v152, s[12:15], s24 offen
    s_add_u32 s24, s24, 30720
    buffer_load_dwordx4 v[76:79], v152, s[12:15], s24 offen
    s_add_u32 s24, s24, 30720
    buffer_load_dwordx4 v[80:83], v152, s[12:15], s24 offen
    s_add_u32 s24, s24, 30720
    buffer_load_dwordx4 v[84:87], v152, s[12:15], s24 offen
    v_mfma_f32_16x16x32_bf16 v[156:159], a[16:19], v[172:175], v[156:159]
    v_mfma_f32_16x16x32_bf16 v[160:163], a[96:99], v[172:175], v[160:163]
    v_mfma_f32_16x16x32_bf16 v[164:167], a[176:179], v[172:175], v[164:167]
    v_mfma_f32_16x16x32_bf16 v[168:171], v[192:195], v[172:175], v[168:171]
    v_mfma_f32_16x16x32_bf16 v[156:159], a[20:23], v[172:175], v[156:159]
    v_mfma_f32_16x16x32_bf16 v[160:163], a[100:103], v[172:175], v[160:163]
    v_mfma_f32_16x16x32_bf16 v[164:167], a[180:183], v[172:175], v[164:167]
    v_mfma_f32_16x16x32_bf16 v[168:171], v[196:199], v[172:175], v[168:171]
    s_barrier
    ds_read_b64_tr_b16 a[24:25], v12 offset:34816
    ds_read_b64_tr_b16 a[26:27], v12 offset:43520
    ds_read_b64_tr_b16 a[28:29], v12 offset:52224
    ds_read_b64_tr_b16 a[30:31], v12 offset:60928
    ds_read_b64_tr_b16 a[104:105], v13 offset:34816
    ds_read_b64_tr_b16 a[106:107], v13 offset:43520
    ds_read_b64_tr_b16 a[108:109], v13 offset:52224
    ds_read_b64_tr_b16 a[110:111], v13 offset:60928
    ds_read_b64_tr_b16 a[184:185], v14 offset:34816
    ds_read_b64_tr_b16 a[186:187], v14 offset:43520
    ds_read_b64_tr_b16 a[188:189], v14 offset:52224
    ds_read_b64_tr_b16 a[190:191], v14 offset:60928
    ds_read_b64_tr_b16 v[200:201], v15 offset:34816
    ds_read_b64_tr_b16 v[202:203], v15 offset:43520
    ds_read_b64_tr_b16 v[204:205], v15 offset:52224
    ds_read_b64_tr_b16 v[206:207], v15 offset:60928
    s_waitcnt vmcnt(16)
    ds_write_b128 v153, v[88:91] offset:0
    ds_write_b128 v153, v[92:95] offset:4352
    ds_write_b128 v153, v[96:99] offset:8704
    ds_write_b128 v153, v[100:103] offset:13056
    ds_write_b128 v153, v[104:107] offset:17408
    ds_write_b128 v153, v[108:111] offset:21760
    ds_write_b128 v153, v[112:115] offset:26112
    ds_write_b128 v153, v[116:119] offset:30464
    s_waitcnt lgkmcnt(0)
    s_add_u32 s24, s52, 1720320
    buffer_load_dwordx4 v[88:91], v152, s[12:15], s24 offen
    s_add_u32 s24, s24, 30720
    buffer_load_dwordx4 v[92:95], v152, s[12:15], s24 offen
    s_add_u32 s24, s24, 30720
    buffer_load_dwordx4 v[96:99], v152, s[12:15], s24 offen
    s_add_u32 s24, s24, 30720
    buffer_load_dwordx4 v[100:103], v152, s[12:15], s24 offen
    s_add_u32 s24, s24, 30720
    buffer_load_dwordx4 v[104:107], v152, s[12:15], s24 offen
    s_add_u32 s24, s24, 30720
    buffer_load_dwordx4 v[108:111], v152, s[12:15], s24 offen
    s_add_u32 s24, s24, 30720
    buffer_load_dwordx4 v[112:115], v152, s[12:15], s24 offen
    s_add_u32 s24, s24, 30720
    buffer_load_dwordx4 v[116:119], v152, s[12:15], s24 offen
    v_mfma_f32_16x16x32_bf16 v[156:159], a[24:27], v[172:175], v[156:159]
    v_mfma_f32_16x16x32_bf16 v[160:163], a[104:107], v[172:175], v[160:163]
    v_mfma_f32_16x16x32_bf16 v[164:167], a[184:187], v[172:175], v[164:167]
    v_mfma_f32_16x16x32_bf16 v[168:171], v[200:203], v[172:175], v[168:171]
    v_mfma_f32_16x16x32_bf16 v[156:159], a[28:31], v[172:175], v[156:159]
    v_mfma_f32_16x16x32_bf16 v[160:163], a[108:111], v[172:175], v[160:163]
    v_mfma_f32_16x16x32_bf16 v[164:167], a[188:191], v[172:175], v[164:167]
    v_mfma_f32_16x16x32_bf16 v[168:171], v[204:207], v[172:175], v[168:171]
    s_barrier
    ds_read_b64_tr_b16 a[32:33], v12 offset:0
    ds_read_b64_tr_b16 a[34:35], v12 offset:8704
    ds_read_b64_tr_b16 a[36:37], v12 offset:17408
    ds_read_b64_tr_b16 a[38:39], v12 offset:26112
    ds_read_b64_tr_b16 a[112:113], v13 offset:0
    ds_read_b64_tr_b16 a[114:115], v13 offset:8704
    ds_read_b64_tr_b16 a[116:117], v13 offset:17408
    ds_read_b64_tr_b16 a[118:119], v13 offset:26112
    ds_read_b64_tr_b16 a[192:193], v14 offset:0
    ds_read_b64_tr_b16 a[194:195], v14 offset:8704
    ds_read_b64_tr_b16 a[196:197], v14 offset:17408
    ds_read_b64_tr_b16 a[198:199], v14 offset:26112
    ds_read_b64_tr_b16 v[208:209], v15 offset:0
    ds_read_b64_tr_b16 v[210:211], v15 offset:8704
    ds_read_b64_tr_b16 v[212:213], v15 offset:17408
    ds_read_b64_tr_b16 v[214:215], v15 offset:26112
    s_waitcnt vmcnt(16)
    ds_write_b128 v153, v[120:123] offset:34816
    ds_write_b128 v153, v[124:127] offset:39168
    ds_write_b128 v153, v[128:131] offset:43520
    ds_write_b128 v153, v[132:135] offset:47872
    ds_write_b128 v153, v[136:139] offset:52224
    ds_write_b128 v153, v[140:143] offset:56576
    ds_write_b128 v153, v[144:147] offset:60928
    ds_write_b128 v153, v[148:151] offset:65280
    s_waitcnt lgkmcnt(0)
    s_add_u32 s24, s52, 1966080
    buffer_load_dwordx4 v[120:123], v152, s[12:15], s24 offen
    s_add_u32 s24, s24, 30720
    buffer_load_dwordx4 v[124:127], v152, s[12:15], s24 offen
    s_add_u32 s24, s24, 30720
    buffer_load_dwordx4 v[128:131], v152, s[12:15], s24 offen
    s_add_u32 s24, s24, 30720
    buffer_load_dwordx4 v[132:135], v152, s[12:15], s24 offen
    s_add_u32 s24, s24, 30720
    buffer_load_dwordx4 v[136:139], v152, s[12:15], s24 offen
    s_add_u32 s24, s24, 30720
    buffer_load_dwordx4 v[140:143], v152, s[12:15], s24 offen
    s_add_u32 s24, s24, 30720
    buffer_load_dwordx4 v[144:147], v152, s[12:15], s24 offen
    s_add_u32 s24, s24, 30720
    buffer_load_dwordx4 v[148:151], v152, s[12:15], s24 offen
    v_mfma_f32_16x16x32_bf16 v[156:159], a[32:35], v[172:175], v[156:159]
    v_mfma_f32_16x16x32_bf16 v[160:163], a[112:115], v[172:175], v[160:163]
    v_mfma_f32_16x16x32_bf16 v[164:167], a[192:195], v[172:175], v[164:167]
    v_mfma_f32_16x16x32_bf16 v[168:171], v[208:211], v[172:175], v[168:171]
    v_mfma_f32_16x16x32_bf16 v[156:159], a[36:39], v[172:175], v[156:159]
    v_mfma_f32_16x16x32_bf16 v[160:163], a[116:119], v[172:175], v[160:163]
    v_mfma_f32_16x16x32_bf16 v[164:167], a[196:199], v[172:175], v[164:167]
    v_mfma_f32_16x16x32_bf16 v[168:171], v[212:215], v[172:175], v[168:171]
    s_barrier
    ds_read_b64_tr_b16 a[40:41], v12 offset:34816
    ds_read_b64_tr_b16 a[42:43], v12 offset:43520
    ds_read_b64_tr_b16 a[44:45], v12 offset:52224
    ds_read_b64_tr_b16 a[46:47], v12 offset:60928
    ds_read_b64_tr_b16 a[120:121], v13 offset:34816
    ds_read_b64_tr_b16 a[122:123], v13 offset:43520
    ds_read_b64_tr_b16 a[124:125], v13 offset:52224
    ds_read_b64_tr_b16 a[126:127], v13 offset:60928
    ds_read_b64_tr_b16 a[200:201], v14 offset:34816
    ds_read_b64_tr_b16 a[202:203], v14 offset:43520
    ds_read_b64_tr_b16 a[204:205], v14 offset:52224
    ds_read_b64_tr_b16 a[206:207], v14 offset:60928
    ds_read_b64_tr_b16 v[216:217], v15 offset:34816
    ds_read_b64_tr_b16 v[218:219], v15 offset:43520
    ds_read_b64_tr_b16 v[220:221], v15 offset:52224
    ds_read_b64_tr_b16 v[222:223], v15 offset:60928
    s_waitcnt vmcnt(16)
    ds_write_b128 v153, v[56:59] offset:0
    ds_write_b128 v153, v[60:63] offset:4352
    ds_write_b128 v153, v[64:67] offset:8704
    ds_write_b128 v153, v[68:71] offset:13056
    ds_write_b128 v153, v[72:75] offset:17408
    ds_write_b128 v153, v[76:79] offset:21760
    ds_write_b128 v153, v[80:83] offset:26112
    ds_write_b128 v153, v[84:87] offset:30464
    s_waitcnt lgkmcnt(0)
    s_add_u32 s24, s52, 2211840
    buffer_load_dwordx4 v[56:59], v152, s[12:15], s24 offen
    s_add_u32 s24, s24, 30720
    buffer_load_dwordx4 v[60:63], v152, s[12:15], s24 offen
    s_add_u32 s24, s24, 30720
    buffer_load_dwordx4 v[64:67], v152, s[12:15], s24 offen
    s_add_u32 s24, s24, 30720
    buffer_load_dwordx4 v[68:71], v152, s[12:15], s24 offen
    s_add_u32 s24, s24, 30720
    buffer_load_dwordx4 v[72:75], v152, s[12:15], s24 offen
    s_add_u32 s24, s24, 30720
    buffer_load_dwordx4 v[76:79], v152, s[12:15], s24 offen
    s_add_u32 s24, s24, 30720
    buffer_load_dwordx4 v[80:83], v152, s[12:15], s24 offen
    s_add_u32 s24, s24, 30720
    buffer_load_dwordx4 v[84:87], v152, s[12:15], s24 offen
    v_mfma_f32_16x16x32_bf16 v[156:159], a[40:43], v[172:175], v[156:159]
    v_mfma_f32_16x16x32_bf16 v[160:163], a[120:123], v[172:175], v[160:163]
    v_mfma_f32_16x16x32_bf16 v[164:167], a[200:203], v[172:175], v[164:167]
    v_mfma_f32_16x16x32_bf16 v[168:171], v[216:219], v[172:175], v[168:171]
    v_mfma_f32_16x16x32_bf16 v[156:159], a[44:47], v[172:175], v[156:159]
    v_mfma_f32_16x16x32_bf16 v[160:163], a[124:127], v[172:175], v[160:163]
    v_mfma_f32_16x16x32_bf16 v[164:167], a[204:207], v[172:175], v[164:167]
    v_mfma_f32_16x16x32_bf16 v[168:171], v[220:223], v[172:175], v[168:171]
    s_barrier
    ds_read_b64_tr_b16 a[48:49], v12 offset:0
    ds_read_b64_tr_b16 a[50:51], v12 offset:8704
    ds_read_b64_tr_b16 a[52:53], v12 offset:17408
    ds_read_b64_tr_b16 a[54:55], v12 offset:26112
    ds_read_b64_tr_b16 a[128:129], v13 offset:0
    ds_read_b64_tr_b16 a[130:131], v13 offset:8704
    ds_read_b64_tr_b16 a[132:133], v13 offset:17408
    ds_read_b64_tr_b16 a[134:135], v13 offset:26112
    ds_read_b64_tr_b16 a[208:209], v14 offset:0
    ds_read_b64_tr_b16 a[210:211], v14 offset:8704
    ds_read_b64_tr_b16 a[212:213], v14 offset:17408
    ds_read_b64_tr_b16 a[214:215], v14 offset:26112
    ds_read_b64_tr_b16 v[224:225], v15 offset:0
    ds_read_b64_tr_b16 v[226:227], v15 offset:8704
    ds_read_b64_tr_b16 v[228:229], v15 offset:17408
    ds_read_b64_tr_b16 v[230:231], v15 offset:26112
    s_waitcnt vmcnt(16)
    ds_write_b128 v153, v[88:91] offset:34816
    ds_write_b128 v153, v[92:95] offset:39168
    ds_write_b128 v153, v[96:99] offset:43520
    ds_write_b128 v153, v[100:103] offset:47872
    ds_write_b128 v153, v[104:107] offset:52224
    ds_write_b128 v153, v[108:111] offset:56576
    ds_write_b128 v153, v[112:115] offset:60928
    ds_write_b128 v153, v[116:119] offset:65280
    s_waitcnt lgkmcnt(0)
    v_mfma_f32_16x16x32_bf16 v[156:159], a[48:51], v[172:175], v[156:159]
    v_mfma_f32_16x16x32_bf16 v[160:163], a[128:131], v[172:175], v[160:163]
    v_mfma_f32_16x16x32_bf16 v[164:167], a[208:211], v[172:175], v[164:167]
    v_mfma_f32_16x16x32_bf16 v[168:171], v[224:227], v[172:175], v[168:171]
    v_mfma_f32_16x16x32_bf16 v[156:159], a[52:55], v[172:175], v[156:159]
    v_mfma_f32_16x16x32_bf16 v[160:163], a[132:135], v[172:175], v[160:163]
    v_mfma_f32_16x16x32_bf16 v[164:167], a[212:215], v[172:175], v[164:167]
    v_mfma_f32_16x16x32_bf16 v[168:171], v[228:231], v[172:175], v[168:171]
    s_barrier
    ds_read_b64_tr_b16 a[56:57], v12 offset:34816
    ds_read_b64_tr_b16 a[58:59], v12 offset:43520
    ds_read_b64_tr_b16 a[60:61], v12 offset:52224
    ds_read_b64_tr_b16 a[62:63], v12 offset:60928
    ds_read_b64_tr_b16 a[136:137], v13 offset:34816
    ds_read_b64_tr_b16 a[138:139], v13 offset:43520
    ds_read_b64_tr_b16 a[140:141], v13 offset:52224
    ds_read_b64_tr_b16 a[142:143], v13 offset:60928
    ds_read_b64_tr_b16 a[216:217], v14 offset:34816
    ds_read_b64_tr_b16 a[218:219], v14 offset:43520
    ds_read_b64_tr_b16 a[220:221], v14 offset:52224
    ds_read_b64_tr_b16 a[222:223], v14 offset:60928
    ds_read_b64_tr_b16 v[232:233], v15 offset:34816
    ds_read_b64_tr_b16 v[234:235], v15 offset:43520
    ds_read_b64_tr_b16 v[236:237], v15 offset:52224
    ds_read_b64_tr_b16 v[238:239], v15 offset:60928
    s_waitcnt vmcnt(8)
    ds_write_b128 v153, v[120:123] offset:0
    ds_write_b128 v153, v[124:127] offset:4352
    ds_write_b128 v153, v[128:131] offset:8704
    ds_write_b128 v153, v[132:135] offset:13056
    ds_write_b128 v153, v[136:139] offset:17408
    ds_write_b128 v153, v[140:143] offset:21760
    ds_write_b128 v153, v[144:147] offset:26112
    ds_write_b128 v153, v[148:151] offset:30464
    s_waitcnt lgkmcnt(0)
    v_mfma_f32_16x16x32_bf16 v[156:159], a[56:59], v[172:175], v[156:159]
    v_mfma_f32_16x16x32_bf16 v[160:163], a[136:139], v[172:175], v[160:163]
    v_mfma_f32_16x16x32_bf16 v[164:167], a[216:219], v[172:175], v[164:167]
    v_mfma_f32_16x16x32_bf16 v[168:171], v[232:235], v[172:175], v[168:171]
    v_mfma_f32_16x16x32_bf16 v[156:159], a[60:63], v[172:175], v[156:159]
    v_mfma_f32_16x16x32_bf16 v[160:163], a[140:143], v[172:175], v[160:163]
    v_mfma_f32_16x16x32_bf16 v[164:167], a[220:223], v[172:175], v[164:167]
    v_mfma_f32_16x16x32_bf16 v[168:171], v[236:239], v[172:175], v[168:171]
    s_barrier
    ds_read_b64_tr_b16 a[64:65], v12 offset:0
    ds_read_b64_tr_b16 a[66:67], v12 offset:8704
    ds_read_b64_tr_b16 a[68:69], v12 offset:17408
    ds_read_b64_tr_b16 a[70:71], v12 offset:26112
    ds_read_b64_tr_b16 a[144:145], v13 offset:0
    ds_read_b64_tr_b16 a[146:147], v13 offset:8704
    ds_read_b64_tr_b16 a[148:149], v13 offset:17408
    ds_read_b64_tr_b16 a[150:151], v13 offset:26112
    ds_read_b64_tr_b16 a[224:225], v14 offset:0
    ds_read_b64_tr_b16 a[226:227], v14 offset:8704
    ds_read_b64_tr_b16 a[228:229], v14 offset:17408
    ds_read_b64_tr_b16 a[230:231], v14 offset:26112
    ds_read_b64_tr_b16 v[240:241], v15 offset:0
    ds_read_b64_tr_b16 v[242:243], v15 offset:8704
    ds_read_b64_tr_b16 v[244:245], v15 offset:17408
    ds_read_b64_tr_b16 v[246:247], v15 offset:26112
    s_waitcnt vmcnt(0)
    ds_write_b128 v153, v[56:59] offset:34816
    ds_write_b128 v153, v[60:63] offset:39168
    ds_write_b128 v153, v[64:67] offset:43520
    ds_write_b128 v153, v[68:71] offset:47872
    ds_write_b128 v153, v[72:75] offset:52224
    ds_write_b128 v153, v[76:79] offset:56576
    ds_write_b128 v153, v[80:83] offset:60928
    ds_write_b128 v153, v[84:87] offset:65280
    s_waitcnt lgkmcnt(0)
    v_mfma_f32_16x16x32_bf16 v[156:159], a[64:67], v[172:175], v[156:159]
    v_mfma_f32_16x16x32_bf16 v[160:163], a[144:147], v[172:175], v[160:163]
    v_mfma_f32_16x16x32_bf16 v[164:167], a[224:227], v[172:175], v[164:167]
    v_mfma_f32_16x16x32_bf16 v[168:171], v[240:243], v[172:175], v[168:171]
    v_mfma_f32_16x16x32_bf16 v[156:159], a[68:71], v[172:175], v[156:159]
    v_mfma_f32_16x16x32_bf16 v[160:163], a[148:151], v[172:175], v[160:163]
    v_mfma_f32_16x16x32_bf16 v[164:167], a[228:231], v[172:175], v[164:167]
    v_mfma_f32_16x16x32_bf16 v[168:171], v[244:247], v[172:175], v[168:171]
    s_barrier
    ds_read_b64_tr_b16 a[72:73], v12 offset:34816
    ds_read_b64_tr_b16 a[74:75], v12 offset:43520
    ds_read_b64_tr_b16 a[76:77], v12 offset:52224
    ds_read_b64_tr_b16 a[78:79], v12 offset:60928
    ds_read_b64_tr_b16 a[152:153], v13 offset:34816
    ds_read_b64_tr_b16 a[154:155], v13 offset:43520
    ds_read_b64_tr_b16 a[156:157], v13 offset:52224
    ds_read_b64_tr_b16 a[158:159], v13 offset:60928
    ds_read_b64_tr_b16 a[232:233], v14 offset:34816
    ds_read_b64_tr_b16 a[234:235], v14 offset:43520
    ds_read_b64_tr_b16 a[236:237], v14 offset:52224
    ds_read_b64_tr_b16 a[238:239], v14 offset:60928
    ds_read_b64_tr_b16 v[248:249], v15 offset:34816
    ds_read_b64_tr_b16 v[250:251], v15 offset:43520
    ds_read_b64_tr_b16 v[252:253], v15 offset:52224
    ds_read_b64_tr_b16 v[254:255], v15 offset:60928
    s_cmp_eq_u32 s2, 255
    s_cbranch_scc0 interleave_layers__linear_attn_block__memory_aug_recurrent_mem_tr__prompt_kernel_fb2
    s_cmp_eq_u32 s92, 0
    s_cbranch_scc0 interleave_layers__linear_attn_block__memory_aug_recurrent_mem_tr__prompt_kernel_fb2
    s_waitcnt vmcnt(0)
    s_lshl_b32 s24, s3, 9
    s_add_u32 s24, s24, 118423552
    v_mov_b32 v154, 0
    s_lshl_b32 s27, s3, 3
    s_add_u32 s27, s27, 131072
    s_barrier
    s_mov_b32 s25, -1
    s_mov_b64 exec, 1
    v_mov_b32 v155, 0
    s_memtime s[28:29]
    s_waitcnt lgkmcnt(0)
    buffer_atomic_add v155, v154, s[8:11], s24 offen offset:0 sc0
    s_waitcnt vmcnt(0)
    s_memtime s[30:31]
    s_waitcnt lgkmcnt(0)
    s_sub_u32 s30, s30, s28
    s_min_u32 s25, s25, s30
    v_mov_b32 v155, 0
    s_memtime s[28:29]
    s_waitcnt lgkmcnt(0)
    buffer_atomic_add v155, v154, s[8:11], s24 offen offset:128 sc0
    s_waitcnt vmcnt(0)
    s_memtime s[30:31]
    s_waitcnt lgkmcnt(0)
    s_sub_u32 s30, s30, s28
    s_min_u32 s25, s25, s30
    v_mov_b32 v155, 0
    s_memtime s[28:29]
    s_waitcnt lgkmcnt(0)
    buffer_atomic_add v155, v154, s[8:11], s24 offen offset:256 sc0
    s_waitcnt vmcnt(0)
    s_memtime s[30:31]
    s_waitcnt lgkmcnt(0)
    s_sub_u32 s30, s30, s28
    s_min_u32 s25, s25, s30
    v_mov_b32 v148, s27
    v_mov_b32 v155, s25
    ds_write_b32 v148, v155 offset:0
    s_mov_b64 exec, -1
    s_add_u32 s24, s24, 0x2000
    s_barrier
    s_mov_b32 s25, -1
    s_mov_b64 exec, 1
    v_mov_b32 v155, 0
    s_memtime s[28:29]
    s_waitcnt lgkmcnt(0)
    buffer_atomic_add v155, v154, s[8:11], s24 offen offset:0 sc0
    s_waitcnt vmcnt(0)
    s_memtime s[30:31]
    s_waitcnt lgkmcnt(0)
    s_sub_u32 s30, s30, s28
    s_min_u32 s25, s25, s30
    v_mov_b32 v155, 0
    s_memtime s[28:29]
    s_waitcnt lgkmcnt(0)
    buffer_atomic_add v155, v154, s[8:11], s24 offen offset:128 sc0
    s_waitcnt vmcnt(0)
    s_memtime s[30:31]
    s_waitcnt lgkmcnt(0)
    s_sub_u32 s30, s30, s28
    s_min_u32 s25, s25, s30
    v_mov_b32 v155, 0
    s_memtime s[28:29]
    s_waitcnt lgkmcnt(0)
    buffer_atomic_add v155, v154, s[8:11], s24 offen offset:256 sc0
    s_waitcnt vmcnt(0)
    s_memtime s[30:31]
    s_waitcnt lgkmcnt(0)
    s_sub_u32 s30, s30, s28
    s_min_u32 s25, s25, s30
    v_mov_b32 v148, s27
    v_mov_b32 v155, s25
    ds_write_b32 v148, v155 offset:4
    s_mov_b64 exec, -1
    s_add_u32 s24, s24, 0x2000
    s_waitcnt lgkmcnt(0)
    s_barrier
    v_mov_b32 v154, 131072
    ds_read_b128 v[148:151], v154
    ds_read_b128 v[152:155], v154 offset:16
    s_waitcnt lgkmcnt(0)
    v_min_u32 v148, v148, v152
    v_min_u32 v149, v149, v153
    v_min_u32 v150, v150, v154
    v_min_u32 v151, v151, v155
    v_min_u32 v148, v148, v150
    v_min_u32 v149, v149, v151
    v_cmp_lt_u32 vcc, v149, v148
    s_nop 1
    v_cndmask_b32 v155, 1, 2, vcc
    s_cmp_eq_u32 s3, 0
    s_cbranch_scc0 interleave_layers__linear_attn_block__memory_aug_recurrent_mem_tr__prompt_kernel_fb2
    v_mov_b32 v154, 2146435072
    v_cmp_eq_u32 vcc, 0, v1
    s_nop 1
    v_cndmask_b32 v154, v154, 0, vcc
    buffer_store_dword v155, v154, s[72:75], 0 offen sc1
interleave_layers__linear_attn_block__memory_aug_recurrent_mem_tr__prompt_kernel_fb2:
    v_lshlrev_b32 v7, 4, v1
    s_lshr_b32 s24, s3, 1
    s_mul_i32 s24, s24, 20
    s_and_b32 s25, s3, 1
    s_mul_i32 s25, s25, 10
    s_add_u32 s24, s24, s25
    s_lshl_b32 s24, s24, 10
    v_add_u32 v6, s24, v7
    s_lshr_b32 s24, s3, 1
    s_lshl_b32 s24, s24, 8
    s_and_b32 s25, s3, 1
    s_lshl_b32 s25, s25, 3
    s_add_u32 s24, s24, s25
    s_add_u32 s24, s24, 51712
    v_lshlrev_b32 v9, 4, v2
    v_add_u32 v8, s24, v9
    v_add_u32 v9, 51712, v9
    v_mul_u32_u24 v10, 336, v2
    v_lshl_add_u32 v10, v3, 3, v10
    v_add_u32 v10, 40960, v10
    v_lshrrev_b32 v11, 2, v2
    v_lshl_add_u32 v11, v3, 3, v11
    v_mul_u32_u24 v11, 336, v11
    v_and_b32 v15, 3, v2
    v_lshl_add_u32 v11, v15, 3, v11
    s_lshl_b32 s24, s3, 5
    s_add_u32 s24, s24, 40960
    v_add_u32 v11, s24, v11
    s_lshl_b32 s24, s3, 10
    v_add_u32 v12, s24, v7
    v_lshlrev_b32 v15, 3, v1
    v_add_u32 v15, 2048, v15
    s_cmp_eq_u32 s3, 2
    s_cselect_b64 vcc, -1, 0
    v_cndmask_b32 v12, v12, v15, vcc
    s_mul_i32 s24, s44, 2560
    s_add_u32 s24, s24, 12582912
    v_add_u32 v12, s24, v12
    s_mov_b32 s52, 0x3fb8aa3b
    s_mov_b32 s53, s52
    s_mov_b32 s54, 0x358637bd
    s_mov_b32 s55, s54
    v_mov_b32 v120, 0
    v_mov_b32 v121, 0
    v_mov_b32 v122, 0
    v_mov_b32 v123, 0
    v_mov_b32 v124, 0
    v_mov_b32 v125, 0
    v_mov_b32 v126, 0
    v_mov_b32 v127, 0
    v_mov_b32 v128, 0
    v_mov_b32 v129, 0
    v_mov_b32 v130, 0
    v_mov_b32 v131, 0
    v_mov_b32 v132, 0
    v_mov_b32 v133, 0
    v_mov_b32 v134, 0
    v_mov_b32 v135, 0
    v_mov_b32 v136, 0
    v_mov_b32 v137, 0
    v_mov_b32 v138, 0
    v_mov_b32 v139, 0
    v_mov_b32 v140, 0
    v_mov_b32 v141, 0
    v_mov_b32 v142, 0
    v_mov_b32 v143, 0
    s_waitcnt lgkmcnt(0)
    v_mfma_f32_16x16x32_bf16 v[156:159], a[72:75], v[172:175], v[156:159]
    v_mfma_f32_16x16x32_bf16 v[160:163], a[152:155], v[172:175], v[160:163]
    v_mfma_f32_16x16x32_bf16 v[164:167], a[232:235], v[172:175], v[164:167]
    v_mfma_f32_16x16x32_bf16 v[168:171], v[248:251], v[172:175], v[168:171]
    v_mfma_f32_16x16x32_bf16 v[156:159], a[76:79], v[172:175], v[156:159]
    v_mfma_f32_16x16x32_bf16 v[160:163], a[156:159], v[172:175], v[160:163]
    v_mfma_f32_16x16x32_bf16 v[164:167], a[236:239], v[172:175], v[164:167]
    v_mfma_f32_16x16x32_bf16 v[168:171], v[252:255], v[172:175], v[168:171]
    s_mov_b32 s56, 1
interleave_layers__linear_attn_block__memory_aug_recurrent_mem_tr__prompt_kernel_k1_seg:
    s_cmp_eq_u32 s51, 1
    s_cbranch_scc1 interleave_layers__linear_attn_block__memory_aug_recurrent_mem_tr__prompt_kernel_k13
    s_and_b32 s24, s48, 3
    s_lshl_b32 s24, s24, 7
    s_add_u32 s24, s24, 23107584
    v_lshlrev_b32 v15, 2, v1
    v_add_u32 v15, s24, v15
    s_lshr_b32 s95, s48, 2
    s_add_u32 s95, s95, 1
    s_mov_b32 s61, 0
interleave_layers__linear_attn_block__memory_aug_recurrent_mem_tr__prompt_kernel_k1_wx:
    buffer_load_dword v14, v15, s[8:11], 0 offen sc1
    s_waitcnt vmcnt(0)
    v_cmp_le_i32 vcc, s95, v14
    s_mov_b32 s25, 0xfffff
    s_and_b32 s24, vcc_lo, s25
    s_cmp_eq_u32 s24, s25
    s_cbranch_scc1 interleave_layers__linear_attn_block__memory_aug_recurrent_mem_tr__prompt_kernel_k1_wx_ok
    s_add_u32 s61, s61, 1
    s_cmp_ge_u32 s61, s60
    s_cbranch_scc1 interleave_layers__linear_attn_block__memory_aug_recurrent_mem_tr__prompt_kernel_k1_wx_to
    s_sleep 4
    s_branch interleave_layers__linear_attn_block__memory_aug_recurrent_mem_tr__prompt_kernel_k1_wx
interleave_layers__linear_attn_block__memory_aug_recurrent_mem_tr__prompt_kernel_k1_wx_to:
    s_mov_b32 s60, 1
interleave_layers__linear_attn_block__memory_aug_recurrent_mem_tr__prompt_kernel_k1_wx_ok:
    s_mov_b32 s41, s43
    s_mov_b32 s24, s41
    buffer_load_dwordx4 v[16:19], v4, s[16:19], s24 offen sc1
    s_add_u32 s24, s24, s46
    buffer_load_dwordx4 v[20:23], v4, s[16:19], s24 offen sc1
    s_add_u32 s24, s24, s46
    buffer_load_dwordx4 v[24:27], v4, s[16:19], s24 offen sc1
    s_add_u32 s24, s24, s46
    buffer_load_dwordx4 v[28:31], v4, s[16:19], s24 offen sc1
    s_add_u32 s24, s24, s46
    buffer_load_dwordx4 v[32:35], v4, s[16:19], s24 offen sc1
    s_add_u32 s24, s24, s46
    buffer_load_dwordx4 v[36:39], v4, s[16:19], s24 offen sc1
    s_add_u32 s24, s24, s46
    buffer_load_dwordx4 v[40:43], v4, s[16:19], s24 offen sc1
    s_add_u32 s24, s24, s46
    buffer_load_dwordx4 v[44:47], v4, s[16:19], s24 offen sc1
    s_add_u32 s24, s24, s46
    buffer_load_dwordx4 v[48:51], v4, s[16:19], s24 offen sc1
    s_add_u32 s24, s24, s46
    buffer_load_dwordx4 v[52:55], v4, s[16:19], s24 offen sc1
    s_mul_i32 s24, s49, 1
    s_add_u32 s24, s24, s48
    s_and_b32 s24, s24, 3
    s_lshl_b32 s24, s24, 7
    s_add_u32 s24, s24, 23107584
    v_lshlrev_b32 v15, 2, v1
    v_add_u32 v15, s24, v15
    buffer_load_dword v13, v15, s[8:11], 0 offen sc1
interleave_layers__linear_attn_block__memory_aug_recurrent_mem_tr__prompt_kernel_k13:
    s_cmp_eq_u32 s92, 0
    s_cselect_b32 s24, s56, 0
    s_cmp_eq_u32 s24, 1
    s_cbranch_scc1 interleave_layers__linear_attn_block__memory_aug_recurrent_mem_tr__prompt_kernel_k1w4
    s_waitcnt vmcnt(0)
interleave_layers__linear_attn_block__memory_aug_recurrent_mem_tr__prompt_kernel_k1w4:
    s_mov_b32 s56, 0
    v_mov_b32 v148, 0
    v_mov_b32 v149, 0
    v_mov_b32 v150, 0
    v_mov_b32 v151, 0
    v_dot2c_f32_bf16 v148, v16, v172
    v_dot2c_f32_bf16 v149, v16, v16
    v_dot2c_f32_bf16 v150, v17, v172
    v_dot2c_f32_bf16 v151, v17, v17
    v_dot2c_f32_bf16 v148, v18, v172
    v_dot2c_f32_bf16 v149, v18, v18
    v_dot2c_f32_bf16 v150, v19, v172
    v_dot2c_f32_bf16 v151, v19, v19
    v_dot2c_f32_bf16 v148, v20, v172
    v_dot2c_f32_bf16 v149, v20, v20
    v_dot2c_f32_bf16 v150, v21, v172
    v_dot2c_f32_bf16 v151, v21, v21
    v_dot2c_f32_bf16 v148, v22, v172
    v_dot2c_f32_bf16 v149, v22, v22
    v_dot2c_f32_bf16 v150, v23, v172
    v_dot2c_f32_bf16 v151, v23, v23
    v_dot2c_f32_bf16 v148, v24, v172
    v_dot2c_f32_bf16 v149, v24, v24
    v_dot2c_f32_bf16 v150, v25, v172
    v_dot2c_f32_bf16 v151, v25, v25
    v_dot2c_f32_bf16 v148, v26, v172
    v_dot2c_f32_bf16 v149, v26, v26
    v_dot2c_f32_bf16 v150, v27, v172
    v_dot2c_f32_bf16 v151, v27, v27
    v_dot2c_f32_bf16 v148, v28, v172
    v_dot2c_f32_bf16 v149, v28, v28
    v_dot2c_f32_bf16 v150, v29, v172
    v_dot2c_f32_bf16 v151, v29, v29
    v_dot2c_f32_bf16 v148, v30, v172
    v_dot2c_f32_bf16 v149, v30, v30
    v_dot2c_f32_bf16 v150, v31, v172
    v_dot2c_f32_bf16 v151, v31, v31
    v_dot2c_f32_bf16 v148, v32, v172
    v_dot2c_f32_bf16 v149, v32, v32
    v_dot2c_f32_bf16 v150, v33, v172
    v_dot2c_f32_bf16 v151, v33, v33
    v_dot2c_f32_bf16 v148, v34, v172
    v_dot2c_f32_bf16 v149, v34, v34
    v_dot2c_f32_bf16 v150, v35, v172
    v_dot2c_f32_bf16 v151, v35, v35
    v_dot2c_f32_bf16 v148, v36, v172
    v_dot2c_f32_bf16 v149, v36, v36
    v_dot2c_f32_bf16 v150, v37, v172
    v_dot2c_f32_bf16 v151, v37, v37
    v_dot2c_f32_bf16 v148, v38, v172
    v_dot2c_f32_bf16 v149, v38, v38
    v_dot2c_f32_bf16 v150, v39, v172
    v_dot2c_f32_bf16 v151, v39, v39
    v_dot2c_f32_bf16 v148, v40, v172
    v_dot2c_f32_bf16 v149, v40, v40
    v_dot2c_f32_bf16 v150, v41, v172
    v_dot2c_f32_bf16 v151, v41, v41
    v_dot2c_f32_bf16 v148, v42, v172
    v_dot2c_f32_bf16 v149, v42, v42
    v_dot2c_f32_bf16 v150, v43, v172
    v_dot2c_f32_bf16 v151, v43, v43
    v_dot2c_f32_bf16 v148, v44, v172
    v_dot2c_f32_bf16 v149, v44, v44
    v_dot2c_f32_bf16 v150, v45, v172
    v_dot2c_f32_bf16 v151, v45, v45
    v_dot2c_f32_bf16 v148, v46, v172
    v_dot2c_f32_bf16 v149, v46, v46
    v_dot2c_f32_bf16 v150, v47, v172
    v_dot2c_f32_bf16 v151, v47, v47
    v_dot2c_f32_bf16 v148, v48, v172
    v_dot2c_f32_bf16 v149, v48, v48
    v_dot2c_f32_bf16 v150, v49, v172
    v_dot2c_f32_bf16 v151, v49, v49
    v_dot2c_f32_bf16 v148, v50, v172
    v_dot2c_f32_bf16 v149, v50, v50
    v_dot2c_f32_bf16 v150, v51, v172
    v_dot2c_f32_bf16 v151, v51, v51
    v_dot2c_f32_bf16 v148, v52, v172
    v_dot2c_f32_bf16 v149, v52, v52
    v_dot2c_f32_bf16 v150, v53, v172
    v_dot2c_f32_bf16 v151, v53, v53
    v_dot2c_f32_bf16 v148, v54, v172
    v_dot2c_f32_bf16 v149, v54, v54
    v_dot2c_f32_bf16 v150, v55, v172
    v_dot2c_f32_bf16 v151, v55, v55
    s_nop 1
    v_add_f32 v148, v148, v150
    v_add_f32 v149, v149, v151
    v_mov_b32 v150, v148
    v_mov_b32 v151, v149
    s_nop 0
    v_permlane16_swap_b32 v148, v150
    v_permlane16_swap_b32 v149, v151
    v_add_f32 v148, v148, v150
    v_add_f32 v149, v149, v151
    v_mov_b32 v150, v148
    v_mov_b32 v151, v149
    s_nop 0
    v_permlane32_swap_b32 v148, v150
    v_permlane32_swap_b32 v149, v151
    v_add_f32 v148, v148, v150
    v_add_f32 v149, v149, v151
    ds_write_b128 v6, v[16:19] offset:0
    ds_write_b128 v6, v[20:23] offset:1024
    ds_write_b128 v6, v[24:27] offset:2048
    ds_write_b128 v6, v[28:31] offset:3072
    ds_write_b128 v6, v[32:35] offset:4096
    ds_write_b128 v6, v[36:39] offset:5120
    ds_write_b128 v6, v[40:43] offset:6144
    ds_write_b128 v6, v[44:47] offset:7168
    ds_write_b128 v6, v[48:51] offset:8192
    ds_write_b128 v6, v[52:55] offset:9216
    ds_write_b64 v8, v[148:149]
    s_mov_b32 s51, 0
    s_waitcnt lgkmcnt(0)
    s_cmp_gt_u32 s40, 1
    s_cbranch_scc0 interleave_layers__linear_attn_block__memory_aug_recurrent_mem_tr__prompt_kernel_k15
    s_cmp_eq_u32 s92, 0
    s_cbranch_scc1 interleave_layers__linear_attn_block__memory_aug_recurrent_mem_tr__prompt_kernel_k16
    s_add_u32 s24, s48, s49
    s_lshr_b32 s24, s24, 2
    s_add_u32 s24, s24, 1
    v_cmp_le_i32 vcc, s24, v13
    s_and_b32 s24, vcc_lo, 0xfffff
    s_cmp_eq_u32 s24, 0xfffff
    s_cbranch_scc0 interleave_layers__linear_attn_block__memory_aug_recurrent_mem_tr__prompt_kernel_k15
    s_add_u32 s41, s43, s42
    s_mov_b32 s24, s41
    buffer_load_dwordx4 v[16:19], v4, s[16:19], s24 offen sc1
    s_add_u32 s24, s24, s46
    buffer_load_dwordx4 v[20:23], v4, s[16:19], s24 offen sc1
    s_add_u32 s24, s24, s46
    buffer_load_dwordx4 v[24:27], v4, s[16:19], s24 offen sc1
    s_add_u32 s24, s24, s46
    buffer_load_dwordx4 v[28:31], v4, s[16:19], s24 offen sc1
    s_add_u32 s24, s24, s46
    buffer_load_dwordx4 v[32:35], v4, s[16:19], s24 offen sc1
    s_add_u32 s24, s24, s46
    buffer_load_dwordx4 v[36:39], v4, s[16:19], s24 offen sc1
    s_add_u32 s24, s24, s46
    buffer_load_dwordx4 v[40:43], v4, s[16:19], s24 offen sc1
    s_add_u32 s24, s24, s46
    buffer_load_dwordx4 v[44:47], v4, s[16:19], s24 offen sc1
    s_add_u32 s24, s24, s46
    buffer_load_dwordx4 v[48:51], v4, s[16:19], s24 offen sc1
    s_add_u32 s24, s24, s46
    buffer_load_dwordx4 v[52:55], v4, s[16:19], s24 offen sc1
    s_mov_b32 s51, 1
    s_mul_i32 s24, s49, 2
    s_add_u32 s24, s24, s48
    s_and_b32 s24, s24, 3
    s_lshl_b32 s24, s24, 7
    s_add_u32 s24, s24, 23107584
    v_lshlrev_b32 v15, 2, v1
    v_add_u32 v15, s24, v15
    buffer_load_dword v13, v15, s[8:11], 0 offen sc1
    s_branch interleave_layers__linear_attn_block__memory_aug_recurrent_mem_tr__prompt_kernel_k15
interleave_layers__linear_attn_block__memory_aug_recurrent_mem_tr__prompt_kernel_k16:
    s_add_u32 s41, s43, s42
    s_mov_b32 s24, s41
    buffer_load_dwordx2 v[16:17], v4, s[16:19], s24 offen
    buffer_load_dwordx2 v[18:19], v5, s[16:19], s24 offen
    s_add_u32 s24, s24, s46
    buffer_load_dwordx2 v[20:21], v4, s[16:19], s24 offen
    buffer_load_dwordx2 v[22:23], v5, s[16:19], s24 offen
    s_add_u32 s24, s24, s46
    buffer_load_dwordx2 v[24:25], v4, s[16:19], s24 offen
    buffer_load_dwordx2 v[26:27], v5, s[16:19], s24 offen
    s_add_u32 s24, s24, s46
    buffer_load_dwordx2 v[28:29], v4, s[16:19], s24 offen
    buffer_load_dwordx2 v[30:31], v5, s[16:19], s24 offen
    s_add_u32 s24, s24, s46
    buffer_load_dwordx2 v[32:33], v4, s[16:19], s24 offen
    buffer_load_dwordx2 v[34:35], v5, s[16:19], s24 offen
    s_add_u32 s24, s24, s46
    buffer_load_dwordx2 v[36:37], v4, s[16:19], s24 offen
    buffer_load_dwordx2 v[38:39], v5, s[16:19], s24 offen
    s_add_u32 s24, s24, s46
    buffer_load_dwordx2 v[40:41], v4, s[16:19], s24 offen
    buffer_load_dwordx2 v[42:43], v5, s[16:19], s24 offen
    s_add_u32 s24, s24, s46
    buffer_load_dwordx2 v[44:45], v4, s[16:19], s24 offen
    buffer_load_dwordx2 v[46:47], v5, s[16:19], s24 offen
    s_add_u32 s24, s24, s46
    buffer_load_dwordx2 v[48:49], v4, s[16:19], s24 offen
    buffer_load_dwordx2 v[50:51], v5, s[16:19], s24 offen
    s_add_u32 s24, s24, s46
    buffer_load_dwordx2 v[52:53], v4, s[16:19], s24 offen
    buffer_load_dwordx2 v[54:55], v5, s[16:19], s24 offen
    s_mov_b32 s51, 1
interleave_layers__linear_attn_block__memory_aug_recurrent_mem_tr__prompt_kernel_k15:
    s_barrier
    ds_read_b128 v[148:151], v9
    ds_read_b128 v[152:155], v9 offset:256
    ds_read_b128 v[56:59], v7 offset:0
    ds_read_b128 v[60:63], v7 offset:20480
    ds_read_b128 v[64:67], v7 offset:1024
    ds_read_b128 v[68:71], v7 offset:21504
    ds_read_b128 v[72:75], v7 offset:2048
    ds_read_b128 v[76:79], v7 offset:22528
    s_waitcnt lgkmcnt(6)
    v_add_f32 v148, v148, v150
    v_add_f32 v149, v149, v151
    v_mul_f32 v148, 0x3acccccd, v148
    v_mul_f32 v150, v148, v148
    v_mov_b32 v151, 0x3acccccd
    v_fma_f32 v149, v149, v151, -v150
    v_max_f32 v149, 0, v149
    v_add_f32 v149, 0x3727c5ac, v149
    v_rsq_f32 v144, v149
    s_nop 0
    v_mul_f32 v145, v148, v144
    v_sub_f32 v145, 0, v145
    v_add_f32 v152, v152, v154
    v_add_f32 v153, v153, v155
    v_mul_f32 v152, 0x3acccccd, v152
    v_mul_f32 v154, v152, v152
    v_mov_b32 v155, 0x3acccccd
    v_fma_f32 v153, v153, v155, -v154
    v_max_f32 v153, 0, v153
    v_add_f32 v153, 0x3727c5ac, v153
    v_rsq_f32 v146, v153
    s_nop 0
    v_mul_f32 v147, v152, v146
    v_sub_f32 v147, 0, v147
    ds_read_b128 v[80:83], v7 offset:3072
    ds_read_b128 v[84:87], v7 offset:23552
    s_waitcnt lgkmcnt(6)
    v_mfma_f32_16x16x32_bf16 v[88:91], a[0:3], v[56:59], 0
    v_mfma_f32_16x16x32_bf16 v[96:99], a[80:83], v[56:59], 0
    v_mfma_f32_16x16x32_bf16 v[104:107], a[160:163], v[56:59], 0
    v_mfma_f32_16x16x32_bf16 v[112:115], v[176:179], v[56:59], 0
    v_mfma_f32_16x16x32_bf16 v[92:95], a[0:3], v[60:63], 0
    v_mfma_f32_16x16x32_bf16 v[100:103], a[80:83], v[60:63], 0
    v_mfma_f32_16x16x32_bf16 v[108:111], a[160:163], v[60:63], 0
    v_mfma_f32_16x16x32_bf16 v[116:119], v[176:179], v[60:63], 0
    ds_read_b128 v[56:59], v7 offset:4096
    ds_read_b128 v[60:63], v7 offset:24576
    s_waitcnt lgkmcnt(6)
    v_mfma_f32_16x16x32_bf16 v[88:91], a[4:7], v[64:67], v[88:91]
    v_mfma_f32_16x16x32_bf16 v[96:99], a[84:87], v[64:67], v[96:99]
    v_mfma_f32_16x16x32_bf16 v[104:107], a[164:167], v[64:67], v[104:107]
    v_mfma_f32_16x16x32_bf16 v[112:115], v[180:183], v[64:67], v[112:115]
    v_mfma_f32_16x16x32_bf16 v[92:95], a[4:7], v[68:71], v[92:95]
    v_mfma_f32_16x16x32_bf16 v[100:103], a[84:87], v[68:71], v[100:103]
    v_mfma_f32_16x16x32_bf16 v[108:111], a[164:167], v[68:71], v[108:111]
    v_mfma_f32_16x16x32_bf16 v[116:119], v[180:183], v[68:71], v[116:119]
    ds_read_b128 v[64:67], v7 offset:5120
    ds_read_b128 v[68:71], v7 offset:25600
    s_waitcnt lgkmcnt(6)
    v_mfma_f32_16x16x32_bf16 v[88:91], a[8:11], v[72:75], v[88:91]
    v_mfma_f32_16x16x32_bf16 v[96:99], a[88:91], v[72:75], v[96:99]
    v_mfma_f32_16x16x32_bf16 v[104:107], a[168:171], v[72:75], v[104:107]
    v_mfma_f32_16x16x32_bf16 v[112:115], v[184:187], v[72:75], v[112:115]
    v_mfma_f32_16x16x32_bf16 v[92:95], a[8:11], v[76:79], v[92:95]
    v_mfma_f32_16x16x32_bf16 v[100:103], a[88:91], v[76:79], v[100:103]
    v_mfma_f32_16x16x32_bf16 v[108:111], a[168:171], v[76:79], v[108:111]
    v_mfma_f32_16x16x32_bf16 v[116:119], v[184:187], v[76:79], v[116:119]
    ds_read_b128 v[72:75], v7 offset:6144
    ds_read_b128 v[76:79], v7 offset:26624
    s_waitcnt lgkmcnt(6)
    v_mfma_f32_16x16x32_bf16 v[88:91], a[12:15], v[80:83], v[88:91]
    v_mfma_f32_16x16x32_bf16 v[96:99], a[92:95], v[80:83], v[96:99]
    v_mfma_f32_16x16x32_bf16 v[104:107], a[172:175], v[80:83], v[104:107]
    v_mfma_f32_16x16x32_bf16 v[112:115], v[188:191], v[80:83], v[112:115]
    v_mfma_f32_16x16x32_bf16 v[92:95], a[12:15], v[84:87], v[92:95]
    v_mfma_f32_16x16x32_bf16 v[100:103], a[92:95], v[84:87], v[100:103]
    v_mfma_f32_16x16x32_bf16 v[108:111], a[172:175], v[84:87], v[108:111]
    v_mfma_f32_16x16x32_bf16 v[116:119], v[188:191], v[84:87], v[116:119]
    ds_read_b128 v[80:83], v7 offset:7168
    ds_read_b128 v[84:87], v7 offset:27648
    s_waitcnt lgkmcnt(6)
    v_mfma_f32_16x16x32_bf16 v[88:91], a[16:19], v[56:59], v[88:91]
    v_mfma_f32_16x16x32_bf16 v[96:99], a[96:99], v[56:59], v[96:99]
    v_mfma_f32_16x16x32_bf16 v[104:107], a[176:179], v[56:59], v[104:107]
    v_mfma_f32_16x16x32_bf16 v[112:115], v[192:195], v[56:59], v[112:115]
    v_mfma_f32_16x16x32_bf16 v[92:95], a[16:19], v[60:63], v[92:95]
    v_mfma_f32_16x16x32_bf16 v[100:103], a[96:99], v[60:63], v[100:103]
    v_mfma_f32_16x16x32_bf16 v[108:111], a[176:179], v[60:63], v[108:111]
    v_mfma_f32_16x16x32_bf16 v[116:119], v[192:195], v[60:63], v[116:119]
    ds_read_b128 v[56:59], v7 offset:8192
    ds_read_b128 v[60:63], v7 offset:28672
    s_waitcnt lgkmcnt(6)
    v_mfma_f32_16x16x32_bf16 v[88:91], a[20:23], v[64:67], v[88:91]
    v_mfma_f32_16x16x32_bf16 v[96:99], a[100:103], v[64:67], v[96:99]
    v_mfma_f32_16x16x32_bf16 v[104:107], a[180:183], v[64:67], v[104:107]
    v_mfma_f32_16x16x32_bf16 v[112:115], v[196:199], v[64:67], v[112:115]
    v_mfma_f32_16x16x32_bf16 v[92:95], a[20:23], v[68:71], v[92:95]
    v_mfma_f32_16x16x32_bf16 v[100:103], a[100:103], v[68:71], v[100:103]
    v_mfma_f32_16x16x32_bf16 v[108:111], a[180:183], v[68:71], v[108:111]
    v_mfma_f32_16x16x32_bf16 v[116:119], v[196:199], v[68:71], v[116:119]
    ds_read_b128 v[64:67], v7 offset:9216
    ds_read_b128 v[68:71], v7 offset:29696
    s_waitcnt lgkmcnt(6)
    v_mfma_f32_16x16x32_bf16 v[88:91], a[24:27], v[72:75], v[88:91]
    v_mfma_f32_16x16x32_bf16 v[96:99], a[104:107], v[72:75], v[96:99]
    v_mfma_f32_16x16x32_bf16 v[104:107], a[184:187], v[72:75], v[104:107]
    v_mfma_f32_16x16x32_bf16 v[112:115], v[200:203], v[72:75], v[112:115]
    v_mfma_f32_16x16x32_bf16 v[92:95], a[24:27], v[76:79], v[92:95]
    v_mfma_f32_16x16x32_bf16 v[100:103], a[104:107], v[76:79], v[100:103]
    v_mfma_f32_16x16x32_bf16 v[108:111], a[184:187], v[76:79], v[108:111]
    v_mfma_f32_16x16x32_bf16 v[116:119], v[200:203], v[76:79], v[116:119]
    ds_read_b128 v[72:75], v7 offset:10240
    ds_read_b128 v[76:79], v7 offset:30720
    s_waitcnt lgkmcnt(6)
    v_mfma_f32_16x16x32_bf16 v[88:91], a[28:31], v[80:83], v[88:91]
    v_mfma_f32_16x16x32_bf16 v[96:99], a[108:111], v[80:83], v[96:99]
    v_mfma_f32_16x16x32_bf16 v[104:107], a[188:191], v[80:83], v[104:107]
    v_mfma_f32_16x16x32_bf16 v[112:115], v[204:207], v[80:83], v[112:115]
    v_mfma_f32_16x16x32_bf16 v[92:95], a[28:31], v[84:87], v[92:95]
    v_mfma_f32_16x16x32_bf16 v[100:103], a[108:111], v[84:87], v[100:103]
    v_mfma_f32_16x16x32_bf16 v[108:111], a[188:191], v[84:87], v[108:111]
    v_mfma_f32_16x16x32_bf16 v[116:119], v[204:207], v[84:87], v[116:119]
    ds_read_b128 v[80:83], v7 offset:11264
    ds_read_b128 v[84:87], v7 offset:31744
    s_waitcnt lgkmcnt(6)
    v_mfma_f32_16x16x32_bf16 v[88:91], a[32:35], v[56:59], v[88:91]
    v_mfma_f32_16x16x32_bf16 v[96:99], a[112:115], v[56:59], v[96:99]
    v_mfma_f32_16x16x32_bf16 v[104:107], a[192:195], v[56:59], v[104:107]
    v_mfma_f32_16x16x32_bf16 v[112:115], v[208:211], v[56:59], v[112:115]
    v_mfma_f32_16x16x32_bf16 v[92:95], a[32:35], v[60:63], v[92:95]
    v_mfma_f32_16x16x32_bf16 v[100:103], a[112:115], v[60:63], v[100:103]
    v_mfma_f32_16x16x32_bf16 v[108:111], a[192:195], v[60:63], v[108:111]
    v_mfma_f32_16x16x32_bf16 v[116:119], v[208:211], v[60:63], v[116:119]
    ds_read_b128 v[56:59], v7 offset:12288
    ds_read_b128 v[60:63], v7 offset:32768
    s_waitcnt lgkmcnt(6)
    v_mfma_f32_16x16x32_bf16 v[88:91], a[36:39], v[64:67], v[88:91]
    v_mfma_f32_16x16x32_bf16 v[96:99], a[116:119], v[64:67], v[96:99]
    v_mfma_f32_16x16x32_bf16 v[104:107], a[196:199], v[64:67], v[104:107]
    v_mfma_f32_16x16x32_bf16 v[112:115], v[212:215], v[64:67], v[112:115]
    v_mfma_f32_16x16x32_bf16 v[92:95], a[36:39], v[68:71], v[92:95]
    v_mfma_f32_16x16x32_bf16 v[100:103], a[116:119], v[68:71], v[100:103]
    v_mfma_f32_16x16x32_bf16 v[108:111], a[196:199], v[68:71], v[108:111]
    v_mfma_f32_16x16x32_bf16 v[116:119], v[212:215], v[68:71], v[116:119]
    ds_read_b128 v[64:67], v7 offset:13312
    ds_read_b128 v[68:71], v7 offset:33792
    s_waitcnt lgkmcnt(6)
    v_mfma_f32_16x16x32_bf16 v[88:91], a[40:43], v[72:75], v[88:91]
    v_mfma_f32_16x16x32_bf16 v[96:99], a[120:123], v[72:75], v[96:99]
    v_mfma_f32_16x16x32_bf16 v[104:107], a[200:203], v[72:75], v[104:107]
    v_mfma_f32_16x16x32_bf16 v[112:115], v[216:219], v[72:75], v[112:115]
    v_mfma_f32_16x16x32_bf16 v[92:95], a[40:43], v[76:79], v[92:95]
    v_mfma_f32_16x16x32_bf16 v[100:103], a[120:123], v[76:79], v[100:103]
    v_mfma_f32_16x16x32_bf16 v[108:111], a[200:203], v[76:79], v[108:111]
    v_mfma_f32_16x16x32_bf16 v[116:119], v[216:219], v[76:79], v[116:119]
    ds_read_b128 v[72:75], v7 offset:14336
    ds_read_b128 v[76:79], v7 offset:34816
    s_waitcnt lgkmcnt(6)
    v_mfma_f32_16x16x32_bf16 v[88:91], a[44:47], v[80:83], v[88:91]
    v_mfma_f32_16x16x32_bf16 v[96:99], a[124:127], v[80:83], v[96:99]
    v_mfma_f32_16x16x32_bf16 v[104:107], a[204:207], v[80:83], v[104:107]
    v_mfma_f32_16x16x32_bf16 v[112:115], v[220:223], v[80:83], v[112:115]
    v_mfma_f32_16x16x32_bf16 v[92:95], a[44:47], v[84:87], v[92:95]
    v_mfma_f32_16x16x32_bf16 v[100:103], a[124:127], v[84:87], v[100:103]
    v_mfma_f32_16x16x32_bf16 v[108:111], a[204:207], v[84:87], v[108:111]
    v_mfma_f32_16x16x32_bf16 v[116:119], v[220:223], v[84:87], v[116:119]
    ds_read_b128 v[80:83], v7 offset:15360
    ds_read_b128 v[84:87], v7 offset:35840
    s_waitcnt lgkmcnt(6)
    v_mfma_f32_16x16x32_bf16 v[88:91], a[48:51], v[56:59], v[88:91]
    v_mfma_f32_16x16x32_bf16 v[96:99], a[128:131], v[56:59], v[96:99]
    v_mfma_f32_16x16x32_bf16 v[104:107], a[208:211], v[56:59], v[104:107]
    v_mfma_f32_16x16x32_bf16 v[112:115], v[224:227], v[56:59], v[112:115]
    v_mfma_f32_16x16x32_bf16 v[92:95], a[48:51], v[60:63], v[92:95]
    v_mfma_f32_16x16x32_bf16 v[100:103], a[128:131], v[60:63], v[100:103]
    v_mfma_f32_16x16x32_bf16 v[108:111], a[208:211], v[60:63], v[108:111]
    v_mfma_f32_16x16x32_bf16 v[116:119], v[224:227], v[60:63], v[116:119]
    ds_read_b128 v[56:59], v7 offset:16384
    ds_read_b128 v[60:63], v7 offset:36864
    s_waitcnt lgkmcnt(6)
    v_mfma_f32_16x16x32_bf16 v[88:91], a[52:55], v[64:67], v[88:91]
    v_mfma_f32_16x16x32_bf16 v[96:99], a[132:135], v[64:67], v[96:99]
    v_mfma_f32_16x16x32_bf16 v[104:107], a[212:215], v[64:67], v[104:107]
    v_mfma_f32_16x16x32_bf16 v[112:115], v[228:231], v[64:67], v[112:115]
    v_mfma_f32_16x16x32_bf16 v[92:95], a[52:55], v[68:71], v[92:95]
    v_mfma_f32_16x16x32_bf16 v[100:103], a[132:135], v[68:71], v[100:103]
    v_mfma_f32_16x16x32_bf16 v[108:111], a[212:215], v[68:71], v[108:111]
    v_mfma_f32_16x16x32_bf16 v[116:119], v[228:231], v[68:71], v[116:119]
    ds_read_b128 v[64:67], v7 offset:17408
    ds_read_b128 v[68:71], v7 offset:37888
    s_waitcnt lgkmcnt(6)
    v_mfma_f32_16x16x32_bf16 v[88:91], a[56:59], v[72:75], v[88:91]
    v_mfma_f32_16x16x32_bf16 v[96:99], a[136:139], v[72:75], v[96:99]
    v_mfma_f32_16x16x32_bf16 v[104:107], a[216:219], v[72:75], v[104:107]
    v_mfma_f32_16x16x32_bf16 v[112:115], v[232:235], v[72:75], v[112:115]
    v_mfma_f32_16x16x32_bf16 v[92:95], a[56:59], v[76:79], v[92:95]
    v_mfma_f32_16x16x32_bf16 v[100:103], a[136:139], v[76:79], v[100:103]
    v_mfma_f32_16x16x32_bf16 v[108:111], a[216:219], v[76:79], v[108:111]
    v_mfma_f32_16x16x32_bf16 v[116:119], v[232:235], v[76:79], v[116:119]
    ds_read_b128 v[72:75], v7 offset:18432
    ds_read_b128 v[76:79], v7 offset:38912
    s_waitcnt lgkmcnt(6)
    v_mfma_f32_16x16x32_bf16 v[88:91], a[60:63], v[80:83], v[88:91]
    v_mfma_f32_16x16x32_bf16 v[96:99], a[140:143], v[80:83], v[96:99]
    v_mfma_f32_16x16x32_bf16 v[104:107], a[220:223], v[80:83], v[104:107]
    v_mfma_f32_16x16x32_bf16 v[112:115], v[236:239], v[80:83], v[112:115]
    v_mfma_f32_16x16x32_bf16 v[92:95], a[60:63], v[84:87], v[92:95]
    v_mfma_f32_16x16x32_bf16 v[100:103], a[140:143], v[84:87], v[100:103]
    v_mfma_f32_16x16x32_bf16 v[108:111], a[220:223], v[84:87], v[108:111]
    v_mfma_f32_16x16x32_bf16 v[116:119], v[236:239], v[84:87], v[116:119]
    ds_read_b128 v[80:83], v7 offset:19456
    ds_read_b128 v[84:87], v7 offset:39936
    s_waitcnt lgkmcnt(6)
    v_mfma_f32_16x16x32_bf16 v[88:91], a[64:67], v[56:59], v[88:91]
    v_mfma_f32_16x16x32_bf16 v[96:99], a[144:147], v[56:59], v[96:99]
    v_mfma_f32_16x16x32_bf16 v[104:107], a[224:227], v[56:59], v[104:107]
    v_mfma_f32_16x16x32_bf16 v[112:115], v[240:243], v[56:59], v[112:115]
    v_mfma_f32_16x16x32_bf16 v[92:95], a[64:67], v[60:63], v[92:95]
    v_mfma_f32_16x16x32_bf16 v[100:103], a[144:147], v[60:63], v[100:103]
    v_mfma_f32_16x16x32_bf16 v[108:111], a[224:227], v[60:63], v[108:111]
    v_mfma_f32_16x16x32_bf16 v[116:119], v[240:243], v[60:63], v[116:119]
    s_waitcnt lgkmcnt(4)
    v_mfma_f32_16x16x32_bf16 v[88:91], a[68:71], v[64:67], v[88:91]
    v_mfma_f32_16x16x32_bf16 v[96:99], a[148:151], v[64:67], v[96:99]
    v_mfma_f32_16x16x32_bf16 v[104:107], a[228:231], v[64:67], v[104:107]
    v_mfma_f32_16x16x32_bf16 v[112:115], v[244:247], v[64:67], v[112:115]
    v_mfma_f32_16x16x32_bf16 v[92:95], a[68:71], v[68:71], v[92:95]
    v_mfma_f32_16x16x32_bf16 v[100:103], a[148:151], v[68:71], v[100:103]
    v_mfma_f32_16x16x32_bf16 v[108:111], a[228:231], v[68:71], v[108:111]
    v_mfma_f32_16x16x32_bf16 v[116:119], v[244:247], v[68:71], v[116:119]
    s_waitcnt lgkmcnt(2)
    v_mfma_f32_16x16x32_bf16 v[88:91], a[72:75], v[72:75], v[88:91]
    v_mfma_f32_16x16x32_bf16 v[96:99], a[152:155], v[72:75], v[96:99]
    v_mfma_f32_16x16x32_bf16 v[104:107], a[232:235], v[72:75], v[104:107]
    v_mfma_f32_16x16x32_bf16 v[112:115], v[248:251], v[72:75], v[112:115]
    v_mfma_f32_16x16x32_bf16 v[92:95], a[72:75], v[76:79], v[92:95]
    v_mfma_f32_16x16x32_bf16 v[100:103], a[152:155], v[76:79], v[100:103]
    v_mfma_f32_16x16x32_bf16 v[108:111], a[232:235], v[76:79], v[108:111]
    v_mfma_f32_16x16x32_bf16 v[116:119], v[248:251], v[76:79], v[116:119]
    s_waitcnt lgkmcnt(0)
    v_mfma_f32_16x16x32_bf16 v[88:91], a[76:79], v[80:83], v[88:91]
    v_mfma_f32_16x16x32_bf16 v[96:99], a[156:159], v[80:83], v[96:99]
    v_mfma_f32_16x16x32_bf16 v[104:107], a[236:239], v[80:83], v[104:107]
    v_mfma_f32_16x16x32_bf16 v[112:115], v[252:255], v[80:83], v[112:115]
    v_mfma_f32_16x16x32_bf16 v[92:95], a[76:79], v[84:87], v[92:95]
    v_mfma_f32_16x16x32_bf16 v[100:103], a[156:159], v[84:87], v[100:103]
    v_mfma_f32_16x16x32_bf16 v[108:111], a[236:239], v[84:87], v[108:111]
    v_mfma_f32_16x16x32_bf16 v[116:119], v[252:255], v[84:87], v[116:119]
    v_pk_mul_f32 v[148:149], v[156:157], v[144:145] op_sel:[0,1] op_sel_hi:[1,1]
    v_pk_mul_f32 v[150:151], v[158:159], v[144:145] op_sel:[0,1] op_sel_hi:[1,1]
    v_pk_fma_f32 v[88:89], v[88:89], v[144:145], v[148:149] op_sel:[0,0,0] op_sel_hi:[1,0,1]
    v_pk_fma_f32 v[90:91], v[90:91], v[144:145], v[150:151] op_sel:[0,0,0] op_sel_hi:[1,0,1]
    v_pk_mul_f32 v[148:149], v[156:157], v[146:147] op_sel:[0,1] op_sel_hi:[1,1]
    v_pk_mul_f32 v[150:151], v[158:159], v[146:147] op_sel:[0,1] op_sel_hi:[1,1]
    v_pk_fma_f32 v[92:93], v[92:93], v[146:147], v[148:149] op_sel:[0,0,0] op_sel_hi:[1,0,1]
    v_pk_fma_f32 v[94:95], v[94:95], v[146:147], v[150:151] op_sel:[0,0,0] op_sel_hi:[1,0,1]
    v_pk_mul_f32 v[148:149], v[160:161], v[144:145] op_sel:[0,1] op_sel_hi:[1,1]
    v_pk_mul_f32 v[150:151], v[162:163], v[144:145] op_sel:[0,1] op_sel_hi:[1,1]
    v_pk_fma_f32 v[96:97], v[96:97], v[144:145], v[148:149] op_sel:[0,0,0] op_sel_hi:[1,0,1]
    v_pk_fma_f32 v[98:99], v[98:99], v[144:145], v[150:151] op_sel:[0,0,0] op_sel_hi:[1,0,1]
    v_pk_mul_f32 v[148:149], v[160:161], v[146:147] op_sel:[0,1] op_sel_hi:[1,1]
    v_pk_mul_f32 v[150:151], v[162:163], v[146:147] op_sel:[0,1] op_sel_hi:[1,1]
    v_pk_fma_f32 v[100:101], v[100:101], v[146:147], v[148:149] op_sel:[0,0,0] op_sel_hi:[1,0,1]
    v_pk_fma_f32 v[102:103], v[102:103], v[146:147], v[150:151] op_sel:[0,0,0] op_sel_hi:[1,0,1]
    v_pk_mul_f32 v[148:149], v[164:165], v[144:145] op_sel:[0,1] op_sel_hi:[1,1]
    v_pk_mul_f32 v[150:151], v[166:167], v[144:145] op_sel:[0,1] op_sel_hi:[1,1]
    v_pk_fma_f32 v[104:105], v[104:105], v[144:145], v[148:149] op_sel:[0,0,0] op_sel_hi:[1,0,1]
    v_pk_fma_f32 v[106:107], v[106:107], v[144:145], v[150:151] op_sel:[0,0,0] op_sel_hi:[1,0,1]
    v_pk_mul_f32 v[148:149], v[164:165], v[146:147] op_sel:[0,1] op_sel_hi:[1,1]
    v_pk_mul_f32 v[150:151], v[166:167], v[146:147] op_sel:[0,1] op_sel_hi:[1,1]
    v_pk_fma_f32 v[108:109], v[108:109], v[146:147], v[148:149] op_sel:[0,0,0] op_sel_hi:[1,0,1]
    v_pk_fma_f32 v[110:111], v[110:111], v[146:147], v[150:151] op_sel:[0,0,0] op_sel_hi:[1,0,1]
    v_pk_mul_f32 v[148:149], v[168:169], v[144:145] op_sel:[0,1] op_sel_hi:[1,1]
    v_pk_mul_f32 v[150:151], v[170:171], v[144:145] op_sel:[0,1] op_sel_hi:[1,1]
    v_pk_fma_f32 v[112:113], v[112:113], v[144:145], v[148:149] op_sel:[0,0,0] op_sel_hi:[1,0,1]
    v_pk_fma_f32 v[114:115], v[114:115], v[144:145], v[150:151] op_sel:[0,0,0] op_sel_hi:[1,0,1]
    v_pk_mul_f32 v[148:149], v[168:169], v[146:147] op_sel:[0,1] op_sel_hi:[1,1]
    v_pk_mul_f32 v[150:151], v[170:171], v[146:147] op_sel:[0,1] op_sel_hi:[1,1]
    v_pk_fma_f32 v[116:117], v[116:117], v[146:147], v[148:149] op_sel:[0,0,0] op_sel_hi:[1,0,1]
    v_pk_fma_f32 v[118:119], v[118:119], v[146:147], v[150:151] op_sel:[0,0,0] op_sel_hi:[1,0,1]
    s_add_u32 s25, s43, 20480
    s_cmp_ge_u32 s3, 2
    s_cbranch_scc1 interleave_layers__linear_attn_block__memory_aug_recurrent_mem_tr__prompt_kernel_k1_e2
    s_lshl_b32 s24, s3, 6
    v_add_u32 v15, s24, v10
    v_cvt_pk_bf16_f32 v64, v104, v105
    v_cvt_pk_bf16_f32 v65, v106, v107
    ds_write_b64 v15, v[64:65] offset:160
    v_cvt_pk_bf16_f32 v66, v108, v109
    v_cvt_pk_bf16_f32 v67, v110, v111
    ds_write_b64 v15, v[66:67] offset:5536
    v_cvt_pk_bf16_f32 v68, v112, v113
    v_cvt_pk_bf16_f32 v69, v114, v115
    ds_write_b64 v15, v[68:69] offset:192
    v_cvt_pk_bf16_f32 v70, v116, v117
    v_cvt_pk_bf16_f32 v71, v118, v119
    ds_write_b64 v15, v[70:71] offset:5568
    v_min_f32 v148, 0, v88
    v_min_f32 v149, 0, v89
    v_pk_mul_f32 v[148:149], v[148:149], s[52:53]
    v_min_f32 v150, 0, v90
    v_min_f32 v151, 0, v91
    v_pk_mul_f32 v[150:151], v[150:151], s[52:53]
    v_exp_f32 v148, v148
    v_exp_f32 v149, v149
    v_exp_f32 v150, v150
    v_exp_f32 v151, v151
    v_max_f32 v88, 0, v88
    v_max_f32 v89, 0, v89
    v_max_f32 v90, 0, v90
    v_max_f32 v91, 0, v91
    v_pk_add_f32 v[88:89], v[88:89], v[148:149]
    v_pk_add_f32 v[90:91], v[90:91], v[150:151]
    v_pk_add_f32 v[88:89], v[88:89], s[54:55]
    v_pk_add_f32 v[90:91], v[90:91], s[54:55]
    v_min_f32 v148, 0, v96
    v_min_f32 v149, 0, v97
    v_pk_mul_f32 v[148:149], v[148:149], s[52:53]
    v_min_f32 v150, 0, v98
    v_min_f32 v151, 0, v99
    v_pk_mul_f32 v[150:151], v[150:151], s[52:53]
    v_exp_f32 v148, v148
    v_exp_f32 v149, v149
    v_exp_f32 v150, v150
    v_exp_f32 v151, v151
    v_max_f32 v96, 0, v96
    v_max_f32 v97, 0, v97
    v_max_f32 v98, 0, v98
    v_max_f32 v99, 0, v99
    v_pk_add_f32 v[96:97], v[96:97], v[148:149]
    v_pk_add_f32 v[98:99], v[98:99], v[150:151]
    v_pk_add_f32 v[96:97], v[96:97], s[54:55]
    v_pk_add_f32 v[98:99], v[98:99], s[54:55]
    v_cvt_pk_bf16_f32 v56, v88, v89
    v_cvt_pk_bf16_f32 v57, v90, v91
    v_cvt_pk_bf16_f32 v58, v96, v97
    v_cvt_pk_bf16_f32 v59, v98, v99
    buffer_store_dwordx4 v[56:59], v12, s[8:11], s43 offen sc1
    v_min_f32 v148, 0, v92
    v_min_f32 v149, 0, v93
    v_pk_mul_f32 v[148:149], v[148:149], s[52:53]
    v_min_f32 v150, 0, v94
    v_min_f32 v151, 0, v95
    v_pk_mul_f32 v[150:151], v[150:151], s[52:53]
    v_exp_f32 v148, v148
    v_exp_f32 v149, v149
    v_exp_f32 v150, v150
    v_exp_f32 v151, v151
    v_max_f32 v92, 0, v92
    v_max_f32 v93, 0, v93
    v_max_f32 v94, 0, v94
    v_max_f32 v95, 0, v95
    v_pk_add_f32 v[92:93], v[92:93], v[148:149]
    v_pk_add_f32 v[94:95], v[94:95], v[150:151]
    v_pk_add_f32 v[92:93], v[92:93], s[54:55]
    v_pk_add_f32 v[94:95], v[94:95], s[54:55]
    v_min_f32 v148, 0, v100
    v_min_f32 v149, 0, v101
    v_pk_mul_f32 v[148:149], v[148:149], s[52:53]
    v_min_f32 v150, 0, v102
    v_min_f32 v151, 0, v103
    v_pk_mul_f32 v[150:151], v[150:151], s[52:53]
    v_exp_f32 v148, v148
    v_exp_f32 v149, v149
    v_exp_f32 v150, v150
    v_exp_f32 v151, v151
    v_max_f32 v100, 0, v100
    v_max_f32 v101, 0, v101
    v_max_f32 v102, 0, v102
    v_max_f32 v103, 0, v103
    v_pk_add_f32 v[100:101], v[100:101], v[148:149]
    v_pk_add_f32 v[102:103], v[102:103], v[150:151]
    v_pk_add_f32 v[100:101], v[100:101], s[54:55]
    v_pk_add_f32 v[102:103], v[102:103], s[54:55]
    v_cvt_pk_bf16_f32 v60, v92, v93
    v_cvt_pk_bf16_f32 v61, v94, v95
    v_cvt_pk_bf16_f32 v62, v100, v101
    v_cvt_pk_bf16_f32 v63, v102, v103
    buffer_store_dwordx4 v[60:63], v12, s[8:11], s25 offen sc1
    s_branch interleave_layers__linear_attn_block__memory_aug_recurrent_mem_tr__prompt_kernel_k1_ej
interleave_layers__linear_attn_block__memory_aug_recurrent_mem_tr__prompt_kernel_k1_e2:
    s_cmp_eq_u32 s3, 3
    s_cbranch_scc1 interleave_layers__linear_attn_block__memory_aug_recurrent_mem_tr__prompt_kernel_k1_e3
    v_cvt_pk_bf16_f32 v68, v112, v113
    v_cvt_pk_bf16_f32 v69, v114, v115
    ds_write_b64 v10, v[68:69] offset:288
    v_cvt_pk_bf16_f32 v70, v116, v117
    v_cvt_pk_bf16_f32 v71, v118, v119
    ds_write_b64 v10, v[70:71] offset:5664
    v_min_f32 v148, 0, v96
    v_min_f32 v149, 0, v97
    v_pk_mul_f32 v[148:149], v[148:149], s[52:53]
    v_min_f32 v150, 0, v98
    v_min_f32 v151, 0, v99
    v_pk_mul_f32 v[150:151], v[150:151], s[52:53]
    v_exp_f32 v148, v148
    v_exp_f32 v149, v149
    v_exp_f32 v150, v150
    v_exp_f32 v151, v151
    v_max_f32 v96, 0, v96
    v_max_f32 v97, 0, v97
    v_max_f32 v98, 0, v98
    v_max_f32 v99, 0, v99
    v_pk_add_f32 v[96:97], v[96:97], v[148:149]
    v_pk_add_f32 v[98:99], v[98:99], v[150:151]
    v_pk_add_f32 v[96:97], v[96:97], s[54:55]
    v_pk_add_f32 v[98:99], v[98:99], s[54:55]
    v_min_f32 v148, 0, v104
    v_min_f32 v149, 0, v105
    v_pk_mul_f32 v[148:149], v[148:149], s[52:53]
    v_min_f32 v150, 0, v106
    v_min_f32 v151, 0, v107
    v_pk_mul_f32 v[150:151], v[150:151], s[52:53]
    v_exp_f32 v148, v148
    v_exp_f32 v149, v149
    v_exp_f32 v150, v150
    v_exp_f32 v151, v151
    v_max_f32 v104, 0, v104
    v_max_f32 v105, 0, v105
    v_max_f32 v106, 0, v106
    v_max_f32 v107, 0, v107
    v_pk_add_f32 v[104:105], v[104:105], v[148:149]
    v_pk_add_f32 v[106:107], v[106:107], v[150:151]
    v_pk_add_f32 v[104:105], v[104:105], s[54:55]
    v_pk_add_f32 v[106:107], v[106:107], s[54:55]
    v_min_f32 v148, 0, v100
    v_min_f32 v149, 0, v101
    v_pk_mul_f32 v[148:149], v[148:149], s[52:53]
    v_min_f32 v150, 0, v102
    v_min_f32 v151, 0, v103
    v_pk_mul_f32 v[150:151], v[150:151], s[52:53]
    v_exp_f32 v148, v148
    v_exp_f32 v149, v149
    v_exp_f32 v150, v150
    v_exp_f32 v151, v151
    v_max_f32 v100, 0, v100
    v_max_f32 v101, 0, v101
    v_max_f32 v102, 0, v102
    v_max_f32 v103, 0, v103
    v_pk_add_f32 v[100:101], v[100:101], v[148:149]
    v_pk_add_f32 v[102:103], v[102:103], v[150:151]
    v_pk_add_f32 v[100:101], v[100:101], s[54:55]
    v_pk_add_f32 v[102:103], v[102:103], s[54:55]
    v_min_f32 v148, 0, v108
    v_min_f32 v149, 0, v109
    v_pk_mul_f32 v[148:149], v[148:149], s[52:53]
    v_min_f32 v150, 0, v110
    v_min_f32 v151, 0, v111
    v_pk_mul_f32 v[150:151], v[150:151], s[52:53]
    v_exp_f32 v148, v148
    v_exp_f32 v149, v149
    v_exp_f32 v150, v150
    v_exp_f32 v151, v151
    v_max_f32 v108, 0, v108
    v_max_f32 v109, 0, v109
    v_max_f32 v110, 0, v110
    v_max_f32 v111, 0, v111
    v_pk_add_f32 v[108:109], v[108:109], v[148:149]
    v_pk_add_f32 v[110:111], v[110:111], v[150:151]
    v_pk_add_f32 v[108:109], v[108:109], s[54:55]
    v_pk_add_f32 v[110:111], v[110:111], s[54:55]
    v_cvt_pk_bf16_f32 v60, v96, v97
    v_cvt_pk_bf16_f32 v61, v98, v99
    ds_write_b64 v10, v[60:61] offset:0
    v_cvt_pk_bf16_f32 v62, v100, v101
    v_cvt_pk_bf16_f32 v63, v102, v103
    ds_write_b64 v10, v[62:63] offset:5376
    v_cvt_pk_bf16_f32 v64, v104, v105
    v_cvt_pk_bf16_f32 v65, v106, v107
    ds_write_b64 v10, v[64:65] offset:32
    v_cvt_pk_bf16_f32 v66, v108, v109
    v_cvt_pk_bf16_f32 v67, v110, v111
    ds_write_b64 v10, v[66:67] offset:5408
    v_min_f32 v148, 0, v88
    v_min_f32 v149, 0, v89
    v_pk_mul_f32 v[148:149], v[148:149], s[52:53]
    v_min_f32 v150, 0, v90
    v_min_f32 v151, 0, v91
    v_pk_mul_f32 v[150:151], v[150:151], s[52:53]
    v_exp_f32 v148, v148
    v_exp_f32 v149, v149
    v_exp_f32 v150, v150
    v_exp_f32 v151, v151
    v_max_f32 v88, 0, v88
    v_max_f32 v89, 0, v89
    v_max_f32 v90, 0, v90
    v_max_f32 v91, 0, v91
    v_pk_add_f32 v[88:89], v[88:89], v[148:149]
    v_pk_add_f32 v[90:91], v[90:91], v[150:151]
    v_pk_add_f32 v[88:89], v[88:89], s[54:55]
    v_pk_add_f32 v[90:91], v[90:91], s[54:55]
    v_cvt_pk_bf16_f32 v56, v88, v89
    v_cvt_pk_bf16_f32 v57, v90, v91
    buffer_store_dwordx2 v[56:57], v12, s[8:11], s43 offen sc1
    v_min_f32 v148, 0, v92
    v_min_f32 v149, 0, v93
    v_pk_mul_f32 v[148:149], v[148:149], s[52:53]
    v_min_f32 v150, 0, v94
    v_min_f32 v151, 0, v95
    v_pk_mul_f32 v[150:151], v[150:151], s[52:53]
    v_exp_f32 v148, v148
    v_exp_f32 v149, v149
    v_exp_f32 v150, v150
    v_exp_f32 v151, v151
    v_max_f32 v92, 0, v92
    v_max_f32 v93, 0, v93
    v_max_f32 v94, 0, v94
    v_max_f32 v95, 0, v95
    v_pk_add_f32 v[92:93], v[92:93], v[148:149]
    v_pk_add_f32 v[94:95], v[94:95], v[150:151]
    v_pk_add_f32 v[92:93], v[92:93], s[54:55]
    v_pk_add_f32 v[94:95], v[94:95], s[54:55]
    v_cvt_pk_bf16_f32 v58, v92, v93
    v_cvt_pk_bf16_f32 v59, v94, v95
    buffer_store_dwordx2 v[58:59], v12, s[8:11], s25 offen sc1
    s_branch interleave_layers__linear_attn_block__memory_aug_recurrent_mem_tr__prompt_kernel_k1_ej
interleave_layers__linear_attn_block__memory_aug_recurrent_mem_tr__prompt_kernel_k1_e3:
    v_min_f32 v148, 0, v88
    v_min_f32 v149, 0, v89
    v_pk_mul_f32 v[148:149], v[148:149], s[52:53]
    v_min_f32 v150, 0, v90
    v_min_f32 v151, 0, v91
    v_pk_mul_f32 v[150:151], v[150:151], s[52:53]
    v_exp_f32 v148, v148
    v_exp_f32 v149, v149
    v_exp_f32 v150, v150
    v_exp_f32 v151, v151
    v_max_f32 v88, 0, v88
    v_max_f32 v89, 0, v89
    v_max_f32 v90, 0, v90
    v_max_f32 v91, 0, v91
    v_pk_add_f32 v[88:89], v[88:89], v[148:149]
    v_pk_add_f32 v[90:91], v[90:91], v[150:151]
    v_pk_add_f32 v[88:89], v[88:89], s[54:55]
    v_pk_add_f32 v[90:91], v[90:91], s[54:55]
    v_min_f32 v148, 0, v92
    v_min_f32 v149, 0, v93
    v_pk_mul_f32 v[148:149], v[148:149], s[52:53]
    v_min_f32 v150, 0, v94
    v_min_f32 v151, 0, v95
    v_pk_mul_f32 v[150:151], v[150:151], s[52:53]
    v_exp_f32 v148, v148
    v_exp_f32 v149, v149
    v_exp_f32 v150, v150
    v_exp_f32 v151, v151
    v_max_f32 v92, 0, v92
    v_max_f32 v93, 0, v93
    v_max_f32 v94, 0, v94
    v_max_f32 v95, 0, v95
    v_pk_add_f32 v[92:93], v[92:93], v[148:149]
    v_pk_add_f32 v[94:95], v[94:95], v[150:151]
    v_pk_add_f32 v[92:93], v[92:93], s[54:55]
    v_pk_add_f32 v[94:95], v[94:95], s[54:55]
    v_cvt_pk_bf16_f32 v56, v88, v89
    v_cvt_pk_bf16_f32 v57, v90, v91
    ds_write_b64 v10, v[56:57] offset:64
    v_cvt_pk_bf16_f32 v58, v92, v93
    v_cvt_pk_bf16_f32 v59, v94, v95
    ds_write_b64 v10, v[58:59] offset:5440
    v_min_f32 v148, 0, v96
    v_min_f32 v149, 0, v97
    v_pk_mul_f32 v[148:149], v[148:149], s[52:53]
    v_min_f32 v150, 0, v98
    v_min_f32 v151, 0, v99
    v_pk_mul_f32 v[150:151], v[150:151], s[52:53]
    v_exp_f32 v148, v148
    v_exp_f32 v149, v149
    v_exp_f32 v150, v150
    v_exp_f32 v151, v151
    v_max_f32 v96, 0, v96
    v_max_f32 v97, 0, v97
    v_max_f32 v98, 0, v98
    v_max_f32 v99, 0, v99
    v_pk_add_f32 v[96:97], v[96:97], v[148:149]
    v_pk_add_f32 v[98:99], v[98:99], v[150:151]
    v_pk_add_f32 v[96:97], v[96:97], s[54:55]
    v_pk_add_f32 v[98:99], v[98:99], s[54:55]
    v_min_f32 v148, 0, v100
    v_min_f32 v149, 0, v101
    v_pk_mul_f32 v[148:149], v[148:149], s[52:53]
    v_min_f32 v150, 0, v102
    v_min_f32 v151, 0, v103
    v_pk_mul_f32 v[150:151], v[150:151], s[52:53]
    v_exp_f32 v148, v148
    v_exp_f32 v149, v149
    v_exp_f32 v150, v150
    v_exp_f32 v151, v151
    v_max_f32 v100, 0, v100
    v_max_f32 v101, 0, v101
    v_max_f32 v102, 0, v102
    v_max_f32 v103, 0, v103
    v_pk_add_f32 v[100:101], v[100:101], v[148:149]
    v_pk_add_f32 v[102:103], v[102:103], v[150:151]
    v_pk_add_f32 v[100:101], v[100:101], s[54:55]
    v_pk_add_f32 v[102:103], v[102:103], s[54:55]
    v_cvt_pk_bf16_f32 v60, v96, v97
    v_cvt_pk_bf16_f32 v61, v98, v99
    ds_write_b64 v10, v[60:61] offset:96
    v_cvt_pk_bf16_f32 v62, v100, v101
    v_cvt_pk_bf16_f32 v63, v102, v103
    ds_write_b64 v10, v[62:63] offset:5472
    v_min_f32 v148, 0, v104
    v_min_f32 v149, 0, v105
    v_pk_mul_f32 v[148:149], v[148:149], s[52:53]
    v_min_f32 v150, 0, v106
    v_min_f32 v151, 0, v107
    v_pk_mul_f32 v[150:151], v[150:151], s[52:53]
    v_exp_f32 v148, v148
    v_exp_f32 v149, v149
    v_exp_f32 v150, v150
    v_exp_f32 v151, v151
    v_max_f32 v104, 0, v104
    v_max_f32 v105, 0, v105
    v_max_f32 v106, 0, v106
    v_max_f32 v107, 0, v107
    v_pk_add_f32 v[104:105], v[104:105], v[148:149]
    v_pk_add_f32 v[106:107], v[106:107], v[150:151]
    v_pk_add_f32 v[104:105], v[104:105], s[54:55]
    v_pk_add_f32 v[106:107], v[106:107], s[54:55]
    v_min_f32 v148, 0, v108
    v_min_f32 v149, 0, v109
    v_pk_mul_f32 v[148:149], v[148:149], s[52:53]
    v_min_f32 v150, 0, v110
    v_min_f32 v151, 0, v111
    v_pk_mul_f32 v[150:151], v[150:151], s[52:53]
    v_exp_f32 v148, v148
    v_exp_f32 v149, v149
    v_exp_f32 v150, v150
    v_exp_f32 v151, v151
    v_max_f32 v108, 0, v108
    v_max_f32 v109, 0, v109
    v_max_f32 v110, 0, v110
    v_max_f32 v111, 0, v111
    v_pk_add_f32 v[108:109], v[108:109], v[148:149]
    v_pk_add_f32 v[110:111], v[110:111], v[150:151]
    v_pk_add_f32 v[108:109], v[108:109], s[54:55]
    v_pk_add_f32 v[110:111], v[110:111], s[54:55]
    v_cvt_pk_bf16_f32 v64, v104, v105
    v_cvt_pk_bf16_f32 v65, v106, v107
    ds_write_b64 v10, v[64:65] offset:128
    v_cvt_pk_bf16_f32 v66, v108, v109
    v_cvt_pk_bf16_f32 v67, v110, v111
    ds_write_b64 v10, v[66:67] offset:5504
interleave_layers__linear_attn_block__memory_aug_recurrent_mem_tr__prompt_kernel_k1_ej:
    s_waitcnt lgkmcnt(0)
    s_barrier
    ds_read_b64_tr_b16 v[72:73], v11 offset:0
    ds_read_b64_tr_b16 v[74:75], v11 offset:1344
    ds_read_b64_tr_b16 v[76:77], v11 offset:32
    ds_read_b64_tr_b16 v[78:79], v11 offset:1376
    ds_read_b64_tr_b16 v[80:81], v11 offset:160
    ds_read_b64_tr_b16 v[82:83], v11 offset:1504
    ds_read_b64_tr_b16 v[84:85], v11 offset:192
    ds_read_b64_tr_b16 v[86:87], v11 offset:1536
    s_waitcnt lgkmcnt(0)
    v_mfma_f32_16x16x32_bf16 v[120:123], v[72:75], v[84:87], v[120:123]
    v_mfma_f32_16x16x32_bf16 v[124:127], v[76:79], v[80:83], v[124:127]
    v_mfma_f32_16x16x32_bf16 v[128:131], v[76:79], v[84:87], v[128:131]
    v_mfma_f32_16x16x32_bf16 v[132:135], v[76:79], v[172:175], v[132:135]
    v_mfma_f32_16x16x32_bf16 v[136:139], v[72:75], v[80:83], v[136:139]
    v_mfma_f32_16x16x32_bf16 v[140:143], v[72:75], v[172:175], v[140:143]
    s_add_u32 s43, s43, s42
    s_add_u32 s48, s48, s49
    s_sub_u32 s40, s40, 1
    s_cmp_gt_u32 s40, 0
    s_cbranch_scc1 interleave_layers__linear_attn_block__memory_aug_recurrent_mem_tr__prompt_kernel_k1_seg
    s_cmp_eq_u32 s92, 0
    s_cbranch_scc0 interleave_layers__linear_attn_block__memory_aug_recurrent_mem_tr__prompt_kernel_ri7
    v_mov_b32 v15, 0
    buffer_load_dword v14, v15, s[72:75], 0 offen sc1
interleave_layers__linear_attn_block__memory_aug_recurrent_mem_tr__prompt_kernel_ri7:
    s_mul_i32 s24, s45, 147456
    s_mul_i32 s25, s44, 18432
    s_add_u32 s24, s24, s25
    s_add_u32 s24, s24, 16777216
    s_mul_i32 s25, s3, 3072
    s_add_u32 s25, s25, s24
    s_lshl_b32 s26, s3, 10
    s_add_u32 s26, s26, s24
    s_add_u32 s26, s26, 13312
    s_cmp_eq_u32 s3, 0
    s_cselect_b32 s27, 0, 2146435072
    s_add_u32 s27, s27, s24
    s_add_u32 s28, s27, 17408
    s_add_u32 s27, s27, 12288
    buffer_store_dwordx4 v[120:123], v7, s[8:11], s25 offen offset:0 sc1
    buffer_store_dwordx4 v[124:127], v7, s[8:11], s25 offen offset:1024 sc1
    buffer_store_dwordx4 v[128:131], v7, s[8:11], s25 offen offset:2048 sc1
    buffer_store_dwordx4 v[132:135], v7, s[8:11], s26 offen sc1
    buffer_store_dwordx4 v[136:139], v7, s[8:11], s27 offen sc1
    buffer_store_dwordx4 v[140:143], v7, s[8:11], s28 offen sc1
    s_waitcnt vmcnt(0)
    s_cmp_eq_u32 s92, 0
    s_cbranch_scc0 interleave_layers__linear_attn_block__memory_aug_recurrent_mem_tr__prompt_kernel_rc8_ok
    s_mov_b32 s61, 0
interleave_layers__linear_attn_block__memory_aug_recurrent_mem_tr__prompt_kernel_rc8:
    s_waitcnt vmcnt(0)
    v_readfirstlane_b32 s24, v14
    s_sub_u32 s36, s24, 1
    s_and_b32 s36, s36, 1
    s_lshl_b32 s36, s36, 13
    s_cmp_ge_u32 s24, 1
    s_cbranch_scc1 interleave_layers__linear_attn_block__memory_aug_recurrent_mem_tr__prompt_kernel_rc8_ok
    s_add_u32 s61, s61, 1
    s_cmp_ge_u32 s61, s60
    s_cbranch_scc1 interleave_layers__linear_attn_block__memory_aug_recurrent_mem_tr__prompt_kernel_rc8_to
    s_sleep 2
    v_mov_b32 v15, 0
    buffer_load_dword v14, v15, s[72:75], 0 offen sc1
    s_branch interleave_layers__linear_attn_block__memory_aug_recurrent_mem_tr__prompt_kernel_rc8
interleave_layers__linear_attn_block__memory_aug_recurrent_mem_tr__prompt_kernel_rc8_to:
    s_mov_b32 s60, 1
interleave_layers__linear_attn_block__memory_aug_recurrent_mem_tr__prompt_kernel_rc8_ok:
    s_barrier
    s_cmp_eq_u32 s3, 0
    s_cbranch_scc0 interleave_layers__linear_attn_block__memory_aug_recurrent_mem_tr__prompt_kernel_ka9
    s_lshl_b32 s24, s92, 3
    s_add_u32 s24, s24, s44
    s_lshl_b32 s24, s24, 7
    s_add_u32 s24, s24, 23101440
    v_mov_b32 v14, s24
    v_mov_b32 v15, 2146435072
    v_cmp_eq_u32 vcc, 0, v1
    s_nop 1
    v_cndmask_b32 v14, v15, v14, vcc
    v_mov_b32 v15, 1
    buffer_atomic_add v15, v14, s[8:11], 0 offen sc1
interleave_layers__linear_attn_block__memory_aug_recurrent_mem_tr__prompt_kernel_ka9:
    s_cmp_eq_u32 s92, 0
    s_cbranch_scc1 interleave_layers__linear_attn_block__memory_aug_recurrent_mem_tr__prompt_kernel_k3w10
    s_cmp_eq_u32 s2, 247
    s_cbranch_scc1 interleave_layers__linear_attn_block__memory_aug_recurrent_mem_tr__prompt_kernel_end
    s_branch interleave_layers__linear_attn_block__memory_aug_recurrent_mem_tr__prompt_kernel_helper
interleave_layers__linear_attn_block__memory_aug_recurrent_mem_tr__prompt_kernel_k3w10:
    s_cmp_ge_u32 s2, 232
    s_cbranch_scc1 interleave_layers__linear_attn_block__memory_aug_recurrent_mem_tr__prompt_kernel_helper
    s_cmp_ge_u32 s2, 200
    s_cbranch_scc1 interleave_layers__linear_attn_block__memory_aug_recurrent_mem_tr__prompt_kernel_toO
    s_cmp_ge_u32 s2, 104
    s_cbranch_scc1 interleave_layers__linear_attn_block__memory_aug_recurrent_mem_tr__prompt_kernel_toP
    s_cmp_ge_u32 s2, 64
    s_cbranch_scc1 interleave_layers__linear_attn_block__memory_aug_recurrent_mem_tr__prompt_kernel_toR
    s_cmp_ge_u32 s2, 32
    s_cbranch_scc1 interleave_layers__linear_attn_block__memory_aug_recurrent_mem_tr__prompt_kernel_toV
    s_branch interleave_layers__linear_attn_block__memory_aug_recurrent_mem_tr__prompt_kernel_roleS
interleave_layers__linear_attn_block__memory_aug_recurrent_mem_tr__prompt_kernel_toV:
    s_branch interleave_layers__linear_attn_block__memory_aug_recurrent_mem_tr__prompt_kernel_roleV
interleave_layers__linear_attn_block__memory_aug_recurrent_mem_tr__prompt_kernel_toR:
    s_branch interleave_layers__linear_attn_block__memory_aug_recurrent_mem_tr__prompt_kernel_roleR
interleave_layers__linear_attn_block__memory_aug_recurrent_mem_tr__prompt_kernel_toP:
    s_branch interleave_layers__linear_attn_block__memory_aug_recurrent_mem_tr__prompt_kernel_roleP
interleave_layers__linear_attn_block__memory_aug_recurrent_mem_tr__prompt_kernel_toO:
    s_branch interleave_layers__linear_attn_block__memory_aug_recurrent_mem_tr__prompt_kernel_roleO
interleave_layers__linear_attn_block__memory_aug_recurrent_mem_tr__prompt_kernel_helper:
    s_sub_u32 s24, s2, 232
    s_cmp_ge_u32 s24, 21
    s_cbranch_scc1 interleave_layers__linear_attn_block__memory_aug_recurrent_mem_tr__prompt_kernel_helper_clr
    s_cmp_eq_u32 s24, 15
    s_cbranch_scc1 interleave_layers__linear_attn_block__memory_aug_recurrent_mem_tr__prompt_kernel_helper_k1
    s_mul_i32 s57, s24, 52
    s_lshr_b32 s57, s57, 8
    s_mul_i32 s56, s57, 5
    s_sub_u32 s56, s24, s56
    s_add_u32 s57, s57, 1
    s_sub_u32 s25, s24, 16
    s_cmp_ge_u32 s24, 16
    s_cselect_b32 s56, s25, s56
    s_cselect_b32 s57, 0, s57
    s_mul_i32 s78, s57, 5
    s_add_u32 s78, s78, s56
    s_load_dwordx2 s[6:7], s[0:1], 16
    v_lshrrev_b32 v12, 4, v0
    v_mul_u32_u24 v12, 1280, v12
    v_and_b32 v13, 15, v0
    v_lshl_add_u32 v12, v13, 4, v12
    s_waitcnt lgkmcnt(0)
    s_mov_b32 s12, s6
    s_mov_b32 s13, s7
    s_mov_b32 s14, 819200
    s_mov_b32 s15, 0x00020000
    s_lshl_b32 s52, s56, 8
    s_add_u32 s24, s52, 0
    buffer_load_dwordx4 a[0:3], v12, s[12:15], s24 offen
    s_add_u32 s24, s52, 20480
    buffer_load_dwordx4 a[4:7], v12, s[12:15], s24 offen
    s_add_u32 s24, s52, 40960
    buffer_load_dwordx4 a[8:11], v12, s[12:15], s24 offen
    s_add_u32 s24, s52, 61440
    buffer_load_dwordx4 a[12:15], v12, s[12:15], s24 offen
    s_add_u32 s24, s52, 81920
    buffer_load_dwordx4 a[16:19], v12, s[12:15], s24 offen
    s_add_u32 s24, s52, 102400
    buffer_load_dwordx4 a[20:23], v12, s[12:15], s24 offen
    s_add_u32 s24, s52, 122880
    buffer_load_dwordx4 a[24:27], v12, s[12:15], s24 offen
    s_add_u32 s24, s52, 143360
    buffer_load_dwordx4 a[28:31], v12, s[12:15], s24 offen
    s_add_u32 s24, s52, 163840
    buffer_load_dwordx4 a[32:35], v12, s[12:15], s24 offen
    s_add_u32 s24, s52, 184320
    buffer_load_dwordx4 a[36:39], v12, s[12:15], s24 offen
    s_add_u32 s24, s52, 204800
    buffer_load_dwordx4 a[40:43], v12, s[12:15], s24 offen
    s_add_u32 s24, s52, 225280
    buffer_load_dwordx4 a[44:47], v12, s[12:15], s24 offen
    s_add_u32 s24, s52, 245760
    buffer_load_dwordx4 a[48:51], v12, s[12:15], s24 offen
    s_add_u32 s24, s52, 266240
    buffer_load_dwordx4 a[52:55], v12, s[12:15], s24 offen
    s_add_u32 s24, s52, 286720
    buffer_load_dwordx4 a[56:59], v12, s[12:15], s24 offen
    s_add_u32 s24, s52, 307200
    buffer_load_dwordx4 a[60:63], v12, s[12:15], s24 offen
    s_add_u32 s24, s52, 327680
    buffer_load_dwordx4 a[64:67], v12, s[12:15], s24 offen
    s_add_u32 s24, s52, 348160
    buffer_load_dwordx4 a[68:71], v12, s[12:15], s24 offen
    s_add_u32 s24, s52, 368640
    buffer_load_dwordx4 a[72:75], v12, s[12:15], s24 offen
    s_add_u32 s24, s52, 389120
    buffer_load_dwordx4 a[76:79], v12, s[12:15], s24 offen
    s_add_u32 s24, s52, 409600
    buffer_load_dwordx4 a[80:83], v12, s[12:15], s24 offen
    s_add_u32 s24, s52, 430080
    buffer_load_dwordx4 a[84:87], v12, s[12:15], s24 offen
    s_add_u32 s24, s52, 450560
    buffer_load_dwordx4 a[88:91], v12, s[12:15], s24 offen
    s_add_u32 s24, s52, 471040
    buffer_load_dwordx4 a[92:95], v12, s[12:15], s24 offen
    s_add_u32 s24, s52, 491520
    buffer_load_dwordx4 a[96:99], v12, s[12:15], s24 offen
    s_add_u32 s24, s52, 512000
    buffer_load_dwordx4 a[100:103], v12, s[12:15], s24 offen
    s_add_u32 s24, s52, 532480
    buffer_load_dwordx4 a[104:107], v12, s[12:15], s24 offen
    s_add_u32 s24, s52, 552960
    buffer_load_dwordx4 a[108:111], v12, s[12:15], s24 offen
    s_add_u32 s24, s52, 573440
    buffer_load_dwordx4 a[112:115], v12, s[12:15], s24 offen
    s_add_u32 s24, s52, 593920
    buffer_load_dwordx4 a[116:119], v12, s[12:15], s24 offen
    s_add_u32 s24, s52, 614400
    buffer_load_dwordx4 a[120:123], v12, s[12:15], s24 offen
    s_add_u32 s24, s52, 634880
    buffer_load_dwordx4 a[124:127], v12, s[12:15], s24 offen
    s_add_u32 s24, s52, 655360
    buffer_load_dwordx4 a[128:131], v12, s[12:15], s24 offen
    s_add_u32 s24, s52, 675840
    buffer_load_dwordx4 a[132:135], v12, s[12:15], s24 offen
    s_add_u32 s24, s52, 696320
    buffer_load_dwordx4 a[136:139], v12, s[12:15], s24 offen
    s_add_u32 s24, s52, 716800
    buffer_load_dwordx4 a[140:143], v12, s[12:15], s24 offen
    s_add_u32 s24, s52, 737280
    buffer_load_dwordx4 a[144:147], v12, s[12:15], s24 offen
    s_add_u32 s24, s52, 757760
    buffer_load_dwordx4 a[148:151], v12, s[12:15], s24 offen
    s_add_u32 s24, s52, 778240
    buffer_load_dwordx4 a[152:155], v12, s[12:15], s24 offen
    s_add_u32 s24, s52, 798720
    buffer_load_dwordx4 a[156:159], v12, s[12:15], s24 offen
    v_lshrrev_b32 v6, 4, v0
    v_mul_u32_u24 v6, 288, v6
    v_and_b32 v7, 15, v0
    v_lshl_add_u32 v6, v7, 4, v6
    v_add_u32 v6, 81920, v6
    v_lshrrev_b32 v7, 2, v2
    v_lshl_add_u32 v7, v3, 2, v7
    v_mul_u32_u24 v7, 288, v7
    v_and_b32 v8, 3, v2
    v_lshl_add_u32 v7, v8, 3, v7
    s_lshl_b32 s24, s3, 6
    s_add_u32 s24, s24, 81920
    v_add_u32 v7, s24, v7
    s_waitcnt vmcnt(36)
    ds_write_b128 v6, a[0:3] offset:0
    ds_write_b128 v6, a[4:7] offset:4608
    ds_write_b128 v6, a[8:11] offset:9216
    ds_write_b128 v6, a[12:15] offset:13824
    s_waitcnt lgkmcnt(0)
    s_barrier
    ds_read_b64_tr_b16 a[0:1], v7 offset:0
    ds_read_b64_tr_b16 a[2:3], v7 offset:4608
    ds_read_b64_tr_b16 a[4:5], v7 offset:32
    ds_read_b64_tr_b16 a[6:7], v7 offset:4640
    ds_read_b64_tr_b16 a[8:9], v7 offset:9216
    ds_read_b64_tr_b16 a[10:11], v7 offset:13824
    ds_read_b64_tr_b16 a[12:13], v7 offset:9248
    ds_read_b64_tr_b16 a[14:15], v7 offset:13856
    s_waitcnt vmcnt(32)
    ds_write_b128 v6, a[16:19] offset:18432
    ds_write_b128 v6, a[20:23] offset:23040
    ds_write_b128 v6, a[24:27] offset:27648
    ds_write_b128 v6, a[28:31] offset:32256
    s_waitcnt lgkmcnt(0)
    s_barrier
    ds_read_b64_tr_b16 a[16:17], v7 offset:18432
    ds_read_b64_tr_b16 a[18:19], v7 offset:23040
    ds_read_b64_tr_b16 a[20:21], v7 offset:18464
    ds_read_b64_tr_b16 a[22:23], v7 offset:23072
    ds_read_b64_tr_b16 a[24:25], v7 offset:27648
    ds_read_b64_tr_b16 a[26:27], v7 offset:32256
    ds_read_b64_tr_b16 a[28:29], v7 offset:27680
    ds_read_b64_tr_b16 a[30:31], v7 offset:32288
    s_waitcnt vmcnt(28)
    ds_write_b128 v6, a[32:35] offset:0
    ds_write_b128 v6, a[36:39] offset:4608
    ds_write_b128 v6, a[40:43] offset:9216
    ds_write_b128 v6, a[44:47] offset:13824
    s_waitcnt lgkmcnt(0)
    s_barrier
    ds_read_b64_tr_b16 a[32:33], v7 offset:0
    ds_read_b64_tr_b16 a[34:35], v7 offset:4608
    ds_read_b64_tr_b16 a[36:37], v7 offset:32
    ds_read_b64_tr_b16 a[38:39], v7 offset:4640
    ds_read_b64_tr_b16 a[40:41], v7 offset:9216
    ds_read_b64_tr_b16 a[42:43], v7 offset:13824
    ds_read_b64_tr_b16 a[44:45], v7 offset:9248
    ds_read_b64_tr_b16 a[46:47], v7 offset:13856
    s_waitcnt vmcnt(24)
    ds_write_b128 v6, a[48:51] offset:18432
    ds_write_b128 v6, a[52:55] offset:23040
    ds_write_b128 v6, a[56:59] offset:27648
    ds_write_b128 v6, a[60:63] offset:32256
    s_waitcnt lgkmcnt(0)
    s_barrier
    ds_read_b64_tr_b16 a[48:49], v7 offset:18432
    ds_read_b64_tr_b16 a[50:51], v7 offset:23040
    ds_read_b64_tr_b16 a[52:53], v7 offset:18464
    ds_read_b64_tr_b16 a[54:55], v7 offset:23072
    ds_read_b64_tr_b16 a[56:57], v7 offset:27648
    ds_read_b64_tr_b16 a[58:59], v7 offset:32256
    ds_read_b64_tr_b16 a[60:61], v7 offset:27680
    ds_read_b64_tr_b16 a[62:63], v7 offset:32288
    s_waitcnt vmcnt(20)
    ds_write_b128 v6, a[64:67] offset:0
    ds_write_b128 v6, a[68:71] offset:4608
    ds_write_b128 v6, a[72:75] offset:9216
    ds_write_b128 v6, a[76:79] offset:13824
    s_waitcnt lgkmcnt(0)
    s_barrier
    ds_read_b64_tr_b16 a[64:65], v7 offset:0
    ds_read_b64_tr_b16 a[66:67], v7 offset:4608
    ds_read_b64_tr_b16 a[68:69], v7 offset:32
    ds_read_b64_tr_b16 a[70:71], v7 offset:4640
    ds_read_b64_tr_b16 a[72:73], v7 offset:9216
    ds_read_b64_tr_b16 a[74:75], v7 offset:13824
    ds_read_b64_tr_b16 a[76:77], v7 offset:9248
    ds_read_b64_tr_b16 a[78:79], v7 offset:13856
    s_waitcnt vmcnt(16)
    ds_write_b128 v6, a[80:83] offset:18432
    ds_write_b128 v6, a[84:87] offset:23040
    ds_write_b128 v6, a[88:91] offset:27648
    ds_write_b128 v6, a[92:95] offset:32256
    s_waitcnt lgkmcnt(0)
    s_barrier
    ds_read_b64_tr_b16 a[80:81], v7 offset:18432
    ds_read_b64_tr_b16 a[82:83], v7 offset:23040
    ds_read_b64_tr_b16 a[84:85], v7 offset:18464
    ds_read_b64_tr_b16 a[86:87], v7 offset:23072
    ds_read_b64_tr_b16 a[88:89], v7 offset:27648
    ds_read_b64_tr_b16 a[90:91], v7 offset:32256
    ds_read_b64_tr_b16 a[92:93], v7 offset:27680
    ds_read_b64_tr_b16 a[94:95], v7 offset:32288
    s_waitcnt vmcnt(12)
    ds_write_b128 v6, a[96:99] offset:0
    ds_write_b128 v6, a[100:103] offset:4608
    ds_write_b128 v6, a[104:107] offset:9216
    ds_write_b128 v6, a[108:111] offset:13824
    s_waitcnt lgkmcnt(0)
    s_barrier
    ds_read_b64_tr_b16 a[96:97], v7 offset:0
    ds_read_b64_tr_b16 a[98:99], v7 offset:4608
    ds_read_b64_tr_b16 a[100:101], v7 offset:32
    ds_read_b64_tr_b16 a[102:103], v7 offset:4640
    ds_read_b64_tr_b16 a[104:105], v7 offset:9216
    ds_read_b64_tr_b16 a[106:107], v7 offset:13824
    ds_read_b64_tr_b16 a[108:109], v7 offset:9248
    ds_read_b64_tr_b16 a[110:111], v7 offset:13856
    s_waitcnt vmcnt(8)
    ds_write_b128 v6, a[112:115] offset:18432
    ds_write_b128 v6, a[116:119] offset:23040
    ds_write_b128 v6, a[120:123] offset:27648
    ds_write_b128 v6, a[124:127] offset:32256
    s_waitcnt lgkmcnt(0)
    s_barrier
    ds_read_b64_tr_b16 a[112:113], v7 offset:18432
    ds_read_b64_tr_b16 a[114:115], v7 offset:23040
    ds_read_b64_tr_b16 a[116:117], v7 offset:18464
    ds_read_b64_tr_b16 a[118:119], v7 offset:23072
    ds_read_b64_tr_b16 a[120:121], v7 offset:27648
    ds_read_b64_tr_b16 a[122:123], v7 offset:32256
    ds_read_b64_tr_b16 a[124:125], v7 offset:27680
    ds_read_b64_tr_b16 a[126:127], v7 offset:32288
    s_waitcnt vmcnt(4)
    ds_write_b128 v6, a[128:131] offset:0
    ds_write_b128 v6, a[132:135] offset:4608
    ds_write_b128 v6, a[136:139] offset:9216
    ds_write_b128 v6, a[140:143] offset:13824
    s_waitcnt lgkmcnt(0)
    s_barrier
    ds_read_b64_tr_b16 a[128:129], v7 offset:0
    ds_read_b64_tr_b16 a[130:131], v7 offset:4608
    ds_read_b64_tr_b16 a[132:133], v7 offset:32
    ds_read_b64_tr_b16 a[134:135], v7 offset:4640
    ds_read_b64_tr_b16 a[136:137], v7 offset:9216
    ds_read_b64_tr_b16 a[138:139], v7 offset:13824
    ds_read_b64_tr_b16 a[140:141], v7 offset:9248
    ds_read_b64_tr_b16 a[142:143], v7 offset:13856
    s_waitcnt vmcnt(0)
    ds_write_b128 v6, a[144:147] offset:18432
    ds_write_b128 v6, a[148:151] offset:23040
    ds_write_b128 v6, a[152:155] offset:27648
    ds_write_b128 v6, a[156:159] offset:32256
    s_waitcnt lgkmcnt(0)
    s_barrier
    ds_read_b64_tr_b16 a[144:145], v7 offset:18432
    ds_read_b64_tr_b16 a[146:147], v7 offset:23040
    ds_read_b64_tr_b16 a[148:149], v7 offset:18464
    ds_read_b64_tr_b16 a[150:151], v7 offset:23072
    ds_read_b64_tr_b16 a[152:153], v7 offset:27648
    ds_read_b64_tr_b16 a[154:155], v7 offset:32256
    ds_read_b64_tr_b16 a[156:157], v7 offset:27680
    ds_read_b64_tr_b16 a[158:159], v7 offset:32288
    s_waitcnt lgkmcnt(0)
    s_cmp_eq_u32 s92, 1
    s_cbranch_scc1 interleave_layers__linear_attn_block__memory_aug_recurrent_mem_tr__prompt_kernel_k3_l1
    s_load_dwordx2 s[6:7], s[0:1], 0
    s_waitcnt lgkmcnt(0)
    s_mov_b32 s16, s6
    s_mov_b32 s17, s7
    s_mov_b32 s18, 2621440
    s_mov_b32 s19, 0x00020000
    s_mov_b32 s46, 64
    s_mov_b32 s47, 32
    s_mov_b32 s50, 0
    s_mov_b32 s58, 0
    s_mov_b32 s76, 16
    s_mov_b32 s77, 163840
interleave_layers__linear_attn_block__memory_aug_recurrent_mem_tr__prompt_kernel_k3_entry:
    v_lshlrev_b32 v5, 4, v1
    s_mul_i32 s24, s3, 5120
    s_add_u32 s24, s24, 12582912
    v_add_u32 v8, s24, v5
    v_lshlrev_b32 v9, 3, v1
    s_add_u32 s24, s24, 2048
    v_add_u32 v9, s24, v9
    s_cmp_eq_u32 s50, 1
    s_cselect_b32 s25, 16, 1280
    s_cselect_b32 s26, 256, 8
    v_mul_u32_u24 v10, s25, v2
    v_mul_u32_u24 v11, s26, v3
    s_lshl_b32 s24, s56, 2
    s_add_u32 s24, s24, s3
    s_mul_i32 s25, s24, s46
    v_add3_u32 v10, v10, v11, s25
    v_add_u32 v11, s47, v10
    s_lshl_b32 s24, s24, 10
    s_add_u32 s24, s24, s58
    v_add_u32 v12, s24, v5
    s_mul_i32 s24, s3, 5120
    s_add_u32 s24, s24, 0
    v_add_u32 v13, s24, v5
    s_mov_b32 s54, 0x358637bd
    s_mul_i32 s43, s57, 40960
    s_mov_b32 s40, 0
    s_mov_b32 s42, 0
    s_cmp_eq_u32 s3, 0
    s_cbranch_scc0 interleave_layers__linear_attn_block__memory_aug_recurrent_mem_tr__prompt_kernel_kw11
    s_lshl_b32 s24, s92, 10
    s_add_u32 s24, s24, 23101440
    v_and_b32 v15, 7, v1
    v_lshlrev_b32 v15, 7, v15
    v_add_u32 v15, s24, v15
    s_cmp_eq_u32 s92, 0
    s_cselect_b32 s26, 31, 1
    s_mov_b64 exec, 255
    s_mov_b32 s61, 0
interleave_layers__linear_attn_block__memory_aug_recurrent_mem_tr__prompt_kernel_k3_w0:
    v_mov_b32 v14, 0
    buffer_atomic_add v14, v15, s[8:11], 0 offen sc0 sc1
    s_waitcnt vmcnt(0)
    v_cmp_gt_i32 vcc, s26, v14
    s_cbranch_vccz interleave_layers__linear_attn_block__memory_aug_recurrent_mem_tr__prompt_kernel_k3_w0_ok
    s_add_u32 s61, s61, 1
    s_cmp_ge_u32 s61, s60
    s_cbranch_scc1 interleave_layers__linear_attn_block__memory_aug_recurrent_mem_tr__prompt_kernel_k3_w0_to
    s_sleep 6
    s_branch interleave_layers__linear_attn_block__memory_aug_recurrent_mem_tr__prompt_kernel_k3_w0
interleave_layers__linear_attn_block__memory_aug_recurrent_mem_tr__prompt_kernel_k3_w0_to:
    s_mov_b32 s60, 1
interleave_layers__linear_attn_block__memory_aug_recurrent_mem_tr__prompt_kernel_k3_w0_ok:
    s_mov_b64 exec, -1
interleave_layers__linear_attn_block__memory_aug_recurrent_mem_tr__prompt_kernel_kw11:
    s_barrier
    s_mov_b32 s41, s43
    s_add_u32 s25, s41, 20480
    buffer_load_dwordx4 v[16:19], v8, s[8:11], s41 offen offset:0 sc1
    buffer_load_dwordx4 v[20:23], v8, s[8:11], s41 offen offset:1024 sc1
    buffer_load_dwordx2 v[24:25], v9, s[8:11], s41 offen offset:0 sc1
    buffer_load_dwordx4 v[26:29], v8, s[8:11], s41 offen offset:2560 sc1
    buffer_load_dwordx4 v[30:33], v8, s[8:11], s41 offen offset:3584 sc1
    buffer_load_dwordx2 v[34:35], v9, s[8:11], s41 offen offset:2560 sc1
    buffer_load_dwordx4 v[36:39], v8, s[8:11], s25 offen offset:0 sc1
    buffer_load_dwordx4 v[40:43], v8, s[8:11], s25 offen offset:1024 sc1
    buffer_load_dwordx2 v[44:45], v9, s[8:11], s25 offen offset:0 sc1
    buffer_load_dwordx4 v[46:49], v8, s[8:11], s25 offen offset:2560 sc1
    buffer_load_dwordx4 v[50:53], v8, s[8:11], s25 offen offset:3584 sc1
    buffer_load_dwordx2 v[54:55], v9, s[8:11], s25 offen offset:2560 sc1
    buffer_load_dwordx2 v[96:97], v10, s[16:19], s41 offen sc1
    buffer_load_dwordx2 v[98:99], v11, s[16:19], s41 offen sc1
    buffer_load_dwordx2 v[100:101], v10, s[16:19], s25 offen sc1
    buffer_load_dwordx2 v[102:103], v11, s[16:19], s25 offen sc1
    s_add_u32 s41, s43, s77
    s_add_u32 s25, s41, 20480
    buffer_load_dwordx4 v[56:59], v8, s[8:11], s41 offen offset:0 sc1
    buffer_load_dwordx4 v[60:63], v8, s[8:11], s41 offen offset:1024 sc1
    buffer_load_dwordx2 v[64:65], v9, s[8:11], s41 offen offset:0 sc1
    buffer_load_dwordx4 v[66:69], v8, s[8:11], s41 offen offset:2560 sc1
    buffer_load_dwordx4 v[70:73], v8, s[8:11], s41 offen offset:3584 sc1
    buffer_load_dwordx2 v[74:75], v9, s[8:11], s41 offen offset:2560 sc1
    buffer_load_dwordx4 v[76:79], v8, s[8:11], s25 offen offset:0 sc1
    buffer_load_dwordx4 v[80:83], v8, s[8:11], s25 offen offset:1024 sc1
    buffer_load_dwordx2 v[84:85], v9, s[8:11], s25 offen offset:0 sc1
    buffer_load_dwordx4 v[86:89], v8, s[8:11], s25 offen offset:2560 sc1
    buffer_load_dwordx4 v[90:93], v8, s[8:11], s25 offen offset:3584 sc1
    buffer_load_dwordx2 v[94:95], v9, s[8:11], s25 offen offset:2560 sc1
    buffer_load_dwordx2 v[104:105], v10, s[16:19], s41 offen sc1
    buffer_load_dwordx2 v[106:107], v11, s[16:19], s41 offen sc1
    buffer_load_dwordx2 v[108:109], v10, s[16:19], s25 offen sc1
    buffer_load_dwordx2 v[110:111], v11, s[16:19], s25 offen sc1
    s_lshl_b32 s24, s92, 7
    s_add_u32 s24, s24, 23103488
    v_lshlrev_b32 v15, 2, v1
    v_add_u32 v15, s24, v15
    s_mov_b32 s61, 0
interleave_layers__linear_attn_block__memory_aug_recurrent_mem_tr__prompt_kernel_k3_w:
    buffer_load_dword v14, v15, s[8:11], 0 offen sc1
    s_waitcnt vmcnt(0)
    v_cmp_le_i32 vcc, 1, v14
    s_mov_b32 s25, 0xffffff
    s_and_b32 s24, vcc_lo, s25
    s_cmp_eq_u32 s24, s25
    s_cbranch_scc1 interleave_layers__linear_attn_block__memory_aug_recurrent_mem_tr__prompt_kernel_k3_w_ok
    s_add_u32 s61, s61, 1
    s_cmp_ge_u32 s61, s60
    s_cbranch_scc1 interleave_layers__linear_attn_block__memory_aug_recurrent_mem_tr__prompt_kernel_k3_w_to
    s_sleep 2
    s_branch interleave_layers__linear_attn_block__memory_aug_recurrent_mem_tr__prompt_kernel_k3_w
interleave_layers__linear_attn_block__memory_aug_recurrent_mem_tr__prompt_kernel_k3_w_to:
    s_mov_b32 s60, 1
interleave_layers__linear_attn_block__memory_aug_recurrent_mem_tr__prompt_kernel_k3_w_ok:
    s_mul_i32 s24, s92, 131072
    s_mul_i32 s25, s3, 28672
    s_add_u32 s24, s24, s25
    s_add_u32 s24, s24, 22020096
    s_add_u32 s25, s24, 0
    buffer_load_dwordx4 a[160:163], v5, s[8:11], s25 offen sc1
    s_add_u32 s25, s24, 1024
    buffer_load_dwordx4 a[164:167], v5, s[8:11], s25 offen sc1
    s_add_u32 s25, s24, 2048
    buffer_load_dwordx4 a[168:171], v5, s[8:11], s25 offen sc1
    s_add_u32 s25, s24, 3072
    buffer_load_dwordx4 a[172:175], v5, s[8:11], s25 offen sc1
    s_add_u32 s25, s24, 4096
    buffer_load_dwordx4 a[176:179], v5, s[8:11], s25 offen sc1
    s_add_u32 s25, s24, 5120
    buffer_load_dwordx4 a[180:183], v5, s[8:11], s25 offen sc1
    s_add_u32 s25, s24, 6144
    buffer_load_dwordx2 a[184:185], v5, s[8:11], s25 offen sc1
    s_add_u32 s25, s24, 7168
    buffer_load_dwordx4 a[186:189], v5, s[8:11], s25 offen sc1
    s_add_u32 s25, s24, 8192
    buffer_load_dwordx2 a[190:191], v5, s[8:11], s25 offen sc1
    s_add_u32 s25, s24, 9216
    buffer_load_dwordx4 a[192:195], v5, s[8:11], s25 offen sc1
    s_add_u32 s25, s24, 10240
    buffer_load_dwordx4 a[196:199], v5, s[8:11], s25 offen sc1
    s_add_u32 s25, s24, 11264
    buffer_load_dwordx2 a[200:201], v5, s[8:11], s25 offen sc1
    s_add_u32 s25, s24, 12288
    buffer_load_dwordx4 a[202:205], v5, s[8:11], s25 offen sc1
    s_add_u32 s25, s24, 13312
    buffer_load_dwordx2 a[206:207], v5, s[8:11], s25 offen sc1
    s_add_u32 s25, s24, 14336
    buffer_load_dwordx4 a[208:211], v5, s[8:11], s25 offen sc1
    s_add_u32 s25, s24, 15360
    buffer_load_dwordx4 a[212:215], v5, s[8:11], s25 offen sc1
    s_add_u32 s25, s24, 16384
    buffer_load_dwordx4 a[216:219], v5, s[8:11], s25 offen sc1
    s_add_u32 s25, s24, 17408
    buffer_load_dwordx4 a[220:223], v5, s[8:11], s25 offen sc1
    s_add_u32 s25, s24, 18432
    buffer_load_dwordx4 a[224:227], v5, s[8:11], s25 offen sc1
    s_add_u32 s25, s24, 19456
    buffer_load_dwordx4 a[228:231], v5, s[8:11], s25 offen sc1
    s_add_u32 s25, s24, 20480
    buffer_load_dwordx2 a[232:233], v5, s[8:11], s25 offen sc1
    s_add_u32 s25, s24, 21504
    buffer_load_dwordx4 a[234:237], v5, s[8:11], s25 offen sc1
    s_add_u32 s25, s24, 22528
    buffer_load_dwordx2 a[238:239], v5, s[8:11], s25 offen sc1
    s_add_u32 s25, s24, 23552
    buffer_load_dwordx4 a[240:243], v5, s[8:11], s25 offen sc1
    s_add_u32 s25, s24, 24576
    buffer_load_dwordx4 a[244:247], v5, s[8:11], s25 offen sc1
    s_add_u32 s25, s24, 25600
    buffer_load_dwordx2 a[248:249], v5, s[8:11], s25 offen sc1
    s_add_u32 s25, s24, 26624
    buffer_load_dwordx4 a[250:253], v5, s[8:11], s25 offen sc1
    s_add_u32 s25, s24, 27648
    buffer_load_dwordx2 a[254:255], v5, s[8:11], s25 offen sc1
    s_waitcnt vmcnt(0)
    v_mfma_f32_16x16x32_bf16 v[132:135], a[192:195], v[16:19], 0
    v_mfma_f32_16x16x32_bf16 v[136:139], a[202:205], v[20:23], 0
    v_mfma_f32_16x16x32_bf16 v[112:115], a[160:163], v[16:19], 0
    v_mfma_f32_16x16x32_bf16 v[116:119], a[164:167], v[16:19], 0
    v_mfma_f32_16x16x32_bf16 v[120:123], a[172:175], v[16:19], 0
    v_mfma_f32_16x16x32_bf16 v[124:127], a[180:183], v[20:23], 0
    v_mfma_f32_16x16x32_bf16 v[128:131], a[186:189], v[20:23], 0
    v_mfma_f32_16x16x32_bf16 v[132:135], a[196:199], v[20:23], v[132:135]
    v_mfma_f32_16x16x32_bf16 v[116:119], a[168:171], v[20:23], v[116:119]
    v_mfma_f32_16x16x32_bf16 v[120:123], a[176:179], v[20:23], v[120:123]
    v_mfma_f32_16x16x16_bf16 v[136:139], a[206:207], v[24:25], v[136:139]
    s_nop 0
    v_mfma_f32_16x16x16_bf16 v[124:127], a[184:185], v[24:25], v[124:127]
    v_mfma_f32_16x16x16_bf16 v[128:131], a[190:191], v[24:25], v[128:131]
    v_mfma_f32_16x16x16_bf16 v[132:135], a[200:201], v[24:25], v[132:135]
    v_mfma_f32_16x16x32_bf16 v[160:163], a[240:243], v[26:29], 0
    v_mfma_f32_16x16x32_bf16 v[164:167], a[250:253], v[30:33], 0
    v_mfma_f32_16x16x32_bf16 v[140:143], a[208:211], v[26:29], 0
    v_mfma_f32_16x16x32_bf16 v[144:147], a[212:215], v[26:29], 0
    v_mfma_f32_16x16x32_bf16 v[148:151], a[220:223], v[26:29], 0
    v_mfma_f32_16x16x32_bf16 v[152:155], a[228:231], v[30:33], 0
    v_mfma_f32_16x16x32_bf16 v[156:159], a[234:237], v[30:33], 0
    v_mfma_f32_16x16x32_bf16 v[160:163], a[244:247], v[30:33], v[160:163]
    v_mfma_f32_16x16x32_bf16 v[144:147], a[216:219], v[30:33], v[144:147]
    v_mfma_f32_16x16x32_bf16 v[148:151], a[224:227], v[30:33], v[148:151]
    v_mfma_f32_16x16x16_bf16 v[164:167], a[254:255], v[34:35], v[164:167]
    s_nop 0
    v_mfma_f32_16x16x16_bf16 v[152:155], a[232:233], v[34:35], v[152:155]
    v_mfma_f32_16x16x16_bf16 v[156:159], a[238:239], v[34:35], v[156:159]
    v_mfma_f32_16x16x16_bf16 v[160:163], a[248:249], v[34:35], v[160:163]
    v_add_f32 v132, s54, v132
    v_add_f32 v133, s54, v133
    v_add_f32 v134, s54, v134
    v_add_f32 v135, s54, v135
    v_add_f32 v136, s54, v136
    v_rcp_f32 v132, v132
    v_rcp_f32 v133, v133
    v_rcp_f32 v134, v134
    v_rcp_f32 v135, v135
    v_rcp_f32 v136, v136
    v_mul_f32 v112, v112, v132
    v_mul_f32 v113, v113, v132
    v_mul_f32 v114, v114, v132
    v_mul_f32 v115, v115, v132
    v_cvt_pk_bf16_f32 v168, v112, v113
    v_cvt_pk_bf16_f32 v169, v114, v115
    v_mul_f32 v116, v116, v133
    v_mul_f32 v117, v117, v133
    v_mul_f32 v118, v118, v133
    v_mul_f32 v119, v119, v133
    v_cvt_pk_bf16_f32 v170, v116, v117
    v_cvt_pk_bf16_f32 v171, v118, v119
    v_mul_f32 v120, v120, v134
    v_mul_f32 v121, v121, v134
    v_mul_f32 v122, v122, v134
    v_mul_f32 v123, v123, v134
    v_cvt_pk_bf16_f32 v172, v120, v121
    v_cvt_pk_bf16_f32 v173, v122, v123
    v_mul_f32 v124, v124, v135
    v_mul_f32 v125, v125, v135
    v_mul_f32 v126, v126, v135
    v_mul_f32 v127, v127, v135
    v_cvt_pk_bf16_f32 v174, v124, v125
    v_cvt_pk_bf16_f32 v175, v126, v127
    v_mul_f32 v128, v128, v136
    v_mul_f32 v129, v129, v136
    v_mul_f32 v130, v130, v136
    v_mul_f32 v131, v131, v136
    v_cvt_pk_bf16_f32 v176, v128, v129
    v_cvt_pk_bf16_f32 v177, v130, v131
    v_add_f32 v160, s54, v160
    v_add_f32 v161, s54, v161
    v_add_f32 v162, s54, v162
    v_add_f32 v163, s54, v163
    v_add_f32 v164, s54, v164
    v_rcp_f32 v160, v160
    v_rcp_f32 v161, v161
    v_rcp_f32 v162, v162
    v_rcp_f32 v163, v163
    v_rcp_f32 v164, v164
    v_mul_f32 v140, v140, v160
    v_mul_f32 v141, v141, v160
    v_mul_f32 v142, v142, v160
    v_mul_f32 v143, v143, v160
    v_cvt_pk_bf16_f32 v178, v140, v141
    v_cvt_pk_bf16_f32 v179, v142, v143
    v_mul_f32 v144, v144, v161
    v_mul_f32 v145, v145, v161
    v_mul_f32 v146, v146, v161
    v_mul_f32 v147, v147, v161
    v_cvt_pk_bf16_f32 v180, v144, v145
    v_cvt_pk_bf16_f32 v181, v146, v147
    v_mul_f32 v148, v148, v162
    v_mul_f32 v149, v149, v162
    v_mul_f32 v150, v150, v162
    v_mul_f32 v151, v151, v162
    v_cvt_pk_bf16_f32 v182, v148, v149
    v_cvt_pk_bf16_f32 v183, v150, v151
    v_mul_f32 v152, v152, v163
    v_mul_f32 v153, v153, v163
    v_mul_f32 v154, v154, v163
    v_mul_f32 v155, v155, v163
    v_cvt_pk_bf16_f32 v184, v152, v153
    v_cvt_pk_bf16_f32 v185, v154, v155
    v_mul_f32 v156, v156, v164
    v_mul_f32 v157, v157, v164
    v_mul_f32 v158, v158, v164
    v_mul_f32 v159, v159, v164
    v_cvt_pk_bf16_f32 v186, v156, v157
    v_cvt_pk_bf16_f32 v187, v158, v159
    v_mfma_f32_16x16x32_bf16 v[132:135], a[192:195], v[36:39], 0
    v_mfma_f32_16x16x32_bf16 v[136:139], a[202:205], v[40:43], 0
    v_mfma_f32_16x16x32_bf16 v[112:115], a[160:163], v[36:39], 0
    v_mfma_f32_16x16x32_bf16 v[116:119], a[164:167], v[36:39], 0
    v_mfma_f32_16x16x32_bf16 v[120:123], a[172:175], v[36:39], 0
    v_mfma_f32_16x16x32_bf16 v[124:127], a[180:183], v[40:43], 0
    v_mfma_f32_16x16x32_bf16 v[128:131], a[186:189], v[40:43], 0
    v_mfma_f32_16x16x32_bf16 v[132:135], a[196:199], v[40:43], v[132:135]
    v_mfma_f32_16x16x32_bf16 v[116:119], a[168:171], v[40:43], v[116:119]
    v_mfma_f32_16x16x32_bf16 v[120:123], a[176:179], v[40:43], v[120:123]
    v_mfma_f32_16x16x16_bf16 v[136:139], a[206:207], v[44:45], v[136:139]
    s_nop 0
    v_mfma_f32_16x16x16_bf16 v[124:127], a[184:185], v[44:45], v[124:127]
    v_mfma_f32_16x16x16_bf16 v[128:131], a[190:191], v[44:45], v[128:131]
    v_mfma_f32_16x16x16_bf16 v[132:135], a[200:201], v[44:45], v[132:135]
    v_mfma_f32_16x16x32_bf16 v[160:163], a[240:243], v[46:49], 0
    v_mfma_f32_16x16x32_bf16 v[164:167], a[250:253], v[50:53], 0
    v_mfma_f32_16x16x32_bf16 v[140:143], a[208:211], v[46:49], 0
    v_mfma_f32_16x16x32_bf16 v[144:147], a[212:215], v[46:49], 0
    v_mfma_f32_16x16x32_bf16 v[148:151], a[220:223], v[46:49], 0
    v_mfma_f32_16x16x32_bf16 v[152:155], a[228:231], v[50:53], 0
    v_mfma_f32_16x16x32_bf16 v[156:159], a[234:237], v[50:53], 0
    v_mfma_f32_16x16x32_bf16 v[160:163], a[244:247], v[50:53], v[160:163]
    v_mfma_f32_16x16x32_bf16 v[144:147], a[216:219], v[50:53], v[144:147]
    v_mfma_f32_16x16x32_bf16 v[148:151], a[224:227], v[50:53], v[148:151]
    v_mfma_f32_16x16x16_bf16 v[164:167], a[254:255], v[54:55], v[164:167]
    s_nop 0
    v_mfma_f32_16x16x16_bf16 v[152:155], a[232:233], v[54:55], v[152:155]
    v_mfma_f32_16x16x16_bf16 v[156:159], a[238:239], v[54:55], v[156:159]
    v_mfma_f32_16x16x16_bf16 v[160:163], a[248:249], v[54:55], v[160:163]
    v_add_f32 v132, s54, v132
    v_add_f32 v133, s54, v133
    v_add_f32 v134, s54, v134
    v_add_f32 v135, s54, v135
    v_add_f32 v136, s54, v136
    v_rcp_f32 v132, v132
    v_rcp_f32 v133, v133
    v_rcp_f32 v134, v134
    v_rcp_f32 v135, v135
    v_rcp_f32 v136, v136
    v_mul_f32 v112, v112, v132
    v_mul_f32 v113, v113, v132
    v_mul_f32 v114, v114, v132
    v_mul_f32 v115, v115, v132
    v_cvt_pk_bf16_f32 v188, v112, v113
    v_cvt_pk_bf16_f32 v189, v114, v115
    v_mul_f32 v116, v116, v133
    v_mul_f32 v117, v117, v133
    v_mul_f32 v118, v118, v133
    v_mul_f32 v119, v119, v133
    v_cvt_pk_bf16_f32 v190, v116, v117
    v_cvt_pk_bf16_f32 v191, v118, v119
    v_mul_f32 v120, v120, v134
    v_mul_f32 v121, v121, v134
    v_mul_f32 v122, v122, v134
    v_mul_f32 v123, v123, v134
    v_cvt_pk_bf16_f32 v192, v120, v121
    v_cvt_pk_bf16_f32 v193, v122, v123
    v_mul_f32 v124, v124, v135
    v_mul_f32 v125, v125, v135
    v_mul_f32 v126, v126, v135
    v_mul_f32 v127, v127, v135
    v_cvt_pk_bf16_f32 v194, v124, v125
    v_cvt_pk_bf16_f32 v195, v126, v127
    v_mul_f32 v128, v128, v136
    v_mul_f32 v129, v129, v136
    v_mul_f32 v130, v130, v136
    v_mul_f32 v131, v131, v136
    v_cvt_pk_bf16_f32 v196, v128, v129
    v_cvt_pk_bf16_f32 v197, v130, v131
    v_add_f32 v160, s54, v160
    v_add_f32 v161, s54, v161
    v_add_f32 v162, s54, v162
    v_add_f32 v163, s54, v163
    v_add_f32 v164, s54, v164
    v_rcp_f32 v160, v160
    v_rcp_f32 v161, v161
    v_rcp_f32 v162, v162
    v_rcp_f32 v163, v163
    v_rcp_f32 v164, v164
    v_mul_f32 v140, v140, v160
    v_mul_f32 v141, v141, v160
    v_mul_f32 v142, v142, v160
    v_mul_f32 v143, v143, v160
    v_cvt_pk_bf16_f32 v198, v140, v141
    v_cvt_pk_bf16_f32 v199, v142, v143
    v_mul_f32 v144, v144, v161
    v_mul_f32 v145, v145, v161
    v_mul_f32 v146, v146, v161
    v_mul_f32 v147, v147, v161
    v_cvt_pk_bf16_f32 v200, v144, v145
    v_cvt_pk_bf16_f32 v201, v146, v147
    v_mul_f32 v148, v148, v162
    v_mul_f32 v149, v149, v162
    v_mul_f32 v150, v150, v162
    v_mul_f32 v151, v151, v162
    v_cvt_pk_bf16_f32 v202, v148, v149
    v_cvt_pk_bf16_f32 v203, v150, v151
    v_mul_f32 v152, v152, v163
    v_mul_f32 v153, v153, v163
    v_mul_f32 v154, v154, v163
    v_mul_f32 v155, v155, v163
    v_cvt_pk_bf16_f32 v204, v152, v153
    v_cvt_pk_bf16_f32 v205, v154, v155
    v_mul_f32 v156, v156, v164
    v_mul_f32 v157, v157, v164
    v_mul_f32 v158, v158, v164
    v_mul_f32 v159, v159, v164
    v_cvt_pk_bf16_f32 v206, v156, v157
    v_cvt_pk_bf16_f32 v207, v158, v159
    v_add_u32 v14, s42, v13
    ds_write_b128 v14, v[168:171] offset:0
    ds_write_b128 v14, v[172:175] offset:1024
    ds_write_b128 v14, v[176:179] offset:2048
    ds_write_b128 v14, v[180:183] offset:3072
    ds_write_b128 v14, v[184:187] offset:4096
    ds_write_b128 v14, v[188:191] offset:20480
    ds_write_b128 v14, v[192:195] offset:21504
    ds_write_b128 v14, v[196:199] offset:22528
    ds_write_b128 v14, v[200:203] offset:23552
    ds_write_b128 v14, v[204:207] offset:24576
    s_waitcnt lgkmcnt(0)
    s_barrier
interleave_layers__linear_attn_block__memory_aug_recurrent_mem_tr__prompt_kernel_k3_seg:
    v_add_u32 v15, s42, v5
    ds_read_b128 v[208:211], v15 offset:0
    ds_read_b128 v[212:215], v15 offset:20480
    ds_read_b128 v[216:219], v15 offset:1024
    ds_read_b128 v[220:223], v15 offset:21504
    ds_read_b128 v[224:227], v15 offset:2048
    ds_read_b128 v[228:231], v15 offset:22528
    ds_read_b128 v[232:235], v15 offset:3072
    ds_read_b128 v[236:239], v15 offset:23552
    s_waitcnt lgkmcnt(6)
    v_mfma_f32_16x16x32_bf16 v[240:243], a[0:3], v[208:211], 0
    v_mfma_f32_16x16x32_bf16 v[244:247], a[4:7], v[208:211], 0
    v_mfma_f32_16x16x32_bf16 v[248:251], a[0:3], v[212:215], 0
    v_mfma_f32_16x16x32_bf16 v[252:255], a[4:7], v[212:215], 0
    ds_read_b128 v[208:211], v15 offset:4096
    ds_read_b128 v[212:215], v15 offset:24576
    s_waitcnt lgkmcnt(6)
    v_mfma_f32_16x16x32_bf16 v[240:243], a[8:11], v[216:219], v[240:243]
    v_mfma_f32_16x16x32_bf16 v[244:247], a[12:15], v[216:219], v[244:247]
    v_mfma_f32_16x16x32_bf16 v[248:251], a[8:11], v[220:223], v[248:251]
    v_mfma_f32_16x16x32_bf16 v[252:255], a[12:15], v[220:223], v[252:255]
    ds_read_b128 v[216:219], v15 offset:5120
    ds_read_b128 v[220:223], v15 offset:25600
    s_waitcnt lgkmcnt(6)
    v_mfma_f32_16x16x32_bf16 v[240:243], a[16:19], v[224:227], v[240:243]
    v_mfma_f32_16x16x32_bf16 v[244:247], a[20:23], v[224:227], v[244:247]
    v_mfma_f32_16x16x32_bf16 v[248:251], a[16:19], v[228:231], v[248:251]
    v_mfma_f32_16x16x32_bf16 v[252:255], a[20:23], v[228:231], v[252:255]
    ds_read_b128 v[224:227], v15 offset:6144
    ds_read_b128 v[228:231], v15 offset:26624
    s_waitcnt lgkmcnt(6)
    v_mfma_f32_16x16x32_bf16 v[240:243], a[24:27], v[232:235], v[240:243]
    v_mfma_f32_16x16x32_bf16 v[244:247], a[28:31], v[232:235], v[244:247]
    v_mfma_f32_16x16x32_bf16 v[248:251], a[24:27], v[236:239], v[248:251]
    v_mfma_f32_16x16x32_bf16 v[252:255], a[28:31], v[236:239], v[252:255]
    ds_read_b128 v[232:235], v15 offset:7168
    ds_read_b128 v[236:239], v15 offset:27648
    s_waitcnt lgkmcnt(6)
    v_mfma_f32_16x16x32_bf16 v[240:243], a[32:35], v[208:211], v[240:243]
    v_mfma_f32_16x16x32_bf16 v[244:247], a[36:39], v[208:211], v[244:247]
    v_mfma_f32_16x16x32_bf16 v[248:251], a[32:35], v[212:215], v[248:251]
    v_mfma_f32_16x16x32_bf16 v[252:255], a[36:39], v[212:215], v[252:255]
    ds_read_b128 v[208:211], v15 offset:8192
    ds_read_b128 v[212:215], v15 offset:28672
    s_waitcnt lgkmcnt(6)
    v_mfma_f32_16x16x32_bf16 v[240:243], a[40:43], v[216:219], v[240:243]
    v_mfma_f32_16x16x32_bf16 v[244:247], a[44:47], v[216:219], v[244:247]
    v_mfma_f32_16x16x32_bf16 v[248:251], a[40:43], v[220:223], v[248:251]
    v_mfma_f32_16x16x32_bf16 v[252:255], a[44:47], v[220:223], v[252:255]
    ds_read_b128 v[216:219], v15 offset:9216
    ds_read_b128 v[220:223], v15 offset:29696
    s_waitcnt lgkmcnt(6)
    v_mfma_f32_16x16x32_bf16 v[240:243], a[48:51], v[224:227], v[240:243]
    v_mfma_f32_16x16x32_bf16 v[244:247], a[52:55], v[224:227], v[244:247]
    v_mfma_f32_16x16x32_bf16 v[248:251], a[48:51], v[228:231], v[248:251]
    v_mfma_f32_16x16x32_bf16 v[252:255], a[52:55], v[228:231], v[252:255]
    ds_read_b128 v[224:227], v15 offset:10240
    ds_read_b128 v[228:231], v15 offset:30720
    s_waitcnt lgkmcnt(6)
    v_mfma_f32_16x16x32_bf16 v[240:243], a[56:59], v[232:235], v[240:243]
    v_mfma_f32_16x16x32_bf16 v[244:247], a[60:63], v[232:235], v[244:247]
    v_mfma_f32_16x16x32_bf16 v[248:251], a[56:59], v[236:239], v[248:251]
    v_mfma_f32_16x16x32_bf16 v[252:255], a[60:63], v[236:239], v[252:255]
    ds_read_b128 v[232:235], v15 offset:11264
    ds_read_b128 v[236:239], v15 offset:31744
    s_waitcnt lgkmcnt(6)
    v_mfma_f32_16x16x32_bf16 v[240:243], a[64:67], v[208:211], v[240:243]
    v_mfma_f32_16x16x32_bf16 v[244:247], a[68:71], v[208:211], v[244:247]
    v_mfma_f32_16x16x32_bf16 v[248:251], a[64:67], v[212:215], v[248:251]
    v_mfma_f32_16x16x32_bf16 v[252:255], a[68:71], v[212:215], v[252:255]
    ds_read_b128 v[208:211], v15 offset:12288
    ds_read_b128 v[212:215], v15 offset:32768
    s_waitcnt lgkmcnt(6)
    v_mfma_f32_16x16x32_bf16 v[240:243], a[72:75], v[216:219], v[240:243]
    v_mfma_f32_16x16x32_bf16 v[244:247], a[76:79], v[216:219], v[244:247]
    v_mfma_f32_16x16x32_bf16 v[248:251], a[72:75], v[220:223], v[248:251]
    v_mfma_f32_16x16x32_bf16 v[252:255], a[76:79], v[220:223], v[252:255]
    ds_read_b128 v[216:219], v15 offset:13312
    ds_read_b128 v[220:223], v15 offset:33792
    s_waitcnt lgkmcnt(6)
    v_mfma_f32_16x16x32_bf16 v[240:243], a[80:83], v[224:227], v[240:243]
    v_mfma_f32_16x16x32_bf16 v[244:247], a[84:87], v[224:227], v[244:247]
    v_mfma_f32_16x16x32_bf16 v[248:251], a[80:83], v[228:231], v[248:251]
    v_mfma_f32_16x16x32_bf16 v[252:255], a[84:87], v[228:231], v[252:255]
    ds_read_b128 v[224:227], v15 offset:14336
    ds_read_b128 v[228:231], v15 offset:34816
    s_waitcnt lgkmcnt(6)
    v_mfma_f32_16x16x32_bf16 v[240:243], a[88:91], v[232:235], v[240:243]
    v_mfma_f32_16x16x32_bf16 v[244:247], a[92:95], v[232:235], v[244:247]
    v_mfma_f32_16x16x32_bf16 v[248:251], a[88:91], v[236:239], v[248:251]
    v_mfma_f32_16x16x32_bf16 v[252:255], a[92:95], v[236:239], v[252:255]
    ds_read_b128 v[232:235], v15 offset:15360
    ds_read_b128 v[236:239], v15 offset:35840
    s_waitcnt lgkmcnt(6)
    v_mfma_f32_16x16x32_bf16 v[240:243], a[96:99], v[208:211], v[240:243]
    v_mfma_f32_16x16x32_bf16 v[244:247], a[100:103], v[208:211], v[244:247]
    v_mfma_f32_16x16x32_bf16 v[248:251], a[96:99], v[212:215], v[248:251]
    v_mfma_f32_16x16x32_bf16 v[252:255], a[100:103], v[212:215], v[252:255]
    ds_read_b128 v[208:211], v15 offset:16384
    ds_read_b128 v[212:215], v15 offset:36864
    s_waitcnt lgkmcnt(6)
    v_mfma_f32_16x16x32_bf16 v[240:243], a[104:107], v[216:219], v[240:243]
    v_mfma_f32_16x16x32_bf16 v[244:247], a[108:111], v[216:219], v[244:247]
    v_mfma_f32_16x16x32_bf16 v[248:251], a[104:107], v[220:223], v[248:251]
    v_mfma_f32_16x16x32_bf16 v[252:255], a[108:111], v[220:223], v[252:255]
    ds_read_b128 v[216:219], v15 offset:17408
    ds_read_b128 v[220:223], v15 offset:37888
    s_waitcnt lgkmcnt(6)
    v_mfma_f32_16x16x32_bf16 v[240:243], a[112:115], v[224:227], v[240:243]
    v_mfma_f32_16x16x32_bf16 v[244:247], a[116:119], v[224:227], v[244:247]
    v_mfma_f32_16x16x32_bf16 v[248:251], a[112:115], v[228:231], v[248:251]
    v_mfma_f32_16x16x32_bf16 v[252:255], a[116:119], v[228:231], v[252:255]
    ds_read_b128 v[224:227], v15 offset:18432
    ds_read_b128 v[228:231], v15 offset:38912
    s_waitcnt lgkmcnt(6)
    v_mfma_f32_16x16x32_bf16 v[240:243], a[120:123], v[232:235], v[240:243]
    v_mfma_f32_16x16x32_bf16 v[244:247], a[124:127], v[232:235], v[244:247]
    v_mfma_f32_16x16x32_bf16 v[248:251], a[120:123], v[236:239], v[248:251]
    v_mfma_f32_16x16x32_bf16 v[252:255], a[124:127], v[236:239], v[252:255]
    ds_read_b128 v[232:235], v15 offset:19456
    ds_read_b128 v[236:239], v15 offset:39936
    s_waitcnt lgkmcnt(6)
    v_mfma_f32_16x16x32_bf16 v[240:243], a[128:131], v[208:211], v[240:243]
    v_mfma_f32_16x16x32_bf16 v[244:247], a[132:135], v[208:211], v[244:247]
    v_mfma_f32_16x16x32_bf16 v[248:251], a[128:131], v[212:215], v[248:251]
    v_mfma_f32_16x16x32_bf16 v[252:255], a[132:135], v[212:215], v[252:255]
    s_waitcnt lgkmcnt(4)
    v_mfma_f32_16x16x32_bf16 v[240:243], a[136:139], v[216:219], v[240:243]
    v_mfma_f32_16x16x32_bf16 v[244:247], a[140:143], v[216:219], v[244:247]
    v_mfma_f32_16x16x32_bf16 v[248:251], a[136:139], v[220:223], v[248:251]
    v_mfma_f32_16x16x32_bf16 v[252:255], a[140:143], v[220:223], v[252:255]
    s_waitcnt lgkmcnt(2)
    v_mfma_f32_16x16x32_bf16 v[240:243], a[144:147], v[224:227], v[240:243]
    v_mfma_f32_16x16x32_bf16 v[244:247], a[148:151], v[224:227], v[244:247]
    v_mfma_f32_16x16x32_bf16 v[248:251], a[144:147], v[228:231], v[248:251]
    v_mfma_f32_16x16x32_bf16 v[252:255], a[148:151], v[228:231], v[252:255]
    s_waitcnt lgkmcnt(0)
    v_mfma_f32_16x16x32_bf16 v[240:243], a[152:155], v[232:235], v[240:243]
    v_mfma_f32_16x16x32_bf16 v[244:247], a[156:159], v[232:235], v[244:247]
    v_mfma_f32_16x16x32_bf16 v[248:251], a[152:155], v[236:239], v[248:251]
    v_mfma_f32_16x16x32_bf16 v[252:255], a[156:159], v[236:239], v[252:255]
    s_nop 4
    v_cvt_pk_bf16_f32 v208, v240, v241
    v_cvt_pk_bf16_f32 v209, v242, v243
    v_lshlrev_b32 v210, 16, v208
    v_and_b32 v211, 0xffff0000, v208
    v_lshlrev_b32 v212, 16, v96
    v_and_b32 v213, 0xffff0000, v96
    v_pk_add_f32 v[210:211], v[210:211], v[212:213]
    v_cvt_pk_bf16_f32 v216, v210, v211
    v_lshlrev_b32 v210, 16, v209
    v_and_b32 v211, 0xffff0000, v209
    v_lshlrev_b32 v212, 16, v97
    v_and_b32 v213, 0xffff0000, v97
    v_pk_add_f32 v[210:211], v[210:211], v[212:213]
    v_cvt_pk_bf16_f32 v217, v210, v211
    v_cvt_pk_bf16_f32 v208, v244, v245
    v_cvt_pk_bf16_f32 v209, v246, v247
    v_lshlrev_b32 v210, 16, v208
    v_and_b32 v211, 0xffff0000, v208
    v_lshlrev_b32 v212, 16, v98
    v_and_b32 v213, 0xffff0000, v98
    v_pk_add_f32 v[210:211], v[210:211], v[212:213]
    v_cvt_pk_bf16_f32 v218, v210, v211
    v_lshlrev_b32 v210, 16, v209
    v_and_b32 v211, 0xffff0000, v209
    v_lshlrev_b32 v212, 16, v99
    v_and_b32 v213, 0xffff0000, v99
    v_pk_add_f32 v[210:211], v[210:211], v[212:213]
    v_cvt_pk_bf16_f32 v219, v210, v211
    v_cvt_pk_bf16_f32 v208, v248, v249
    v_cvt_pk_bf16_f32 v209, v250, v251
    v_lshlrev_b32 v210, 16, v208
    v_and_b32 v211, 0xffff0000, v208
    v_lshlrev_b32 v212, 16, v100
    v_and_b32 v213, 0xffff0000, v100
    v_pk_add_f32 v[210:211], v[210:211], v[212:213]
    v_cvt_pk_bf16_f32 v220, v210, v211
    v_lshlrev_b32 v210, 16, v209
    v_and_b32 v211, 0xffff0000, v209
    v_lshlrev_b32 v212, 16, v101
    v_and_b32 v213, 0xffff0000, v101
    v_pk_add_f32 v[210:211], v[210:211], v[212:213]
    v_cvt_pk_bf16_f32 v221, v210, v211
    v_cvt_pk_bf16_f32 v208, v252, v253
    v_cvt_pk_bf16_f32 v209, v254, v255
    v_lshlrev_b32 v210, 16, v208
    v_and_b32 v211, 0xffff0000, v208
    v_lshlrev_b32 v212, 16, v102
    v_and_b32 v213, 0xffff0000, v102
    v_pk_add_f32 v[210:211], v[210:211], v[212:213]
    v_cvt_pk_bf16_f32 v222, v210, v211
    v_lshlrev_b32 v210, 16, v209
    v_and_b32 v211, 0xffff0000, v209
    v_lshlrev_b32 v212, 16, v103
    v_and_b32 v213, 0xffff0000, v103
    v_pk_add_f32 v[210:211], v[210:211], v[212:213]
    v_cvt_pk_bf16_f32 v223, v210, v211
    s_add_u32 s25, s43, 20480
    buffer_store_dwordx4 v[216:219], v12, s[8:11], s43 offen sc1
    buffer_store_dwordx4 v[220:223], v12, s[8:11], s25 offen sc1
    s_add_u32 s40, s40, 1
    s_add_u32 s43, s43, s77
    s_cmp_ge_u32 s40, s76
    s_cbranch_scc1 interleave_layers__linear_attn_block__memory_aug_recurrent_mem_tr__prompt_kernel_k3_done
    s_cmp_eq_u32 s40, 1
    s_cbranch_scc0 interleave_layers__linear_attn_block__memory_aug_recurrent_mem_tr__prompt_kernel_k3q12
    s_waitcnt vmcnt(0)
    s_barrier
    s_lshl_b32 s24, s92, 10
    s_lshl_b32 s25, s78, 2
    s_add_u32 s24, s24, s25
    s_add_u32 s24, s24, 23105536
    s_cmp_eq_u32 s3, 0
    s_cbranch_scc0 interleave_layers__linear_attn_block__memory_aug_recurrent_mem_tr__prompt_kernel_pb13
    v_lshlrev_b32 v14, 7, v1
    v_add_u32 v14, s24, v14
    v_mov_b32 v15, 2146435072
    v_cmp_le_u32 vcc, 8, v1
    s_nop 1
    v_cndmask_b32 v14, v14, v15, vcc
    v_mov_b32 v15, s40
    buffer_store_dword v15, v14, s[8:11], 0 offen sc1
interleave_layers__linear_attn_block__memory_aug_recurrent_mem_tr__prompt_kernel_pb13:
interleave_layers__linear_attn_block__memory_aug_recurrent_mem_tr__prompt_kernel_k3q12:
    s_xor_b32 s42, s42, 40960
    s_waitcnt vmcnt(2)
    v_mfma_f32_16x16x32_bf16 v[132:135], a[192:195], v[56:59], 0
    v_mfma_f32_16x16x32_bf16 v[136:139], a[202:205], v[60:63], 0
    v_mfma_f32_16x16x32_bf16 v[112:115], a[160:163], v[56:59], 0
    v_mfma_f32_16x16x32_bf16 v[116:119], a[164:167], v[56:59], 0
    v_mfma_f32_16x16x32_bf16 v[120:123], a[172:175], v[56:59], 0
    v_mfma_f32_16x16x32_bf16 v[124:127], a[180:183], v[60:63], 0
    v_mfma_f32_16x16x32_bf16 v[128:131], a[186:189], v[60:63], 0
    v_mfma_f32_16x16x32_bf16 v[132:135], a[196:199], v[60:63], v[132:135]
    v_mfma_f32_16x16x32_bf16 v[116:119], a[168:171], v[60:63], v[116:119]
    v_mfma_f32_16x16x32_bf16 v[120:123], a[176:179], v[60:63], v[120:123]
    v_mfma_f32_16x16x16_bf16 v[136:139], a[206:207], v[64:65], v[136:139]
    s_nop 0
    v_mfma_f32_16x16x16_bf16 v[124:127], a[184:185], v[64:65], v[124:127]
    v_mfma_f32_16x16x16_bf16 v[128:131], a[190:191], v[64:65], v[128:131]
    v_mfma_f32_16x16x16_bf16 v[132:135], a[200:201], v[64:65], v[132:135]
    v_mfma_f32_16x16x32_bf16 v[160:163], a[240:243], v[66:69], 0
    v_mfma_f32_16x16x32_bf16 v[164:167], a[250:253], v[70:73], 0
    v_mfma_f32_16x16x32_bf16 v[140:143], a[208:211], v[66:69], 0
    v_mfma_f32_16x16x32_bf16 v[144:147], a[212:215], v[66:69], 0
    v_mfma_f32_16x16x32_bf16 v[148:151], a[220:223], v[66:69], 0
    v_mfma_f32_16x16x32_bf16 v[152:155], a[228:231], v[70:73], 0
    v_mfma_f32_16x16x32_bf16 v[156:159], a[234:237], v[70:73], 0
    v_mfma_f32_16x16x32_bf16 v[160:163], a[244:247], v[70:73], v[160:163]
    v_mfma_f32_16x16x32_bf16 v[144:147], a[216:219], v[70:73], v[144:147]
    v_mfma_f32_16x16x32_bf16 v[148:151], a[224:227], v[70:73], v[148:151]
    v_mfma_f32_16x16x16_bf16 v[164:167], a[254:255], v[74:75], v[164:167]
    s_nop 0
    v_mfma_f32_16x16x16_bf16 v[152:155], a[232:233], v[74:75], v[152:155]
    v_mfma_f32_16x16x16_bf16 v[156:159], a[238:239], v[74:75], v[156:159]
    v_mfma_f32_16x16x16_bf16 v[160:163], a[248:249], v[74:75], v[160:163]
    v_add_f32 v132, s54, v132
    v_add_f32 v133, s54, v133
    v_add_f32 v134, s54, v134
    v_add_f32 v135, s54, v135
    v_add_f32 v136, s54, v136
    v_rcp_f32 v132, v132
    v_rcp_f32 v133, v133
    v_rcp_f32 v134, v134
    v_rcp_f32 v135, v135
    v_rcp_f32 v136, v136
    v_mul_f32 v112, v112, v132
    v_mul_f32 v113, v113, v132
    v_mul_f32 v114, v114, v132
    v_mul_f32 v115, v115, v132
    v_cvt_pk_bf16_f32 v168, v112, v113
    v_cvt_pk_bf16_f32 v169, v114, v115
    v_mul_f32 v116, v116, v133
    v_mul_f32 v117, v117, v133
    v_mul_f32 v118, v118, v133
    v_mul_f32 v119, v119, v133
    v_cvt_pk_bf16_f32 v170, v116, v117
    v_cvt_pk_bf16_f32 v171, v118, v119
    v_mul_f32 v120, v120, v134
    v_mul_f32 v121, v121, v134
    v_mul_f32 v122, v122, v134
    v_mul_f32 v123, v123, v134
    v_cvt_pk_bf16_f32 v172, v120, v121
    v_cvt_pk_bf16_f32 v173, v122, v123
    v_mul_f32 v124, v124, v135
    v_mul_f32 v125, v125, v135
    v_mul_f32 v126, v126, v135
    v_mul_f32 v127, v127, v135
    v_cvt_pk_bf16_f32 v174, v124, v125
    v_cvt_pk_bf16_f32 v175, v126, v127
    v_mul_f32 v128, v128, v136
    v_mul_f32 v129, v129, v136
    v_mul_f32 v130, v130, v136
    v_mul_f32 v131, v131, v136
    v_cvt_pk_bf16_f32 v176, v128, v129
    v_cvt_pk_bf16_f32 v177, v130, v131
    v_add_f32 v160, s54, v160
    v_add_f32 v161, s54, v161
    v_add_f32 v162, s54, v162
    v_add_f32 v163, s54, v163
    v_add_f32 v164, s54, v164
    v_rcp_f32 v160, v160
    v_rcp_f32 v161, v161
    v_rcp_f32 v162, v162
    v_rcp_f32 v163, v163
    v_rcp_f32 v164, v164
    v_mul_f32 v140, v140, v160
    v_mul_f32 v141, v141, v160
    v_mul_f32 v142, v142, v160
    v_mul_f32 v143, v143, v160
    v_cvt_pk_bf16_f32 v178, v140, v141
    v_cvt_pk_bf16_f32 v179, v142, v143
    v_mul_f32 v144, v144, v161
    v_mul_f32 v145, v145, v161
    v_mul_f32 v146, v146, v161
    v_mul_f32 v147, v147, v161
    v_cvt_pk_bf16_f32 v180, v144, v145
    v_cvt_pk_bf16_f32 v181, v146, v147
    v_mul_f32 v148, v148, v162
    v_mul_f32 v149, v149, v162
    v_mul_f32 v150, v150, v162
    v_mul_f32 v151, v151, v162
    v_cvt_pk_bf16_f32 v182, v148, v149
    v_cvt_pk_bf16_f32 v183, v150, v151
    v_mul_f32 v152, v152, v163
    v_mul_f32 v153, v153, v163
    v_mul_f32 v154, v154, v163
    v_mul_f32 v155, v155, v163
    v_cvt_pk_bf16_f32 v184, v152, v153
    v_cvt_pk_bf16_f32 v185, v154, v155
    v_mul_f32 v156, v156, v164
    v_mul_f32 v157, v157, v164
    v_mul_f32 v158, v158, v164
    v_mul_f32 v159, v159, v164
    v_cvt_pk_bf16_f32 v186, v156, v157
    v_cvt_pk_bf16_f32 v187, v158, v159
    v_mfma_f32_16x16x32_bf16 v[132:135], a[192:195], v[76:79], 0
    v_mfma_f32_16x16x32_bf16 v[136:139], a[202:205], v[80:83], 0
    v_mfma_f32_16x16x32_bf16 v[112:115], a[160:163], v[76:79], 0
    v_mfma_f32_16x16x32_bf16 v[116:119], a[164:167], v[76:79], 0
    v_mfma_f32_16x16x32_bf16 v[120:123], a[172:175], v[76:79], 0
    v_mfma_f32_16x16x32_bf16 v[124:127], a[180:183], v[80:83], 0
    v_mfma_f32_16x16x32_bf16 v[128:131], a[186:189], v[80:83], 0
    v_mfma_f32_16x16x32_bf16 v[132:135], a[196:199], v[80:83], v[132:135]
    v_mfma_f32_16x16x32_bf16 v[116:119], a[168:171], v[80:83], v[116:119]
    v_mfma_f32_16x16x32_bf16 v[120:123], a[176:179], v[80:83], v[120:123]
    v_mfma_f32_16x16x16_bf16 v[136:139], a[206:207], v[84:85], v[136:139]
    s_nop 0
    v_mfma_f32_16x16x16_bf16 v[124:127], a[184:185], v[84:85], v[124:127]
    v_mfma_f32_16x16x16_bf16 v[128:131], a[190:191], v[84:85], v[128:131]
    v_mfma_f32_16x16x16_bf16 v[132:135], a[200:201], v[84:85], v[132:135]
    v_mfma_f32_16x16x32_bf16 v[160:163], a[240:243], v[86:89], 0
    v_mfma_f32_16x16x32_bf16 v[164:167], a[250:253], v[90:93], 0
    v_mfma_f32_16x16x32_bf16 v[140:143], a[208:211], v[86:89], 0
    v_mfma_f32_16x16x32_bf16 v[144:147], a[212:215], v[86:89], 0
    v_mfma_f32_16x16x32_bf16 v[148:151], a[220:223], v[86:89], 0
    v_mfma_f32_16x16x32_bf16 v[152:155], a[228:231], v[90:93], 0
    v_mfma_f32_16x16x32_bf16 v[156:159], a[234:237], v[90:93], 0
    v_mfma_f32_16x16x32_bf16 v[160:163], a[244:247], v[90:93], v[160:163]
    v_mfma_f32_16x16x32_bf16 v[144:147], a[216:219], v[90:93], v[144:147]
    v_mfma_f32_16x16x32_bf16 v[148:151], a[224:227], v[90:93], v[148:151]
    v_mfma_f32_16x16x16_bf16 v[164:167], a[254:255], v[94:95], v[164:167]
    s_nop 0
    v_mfma_f32_16x16x16_bf16 v[152:155], a[232:233], v[94:95], v[152:155]
    v_mfma_f32_16x16x16_bf16 v[156:159], a[238:239], v[94:95], v[156:159]
    v_mfma_f32_16x16x16_bf16 v[160:163], a[248:249], v[94:95], v[160:163]
    v_add_f32 v132, s54, v132
    v_add_f32 v133, s54, v133
    v_add_f32 v134, s54, v134
    v_add_f32 v135, s54, v135
    v_add_f32 v136, s54, v136
    v_rcp_f32 v132, v132
    v_rcp_f32 v133, v133
    v_rcp_f32 v134, v134
    v_rcp_f32 v135, v135
    v_rcp_f32 v136, v136
    v_mul_f32 v112, v112, v132
    v_mul_f32 v113, v113, v132
    v_mul_f32 v114, v114, v132
    v_mul_f32 v115, v115, v132
    v_cvt_pk_bf16_f32 v188, v112, v113
    v_cvt_pk_bf16_f32 v189, v114, v115
    v_mul_f32 v116, v116, v133
    v_mul_f32 v117, v117, v133
    v_mul_f32 v118, v118, v133
    v_mul_f32 v119, v119, v133
    v_cvt_pk_bf16_f32 v190, v116, v117
    v_cvt_pk_bf16_f32 v191, v118, v119
    v_mul_f32 v120, v120, v134
    v_mul_f32 v121, v121, v134
    v_mul_f32 v122, v122, v134
    v_mul_f32 v123, v123, v134
    v_cvt_pk_bf16_f32 v192, v120, v121
    v_cvt_pk_bf16_f32 v193, v122, v123
    v_mul_f32 v124, v124, v135
    v_mul_f32 v125, v125, v135
    v_mul_f32 v126, v126, v135
    v_mul_f32 v127, v127, v135
    v_cvt_pk_bf16_f32 v194, v124, v125
    v_cvt_pk_bf16_f32 v195, v126, v127
    v_mul_f32 v128, v128, v136
    v_mul_f32 v129, v129, v136
    v_mul_f32 v130, v130, v136
    v_mul_f32 v131, v131, v136
    v_cvt_pk_bf16_f32 v196, v128, v129
    v_cvt_pk_bf16_f32 v197, v130, v131
    v_add_f32 v160, s54, v160
    v_add_f32 v161, s54, v161
    v_add_f32 v162, s54, v162
    v_add_f32 v163, s54, v163
    v_add_f32 v164, s54, v164
    v_rcp_f32 v160, v160
    v_rcp_f32 v161, v161
    v_rcp_f32 v162, v162
    v_rcp_f32 v163, v163
    v_rcp_f32 v164, v164
    v_mul_f32 v140, v140, v160
    v_mul_f32 v141, v141, v160
    v_mul_f32 v142, v142, v160
    v_mul_f32 v143, v143, v160
    v_cvt_pk_bf16_f32 v198, v140, v141
    v_cvt_pk_bf16_f32 v199, v142, v143
    v_mul_f32 v144, v144, v161
    v_mul_f32 v145, v145, v161
    v_mul_f32 v146, v146, v161
    v_mul_f32 v147, v147, v161
    v_cvt_pk_bf16_f32 v200, v144, v145
    v_cvt_pk_bf16_f32 v201, v146, v147
    v_mul_f32 v148, v148, v162
    v_mul_f32 v149, v149, v162
    v_mul_f32 v150, v150, v162
    v_mul_f32 v151, v151, v162
    v_cvt_pk_bf16_f32 v202, v148, v149
    v_cvt_pk_bf16_f32 v203, v150, v151
    v_mul_f32 v152, v152, v163
    v_mul_f32 v153, v153, v163
    v_mul_f32 v154, v154, v163
    v_mul_f32 v155, v155, v163
    v_cvt_pk_bf16_f32 v204, v152, v153
    v_cvt_pk_bf16_f32 v205, v154, v155
    v_mul_f32 v156, v156, v164
    v_mul_f32 v157, v157, v164
    v_mul_f32 v158, v158, v164
    v_mul_f32 v159, v159, v164
    v_cvt_pk_bf16_f32 v206, v156, v157
    v_cvt_pk_bf16_f32 v207, v158, v159
    v_add_u32 v14, s42, v13
    ds_write_b128 v14, v[168:171] offset:0
    ds_write_b128 v14, v[172:175] offset:1024
    ds_write_b128 v14, v[176:179] offset:2048
    ds_write_b128 v14, v[180:183] offset:3072
    ds_write_b128 v14, v[184:187] offset:4096
    ds_write_b128 v14, v[188:191] offset:20480
    ds_write_b128 v14, v[192:195] offset:21504
    ds_write_b128 v14, v[196:199] offset:22528
    ds_write_b128 v14, v[200:203] offset:23552
    ds_write_b128 v14, v[204:207] offset:24576
    s_add_u32 s41, s43, s77
    s_add_u32 s24, s40, 1
    s_cmp_lt_u32 s24, s76
    s_cselect_b32 s41, s41, 2146435072
    s_waitcnt vmcnt(0)
    s_add_u32 s25, s41, 20480
    buffer_load_dwordx4 v[16:19], v8, s[8:11], s41 offen offset:0 sc1
    buffer_load_dwordx4 v[20:23], v8, s[8:11], s41 offen offset:1024 sc1
    buffer_load_dwordx2 v[24:25], v9, s[8:11], s41 offen offset:0 sc1
    buffer_load_dwordx4 v[26:29], v8, s[8:11], s41 offen offset:2560 sc1
    buffer_load_dwordx4 v[30:33], v8, s[8:11], s41 offen offset:3584 sc1
    buffer_load_dwordx2 v[34:35], v9, s[8:11], s41 offen offset:2560 sc1
    buffer_load_dwordx4 v[36:39], v8, s[8:11], s25 offen offset:0 sc1
    buffer_load_dwordx4 v[40:43], v8, s[8:11], s25 offen offset:1024 sc1
    buffer_load_dwordx2 v[44:45], v9, s[8:11], s25 offen offset:0 sc1
    buffer_load_dwordx4 v[46:49], v8, s[8:11], s25 offen offset:2560 sc1
    buffer_load_dwordx4 v[50:53], v8, s[8:11], s25 offen offset:3584 sc1
    buffer_load_dwordx2 v[54:55], v9, s[8:11], s25 offen offset:2560 sc1
    buffer_load_dwordx2 v[96:97], v10, s[16:19], s41 offen sc1
    buffer_load_dwordx2 v[98:99], v11, s[16:19], s41 offen sc1
    buffer_load_dwordx2 v[100:101], v10, s[16:19], s25 offen sc1
    buffer_load_dwordx2 v[102:103], v11, s[16:19], s25 offen sc1
    s_waitcnt lgkmcnt(0)
    s_barrier
    s_lshl_b32 s24, s92, 10
    s_lshl_b32 s25, s78, 2
    s_add_u32 s24, s24, s25
    s_add_u32 s24, s24, 23105536
    s_cmp_eq_u32 s3, 0
    s_cbranch_scc0 interleave_layers__linear_attn_block__memory_aug_recurrent_mem_tr__prompt_kernel_pb14
    v_lshlrev_b32 v14, 7, v1
    v_add_u32 v14, s24, v14
    v_mov_b32 v15, 2146435072
    v_cmp_le_u32 vcc, 8, v1
    s_nop 1
    v_cndmask_b32 v14, v14, v15, vcc
    v_mov_b32 v15, s40
    buffer_store_dword v15, v14, s[8:11], 0 offen sc1
interleave_layers__linear_attn_block__memory_aug_recurrent_mem_tr__prompt_kernel_pb14:
    v_add_u32 v15, s42, v5
    ds_read_b128 v[208:211], v15 offset:0
    ds_read_b128 v[212:215], v15 offset:20480
    ds_read_b128 v[216:219], v15 offset:1024
    ds_read_b128 v[220:223], v15 offset:21504
    ds_read_b128 v[224:227], v15 offset:2048
    ds_read_b128 v[228:231], v15 offset:22528
    ds_read_b128 v[232:235], v15 offset:3072
    ds_read_b128 v[236:239], v15 offset:23552
    s_waitcnt lgkmcnt(6)
    v_mfma_f32_16x16x32_bf16 v[240:243], a[0:3], v[208:211], 0
    v_mfma_f32_16x16x32_bf16 v[244:247], a[4:7], v[208:211], 0
    v_mfma_f32_16x16x32_bf16 v[248:251], a[0:3], v[212:215], 0
    v_mfma_f32_16x16x32_bf16 v[252:255], a[4:7], v[212:215], 0
    ds_read_b128 v[208:211], v15 offset:4096
    ds_read_b128 v[212:215], v15 offset:24576
    s_waitcnt lgkmcnt(6)
    v_mfma_f32_16x16x32_bf16 v[240:243], a[8:11], v[216:219], v[240:243]
    v_mfma_f32_16x16x32_bf16 v[244:247], a[12:15], v[216:219], v[244:247]
    v_mfma_f32_16x16x32_bf16 v[248:251], a[8:11], v[220:223], v[248:251]
    v_mfma_f32_16x16x32_bf16 v[252:255], a[12:15], v[220:223], v[252:255]
    ds_read_b128 v[216:219], v15 offset:5120
    ds_read_b128 v[220:223], v15 offset:25600
    s_waitcnt lgkmcnt(6)
    v_mfma_f32_16x16x32_bf16 v[240:243], a[16:19], v[224:227], v[240:243]
    v_mfma_f32_16x16x32_bf16 v[244:247], a[20:23], v[224:227], v[244:247]
    v_mfma_f32_16x16x32_bf16 v[248:251], a[16:19], v[228:231], v[248:251]
    v_mfma_f32_16x16x32_bf16 v[252:255], a[20:23], v[228:231], v[252:255]
    ds_read_b128 v[224:227], v15 offset:6144
    ds_read_b128 v[228:231], v15 offset:26624
    s_waitcnt lgkmcnt(6)
    v_mfma_f32_16x16x32_bf16 v[240:243], a[24:27], v[232:235], v[240:243]
    v_mfma_f32_16x16x32_bf16 v[244:247], a[28:31], v[232:235], v[244:247]
    v_mfma_f32_16x16x32_bf16 v[248:251], a[24:27], v[236:239], v[248:251]
    v_mfma_f32_16x16x32_bf16 v[252:255], a[28:31], v[236:239], v[252:255]
    ds_read_b128 v[232:235], v15 offset:7168
    ds_read_b128 v[236:239], v15 offset:27648
    s_waitcnt lgkmcnt(6)
    v_mfma_f32_16x16x32_bf16 v[240:243], a[32:35], v[208:211], v[240:243]
    v_mfma_f32_16x16x32_bf16 v[244:247], a[36:39], v[208:211], v[244:247]
    v_mfma_f32_16x16x32_bf16 v[248:251], a[32:35], v[212:215], v[248:251]
    v_mfma_f32_16x16x32_bf16 v[252:255], a[36:39], v[212:215], v[252:255]
    ds_read_b128 v[208:211], v15 offset:8192
    ds_read_b128 v[212:215], v15 offset:28672
    s_waitcnt lgkmcnt(6)
    v_mfma_f32_16x16x32_bf16 v[240:243], a[40:43], v[216:219], v[240:243]
    v_mfma_f32_16x16x32_bf16 v[244:247], a[44:47], v[216:219], v[244:247]
    v_mfma_f32_16x16x32_bf16 v[248:251], a[40:43], v[220:223], v[248:251]
    v_mfma_f32_16x16x32_bf16 v[252:255], a[44:47], v[220:223], v[252:255]
    ds_read_b128 v[216:219], v15 offset:9216
    ds_read_b128 v[220:223], v15 offset:29696
    s_waitcnt lgkmcnt(6)
    v_mfma_f32_16x16x32_bf16 v[240:243], a[48:51], v[224:227], v[240:243]
    v_mfma_f32_16x16x32_bf16 v[244:247], a[52:55], v[224:227], v[244:247]
    v_mfma_f32_16x16x32_bf16 v[248:251], a[48:51], v[228:231], v[248:251]
    v_mfma_f32_16x16x32_bf16 v[252:255], a[52:55], v[228:231], v[252:255]
    ds_read_b128 v[224:227], v15 offset:10240
    ds_read_b128 v[228:231], v15 offset:30720
    s_waitcnt lgkmcnt(6)
    v_mfma_f32_16x16x32_bf16 v[240:243], a[56:59], v[232:235], v[240:243]
    v_mfma_f32_16x16x32_bf16 v[244:247], a[60:63], v[232:235], v[244:247]
    v_mfma_f32_16x16x32_bf16 v[248:251], a[56:59], v[236:239], v[248:251]
    v_mfma_f32_16x16x32_bf16 v[252:255], a[60:63], v[236:239], v[252:255]
    ds_read_b128 v[232:235], v15 offset:11264
    ds_read_b128 v[236:239], v15 offset:31744
    s_waitcnt lgkmcnt(6)
    v_mfma_f32_16x16x32_bf16 v[240:243], a[64:67], v[208:211], v[240:243]
    v_mfma_f32_16x16x32_bf16 v[244:247], a[68:71], v[208:211], v[244:247]
    v_mfma_f32_16x16x32_bf16 v[248:251], a[64:67], v[212:215], v[248:251]
    v_mfma_f32_16x16x32_bf16 v[252:255], a[68:71], v[212:215], v[252:255]
    ds_read_b128 v[208:211], v15 offset:12288
    ds_read_b128 v[212:215], v15 offset:32768
    s_waitcnt lgkmcnt(6)
    v_mfma_f32_16x16x32_bf16 v[240:243], a[72:75], v[216:219], v[240:243]
    v_mfma_f32_16x16x32_bf16 v[244:247], a[76:79], v[216:219], v[244:247]
    v_mfma_f32_16x16x32_bf16 v[248:251], a[72:75], v[220:223], v[248:251]
    v_mfma_f32_16x16x32_bf16 v[252:255], a[76:79], v[220:223], v[252:255]
    ds_read_b128 v[216:219], v15 offset:13312
    ds_read_b128 v[220:223], v15 offset:33792
    s_waitcnt lgkmcnt(6)
    v_mfma_f32_16x16x32_bf16 v[240:243], a[80:83], v[224:227], v[240:243]
    v_mfma_f32_16x16x32_bf16 v[244:247], a[84:87], v[224:227], v[244:247]
    v_mfma_f32_16x16x32_bf16 v[248:251], a[80:83], v[228:231], v[248:251]
    v_mfma_f32_16x16x32_bf16 v[252:255], a[84:87], v[228:231], v[252:255]
    ds_read_b128 v[224:227], v15 offset:14336
    ds_read_b128 v[228:231], v15 offset:34816
    s_waitcnt lgkmcnt(6)
    v_mfma_f32_16x16x32_bf16 v[240:243], a[88:91], v[232:235], v[240:243]
    v_mfma_f32_16x16x32_bf16 v[244:247], a[92:95], v[232:235], v[244:247]
    v_mfma_f32_16x16x32_bf16 v[248:251], a[88:91], v[236:239], v[248:251]
    v_mfma_f32_16x16x32_bf16 v[252:255], a[92:95], v[236:239], v[252:255]
    ds_read_b128 v[232:235], v15 offset:15360
    ds_read_b128 v[236:239], v15 offset:35840
    s_waitcnt lgkmcnt(6)
    v_mfma_f32_16x16x32_bf16 v[240:243], a[96:99], v[208:211], v[240:243]
    v_mfma_f32_16x16x32_bf16 v[244:247], a[100:103], v[208:211], v[244:247]
    v_mfma_f32_16x16x32_bf16 v[248:251], a[96:99], v[212:215], v[248:251]
    v_mfma_f32_16x16x32_bf16 v[252:255], a[100:103], v[212:215], v[252:255]
    ds_read_b128 v[208:211], v15 offset:16384
    ds_read_b128 v[212:215], v15 offset:36864
    s_waitcnt lgkmcnt(6)
    v_mfma_f32_16x16x32_bf16 v[240:243], a[104:107], v[216:219], v[240:243]
    v_mfma_f32_16x16x32_bf16 v[244:247], a[108:111], v[216:219], v[244:247]
    v_mfma_f32_16x16x32_bf16 v[248:251], a[104:107], v[220:223], v[248:251]
    v_mfma_f32_16x16x32_bf16 v[252:255], a[108:111], v[220:223], v[252:255]
    ds_read_b128 v[216:219], v15 offset:17408
    ds_read_b128 v[220:223], v15 offset:37888
    s_waitcnt lgkmcnt(6)
    v_mfma_f32_16x16x32_bf16 v[240:243], a[112:115], v[224:227], v[240:243]
    v_mfma_f32_16x16x32_bf16 v[244:247], a[116:119], v[224:227], v[244:247]
    v_mfma_f32_16x16x32_bf16 v[248:251], a[112:115], v[228:231], v[248:251]
    v_mfma_f32_16x16x32_bf16 v[252:255], a[116:119], v[228:231], v[252:255]
    ds_read_b128 v[224:227], v15 offset:18432
    ds_read_b128 v[228:231], v15 offset:38912
    s_waitcnt lgkmcnt(6)
    v_mfma_f32_16x16x32_bf16 v[240:243], a[120:123], v[232:235], v[240:243]
    v_mfma_f32_16x16x32_bf16 v[244:247], a[124:127], v[232:235], v[244:247]
    v_mfma_f32_16x16x32_bf16 v[248:251], a[120:123], v[236:239], v[248:251]
    v_mfma_f32_16x16x32_bf16 v[252:255], a[124:127], v[236:239], v[252:255]
    ds_read_b128 v[232:235], v15 offset:19456
    ds_read_b128 v[236:239], v15 offset:39936
    s_waitcnt lgkmcnt(6)
    v_mfma_f32_16x16x32_bf16 v[240:243], a[128:131], v[208:211], v[240:243]
    v_mfma_f32_16x16x32_bf16 v[244:247], a[132:135], v[208:211], v[244:247]
    v_mfma_f32_16x16x32_bf16 v[248:251], a[128:131], v[212:215], v[248:251]
    v_mfma_f32_16x16x32_bf16 v[252:255], a[132:135], v[212:215], v[252:255]
    s_waitcnt lgkmcnt(4)
    v_mfma_f32_16x16x32_bf16 v[240:243], a[136:139], v[216:219], v[240:243]
    v_mfma_f32_16x16x32_bf16 v[244:247], a[140:143], v[216:219], v[244:247]
    v_mfma_f32_16x16x32_bf16 v[248:251], a[136:139], v[220:223], v[248:251]
    v_mfma_f32_16x16x32_bf16 v[252:255], a[140:143], v[220:223], v[252:255]
    s_waitcnt lgkmcnt(2)
    v_mfma_f32_16x16x32_bf16 v[240:243], a[144:147], v[224:227], v[240:243]
    v_mfma_f32_16x16x32_bf16 v[244:247], a[148:151], v[224:227], v[244:247]
    v_mfma_f32_16x16x32_bf16 v[248:251], a[144:147], v[228:231], v[248:251]
    v_mfma_f32_16x16x32_bf16 v[252:255], a[148:151], v[228:231], v[252:255]
    s_waitcnt lgkmcnt(0)
    v_mfma_f32_16x16x32_bf16 v[240:243], a[152:155], v[232:235], v[240:243]
    v_mfma_f32_16x16x32_bf16 v[244:247], a[156:159], v[232:235], v[244:247]
    v_mfma_f32_16x16x32_bf16 v[248:251], a[152:155], v[236:239], v[248:251]
    v_mfma_f32_16x16x32_bf16 v[252:255], a[156:159], v[236:239], v[252:255]
    s_nop 4
    v_cvt_pk_bf16_f32 v208, v240, v241
    v_cvt_pk_bf16_f32 v209, v242, v243
    v_lshlrev_b32 v210, 16, v208
    v_and_b32 v211, 0xffff0000, v208
    v_lshlrev_b32 v212, 16, v104
    v_and_b32 v213, 0xffff0000, v104
    v_pk_add_f32 v[210:211], v[210:211], v[212:213]
    v_cvt_pk_bf16_f32 v216, v210, v211
    v_lshlrev_b32 v210, 16, v209
    v_and_b32 v211, 0xffff0000, v209
    v_lshlrev_b32 v212, 16, v105
    v_and_b32 v213, 0xffff0000, v105
    v_pk_add_f32 v[210:211], v[210:211], v[212:213]
    v_cvt_pk_bf16_f32 v217, v210, v211
    v_cvt_pk_bf16_f32 v208, v244, v245
    v_cvt_pk_bf16_f32 v209, v246, v247
    v_lshlrev_b32 v210, 16, v208
    v_and_b32 v211, 0xffff0000, v208
    v_lshlrev_b32 v212, 16, v106
    v_and_b32 v213, 0xffff0000, v106
    v_pk_add_f32 v[210:211], v[210:211], v[212:213]
    v_cvt_pk_bf16_f32 v218, v210, v211
    v_lshlrev_b32 v210, 16, v209
    v_and_b32 v211, 0xffff0000, v209
    v_lshlrev_b32 v212, 16, v107
    v_and_b32 v213, 0xffff0000, v107
    v_pk_add_f32 v[210:211], v[210:211], v[212:213]
    v_cvt_pk_bf16_f32 v219, v210, v211
    v_cvt_pk_bf16_f32 v208, v248, v249
    v_cvt_pk_bf16_f32 v209, v250, v251
    v_lshlrev_b32 v210, 16, v208
    v_and_b32 v211, 0xffff0000, v208
    v_lshlrev_b32 v212, 16, v108
    v_and_b32 v213, 0xffff0000, v108
    v_pk_add_f32 v[210:211], v[210:211], v[212:213]
    v_cvt_pk_bf16_f32 v220, v210, v211
    v_lshlrev_b32 v210, 16, v209
    v_and_b32 v211, 0xffff0000, v209
    v_lshlrev_b32 v212, 16, v109
    v_and_b32 v213, 0xffff0000, v109
    v_pk_add_f32 v[210:211], v[210:211], v[212:213]
    v_cvt_pk_bf16_f32 v221, v210, v211
    v_cvt_pk_bf16_f32 v208, v252, v253
    v_cvt_pk_bf16_f32 v209, v254, v255
    v_lshlrev_b32 v210, 16, v208
    v_and_b32 v211, 0xffff0000, v208
    v_lshlrev_b32 v212, 16, v110
    v_and_b32 v213, 0xffff0000, v110
    v_pk_add_f32 v[210:211], v[210:211], v[212:213]
    v_cvt_pk_bf16_f32 v222, v210, v211
    v_lshlrev_b32 v210, 16, v209
    v_and_b32 v211, 0xffff0000, v209
    v_lshlrev_b32 v212, 16, v111
    v_and_b32 v213, 0xffff0000, v111
    v_pk_add_f32 v[210:211], v[210:211], v[212:213]
    v_cvt_pk_bf16_f32 v223, v210, v211
    s_add_u32 s25, s43, 20480
    buffer_store_dwordx4 v[216:219], v12, s[8:11], s43 offen sc1
    buffer_store_dwordx4 v[220:223], v12, s[8:11], s25 offen sc1
    s_add_u32 s40, s40, 1
    s_add_u32 s43, s43, s77
    s_cmp_ge_u32 s40, s76
    s_cbranch_scc1 interleave_layers__linear_attn_block__memory_aug_recurrent_mem_tr__prompt_kernel_k3_done
    s_xor_b32 s42, s42, 40960
    s_waitcnt vmcnt(2)
    v_mfma_f32_16x16x32_bf16 v[132:135], a[192:195], v[16:19], 0
    v_mfma_f32_16x16x32_bf16 v[136:139], a[202:205], v[20:23], 0
    v_mfma_f32_16x16x32_bf16 v[112:115], a[160:163], v[16:19], 0
    v_mfma_f32_16x16x32_bf16 v[116:119], a[164:167], v[16:19], 0
    v_mfma_f32_16x16x32_bf16 v[120:123], a[172:175], v[16:19], 0
    v_mfma_f32_16x16x32_bf16 v[124:127], a[180:183], v[20:23], 0
    v_mfma_f32_16x16x32_bf16 v[128:131], a[186:189], v[20:23], 0
    v_mfma_f32_16x16x32_bf16 v[132:135], a[196:199], v[20:23], v[132:135]
    v_mfma_f32_16x16x32_bf16 v[116:119], a[168:171], v[20:23], v[116:119]
    v_mfma_f32_16x16x32_bf16 v[120:123], a[176:179], v[20:23], v[120:123]
    v_mfma_f32_16x16x16_bf16 v[136:139], a[206:207], v[24:25], v[136:139]
    s_nop 0
    v_mfma_f32_16x16x16_bf16 v[124:127], a[184:185], v[24:25], v[124:127]
    v_mfma_f32_16x16x16_bf16 v[128:131], a[190:191], v[24:25], v[128:131]
    v_mfma_f32_16x16x16_bf16 v[132:135], a[200:201], v[24:25], v[132:135]
    v_mfma_f32_16x16x32_bf16 v[160:163], a[240:243], v[26:29], 0
    v_mfma_f32_16x16x32_bf16 v[164:167], a[250:253], v[30:33], 0
    v_mfma_f32_16x16x32_bf16 v[140:143], a[208:211], v[26:29], 0
    v_mfma_f32_16x16x32_bf16 v[144:147], a[212:215], v[26:29], 0
    v_mfma_f32_16x16x32_bf16 v[148:151], a[220:223], v[26:29], 0
    v_mfma_f32_16x16x32_bf16 v[152:155], a[228:231], v[30:33], 0
    v_mfma_f32_16x16x32_bf16 v[156:159], a[234:237], v[30:33], 0
    v_mfma_f32_16x16x32_bf16 v[160:163], a[244:247], v[30:33], v[160:163]
    v_mfma_f32_16x16x32_bf16 v[144:147], a[216:219], v[30:33], v[144:147]
    v_mfma_f32_16x16x32_bf16 v[148:151], a[224:227], v[30:33], v[148:151]
    v_mfma_f32_16x16x16_bf16 v[164:167], a[254:255], v[34:35], v[164:167]
    s_nop 0
    v_mfma_f32_16x16x16_bf16 v[152:155], a[232:233], v[34:35], v[152:155]
    v_mfma_f32_16x16x16_bf16 v[156:159], a[238:239], v[34:35], v[156:159]
    v_mfma_f32_16x16x16_bf16 v[160:163], a[248:249], v[34:35], v[160:163]
    v_add_f32 v132, s54, v132
    v_add_f32 v133, s54, v133
    v_add_f32 v134, s54, v134
    v_add_f32 v135, s54, v135
    v_add_f32 v136, s54, v136
    v_rcp_f32 v132, v132
    v_rcp_f32 v133, v133
    v_rcp_f32 v134, v134
    v_rcp_f32 v135, v135
    v_rcp_f32 v136, v136
    v_mul_f32 v112, v112, v132
    v_mul_f32 v113, v113, v132
    v_mul_f32 v114, v114, v132
    v_mul_f32 v115, v115, v132
    v_cvt_pk_bf16_f32 v168, v112, v113
    v_cvt_pk_bf16_f32 v169, v114, v115
    v_mul_f32 v116, v116, v133
    v_mul_f32 v117, v117, v133
    v_mul_f32 v118, v118, v133
    v_mul_f32 v119, v119, v133
    v_cvt_pk_bf16_f32 v170, v116, v117
    v_cvt_pk_bf16_f32 v171, v118, v119
    v_mul_f32 v120, v120, v134
    v_mul_f32 v121, v121, v134
    v_mul_f32 v122, v122, v134
    v_mul_f32 v123, v123, v134
    v_cvt_pk_bf16_f32 v172, v120, v121
    v_cvt_pk_bf16_f32 v173, v122, v123
    v_mul_f32 v124, v124, v135
    v_mul_f32 v125, v125, v135
    v_mul_f32 v126, v126, v135
    v_mul_f32 v127, v127, v135
    v_cvt_pk_bf16_f32 v174, v124, v125
    v_cvt_pk_bf16_f32 v175, v126, v127
    v_mul_f32 v128, v128, v136
    v_mul_f32 v129, v129, v136
    v_mul_f32 v130, v130, v136
    v_mul_f32 v131, v131, v136
    v_cvt_pk_bf16_f32 v176, v128, v129
    v_cvt_pk_bf16_f32 v177, v130, v131
    v_add_f32 v160, s54, v160
    v_add_f32 v161, s54, v161
    v_add_f32 v162, s54, v162
    v_add_f32 v163, s54, v163
    v_add_f32 v164, s54, v164
    v_rcp_f32 v160, v160
    v_rcp_f32 v161, v161
    v_rcp_f32 v162, v162
    v_rcp_f32 v163, v163
    v_rcp_f32 v164, v164
    v_mul_f32 v140, v140, v160
    v_mul_f32 v141, v141, v160
    v_mul_f32 v142, v142, v160
    v_mul_f32 v143, v143, v160
    v_cvt_pk_bf16_f32 v178, v140, v141
    v_cvt_pk_bf16_f32 v179, v142, v143
    v_mul_f32 v144, v144, v161
    v_mul_f32 v145, v145, v161
    v_mul_f32 v146, v146, v161
    v_mul_f32 v147, v147, v161
    v_cvt_pk_bf16_f32 v180, v144, v145
    v_cvt_pk_bf16_f32 v181, v146, v147
    v_mul_f32 v148, v148, v162
    v_mul_f32 v149, v149, v162
    v_mul_f32 v150, v150, v162
    v_mul_f32 v151, v151, v162
    v_cvt_pk_bf16_f32 v182, v148, v149
    v_cvt_pk_bf16_f32 v183, v150, v151
    v_mul_f32 v152, v152, v163
    v_mul_f32 v153, v153, v163
    v_mul_f32 v154, v154, v163
    v_mul_f32 v155, v155, v163
    v_cvt_pk_bf16_f32 v184, v152, v153
    v_cvt_pk_bf16_f32 v185, v154, v155
    v_mul_f32 v156, v156, v164
    v_mul_f32 v157, v157, v164
    v_mul_f32 v158, v158, v164
    v_mul_f32 v159, v159, v164
    v_cvt_pk_bf16_f32 v186, v156, v157
    v_cvt_pk_bf16_f32 v187, v158, v159
    v_mfma_f32_16x16x32_bf16 v[132:135], a[192:195], v[36:39], 0
    v_mfma_f32_16x16x32_bf16 v[136:139], a[202:205], v[40:43], 0
    v_mfma_f32_16x16x32_bf16 v[112:115], a[160:163], v[36:39], 0
    v_mfma_f32_16x16x32_bf16 v[116:119], a[164:167], v[36:39], 0
    v_mfma_f32_16x16x32_bf16 v[120:123], a[172:175], v[36:39], 0
    v_mfma_f32_16x16x32_bf16 v[124:127], a[180:183], v[40:43], 0
    v_mfma_f32_16x16x32_bf16 v[128:131], a[186:189], v[40:43], 0
    v_mfma_f32_16x16x32_bf16 v[132:135], a[196:199], v[40:43], v[132:135]
    v_mfma_f32_16x16x32_bf16 v[116:119], a[168:171], v[40:43], v[116:119]
    v_mfma_f32_16x16x32_bf16 v[120:123], a[176:179], v[40:43], v[120:123]
    v_mfma_f32_16x16x16_bf16 v[136:139], a[206:207], v[44:45], v[136:139]
    s_nop 0
    v_mfma_f32_16x16x16_bf16 v[124:127], a[184:185], v[44:45], v[124:127]
    v_mfma_f32_16x16x16_bf16 v[128:131], a[190:191], v[44:45], v[128:131]
    v_mfma_f32_16x16x16_bf16 v[132:135], a[200:201], v[44:45], v[132:135]
    v_mfma_f32_16x16x32_bf16 v[160:163], a[240:243], v[46:49], 0
    v_mfma_f32_16x16x32_bf16 v[164:167], a[250:253], v[50:53], 0
    v_mfma_f32_16x16x32_bf16 v[140:143], a[208:211], v[46:49], 0
    v_mfma_f32_16x16x32_bf16 v[144:147], a[212:215], v[46:49], 0
    v_mfma_f32_16x16x32_bf16 v[148:151], a[220:223], v[46:49], 0
    v_mfma_f32_16x16x32_bf16 v[152:155], a[228:231], v[50:53], 0
    v_mfma_f32_16x16x32_bf16 v[156:159], a[234:237], v[50:53], 0
    v_mfma_f32_16x16x32_bf16 v[160:163], a[244:247], v[50:53], v[160:163]
    v_mfma_f32_16x16x32_bf16 v[144:147], a[216:219], v[50:53], v[144:147]
    v_mfma_f32_16x16x32_bf16 v[148:151], a[224:227], v[50:53], v[148:151]
    v_mfma_f32_16x16x16_bf16 v[164:167], a[254:255], v[54:55], v[164:167]
    s_nop 0
    v_mfma_f32_16x16x16_bf16 v[152:155], a[232:233], v[54:55], v[152:155]
    v_mfma_f32_16x16x16_bf16 v[156:159], a[238:239], v[54:55], v[156:159]
    v_mfma_f32_16x16x16_bf16 v[160:163], a[248:249], v[54:55], v[160:163]
    v_add_f32 v132, s54, v132
    v_add_f32 v133, s54, v133
    v_add_f32 v134, s54, v134
    v_add_f32 v135, s54, v135
    v_add_f32 v136, s54, v136
    v_rcp_f32 v132, v132
    v_rcp_f32 v133, v133
    v_rcp_f32 v134, v134
    v_rcp_f32 v135, v135
    v_rcp_f32 v136, v136
    v_mul_f32 v112, v112, v132
    v_mul_f32 v113, v113, v132
    v_mul_f32 v114, v114, v132
    v_mul_f32 v115, v115, v132
    v_cvt_pk_bf16_f32 v188, v112, v113
    v_cvt_pk_bf16_f32 v189, v114, v115
    v_mul_f32 v116, v116, v133
    v_mul_f32 v117, v117, v133
    v_mul_f32 v118, v118, v133
    v_mul_f32 v119, v119, v133
    v_cvt_pk_bf16_f32 v190, v116, v117
    v_cvt_pk_bf16_f32 v191, v118, v119
    v_mul_f32 v120, v120, v134
    v_mul_f32 v121, v121, v134
    v_mul_f32 v122, v122, v134
    v_mul_f32 v123, v123, v134
    v_cvt_pk_bf16_f32 v192, v120, v121
    v_cvt_pk_bf16_f32 v193, v122, v123
    v_mul_f32 v124, v124, v135
    v_mul_f32 v125, v125, v135
    v_mul_f32 v126, v126, v135
    v_mul_f32 v127, v127, v135
    v_cvt_pk_bf16_f32 v194, v124, v125
    v_cvt_pk_bf16_f32 v195, v126, v127
    v_mul_f32 v128, v128, v136
    v_mul_f32 v129, v129, v136
    v_mul_f32 v130, v130, v136
    v_mul_f32 v131, v131, v136
    v_cvt_pk_bf16_f32 v196, v128, v129
    v_cvt_pk_bf16_f32 v197, v130, v131
    v_add_f32 v160, s54, v160
    v_add_f32 v161, s54, v161
    v_add_f32 v162, s54, v162
    v_add_f32 v163, s54, v163
    v_add_f32 v164, s54, v164
    v_rcp_f32 v160, v160
    v_rcp_f32 v161, v161
    v_rcp_f32 v162, v162
    v_rcp_f32 v163, v163
    v_rcp_f32 v164, v164
    v_mul_f32 v140, v140, v160
    v_mul_f32 v141, v141, v160
    v_mul_f32 v142, v142, v160
    v_mul_f32 v143, v143, v160
    v_cvt_pk_bf16_f32 v198, v140, v141
    v_cvt_pk_bf16_f32 v199, v142, v143
    v_mul_f32 v144, v144, v161
    v_mul_f32 v145, v145, v161
    v_mul_f32 v146, v146, v161
    v_mul_f32 v147, v147, v161
    v_cvt_pk_bf16_f32 v200, v144, v145
    v_cvt_pk_bf16_f32 v201, v146, v147
    v_mul_f32 v148, v148, v162
    v_mul_f32 v149, v149, v162
    v_mul_f32 v150, v150, v162
    v_mul_f32 v151, v151, v162
    v_cvt_pk_bf16_f32 v202, v148, v149
    v_cvt_pk_bf16_f32 v203, v150, v151
    v_mul_f32 v152, v152, v163
    v_mul_f32 v153, v153, v163
    v_mul_f32 v154, v154, v163
    v_mul_f32 v155, v155, v163
    v_cvt_pk_bf16_f32 v204, v152, v153
    v_cvt_pk_bf16_f32 v205, v154, v155
    v_mul_f32 v156, v156, v164
    v_mul_f32 v157, v157, v164
    v_mul_f32 v158, v158, v164
    v_mul_f32 v159, v159, v164
    v_cvt_pk_bf16_f32 v206, v156, v157
    v_cvt_pk_bf16_f32 v207, v158, v159
    v_add_u32 v14, s42, v13
    ds_write_b128 v14, v[168:171] offset:0
    ds_write_b128 v14, v[172:175] offset:1024
    ds_write_b128 v14, v[176:179] offset:2048
    ds_write_b128 v14, v[180:183] offset:3072
    ds_write_b128 v14, v[184:187] offset:4096
    ds_write_b128 v14, v[188:191] offset:20480
    ds_write_b128 v14, v[192:195] offset:21504
    ds_write_b128 v14, v[196:199] offset:22528
    ds_write_b128 v14, v[200:203] offset:23552
    ds_write_b128 v14, v[204:207] offset:24576
    s_add_u32 s41, s43, s77
    s_add_u32 s24, s40, 1
    s_cmp_lt_u32 s24, s76
    s_cselect_b32 s41, s41, 2146435072
    s_waitcnt vmcnt(0)
    s_add_u32 s25, s41, 20480
    buffer_load_dwordx4 v[56:59], v8, s[8:11], s41 offen offset:0 sc1
    buffer_load_dwordx4 v[60:63], v8, s[8:11], s41 offen offset:1024 sc1
    buffer_load_dwordx2 v[64:65], v9, s[8:11], s41 offen offset:0 sc1
    buffer_load_dwordx4 v[66:69], v8, s[8:11], s41 offen offset:2560 sc1
    buffer_load_dwordx4 v[70:73], v8, s[8:11], s41 offen offset:3584 sc1
    buffer_load_dwordx2 v[74:75], v9, s[8:11], s41 offen offset:2560 sc1
    buffer_load_dwordx4 v[76:79], v8, s[8:11], s25 offen offset:0 sc1
    buffer_load_dwordx4 v[80:83], v8, s[8:11], s25 offen offset:1024 sc1
    buffer_load_dwordx2 v[84:85], v9, s[8:11], s25 offen offset:0 sc1
    buffer_load_dwordx4 v[86:89], v8, s[8:11], s25 offen offset:2560 sc1
    buffer_load_dwordx4 v[90:93], v8, s[8:11], s25 offen offset:3584 sc1
    buffer_load_dwordx2 v[94:95], v9, s[8:11], s25 offen offset:2560 sc1
    buffer_load_dwordx2 v[104:105], v10, s[16:19], s41 offen sc1
    buffer_load_dwordx2 v[106:107], v11, s[16:19], s41 offen sc1
    buffer_load_dwordx2 v[108:109], v10, s[16:19], s25 offen sc1
    buffer_load_dwordx2 v[110:111], v11, s[16:19], s25 offen sc1
    s_waitcnt lgkmcnt(0)
    s_barrier
    s_lshl_b32 s24, s92, 10
    s_lshl_b32 s25, s78, 2
    s_add_u32 s24, s24, s25
    s_add_u32 s24, s24, 23105536
    s_cmp_eq_u32 s3, 0
    s_cbranch_scc0 interleave_layers__linear_attn_block__memory_aug_recurrent_mem_tr__prompt_kernel_pb15
    v_lshlrev_b32 v14, 7, v1
    v_add_u32 v14, s24, v14
    v_mov_b32 v15, 2146435072
    v_cmp_le_u32 vcc, 8, v1
    s_nop 1
    v_cndmask_b32 v14, v14, v15, vcc
    v_mov_b32 v15, s40
    buffer_store_dword v15, v14, s[8:11], 0 offen sc1
interleave_layers__linear_attn_block__memory_aug_recurrent_mem_tr__prompt_kernel_pb15:
    s_branch interleave_layers__linear_attn_block__memory_aug_recurrent_mem_tr__prompt_kernel_k3_seg
interleave_layers__linear_attn_block__memory_aug_recurrent_mem_tr__prompt_kernel_k3_done:
    s_waitcnt vmcnt(0)
    s_barrier
    s_lshl_b32 s24, s92, 10
    s_lshl_b32 s25, s78, 2
    s_add_u32 s24, s24, s25
    s_add_u32 s24, s24, 23105536
    s_cmp_eq_u32 s3, 0
    s_cbranch_scc0 interleave_layers__linear_attn_block__memory_aug_recurrent_mem_tr__prompt_kernel_pb16
    v_lshlrev_b32 v14, 7, v1
    v_add_u32 v14, s24, v14
    v_mov_b32 v15, 2146435072
    v_cmp_le_u32 vcc, 8, v1
    s_nop 1
    v_cndmask_b32 v14, v14, v15, vcc
    v_mov_b32 v15, s40
    buffer_store_dword v15, v14, s[8:11], 0 offen sc1
interleave_layers__linear_attn_block__memory_aug_recurrent_mem_tr__prompt_kernel_pb16:
    s_cmp_eq_u32 s92, 0
    s_cbranch_scc0 interleave_layers__linear_attn_block__memory_aug_recurrent_mem_tr__prompt_kernel_end
    s_mov_b32 s92, 1
    s_cmp_lt_u32 s2, 248
    s_cbranch_scc1 interleave_layers__linear_attn_block__memory_aug_recurrent_mem_tr__prompt_kernel_helper_k1
interleave_layers__linear_attn_block__memory_aug_recurrent_mem_tr__prompt_kernel_k3_l1:
    s_add_u32 s16, s4, 4194304
    s_addc_u32 s17, s5, 0
    s_mov_b32 s18, 2621440
    s_mov_b32 s19, 0x00020000
    s_mov_b32 s46, 1024
    s_mov_b32 s47, 8
    s_mov_b32 s50, 1
    s_mov_b32 s58, 8388608
    s_mov_b32 s76, 16
    s_mov_b32 s77, 163840
    s_branch interleave_layers__linear_attn_block__memory_aug_recurrent_mem_tr__prompt_kernel_k3_entry
interleave_layers__linear_attn_block__memory_aug_recurrent_mem_tr__prompt_kernel_helper_k1:
    s_mov_b32 s92, 1
    s_sub_u32 s24, s2, 232
    s_add_u32 s16, s4, 4194304
    s_addc_u32 s17, s5, 0
    s_mov_b32 s18, 2621440
    s_mov_b32 s19, 0x00020000
    s_mov_b32 s46, 1024
    s_mov_b32 s47, 8
    s_mov_b32 s50, 1
    s_and_b32 s44, s24, 7
    s_lshr_b32 s45, s24, 3
    s_mov_b32 s48, s45
    s_mov_b32 s49, 2
    s_mov_b32 s40, 32
    s_branch interleave_layers__linear_attn_block__memory_aug_recurrent_mem_tr__prompt_kernel_k1_entry
interleave_layers__linear_attn_block__memory_aug_recurrent_mem_tr__prompt_kernel_helper_clr:
    s_sub_u32 s44, s2, 253
    s_lshl_b32 s24, s44, 2
    s_add_u32 s24, s24, s3
    s_mul_i32 s45, s24, 5
    s_add_u32 s24, s45, 0
    s_min_u32 s24, s24, 56
    s_sub_u32 s25, s24, 47
    s_cmp_ge_u32 s24, 47
    s_cselect_b32 s24, s25, s24
    s_cselect_b32 s69, 0x2000, 0
    s_lshl_b32 s64, s24, 14
    s_add_u32 s24, s45, 1
    s_min_u32 s24, s24, 56
    s_sub_u32 s25, s24, 47
    s_cmp_ge_u32 s24, 47
    s_cselect_b32 s24, s25, s24
    s_cselect_b32 s70, 0x2000, 0
    s_lshl_b32 s65, s24, 14
    s_add_u32 s24, s45, 2
    s_min_u32 s24, s24, 56
    s_sub_u32 s25, s24, 47
    s_cmp_ge_u32 s24, 47
    s_cselect_b32 s24, s25, s24
    s_cselect_b32 s71, 0x2000, 0
    s_lshl_b32 s66, s24, 14
    s_add_u32 s24, s45, 3
    s_min_u32 s24, s24, 56
    s_sub_u32 s25, s24, 47
    s_cmp_ge_u32 s24, 47
    s_cselect_b32 s24, s25, s24
    s_cselect_b32 s72, 0x2000, 0
    s_lshl_b32 s67, s24, 14
    s_add_u32 s24, s45, 4
    s_min_u32 s24, s24, 56
    s_sub_u32 s25, s24, 47
    s_cmp_ge_u32 s24, 47
    s_cselect_b32 s24, s25, s24
    s_cselect_b32 s73, 0x2000, 0
    s_lshl_b32 s68, s24, 14
    v_lshlrev_b32 v5, 4, v1
    v_mov_b32 v8, -1
    v_mov_b32 v9, -1
    v_mov_b32 v10, -1
    v_mov_b32 v11, -1
    s_lshl_b32 s24, s44, 2
    s_add_u32 s42, s24, 23109632
    s_mov_b32 s40, 0
interleave_layers__linear_attn_block__memory_aug_recurrent_mem_tr__prompt_kernel_clr_blk:
    s_lshl_b32 s24, s40, 12
    s_and_b32 s24, s24, 0x2000
    s_xor_b32 s24, s24, s36
    s_lshl_b32 s41, s40, 20
    s_add_u32 s41, s41, s24
    s_add_u32 s41, s41, 117440512
    s_add_u32 s43, s41, s64
    s_xor_b32 s43, s43, s69
    s_add_u32 s46, s43, 4096
    buffer_store_dwordx4 v[8:11], v5, s[8:11], s43 offen offset:0 sc1
    buffer_store_dwordx4 v[8:11], v5, s[8:11], s43 offen offset:1024 sc1
    buffer_store_dwordx4 v[8:11], v5, s[8:11], s43 offen offset:2048 sc1
    buffer_store_dwordx4 v[8:11], v5, s[8:11], s43 offen offset:3072 sc1
    buffer_store_dwordx4 v[8:11], v5, s[8:11], s46 offen offset:0 sc1
    buffer_store_dwordx4 v[8:11], v5, s[8:11], s46 offen offset:1024 sc1
    buffer_store_dwordx4 v[8:11], v5, s[8:11], s46 offen offset:2048 sc1
    buffer_store_dwordx4 v[8:11], v5, s[8:11], s46 offen offset:3072 sc1
    s_add_u32 s43, s41, s65
    s_xor_b32 s43, s43, s70
    s_add_u32 s46, s43, 4096
    buffer_store_dwordx4 v[8:11], v5, s[8:11], s43 offen offset:0 sc1
    buffer_store_dwordx4 v[8:11], v5, s[8:11], s43 offen offset:1024 sc1
    buffer_store_dwordx4 v[8:11], v5, s[8:11], s43 offen offset:2048 sc1
    buffer_store_dwordx4 v[8:11], v5, s[8:11], s43 offen offset:3072 sc1
    buffer_store_dwordx4 v[8:11], v5, s[8:11], s46 offen offset:0 sc1
    buffer_store_dwordx4 v[8:11], v5, s[8:11], s46 offen offset:1024 sc1
    buffer_store_dwordx4 v[8:11], v5, s[8:11], s46 offen offset:2048 sc1
    buffer_store_dwordx4 v[8:11], v5, s[8:11], s46 offen offset:3072 sc1
    s_add_u32 s43, s41, s66
    s_xor_b32 s43, s43, s71
    s_add_u32 s46, s43, 4096
    buffer_store_dwordx4 v[8:11], v5, s[8:11], s43 offen offset:0 sc1
    buffer_store_dwordx4 v[8:11], v5, s[8:11], s43 offen offset:1024 sc1
    buffer_store_dwordx4 v[8:11], v5, s[8:11], s43 offen offset:2048 sc1
    buffer_store_dwordx4 v[8:11], v5, s[8:11], s43 offen offset:3072 sc1
    buffer_store_dwordx4 v[8:11], v5, s[8:11], s46 offen offset:0 sc1
    buffer_store_dwordx4 v[8:11], v5, s[8:11], s46 offen offset:1024 sc1
    buffer_store_dwordx4 v[8:11], v5, s[8:11], s46 offen offset:2048 sc1
    buffer_store_dwordx4 v[8:11], v5, s[8:11], s46 offen offset:3072 sc1
    s_add_u32 s43, s41, s67
    s_xor_b32 s43, s43, s72
    s_add_u32 s46, s43, 4096
    buffer_store_dwordx4 v[8:11], v5, s[8:11], s43 offen offset:0 sc1
    buffer_store_dwordx4 v[8:11], v5, s[8:11], s43 offen offset:1024 sc1
    buffer_store_dwordx4 v[8:11], v5, s[8:11], s43 offen offset:2048 sc1
    buffer_store_dwordx4 v[8:11], v5, s[8:11], s43 offen offset:3072 sc1
    buffer_store_dwordx4 v[8:11], v5, s[8:11], s46 offen offset:0 sc1
    buffer_store_dwordx4 v[8:11], v5, s[8:11], s46 offen offset:1024 sc1
    buffer_store_dwordx4 v[8:11], v5, s[8:11], s46 offen offset:2048 sc1
    buffer_store_dwordx4 v[8:11], v5, s[8:11], s46 offen offset:3072 sc1
    s_add_u32 s43, s41, s68
    s_xor_b32 s43, s43, s73
    s_add_u32 s46, s43, 4096
    buffer_store_dwordx4 v[8:11], v5, s[8:11], s43 offen offset:0 sc1
    buffer_store_dwordx4 v[8:11], v5, s[8:11], s43 offen offset:1024 sc1
    buffer_store_dwordx4 v[8:11], v5, s[8:11], s43 offen offset:2048 sc1
    buffer_store_dwordx4 v[8:11], v5, s[8:11], s43 offen offset:3072 sc1
    buffer_store_dwordx4 v[8:11], v5, s[8:11], s46 offen offset:0 sc1
    buffer_store_dwordx4 v[8:11], v5, s[8:11], s46 offen offset:1024 sc1
    buffer_store_dwordx4 v[8:11], v5, s[8:11], s46 offen offset:2048 sc1
    buffer_store_dwordx4 v[8:11], v5, s[8:11], s46 offen offset:3072 sc1
    s_waitcnt vmcnt(40)
    s_barrier
    s_cmp_eq_u32 s3, 0
    s_cbranch_scc0 interleave_layers__linear_attn_block__memory_aug_recurrent_mem_tr__prompt_kernel_pb17
    v_lshlrev_b32 v14, 7, v1
    v_add_u32 v14, s42, v14
    v_mov_b32 v15, 2146435072
    v_cmp_le_u32 vcc, 8, v1
    s_nop 1
    v_cndmask_b32 v14, v14, v15, vcc
    v_mov_b32 v15, s40
    buffer_store_dword v15, v14, s[8:11], 0 offen sc1
interleave_layers__linear_attn_block__memory_aug_recurrent_mem_tr__prompt_kernel_pb17:
    s_add_u32 s40, s40, 1
    s_cmp_lt_u32 s40, 64
    s_cbranch_scc1 interleave_layers__linear_attn_block__memory_aug_recurrent_mem_tr__prompt_kernel_clr_blk
    s_waitcnt vmcnt(0)
    s_barrier
    s_cmp_eq_u32 s3, 0
    s_cbranch_scc0 interleave_layers__linear_attn_block__memory_aug_recurrent_mem_tr__prompt_kernel_pb18
    v_lshlrev_b32 v14, 7, v1
    v_add_u32 v14, s42, v14
    v_mov_b32 v15, 2146435072
    v_cmp_le_u32 vcc, 8, v1
    s_nop 1
    v_cndmask_b32 v14, v14, v15, vcc
    v_mov_b32 v15, s40
    buffer_store_dword v15, v14, s[8:11], 0 offen sc1
interleave_layers__linear_attn_block__memory_aug_recurrent_mem_tr__prompt_kernel_pb18:
interleave_layers__linear_attn_block__memory_aug_recurrent_mem_tr__prompt_kernel_clr_blk2:
    s_sub_u32 s47, s40, 64
    s_cmp_ge_u32 s47, 60
    s_cbranch_scc1 interleave_layers__linear_attn_block__memory_aug_recurrent_mem_tr__prompt_kernel_clr_last
    s_and_b32 s24, s47, 3
    s_lshl_b32 s24, s24, 7
    s_add_u32 s24, s24, 23107584
    v_lshlrev_b32 v15, 2, v1
    v_add_u32 v15, s24, v15
    s_lshr_b32 s95, s47, 2
    s_add_u32 s95, s95, 2
    s_mov_b32 s61, 0
interleave_layers__linear_attn_block__memory_aug_recurrent_mem_tr__prompt_kernel_clr_wx:
    buffer_load_dword v14, v15, s[8:11], 0 offen sc1
    s_waitcnt vmcnt(0)
    v_cmp_le_i32 vcc, s95, v14
    s_mov_b32 s25, 0xfffff
    s_and_b32 s24, vcc_lo, s25
    s_cmp_eq_u32 s24, s25
    s_cbranch_scc1 interleave_layers__linear_attn_block__memory_aug_recurrent_mem_tr__prompt_kernel_clr_wx_ok
    s_add_u32 s61, s61, 1
    s_cmp_ge_u32 s61, s60
    s_cbranch_scc1 interleave_layers__linear_attn_block__memory_aug_recurrent_mem_tr__prompt_kernel_clr_wx_to
    s_sleep 32
    s_branch interleave_layers__linear_attn_block__memory_aug_recurrent_mem_tr__prompt_kernel_clr_wx
interleave_layers__linear_attn_block__memory_aug_recurrent_mem_tr__prompt_kernel_clr_wx_to:
    s_mov_b32 s60, 1
interleave_layers__linear_attn_block__memory_aug_recurrent_mem_tr__prompt_kernel_clr_wx_ok:
    s_branch interleave_layers__linear_attn_block__memory_aug_recurrent_mem_tr__prompt_kernel_clr_go
interleave_layers__linear_attn_block__memory_aug_recurrent_mem_tr__prompt_kernel_clr_last:
    v_mov_b32 v15, 23111680
    s_mov_b32 s95, 66
    s_mov_b32 s61, 0
interleave_layers__linear_attn_block__memory_aug_recurrent_mem_tr__prompt_kernel_clr_ws:
    buffer_load_dword v14, v15, s[8:11], 0 offen sc1
    s_waitcnt vmcnt(0)
    v_cmp_le_i32 vcc, s95, v14
    s_mov_b32 s25, 0x1
    s_and_b32 s24, vcc_lo, s25
    s_cmp_eq_u32 s24, s25
    s_cbranch_scc1 interleave_layers__linear_attn_block__memory_aug_recurrent_mem_tr__prompt_kernel_clr_ws_ok
    s_add_u32 s61, s61, 1
    s_cmp_ge_u32 s61, s60
    s_cbranch_scc1 interleave_layers__linear_attn_block__memory_aug_recurrent_mem_tr__prompt_kernel_clr_ws_to
    s_sleep 32
    s_branch interleave_layers__linear_attn_block__memory_aug_recurrent_mem_tr__prompt_kernel_clr_ws
interleave_layers__linear_attn_block__memory_aug_recurrent_mem_tr__prompt_kernel_clr_ws_to:
    s_mov_b32 s60, 1
interleave_layers__linear_attn_block__memory_aug_recurrent_mem_tr__prompt_kernel_clr_ws_ok:
interleave_layers__linear_attn_block__memory_aug_recurrent_mem_tr__prompt_kernel_clr_go:
    s_lshl_b32 s24, s47, 12
    s_and_b32 s24, s24, 0x2000
    s_xor_b32 s24, s24, s36
    s_lshl_b32 s41, s47, 20
    s_add_u32 s41, s41, s24
    s_add_u32 s41, s41, 117440512
    s_add_u32 s43, s41, s64
    s_xor_b32 s43, s43, s69
    s_add_u32 s46, s43, 4096
    buffer_store_dwordx4 v[8:11], v5, s[8:11], s43 offen offset:0 sc1
    buffer_store_dwordx4 v[8:11], v5, s[8:11], s43 offen offset:1024 sc1
    buffer_store_dwordx4 v[8:11], v5, s[8:11], s43 offen offset:2048 sc1
    buffer_store_dwordx4 v[8:11], v5, s[8:11], s43 offen offset:3072 sc1
    buffer_store_dwordx4 v[8:11], v5, s[8:11], s46 offen offset:0 sc1
    buffer_store_dwordx4 v[8:11], v5, s[8:11], s46 offen offset:1024 sc1
    buffer_store_dwordx4 v[8:11], v5, s[8:11], s46 offen offset:2048 sc1
    buffer_store_dwordx4 v[8:11], v5, s[8:11], s46 offen offset:3072 sc1
    s_add_u32 s43, s41, s65
    s_xor_b32 s43, s43, s70
    s_add_u32 s46, s43, 4096
    buffer_store_dwordx4 v[8:11], v5, s[8:11], s43 offen offset:0 sc1
    buffer_store_dwordx4 v[8:11], v5, s[8:11], s43 offen offset:1024 sc1
    buffer_store_dwordx4 v[8:11], v5, s[8:11], s43 offen offset:2048 sc1
    buffer_store_dwordx4 v[8:11], v5, s[8:11], s43 offen offset:3072 sc1
    buffer_store_dwordx4 v[8:11], v5, s[8:11], s46 offen offset:0 sc1
    buffer_store_dwordx4 v[8:11], v5, s[8:11], s46 offen offset:1024 sc1
    buffer_store_dwordx4 v[8:11], v5, s[8:11], s46 offen offset:2048 sc1
    buffer_store_dwordx4 v[8:11], v5, s[8:11], s46 offen offset:3072 sc1
    s_add_u32 s43, s41, s66
    s_xor_b32 s43, s43, s71
    s_add_u32 s46, s43, 4096
    buffer_store_dwordx4 v[8:11], v5, s[8:11], s43 offen offset:0 sc1
    buffer_store_dwordx4 v[8:11], v5, s[8:11], s43 offen offset:1024 sc1
    buffer_store_dwordx4 v[8:11], v5, s[8:11], s43 offen offset:2048 sc1
    buffer_store_dwordx4 v[8:11], v5, s[8:11], s43 offen offset:3072 sc1
    buffer_store_dwordx4 v[8:11], v5, s[8:11], s46 offen offset:0 sc1
    buffer_store_dwordx4 v[8:11], v5, s[8:11], s46 offen offset:1024 sc1
    buffer_store_dwordx4 v[8:11], v5, s[8:11], s46 offen offset:2048 sc1
    buffer_store_dwordx4 v[8:11], v5, s[8:11], s46 offen offset:3072 sc1
    s_add_u32 s43, s41, s67
    s_xor_b32 s43, s43, s72
    s_add_u32 s46, s43, 4096
    buffer_store_dwordx4 v[8:11], v5, s[8:11], s43 offen offset:0 sc1
    buffer_store_dwordx4 v[8:11], v5, s[8:11], s43 offen offset:1024 sc1
    buffer_store_dwordx4 v[8:11], v5, s[8:11], s43 offen offset:2048 sc1
    buffer_store_dwordx4 v[8:11], v5, s[8:11], s43 offen offset:3072 sc1
    buffer_store_dwordx4 v[8:11], v5, s[8:11], s46 offen offset:0 sc1
    buffer_store_dwordx4 v[8:11], v5, s[8:11], s46 offen offset:1024 sc1
    buffer_store_dwordx4 v[8:11], v5, s[8:11], s46 offen offset:2048 sc1
    buffer_store_dwordx4 v[8:11], v5, s[8:11], s46 offen offset:3072 sc1
    s_add_u32 s43, s41, s68
    s_xor_b32 s43, s43, s73
    s_add_u32 s46, s43, 4096
    buffer_store_dwordx4 v[8:11], v5, s[8:11], s43 offen offset:0 sc1
    buffer_store_dwordx4 v[8:11], v5, s[8:11], s43 offen offset:1024 sc1
    buffer_store_dwordx4 v[8:11], v5, s[8:11], s43 offen offset:2048 sc1
    buffer_store_dwordx4 v[8:11], v5, s[8:11], s43 offen offset:3072 sc1
    buffer_store_dwordx4 v[8:11], v5, s[8:11], s46 offen offset:0 sc1
    buffer_store_dwordx4 v[8:11], v5, s[8:11], s46 offen offset:1024 sc1
    buffer_store_dwordx4 v[8:11], v5, s[8:11], s46 offen offset:2048 sc1
    buffer_store_dwordx4 v[8:11], v5, s[8:11], s46 offen offset:3072 sc1
    s_waitcnt vmcnt(0)
    s_barrier
    s_add_u32 s40, s40, 1
    s_cmp_eq_u32 s3, 0
    s_cbranch_scc0 interleave_layers__linear_attn_block__memory_aug_recurrent_mem_tr__prompt_kernel_pb19
    v_lshlrev_b32 v14, 7, v1
    v_add_u32 v14, s42, v14
    v_mov_b32 v15, 2146435072
    v_cmp_le_u32 vcc, 8, v1
    s_nop 1
    v_cndmask_b32 v14, v14, v15, vcc
    v_mov_b32 v15, s40
    buffer_store_dword v15, v14, s[8:11], 0 offen sc1
interleave_layers__linear_attn_block__memory_aug_recurrent_mem_tr__prompt_kernel_pb19:
    s_cmp_lt_u32 s40, 128
    s_cbranch_scc1 interleave_layers__linear_attn_block__memory_aug_recurrent_mem_tr__prompt_kernel_clr_blk2
    s_waitcnt vmcnt(0)
    s_branch interleave_layers__linear_attn_block__memory_aug_recurrent_mem_tr__prompt_kernel_end
interleave_layers__linear_attn_block__memory_aug_recurrent_mem_tr__prompt_kernel_roleS:
    s_mov_b32 s44, s2
    s_load_dwordx2 s[6:7], s[0:1], 40
    s_load_dwordx2 s[24:25], s[0:1], 48
    s_load_dwordx2 s[26:27], s[0:1], 32
    s_waitcnt lgkmcnt(0)
    s_mov_b32 s12, s6
    s_mov_b32 s13, s7
    s_mov_b32 s14, 7864320
    s_mov_b32 s15, 0x00020000
    s_mov_b32 s16, s24
    s_mov_b32 s17, s25
    s_mov_b32 s18, 7864320
    s_mov_b32 s19, 0x00020000
    s_mov_b32 s20, s26
    s_mov_b32 s21, s27
    s_mov_b32 s22, 10240
    s_mov_b32 s23, 0x00020000
    v_add_u32 v16, 0, v0
    s_mov_b32 s24, 683
    v_mul_lo_u32 v17, v16, s24
    v_lshrrev_b32 v17, 14, v17
    v_mul_u32_u24 v18, 24, v17
    v_sub_u32 v18, v16, v18
    s_mov_b32 s24, 12288
    v_mul_lo_u32 v4, v17, s24
    v_lshl_add_u32 v4, v18, 4, v4
    v_mul_u32_u24 v10, 400, v17
    v_lshl_add_u32 v10, v18, 4, v10
    v_add_u32 v10, 106496, v10
    v_add_u32 v16, 256, v0
    s_mov_b32 s24, 683
    v_mul_lo_u32 v17, v16, s24
    v_lshrrev_b32 v17, 14, v17
    v_mul_u32_u24 v18, 24, v17
    v_sub_u32 v18, v16, v18
    s_mov_b32 s24, 12288
    v_mul_lo_u32 v5, v17, s24
    v_lshl_add_u32 v5, v18, 4, v5
    v_mul_u32_u24 v11, 400, v17
    v_lshl_add_u32 v11, v18, 4, v11
    v_add_u32 v11, 106496, v11
    v_add_u32 v16, 512, v0
    s_mov_b32 s24, 683
    v_mul_lo_u32 v17, v16, s24
    v_lshrrev_b32 v17, 14, v17
    v_mul_u32_u24 v18, 24, v17
    v_sub_u32 v18, v16, v18
    s_mov_b32 s24, 12288
    v_mul_lo_u32 v6, v17, s24
    v_lshl_add_u32 v6, v18, 4, v6
    v_mul_u32_u24 v12, 400, v17
    v_lshl_add_u32 v12, v18, 4, v12
    v_add_u32 v12, 106496, v12
    v_add_u32 v16, 768, v0
    s_mov_b32 s24, 683
    v_mul_lo_u32 v17, v16, s24
    v_lshrrev_b32 v17, 14, v17
    v_mul_u32_u24 v18, 24, v17
    v_sub_u32 v18, v16, v18
    s_mov_b32 s24, 12288
    v_mul_lo_u32 v7, v17, s24
    v_lshl_add_u32 v7, v18, 4, v7
    v_mul_u32_u24 v13, 400, v17
    v_lshl_add_u32 v13, v18, 4, v13
    v_add_u32 v13, 106496, v13
    v_add_u32 v16, 1024, v0
    s_mov_b32 s24, 683
    v_mul_lo_u32 v17, v16, s24
    v_lshrrev_b32 v17, 14, v17
    v_mul_u32_u24 v18, 24, v17
    v_sub_u32 v18, v16, v18
    s_mov_b32 s24, 12288
    v_mul_lo_u32 v8, v17, s24
    v_lshl_add_u32 v8, v18, 4, v8
    v_mul_u32_u24 v14, 400, v17
    v_lshl_add_u32 v14, v18, 4, v14
    v_add_u32 v14, 106496, v14
    v_add_u32 v16, 1280, v0
    s_mov_b32 s24, 683
    v_mul_lo_u32 v17, v16, s24
    v_lshrrev_b32 v17, 14, v17
    v_mul_u32_u24 v18, 24, v17
    v_sub_u32 v18, v16, v18
    s_mov_b32 s24, 12288
    v_mul_lo_u32 v9, v17, s24
    v_lshl_add_u32 v9, v18, 4, v9
    v_mul_u32_u24 v15, 400, v17
    v_lshl_add_u32 v15, v18, 4, v15
    v_add_u32 v15, 106496, v15
    v_lshrrev_b32 v17, 1, v3
    v_lshlrev_b32 v17, 4, v17
    v_and_b32 v18, 1, v3
    v_lshl_add_u32 v17, v18, 2, v17
    v_lshrrev_b32 v18, 2, v2
    v_and_b32 v19, 1, v18
    v_add_u32 v17, v17, v19
    v_lshrrev_b32 v18, 1, v18
    v_lshl_add_u32 v17, v18, 3, v17
    v_mul_u32_u24 v16, 400, v17
    v_and_b32 v18, 3, v2
    v_lshl_add_u32 v16, v18, 3, v16
    v_add_u32 v16, 106496, v16
    s_mul_i32 s24, s3, 96
    v_add_u32 v16, s24, v16
    v_lshlrev_b32 v17, 4, v1
    s_mul_i32 s24, s3, 20480
    s_add_u32 s24, s24, 24576
    v_add_u32 v17, s24, v17
    s_mul_i32 s45, s44, 384
    s_add_u32 s46, s45, 0
    buffer_load_dwordx4 v[24:27], v4, s[12:15], s46 offen
    buffer_load_dwordx4 v[28:31], v5, s[12:15], s46 offen
    buffer_load_dwordx4 v[32:35], v6, s[12:15], s46 offen
    buffer_load_dwordx4 v[36:39], v7, s[12:15], s46 offen
    buffer_load_dwordx4 v[40:43], v8, s[12:15], s46 offen
    buffer_load_dwordx4 v[44:47], v9, s[12:15], s46 offen
    s_add_u32 s46, s45, 0
    buffer_load_dwordx4 v[48:51], v4, s[16:19], s46 offen
    buffer_load_dwordx4 v[52:55], v5, s[16:19], s46 offen
    buffer_load_dwordx4 v[56:59], v6, s[16:19], s46 offen
    buffer_load_dwordx4 v[60:63], v7, s[16:19], s46 offen
    buffer_load_dwordx4 v[64:67], v8, s[16:19], s46 offen
    buffer_load_dwordx4 v[68:71], v9, s[16:19], s46 offen
    s_waitcnt vmcnt(6)
    ds_write_b128 v10, v[24:27]
    ds_write_b128 v11, v[28:31]
    ds_write_b128 v12, v[32:35]
    ds_write_b128 v13, v[36:39]
    ds_write_b128 v14, v[40:43]
    ds_write_b128 v15, v[44:47]
    s_add_u32 s46, s45, 786432
    buffer_load_dwordx4 v[72:75], v4, s[12:15], s46 offen
    buffer_load_dwordx4 v[76:79], v5, s[12:15], s46 offen
    buffer_load_dwordx4 v[80:83], v6, s[12:15], s46 offen
    buffer_load_dwordx4 v[84:87], v7, s[12:15], s46 offen
    buffer_load_dwordx4 v[88:91], v8, s[12:15], s46 offen
    buffer_load_dwordx4 v[92:95], v9, s[12:15], s46 offen
    s_waitcnt lgkmcnt(0)
    s_barrier
    ds_read_b64_tr_b16 a[0:1], v16 offset:0
    ds_read_b64_tr_b16 a[2:3], v16 offset:800
    ds_read_b64_tr_b16 a[4:5], v16 offset:12800
    ds_read_b64_tr_b16 a[6:7], v16 offset:13600
    ds_read_b64_tr_b16 a[80:81], v16 offset:32
    ds_read_b64_tr_b16 a[82:83], v16 offset:832
    ds_read_b64_tr_b16 a[84:85], v16 offset:12832
    ds_read_b64_tr_b16 a[86:87], v16 offset:13632
    ds_read_b64_tr_b16 a[160:161], v16 offset:64
    ds_read_b64_tr_b16 a[162:163], v16 offset:864
    ds_read_b64_tr_b16 a[164:165], v16 offset:12864
    ds_read_b64_tr_b16 a[166:167], v16 offset:13664
    s_waitcnt lgkmcnt(0)
    s_barrier
    s_waitcnt vmcnt(6)
    ds_write_b128 v10, v[48:51]
    ds_write_b128 v11, v[52:55]
    ds_write_b128 v12, v[56:59]
    ds_write_b128 v13, v[60:63]
    ds_write_b128 v14, v[64:67]
    ds_write_b128 v15, v[68:71]
    s_add_u32 s46, s45, 786432
    buffer_load_dwordx4 v[24:27], v4, s[16:19], s46 offen
    buffer_load_dwordx4 v[28:31], v5, s[16:19], s46 offen
    buffer_load_dwordx4 v[32:35], v6, s[16:19], s46 offen
    buffer_load_dwordx4 v[36:39], v7, s[16:19], s46 offen
    buffer_load_dwordx4 v[40:43], v8, s[16:19], s46 offen
    buffer_load_dwordx4 v[44:47], v9, s[16:19], s46 offen
    s_waitcnt lgkmcnt(0)
    s_barrier
    ds_read_b64_tr_b16 v[96:97], v16 offset:32
    ds_read_b64_tr_b16 v[98:99], v16 offset:832
    ds_read_b64_tr_b16 v[100:101], v16 offset:12832
    ds_read_b64_tr_b16 v[102:103], v16 offset:13632
    ds_read_b64_tr_b16 v[176:177], v16 offset:64
    ds_read_b64_tr_b16 v[178:179], v16 offset:864
    ds_read_b64_tr_b16 v[180:181], v16 offset:12864
    ds_read_b64_tr_b16 v[182:183], v16 offset:13664
    ds_read_b64_tr_b16 v[48:49], v16 offset:0
    ds_read_b64_tr_b16 v[50:51], v16 offset:800
    ds_read_b64_tr_b16 v[52:53], v16 offset:12800
    ds_read_b64_tr_b16 v[54:55], v16 offset:13600
    s_waitcnt lgkmcnt(0)
    ds_write_b128 v17, v[48:51] offset:0
    ds_write_b128 v17, v[52:55] offset:1024
    s_waitcnt lgkmcnt(0)
    s_barrier
    s_waitcnt vmcnt(6)
    ds_write_b128 v10, v[72:75]
    ds_write_b128 v11, v[76:79]
    ds_write_b128 v12, v[80:83]
    ds_write_b128 v13, v[84:87]
    ds_write_b128 v14, v[88:91]
    ds_write_b128 v15, v[92:95]
    s_add_u32 s46, s45, 1572864
    buffer_load_dwordx4 v[48:51], v4, s[12:15], s46 offen
    buffer_load_dwordx4 v[52:55], v5, s[12:15], s46 offen
    buffer_load_dwordx4 v[56:59], v6, s[12:15], s46 offen
    buffer_load_dwordx4 v[60:63], v7, s[12:15], s46 offen
    buffer_load_dwordx4 v[64:67], v8, s[12:15], s46 offen
    buffer_load_dwordx4 v[68:71], v9, s[12:15], s46 offen
    s_waitcnt lgkmcnt(0)
    s_barrier
    ds_read_b64_tr_b16 a[8:9], v16 offset:0
    ds_read_b64_tr_b16 a[10:11], v16 offset:800
    ds_read_b64_tr_b16 a[12:13], v16 offset:12800
    ds_read_b64_tr_b16 a[14:15], v16 offset:13600
    ds_read_b64_tr_b16 a[88:89], v16 offset:32
    ds_read_b64_tr_b16 a[90:91], v16 offset:832
    ds_read_b64_tr_b16 a[92:93], v16 offset:12832
    ds_read_b64_tr_b16 a[94:95], v16 offset:13632
    ds_read_b64_tr_b16 a[168:169], v16 offset:64
    ds_read_b64_tr_b16 a[170:171], v16 offset:864
    ds_read_b64_tr_b16 a[172:173], v16 offset:12864
    ds_read_b64_tr_b16 a[174:175], v16 offset:13664
    s_waitcnt lgkmcnt(0)
    s_barrier
    s_waitcnt vmcnt(6)
    ds_write_b128 v10, v[24:27]
    ds_write_b128 v11, v[28:31]
    ds_write_b128 v12, v[32:35]
    ds_write_b128 v13, v[36:39]
    ds_write_b128 v14, v[40:43]
    ds_write_b128 v15, v[44:47]
    s_add_u32 s46, s45, 1572864
    buffer_load_dwordx4 v[72:75], v4, s[16:19], s46 offen
    buffer_load_dwordx4 v[76:79], v5, s[16:19], s46 offen
    buffer_load_dwordx4 v[80:83], v6, s[16:19], s46 offen
    buffer_load_dwordx4 v[84:87], v7, s[16:19], s46 offen
    buffer_load_dwordx4 v[88:91], v8, s[16:19], s46 offen
    buffer_load_dwordx4 v[92:95], v9, s[16:19], s46 offen
    s_waitcnt lgkmcnt(0)
    s_barrier
    ds_read_b64_tr_b16 v[104:105], v16 offset:32
    ds_read_b64_tr_b16 v[106:107], v16 offset:832
    ds_read_b64_tr_b16 v[108:109], v16 offset:12832
    ds_read_b64_tr_b16 v[110:111], v16 offset:13632
    ds_read_b64_tr_b16 v[184:185], v16 offset:64
    ds_read_b64_tr_b16 v[186:187], v16 offset:864
    ds_read_b64_tr_b16 v[188:189], v16 offset:12864
    ds_read_b64_tr_b16 v[190:191], v16 offset:13664
    ds_read_b64_tr_b16 v[24:25], v16 offset:0
    ds_read_b64_tr_b16 v[26:27], v16 offset:800
    ds_read_b64_tr_b16 v[28:29], v16 offset:12800
    ds_read_b64_tr_b16 v[30:31], v16 offset:13600
    s_waitcnt lgkmcnt(0)
    ds_write_b128 v17, v[24:27] offset:2048
    ds_write_b128 v17, v[28:31] offset:3072
    s_waitcnt lgkmcnt(0)
    s_barrier
    s_waitcnt vmcnt(6)
    ds_write_b128 v10, v[48:51]
    ds_write_b128 v11, v[52:55]
    ds_write_b128 v12, v[56:59]
    ds_write_b128 v13, v[60:63]
    ds_write_b128 v14, v[64:67]
    ds_write_b128 v15, v[68:71]
    s_add_u32 s46, s45, 2359296
    buffer_load_dwordx4 v[24:27], v4, s[12:15], s46 offen
    buffer_load_dwordx4 v[28:31], v5, s[12:15], s46 offen
    buffer_load_dwordx4 v[32:35], v6, s[12:15], s46 offen
    buffer_load_dwordx4 v[36:39], v7, s[12:15], s46 offen
    buffer_load_dwordx4 v[40:43], v8, s[12:15], s46 offen
    buffer_load_dwordx4 v[44:47], v9, s[12:15], s46 offen
    s_waitcnt lgkmcnt(0)
    s_barrier
    ds_read_b64_tr_b16 a[16:17], v16 offset:0
    ds_read_b64_tr_b16 a[18:19], v16 offset:800
    ds_read_b64_tr_b16 a[20:21], v16 offset:12800
    ds_read_b64_tr_b16 a[22:23], v16 offset:13600
    ds_read_b64_tr_b16 a[96:97], v16 offset:32
    ds_read_b64_tr_b16 a[98:99], v16 offset:832
    ds_read_b64_tr_b16 a[100:101], v16 offset:12832
    ds_read_b64_tr_b16 a[102:103], v16 offset:13632
    ds_read_b64_tr_b16 a[176:177], v16 offset:64
    ds_read_b64_tr_b16 a[178:179], v16 offset:864
    ds_read_b64_tr_b16 a[180:181], v16 offset:12864
    ds_read_b64_tr_b16 a[182:183], v16 offset:13664
    s_waitcnt lgkmcnt(0)
    s_barrier
    s_waitcnt vmcnt(6)
    ds_write_b128 v10, v[72:75]
    ds_write_b128 v11, v[76:79]
    ds_write_b128 v12, v[80:83]
    ds_write_b128 v13, v[84:87]
    ds_write_b128 v14, v[88:91]
    ds_write_b128 v15, v[92:95]
    s_add_u32 s46, s45, 2359296
    buffer_load_dwordx4 v[48:51], v4, s[16:19], s46 offen
    buffer_load_dwordx4 v[52:55], v5, s[16:19], s46 offen
    buffer_load_dwordx4 v[56:59], v6, s[16:19], s46 offen
    buffer_load_dwordx4 v[60:63], v7, s[16:19], s46 offen
    buffer_load_dwordx4 v[64:67], v8, s[16:19], s46 offen
    buffer_load_dwordx4 v[68:71], v9, s[16:19], s46 offen
    s_waitcnt lgkmcnt(0)
    s_barrier
    ds_read_b64_tr_b16 v[112:113], v16 offset:32
    ds_read_b64_tr_b16 v[114:115], v16 offset:832
    ds_read_b64_tr_b16 v[116:117], v16 offset:12832
    ds_read_b64_tr_b16 v[118:119], v16 offset:13632
    ds_read_b64_tr_b16 v[192:193], v16 offset:64
    ds_read_b64_tr_b16 v[194:195], v16 offset:864
    ds_read_b64_tr_b16 v[196:197], v16 offset:12864
    ds_read_b64_tr_b16 v[198:199], v16 offset:13664
    ds_read_b64_tr_b16 v[72:73], v16 offset:0
    ds_read_b64_tr_b16 v[74:75], v16 offset:800
    ds_read_b64_tr_b16 v[76:77], v16 offset:12800
    ds_read_b64_tr_b16 v[78:79], v16 offset:13600
    s_waitcnt lgkmcnt(0)
    ds_write_b128 v17, v[72:75] offset:4096
    ds_write_b128 v17, v[76:79] offset:5120
    s_waitcnt lgkmcnt(0)
    s_barrier
    s_waitcnt vmcnt(6)
    ds_write_b128 v10, v[24:27]
    ds_write_b128 v11, v[28:31]
    ds_write_b128 v12, v[32:35]
    ds_write_b128 v13, v[36:39]
    ds_write_b128 v14, v[40:43]
    ds_write_b128 v15, v[44:47]
    s_add_u32 s46, s45, 3145728
    buffer_load_dwordx4 v[72:75], v4, s[12:15], s46 offen
    buffer_load_dwordx4 v[76:79], v5, s[12:15], s46 offen
    buffer_load_dwordx4 v[80:83], v6, s[12:15], s46 offen
    buffer_load_dwordx4 v[84:87], v7, s[12:15], s46 offen
    buffer_load_dwordx4 v[88:91], v8, s[12:15], s46 offen
    buffer_load_dwordx4 v[92:95], v9, s[12:15], s46 offen
    s_waitcnt lgkmcnt(0)
    s_barrier
    ds_read_b64_tr_b16 a[24:25], v16 offset:0
    ds_read_b64_tr_b16 a[26:27], v16 offset:800
    ds_read_b64_tr_b16 a[28:29], v16 offset:12800
    ds_read_b64_tr_b16 a[30:31], v16 offset:13600
    ds_read_b64_tr_b16 a[104:105], v16 offset:32
    ds_read_b64_tr_b16 a[106:107], v16 offset:832
    ds_read_b64_tr_b16 a[108:109], v16 offset:12832
    ds_read_b64_tr_b16 a[110:111], v16 offset:13632
    ds_read_b64_tr_b16 a[184:185], v16 offset:64
    ds_read_b64_tr_b16 a[186:187], v16 offset:864
    ds_read_b64_tr_b16 a[188:189], v16 offset:12864
    ds_read_b64_tr_b16 a[190:191], v16 offset:13664
    s_waitcnt lgkmcnt(0)
    s_barrier
    s_waitcnt vmcnt(6)
    ds_write_b128 v10, v[48:51]
    ds_write_b128 v11, v[52:55]
    ds_write_b128 v12, v[56:59]
    ds_write_b128 v13, v[60:63]
    ds_write_b128 v14, v[64:67]
    ds_write_b128 v15, v[68:71]
    s_add_u32 s46, s45, 3145728
    buffer_load_dwordx4 v[24:27], v4, s[16:19], s46 offen
    buffer_load_dwordx4 v[28:31], v5, s[16:19], s46 offen
    buffer_load_dwordx4 v[32:35], v6, s[16:19], s46 offen
    buffer_load_dwordx4 v[36:39], v7, s[16:19], s46 offen
    buffer_load_dwordx4 v[40:43], v8, s[16:19], s46 offen
    buffer_load_dwordx4 v[44:47], v9, s[16:19], s46 offen
    s_waitcnt lgkmcnt(0)
    s_barrier
    ds_read_b64_tr_b16 v[120:121], v16 offset:32
    ds_read_b64_tr_b16 v[122:123], v16 offset:832
    ds_read_b64_tr_b16 v[124:125], v16 offset:12832
    ds_read_b64_tr_b16 v[126:127], v16 offset:13632
    ds_read_b64_tr_b16 v[200:201], v16 offset:64
    ds_read_b64_tr_b16 v[202:203], v16 offset:864
    ds_read_b64_tr_b16 v[204:205], v16 offset:12864
    ds_read_b64_tr_b16 v[206:207], v16 offset:13664
    ds_read_b64_tr_b16 v[48:49], v16 offset:0
    ds_read_b64_tr_b16 v[50:51], v16 offset:800
    ds_read_b64_tr_b16 v[52:53], v16 offset:12800
    ds_read_b64_tr_b16 v[54:55], v16 offset:13600
    s_waitcnt lgkmcnt(0)
    ds_write_b128 v17, v[48:51] offset:6144
    ds_write_b128 v17, v[52:55] offset:7168
    s_waitcnt lgkmcnt(0)
    s_barrier
    s_waitcnt vmcnt(6)
    ds_write_b128 v10, v[72:75]
    ds_write_b128 v11, v[76:79]
    ds_write_b128 v12, v[80:83]
    ds_write_b128 v13, v[84:87]
    ds_write_b128 v14, v[88:91]
    ds_write_b128 v15, v[92:95]
    s_add_u32 s46, s45, 3932160
    buffer_load_dwordx4 v[48:51], v4, s[12:15], s46 offen
    buffer_load_dwordx4 v[52:55], v5, s[12:15], s46 offen
    buffer_load_dwordx4 v[56:59], v6, s[12:15], s46 offen
    buffer_load_dwordx4 v[60:63], v7, s[12:15], s46 offen
    buffer_load_dwordx4 v[64:67], v8, s[12:15], s46 offen
    buffer_load_dwordx4 v[68:71], v9, s[12:15], s46 offen
    s_waitcnt lgkmcnt(0)
    s_barrier
    ds_read_b64_tr_b16 a[32:33], v16 offset:0
    ds_read_b64_tr_b16 a[34:35], v16 offset:800
    ds_read_b64_tr_b16 a[36:37], v16 offset:12800
    ds_read_b64_tr_b16 a[38:39], v16 offset:13600
    ds_read_b64_tr_b16 a[112:113], v16 offset:32
    ds_read_b64_tr_b16 a[114:115], v16 offset:832
    ds_read_b64_tr_b16 a[116:117], v16 offset:12832
    ds_read_b64_tr_b16 a[118:119], v16 offset:13632
    ds_read_b64_tr_b16 a[192:193], v16 offset:64
    ds_read_b64_tr_b16 a[194:195], v16 offset:864
    ds_read_b64_tr_b16 a[196:197], v16 offset:12864
    ds_read_b64_tr_b16 a[198:199], v16 offset:13664
    s_waitcnt lgkmcnt(0)
    s_barrier
    s_waitcnt vmcnt(6)
    ds_write_b128 v10, v[24:27]
    ds_write_b128 v11, v[28:31]
    ds_write_b128 v12, v[32:35]
    ds_write_b128 v13, v[36:39]
    ds_write_b128 v14, v[40:43]
    ds_write_b128 v15, v[44:47]
    s_add_u32 s46, s45, 3932160
    buffer_load_dwordx4 v[72:75], v4, s[16:19], s46 offen
    buffer_load_dwordx4 v[76:79], v5, s[16:19], s46 offen
    buffer_load_dwordx4 v[80:83], v6, s[16:19], s46 offen
    buffer_load_dwordx4 v[84:87], v7, s[16:19], s46 offen
    buffer_load_dwordx4 v[88:91], v8, s[16:19], s46 offen
    buffer_load_dwordx4 v[92:95], v9, s[16:19], s46 offen
    s_waitcnt lgkmcnt(0)
    s_barrier
    ds_read_b64_tr_b16 v[128:129], v16 offset:32
    ds_read_b64_tr_b16 v[130:131], v16 offset:832
    ds_read_b64_tr_b16 v[132:133], v16 offset:12832
    ds_read_b64_tr_b16 v[134:135], v16 offset:13632
    ds_read_b64_tr_b16 v[208:209], v16 offset:64
    ds_read_b64_tr_b16 v[210:211], v16 offset:864
    ds_read_b64_tr_b16 v[212:213], v16 offset:12864
    ds_read_b64_tr_b16 v[214:215], v16 offset:13664
    ds_read_b64_tr_b16 v[24:25], v16 offset:0
    ds_read_b64_tr_b16 v[26:27], v16 offset:800
    ds_read_b64_tr_b16 v[28:29], v16 offset:12800
    ds_read_b64_tr_b16 v[30:31], v16 offset:13600
    s_waitcnt lgkmcnt(0)
    ds_write_b128 v17, v[24:27] offset:8192
    ds_write_b128 v17, v[28:31] offset:9216
    s_waitcnt lgkmcnt(0)
    s_barrier
    s_waitcnt vmcnt(6)
    ds_write_b128 v10, v[48:51]
    ds_write_b128 v11, v[52:55]
    ds_write_b128 v12, v[56:59]
    ds_write_b128 v13, v[60:63]
    ds_write_b128 v14, v[64:67]
    ds_write_b128 v15, v[68:71]
    s_add_u32 s46, s45, 4718592
    buffer_load_dwordx4 v[24:27], v4, s[12:15], s46 offen
    buffer_load_dwordx4 v[28:31], v5, s[12:15], s46 offen
    buffer_load_dwordx4 v[32:35], v6, s[12:15], s46 offen
    buffer_load_dwordx4 v[36:39], v7, s[12:15], s46 offen
    buffer_load_dwordx4 v[40:43], v8, s[12:15], s46 offen
    buffer_load_dwordx4 v[44:47], v9, s[12:15], s46 offen
    s_waitcnt lgkmcnt(0)
    s_barrier
    ds_read_b64_tr_b16 a[40:41], v16 offset:0
    ds_read_b64_tr_b16 a[42:43], v16 offset:800
    ds_read_b64_tr_b16 a[44:45], v16 offset:12800
    ds_read_b64_tr_b16 a[46:47], v16 offset:13600
    ds_read_b64_tr_b16 a[120:121], v16 offset:32
    ds_read_b64_tr_b16 a[122:123], v16 offset:832
    ds_read_b64_tr_b16 a[124:125], v16 offset:12832
    ds_read_b64_tr_b16 a[126:127], v16 offset:13632
    ds_read_b64_tr_b16 a[200:201], v16 offset:64
    ds_read_b64_tr_b16 a[202:203], v16 offset:864
    ds_read_b64_tr_b16 a[204:205], v16 offset:12864
    ds_read_b64_tr_b16 a[206:207], v16 offset:13664
    s_waitcnt lgkmcnt(0)
    s_barrier
    s_waitcnt vmcnt(6)
    ds_write_b128 v10, v[72:75]
    ds_write_b128 v11, v[76:79]
    ds_write_b128 v12, v[80:83]
    ds_write_b128 v13, v[84:87]
    ds_write_b128 v14, v[88:91]
    ds_write_b128 v15, v[92:95]
    s_add_u32 s46, s45, 4718592
    buffer_load_dwordx4 v[48:51], v4, s[16:19], s46 offen
    buffer_load_dwordx4 v[52:55], v5, s[16:19], s46 offen
    buffer_load_dwordx4 v[56:59], v6, s[16:19], s46 offen
    buffer_load_dwordx4 v[60:63], v7, s[16:19], s46 offen
    buffer_load_dwordx4 v[64:67], v8, s[16:19], s46 offen
    buffer_load_dwordx4 v[68:71], v9, s[16:19], s46 offen
    s_waitcnt lgkmcnt(0)
    s_barrier
    ds_read_b64_tr_b16 v[136:137], v16 offset:32
    ds_read_b64_tr_b16 v[138:139], v16 offset:832
    ds_read_b64_tr_b16 v[140:141], v16 offset:12832
    ds_read_b64_tr_b16 v[142:143], v16 offset:13632
    ds_read_b64_tr_b16 v[216:217], v16 offset:64
    ds_read_b64_tr_b16 v[218:219], v16 offset:864
    ds_read_b64_tr_b16 v[220:221], v16 offset:12864
    ds_read_b64_tr_b16 v[222:223], v16 offset:13664
    ds_read_b64_tr_b16 v[72:73], v16 offset:0
    ds_read_b64_tr_b16 v[74:75], v16 offset:800
    ds_read_b64_tr_b16 v[76:77], v16 offset:12800
    ds_read_b64_tr_b16 v[78:79], v16 offset:13600
    s_waitcnt lgkmcnt(0)
    ds_write_b128 v17, v[72:75] offset:10240
    ds_write_b128 v17, v[76:79] offset:11264
    s_waitcnt lgkmcnt(0)
    s_barrier
    s_waitcnt vmcnt(6)
    ds_write_b128 v10, v[24:27]
    ds_write_b128 v11, v[28:31]
    ds_write_b128 v12, v[32:35]
    ds_write_b128 v13, v[36:39]
    ds_write_b128 v14, v[40:43]
    ds_write_b128 v15, v[44:47]
    s_add_u32 s46, s45, 5505024
    buffer_load_dwordx4 v[72:75], v4, s[12:15], s46 offen
    buffer_load_dwordx4 v[76:79], v5, s[12:15], s46 offen
    buffer_load_dwordx4 v[80:83], v6, s[12:15], s46 offen
    buffer_load_dwordx4 v[84:87], v7, s[12:15], s46 offen
    buffer_load_dwordx4 v[88:91], v8, s[12:15], s46 offen
    buffer_load_dwordx4 v[92:95], v9, s[12:15], s46 offen
    s_waitcnt lgkmcnt(0)
    s_barrier
    ds_read_b64_tr_b16 a[48:49], v16 offset:0
    ds_read_b64_tr_b16 a[50:51], v16 offset:800
    ds_read_b64_tr_b16 a[52:53], v16 offset:12800
    ds_read_b64_tr_b16 a[54:55], v16 offset:13600
    ds_read_b64_tr_b16 a[128:129], v16 offset:32
    ds_read_b64_tr_b16 a[130:131], v16 offset:832
    ds_read_b64_tr_b16 a[132:133], v16 offset:12832
    ds_read_b64_tr_b16 a[134:135], v16 offset:13632
    ds_read_b64_tr_b16 a[208:209], v16 offset:64
    ds_read_b64_tr_b16 a[210:211], v16 offset:864
    ds_read_b64_tr_b16 a[212:213], v16 offset:12864
    ds_read_b64_tr_b16 a[214:215], v16 offset:13664
    s_waitcnt lgkmcnt(0)
    s_barrier
    s_waitcnt vmcnt(6)
    ds_write_b128 v10, v[48:51]
    ds_write_b128 v11, v[52:55]
    ds_write_b128 v12, v[56:59]
    ds_write_b128 v13, v[60:63]
    ds_write_b128 v14, v[64:67]
    ds_write_b128 v15, v[68:71]
    s_add_u32 s46, s45, 5505024
    buffer_load_dwordx4 v[24:27], v4, s[16:19], s46 offen
    buffer_load_dwordx4 v[28:31], v5, s[16:19], s46 offen
    buffer_load_dwordx4 v[32:35], v6, s[16:19], s46 offen
    buffer_load_dwordx4 v[36:39], v7, s[16:19], s46 offen
    buffer_load_dwordx4 v[40:43], v8, s[16:19], s46 offen
    buffer_load_dwordx4 v[44:47], v9, s[16:19], s46 offen
    s_waitcnt lgkmcnt(0)
    s_barrier
    ds_read_b64_tr_b16 v[144:145], v16 offset:32
    ds_read_b64_tr_b16 v[146:147], v16 offset:832
    ds_read_b64_tr_b16 v[148:149], v16 offset:12832
    ds_read_b64_tr_b16 v[150:151], v16 offset:13632
    ds_read_b64_tr_b16 v[224:225], v16 offset:64
    ds_read_b64_tr_b16 v[226:227], v16 offset:864
    ds_read_b64_tr_b16 v[228:229], v16 offset:12864
    ds_read_b64_tr_b16 v[230:231], v16 offset:13664
    ds_read_b64_tr_b16 v[48:49], v16 offset:0
    ds_read_b64_tr_b16 v[50:51], v16 offset:800
    ds_read_b64_tr_b16 v[52:53], v16 offset:12800
    ds_read_b64_tr_b16 v[54:55], v16 offset:13600
    s_waitcnt lgkmcnt(0)
    ds_write_b128 v17, v[48:51] offset:12288
    ds_write_b128 v17, v[52:55] offset:13312
    s_waitcnt lgkmcnt(0)
    s_barrier
    s_waitcnt vmcnt(6)
    ds_write_b128 v10, v[72:75]
    ds_write_b128 v11, v[76:79]
    ds_write_b128 v12, v[80:83]
    ds_write_b128 v13, v[84:87]
    ds_write_b128 v14, v[88:91]
    ds_write_b128 v15, v[92:95]
    s_add_u32 s46, s45, 6291456
    buffer_load_dwordx4 v[48:51], v4, s[12:15], s46 offen
    buffer_load_dwordx4 v[52:55], v5, s[12:15], s46 offen
    buffer_load_dwordx4 v[56:59], v6, s[12:15], s46 offen
    buffer_load_dwordx4 v[60:63], v7, s[12:15], s46 offen
    buffer_load_dwordx4 v[64:67], v8, s[12:15], s46 offen
    buffer_load_dwordx4 v[68:71], v9, s[12:15], s46 offen
    s_waitcnt lgkmcnt(0)
    s_barrier
    ds_read_b64_tr_b16 a[56:57], v16 offset:0
    ds_read_b64_tr_b16 a[58:59], v16 offset:800
    ds_read_b64_tr_b16 a[60:61], v16 offset:12800
    ds_read_b64_tr_b16 a[62:63], v16 offset:13600
    ds_read_b64_tr_b16 a[136:137], v16 offset:32
    ds_read_b64_tr_b16 a[138:139], v16 offset:832
    ds_read_b64_tr_b16 a[140:141], v16 offset:12832
    ds_read_b64_tr_b16 a[142:143], v16 offset:13632
    ds_read_b64_tr_b16 a[216:217], v16 offset:64
    ds_read_b64_tr_b16 a[218:219], v16 offset:864
    ds_read_b64_tr_b16 a[220:221], v16 offset:12864
    ds_read_b64_tr_b16 a[222:223], v16 offset:13664
    s_waitcnt lgkmcnt(0)
    s_barrier
    s_waitcnt vmcnt(6)
    ds_write_b128 v10, v[24:27]
    ds_write_b128 v11, v[28:31]
    ds_write_b128 v12, v[32:35]
    ds_write_b128 v13, v[36:39]
    ds_write_b128 v14, v[40:43]
    ds_write_b128 v15, v[44:47]
    s_add_u32 s46, s45, 6291456
    buffer_load_dwordx4 v[72:75], v4, s[16:19], s46 offen
    buffer_load_dwordx4 v[76:79], v5, s[16:19], s46 offen
    buffer_load_dwordx4 v[80:83], v6, s[16:19], s46 offen
    buffer_load_dwordx4 v[84:87], v7, s[16:19], s46 offen
    buffer_load_dwordx4 v[88:91], v8, s[16:19], s46 offen
    buffer_load_dwordx4 v[92:95], v9, s[16:19], s46 offen
    s_waitcnt lgkmcnt(0)
    s_barrier
    ds_read_b64_tr_b16 v[152:153], v16 offset:32
    ds_read_b64_tr_b16 v[154:155], v16 offset:832
    ds_read_b64_tr_b16 v[156:157], v16 offset:12832
    ds_read_b64_tr_b16 v[158:159], v16 offset:13632
    ds_read_b64_tr_b16 v[232:233], v16 offset:64
    ds_read_b64_tr_b16 v[234:235], v16 offset:864
    ds_read_b64_tr_b16 v[236:237], v16 offset:12864
    ds_read_b64_tr_b16 v[238:239], v16 offset:13664
    ds_read_b64_tr_b16 v[24:25], v16 offset:0
    ds_read_b64_tr_b16 v[26:27], v16 offset:800
    ds_read_b64_tr_b16 v[28:29], v16 offset:12800
    ds_read_b64_tr_b16 v[30:31], v16 offset:13600
    s_waitcnt lgkmcnt(0)
    ds_write_b128 v17, v[24:27] offset:14336
    ds_write_b128 v17, v[28:31] offset:15360
    s_waitcnt lgkmcnt(0)
    s_barrier
    s_waitcnt vmcnt(6)
    ds_write_b128 v10, v[48:51]
    ds_write_b128 v11, v[52:55]
    ds_write_b128 v12, v[56:59]
    ds_write_b128 v13, v[60:63]
    ds_write_b128 v14, v[64:67]
    ds_write_b128 v15, v[68:71]
    s_add_u32 s46, s45, 7077888
    buffer_load_dwordx4 v[24:27], v4, s[12:15], s46 offen
    buffer_load_dwordx4 v[28:31], v5, s[12:15], s46 offen
    buffer_load_dwordx4 v[32:35], v6, s[12:15], s46 offen
    buffer_load_dwordx4 v[36:39], v7, s[12:15], s46 offen
    buffer_load_dwordx4 v[40:43], v8, s[12:15], s46 offen
    buffer_load_dwordx4 v[44:47], v9, s[12:15], s46 offen
    s_waitcnt lgkmcnt(0)
    s_barrier
    ds_read_b64_tr_b16 a[64:65], v16 offset:0
    ds_read_b64_tr_b16 a[66:67], v16 offset:800
    ds_read_b64_tr_b16 a[68:69], v16 offset:12800
    ds_read_b64_tr_b16 a[70:71], v16 offset:13600
    ds_read_b64_tr_b16 a[144:145], v16 offset:32
    ds_read_b64_tr_b16 a[146:147], v16 offset:832
    ds_read_b64_tr_b16 a[148:149], v16 offset:12832
    ds_read_b64_tr_b16 a[150:151], v16 offset:13632
    ds_read_b64_tr_b16 a[224:225], v16 offset:64
    ds_read_b64_tr_b16 a[226:227], v16 offset:864
    ds_read_b64_tr_b16 a[228:229], v16 offset:12864
    ds_read_b64_tr_b16 a[230:231], v16 offset:13664
    s_waitcnt lgkmcnt(0)
    s_barrier
    s_waitcnt vmcnt(6)
    ds_write_b128 v10, v[72:75]
    ds_write_b128 v11, v[76:79]
    ds_write_b128 v12, v[80:83]
    ds_write_b128 v13, v[84:87]
    ds_write_b128 v14, v[88:91]
    ds_write_b128 v15, v[92:95]
    s_add_u32 s46, s45, 7077888
    buffer_load_dwordx4 v[48:51], v4, s[16:19], s46 offen
    buffer_load_dwordx4 v[52:55], v5, s[16:19], s46 offen
    buffer_load_dwordx4 v[56:59], v6, s[16:19], s46 offen
    buffer_load_dwordx4 v[60:63], v7, s[16:19], s46 offen
    buffer_load_dwordx4 v[64:67], v8, s[16:19], s46 offen
    buffer_load_dwordx4 v[68:71], v9, s[16:19], s46 offen
    s_waitcnt lgkmcnt(0)
    s_barrier
    ds_read_b64_tr_b16 v[160:161], v16 offset:32
    ds_read_b64_tr_b16 v[162:163], v16 offset:832
    ds_read_b64_tr_b16 v[164:165], v16 offset:12832
    ds_read_b64_tr_b16 v[166:167], v16 offset:13632
    ds_read_b64_tr_b16 v[240:241], v16 offset:64
    ds_read_b64_tr_b16 v[242:243], v16 offset:864
    ds_read_b64_tr_b16 v[244:245], v16 offset:12864
    ds_read_b64_tr_b16 v[246:247], v16 offset:13664
    ds_read_b64_tr_b16 v[72:73], v16 offset:0
    ds_read_b64_tr_b16 v[74:75], v16 offset:800
    ds_read_b64_tr_b16 v[76:77], v16 offset:12800
    ds_read_b64_tr_b16 v[78:79], v16 offset:13600
    s_waitcnt lgkmcnt(0)
    ds_write_b128 v17, v[72:75] offset:16384
    ds_write_b128 v17, v[76:79] offset:17408
    s_waitcnt lgkmcnt(0)
    s_barrier
    s_waitcnt vmcnt(6)
    ds_write_b128 v10, v[24:27]
    ds_write_b128 v11, v[28:31]
    ds_write_b128 v12, v[32:35]
    ds_write_b128 v13, v[36:39]
    ds_write_b128 v14, v[40:43]
    ds_write_b128 v15, v[44:47]
    s_waitcnt lgkmcnt(0)
    s_barrier
    ds_read_b64_tr_b16 a[72:73], v16 offset:0
    ds_read_b64_tr_b16 a[74:75], v16 offset:800
    ds_read_b64_tr_b16 a[76:77], v16 offset:12800
    ds_read_b64_tr_b16 a[78:79], v16 offset:13600
    ds_read_b64_tr_b16 a[152:153], v16 offset:32
    ds_read_b64_tr_b16 a[154:155], v16 offset:832
    ds_read_b64_tr_b16 a[156:157], v16 offset:12832
    ds_read_b64_tr_b16 a[158:159], v16 offset:13632
    ds_read_b64_tr_b16 a[232:233], v16 offset:64
    ds_read_b64_tr_b16 a[234:235], v16 offset:864
    ds_read_b64_tr_b16 a[236:237], v16 offset:12864
    ds_read_b64_tr_b16 a[238:239], v16 offset:13664
    s_waitcnt lgkmcnt(0)
    s_barrier
    s_waitcnt vmcnt(0)
    ds_write_b128 v10, v[48:51]
    ds_write_b128 v11, v[52:55]
    ds_write_b128 v12, v[56:59]
    ds_write_b128 v13, v[60:63]
    ds_write_b128 v14, v[64:67]
    ds_write_b128 v15, v[68:71]
    s_waitcnt lgkmcnt(0)
    s_barrier
    ds_read_b64_tr_b16 v[168:169], v16 offset:32
    ds_read_b64_tr_b16 v[170:171], v16 offset:832
    ds_read_b64_tr_b16 v[172:173], v16 offset:12832
    ds_read_b64_tr_b16 v[174:175], v16 offset:13632
    ds_read_b64_tr_b16 v[248:249], v16 offset:64
    ds_read_b64_tr_b16 v[250:251], v16 offset:864
    ds_read_b64_tr_b16 v[252:253], v16 offset:12864
    ds_read_b64_tr_b16 v[254:255], v16 offset:13664
    ds_read_b64_tr_b16 v[48:49], v16 offset:0
    ds_read_b64_tr_b16 v[50:51], v16 offset:800
    ds_read_b64_tr_b16 v[52:53], v16 offset:12800
    ds_read_b64_tr_b16 v[54:55], v16 offset:13600
    s_waitcnt lgkmcnt(0)
    ds_write_b128 v17, v[48:51] offset:18432
    ds_write_b128 v17, v[52:55] offset:19456
    s_waitcnt lgkmcnt(0)
    s_barrier
    v_mov_b32 v6, v17
    v_mov_b32 v30, 0xeeee
    v_mov_b32 v4, 0x4444
    v_cmp_gt_u32 vcc, 8, v2
    s_nop 1
    v_cndmask_b32 v4, v30, v4, vcc
    v_lshlrev_b32 v5, 4, v1
    s_lshl_b32 s24, s3, 10
    v_add_u32 v7, s24, v5
    s_lshl_b32 s24, s3, 9
    s_add_u32 s24, s24, 8192
    v_lshlrev_b32 v8, 3, v1
    v_add_u32 v8, s24, v8
    v_and_b32 v30, 1, v2
    v_lshlrev_b32 v30, 4, v30
    v_mov_b32 v31, 0x3f80
    v_lshlrev_b32 v31, v30, v31
    v_lshrrev_b32 v30, 2, v2
    v_cmp_eq_u32 vcc, v30, v3
    s_nop 1
    v_cndmask_b32 v31, 0, v31, vcc
    v_and_b32 v30, 2, v2
    v_cmp_eq_u32 vcc, 0, v30
    s_nop 1
    v_cndmask_b32 v10, 0, v31, vcc
    v_cndmask_b32 v11, v31, 0, vcc
    v_add_u32 v33, 22528, v5
    s_mul_i32 s24, s3, 1408
    s_add_u32 s24, s24, 16384
    v_mul_u32_u24 v30, 176, v2
    v_add_u32 v30, s24, v30
    v_lshl_add_u32 v12, v3, 5, v30
    v_cmp_gt_u32 vcc, 8, v2
    s_nop 1
    v_cndmask_b32 v12, v33, v12, vcc
    v_lshl_add_u32 v13, v3, 4, v30
    v_add_u32 v13, 96, v13
    v_cmp_le_u32 s[24:25], 2, v3
    s_and_b64 vcc, vcc, s[24:25]
    v_cndmask_b32 v13, v33, v13, vcc
    s_mul_i32 s24, s3, 5632
    s_add_u32 s24, s24, 106496
    v_mul_u32_u24 v30, 176, v2
    v_add_u32 v30, s24, v30
    v_lshl_add_u32 v16, v3, 5, v30
    v_lshl_add_u32 v17, v3, 4, v30
    v_add_u32 v17, 96, v17
    v_add_u32 v18, 2816, v17
    v_cmp_le_u32 vcc, 2, v3
    s_nop 1
    v_cndmask_b32 v17, v33, v17, vcc
    v_cndmask_b32 v18, v33, v18, vcc
    v_lshrrev_b32 v30, 3, v1
    v_and_b32 v31, 7, v1
    v_min_u32 v32, 4, v31
    v_mul_u32_u24 v14, 176, v30
    v_lshl_add_u32 v14, v32, 5, v14
    s_mul_i32 s24, s3, 1408
    s_add_u32 s24, s24, 106496
    v_add_u32 v21, s24, v14
    v_add_u32 v14, 16384, v14
    v_cmp_gt_u32 s[50:51], 5, v31
    s_lshl_b32 s24, s3, 3
    v_add_u32 v32, s24, v30
    v_lshlrev_b32 v33, 2, v31
    v_sub_u32 v32, v32, v33
    v_mov_b32 v33, 100
    v_cmp_gt_u32 vcc, 4, v31
    s_nop 1
    v_cndmask_b32 v32, v33, v32, vcc
    v_cmp_le_i32 s[64:65], 0, v32
    v_cmp_le_i32 s[66:67], 1, v32
    v_cmp_le_i32 s[68:69], 2, v32
    v_cmp_le_i32 s[70:71], 3, v32
    v_cmp_le_i32 s[72:73], 16, v32
    v_cmp_le_i32 s[74:75], 17, v32
    v_cmp_le_i32 s[76:77], 18, v32
    v_cmp_le_i32 s[78:79], 19, v32
    s_lshr_b32 s24, s44, 1
    s_lshl_b32 s24, s24, 10
    s_and_b32 s25, s44, 1
    s_lshl_b32 s25, s25, 7
    s_add_u32 s24, s24, s25
    v_lshlrev_b32 v15, 8, v31
    v_lshl_add_u32 v15, v30, 4, v15
    v_add_u32 v15, s24, v15
    s_lshr_b32 s24, s44, 3
    s_lshl_b32 s24, s24, 10
    s_and_b32 s25, s44, 3
    s_lshl_b32 s25, s25, 8
    s_add_u32 s24, s24, s25
    s_lshr_b32 s25, s44, 2
    s_and_b32 s25, s25, 1
    s_lshl_b32 s25, s25, 7
    s_add_u32 s24, s24, s25
    s_add_u32 s24, s24, 16384
    v_lshlrev_b32 v32, 4, v30
    v_add_u32 v32, s24, v32
    v_cmp_eq_u32 vcc, 4, v31
    s_nop 1
    v_cndmask_b32 v15, v15, v32, vcc
    v_and_b32 v32, 0xffffe000, v15
    v_add_u32 v15, v15, v32
    v_mov_b32 v32, 2146435072
    v_cndmask_b32 v15, v32, v15, s[50:51]
    s_cmp_lt_u32 s3, 1
    s_cselect_b32 s24, 0, 2146435072
    v_or_b32 v15, s24, v15
    s_and_b32 s24, s3, 1
    s_lshl_b32 s24, s24, 7
    s_lshr_b32 s25, s3, 1
    s_lshl_b32 s25, s25, 10
    s_add_u32 s24, s24, s25
    s_lshl_b32 s25, s44, 11
    s_add_u32 s25, s25, s24
    v_lshlrev_b32 v22, 8, v31
    v_lshl_add_u32 v22, v30, 4, v22
    v_add_u32 v22, s25, v22
    s_lshr_b32 s25, s44, 2
    s_lshl_b32 s25, s25, 11
    s_add_u32 s25, s25, s24
    s_and_b32 s26, s44, 3
    s_lshl_b32 s26, s26, 8
    s_add_u32 s25, s25, s26
    s_add_u32 s25, s25, 65536
    v_lshlrev_b32 v32, 4, v30
    v_add_u32 v32, s25, v32
    v_cmp_eq_u32 vcc, 4, v31
    s_nop 1
    v_cndmask_b32 v22, v22, v32, vcc
    v_and_b32 v32, 0xffffe000, v22
    v_add_u32 v22, v22, v32
    v_mov_b32 v32, 2146435072
    v_cndmask_b32 v22, v32, v22, s[50:51]
    s_mul_i32 s24, s44, 12288
    s_mul_i32 s25, s3, 3072
    s_add_u32 s24, s24, s25
    v_add_u32 v19, s24, v5
    s_and_b32 s24, s2, 15
    s_mul_i32 s25, s3, 16
    s_add_u32 s24, s24, s25
    s_lshl_b32 s24, s24, 7
    v_mov_b32 v23, s24
    s_lshr_b32 s25, s44, 3
    s_mul_i32 s24, s25, 8
    v_add_u32 v20, s24, v1
    v_lshlrev_b32 v20, 7, v20
    v_mov_b32 v30, 2146435072
    v_cmp_le_u32 vcc, 8, v1
    s_nop 1
    v_cndmask_b32 v20, v20, v30, vcc
    s_cmp_eq_u32 s3, 0
    s_cselect_b32 s24, 0, 2146435072
    v_or_b32 v20, s24, v20
    v_mov_b32 v0, 1
interleave_layers__linear_attn_block__memory_aug_recurrent_mem_tr__prompt_kernel_s_layer:
    s_mov_b32 s93, 0
    s_lshl_b32 s24, s93, 12
    s_and_b32 s24, s24, 0x2000
    s_xor_b32 s24, s24, s36
    s_lshl_b32 s93, s93, 20
    s_add_u32 s93, s93, s24
    s_add_u32 s93, s93, 117440512
    s_mul_i32 s94, s92, 16384
    s_add_u32 s94, s94, 23068672
    v_and_b32 v9, 1, v1
    v_lshlrev_b32 v9, 12, v9
    s_lshl_b32 s24, s44, 7
    s_add_u32 s24, s24, s94
    v_add_u32 v9, s24, v9
    s_lshl_b32 s24, s3, 6
    s_add_u32 s24, s24, 0
    v_add_u32 v48, s24, v1
    v_and_b32 v49, 7, v48
    v_mul_u32_u24 v49, 1280, v49
    v_lshrrev_b32 v50, 3, v48
    v_lshl_add_u32 v49, v50, 4, v49
    v_cmp_gt_u32 vcc, 640, v48
    v_mov_b32 v51, 2146435072
    s_nop 0
    v_cndmask_b32 v49, v51, v49, vcc
    buffer_load_dwordx4 v[52:55], v49, s[20:23], 0 offen
    v_lshlrev_b32 v48, 4, v48
    s_waitcnt vmcnt(0)
    s_and_saveexec_b64 s[30:31], vcc
    ds_write_b128 v48, v[52:55]
    s_mov_b64 exec, s[30:31]
    s_lshl_b32 s24, s3, 6
    s_add_u32 s24, s24, 256
    v_add_u32 v48, s24, v1
    v_and_b32 v49, 7, v48
    v_mul_u32_u24 v49, 1280, v49
    v_lshrrev_b32 v50, 3, v48
    v_lshl_add_u32 v49, v50, 4, v49
    v_cmp_gt_u32 vcc, 640, v48
    v_mov_b32 v51, 2146435072
    s_nop 0
    v_cndmask_b32 v49, v51, v49, vcc
    buffer_load_dwordx4 v[52:55], v49, s[20:23], 0 offen
    v_lshlrev_b32 v48, 4, v48
    s_waitcnt vmcnt(0)
    s_and_saveexec_b64 s[30:31], vcc
    ds_write_b128 v48, v[52:55]
    s_mov_b64 exec, s[30:31]
    s_lshl_b32 s24, s3, 6
    s_add_u32 s24, s24, 512
    v_add_u32 v48, s24, v1
    v_and_b32 v49, 7, v48
    v_mul_u32_u24 v49, 1280, v49
    v_lshrrev_b32 v50, 3, v48
    v_lshl_add_u32 v49, v50, 4, v49
    v_cmp_gt_u32 vcc, 640, v48
    v_mov_b32 v51, 2146435072
    s_nop 0
    v_cndmask_b32 v49, v51, v49, vcc
    buffer_load_dwordx4 v[52:55], v49, s[20:23], 0 offen
    v_lshlrev_b32 v48, 4, v48
    s_waitcnt vmcnt(0)
    s_and_saveexec_b64 s[30:31], vcc
    ds_write_b128 v48, v[52:55]
    s_mov_b64 exec, s[30:31]
    s_mov_b32 s40, 0
    s_mov_b32 s41, 92274688
    s_mov_b32 s37, s93
    s_add_u32 s43, s93, 655360
    s_mov_b32 s45, 67108864
    s_add_u32 s49, s93, 753664
    s_lshl_b32 s95, s92, 6
    s_add_u32 s95, s95, s40
    s_add_u32 s95, s95, 1
    s_cmp_ge_i32 s59, s95
    s_cbranch_scc1 interleave_layers__linear_attn_block__memory_aug_recurrent_mem_tr__prompt_kernel_s_ec0_ok
    s_and_b32 s24, s2, 7
    s_lshl_b32 s24, s24, 7
    s_add_u32 s24, s24, 23109632
    v_and_b32 v49, 3, v1
    v_lshl_add_u32 v49, v49, 2, s24
    s_mov_b32 s61, 0
interleave_layers__linear_attn_block__memory_aug_recurrent_mem_tr__prompt_kernel_s_ec0:
    buffer_load_dword v48, v49, s[8:11], 0 offen sc1
    s_waitcnt vmcnt(0)
    v_readlane_b32 s59, v48, 0
    v_readlane_b32 s24, v48, 1
    s_min_i32 s59, s59, s24
    v_readlane_b32 s24, v48, 2
    s_min_i32 s59, s59, s24
    s_cmp_ge_i32 s59, s95
    s_cbranch_scc1 interleave_layers__linear_attn_block__memory_aug_recurrent_mem_tr__prompt_kernel_s_ec0_ok
    s_add_u32 s61, s61, 1
    s_cmp_ge_u32 s61, s60
    s_cbranch_scc1 interleave_layers__linear_attn_block__memory_aug_recurrent_mem_tr__prompt_kernel_s_ec0_to
    s_sleep 2
    s_branch interleave_layers__linear_attn_block__memory_aug_recurrent_mem_tr__prompt_kernel_s_ec0
interleave_layers__linear_attn_block__memory_aug_recurrent_mem_tr__prompt_kernel_s_ec0_to:
    s_mov_b32 s60, 1
interleave_layers__linear_attn_block__memory_aug_recurrent_mem_tr__prompt_kernel_s_ec0_ok:
    s_mov_b32 s62, -1
    s_mov_b32 s63, 1
    s_cmp_ge_i32 s62, s63
    s_cbranch_scc1 interleave_layers__linear_attn_block__memory_aug_recurrent_mem_tr__prompt_kernel_s_en0_ok
    s_mov_b32 s61, 0
interleave_layers__linear_attn_block__memory_aug_recurrent_mem_tr__prompt_kernel_s_en0:
    buffer_load_dword v48, v9, s[8:11], 0 offen sc1
    s_waitcnt vmcnt(0)
    v_readlane_b32 s62, v48, 0
    v_readlane_b32 s24, v48, 1
    s_min_i32 s62, s62, s24
    s_cmp_ge_i32 s62, s63
    s_cbranch_scc1 interleave_layers__linear_attn_block__memory_aug_recurrent_mem_tr__prompt_kernel_s_en0_ok
    s_add_u32 s61, s61, 1
    s_cmp_ge_u32 s61, s60
    s_cbranch_scc1 interleave_layers__linear_attn_block__memory_aug_recurrent_mem_tr__prompt_kernel_s_en0_to
    s_sleep 2
    s_branch interleave_layers__linear_attn_block__memory_aug_recurrent_mem_tr__prompt_kernel_s_en0
interleave_layers__linear_attn_block__memory_aug_recurrent_mem_tr__prompt_kernel_s_en0_to:
    s_mov_b32 s60, 1
interleave_layers__linear_attn_block__memory_aug_recurrent_mem_tr__prompt_kernel_s_en0_ok:
    buffer_load_dwordx4 a[240:243], v19, s[8:11], s41 offen offset:0 sc1
    buffer_load_dwordx4 a[244:247], v19, s[8:11], s41 offen offset:1024 sc1
    buffer_load_dwordx4 a[248:251], v19, s[8:11], s41 offen offset:2048 sc1
    s_waitcnt lgkmcnt(0)
    v_mov_b32 v24, 0
    v_mov_b32 v25, 0
    v_mov_b32 v26, 0
    v_mov_b32 v27, 0
    v_mov_b32 v28, 0
    v_mov_b32 v29, 0
    v_mov_b32 v30, 0
    v_mov_b32 v31, 0
    v_mov_b32 v32, 0
    v_mov_b32 v33, 0
    v_mov_b32 v34, 0
    v_mov_b32 v35, 0
    v_mov_b32 v36, 0
    v_mov_b32 v37, 0
    v_mov_b32 v38, 0
    v_mov_b32 v39, 0
    v_mov_b32 v40, 0
    v_mov_b32 v41, 0
    v_mov_b32 v42, 0
    v_mov_b32 v43, 0
    v_mov_b32 v44, 0
    v_mov_b32 v45, 0
    v_mov_b32 v46, 0
    v_mov_b32 v47, 0
    s_barrier
    ds_read_b128 v[84:87], v7
    ds_read_b128 v[88:91], v7 offset:4096
    s_waitcnt vmcnt(0) lgkmcnt(0)
    s_cmp_eq_u32 s3, 0
    s_cbranch_scc1 interleave_layers__linear_attn_block__memory_aug_recurrent_mem_tr__prompt_kernel_s_gow0
    s_cmp_eq_u32 s3, 1
    s_cbranch_scc1 interleave_layers__linear_attn_block__memory_aug_recurrent_mem_tr__prompt_kernel_s_gow1
    s_cmp_eq_u32 s3, 2
    s_cbranch_scc1 interleave_layers__linear_attn_block__memory_aug_recurrent_mem_tr__prompt_kernel_s_gow2
    s_branch interleave_layers__linear_attn_block__memory_aug_recurrent_mem_tr__prompt_kernel_s_gow3
interleave_layers__linear_attn_block__memory_aug_recurrent_mem_tr__prompt_kernel_s_stepw0:
    v_mov_b32 v24, 0
    v_mov_b32 v25, 0
    v_mov_b32 v26, 0
    v_mov_b32 v27, 0
    v_mov_b32 v28, 0
    v_mov_b32 v29, 0
    v_mov_b32 v30, 0
    v_mov_b32 v31, 0
    v_mov_b32 v32, 0
    v_mov_b32 v33, 0
    v_mov_b32 v34, 0
    v_mov_b32 v35, 0
    v_mov_b32 v36, 0
    v_mov_b32 v37, 0
    v_mov_b32 v38, 0
    v_mov_b32 v39, 0
    v_mov_b32 v40, 0
    v_mov_b32 v41, 0
    v_mov_b32 v42, 0
    v_mov_b32 v43, 0
    v_mov_b32 v44, 0
    v_mov_b32 v45, 0
    v_mov_b32 v46, 0
    v_mov_b32 v47, 0
    s_add_u32 s46, s47, 4096
    s_add_u32 s52, s47, 8192
    s_lshl_b32 s95, s92, 6
    s_add_u32 s95, s95, s40
    s_add_u32 s95, s95, 1
    s_cmp_ge_i32 s59, s95
    s_cbranch_scc1 interleave_layers__linear_attn_block__memory_aug_recurrent_mem_tr__prompt_kernel_s_ecw0_ok
    s_and_b32 s24, s2, 7
    s_lshl_b32 s24, s24, 7
    s_add_u32 s24, s24, 23109632
    v_and_b32 v49, 3, v1
    v_lshl_add_u32 v49, v49, 2, s24
    s_mov_b32 s61, 0
interleave_layers__linear_attn_block__memory_aug_recurrent_mem_tr__prompt_kernel_s_ecw0:
    buffer_load_dword v48, v49, s[8:11], 0 offen sc1
    s_waitcnt vmcnt(0)
    v_readlane_b32 s59, v48, 0
    v_readlane_b32 s24, v48, 1
    s_min_i32 s59, s59, s24
    v_readlane_b32 s24, v48, 2
    s_min_i32 s59, s59, s24
    s_cmp_ge_i32 s59, s95
    s_cbranch_scc1 interleave_layers__linear_attn_block__memory_aug_recurrent_mem_tr__prompt_kernel_s_ecw0_ok
    s_add_u32 s61, s61, 1
    s_cmp_ge_u32 s61, s60
    s_cbranch_scc1 interleave_layers__linear_attn_block__memory_aug_recurrent_mem_tr__prompt_kernel_s_ecw0_to
    s_sleep 2
    s_branch interleave_layers__linear_attn_block__memory_aug_recurrent_mem_tr__prompt_kernel_s_ecw0
interleave_layers__linear_attn_block__memory_aug_recurrent_mem_tr__prompt_kernel_s_ecw0_to:
    s_mov_b32 s60, 1
interleave_layers__linear_attn_block__memory_aug_recurrent_mem_tr__prompt_kernel_s_ecw0_ok:
    s_add_u32 s63, s40, 1
    s_cmp_ge_i32 s62, s63
    s_cbranch_scc1 interleave_layers__linear_attn_block__memory_aug_recurrent_mem_tr__prompt_kernel_s_enw0_ok
    s_mov_b32 s61, 0
interleave_layers__linear_attn_block__memory_aug_recurrent_mem_tr__prompt_kernel_s_enw0:
    buffer_load_dword v48, v9, s[8:11], 0 offen sc1
    s_waitcnt vmcnt(0)
    v_readlane_b32 s62, v48, 0
    v_readlane_b32 s24, v48, 1
    s_min_i32 s62, s62, s24
    s_cmp_ge_i32 s62, s63
    s_cbranch_scc1 interleave_layers__linear_attn_block__memory_aug_recurrent_mem_tr__prompt_kernel_s_enw0_ok
    s_add_u32 s61, s61, 1
    s_cmp_ge_u32 s61, s60
    s_cbranch_scc1 interleave_layers__linear_attn_block__memory_aug_recurrent_mem_tr__prompt_kernel_s_enw0_to
    s_sleep 2
    s_branch interleave_layers__linear_attn_block__memory_aug_recurrent_mem_tr__prompt_kernel_s_enw0
interleave_layers__linear_attn_block__memory_aug_recurrent_mem_tr__prompt_kernel_s_enw0_to:
    s_mov_b32 s60, 1
interleave_layers__linear_attn_block__memory_aug_recurrent_mem_tr__prompt_kernel_s_enw0_ok:
    buffer_load_dwordx4 a[240:243], v19, s[8:11], s41 offen offset:0 sc1
    buffer_load_dwordx4 a[244:247], v19, s[8:11], s41 offen offset:1024 sc1
    buffer_load_dwordx4 a[248:251], v19, s[8:11], s41 offen offset:2048 sc1
    s_sleep 5
    s_mov_b64 exec, 1
    s_mov_b32 s61, 0
    v_mov_b32 v83, 0
    buffer_atomic_add v83, v23, s[8:11], s48 offen sc0
    s_sleep 2
    v_mov_b32 v94, 0
    buffer_atomic_add v94, v23, s[8:11], s48 offen sc0
    s_sleep 2
    v_mov_b32 v95, 0
    buffer_atomic_add v95, v23, s[8:11], s48 offen sc0
    s_sleep 2
interleave_layers__linear_attn_block__memory_aug_recurrent_mem_tr__prompt_kernel_s_prw0:
    v_mov_b32 v82, 0
    buffer_atomic_add v82, v23, s[8:11], s48 offen sc0
    s_waitcnt vmcnt(3)
    v_cmp_le_i32 vcc, 9, v83
    s_add_u32 s61, s61, 1
    s_cbranch_vccnz interleave_layers__linear_attn_block__memory_aug_recurrent_mem_tr__prompt_kernel_s_prw0_out
    s_sleep 2
    v_mov_b32 v83, 0
    buffer_atomic_add v83, v23, s[8:11], s48 offen sc0
    s_waitcnt vmcnt(3)
    v_cmp_le_i32 vcc, 9, v94
    s_add_u32 s61, s61, 1
    s_cbranch_vccnz interleave_layers__linear_attn_block__memory_aug_recurrent_mem_tr__prompt_kernel_s_prw0_out
    s_sleep 2
    v_mov_b32 v94, 0
    buffer_atomic_add v94, v23, s[8:11], s48 offen sc0
    s_waitcnt vmcnt(3)
    v_cmp_le_i32 vcc, 9, v95
    s_add_u32 s61, s61, 1
    s_cbranch_vccnz interleave_layers__linear_attn_block__memory_aug_recurrent_mem_tr__prompt_kernel_s_prw0_out
    s_sleep 2
    v_mov_b32 v95, 0
    buffer_atomic_add v95, v23, s[8:11], s48 offen sc0
    s_waitcnt vmcnt(3)
    v_cmp_le_i32 vcc, 9, v82
    s_add_u32 s61, s61, 1
    s_cbranch_vccnz interleave_layers__linear_attn_block__memory_aug_recurrent_mem_tr__prompt_kernel_s_prw0_out
    s_sleep 2
    s_cmp_ge_u32 s61, s60
    s_cbranch_scc0 interleave_layers__linear_attn_block__memory_aug_recurrent_mem_tr__prompt_kernel_s_prw0
    s_mov_b32 s60, 1
interleave_layers__linear_attn_block__memory_aug_recurrent_mem_tr__prompt_kernel_s_prw0_out:
    s_mov_b64 exec, -1
    buffer_load_dwordx4 v[84:87], v7, s[8:11], s47 offen sc1
    buffer_load_dwordx4 v[88:91], v7, s[8:11], s46 offen sc1
    buffer_load_dwordx2 v[92:93], v8, s[8:11], s52 offen sc1
    ds_read_b128 v[48:51], v21 offset:0
    ds_read_b128 v[52:55], v21 offset:16
    ds_read_b128 v[56:59], v21 offset:5632
    ds_read_b128 v[60:63], v21 offset:5648
    ds_read_b128 v[64:67], v21 offset:11264
    ds_read_b128 v[68:71], v21 offset:11280
    ds_read_b128 v[72:75], v21 offset:16896
    ds_read_b128 v[76:79], v21 offset:16912
    s_waitcnt lgkmcnt(4)
    v_pk_add_f32 v[48:49], v[48:49], v[56:57]
    v_pk_add_f32 v[50:51], v[50:51], v[58:59]
    v_pk_add_f32 v[52:53], v[52:53], v[60:61]
    v_pk_add_f32 v[54:55], v[54:55], v[62:63]
    s_waitcnt lgkmcnt(0)
    v_pk_add_f32 v[64:65], v[64:65], v[72:73]
    v_pk_add_f32 v[66:67], v[66:67], v[74:75]
    v_pk_add_f32 v[68:69], v[68:69], v[76:77]
    v_pk_add_f32 v[70:71], v[70:71], v[78:79]
    v_pk_add_f32 v[48:49], v[48:49], v[64:65]
    v_pk_add_f32 v[50:51], v[50:51], v[66:67]
    v_pk_add_f32 v[52:53], v[52:53], v[68:69]
    v_pk_add_f32 v[54:55], v[54:55], v[70:71]
    v_mov_b32 v81, 0xff800000
    v_cndmask_b32 v48, v81, v48, s[64:65]
    v_cndmask_b32 v49, v81, v49, s[66:67]
    v_cndmask_b32 v50, v81, v50, s[68:69]
    v_cndmask_b32 v51, v81, v51, s[70:71]
    v_cndmask_b32 v52, v81, v52, s[72:73]
    v_cndmask_b32 v53, v81, v53, s[74:75]
    v_cndmask_b32 v54, v81, v54, s[76:77]
    v_cndmask_b32 v55, v81, v55, s[78:79]
    v_max3_f32 v80, v48, v49, v50
    v_max3_f32 v80, v80, v51, v52
    v_max3_f32 v80, v80, v53, v54
    v_max_f32 v80, v80, v55
    v_mov_b32 v81, 0xff800000
    v_cndmask_b32 v80, v81, v80, s[50:51]
    s_nop 1
    v_max_f32 v80, v80, v80 quad_perm:[1,0,3,2] row_mask:0xf bank_mask:0xf
    s_nop 1
    v_max_f32 v80, v80, v80 quad_perm:[2,3,0,1] row_mask:0xf bank_mask:0xf
    s_nop 1
    v_max_f32 v80, v80, v80 row_half_mirror row_mask:0xf bank_mask:0xf
    s_mov_b32 s24, 0x3dd53b95
    v_mul_f32 v80, s24, v80
    v_pk_fma_f32 v[48:49], v[48:49], s[24:25], v[80:81] op_sel_hi:[1,0,0] neg_lo:[0,0,1] neg_hi:[0,0,1]
    v_pk_fma_f32 v[50:51], v[50:51], s[24:25], v[80:81] op_sel_hi:[1,0,0] neg_lo:[0,0,1] neg_hi:[0,0,1]
    v_pk_fma_f32 v[52:53], v[52:53], s[24:25], v[80:81] op_sel_hi:[1,0,0] neg_lo:[0,0,1] neg_hi:[0,0,1]
    v_pk_fma_f32 v[54:55], v[54:55], s[24:25], v[80:81] op_sel_hi:[1,0,0] neg_lo:[0,0,1] neg_hi:[0,0,1]
    v_exp_f32 v48, v48
    v_exp_f32 v49, v49
    v_exp_f32 v50, v50
    v_exp_f32 v51, v51
    v_exp_f32 v52, v52
    v_exp_f32 v53, v53
    v_exp_f32 v54, v54
    v_exp_f32 v55, v55
    v_pk_add_f32 v[56:57], v[48:49], v[50:51]
    v_pk_add_f32 v[58:59], v[52:53], v[54:55]
    v_pk_add_f32 v[56:57], v[56:57], v[58:59]
    v_add_f32 v80, v56, v57
    v_cndmask_b32 v80, 0, v80, s[50:51]
    s_nop 1
    v_add_f32 v80, v80, v80 quad_perm:[1,0,3,2] row_mask:0xf bank_mask:0xf
    s_nop 1
    v_add_f32 v80, v80, v80 quad_perm:[2,3,0,1] row_mask:0xf bank_mask:0xf
    s_nop 1
    v_add_f32 v80, v80, v80 row_half_mirror row_mask:0xf bank_mask:0xf
    v_rcp_f32 v80, v80
    s_nop 0
    v_pk_mul_f32 v[48:49], v[48:49], v[80:81] op_sel_hi:[1,0]
    v_pk_mul_f32 v[50:51], v[50:51], v[80:81] op_sel_hi:[1,0]
    v_pk_mul_f32 v[52:53], v[52:53], v[80:81] op_sel_hi:[1,0]
    v_pk_mul_f32 v[54:55], v[54:55], v[80:81] op_sel_hi:[1,0]
    v_cvt_pk_bf16_f32 v56, v48, v49
    v_cvt_pk_bf16_f32 v57, v50, v51
    v_cvt_pk_bf16_f32 v58, v52, v53
    v_cvt_pk_bf16_f32 v59, v54, v55
    v_min_u32 v56, -2, v56
    v_min_u32 v57, -2, v57
    v_min_u32 v58, -2, v58
    v_min_u32 v59, -2, v59
    buffer_store_dwordx4 v[56:59], v22, s[8:11], s42 offen sc1
    s_waitcnt vmcnt(1)
    s_nop 0
    v_max3_u32 v58, v84, v85, v86
    v_max3_u32 v58, v58, v87, v88
    v_max3_u32 v58, v58, v89, v90
    v_max3_u32 v58, v58, v91, v92
    v_max_u32 v58, v58, v93
    v_cmp_eq_u32 vcc, -1, v58
    s_cbranch_vccz interleave_layers__linear_attn_block__memory_aug_recurrent_mem_tr__prompt_kernel_s_pmw0_out
    s_mov_b32 s61, 0
interleave_layers__linear_attn_block__memory_aug_recurrent_mem_tr__prompt_kernel_s_pmw0:
    buffer_load_dwordx4 v[84:87], v7, s[8:11], s47 offen sc1
    buffer_load_dwordx4 v[88:91], v7, s[8:11], s46 offen sc1
    buffer_load_dwordx2 v[92:93], v8, s[8:11], s52 offen sc1
    s_waitcnt vmcnt(0)
    v_max3_u32 v58, v84, v85, v86
    v_max3_u32 v58, v58, v87, v88
    v_max3_u32 v58, v58, v89, v90
    v_max3_u32 v58, v58, v91, v92
    v_max_u32 v58, v58, v93
    v_cmp_eq_u32 vcc, -1, v58
    s_add_u32 s61, s61, 1
    s_cbranch_vccz interleave_layers__linear_attn_block__memory_aug_recurrent_mem_tr__prompt_kernel_s_pmw0_out
    s_cmp_ge_u32 s61, s60
    s_cbranch_scc1 interleave_layers__linear_attn_block__memory_aug_recurrent_mem_tr__prompt_kernel_s_pmw0_to
    s_sleep 1
    s_branch interleave_layers__linear_attn_block__memory_aug_recurrent_mem_tr__prompt_kernel_s_pmw0
interleave_layers__linear_attn_block__memory_aug_recurrent_mem_tr__prompt_kernel_s_pmw0_to:
    s_mov_b32 s60, 1
interleave_layers__linear_attn_block__memory_aug_recurrent_mem_tr__prompt_kernel_s_pmw0_out:
    ds_write_b128 v7, v[84:87]
    ds_write_b128 v7, v[88:91] offset:4096
    ds_write_b64 v8, v[92:93]
interleave_layers__linear_attn_block__memory_aug_recurrent_mem_tr__prompt_kernel_s_gow0:
    ds_read_b128 v[68:71], v6 offset:0
    ds_read_b128 v[72:75], v6 offset:1024
    ds_read_b128 v[76:79], v6 offset:8192
    ds_read_b128 v[80:83], v6 offset:9216
    v_smfmac_f32_16x16x64_bf16 v[24:27], v[84:87], a[0:7], v4
    v_smfmac_f32_16x16x64_bf16 v[28:31], v[84:87], a[80:87], v4
    v_smfmac_f32_16x16x64_bf16 v[32:35], v[84:87], a[160:167], v4
    v_smfmac_f32_16x16x64_bf16 v[40:43], v[84:87], v[96:103], v4
    v_smfmac_f32_16x16x64_bf16 v[44:47], v[84:87], v[176:183], v4
    s_waitcnt lgkmcnt(2)
    v_smfmac_f32_16x16x64_bf16 v[36:39], v[84:87], v[68:75], v4
    ds_read_b128 v[68:71], v6 offset:2048
    ds_read_b128 v[72:75], v6 offset:3072
    s_barrier
    ds_read_b128 v[48:51], v5 offset:1024
    ds_read_b128 v[52:55], v5 offset:2048
    ds_read_b128 v[56:59], v5 offset:3072
    ds_read_b128 v[60:63], v5 offset:5120
    ds_read_b128 v[64:67], v5 offset:6144
    v_smfmac_f32_16x16x64_bf16 v[24:27], v[88:91], a[32:39], v4
    v_smfmac_f32_16x16x64_bf16 v[28:31], v[88:91], a[112:119], v4
    v_smfmac_f32_16x16x64_bf16 v[32:35], v[88:91], a[192:199], v4
    v_smfmac_f32_16x16x64_bf16 v[40:43], v[88:91], v[128:135], v4
    v_smfmac_f32_16x16x64_bf16 v[44:47], v[88:91], v[208:215], v4
    s_waitcnt lgkmcnt(7)
    v_smfmac_f32_16x16x64_bf16 v[36:39], v[88:91], v[76:83], v4
    ds_read_b128 v[76:79], v6 offset:4096
    ds_read_b128 v[80:83], v6 offset:5120
    s_waitcnt lgkmcnt(6)
    v_smfmac_f32_16x16x64_bf16 v[24:27], v[48:51], a[8:15], v4
    v_smfmac_f32_16x16x64_bf16 v[28:31], v[48:51], a[88:95], v4
    v_smfmac_f32_16x16x64_bf16 v[40:43], v[48:51], v[104:111], v4
    v_smfmac_f32_16x16x64_bf16 v[36:39], v[48:51], v[68:75], v4
    ds_read_b128 v[68:71], v6 offset:6144
    ds_read_b128 v[72:75], v6 offset:7168
    ds_read_b128 v[48:51], v5 offset:7168
    s_waitcnt lgkmcnt(8)
    v_smfmac_f32_16x16x64_bf16 v[24:27], v[52:55], a[16:23], v4
    v_smfmac_f32_16x16x64_bf16 v[28:31], v[52:55], a[96:103], v4
    v_smfmac_f32_16x16x64_bf16 v[40:43], v[52:55], v[112:119], v4
    s_waitcnt lgkmcnt(3)
    v_smfmac_f32_16x16x64_bf16 v[36:39], v[52:55], v[76:83], v4
    ds_read_b128 v[76:79], v6 offset:10240
    ds_read_b128 v[80:83], v6 offset:11264
    ds_read_b128 v[52:55], v5 offset:8192
    v_smfmac_f32_16x16x64_bf16 v[24:27], v[56:59], a[24:31], v4
    v_smfmac_f32_16x16x64_bf16 v[28:31], v[56:59], a[104:111], v4
    v_smfmac_f32_16x16x64_bf16 v[40:43], v[56:59], v[120:127], v4
    s_waitcnt lgkmcnt(4)
    v_smfmac_f32_16x16x64_bf16 v[36:39], v[56:59], v[68:75], v4
    ds_read_b128 v[68:71], v6 offset:12288
    ds_read_b128 v[72:75], v6 offset:13312
    ds_read_b128 v[56:59], v5 offset:9216
    v_smfmac_f32_16x16x64_bf16 v[24:27], v[60:63], a[40:47], v4
    v_smfmac_f32_16x16x64_bf16 v[28:31], v[60:63], a[120:127], v4
    v_smfmac_f32_16x16x64_bf16 v[40:43], v[60:63], v[136:143], v4
    s_waitcnt lgkmcnt(4)
    v_smfmac_f32_16x16x64_bf16 v[36:39], v[60:63], v[76:83], v4
    ds_read_b128 v[76:79], v6 offset:14336
    ds_read_b128 v[80:83], v6 offset:15360
    ds_read_b128 v[60:63], v5 offset:1024
    v_smfmac_f32_16x16x64_bf16 v[24:27], v[64:67], a[48:55], v4
    v_smfmac_f32_16x16x64_bf16 v[28:31], v[64:67], a[128:135], v4
    v_smfmac_f32_16x16x64_bf16 v[40:43], v[64:67], v[144:151], v4
    s_waitcnt lgkmcnt(4)
    v_smfmac_f32_16x16x64_bf16 v[36:39], v[64:67], v[68:75], v4
    ds_read_b128 v[68:71], v6 offset:16384
    ds_read_b128 v[72:75], v6 offset:17408
    ds_read_b128 v[64:67], v5 offset:2048
    v_smfmac_f32_16x16x64_bf16 v[24:27], v[48:51], a[56:63], v4
    v_smfmac_f32_16x16x64_bf16 v[28:31], v[48:51], a[136:143], v4
    v_smfmac_f32_16x16x64_bf16 v[40:43], v[48:51], v[152:159], v4
    s_waitcnt lgkmcnt(4)
    v_smfmac_f32_16x16x64_bf16 v[36:39], v[48:51], v[76:83], v4
    ds_read_b128 v[76:79], v6 offset:18432
    ds_read_b128 v[80:83], v6 offset:19456
    ds_read_b128 v[48:51], v5 offset:3072
    v_smfmac_f32_16x16x64_bf16 v[24:27], v[52:55], a[64:71], v4
    v_smfmac_f32_16x16x64_bf16 v[28:31], v[52:55], a[144:151], v4
    v_smfmac_f32_16x16x64_bf16 v[40:43], v[52:55], v[160:167], v4
    s_waitcnt lgkmcnt(4)
    v_smfmac_f32_16x16x64_bf16 v[36:39], v[52:55], v[68:75], v4
    ds_read_b128 v[52:55], v5 offset:5120
    v_smfmac_f32_16x16x64_bf16 v[24:27], v[56:59], a[72:79], v4
    v_smfmac_f32_16x16x64_bf16 v[28:31], v[56:59], a[152:159], v4
    v_smfmac_f32_16x16x64_bf16 v[40:43], v[56:59], v[168:175], v4
    s_waitcnt lgkmcnt(2)
    v_smfmac_f32_16x16x64_bf16 v[36:39], v[56:59], v[76:83], v4
    ds_read_b128 v[56:59], v5 offset:6144
    buffer_load_dwordx4 v[80:83], v19, s[8:11], s45 offen offset:0 sc1
    buffer_load_dwordx4 v[84:87], v19, s[8:11], s45 offen offset:1024 sc1
    buffer_load_dwordx4 v[88:91], v19, s[8:11], s45 offen offset:2048 sc1
    v_smfmac_f32_16x16x64_bf16 v[32:35], v[60:63], a[168:175], v4
    v_smfmac_f32_16x16x64_bf16 v[44:47], v[60:63], v[184:191], v4
    v_permlane32_swap_b32 v28, v40
    v_permlane32_swap_b32 v29, v41
    ds_read_b128 v[60:63], v5 offset:7168
    v_smfmac_f32_16x16x64_bf16 v[32:35], v[64:67], a[176:183], v4
    v_permlane32_swap_b32 v30, v42
    v_permlane32_swap_b32 v31, v43
    v_smfmac_f32_16x16x64_bf16 v[44:47], v[64:67], v[192:199], v4
    v_add_f32 v28, v28, v40
    v_add_f32 v29, v29, v41
    ds_read_b128 v[64:67], v5 offset:8192
    s_waitcnt lgkmcnt(4)
    v_smfmac_f32_16x16x64_bf16 v[32:35], v[48:51], a[184:191], v4
    v_add_f32 v30, v30, v42
    v_add_f32 v31, v31, v43
    v_smfmac_f32_16x16x64_bf16 v[44:47], v[48:51], v[200:207], v4
    v_cvt_pk_bf16_f32 v40, v28, v29
    v_cvt_pk_bf16_f32 v41, v30, v31
    ds_read_b128 v[48:51], v5 offset:9216
    s_waitcnt lgkmcnt(4)
    v_smfmac_f32_16x16x64_bf16 v[32:35], v[52:55], a[200:207], v4
    v_mfma_f32_16x16x16_bf16 v[28:31], v[40:41], v[10:11], 0
    v_permlane32_swap_b32 v24, v36
    v_smfmac_f32_16x16x64_bf16 v[44:47], v[52:55], v[216:223], v4
    v_permlane32_swap_b32 v25, v37
    v_permlane32_swap_b32 v26, v38
    s_waitcnt lgkmcnt(3)
    v_smfmac_f32_16x16x64_bf16 v[32:35], v[56:59], a[208:215], v4
    v_permlane32_swap_b32 v27, v39
    v_add_f32 v24, v24, v36
    v_smfmac_f32_16x16x64_bf16 v[44:47], v[56:59], v[224:231], v4
    v_add_f32 v25, v25, v37
    v_add_f32 v26, v26, v38
    s_waitcnt lgkmcnt(2)
    v_smfmac_f32_16x16x64_bf16 v[32:35], v[60:63], a[216:223], v4
    v_add_f32 v27, v27, v39
    v_cvt_pk_bf16_f32 v36, v24, v25
    v_smfmac_f32_16x16x64_bf16 v[44:47], v[60:63], v[232:239], v4
    v_cvt_pk_bf16_f32 v37, v26, v27
    s_nop 1
    v_mfma_f32_16x16x16_bf16 v[24:27], v[36:37], v[10:11], 0
    s_waitcnt lgkmcnt(1)
    v_smfmac_f32_16x16x64_bf16 v[32:35], v[64:67], a[224:231], v4
    s_nop 5
    v_cvt_pk_bf16_f32 v24, v24, v25
    v_smfmac_f32_16x16x64_bf16 v[44:47], v[64:67], v[240:247], v4
    v_cvt_pk_bf16_f32 v25, v26, v27
    v_cvt_pk_bf16_f32 v26, v28, v29
    s_waitcnt lgkmcnt(0)
    v_smfmac_f32_16x16x64_bf16 v[32:35], v[48:51], a[232:239], v4
    v_cvt_pk_bf16_f32 v27, v30, v31
    s_waitcnt vmcnt(3)
    v_smfmac_f32_16x16x64_bf16 v[44:47], v[48:51], v[248:255], v4
    v_mfma_f32_16x16x32_bf16 v[28:31], a[240:243], v[24:27], 0
    v_mfma_f32_16x16x32_bf16 v[36:39], a[244:247], v[24:27], 0
    v_mfma_f32_16x16x32_bf16 v[40:43], v[24:27], v[24:27], 0
    s_nop 4
    v_permlane32_swap_b32 v32, v44
    v_permlane32_swap_b32 v33, v45
    v_permlane32_swap_b32 v34, v46
    v_permlane32_swap_b32 v35, v47
    v_add_f32 v32, v32, v44
    v_add_f32 v33, v33, v45
    v_add_f32 v34, v34, v46
    v_add_f32 v35, v35, v47
    v_cvt_pk_bf16_f32 v44, v32, v33
    v_cvt_pk_bf16_f32 v45, v34, v35
    s_nop 1
    v_mfma_f32_16x16x16_bf16 v[32:35], v[44:45], v[10:11], 0
    s_nop 7
    v_cvt_pk_bf16_f32 v32, v32, v33
    v_cvt_pk_bf16_f32 v33, v34, v35
    s_nop 1
    v_mfma_f32_16x16x16_bf16 v[28:31], a[248:249], v[32:33], v[28:31]
    v_mfma_f32_16x16x16_bf16 v[36:39], a[250:251], v[32:33], v[36:39]
    v_mfma_f32_16x16x16_bf16 v[40:43], v[32:33], v[32:33], v[40:43]
    s_nop 5
    ds_write_b128 v12, v[28:31]
    ds_write_b128 v12, v[36:39] offset:16
    ds_write_b128 v13, v[40:43]
    buffer_atomic_add v0, v20, s[8:11], s49 offen
    s_waitcnt lgkmcnt(0)
    s_barrier
    ds_read_b128 v[48:51], v14 offset:0
    ds_read_b128 v[52:55], v14 offset:16
    ds_read_b128 v[56:59], v14 offset:1408
    ds_read_b128 v[60:63], v14 offset:1424
    ds_read_b128 v[64:67], v14 offset:2816
    ds_read_b128 v[68:71], v14 offset:2832
    ds_read_b128 v[72:75], v14 offset:4224
    ds_read_b128 v[76:79], v14 offset:4240
    s_waitcnt lgkmcnt(4)
    v_pk_add_f32 v[48:49], v[48:49], v[56:57]
    v_pk_add_f32 v[50:51], v[50:51], v[58:59]
    v_pk_add_f32 v[52:53], v[52:53], v[60:61]
    v_pk_add_f32 v[54:55], v[54:55], v[62:63]
    s_waitcnt lgkmcnt(0)
    v_pk_add_f32 v[64:65], v[64:65], v[72:73]
    v_pk_add_f32 v[66:67], v[66:67], v[74:75]
    v_pk_add_f32 v[68:69], v[68:69], v[76:77]
    v_pk_add_f32 v[70:71], v[70:71], v[78:79]
    v_pk_add_f32 v[48:49], v[48:49], v[64:65]
    v_pk_add_f32 v[50:51], v[50:51], v[66:67]
    v_pk_add_f32 v[52:53], v[52:53], v[68:69]
    v_pk_add_f32 v[54:55], v[54:55], v[70:71]
    v_max3_f32 v92, v48, v49, v50
    v_max3_f32 v92, v92, v51, v52
    v_max3_f32 v92, v92, v53, v54
    v_max_f32 v92, v92, v55
    v_mov_b32 v93, 0xff800000
    v_cndmask_b32 v92, v93, v92, s[50:51]
    s_nop 1
    v_max_f32 v92, v92, v92 quad_perm:[1,0,3,2] row_mask:0xf bank_mask:0xf
    s_nop 1
    v_max_f32 v92, v92, v92 quad_perm:[2,3,0,1] row_mask:0xf bank_mask:0xf
    s_nop 1
    v_max_f32 v92, v92, v92 row_half_mirror row_mask:0xf bank_mask:0xf
    s_mov_b32 s24, 0x3dd53b95
    v_mul_f32 v92, s24, v92
    v_pk_fma_f32 v[48:49], v[48:49], s[24:25], v[92:93] op_sel_hi:[1,0,0] neg_lo:[0,0,1] neg_hi:[0,0,1]
    v_pk_fma_f32 v[50:51], v[50:51], s[24:25], v[92:93] op_sel_hi:[1,0,0] neg_lo:[0,0,1] neg_hi:[0,0,1]
    v_pk_fma_f32 v[52:53], v[52:53], s[24:25], v[92:93] op_sel_hi:[1,0,0] neg_lo:[0,0,1] neg_hi:[0,0,1]
    v_pk_fma_f32 v[54:55], v[54:55], s[24:25], v[92:93] op_sel_hi:[1,0,0] neg_lo:[0,0,1] neg_hi:[0,0,1]
    v_exp_f32 v48, v48
    v_exp_f32 v49, v49
    v_exp_f32 v50, v50
    v_exp_f32 v51, v51
    v_exp_f32 v52, v52
    v_exp_f32 v53, v53
    v_exp_f32 v54, v54
    v_exp_f32 v55, v55
    v_pk_add_f32 v[56:57], v[48:49], v[50:51]
    v_pk_add_f32 v[58:59], v[52:53], v[54:55]
    v_pk_add_f32 v[56:57], v[56:57], v[58:59]
    v_add_f32 v92, v56, v57
    v_cndmask_b32 v92, 0, v92, s[50:51]
    s_nop 1
    v_add_f32 v92, v92, v92 quad_perm:[1,0,3,2] row_mask:0xf bank_mask:0xf
    s_nop 1
    v_add_f32 v92, v92, v92 quad_perm:[2,3,0,1] row_mask:0xf bank_mask:0xf
    s_nop 1
    v_add_f32 v92, v92, v92 row_half_mirror row_mask:0xf bank_mask:0xf
    v_rcp_f32 v92, v92
    s_nop 0
    v_pk_mul_f32 v[48:49], v[48:49], v[92:93] op_sel_hi:[1,0]
    v_pk_mul_f32 v[50:51], v[50:51], v[92:93] op_sel_hi:[1,0]
    v_pk_mul_f32 v[52:53], v[52:53], v[92:93] op_sel_hi:[1,0]
    v_pk_mul_f32 v[54:55], v[54:55], v[92:93] op_sel_hi:[1,0]
    v_cvt_pk_bf16_f32 v56, v48, v49
    v_cvt_pk_bf16_f32 v57, v50, v51
    v_cvt_pk_bf16_f32 v58, v52, v53
    v_cvt_pk_bf16_f32 v59, v54, v55
    v_min_u32 v56, -2, v56
    v_min_u32 v57, -2, v57
    v_min_u32 v58, -2, v58
    v_min_u32 v59, -2, v59
    buffer_store_dwordx4 v[56:59], v15, s[8:11], s43 offen sc1
    s_waitcnt vmcnt(2)
    v_mfma_f32_16x16x32_bf16 v[36:39], a[240:243], v[80:83], 0
    v_mfma_f32_16x16x32_bf16 v[44:47], a[244:247], v[80:83], 0
    v_mfma_f32_16x16x32_bf16 v[68:71], v[24:27], v[80:83], 0
    v_mfma_f32_16x16x32_bf16 v[40:43], a[240:243], v[84:87], 0
    v_mfma_f32_16x16x32_bf16 v[64:67], a[244:247], v[84:87], 0
    v_mfma_f32_16x16x32_bf16 v[72:75], v[24:27], v[84:87], 0
    s_nop 0
    v_mfma_f32_16x16x16_bf16 v[36:39], a[248:249], v[88:89], v[36:39]
    v_mfma_f32_16x16x16_bf16 v[44:47], a[250:251], v[88:89], v[44:47]
    v_mfma_f32_16x16x16_bf16 v[68:71], v[32:33], v[88:89], v[68:71]
    v_mfma_f32_16x16x16_bf16 v[40:43], a[248:249], v[90:91], v[40:43]
    v_mfma_f32_16x16x16_bf16 v[64:67], a[250:251], v[90:91], v[64:67]
    v_mfma_f32_16x16x16_bf16 v[72:75], v[32:33], v[90:91], v[72:75]
    s_nop 2
    ds_write_b128 v16, v[36:39] offset:0
    ds_write_b128 v16, v[44:47] offset:16
    ds_write_b128 v17, v[68:71]
    ds_write_b128 v16, v[40:43] offset:2816
    ds_write_b128 v16, v[64:67] offset:2832
    ds_write_b128 v18, v[72:75]
    s_add_u32 s40, s40, 1
    s_add_u32 s41, s41, 393216
    s_add_u32 s45, s45, 393216
    s_add_u32 s47, s37, 704512
    s_add_u32 s48, s37, 737280
    s_xor_b32 s42, s37, 0x2000
    s_lshl_b32 s24, s40, 12
    s_and_b32 s24, s24, 0x2000
    s_xor_b32 s24, s24, s36
    s_lshl_b32 s37, s40, 20
    s_add_u32 s37, s37, s24
    s_add_u32 s37, s37, 117440512
    s_add_u32 s43, s37, 655360
    s_add_u32 s49, s37, 753664
    s_waitcnt lgkmcnt(0)
    s_barrier
    s_cmp_lt_u32 s40, 64
    s_cbranch_scc1 interleave_layers__linear_attn_block__memory_aug_recurrent_mem_tr__prompt_kernel_s_stepw0
    s_branch interleave_layers__linear_attn_block__memory_aug_recurrent_mem_tr__prompt_kernel_s_end
interleave_layers__linear_attn_block__memory_aug_recurrent_mem_tr__prompt_kernel_s_stepw1:
    v_mov_b32 v24, 0
    v_mov_b32 v25, 0
    v_mov_b32 v26, 0
    v_mov_b32 v27, 0
    v_mov_b32 v28, 0
    v_mov_b32 v29, 0
    v_mov_b32 v30, 0
    v_mov_b32 v31, 0
    v_mov_b32 v32, 0
    v_mov_b32 v33, 0
    v_mov_b32 v34, 0
    v_mov_b32 v35, 0
    v_mov_b32 v36, 0
    v_mov_b32 v37, 0
    v_mov_b32 v38, 0
    v_mov_b32 v39, 0
    v_mov_b32 v40, 0
    v_mov_b32 v41, 0
    v_mov_b32 v42, 0
    v_mov_b32 v43, 0
    v_mov_b32 v44, 0
    v_mov_b32 v45, 0
    v_mov_b32 v46, 0
    v_mov_b32 v47, 0
    s_add_u32 s46, s47, 4096
    s_add_u32 s52, s47, 8192
    s_lshl_b32 s95, s92, 6
    s_add_u32 s95, s95, s40
    s_add_u32 s95, s95, 1
    s_cmp_ge_i32 s59, s95
    s_cbranch_scc1 interleave_layers__linear_attn_block__memory_aug_recurrent_mem_tr__prompt_kernel_s_ecw1_ok
    s_and_b32 s24, s2, 7
    s_lshl_b32 s24, s24, 7
    s_add_u32 s24, s24, 23109632
    v_and_b32 v49, 3, v1
    v_lshl_add_u32 v49, v49, 2, s24
    s_mov_b32 s61, 0
interleave_layers__linear_attn_block__memory_aug_recurrent_mem_tr__prompt_kernel_s_ecw1:
    buffer_load_dword v48, v49, s[8:11], 0 offen sc1
    s_waitcnt vmcnt(0)
    v_readlane_b32 s59, v48, 0
    v_readlane_b32 s24, v48, 1
    s_min_i32 s59, s59, s24
    v_readlane_b32 s24, v48, 2
    s_min_i32 s59, s59, s24
    s_cmp_ge_i32 s59, s95
    s_cbranch_scc1 interleave_layers__linear_attn_block__memory_aug_recurrent_mem_tr__prompt_kernel_s_ecw1_ok
    s_add_u32 s61, s61, 1
    s_cmp_ge_u32 s61, s60
    s_cbranch_scc1 interleave_layers__linear_attn_block__memory_aug_recurrent_mem_tr__prompt_kernel_s_ecw1_to
    s_sleep 2
    s_branch interleave_layers__linear_attn_block__memory_aug_recurrent_mem_tr__prompt_kernel_s_ecw1
interleave_layers__linear_attn_block__memory_aug_recurrent_mem_tr__prompt_kernel_s_ecw1_to:
    s_mov_b32 s60, 1
interleave_layers__linear_attn_block__memory_aug_recurrent_mem_tr__prompt_kernel_s_ecw1_ok:
    s_add_u32 s63, s40, 1
    s_cmp_ge_i32 s62, s63
    s_cbranch_scc1 interleave_layers__linear_attn_block__memory_aug_recurrent_mem_tr__prompt_kernel_s_enw1_ok
    s_mov_b32 s61, 0
interleave_layers__linear_attn_block__memory_aug_recurrent_mem_tr__prompt_kernel_s_enw1:
    buffer_load_dword v48, v9, s[8:11], 0 offen sc1
    s_waitcnt vmcnt(0)
    v_readlane_b32 s62, v48, 0
    v_readlane_b32 s24, v48, 1
    s_min_i32 s62, s62, s24
    s_cmp_ge_i32 s62, s63
    s_cbranch_scc1 interleave_layers__linear_attn_block__memory_aug_recurrent_mem_tr__prompt_kernel_s_enw1_ok
    s_add_u32 s61, s61, 1
    s_cmp_ge_u32 s61, s60
    s_cbranch_scc1 interleave_layers__linear_attn_block__memory_aug_recurrent_mem_tr__prompt_kernel_s_enw1_to
    s_sleep 2
    s_branch interleave_layers__linear_attn_block__memory_aug_recurrent_mem_tr__prompt_kernel_s_enw1
interleave_layers__linear_attn_block__memory_aug_recurrent_mem_tr__prompt_kernel_s_enw1_to:
    s_mov_b32 s60, 1
interleave_layers__linear_attn_block__memory_aug_recurrent_mem_tr__prompt_kernel_s_enw1_ok:
    buffer_load_dwordx4 a[240:243], v19, s[8:11], s41 offen offset:0 sc1
    buffer_load_dwordx4 a[244:247], v19, s[8:11], s41 offen offset:1024 sc1
    buffer_load_dwordx4 a[248:251], v19, s[8:11], s41 offen offset:2048 sc1
    s_sleep 5
    s_mov_b64 exec, 1
    s_mov_b32 s61, 0
    v_mov_b32 v83, 0
    buffer_atomic_add v83, v23, s[8:11], s48 offen sc0
    s_sleep 2
    v_mov_b32 v94, 0
    buffer_atomic_add v94, v23, s[8:11], s48 offen sc0
    s_sleep 2
    v_mov_b32 v95, 0
    buffer_atomic_add v95, v23, s[8:11], s48 offen sc0
    s_sleep 2
interleave_layers__linear_attn_block__memory_aug_recurrent_mem_tr__prompt_kernel_s_prw1:
    v_mov_b32 v82, 0
    buffer_atomic_add v82, v23, s[8:11], s48 offen sc0
    s_waitcnt vmcnt(3)
    v_cmp_le_i32 vcc, 9, v83
    s_add_u32 s61, s61, 1
    s_cbranch_vccnz interleave_layers__linear_attn_block__memory_aug_recurrent_mem_tr__prompt_kernel_s_prw1_out
    s_sleep 2
    v_mov_b32 v83, 0
    buffer_atomic_add v83, v23, s[8:11], s48 offen sc0
    s_waitcnt vmcnt(3)
    v_cmp_le_i32 vcc, 9, v94
    s_add_u32 s61, s61, 1
    s_cbranch_vccnz interleave_layers__linear_attn_block__memory_aug_recurrent_mem_tr__prompt_kernel_s_prw1_out
    s_sleep 2
    v_mov_b32 v94, 0
    buffer_atomic_add v94, v23, s[8:11], s48 offen sc0
    s_waitcnt vmcnt(3)
    v_cmp_le_i32 vcc, 9, v95
    s_add_u32 s61, s61, 1
    s_cbranch_vccnz interleave_layers__linear_attn_block__memory_aug_recurrent_mem_tr__prompt_kernel_s_prw1_out
    s_sleep 2
    v_mov_b32 v95, 0
    buffer_atomic_add v95, v23, s[8:11], s48 offen sc0
    s_waitcnt vmcnt(3)
    v_cmp_le_i32 vcc, 9, v82
    s_add_u32 s61, s61, 1
    s_cbranch_vccnz interleave_layers__linear_attn_block__memory_aug_recurrent_mem_tr__prompt_kernel_s_prw1_out
    s_sleep 2
    s_cmp_ge_u32 s61, s60
    s_cbranch_scc0 interleave_layers__linear_attn_block__memory_aug_recurrent_mem_tr__prompt_kernel_s_prw1
    s_mov_b32 s60, 1
interleave_layers__linear_attn_block__memory_aug_recurrent_mem_tr__prompt_kernel_s_prw1_out:
    s_mov_b64 exec, -1
    buffer_load_dwordx4 v[84:87], v7, s[8:11], s47 offen sc1
    buffer_load_dwordx4 v[88:91], v7, s[8:11], s46 offen sc1
    buffer_load_dwordx2 v[92:93], v8, s[8:11], s52 offen sc1
    ds_read_b128 v[48:51], v21 offset:0
    ds_read_b128 v[52:55], v21 offset:16
    ds_read_b128 v[56:59], v21 offset:5632
    ds_read_b128 v[60:63], v21 offset:5648
    ds_read_b128 v[64:67], v21 offset:11264
    ds_read_b128 v[68:71], v21 offset:11280
    ds_read_b128 v[72:75], v21 offset:16896
    ds_read_b128 v[76:79], v21 offset:16912
    s_waitcnt lgkmcnt(4)
    v_pk_add_f32 v[48:49], v[48:49], v[56:57]
    v_pk_add_f32 v[50:51], v[50:51], v[58:59]
    v_pk_add_f32 v[52:53], v[52:53], v[60:61]
    v_pk_add_f32 v[54:55], v[54:55], v[62:63]
    s_waitcnt lgkmcnt(0)
    v_pk_add_f32 v[64:65], v[64:65], v[72:73]
    v_pk_add_f32 v[66:67], v[66:67], v[74:75]
    v_pk_add_f32 v[68:69], v[68:69], v[76:77]
    v_pk_add_f32 v[70:71], v[70:71], v[78:79]
    v_pk_add_f32 v[48:49], v[48:49], v[64:65]
    v_pk_add_f32 v[50:51], v[50:51], v[66:67]
    v_pk_add_f32 v[52:53], v[52:53], v[68:69]
    v_pk_add_f32 v[54:55], v[54:55], v[70:71]
    v_mov_b32 v81, 0xff800000
    v_cndmask_b32 v48, v81, v48, s[64:65]
    v_cndmask_b32 v49, v81, v49, s[66:67]
    v_cndmask_b32 v50, v81, v50, s[68:69]
    v_cndmask_b32 v51, v81, v51, s[70:71]
    v_cndmask_b32 v52, v81, v52, s[72:73]
    v_cndmask_b32 v53, v81, v53, s[74:75]
    v_cndmask_b32 v54, v81, v54, s[76:77]
    v_cndmask_b32 v55, v81, v55, s[78:79]
    v_max3_f32 v80, v48, v49, v50
    v_max3_f32 v80, v80, v51, v52
    v_max3_f32 v80, v80, v53, v54
    v_max_f32 v80, v80, v55
    v_mov_b32 v81, 0xff800000
    v_cndmask_b32 v80, v81, v80, s[50:51]
    s_nop 1
    v_max_f32 v80, v80, v80 quad_perm:[1,0,3,2] row_mask:0xf bank_mask:0xf
    s_nop 1
    v_max_f32 v80, v80, v80 quad_perm:[2,3,0,1] row_mask:0xf bank_mask:0xf
    s_nop 1
    v_max_f32 v80, v80, v80 row_half_mirror row_mask:0xf bank_mask:0xf
    s_mov_b32 s24, 0x3dd53b95
    v_mul_f32 v80, s24, v80
    v_pk_fma_f32 v[48:49], v[48:49], s[24:25], v[80:81] op_sel_hi:[1,0,0] neg_lo:[0,0,1] neg_hi:[0,0,1]
    v_pk_fma_f32 v[50:51], v[50:51], s[24:25], v[80:81] op_sel_hi:[1,0,0] neg_lo:[0,0,1] neg_hi:[0,0,1]
    v_pk_fma_f32 v[52:53], v[52:53], s[24:25], v[80:81] op_sel_hi:[1,0,0] neg_lo:[0,0,1] neg_hi:[0,0,1]
    v_pk_fma_f32 v[54:55], v[54:55], s[24:25], v[80:81] op_sel_hi:[1,0,0] neg_lo:[0,0,1] neg_hi:[0,0,1]
    v_exp_f32 v48, v48
    v_exp_f32 v49, v49
    v_exp_f32 v50, v50
    v_exp_f32 v51, v51
    v_exp_f32 v52, v52
    v_exp_f32 v53, v53
    v_exp_f32 v54, v54
    v_exp_f32 v55, v55
    v_pk_add_f32 v[56:57], v[48:49], v[50:51]
    v_pk_add_f32 v[58:59], v[52:53], v[54:55]
    v_pk_add_f32 v[56:57], v[56:57], v[58:59]
    v_add_f32 v80, v56, v57
    v_cndmask_b32 v80, 0, v80, s[50:51]
    s_nop 1
    v_add_f32 v80, v80, v80 quad_perm:[1,0,3,2] row_mask:0xf bank_mask:0xf
    s_nop 1
    v_add_f32 v80, v80, v80 quad_perm:[2,3,0,1] row_mask:0xf bank_mask:0xf
    s_nop 1
    v_add_f32 v80, v80, v80 row_half_mirror row_mask:0xf bank_mask:0xf
    v_rcp_f32 v80, v80
    s_nop 0
    v_pk_mul_f32 v[48:49], v[48:49], v[80:81] op_sel_hi:[1,0]
    v_pk_mul_f32 v[50:51], v[50:51], v[80:81] op_sel_hi:[1,0]
    v_pk_mul_f32 v[52:53], v[52:53], v[80:81] op_sel_hi:[1,0]
    v_pk_mul_f32 v[54:55], v[54:55], v[80:81] op_sel_hi:[1,0]
    v_cvt_pk_bf16_f32 v56, v48, v49
    v_cvt_pk_bf16_f32 v57, v50, v51
    v_cvt_pk_bf16_f32 v58, v52, v53
    v_cvt_pk_bf16_f32 v59, v54, v55
    v_min_u32 v56, -2, v56
    v_min_u32 v57, -2, v57
    v_min_u32 v58, -2, v58
    v_min_u32 v59, -2, v59
    buffer_store_dwordx4 v[56:59], v22, s[8:11], s42 offen sc1
    s_waitcnt vmcnt(1)
    s_nop 0
    v_max3_u32 v58, v84, v85, v86
    v_max3_u32 v58, v58, v87, v88
    v_max3_u32 v58, v58, v89, v90
    v_max3_u32 v58, v58, v91, v92
    v_max_u32 v58, v58, v93
    v_cmp_eq_u32 vcc, -1, v58
    s_cbranch_vccz interleave_layers__linear_attn_block__memory_aug_recurrent_mem_tr__prompt_kernel_s_pmw1_out
    s_mov_b32 s61, 0
interleave_layers__linear_attn_block__memory_aug_recurrent_mem_tr__prompt_kernel_s_pmw1:
    buffer_load_dwordx4 v[84:87], v7, s[8:11], s47 offen sc1
    buffer_load_dwordx4 v[88:91], v7, s[8:11], s46 offen sc1
    buffer_load_dwordx2 v[92:93], v8, s[8:11], s52 offen sc1
    s_waitcnt vmcnt(0)
    v_max3_u32 v58, v84, v85, v86
    v_max3_u32 v58, v58, v87, v88
    v_max3_u32 v58, v58, v89, v90
    v_max3_u32 v58, v58, v91, v92
    v_max_u32 v58, v58, v93
    v_cmp_eq_u32 vcc, -1, v58
    s_add_u32 s61, s61, 1
    s_cbranch_vccz interleave_layers__linear_attn_block__memory_aug_recurrent_mem_tr__prompt_kernel_s_pmw1_out
    s_cmp_ge_u32 s61, s60
    s_cbranch_scc1 interleave_layers__linear_attn_block__memory_aug_recurrent_mem_tr__prompt_kernel_s_pmw1_to
    s_sleep 1
    s_branch interleave_layers__linear_attn_block__memory_aug_recurrent_mem_tr__prompt_kernel_s_pmw1
interleave_layers__linear_attn_block__memory_aug_recurrent_mem_tr__prompt_kernel_s_pmw1_to:
    s_mov_b32 s60, 1
interleave_layers__linear_attn_block__memory_aug_recurrent_mem_tr__prompt_kernel_s_pmw1_out:
    ds_write_b128 v7, v[84:87]
    ds_write_b128 v7, v[88:91] offset:4096
    ds_write_b64 v8, v[92:93]
interleave_layers__linear_attn_block__memory_aug_recurrent_mem_tr__prompt_kernel_s_gow1:
    ds_read_b128 v[68:71], v6 offset:2048
    ds_read_b128 v[72:75], v6 offset:3072
    ds_read_b128 v[76:79], v6 offset:10240
    ds_read_b128 v[80:83], v6 offset:11264
    v_smfmac_f32_16x16x64_bf16 v[24:27], v[84:87], a[8:15], v4
    v_smfmac_f32_16x16x64_bf16 v[28:31], v[84:87], a[88:95], v4
    v_smfmac_f32_16x16x64_bf16 v[32:35], v[84:87], a[168:175], v4
    v_smfmac_f32_16x16x64_bf16 v[40:43], v[84:87], v[104:111], v4
    v_smfmac_f32_16x16x64_bf16 v[44:47], v[84:87], v[184:191], v4
    s_waitcnt lgkmcnt(2)
    v_smfmac_f32_16x16x64_bf16 v[36:39], v[84:87], v[68:75], v4
    ds_read_b128 v[68:71], v6 offset:0
    ds_read_b128 v[72:75], v6 offset:1024
    s_barrier
    ds_read_b128 v[48:51], v5 offset:0
    ds_read_b128 v[52:55], v5 offset:2048
    ds_read_b128 v[56:59], v5 offset:3072
    ds_read_b128 v[60:63], v5 offset:4096
    ds_read_b128 v[64:67], v5 offset:6144
    v_smfmac_f32_16x16x64_bf16 v[24:27], v[88:91], a[40:47], v4
    v_smfmac_f32_16x16x64_bf16 v[28:31], v[88:91], a[120:127], v4
    v_smfmac_f32_16x16x64_bf16 v[32:35], v[88:91], a[200:207], v4
    v_smfmac_f32_16x16x64_bf16 v[40:43], v[88:91], v[136:143], v4
    v_smfmac_f32_16x16x64_bf16 v[44:47], v[88:91], v[216:223], v4
    s_waitcnt lgkmcnt(7)
    v_smfmac_f32_16x16x64_bf16 v[36:39], v[88:91], v[76:83], v4
    ds_read_b128 v[76:79], v6 offset:4096
    ds_read_b128 v[80:83], v6 offset:5120
    s_waitcnt lgkmcnt(6)
    v_smfmac_f32_16x16x64_bf16 v[24:27], v[48:51], a[0:7], v4
    v_smfmac_f32_16x16x64_bf16 v[28:31], v[48:51], a[80:87], v4
    v_smfmac_f32_16x16x64_bf16 v[40:43], v[48:51], v[96:103], v4
    v_smfmac_f32_16x16x64_bf16 v[36:39], v[48:51], v[68:75], v4
    ds_read_b128 v[68:71], v6 offset:6144
    ds_read_b128 v[72:75], v6 offset:7168
    ds_read_b128 v[48:51], v5 offset:7168
    s_waitcnt lgkmcnt(8)
    v_smfmac_f32_16x16x64_bf16 v[24:27], v[52:55], a[16:23], v4
    v_smfmac_f32_16x16x64_bf16 v[28:31], v[52:55], a[96:103], v4
    v_smfmac_f32_16x16x64_bf16 v[40:43], v[52:55], v[112:119], v4
    s_waitcnt lgkmcnt(3)
    v_smfmac_f32_16x16x64_bf16 v[36:39], v[52:55], v[76:83], v4
    ds_read_b128 v[76:79], v6 offset:8192
    ds_read_b128 v[80:83], v6 offset:9216
    ds_read_b128 v[52:55], v5 offset:8192
    v_smfmac_f32_16x16x64_bf16 v[24:27], v[56:59], a[24:31], v4
    v_smfmac_f32_16x16x64_bf16 v[28:31], v[56:59], a[104:111], v4
    v_smfmac_f32_16x16x64_bf16 v[40:43], v[56:59], v[120:127], v4
    s_waitcnt lgkmcnt(4)
    v_smfmac_f32_16x16x64_bf16 v[36:39], v[56:59], v[68:75], v4
    ds_read_b128 v[68:71], v6 offset:12288
    ds_read_b128 v[72:75], v6 offset:13312
    ds_read_b128 v[56:59], v5 offset:9216
    v_smfmac_f32_16x16x64_bf16 v[24:27], v[60:63], a[32:39], v4
    v_smfmac_f32_16x16x64_bf16 v[28:31], v[60:63], a[112:119], v4
    v_smfmac_f32_16x16x64_bf16 v[40:43], v[60:63], v[128:135], v4
    s_waitcnt lgkmcnt(4)
    v_smfmac_f32_16x16x64_bf16 v[36:39], v[60:63], v[76:83], v4
    ds_read_b128 v[76:79], v6 offset:14336
    ds_read_b128 v[80:83], v6 offset:15360
    ds_read_b128 v[60:63], v5 offset:0
    v_smfmac_f32_16x16x64_bf16 v[24:27], v[64:67], a[48:55], v4
    v_smfmac_f32_16x16x64_bf16 v[28:31], v[64:67], a[128:135], v4
    v_smfmac_f32_16x16x64_bf16 v[40:43], v[64:67], v[144:151], v4
    s_waitcnt lgkmcnt(4)
    v_smfmac_f32_16x16x64_bf16 v[36:39], v[64:67], v[68:75], v4
    ds_read_b128 v[68:71], v6 offset:16384
    ds_read_b128 v[72:75], v6 offset:17408
    ds_read_b128 v[64:67], v5 offset:2048
    v_smfmac_f32_16x16x64_bf16 v[24:27], v[48:51], a[56:63], v4
    v_smfmac_f32_16x16x64_bf16 v[28:31], v[48:51], a[136:143], v4
    v_smfmac_f32_16x16x64_bf16 v[40:43], v[48:51], v[152:159], v4
    s_waitcnt lgkmcnt(4)
    v_smfmac_f32_16x16x64_bf16 v[36:39], v[48:51], v[76:83], v4
    ds_read_b128 v[76:79], v6 offset:18432
    ds_read_b128 v[80:83], v6 offset:19456
    ds_read_b128 v[48:51], v5 offset:3072
    v_smfmac_f32_16x16x64_bf16 v[24:27], v[52:55], a[64:71], v4
    v_smfmac_f32_16x16x64_bf16 v[28:31], v[52:55], a[144:151], v4
    v_smfmac_f32_16x16x64_bf16 v[40:43], v[52:55], v[160:167], v4
    s_waitcnt lgkmcnt(4)
    v_smfmac_f32_16x16x64_bf16 v[36:39], v[52:55], v[68:75], v4
    ds_read_b128 v[52:55], v5 offset:4096
    v_smfmac_f32_16x16x64_bf16 v[24:27], v[56:59], a[72:79], v4
    v_smfmac_f32_16x16x64_bf16 v[28:31], v[56:59], a[152:159], v4
    v_smfmac_f32_16x16x64_bf16 v[40:43], v[56:59], v[168:175], v4
    s_waitcnt lgkmcnt(2)
    v_smfmac_f32_16x16x64_bf16 v[36:39], v[56:59], v[76:83], v4
    ds_read_b128 v[56:59], v5 offset:6144
    buffer_load_dwordx4 v[80:83], v19, s[8:11], s45 offen offset:0 sc1
    buffer_load_dwordx4 v[84:87], v19, s[8:11], s45 offen offset:1024 sc1
    buffer_load_dwordx4 v[88:91], v19, s[8:11], s45 offen offset:2048 sc1
    v_smfmac_f32_16x16x64_bf16 v[32:35], v[60:63], a[160:167], v4
    v_smfmac_f32_16x16x64_bf16 v[44:47], v[60:63], v[176:183], v4
    v_permlane32_swap_b32 v28, v40
    v_permlane32_swap_b32 v29, v41
    ds_read_b128 v[60:63], v5 offset:7168
    v_smfmac_f32_16x16x64_bf16 v[32:35], v[64:67], a[176:183], v4
    v_permlane32_swap_b32 v30, v42
    v_permlane32_swap_b32 v31, v43
    v_smfmac_f32_16x16x64_bf16 v[44:47], v[64:67], v[192:199], v4
    v_add_f32 v28, v28, v40
    v_add_f32 v29, v29, v41
    ds_read_b128 v[64:67], v5 offset:8192
    s_waitcnt lgkmcnt(4)
    v_smfmac_f32_16x16x64_bf16 v[32:35], v[48:51], a[184:191], v4
    v_add_f32 v30, v30, v42
    v_add_f32 v31, v31, v43
    v_smfmac_f32_16x16x64_bf16 v[44:47], v[48:51], v[200:207], v4
    v_cvt_pk_bf16_f32 v40, v28, v29
    v_cvt_pk_bf16_f32 v41, v30, v31
    ds_read_b128 v[48:51], v5 offset:9216
    s_waitcnt lgkmcnt(4)
    v_smfmac_f32_16x16x64_bf16 v[32:35], v[52:55], a[192:199], v4
    v_mfma_f32_16x16x16_bf16 v[28:31], v[40:41], v[10:11], 0
    v_permlane32_swap_b32 v24, v36
    v_smfmac_f32_16x16x64_bf16 v[44:47], v[52:55], v[208:215], v4
    v_permlane32_swap_b32 v25, v37
    v_permlane32_swap_b32 v26, v38
    s_waitcnt lgkmcnt(3)
    v_smfmac_f32_16x16x64_bf16 v[32:35], v[56:59], a[208:215], v4
    v_permlane32_swap_b32 v27, v39
    v_add_f32 v24, v24, v36
    v_smfmac_f32_16x16x64_bf16 v[44:47], v[56:59], v[224:231], v4
    v_add_f32 v25, v25, v37
    v_add_f32 v26, v26, v38
    s_waitcnt lgkmcnt(2)
    v_smfmac_f32_16x16x64_bf16 v[32:35], v[60:63], a[216:223], v4
    v_add_f32 v27, v27, v39
    v_cvt_pk_bf16_f32 v36, v24, v25
    v_smfmac_f32_16x16x64_bf16 v[44:47], v[60:63], v[232:239], v4
    v_cvt_pk_bf16_f32 v37, v26, v27
    s_nop 1
    v_mfma_f32_16x16x16_bf16 v[24:27], v[36:37], v[10:11], 0
    s_waitcnt lgkmcnt(1)
    v_smfmac_f32_16x16x64_bf16 v[32:35], v[64:67], a[224:231], v4
    s_nop 5
    v_cvt_pk_bf16_f32 v24, v24, v25
    v_smfmac_f32_16x16x64_bf16 v[44:47], v[64:67], v[240:247], v4
    v_cvt_pk_bf16_f32 v25, v26, v27
    v_cvt_pk_bf16_f32 v26, v28, v29
    s_waitcnt lgkmcnt(0)
    v_smfmac_f32_16x16x64_bf16 v[32:35], v[48:51], a[232:239], v4
    v_cvt_pk_bf16_f32 v27, v30, v31
    s_waitcnt vmcnt(3)
    v_smfmac_f32_16x16x64_bf16 v[44:47], v[48:51], v[248:255], v4
    v_mfma_f32_16x16x32_bf16 v[28:31], a[240:243], v[24:27], 0
    v_mfma_f32_16x16x32_bf16 v[36:39], a[244:247], v[24:27], 0
    v_mfma_f32_16x16x32_bf16 v[40:43], v[24:27], v[24:27], 0
    s_nop 4
    v_permlane32_swap_b32 v32, v44
    v_permlane32_swap_b32 v33, v45
    v_permlane32_swap_b32 v34, v46
    v_permlane32_swap_b32 v35, v47
    v_add_f32 v32, v32, v44
    v_add_f32 v33, v33, v45
    v_add_f32 v34, v34, v46
    v_add_f32 v35, v35, v47
    v_cvt_pk_bf16_f32 v44, v32, v33
    v_cvt_pk_bf16_f32 v45, v34, v35
    s_nop 1
    v_mfma_f32_16x16x16_bf16 v[32:35], v[44:45], v[10:11], 0
    s_nop 7
    v_cvt_pk_bf16_f32 v32, v32, v33
    v_cvt_pk_bf16_f32 v33, v34, v35
    s_nop 1
    v_mfma_f32_16x16x16_bf16 v[28:31], a[248:249], v[32:33], v[28:31]
    v_mfma_f32_16x16x16_bf16 v[36:39], a[250:251], v[32:33], v[36:39]
    v_mfma_f32_16x16x16_bf16 v[40:43], v[32:33], v[32:33], v[40:43]
    s_nop 5
    ds_write_b128 v12, v[28:31]
    ds_write_b128 v12, v[36:39] offset:16
    ds_write_b128 v13, v[40:43]
    s_waitcnt lgkmcnt(0)
    s_barrier
    s_waitcnt vmcnt(0)
    v_mfma_f32_16x16x32_bf16 v[36:39], a[240:243], v[80:83], 0
    v_mfma_f32_16x16x32_bf16 v[44:47], a[244:247], v[80:83], 0
    v_mfma_f32_16x16x32_bf16 v[68:71], v[24:27], v[80:83], 0
    v_mfma_f32_16x16x32_bf16 v[40:43], a[240:243], v[84:87], 0
    v_mfma_f32_16x16x32_bf16 v[64:67], a[244:247], v[84:87], 0
    v_mfma_f32_16x16x32_bf16 v[72:75], v[24:27], v[84:87], 0
    s_nop 0
    v_mfma_f32_16x16x16_bf16 v[36:39], a[248:249], v[88:89], v[36:39]
    v_mfma_f32_16x16x16_bf16 v[44:47], a[250:251], v[88:89], v[44:47]
    v_mfma_f32_16x16x16_bf16 v[68:71], v[32:33], v[88:89], v[68:71]
    v_mfma_f32_16x16x16_bf16 v[40:43], a[248:249], v[90:91], v[40:43]
    v_mfma_f32_16x16x16_bf16 v[64:67], a[250:251], v[90:91], v[64:67]
    v_mfma_f32_16x16x16_bf16 v[72:75], v[32:33], v[90:91], v[72:75]
    s_nop 2
    ds_write_b128 v16, v[36:39] offset:0
    ds_write_b128 v16, v[44:47] offset:16
    ds_write_b128 v17, v[68:71]
    ds_write_b128 v16, v[40:43] offset:2816
    ds_write_b128 v16, v[64:67] offset:2832
    ds_write_b128 v18, v[72:75]
    s_add_u32 s40, s40, 1
    s_add_u32 s41, s41, 393216
    s_add_u32 s45, s45, 393216
    s_add_u32 s47, s37, 704512
    s_add_u32 s48, s37, 737280
    s_xor_b32 s42, s37, 0x2000
    s_lshl_b32 s24, s40, 12
    s_and_b32 s24, s24, 0x2000
    s_xor_b32 s24, s24, s36
    s_lshl_b32 s37, s40, 20
    s_add_u32 s37, s37, s24
    s_add_u32 s37, s37, 117440512
    s_add_u32 s43, s37, 655360
    s_add_u32 s49, s37, 753664
    s_waitcnt lgkmcnt(0)
    s_barrier
    s_cmp_lt_u32 s40, 64
    s_cbranch_scc1 interleave_layers__linear_attn_block__memory_aug_recurrent_mem_tr__prompt_kernel_s_stepw1
    s_branch interleave_layers__linear_attn_block__memory_aug_recurrent_mem_tr__prompt_kernel_s_end
interleave_layers__linear_attn_block__memory_aug_recurrent_mem_tr__prompt_kernel_s_stepw2:
    v_mov_b32 v24, 0
    v_mov_b32 v25, 0
    v_mov_b32 v26, 0
    v_mov_b32 v27, 0
    v_mov_b32 v28, 0
    v_mov_b32 v29, 0
    v_mov_b32 v30, 0
    v_mov_b32 v31, 0
    v_mov_b32 v32, 0
    v_mov_b32 v33, 0
    v_mov_b32 v34, 0
    v_mov_b32 v35, 0
    v_mov_b32 v36, 0
    v_mov_b32 v37, 0
    v_mov_b32 v38, 0
    v_mov_b32 v39, 0
    v_mov_b32 v40, 0
    v_mov_b32 v41, 0
    v_mov_b32 v42, 0
    v_mov_b32 v43, 0
    v_mov_b32 v44, 0
    v_mov_b32 v45, 0
    v_mov_b32 v46, 0
    v_mov_b32 v47, 0
    s_add_u32 s46, s47, 4096
    s_add_u32 s52, s47, 8192
    s_lshl_b32 s95, s92, 6
    s_add_u32 s95, s95, s40
    s_add_u32 s95, s95, 1
    s_cmp_ge_i32 s59, s95
    s_cbranch_scc1 interleave_layers__linear_attn_block__memory_aug_recurrent_mem_tr__prompt_kernel_s_ecw2_ok
    s_and_b32 s24, s2, 7
    s_lshl_b32 s24, s24, 7
    s_add_u32 s24, s24, 23109632
    v_and_b32 v49, 3, v1
    v_lshl_add_u32 v49, v49, 2, s24
    s_mov_b32 s61, 0
interleave_layers__linear_attn_block__memory_aug_recurrent_mem_tr__prompt_kernel_s_ecw2:
    buffer_load_dword v48, v49, s[8:11], 0 offen sc1
    s_waitcnt vmcnt(0)
    v_readlane_b32 s59, v48, 0
    v_readlane_b32 s24, v48, 1
    s_min_i32 s59, s59, s24
    v_readlane_b32 s24, v48, 2
    s_min_i32 s59, s59, s24
    s_cmp_ge_i32 s59, s95
    s_cbranch_scc1 interleave_layers__linear_attn_block__memory_aug_recurrent_mem_tr__prompt_kernel_s_ecw2_ok
    s_add_u32 s61, s61, 1
    s_cmp_ge_u32 s61, s60
    s_cbranch_scc1 interleave_layers__linear_attn_block__memory_aug_recurrent_mem_tr__prompt_kernel_s_ecw2_to
    s_sleep 2
    s_branch interleave_layers__linear_attn_block__memory_aug_recurrent_mem_tr__prompt_kernel_s_ecw2
interleave_layers__linear_attn_block__memory_aug_recurrent_mem_tr__prompt_kernel_s_ecw2_to:
    s_mov_b32 s60, 1
interleave_layers__linear_attn_block__memory_aug_recurrent_mem_tr__prompt_kernel_s_ecw2_ok:
    s_add_u32 s63, s40, 1
    s_cmp_ge_i32 s62, s63
    s_cbranch_scc1 interleave_layers__linear_attn_block__memory_aug_recurrent_mem_tr__prompt_kernel_s_enw2_ok
    s_mov_b32 s61, 0
interleave_layers__linear_attn_block__memory_aug_recurrent_mem_tr__prompt_kernel_s_enw2:
    buffer_load_dword v48, v9, s[8:11], 0 offen sc1
    s_waitcnt vmcnt(0)
    v_readlane_b32 s62, v48, 0
    v_readlane_b32 s24, v48, 1
    s_min_i32 s62, s62, s24
    s_cmp_ge_i32 s62, s63
    s_cbranch_scc1 interleave_layers__linear_attn_block__memory_aug_recurrent_mem_tr__prompt_kernel_s_enw2_ok
    s_add_u32 s61, s61, 1
    s_cmp_ge_u32 s61, s60
    s_cbranch_scc1 interleave_layers__linear_attn_block__memory_aug_recurrent_mem_tr__prompt_kernel_s_enw2_to
    s_sleep 2
    s_branch interleave_layers__linear_attn_block__memory_aug_recurrent_mem_tr__prompt_kernel_s_enw2
interleave_layers__linear_attn_block__memory_aug_recurrent_mem_tr__prompt_kernel_s_enw2_to:
    s_mov_b32 s60, 1
interleave_layers__linear_attn_block__memory_aug_recurrent_mem_tr__prompt_kernel_s_enw2_ok:
    buffer_load_dwordx4 a[240:243], v19, s[8:11], s41 offen offset:0 sc1
    buffer_load_dwordx4 a[244:247], v19, s[8:11], s41 offen offset:1024 sc1
    buffer_load_dwordx4 a[248:251], v19, s[8:11], s41 offen offset:2048 sc1
    s_sleep 5
    s_mov_b64 exec, 1
    s_mov_b32 s61, 0
    v_mov_b32 v83, 0
    buffer_atomic_add v83, v23, s[8:11], s48 offen sc0
    s_sleep 2
    v_mov_b32 v94, 0
    buffer_atomic_add v94, v23, s[8:11], s48 offen sc0
    s_sleep 2
    v_mov_b32 v95, 0
    buffer_atomic_add v95, v23, s[8:11], s48 offen sc0
    s_sleep 2
interleave_layers__linear_attn_block__memory_aug_recurrent_mem_tr__prompt_kernel_s_prw2:
    v_mov_b32 v82, 0
    buffer_atomic_add v82, v23, s[8:11], s48 offen sc0
    s_waitcnt vmcnt(3)
    v_cmp_le_i32 vcc, 9, v83
    s_add_u32 s61, s61, 1
    s_cbranch_vccnz interleave_layers__linear_attn_block__memory_aug_recurrent_mem_tr__prompt_kernel_s_prw2_out
    s_sleep 2
    v_mov_b32 v83, 0
    buffer_atomic_add v83, v23, s[8:11], s48 offen sc0
    s_waitcnt vmcnt(3)
    v_cmp_le_i32 vcc, 9, v94
    s_add_u32 s61, s61, 1
    s_cbranch_vccnz interleave_layers__linear_attn_block__memory_aug_recurrent_mem_tr__prompt_kernel_s_prw2_out
    s_sleep 2
    v_mov_b32 v94, 0
    buffer_atomic_add v94, v23, s[8:11], s48 offen sc0
    s_waitcnt vmcnt(3)
    v_cmp_le_i32 vcc, 9, v95
    s_add_u32 s61, s61, 1
    s_cbranch_vccnz interleave_layers__linear_attn_block__memory_aug_recurrent_mem_tr__prompt_kernel_s_prw2_out
    s_sleep 2
    v_mov_b32 v95, 0
    buffer_atomic_add v95, v23, s[8:11], s48 offen sc0
    s_waitcnt vmcnt(3)
    v_cmp_le_i32 vcc, 9, v82
    s_add_u32 s61, s61, 1
    s_cbranch_vccnz interleave_layers__linear_attn_block__memory_aug_recurrent_mem_tr__prompt_kernel_s_prw2_out
    s_sleep 2
    s_cmp_ge_u32 s61, s60
    s_cbranch_scc0 interleave_layers__linear_attn_block__memory_aug_recurrent_mem_tr__prompt_kernel_s_prw2
    s_mov_b32 s60, 1
interleave_layers__linear_attn_block__memory_aug_recurrent_mem_tr__prompt_kernel_s_prw2_out:
    s_mov_b64 exec, -1
    buffer_load_dwordx4 v[84:87], v7, s[8:11], s47 offen sc1
    buffer_load_dwordx4 v[88:91], v7, s[8:11], s46 offen sc1
    buffer_load_dwordx2 v[92:93], v8, s[8:11], s52 offen sc1
    ds_read_b128 v[48:51], v21 offset:0
    ds_read_b128 v[52:55], v21 offset:16
    ds_read_b128 v[56:59], v21 offset:5632
    ds_read_b128 v[60:63], v21 offset:5648
    ds_read_b128 v[64:67], v21 offset:11264
    ds_read_b128 v[68:71], v21 offset:11280
    ds_read_b128 v[72:75], v21 offset:16896
    ds_read_b128 v[76:79], v21 offset:16912
    s_waitcnt lgkmcnt(4)
    v_pk_add_f32 v[48:49], v[48:49], v[56:57]
    v_pk_add_f32 v[50:51], v[50:51], v[58:59]
    v_pk_add_f32 v[52:53], v[52:53], v[60:61]
    v_pk_add_f32 v[54:55], v[54:55], v[62:63]
    s_waitcnt lgkmcnt(0)
    v_pk_add_f32 v[64:65], v[64:65], v[72:73]
    v_pk_add_f32 v[66:67], v[66:67], v[74:75]
    v_pk_add_f32 v[68:69], v[68:69], v[76:77]
    v_pk_add_f32 v[70:71], v[70:71], v[78:79]
    v_pk_add_f32 v[48:49], v[48:49], v[64:65]
    v_pk_add_f32 v[50:51], v[50:51], v[66:67]
    v_pk_add_f32 v[52:53], v[52:53], v[68:69]
    v_pk_add_f32 v[54:55], v[54:55], v[70:71]
    v_mov_b32 v81, 0xff800000
    v_cndmask_b32 v48, v81, v48, s[64:65]
    v_cndmask_b32 v49, v81, v49, s[66:67]
    v_cndmask_b32 v50, v81, v50, s[68:69]
    v_cndmask_b32 v51, v81, v51, s[70:71]
    v_cndmask_b32 v52, v81, v52, s[72:73]
    v_cndmask_b32 v53, v81, v53, s[74:75]
    v_cndmask_b32 v54, v81, v54, s[76:77]
    v_cndmask_b32 v55, v81, v55, s[78:79]
    v_max3_f32 v80, v48, v49, v50
    v_max3_f32 v80, v80, v51, v52
    v_max3_f32 v80, v80, v53, v54
    v_max_f32 v80, v80, v55
    v_mov_b32 v81, 0xff800000
    v_cndmask_b32 v80, v81, v80, s[50:51]
    s_nop 1
    v_max_f32 v80, v80, v80 quad_perm:[1,0,3,2] row_mask:0xf bank_mask:0xf
    s_nop 1
    v_max_f32 v80, v80, v80 quad_perm:[2,3,0,1] row_mask:0xf bank_mask:0xf
    s_nop 1
    v_max_f32 v80, v80, v80 row_half_mirror row_mask:0xf bank_mask:0xf
    s_mov_b32 s24, 0x3dd53b95
    v_mul_f32 v80, s24, v80
    v_pk_fma_f32 v[48:49], v[48:49], s[24:25], v[80:81] op_sel_hi:[1,0,0] neg_lo:[0,0,1] neg_hi:[0,0,1]
    v_pk_fma_f32 v[50:51], v[50:51], s[24:25], v[80:81] op_sel_hi:[1,0,0] neg_lo:[0,0,1] neg_hi:[0,0,1]
    v_pk_fma_f32 v[52:53], v[52:53], s[24:25], v[80:81] op_sel_hi:[1,0,0] neg_lo:[0,0,1] neg_hi:[0,0,1]
    v_pk_fma_f32 v[54:55], v[54:55], s[24:25], v[80:81] op_sel_hi:[1,0,0] neg_lo:[0,0,1] neg_hi:[0,0,1]
    v_exp_f32 v48, v48
    v_exp_f32 v49, v49
    v_exp_f32 v50, v50
    v_exp_f32 v51, v51
    v_exp_f32 v52, v52
    v_exp_f32 v53, v53
    v_exp_f32 v54, v54
    v_exp_f32 v55, v55
    v_pk_add_f32 v[56:57], v[48:49], v[50:51]
    v_pk_add_f32 v[58:59], v[52:53], v[54:55]
    v_pk_add_f32 v[56:57], v[56:57], v[58:59]
    v_add_f32 v80, v56, v57
    v_cndmask_b32 v80, 0, v80, s[50:51]
    s_nop 1
    v_add_f32 v80, v80, v80 quad_perm:[1,0,3,2] row_mask:0xf bank_mask:0xf
    s_nop 1
    v_add_f32 v80, v80, v80 quad_perm:[2,3,0,1] row_mask:0xf bank_mask:0xf
    s_nop 1
    v_add_f32 v80, v80, v80 row_half_mirror row_mask:0xf bank_mask:0xf
    v_rcp_f32 v80, v80
    s_nop 0
    v_pk_mul_f32 v[48:49], v[48:49], v[80:81] op_sel_hi:[1,0]
    v_pk_mul_f32 v[50:51], v[50:51], v[80:81] op_sel_hi:[1,0]
    v_pk_mul_f32 v[52:53], v[52:53], v[80:81] op_sel_hi:[1,0]
    v_pk_mul_f32 v[54:55], v[54:55], v[80:81] op_sel_hi:[1,0]
    v_cvt_pk_bf16_f32 v56, v48, v49
    v_cvt_pk_bf16_f32 v57, v50, v51
    v_cvt_pk_bf16_f32 v58, v52, v53
    v_cvt_pk_bf16_f32 v59, v54, v55
    v_min_u32 v56, -2, v56
    v_min_u32 v57, -2, v57
    v_min_u32 v58, -2, v58
    v_min_u32 v59, -2, v59
    buffer_store_dwordx4 v[56:59], v22, s[8:11], s42 offen sc1
    s_waitcnt vmcnt(1)
    s_nop 0
    v_max3_u32 v58, v84, v85, v86
    v_max3_u32 v58, v58, v87, v88
    v_max3_u32 v58, v58, v89, v90
    v_max3_u32 v58, v58, v91, v92
    v_max_u32 v58, v58, v93
    v_cmp_eq_u32 vcc, -1, v58
    s_cbranch_vccz interleave_layers__linear_attn_block__memory_aug_recurrent_mem_tr__prompt_kernel_s_pmw2_out
    s_mov_b32 s61, 0
interleave_layers__linear_attn_block__memory_aug_recurrent_mem_tr__prompt_kernel_s_pmw2:
    buffer_load_dwordx4 v[84:87], v7, s[8:11], s47 offen sc1
    buffer_load_dwordx4 v[88:91], v7, s[8:11], s46 offen sc1
    buffer_load_dwordx2 v[92:93], v8, s[8:11], s52 offen sc1
    s_waitcnt vmcnt(0)
    v_max3_u32 v58, v84, v85, v86
    v_max3_u32 v58, v58, v87, v88
    v_max3_u32 v58, v58, v89, v90
    v_max3_u32 v58, v58, v91, v92
    v_max_u32 v58, v58, v93
    v_cmp_eq_u32 vcc, -1, v58
    s_add_u32 s61, s61, 1
    s_cbranch_vccz interleave_layers__linear_attn_block__memory_aug_recurrent_mem_tr__prompt_kernel_s_pmw2_out
    s_cmp_ge_u32 s61, s60
    s_cbranch_scc1 interleave_layers__linear_attn_block__memory_aug_recurrent_mem_tr__prompt_kernel_s_pmw2_to
    s_sleep 1
    s_branch interleave_layers__linear_attn_block__memory_aug_recurrent_mem_tr__prompt_kernel_s_pmw2
interleave_layers__linear_attn_block__memory_aug_recurrent_mem_tr__prompt_kernel_s_pmw2_to:
    s_mov_b32 s60, 1
interleave_layers__linear_attn_block__memory_aug_recurrent_mem_tr__prompt_kernel_s_pmw2_out:
    ds_write_b128 v7, v[84:87]
    ds_write_b128 v7, v[88:91] offset:4096
    ds_write_b64 v8, v[92:93]
interleave_layers__linear_attn_block__memory_aug_recurrent_mem_tr__prompt_kernel_s_gow2:
    ds_read_b128 v[68:71], v6 offset:4096
    ds_read_b128 v[72:75], v6 offset:5120
    ds_read_b128 v[76:79], v6 offset:12288
    ds_read_b128 v[80:83], v6 offset:13312
    v_smfmac_f32_16x16x64_bf16 v[24:27], v[84:87], a[16:23], v4
    v_smfmac_f32_16x16x64_bf16 v[28:31], v[84:87], a[96:103], v4
    v_smfmac_f32_16x16x64_bf16 v[32:35], v[84:87], a[176:183], v4
    v_smfmac_f32_16x16x64_bf16 v[40:43], v[84:87], v[112:119], v4
    v_smfmac_f32_16x16x64_bf16 v[44:47], v[84:87], v[192:199], v4
    s_waitcnt lgkmcnt(2)
    v_smfmac_f32_16x16x64_bf16 v[36:39], v[84:87], v[68:75], v4
    ds_read_b128 v[68:71], v6 offset:0
    ds_read_b128 v[72:75], v6 offset:1024
    s_barrier
    ds_read_b128 v[48:51], v5 offset:0
    ds_read_b128 v[52:55], v5 offset:1024
    ds_read_b128 v[56:59], v5 offset:3072
    ds_read_b128 v[60:63], v5 offset:4096
    ds_read_b128 v[64:67], v5 offset:5120
    v_smfmac_f32_16x16x64_bf16 v[24:27], v[88:91], a[48:55], v4
    v_smfmac_f32_16x16x64_bf16 v[28:31], v[88:91], a[128:135], v4
    v_smfmac_f32_16x16x64_bf16 v[32:35], v[88:91], a[208:215], v4
    v_smfmac_f32_16x16x64_bf16 v[40:43], v[88:91], v[144:151], v4
    v_smfmac_f32_16x16x64_bf16 v[44:47], v[88:91], v[224:231], v4
    s_waitcnt lgkmcnt(7)
    v_smfmac_f32_16x16x64_bf16 v[36:39], v[88:91], v[76:83], v4
    ds_read_b128 v[76:79], v6 offset:2048
    ds_read_b128 v[80:83], v6 offset:3072
    s_waitcnt lgkmcnt(6)
    v_smfmac_f32_16x16x64_bf16 v[24:27], v[48:51], a[0:7], v4
    v_smfmac_f32_16x16x64_bf16 v[28:31], v[48:51], a[80:87], v4
    v_smfmac_f32_16x16x64_bf16 v[40:43], v[48:51], v[96:103], v4
    v_smfmac_f32_16x16x64_bf16 v[36:39], v[48:51], v[68:75], v4
    ds_read_b128 v[68:71], v6 offset:6144
    ds_read_b128 v[72:75], v6 offset:7168
    ds_read_b128 v[48:51], v5 offset:7168
    s_waitcnt lgkmcnt(8)
    v_smfmac_f32_16x16x64_bf16 v[24:27], v[52:55], a[8:15], v4
    v_smfmac_f32_16x16x64_bf16 v[28:31], v[52:55], a[88:95], v4
    v_smfmac_f32_16x16x64_bf16 v[40:43], v[52:55], v[104:111], v4
    s_waitcnt lgkmcnt(3)
    v_smfmac_f32_16x16x64_bf16 v[36:39], v[52:55], v[76:83], v4
    ds_read_b128 v[76:79], v6 offset:8192
    ds_read_b128 v[80:83], v6 offset:9216
    ds_read_b128 v[52:55], v5 offset:8192
    v_smfmac_f32_16x16x64_bf16 v[24:27], v[56:59], a[24:31], v4
    v_smfmac_f32_16x16x64_bf16 v[28:31], v[56:59], a[104:111], v4
    v_smfmac_f32_16x16x64_bf16 v[40:43], v[56:59], v[120:127], v4
    s_waitcnt lgkmcnt(4)
    v_smfmac_f32_16x16x64_bf16 v[36:39], v[56:59], v[68:75], v4
    ds_read_b128 v[68:71], v6 offset:10240
    ds_read_b128 v[72:75], v6 offset:11264
    ds_read_b128 v[56:59], v5 offset:9216
    v_smfmac_f32_16x16x64_bf16 v[24:27], v[60:63], a[32:39], v4
    v_smfmac_f32_16x16x64_bf16 v[28:31], v[60:63], a[112:119], v4
    v_smfmac_f32_16x16x64_bf16 v[40:43], v[60:63], v[128:135], v4
    s_waitcnt lgkmcnt(4)
    v_smfmac_f32_16x16x64_bf16 v[36:39], v[60:63], v[76:83], v4
    ds_read_b128 v[76:79], v6 offset:14336
    ds_read_b128 v[80:83], v6 offset:15360
    ds_read_b128 v[60:63], v5 offset:0
    v_smfmac_f32_16x16x64_bf16 v[24:27], v[64:67], a[40:47], v4
    v_smfmac_f32_16x16x64_bf16 v[28:31], v[64:67], a[120:127], v4
    v_smfmac_f32_16x16x64_bf16 v[40:43], v[64:67], v[136:143], v4
    s_waitcnt lgkmcnt(4)
    v_smfmac_f32_16x16x64_bf16 v[36:39], v[64:67], v[68:75], v4
    ds_read_b128 v[68:71], v6 offset:16384
    ds_read_b128 v[72:75], v6 offset:17408
    ds_read_b128 v[64:67], v5 offset:1024
    v_smfmac_f32_16x16x64_bf16 v[24:27], v[48:51], a[56:63], v4
    v_smfmac_f32_16x16x64_bf16 v[28:31], v[48:51], a[136:143], v4
    v_smfmac_f32_16x16x64_bf16 v[40:43], v[48:51], v[152:159], v4
    s_waitcnt lgkmcnt(4)
    v_smfmac_f32_16x16x64_bf16 v[36:39], v[48:51], v[76:83], v4
    ds_read_b128 v[76:79], v6 offset:18432
    ds_read_b128 v[80:83], v6 offset:19456
    ds_read_b128 v[48:51], v5 offset:3072
    v_smfmac_f32_16x16x64_bf16 v[24:27], v[52:55], a[64:71], v4
    v_smfmac_f32_16x16x64_bf16 v[28:31], v[52:55], a[144:151], v4
    v_smfmac_f32_16x16x64_bf16 v[40:43], v[52:55], v[160:167], v4
    s_waitcnt lgkmcnt(4)
    v_smfmac_f32_16x16x64_bf16 v[36:39], v[52:55], v[68:75], v4
    ds_read_b128 v[52:55], v5 offset:4096
    v_smfmac_f32_16x16x64_bf16 v[24:27], v[56:59], a[72:79], v4
    v_smfmac_f32_16x16x64_bf16 v[28:31], v[56:59], a[152:159], v4
    v_smfmac_f32_16x16x64_bf16 v[40:43], v[56:59], v[168:175], v4
    s_waitcnt lgkmcnt(2)
    v_smfmac_f32_16x16x64_bf16 v[36:39], v[56:59], v[76:83], v4
    ds_read_b128 v[56:59], v5 offset:5120
    buffer_load_dwordx4 v[80:83], v19, s[8:11], s45 offen offset:0 sc1
    buffer_load_dwordx4 v[84:87], v19, s[8:11], s45 offen offset:1024 sc1
    buffer_load_dwordx4 v[88:91], v19, s[8:11], s45 offen offset:2048 sc1
    v_smfmac_f32_16x16x64_bf16 v[32:35], v[60:63], a[160:167], v4
    v_smfmac_f32_16x16x64_bf16 v[44:47], v[60:63], v[176:183], v4
    v_permlane32_swap_b32 v28, v40
    v_permlane32_swap_b32 v29, v41
    ds_read_b128 v[60:63], v5 offset:7168
    v_smfmac_f32_16x16x64_bf16 v[32:35], v[64:67], a[168:175], v4
    v_permlane32_swap_b32 v30, v42
    v_permlane32_swap_b32 v31, v43
    v_smfmac_f32_16x16x64_bf16 v[44:47], v[64:67], v[184:191], v4
    v_add_f32 v28, v28, v40
    v_add_f32 v29, v29, v41
    ds_read_b128 v[64:67], v5 offset:8192
    s_waitcnt lgkmcnt(4)
    v_smfmac_f32_16x16x64_bf16 v[32:35], v[48:51], a[184:191], v4
    v_add_f32 v30, v30, v42
    v_add_f32 v31, v31, v43
    v_smfmac_f32_16x16x64_bf16 v[44:47], v[48:51], v[200:207], v4
    v_cvt_pk_bf16_f32 v40, v28, v29
    v_cvt_pk_bf16_f32 v41, v30, v31
    ds_read_b128 v[48:51], v5 offset:9216
    s_waitcnt lgkmcnt(4)
    v_smfmac_f32_16x16x64_bf16 v[32:35], v[52:55], a[192:199], v4
    v_mfma_f32_16x16x16_bf16 v[28:31], v[40:41], v[10:11], 0
    v_permlane32_swap_b32 v24, v36
    v_smfmac_f32_16x16x64_bf16 v[44:47], v[52:55], v[208:215], v4
    v_permlane32_swap_b32 v25, v37
    v_permlane32_swap_b32 v26, v38
    s_waitcnt lgkmcnt(3)
    v_smfmac_f32_16x16x64_bf16 v[32:35], v[56:59], a[200:207], v4
    v_permlane32_swap_b32 v27, v39
    v_add_f32 v24, v24, v36
    v_smfmac_f32_16x16x64_bf16 v[44:47], v[56:59], v[216:223], v4
    v_add_f32 v25, v25, v37
    v_add_f32 v26, v26, v38
    s_waitcnt lgkmcnt(2)
    v_smfmac_f32_16x16x64_bf16 v[32:35], v[60:63], a[216:223], v4
    v_add_f32 v27, v27, v39
    v_cvt_pk_bf16_f32 v36, v24, v25
    v_smfmac_f32_16x16x64_bf16 v[44:47], v[60:63], v[232:239], v4
    v_cvt_pk_bf16_f32 v37, v26, v27
    s_nop 1
    v_mfma_f32_16x16x16_bf16 v[24:27], v[36:37], v[10:11], 0
    s_waitcnt lgkmcnt(1)
    v_smfmac_f32_16x16x64_bf16 v[32:35], v[64:67], a[224:231], v4
    s_nop 5
    v_cvt_pk_bf16_f32 v24, v24, v25
    v_smfmac_f32_16x16x64_bf16 v[44:47], v[64:67], v[240:247], v4
    v_cvt_pk_bf16_f32 v25, v26, v27
    v_cvt_pk_bf16_f32 v26, v28, v29
    s_waitcnt lgkmcnt(0)
    v_smfmac_f32_16x16x64_bf16 v[32:35], v[48:51], a[232:239], v4
    v_cvt_pk_bf16_f32 v27, v30, v31
    s_waitcnt vmcnt(3)
    v_smfmac_f32_16x16x64_bf16 v[44:47], v[48:51], v[248:255], v4
    v_mfma_f32_16x16x32_bf16 v[28:31], a[240:243], v[24:27], 0
    v_mfma_f32_16x16x32_bf16 v[36:39], a[244:247], v[24:27], 0
    v_mfma_f32_16x16x32_bf16 v[40:43], v[24:27], v[24:27], 0
    s_nop 4
    v_permlane32_swap_b32 v32, v44
    v_permlane32_swap_b32 v33, v45
    v_permlane32_swap_b32 v34, v46
    v_permlane32_swap_b32 v35, v47
    v_add_f32 v32, v32, v44
    v_add_f32 v33, v33, v45
    v_add_f32 v34, v34, v46
    v_add_f32 v35, v35, v47
    v_cvt_pk_bf16_f32 v44, v32, v33
    v_cvt_pk_bf16_f32 v45, v34, v35
    s_nop 1
    v_mfma_f32_16x16x16_bf16 v[32:35], v[44:45], v[10:11], 0
    s_nop 7
    v_cvt_pk_bf16_f32 v32, v32, v33
    v_cvt_pk_bf16_f32 v33, v34, v35
    s_nop 1
    v_mfma_f32_16x16x16_bf16 v[28:31], a[248:249], v[32:33], v[28:31]
    v_mfma_f32_16x16x16_bf16 v[36:39], a[250:251], v[32:33], v[36:39]
    v_mfma_f32_16x16x16_bf16 v[40:43], v[32:33], v[32:33], v[40:43]
    s_nop 5
    ds_write_b128 v12, v[28:31]
    ds_write_b128 v12, v[36:39] offset:16
    ds_write_b128 v13, v[40:43]
    s_waitcnt lgkmcnt(0)
    s_barrier
    s_waitcnt vmcnt(0)
    v_mfma_f32_16x16x32_bf16 v[36:39], a[240:243], v[80:83], 0
    v_mfma_f32_16x16x32_bf16 v[44:47], a[244:247], v[80:83], 0
    v_mfma_f32_16x16x32_bf16 v[68:71], v[24:27], v[80:83], 0
    v_mfma_f32_16x16x32_bf16 v[40:43], a[240:243], v[84:87], 0
    v_mfma_f32_16x16x32_bf16 v[64:67], a[244:247], v[84:87], 0
    v_mfma_f32_16x16x32_bf16 v[72:75], v[24:27], v[84:87], 0
    s_nop 0
    v_mfma_f32_16x16x16_bf16 v[36:39], a[248:249], v[88:89], v[36:39]
    v_mfma_f32_16x16x16_bf16 v[44:47], a[250:251], v[88:89], v[44:47]
    v_mfma_f32_16x16x16_bf16 v[68:71], v[32:33], v[88:89], v[68:71]
    v_mfma_f32_16x16x16_bf16 v[40:43], a[248:249], v[90:91], v[40:43]
    v_mfma_f32_16x16x16_bf16 v[64:67], a[250:251], v[90:91], v[64:67]
    v_mfma_f32_16x16x16_bf16 v[72:75], v[32:33], v[90:91], v[72:75]
    s_nop 2
    ds_write_b128 v16, v[36:39] offset:0
    ds_write_b128 v16, v[44:47] offset:16
    ds_write_b128 v17, v[68:71]
    ds_write_b128 v16, v[40:43] offset:2816
    ds_write_b128 v16, v[64:67] offset:2832
    ds_write_b128 v18, v[72:75]
    s_add_u32 s40, s40, 1
    s_add_u32 s41, s41, 393216
    s_add_u32 s45, s45, 393216
    s_add_u32 s47, s37, 704512
    s_add_u32 s48, s37, 737280
    s_xor_b32 s42, s37, 0x2000
    s_lshl_b32 s24, s40, 12
    s_and_b32 s24, s24, 0x2000
    s_xor_b32 s24, s24, s36
    s_lshl_b32 s37, s40, 20
    s_add_u32 s37, s37, s24
    s_add_u32 s37, s37, 117440512
    s_add_u32 s43, s37, 655360
    s_add_u32 s49, s37, 753664
    s_waitcnt lgkmcnt(0)
    s_barrier
    s_cmp_lt_u32 s40, 64
    s_cbranch_scc1 interleave_layers__linear_attn_block__memory_aug_recurrent_mem_tr__prompt_kernel_s_stepw2
    s_branch interleave_layers__linear_attn_block__memory_aug_recurrent_mem_tr__prompt_kernel_s_end
interleave_layers__linear_attn_block__memory_aug_recurrent_mem_tr__prompt_kernel_s_stepw3:
    v_mov_b32 v24, 0
    v_mov_b32 v25, 0
    v_mov_b32 v26, 0
    v_mov_b32 v27, 0
    v_mov_b32 v28, 0
    v_mov_b32 v29, 0
    v_mov_b32 v30, 0
    v_mov_b32 v31, 0
    v_mov_b32 v32, 0
    v_mov_b32 v33, 0
    v_mov_b32 v34, 0
    v_mov_b32 v35, 0
    v_mov_b32 v36, 0
    v_mov_b32 v37, 0
    v_mov_b32 v38, 0
    v_mov_b32 v39, 0
    v_mov_b32 v40, 0
    v_mov_b32 v41, 0
    v_mov_b32 v42, 0
    v_mov_b32 v43, 0
    v_mov_b32 v44, 0
    v_mov_b32 v45, 0
    v_mov_b32 v46, 0
    v_mov_b32 v47, 0
    s_add_u32 s46, s47, 4096
    s_add_u32 s52, s47, 8192
    s_lshl_b32 s95, s92, 6
    s_add_u32 s95, s95, s40
    s_add_u32 s95, s95, 1
    s_cmp_ge_i32 s59, s95
    s_cbranch_scc1 interleave_layers__linear_attn_block__memory_aug_recurrent_mem_tr__prompt_kernel_s_ecw3_ok
    s_and_b32 s24, s2, 7
    s_lshl_b32 s24, s24, 7
    s_add_u32 s24, s24, 23109632
    v_and_b32 v49, 3, v1
    v_lshl_add_u32 v49, v49, 2, s24
    s_mov_b32 s61, 0
interleave_layers__linear_attn_block__memory_aug_recurrent_mem_tr__prompt_kernel_s_ecw3:
    buffer_load_dword v48, v49, s[8:11], 0 offen sc1
    s_waitcnt vmcnt(0)
    v_readlane_b32 s59, v48, 0
    v_readlane_b32 s24, v48, 1
    s_min_i32 s59, s59, s24
    v_readlane_b32 s24, v48, 2
    s_min_i32 s59, s59, s24
    s_cmp_ge_i32 s59, s95
    s_cbranch_scc1 interleave_layers__linear_attn_block__memory_aug_recurrent_mem_tr__prompt_kernel_s_ecw3_ok
    s_add_u32 s61, s61, 1
    s_cmp_ge_u32 s61, s60
    s_cbranch_scc1 interleave_layers__linear_attn_block__memory_aug_recurrent_mem_tr__prompt_kernel_s_ecw3_to
    s_sleep 2
    s_branch interleave_layers__linear_attn_block__memory_aug_recurrent_mem_tr__prompt_kernel_s_ecw3
interleave_layers__linear_attn_block__memory_aug_recurrent_mem_tr__prompt_kernel_s_ecw3_to:
    s_mov_b32 s60, 1
interleave_layers__linear_attn_block__memory_aug_recurrent_mem_tr__prompt_kernel_s_ecw3_ok:
    s_add_u32 s63, s40, 1
    s_cmp_ge_i32 s62, s63
    s_cbranch_scc1 interleave_layers__linear_attn_block__memory_aug_recurrent_mem_tr__prompt_kernel_s_enw3_ok
    s_mov_b32 s61, 0
interleave_layers__linear_attn_block__memory_aug_recurrent_mem_tr__prompt_kernel_s_enw3:
    buffer_load_dword v48, v9, s[8:11], 0 offen sc1
    s_waitcnt vmcnt(0)
    v_readlane_b32 s62, v48, 0
    v_readlane_b32 s24, v48, 1
    s_min_i32 s62, s62, s24
    s_cmp_ge_i32 s62, s63
    s_cbranch_scc1 interleave_layers__linear_attn_block__memory_aug_recurrent_mem_tr__prompt_kernel_s_enw3_ok
    s_add_u32 s61, s61, 1
    s_cmp_ge_u32 s61, s60
    s_cbranch_scc1 interleave_layers__linear_attn_block__memory_aug_recurrent_mem_tr__prompt_kernel_s_enw3_to
    s_sleep 2
    s_branch interleave_layers__linear_attn_block__memory_aug_recurrent_mem_tr__prompt_kernel_s_enw3
interleave_layers__linear_attn_block__memory_aug_recurrent_mem_tr__prompt_kernel_s_enw3_to:
    s_mov_b32 s60, 1
interleave_layers__linear_attn_block__memory_aug_recurrent_mem_tr__prompt_kernel_s_enw3_ok:
    buffer_load_dwordx4 a[240:243], v19, s[8:11], s41 offen offset:0 sc1
    buffer_load_dwordx4 a[244:247], v19, s[8:11], s41 offen offset:1024 sc1
    buffer_load_dwordx4 a[248:251], v19, s[8:11], s41 offen offset:2048 sc1
    s_sleep 5
    s_mov_b64 exec, 1
    s_mov_b32 s61, 0
    v_mov_b32 v83, 0
    buffer_atomic_add v83, v23, s[8:11], s48 offen sc0
    s_sleep 2
    v_mov_b32 v94, 0
    buffer_atomic_add v94, v23, s[8:11], s48 offen sc0
    s_sleep 2
    v_mov_b32 v95, 0
    buffer_atomic_add v95, v23, s[8:11], s48 offen sc0
    s_sleep 2
interleave_layers__linear_attn_block__memory_aug_recurrent_mem_tr__prompt_kernel_s_prw3:
    v_mov_b32 v82, 0
    buffer_atomic_add v82, v23, s[8:11], s48 offen sc0
    s_waitcnt vmcnt(3)
    v_cmp_le_i32 vcc, 9, v83
    s_add_u32 s61, s61, 1
    s_cbranch_vccnz interleave_layers__linear_attn_block__memory_aug_recurrent_mem_tr__prompt_kernel_s_prw3_out
    s_sleep 2
    v_mov_b32 v83, 0
    buffer_atomic_add v83, v23, s[8:11], s48 offen sc0
    s_waitcnt vmcnt(3)
    v_cmp_le_i32 vcc, 9, v94
    s_add_u32 s61, s61, 1
    s_cbranch_vccnz interleave_layers__linear_attn_block__memory_aug_recurrent_mem_tr__prompt_kernel_s_prw3_out
    s_sleep 2
    v_mov_b32 v94, 0
    buffer_atomic_add v94, v23, s[8:11], s48 offen sc0
    s_waitcnt vmcnt(3)
    v_cmp_le_i32 vcc, 9, v95
    s_add_u32 s61, s61, 1
    s_cbranch_vccnz interleave_layers__linear_attn_block__memory_aug_recurrent_mem_tr__prompt_kernel_s_prw3_out
    s_sleep 2
    v_mov_b32 v95, 0
    buffer_atomic_add v95, v23, s[8:11], s48 offen sc0
    s_waitcnt vmcnt(3)
    v_cmp_le_i32 vcc, 9, v82
    s_add_u32 s61, s61, 1
    s_cbranch_vccnz interleave_layers__linear_attn_block__memory_aug_recurrent_mem_tr__prompt_kernel_s_prw3_out
    s_sleep 2
    s_cmp_ge_u32 s61, s60
    s_cbranch_scc0 interleave_layers__linear_attn_block__memory_aug_recurrent_mem_tr__prompt_kernel_s_prw3
    s_mov_b32 s60, 1
interleave_layers__linear_attn_block__memory_aug_recurrent_mem_tr__prompt_kernel_s_prw3_out:
    s_mov_b64 exec, -1
    buffer_load_dwordx4 v[84:87], v7, s[8:11], s47 offen sc1
    buffer_load_dwordx4 v[88:91], v7, s[8:11], s46 offen sc1
    buffer_load_dwordx2 v[92:93], v8, s[8:11], s52 offen sc1
    ds_read_b128 v[48:51], v21 offset:0
    ds_read_b128 v[52:55], v21 offset:16
    ds_read_b128 v[56:59], v21 offset:5632
    ds_read_b128 v[60:63], v21 offset:5648
    ds_read_b128 v[64:67], v21 offset:11264
    ds_read_b128 v[68:71], v21 offset:11280
    ds_read_b128 v[72:75], v21 offset:16896
    ds_read_b128 v[76:79], v21 offset:16912
    s_waitcnt lgkmcnt(4)
    v_pk_add_f32 v[48:49], v[48:49], v[56:57]
    v_pk_add_f32 v[50:51], v[50:51], v[58:59]
    v_pk_add_f32 v[52:53], v[52:53], v[60:61]
    v_pk_add_f32 v[54:55], v[54:55], v[62:63]
    s_waitcnt lgkmcnt(0)
    v_pk_add_f32 v[64:65], v[64:65], v[72:73]
    v_pk_add_f32 v[66:67], v[66:67], v[74:75]
    v_pk_add_f32 v[68:69], v[68:69], v[76:77]
    v_pk_add_f32 v[70:71], v[70:71], v[78:79]
    v_pk_add_f32 v[48:49], v[48:49], v[64:65]
    v_pk_add_f32 v[50:51], v[50:51], v[66:67]
    v_pk_add_f32 v[52:53], v[52:53], v[68:69]
    v_pk_add_f32 v[54:55], v[54:55], v[70:71]
    v_mov_b32 v81, 0xff800000
    v_cndmask_b32 v48, v81, v48, s[64:65]
    v_cndmask_b32 v49, v81, v49, s[66:67]
    v_cndmask_b32 v50, v81, v50, s[68:69]
    v_cndmask_b32 v51, v81, v51, s[70:71]
    v_cndmask_b32 v52, v81, v52, s[72:73]
    v_cndmask_b32 v53, v81, v53, s[74:75]
    v_cndmask_b32 v54, v81, v54, s[76:77]
    v_cndmask_b32 v55, v81, v55, s[78:79]
    v_max3_f32 v80, v48, v49, v50
    v_max3_f32 v80, v80, v51, v52
    v_max3_f32 v80, v80, v53, v54
    v_max_f32 v80, v80, v55
    v_mov_b32 v81, 0xff800000
    v_cndmask_b32 v80, v81, v80, s[50:51]
    s_nop 1
    v_max_f32 v80, v80, v80 quad_perm:[1,0,3,2] row_mask:0xf bank_mask:0xf
    s_nop 1
    v_max_f32 v80, v80, v80 quad_perm:[2,3,0,1] row_mask:0xf bank_mask:0xf
    s_nop 1
    v_max_f32 v80, v80, v80 row_half_mirror row_mask:0xf bank_mask:0xf
    s_mov_b32 s24, 0x3dd53b95
    v_mul_f32 v80, s24, v80
    v_pk_fma_f32 v[48:49], v[48:49], s[24:25], v[80:81] op_sel_hi:[1,0,0] neg_lo:[0,0,1] neg_hi:[0,0,1]
    v_pk_fma_f32 v[50:51], v[50:51], s[24:25], v[80:81] op_sel_hi:[1,0,0] neg_lo:[0,0,1] neg_hi:[0,0,1]
    v_pk_fma_f32 v[52:53], v[52:53], s[24:25], v[80:81] op_sel_hi:[1,0,0] neg_lo:[0,0,1] neg_hi:[0,0,1]
    v_pk_fma_f32 v[54:55], v[54:55], s[24:25], v[80:81] op_sel_hi:[1,0,0] neg_lo:[0,0,1] neg_hi:[0,0,1]
    v_exp_f32 v48, v48
    v_exp_f32 v49, v49
    v_exp_f32 v50, v50
    v_exp_f32 v51, v51
    v_exp_f32 v52, v52
    v_exp_f32 v53, v53
    v_exp_f32 v54, v54
    v_exp_f32 v55, v55
    v_pk_add_f32 v[56:57], v[48:49], v[50:51]
    v_pk_add_f32 v[58:59], v[52:53], v[54:55]
    v_pk_add_f32 v[56:57], v[56:57], v[58:59]
    v_add_f32 v80, v56, v57
    v_cndmask_b32 v80, 0, v80, s[50:51]
    s_nop 1
    v_add_f32 v80, v80, v80 quad_perm:[1,0,3,2] row_mask:0xf bank_mask:0xf
    s_nop 1
    v_add_f32 v80, v80, v80 quad_perm:[2,3,0,1] row_mask:0xf bank_mask:0xf
    s_nop 1
    v_add_f32 v80, v80, v80 row_half_mirror row_mask:0xf bank_mask:0xf
    v_rcp_f32 v80, v80
    s_nop 0
    v_pk_mul_f32 v[48:49], v[48:49], v[80:81] op_sel_hi:[1,0]
    v_pk_mul_f32 v[50:51], v[50:51], v[80:81] op_sel_hi:[1,0]
    v_pk_mul_f32 v[52:53], v[52:53], v[80:81] op_sel_hi:[1,0]
    v_pk_mul_f32 v[54:55], v[54:55], v[80:81] op_sel_hi:[1,0]
    v_cvt_pk_bf16_f32 v56, v48, v49
    v_cvt_pk_bf16_f32 v57, v50, v51
    v_cvt_pk_bf16_f32 v58, v52, v53
    v_cvt_pk_bf16_f32 v59, v54, v55
    v_min_u32 v56, -2, v56
    v_min_u32 v57, -2, v57
    v_min_u32 v58, -2, v58
    v_min_u32 v59, -2, v59
    buffer_store_dwordx4 v[56:59], v22, s[8:11], s42 offen sc1
    s_waitcnt vmcnt(1)
    s_nop 0
    v_max3_u32 v58, v84, v85, v86
    v_max3_u32 v58, v58, v87, v88
    v_max3_u32 v58, v58, v89, v90
    v_max3_u32 v58, v58, v91, v92
    v_max_u32 v58, v58, v93
    v_cmp_eq_u32 vcc, -1, v58
    s_cbranch_vccz interleave_layers__linear_attn_block__memory_aug_recurrent_mem_tr__prompt_kernel_s_pmw3_out
    s_mov_b32 s61, 0
interleave_layers__linear_attn_block__memory_aug_recurrent_mem_tr__prompt_kernel_s_pmw3:
    buffer_load_dwordx4 v[84:87], v7, s[8:11], s47 offen sc1
    buffer_load_dwordx4 v[88:91], v7, s[8:11], s46 offen sc1
    buffer_load_dwordx2 v[92:93], v8, s[8:11], s52 offen sc1
    s_waitcnt vmcnt(0)
    v_max3_u32 v58, v84, v85, v86
    v_max3_u32 v58, v58, v87, v88
    v_max3_u32 v58, v58, v89, v90
    v_max3_u32 v58, v58, v91, v92
    v_max_u32 v58, v58, v93
    v_cmp_eq_u32 vcc, -1, v58
    s_add_u32 s61, s61, 1
    s_cbranch_vccz interleave_layers__linear_attn_block__memory_aug_recurrent_mem_tr__prompt_kernel_s_pmw3_out
    s_cmp_ge_u32 s61, s60
    s_cbranch_scc1 interleave_layers__linear_attn_block__memory_aug_recurrent_mem_tr__prompt_kernel_s_pmw3_to
    s_sleep 1
    s_branch interleave_layers__linear_attn_block__memory_aug_recurrent_mem_tr__prompt_kernel_s_pmw3
interleave_layers__linear_attn_block__memory_aug_recurrent_mem_tr__prompt_kernel_s_pmw3_to:
    s_mov_b32 s60, 1
interleave_layers__linear_attn_block__memory_aug_recurrent_mem_tr__prompt_kernel_s_pmw3_out:
    ds_write_b128 v7, v[84:87]
    ds_write_b128 v7, v[88:91] offset:4096
    ds_write_b64 v8, v[92:93]
interleave_layers__linear_attn_block__memory_aug_recurrent_mem_tr__prompt_kernel_s_gow3:
    ds_read_b128 v[68:71], v6 offset:6144
    ds_read_b128 v[72:75], v6 offset:7168
    ds_read_b128 v[76:79], v6 offset:14336
    ds_read_b128 v[80:83], v6 offset:15360
    v_smfmac_f32_16x16x64_bf16 v[24:27], v[84:87], a[24:31], v4
    v_smfmac_f32_16x16x64_bf16 v[28:31], v[84:87], a[104:111], v4
    v_smfmac_f32_16x16x64_bf16 v[32:35], v[84:87], a[184:191], v4
    v_smfmac_f32_16x16x64_bf16 v[40:43], v[84:87], v[120:127], v4
    v_smfmac_f32_16x16x64_bf16 v[44:47], v[84:87], v[200:207], v4
    s_waitcnt lgkmcnt(2)
    v_smfmac_f32_16x16x64_bf16 v[36:39], v[84:87], v[68:75], v4
    ds_read_b128 v[68:71], v6 offset:0
    ds_read_b128 v[72:75], v6 offset:1024
    s_barrier
    ds_read_b128 v[48:51], v5 offset:0
    ds_read_b128 v[52:55], v5 offset:1024
    ds_read_b128 v[56:59], v5 offset:2048
    ds_read_b128 v[60:63], v5 offset:4096
    ds_read_b128 v[64:67], v5 offset:5120
    v_smfmac_f32_16x16x64_bf16 v[24:27], v[88:91], a[56:63], v4
    v_smfmac_f32_16x16x64_bf16 v[28:31], v[88:91], a[136:143], v4
    v_smfmac_f32_16x16x64_bf16 v[32:35], v[88:91], a[216:223], v4
    v_smfmac_f32_16x16x64_bf16 v[40:43], v[88:91], v[152:159], v4
    v_smfmac_f32_16x16x64_bf16 v[44:47], v[88:91], v[232:239], v4
    s_waitcnt lgkmcnt(7)
    v_smfmac_f32_16x16x64_bf16 v[36:39], v[88:91], v[76:83], v4
    ds_read_b128 v[76:79], v6 offset:2048
    ds_read_b128 v[80:83], v6 offset:3072
    s_waitcnt lgkmcnt(6)
    v_smfmac_f32_16x16x64_bf16 v[24:27], v[48:51], a[0:7], v4
    v_smfmac_f32_16x16x64_bf16 v[28:31], v[48:51], a[80:87], v4
    v_smfmac_f32_16x16x64_bf16 v[40:43], v[48:51], v[96:103], v4
    v_smfmac_f32_16x16x64_bf16 v[36:39], v[48:51], v[68:75], v4
    ds_read_b128 v[68:71], v6 offset:4096
    ds_read_b128 v[72:75], v6 offset:5120
    ds_read_b128 v[48:51], v5 offset:6144
    s_waitcnt lgkmcnt(8)
    v_smfmac_f32_16x16x64_bf16 v[24:27], v[52:55], a[8:15], v4
    v_smfmac_f32_16x16x64_bf16 v[28:31], v[52:55], a[88:95], v4
    v_smfmac_f32_16x16x64_bf16 v[40:43], v[52:55], v[104:111], v4
    s_waitcnt lgkmcnt(3)
    v_smfmac_f32_16x16x64_bf16 v[36:39], v[52:55], v[76:83], v4
    ds_read_b128 v[76:79], v6 offset:8192
    ds_read_b128 v[80:83], v6 offset:9216
    ds_read_b128 v[52:55], v5 offset:8192
    v_smfmac_f32_16x16x64_bf16 v[24:27], v[56:59], a[16:23], v4
    v_smfmac_f32_16x16x64_bf16 v[28:31], v[56:59], a[96:103], v4
    v_smfmac_f32_16x16x64_bf16 v[40:43], v[56:59], v[112:119], v4
    s_waitcnt lgkmcnt(4)
    v_smfmac_f32_16x16x64_bf16 v[36:39], v[56:59], v[68:75], v4
    ds_read_b128 v[68:71], v6 offset:10240
    ds_read_b128 v[72:75], v6 offset:11264
    ds_read_b128 v[56:59], v5 offset:9216
    v_smfmac_f32_16x16x64_bf16 v[24:27], v[60:63], a[32:39], v4
    v_smfmac_f32_16x16x64_bf16 v[28:31], v[60:63], a[112:119], v4
    v_smfmac_f32_16x16x64_bf16 v[40:43], v[60:63], v[128:135], v4
    s_waitcnt lgkmcnt(4)
    v_smfmac_f32_16x16x64_bf16 v[36:39], v[60:63], v[76:83], v4
    ds_read_b128 v[76:79], v6 offset:12288
    ds_read_b128 v[80:83], v6 offset:13312
    ds_read_b128 v[60:63], v5 offset:0
    v_smfmac_f32_16x16x64_bf16 v[24:27], v[64:67], a[40:47], v4
    v_smfmac_f32_16x16x64_bf16 v[28:31], v[64:67], a[120:127], v4
    v_smfmac_f32_16x16x64_bf16 v[40:43], v[64:67], v[136:143], v4
    s_waitcnt lgkmcnt(4)
    v_smfmac_f32_16x16x64_bf16 v[36:39], v[64:67], v[68:75], v4
    ds_read_b128 v[68:71], v6 offset:16384
    ds_read_b128 v[72:75], v6 offset:17408
    ds_read_b128 v[64:67], v5 offset:1024
    v_smfmac_f32_16x16x64_bf16 v[24:27], v[48:51], a[48:55], v4
    v_smfmac_f32_16x16x64_bf16 v[28:31], v[48:51], a[128:135], v4
    v_smfmac_f32_16x16x64_bf16 v[40:43], v[48:51], v[144:151], v4
    s_waitcnt lgkmcnt(4)
    v_smfmac_f32_16x16x64_bf16 v[36:39], v[48:51], v[76:83], v4
    ds_read_b128 v[76:79], v6 offset:18432
    ds_read_b128 v[80:83], v6 offset:19456
    ds_read_b128 v[48:51], v5 offset:2048
    v_smfmac_f32_16x16x64_bf16 v[24:27], v[52:55], a[64:71], v4
    v_smfmac_f32_16x16x64_bf16 v[28:31], v[52:55], a[144:151], v4
    v_smfmac_f32_16x16x64_bf16 v[40:43], v[52:55], v[160:167], v4
    s_waitcnt lgkmcnt(4)
    v_smfmac_f32_16x16x64_bf16 v[36:39], v[52:55], v[68:75], v4
    ds_read_b128 v[52:55], v5 offset:4096
    v_smfmac_f32_16x16x64_bf16 v[24:27], v[56:59], a[72:79], v4
    v_smfmac_f32_16x16x64_bf16 v[28:31], v[56:59], a[152:159], v4
    v_smfmac_f32_16x16x64_bf16 v[40:43], v[56:59], v[168:175], v4
    s_waitcnt lgkmcnt(2)
    v_smfmac_f32_16x16x64_bf16 v[36:39], v[56:59], v[76:83], v4
    ds_read_b128 v[56:59], v5 offset:5120
    buffer_load_dwordx4 v[80:83], v19, s[8:11], s45 offen offset:0 sc1
    buffer_load_dwordx4 v[84:87], v19, s[8:11], s45 offen offset:1024 sc1
    buffer_load_dwordx4 v[88:91], v19, s[8:11], s45 offen offset:2048 sc1
    v_smfmac_f32_16x16x64_bf16 v[32:35], v[60:63], a[160:167], v4
    v_smfmac_f32_16x16x64_bf16 v[44:47], v[60:63], v[176:183], v4
    v_permlane32_swap_b32 v28, v40
    v_permlane32_swap_b32 v29, v41
    ds_read_b128 v[60:63], v5 offset:6144
    v_smfmac_f32_16x16x64_bf16 v[32:35], v[64:67], a[168:175], v4
    v_permlane32_swap_b32 v30, v42
    v_permlane32_swap_b32 v31, v43
    v_smfmac_f32_16x16x64_bf16 v[44:47], v[64:67], v[184:191], v4
    v_add_f32 v28, v28, v40
    v_add_f32 v29, v29, v41
    ds_read_b128 v[64:67], v5 offset:8192
    s_waitcnt lgkmcnt(4)
    v_smfmac_f32_16x16x64_bf16 v[32:35], v[48:51], a[176:183], v4
    v_add_f32 v30, v30, v42
    v_add_f32 v31, v31, v43
    v_smfmac_f32_16x16x64_bf16 v[44:47], v[48:51], v[192:199], v4
    v_cvt_pk_bf16_f32 v40, v28, v29
    v_cvt_pk_bf16_f32 v41, v30, v31
    ds_read_b128 v[48:51], v5 offset:9216
    s_waitcnt lgkmcnt(4)
    v_smfmac_f32_16x16x64_bf16 v[32:35], v[52:55], a[192:199], v4
    v_mfma_f32_16x16x16_bf16 v[28:31], v[40:41], v[10:11], 0
    v_permlane32_swap_b32 v24, v36
    v_smfmac_f32_16x16x64_bf16 v[44:47], v[52:55], v[208:215], v4
    v_permlane32_swap_b32 v25, v37
    v_permlane32_swap_b32 v26, v38
    s_waitcnt lgkmcnt(3)
    v_smfmac_f32_16x16x64_bf16 v[32:35], v[56:59], a[200:207], v4
    v_permlane32_swap_b32 v27, v39
    v_add_f32 v24, v24, v36
    v_smfmac_f32_16x16x64_bf16 v[44:47], v[56:59], v[216:223], v4
    v_add_f32 v25, v25, v37
    v_add_f32 v26, v26, v38
    s_waitcnt lgkmcnt(2)
    v_smfmac_f32_16x16x64_bf16 v[32:35], v[60:63], a[208:215], v4
    v_add_f32 v27, v27, v39
    v_cvt_pk_bf16_f32 v36, v24, v25
    v_smfmac_f32_16x16x64_bf16 v[44:47], v[60:63], v[224:231], v4
    v_cvt_pk_bf16_f32 v37, v26, v27
    s_nop 1
    v_mfma_f32_16x16x16_bf16 v[24:27], v[36:37], v[10:11], 0
    s_waitcnt lgkmcnt(1)
    v_smfmac_f32_16x16x64_bf16 v[32:35], v[64:67], a[224:231], v4
    s_nop 5
    v_cvt_pk_bf16_f32 v24, v24, v25
    v_smfmac_f32_16x16x64_bf16 v[44:47], v[64:67], v[240:247], v4
    v_cvt_pk_bf16_f32 v25, v26, v27
    v_cvt_pk_bf16_f32 v26, v28, v29
    s_waitcnt lgkmcnt(0)
    v_smfmac_f32_16x16x64_bf16 v[32:35], v[48:51], a[232:239], v4
    v_cvt_pk_bf16_f32 v27, v30, v31
    s_waitcnt vmcnt(3)
    v_smfmac_f32_16x16x64_bf16 v[44:47], v[48:51], v[248:255], v4
    v_mfma_f32_16x16x32_bf16 v[28:31], a[240:243], v[24:27], 0
    v_mfma_f32_16x16x32_bf16 v[36:39], a[244:247], v[24:27], 0
    v_mfma_f32_16x16x32_bf16 v[40:43], v[24:27], v[24:27], 0
    s_nop 4
    v_permlane32_swap_b32 v32, v44
    v_permlane32_swap_b32 v33, v45
    v_permlane32_swap_b32 v34, v46
    v_permlane32_swap_b32 v35, v47
    v_add_f32 v32, v32, v44
    v_add_f32 v33, v33, v45
    v_add_f32 v34, v34, v46
    v_add_f32 v35, v35, v47
    v_cvt_pk_bf16_f32 v44, v32, v33
    v_cvt_pk_bf16_f32 v45, v34, v35
    s_nop 1
    v_mfma_f32_16x16x16_bf16 v[32:35], v[44:45], v[10:11], 0
    s_nop 7
    v_cvt_pk_bf16_f32 v32, v32, v33
    v_cvt_pk_bf16_f32 v33, v34, v35
    s_nop 1
    v_mfma_f32_16x16x16_bf16 v[28:31], a[248:249], v[32:33], v[28:31]
    v_mfma_f32_16x16x16_bf16 v[36:39], a[250:251], v[32:33], v[36:39]
    v_mfma_f32_16x16x16_bf16 v[40:43], v[32:33], v[32:33], v[40:43]
    s_nop 5
    ds_write_b128 v12, v[28:31]
    ds_write_b128 v12, v[36:39] offset:16
    ds_write_b128 v13, v[40:43]
    s_waitcnt lgkmcnt(0)
    s_barrier
    s_waitcnt vmcnt(0)
    v_mfma_f32_16x16x32_bf16 v[36:39], a[240:243], v[80:83], 0
    v_mfma_f32_16x16x32_bf16 v[44:47], a[244:247], v[80:83], 0
    v_mfma_f32_16x16x32_bf16 v[68:71], v[24:27], v[80:83], 0
    v_mfma_f32_16x16x32_bf16 v[40:43], a[240:243], v[84:87], 0
    v_mfma_f32_16x16x32_bf16 v[64:67], a[244:247], v[84:87], 0
    v_mfma_f32_16x16x32_bf16 v[72:75], v[24:27], v[84:87], 0
    s_nop 0
    v_mfma_f32_16x16x16_bf16 v[36:39], a[248:249], v[88:89], v[36:39]
    v_mfma_f32_16x16x16_bf16 v[44:47], a[250:251], v[88:89], v[44:47]
    v_mfma_f32_16x16x16_bf16 v[68:71], v[32:33], v[88:89], v[68:71]
    v_mfma_f32_16x16x16_bf16 v[40:43], a[248:249], v[90:91], v[40:43]
    v_mfma_f32_16x16x16_bf16 v[64:67], a[250:251], v[90:91], v[64:67]
    v_mfma_f32_16x16x16_bf16 v[72:75], v[32:33], v[90:91], v[72:75]
    s_nop 2
    ds_write_b128 v16, v[36:39] offset:0
    ds_write_b128 v16, v[44:47] offset:16
    ds_write_b128 v17, v[68:71]
    ds_write_b128 v16, v[40:43] offset:2816
    ds_write_b128 v16, v[64:67] offset:2832
    ds_write_b128 v18, v[72:75]
    s_add_u32 s40, s40, 1
    s_add_u32 s41, s41, 393216
    s_add_u32 s45, s45, 393216
    s_add_u32 s47, s37, 704512
    s_add_u32 s48, s37, 737280
    s_xor_b32 s42, s37, 0x2000
    s_lshl_b32 s24, s40, 12
    s_and_b32 s24, s24, 0x2000
    s_xor_b32 s24, s24, s36
    s_lshl_b32 s37, s40, 20
    s_add_u32 s37, s37, s24
    s_add_u32 s37, s37, 117440512
    s_add_u32 s43, s37, 655360
    s_add_u32 s49, s37, 753664
    s_waitcnt lgkmcnt(0)
    s_barrier
    s_cmp_lt_u32 s40, 64
    s_cbranch_scc1 interleave_layers__linear_attn_block__memory_aug_recurrent_mem_tr__prompt_kernel_s_stepw3
interleave_layers__linear_attn_block__memory_aug_recurrent_mem_tr__prompt_kernel_s_end:
    ds_read_b128 v[48:51], v21 offset:0
    ds_read_b128 v[52:55], v21 offset:16
    ds_read_b128 v[56:59], v21 offset:5632
    ds_read_b128 v[60:63], v21 offset:5648
    ds_read_b128 v[64:67], v21 offset:11264
    ds_read_b128 v[68:71], v21 offset:11280
    ds_read_b128 v[72:75], v21 offset:16896
    ds_read_b128 v[76:79], v21 offset:16912
    s_waitcnt lgkmcnt(4)
    v_pk_add_f32 v[48:49], v[48:49], v[56:57]
    v_pk_add_f32 v[50:51], v[50:51], v[58:59]
    v_pk_add_f32 v[52:53], v[52:53], v[60:61]
    v_pk_add_f32 v[54:55], v[54:55], v[62:63]
    s_waitcnt lgkmcnt(0)
    v_pk_add_f32 v[64:65], v[64:65], v[72:73]
    v_pk_add_f32 v[66:67], v[66:67], v[74:75]
    v_pk_add_f32 v[68:69], v[68:69], v[76:77]
    v_pk_add_f32 v[70:71], v[70:71], v[78:79]
    v_pk_add_f32 v[48:49], v[48:49], v[64:65]
    v_pk_add_f32 v[50:51], v[50:51], v[66:67]
    v_pk_add_f32 v[52:53], v[52:53], v[68:69]
    v_pk_add_f32 v[54:55], v[54:55], v[70:71]
    v_mov_b32 v81, 0xff800000
    v_cndmask_b32 v48, v81, v48, s[64:65]
    v_cndmask_b32 v49, v81, v49, s[66:67]
    v_cndmask_b32 v50, v81, v50, s[68:69]
    v_cndmask_b32 v51, v81, v51, s[70:71]
    v_cndmask_b32 v52, v81, v52, s[72:73]
    v_cndmask_b32 v53, v81, v53, s[74:75]
    v_cndmask_b32 v54, v81, v54, s[76:77]
    v_cndmask_b32 v55, v81, v55, s[78:79]
    v_max3_f32 v80, v48, v49, v50
    v_max3_f32 v80, v80, v51, v52
    v_max3_f32 v80, v80, v53, v54
    v_max_f32 v80, v80, v55
    v_mov_b32 v81, 0xff800000
    v_cndmask_b32 v80, v81, v80, s[50:51]
    s_nop 1
    v_max_f32 v80, v80, v80 quad_perm:[1,0,3,2] row_mask:0xf bank_mask:0xf
    s_nop 1
    v_max_f32 v80, v80, v80 quad_perm:[2,3,0,1] row_mask:0xf bank_mask:0xf
    s_nop 1
    v_max_f32 v80, v80, v80 row_half_mirror row_mask:0xf bank_mask:0xf
    s_mov_b32 s24, 0x3dd53b95
    v_mul_f32 v80, s24, v80
    v_pk_fma_f32 v[48:49], v[48:49], s[24:25], v[80:81] op_sel_hi:[1,0,0] neg_lo:[0,0,1] neg_hi:[0,0,1]
    v_pk_fma_f32 v[50:51], v[50:51], s[24:25], v[80:81] op_sel_hi:[1,0,0] neg_lo:[0,0,1] neg_hi:[0,0,1]
    v_pk_fma_f32 v[52:53], v[52:53], s[24:25], v[80:81] op_sel_hi:[1,0,0] neg_lo:[0,0,1] neg_hi:[0,0,1]
    v_pk_fma_f32 v[54:55], v[54:55], s[24:25], v[80:81] op_sel_hi:[1,0,0] neg_lo:[0,0,1] neg_hi:[0,0,1]
    v_exp_f32 v48, v48
    v_exp_f32 v49, v49
    v_exp_f32 v50, v50
    v_exp_f32 v51, v51
    v_exp_f32 v52, v52
    v_exp_f32 v53, v53
    v_exp_f32 v54, v54
    v_exp_f32 v55, v55
    v_pk_add_f32 v[56:57], v[48:49], v[50:51]
    v_pk_add_f32 v[58:59], v[52:53], v[54:55]
    v_pk_add_f32 v[56:57], v[56:57], v[58:59]
    v_add_f32 v80, v56, v57
    v_cndmask_b32 v80, 0, v80, s[50:51]
    s_nop 1
    v_add_f32 v80, v80, v80 quad_perm:[1,0,3,2] row_mask:0xf bank_mask:0xf
    s_nop 1
    v_add_f32 v80, v80, v80 quad_perm:[2,3,0,1] row_mask:0xf bank_mask:0xf
    s_nop 1
    v_add_f32 v80, v80, v80 row_half_mirror row_mask:0xf bank_mask:0xf
    v_rcp_f32 v80, v80
    s_nop 0
    v_pk_mul_f32 v[48:49], v[48:49], v[80:81] op_sel_hi:[1,0]
    v_pk_mul_f32 v[50:51], v[50:51], v[80:81] op_sel_hi:[1,0]
    v_pk_mul_f32 v[52:53], v[52:53], v[80:81] op_sel_hi:[1,0]
    v_pk_mul_f32 v[54:55], v[54:55], v[80:81] op_sel_hi:[1,0]
    v_cvt_pk_bf16_f32 v56, v48, v49
    v_cvt_pk_bf16_f32 v57, v50, v51
    v_cvt_pk_bf16_f32 v58, v52, v53
    v_cvt_pk_bf16_f32 v59, v54, v55
    v_min_u32 v56, -2, v56
    v_min_u32 v57, -2, v57
    v_min_u32 v58, -2, v58
    v_min_u32 v59, -2, v59
    buffer_store_dwordx4 v[56:59], v22, s[8:11], s42 offen sc1
    s_cmp_eq_u32 s92, 0
    s_cbranch_scc0 interleave_layers__linear_attn_block__memory_aug_recurrent_mem_tr__prompt_kernel_end
    s_mov_b32 s92, 1
    s_branch interleave_layers__linear_attn_block__memory_aug_recurrent_mem_tr__prompt_kernel_s_layer
interleave_layers__linear_attn_block__memory_aug_recurrent_mem_tr__prompt_kernel_roleV:
    s_sub_u32 s44, s2, 32
    s_load_dwordx2 s[6:7], s[0:1], 56
    s_load_dwordx2 s[24:25], s[0:1], 64
    s_load_dwordx2 s[26:27], s[0:1], 32
    s_waitcnt lgkmcnt(0)
    s_mov_b32 s12, s6
    s_mov_b32 s13, s7
    s_mov_b32 s14, 7864320
    s_mov_b32 s15, 0x00020000
    s_mov_b32 s16, s24
    s_mov_b32 s17, s25
    s_mov_b32 s18, 7864320
    s_mov_b32 s19, 0x00020000
    s_mov_b32 s20, s26
    s_mov_b32 s21, s27
    s_mov_b32 s22, 10240
    s_mov_b32 s23, 0x00020000
    v_add_u32 v16, 0, v0
    s_mov_b32 s24, 683
    v_mul_lo_u32 v17, v16, s24
    v_lshrrev_b32 v17, 14, v17
    v_mul_u32_u24 v18, 24, v17
    v_sub_u32 v18, v16, v18
    s_mov_b32 s24, 12288
    v_mul_lo_u32 v4, v17, s24
    v_lshl_add_u32 v4, v18, 4, v4
    v_mul_u32_u24 v10, 400, v17
    v_lshl_add_u32 v10, v18, 4, v10
    v_add_u32 v10, 90112, v10
    v_add_u32 v16, 256, v0
    s_mov_b32 s24, 683
    v_mul_lo_u32 v17, v16, s24
    v_lshrrev_b32 v17, 14, v17
    v_mul_u32_u24 v18, 24, v17
    v_sub_u32 v18, v16, v18
    s_mov_b32 s24, 12288
    v_mul_lo_u32 v5, v17, s24
    v_lshl_add_u32 v5, v18, 4, v5
    v_mul_u32_u24 v11, 400, v17
    v_lshl_add_u32 v11, v18, 4, v11
    v_add_u32 v11, 90112, v11
    v_add_u32 v16, 512, v0
    s_mov_b32 s24, 683
    v_mul_lo_u32 v17, v16, s24
    v_lshrrev_b32 v17, 14, v17
    v_mul_u32_u24 v18, 24, v17
    v_sub_u32 v18, v16, v18
    s_mov_b32 s24, 12288
    v_mul_lo_u32 v6, v17, s24
    v_lshl_add_u32 v6, v18, 4, v6
    v_mul_u32_u24 v12, 400, v17
    v_lshl_add_u32 v12, v18, 4, v12
    v_add_u32 v12, 90112, v12
    v_add_u32 v16, 768, v0
    s_mov_b32 s24, 683
    v_mul_lo_u32 v17, v16, s24
    v_lshrrev_b32 v17, 14, v17
    v_mul_u32_u24 v18, 24, v17
    v_sub_u32 v18, v16, v18
    s_mov_b32 s24, 12288
    v_mul_lo_u32 v7, v17, s24
    v_lshl_add_u32 v7, v18, 4, v7
    v_mul_u32_u24 v13, 400, v17
    v_lshl_add_u32 v13, v18, 4, v13
    v_add_u32 v13, 90112, v13
    v_add_u32 v16, 1024, v0
    s_mov_b32 s24, 683
    v_mul_lo_u32 v17, v16, s24
    v_lshrrev_b32 v17, 14, v17
    v_mul_u32_u24 v18, 24, v17
    v_sub_u32 v18, v16, v18
    s_mov_b32 s24, 12288
    v_mul_lo_u32 v8, v17, s24
    v_lshl_add_u32 v8, v18, 4, v8
    v_mul_u32_u24 v14, 400, v17
    v_lshl_add_u32 v14, v18, 4, v14
    v_add_u32 v14, 90112, v14
    v_add_u32 v16, 1280, v0
    s_mov_b32 s24, 683
    v_mul_lo_u32 v17, v16, s24
    v_lshrrev_b32 v17, 14, v17
    v_mul_u32_u24 v18, 24, v17
    v_sub_u32 v18, v16, v18
    s_mov_b32 s24, 12288
    v_mul_lo_u32 v9, v17, s24
    v_lshl_add_u32 v9, v18, 4, v9
    v_mul_u32_u24 v15, 400, v17
    v_lshl_add_u32 v15, v18, 4, v15
    v_add_u32 v15, 90112, v15
    v_lshrrev_b32 v17, 1, v3
    v_lshlrev_b32 v17, 4, v17
    v_and_b32 v18, 1, v3
    v_lshl_add_u32 v17, v18, 2, v17
    v_lshrrev_b32 v18, 2, v2
    v_and_b32 v19, 1, v18
    v_add_u32 v17, v17, v19
    v_lshrrev_b32 v18, 1, v18
    v_lshl_add_u32 v17, v18, 3, v17
    v_mul_u32_u24 v16, 400, v17
    v_and_b32 v18, 3, v2
    v_lshl_add_u32 v16, v18, 3, v16
    v_add_u32 v16, 90112, v16
    s_mul_i32 s24, s3, 96
    v_add_u32 v16, s24, v16
    s_mul_i32 s45, s44, 384
    s_add_u32 s46, s45, 0
    buffer_load_dwordx4 v[24:27], v4, s[12:15], s46 offen
    buffer_load_dwordx4 v[28:31], v5, s[12:15], s46 offen
    buffer_load_dwordx4 v[32:35], v6, s[12:15], s46 offen
    buffer_load_dwordx4 v[36:39], v7, s[12:15], s46 offen
    buffer_load_dwordx4 v[40:43], v8, s[12:15], s46 offen
    buffer_load_dwordx4 v[44:47], v9, s[12:15], s46 offen
    s_add_u32 s46, s45, 786432
    buffer_load_dwordx4 v[48:51], v4, s[12:15], s46 offen
    buffer_load_dwordx4 v[52:55], v5, s[12:15], s46 offen
    buffer_load_dwordx4 v[56:59], v6, s[12:15], s46 offen
    buffer_load_dwordx4 v[60:63], v7, s[12:15], s46 offen
    buffer_load_dwordx4 v[64:67], v8, s[12:15], s46 offen
    buffer_load_dwordx4 v[68:71], v9, s[12:15], s46 offen
    s_waitcnt vmcnt(6)
    ds_write_b128 v10, v[24:27]
    ds_write_b128 v11, v[28:31]
    ds_write_b128 v12, v[32:35]
    ds_write_b128 v13, v[36:39]
    ds_write_b128 v14, v[40:43]
    ds_write_b128 v15, v[44:47]
    s_add_u32 s46, s45, 1572864
    buffer_load_dwordx4 v[72:75], v4, s[12:15], s46 offen
    buffer_load_dwordx4 v[76:79], v5, s[12:15], s46 offen
    buffer_load_dwordx4 v[80:83], v6, s[12:15], s46 offen
    buffer_load_dwordx4 v[84:87], v7, s[12:15], s46 offen
    buffer_load_dwordx4 v[88:91], v8, s[12:15], s46 offen
    buffer_load_dwordx4 v[92:95], v9, s[12:15], s46 offen
    s_waitcnt lgkmcnt(0)
    s_barrier
    ds_read_b64_tr_b16 a[0:1], v16 offset:0
    ds_read_b64_tr_b16 a[2:3], v16 offset:800
    ds_read_b64_tr_b16 a[4:5], v16 offset:12800
    ds_read_b64_tr_b16 a[6:7], v16 offset:13600
    ds_read_b64_tr_b16 a[80:81], v16 offset:32
    ds_read_b64_tr_b16 a[82:83], v16 offset:832
    ds_read_b64_tr_b16 a[84:85], v16 offset:12832
    ds_read_b64_tr_b16 a[86:87], v16 offset:13632
    ds_read_b64_tr_b16 a[160:161], v16 offset:64
    ds_read_b64_tr_b16 a[162:163], v16 offset:864
    ds_read_b64_tr_b16 a[164:165], v16 offset:12864
    ds_read_b64_tr_b16 a[166:167], v16 offset:13664
    s_waitcnt lgkmcnt(0)
    s_barrier
    s_waitcnt vmcnt(6)
    ds_write_b128 v10, v[48:51]
    ds_write_b128 v11, v[52:55]
    ds_write_b128 v12, v[56:59]
    ds_write_b128 v13, v[60:63]
    ds_write_b128 v14, v[64:67]
    ds_write_b128 v15, v[68:71]
    s_add_u32 s46, s45, 2359296
    buffer_load_dwordx4 v[24:27], v4, s[12:15], s46 offen
    buffer_load_dwordx4 v[28:31], v5, s[12:15], s46 offen
    buffer_load_dwordx4 v[32:35], v6, s[12:15], s46 offen
    buffer_load_dwordx4 v[36:39], v7, s[12:15], s46 offen
    buffer_load_dwordx4 v[40:43], v8, s[12:15], s46 offen
    buffer_load_dwordx4 v[44:47], v9, s[12:15], s46 offen
    s_waitcnt lgkmcnt(0)
    s_barrier
    ds_read_b64_tr_b16 a[8:9], v16 offset:0
    ds_read_b64_tr_b16 a[10:11], v16 offset:800
    ds_read_b64_tr_b16 a[12:13], v16 offset:12800
    ds_read_b64_tr_b16 a[14:15], v16 offset:13600
    ds_read_b64_tr_b16 a[88:89], v16 offset:32
    ds_read_b64_tr_b16 a[90:91], v16 offset:832
    ds_read_b64_tr_b16 a[92:93], v16 offset:12832
    ds_read_b64_tr_b16 a[94:95], v16 offset:13632
    ds_read_b64_tr_b16 a[168:169], v16 offset:64
    ds_read_b64_tr_b16 a[170:171], v16 offset:864
    ds_read_b64_tr_b16 a[172:173], v16 offset:12864
    ds_read_b64_tr_b16 a[174:175], v16 offset:13664
    s_waitcnt lgkmcnt(0)
    s_barrier
    s_waitcnt vmcnt(6)
    ds_write_b128 v10, v[72:75]
    ds_write_b128 v11, v[76:79]
    ds_write_b128 v12, v[80:83]
    ds_write_b128 v13, v[84:87]
    ds_write_b128 v14, v[88:91]
    ds_write_b128 v15, v[92:95]
    s_add_u32 s46, s45, 3145728
    buffer_load_dwordx4 v[48:51], v4, s[12:15], s46 offen
    buffer_load_dwordx4 v[52:55], v5, s[12:15], s46 offen
    buffer_load_dwordx4 v[56:59], v6, s[12:15], s46 offen
    buffer_load_dwordx4 v[60:63], v7, s[12:15], s46 offen
    buffer_load_dwordx4 v[64:67], v8, s[12:15], s46 offen
    buffer_load_dwordx4 v[68:71], v9, s[12:15], s46 offen
    s_waitcnt lgkmcnt(0)
    s_barrier
    ds_read_b64_tr_b16 a[16:17], v16 offset:0
    ds_read_b64_tr_b16 a[18:19], v16 offset:800
    ds_read_b64_tr_b16 a[20:21], v16 offset:12800
    ds_read_b64_tr_b16 a[22:23], v16 offset:13600
    ds_read_b64_tr_b16 a[96:97], v16 offset:32
    ds_read_b64_tr_b16 a[98:99], v16 offset:832
    ds_read_b64_tr_b16 a[100:101], v16 offset:12832
    ds_read_b64_tr_b16 a[102:103], v16 offset:13632
    ds_read_b64_tr_b16 a[176:177], v16 offset:64
    ds_read_b64_tr_b16 a[178:179], v16 offset:864
    ds_read_b64_tr_b16 a[180:181], v16 offset:12864
    ds_read_b64_tr_b16 a[182:183], v16 offset:13664
    s_waitcnt lgkmcnt(0)
    s_barrier
    s_waitcnt vmcnt(6)
    ds_write_b128 v10, v[24:27]
    ds_write_b128 v11, v[28:31]
    ds_write_b128 v12, v[32:35]
    ds_write_b128 v13, v[36:39]
    ds_write_b128 v14, v[40:43]
    ds_write_b128 v15, v[44:47]
    s_add_u32 s46, s45, 3932160
    buffer_load_dwordx4 v[72:75], v4, s[12:15], s46 offen
    buffer_load_dwordx4 v[76:79], v5, s[12:15], s46 offen
    buffer_load_dwordx4 v[80:83], v6, s[12:15], s46 offen
    buffer_load_dwordx4 v[84:87], v7, s[12:15], s46 offen
    buffer_load_dwordx4 v[88:91], v8, s[12:15], s46 offen
    buffer_load_dwordx4 v[92:95], v9, s[12:15], s46 offen
    s_waitcnt lgkmcnt(0)
    s_barrier
    ds_read_b64_tr_b16 a[24:25], v16 offset:0
    ds_read_b64_tr_b16 a[26:27], v16 offset:800
    ds_read_b64_tr_b16 a[28:29], v16 offset:12800
    ds_read_b64_tr_b16 a[30:31], v16 offset:13600
    ds_read_b64_tr_b16 a[104:105], v16 offset:32
    ds_read_b64_tr_b16 a[106:107], v16 offset:832
    ds_read_b64_tr_b16 a[108:109], v16 offset:12832
    ds_read_b64_tr_b16 a[110:111], v16 offset:13632
    ds_read_b64_tr_b16 a[184:185], v16 offset:64
    ds_read_b64_tr_b16 a[186:187], v16 offset:864
    ds_read_b64_tr_b16 a[188:189], v16 offset:12864
    ds_read_b64_tr_b16 a[190:191], v16 offset:13664
    s_waitcnt lgkmcnt(0)
    s_barrier
    s_waitcnt vmcnt(6)
    ds_write_b128 v10, v[48:51]
    ds_write_b128 v11, v[52:55]
    ds_write_b128 v12, v[56:59]
    ds_write_b128 v13, v[60:63]
    ds_write_b128 v14, v[64:67]
    ds_write_b128 v15, v[68:71]
    s_add_u32 s46, s45, 4718592
    buffer_load_dwordx4 v[24:27], v4, s[12:15], s46 offen
    buffer_load_dwordx4 v[28:31], v5, s[12:15], s46 offen
    buffer_load_dwordx4 v[32:35], v6, s[12:15], s46 offen
    buffer_load_dwordx4 v[36:39], v7, s[12:15], s46 offen
    buffer_load_dwordx4 v[40:43], v8, s[12:15], s46 offen
    buffer_load_dwordx4 v[44:47], v9, s[12:15], s46 offen
    s_waitcnt lgkmcnt(0)
    s_barrier
    ds_read_b64_tr_b16 a[32:33], v16 offset:0
    ds_read_b64_tr_b16 a[34:35], v16 offset:800
    ds_read_b64_tr_b16 a[36:37], v16 offset:12800
    ds_read_b64_tr_b16 a[38:39], v16 offset:13600
    ds_read_b64_tr_b16 a[112:113], v16 offset:32
    ds_read_b64_tr_b16 a[114:115], v16 offset:832
    ds_read_b64_tr_b16 a[116:117], v16 offset:12832
    ds_read_b64_tr_b16 a[118:119], v16 offset:13632
    ds_read_b64_tr_b16 a[192:193], v16 offset:64
    ds_read_b64_tr_b16 a[194:195], v16 offset:864
    ds_read_b64_tr_b16 a[196:197], v16 offset:12864
    ds_read_b64_tr_b16 a[198:199], v16 offset:13664
    s_waitcnt lgkmcnt(0)
    s_barrier
    s_waitcnt vmcnt(6)
    ds_write_b128 v10, v[72:75]
    ds_write_b128 v11, v[76:79]
    ds_write_b128 v12, v[80:83]
    ds_write_b128 v13, v[84:87]
    ds_write_b128 v14, v[88:91]
    ds_write_b128 v15, v[92:95]
    s_add_u32 s46, s45, 5505024
    buffer_load_dwordx4 v[48:51], v4, s[12:15], s46 offen
    buffer_load_dwordx4 v[52:55], v5, s[12:15], s46 offen
    buffer_load_dwordx4 v[56:59], v6, s[12:15], s46 offen
    buffer_load_dwordx4 v[60:63], v7, s[12:15], s46 offen
    buffer_load_dwordx4 v[64:67], v8, s[12:15], s46 offen
    buffer_load_dwordx4 v[68:71], v9, s[12:15], s46 offen
    s_waitcnt lgkmcnt(0)
    s_barrier
    ds_read_b64_tr_b16 a[40:41], v16 offset:0
    ds_read_b64_tr_b16 a[42:43], v16 offset:800
    ds_read_b64_tr_b16 a[44:45], v16 offset:12800
    ds_read_b64_tr_b16 a[46:47], v16 offset:13600
    ds_read_b64_tr_b16 a[120:121], v16 offset:32
    ds_read_b64_tr_b16 a[122:123], v16 offset:832
    ds_read_b64_tr_b16 a[124:125], v16 offset:12832
    ds_read_b64_tr_b16 a[126:127], v16 offset:13632
    ds_read_b64_tr_b16 a[200:201], v16 offset:64
    ds_read_b64_tr_b16 a[202:203], v16 offset:864
    ds_read_b64_tr_b16 a[204:205], v16 offset:12864
    ds_read_b64_tr_b16 a[206:207], v16 offset:13664
    s_waitcnt lgkmcnt(0)
    s_barrier
    s_waitcnt vmcnt(6)
    ds_write_b128 v10, v[24:27]
    ds_write_b128 v11, v[28:31]
    ds_write_b128 v12, v[32:35]
    ds_write_b128 v13, v[36:39]
    ds_write_b128 v14, v[40:43]
    ds_write_b128 v15, v[44:47]
    s_add_u32 s46, s45, 6291456
    buffer_load_dwordx4 v[72:75], v4, s[12:15], s46 offen
    buffer_load_dwordx4 v[76:79], v5, s[12:15], s46 offen
    buffer_load_dwordx4 v[80:83], v6, s[12:15], s46 offen
    buffer_load_dwordx4 v[84:87], v7, s[12:15], s46 offen
    buffer_load_dwordx4 v[88:91], v8, s[12:15], s46 offen
    buffer_load_dwordx4 v[92:95], v9, s[12:15], s46 offen
    s_waitcnt lgkmcnt(0)
    s_barrier
    ds_read_b64_tr_b16 a[48:49], v16 offset:0
    ds_read_b64_tr_b16 a[50:51], v16 offset:800
    ds_read_b64_tr_b16 a[52:53], v16 offset:12800
    ds_read_b64_tr_b16 a[54:55], v16 offset:13600
    ds_read_b64_tr_b16 a[128:129], v16 offset:32
    ds_read_b64_tr_b16 a[130:131], v16 offset:832
    ds_read_b64_tr_b16 a[132:133], v16 offset:12832
    ds_read_b64_tr_b16 a[134:135], v16 offset:13632
    ds_read_b64_tr_b16 a[208:209], v16 offset:64
    ds_read_b64_tr_b16 a[210:211], v16 offset:864
    ds_read_b64_tr_b16 a[212:213], v16 offset:12864
    ds_read_b64_tr_b16 a[214:215], v16 offset:13664
    s_waitcnt lgkmcnt(0)
    s_barrier
    s_waitcnt vmcnt(6)
    ds_write_b128 v10, v[48:51]
    ds_write_b128 v11, v[52:55]
    ds_write_b128 v12, v[56:59]
    ds_write_b128 v13, v[60:63]
    ds_write_b128 v14, v[64:67]
    ds_write_b128 v15, v[68:71]
    s_add_u32 s46, s45, 7077888
    buffer_load_dwordx4 v[24:27], v4, s[12:15], s46 offen
    buffer_load_dwordx4 v[28:31], v5, s[12:15], s46 offen
    buffer_load_dwordx4 v[32:35], v6, s[12:15], s46 offen
    buffer_load_dwordx4 v[36:39], v7, s[12:15], s46 offen
    buffer_load_dwordx4 v[40:43], v8, s[12:15], s46 offen
    buffer_load_dwordx4 v[44:47], v9, s[12:15], s46 offen
    s_waitcnt lgkmcnt(0)
    s_barrier
    ds_read_b64_tr_b16 a[56:57], v16 offset:0
    ds_read_b64_tr_b16 a[58:59], v16 offset:800
    ds_read_b64_tr_b16 a[60:61], v16 offset:12800
    ds_read_b64_tr_b16 a[62:63], v16 offset:13600
    ds_read_b64_tr_b16 a[136:137], v16 offset:32
    ds_read_b64_tr_b16 a[138:139], v16 offset:832
    ds_read_b64_tr_b16 a[140:141], v16 offset:12832
    ds_read_b64_tr_b16 a[142:143], v16 offset:13632
    ds_read_b64_tr_b16 a[216:217], v16 offset:64
    ds_read_b64_tr_b16 a[218:219], v16 offset:864
    ds_read_b64_tr_b16 a[220:221], v16 offset:12864
    ds_read_b64_tr_b16 a[222:223], v16 offset:13664
    s_waitcnt lgkmcnt(0)
    s_barrier
    s_waitcnt vmcnt(6)
    ds_write_b128 v10, v[72:75]
    ds_write_b128 v11, v[76:79]
    ds_write_b128 v12, v[80:83]
    ds_write_b128 v13, v[84:87]
    ds_write_b128 v14, v[88:91]
    ds_write_b128 v15, v[92:95]
    s_waitcnt lgkmcnt(0)
    s_barrier
    ds_read_b64_tr_b16 a[64:65], v16 offset:0
    ds_read_b64_tr_b16 a[66:67], v16 offset:800
    ds_read_b64_tr_b16 a[68:69], v16 offset:12800
    ds_read_b64_tr_b16 a[70:71], v16 offset:13600
    ds_read_b64_tr_b16 a[144:145], v16 offset:32
    ds_read_b64_tr_b16 a[146:147], v16 offset:832
    ds_read_b64_tr_b16 a[148:149], v16 offset:12832
    ds_read_b64_tr_b16 a[150:151], v16 offset:13632
    ds_read_b64_tr_b16 a[224:225], v16 offset:64
    ds_read_b64_tr_b16 a[226:227], v16 offset:864
    ds_read_b64_tr_b16 a[228:229], v16 offset:12864
    ds_read_b64_tr_b16 a[230:231], v16 offset:13664
    s_waitcnt lgkmcnt(0)
    s_barrier
    s_waitcnt vmcnt(0)
    ds_write_b128 v10, v[24:27]
    ds_write_b128 v11, v[28:31]
    ds_write_b128 v12, v[32:35]
    ds_write_b128 v13, v[36:39]
    ds_write_b128 v14, v[40:43]
    ds_write_b128 v15, v[44:47]
    s_waitcnt lgkmcnt(0)
    s_barrier
    ds_read_b64_tr_b16 a[72:73], v16 offset:0
    ds_read_b64_tr_b16 a[74:75], v16 offset:800
    ds_read_b64_tr_b16 a[76:77], v16 offset:12800
    ds_read_b64_tr_b16 a[78:79], v16 offset:13600
    ds_read_b64_tr_b16 a[152:153], v16 offset:32
    ds_read_b64_tr_b16 a[154:155], v16 offset:832
    ds_read_b64_tr_b16 a[156:157], v16 offset:12832
    ds_read_b64_tr_b16 a[158:159], v16 offset:13632
    ds_read_b64_tr_b16 a[232:233], v16 offset:64
    ds_read_b64_tr_b16 a[234:235], v16 offset:864
    ds_read_b64_tr_b16 a[236:237], v16 offset:12864
    ds_read_b64_tr_b16 a[238:239], v16 offset:13664
    s_waitcnt lgkmcnt(0)
    s_barrier
    v_add_u32 v64, 0, v0
    s_mov_b32 s24, 1639
    v_mul_lo_u32 v65, v64, s24
    v_lshrrev_b32 v65, 16, v65
    v_mul_u32_u24 v66, 40, v65
    v_sub_u32 v66, v64, v66
    s_mov_b32 s24, 1280
    v_mul_lo_u32 v4, v65, s24
    v_lshl_add_u32 v4, v66, 4, v4
    v_mul_u32_u24 v14, 656, v65
    v_lshl_add_u32 v14, v66, 4, v14
    v_add_u32 v14, 90112, v14
    v_add_u32 v64, 256, v0
    s_mov_b32 s24, 1639
    v_mul_lo_u32 v65, v64, s24
    v_lshrrev_b32 v65, 16, v65
    v_mul_u32_u24 v66, 40, v65
    v_sub_u32 v66, v64, v66
    s_mov_b32 s24, 1280
    v_mul_lo_u32 v5, v65, s24
    v_lshl_add_u32 v5, v66, 4, v5
    v_mul_u32_u24 v15, 656, v65
    v_lshl_add_u32 v15, v66, 4, v15
    v_add_u32 v15, 90112, v15
    v_add_u32 v64, 512, v0
    s_mov_b32 s24, 1639
    v_mul_lo_u32 v65, v64, s24
    v_lshrrev_b32 v65, 16, v65
    v_mul_u32_u24 v66, 40, v65
    v_sub_u32 v66, v64, v66
    s_mov_b32 s24, 1280
    v_mul_lo_u32 v6, v65, s24
    v_lshl_add_u32 v6, v66, 4, v6
    v_mul_u32_u24 v16, 656, v65
    v_lshl_add_u32 v16, v66, 4, v16
    v_add_u32 v16, 90112, v16
    v_add_u32 v64, 768, v0
    s_mov_b32 s24, 1639
    v_mul_lo_u32 v65, v64, s24
    v_lshrrev_b32 v65, 16, v65
    v_mul_u32_u24 v66, 40, v65
    v_sub_u32 v66, v64, v66
    s_mov_b32 s24, 1280
    v_mul_lo_u32 v7, v65, s24
    v_lshl_add_u32 v7, v66, 4, v7
    v_mul_u32_u24 v17, 656, v65
    v_lshl_add_u32 v17, v66, 4, v17
    v_add_u32 v17, 90112, v17
    v_add_u32 v64, 1024, v0
    s_mov_b32 s24, 1639
    v_mul_lo_u32 v65, v64, s24
    v_lshrrev_b32 v65, 16, v65
    v_mul_u32_u24 v66, 40, v65
    v_sub_u32 v66, v64, v66
    s_mov_b32 s24, 1280
    v_mul_lo_u32 v8, v65, s24
    v_lshl_add_u32 v8, v66, 4, v8
    v_mul_u32_u24 v18, 656, v65
    v_lshl_add_u32 v18, v66, 4, v18
    v_add_u32 v18, 90112, v18
    v_add_u32 v64, 1280, v0
    s_mov_b32 s24, 1639
    v_mul_lo_u32 v65, v64, s24
    v_lshrrev_b32 v65, 16, v65
    v_mul_u32_u24 v66, 40, v65
    v_sub_u32 v66, v64, v66
    s_mov_b32 s24, 1280
    v_mul_lo_u32 v9, v65, s24
    v_lshl_add_u32 v9, v66, 4, v9
    v_mul_u32_u24 v19, 656, v65
    v_lshl_add_u32 v19, v66, 4, v19
    v_add_u32 v19, 90112, v19
    v_add_u32 v64, 1536, v0
    s_mov_b32 s24, 1639
    v_mul_lo_u32 v65, v64, s24
    v_lshrrev_b32 v65, 16, v65
    v_mul_u32_u24 v66, 40, v65
    v_sub_u32 v66, v64, v66
    s_mov_b32 s24, 1280
    v_mul_lo_u32 v10, v65, s24
    v_lshl_add_u32 v10, v66, 4, v10
    v_mul_u32_u24 v20, 656, v65
    v_lshl_add_u32 v20, v66, 4, v20
    v_add_u32 v20, 90112, v20
    v_add_u32 v64, 1792, v0
    s_mov_b32 s24, 1639
    v_mul_lo_u32 v65, v64, s24
    v_lshrrev_b32 v65, 16, v65
    v_mul_u32_u24 v66, 40, v65
    v_sub_u32 v66, v64, v66
    s_mov_b32 s24, 1280
    v_mul_lo_u32 v11, v65, s24
    v_lshl_add_u32 v11, v66, 4, v11
    v_mul_u32_u24 v21, 656, v65
    v_lshl_add_u32 v21, v66, 4, v21
    v_add_u32 v21, 90112, v21
    v_add_u32 v64, 2048, v0
    s_mov_b32 s24, 1639
    v_mul_lo_u32 v65, v64, s24
    v_lshrrev_b32 v65, 16, v65
    v_mul_u32_u24 v66, 40, v65
    v_sub_u32 v66, v64, v66
    s_mov_b32 s24, 1280
    v_mul_lo_u32 v12, v65, s24
    v_lshl_add_u32 v12, v66, 4, v12
    v_mul_u32_u24 v22, 656, v65
    v_lshl_add_u32 v22, v66, 4, v22
    v_add_u32 v22, 90112, v22
    v_add_u32 v64, 2304, v0
    s_mov_b32 s24, 1639
    v_mul_lo_u32 v65, v64, s24
    v_lshrrev_b32 v65, 16, v65
    v_mul_u32_u24 v66, 40, v65
    v_sub_u32 v66, v64, v66
    s_mov_b32 s24, 1280
    v_mul_lo_u32 v13, v65, s24
    v_lshl_add_u32 v13, v66, 4, v13
    v_mul_u32_u24 v23, 656, v65
    v_lshl_add_u32 v23, v66, 4, v23
    v_add_u32 v23, 90112, v23
    v_lshrrev_b32 v64, 1, v3
    v_lshlrev_b32 v64, 4, v64
    v_and_b32 v65, 1, v3
    v_lshl_add_u32 v64, v65, 2, v64
    v_lshrrev_b32 v65, 2, v2
    v_and_b32 v66, 1, v65
    v_add_u32 v64, v64, v66
    v_lshrrev_b32 v65, 1, v65
    v_lshl_add_u32 v64, v65, 3, v64
    v_mul_u32_u24 v72, 656, v64
    v_and_b32 v65, 3, v2
    v_lshl_add_u32 v72, v65, 3, v72
    v_add_u32 v72, 90112, v72
    s_and_b32 s24, s3, 1
    s_mul_i32 s24, s24, 320
    v_add_u32 v72, s24, v72
    v_lshlrev_b32 v73, 4, v1
    s_mul_i32 s24, s3, 18432
    s_add_u32 s24, s24, 16384
    v_add_u32 v73, s24, v73
    s_mul_i32 s45, s44, 245760
    s_add_u32 s46, s45, 0
    buffer_load_dwordx4 v[24:27], v4, s[16:19], s46 offen
    buffer_load_dwordx4 v[28:31], v5, s[16:19], s46 offen
    buffer_load_dwordx4 v[32:35], v6, s[16:19], s46 offen
    buffer_load_dwordx4 v[36:39], v7, s[16:19], s46 offen
    buffer_load_dwordx4 v[40:43], v8, s[16:19], s46 offen
    buffer_load_dwordx4 v[44:47], v9, s[16:19], s46 offen
    buffer_load_dwordx4 v[48:51], v10, s[16:19], s46 offen
    buffer_load_dwordx4 v[52:55], v11, s[16:19], s46 offen
    buffer_load_dwordx4 v[56:59], v12, s[16:19], s46 offen
    buffer_load_dwordx4 v[60:63], v13, s[16:19], s46 offen
    s_waitcnt vmcnt(0)
    ds_write_b128 v14, v[24:27]
    ds_write_b128 v15, v[28:31]
    ds_write_b128 v16, v[32:35]
    ds_write_b128 v17, v[36:39]
    ds_write_b128 v18, v[40:43]
    ds_write_b128 v19, v[44:47]
    ds_write_b128 v20, v[48:51]
    ds_write_b128 v21, v[52:55]
    ds_write_b128 v22, v[56:59]
    ds_write_b128 v23, v[60:63]
    s_waitcnt lgkmcnt(0)
    s_barrier
    s_lshr_b32 s24, s3, 1
    s_cmp_eq_u32 s24, 0
    s_cbranch_scc0 interleave_layers__linear_attn_block__memory_aug_recurrent_mem_tr__prompt_kernel_wo20
    ds_read_b64_tr_b16 a[240:241], v72 offset:0
    ds_read_b64_tr_b16 a[242:243], v72 offset:1312
    ds_read_b64_tr_b16 a[244:245], v72 offset:20992
    ds_read_b64_tr_b16 a[246:247], v72 offset:22304
    ds_read_b64_tr_b16 v[112:113], v72 offset:32
    ds_read_b64_tr_b16 v[114:115], v72 offset:1344
    ds_read_b64_tr_b16 v[116:117], v72 offset:21024
    ds_read_b64_tr_b16 v[118:119], v72 offset:22336
    ds_read_b64_tr_b16 v[136:137], v72 offset:64
    ds_read_b64_tr_b16 v[138:139], v72 offset:1376
    ds_read_b64_tr_b16 v[140:141], v72 offset:21056
    ds_read_b64_tr_b16 v[142:143], v72 offset:22368
    ds_read_b64_tr_b16 v[160:161], v72 offset:96
    ds_read_b64_tr_b16 v[162:163], v72 offset:1408
    ds_read_b64_tr_b16 v[164:165], v72 offset:21088
    ds_read_b64_tr_b16 v[166:167], v72 offset:22400
    ds_read_b64_tr_b16 v[184:185], v72 offset:128
    ds_read_b64_tr_b16 v[186:187], v72 offset:1440
    ds_read_b64_tr_b16 v[188:189], v72 offset:21120
    ds_read_b64_tr_b16 v[190:191], v72 offset:22432
    ds_read_b64_tr_b16 v[208:209], v72 offset:160
    ds_read_b64_tr_b16 v[210:211], v72 offset:1472
    ds_read_b64_tr_b16 v[212:213], v72 offset:21152
    ds_read_b64_tr_b16 v[214:215], v72 offset:22464
    ds_read_b64_tr_b16 v[232:233], v72 offset:192
    ds_read_b64_tr_b16 v[234:235], v72 offset:1504
    ds_read_b64_tr_b16 v[236:237], v72 offset:21184
    ds_read_b64_tr_b16 v[238:239], v72 offset:22496
    ds_read_b64_tr_b16 v[64:65], v72 offset:224
    ds_read_b64_tr_b16 v[66:67], v72 offset:1536
    ds_read_b64_tr_b16 v[68:69], v72 offset:21216
    ds_read_b64_tr_b16 v[70:71], v72 offset:22528
    s_waitcnt lgkmcnt(0)
    ds_write_b128 v73, v[64:67] offset:0
    ds_write_b128 v73, v[68:71] offset:1024
    s_waitcnt lgkmcnt(0)
    ds_read_b64_tr_b16 v[64:65], v72 offset:256
    ds_read_b64_tr_b16 v[66:67], v72 offset:1568
    ds_read_b64_tr_b16 v[68:69], v72 offset:21248
    ds_read_b64_tr_b16 v[70:71], v72 offset:22560
    s_waitcnt lgkmcnt(0)
    ds_write_b128 v73, v[64:67] offset:6144
    ds_write_b128 v73, v[68:71] offset:7168
    s_waitcnt lgkmcnt(0)
    ds_read_b64_tr_b16 v[64:65], v72 offset:288
    ds_read_b64_tr_b16 v[66:67], v72 offset:1600
    ds_read_b64_tr_b16 v[68:69], v72 offset:21280
    ds_read_b64_tr_b16 v[70:71], v72 offset:22592
    s_waitcnt lgkmcnt(0)
    ds_write_b128 v73, v[64:67] offset:12288
    ds_write_b128 v73, v[68:71] offset:13312
    s_waitcnt lgkmcnt(0)
    s_waitcnt lgkmcnt(0)
interleave_layers__linear_attn_block__memory_aug_recurrent_mem_tr__prompt_kernel_wo20:
    s_barrier
    s_add_u32 s46, s45, 640
    buffer_load_dwordx4 v[24:27], v4, s[16:19], s46 offen
    buffer_load_dwordx4 v[28:31], v5, s[16:19], s46 offen
    buffer_load_dwordx4 v[32:35], v6, s[16:19], s46 offen
    buffer_load_dwordx4 v[36:39], v7, s[16:19], s46 offen
    buffer_load_dwordx4 v[40:43], v8, s[16:19], s46 offen
    buffer_load_dwordx4 v[44:47], v9, s[16:19], s46 offen
    buffer_load_dwordx4 v[48:51], v10, s[16:19], s46 offen
    buffer_load_dwordx4 v[52:55], v11, s[16:19], s46 offen
    buffer_load_dwordx4 v[56:59], v12, s[16:19], s46 offen
    buffer_load_dwordx4 v[60:63], v13, s[16:19], s46 offen
    s_waitcnt vmcnt(0)
    ds_write_b128 v14, v[24:27]
    ds_write_b128 v15, v[28:31]
    ds_write_b128 v16, v[32:35]
    ds_write_b128 v17, v[36:39]
    ds_write_b128 v18, v[40:43]
    ds_write_b128 v19, v[44:47]
    ds_write_b128 v20, v[48:51]
    ds_write_b128 v21, v[52:55]
    ds_write_b128 v22, v[56:59]
    ds_write_b128 v23, v[60:63]
    s_waitcnt lgkmcnt(0)
    s_barrier
    s_lshr_b32 s24, s3, 1
    s_cmp_eq_u32 s24, 1
    s_cbranch_scc0 interleave_layers__linear_attn_block__memory_aug_recurrent_mem_tr__prompt_kernel_wo21
    ds_read_b64_tr_b16 a[240:241], v72 offset:0
    ds_read_b64_tr_b16 a[242:243], v72 offset:1312
    ds_read_b64_tr_b16 a[244:245], v72 offset:20992
    ds_read_b64_tr_b16 a[246:247], v72 offset:22304
    ds_read_b64_tr_b16 v[112:113], v72 offset:32
    ds_read_b64_tr_b16 v[114:115], v72 offset:1344
    ds_read_b64_tr_b16 v[116:117], v72 offset:21024
    ds_read_b64_tr_b16 v[118:119], v72 offset:22336
    ds_read_b64_tr_b16 v[136:137], v72 offset:64
    ds_read_b64_tr_b16 v[138:139], v72 offset:1376
    ds_read_b64_tr_b16 v[140:141], v72 offset:21056
    ds_read_b64_tr_b16 v[142:143], v72 offset:22368
    ds_read_b64_tr_b16 v[160:161], v72 offset:96
    ds_read_b64_tr_b16 v[162:163], v72 offset:1408
    ds_read_b64_tr_b16 v[164:165], v72 offset:21088
    ds_read_b64_tr_b16 v[166:167], v72 offset:22400
    ds_read_b64_tr_b16 v[184:185], v72 offset:128
    ds_read_b64_tr_b16 v[186:187], v72 offset:1440
    ds_read_b64_tr_b16 v[188:189], v72 offset:21120
    ds_read_b64_tr_b16 v[190:191], v72 offset:22432
    ds_read_b64_tr_b16 v[208:209], v72 offset:160
    ds_read_b64_tr_b16 v[210:211], v72 offset:1472
    ds_read_b64_tr_b16 v[212:213], v72 offset:21152
    ds_read_b64_tr_b16 v[214:215], v72 offset:22464
    ds_read_b64_tr_b16 v[232:233], v72 offset:192
    ds_read_b64_tr_b16 v[234:235], v72 offset:1504
    ds_read_b64_tr_b16 v[236:237], v72 offset:21184
    ds_read_b64_tr_b16 v[238:239], v72 offset:22496
    ds_read_b64_tr_b16 v[64:65], v72 offset:224
    ds_read_b64_tr_b16 v[66:67], v72 offset:1536
    ds_read_b64_tr_b16 v[68:69], v72 offset:21216
    ds_read_b64_tr_b16 v[70:71], v72 offset:22528
    s_waitcnt lgkmcnt(0)
    ds_write_b128 v73, v[64:67] offset:0
    ds_write_b128 v73, v[68:71] offset:1024
    s_waitcnt lgkmcnt(0)
    ds_read_b64_tr_b16 v[64:65], v72 offset:256
    ds_read_b64_tr_b16 v[66:67], v72 offset:1568
    ds_read_b64_tr_b16 v[68:69], v72 offset:21248
    ds_read_b64_tr_b16 v[70:71], v72 offset:22560
    s_waitcnt lgkmcnt(0)
    ds_write_b128 v73, v[64:67] offset:6144
    ds_write_b128 v73, v[68:71] offset:7168
    s_waitcnt lgkmcnt(0)
    ds_read_b64_tr_b16 v[64:65], v72 offset:288
    ds_read_b64_tr_b16 v[66:67], v72 offset:1600
    ds_read_b64_tr_b16 v[68:69], v72 offset:21280
    ds_read_b64_tr_b16 v[70:71], v72 offset:22592
    s_waitcnt lgkmcnt(0)
    ds_write_b128 v73, v[64:67] offset:12288
    ds_write_b128 v73, v[68:71] offset:13312
    s_waitcnt lgkmcnt(0)
    s_waitcnt lgkmcnt(0)
interleave_layers__linear_attn_block__memory_aug_recurrent_mem_tr__prompt_kernel_wo21:
    s_barrier
    s_add_u32 s46, s45, 81920
    buffer_load_dwordx4 v[24:27], v4, s[16:19], s46 offen
    buffer_load_dwordx4 v[28:31], v5, s[16:19], s46 offen
    buffer_load_dwordx4 v[32:35], v6, s[16:19], s46 offen
    buffer_load_dwordx4 v[36:39], v7, s[16:19], s46 offen
    buffer_load_dwordx4 v[40:43], v8, s[16:19], s46 offen
    buffer_load_dwordx4 v[44:47], v9, s[16:19], s46 offen
    buffer_load_dwordx4 v[48:51], v10, s[16:19], s46 offen
    buffer_load_dwordx4 v[52:55], v11, s[16:19], s46 offen
    buffer_load_dwordx4 v[56:59], v12, s[16:19], s46 offen
    buffer_load_dwordx4 v[60:63], v13, s[16:19], s46 offen
    s_waitcnt vmcnt(0)
    ds_write_b128 v14, v[24:27]
    ds_write_b128 v15, v[28:31]
    ds_write_b128 v16, v[32:35]
    ds_write_b128 v17, v[36:39]
    ds_write_b128 v18, v[40:43]
    ds_write_b128 v19, v[44:47]
    ds_write_b128 v20, v[48:51]
    ds_write_b128 v21, v[52:55]
    ds_write_b128 v22, v[56:59]
    ds_write_b128 v23, v[60:63]
    s_waitcnt lgkmcnt(0)
    s_barrier
    s_lshr_b32 s24, s3, 1
    s_cmp_eq_u32 s24, 0
    s_cbranch_scc0 interleave_layers__linear_attn_block__memory_aug_recurrent_mem_tr__prompt_kernel_wo22
    ds_read_b64_tr_b16 a[248:249], v72 offset:0
    ds_read_b64_tr_b16 a[250:251], v72 offset:1312
    ds_read_b64_tr_b16 a[252:253], v72 offset:20992
    ds_read_b64_tr_b16 a[254:255], v72 offset:22304
    ds_read_b64_tr_b16 v[120:121], v72 offset:32
    ds_read_b64_tr_b16 v[122:123], v72 offset:1344
    ds_read_b64_tr_b16 v[124:125], v72 offset:21024
    ds_read_b64_tr_b16 v[126:127], v72 offset:22336
    ds_read_b64_tr_b16 v[144:145], v72 offset:64
    ds_read_b64_tr_b16 v[146:147], v72 offset:1376
    ds_read_b64_tr_b16 v[148:149], v72 offset:21056
    ds_read_b64_tr_b16 v[150:151], v72 offset:22368
    ds_read_b64_tr_b16 v[168:169], v72 offset:96
    ds_read_b64_tr_b16 v[170:171], v72 offset:1408
    ds_read_b64_tr_b16 v[172:173], v72 offset:21088
    ds_read_b64_tr_b16 v[174:175], v72 offset:22400
    ds_read_b64_tr_b16 v[192:193], v72 offset:128
    ds_read_b64_tr_b16 v[194:195], v72 offset:1440
    ds_read_b64_tr_b16 v[196:197], v72 offset:21120
    ds_read_b64_tr_b16 v[198:199], v72 offset:22432
    ds_read_b64_tr_b16 v[216:217], v72 offset:160
    ds_read_b64_tr_b16 v[218:219], v72 offset:1472
    ds_read_b64_tr_b16 v[220:221], v72 offset:21152
    ds_read_b64_tr_b16 v[222:223], v72 offset:22464
    ds_read_b64_tr_b16 v[240:241], v72 offset:192
    ds_read_b64_tr_b16 v[242:243], v72 offset:1504
    ds_read_b64_tr_b16 v[244:245], v72 offset:21184
    ds_read_b64_tr_b16 v[246:247], v72 offset:22496
    ds_read_b64_tr_b16 v[64:65], v72 offset:224
    ds_read_b64_tr_b16 v[66:67], v72 offset:1536
    ds_read_b64_tr_b16 v[68:69], v72 offset:21216
    ds_read_b64_tr_b16 v[70:71], v72 offset:22528
    s_waitcnt lgkmcnt(0)
    ds_write_b128 v73, v[64:67] offset:2048
    ds_write_b128 v73, v[68:71] offset:3072
    s_waitcnt lgkmcnt(0)
    ds_read_b64_tr_b16 v[64:65], v72 offset:256
    ds_read_b64_tr_b16 v[66:67], v72 offset:1568
    ds_read_b64_tr_b16 v[68:69], v72 offset:21248
    ds_read_b64_tr_b16 v[70:71], v72 offset:22560
    s_waitcnt lgkmcnt(0)
    ds_write_b128 v73, v[64:67] offset:8192
    ds_write_b128 v73, v[68:71] offset:9216
    s_waitcnt lgkmcnt(0)
    ds_read_b64_tr_b16 v[64:65], v72 offset:288
    ds_read_b64_tr_b16 v[66:67], v72 offset:1600
    ds_read_b64_tr_b16 v[68:69], v72 offset:21280
    ds_read_b64_tr_b16 v[70:71], v72 offset:22592
    s_waitcnt lgkmcnt(0)
    ds_write_b128 v73, v[64:67] offset:14336
    ds_write_b128 v73, v[68:71] offset:15360
    s_waitcnt lgkmcnt(0)
    s_waitcnt lgkmcnt(0)
interleave_layers__linear_attn_block__memory_aug_recurrent_mem_tr__prompt_kernel_wo22:
    s_barrier
    s_add_u32 s46, s45, 82560
    buffer_load_dwordx4 v[24:27], v4, s[16:19], s46 offen
    buffer_load_dwordx4 v[28:31], v5, s[16:19], s46 offen
    buffer_load_dwordx4 v[32:35], v6, s[16:19], s46 offen
    buffer_load_dwordx4 v[36:39], v7, s[16:19], s46 offen
    buffer_load_dwordx4 v[40:43], v8, s[16:19], s46 offen
    buffer_load_dwordx4 v[44:47], v9, s[16:19], s46 offen
    buffer_load_dwordx4 v[48:51], v10, s[16:19], s46 offen
    buffer_load_dwordx4 v[52:55], v11, s[16:19], s46 offen
    buffer_load_dwordx4 v[56:59], v12, s[16:19], s46 offen
    buffer_load_dwordx4 v[60:63], v13, s[16:19], s46 offen
    s_waitcnt vmcnt(0)
    ds_write_b128 v14, v[24:27]
    ds_write_b128 v15, v[28:31]
    ds_write_b128 v16, v[32:35]
    ds_write_b128 v17, v[36:39]
    ds_write_b128 v18, v[40:43]
    ds_write_b128 v19, v[44:47]
    ds_write_b128 v20, v[48:51]
    ds_write_b128 v21, v[52:55]
    ds_write_b128 v22, v[56:59]
    ds_write_b128 v23, v[60:63]
    s_waitcnt lgkmcnt(0)
    s_barrier
    s_lshr_b32 s24, s3, 1
    s_cmp_eq_u32 s24, 1
    s_cbranch_scc0 interleave_layers__linear_attn_block__memory_aug_recurrent_mem_tr__prompt_kernel_wo23
    ds_read_b64_tr_b16 a[248:249], v72 offset:0
    ds_read_b64_tr_b16 a[250:251], v72 offset:1312
    ds_read_b64_tr_b16 a[252:253], v72 offset:20992
    ds_read_b64_tr_b16 a[254:255], v72 offset:22304
    ds_read_b64_tr_b16 v[120:121], v72 offset:32
    ds_read_b64_tr_b16 v[122:123], v72 offset:1344
    ds_read_b64_tr_b16 v[124:125], v72 offset:21024
    ds_read_b64_tr_b16 v[126:127], v72 offset:22336
    ds_read_b64_tr_b16 v[144:145], v72 offset:64
    ds_read_b64_tr_b16 v[146:147], v72 offset:1376
    ds_read_b64_tr_b16 v[148:149], v72 offset:21056
    ds_read_b64_tr_b16 v[150:151], v72 offset:22368
    ds_read_b64_tr_b16 v[168:169], v72 offset:96
    ds_read_b64_tr_b16 v[170:171], v72 offset:1408
    ds_read_b64_tr_b16 v[172:173], v72 offset:21088
    ds_read_b64_tr_b16 v[174:175], v72 offset:22400
    ds_read_b64_tr_b16 v[192:193], v72 offset:128
    ds_read_b64_tr_b16 v[194:195], v72 offset:1440
    ds_read_b64_tr_b16 v[196:197], v72 offset:21120
    ds_read_b64_tr_b16 v[198:199], v72 offset:22432
    ds_read_b64_tr_b16 v[216:217], v72 offset:160
    ds_read_b64_tr_b16 v[218:219], v72 offset:1472
    ds_read_b64_tr_b16 v[220:221], v72 offset:21152
    ds_read_b64_tr_b16 v[222:223], v72 offset:22464
    ds_read_b64_tr_b16 v[240:241], v72 offset:192
    ds_read_b64_tr_b16 v[242:243], v72 offset:1504
    ds_read_b64_tr_b16 v[244:245], v72 offset:21184
    ds_read_b64_tr_b16 v[246:247], v72 offset:22496
    ds_read_b64_tr_b16 v[64:65], v72 offset:224
    ds_read_b64_tr_b16 v[66:67], v72 offset:1536
    ds_read_b64_tr_b16 v[68:69], v72 offset:21216
    ds_read_b64_tr_b16 v[70:71], v72 offset:22528
    s_waitcnt lgkmcnt(0)
    ds_write_b128 v73, v[64:67] offset:2048
    ds_write_b128 v73, v[68:71] offset:3072
    s_waitcnt lgkmcnt(0)
    ds_read_b64_tr_b16 v[64:65], v72 offset:256
    ds_read_b64_tr_b16 v[66:67], v72 offset:1568
    ds_read_b64_tr_b16 v[68:69], v72 offset:21248
    ds_read_b64_tr_b16 v[70:71], v72 offset:22560
    s_waitcnt lgkmcnt(0)
    ds_write_b128 v73, v[64:67] offset:8192
    ds_write_b128 v73, v[68:71] offset:9216
    s_waitcnt lgkmcnt(0)
    ds_read_b64_tr_b16 v[64:65], v72 offset:288
    ds_read_b64_tr_b16 v[66:67], v72 offset:1600
    ds_read_b64_tr_b16 v[68:69], v72 offset:21280
    ds_read_b64_tr_b16 v[70:71], v72 offset:22592
    s_waitcnt lgkmcnt(0)
    ds_write_b128 v73, v[64:67] offset:14336
    ds_write_b128 v73, v[68:71] offset:15360
    s_waitcnt lgkmcnt(0)
    s_waitcnt lgkmcnt(0)
interleave_layers__linear_attn_block__memory_aug_recurrent_mem_tr__prompt_kernel_wo23:
    s_barrier
    s_add_u32 s46, s45, 163840
    buffer_load_dwordx4 v[24:27], v4, s[16:19], s46 offen
    buffer_load_dwordx4 v[28:31], v5, s[16:19], s46 offen
    buffer_load_dwordx4 v[32:35], v6, s[16:19], s46 offen
    buffer_load_dwordx4 v[36:39], v7, s[16:19], s46 offen
    buffer_load_dwordx4 v[40:43], v8, s[16:19], s46 offen
    buffer_load_dwordx4 v[44:47], v9, s[16:19], s46 offen
    buffer_load_dwordx4 v[48:51], v10, s[16:19], s46 offen
    buffer_load_dwordx4 v[52:55], v11, s[16:19], s46 offen
    buffer_load_dwordx4 v[56:59], v12, s[16:19], s46 offen
    buffer_load_dwordx4 v[60:63], v13, s[16:19], s46 offen
    s_waitcnt vmcnt(0)
    ds_write_b128 v14, v[24:27]
    ds_write_b128 v15, v[28:31]
    ds_write_b128 v16, v[32:35]
    ds_write_b128 v17, v[36:39]
    ds_write_b128 v18, v[40:43]
    ds_write_b128 v19, v[44:47]
    ds_write_b128 v20, v[48:51]
    ds_write_b128 v21, v[52:55]
    ds_write_b128 v22, v[56:59]
    ds_write_b128 v23, v[60:63]
    s_waitcnt lgkmcnt(0)
    s_barrier
    s_lshr_b32 s24, s3, 1
    s_cmp_eq_u32 s24, 0
    s_cbranch_scc0 interleave_layers__linear_attn_block__memory_aug_recurrent_mem_tr__prompt_kernel_wo24
    ds_read_b64_tr_b16 v[104:105], v72 offset:0
    ds_read_b64_tr_b16 v[106:107], v72 offset:1312
    ds_read_b64_tr_b16 v[108:109], v72 offset:20992
    ds_read_b64_tr_b16 v[110:111], v72 offset:22304
    ds_read_b64_tr_b16 v[128:129], v72 offset:32
    ds_read_b64_tr_b16 v[130:131], v72 offset:1344
    ds_read_b64_tr_b16 v[132:133], v72 offset:21024
    ds_read_b64_tr_b16 v[134:135], v72 offset:22336
    ds_read_b64_tr_b16 v[152:153], v72 offset:64
    ds_read_b64_tr_b16 v[154:155], v72 offset:1376
    ds_read_b64_tr_b16 v[156:157], v72 offset:21056
    ds_read_b64_tr_b16 v[158:159], v72 offset:22368
    ds_read_b64_tr_b16 v[176:177], v72 offset:96
    ds_read_b64_tr_b16 v[178:179], v72 offset:1408
    ds_read_b64_tr_b16 v[180:181], v72 offset:21088
    ds_read_b64_tr_b16 v[182:183], v72 offset:22400
    ds_read_b64_tr_b16 v[200:201], v72 offset:128
    ds_read_b64_tr_b16 v[202:203], v72 offset:1440
    ds_read_b64_tr_b16 v[204:205], v72 offset:21120
    ds_read_b64_tr_b16 v[206:207], v72 offset:22432
    ds_read_b64_tr_b16 v[224:225], v72 offset:160
    ds_read_b64_tr_b16 v[226:227], v72 offset:1472
    ds_read_b64_tr_b16 v[228:229], v72 offset:21152
    ds_read_b64_tr_b16 v[230:231], v72 offset:22464
    ds_read_b64_tr_b16 v[248:249], v72 offset:192
    ds_read_b64_tr_b16 v[250:251], v72 offset:1504
    ds_read_b64_tr_b16 v[252:253], v72 offset:21184
    ds_read_b64_tr_b16 v[254:255], v72 offset:22496
    ds_read_b64_tr_b16 v[64:65], v72 offset:224
    ds_read_b64_tr_b16 v[66:67], v72 offset:1536
    ds_read_b64_tr_b16 v[68:69], v72 offset:21216
    ds_read_b64_tr_b16 v[70:71], v72 offset:22528
    s_waitcnt lgkmcnt(0)
    ds_write_b128 v73, v[64:67] offset:4096
    ds_write_b128 v73, v[68:71] offset:5120
    s_waitcnt lgkmcnt(0)
    ds_read_b64_tr_b16 v[64:65], v72 offset:256
    ds_read_b64_tr_b16 v[66:67], v72 offset:1568
    ds_read_b64_tr_b16 v[68:69], v72 offset:21248
    ds_read_b64_tr_b16 v[70:71], v72 offset:22560
    s_waitcnt lgkmcnt(0)
    ds_write_b128 v73, v[64:67] offset:10240
    ds_write_b128 v73, v[68:71] offset:11264
    s_waitcnt lgkmcnt(0)
    ds_read_b64_tr_b16 v[64:65], v72 offset:288
    ds_read_b64_tr_b16 v[66:67], v72 offset:1600
    ds_read_b64_tr_b16 v[68:69], v72 offset:21280
    ds_read_b64_tr_b16 v[70:71], v72 offset:22592
    s_waitcnt lgkmcnt(0)
    ds_write_b128 v73, v[64:67] offset:16384
    ds_write_b128 v73, v[68:71] offset:17408
    s_waitcnt lgkmcnt(0)
    s_waitcnt lgkmcnt(0)
interleave_layers__linear_attn_block__memory_aug_recurrent_mem_tr__prompt_kernel_wo24:
    s_barrier
    s_add_u32 s46, s45, 164480
    buffer_load_dwordx4 v[24:27], v4, s[16:19], s46 offen
    buffer_load_dwordx4 v[28:31], v5, s[16:19], s46 offen
    buffer_load_dwordx4 v[32:35], v6, s[16:19], s46 offen
    buffer_load_dwordx4 v[36:39], v7, s[16:19], s46 offen
    buffer_load_dwordx4 v[40:43], v8, s[16:19], s46 offen
    buffer_load_dwordx4 v[44:47], v9, s[16:19], s46 offen
    buffer_load_dwordx4 v[48:51], v10, s[16:19], s46 offen
    buffer_load_dwordx4 v[52:55], v11, s[16:19], s46 offen
    buffer_load_dwordx4 v[56:59], v12, s[16:19], s46 offen
    buffer_load_dwordx4 v[60:63], v13, s[16:19], s46 offen
    s_waitcnt vmcnt(0)
    ds_write_b128 v14, v[24:27]
    ds_write_b128 v15, v[28:31]
    ds_write_b128 v16, v[32:35]
    ds_write_b128 v17, v[36:39]
    ds_write_b128 v18, v[40:43]
    ds_write_b128 v19, v[44:47]
    ds_write_b128 v20, v[48:51]
    ds_write_b128 v21, v[52:55]
    ds_write_b128 v22, v[56:59]
    ds_write_b128 v23, v[60:63]
    s_waitcnt lgkmcnt(0)
    s_barrier
    s_lshr_b32 s24, s3, 1
    s_cmp_eq_u32 s24, 1
    s_cbranch_scc0 interleave_layers__linear_attn_block__memory_aug_recurrent_mem_tr__prompt_kernel_wo25
    ds_read_b64_tr_b16 v[104:105], v72 offset:0
    ds_read_b64_tr_b16 v[106:107], v72 offset:1312
    ds_read_b64_tr_b16 v[108:109], v72 offset:20992
    ds_read_b64_tr_b16 v[110:111], v72 offset:22304
    ds_read_b64_tr_b16 v[128:129], v72 offset:32
    ds_read_b64_tr_b16 v[130:131], v72 offset:1344
    ds_read_b64_tr_b16 v[132:133], v72 offset:21024
    ds_read_b64_tr_b16 v[134:135], v72 offset:22336
    ds_read_b64_tr_b16 v[152:153], v72 offset:64
    ds_read_b64_tr_b16 v[154:155], v72 offset:1376
    ds_read_b64_tr_b16 v[156:157], v72 offset:21056
    ds_read_b64_tr_b16 v[158:159], v72 offset:22368
    ds_read_b64_tr_b16 v[176:177], v72 offset:96
    ds_read_b64_tr_b16 v[178:179], v72 offset:1408
    ds_read_b64_tr_b16 v[180:181], v72 offset:21088
    ds_read_b64_tr_b16 v[182:183], v72 offset:22400
    ds_read_b64_tr_b16 v[200:201], v72 offset:128
    ds_read_b64_tr_b16 v[202:203], v72 offset:1440
    ds_read_b64_tr_b16 v[204:205], v72 offset:21120
    ds_read_b64_tr_b16 v[206:207], v72 offset:22432
    ds_read_b64_tr_b16 v[224:225], v72 offset:160
    ds_read_b64_tr_b16 v[226:227], v72 offset:1472
    ds_read_b64_tr_b16 v[228:229], v72 offset:21152
    ds_read_b64_tr_b16 v[230:231], v72 offset:22464
    ds_read_b64_tr_b16 v[248:249], v72 offset:192
    ds_read_b64_tr_b16 v[250:251], v72 offset:1504
    ds_read_b64_tr_b16 v[252:253], v72 offset:21184
    ds_read_b64_tr_b16 v[254:255], v72 offset:22496
    ds_read_b64_tr_b16 v[64:65], v72 offset:224
    ds_read_b64_tr_b16 v[66:67], v72 offset:1536
    ds_read_b64_tr_b16 v[68:69], v72 offset:21216
    ds_read_b64_tr_b16 v[70:71], v72 offset:22528
    s_waitcnt lgkmcnt(0)
    ds_write_b128 v73, v[64:67] offset:4096
    ds_write_b128 v73, v[68:71] offset:5120
    s_waitcnt lgkmcnt(0)
    ds_read_b64_tr_b16 v[64:65], v72 offset:256
    ds_read_b64_tr_b16 v[66:67], v72 offset:1568
    ds_read_b64_tr_b16 v[68:69], v72 offset:21248
    ds_read_b64_tr_b16 v[70:71], v72 offset:22560
    s_waitcnt lgkmcnt(0)
    ds_write_b128 v73, v[64:67] offset:10240
    ds_write_b128 v73, v[68:71] offset:11264
    s_waitcnt lgkmcnt(0)
    ds_read_b64_tr_b16 v[64:65], v72 offset:288
    ds_read_b64_tr_b16 v[66:67], v72 offset:1600
    ds_read_b64_tr_b16 v[68:69], v72 offset:21280
    ds_read_b64_tr_b16 v[70:71], v72 offset:22592
    s_waitcnt lgkmcnt(0)
    ds_write_b128 v73, v[64:67] offset:16384
    ds_write_b128 v73, v[68:71] offset:17408
    s_waitcnt lgkmcnt(0)
    s_waitcnt lgkmcnt(0)
interleave_layers__linear_attn_block__memory_aug_recurrent_mem_tr__prompt_kernel_wo25:
    s_barrier
    v_mov_b32 v6, v73
    v_mov_b32 v4, 0x4444
    v_mov_b32 v5, 0xeeee
    v_cmp_gt_u32 vcc, 8, v2
    s_nop 1
    v_cndmask_b32 v4, v5, v4, vcc
    v_lshlrev_b32 v5, 4, v1
    s_lshl_b32 s24, s3, 10
    v_add_u32 v7, s24, v5
    s_lshl_b32 s24, s3, 9
    s_add_u32 s24, s24, 8192
    v_lshlrev_b32 v8, 3, v1
    v_add_u32 v8, s24, v8
    v_and_b32 v64, 7, v2
    v_lshlrev_b32 v9, 5, v64
    v_lshrrev_b32 v64, 3, v2
    v_lshl_add_u32 v9, v64, 4, v9
    v_and_b32 v64, 1, v3
    v_lshl_add_u32 v9, v64, 3, v9
    s_mul_i32 s24, s3, 768
    s_add_u32 s24, s24, 10240
    v_add_u32 v9, s24, v9
    v_lshrrev_b32 v65, 1, v3
    v_lshl_add_u32 v10, v65, 8, v9
    v_lshrrev_b32 v64, 2, v2
    v_lshlrev_b32 v11, 5, v64
    v_and_b32 v64, 3, v2
    v_lshl_add_u32 v11, v64, 3, v11
    v_lshl_add_u32 v11, v3, 8, v11
    v_add_u32 v11, 10240, v11
    s_mul_i32 s24, s3, 10
    s_lshl_b32 s24, s24, 14
    s_lshl_b32 s25, s44, 8
    s_add_u32 s24, s24, s25
    v_lshlrev_b32 v14, 14, v3
    v_lshl_add_u32 v14, v2, 4, v14
    v_add_u32 v14, s24, v14
    v_lshrrev_b32 v64, 1, v3
    v_lshlrev_b32 v15, 14, v64
    v_lshl_add_u32 v15, v2, 4, v15
    v_add_u32 v15, s24, v15
    v_add_u32 v15, 131072, v15
    v_and_b32 v64, 1, v3
    v_cmp_eq_u32 vcc, 0, v64
    v_mov_b32 v64, 2146435072
    s_nop 0
    v_cndmask_b32 v15, v64, v15, vcc
    s_and_b32 s24, s2, 15
    s_mul_i32 s25, s3, 16
    s_add_u32 s24, s24, s25
    s_lshl_b32 s24, s24, 7
    v_mov_b32 v12, s24
    v_mov_b32 v0, 1
interleave_layers__linear_attn_block__memory_aug_recurrent_mem_tr__prompt_kernel_v_layer:
    s_mov_b32 s93, 0
    s_lshl_b32 s24, s93, 12
    s_and_b32 s24, s24, 0x2000
    s_xor_b32 s24, s24, s36
    s_lshl_b32 s93, s93, 20
    s_add_u32 s93, s93, s24
    s_add_u32 s93, s93, 117440512
    s_mul_i32 s94, s92, 16384
    s_add_u32 s94, s94, 23068672
    s_lshl_b32 s24, s3, 6
    s_add_u32 s24, s24, 0
    v_add_u32 v64, s24, v1
    v_and_b32 v65, 7, v64
    v_mul_u32_u24 v65, 1280, v65
    v_lshrrev_b32 v66, 3, v64
    v_lshl_add_u32 v65, v66, 4, v65
    v_cmp_gt_u32 vcc, 640, v64
    v_mov_b32 v67, 2146435072
    s_nop 0
    v_cndmask_b32 v65, v67, v65, vcc
    buffer_load_dwordx4 v[68:71], v65, s[20:23], 0 offen
    v_lshlrev_b32 v64, 4, v64
    s_waitcnt vmcnt(0)
    s_and_saveexec_b64 s[30:31], vcc
    ds_write_b128 v64, v[68:71]
    s_mov_b64 exec, s[30:31]
    s_lshl_b32 s24, s3, 6
    s_add_u32 s24, s24, 256
    v_add_u32 v64, s24, v1
    v_and_b32 v65, 7, v64
    v_mul_u32_u24 v65, 1280, v65
    v_lshrrev_b32 v66, 3, v64
    v_lshl_add_u32 v65, v66, 4, v65
    v_cmp_gt_u32 vcc, 640, v64
    v_mov_b32 v67, 2146435072
    s_nop 0
    v_cndmask_b32 v65, v67, v65, vcc
    buffer_load_dwordx4 v[68:71], v65, s[20:23], 0 offen
    v_lshlrev_b32 v64, 4, v64
    s_waitcnt vmcnt(0)
    s_and_saveexec_b64 s[30:31], vcc
    ds_write_b128 v64, v[68:71]
    s_mov_b64 exec, s[30:31]
    s_lshl_b32 s24, s3, 6
    s_add_u32 s24, s24, 512
    v_add_u32 v64, s24, v1
    v_and_b32 v65, 7, v64
    v_mul_u32_u24 v65, 1280, v65
    v_lshrrev_b32 v66, 3, v64
    v_lshl_add_u32 v65, v66, 4, v65
    v_cmp_gt_u32 vcc, 640, v64
    v_mov_b32 v67, 2146435072
    s_nop 0
    v_cndmask_b32 v65, v67, v65, vcc
    buffer_load_dwordx4 v[68:71], v65, s[20:23], 0 offen
    v_lshlrev_b32 v64, 4, v64
    s_waitcnt vmcnt(0)
    s_and_saveexec_b64 s[30:31], vcc
    ds_write_b128 v64, v[68:71]
    s_mov_b64 exec, s[30:31]
    s_mov_b32 s40, 0
    s_mov_b32 s37, s93
    s_add_u32 s43, s93, 0
    s_lshl_b32 s95, s92, 6
    s_add_u32 s95, s95, s40
    s_add_u32 s95, s95, 1
    s_cmp_ge_i32 s59, s95
    s_cbranch_scc1 interleave_layers__linear_attn_block__memory_aug_recurrent_mem_tr__prompt_kernel_v_ec0_ok
    s_and_b32 s24, s2, 7
    s_lshl_b32 s24, s24, 7
    s_add_u32 s24, s24, 23109632
    v_and_b32 v65, 3, v1
    v_lshl_add_u32 v65, v65, 2, s24
    s_mov_b32 s61, 0
interleave_layers__linear_attn_block__memory_aug_recurrent_mem_tr__prompt_kernel_v_ec0:
    buffer_load_dword v64, v65, s[8:11], 0 offen sc1
    s_waitcnt vmcnt(0)
    v_readlane_b32 s59, v64, 0
    v_readlane_b32 s24, v64, 1
    s_min_i32 s59, s59, s24
    v_readlane_b32 s24, v64, 2
    s_min_i32 s59, s59, s24
    s_cmp_ge_i32 s59, s95
    s_cbranch_scc1 interleave_layers__linear_attn_block__memory_aug_recurrent_mem_tr__prompt_kernel_v_ec0_ok
    s_add_u32 s61, s61, 1
    s_cmp_ge_u32 s61, s60
    s_cbranch_scc1 interleave_layers__linear_attn_block__memory_aug_recurrent_mem_tr__prompt_kernel_v_ec0_to
    s_sleep 2
    s_branch interleave_layers__linear_attn_block__memory_aug_recurrent_mem_tr__prompt_kernel_v_ec0
interleave_layers__linear_attn_block__memory_aug_recurrent_mem_tr__prompt_kernel_v_ec0_to:
    s_mov_b32 s60, 1
interleave_layers__linear_attn_block__memory_aug_recurrent_mem_tr__prompt_kernel_v_ec0_ok:
    v_mov_b32 v16, 0
    v_mov_b32 v17, 0
    v_mov_b32 v18, 0
    v_mov_b32 v19, 0
    v_mov_b32 v20, 0
    v_mov_b32 v21, 0
    v_mov_b32 v22, 0
    v_mov_b32 v23, 0
    v_mov_b32 v24, 0
    v_mov_b32 v25, 0
    v_mov_b32 v26, 0
    v_mov_b32 v27, 0
    v_mov_b32 v28, 0
    v_mov_b32 v29, 0
    v_mov_b32 v30, 0
    v_mov_b32 v31, 0
    v_mov_b32 v32, 0
    v_mov_b32 v33, 0
    v_mov_b32 v34, 0
    v_mov_b32 v35, 0
    v_mov_b32 v36, 0
    v_mov_b32 v37, 0
    v_mov_b32 v38, 0
    v_mov_b32 v39, 0
    v_mov_b32 v40, 0
    v_mov_b32 v41, 0
    v_mov_b32 v42, 0
    v_mov_b32 v43, 0
    v_mov_b32 v44, 0
    v_mov_b32 v45, 0
    v_mov_b32 v46, 0
    v_mov_b32 v47, 0
    v_mov_b32 v48, 0
    v_mov_b32 v49, 0
    v_mov_b32 v50, 0
    v_mov_b32 v51, 0
    v_mov_b32 v52, 0
    v_mov_b32 v53, 0
    v_mov_b32 v54, 0
    v_mov_b32 v55, 0
    v_mov_b32 v56, 0
    v_mov_b32 v57, 0
    v_mov_b32 v58, 0
    v_mov_b32 v59, 0
    v_mov_b32 v60, 0
    v_mov_b32 v61, 0
    v_mov_b32 v62, 0
    v_mov_b32 v63, 0
    v_mov_b32 v64, 0
    v_mov_b32 v65, 0
    v_mov_b32 v66, 0
    v_mov_b32 v67, 0
    s_waitcnt lgkmcnt(0)
    s_barrier
    ds_read_b128 v[68:71], v7
    ds_read_b128 v[72:75], v7 offset:4096
    s_waitcnt lgkmcnt(0)
    s_cmp_eq_u32 s3, 0
    s_cbranch_scc1 interleave_layers__linear_attn_block__memory_aug_recurrent_mem_tr__prompt_kernel_v_gow0
    s_cmp_eq_u32 s3, 1
    s_cbranch_scc1 interleave_layers__linear_attn_block__memory_aug_recurrent_mem_tr__prompt_kernel_v_gow1
    s_cmp_eq_u32 s3, 2
    s_cbranch_scc1 interleave_layers__linear_attn_block__memory_aug_recurrent_mem_tr__prompt_kernel_v_gow2
    s_branch interleave_layers__linear_attn_block__memory_aug_recurrent_mem_tr__prompt_kernel_v_gow3
interleave_layers__linear_attn_block__memory_aug_recurrent_mem_tr__prompt_kernel_v_stepw0:
    v_mov_b32 v16, 0
    v_mov_b32 v17, 0
    v_mov_b32 v18, 0
    v_mov_b32 v19, 0
    v_mov_b32 v20, 0
    v_mov_b32 v21, 0
    v_mov_b32 v22, 0
    v_mov_b32 v23, 0
    v_mov_b32 v24, 0
    v_mov_b32 v25, 0
    v_mov_b32 v26, 0
    v_mov_b32 v27, 0
    v_mov_b32 v28, 0
    v_mov_b32 v29, 0
    v_mov_b32 v30, 0
    v_mov_b32 v31, 0
    v_mov_b32 v32, 0
    v_mov_b32 v33, 0
    v_mov_b32 v34, 0
    v_mov_b32 v35, 0
    v_mov_b32 v36, 0
    v_mov_b32 v37, 0
    v_mov_b32 v38, 0
    v_mov_b32 v39, 0
    v_mov_b32 v40, 0
    v_mov_b32 v41, 0
    v_mov_b32 v42, 0
    v_mov_b32 v43, 0
    v_mov_b32 v44, 0
    v_mov_b32 v45, 0
    v_mov_b32 v46, 0
    v_mov_b32 v47, 0
    v_mov_b32 v48, 0
    v_mov_b32 v49, 0
    v_mov_b32 v50, 0
    v_mov_b32 v51, 0
    v_mov_b32 v52, 0
    v_mov_b32 v53, 0
    v_mov_b32 v54, 0
    v_mov_b32 v55, 0
    v_mov_b32 v56, 0
    v_mov_b32 v57, 0
    v_mov_b32 v58, 0
    v_mov_b32 v59, 0
    v_mov_b32 v60, 0
    v_mov_b32 v61, 0
    v_mov_b32 v62, 0
    v_mov_b32 v63, 0
    v_mov_b32 v64, 0
    v_mov_b32 v65, 0
    v_mov_b32 v66, 0
    v_mov_b32 v67, 0
    s_add_u32 s48, s47, 4096
    s_add_u32 s50, s47, 8192
    s_lshl_b32 s95, s92, 6
    s_add_u32 s95, s95, s40
    s_add_u32 s95, s95, 1
    s_cmp_ge_i32 s59, s95
    s_cbranch_scc1 interleave_layers__linear_attn_block__memory_aug_recurrent_mem_tr__prompt_kernel_v_ecw0_ok
    s_and_b32 s24, s2, 7
    s_lshl_b32 s24, s24, 7
    s_add_u32 s24, s24, 23109632
    v_and_b32 v79, 3, v1
    v_lshl_add_u32 v79, v79, 2, s24
    s_mov_b32 s61, 0
interleave_layers__linear_attn_block__memory_aug_recurrent_mem_tr__prompt_kernel_v_ecw0:
    buffer_load_dword v78, v79, s[8:11], 0 offen sc1
    s_waitcnt vmcnt(0)
    v_readlane_b32 s59, v78, 0
    v_readlane_b32 s24, v78, 1
    s_min_i32 s59, s59, s24
    v_readlane_b32 s24, v78, 2
    s_min_i32 s59, s59, s24
    s_cmp_ge_i32 s59, s95
    s_cbranch_scc1 interleave_layers__linear_attn_block__memory_aug_recurrent_mem_tr__prompt_kernel_v_ecw0_ok
    s_add_u32 s61, s61, 1
    s_cmp_ge_u32 s61, s60
    s_cbranch_scc1 interleave_layers__linear_attn_block__memory_aug_recurrent_mem_tr__prompt_kernel_v_ecw0_to
    s_sleep 2
    s_branch interleave_layers__linear_attn_block__memory_aug_recurrent_mem_tr__prompt_kernel_v_ecw0
interleave_layers__linear_attn_block__memory_aug_recurrent_mem_tr__prompt_kernel_v_ecw0_to:
    s_mov_b32 s60, 1
interleave_layers__linear_attn_block__memory_aug_recurrent_mem_tr__prompt_kernel_v_ecw0_ok:
    s_sleep 20
    s_mov_b64 exec, 1
    s_mov_b32 s61, 0
    v_mov_b32 v81, 0
    buffer_atomic_add v81, v12, s[8:11], s45 offen sc0
    s_sleep 2
    v_mov_b32 v82, 0
    buffer_atomic_add v82, v12, s[8:11], s45 offen sc0
    s_sleep 2
    v_mov_b32 v83, 0
    buffer_atomic_add v83, v12, s[8:11], s45 offen sc0
    s_sleep 2
interleave_layers__linear_attn_block__memory_aug_recurrent_mem_tr__prompt_kernel_v_prw0:
    v_mov_b32 v80, 0
    buffer_atomic_add v80, v12, s[8:11], s45 offen sc0
    s_waitcnt vmcnt(3)
    v_cmp_le_i32 vcc, 9, v81
    s_add_u32 s61, s61, 1
    s_cbranch_vccnz interleave_layers__linear_attn_block__memory_aug_recurrent_mem_tr__prompt_kernel_v_prw0_out
    s_sleep 2
    v_mov_b32 v81, 0
    buffer_atomic_add v81, v12, s[8:11], s45 offen sc0
    s_waitcnt vmcnt(3)
    v_cmp_le_i32 vcc, 9, v82
    s_add_u32 s61, s61, 1
    s_cbranch_vccnz interleave_layers__linear_attn_block__memory_aug_recurrent_mem_tr__prompt_kernel_v_prw0_out
    s_sleep 2
    v_mov_b32 v82, 0
    buffer_atomic_add v82, v12, s[8:11], s45 offen sc0
    s_waitcnt vmcnt(3)
    v_cmp_le_i32 vcc, 9, v83
    s_add_u32 s61, s61, 1
    s_cbranch_vccnz interleave_layers__linear_attn_block__memory_aug_recurrent_mem_tr__prompt_kernel_v_prw0_out
    s_sleep 2
    v_mov_b32 v83, 0
    buffer_atomic_add v83, v12, s[8:11], s45 offen sc0
    s_waitcnt vmcnt(3)
    v_cmp_le_i32 vcc, 9, v80
    s_add_u32 s61, s61, 1
    s_cbranch_vccnz interleave_layers__linear_attn_block__memory_aug_recurrent_mem_tr__prompt_kernel_v_prw0_out
    s_sleep 2
    s_cmp_ge_u32 s61, s60
    s_cbranch_scc0 interleave_layers__linear_attn_block__memory_aug_recurrent_mem_tr__prompt_kernel_v_prw0
    s_mov_b32 s60, 1
interleave_layers__linear_attn_block__memory_aug_recurrent_mem_tr__prompt_kernel_v_prw0_out:
    s_mov_b64 exec, -1
    buffer_load_dwordx4 v[68:71], v7, s[8:11], s47 offen sc1
    buffer_load_dwordx4 v[72:75], v7, s[8:11], s48 offen sc1
    buffer_load_dwordx2 v[76:77], v8, s[8:11], s50 offen sc1
    s_waitcnt vmcnt(0)
    v_max3_u32 v103, v68, v69, v70
    v_max3_u32 v103, v103, v71, v72
    v_max3_u32 v103, v103, v73, v74
    v_max3_u32 v103, v103, v75, v76
    v_max_u32 v103, v103, v77
    v_cmp_eq_u32 vcc, -1, v103
    s_cbranch_vccz interleave_layers__linear_attn_block__memory_aug_recurrent_mem_tr__prompt_kernel_v_pmw0_out
    s_mov_b32 s61, 0
interleave_layers__linear_attn_block__memory_aug_recurrent_mem_tr__prompt_kernel_v_pmw0:
    buffer_load_dwordx4 v[68:71], v7, s[8:11], s47 offen sc1
    buffer_load_dwordx4 v[72:75], v7, s[8:11], s48 offen sc1
    buffer_load_dwordx2 v[76:77], v8, s[8:11], s50 offen sc1
    s_waitcnt vmcnt(0)
    v_max3_u32 v103, v68, v69, v70
    v_max3_u32 v103, v103, v71, v72
    v_max3_u32 v103, v103, v73, v74
    v_max3_u32 v103, v103, v75, v76
    v_max_u32 v103, v103, v77
    v_cmp_eq_u32 vcc, -1, v103
    s_add_u32 s61, s61, 1
    s_cbranch_vccz interleave_layers__linear_attn_block__memory_aug_recurrent_mem_tr__prompt_kernel_v_pmw0_out
    s_cmp_ge_u32 s61, s60
    s_cbranch_scc1 interleave_layers__linear_attn_block__memory_aug_recurrent_mem_tr__prompt_kernel_v_pmw0_to
    s_sleep 1
    s_branch interleave_layers__linear_attn_block__memory_aug_recurrent_mem_tr__prompt_kernel_v_pmw0
interleave_layers__linear_attn_block__memory_aug_recurrent_mem_tr__prompt_kernel_v_pmw0_to:
    s_mov_b32 s60, 1
interleave_layers__linear_attn_block__memory_aug_recurrent_mem_tr__prompt_kernel_v_pmw0_out:
    ds_write_b128 v7, v[68:71]
    ds_write_b128 v7, v[72:75] offset:4096
    ds_write_b64 v8, v[76:77]
interleave_layers__linear_attn_block__memory_aug_recurrent_mem_tr__prompt_kernel_v_gow0:
    v_smfmac_f32_16x16x64_bf16 v[56:59], v[68:71], a[0:7], v4
    v_smfmac_f32_16x16x64_bf16 v[60:63], v[68:71], a[80:87], v4
    v_smfmac_f32_16x16x64_bf16 v[64:67], v[68:71], a[160:167], v4
    s_waitcnt lgkmcnt(0)
    s_barrier
    ds_read_b128 v[80:83], v5 offset:1024
    ds_read_b128 v[84:87], v5 offset:2048
    ds_read_b128 v[88:91], v5 offset:3072
    ds_read_b128 v[92:95], v5 offset:5120
    ds_read_b128 v[96:99], v5 offset:6144
    ds_read_b128 v[100:103], v5 offset:7168
    ds_read_b128 v[76:79], v5 offset:8192
    ds_read_b128 v[68:71], v5 offset:9216
    v_smfmac_f32_16x16x64_bf16 v[64:67], v[72:75], a[192:199], v4
    v_smfmac_f32_16x16x64_bf16 v[56:59], v[72:75], a[32:39], v4
    v_smfmac_f32_16x16x64_bf16 v[60:63], v[72:75], a[112:119], v4
    s_waitcnt lgkmcnt(7)
    v_smfmac_f32_16x16x64_bf16 v[64:67], v[80:83], a[168:175], v4
    s_waitcnt lgkmcnt(6)
    v_smfmac_f32_16x16x64_bf16 v[64:67], v[84:87], a[176:183], v4
    s_waitcnt lgkmcnt(5)
    v_smfmac_f32_16x16x64_bf16 v[64:67], v[88:91], a[184:191], v4
    s_waitcnt lgkmcnt(4)
    v_smfmac_f32_16x16x64_bf16 v[64:67], v[92:95], a[200:207], v4
    s_waitcnt lgkmcnt(3)
    v_smfmac_f32_16x16x64_bf16 v[64:67], v[96:99], a[208:215], v4
    s_waitcnt lgkmcnt(2)
    v_smfmac_f32_16x16x64_bf16 v[64:67], v[100:103], a[216:223], v4
    s_waitcnt lgkmcnt(1)
    v_smfmac_f32_16x16x64_bf16 v[64:67], v[76:79], a[224:231], v4
    s_waitcnt lgkmcnt(0)
    v_smfmac_f32_16x16x64_bf16 v[64:67], v[68:71], a[232:239], v4
    v_smfmac_f32_16x16x64_bf16 v[56:59], v[80:83], a[8:15], v4
    v_smfmac_f32_16x16x64_bf16 v[60:63], v[80:83], a[88:95], v4
    v_smfmac_f32_16x16x64_bf16 v[56:59], v[84:87], a[16:23], v4
    s_nop 4
    v_mov_b32 v72, v64
    v_smfmac_f32_16x16x64_bf16 v[60:63], v[84:87], a[96:103], v4
    v_mov_b32 v73, v65
    v_mov_b32 v74, v66
    v_smfmac_f32_16x16x64_bf16 v[56:59], v[88:91], a[24:31], v4
    v_mov_b32 v75, v67
    v_smfmac_f32_16x16x64_bf16 v[60:63], v[88:91], a[104:111], v4
    v_permlane32_swap_b32 v64, v72
    v_permlane32_swap_b32 v65, v73
    v_smfmac_f32_16x16x64_bf16 v[56:59], v[92:95], a[40:47], v4
    v_permlane32_swap_b32 v66, v74
    v_permlane32_swap_b32 v67, v75
    v_smfmac_f32_16x16x64_bf16 v[60:63], v[92:95], a[120:127], v4
    v_add_f32 v64, v64, v72
    v_add_f32 v65, v65, v73
    v_smfmac_f32_16x16x64_bf16 v[56:59], v[96:99], a[48:55], v4
    v_add_f32 v66, v66, v74
    v_add_f32 v67, v67, v75
    v_smfmac_f32_16x16x64_bf16 v[60:63], v[96:99], a[128:135], v4
    v_cvt_pk_bf16_f32 v72, v64, v65
    v_cvt_pk_bf16_f32 v73, v66, v67
    v_smfmac_f32_16x16x64_bf16 v[56:59], v[100:103], a[56:63], v4
    ds_write_b64 v9, v[72:73] offset:512
    v_smfmac_f32_16x16x64_bf16 v[60:63], v[100:103], a[136:143], v4
    v_smfmac_f32_16x16x64_bf16 v[56:59], v[76:79], a[64:71], v4
    v_smfmac_f32_16x16x64_bf16 v[60:63], v[76:79], a[144:151], v4
    v_smfmac_f32_16x16x64_bf16 v[56:59], v[68:71], a[72:79], v4
    v_smfmac_f32_16x16x64_bf16 v[60:63], v[68:71], a[152:159], v4
    s_nop 7
    v_permlane32_swap_b32 v56, v60
    v_permlane32_swap_b32 v57, v61
    v_permlane32_swap_b32 v58, v62
    v_permlane32_swap_b32 v59, v63
    v_add_f32 v56, v56, v60
    v_add_f32 v57, v57, v61
    v_add_f32 v58, v58, v62
    v_add_f32 v59, v59, v63
    v_cvt_pk_bf16_f32 v68, v56, v57
    v_cvt_pk_bf16_f32 v69, v58, v59
    ds_write_b64 v10, v[68:69]
    s_waitcnt lgkmcnt(0)
    s_barrier
    ds_read_b64_tr_b16 v[68:69], v11 offset:0
    ds_read_b64_tr_b16 v[70:71], v11 offset:128
    ds_read_b64_tr_b16 v[72:73], v11 offset:1024
    ds_read_b64_tr_b16 v[74:75], v11 offset:1152
    ds_read_b64_tr_b16 v[76:77], v11 offset:2048
    ds_read_b64_tr_b16 v[78:79], v11 offset:2176
    ds_read_b128 v[80:83], v6 offset:0
    ds_read_b128 v[84:87], v6 offset:1024
    ds_read_b128 v[88:91], v6 offset:2048
    ds_read_b128 v[92:95], v6 offset:3072
    ds_read_b128 v[96:99], v6 offset:4096
    ds_read_b128 v[100:103], v6 offset:5120
    s_waitcnt lgkmcnt(10)
    v_smfmac_f32_16x16x64_bf16 v[16:19], v[68:71], a[240:247], v4
    v_smfmac_f32_16x16x64_bf16 v[20:23], v[68:71], v[112:119], v4
    v_smfmac_f32_16x16x64_bf16 v[24:27], v[68:71], v[136:143], v4
    v_smfmac_f32_16x16x64_bf16 v[28:31], v[68:71], v[160:167], v4
    s_waitcnt lgkmcnt(8)
    v_smfmac_f32_16x16x64_bf16 v[16:19], v[72:75], a[248:255], v4
    v_smfmac_f32_16x16x64_bf16 v[20:23], v[72:75], v[120:127], v4
    v_smfmac_f32_16x16x64_bf16 v[24:27], v[72:75], v[144:151], v4
    v_smfmac_f32_16x16x64_bf16 v[28:31], v[72:75], v[168:175], v4
    s_waitcnt lgkmcnt(6)
    v_smfmac_f32_16x16x64_bf16 v[16:19], v[76:79], v[104:111], v4
    v_smfmac_f32_16x16x64_bf16 v[20:23], v[76:79], v[128:135], v4
    v_smfmac_f32_16x16x64_bf16 v[24:27], v[76:79], v[152:159], v4
    v_smfmac_f32_16x16x64_bf16 v[28:31], v[76:79], v[176:183], v4
    v_smfmac_f32_16x16x64_bf16 v[32:35], v[68:71], v[184:191], v4
    v_smfmac_f32_16x16x64_bf16 v[36:39], v[68:71], v[208:215], v4
    s_nop 4
    v_permlane32_swap_b32 v16, v24
    v_permlane32_swap_b32 v17, v25
    v_smfmac_f32_16x16x64_bf16 v[40:43], v[68:71], v[232:239], v4
    v_permlane32_swap_b32 v18, v26
    v_permlane32_swap_b32 v19, v27
    s_waitcnt lgkmcnt(4)
    v_smfmac_f32_16x16x64_bf16 v[44:47], v[68:71], v[80:87], v4
    v_add_f32 v16, v16, v24
    v_add_f32 v17, v17, v25
    ds_read_b128 v[80:83], v6 offset:6144
    ds_read_b128 v[84:87], v6 offset:7168
    v_smfmac_f32_16x16x64_bf16 v[32:35], v[72:75], v[192:199], v4
    v_add_f32 v18, v18, v26
    v_add_f32 v19, v19, v27
    v_smfmac_f32_16x16x64_bf16 v[36:39], v[72:75], v[216:223], v4
    v_permlane32_swap_b32 v20, v28
    v_permlane32_swap_b32 v21, v29
    v_smfmac_f32_16x16x64_bf16 v[40:43], v[72:75], v[240:247], v4
    v_permlane32_swap_b32 v22, v30
    v_permlane32_swap_b32 v23, v31
    s_waitcnt lgkmcnt(4)
    v_smfmac_f32_16x16x64_bf16 v[44:47], v[72:75], v[88:95], v4
    v_add_f32 v20, v20, v28
    v_add_f32 v21, v21, v29
    ds_read_b128 v[88:91], v6 offset:8192
    ds_read_b128 v[92:95], v6 offset:9216
    v_smfmac_f32_16x16x64_bf16 v[32:35], v[76:79], v[200:207], v4
    v_add_f32 v22, v22, v30
    v_add_f32 v23, v23, v31
    v_smfmac_f32_16x16x64_bf16 v[36:39], v[76:79], v[224:231], v4
    v_cvt_pk_bf16_f32 v56, v16, v17
    v_cvt_pk_bf16_f32 v57, v18, v19
    v_smfmac_f32_16x16x64_bf16 v[40:43], v[76:79], v[248:255], v4
    v_cvt_pk_bf16_f32 v58, v20, v21
    v_cvt_pk_bf16_f32 v59, v22, v23
    s_waitcnt lgkmcnt(4)
    v_smfmac_f32_16x16x64_bf16 v[44:47], v[76:79], v[96:103], v4
    v_permlane16_swap_b32 v56, v58
    ds_read_b128 v[96:99], v6 offset:10240
    ds_read_b128 v[100:103], v6 offset:11264
    v_permlane16_swap_b32 v57, v59
    v_min_u32 v56, -2, v56
    v_min_u32 v57, -2, v57
    v_min_u32 v58, -2, v58
    v_min_u32 v59, -2, v59
    buffer_store_dwordx4 v[56:59], v14, s[8:11], s43 offen sc1
    s_add_u32 s49, s43, 65536
    s_waitcnt lgkmcnt(4)
    v_smfmac_f32_16x16x64_bf16 v[48:51], v[68:71], v[80:87], v4
    v_permlane32_swap_b32 v32, v40
    v_permlane32_swap_b32 v33, v41
    v_permlane32_swap_b32 v34, v42
    ds_read_b128 v[80:83], v6 offset:12288
    ds_read_b128 v[84:87], v6 offset:13312
    s_waitcnt lgkmcnt(4)
    v_smfmac_f32_16x16x64_bf16 v[48:51], v[72:75], v[88:95], v4
    v_permlane32_swap_b32 v35, v43
    v_add_f32 v32, v32, v40
    v_add_f32 v33, v33, v41
    v_add_f32 v34, v34, v42
    ds_read_b128 v[88:91], v6 offset:14336
    ds_read_b128 v[92:95], v6 offset:15360
    s_waitcnt lgkmcnt(4)
    v_smfmac_f32_16x16x64_bf16 v[48:51], v[76:79], v[96:103], v4
    v_add_f32 v35, v35, v43
    v_permlane32_swap_b32 v36, v44
    v_permlane32_swap_b32 v37, v45
    v_permlane32_swap_b32 v38, v46
    ds_read_b128 v[96:99], v6 offset:16384
    ds_read_b128 v[100:103], v6 offset:17408
    v_permlane32_swap_b32 v39, v47
    v_add_f32 v36, v36, v44
    v_add_f32 v37, v37, v45
    v_add_f32 v38, v38, v46
    s_waitcnt lgkmcnt(4)
    v_smfmac_f32_16x16x64_bf16 v[52:55], v[68:71], v[80:87], v4
    v_add_f32 v39, v39, v47
    v_cvt_pk_bf16_f32 v60, v32, v33
    v_cvt_pk_bf16_f32 v61, v34, v35
    s_waitcnt lgkmcnt(2)
    v_smfmac_f32_16x16x64_bf16 v[52:55], v[72:75], v[88:95], v4
    v_cvt_pk_bf16_f32 v62, v36, v37
    v_cvt_pk_bf16_f32 v63, v38, v39
    s_waitcnt lgkmcnt(0)
    v_smfmac_f32_16x16x64_bf16 v[52:55], v[76:79], v[96:103], v4
    v_permlane16_swap_b32 v60, v62
    v_permlane16_swap_b32 v61, v63
    v_min_u32 v60, -2, v60
    v_min_u32 v61, -2, v61
    v_min_u32 v62, -2, v62
    v_min_u32 v63, -2, v63
    buffer_store_dwordx4 v[60:63], v14, s[8:11], s49 offen sc1
    s_nop 0
    v_permlane32_swap_b32 v48, v52
    v_permlane32_swap_b32 v49, v53
    v_permlane32_swap_b32 v50, v54
    v_permlane32_swap_b32 v51, v55
    v_add_f32 v48, v48, v52
    v_add_f32 v49, v49, v53
    v_add_f32 v50, v50, v54
    v_add_f32 v51, v51, v55
    v_cvt_pk_bf16_f32 v64, v48, v49
    v_cvt_pk_bf16_f32 v65, v50, v51
    v_mov_b32 v66, v64
    v_mov_b32 v67, v65
    s_nop 0
    v_permlane16_swap_b32 v64, v66
    v_permlane16_swap_b32 v65, v67
    v_min_u32 v64, -2, v64
    v_min_u32 v65, -2, v65
    v_min_u32 v66, -2, v66
    v_min_u32 v67, -2, v67
    buffer_store_dwordx4 v[64:67], v15, s[8:11], s43 offen sc1
    s_add_u32 s40, s40, 1
    s_add_u32 s47, s37, 704512
    s_add_u32 s45, s37, 737280
    s_lshl_b32 s24, s40, 12
    s_and_b32 s24, s24, 0x2000
    s_xor_b32 s24, s24, s36
    s_lshl_b32 s37, s40, 20
    s_add_u32 s37, s37, s24
    s_add_u32 s37, s37, 117440512
    s_add_u32 s43, s37, 0
    s_cmp_lt_u32 s40, 64
    s_cbranch_scc1 interleave_layers__linear_attn_block__memory_aug_recurrent_mem_tr__prompt_kernel_v_stepw0
    s_branch interleave_layers__linear_attn_block__memory_aug_recurrent_mem_tr__prompt_kernel_v_end
interleave_layers__linear_attn_block__memory_aug_recurrent_mem_tr__prompt_kernel_v_stepw1:
    v_mov_b32 v16, 0
    v_mov_b32 v17, 0
    v_mov_b32 v18, 0
    v_mov_b32 v19, 0
    v_mov_b32 v20, 0
    v_mov_b32 v21, 0
    v_mov_b32 v22, 0
    v_mov_b32 v23, 0
    v_mov_b32 v24, 0
    v_mov_b32 v25, 0
    v_mov_b32 v26, 0
    v_mov_b32 v27, 0
    v_mov_b32 v28, 0
    v_mov_b32 v29, 0
    v_mov_b32 v30, 0
    v_mov_b32 v31, 0
    v_mov_b32 v32, 0
    v_mov_b32 v33, 0
    v_mov_b32 v34, 0
    v_mov_b32 v35, 0
    v_mov_b32 v36, 0
    v_mov_b32 v37, 0
    v_mov_b32 v38, 0
    v_mov_b32 v39, 0
    v_mov_b32 v40, 0
    v_mov_b32 v41, 0
    v_mov_b32 v42, 0
    v_mov_b32 v43, 0
    v_mov_b32 v44, 0
    v_mov_b32 v45, 0
    v_mov_b32 v46, 0
    v_mov_b32 v47, 0
    v_mov_b32 v48, 0
    v_mov_b32 v49, 0
    v_mov_b32 v50, 0
    v_mov_b32 v51, 0
    v_mov_b32 v52, 0
    v_mov_b32 v53, 0
    v_mov_b32 v54, 0
    v_mov_b32 v55, 0
    v_mov_b32 v56, 0
    v_mov_b32 v57, 0
    v_mov_b32 v58, 0
    v_mov_b32 v59, 0
    v_mov_b32 v60, 0
    v_mov_b32 v61, 0
    v_mov_b32 v62, 0
    v_mov_b32 v63, 0
    v_mov_b32 v64, 0
    v_mov_b32 v65, 0
    v_mov_b32 v66, 0
    v_mov_b32 v67, 0
    s_add_u32 s48, s47, 4096
    s_add_u32 s50, s47, 8192
    s_lshl_b32 s95, s92, 6
    s_add_u32 s95, s95, s40
    s_add_u32 s95, s95, 1
    s_cmp_ge_i32 s59, s95
    s_cbranch_scc1 interleave_layers__linear_attn_block__memory_aug_recurrent_mem_tr__prompt_kernel_v_ecw1_ok
    s_and_b32 s24, s2, 7
    s_lshl_b32 s24, s24, 7
    s_add_u32 s24, s24, 23109632
    v_and_b32 v79, 3, v1
    v_lshl_add_u32 v79, v79, 2, s24
    s_mov_b32 s61, 0
interleave_layers__linear_attn_block__memory_aug_recurrent_mem_tr__prompt_kernel_v_ecw1:
    buffer_load_dword v78, v79, s[8:11], 0 offen sc1
    s_waitcnt vmcnt(0)
    v_readlane_b32 s59, v78, 0
    v_readlane_b32 s24, v78, 1
    s_min_i32 s59, s59, s24
    v_readlane_b32 s24, v78, 2
    s_min_i32 s59, s59, s24
    s_cmp_ge_i32 s59, s95
    s_cbranch_scc1 interleave_layers__linear_attn_block__memory_aug_recurrent_mem_tr__prompt_kernel_v_ecw1_ok
    s_add_u32 s61, s61, 1
    s_cmp_ge_u32 s61, s60
    s_cbranch_scc1 interleave_layers__linear_attn_block__memory_aug_recurrent_mem_tr__prompt_kernel_v_ecw1_to
    s_sleep 2
    s_branch interleave_layers__linear_attn_block__memory_aug_recurrent_mem_tr__prompt_kernel_v_ecw1
interleave_layers__linear_attn_block__memory_aug_recurrent_mem_tr__prompt_kernel_v_ecw1_to:
    s_mov_b32 s60, 1
interleave_layers__linear_attn_block__memory_aug_recurrent_mem_tr__prompt_kernel_v_ecw1_ok:
    s_sleep 20
    s_mov_b64 exec, 1
    s_mov_b32 s61, 0
    v_mov_b32 v81, 0
    buffer_atomic_add v81, v12, s[8:11], s45 offen sc0
    s_sleep 2
    v_mov_b32 v82, 0
    buffer_atomic_add v82, v12, s[8:11], s45 offen sc0
    s_sleep 2
    v_mov_b32 v83, 0
    buffer_atomic_add v83, v12, s[8:11], s45 offen sc0
    s_sleep 2
interleave_layers__linear_attn_block__memory_aug_recurrent_mem_tr__prompt_kernel_v_prw1:
    v_mov_b32 v80, 0
    buffer_atomic_add v80, v12, s[8:11], s45 offen sc0
    s_waitcnt vmcnt(3)
    v_cmp_le_i32 vcc, 9, v81
    s_add_u32 s61, s61, 1
    s_cbranch_vccnz interleave_layers__linear_attn_block__memory_aug_recurrent_mem_tr__prompt_kernel_v_prw1_out
    s_sleep 2
    v_mov_b32 v81, 0
    buffer_atomic_add v81, v12, s[8:11], s45 offen sc0
    s_waitcnt vmcnt(3)
    v_cmp_le_i32 vcc, 9, v82
    s_add_u32 s61, s61, 1
    s_cbranch_vccnz interleave_layers__linear_attn_block__memory_aug_recurrent_mem_tr__prompt_kernel_v_prw1_out
    s_sleep 2
    v_mov_b32 v82, 0
    buffer_atomic_add v82, v12, s[8:11], s45 offen sc0
    s_waitcnt vmcnt(3)
    v_cmp_le_i32 vcc, 9, v83
    s_add_u32 s61, s61, 1
    s_cbranch_vccnz interleave_layers__linear_attn_block__memory_aug_recurrent_mem_tr__prompt_kernel_v_prw1_out
    s_sleep 2
    v_mov_b32 v83, 0
    buffer_atomic_add v83, v12, s[8:11], s45 offen sc0
    s_waitcnt vmcnt(3)
    v_cmp_le_i32 vcc, 9, v80
    s_add_u32 s61, s61, 1
    s_cbranch_vccnz interleave_layers__linear_attn_block__memory_aug_recurrent_mem_tr__prompt_kernel_v_prw1_out
    s_sleep 2
    s_cmp_ge_u32 s61, s60
    s_cbranch_scc0 interleave_layers__linear_attn_block__memory_aug_recurrent_mem_tr__prompt_kernel_v_prw1
    s_mov_b32 s60, 1
interleave_layers__linear_attn_block__memory_aug_recurrent_mem_tr__prompt_kernel_v_prw1_out:
    s_mov_b64 exec, -1
    buffer_load_dwordx4 v[68:71], v7, s[8:11], s47 offen sc1
    buffer_load_dwordx4 v[72:75], v7, s[8:11], s48 offen sc1
    buffer_load_dwordx2 v[76:77], v8, s[8:11], s50 offen sc1
    s_waitcnt vmcnt(0)
    v_max3_u32 v103, v68, v69, v70
    v_max3_u32 v103, v103, v71, v72
    v_max3_u32 v103, v103, v73, v74
    v_max3_u32 v103, v103, v75, v76
    v_max_u32 v103, v103, v77
    v_cmp_eq_u32 vcc, -1, v103
    s_cbranch_vccz interleave_layers__linear_attn_block__memory_aug_recurrent_mem_tr__prompt_kernel_v_pmw1_out
    s_mov_b32 s61, 0
interleave_layers__linear_attn_block__memory_aug_recurrent_mem_tr__prompt_kernel_v_pmw1:
    buffer_load_dwordx4 v[68:71], v7, s[8:11], s47 offen sc1
    buffer_load_dwordx4 v[72:75], v7, s[8:11], s48 offen sc1
    buffer_load_dwordx2 v[76:77], v8, s[8:11], s50 offen sc1
    s_waitcnt vmcnt(0)
    v_max3_u32 v103, v68, v69, v70
    v_max3_u32 v103, v103, v71, v72
    v_max3_u32 v103, v103, v73, v74
    v_max3_u32 v103, v103, v75, v76
    v_max_u32 v103, v103, v77
    v_cmp_eq_u32 vcc, -1, v103
    s_add_u32 s61, s61, 1
    s_cbranch_vccz interleave_layers__linear_attn_block__memory_aug_recurrent_mem_tr__prompt_kernel_v_pmw1_out
    s_cmp_ge_u32 s61, s60
    s_cbranch_scc1 interleave_layers__linear_attn_block__memory_aug_recurrent_mem_tr__prompt_kernel_v_pmw1_to
    s_sleep 1
    s_branch interleave_layers__linear_attn_block__memory_aug_recurrent_mem_tr__prompt_kernel_v_pmw1
interleave_layers__linear_attn_block__memory_aug_recurrent_mem_tr__prompt_kernel_v_pmw1_to:
    s_mov_b32 s60, 1
interleave_layers__linear_attn_block__memory_aug_recurrent_mem_tr__prompt_kernel_v_pmw1_out:
    ds_write_b128 v7, v[68:71]
    ds_write_b128 v7, v[72:75] offset:4096
    ds_write_b64 v8, v[76:77]
interleave_layers__linear_attn_block__memory_aug_recurrent_mem_tr__prompt_kernel_v_gow1:
    v_smfmac_f32_16x16x64_bf16 v[56:59], v[68:71], a[8:15], v4
    v_smfmac_f32_16x16x64_bf16 v[60:63], v[68:71], a[88:95], v4
    v_smfmac_f32_16x16x64_bf16 v[64:67], v[68:71], a[168:175], v4
    s_waitcnt lgkmcnt(0)
    s_barrier
    ds_read_b128 v[80:83], v5 offset:0
    ds_read_b128 v[84:87], v5 offset:2048
    ds_read_b128 v[88:91], v5 offset:3072
    ds_read_b128 v[92:95], v5 offset:4096
    ds_read_b128 v[96:99], v5 offset:6144
    ds_read_b128 v[100:103], v5 offset:7168
    ds_read_b128 v[76:79], v5 offset:8192
    ds_read_b128 v[68:71], v5 offset:9216
    v_smfmac_f32_16x16x64_bf16 v[64:67], v[72:75], a[200:207], v4
    v_smfmac_f32_16x16x64_bf16 v[56:59], v[72:75], a[40:47], v4
    v_smfmac_f32_16x16x64_bf16 v[60:63], v[72:75], a[120:127], v4
    s_waitcnt lgkmcnt(7)
    v_smfmac_f32_16x16x64_bf16 v[64:67], v[80:83], a[160:167], v4
    s_waitcnt lgkmcnt(6)
    v_smfmac_f32_16x16x64_bf16 v[64:67], v[84:87], a[176:183], v4
    s_waitcnt lgkmcnt(5)
    v_smfmac_f32_16x16x64_bf16 v[64:67], v[88:91], a[184:191], v4
    s_waitcnt lgkmcnt(4)
    v_smfmac_f32_16x16x64_bf16 v[64:67], v[92:95], a[192:199], v4
    s_waitcnt lgkmcnt(3)
    v_smfmac_f32_16x16x64_bf16 v[64:67], v[96:99], a[208:215], v4
    s_waitcnt lgkmcnt(2)
    v_smfmac_f32_16x16x64_bf16 v[64:67], v[100:103], a[216:223], v4
    s_waitcnt lgkmcnt(1)
    v_smfmac_f32_16x16x64_bf16 v[64:67], v[76:79], a[224:231], v4
    s_waitcnt lgkmcnt(0)
    v_smfmac_f32_16x16x64_bf16 v[64:67], v[68:71], a[232:239], v4
    v_smfmac_f32_16x16x64_bf16 v[56:59], v[80:83], a[0:7], v4
    v_smfmac_f32_16x16x64_bf16 v[60:63], v[80:83], a[80:87], v4
    v_smfmac_f32_16x16x64_bf16 v[56:59], v[84:87], a[16:23], v4
    s_nop 4
    v_mov_b32 v72, v64
    v_smfmac_f32_16x16x64_bf16 v[60:63], v[84:87], a[96:103], v4
    v_mov_b32 v73, v65
    v_mov_b32 v74, v66
    v_smfmac_f32_16x16x64_bf16 v[56:59], v[88:91], a[24:31], v4
    v_mov_b32 v75, v67
    v_smfmac_f32_16x16x64_bf16 v[60:63], v[88:91], a[104:111], v4
    v_permlane32_swap_b32 v64, v72
    v_permlane32_swap_b32 v65, v73
    v_smfmac_f32_16x16x64_bf16 v[56:59], v[92:95], a[32:39], v4
    v_permlane32_swap_b32 v66, v74
    v_permlane32_swap_b32 v67, v75
    v_smfmac_f32_16x16x64_bf16 v[60:63], v[92:95], a[112:119], v4
    v_add_f32 v64, v64, v72
    v_add_f32 v65, v65, v73
    v_smfmac_f32_16x16x64_bf16 v[56:59], v[96:99], a[48:55], v4
    v_add_f32 v66, v66, v74
    v_add_f32 v67, v67, v75
    v_smfmac_f32_16x16x64_bf16 v[60:63], v[96:99], a[128:135], v4
    v_cvt_pk_bf16_f32 v72, v64, v65
    v_cvt_pk_bf16_f32 v73, v66, v67
    v_smfmac_f32_16x16x64_bf16 v[56:59], v[100:103], a[56:63], v4
    ds_write_b64 v9, v[72:73] offset:512
    v_smfmac_f32_16x16x64_bf16 v[60:63], v[100:103], a[136:143], v4
    v_smfmac_f32_16x16x64_bf16 v[56:59], v[76:79], a[64:71], v4
    v_smfmac_f32_16x16x64_bf16 v[60:63], v[76:79], a[144:151], v4
    v_smfmac_f32_16x16x64_bf16 v[56:59], v[68:71], a[72:79], v4
    v_smfmac_f32_16x16x64_bf16 v[60:63], v[68:71], a[152:159], v4
    s_nop 7
    v_permlane32_swap_b32 v56, v60
    v_permlane32_swap_b32 v57, v61
    v_permlane32_swap_b32 v58, v62
    v_permlane32_swap_b32 v59, v63
    v_add_f32 v56, v56, v60
    v_add_f32 v57, v57, v61
    v_add_f32 v58, v58, v62
    v_add_f32 v59, v59, v63
    v_cvt_pk_bf16_f32 v68, v56, v57
    v_cvt_pk_bf16_f32 v69, v58, v59
    ds_write_b64 v10, v[68:69]
    s_waitcnt lgkmcnt(0)
    s_barrier
    ds_read_b64_tr_b16 v[68:69], v11 offset:0
    ds_read_b64_tr_b16 v[70:71], v11 offset:128
    ds_read_b64_tr_b16 v[72:73], v11 offset:1024
    ds_read_b64_tr_b16 v[74:75], v11 offset:1152
    ds_read_b64_tr_b16 v[76:77], v11 offset:2048
    ds_read_b64_tr_b16 v[78:79], v11 offset:2176
    ds_read_b128 v[80:83], v6 offset:0
    ds_read_b128 v[84:87], v6 offset:1024
    ds_read_b128 v[88:91], v6 offset:2048
    ds_read_b128 v[92:95], v6 offset:3072
    ds_read_b128 v[96:99], v6 offset:4096
    ds_read_b128 v[100:103], v6 offset:5120
    s_waitcnt lgkmcnt(10)
    v_smfmac_f32_16x16x64_bf16 v[16:19], v[68:71], a[240:247], v4
    v_smfmac_f32_16x16x64_bf16 v[20:23], v[68:71], v[112:119], v4
    v_smfmac_f32_16x16x64_bf16 v[24:27], v[68:71], v[136:143], v4
    v_smfmac_f32_16x16x64_bf16 v[28:31], v[68:71], v[160:167], v4
    s_waitcnt lgkmcnt(8)
    v_smfmac_f32_16x16x64_bf16 v[16:19], v[72:75], a[248:255], v4
    v_smfmac_f32_16x16x64_bf16 v[20:23], v[72:75], v[120:127], v4
    v_smfmac_f32_16x16x64_bf16 v[24:27], v[72:75], v[144:151], v4
    v_smfmac_f32_16x16x64_bf16 v[28:31], v[72:75], v[168:175], v4
    s_waitcnt lgkmcnt(6)
    v_smfmac_f32_16x16x64_bf16 v[16:19], v[76:79], v[104:111], v4
    v_smfmac_f32_16x16x64_bf16 v[20:23], v[76:79], v[128:135], v4
    v_smfmac_f32_16x16x64_bf16 v[24:27], v[76:79], v[152:159], v4
    v_smfmac_f32_16x16x64_bf16 v[28:31], v[76:79], v[176:183], v4
    v_smfmac_f32_16x16x64_bf16 v[32:35], v[68:71], v[184:191], v4
    v_smfmac_f32_16x16x64_bf16 v[36:39], v[68:71], v[208:215], v4
    s_nop 4
    v_permlane32_swap_b32 v16, v24
    v_permlane32_swap_b32 v17, v25
    v_smfmac_f32_16x16x64_bf16 v[40:43], v[68:71], v[232:239], v4
    v_permlane32_swap_b32 v18, v26
    v_permlane32_swap_b32 v19, v27
    s_waitcnt lgkmcnt(4)
    v_smfmac_f32_16x16x64_bf16 v[44:47], v[68:71], v[80:87], v4
    v_add_f32 v16, v16, v24
    v_add_f32 v17, v17, v25
    ds_read_b128 v[80:83], v6 offset:6144
    ds_read_b128 v[84:87], v6 offset:7168
    v_smfmac_f32_16x16x64_bf16 v[32:35], v[72:75], v[192:199], v4
    v_add_f32 v18, v18, v26
    v_add_f32 v19, v19, v27
    v_smfmac_f32_16x16x64_bf16 v[36:39], v[72:75], v[216:223], v4
    v_permlane32_swap_b32 v20, v28
    v_permlane32_swap_b32 v21, v29
    v_smfmac_f32_16x16x64_bf16 v[40:43], v[72:75], v[240:247], v4
    v_permlane32_swap_b32 v22, v30
    v_permlane32_swap_b32 v23, v31
    s_waitcnt lgkmcnt(4)
    v_smfmac_f32_16x16x64_bf16 v[44:47], v[72:75], v[88:95], v4
    v_add_f32 v20, v20, v28
    v_add_f32 v21, v21, v29
    ds_read_b128 v[88:91], v6 offset:8192
    ds_read_b128 v[92:95], v6 offset:9216
    v_smfmac_f32_16x16x64_bf16 v[32:35], v[76:79], v[200:207], v4
    v_add_f32 v22, v22, v30
    v_add_f32 v23, v23, v31
    v_smfmac_f32_16x16x64_bf16 v[36:39], v[76:79], v[224:231], v4
    v_cvt_pk_bf16_f32 v56, v16, v17
    v_cvt_pk_bf16_f32 v57, v18, v19
    v_smfmac_f32_16x16x64_bf16 v[40:43], v[76:79], v[248:255], v4
    v_cvt_pk_bf16_f32 v58, v20, v21
    v_cvt_pk_bf16_f32 v59, v22, v23
    s_waitcnt lgkmcnt(4)
    v_smfmac_f32_16x16x64_bf16 v[44:47], v[76:79], v[96:103], v4
    v_permlane16_swap_b32 v56, v58
    ds_read_b128 v[96:99], v6 offset:10240
    ds_read_b128 v[100:103], v6 offset:11264
    v_permlane16_swap_b32 v57, v59
    v_min_u32 v56, -2, v56
    v_min_u32 v57, -2, v57
    v_min_u32 v58, -2, v58
    v_min_u32 v59, -2, v59
    buffer_store_dwordx4 v[56:59], v14, s[8:11], s43 offen sc1
    s_add_u32 s49, s43, 65536
    s_waitcnt lgkmcnt(4)
    v_smfmac_f32_16x16x64_bf16 v[48:51], v[68:71], v[80:87], v4
    v_permlane32_swap_b32 v32, v40
    v_permlane32_swap_b32 v33, v41
    v_permlane32_swap_b32 v34, v42
    ds_read_b128 v[80:83], v6 offset:12288
    ds_read_b128 v[84:87], v6 offset:13312
    s_waitcnt lgkmcnt(4)
    v_smfmac_f32_16x16x64_bf16 v[48:51], v[72:75], v[88:95], v4
    v_permlane32_swap_b32 v35, v43
    v_add_f32 v32, v32, v40
    v_add_f32 v33, v33, v41
    v_add_f32 v34, v34, v42
    ds_read_b128 v[88:91], v6 offset:14336
    ds_read_b128 v[92:95], v6 offset:15360
    s_waitcnt lgkmcnt(4)
    v_smfmac_f32_16x16x64_bf16 v[48:51], v[76:79], v[96:103], v4
    v_add_f32 v35, v35, v43
    v_permlane32_swap_b32 v36, v44
    v_permlane32_swap_b32 v37, v45
    v_permlane32_swap_b32 v38, v46
    ds_read_b128 v[96:99], v6 offset:16384
    ds_read_b128 v[100:103], v6 offset:17408
    v_permlane32_swap_b32 v39, v47
    v_add_f32 v36, v36, v44
    v_add_f32 v37, v37, v45
    v_add_f32 v38, v38, v46
    s_waitcnt lgkmcnt(4)
    v_smfmac_f32_16x16x64_bf16 v[52:55], v[68:71], v[80:87], v4
    v_add_f32 v39, v39, v47
    v_cvt_pk_bf16_f32 v60, v32, v33
    v_cvt_pk_bf16_f32 v61, v34, v35
    s_waitcnt lgkmcnt(2)
    v_smfmac_f32_16x16x64_bf16 v[52:55], v[72:75], v[88:95], v4
    v_cvt_pk_bf16_f32 v62, v36, v37
    v_cvt_pk_bf16_f32 v63, v38, v39
    s_waitcnt lgkmcnt(0)
    v_smfmac_f32_16x16x64_bf16 v[52:55], v[76:79], v[96:103], v4
    v_permlane16_swap_b32 v60, v62
    v_permlane16_swap_b32 v61, v63
    v_min_u32 v60, -2, v60
    v_min_u32 v61, -2, v61
    v_min_u32 v62, -2, v62
    v_min_u32 v63, -2, v63
    buffer_store_dwordx4 v[60:63], v14, s[8:11], s49 offen sc1
    s_nop 0
    v_permlane32_swap_b32 v48, v52
    v_permlane32_swap_b32 v49, v53
    v_permlane32_swap_b32 v50, v54
    v_permlane32_swap_b32 v51, v55
    v_add_f32 v48, v48, v52
    v_add_f32 v49, v49, v53
    v_add_f32 v50, v50, v54
    v_add_f32 v51, v51, v55
    v_cvt_pk_bf16_f32 v64, v48, v49
    v_cvt_pk_bf16_f32 v65, v50, v51
    v_mov_b32 v66, v64
    v_mov_b32 v67, v65
    s_nop 0
    v_permlane16_swap_b32 v64, v66
    v_permlane16_swap_b32 v65, v67
    v_min_u32 v64, -2, v64
    v_min_u32 v65, -2, v65
    v_min_u32 v66, -2, v66
    v_min_u32 v67, -2, v67
    buffer_store_dwordx4 v[64:67], v15, s[8:11], s43 offen sc1
    s_add_u32 s40, s40, 1
    s_add_u32 s47, s37, 704512
    s_add_u32 s45, s37, 737280
    s_lshl_b32 s24, s40, 12
    s_and_b32 s24, s24, 0x2000
    s_xor_b32 s24, s24, s36
    s_lshl_b32 s37, s40, 20
    s_add_u32 s37, s37, s24
    s_add_u32 s37, s37, 117440512
    s_add_u32 s43, s37, 0
    s_cmp_lt_u32 s40, 64
    s_cbranch_scc1 interleave_layers__linear_attn_block__memory_aug_recurrent_mem_tr__prompt_kernel_v_stepw1
    s_branch interleave_layers__linear_attn_block__memory_aug_recurrent_mem_tr__prompt_kernel_v_end
interleave_layers__linear_attn_block__memory_aug_recurrent_mem_tr__prompt_kernel_v_stepw2:
    v_mov_b32 v16, 0
    v_mov_b32 v17, 0
    v_mov_b32 v18, 0
    v_mov_b32 v19, 0
    v_mov_b32 v20, 0
    v_mov_b32 v21, 0
    v_mov_b32 v22, 0
    v_mov_b32 v23, 0
    v_mov_b32 v24, 0
    v_mov_b32 v25, 0
    v_mov_b32 v26, 0
    v_mov_b32 v27, 0
    v_mov_b32 v28, 0
    v_mov_b32 v29, 0
    v_mov_b32 v30, 0
    v_mov_b32 v31, 0
    v_mov_b32 v32, 0
    v_mov_b32 v33, 0
    v_mov_b32 v34, 0
    v_mov_b32 v35, 0
    v_mov_b32 v36, 0
    v_mov_b32 v37, 0
    v_mov_b32 v38, 0
    v_mov_b32 v39, 0
    v_mov_b32 v40, 0
    v_mov_b32 v41, 0
    v_mov_b32 v42, 0
    v_mov_b32 v43, 0
    v_mov_b32 v44, 0
    v_mov_b32 v45, 0
    v_mov_b32 v46, 0
    v_mov_b32 v47, 0
    v_mov_b32 v48, 0
    v_mov_b32 v49, 0
    v_mov_b32 v50, 0
    v_mov_b32 v51, 0
    v_mov_b32 v52, 0
    v_mov_b32 v53, 0
    v_mov_b32 v54, 0
    v_mov_b32 v55, 0
    v_mov_b32 v56, 0
    v_mov_b32 v57, 0
    v_mov_b32 v58, 0
    v_mov_b32 v59, 0
    v_mov_b32 v60, 0
    v_mov_b32 v61, 0
    v_mov_b32 v62, 0
    v_mov_b32 v63, 0
    v_mov_b32 v64, 0
    v_mov_b32 v65, 0
    v_mov_b32 v66, 0
    v_mov_b32 v67, 0
    s_add_u32 s48, s47, 4096
    s_add_u32 s50, s47, 8192
    s_lshl_b32 s95, s92, 6
    s_add_u32 s95, s95, s40
    s_add_u32 s95, s95, 1
    s_cmp_ge_i32 s59, s95
    s_cbranch_scc1 interleave_layers__linear_attn_block__memory_aug_recurrent_mem_tr__prompt_kernel_v_ecw2_ok
    s_and_b32 s24, s2, 7
    s_lshl_b32 s24, s24, 7
    s_add_u32 s24, s24, 23109632
    v_and_b32 v79, 3, v1
    v_lshl_add_u32 v79, v79, 2, s24
    s_mov_b32 s61, 0
interleave_layers__linear_attn_block__memory_aug_recurrent_mem_tr__prompt_kernel_v_ecw2:
    buffer_load_dword v78, v79, s[8:11], 0 offen sc1
    s_waitcnt vmcnt(0)
    v_readlane_b32 s59, v78, 0
    v_readlane_b32 s24, v78, 1
    s_min_i32 s59, s59, s24
    v_readlane_b32 s24, v78, 2
    s_min_i32 s59, s59, s24
    s_cmp_ge_i32 s59, s95
    s_cbranch_scc1 interleave_layers__linear_attn_block__memory_aug_recurrent_mem_tr__prompt_kernel_v_ecw2_ok
    s_add_u32 s61, s61, 1
    s_cmp_ge_u32 s61, s60
    s_cbranch_scc1 interleave_layers__linear_attn_block__memory_aug_recurrent_mem_tr__prompt_kernel_v_ecw2_to
    s_sleep 2
    s_branch interleave_layers__linear_attn_block__memory_aug_recurrent_mem_tr__prompt_kernel_v_ecw2
interleave_layers__linear_attn_block__memory_aug_recurrent_mem_tr__prompt_kernel_v_ecw2_to:
    s_mov_b32 s60, 1
interleave_layers__linear_attn_block__memory_aug_recurrent_mem_tr__prompt_kernel_v_ecw2_ok:
    s_sleep 20
    s_mov_b64 exec, 1
    s_mov_b32 s61, 0
    v_mov_b32 v81, 0
    buffer_atomic_add v81, v12, s[8:11], s45 offen sc0
    s_sleep 2
    v_mov_b32 v82, 0
    buffer_atomic_add v82, v12, s[8:11], s45 offen sc0
    s_sleep 2
    v_mov_b32 v83, 0
    buffer_atomic_add v83, v12, s[8:11], s45 offen sc0
    s_sleep 2
interleave_layers__linear_attn_block__memory_aug_recurrent_mem_tr__prompt_kernel_v_prw2:
    v_mov_b32 v80, 0
    buffer_atomic_add v80, v12, s[8:11], s45 offen sc0
    s_waitcnt vmcnt(3)
    v_cmp_le_i32 vcc, 9, v81
    s_add_u32 s61, s61, 1
    s_cbranch_vccnz interleave_layers__linear_attn_block__memory_aug_recurrent_mem_tr__prompt_kernel_v_prw2_out
    s_sleep 2
    v_mov_b32 v81, 0
    buffer_atomic_add v81, v12, s[8:11], s45 offen sc0
    s_waitcnt vmcnt(3)
    v_cmp_le_i32 vcc, 9, v82
    s_add_u32 s61, s61, 1
    s_cbranch_vccnz interleave_layers__linear_attn_block__memory_aug_recurrent_mem_tr__prompt_kernel_v_prw2_out
    s_sleep 2
    v_mov_b32 v82, 0
    buffer_atomic_add v82, v12, s[8:11], s45 offen sc0
    s_waitcnt vmcnt(3)
    v_cmp_le_i32 vcc, 9, v83
    s_add_u32 s61, s61, 1
    s_cbranch_vccnz interleave_layers__linear_attn_block__memory_aug_recurrent_mem_tr__prompt_kernel_v_prw2_out
    s_sleep 2
    v_mov_b32 v83, 0
    buffer_atomic_add v83, v12, s[8:11], s45 offen sc0
    s_waitcnt vmcnt(3)
    v_cmp_le_i32 vcc, 9, v80
    s_add_u32 s61, s61, 1
    s_cbranch_vccnz interleave_layers__linear_attn_block__memory_aug_recurrent_mem_tr__prompt_kernel_v_prw2_out
    s_sleep 2
    s_cmp_ge_u32 s61, s60
    s_cbranch_scc0 interleave_layers__linear_attn_block__memory_aug_recurrent_mem_tr__prompt_kernel_v_prw2
    s_mov_b32 s60, 1
interleave_layers__linear_attn_block__memory_aug_recurrent_mem_tr__prompt_kernel_v_prw2_out:
    s_mov_b64 exec, -1
    buffer_load_dwordx4 v[68:71], v7, s[8:11], s47 offen sc1
    buffer_load_dwordx4 v[72:75], v7, s[8:11], s48 offen sc1
    buffer_load_dwordx2 v[76:77], v8, s[8:11], s50 offen sc1
    s_waitcnt vmcnt(0)
    v_max3_u32 v103, v68, v69, v70
    v_max3_u32 v103, v103, v71, v72
    v_max3_u32 v103, v103, v73, v74
    v_max3_u32 v103, v103, v75, v76
    v_max_u32 v103, v103, v77
    v_cmp_eq_u32 vcc, -1, v103
    s_cbranch_vccz interleave_layers__linear_attn_block__memory_aug_recurrent_mem_tr__prompt_kernel_v_pmw2_out
    s_mov_b32 s61, 0
interleave_layers__linear_attn_block__memory_aug_recurrent_mem_tr__prompt_kernel_v_pmw2:
    buffer_load_dwordx4 v[68:71], v7, s[8:11], s47 offen sc1
    buffer_load_dwordx4 v[72:75], v7, s[8:11], s48 offen sc1
    buffer_load_dwordx2 v[76:77], v8, s[8:11], s50 offen sc1
    s_waitcnt vmcnt(0)
    v_max3_u32 v103, v68, v69, v70
    v_max3_u32 v103, v103, v71, v72
    v_max3_u32 v103, v103, v73, v74
    v_max3_u32 v103, v103, v75, v76
    v_max_u32 v103, v103, v77
    v_cmp_eq_u32 vcc, -1, v103
    s_add_u32 s61, s61, 1
    s_cbranch_vccz interleave_layers__linear_attn_block__memory_aug_recurrent_mem_tr__prompt_kernel_v_pmw2_out
    s_cmp_ge_u32 s61, s60
    s_cbranch_scc1 interleave_layers__linear_attn_block__memory_aug_recurrent_mem_tr__prompt_kernel_v_pmw2_to
    s_sleep 1
    s_branch interleave_layers__linear_attn_block__memory_aug_recurrent_mem_tr__prompt_kernel_v_pmw2
interleave_layers__linear_attn_block__memory_aug_recurrent_mem_tr__prompt_kernel_v_pmw2_to:
    s_mov_b32 s60, 1
interleave_layers__linear_attn_block__memory_aug_recurrent_mem_tr__prompt_kernel_v_pmw2_out:
    ds_write_b128 v7, v[68:71]
    ds_write_b128 v7, v[72:75] offset:4096
    ds_write_b64 v8, v[76:77]
interleave_layers__linear_attn_block__memory_aug_recurrent_mem_tr__prompt_kernel_v_gow2:
    v_smfmac_f32_16x16x64_bf16 v[56:59], v[68:71], a[16:23], v4
    v_smfmac_f32_16x16x64_bf16 v[60:63], v[68:71], a[96:103], v4
    v_smfmac_f32_16x16x64_bf16 v[64:67], v[68:71], a[176:183], v4
    s_waitcnt lgkmcnt(0)
    s_barrier
    ds_read_b128 v[80:83], v5 offset:0
    ds_read_b128 v[84:87], v5 offset:1024
    ds_read_b128 v[88:91], v5 offset:3072
    ds_read_b128 v[92:95], v5 offset:4096
    ds_read_b128 v[96:99], v5 offset:5120
    ds_read_b128 v[100:103], v5 offset:7168
    ds_read_b128 v[76:79], v5 offset:8192
    ds_read_b128 v[68:71], v5 offset:9216
    v_smfmac_f32_16x16x64_bf16 v[64:67], v[72:75], a[208:215], v4
    v_smfmac_f32_16x16x64_bf16 v[56:59], v[72:75], a[48:55], v4
    v_smfmac_f32_16x16x64_bf16 v[60:63], v[72:75], a[128:135], v4
    s_waitcnt lgkmcnt(7)
    v_smfmac_f32_16x16x64_bf16 v[64:67], v[80:83], a[160:167], v4
    s_waitcnt lgkmcnt(6)
    v_smfmac_f32_16x16x64_bf16 v[64:67], v[84:87], a[168:175], v4
    s_waitcnt lgkmcnt(5)
    v_smfmac_f32_16x16x64_bf16 v[64:67], v[88:91], a[184:191], v4
    s_waitcnt lgkmcnt(4)
    v_smfmac_f32_16x16x64_bf16 v[64:67], v[92:95], a[192:199], v4
    s_waitcnt lgkmcnt(3)
    v_smfmac_f32_16x16x64_bf16 v[64:67], v[96:99], a[200:207], v4
    s_waitcnt lgkmcnt(2)
    v_smfmac_f32_16x16x64_bf16 v[64:67], v[100:103], a[216:223], v4
    s_waitcnt lgkmcnt(1)
    v_smfmac_f32_16x16x64_bf16 v[64:67], v[76:79], a[224:231], v4
    s_waitcnt lgkmcnt(0)
    v_smfmac_f32_16x16x64_bf16 v[64:67], v[68:71], a[232:239], v4
    v_smfmac_f32_16x16x64_bf16 v[56:59], v[80:83], a[0:7], v4
    v_smfmac_f32_16x16x64_bf16 v[60:63], v[80:83], a[80:87], v4
    v_smfmac_f32_16x16x64_bf16 v[56:59], v[84:87], a[8:15], v4
    s_nop 4
    v_mov_b32 v72, v64
    v_smfmac_f32_16x16x64_bf16 v[60:63], v[84:87], a[88:95], v4
    v_mov_b32 v73, v65
    v_mov_b32 v74, v66
    v_smfmac_f32_16x16x64_bf16 v[56:59], v[88:91], a[24:31], v4
    v_mov_b32 v75, v67
    v_smfmac_f32_16x16x64_bf16 v[60:63], v[88:91], a[104:111], v4
    v_permlane32_swap_b32 v64, v72
    v_permlane32_swap_b32 v65, v73
    v_smfmac_f32_16x16x64_bf16 v[56:59], v[92:95], a[32:39], v4
    v_permlane32_swap_b32 v66, v74
    v_permlane32_swap_b32 v67, v75
    v_smfmac_f32_16x16x64_bf16 v[60:63], v[92:95], a[112:119], v4
    v_add_f32 v64, v64, v72
    v_add_f32 v65, v65, v73
    v_smfmac_f32_16x16x64_bf16 v[56:59], v[96:99], a[40:47], v4
    v_add_f32 v66, v66, v74
    v_add_f32 v67, v67, v75
    v_smfmac_f32_16x16x64_bf16 v[60:63], v[96:99], a[120:127], v4
    v_cvt_pk_bf16_f32 v72, v64, v65
    v_cvt_pk_bf16_f32 v73, v66, v67
    v_smfmac_f32_16x16x64_bf16 v[56:59], v[100:103], a[56:63], v4
    ds_write_b64 v9, v[72:73] offset:512
    v_smfmac_f32_16x16x64_bf16 v[60:63], v[100:103], a[136:143], v4
    v_smfmac_f32_16x16x64_bf16 v[56:59], v[76:79], a[64:71], v4
    v_smfmac_f32_16x16x64_bf16 v[60:63], v[76:79], a[144:151], v4
    v_smfmac_f32_16x16x64_bf16 v[56:59], v[68:71], a[72:79], v4
    v_smfmac_f32_16x16x64_bf16 v[60:63], v[68:71], a[152:159], v4
    s_nop 7
    v_permlane32_swap_b32 v56, v60
    v_permlane32_swap_b32 v57, v61
    v_permlane32_swap_b32 v58, v62
    v_permlane32_swap_b32 v59, v63
    v_add_f32 v56, v56, v60
    v_add_f32 v57, v57, v61
    v_add_f32 v58, v58, v62
    v_add_f32 v59, v59, v63
    v_cvt_pk_bf16_f32 v68, v56, v57
    v_cvt_pk_bf16_f32 v69, v58, v59
    ds_write_b64 v10, v[68:69]
    s_waitcnt lgkmcnt(0)
    s_barrier
    ds_read_b64_tr_b16 v[68:69], v11 offset:0
    ds_read_b64_tr_b16 v[70:71], v11 offset:128
    ds_read_b64_tr_b16 v[72:73], v11 offset:1024
    ds_read_b64_tr_b16 v[74:75], v11 offset:1152
    ds_read_b64_tr_b16 v[76:77], v11 offset:2048
    ds_read_b64_tr_b16 v[78:79], v11 offset:2176
    ds_read_b128 v[80:83], v6 offset:0
    ds_read_b128 v[84:87], v6 offset:1024
    ds_read_b128 v[88:91], v6 offset:2048
    ds_read_b128 v[92:95], v6 offset:3072
    ds_read_b128 v[96:99], v6 offset:4096
    ds_read_b128 v[100:103], v6 offset:5120
    s_waitcnt lgkmcnt(10)
    v_smfmac_f32_16x16x64_bf16 v[16:19], v[68:71], a[240:247], v4
    v_smfmac_f32_16x16x64_bf16 v[20:23], v[68:71], v[112:119], v4
    v_smfmac_f32_16x16x64_bf16 v[24:27], v[68:71], v[136:143], v4
    v_smfmac_f32_16x16x64_bf16 v[28:31], v[68:71], v[160:167], v4
    s_waitcnt lgkmcnt(8)
    v_smfmac_f32_16x16x64_bf16 v[16:19], v[72:75], a[248:255], v4
    v_smfmac_f32_16x16x64_bf16 v[20:23], v[72:75], v[120:127], v4
    v_smfmac_f32_16x16x64_bf16 v[24:27], v[72:75], v[144:151], v4
    v_smfmac_f32_16x16x64_bf16 v[28:31], v[72:75], v[168:175], v4
    s_waitcnt lgkmcnt(6)
    v_smfmac_f32_16x16x64_bf16 v[16:19], v[76:79], v[104:111], v4
    v_smfmac_f32_16x16x64_bf16 v[20:23], v[76:79], v[128:135], v4
    v_smfmac_f32_16x16x64_bf16 v[24:27], v[76:79], v[152:159], v4
    v_smfmac_f32_16x16x64_bf16 v[28:31], v[76:79], v[176:183], v4
    v_smfmac_f32_16x16x64_bf16 v[32:35], v[68:71], v[184:191], v4
    v_smfmac_f32_16x16x64_bf16 v[36:39], v[68:71], v[208:215], v4
    s_nop 4
    v_permlane32_swap_b32 v16, v24
    v_permlane32_swap_b32 v17, v25
    v_smfmac_f32_16x16x64_bf16 v[40:43], v[68:71], v[232:239], v4
    v_permlane32_swap_b32 v18, v26
    v_permlane32_swap_b32 v19, v27
    s_waitcnt lgkmcnt(4)
    v_smfmac_f32_16x16x64_bf16 v[44:47], v[68:71], v[80:87], v4
    v_add_f32 v16, v16, v24
    v_add_f32 v17, v17, v25
    ds_read_b128 v[80:83], v6 offset:6144
    ds_read_b128 v[84:87], v6 offset:7168
    v_smfmac_f32_16x16x64_bf16 v[32:35], v[72:75], v[192:199], v4
    v_add_f32 v18, v18, v26
    v_add_f32 v19, v19, v27
    v_smfmac_f32_16x16x64_bf16 v[36:39], v[72:75], v[216:223], v4
    v_permlane32_swap_b32 v20, v28
    v_permlane32_swap_b32 v21, v29
    v_smfmac_f32_16x16x64_bf16 v[40:43], v[72:75], v[240:247], v4
    v_permlane32_swap_b32 v22, v30
    v_permlane32_swap_b32 v23, v31
    s_waitcnt lgkmcnt(4)
    v_smfmac_f32_16x16x64_bf16 v[44:47], v[72:75], v[88:95], v4
    v_add_f32 v20, v20, v28
    v_add_f32 v21, v21, v29
    ds_read_b128 v[88:91], v6 offset:8192
    ds_read_b128 v[92:95], v6 offset:9216
    v_smfmac_f32_16x16x64_bf16 v[32:35], v[76:79], v[200:207], v4
    v_add_f32 v22, v22, v30
    v_add_f32 v23, v23, v31
    v_smfmac_f32_16x16x64_bf16 v[36:39], v[76:79], v[224:231], v4
    v_cvt_pk_bf16_f32 v56, v16, v17
    v_cvt_pk_bf16_f32 v57, v18, v19
    v_smfmac_f32_16x16x64_bf16 v[40:43], v[76:79], v[248:255], v4
    v_cvt_pk_bf16_f32 v58, v20, v21
    v_cvt_pk_bf16_f32 v59, v22, v23
    s_waitcnt lgkmcnt(4)
    v_smfmac_f32_16x16x64_bf16 v[44:47], v[76:79], v[96:103], v4
    v_permlane16_swap_b32 v56, v58
    ds_read_b128 v[96:99], v6 offset:10240
    ds_read_b128 v[100:103], v6 offset:11264
    v_permlane16_swap_b32 v57, v59
    v_min_u32 v56, -2, v56
    v_min_u32 v57, -2, v57
    v_min_u32 v58, -2, v58
    v_min_u32 v59, -2, v59
    buffer_store_dwordx4 v[56:59], v14, s[8:11], s43 offen sc1
    s_add_u32 s49, s43, 65536
    s_waitcnt lgkmcnt(4)
    v_smfmac_f32_16x16x64_bf16 v[48:51], v[68:71], v[80:87], v4
    v_permlane32_swap_b32 v32, v40
    v_permlane32_swap_b32 v33, v41
    v_permlane32_swap_b32 v34, v42
    ds_read_b128 v[80:83], v6 offset:12288
    ds_read_b128 v[84:87], v6 offset:13312
    s_waitcnt lgkmcnt(4)
    v_smfmac_f32_16x16x64_bf16 v[48:51], v[72:75], v[88:95], v4
    v_permlane32_swap_b32 v35, v43
    v_add_f32 v32, v32, v40
    v_add_f32 v33, v33, v41
    v_add_f32 v34, v34, v42
    ds_read_b128 v[88:91], v6 offset:14336
    ds_read_b128 v[92:95], v6 offset:15360
    s_waitcnt lgkmcnt(4)
    v_smfmac_f32_16x16x64_bf16 v[48:51], v[76:79], v[96:103], v4
    v_add_f32 v35, v35, v43
    v_permlane32_swap_b32 v36, v44
    v_permlane32_swap_b32 v37, v45
    v_permlane32_swap_b32 v38, v46
    ds_read_b128 v[96:99], v6 offset:16384
    ds_read_b128 v[100:103], v6 offset:17408
    v_permlane32_swap_b32 v39, v47
    v_add_f32 v36, v36, v44
    v_add_f32 v37, v37, v45
    v_add_f32 v38, v38, v46
    s_waitcnt lgkmcnt(4)
    v_smfmac_f32_16x16x64_bf16 v[52:55], v[68:71], v[80:87], v4
    v_add_f32 v39, v39, v47
    v_cvt_pk_bf16_f32 v60, v32, v33
    v_cvt_pk_bf16_f32 v61, v34, v35
    s_waitcnt lgkmcnt(2)
    v_smfmac_f32_16x16x64_bf16 v[52:55], v[72:75], v[88:95], v4
    v_cvt_pk_bf16_f32 v62, v36, v37
    v_cvt_pk_bf16_f32 v63, v38, v39
    s_waitcnt lgkmcnt(0)
    v_smfmac_f32_16x16x64_bf16 v[52:55], v[76:79], v[96:103], v4
    v_permlane16_swap_b32 v60, v62
    v_permlane16_swap_b32 v61, v63
    v_min_u32 v60, -2, v60
    v_min_u32 v61, -2, v61
    v_min_u32 v62, -2, v62
    v_min_u32 v63, -2, v63
    buffer_store_dwordx4 v[60:63], v14, s[8:11], s49 offen sc1
    s_nop 0
    v_permlane32_swap_b32 v48, v52
    v_permlane32_swap_b32 v49, v53
    v_permlane32_swap_b32 v50, v54
    v_permlane32_swap_b32 v51, v55
    v_add_f32 v48, v48, v52
    v_add_f32 v49, v49, v53
    v_add_f32 v50, v50, v54
    v_add_f32 v51, v51, v55
    v_cvt_pk_bf16_f32 v64, v48, v49
    v_cvt_pk_bf16_f32 v65, v50, v51
    v_mov_b32 v66, v64
    v_mov_b32 v67, v65
    s_nop 0
    v_permlane16_swap_b32 v64, v66
    v_permlane16_swap_b32 v65, v67
    v_min_u32 v64, -2, v64
    v_min_u32 v65, -2, v65
    v_min_u32 v66, -2, v66
    v_min_u32 v67, -2, v67
    buffer_store_dwordx4 v[64:67], v15, s[8:11], s43 offen sc1
    s_add_u32 s40, s40, 1
    s_add_u32 s47, s37, 704512
    s_add_u32 s45, s37, 737280
    s_lshl_b32 s24, s40, 12
    s_and_b32 s24, s24, 0x2000
    s_xor_b32 s24, s24, s36
    s_lshl_b32 s37, s40, 20
    s_add_u32 s37, s37, s24
    s_add_u32 s37, s37, 117440512
    s_add_u32 s43, s37, 0
    s_cmp_lt_u32 s40, 64
    s_cbranch_scc1 interleave_layers__linear_attn_block__memory_aug_recurrent_mem_tr__prompt_kernel_v_stepw2
    s_branch interleave_layers__linear_attn_block__memory_aug_recurrent_mem_tr__prompt_kernel_v_end
interleave_layers__linear_attn_block__memory_aug_recurrent_mem_tr__prompt_kernel_v_stepw3:
    v_mov_b32 v16, 0
    v_mov_b32 v17, 0
    v_mov_b32 v18, 0
    v_mov_b32 v19, 0
    v_mov_b32 v20, 0
    v_mov_b32 v21, 0
    v_mov_b32 v22, 0
    v_mov_b32 v23, 0
    v_mov_b32 v24, 0
    v_mov_b32 v25, 0
    v_mov_b32 v26, 0
    v_mov_b32 v27, 0
    v_mov_b32 v28, 0
    v_mov_b32 v29, 0
    v_mov_b32 v30, 0
    v_mov_b32 v31, 0
    v_mov_b32 v32, 0
    v_mov_b32 v33, 0
    v_mov_b32 v34, 0
    v_mov_b32 v35, 0
    v_mov_b32 v36, 0
    v_mov_b32 v37, 0
    v_mov_b32 v38, 0
    v_mov_b32 v39, 0
    v_mov_b32 v40, 0
    v_mov_b32 v41, 0
    v_mov_b32 v42, 0
    v_mov_b32 v43, 0
    v_mov_b32 v44, 0
    v_mov_b32 v45, 0
    v_mov_b32 v46, 0
    v_mov_b32 v47, 0
    v_mov_b32 v48, 0
    v_mov_b32 v49, 0
    v_mov_b32 v50, 0
    v_mov_b32 v51, 0
    v_mov_b32 v52, 0
    v_mov_b32 v53, 0
    v_mov_b32 v54, 0
    v_mov_b32 v55, 0
    v_mov_b32 v56, 0
    v_mov_b32 v57, 0
    v_mov_b32 v58, 0
    v_mov_b32 v59, 0
    v_mov_b32 v60, 0
    v_mov_b32 v61, 0
    v_mov_b32 v62, 0
    v_mov_b32 v63, 0
    v_mov_b32 v64, 0
    v_mov_b32 v65, 0
    v_mov_b32 v66, 0
    v_mov_b32 v67, 0
    s_add_u32 s48, s47, 4096
    s_add_u32 s50, s47, 8192
    s_lshl_b32 s95, s92, 6
    s_add_u32 s95, s95, s40
    s_add_u32 s95, s95, 1
    s_cmp_ge_i32 s59, s95
    s_cbranch_scc1 interleave_layers__linear_attn_block__memory_aug_recurrent_mem_tr__prompt_kernel_v_ecw3_ok
    s_and_b32 s24, s2, 7
    s_lshl_b32 s24, s24, 7
    s_add_u32 s24, s24, 23109632
    v_and_b32 v79, 3, v1
    v_lshl_add_u32 v79, v79, 2, s24
    s_mov_b32 s61, 0
interleave_layers__linear_attn_block__memory_aug_recurrent_mem_tr__prompt_kernel_v_ecw3:
    buffer_load_dword v78, v79, s[8:11], 0 offen sc1
    s_waitcnt vmcnt(0)
    v_readlane_b32 s59, v78, 0
    v_readlane_b32 s24, v78, 1
    s_min_i32 s59, s59, s24
    v_readlane_b32 s24, v78, 2
    s_min_i32 s59, s59, s24
    s_cmp_ge_i32 s59, s95
    s_cbranch_scc1 interleave_layers__linear_attn_block__memory_aug_recurrent_mem_tr__prompt_kernel_v_ecw3_ok
    s_add_u32 s61, s61, 1
    s_cmp_ge_u32 s61, s60
    s_cbranch_scc1 interleave_layers__linear_attn_block__memory_aug_recurrent_mem_tr__prompt_kernel_v_ecw3_to
    s_sleep 2
    s_branch interleave_layers__linear_attn_block__memory_aug_recurrent_mem_tr__prompt_kernel_v_ecw3
interleave_layers__linear_attn_block__memory_aug_recurrent_mem_tr__prompt_kernel_v_ecw3_to:
    s_mov_b32 s60, 1
interleave_layers__linear_attn_block__memory_aug_recurrent_mem_tr__prompt_kernel_v_ecw3_ok:
    s_sleep 20
    s_mov_b64 exec, 1
    s_mov_b32 s61, 0
    v_mov_b32 v81, 0
    buffer_atomic_add v81, v12, s[8:11], s45 offen sc0
    s_sleep 2
    v_mov_b32 v82, 0
    buffer_atomic_add v82, v12, s[8:11], s45 offen sc0
    s_sleep 2
    v_mov_b32 v83, 0
    buffer_atomic_add v83, v12, s[8:11], s45 offen sc0
    s_sleep 2
interleave_layers__linear_attn_block__memory_aug_recurrent_mem_tr__prompt_kernel_v_prw3:
    v_mov_b32 v80, 0
    buffer_atomic_add v80, v12, s[8:11], s45 offen sc0
    s_waitcnt vmcnt(3)
    v_cmp_le_i32 vcc, 9, v81
    s_add_u32 s61, s61, 1
    s_cbranch_vccnz interleave_layers__linear_attn_block__memory_aug_recurrent_mem_tr__prompt_kernel_v_prw3_out
    s_sleep 2
    v_mov_b32 v81, 0
    buffer_atomic_add v81, v12, s[8:11], s45 offen sc0
    s_waitcnt vmcnt(3)
    v_cmp_le_i32 vcc, 9, v82
    s_add_u32 s61, s61, 1
    s_cbranch_vccnz interleave_layers__linear_attn_block__memory_aug_recurrent_mem_tr__prompt_kernel_v_prw3_out
    s_sleep 2
    v_mov_b32 v82, 0
    buffer_atomic_add v82, v12, s[8:11], s45 offen sc0
    s_waitcnt vmcnt(3)
    v_cmp_le_i32 vcc, 9, v83
    s_add_u32 s61, s61, 1
    s_cbranch_vccnz interleave_layers__linear_attn_block__memory_aug_recurrent_mem_tr__prompt_kernel_v_prw3_out
    s_sleep 2
    v_mov_b32 v83, 0
    buffer_atomic_add v83, v12, s[8:11], s45 offen sc0
    s_waitcnt vmcnt(3)
    v_cmp_le_i32 vcc, 9, v80
    s_add_u32 s61, s61, 1
    s_cbranch_vccnz interleave_layers__linear_attn_block__memory_aug_recurrent_mem_tr__prompt_kernel_v_prw3_out
    s_sleep 2
    s_cmp_ge_u32 s61, s60
    s_cbranch_scc0 interleave_layers__linear_attn_block__memory_aug_recurrent_mem_tr__prompt_kernel_v_prw3
    s_mov_b32 s60, 1
interleave_layers__linear_attn_block__memory_aug_recurrent_mem_tr__prompt_kernel_v_prw3_out:
    s_mov_b64 exec, -1
    buffer_load_dwordx4 v[68:71], v7, s[8:11], s47 offen sc1
    buffer_load_dwordx4 v[72:75], v7, s[8:11], s48 offen sc1
    buffer_load_dwordx2 v[76:77], v8, s[8:11], s50 offen sc1
    s_waitcnt vmcnt(0)
    v_max3_u32 v103, v68, v69, v70
    v_max3_u32 v103, v103, v71, v72
    v_max3_u32 v103, v103, v73, v74
    v_max3_u32 v103, v103, v75, v76
    v_max_u32 v103, v103, v77
    v_cmp_eq_u32 vcc, -1, v103
    s_cbranch_vccz interleave_layers__linear_attn_block__memory_aug_recurrent_mem_tr__prompt_kernel_v_pmw3_out
    s_mov_b32 s61, 0
interleave_layers__linear_attn_block__memory_aug_recurrent_mem_tr__prompt_kernel_v_pmw3:
    buffer_load_dwordx4 v[68:71], v7, s[8:11], s47 offen sc1
    buffer_load_dwordx4 v[72:75], v7, s[8:11], s48 offen sc1
    buffer_load_dwordx2 v[76:77], v8, s[8:11], s50 offen sc1
    s_waitcnt vmcnt(0)
    v_max3_u32 v103, v68, v69, v70
    v_max3_u32 v103, v103, v71, v72
    v_max3_u32 v103, v103, v73, v74
    v_max3_u32 v103, v103, v75, v76
    v_max_u32 v103, v103, v77
    v_cmp_eq_u32 vcc, -1, v103
    s_add_u32 s61, s61, 1
    s_cbranch_vccz interleave_layers__linear_attn_block__memory_aug_recurrent_mem_tr__prompt_kernel_v_pmw3_out
    s_cmp_ge_u32 s61, s60
    s_cbranch_scc1 interleave_layers__linear_attn_block__memory_aug_recurrent_mem_tr__prompt_kernel_v_pmw3_to
    s_sleep 1
    s_branch interleave_layers__linear_attn_block__memory_aug_recurrent_mem_tr__prompt_kernel_v_pmw3
interleave_layers__linear_attn_block__memory_aug_recurrent_mem_tr__prompt_kernel_v_pmw3_to:
    s_mov_b32 s60, 1
interleave_layers__linear_attn_block__memory_aug_recurrent_mem_tr__prompt_kernel_v_pmw3_out:
    ds_write_b128 v7, v[68:71]
    ds_write_b128 v7, v[72:75] offset:4096
    ds_write_b64 v8, v[76:77]
interleave_layers__linear_attn_block__memory_aug_recurrent_mem_tr__prompt_kernel_v_gow3:
    v_smfmac_f32_16x16x64_bf16 v[56:59], v[68:71], a[24:31], v4
    v_smfmac_f32_16x16x64_bf16 v[60:63], v[68:71], a[104:111], v4
    v_smfmac_f32_16x16x64_bf16 v[64:67], v[68:71], a[184:191], v4
    s_waitcnt lgkmcnt(0)
    s_barrier
    ds_read_b128 v[80:83], v5 offset:0
    ds_read_b128 v[84:87], v5 offset:1024
    ds_read_b128 v[88:91], v5 offset:2048
    ds_read_b128 v[92:95], v5 offset:4096
    ds_read_b128 v[96:99], v5 offset:5120
    ds_read_b128 v[100:103], v5 offset:6144
    ds_read_b128 v[76:79], v5 offset:8192
    ds_read_b128 v[68:71], v5 offset:9216
    v_smfmac_f32_16x16x64_bf16 v[64:67], v[72:75], a[216:223], v4
    v_smfmac_f32_16x16x64_bf16 v[56:59], v[72:75], a[56:63], v4
    v_smfmac_f32_16x16x64_bf16 v[60:63], v[72:75], a[136:143], v4
    s_waitcnt lgkmcnt(7)
    v_smfmac_f32_16x16x64_bf16 v[64:67], v[80:83], a[160:167], v4
    s_waitcnt lgkmcnt(6)
    v_smfmac_f32_16x16x64_bf16 v[64:67], v[84:87], a[168:175], v4
    s_waitcnt lgkmcnt(5)
    v_smfmac_f32_16x16x64_bf16 v[64:67], v[88:91], a[176:183], v4
    s_waitcnt lgkmcnt(4)
    v_smfmac_f32_16x16x64_bf16 v[64:67], v[92:95], a[192:199], v4
    s_waitcnt lgkmcnt(3)
    v_smfmac_f32_16x16x64_bf16 v[64:67], v[96:99], a[200:207], v4
    s_waitcnt lgkmcnt(2)
    v_smfmac_f32_16x16x64_bf16 v[64:67], v[100:103], a[208:215], v4
    s_waitcnt lgkmcnt(1)
    v_smfmac_f32_16x16x64_bf16 v[64:67], v[76:79], a[224:231], v4
    s_waitcnt lgkmcnt(0)
    v_smfmac_f32_16x16x64_bf16 v[64:67], v[68:71], a[232:239], v4
    v_smfmac_f32_16x16x64_bf16 v[56:59], v[80:83], a[0:7], v4
    v_smfmac_f32_16x16x64_bf16 v[60:63], v[80:83], a[80:87], v4
    v_smfmac_f32_16x16x64_bf16 v[56:59], v[84:87], a[8:15], v4
    s_nop 4
    v_mov_b32 v72, v64
    v_smfmac_f32_16x16x64_bf16 v[60:63], v[84:87], a[88:95], v4
    v_mov_b32 v73, v65
    v_mov_b32 v74, v66
    v_smfmac_f32_16x16x64_bf16 v[56:59], v[88:91], a[16:23], v4
    v_mov_b32 v75, v67
    v_smfmac_f32_16x16x64_bf16 v[60:63], v[88:91], a[96:103], v4
    v_permlane32_swap_b32 v64, v72
    v_permlane32_swap_b32 v65, v73
    v_smfmac_f32_16x16x64_bf16 v[56:59], v[92:95], a[32:39], v4
    v_permlane32_swap_b32 v66, v74
    v_permlane32_swap_b32 v67, v75
    v_smfmac_f32_16x16x64_bf16 v[60:63], v[92:95], a[112:119], v4
    v_add_f32 v64, v64, v72
    v_add_f32 v65, v65, v73
    v_smfmac_f32_16x16x64_bf16 v[56:59], v[96:99], a[40:47], v4
    v_add_f32 v66, v66, v74
    v_add_f32 v67, v67, v75
    v_smfmac_f32_16x16x64_bf16 v[60:63], v[96:99], a[120:127], v4
    v_cvt_pk_bf16_f32 v72, v64, v65
    v_cvt_pk_bf16_f32 v73, v66, v67
    v_smfmac_f32_16x16x64_bf16 v[56:59], v[100:103], a[48:55], v4
    ds_write_b64 v9, v[72:73] offset:512
    v_smfmac_f32_16x16x64_bf16 v[60:63], v[100:103], a[128:135], v4
    v_smfmac_f32_16x16x64_bf16 v[56:59], v[76:79], a[64:71], v4
    v_smfmac_f32_16x16x64_bf16 v[60:63], v[76:79], a[144:151], v4
    v_smfmac_f32_16x16x64_bf16 v[56:59], v[68:71], a[72:79], v4
    v_smfmac_f32_16x16x64_bf16 v[60:63], v[68:71], a[152:159], v4
    s_nop 7
    v_permlane32_swap_b32 v56, v60
    v_permlane32_swap_b32 v57, v61
    v_permlane32_swap_b32 v58, v62
    v_permlane32_swap_b32 v59, v63
    v_add_f32 v56, v56, v60
    v_add_f32 v57, v57, v61
    v_add_f32 v58, v58, v62
    v_add_f32 v59, v59, v63
    v_cvt_pk_bf16_f32 v68, v56, v57
    v_cvt_pk_bf16_f32 v69, v58, v59
    ds_write_b64 v10, v[68:69]
    s_waitcnt lgkmcnt(0)
    s_barrier
    ds_read_b64_tr_b16 v[68:69], v11 offset:0
    ds_read_b64_tr_b16 v[70:71], v11 offset:128
    ds_read_b64_tr_b16 v[72:73], v11 offset:1024
    ds_read_b64_tr_b16 v[74:75], v11 offset:1152
    ds_read_b64_tr_b16 v[76:77], v11 offset:2048
    ds_read_b64_tr_b16 v[78:79], v11 offset:2176
    ds_read_b128 v[80:83], v6 offset:0
    ds_read_b128 v[84:87], v6 offset:1024
    ds_read_b128 v[88:91], v6 offset:2048
    ds_read_b128 v[92:95], v6 offset:3072
    ds_read_b128 v[96:99], v6 offset:4096
    ds_read_b128 v[100:103], v6 offset:5120
    s_waitcnt lgkmcnt(10)
    v_smfmac_f32_16x16x64_bf16 v[16:19], v[68:71], a[240:247], v4
    v_smfmac_f32_16x16x64_bf16 v[20:23], v[68:71], v[112:119], v4
    v_smfmac_f32_16x16x64_bf16 v[24:27], v[68:71], v[136:143], v4
    v_smfmac_f32_16x16x64_bf16 v[28:31], v[68:71], v[160:167], v4
    s_waitcnt lgkmcnt(8)
    v_smfmac_f32_16x16x64_bf16 v[16:19], v[72:75], a[248:255], v4
    v_smfmac_f32_16x16x64_bf16 v[20:23], v[72:75], v[120:127], v4
    v_smfmac_f32_16x16x64_bf16 v[24:27], v[72:75], v[144:151], v4
    v_smfmac_f32_16x16x64_bf16 v[28:31], v[72:75], v[168:175], v4
    s_waitcnt lgkmcnt(6)
    v_smfmac_f32_16x16x64_bf16 v[16:19], v[76:79], v[104:111], v4
    v_smfmac_f32_16x16x64_bf16 v[20:23], v[76:79], v[128:135], v4
    v_smfmac_f32_16x16x64_bf16 v[24:27], v[76:79], v[152:159], v4
    v_smfmac_f32_16x16x64_bf16 v[28:31], v[76:79], v[176:183], v4
    v_smfmac_f32_16x16x64_bf16 v[32:35], v[68:71], v[184:191], v4
    v_smfmac_f32_16x16x64_bf16 v[36:39], v[68:71], v[208:215], v4
    s_nop 4
    v_permlane32_swap_b32 v16, v24
    v_permlane32_swap_b32 v17, v25
    v_smfmac_f32_16x16x64_bf16 v[40:43], v[68:71], v[232:239], v4
    v_permlane32_swap_b32 v18, v26
    v_permlane32_swap_b32 v19, v27
    s_waitcnt lgkmcnt(4)
    v_smfmac_f32_16x16x64_bf16 v[44:47], v[68:71], v[80:87], v4
    v_add_f32 v16, v16, v24
    v_add_f32 v17, v17, v25
    ds_read_b128 v[80:83], v6 offset:6144
    ds_read_b128 v[84:87], v6 offset:7168
    v_smfmac_f32_16x16x64_bf16 v[32:35], v[72:75], v[192:199], v4
    v_add_f32 v18, v18, v26
    v_add_f32 v19, v19, v27
    v_smfmac_f32_16x16x64_bf16 v[36:39], v[72:75], v[216:223], v4
    v_permlane32_swap_b32 v20, v28
    v_permlane32_swap_b32 v21, v29
    v_smfmac_f32_16x16x64_bf16 v[40:43], v[72:75], v[240:247], v4
    v_permlane32_swap_b32 v22, v30
    v_permlane32_swap_b32 v23, v31
    s_waitcnt lgkmcnt(4)
    v_smfmac_f32_16x16x64_bf16 v[44:47], v[72:75], v[88:95], v4
    v_add_f32 v20, v20, v28
    v_add_f32 v21, v21, v29
    ds_read_b128 v[88:91], v6 offset:8192
    ds_read_b128 v[92:95], v6 offset:9216
    v_smfmac_f32_16x16x64_bf16 v[32:35], v[76:79], v[200:207], v4
    v_add_f32 v22, v22, v30
    v_add_f32 v23, v23, v31
    v_smfmac_f32_16x16x64_bf16 v[36:39], v[76:79], v[224:231], v4
    v_cvt_pk_bf16_f32 v56, v16, v17
    v_cvt_pk_bf16_f32 v57, v18, v19
    v_smfmac_f32_16x16x64_bf16 v[40:43], v[76:79], v[248:255], v4
    v_cvt_pk_bf16_f32 v58, v20, v21
    v_cvt_pk_bf16_f32 v59, v22, v23
    s_waitcnt lgkmcnt(4)
    v_smfmac_f32_16x16x64_bf16 v[44:47], v[76:79], v[96:103], v4
    v_permlane16_swap_b32 v56, v58
    ds_read_b128 v[96:99], v6 offset:10240
    ds_read_b128 v[100:103], v6 offset:11264
    v_permlane16_swap_b32 v57, v59
    v_min_u32 v56, -2, v56
    v_min_u32 v57, -2, v57
    v_min_u32 v58, -2, v58
    v_min_u32 v59, -2, v59
    buffer_store_dwordx4 v[56:59], v14, s[8:11], s43 offen sc1
    s_add_u32 s49, s43, 65536
    s_waitcnt lgkmcnt(4)
    v_smfmac_f32_16x16x64_bf16 v[48:51], v[68:71], v[80:87], v4
    v_permlane32_swap_b32 v32, v40
    v_permlane32_swap_b32 v33, v41
    v_permlane32_swap_b32 v34, v42
    ds_read_b128 v[80:83], v6 offset:12288
    ds_read_b128 v[84:87], v6 offset:13312
    s_waitcnt lgkmcnt(4)
    v_smfmac_f32_16x16x64_bf16 v[48:51], v[72:75], v[88:95], v4
    v_permlane32_swap_b32 v35, v43
    v_add_f32 v32, v32, v40
    v_add_f32 v33, v33, v41
    v_add_f32 v34, v34, v42
    ds_read_b128 v[88:91], v6 offset:14336
    ds_read_b128 v[92:95], v6 offset:15360
    s_waitcnt lgkmcnt(4)
    v_smfmac_f32_16x16x64_bf16 v[48:51], v[76:79], v[96:103], v4
    v_add_f32 v35, v35, v43
    v_permlane32_swap_b32 v36, v44
    v_permlane32_swap_b32 v37, v45
    v_permlane32_swap_b32 v38, v46
    ds_read_b128 v[96:99], v6 offset:16384
    ds_read_b128 v[100:103], v6 offset:17408
    v_permlane32_swap_b32 v39, v47
    v_add_f32 v36, v36, v44
    v_add_f32 v37, v37, v45
    v_add_f32 v38, v38, v46
    s_waitcnt lgkmcnt(4)
    v_smfmac_f32_16x16x64_bf16 v[52:55], v[68:71], v[80:87], v4
    v_add_f32 v39, v39, v47
    v_cvt_pk_bf16_f32 v60, v32, v33
    v_cvt_pk_bf16_f32 v61, v34, v35
    s_waitcnt lgkmcnt(2)
    v_smfmac_f32_16x16x64_bf16 v[52:55], v[72:75], v[88:95], v4
    v_cvt_pk_bf16_f32 v62, v36, v37
    v_cvt_pk_bf16_f32 v63, v38, v39
    s_waitcnt lgkmcnt(0)
    v_smfmac_f32_16x16x64_bf16 v[52:55], v[76:79], v[96:103], v4
    v_permlane16_swap_b32 v60, v62
    v_permlane16_swap_b32 v61, v63
    v_min_u32 v60, -2, v60
    v_min_u32 v61, -2, v61
    v_min_u32 v62, -2, v62
    v_min_u32 v63, -2, v63
    buffer_store_dwordx4 v[60:63], v14, s[8:11], s49 offen sc1
    s_nop 0
    v_permlane32_swap_b32 v48, v52
    v_permlane32_swap_b32 v49, v53
    v_permlane32_swap_b32 v50, v54
    v_permlane32_swap_b32 v51, v55
    v_add_f32 v48, v48, v52
    v_add_f32 v49, v49, v53
    v_add_f32 v50, v50, v54
    v_add_f32 v51, v51, v55
    v_cvt_pk_bf16_f32 v64, v48, v49
    v_cvt_pk_bf16_f32 v65, v50, v51
    v_mov_b32 v66, v64
    v_mov_b32 v67, v65
    s_nop 0
    v_permlane16_swap_b32 v64, v66
    v_permlane16_swap_b32 v65, v67
    v_min_u32 v64, -2, v64
    v_min_u32 v65, -2, v65
    v_min_u32 v66, -2, v66
    v_min_u32 v67, -2, v67
    buffer_store_dwordx4 v[64:67], v15, s[8:11], s43 offen sc1
    s_add_u32 s40, s40, 1
    s_add_u32 s47, s37, 704512
    s_add_u32 s45, s37, 737280
    s_lshl_b32 s24, s40, 12
    s_and_b32 s24, s24, 0x2000
    s_xor_b32 s24, s24, s36
    s_lshl_b32 s37, s40, 20
    s_add_u32 s37, s37, s24
    s_add_u32 s37, s37, 117440512
    s_add_u32 s43, s37, 0
    s_cmp_lt_u32 s40, 64
    s_cbranch_scc1 interleave_layers__linear_attn_block__memory_aug_recurrent_mem_tr__prompt_kernel_v_stepw3
interleave_layers__linear_attn_block__memory_aug_recurrent_mem_tr__prompt_kernel_v_end:
    s_cmp_eq_u32 s92, 0
    s_cbranch_scc0 interleave_layers__linear_attn_block__memory_aug_recurrent_mem_tr__prompt_kernel_end
    s_mov_b32 s92, 1
    s_branch interleave_layers__linear_attn_block__memory_aug_recurrent_mem_tr__prompt_kernel_v_layer
interleave_layers__linear_attn_block__memory_aug_recurrent_mem_tr__prompt_kernel_roleR:
interleave_layers__linear_attn_block__memory_aug_recurrent_mem_tr__prompt_kernel_r_top:
    s_barrier
    s_sub_u32 s24, s2, 64
    s_cmp_ge_u32 s24, 24
    s_cbranch_scc1 interleave_layers__linear_attn_block__memory_aug_recurrent_mem_tr__prompt_kernel_rk26
    s_and_b32 s44, s24, 7
    s_lshr_b32 s45, s24, 3
    s_cmp_eq_u32 s92, 0
    s_cselect_b32 s46, 32, 2
    v_lshlrev_b32 v5, 4, v1
    s_mov_b32 s64, 12288
    s_cmp_eq_u32 s45, 1
    s_cselect_b32 s64, 5120, s64
    s_cmp_eq_u32 s45, 2
    s_cselect_b32 s64, 17408, s64
    s_mov_b32 s65, 1024
    s_cmp_eq_u32 s45, 1
    s_cselect_b32 s65, 7168, s65
    s_cmp_eq_u32 s45, 2
    s_cselect_b32 s65, 13312, s65
    s_mov_b32 s66, 0
    s_cmp_eq_u32 s45, 1
    s_cselect_b32 s66, 6144, s66
    s_cmp_eq_u32 s45, 2
    s_cselect_b32 s66, 14336, s66
    s_mov_b32 s67, 2048
    s_cmp_eq_u32 s45, 1
    s_cselect_b32 s67, 8192, s67
    s_cmp_eq_u32 s45, 2
    s_cselect_b32 s67, 15360, s67
    s_mov_b32 s68, 4096
    s_cmp_eq_u32 s45, 1
    s_cselect_b32 s68, 10240, s68
    s_cmp_eq_u32 s45, 2
    s_cselect_b32 s68, 16384, s68
    s_mov_b32 s69, 3072
    s_cmp_eq_u32 s45, 1
    s_cselect_b32 s69, 9216, s69
    s_cmp_eq_u32 s45, 2
    s_cselect_b32 s69, 16384, s69
    s_mov_b32 s70, 3072
    s_cmp_eq_u32 s45, 1
    s_cselect_b32 s70, 11264, s70
    s_cmp_eq_u32 s45, 2
    s_cselect_b32 s70, 16384, s70
    s_lshl_b32 s24, s92, 3
    s_add_u32 s24, s24, s44
    s_lshl_b32 s24, s24, 7
    s_add_u32 s24, s24, 23101440
    v_mov_b32 v15, s24
    s_cmp_eq_u32 s92, 0
    s_cselect_b32 s26, 31, 1
    s_mov_b64 exec, 1
    s_mov_b32 s61, 0
interleave_layers__linear_attn_block__memory_aug_recurrent_mem_tr__prompt_kernel_k2_w:
    v_mov_b32 v14, 0
    buffer_atomic_add v14, v15, s[8:11], 0 offen sc0 sc1
    s_waitcnt vmcnt(0)
    v_cmp_gt_i32 vcc, s26, v14
    s_cbranch_vccz interleave_layers__linear_attn_block__memory_aug_recurrent_mem_tr__prompt_kernel_k2_w_ok
    s_add_u32 s61, s61, 1
    s_cmp_ge_u32 s61, s60
    s_cbranch_scc1 interleave_layers__linear_attn_block__memory_aug_recurrent_mem_tr__prompt_kernel_k2_w_to
    s_sleep 2
    s_branch interleave_layers__linear_attn_block__memory_aug_recurrent_mem_tr__prompt_kernel_k2_w
interleave_layers__linear_attn_block__memory_aug_recurrent_mem_tr__prompt_kernel_k2_w_to:
    s_mov_b32 s60, 1
interleave_layers__linear_attn_block__memory_aug_recurrent_mem_tr__prompt_kernel_k2_w_ok:
    s_mov_b64 exec, -1
    s_add_u32 s25, s3, 0
    s_mul_i32 s24, s25, 147456
    s_mul_i32 s26, s44, 18432
    s_add_u32 s24, s24, s26
    s_add_u32 s24, s24, 16777216
    s_cmp_lt_u32 s25, s46
    s_cselect_b32 s24, s24, 2146435072
    s_add_u32 s26, s24, s64
    buffer_load_dwordx4 v[16:19], v5, s[8:11], s26 offen sc1
    s_add_u32 s26, s24, s65
    buffer_load_dwordx4 v[20:23], v5, s[8:11], s26 offen sc1
    s_add_u32 s26, s24, s66
    buffer_load_dwordx4 v[24:27], v5, s[8:11], s26 offen sc1
    s_add_u32 s26, s24, s67
    buffer_load_dwordx4 v[28:31], v5, s[8:11], s26 offen sc1
    s_add_u32 s26, s24, s68
    buffer_load_dwordx4 v[32:35], v5, s[8:11], s26 offen sc1
    s_add_u32 s26, s24, s69
    buffer_load_dwordx4 v[36:39], v5, s[8:11], s26 offen sc1
    s_add_u32 s26, s24, s70
    buffer_load_dwordx4 v[40:43], v5, s[8:11], s26 offen sc1
    s_add_u32 s25, s3, 4
    s_mul_i32 s24, s25, 147456
    s_mul_i32 s26, s44, 18432
    s_add_u32 s24, s24, s26
    s_add_u32 s24, s24, 16777216
    s_cmp_lt_u32 s25, s46
    s_cselect_b32 s24, s24, 2146435072
    s_add_u32 s26, s24, s64
    buffer_load_dwordx4 v[44:47], v5, s[8:11], s26 offen sc1
    s_add_u32 s26, s24, s65
    buffer_load_dwordx4 v[48:51], v5, s[8:11], s26 offen sc1
    s_add_u32 s26, s24, s66
    buffer_load_dwordx4 v[52:55], v5, s[8:11], s26 offen sc1
    s_add_u32 s26, s24, s67
    buffer_load_dwordx4 v[56:59], v5, s[8:11], s26 offen sc1
    s_add_u32 s26, s24, s68
    buffer_load_dwordx4 v[60:63], v5, s[8:11], s26 offen sc1
    s_add_u32 s26, s24, s69
    buffer_load_dwordx4 v[64:67], v5, s[8:11], s26 offen sc1
    s_add_u32 s26, s24, s70
    buffer_load_dwordx4 v[68:71], v5, s[8:11], s26 offen sc1
    s_add_u32 s25, s3, 8
    s_mul_i32 s24, s25, 147456
    s_mul_i32 s26, s44, 18432
    s_add_u32 s24, s24, s26
    s_add_u32 s24, s24, 16777216
    s_cmp_lt_u32 s25, s46
    s_cselect_b32 s24, s24, 2146435072
    s_add_u32 s26, s24, s64
    buffer_load_dwordx4 v[72:75], v5, s[8:11], s26 offen sc1
    s_add_u32 s26, s24, s65
    buffer_load_dwordx4 v[76:79], v5, s[8:11], s26 offen sc1
    s_add_u32 s26, s24, s66
    buffer_load_dwordx4 v[80:83], v5, s[8:11], s26 offen sc1
    s_add_u32 s26, s24, s67
    buffer_load_dwordx4 v[84:87], v5, s[8:11], s26 offen sc1
    s_add_u32 s26, s24, s68
    buffer_load_dwordx4 v[88:91], v5, s[8:11], s26 offen sc1
    s_add_u32 s26, s24, s69
    buffer_load_dwordx4 v[92:95], v5, s[8:11], s26 offen sc1
    s_add_u32 s26, s24, s70
    buffer_load_dwordx4 v[96:99], v5, s[8:11], s26 offen sc1
    s_add_u32 s25, s3, 12
    s_mul_i32 s24, s25, 147456
    s_mul_i32 s26, s44, 18432
    s_add_u32 s24, s24, s26
    s_add_u32 s24, s24, 16777216
    s_cmp_lt_u32 s25, s46
    s_cselect_b32 s24, s24, 2146435072
    s_add_u32 s26, s24, s64
    buffer_load_dwordx4 v[100:103], v5, s[8:11], s26 offen sc1
    s_add_u32 s26, s24, s65
    buffer_load_dwordx4 v[104:107], v5, s[8:11], s26 offen sc1
    s_add_u32 s26, s24, s66
    buffer_load_dwordx4 v[108:111], v5, s[8:11], s26 offen sc1
    s_add_u32 s26, s24, s67
    buffer_load_dwordx4 v[112:115], v5, s[8:11], s26 offen sc1
    s_add_u32 s26, s24, s68
    buffer_load_dwordx4 v[116:119], v5, s[8:11], s26 offen sc1
    s_add_u32 s26, s24, s69
    buffer_load_dwordx4 v[120:123], v5, s[8:11], s26 offen sc1
    s_add_u32 s26, s24, s70
    buffer_load_dwordx4 v[124:127], v5, s[8:11], s26 offen sc1
    s_add_u32 s25, s3, 16
    s_mul_i32 s24, s25, 147456
    s_mul_i32 s26, s44, 18432
    s_add_u32 s24, s24, s26
    s_add_u32 s24, s24, 16777216
    s_cmp_lt_u32 s25, s46
    s_cselect_b32 s24, s24, 2146435072
    s_add_u32 s26, s24, s64
    buffer_load_dwordx4 v[128:131], v5, s[8:11], s26 offen sc1
    s_add_u32 s26, s24, s65
    buffer_load_dwordx4 v[132:135], v5, s[8:11], s26 offen sc1
    s_add_u32 s26, s24, s66
    buffer_load_dwordx4 v[136:139], v5, s[8:11], s26 offen sc1
    s_add_u32 s26, s24, s67
    buffer_load_dwordx4 v[140:143], v5, s[8:11], s26 offen sc1
    s_add_u32 s26, s24, s68
    buffer_load_dwordx4 v[144:147], v5, s[8:11], s26 offen sc1
    s_add_u32 s26, s24, s69
    buffer_load_dwordx4 v[148:151], v5, s[8:11], s26 offen sc1
    s_add_u32 s26, s24, s70
    buffer_load_dwordx4 v[152:155], v5, s[8:11], s26 offen sc1
    s_add_u32 s25, s3, 20
    s_mul_i32 s24, s25, 147456
    s_mul_i32 s26, s44, 18432
    s_add_u32 s24, s24, s26
    s_add_u32 s24, s24, 16777216
    s_cmp_lt_u32 s25, s46
    s_cselect_b32 s24, s24, 2146435072
    s_add_u32 s26, s24, s64
    buffer_load_dwordx4 v[156:159], v5, s[8:11], s26 offen sc1
    s_add_u32 s26, s24, s65
    buffer_load_dwordx4 v[160:163], v5, s[8:11], s26 offen sc1
    s_add_u32 s26, s24, s66
    buffer_load_dwordx4 v[164:167], v5, s[8:11], s26 offen sc1
    s_add_u32 s26, s24, s67
    buffer_load_dwordx4 v[168:171], v5, s[8:11], s26 offen sc1
    s_add_u32 s26, s24, s68
    buffer_load_dwordx4 v[172:175], v5, s[8:11], s26 offen sc1
    s_add_u32 s26, s24, s69
    buffer_load_dwordx4 v[176:179], v5, s[8:11], s26 offen sc1
    s_add_u32 s26, s24, s70
    buffer_load_dwordx4 v[180:183], v5, s[8:11], s26 offen sc1
    s_add_u32 s25, s3, 24
    s_mul_i32 s24, s25, 147456
    s_mul_i32 s26, s44, 18432
    s_add_u32 s24, s24, s26
    s_add_u32 s24, s24, 16777216
    s_cmp_lt_u32 s25, s46
    s_cselect_b32 s24, s24, 2146435072
    s_add_u32 s26, s24, s64
    buffer_load_dwordx4 v[184:187], v5, s[8:11], s26 offen sc1
    s_add_u32 s26, s24, s65
    buffer_load_dwordx4 v[188:191], v5, s[8:11], s26 offen sc1
    s_add_u32 s26, s24, s66
    buffer_load_dwordx4 v[192:195], v5, s[8:11], s26 offen sc1
    s_add_u32 s26, s24, s67
    buffer_load_dwordx4 v[196:199], v5, s[8:11], s26 offen sc1
    s_add_u32 s26, s24, s68
    buffer_load_dwordx4 v[200:203], v5, s[8:11], s26 offen sc1
    s_add_u32 s26, s24, s69
    buffer_load_dwordx4 v[204:207], v5, s[8:11], s26 offen sc1
    s_add_u32 s26, s24, s70
    buffer_load_dwordx4 v[208:211], v5, s[8:11], s26 offen sc1
    s_add_u32 s25, s3, 28
    s_mul_i32 s24, s25, 147456
    s_mul_i32 s26, s44, 18432
    s_add_u32 s24, s24, s26
    s_add_u32 s24, s24, 16777216
    s_cmp_lt_u32 s25, s46
    s_cselect_b32 s24, s24, 2146435072
    s_add_u32 s26, s24, s64
    buffer_load_dwordx4 v[212:215], v5, s[8:11], s26 offen sc1
    s_add_u32 s26, s24, s65
    buffer_load_dwordx4 v[216:219], v5, s[8:11], s26 offen sc1
    s_add_u32 s26, s24, s66
    buffer_load_dwordx4 v[220:223], v5, s[8:11], s26 offen sc1
    s_add_u32 s26, s24, s67
    buffer_load_dwordx4 v[224:227], v5, s[8:11], s26 offen sc1
    s_add_u32 s26, s24, s68
    buffer_load_dwordx4 v[228:231], v5, s[8:11], s26 offen sc1
    s_add_u32 s26, s24, s69
    buffer_load_dwordx4 v[232:235], v5, s[8:11], s26 offen sc1
    s_add_u32 s26, s24, s70
    buffer_load_dwordx4 v[236:239], v5, s[8:11], s26 offen sc1
    s_waitcnt vmcnt(42)
    v_pk_add_f32 v[16:17], v[16:17], v[44:45]
    v_pk_add_f32 v[18:19], v[18:19], v[46:47]
    v_pk_add_f32 v[20:21], v[20:21], v[48:49]
    v_pk_add_f32 v[22:23], v[22:23], v[50:51]
    v_pk_add_f32 v[24:25], v[24:25], v[52:53]
    v_pk_add_f32 v[26:27], v[26:27], v[54:55]
    v_pk_add_f32 v[28:29], v[28:29], v[56:57]
    v_pk_add_f32 v[30:31], v[30:31], v[58:59]
    v_pk_add_f32 v[32:33], v[32:33], v[60:61]
    v_pk_add_f32 v[34:35], v[34:35], v[62:63]
    v_pk_add_f32 v[36:37], v[36:37], v[64:65]
    v_pk_add_f32 v[38:39], v[38:39], v[66:67]
    v_pk_add_f32 v[40:41], v[40:41], v[68:69]
    v_pk_add_f32 v[42:43], v[42:43], v[70:71]
    s_waitcnt vmcnt(35)
    v_pk_add_f32 v[16:17], v[16:17], v[72:73]
    v_pk_add_f32 v[18:19], v[18:19], v[74:75]
    v_pk_add_f32 v[20:21], v[20:21], v[76:77]
    v_pk_add_f32 v[22:23], v[22:23], v[78:79]
    v_pk_add_f32 v[24:25], v[24:25], v[80:81]
    v_pk_add_f32 v[26:27], v[26:27], v[82:83]
    v_pk_add_f32 v[28:29], v[28:29], v[84:85]
    v_pk_add_f32 v[30:31], v[30:31], v[86:87]
    v_pk_add_f32 v[32:33], v[32:33], v[88:89]
    v_pk_add_f32 v[34:35], v[34:35], v[90:91]
    v_pk_add_f32 v[36:37], v[36:37], v[92:93]
    v_pk_add_f32 v[38:39], v[38:39], v[94:95]
    v_pk_add_f32 v[40:41], v[40:41], v[96:97]
    v_pk_add_f32 v[42:43], v[42:43], v[98:99]
    s_waitcnt vmcnt(28)
    v_pk_add_f32 v[16:17], v[16:17], v[100:101]
    v_pk_add_f32 v[18:19], v[18:19], v[102:103]
    v_pk_add_f32 v[20:21], v[20:21], v[104:105]
    v_pk_add_f32 v[22:23], v[22:23], v[106:107]
    v_pk_add_f32 v[24:25], v[24:25], v[108:109]
    v_pk_add_f32 v[26:27], v[26:27], v[110:111]
    v_pk_add_f32 v[28:29], v[28:29], v[112:113]
    v_pk_add_f32 v[30:31], v[30:31], v[114:115]
    v_pk_add_f32 v[32:33], v[32:33], v[116:117]
    v_pk_add_f32 v[34:35], v[34:35], v[118:119]
    v_pk_add_f32 v[36:37], v[36:37], v[120:121]
    v_pk_add_f32 v[38:39], v[38:39], v[122:123]
    v_pk_add_f32 v[40:41], v[40:41], v[124:125]
    v_pk_add_f32 v[42:43], v[42:43], v[126:127]
    s_waitcnt vmcnt(21)
    v_pk_add_f32 v[16:17], v[16:17], v[128:129]
    v_pk_add_f32 v[18:19], v[18:19], v[130:131]
    v_pk_add_f32 v[20:21], v[20:21], v[132:133]
    v_pk_add_f32 v[22:23], v[22:23], v[134:135]
    v_pk_add_f32 v[24:25], v[24:25], v[136:137]
    v_pk_add_f32 v[26:27], v[26:27], v[138:139]
    v_pk_add_f32 v[28:29], v[28:29], v[140:141]
    v_pk_add_f32 v[30:31], v[30:31], v[142:143]
    v_pk_add_f32 v[32:33], v[32:33], v[144:145]
    v_pk_add_f32 v[34:35], v[34:35], v[146:147]
    v_pk_add_f32 v[36:37], v[36:37], v[148:149]
    v_pk_add_f32 v[38:39], v[38:39], v[150:151]
    v_pk_add_f32 v[40:41], v[40:41], v[152:153]
    v_pk_add_f32 v[42:43], v[42:43], v[154:155]
    s_waitcnt vmcnt(14)
    v_pk_add_f32 v[16:17], v[16:17], v[156:157]
    v_pk_add_f32 v[18:19], v[18:19], v[158:159]
    v_pk_add_f32 v[20:21], v[20:21], v[160:161]
    v_pk_add_f32 v[22:23], v[22:23], v[162:163]
    v_pk_add_f32 v[24:25], v[24:25], v[164:165]
    v_pk_add_f32 v[26:27], v[26:27], v[166:167]
    v_pk_add_f32 v[28:29], v[28:29], v[168:169]
    v_pk_add_f32 v[30:31], v[30:31], v[170:171]
    v_pk_add_f32 v[32:33], v[32:33], v[172:173]
    v_pk_add_f32 v[34:35], v[34:35], v[174:175]
    v_pk_add_f32 v[36:37], v[36:37], v[176:177]
    v_pk_add_f32 v[38:39], v[38:39], v[178:179]
    v_pk_add_f32 v[40:41], v[40:41], v[180:181]
    v_pk_add_f32 v[42:43], v[42:43], v[182:183]
    s_waitcnt vmcnt(7)
    v_pk_add_f32 v[16:17], v[16:17], v[184:185]
    v_pk_add_f32 v[18:19], v[18:19], v[186:187]
    v_pk_add_f32 v[20:21], v[20:21], v[188:189]
    v_pk_add_f32 v[22:23], v[22:23], v[190:191]
    v_pk_add_f32 v[24:25], v[24:25], v[192:193]
    v_pk_add_f32 v[26:27], v[26:27], v[194:195]
    v_pk_add_f32 v[28:29], v[28:29], v[196:197]
    v_pk_add_f32 v[30:31], v[30:31], v[198:199]
    v_pk_add_f32 v[32:33], v[32:33], v[200:201]
    v_pk_add_f32 v[34:35], v[34:35], v[202:203]
    v_pk_add_f32 v[36:37], v[36:37], v[204:205]
    v_pk_add_f32 v[38:39], v[38:39], v[206:207]
    v_pk_add_f32 v[40:41], v[40:41], v[208:209]
    v_pk_add_f32 v[42:43], v[42:43], v[210:211]
    s_waitcnt vmcnt(0)
    v_pk_add_f32 v[16:17], v[16:17], v[212:213]
    v_pk_add_f32 v[18:19], v[18:19], v[214:215]
    v_pk_add_f32 v[20:21], v[20:21], v[216:217]
    v_pk_add_f32 v[22:23], v[22:23], v[218:219]
    v_pk_add_f32 v[24:25], v[24:25], v[220:221]
    v_pk_add_f32 v[26:27], v[26:27], v[222:223]
    v_pk_add_f32 v[28:29], v[28:29], v[224:225]
    v_pk_add_f32 v[30:31], v[30:31], v[226:227]
    v_pk_add_f32 v[32:33], v[32:33], v[228:229]
    v_pk_add_f32 v[34:35], v[34:35], v[230:231]
    v_pk_add_f32 v[36:37], v[36:37], v[232:233]
    v_pk_add_f32 v[38:39], v[38:39], v[234:235]
    v_pk_add_f32 v[40:41], v[40:41], v[236:237]
    v_pk_add_f32 v[42:43], v[42:43], v[238:239]
    s_mul_i32 s24, s3, 7168
    v_add_u32 v6, s24, v5
    ds_write_b128 v6, v[16:19] offset:0
    ds_write_b128 v6, v[20:23] offset:1024
    ds_write_b128 v6, v[24:27] offset:2048
    ds_write_b128 v6, v[28:31] offset:3072
    ds_write_b128 v6, v[32:35] offset:4096
    ds_write_b128 v6, v[36:39] offset:5120
    ds_write_b128 v6, v[40:43] offset:6144
    s_waitcnt lgkmcnt(0)
    s_barrier
    s_mov_b32 s41, 0
    s_cmp_eq_u32 s45, 1
    s_cselect_b32 s41, 4, s41
    s_cmp_eq_u32 s45, 2
    s_cselect_b32 s41, 9, s41
    s_mov_b32 s42, 4
    s_cmp_eq_u32 s45, 1
    s_cselect_b32 s42, 5, s42
    s_cmp_eq_u32 s45, 2
    s_cselect_b32 s42, 5, s42
    s_mul_i32 s43, s92, 131072
    s_mul_i32 s24, s44, 14336
    s_add_u32 s43, s43, s24
    s_add_u32 s43, s43, 22020096
    v_and_b32 v7, 3, v2
    v_lshrrev_b32 v8, 2, v2
    s_add_u32 s40, s3, 0
    s_cmp_lt_u32 s40, s42
    s_cbranch_scc0 interleave_layers__linear_attn_block__memory_aug_recurrent_mem_tr__prompt_kernel_k2f27
    s_add_u32 s40, s40, s41
    s_mov_b32 s47, 67633672
    s_cmp_eq_u32 s40, 1
    s_cselect_b32 s47, 67699226, s47
    s_cmp_eq_u32 s40, 2
    s_cselect_b32 s47, 67702404, s47
    s_cmp_eq_u32 s40, 3
    s_cselect_b32 s47, 67765224, s47
    s_cmp_eq_u32 s40, 4
    s_cselect_b32 s47, 67765896, s47
    s_cmp_eq_u32 s40, 5
    s_cselect_b32 s47, 67831450, s47
    s_cmp_eq_u32 s40, 6
    s_cselect_b32 s47, 67833604, s47
    s_cmp_eq_u32 s40, 7
    s_cselect_b32 s47, 67897320, s47
    s_cmp_eq_u32 s40, 8
    s_cselect_b32 s47, 67899142, s47
    s_cmp_eq_u32 s40, 9
    s_cselect_b32 s47, 75497992, s47
    s_cmp_eq_u32 s40, 10
    s_cselect_b32 s47, 75499162, s47
    s_cmp_eq_u32 s40, 11
    s_cselect_b32 s47, 75501316, s47
    s_cmp_eq_u32 s40, 12
    s_cselect_b32 s47, 247768, s47
    s_cmp_eq_u32 s40, 13
    s_cselect_b32 s47, 249604, s47
    s_bfe_u32 s24, s47, 0x7000c
    s_bfe_u32 s25, s47, 0x50013
    s_bfe_u32 s26, s47, 0x30018
    v_mul_u32_u24 v9, s25, v7
    v_mul_u32_u24 v10, s26, v8
    v_add3_u32 v9, v9, v10, s24
    v_mul_u32_u24 v9, 205, v9
    v_lshrrev_b32 v9, 12, v9
    s_bfe_u32 s24, s47, 196608
    s_lshl_b32 s24, s24, 10
    v_add_u32 v10, s24, v5
    ds_read_b128 v[160:163], v10 offset:0
    ds_read_b128 v[164:167], v10 offset:7168
    ds_read_b128 v[168:171], v10 offset:14336
    ds_read_b128 v[172:175], v10 offset:21504
    s_bfe_u32 s25, s47, 196614
    s_lshl_b32 s25, s25, 4
    v_lshl_add_u32 v11, v3, 2, s25
    v_mul_u32_u24 v11, 205, v11
    v_lshrrev_b32 v11, 12, v11
    v_cmp_eq_u32 vcc, v9, v11
    s_waitcnt lgkmcnt(0)
    v_pk_add_f32 v[160:161], v[160:161], v[164:165]
    v_pk_add_f32 v[168:169], v[168:169], v[172:173]
    v_pk_add_f32 v[162:163], v[162:163], v[166:167]
    v_pk_add_f32 v[170:171], v[170:171], v[174:175]
    v_pk_add_f32 v[160:161], v[160:161], v[168:169]
    v_pk_add_f32 v[162:163], v[162:163], v[170:171]
    v_cvt_pk_bf16_f32 v176, v160, v161
    v_cvt_pk_bf16_f32 v177, v162, v163
    v_cndmask_b32 v176, 0, v176, vcc
    v_cndmask_b32 v177, 0, v177, vcc
    s_bfe_u32 s24, s47, 196611
    s_lshl_b32 s24, s24, 10
    v_add_u32 v10, s24, v5
    ds_read_b128 v[160:163], v10 offset:0
    ds_read_b128 v[164:167], v10 offset:7168
    ds_read_b128 v[168:171], v10 offset:14336
    ds_read_b128 v[172:175], v10 offset:21504
    s_bfe_u32 s25, s47, 196617
    s_lshl_b32 s25, s25, 4
    v_lshl_add_u32 v11, v3, 2, s25
    v_mul_u32_u24 v11, 205, v11
    v_lshrrev_b32 v11, 12, v11
    v_cmp_eq_u32 vcc, v9, v11
    s_waitcnt lgkmcnt(0)
    v_pk_add_f32 v[160:161], v[160:161], v[164:165]
    v_pk_add_f32 v[168:169], v[168:169], v[172:173]
    v_pk_add_f32 v[162:163], v[162:163], v[166:167]
    v_pk_add_f32 v[170:171], v[170:171], v[174:175]
    v_pk_add_f32 v[160:161], v[160:161], v[168:169]
    v_pk_add_f32 v[162:163], v[162:163], v[170:171]
    v_cvt_pk_bf16_f32 v178, v160, v161
    v_cvt_pk_bf16_f32 v179, v162, v163
    v_cndmask_b32 v178, 0, v178, vcc
    v_cndmask_b32 v179, 0, v179, vcc
    s_lshl_b32 s24, s40, 10
    s_add_u32 s24, s24, s43
    buffer_store_dwordx4 v[176:179], v5, s[8:11], s24 offen sc1
interleave_layers__linear_attn_block__memory_aug_recurrent_mem_tr__prompt_kernel_k2f27:
    s_add_u32 s40, s3, 4
    s_cmp_lt_u32 s40, s42
    s_cbranch_scc0 interleave_layers__linear_attn_block__memory_aug_recurrent_mem_tr__prompt_kernel_k2f28
    s_add_u32 s40, s40, s41
    s_mov_b32 s47, 67633672
    s_cmp_eq_u32 s40, 1
    s_cselect_b32 s47, 67699226, s47
    s_cmp_eq_u32 s40, 2
    s_cselect_b32 s47, 67702404, s47
    s_cmp_eq_u32 s40, 3
    s_cselect_b32 s47, 67765224, s47
    s_cmp_eq_u32 s40, 4
    s_cselect_b32 s47, 67765896, s47
    s_cmp_eq_u32 s40, 5
    s_cselect_b32 s47, 67831450, s47
    s_cmp_eq_u32 s40, 6
    s_cselect_b32 s47, 67833604, s47
    s_cmp_eq_u32 s40, 7
    s_cselect_b32 s47, 67897320, s47
    s_cmp_eq_u32 s40, 8
    s_cselect_b32 s47, 67899142, s47
    s_cmp_eq_u32 s40, 9
    s_cselect_b32 s47, 75497992, s47
    s_cmp_eq_u32 s40, 10
    s_cselect_b32 s47, 75499162, s47
    s_cmp_eq_u32 s40, 11
    s_cselect_b32 s47, 75501316, s47
    s_cmp_eq_u32 s40, 12
    s_cselect_b32 s47, 247768, s47
    s_cmp_eq_u32 s40, 13
    s_cselect_b32 s47, 249604, s47
    s_bfe_u32 s24, s47, 0x7000c
    s_bfe_u32 s25, s47, 0x50013
    s_bfe_u32 s26, s47, 0x30018
    v_mul_u32_u24 v9, s25, v7
    v_mul_u32_u24 v10, s26, v8
    v_add3_u32 v9, v9, v10, s24
    v_mul_u32_u24 v9, 205, v9
    v_lshrrev_b32 v9, 12, v9
    s_bfe_u32 s24, s47, 196608
    s_lshl_b32 s24, s24, 10
    v_add_u32 v10, s24, v5
    ds_read_b128 v[160:163], v10 offset:0
    ds_read_b128 v[164:167], v10 offset:7168
    ds_read_b128 v[168:171], v10 offset:14336
    ds_read_b128 v[172:175], v10 offset:21504
    s_bfe_u32 s25, s47, 196614
    s_lshl_b32 s25, s25, 4
    v_lshl_add_u32 v11, v3, 2, s25
    v_mul_u32_u24 v11, 205, v11
    v_lshrrev_b32 v11, 12, v11
    v_cmp_eq_u32 vcc, v9, v11
    s_waitcnt lgkmcnt(0)
    v_pk_add_f32 v[160:161], v[160:161], v[164:165]
    v_pk_add_f32 v[168:169], v[168:169], v[172:173]
    v_pk_add_f32 v[162:163], v[162:163], v[166:167]
    v_pk_add_f32 v[170:171], v[170:171], v[174:175]
    v_pk_add_f32 v[160:161], v[160:161], v[168:169]
    v_pk_add_f32 v[162:163], v[162:163], v[170:171]
    v_cvt_pk_bf16_f32 v176, v160, v161
    v_cvt_pk_bf16_f32 v177, v162, v163
    v_cndmask_b32 v176, 0, v176, vcc
    v_cndmask_b32 v177, 0, v177, vcc
    s_bfe_u32 s24, s47, 196611
    s_lshl_b32 s24, s24, 10
    v_add_u32 v10, s24, v5
    ds_read_b128 v[160:163], v10 offset:0
    ds_read_b128 v[164:167], v10 offset:7168
    ds_read_b128 v[168:171], v10 offset:14336
    ds_read_b128 v[172:175], v10 offset:21504
    s_bfe_u32 s25, s47, 196617
    s_lshl_b32 s25, s25, 4
    v_lshl_add_u32 v11, v3, 2, s25
    v_mul_u32_u24 v11, 205, v11
    v_lshrrev_b32 v11, 12, v11
    v_cmp_eq_u32 vcc, v9, v11
    s_waitcnt lgkmcnt(0)
    v_pk_add_f32 v[160:161], v[160:161], v[164:165]
    v_pk_add_f32 v[168:169], v[168:169], v[172:173]
    v_pk_add_f32 v[162:163], v[162:163], v[166:167]
    v_pk_add_f32 v[170:171], v[170:171], v[174:175]
    v_pk_add_f32 v[160:161], v[160:161], v[168:169]
    v_pk_add_f32 v[162:163], v[162:163], v[170:171]
    v_cvt_pk_bf16_f32 v178, v160, v161
    v_cvt_pk_bf16_f32 v179, v162, v163
    v_cndmask_b32 v178, 0, v178, vcc
    v_cndmask_b32 v179, 0, v179, vcc
    s_lshl_b32 s24, s40, 10
    s_add_u32 s24, s24, s43
    buffer_store_dwordx4 v[176:179], v5, s[8:11], s24 offen sc1
interleave_layers__linear_attn_block__memory_aug_recurrent_mem_tr__prompt_kernel_k2f28:
    s_waitcnt vmcnt(0)
    s_barrier
    s_lshl_b32 s24, s92, 7
    s_sub_u32 s25, s2, 64
    s_lshl_b32 s25, s25, 2
    s_add_u32 s24, s24, s25
    s_add_u32 s24, s24, 23103488
    s_cmp_eq_u32 s3, 0
    s_cbranch_scc0 interleave_layers__linear_attn_block__memory_aug_recurrent_mem_tr__prompt_kernel_pb29
    v_lshlrev_b32 v14, 7, v1
    v_add_u32 v14, s24, v14
    v_mov_b32 v15, 2146435072
    v_cmp_le_u32 vcc, 1, v1
    s_nop 1
    v_cndmask_b32 v14, v14, v15, vcc
    v_mov_b32 v15, 1
    buffer_store_dword v15, v14, s[8:11], 0 offen sc1
interleave_layers__linear_attn_block__memory_aug_recurrent_mem_tr__prompt_kernel_pb29:
interleave_layers__linear_attn_block__memory_aug_recurrent_mem_tr__prompt_kernel_rk26:
    s_sub_u32 s44, s2, 64
    v_lshlrev_b32 v5, 4, v1
    s_lshl_b32 s24, s44, 15
    s_lshl_b32 s25, s3, 13
    s_add_u32 s24, s24, s25
    v_add_u32 v6, s24, v5
    v_add_u32 v7, 4096, v6
    s_lshl_b32 s24, s3, 12
    s_and_b32 s25, s24, 0x2000
    s_add_u32 s24, s24, s25
    v_add_u32 v8, s24, v5
    s_lshl_b32 s24, s3, 10
    s_add_u32 s24, s24, 32768
    v_add_u32 v9, s24, v5
    s_lshl_b32 s24, s44, 14
    s_lshl_b32 s25, s3, 11
    s_add_u32 s24, s24, s25
    v_add_u32 v10, s24, v5
    v_and_b32 v204, 7, v2
    v_mul_u32_u24 v11, 80, v204
    v_lshl_add_u32 v11, v3, 4, v11
    s_mul_i32 s24, s3, 640
    v_add_u32 v11, s24, v11
    v_add_u32 v204, 8192, v5
    v_cmp_gt_u32 vcc, 8, v2
    s_nop 1
    v_cndmask_b32 v11, v204, v11, vcc
    v_and_b32 v204, 7, v2
    v_mul_u32_u24 v12, 80, v204
    v_lshrrev_b32 v204, 3, v2
    v_lshl_add_u32 v12, v204, 5, v12
    v_lshlrev_b32 v13, 4, v2
    s_lshl_b32 s24, s44, 8
    s_and_b32 s25, s24, 0x2000
    s_add_u32 s24, s24, s25
    v_add_u32 v13, s24, v13
    v_mov_b32 v204, 2146435072
    v_cmp_gt_u32 vcc, 1, v3
    s_nop 1
    v_cndmask_b32 v13, v204, v13, vcc
    v_cmp_le_u32 s[50:51], 8, v2
    s_and_b32 s25, s44, 15
    s_lshr_b32 s25, s25, 2
    s_sub_u32 s26, s44, 32
    s_lshr_b32 s26, s26, 1
    s_cmp_ge_u32 s44, 32
    s_cselect_b32 s25, s26, s25
    s_mul_i32 s24, s25, 16
    v_add_u32 v120, s24, v1
    v_lshlrev_b32 v120, 7, v120
    v_mov_b32 v204, 2146435072
    v_cmp_le_u32 vcc, 16, v1
    s_nop 1
    v_cndmask_b32 v120, v120, v204, vcc
    s_and_b32 s24, s44, 7
    s_mul_i32 s25, s3, 8
    s_add_u32 s24, s24, s25
    s_lshl_b32 s24, s24, 7
    v_mov_b32 v125, s24
    v_mov_b32 v122, 12288
    v_mov_b32 v123, 0
    s_barrier
    ds_write_b32 v122, v123
    v_mov_b32 v123, 1
    s_waitcnt lgkmcnt(0)
    s_barrier
    s_mov_b32 s93, 0
    s_lshl_b32 s24, s93, 12
    s_and_b32 s24, s24, 0x2000
    s_xor_b32 s24, s24, s36
    s_lshl_b32 s93, s93, 20
    s_add_u32 s93, s93, s24
    s_add_u32 s93, s93, 117440512
    s_mul_i32 s94, s92, 16384
    s_add_u32 s94, s94, 23068672
    s_mov_b32 s40, 0
    s_mov_b32 s41, 184549376
    s_add_u32 s45, s93, 753664
    s_add_u32 s46, s93, 737280
    s_add_u32 s43, s93, 655360
    s_add_u32 s42, s93, 0
    s_add_u32 s47, s93, 704512
    v_and_b32 v252, 7, v1
    v_lshlrev_b32 v252, 7, v252
    s_lshl_b32 s24, s3, 10
    s_add_u32 s24, s24, 12288
    s_add_u32 s24, s24, s94
    v_add_u32 v252, s24, v252
    s_mov_b32 s62, -1
    s_mov_b32 s63, 1
    s_cmp_ge_i32 s62, s63
    s_cbranch_scc1 interleave_layers__linear_attn_block__memory_aug_recurrent_mem_tr__prompt_kernel_r_en0_ok
    s_mov_b32 s61, 0
interleave_layers__linear_attn_block__memory_aug_recurrent_mem_tr__prompt_kernel_r_en0:
    buffer_load_dword v253, v252, s[8:11], 0 offen sc1
    s_waitcnt vmcnt(0)
    v_readlane_b32 s62, v253, 0
    v_readlane_b32 s24, v253, 1
    s_min_i32 s62, s62, s24
    v_readlane_b32 s24, v253, 2
    s_min_i32 s62, s62, s24
    v_readlane_b32 s24, v253, 3
    s_min_i32 s62, s62, s24
    v_readlane_b32 s24, v253, 4
    s_min_i32 s62, s62, s24
    v_readlane_b32 s24, v253, 5
    s_min_i32 s62, s62, s24
    v_readlane_b32 s24, v253, 6
    s_min_i32 s62, s62, s24
    v_readlane_b32 s24, v253, 7
    s_min_i32 s62, s62, s24
    s_cmp_ge_i32 s62, s63
    s_cbranch_scc1 interleave_layers__linear_attn_block__memory_aug_recurrent_mem_tr__prompt_kernel_r_en0_ok
    s_add_u32 s61, s61, 1
    s_cmp_ge_u32 s61, s60
    s_cbranch_scc1 interleave_layers__linear_attn_block__memory_aug_recurrent_mem_tr__prompt_kernel_r_en0_to
    s_sleep 2
    s_branch interleave_layers__linear_attn_block__memory_aug_recurrent_mem_tr__prompt_kernel_r_en0
interleave_layers__linear_attn_block__memory_aug_recurrent_mem_tr__prompt_kernel_r_en0_to:
    s_mov_b32 s60, 1
interleave_layers__linear_attn_block__memory_aug_recurrent_mem_tr__prompt_kernel_r_en0_ok:
    buffer_load_dwordx4 v[48:51], v6, s[8:11], s41 offen offset:0 sc1
    buffer_load_dwordx4 v[52:55], v6, s[8:11], s41 offen offset:1024 sc1
    buffer_load_dwordx4 v[56:59], v6, s[8:11], s41 offen offset:2048 sc1
    buffer_load_dwordx4 v[60:63], v6, s[8:11], s41 offen offset:3072 sc1
    buffer_load_dwordx4 v[64:67], v7, s[8:11], s41 offen offset:0 sc1
    buffer_load_dwordx4 v[68:71], v7, s[8:11], s41 offen offset:1024 sc1
    buffer_load_dwordx4 v[72:75], v7, s[8:11], s41 offen offset:2048 sc1
    buffer_load_dwordx4 v[76:79], v7, s[8:11], s41 offen offset:3072 sc1
    s_add_u32 s41, s41, 1310720
    s_mov_b32 s58, 0
interleave_layers__linear_attn_block__memory_aug_recurrent_mem_tr__prompt_kernel_r_step:
    s_waitcnt vmcnt(0)
    v_mov_b32 v16, v48
    v_mov_b32 v17, v49
    v_mov_b32 v18, v50
    v_mov_b32 v19, v51
    v_mov_b32 v20, v52
    v_mov_b32 v21, v53
    v_mov_b32 v22, v54
    v_mov_b32 v23, v55
    v_mov_b32 v24, v56
    v_mov_b32 v25, v57
    v_mov_b32 v26, v58
    v_mov_b32 v27, v59
    v_mov_b32 v28, v60
    v_mov_b32 v29, v61
    v_mov_b32 v30, v62
    v_mov_b32 v31, v63
    v_mov_b32 v32, v64
    v_mov_b32 v33, v65
    v_mov_b32 v34, v66
    v_mov_b32 v35, v67
    v_mov_b32 v36, v68
    v_mov_b32 v37, v69
    v_mov_b32 v38, v70
    v_mov_b32 v39, v71
    v_mov_b32 v40, v72
    v_mov_b32 v41, v73
    v_mov_b32 v42, v74
    v_mov_b32 v43, v75
    v_mov_b32 v44, v76
    v_mov_b32 v45, v77
    v_mov_b32 v46, v78
    v_mov_b32 v47, v79
    s_lshl_b32 s95, s92, 6
    s_add_u32 s95, s95, s40
    s_add_u32 s95, s95, 1
    s_cmp_ge_i32 s59, s95
    s_cbranch_scc1 interleave_layers__linear_attn_block__memory_aug_recurrent_mem_tr__prompt_kernel_r_ec_ok
    s_and_b32 s24, s2, 7
    s_lshl_b32 s24, s24, 7
    s_add_u32 s24, s24, 23109632
    v_and_b32 v254, 3, v1
    v_lshl_add_u32 v254, v254, 2, s24
    s_mov_b32 s61, 0
interleave_layers__linear_attn_block__memory_aug_recurrent_mem_tr__prompt_kernel_r_ec:
    buffer_load_dword v253, v254, s[8:11], 0 offen sc1
    s_waitcnt vmcnt(0)
    v_readlane_b32 s59, v253, 0
    v_readlane_b32 s24, v253, 1
    s_min_i32 s59, s59, s24
    v_readlane_b32 s24, v253, 2
    s_min_i32 s59, s59, s24
    s_cmp_ge_i32 s59, s95
    s_cbranch_scc1 interleave_layers__linear_attn_block__memory_aug_recurrent_mem_tr__prompt_kernel_r_ec_ok
    s_add_u32 s61, s61, 1
    s_cmp_ge_u32 s61, s60
    s_cbranch_scc1 interleave_layers__linear_attn_block__memory_aug_recurrent_mem_tr__prompt_kernel_r_ec_to
    s_sleep 2
    s_branch interleave_layers__linear_attn_block__memory_aug_recurrent_mem_tr__prompt_kernel_r_ec
interleave_layers__linear_attn_block__memory_aug_recurrent_mem_tr__prompt_kernel_r_ec_to:
    s_mov_b32 s60, 1
interleave_layers__linear_attn_block__memory_aug_recurrent_mem_tr__prompt_kernel_r_ec_ok:
    s_mov_b64 exec, 1
    s_mov_b32 s61, 0
    v_mov_b32 v117, 0
    buffer_atomic_add v117, v125, s[8:11], s45 offen sc0
    s_sleep 1
    v_mov_b32 v118, 0
    buffer_atomic_add v118, v125, s[8:11], s45 offen sc0
    s_sleep 1
    v_mov_b32 v119, 0
    buffer_atomic_add v119, v125, s[8:11], s45 offen sc0
    s_sleep 1
interleave_layers__linear_attn_block__memory_aug_recurrent_mem_tr__prompt_kernel_r_pr:
    v_mov_b32 v116, 0
    buffer_atomic_add v116, v125, s[8:11], s45 offen sc0
    s_waitcnt vmcnt(3)
    v_cmp_le_i32 vcc, 7, v117
    s_add_u32 s61, s61, 1
    s_cbranch_vccnz interleave_layers__linear_attn_block__memory_aug_recurrent_mem_tr__prompt_kernel_r_pr_out
    s_sleep 1
    v_mov_b32 v117, 0
    buffer_atomic_add v117, v125, s[8:11], s45 offen sc0
    s_waitcnt vmcnt(3)
    v_cmp_le_i32 vcc, 7, v118
    s_add_u32 s61, s61, 1
    s_cbranch_vccnz interleave_layers__linear_attn_block__memory_aug_recurrent_mem_tr__prompt_kernel_r_pr_out
    s_sleep 1
    v_mov_b32 v118, 0
    buffer_atomic_add v118, v125, s[8:11], s45 offen sc0
    s_waitcnt vmcnt(3)
    v_cmp_le_i32 vcc, 7, v119
    s_add_u32 s61, s61, 1
    s_cbranch_vccnz interleave_layers__linear_attn_block__memory_aug_recurrent_mem_tr__prompt_kernel_r_pr_out
    s_sleep 1
    v_mov_b32 v119, 0
    buffer_atomic_add v119, v125, s[8:11], s45 offen sc0
    s_waitcnt vmcnt(3)
    v_cmp_le_i32 vcc, 7, v116
    s_add_u32 s61, s61, 1
    s_cbranch_vccnz interleave_layers__linear_attn_block__memory_aug_recurrent_mem_tr__prompt_kernel_r_pr_out
    s_sleep 1
    s_cmp_ge_u32 s61, s60
    s_cbranch_scc0 interleave_layers__linear_attn_block__memory_aug_recurrent_mem_tr__prompt_kernel_r_pr
    s_mov_b32 s60, 1
interleave_layers__linear_attn_block__memory_aug_recurrent_mem_tr__prompt_kernel_r_pr_out:
    s_mov_b64 exec, -1
    buffer_load_dwordx4 v[100:103], v10, s[8:11], s42 offen offset:0 sc1
    buffer_load_dwordx4 v[104:107], v10, s[8:11], s42 offen offset:1024 sc1
    buffer_load_dwordx4 v[80:83], v8, s[8:11], s43 offen offset:0 sc1
    buffer_load_dwordx4 v[84:87], v8, s[8:11], s43 offen offset:1024 sc1
    buffer_load_dwordx4 v[88:91], v8, s[8:11], s43 offen offset:2048 sc1
    buffer_load_dwordx4 v[92:95], v8, s[8:11], s43 offen offset:3072 sc1
    buffer_load_dwordx4 v[96:99], v9, s[8:11], s43 offen sc1
    s_waitcnt vmcnt(0)
    v_max3_u32 v204, v80, v81, v82
    v_max3_u32 v204, v204, v83, v84
    v_max3_u32 v204, v204, v85, v86
    v_max3_u32 v204, v204, v87, v88
    v_max3_u32 v204, v204, v89, v90
    v_max3_u32 v204, v204, v91, v92
    v_max3_u32 v204, v204, v93, v94
    v_max3_u32 v204, v204, v95, v96
    v_max3_u32 v204, v204, v97, v98
    v_max3_u32 v204, v204, v99, v100
    v_max3_u32 v204, v204, v101, v102
    v_max3_u32 v204, v204, v103, v104
    v_max3_u32 v204, v204, v105, v106
    v_max_u32 v204, v204, v107
    v_cmp_eq_u32 vcc, -1, v204
    s_cbranch_vccz interleave_layers__linear_attn_block__memory_aug_recurrent_mem_tr__prompt_kernel_r_p_out
    s_mov_b32 s61, 0
interleave_layers__linear_attn_block__memory_aug_recurrent_mem_tr__prompt_kernel_r_p:
    buffer_load_dwordx4 v[100:103], v10, s[8:11], s42 offen offset:0 sc1
    buffer_load_dwordx4 v[104:107], v10, s[8:11], s42 offen offset:1024 sc1
    buffer_load_dwordx4 v[80:83], v8, s[8:11], s43 offen offset:0 sc1
    buffer_load_dwordx4 v[84:87], v8, s[8:11], s43 offen offset:1024 sc1
    buffer_load_dwordx4 v[88:91], v8, s[8:11], s43 offen offset:2048 sc1
    buffer_load_dwordx4 v[92:95], v8, s[8:11], s43 offen offset:3072 sc1
    buffer_load_dwordx4 v[96:99], v9, s[8:11], s43 offen sc1
    s_waitcnt vmcnt(0)
    v_max3_u32 v204, v80, v81, v82
    v_max3_u32 v204, v204, v83, v84
    v_max3_u32 v204, v204, v85, v86
    v_max3_u32 v204, v204, v87, v88
    v_max3_u32 v204, v204, v89, v90
    v_max3_u32 v204, v204, v91, v92
    v_max3_u32 v204, v204, v93, v94
    v_max3_u32 v204, v204, v95, v96
    v_max3_u32 v204, v204, v97, v98
    v_max3_u32 v204, v204, v99, v100
    v_max3_u32 v204, v204, v101, v102
    v_max3_u32 v204, v204, v103, v104
    v_max3_u32 v204, v204, v105, v106
    v_max_u32 v204, v204, v107
    v_cmp_eq_u32 vcc, -1, v204
    s_add_u32 s61, s61, 1
    s_cbranch_vccz interleave_layers__linear_attn_block__memory_aug_recurrent_mem_tr__prompt_kernel_r_p_out
    s_cmp_ge_u32 s61, s60
    s_cbranch_scc1 interleave_layers__linear_attn_block__memory_aug_recurrent_mem_tr__prompt_kernel_r_p_to
    s_sleep 1
    s_branch interleave_layers__linear_attn_block__memory_aug_recurrent_mem_tr__prompt_kernel_r_p
interleave_layers__linear_attn_block__memory_aug_recurrent_mem_tr__prompt_kernel_r_p_to:
    s_mov_b32 s60, 1
interleave_layers__linear_attn_block__memory_aug_recurrent_mem_tr__prompt_kernel_r_p_out:
    s_mov_b64 exec, 1
    ds_add_rtn_u32 v124, v122, v123
    s_mov_b64 exec, -1
    v_mfma_f32_16x16x32_bf16 v[108:111], v[100:103], v[96:99], 0
    v_mfma_f32_16x16x32_bf16 v[112:115], v[104:107], v[96:99], 0
    v_mfma_f32_16x16x32_bf16 v[108:111], v[16:19], v[80:83], v[108:111]
    v_mfma_f32_16x16x32_bf16 v[112:115], v[20:23], v[80:83], v[112:115]
    s_waitcnt lgkmcnt(0)
    v_readfirstlane_b32 s24, v124
    s_and_b32 s24, s24, 3
    s_cmp_eq_u32 s24, 3
    s_cbranch_scc0 interleave_layers__linear_attn_block__memory_aug_recurrent_mem_tr__prompt_kernel_nh30
    buffer_atomic_add v123, v120, s[8:11], s46 offen
interleave_layers__linear_attn_block__memory_aug_recurrent_mem_tr__prompt_kernel_nh30:
    v_mfma_f32_16x16x32_bf16 v[108:111], v[24:27], v[84:87], v[108:111]
    v_mfma_f32_16x16x32_bf16 v[112:115], v[28:31], v[84:87], v[112:115]
    v_mfma_f32_16x16x32_bf16 v[108:111], v[32:35], v[88:91], v[108:111]
    v_mfma_f32_16x16x32_bf16 v[112:115], v[36:39], v[88:91], v[112:115]
    v_mfma_f32_16x16x32_bf16 v[108:111], v[40:43], v[92:95], v[108:111]
    v_mfma_f32_16x16x32_bf16 v[112:115], v[44:47], v[92:95], v[112:115]
    s_and_b32 s24, s40, 1
    s_mul_i32 s24, s24, 2560
    v_add_u32 v14, s24, v11
    v_add_u32 v15, s24, v12
    s_nop 3
    v_cndmask_b32 v108, v108, v112, s[50:51]
    v_cndmask_b32 v109, v109, v113, s[50:51]
    v_cndmask_b32 v110, v110, v114, s[50:51]
    v_cndmask_b32 v111, v111, v115, s[50:51]
    v_add_f32 v108, v108, v108 row_ror:8 row_mask:0xf bank_mask:0xf
    v_add_f32 v109, v109, v109 row_ror:8 row_mask:0xf bank_mask:0xf
    v_add_f32 v110, v110, v110 row_ror:8 row_mask:0xf bank_mask:0xf
    v_add_f32 v111, v111, v111 row_ror:8 row_mask:0xf bank_mask:0xf
    ds_write_b128 v14, v[108:111]
    s_waitcnt lgkmcnt(0)
    s_barrier
    s_cmp_eq_u32 s3, 0
    s_cbranch_scc0 interleave_layers__linear_attn_block__memory_aug_recurrent_mem_tr__prompt_kernel_np31
    ds_read_b128 v[220:223], v15 offset:0
    ds_read_b128 v[224:227], v15 offset:16
    ds_read_b128 v[228:231], v15 offset:640
    ds_read_b128 v[232:235], v15 offset:656
    ds_read_b128 v[236:239], v15 offset:1280
    ds_read_b128 v[240:243], v15 offset:1296
    ds_read_b128 v[244:247], v15 offset:1920
    ds_read_b128 v[248:251], v15 offset:1936
    s_waitcnt lgkmcnt(4)
    v_pk_add_f32 v[220:221], v[220:221], v[228:229]
    v_pk_add_f32 v[222:223], v[222:223], v[230:231]
    v_pk_add_f32 v[224:225], v[224:225], v[232:233]
    v_pk_add_f32 v[226:227], v[226:227], v[234:235]
    s_waitcnt lgkmcnt(0)
    v_pk_add_f32 v[236:237], v[236:237], v[244:245]
    v_pk_add_f32 v[238:239], v[238:239], v[246:247]
    v_pk_add_f32 v[240:241], v[240:241], v[248:249]
    v_pk_add_f32 v[242:243], v[242:243], v[250:251]
    v_pk_add_f32 v[220:221], v[220:221], v[236:237]
    v_pk_add_f32 v[222:223], v[222:223], v[238:239]
    v_pk_add_f32 v[224:225], v[224:225], v[240:241]
    v_pk_add_f32 v[226:227], v[226:227], v[242:243]
    v_cvt_pk_bf16_f32 v228, v220, v221
    v_cvt_pk_bf16_f32 v229, v222, v223
    v_cvt_pk_bf16_f32 v230, v224, v225
    v_cvt_pk_bf16_f32 v231, v226, v227
    v_min_u32 v228, -2, v228
    v_min_u32 v229, -2, v229
    v_min_u32 v230, -2, v230
    v_min_u32 v231, -2, v231
    buffer_store_dwordx4 v[228:231], v13, s[8:11], s47 offen sc1
interleave_layers__linear_attn_block__memory_aug_recurrent_mem_tr__prompt_kernel_np31:
    s_cmp_eq_u32 s3, 1
    s_cbranch_scc0 interleave_layers__linear_attn_block__memory_aug_recurrent_mem_tr__prompt_kernel_xf32
    s_cmp_eq_u32 s44, 39
    s_cbranch_scc0 interleave_layers__linear_attn_block__memory_aug_recurrent_mem_tr__prompt_kernel_xf32
    s_lshl_b32 s24, s92, 6
    s_add_u32 s24, s24, s40
    s_add_u32 s24, s24, 1
    v_lshlrev_b32 v204, 7, v1
    v_add_u32 v204, 23111680, v204
    v_mov_b32 v205, 2146435072
    v_cmp_le_u32 vcc, 8, v1
    s_nop 1
    v_cndmask_b32 v204, v204, v205, vcc
    v_mov_b32 v205, s24
    buffer_store_dword v205, v204, s[8:11], 0 offen sc1
interleave_layers__linear_attn_block__memory_aug_recurrent_mem_tr__prompt_kernel_xf32:
    s_add_u32 s63, s40, 2
    s_min_u32 s63, s63, 64
    s_cmp_ge_i32 s62, s63
    s_cselect_b32 s58, 1, 0
    s_cmp_eq_u32 s58, 1
    s_cbranch_scc1 interleave_layers__linear_attn_block__memory_aug_recurrent_mem_tr__prompt_kernel_rq33
    buffer_load_dword v253, v252, s[8:11], 0 offen sc1
interleave_layers__linear_attn_block__memory_aug_recurrent_mem_tr__prompt_kernel_rq33:
    s_sleep 18
    s_cmp_eq_u32 s58, 1
    s_cbranch_scc1 interleave_layers__linear_attn_block__memory_aug_recurrent_mem_tr__prompt_kernel_rq34
    s_waitcnt vmcnt(0)
    v_readlane_b32 s58, v253, 0
    v_readlane_b32 s24, v253, 1
    s_min_i32 s58, s58, s24
    v_readlane_b32 s24, v253, 2
    s_min_i32 s58, s58, s24
    v_readlane_b32 s24, v253, 3
    s_min_i32 s58, s58, s24
    v_readlane_b32 s24, v253, 4
    s_min_i32 s58, s58, s24
    v_readlane_b32 s24, v253, 5
    s_min_i32 s58, s58, s24
    v_readlane_b32 s24, v253, 6
    s_min_i32 s58, s58, s24
    v_readlane_b32 s24, v253, 7
    s_min_i32 s58, s58, s24
    s_max_i32 s62, s62, s58
interleave_layers__linear_attn_block__memory_aug_recurrent_mem_tr__prompt_kernel_rq34:
    s_cmp_ge_i32 s62, s63
    s_cbranch_scc1 interleave_layers__linear_attn_block__memory_aug_recurrent_mem_tr__prompt_kernel_r_en_ok
    s_mov_b32 s61, 0
interleave_layers__linear_attn_block__memory_aug_recurrent_mem_tr__prompt_kernel_r_en:
    buffer_load_dword v253, v252, s[8:11], 0 offen sc1
    s_waitcnt vmcnt(0)
    v_readlane_b32 s62, v253, 0
    v_readlane_b32 s24, v253, 1
    s_min_i32 s62, s62, s24
    v_readlane_b32 s24, v253, 2
    s_min_i32 s62, s62, s24
    v_readlane_b32 s24, v253, 3
    s_min_i32 s62, s62, s24
    v_readlane_b32 s24, v253, 4
    s_min_i32 s62, s62, s24
    v_readlane_b32 s24, v253, 5
    s_min_i32 s62, s62, s24
    v_readlane_b32 s24, v253, 6
    s_min_i32 s62, s62, s24
    v_readlane_b32 s24, v253, 7
    s_min_i32 s62, s62, s24
    s_cmp_ge_i32 s62, s63
    s_cbranch_scc1 interleave_layers__linear_attn_block__memory_aug_recurrent_mem_tr__prompt_kernel_r_en_ok
    s_add_u32 s61, s61, 1
    s_cmp_ge_u32 s61, s60
    s_cbranch_scc1 interleave_layers__linear_attn_block__memory_aug_recurrent_mem_tr__prompt_kernel_r_en_to
    s_sleep 2
    s_branch interleave_layers__linear_attn_block__memory_aug_recurrent_mem_tr__prompt_kernel_r_en
interleave_layers__linear_attn_block__memory_aug_recurrent_mem_tr__prompt_kernel_r_en_to:
    s_mov_b32 s60, 1
interleave_layers__linear_attn_block__memory_aug_recurrent_mem_tr__prompt_kernel_r_en_ok:
    buffer_load_dwordx4 v[48:51], v6, s[8:11], s41 offen offset:0 sc1
    buffer_load_dwordx4 v[52:55], v6, s[8:11], s41 offen offset:1024 sc1
    buffer_load_dwordx4 v[56:59], v6, s[8:11], s41 offen offset:2048 sc1
    buffer_load_dwordx4 v[60:63], v6, s[8:11], s41 offen offset:3072 sc1
    buffer_load_dwordx4 v[64:67], v7, s[8:11], s41 offen offset:0 sc1
    buffer_load_dwordx4 v[68:71], v7, s[8:11], s41 offen offset:1024 sc1
    buffer_load_dwordx4 v[72:75], v7, s[8:11], s41 offen offset:2048 sc1
    buffer_load_dwordx4 v[76:79], v7, s[8:11], s41 offen offset:3072 sc1
    s_add_u32 s41, s41, 1310720
    s_add_u32 s40, s40, 1
    s_lshl_b32 s24, s40, 12
    s_and_b32 s24, s24, 0x2000
    s_xor_b32 s24, s24, s36
    s_lshl_b32 s37, s40, 20
    s_add_u32 s37, s37, s24
    s_add_u32 s37, s37, 117440512
    s_add_u32 s42, s37, 0
    s_add_u32 s43, s37, 655360
    s_add_u32 s47, s37, 704512
    s_add_u32 s45, s37, 753664
    s_add_u32 s46, s37, 737280
    s_cmp_lt_u32 s40, 64
    s_cbranch_scc1 interleave_layers__linear_attn_block__memory_aug_recurrent_mem_tr__prompt_kernel_r_step
    s_waitcnt vmcnt(0)
    s_cmp_eq_u32 s92, 0
    s_cbranch_scc0 interleave_layers__linear_attn_block__memory_aug_recurrent_mem_tr__prompt_kernel_end
    s_mov_b32 s92, 1
    s_branch interleave_layers__linear_attn_block__memory_aug_recurrent_mem_tr__prompt_kernel_r_top
interleave_layers__linear_attn_block__memory_aug_recurrent_mem_tr__prompt_kernel_roleP:
    s_sub_u32 s44, s2, 104
    s_lshr_b32 s46, s44, 5
    s_and_b32 s44, s44, 31
    s_load_dwordx2 s[6:7], s[0:1], 40
    s_load_dwordx2 s[24:25], s[0:1], 48
    s_load_dwordx2 s[26:27], s[0:1], 56
    s_waitcnt lgkmcnt(0)
    s_cmp_eq_u32 s46, 1
    s_cselect_b32 s6, s24, s6
    s_cselect_b32 s7, s25, s7
    s_cmp_eq_u32 s46, 2
    s_cselect_b32 s6, s26, s6
    s_cselect_b32 s7, s27, s7
    s_mov_b32 s12, s6
    s_mov_b32 s13, s7
    s_mov_b32 s14, 7864320
    s_mov_b32 s15, 0x00020000
    v_add_u32 v16, 0, v0
    s_mov_b32 s24, 683
    v_mul_lo_u32 v17, v16, s24
    v_lshrrev_b32 v17, 14, v17
    v_mul_u32_u24 v18, 24, v17
    v_sub_u32 v18, v16, v18
    s_mov_b32 s24, 12288
    v_mul_lo_u32 v4, v17, s24
    v_lshl_add_u32 v4, v18, 4, v4
    v_mul_u32_u24 v10, 400, v17
    v_lshl_add_u32 v10, v18, 4, v10
    v_add_u32 v10, 81920, v10
    v_add_u32 v16, 256, v0
    s_mov_b32 s24, 683
    v_mul_lo_u32 v17, v16, s24
    v_lshrrev_b32 v17, 14, v17
    v_mul_u32_u24 v18, 24, v17
    v_sub_u32 v18, v16, v18
    s_mov_b32 s24, 12288
    v_mul_lo_u32 v5, v17, s24
    v_lshl_add_u32 v5, v18, 4, v5
    v_mul_u32_u24 v11, 400, v17
    v_lshl_add_u32 v11, v18, 4, v11
    v_add_u32 v11, 81920, v11
    v_add_u32 v16, 512, v0
    s_mov_b32 s24, 683
    v_mul_lo_u32 v17, v16, s24
    v_lshrrev_b32 v17, 14, v17
    v_mul_u32_u24 v18, 24, v17
    v_sub_u32 v18, v16, v18
    s_mov_b32 s24, 12288
    v_mul_lo_u32 v6, v17, s24
    v_lshl_add_u32 v6, v18, 4, v6
    v_mul_u32_u24 v12, 400, v17
    v_lshl_add_u32 v12, v18, 4, v12
    v_add_u32 v12, 81920, v12
    v_add_u32 v16, 768, v0
    s_mov_b32 s24, 683
    v_mul_lo_u32 v17, v16, s24
    v_lshrrev_b32 v17, 14, v17
    v_mul_u32_u24 v18, 24, v17
    v_sub_u32 v18, v16, v18
    s_mov_b32 s24, 12288
    v_mul_lo_u32 v7, v17, s24
    v_lshl_add_u32 v7, v18, 4, v7
    v_mul_u32_u24 v13, 400, v17
    v_lshl_add_u32 v13, v18, 4, v13
    v_add_u32 v13, 81920, v13
    v_add_u32 v16, 1024, v0
    s_mov_b32 s24, 683
    v_mul_lo_u32 v17, v16, s24
    v_lshrrev_b32 v17, 14, v17
    v_mul_u32_u24 v18, 24, v17
    v_sub_u32 v18, v16, v18
    s_mov_b32 s24, 12288
    v_mul_lo_u32 v8, v17, s24
    v_lshl_add_u32 v8, v18, 4, v8
    v_mul_u32_u24 v14, 400, v17
    v_lshl_add_u32 v14, v18, 4, v14
    v_add_u32 v14, 81920, v14
    v_add_u32 v16, 1280, v0
    s_mov_b32 s24, 683
    v_mul_lo_u32 v17, v16, s24
    v_lshrrev_b32 v17, 14, v17
    v_mul_u32_u24 v18, 24, v17
    v_sub_u32 v18, v16, v18
    s_mov_b32 s24, 12288
    v_mul_lo_u32 v9, v17, s24
    v_lshl_add_u32 v9, v18, 4, v9
    v_mul_u32_u24 v15, 400, v17
    v_lshl_add_u32 v15, v18, 4, v15
    v_add_u32 v15, 81920, v15
    v_lshrrev_b32 v16, 2, v2
    v_lshl_add_u32 v16, v3, 2, v16
    v_mul_u32_u24 v32, 400, v16
    v_and_b32 v16, 3, v2
    v_lshl_add_u32 v32, v16, 3, v32
    s_mul_i32 s24, s3, 96
    s_add_u32 s24, s24, 81920
    v_add_u32 v32, s24, v32
    s_mul_i32 s45, s44, 384
    s_add_u32 s47, s45, 0
    buffer_load_dwordx4 v[56:59], v4, s[12:15], s47 offen
    buffer_load_dwordx4 v[60:63], v5, s[12:15], s47 offen
    buffer_load_dwordx4 v[64:67], v6, s[12:15], s47 offen
    buffer_load_dwordx4 v[68:71], v7, s[12:15], s47 offen
    buffer_load_dwordx4 v[72:75], v8, s[12:15], s47 offen
    buffer_load_dwordx4 v[76:79], v9, s[12:15], s47 offen
    s_add_u32 s47, s45, 786432
    buffer_load_dwordx4 v[80:83], v4, s[12:15], s47 offen
    buffer_load_dwordx4 v[84:87], v5, s[12:15], s47 offen
    buffer_load_dwordx4 v[88:91], v6, s[12:15], s47 offen
    buffer_load_dwordx4 v[92:95], v7, s[12:15], s47 offen
    buffer_load_dwordx4 v[96:99], v8, s[12:15], s47 offen
    buffer_load_dwordx4 v[100:103], v9, s[12:15], s47 offen
    s_add_u32 s47, s45, 1572864
    buffer_load_dwordx4 v[104:107], v4, s[12:15], s47 offen
    buffer_load_dwordx4 v[108:111], v5, s[12:15], s47 offen
    buffer_load_dwordx4 v[112:115], v6, s[12:15], s47 offen
    buffer_load_dwordx4 v[116:119], v7, s[12:15], s47 offen
    buffer_load_dwordx4 v[120:123], v8, s[12:15], s47 offen
    buffer_load_dwordx4 v[124:127], v9, s[12:15], s47 offen
    s_add_u32 s47, s45, 2359296
    buffer_load_dwordx4 v[128:131], v4, s[12:15], s47 offen
    buffer_load_dwordx4 v[132:135], v5, s[12:15], s47 offen
    buffer_load_dwordx4 v[136:139], v6, s[12:15], s47 offen
    buffer_load_dwordx4 v[140:143], v7, s[12:15], s47 offen
    buffer_load_dwordx4 v[144:147], v8, s[12:15], s47 offen
    buffer_load_dwordx4 v[148:151], v9, s[12:15], s47 offen
    s_add_u32 s47, s45, 3145728
    buffer_load_dwordx4 v[152:155], v4, s[12:15], s47 offen
    buffer_load_dwordx4 v[156:159], v5, s[12:15], s47 offen
    buffer_load_dwordx4 v[160:163], v6, s[12:15], s47 offen
    buffer_load_dwordx4 v[164:167], v7, s[12:15], s47 offen
    buffer_load_dwordx4 v[168:171], v8, s[12:15], s47 offen
    buffer_load_dwordx4 v[172:175], v9, s[12:15], s47 offen
    s_add_u32 s47, s45, 3932160
    buffer_load_dwordx4 v[176:179], v4, s[12:15], s47 offen
    buffer_load_dwordx4 v[180:183], v5, s[12:15], s47 offen
    buffer_load_dwordx4 v[184:187], v6, s[12:15], s47 offen
    buffer_load_dwordx4 v[188:191], v7, s[12:15], s47 offen
    buffer_load_dwordx4 v[192:195], v8, s[12:15], s47 offen
    buffer_load_dwordx4 v[196:199], v9, s[12:15], s47 offen
    s_add_u32 s47, s45, 4718592
    buffer_load_dwordx4 v[200:203], v4, s[12:15], s47 offen
    buffer_load_dwordx4 v[204:207], v5, s[12:15], s47 offen
    buffer_load_dwordx4 v[208:211], v6, s[12:15], s47 offen
    buffer_load_dwordx4 v[212:215], v7, s[12:15], s47 offen
    buffer_load_dwordx4 v[216:219], v8, s[12:15], s47 offen
    buffer_load_dwordx4 v[220:223], v9, s[12:15], s47 offen
    s_add_u32 s47, s45, 5505024
    buffer_load_dwordx4 v[224:227], v4, s[12:15], s47 offen
    buffer_load_dwordx4 v[228:231], v5, s[12:15], s47 offen
    buffer_load_dwordx4 v[232:235], v6, s[12:15], s47 offen
    buffer_load_dwordx4 v[236:239], v7, s[12:15], s47 offen
    buffer_load_dwordx4 v[240:243], v8, s[12:15], s47 offen
    buffer_load_dwordx4 v[244:247], v9, s[12:15], s47 offen
    v_mov_b32 v28, 0x3f803f80
    v_mov_b32 v29, 0x3f803f80
    v_mov_b32 v30, 0x3f803f80
    v_mov_b32 v31, 0x3f803f80
    s_waitcnt vmcnt(42)
    ds_write_b128 v10, v[56:59] offset:0
    ds_write_b128 v11, v[60:63] offset:0
    ds_write_b128 v12, v[64:67] offset:0
    ds_write_b128 v13, v[68:71] offset:0
    ds_write_b128 v14, v[72:75] offset:0
    ds_write_b128 v15, v[76:79] offset:0
    s_waitcnt lgkmcnt(0)
    s_add_u32 s47, s45, 6291456
    buffer_load_dwordx4 v[56:59], v4, s[12:15], s47 offen
    buffer_load_dwordx4 v[60:63], v5, s[12:15], s47 offen
    buffer_load_dwordx4 v[64:67], v6, s[12:15], s47 offen
    buffer_load_dwordx4 v[68:71], v7, s[12:15], s47 offen
    buffer_load_dwordx4 v[72:75], v8, s[12:15], s47 offen
    buffer_load_dwordx4 v[76:79], v9, s[12:15], s47 offen
    s_barrier
    ds_read_b64_tr_b16 a[0:1], v32 offset:0
    ds_read_b64_tr_b16 a[2:3], v32 offset:6400
    ds_read_b64_tr_b16 a[4:5], v32 offset:12800
    ds_read_b64_tr_b16 a[6:7], v32 offset:19200
    ds_read_b64_tr_b16 a[80:81], v32 offset:32
    ds_read_b64_tr_b16 a[82:83], v32 offset:6432
    ds_read_b64_tr_b16 a[84:85], v32 offset:12832
    ds_read_b64_tr_b16 a[86:87], v32 offset:19232
    ds_read_b64_tr_b16 a[160:161], v32 offset:64
    ds_read_b64_tr_b16 a[162:163], v32 offset:6464
    ds_read_b64_tr_b16 a[164:165], v32 offset:12864
    ds_read_b64_tr_b16 a[166:167], v32 offset:19264
    s_waitcnt vmcnt(42)
    ds_write_b128 v10, v[80:83] offset:25600
    ds_write_b128 v11, v[84:87] offset:25600
    ds_write_b128 v12, v[88:91] offset:25600
    ds_write_b128 v13, v[92:95] offset:25600
    ds_write_b128 v14, v[96:99] offset:25600
    ds_write_b128 v15, v[100:103] offset:25600
    s_waitcnt lgkmcnt(0)
    s_add_u32 s47, s45, 7077888
    buffer_load_dwordx4 v[80:83], v4, s[12:15], s47 offen
    buffer_load_dwordx4 v[84:87], v5, s[12:15], s47 offen
    buffer_load_dwordx4 v[88:91], v6, s[12:15], s47 offen
    buffer_load_dwordx4 v[92:95], v7, s[12:15], s47 offen
    buffer_load_dwordx4 v[96:99], v8, s[12:15], s47 offen
    buffer_load_dwordx4 v[100:103], v9, s[12:15], s47 offen
    v_mfma_f32_16x16x32_bf16 v[16:19], a[0:3], v[28:31], 0
    v_mfma_f32_16x16x32_bf16 v[20:23], a[80:83], v[28:31], 0
    v_mfma_f32_16x16x32_bf16 v[24:27], a[160:163], v[28:31], 0
    v_mfma_f32_16x16x32_bf16 v[16:19], a[4:7], v[28:31], v[16:19]
    v_mfma_f32_16x16x32_bf16 v[20:23], a[84:87], v[28:31], v[20:23]
    v_mfma_f32_16x16x32_bf16 v[24:27], a[164:167], v[28:31], v[24:27]
    s_barrier
    ds_read_b64_tr_b16 a[8:9], v32 offset:25600
    ds_read_b64_tr_b16 a[10:11], v32 offset:32000
    ds_read_b64_tr_b16 a[12:13], v32 offset:38400
    ds_read_b64_tr_b16 a[14:15], v32 offset:44800
    ds_read_b64_tr_b16 a[88:89], v32 offset:25632
    ds_read_b64_tr_b16 a[90:91], v32 offset:32032
    ds_read_b64_tr_b16 a[92:93], v32 offset:38432
    ds_read_b64_tr_b16 a[94:95], v32 offset:44832
    ds_read_b64_tr_b16 a[168:169], v32 offset:25664
    ds_read_b64_tr_b16 a[170:171], v32 offset:32064
    ds_read_b64_tr_b16 a[172:173], v32 offset:38464
    ds_read_b64_tr_b16 a[174:175], v32 offset:44864
    s_waitcnt vmcnt(42)
    ds_write_b128 v10, v[104:107] offset:0
    ds_write_b128 v11, v[108:111] offset:0
    ds_write_b128 v12, v[112:115] offset:0
    ds_write_b128 v13, v[116:119] offset:0
    ds_write_b128 v14, v[120:123] offset:0
    ds_write_b128 v15, v[124:127] offset:0
    s_waitcnt lgkmcnt(0)
    v_mfma_f32_16x16x32_bf16 v[16:19], a[8:11], v[28:31], v[16:19]
    v_mfma_f32_16x16x32_bf16 v[20:23], a[88:91], v[28:31], v[20:23]
    v_mfma_f32_16x16x32_bf16 v[24:27], a[168:171], v[28:31], v[24:27]
    v_mfma_f32_16x16x32_bf16 v[16:19], a[12:15], v[28:31], v[16:19]
    v_mfma_f32_16x16x32_bf16 v[20:23], a[92:95], v[28:31], v[20:23]
    v_mfma_f32_16x16x32_bf16 v[24:27], a[172:175], v[28:31], v[24:27]
    s_barrier
    ds_read_b64_tr_b16 a[16:17], v32 offset:0
    ds_read_b64_tr_b16 a[18:19], v32 offset:6400
    ds_read_b64_tr_b16 a[20:21], v32 offset:12800
    ds_read_b64_tr_b16 a[22:23], v32 offset:19200
    ds_read_b64_tr_b16 a[96:97], v32 offset:32
    ds_read_b64_tr_b16 a[98:99], v32 offset:6432
    ds_read_b64_tr_b16 a[100:101], v32 offset:12832
    ds_read_b64_tr_b16 a[102:103], v32 offset:19232
    ds_read_b64_tr_b16 a[176:177], v32 offset:64
    ds_read_b64_tr_b16 a[178:179], v32 offset:6464
    ds_read_b64_tr_b16 a[180:181], v32 offset:12864
    ds_read_b64_tr_b16 a[182:183], v32 offset:19264
    s_waitcnt vmcnt(36)
    ds_write_b128 v10, v[128:131] offset:25600
    ds_write_b128 v11, v[132:135] offset:25600
    ds_write_b128 v12, v[136:139] offset:25600
    ds_write_b128 v13, v[140:143] offset:25600
    ds_write_b128 v14, v[144:147] offset:25600
    ds_write_b128 v15, v[148:151] offset:25600
    s_waitcnt lgkmcnt(0)
    v_mfma_f32_16x16x32_bf16 v[16:19], a[16:19], v[28:31], v[16:19]
    v_mfma_f32_16x16x32_bf16 v[20:23], a[96:99], v[28:31], v[20:23]
    v_mfma_f32_16x16x32_bf16 v[24:27], a[176:179], v[28:31], v[24:27]
    v_mfma_f32_16x16x32_bf16 v[16:19], a[20:23], v[28:31], v[16:19]
    v_mfma_f32_16x16x32_bf16 v[20:23], a[100:103], v[28:31], v[20:23]
    v_mfma_f32_16x16x32_bf16 v[24:27], a[180:183], v[28:31], v[24:27]
    s_barrier
    ds_read_b64_tr_b16 a[24:25], v32 offset:25600
    ds_read_b64_tr_b16 a[26:27], v32 offset:32000
    ds_read_b64_tr_b16 a[28:29], v32 offset:38400
    ds_read_b64_tr_b16 a[30:31], v32 offset:44800
    ds_read_b64_tr_b16 a[104:105], v32 offset:25632
    ds_read_b64_tr_b16 a[106:107], v32 offset:32032
    ds_read_b64_tr_b16 a[108:109], v32 offset:38432
    ds_read_b64_tr_b16 a[110:111], v32 offset:44832
    ds_read_b64_tr_b16 a[184:185], v32 offset:25664
    ds_read_b64_tr_b16 a[186:187], v32 offset:32064
    ds_read_b64_tr_b16 a[188:189], v32 offset:38464
    ds_read_b64_tr_b16 a[190:191], v32 offset:44864
    s_waitcnt vmcnt(30)
    ds_write_b128 v10, v[152:155] offset:0
    ds_write_b128 v11, v[156:159] offset:0
    ds_write_b128 v12, v[160:163] offset:0
    ds_write_b128 v13, v[164:167] offset:0
    ds_write_b128 v14, v[168:171] offset:0
    ds_write_b128 v15, v[172:175] offset:0
    s_waitcnt lgkmcnt(0)
    v_mfma_f32_16x16x32_bf16 v[16:19], a[24:27], v[28:31], v[16:19]
    v_mfma_f32_16x16x32_bf16 v[20:23], a[104:107], v[28:31], v[20:23]
    v_mfma_f32_16x16x32_bf16 v[24:27], a[184:187], v[28:31], v[24:27]
    v_mfma_f32_16x16x32_bf16 v[16:19], a[28:31], v[28:31], v[16:19]
    v_mfma_f32_16x16x32_bf16 v[20:23], a[108:111], v[28:31], v[20:23]
    v_mfma_f32_16x16x32_bf16 v[24:27], a[188:191], v[28:31], v[24:27]
    s_barrier
    ds_read_b64_tr_b16 a[32:33], v32 offset:0
    ds_read_b64_tr_b16 a[34:35], v32 offset:6400
    ds_read_b64_tr_b16 a[36:37], v32 offset:12800
    ds_read_b64_tr_b16 a[38:39], v32 offset:19200
    ds_read_b64_tr_b16 a[112:113], v32 offset:32
    ds_read_b64_tr_b16 a[114:115], v32 offset:6432
    ds_read_b64_tr_b16 a[116:117], v32 offset:12832
    ds_read_b64_tr_b16 a[118:119], v32 offset:19232
    ds_read_b64_tr_b16 a[192:193], v32 offset:64
    ds_read_b64_tr_b16 a[194:195], v32 offset:6464
    ds_read_b64_tr_b16 a[196:197], v32 offset:12864
    ds_read_b64_tr_b16 a[198:199], v32 offset:19264
    s_waitcnt vmcnt(24)
    ds_write_b128 v10, v[176:179] offset:25600
    ds_write_b128 v11, v[180:183] offset:25600
    ds_write_b128 v12, v[184:187] offset:25600
    ds_write_b128 v13, v[188:191] offset:25600
    ds_write_b128 v14, v[192:195] offset:25600
    ds_write_b128 v15, v[196:199] offset:25600
    s_waitcnt lgkmcnt(0)
    v_mfma_f32_16x16x32_bf16 v[16:19], a[32:35], v[28:31], v[16:19]
    v_mfma_f32_16x16x32_bf16 v[20:23], a[112:115], v[28:31], v[20:23]
    v_mfma_f32_16x16x32_bf16 v[24:27], a[192:195], v[28:31], v[24:27]
    v_mfma_f32_16x16x32_bf16 v[16:19], a[36:39], v[28:31], v[16:19]
    v_mfma_f32_16x16x32_bf16 v[20:23], a[116:119], v[28:31], v[20:23]
    v_mfma_f32_16x16x32_bf16 v[24:27], a[196:199], v[28:31], v[24:27]
    s_barrier
    ds_read_b64_tr_b16 a[40:41], v32 offset:25600
    ds_read_b64_tr_b16 a[42:43], v32 offset:32000
    ds_read_b64_tr_b16 a[44:45], v32 offset:38400
    ds_read_b64_tr_b16 a[46:47], v32 offset:44800
    ds_read_b64_tr_b16 a[120:121], v32 offset:25632
    ds_read_b64_tr_b16 a[122:123], v32 offset:32032
    ds_read_b64_tr_b16 a[124:125], v32 offset:38432
    ds_read_b64_tr_b16 a[126:127], v32 offset:44832
    ds_read_b64_tr_b16 a[200:201], v32 offset:25664
    ds_read_b64_tr_b16 a[202:203], v32 offset:32064
    ds_read_b64_tr_b16 a[204:205], v32 offset:38464
    ds_read_b64_tr_b16 a[206:207], v32 offset:44864
    s_waitcnt vmcnt(18)
    ds_write_b128 v10, v[200:203] offset:0
    ds_write_b128 v11, v[204:207] offset:0
    ds_write_b128 v12, v[208:211] offset:0
    ds_write_b128 v13, v[212:215] offset:0
    ds_write_b128 v14, v[216:219] offset:0
    ds_write_b128 v15, v[220:223] offset:0
    s_waitcnt lgkmcnt(0)
    v_mfma_f32_16x16x32_bf16 v[16:19], a[40:43], v[28:31], v[16:19]
    v_mfma_f32_16x16x32_bf16 v[20:23], a[120:123], v[28:31], v[20:23]
    v_mfma_f32_16x16x32_bf16 v[24:27], a[200:203], v[28:31], v[24:27]
    v_mfma_f32_16x16x32_bf16 v[16:19], a[44:47], v[28:31], v[16:19]
    v_mfma_f32_16x16x32_bf16 v[20:23], a[124:127], v[28:31], v[20:23]
    v_mfma_f32_16x16x32_bf16 v[24:27], a[204:207], v[28:31], v[24:27]
    s_barrier
    ds_read_b64_tr_b16 a[48:49], v32 offset:0
    ds_read_b64_tr_b16 a[50:51], v32 offset:6400
    ds_read_b64_tr_b16 a[52:53], v32 offset:12800
    ds_read_b64_tr_b16 a[54:55], v32 offset:19200
    ds_read_b64_tr_b16 a[128:129], v32 offset:32
    ds_read_b64_tr_b16 a[130:131], v32 offset:6432
    ds_read_b64_tr_b16 a[132:133], v32 offset:12832
    ds_read_b64_tr_b16 a[134:135], v32 offset:19232
    ds_read_b64_tr_b16 a[208:209], v32 offset:64
    ds_read_b64_tr_b16 a[210:211], v32 offset:6464
    ds_read_b64_tr_b16 a[212:213], v32 offset:12864
    ds_read_b64_tr_b16 a[214:215], v32 offset:19264
    s_waitcnt vmcnt(12)
    ds_write_b128 v10, v[224:227] offset:25600
    ds_write_b128 v11, v[228:231] offset:25600
    ds_write_b128 v12, v[232:235] offset:25600
    ds_write_b128 v13, v[236:239] offset:25600
    ds_write_b128 v14, v[240:243] offset:25600
    ds_write_b128 v15, v[244:247] offset:25600
    s_waitcnt lgkmcnt(0)
    v_mfma_f32_16x16x32_bf16 v[16:19], a[48:51], v[28:31], v[16:19]
    v_mfma_f32_16x16x32_bf16 v[20:23], a[128:131], v[28:31], v[20:23]
    v_mfma_f32_16x16x32_bf16 v[24:27], a[208:211], v[28:31], v[24:27]
    v_mfma_f32_16x16x32_bf16 v[16:19], a[52:55], v[28:31], v[16:19]
    v_mfma_f32_16x16x32_bf16 v[20:23], a[132:135], v[28:31], v[20:23]
    v_mfma_f32_16x16x32_bf16 v[24:27], a[212:215], v[28:31], v[24:27]
    s_barrier
    ds_read_b64_tr_b16 a[56:57], v32 offset:25600
    ds_read_b64_tr_b16 a[58:59], v32 offset:32000
    ds_read_b64_tr_b16 a[60:61], v32 offset:38400
    ds_read_b64_tr_b16 a[62:63], v32 offset:44800
    ds_read_b64_tr_b16 a[136:137], v32 offset:25632
    ds_read_b64_tr_b16 a[138:139], v32 offset:32032
    ds_read_b64_tr_b16 a[140:141], v32 offset:38432
    ds_read_b64_tr_b16 a[142:143], v32 offset:44832
    ds_read_b64_tr_b16 a[216:217], v32 offset:25664
    ds_read_b64_tr_b16 a[218:219], v32 offset:32064
    ds_read_b64_tr_b16 a[220:221], v32 offset:38464
    ds_read_b64_tr_b16 a[222:223], v32 offset:44864
    s_waitcnt vmcnt(6)
    ds_write_b128 v10, v[56:59] offset:0
    ds_write_b128 v11, v[60:63] offset:0
    ds_write_b128 v12, v[64:67] offset:0
    ds_write_b128 v13, v[68:71] offset:0
    ds_write_b128 v14, v[72:75] offset:0
    ds_write_b128 v15, v[76:79] offset:0
    s_waitcnt lgkmcnt(0)
    v_mfma_f32_16x16x32_bf16 v[16:19], a[56:59], v[28:31], v[16:19]
    v_mfma_f32_16x16x32_bf16 v[20:23], a[136:139], v[28:31], v[20:23]
    v_mfma_f32_16x16x32_bf16 v[24:27], a[216:219], v[28:31], v[24:27]
    v_mfma_f32_16x16x32_bf16 v[16:19], a[60:63], v[28:31], v[16:19]
    v_mfma_f32_16x16x32_bf16 v[20:23], a[140:143], v[28:31], v[20:23]
    v_mfma_f32_16x16x32_bf16 v[24:27], a[220:223], v[28:31], v[24:27]
    s_barrier
    ds_read_b64_tr_b16 a[64:65], v32 offset:0
    ds_read_b64_tr_b16 a[66:67], v32 offset:6400
    ds_read_b64_tr_b16 a[68:69], v32 offset:12800
    ds_read_b64_tr_b16 a[70:71], v32 offset:19200
    ds_read_b64_tr_b16 a[144:145], v32 offset:32
    ds_read_b64_tr_b16 a[146:147], v32 offset:6432
    ds_read_b64_tr_b16 a[148:149], v32 offset:12832
    ds_read_b64_tr_b16 a[150:151], v32 offset:19232
    ds_read_b64_tr_b16 a[224:225], v32 offset:64
    ds_read_b64_tr_b16 a[226:227], v32 offset:6464
    ds_read_b64_tr_b16 a[228:229], v32 offset:12864
    ds_read_b64_tr_b16 a[230:231], v32 offset:19264
    s_waitcnt vmcnt(0)
    ds_write_b128 v10, v[80:83] offset:25600
    ds_write_b128 v11, v[84:87] offset:25600
    ds_write_b128 v12, v[88:91] offset:25600
    ds_write_b128 v13, v[92:95] offset:25600
    ds_write_b128 v14, v[96:99] offset:25600
    ds_write_b128 v15, v[100:103] offset:25600
    s_waitcnt lgkmcnt(0)
    v_mfma_f32_16x16x32_bf16 v[16:19], a[64:67], v[28:31], v[16:19]
    v_mfma_f32_16x16x32_bf16 v[20:23], a[144:147], v[28:31], v[20:23]
    v_mfma_f32_16x16x32_bf16 v[24:27], a[224:227], v[28:31], v[24:27]
    v_mfma_f32_16x16x32_bf16 v[16:19], a[68:71], v[28:31], v[16:19]
    v_mfma_f32_16x16x32_bf16 v[20:23], a[148:151], v[28:31], v[20:23]
    v_mfma_f32_16x16x32_bf16 v[24:27], a[228:231], v[28:31], v[24:27]
    s_barrier
    ds_read_b64_tr_b16 a[72:73], v32 offset:25600
    ds_read_b64_tr_b16 a[74:75], v32 offset:32000
    ds_read_b64_tr_b16 a[76:77], v32 offset:38400
    ds_read_b64_tr_b16 a[78:79], v32 offset:44800
    ds_read_b64_tr_b16 a[152:153], v32 offset:25632
    ds_read_b64_tr_b16 a[154:155], v32 offset:32032
    ds_read_b64_tr_b16 a[156:157], v32 offset:38432
    ds_read_b64_tr_b16 a[158:159], v32 offset:44832
    ds_read_b64_tr_b16 a[232:233], v32 offset:25664
    ds_read_b64_tr_b16 a[234:235], v32 offset:32064
    ds_read_b64_tr_b16 a[236:237], v32 offset:38464
    ds_read_b64_tr_b16 a[238:239], v32 offset:44864
    s_waitcnt lgkmcnt(0)
    v_mfma_f32_16x16x32_bf16 v[16:19], a[72:75], v[28:31], v[16:19]
    v_mfma_f32_16x16x32_bf16 v[20:23], a[152:155], v[28:31], v[20:23]
    v_mfma_f32_16x16x32_bf16 v[24:27], a[232:235], v[28:31], v[24:27]
    v_mfma_f32_16x16x32_bf16 v[16:19], a[76:79], v[28:31], v[16:19]
    v_mfma_f32_16x16x32_bf16 v[20:23], a[156:159], v[28:31], v[20:23]
    v_mfma_f32_16x16x32_bf16 v[24:27], a[236:239], v[28:31], v[24:27]
    s_nop 5
    v_mov_b32 v224, v16
    v_mov_b32 v225, v17
    v_mov_b32 v226, v18
    v_mov_b32 v227, v19
    v_mov_b32 v228, v20
    v_mov_b32 v229, v21
    v_mov_b32 v230, v22
    v_mov_b32 v231, v23
    v_mov_b32 v232, v24
    v_mov_b32 v233, v25
    v_mov_b32 v234, v26
    v_mov_b32 v235, v27
    v_mov_b32 v236, v28
    v_mov_b32 v237, v29
    v_mov_b32 v238, v30
    v_mov_b32 v239, v31
    s_barrier
interleave_layers__linear_attn_block__memory_aug_recurrent_mem_tr__prompt_kernel_p_layer:
    s_mov_b32 s93, 0
    s_lshl_b32 s24, s93, 12
    s_and_b32 s24, s24, 0x2000
    s_xor_b32 s24, s24, s36
    s_lshl_b32 s93, s93, 20
    s_add_u32 s93, s93, s24
    s_add_u32 s93, s93, 117440512
    s_mul_i32 s94, s92, 16384
    s_add_u32 s94, s94, 23068672
    s_sub_u32 s44, s2, 104
    s_lshr_b32 s46, s44, 5
    s_and_b32 s44, s44, 31
    s_mov_b32 s43, 67108864
    s_cmp_eq_u32 s46, 1
    s_cselect_b32 s43, 92274688, s43
    s_cmp_eq_u32 s46, 2
    s_cselect_b32 s43, 33554432, s43
    s_cmp_eq_u32 s92, 0
    s_cselect_b32 s73, 0, 8388608
    v_lshlrev_b32 v5, 4, v1
    s_mul_i32 s24, s3, 10240
    v_add_u32 v6, s24, v5
    v_add_u32 v7, 4096, v6
    v_add_u32 v8, 8192, v6
    s_mul_i32 s24, s44, 12288
    s_mul_i32 s25, s3, 3072
    s_add_u32 s24, s24, s25
    v_add_u32 v11, s24, v5
    s_lshr_b32 s24, s3, 1
    s_lshl_b32 s24, s24, 8
    s_and_b32 s25, s3, 1
    s_lshl_b32 s25, s25, 3
    s_add_u32 s24, s24, s25
    s_add_u32 s24, s24, 81920
    v_lshlrev_b32 v13, 4, v2
    v_add_u32 v12, s24, v13
    v_add_u32 v13, 81920, v13
    v_lshrrev_b32 v15, 2, v2
    v_cmp_eq_u32 vcc, v15, v3
    v_lshlrev_b32 v15, 3, v1
    v_add_u32 v15, 82944, v15
    v_cndmask_b32 v12, v15, v12, vcc
    v_and_b32 v15, 3, v2
    v_cmp_eq_u32 s[48:49], 1, v15
    v_cmp_eq_u32 s[50:51], 2, v15
    v_cmp_eq_u32 s[54:55], 3, v15
    s_and_b32 s24, s2, 7
    s_lshl_b32 s24, s24, 7
    s_lshl_b32 s25, s92, 10
    s_add_u32 s24, s24, s25
    s_add_u32 s24, s24, 23105536
    s_mov_b32 s25, 20
    s_mov_b32 s75, 2
    s_mov_b32 s74, 16
    v_cmp_gt_u32 vcc, s25, v1
    s_nop 1
    v_cndmask_b32 v4, 0, v1, vcc
    v_lshlrev_b32 v4, 2, v4
    v_add_u32 v4, s24, v4
    s_lshl_b32 s24, s46, 12
    s_lshl_b32 s25, s44, 7
    s_add_u32 s24, s24, s25
    s_add_u32 s24, s24, s94
    v_mov_b32 v14, s24
    v_mov_b32 v15, 2146435072
    v_cmp_eq_u32 vcc, 0, v1
    s_nop 1
    v_cndmask_b32 v14, v15, v14, vcc
    s_cmp_eq_u32 s3, 0
    s_cselect_b32 s24, 0, 2146435072
    v_or_b32 v14, s24, v14
    s_sub_u32 s70, s2, 104
    s_mul_i32 s71, s70, 205
    s_lshr_b32 s71, s71, 12
    s_mul_i32 s24, s71, 20
    s_sub_u32 s70, s70, s24
    s_cmp_lt_u32 s71, 4
    s_cselect_b32 s64, s71, 64
    s_lshl_b32 s24, s70, 16
    s_lshl_b32 s25, s3, 13
    s_add_u32 s24, s24, s25
    v_add_u32 v240, s24, v5
    v_add_u32 v241, 4096, v240
    s_lshl_b32 s24, s70, 15
    s_lshl_b32 s25, s3, 11
    s_add_u32 s24, s24, s25
    v_add_u32 v242, s24, v5
    s_lshl_b32 s24, s3, 15
    v_add_u32 v193, s24, v5
    v_add_u32 v212, 0, v193
    v_add_u32 v213, 4096, v193
    v_add_u32 v214, 16384, v193
    v_add_u32 v215, 20480, v193
    s_lshl_b32 s24, s3, 12
    s_and_b32 s25, s24, 0x2000
    s_add_u32 s24, s24, s25
    s_add_u32 s24, s24, 131072
    v_add_u32 v216, s24, v5
    s_lshl_b32 s24, s3, 12
    s_add_u32 s24, s24, 83968
    v_add_u32 v217, s24, v5
    s_and_b32 s24, s3, 1
    s_lshl_b32 s24, s24, 10
    s_add_u32 s24, s24, 83968
    v_add_u32 v218, s24, v5
    s_and_b32 s24, s3, 1
    s_mul_i32 s24, s24, 20480
    s_lshl_b32 s25, s70, 10
    s_add_u32 s24, s24, s25
    v_add_u32 v219, s24, v5
    s_and_b32 s24, s3, 1
    s_lshl_b32 s24, s24, 4
    v_add_u32 v243, s24, v2
    v_mul_u32_u24 v243, 1280, v243
    v_lshl_add_u32 v243, v3, 3, v243
    s_lshl_b32 s24, s70, 6
    v_add_u32 v243, s24, v243
    s_load_dwordx2 s[26:27], s[0:1], 80
    s_waitcnt lgkmcnt(0)
    s_mov_b32 s12, s26
    s_mov_b32 s13, s27
    s_mov_b32 s14, 2621440
    s_mov_b32 s15, 0x00020000
    s_mul_i32 s65, s71, 1310720
    s_add_u32 s65, s65, 184549376
    s_lshl_b32 s24, s71, 12
    s_and_b32 s24, s24, 0x2000
    s_xor_b32 s24, s24, s36
    s_lshl_b32 s66, s71, 20
    s_add_u32 s66, s66, s24
    s_add_u32 s66, s66, 117440512
    s_xor_b32 s67, s66, 0x2000
    s_mul_i32 s68, s71, 40960
    v_and_b32 v252, 7, v1
    v_lshlrev_b32 v252, 7, v252
    s_lshl_b32 s24, s3, 10
    s_add_u32 s24, s24, 12288
    s_add_u32 s24, s24, s94
    v_add_u32 v252, s24, v252
    s_mov_b32 s69, -1
    s_lshl_b32 s24, s71, 7
    s_lshl_b32 s25, s70, 2
    s_add_u32 s24, s24, s25
    s_add_u32 s24, s24, 23107584
    s_cmp_eq_u32 s3, 0
    s_cselect_b32 s24, s24, 2146435072
    v_mov_b32 v245, s24
    v_mov_b32 v246, 2146435072
    v_cmp_eq_u32 vcc, 0, v1
    s_nop 1
    v_cndmask_b32 v245, v246, v245, vcc
    s_mov_b32 s79, -1
    s_mov_b32 s76, -1
    s_mov_b32 s62, -1
    s_mov_b32 s63, 1
    s_mov_b32 s39, -1
    s_cmp_ge_i32 s39, s63
    s_cbranch_scc1 interleave_layers__linear_attn_block__memory_aug_recurrent_mem_tr__prompt_kernel_p_en0_ok
    s_mov_b32 s61, 0
interleave_layers__linear_attn_block__memory_aug_recurrent_mem_tr__prompt_kernel_p_en0:
    buffer_load_dword v16, v4, s[8:11], 0 offen sc1
    s_waitcnt vmcnt(0)
    v_readlane_b32 s39, v16, 0
    v_readlane_b32 s24, v16, 1
    s_min_i32 s39, s39, s24
    v_readlane_b32 s24, v16, 2
    s_min_i32 s39, s39, s24
    v_readlane_b32 s24, v16, 3
    s_min_i32 s39, s39, s24
    v_readlane_b32 s24, v16, 4
    s_min_i32 s39, s39, s24
    s_cmp_ge_i32 s39, s63
    s_cbranch_scc1 interleave_layers__linear_attn_block__memory_aug_recurrent_mem_tr__prompt_kernel_p_en0_ok
    s_add_u32 s61, s61, 1
    s_cmp_ge_u32 s61, s60
    s_cbranch_scc1 interleave_layers__linear_attn_block__memory_aug_recurrent_mem_tr__prompt_kernel_p_en0_to
    s_sleep 2
    s_branch interleave_layers__linear_attn_block__memory_aug_recurrent_mem_tr__prompt_kernel_p_en0
interleave_layers__linear_attn_block__memory_aug_recurrent_mem_tr__prompt_kernel_p_en0_to:
    s_mov_b32 s60, 1
interleave_layers__linear_attn_block__memory_aug_recurrent_mem_tr__prompt_kernel_p_en0_ok:
    s_mov_b32 s41, s73
    buffer_load_dwordx4 v[16:19], v6, s[8:11], s41 offen offset:0
    buffer_load_dwordx4 v[20:23], v6, s[8:11], s41 offen offset:1024
    buffer_load_dwordx4 v[24:27], v6, s[8:11], s41 offen offset:2048
    buffer_load_dwordx4 v[28:31], v6, s[8:11], s41 offen offset:3072
    buffer_load_dwordx4 v[32:35], v7, s[8:11], s41 offen offset:0
    buffer_load_dwordx4 v[36:39], v7, s[8:11], s41 offen offset:1024
    buffer_load_dwordx4 v[40:43], v7, s[8:11], s41 offen offset:2048
    buffer_load_dwordx4 v[44:47], v7, s[8:11], s41 offen offset:3072
    buffer_load_dwordx4 v[48:51], v8, s[8:11], s41 offen offset:0
    buffer_load_dwordx4 v[52:55], v8, s[8:11], s41 offen offset:1024
    s_mov_b32 s40, 0
    s_mov_b32 s42, 0
    s_waitcnt vmcnt(0)
    v_mfma_f32_16x16x32_bf16 v[148:151], v[16:19], v[16:19], 0
    v_mfma_f32_16x16x32_bf16 v[144:147], v[236:239], v[16:19], 0
    v_mfma_f32_16x16x32_bf16 v[148:151], v[20:23], v[20:23], v[148:151]
    v_mfma_f32_16x16x32_bf16 v[144:147], v[236:239], v[20:23], v[144:147]
    v_mfma_f32_16x16x32_bf16 v[148:151], v[24:27], v[24:27], v[148:151]
    v_mfma_f32_16x16x32_bf16 v[144:147], v[236:239], v[24:27], v[144:147]
    v_mfma_f32_16x16x32_bf16 v[148:151], v[28:31], v[28:31], v[148:151]
    v_mfma_f32_16x16x32_bf16 v[144:147], v[236:239], v[28:31], v[144:147]
    v_mfma_f32_16x16x32_bf16 v[148:151], v[32:35], v[32:35], v[148:151]
    v_mfma_f32_16x16x32_bf16 v[144:147], v[236:239], v[32:35], v[144:147]
    v_mfma_f32_16x16x32_bf16 v[148:151], v[36:39], v[36:39], v[148:151]
    v_mfma_f32_16x16x32_bf16 v[144:147], v[236:239], v[36:39], v[144:147]
    v_mfma_f32_16x16x32_bf16 v[148:151], v[40:43], v[40:43], v[148:151]
    v_mfma_f32_16x16x32_bf16 v[144:147], v[236:239], v[40:43], v[144:147]
    v_mfma_f32_16x16x32_bf16 v[148:151], v[44:47], v[44:47], v[148:151]
    v_mfma_f32_16x16x32_bf16 v[144:147], v[236:239], v[44:47], v[144:147]
    v_mfma_f32_16x16x32_bf16 v[148:151], v[48:51], v[48:51], v[148:151]
    v_mfma_f32_16x16x32_bf16 v[144:147], v[236:239], v[48:51], v[144:147]
    v_mfma_f32_16x16x32_bf16 v[148:151], v[52:55], v[52:55], v[148:151]
    v_mfma_f32_16x16x32_bf16 v[144:147], v[236:239], v[52:55], v[144:147]
    ds_write_b128 v6, v[16:19] offset:0
    ds_write_b128 v6, v[20:23] offset:1024
    ds_write_b128 v6, v[24:27] offset:2048
    ds_write_b128 v6, v[28:31] offset:3072
    ds_write_b128 v6, v[32:35] offset:4096
    ds_write_b128 v6, v[36:39] offset:5120
    ds_write_b128 v6, v[40:43] offset:6144
    ds_write_b128 v6, v[44:47] offset:7168
    ds_write_b128 v6, v[48:51] offset:8192
    ds_write_b128 v6, v[52:55] offset:9216
    v_cndmask_b32 v145, v148, v149, s[48:49]
    v_cndmask_b32 v145, v145, v150, s[50:51]
    v_cndmask_b32 v145, v145, v151, s[54:55]
    ds_write_b64 v12, v[144:145]
    s_waitcnt lgkmcnt(0)
    s_barrier
    s_branch interleave_layers__linear_attn_block__memory_aug_recurrent_mem_tr__prompt_kernel_p_segA
interleave_layers__linear_attn_block__memory_aug_recurrent_mem_tr__prompt_kernel_p_pubA:
    s_waitcnt vmcnt(0)
    s_barrier
    s_cmp_eq_u32 s3, 0
    s_cbranch_scc0 interleave_layers__linear_attn_block__memory_aug_recurrent_mem_tr__prompt_kernel_fp35
    v_mov_b32 v15, s40
    buffer_store_dword v15, v14, s[8:11], 0 offen sc1
interleave_layers__linear_attn_block__memory_aug_recurrent_mem_tr__prompt_kernel_fp35:
interleave_layers__linear_attn_block__memory_aug_recurrent_mem_tr__prompt_kernel_p_segA:
    v_add_u32 v9, s42, v5
    s_xor_b32 s42, s42, 40960
    v_add_u32 v10, s42, v6
    s_and_b32 s24, s40, 1
    s_lshl_b32 s24, s24, 9
    v_add_u32 v124, s24, v13
    s_xor_b32 s24, s24, 512
    v_add_u32 v140, s24, v12
    ds_read_b128 v[112:115], v124
    ds_read_b128 v[116:119], v124 offset:256
    ds_read_b128 v[56:59], v9 offset:0
    ds_read_b128 v[60:63], v9 offset:20480
    ds_read_b128 v[64:67], v9 offset:1024
    ds_read_b128 v[68:71], v9 offset:21504
    ds_read_b128 v[72:75], v9 offset:2048
    ds_read_b128 v[76:79], v9 offset:22528
    ds_read_b128 v[80:83], v9 offset:3072
    ds_read_b128 v[84:87], v9 offset:23552
    s_waitcnt lgkmcnt(6)
    v_mfma_f32_16x16x32_bf16 v[88:91], a[0:3], v[56:59], 0
    v_add_f32 v112, v112, v114
    v_mfma_f32_16x16x32_bf16 v[92:95], a[80:83], v[56:59], 0
    v_add_f32 v113, v113, v115
    v_mfma_f32_16x16x32_bf16 v[96:99], a[160:163], v[56:59], 0
    v_mul_f32 v112, 0x3acccccd, v112
    v_mfma_f32_16x16x32_bf16 v[100:103], a[0:3], v[60:63], 0
    v_mul_f32 v114, v112, v112
    v_mfma_f32_16x16x32_bf16 v[104:107], a[80:83], v[60:63], 0
    v_mov_b32 v115, 0x3acccccd
    v_mfma_f32_16x16x32_bf16 v[108:111], a[160:163], v[60:63], 0
    v_fma_f32 v113, v113, v115, -v114
    ds_read_b128 v[56:59], v9 offset:4096
    ds_read_b128 v[60:63], v9 offset:24576
    s_waitcnt lgkmcnt(6)
    v_mfma_f32_16x16x32_bf16 v[88:91], a[4:7], v[64:67], v[88:91]
    v_max_f32 v113, 0, v113
    v_mfma_f32_16x16x32_bf16 v[92:95], a[84:87], v[64:67], v[92:95]
    v_add_f32 v113, 0x3727c5ac, v113
    v_mfma_f32_16x16x32_bf16 v[96:99], a[164:167], v[64:67], v[96:99]
    v_rsq_f32 v132, v113
    v_mfma_f32_16x16x32_bf16 v[100:103], a[4:7], v[68:71], v[100:103]
    v_mul_f32 v133, v112, v132
    v_mfma_f32_16x16x32_bf16 v[104:107], a[84:87], v[68:71], v[104:107]
    v_sub_f32 v133, 0, v133
    v_mfma_f32_16x16x32_bf16 v[108:111], a[164:167], v[68:71], v[108:111]
    v_add_f32 v116, v116, v118
    ds_read_b128 v[64:67], v9 offset:5120
    ds_read_b128 v[68:71], v9 offset:25600
    s_waitcnt lgkmcnt(6)
    v_mfma_f32_16x16x32_bf16 v[88:91], a[8:11], v[72:75], v[88:91]
    v_add_f32 v117, v117, v119
    v_mfma_f32_16x16x32_bf16 v[92:95], a[88:91], v[72:75], v[92:95]
    v_mul_f32 v116, 0x3acccccd, v116
    v_mfma_f32_16x16x32_bf16 v[96:99], a[168:171], v[72:75], v[96:99]
    v_mul_f32 v118, v116, v116
    v_mfma_f32_16x16x32_bf16 v[100:103], a[8:11], v[76:79], v[100:103]
    v_mov_b32 v119, 0x3acccccd
    v_mfma_f32_16x16x32_bf16 v[104:107], a[88:91], v[76:79], v[104:107]
    v_fma_f32 v117, v117, v119, -v118
    v_mfma_f32_16x16x32_bf16 v[108:111], a[168:171], v[76:79], v[108:111]
    v_max_f32 v117, 0, v117
    ds_read_b128 v[72:75], v9 offset:6144
    ds_read_b128 v[76:79], v9 offset:26624
    s_waitcnt lgkmcnt(6)
    v_mfma_f32_16x16x32_bf16 v[88:91], a[12:15], v[80:83], v[88:91]
    v_add_f32 v117, 0x3727c5ac, v117
    v_mfma_f32_16x16x32_bf16 v[92:95], a[92:95], v[80:83], v[92:95]
    v_rsq_f32 v134, v117
    v_mfma_f32_16x16x32_bf16 v[96:99], a[172:175], v[80:83], v[96:99]
    v_mul_f32 v135, v116, v134
    v_mfma_f32_16x16x32_bf16 v[100:103], a[12:15], v[84:87], v[100:103]
    v_sub_f32 v135, 0, v135
    v_mfma_f32_16x16x32_bf16 v[104:107], a[92:95], v[84:87], v[104:107]
    v_mfma_f32_16x16x32_bf16 v[108:111], a[172:175], v[84:87], v[108:111]
    ds_read_b128 v[80:83], v9 offset:7168
    ds_read_b128 v[84:87], v9 offset:27648
    s_waitcnt lgkmcnt(6)
    v_mfma_f32_16x16x32_bf16 v[88:91], a[16:19], v[56:59], v[88:91]
    v_mfma_f32_16x16x32_bf16 v[92:95], a[96:99], v[56:59], v[92:95]
    v_mfma_f32_16x16x32_bf16 v[96:99], a[176:179], v[56:59], v[96:99]
    v_mfma_f32_16x16x32_bf16 v[100:103], a[16:19], v[60:63], v[100:103]
    v_mfma_f32_16x16x32_bf16 v[104:107], a[96:99], v[60:63], v[104:107]
    v_mfma_f32_16x16x32_bf16 v[108:111], a[176:179], v[60:63], v[108:111]
    buffer_load_dword v152, v4, s[8:11], 0 offen sc1
    ds_read_b128 v[56:59], v9 offset:8192
    ds_read_b128 v[60:63], v9 offset:28672
    s_waitcnt lgkmcnt(6)
    v_mfma_f32_16x16x32_bf16 v[88:91], a[20:23], v[64:67], v[88:91]
    v_mfma_f32_16x16x32_bf16 v[92:95], a[100:103], v[64:67], v[92:95]
    v_mfma_f32_16x16x32_bf16 v[96:99], a[180:183], v[64:67], v[96:99]
    v_mfma_f32_16x16x32_bf16 v[100:103], a[20:23], v[68:71], v[100:103]
    v_mfma_f32_16x16x32_bf16 v[104:107], a[100:103], v[68:71], v[104:107]
    v_mfma_f32_16x16x32_bf16 v[108:111], a[180:183], v[68:71], v[108:111]
    ds_read_b128 v[64:67], v9 offset:9216
    ds_read_b128 v[68:71], v9 offset:29696
    s_waitcnt lgkmcnt(6)
    v_mfma_f32_16x16x32_bf16 v[88:91], a[24:27], v[72:75], v[88:91]
    v_mfma_f32_16x16x32_bf16 v[92:95], a[104:107], v[72:75], v[92:95]
    v_mfma_f32_16x16x32_bf16 v[96:99], a[184:187], v[72:75], v[96:99]
    v_mfma_f32_16x16x32_bf16 v[100:103], a[24:27], v[76:79], v[100:103]
    v_mfma_f32_16x16x32_bf16 v[104:107], a[104:107], v[76:79], v[104:107]
    v_mfma_f32_16x16x32_bf16 v[108:111], a[184:187], v[76:79], v[108:111]
    ds_read_b128 v[72:75], v9 offset:10240
    ds_read_b128 v[76:79], v9 offset:30720
    s_waitcnt lgkmcnt(6)
    v_mfma_f32_16x16x32_bf16 v[88:91], a[28:31], v[80:83], v[88:91]
    v_mfma_f32_16x16x32_bf16 v[92:95], a[108:111], v[80:83], v[92:95]
    v_mfma_f32_16x16x32_bf16 v[96:99], a[188:191], v[80:83], v[96:99]
    v_mfma_f32_16x16x32_bf16 v[100:103], a[28:31], v[84:87], v[100:103]
    v_mfma_f32_16x16x32_bf16 v[104:107], a[108:111], v[84:87], v[104:107]
    v_mfma_f32_16x16x32_bf16 v[108:111], a[188:191], v[84:87], v[108:111]
    ds_read_b128 v[80:83], v9 offset:11264
    ds_read_b128 v[84:87], v9 offset:31744
    s_waitcnt lgkmcnt(6)
    v_mfma_f32_16x16x32_bf16 v[88:91], a[32:35], v[56:59], v[88:91]
    v_mfma_f32_16x16x32_bf16 v[92:95], a[112:115], v[56:59], v[92:95]
    v_mfma_f32_16x16x32_bf16 v[96:99], a[192:195], v[56:59], v[96:99]
    v_mfma_f32_16x16x32_bf16 v[100:103], a[32:35], v[60:63], v[100:103]
    v_mfma_f32_16x16x32_bf16 v[104:107], a[112:115], v[60:63], v[104:107]
    v_mfma_f32_16x16x32_bf16 v[108:111], a[192:195], v[60:63], v[108:111]
    ds_read_b128 v[56:59], v9 offset:12288
    ds_read_b128 v[60:63], v9 offset:32768
    s_waitcnt lgkmcnt(6)
    v_mfma_f32_16x16x32_bf16 v[88:91], a[36:39], v[64:67], v[88:91]
    v_mfma_f32_16x16x32_bf16 v[92:95], a[116:119], v[64:67], v[92:95]
    v_mfma_f32_16x16x32_bf16 v[96:99], a[196:199], v[64:67], v[96:99]
    v_mfma_f32_16x16x32_bf16 v[100:103], a[36:39], v[68:71], v[100:103]
    v_mfma_f32_16x16x32_bf16 v[104:107], a[116:119], v[68:71], v[104:107]
    v_mfma_f32_16x16x32_bf16 v[108:111], a[196:199], v[68:71], v[108:111]
    ds_read_b128 v[64:67], v9 offset:13312
    ds_read_b128 v[68:71], v9 offset:33792
    s_waitcnt lgkmcnt(6)
    v_mfma_f32_16x16x32_bf16 v[88:91], a[40:43], v[72:75], v[88:91]
    v_mfma_f32_16x16x32_bf16 v[92:95], a[120:123], v[72:75], v[92:95]
    v_mfma_f32_16x16x32_bf16 v[96:99], a[200:203], v[72:75], v[96:99]
    v_mfma_f32_16x16x32_bf16 v[100:103], a[40:43], v[76:79], v[100:103]
    v_mfma_f32_16x16x32_bf16 v[104:107], a[120:123], v[76:79], v[104:107]
    v_mfma_f32_16x16x32_bf16 v[108:111], a[200:203], v[76:79], v[108:111]
    ds_read_b128 v[72:75], v9 offset:14336
    ds_read_b128 v[76:79], v9 offset:34816
    s_waitcnt lgkmcnt(6)
    v_mfma_f32_16x16x32_bf16 v[88:91], a[44:47], v[80:83], v[88:91]
    v_mfma_f32_16x16x32_bf16 v[92:95], a[124:127], v[80:83], v[92:95]
    v_mfma_f32_16x16x32_bf16 v[96:99], a[204:207], v[80:83], v[96:99]
    v_mfma_f32_16x16x32_bf16 v[100:103], a[44:47], v[84:87], v[100:103]
    v_mfma_f32_16x16x32_bf16 v[104:107], a[124:127], v[84:87], v[104:107]
    v_mfma_f32_16x16x32_bf16 v[108:111], a[204:207], v[84:87], v[108:111]
    ds_read_b128 v[80:83], v9 offset:15360
    ds_read_b128 v[84:87], v9 offset:35840
    s_waitcnt lgkmcnt(6)
    v_mfma_f32_16x16x32_bf16 v[88:91], a[48:51], v[56:59], v[88:91]
    v_mfma_f32_16x16x32_bf16 v[92:95], a[128:131], v[56:59], v[92:95]
    v_mfma_f32_16x16x32_bf16 v[96:99], a[208:211], v[56:59], v[96:99]
    v_mfma_f32_16x16x32_bf16 v[100:103], a[48:51], v[60:63], v[100:103]
    v_mfma_f32_16x16x32_bf16 v[104:107], a[128:131], v[60:63], v[104:107]
    v_mfma_f32_16x16x32_bf16 v[108:111], a[208:211], v[60:63], v[108:111]
    ds_read_b128 v[56:59], v9 offset:16384
    ds_read_b128 v[60:63], v9 offset:36864
    s_waitcnt lgkmcnt(6)
    v_mfma_f32_16x16x32_bf16 v[88:91], a[52:55], v[64:67], v[88:91]
    v_mfma_f32_16x16x32_bf16 v[92:95], a[132:135], v[64:67], v[92:95]
    v_mfma_f32_16x16x32_bf16 v[96:99], a[212:215], v[64:67], v[96:99]
    v_mfma_f32_16x16x32_bf16 v[100:103], a[52:55], v[68:71], v[100:103]
    v_mfma_f32_16x16x32_bf16 v[104:107], a[132:135], v[68:71], v[104:107]
    v_mfma_f32_16x16x32_bf16 v[108:111], a[212:215], v[68:71], v[108:111]
    ds_read_b128 v[64:67], v9 offset:17408
    ds_read_b128 v[68:71], v9 offset:37888
    s_waitcnt lgkmcnt(6)
    v_mfma_f32_16x16x32_bf16 v[88:91], a[56:59], v[72:75], v[88:91]
    v_mfma_f32_16x16x32_bf16 v[92:95], a[136:139], v[72:75], v[92:95]
    v_mfma_f32_16x16x32_bf16 v[96:99], a[216:219], v[72:75], v[96:99]
    v_mfma_f32_16x16x32_bf16 v[100:103], a[56:59], v[76:79], v[100:103]
    v_mfma_f32_16x16x32_bf16 v[104:107], a[136:139], v[76:79], v[104:107]
    v_mfma_f32_16x16x32_bf16 v[108:111], a[216:219], v[76:79], v[108:111]
    ds_read_b128 v[72:75], v9 offset:18432
    ds_read_b128 v[76:79], v9 offset:38912
    s_waitcnt lgkmcnt(6)
    v_mfma_f32_16x16x32_bf16 v[88:91], a[60:63], v[80:83], v[88:91]
    v_mfma_f32_16x16x32_bf16 v[92:95], a[140:143], v[80:83], v[92:95]
    v_mfma_f32_16x16x32_bf16 v[96:99], a[220:223], v[80:83], v[96:99]
    v_mfma_f32_16x16x32_bf16 v[100:103], a[60:63], v[84:87], v[100:103]
    v_mfma_f32_16x16x32_bf16 v[104:107], a[140:143], v[84:87], v[104:107]
    v_mfma_f32_16x16x32_bf16 v[108:111], a[220:223], v[84:87], v[108:111]
    ds_read_b128 v[80:83], v9 offset:19456
    ds_read_b128 v[84:87], v9 offset:39936
    s_waitcnt lgkmcnt(6)
    v_mfma_f32_16x16x32_bf16 v[88:91], a[64:67], v[56:59], v[88:91]
    v_mfma_f32_16x16x32_bf16 v[92:95], a[144:147], v[56:59], v[92:95]
    v_mfma_f32_16x16x32_bf16 v[96:99], a[224:227], v[56:59], v[96:99]
    v_mfma_f32_16x16x32_bf16 v[100:103], a[64:67], v[60:63], v[100:103]
    v_mfma_f32_16x16x32_bf16 v[104:107], a[144:147], v[60:63], v[104:107]
    v_mfma_f32_16x16x32_bf16 v[108:111], a[224:227], v[60:63], v[108:111]
    s_waitcnt lgkmcnt(4)
    v_mfma_f32_16x16x32_bf16 v[88:91], a[68:71], v[64:67], v[88:91]
    v_mfma_f32_16x16x32_bf16 v[92:95], a[148:151], v[64:67], v[92:95]
    v_mfma_f32_16x16x32_bf16 v[96:99], a[228:231], v[64:67], v[96:99]
    v_mfma_f32_16x16x32_bf16 v[100:103], a[68:71], v[68:71], v[100:103]
    v_mfma_f32_16x16x32_bf16 v[104:107], a[148:151], v[68:71], v[104:107]
    v_mfma_f32_16x16x32_bf16 v[108:111], a[228:231], v[68:71], v[108:111]
    s_waitcnt lgkmcnt(2)
    v_mfma_f32_16x16x32_bf16 v[88:91], a[72:75], v[72:75], v[88:91]
    v_mfma_f32_16x16x32_bf16 v[92:95], a[152:155], v[72:75], v[92:95]
    v_mfma_f32_16x16x32_bf16 v[96:99], a[232:235], v[72:75], v[96:99]
    v_mfma_f32_16x16x32_bf16 v[100:103], a[72:75], v[76:79], v[100:103]
    v_mfma_f32_16x16x32_bf16 v[104:107], a[152:155], v[76:79], v[104:107]
    v_mfma_f32_16x16x32_bf16 v[108:111], a[232:235], v[76:79], v[108:111]
    s_waitcnt lgkmcnt(0)
    v_mfma_f32_16x16x32_bf16 v[88:91], a[76:79], v[80:83], v[88:91]
    v_mfma_f32_16x16x32_bf16 v[92:95], a[156:159], v[80:83], v[92:95]
    v_mfma_f32_16x16x32_bf16 v[96:99], a[236:239], v[80:83], v[96:99]
    v_mfma_f32_16x16x32_bf16 v[100:103], a[76:79], v[84:87], v[100:103]
    v_mfma_f32_16x16x32_bf16 v[104:107], a[156:159], v[84:87], v[104:107]
    v_mfma_f32_16x16x32_bf16 v[108:111], a[236:239], v[84:87], v[108:111]
    v_pk_mul_f32 v[124:125], v[224:225], v[132:133] op_sel:[0,1] op_sel_hi:[1,1]
    v_pk_mul_f32 v[126:127], v[226:227], v[132:133] op_sel:[0,1] op_sel_hi:[1,1]
    s_nop 0
    v_pk_fma_f32 v[88:89], v[88:89], v[132:133], v[124:125] op_sel:[0,0,0] op_sel_hi:[1,0,1]
    v_pk_fma_f32 v[90:91], v[90:91], v[132:133], v[126:127] op_sel:[0,0,0] op_sel_hi:[1,0,1]
    v_pk_mul_f32 v[124:125], v[228:229], v[132:133] op_sel:[0,1] op_sel_hi:[1,1]
    v_pk_mul_f32 v[126:127], v[230:231], v[132:133] op_sel:[0,1] op_sel_hi:[1,1]
    v_pk_fma_f32 v[92:93], v[92:93], v[132:133], v[124:125] op_sel:[0,0,0] op_sel_hi:[1,0,1]
    v_pk_fma_f32 v[94:95], v[94:95], v[132:133], v[126:127] op_sel:[0,0,0] op_sel_hi:[1,0,1]
    v_pk_mul_f32 v[124:125], v[232:233], v[132:133] op_sel:[0,1] op_sel_hi:[1,1]
    v_pk_mul_f32 v[126:127], v[234:235], v[132:133] op_sel:[0,1] op_sel_hi:[1,1]
    v_pk_fma_f32 v[96:97], v[96:97], v[132:133], v[124:125] op_sel:[0,0,0] op_sel_hi:[1,0,1]
    v_pk_fma_f32 v[98:99], v[98:99], v[132:133], v[126:127] op_sel:[0,0,0] op_sel_hi:[1,0,1]
    v_pk_mul_f32 v[124:125], v[224:225], v[134:135] op_sel:[0,1] op_sel_hi:[1,1]
    v_pk_mul_f32 v[126:127], v[226:227], v[134:135] op_sel:[0,1] op_sel_hi:[1,1]
    v_pk_fma_f32 v[100:101], v[100:101], v[134:135], v[124:125] op_sel:[0,0,0] op_sel_hi:[1,0,1]
    v_pk_fma_f32 v[102:103], v[102:103], v[134:135], v[126:127] op_sel:[0,0,0] op_sel_hi:[1,0,1]
    v_pk_mul_f32 v[124:125], v[228:229], v[134:135] op_sel:[0,1] op_sel_hi:[1,1]
    v_pk_mul_f32 v[126:127], v[230:231], v[134:135] op_sel:[0,1] op_sel_hi:[1,1]
    v_pk_fma_f32 v[104:105], v[104:105], v[134:135], v[124:125] op_sel:[0,0,0] op_sel_hi:[1,0,1]
    v_pk_fma_f32 v[106:107], v[106:107], v[134:135], v[126:127] op_sel:[0,0,0] op_sel_hi:[1,0,1]
    v_pk_mul_f32 v[124:125], v[232:233], v[134:135] op_sel:[0,1] op_sel_hi:[1,1]
    v_pk_mul_f32 v[126:127], v[234:235], v[134:135] op_sel:[0,1] op_sel_hi:[1,1]
    v_pk_fma_f32 v[108:109], v[108:109], v[134:135], v[124:125] op_sel:[0,0,0] op_sel_hi:[1,0,1]
    v_pk_fma_f32 v[110:111], v[110:111], v[134:135], v[126:127] op_sel:[0,0,0] op_sel_hi:[1,0,1]
    v_cvt_pk_bf16_f32 v112, v88, v89
    v_cvt_pk_bf16_f32 v113, v90, v91
    v_cvt_pk_bf16_f32 v114, v92, v93
    v_cvt_pk_bf16_f32 v115, v94, v95
    v_cvt_pk_bf16_f32 v116, v100, v101
    v_cvt_pk_bf16_f32 v117, v102, v103
    v_cvt_pk_bf16_f32 v118, v104, v105
    v_cvt_pk_bf16_f32 v119, v106, v107
    v_cvt_pk_bf16_f32 v120, v96, v97
    v_cvt_pk_bf16_f32 v121, v98, v99
    v_cvt_pk_bf16_f32 v122, v108, v109
    v_cvt_pk_bf16_f32 v123, v110, v111
    buffer_store_dwordx4 v[112:115], v11, s[8:11], s43 offen offset:0 sc1
    buffer_store_dwordx4 v[116:119], v11, s[8:11], s43 offen offset:1024 sc1
    buffer_store_dwordx4 v[120:123], v11, s[8:11], s43 offen offset:2048 sc1
    s_add_u32 s43, s43, 393216
    s_waitcnt vmcnt(3)
    s_add_u32 s63, s40, 1
    s_lshr_b32 s63, s63, s75
    s_add_u32 s63, s63, 1
    s_min_u32 s63, s63, s74
    v_cmp_le_i32 vcc, s63, v152
    s_cmp_eq_u64 vcc, -1
    s_cselect_b32 s24, 1, 0
    s_cmp_ge_i32 s62, s63
    s_cselect_b32 s24, 1, s24
    s_cmp_eq_u32 s24, 1
    s_cbranch_scc0 interleave_layers__linear_attn_block__memory_aug_recurrent_mem_tr__prompt_kernel_po37
    s_max_i32 s62, s62, s63
    s_add_u32 s41, s41, 40960
    buffer_load_dwordx4 v[16:19], v6, s[8:11], s41 offen offset:0
    buffer_load_dwordx4 v[20:23], v6, s[8:11], s41 offen offset:1024
    buffer_load_dwordx4 v[24:27], v6, s[8:11], s41 offen offset:2048
    buffer_load_dwordx4 v[28:31], v6, s[8:11], s41 offen offset:3072
    buffer_load_dwordx4 v[32:35], v7, s[8:11], s41 offen offset:0
    buffer_load_dwordx4 v[36:39], v7, s[8:11], s41 offen offset:1024
    buffer_load_dwordx4 v[40:43], v7, s[8:11], s41 offen offset:2048
    buffer_load_dwordx4 v[44:47], v7, s[8:11], s41 offen offset:3072
    buffer_load_dwordx4 v[48:51], v8, s[8:11], s41 offen offset:0
    buffer_load_dwordx4 v[52:55], v8, s[8:11], s41 offen offset:1024
    buffer_load_dword v152, v4, s[8:11], 0 offen sc1
    s_waitcnt vmcnt(11)
    s_barrier
    s_add_u32 s24, s40, 1
    v_mov_b32 v15, s24
    buffer_store_dword v15, v14, s[8:11], 0 offen sc1
    s_branch interleave_layers__linear_attn_block__memory_aug_recurrent_mem_tr__prompt_kernel_po36
interleave_layers__linear_attn_block__memory_aug_recurrent_mem_tr__prompt_kernel_po37:
    s_waitcnt vmcnt(0)
    s_barrier
    s_add_u32 s24, s40, 1
    v_mov_b32 v15, s24
    buffer_store_dword v15, v14, s[8:11], 0 offen sc1
    s_add_u32 s63, s40, 1
    s_lshr_b32 s63, s63, s75
    s_add_u32 s63, s63, 1
    s_min_u32 s63, s63, s74
    s_cmp_ge_i32 s62, s63
    s_cbranch_scc1 interleave_layers__linear_attn_block__memory_aug_recurrent_mem_tr__prompt_kernel_p_enA_ok
    s_mov_b32 s61, 0
interleave_layers__linear_attn_block__memory_aug_recurrent_mem_tr__prompt_kernel_p_enA:
    buffer_load_dword v16, v4, s[8:11], 0 offen sc1
    s_waitcnt vmcnt(0)
    v_readlane_b32 s62, v16, 0
    v_readlane_b32 s24, v16, 1
    s_min_i32 s62, s62, s24
    v_readlane_b32 s24, v16, 2
    s_min_i32 s62, s62, s24
    v_readlane_b32 s24, v16, 3
    s_min_i32 s62, s62, s24
    v_readlane_b32 s24, v16, 4
    s_min_i32 s62, s62, s24
    v_readlane_b32 s24, v16, 5
    s_min_i32 s62, s62, s24
    v_readlane_b32 s24, v16, 6
    s_min_i32 s62, s62, s24
    v_readlane_b32 s24, v16, 7
    s_min_i32 s62, s62, s24
    v_readlane_b32 s24, v16, 8
    s_min_i32 s62, s62, s24
    v_readlane_b32 s24, v16, 9
    s_min_i32 s62, s62, s24
    v_readlane_b32 s24, v16, 10
    s_min_i32 s62, s62, s24
    v_readlane_b32 s24, v16, 11
    s_min_i32 s62, s62, s24
    v_readlane_b32 s24, v16, 12
    s_min_i32 s62, s62, s24
    v_readlane_b32 s24, v16, 13
    s_min_i32 s62, s62, s24
    v_readlane_b32 s24, v16, 14
    s_min_i32 s62, s62, s24
    v_readlane_b32 s24, v16, 15
    s_min_i32 s62, s62, s24
    v_readlane_b32 s24, v16, 16
    s_min_i32 s62, s62, s24
    v_readlane_b32 s24, v16, 17
    s_min_i32 s62, s62, s24
    v_readlane_b32 s24, v16, 18
    s_min_i32 s62, s62, s24
    v_readlane_b32 s24, v16, 19
    s_min_i32 s62, s62, s24
    s_cmp_ge_i32 s62, s63
    s_cbranch_scc1 interleave_layers__linear_attn_block__memory_aug_recurrent_mem_tr__prompt_kernel_p_enA_ok
    s_add_u32 s61, s61, 1
    s_cmp_ge_u32 s61, s60
    s_cbranch_scc1 interleave_layers__linear_attn_block__memory_aug_recurrent_mem_tr__prompt_kernel_p_enA_to
    s_sleep 2
    s_branch interleave_layers__linear_attn_block__memory_aug_recurrent_mem_tr__prompt_kernel_p_enA
interleave_layers__linear_attn_block__memory_aug_recurrent_mem_tr__prompt_kernel_p_enA_to:
    s_mov_b32 s60, 1
interleave_layers__linear_attn_block__memory_aug_recurrent_mem_tr__prompt_kernel_p_enA_ok:
    s_add_u32 s41, s41, 40960
    buffer_load_dwordx4 v[16:19], v6, s[8:11], s41 offen offset:0
    buffer_load_dwordx4 v[20:23], v6, s[8:11], s41 offen offset:1024
    buffer_load_dwordx4 v[24:27], v6, s[8:11], s41 offen offset:2048
    buffer_load_dwordx4 v[28:31], v6, s[8:11], s41 offen offset:3072
    buffer_load_dwordx4 v[32:35], v7, s[8:11], s41 offen offset:0
    buffer_load_dwordx4 v[36:39], v7, s[8:11], s41 offen offset:1024
    buffer_load_dwordx4 v[40:43], v7, s[8:11], s41 offen offset:2048
    buffer_load_dwordx4 v[44:47], v7, s[8:11], s41 offen offset:3072
    buffer_load_dwordx4 v[48:51], v8, s[8:11], s41 offen offset:0
    buffer_load_dwordx4 v[52:55], v8, s[8:11], s41 offen offset:1024
    buffer_load_dword v152, v4, s[8:11], 0 offen sc1
interleave_layers__linear_attn_block__memory_aug_recurrent_mem_tr__prompt_kernel_po36:
    s_waitcnt vmcnt(0)
    v_mfma_f32_16x16x32_bf16 v[148:151], v[16:19], v[16:19], 0
    v_mfma_f32_16x16x32_bf16 v[144:147], v[236:239], v[16:19], 0
    v_mfma_f32_16x16x32_bf16 v[148:151], v[20:23], v[20:23], v[148:151]
    v_mfma_f32_16x16x32_bf16 v[144:147], v[236:239], v[20:23], v[144:147]
    v_mfma_f32_16x16x32_bf16 v[148:151], v[24:27], v[24:27], v[148:151]
    v_mfma_f32_16x16x32_bf16 v[144:147], v[236:239], v[24:27], v[144:147]
    v_mfma_f32_16x16x32_bf16 v[148:151], v[28:31], v[28:31], v[148:151]
    v_mfma_f32_16x16x32_bf16 v[144:147], v[236:239], v[28:31], v[144:147]
    v_mfma_f32_16x16x32_bf16 v[148:151], v[32:35], v[32:35], v[148:151]
    v_mfma_f32_16x16x32_bf16 v[144:147], v[236:239], v[32:35], v[144:147]
    v_mfma_f32_16x16x32_bf16 v[148:151], v[36:39], v[36:39], v[148:151]
    v_mfma_f32_16x16x32_bf16 v[144:147], v[236:239], v[36:39], v[144:147]
    v_mfma_f32_16x16x32_bf16 v[148:151], v[40:43], v[40:43], v[148:151]
    v_mfma_f32_16x16x32_bf16 v[144:147], v[236:239], v[40:43], v[144:147]
    v_mfma_f32_16x16x32_bf16 v[148:151], v[44:47], v[44:47], v[148:151]
    v_mfma_f32_16x16x32_bf16 v[144:147], v[236:239], v[44:47], v[144:147]
    v_mfma_f32_16x16x32_bf16 v[148:151], v[48:51], v[48:51], v[148:151]
    v_mfma_f32_16x16x32_bf16 v[144:147], v[236:239], v[48:51], v[144:147]
    v_mfma_f32_16x16x32_bf16 v[148:151], v[52:55], v[52:55], v[148:151]
    v_mfma_f32_16x16x32_bf16 v[144:147], v[236:239], v[52:55], v[144:147]
    ds_write_b128 v10, v[16:19] offset:0
    ds_write_b128 v10, v[20:23] offset:1024
    ds_write_b128 v10, v[24:27] offset:2048
    ds_write_b128 v10, v[28:31] offset:3072
    ds_write_b128 v10, v[32:35] offset:4096
    ds_write_b128 v10, v[36:39] offset:5120
    ds_write_b128 v10, v[40:43] offset:6144
    ds_write_b128 v10, v[44:47] offset:7168
    ds_write_b128 v10, v[48:51] offset:8192
    ds_write_b128 v10, v[52:55] offset:9216
    v_cndmask_b32 v145, v148, v149, s[48:49]
    v_cndmask_b32 v145, v145, v150, s[50:51]
    v_cndmask_b32 v145, v145, v151, s[54:55]
    ds_write_b64 v140, v[144:145]
    s_add_u32 s40, s40, 1
    s_add_u32 s63, s40, 1
    s_lshr_b32 s63, s63, s75
    s_add_u32 s63, s63, 1
    s_min_u32 s63, s63, s74
    v_cmp_le_i32 vcc, s63, v152
    s_cmp_eq_u64 vcc, -1
    s_cselect_b32 s58, 1, 0
    s_cmp_ge_i32 s62, s63
    s_cselect_b32 s58, 1, s58
    s_and_b32 s24, s40, 1
    s_lshl_b32 s24, s24, 2
    s_add_u32 s24, s24, 83456
    s_lshl_b32 s25, s3, 4
    s_add_u32 s25, s25, s24
    v_mov_b32 v15, s25
    v_mov_b32 v152, s58
    ds_write_b32 v15, v152
    v_mov_b32 v15, s24
    s_waitcnt lgkmcnt(0)
    s_barrier
    ds_read_b32 v152, v15
    s_waitcnt lgkmcnt(0)
    v_readfirstlane_b32 s58, v152
    s_cmp_eq_u32 s58, 1
    s_cselect_b32 s24, s63, s62
    s_max_i32 s62, s62, s24
    s_branch interleave_layers__linear_attn_block__memory_aug_recurrent_mem_tr__prompt_kernel_p_next
interleave_layers__linear_attn_block__memory_aug_recurrent_mem_tr__prompt_kernel_p_seg:
    v_add_u32 v9, s42, v5
    s_xor_b32 s42, s42, 40960
    v_add_u32 v10, s42, v6
    s_add_u32 s63, s40, 1
    s_lshr_b32 s63, s63, s75
    s_add_u32 s63, s63, 1
    s_min_u32 s63, s63, s74
    s_cmp_ge_i32 s62, s63
    s_cbranch_scc1 interleave_layers__linear_attn_block__memory_aug_recurrent_mem_tr__prompt_kernel_p_en_ok
    s_mov_b32 s61, 0
interleave_layers__linear_attn_block__memory_aug_recurrent_mem_tr__prompt_kernel_p_en:
    buffer_load_dword v16, v4, s[8:11], 0 offen sc1
    s_waitcnt vmcnt(0)
    v_readlane_b32 s62, v16, 0
    v_readlane_b32 s24, v16, 1
    s_min_i32 s62, s62, s24
    v_readlane_b32 s24, v16, 2
    s_min_i32 s62, s62, s24
    v_readlane_b32 s24, v16, 3
    s_min_i32 s62, s62, s24
    v_readlane_b32 s24, v16, 4
    s_min_i32 s62, s62, s24
    v_readlane_b32 s24, v16, 5
    s_min_i32 s62, s62, s24
    v_readlane_b32 s24, v16, 6
    s_min_i32 s62, s62, s24
    v_readlane_b32 s24, v16, 7
    s_min_i32 s62, s62, s24
    v_readlane_b32 s24, v16, 8
    s_min_i32 s62, s62, s24
    v_readlane_b32 s24, v16, 9
    s_min_i32 s62, s62, s24
    v_readlane_b32 s24, v16, 10
    s_min_i32 s62, s62, s24
    v_readlane_b32 s24, v16, 11
    s_min_i32 s62, s62, s24
    v_readlane_b32 s24, v16, 12
    s_min_i32 s62, s62, s24
    v_readlane_b32 s24, v16, 13
    s_min_i32 s62, s62, s24
    v_readlane_b32 s24, v16, 14
    s_min_i32 s62, s62, s24
    v_readlane_b32 s24, v16, 15
    s_min_i32 s62, s62, s24
    v_readlane_b32 s24, v16, 16
    s_min_i32 s62, s62, s24
    v_readlane_b32 s24, v16, 17
    s_min_i32 s62, s62, s24
    v_readlane_b32 s24, v16, 18
    s_min_i32 s62, s62, s24
    v_readlane_b32 s24, v16, 19
    s_min_i32 s62, s62, s24
    s_cmp_ge_i32 s62, s63
    s_cbranch_scc1 interleave_layers__linear_attn_block__memory_aug_recurrent_mem_tr__prompt_kernel_p_en_ok
    s_add_u32 s61, s61, 1
    s_cmp_ge_u32 s61, s60
    s_cbranch_scc1 interleave_layers__linear_attn_block__memory_aug_recurrent_mem_tr__prompt_kernel_p_en_to
    s_sleep 2
    s_branch interleave_layers__linear_attn_block__memory_aug_recurrent_mem_tr__prompt_kernel_p_en
interleave_layers__linear_attn_block__memory_aug_recurrent_mem_tr__prompt_kernel_p_en_to:
    s_mov_b32 s60, 1
interleave_layers__linear_attn_block__memory_aug_recurrent_mem_tr__prompt_kernel_p_en_ok:
    s_add_u32 s41, s41, 40960
    buffer_load_dwordx4 v[16:19], v6, s[8:11], s41 offen offset:0
    buffer_load_dwordx4 v[20:23], v6, s[8:11], s41 offen offset:1024
    buffer_load_dwordx4 v[24:27], v6, s[8:11], s41 offen offset:2048
    buffer_load_dwordx4 v[28:31], v6, s[8:11], s41 offen offset:3072
    buffer_load_dwordx4 v[32:35], v7, s[8:11], s41 offen offset:0
    buffer_load_dwordx4 v[36:39], v7, s[8:11], s41 offen offset:1024
    buffer_load_dwordx4 v[40:43], v7, s[8:11], s41 offen offset:2048
    buffer_load_dwordx4 v[44:47], v7, s[8:11], s41 offen offset:3072
    buffer_load_dwordx4 v[48:51], v8, s[8:11], s41 offen offset:0
    buffer_load_dwordx4 v[52:55], v8, s[8:11], s41 offen offset:1024
    s_and_b32 s24, s40, 1
    s_lshl_b32 s24, s24, 9
    v_add_u32 v124, s24, v13
    s_xor_b32 s24, s24, 512
    v_add_u32 v140, s24, v12
    ds_read_b128 v[112:115], v124
    ds_read_b128 v[116:119], v124 offset:256
    ds_read_b128 v[56:59], v9 offset:0
    ds_read_b128 v[60:63], v9 offset:20480
    ds_read_b128 v[64:67], v9 offset:1024
    ds_read_b128 v[68:71], v9 offset:21504
    ds_read_b128 v[72:75], v9 offset:2048
    ds_read_b128 v[76:79], v9 offset:22528
    ds_read_b128 v[80:83], v9 offset:3072
    ds_read_b128 v[84:87], v9 offset:23552
    s_waitcnt lgkmcnt(6)
    v_mfma_f32_16x16x32_bf16 v[88:91], a[0:3], v[56:59], 0
    v_add_f32 v112, v112, v114
    v_mfma_f32_16x16x32_bf16 v[92:95], a[80:83], v[56:59], 0
    v_add_f32 v113, v113, v115
    v_mfma_f32_16x16x32_bf16 v[96:99], a[160:163], v[56:59], 0
    v_mul_f32 v112, 0x3acccccd, v112
    v_mfma_f32_16x16x32_bf16 v[100:103], a[0:3], v[60:63], 0
    v_mul_f32 v114, v112, v112
    v_mfma_f32_16x16x32_bf16 v[104:107], a[80:83], v[60:63], 0
    v_mov_b32 v115, 0x3acccccd
    v_mfma_f32_16x16x32_bf16 v[108:111], a[160:163], v[60:63], 0
    v_fma_f32 v113, v113, v115, -v114
    ds_read_b128 v[56:59], v9 offset:4096
    ds_read_b128 v[60:63], v9 offset:24576
    s_waitcnt lgkmcnt(6)
    v_mfma_f32_16x16x32_bf16 v[88:91], a[4:7], v[64:67], v[88:91]
    v_max_f32 v113, 0, v113
    v_mfma_f32_16x16x32_bf16 v[92:95], a[84:87], v[64:67], v[92:95]
    v_add_f32 v113, 0x3727c5ac, v113
    v_mfma_f32_16x16x32_bf16 v[96:99], a[164:167], v[64:67], v[96:99]
    v_rsq_f32 v132, v113
    v_mfma_f32_16x16x32_bf16 v[100:103], a[4:7], v[68:71], v[100:103]
    v_mul_f32 v133, v112, v132
    v_mfma_f32_16x16x32_bf16 v[104:107], a[84:87], v[68:71], v[104:107]
    v_sub_f32 v133, 0, v133
    v_mfma_f32_16x16x32_bf16 v[108:111], a[164:167], v[68:71], v[108:111]
    v_add_f32 v116, v116, v118
    ds_read_b128 v[64:67], v9 offset:5120
    ds_read_b128 v[68:71], v9 offset:25600
    s_waitcnt lgkmcnt(6)
    v_mfma_f32_16x16x32_bf16 v[88:91], a[8:11], v[72:75], v[88:91]
    v_add_f32 v117, v117, v119
    v_mfma_f32_16x16x32_bf16 v[92:95], a[88:91], v[72:75], v[92:95]
    v_mul_f32 v116, 0x3acccccd, v116
    v_mfma_f32_16x16x32_bf16 v[96:99], a[168:171], v[72:75], v[96:99]
    v_mul_f32 v118, v116, v116
    v_mfma_f32_16x16x32_bf16 v[100:103], a[8:11], v[76:79], v[100:103]
    v_mov_b32 v119, 0x3acccccd
    v_mfma_f32_16x16x32_bf16 v[104:107], a[88:91], v[76:79], v[104:107]
    v_fma_f32 v117, v117, v119, -v118
    v_mfma_f32_16x16x32_bf16 v[108:111], a[168:171], v[76:79], v[108:111]
    v_max_f32 v117, 0, v117
    ds_read_b128 v[72:75], v9 offset:6144
    ds_read_b128 v[76:79], v9 offset:26624
    s_waitcnt lgkmcnt(6)
    v_mfma_f32_16x16x32_bf16 v[88:91], a[12:15], v[80:83], v[88:91]
    v_add_f32 v117, 0x3727c5ac, v117
    v_mfma_f32_16x16x32_bf16 v[92:95], a[92:95], v[80:83], v[92:95]
    v_rsq_f32 v134, v117
    v_mfma_f32_16x16x32_bf16 v[96:99], a[172:175], v[80:83], v[96:99]
    v_mul_f32 v135, v116, v134
    v_mfma_f32_16x16x32_bf16 v[100:103], a[12:15], v[84:87], v[100:103]
    v_sub_f32 v135, 0, v135
    v_mfma_f32_16x16x32_bf16 v[104:107], a[92:95], v[84:87], v[104:107]
    v_mfma_f32_16x16x32_bf16 v[108:111], a[172:175], v[84:87], v[108:111]
    ds_read_b128 v[80:83], v9 offset:7168
    ds_read_b128 v[84:87], v9 offset:27648
    s_waitcnt lgkmcnt(6)
    v_mfma_f32_16x16x32_bf16 v[88:91], a[16:19], v[56:59], v[88:91]
    v_mfma_f32_16x16x32_bf16 v[92:95], a[96:99], v[56:59], v[92:95]
    v_mfma_f32_16x16x32_bf16 v[96:99], a[176:179], v[56:59], v[96:99]
    v_mfma_f32_16x16x32_bf16 v[100:103], a[16:19], v[60:63], v[100:103]
    v_mfma_f32_16x16x32_bf16 v[104:107], a[96:99], v[60:63], v[104:107]
    v_mfma_f32_16x16x32_bf16 v[108:111], a[176:179], v[60:63], v[108:111]
    ds_read_b128 v[56:59], v9 offset:8192
    ds_read_b128 v[60:63], v9 offset:28672
    s_waitcnt lgkmcnt(6)
    v_mfma_f32_16x16x32_bf16 v[88:91], a[20:23], v[64:67], v[88:91]
    v_mfma_f32_16x16x32_bf16 v[92:95], a[100:103], v[64:67], v[92:95]
    v_mfma_f32_16x16x32_bf16 v[96:99], a[180:183], v[64:67], v[96:99]
    v_mfma_f32_16x16x32_bf16 v[100:103], a[20:23], v[68:71], v[100:103]
    v_mfma_f32_16x16x32_bf16 v[104:107], a[100:103], v[68:71], v[104:107]
    v_mfma_f32_16x16x32_bf16 v[108:111], a[180:183], v[68:71], v[108:111]
    ds_read_b128 v[64:67], v9 offset:9216
    ds_read_b128 v[68:71], v9 offset:29696
    s_waitcnt lgkmcnt(6)
    v_mfma_f32_16x16x32_bf16 v[88:91], a[24:27], v[72:75], v[88:91]
    v_mfma_f32_16x16x32_bf16 v[92:95], a[104:107], v[72:75], v[92:95]
    v_mfma_f32_16x16x32_bf16 v[96:99], a[184:187], v[72:75], v[96:99]
    v_mfma_f32_16x16x32_bf16 v[100:103], a[24:27], v[76:79], v[100:103]
    v_mfma_f32_16x16x32_bf16 v[104:107], a[104:107], v[76:79], v[104:107]
    v_mfma_f32_16x16x32_bf16 v[108:111], a[184:187], v[76:79], v[108:111]
    ds_read_b128 v[72:75], v9 offset:10240
    ds_read_b128 v[76:79], v9 offset:30720
    s_waitcnt lgkmcnt(6)
    v_mfma_f32_16x16x32_bf16 v[88:91], a[28:31], v[80:83], v[88:91]
    v_mfma_f32_16x16x32_bf16 v[92:95], a[108:111], v[80:83], v[92:95]
    v_mfma_f32_16x16x32_bf16 v[96:99], a[188:191], v[80:83], v[96:99]
    v_mfma_f32_16x16x32_bf16 v[100:103], a[28:31], v[84:87], v[100:103]
    v_mfma_f32_16x16x32_bf16 v[104:107], a[108:111], v[84:87], v[104:107]
    v_mfma_f32_16x16x32_bf16 v[108:111], a[188:191], v[84:87], v[108:111]
    ds_read_b128 v[80:83], v9 offset:11264
    ds_read_b128 v[84:87], v9 offset:31744
    s_waitcnt lgkmcnt(6)
    v_mfma_f32_16x16x32_bf16 v[88:91], a[32:35], v[56:59], v[88:91]
    v_mfma_f32_16x16x32_bf16 v[92:95], a[112:115], v[56:59], v[92:95]
    v_mfma_f32_16x16x32_bf16 v[96:99], a[192:195], v[56:59], v[96:99]
    v_mfma_f32_16x16x32_bf16 v[100:103], a[32:35], v[60:63], v[100:103]
    v_mfma_f32_16x16x32_bf16 v[104:107], a[112:115], v[60:63], v[104:107]
    v_mfma_f32_16x16x32_bf16 v[108:111], a[192:195], v[60:63], v[108:111]
    ds_read_b128 v[56:59], v9 offset:12288
    ds_read_b128 v[60:63], v9 offset:32768
    s_waitcnt lgkmcnt(6)
    v_mfma_f32_16x16x32_bf16 v[88:91], a[36:39], v[64:67], v[88:91]
    v_mfma_f32_16x16x32_bf16 v[92:95], a[116:119], v[64:67], v[92:95]
    v_mfma_f32_16x16x32_bf16 v[96:99], a[196:199], v[64:67], v[96:99]
    v_mfma_f32_16x16x32_bf16 v[100:103], a[36:39], v[68:71], v[100:103]
    v_mfma_f32_16x16x32_bf16 v[104:107], a[116:119], v[68:71], v[104:107]
    v_mfma_f32_16x16x32_bf16 v[108:111], a[196:199], v[68:71], v[108:111]
    s_waitcnt vmcnt(10)
    s_barrier
    v_mov_b32 v15, s40
    buffer_store_dword v15, v14, s[8:11], 0 offen sc1
    s_cmp_ge_i32 s79, 0
    s_cselect_b32 s24, 0, 2146435072
    v_or_b32 v246, s24, v245
    v_mov_b32 v247, s79
    buffer_store_dword v247, v246, s[8:11], 0 offen sc1
    s_mov_b32 s79, -1
    buffer_load_dword v152, v4, s[8:11], 0 offen sc1
    ds_read_b128 v[64:67], v9 offset:13312
    ds_read_b128 v[68:71], v9 offset:33792
    s_waitcnt lgkmcnt(6)
    v_mfma_f32_16x16x32_bf16 v[88:91], a[40:43], v[72:75], v[88:91]
    v_mfma_f32_16x16x32_bf16 v[92:95], a[120:123], v[72:75], v[92:95]
    v_mfma_f32_16x16x32_bf16 v[96:99], a[200:203], v[72:75], v[96:99]
    v_mfma_f32_16x16x32_bf16 v[100:103], a[40:43], v[76:79], v[100:103]
    v_mfma_f32_16x16x32_bf16 v[104:107], a[120:123], v[76:79], v[104:107]
    v_mfma_f32_16x16x32_bf16 v[108:111], a[200:203], v[76:79], v[108:111]
    ds_read_b128 v[72:75], v9 offset:14336
    ds_read_b128 v[76:79], v9 offset:34816
    s_waitcnt lgkmcnt(6)
    s_waitcnt vmcnt(3)
    v_mfma_f32_16x16x32_bf16 v[88:91], a[44:47], v[80:83], v[88:91]
    v_mfma_f32_16x16x32_bf16 v[92:95], a[124:127], v[80:83], v[92:95]
    ds_write_b128 v10, v[16:19] offset:0
    v_mfma_f32_16x16x32_bf16 v[96:99], a[204:207], v[80:83], v[96:99]
    v_mfma_f32_16x16x32_bf16 v[100:103], a[44:47], v[84:87], v[100:103]
    v_mfma_f32_16x16x32_bf16 v[104:107], a[124:127], v[84:87], v[104:107]
    v_mfma_f32_16x16x32_bf16 v[108:111], a[204:207], v[84:87], v[108:111]
    v_mfma_f32_16x16x32_bf16 v[148:151], v[16:19], v[16:19], 0
    v_mfma_f32_16x16x32_bf16 v[144:147], v[236:239], v[16:19], 0
    v_mfma_f32_16x16x32_bf16 v[148:151], v[20:23], v[20:23], v[148:151]
    ds_read_b128 v[80:83], v9 offset:15360
    ds_read_b128 v[84:87], v9 offset:35840
    s_waitcnt lgkmcnt(7)
    v_mfma_f32_16x16x32_bf16 v[88:91], a[48:51], v[56:59], v[88:91]
    v_mfma_f32_16x16x32_bf16 v[92:95], a[128:131], v[56:59], v[92:95]
    ds_write_b128 v10, v[20:23] offset:1024
    v_mfma_f32_16x16x32_bf16 v[96:99], a[208:211], v[56:59], v[96:99]
    v_mfma_f32_16x16x32_bf16 v[100:103], a[48:51], v[60:63], v[100:103]
    v_mfma_f32_16x16x32_bf16 v[104:107], a[128:131], v[60:63], v[104:107]
    v_mfma_f32_16x16x32_bf16 v[108:111], a[208:211], v[60:63], v[108:111]
    v_mfma_f32_16x16x32_bf16 v[144:147], v[236:239], v[20:23], v[144:147]
    v_mfma_f32_16x16x32_bf16 v[148:151], v[24:27], v[24:27], v[148:151]
    v_mfma_f32_16x16x32_bf16 v[144:147], v[236:239], v[24:27], v[144:147]
    ds_read_b128 v[56:59], v9 offset:16384
    ds_read_b128 v[60:63], v9 offset:36864
    s_waitcnt lgkmcnt(8)
    v_mfma_f32_16x16x32_bf16 v[88:91], a[52:55], v[64:67], v[88:91]
    v_mfma_f32_16x16x32_bf16 v[92:95], a[132:135], v[64:67], v[92:95]
    ds_write_b128 v10, v[24:27] offset:2048
    v_mfma_f32_16x16x32_bf16 v[96:99], a[212:215], v[64:67], v[96:99]
    v_mfma_f32_16x16x32_bf16 v[100:103], a[52:55], v[68:71], v[100:103]
    v_mfma_f32_16x16x32_bf16 v[104:107], a[132:135], v[68:71], v[104:107]
    v_mfma_f32_16x16x32_bf16 v[108:111], a[212:215], v[68:71], v[108:111]
    v_mfma_f32_16x16x32_bf16 v[148:151], v[28:31], v[28:31], v[148:151]
    v_mfma_f32_16x16x32_bf16 v[144:147], v[236:239], v[28:31], v[144:147]
    v_mfma_f32_16x16x32_bf16 v[148:151], v[32:35], v[32:35], v[148:151]
    ds_read_b128 v[64:67], v9 offset:17408
    ds_read_b128 v[68:71], v9 offset:37888
    s_waitcnt lgkmcnt(9)
    v_mfma_f32_16x16x32_bf16 v[88:91], a[56:59], v[72:75], v[88:91]
    v_mfma_f32_16x16x32_bf16 v[92:95], a[136:139], v[72:75], v[92:95]
    ds_write_b128 v10, v[28:31] offset:3072
    v_mfma_f32_16x16x32_bf16 v[96:99], a[216:219], v[72:75], v[96:99]
    v_mfma_f32_16x16x32_bf16 v[100:103], a[56:59], v[76:79], v[100:103]
    v_mfma_f32_16x16x32_bf16 v[104:107], a[136:139], v[76:79], v[104:107]
    v_mfma_f32_16x16x32_bf16 v[108:111], a[216:219], v[76:79], v[108:111]
    v_mfma_f32_16x16x32_bf16 v[144:147], v[236:239], v[32:35], v[144:147]
    v_mfma_f32_16x16x32_bf16 v[148:151], v[36:39], v[36:39], v[148:151]
    v_mfma_f32_16x16x32_bf16 v[144:147], v[236:239], v[36:39], v[144:147]
    ds_read_b128 v[72:75], v9 offset:18432
    ds_read_b128 v[76:79], v9 offset:38912
    s_waitcnt lgkmcnt(9)
    v_mfma_f32_16x16x32_bf16 v[88:91], a[60:63], v[80:83], v[88:91]
    v_mfma_f32_16x16x32_bf16 v[92:95], a[140:143], v[80:83], v[92:95]
    ds_write_b128 v10, v[32:35] offset:4096
    v_mfma_f32_16x16x32_bf16 v[96:99], a[220:223], v[80:83], v[96:99]
    v_mfma_f32_16x16x32_bf16 v[100:103], a[60:63], v[84:87], v[100:103]
    v_mfma_f32_16x16x32_bf16 v[104:107], a[140:143], v[84:87], v[104:107]
    v_mfma_f32_16x16x32_bf16 v[108:111], a[220:223], v[84:87], v[108:111]
    v_mfma_f32_16x16x32_bf16 v[148:151], v[40:43], v[40:43], v[148:151]
    v_mfma_f32_16x16x32_bf16 v[144:147], v[236:239], v[40:43], v[144:147]
    v_mfma_f32_16x16x32_bf16 v[148:151], v[44:47], v[44:47], v[148:151]
    ds_read_b128 v[80:83], v9 offset:19456
    ds_read_b128 v[84:87], v9 offset:39936
    s_waitcnt lgkmcnt(9)
    v_mfma_f32_16x16x32_bf16 v[88:91], a[64:67], v[56:59], v[88:91]
    v_mfma_f32_16x16x32_bf16 v[92:95], a[144:147], v[56:59], v[92:95]
    ds_write_b128 v10, v[36:39] offset:5120
    v_mfma_f32_16x16x32_bf16 v[96:99], a[224:227], v[56:59], v[96:99]
    v_mfma_f32_16x16x32_bf16 v[100:103], a[64:67], v[60:63], v[100:103]
    v_mfma_f32_16x16x32_bf16 v[104:107], a[144:147], v[60:63], v[104:107]
    v_mfma_f32_16x16x32_bf16 v[108:111], a[224:227], v[60:63], v[108:111]
    v_mfma_f32_16x16x32_bf16 v[144:147], v[236:239], v[44:47], v[144:147]
    v_mfma_f32_16x16x32_bf16 v[148:151], v[48:51], v[48:51], v[148:151]
    v_mfma_f32_16x16x32_bf16 v[144:147], v[236:239], v[48:51], v[144:147]
    s_waitcnt lgkmcnt(7)
    v_mfma_f32_16x16x32_bf16 v[88:91], a[68:71], v[64:67], v[88:91]
    v_mfma_f32_16x16x32_bf16 v[92:95], a[148:151], v[64:67], v[92:95]
    ds_write_b128 v10, v[40:43] offset:6144
    v_mfma_f32_16x16x32_bf16 v[96:99], a[228:231], v[64:67], v[96:99]
    v_mfma_f32_16x16x32_bf16 v[100:103], a[68:71], v[68:71], v[100:103]
    v_mfma_f32_16x16x32_bf16 v[104:107], a[148:151], v[68:71], v[104:107]
    v_mfma_f32_16x16x32_bf16 v[108:111], a[228:231], v[68:71], v[108:111]
    v_mfma_f32_16x16x32_bf16 v[148:151], v[52:55], v[52:55], v[148:151]
    v_mfma_f32_16x16x32_bf16 v[144:147], v[236:239], v[52:55], v[144:147]
    s_waitcnt lgkmcnt(5)
    v_mfma_f32_16x16x32_bf16 v[88:91], a[72:75], v[72:75], v[88:91]
    v_mfma_f32_16x16x32_bf16 v[92:95], a[152:155], v[72:75], v[92:95]
    ds_write_b128 v10, v[44:47] offset:7168
    v_mfma_f32_16x16x32_bf16 v[96:99], a[232:235], v[72:75], v[96:99]
    v_mfma_f32_16x16x32_bf16 v[100:103], a[72:75], v[76:79], v[100:103]
    v_mfma_f32_16x16x32_bf16 v[104:107], a[152:155], v[76:79], v[104:107]
    v_mfma_f32_16x16x32_bf16 v[108:111], a[232:235], v[76:79], v[108:111]
    s_waitcnt lgkmcnt(3)
    v_mfma_f32_16x16x32_bf16 v[88:91], a[76:79], v[80:83], v[88:91]
    v_mfma_f32_16x16x32_bf16 v[92:95], a[156:159], v[80:83], v[92:95]
    ds_write_b128 v10, v[48:51] offset:8192
    v_mfma_f32_16x16x32_bf16 v[96:99], a[236:239], v[80:83], v[96:99]
    v_mfma_f32_16x16x32_bf16 v[100:103], a[76:79], v[84:87], v[100:103]
    v_mfma_f32_16x16x32_bf16 v[104:107], a[156:159], v[84:87], v[104:107]
    v_mfma_f32_16x16x32_bf16 v[108:111], a[236:239], v[84:87], v[108:111]
    v_cndmask_b32 v145, v148, v149, s[48:49]
    v_cndmask_b32 v145, v145, v150, s[50:51]
    v_cndmask_b32 v145, v145, v151, s[54:55]
    ds_write_b128 v10, v[52:55] offset:9216
    ds_write_b64 v140, v[144:145]
    v_pk_mul_f32 v[124:125], v[224:225], v[132:133] op_sel:[0,1] op_sel_hi:[1,1]
    v_pk_mul_f32 v[126:127], v[226:227], v[132:133] op_sel:[0,1] op_sel_hi:[1,1]
    v_pk_fma_f32 v[88:89], v[88:89], v[132:133], v[124:125] op_sel:[0,0,0] op_sel_hi:[1,0,1]
    v_pk_fma_f32 v[90:91], v[90:91], v[132:133], v[126:127] op_sel:[0,0,0] op_sel_hi:[1,0,1]
    v_pk_mul_f32 v[124:125], v[228:229], v[132:133] op_sel:[0,1] op_sel_hi:[1,1]
    v_pk_mul_f32 v[126:127], v[230:231], v[132:133] op_sel:[0,1] op_sel_hi:[1,1]
    v_pk_fma_f32 v[92:93], v[92:93], v[132:133], v[124:125] op_sel:[0,0,0] op_sel_hi:[1,0,1]
    v_pk_fma_f32 v[94:95], v[94:95], v[132:133], v[126:127] op_sel:[0,0,0] op_sel_hi:[1,0,1]
    v_pk_mul_f32 v[124:125], v[232:233], v[132:133] op_sel:[0,1] op_sel_hi:[1,1]
    v_pk_mul_f32 v[126:127], v[234:235], v[132:133] op_sel:[0,1] op_sel_hi:[1,1]
    v_pk_fma_f32 v[96:97], v[96:97], v[132:133], v[124:125] op_sel:[0,0,0] op_sel_hi:[1,0,1]
    v_pk_fma_f32 v[98:99], v[98:99], v[132:133], v[126:127] op_sel:[0,0,0] op_sel_hi:[1,0,1]
    v_pk_mul_f32 v[124:125], v[224:225], v[134:135] op_sel:[0,1] op_sel_hi:[1,1]
    v_pk_mul_f32 v[126:127], v[226:227], v[134:135] op_sel:[0,1] op_sel_hi:[1,1]
    v_pk_fma_f32 v[100:101], v[100:101], v[134:135], v[124:125] op_sel:[0,0,0] op_sel_hi:[1,0,1]
    v_pk_fma_f32 v[102:103], v[102:103], v[134:135], v[126:127] op_sel:[0,0,0] op_sel_hi:[1,0,1]
    v_pk_mul_f32 v[124:125], v[228:229], v[134:135] op_sel:[0,1] op_sel_hi:[1,1]
    v_pk_mul_f32 v[126:127], v[230:231], v[134:135] op_sel:[0,1] op_sel_hi:[1,1]
    v_pk_fma_f32 v[104:105], v[104:105], v[134:135], v[124:125] op_sel:[0,0,0] op_sel_hi:[1,0,1]
    v_pk_fma_f32 v[106:107], v[106:107], v[134:135], v[126:127] op_sel:[0,0,0] op_sel_hi:[1,0,1]
    v_pk_mul_f32 v[124:125], v[232:233], v[134:135] op_sel:[0,1] op_sel_hi:[1,1]
    v_pk_mul_f32 v[126:127], v[234:235], v[134:135] op_sel:[0,1] op_sel_hi:[1,1]
    v_pk_fma_f32 v[108:109], v[108:109], v[134:135], v[124:125] op_sel:[0,0,0] op_sel_hi:[1,0,1]
    v_pk_fma_f32 v[110:111], v[110:111], v[134:135], v[126:127] op_sel:[0,0,0] op_sel_hi:[1,0,1]
    v_cvt_pk_bf16_f32 v112, v88, v89
    v_cvt_pk_bf16_f32 v113, v90, v91
    v_cvt_pk_bf16_f32 v114, v92, v93
    v_cvt_pk_bf16_f32 v115, v94, v95
    v_cvt_pk_bf16_f32 v116, v100, v101
    v_cvt_pk_bf16_f32 v117, v102, v103
    v_cvt_pk_bf16_f32 v118, v104, v105
    v_cvt_pk_bf16_f32 v119, v106, v107
    v_cvt_pk_bf16_f32 v120, v96, v97
    v_cvt_pk_bf16_f32 v121, v98, v99
    v_cvt_pk_bf16_f32 v122, v108, v109
    v_cvt_pk_bf16_f32 v123, v110, v111
    buffer_store_dwordx4 v[112:115], v11, s[8:11], s43 offen offset:0 sc1
    buffer_store_dwordx4 v[116:119], v11, s[8:11], s43 offen offset:1024 sc1
    buffer_store_dwordx4 v[120:123], v11, s[8:11], s43 offen offset:2048 sc1
    s_add_u32 s43, s43, 393216
    s_waitcnt vmcnt(3)
    s_add_u32 s40, s40, 1
    s_add_u32 s63, s40, 1
    s_lshr_b32 s63, s63, s75
    s_add_u32 s63, s63, 1
    s_min_u32 s63, s63, s74
    v_cmp_le_i32 vcc, s63, v152
    s_cmp_eq_u64 vcc, -1
    s_cselect_b32 s58, 1, 0
    s_cmp_ge_i32 s62, s63
    s_cselect_b32 s58, 1, s58
    s_and_b32 s24, s40, 1
    s_lshl_b32 s24, s24, 2
    s_add_u32 s24, s24, 83456
    s_lshl_b32 s25, s3, 4
    s_add_u32 s25, s25, s24
    v_mov_b32 v15, s25
    v_mov_b32 v152, s58
    ds_write_b32 v15, v152
    v_mov_b32 v15, s24
    s_waitcnt lgkmcnt(0)
    s_barrier
    ds_read_b32 v152, v15
    s_waitcnt lgkmcnt(0)
    v_readfirstlane_b32 s58, v152
    s_cmp_eq_u32 s58, 1
    s_cselect_b32 s24, s63, s62
    s_max_i32 s62, s62, s24
interleave_layers__linear_attn_block__memory_aug_recurrent_mem_tr__prompt_kernel_p_next:
    s_cmp_ge_u32 s64, 56
    s_cselect_b32 s24, 8, 12
    s_add_u32 s24, s24, s64
    s_cmp_le_u32 s24, s40
    s_cbranch_scc1 interleave_layers__linear_attn_block__memory_aug_recurrent_mem_tr__prompt_kernel_p_pub
    s_cmp_lt_u32 s40, 64
    s_cbranch_scc0 interleave_layers__linear_attn_block__memory_aug_recurrent_mem_tr__prompt_kernel_pg38
    s_cmp_eq_u32 s58, 1
    s_cbranch_scc1 interleave_layers__linear_attn_block__memory_aug_recurrent_mem_tr__prompt_kernel_p_seg
    s_branch interleave_layers__linear_attn_block__memory_aug_recurrent_mem_tr__prompt_kernel_p_pubA
interleave_layers__linear_attn_block__memory_aug_recurrent_mem_tr__prompt_kernel_pg38:
interleave_layers__linear_attn_block__memory_aug_recurrent_mem_tr__prompt_kernel_p_pub:
    s_waitcnt vmcnt(0)
    s_barrier
    s_cmp_eq_u32 s3, 0
    s_cbranch_scc0 interleave_layers__linear_attn_block__memory_aug_recurrent_mem_tr__prompt_kernel_fp39
    v_mov_b32 v15, s40
    buffer_store_dword v15, v14, s[8:11], 0 offen sc1
interleave_layers__linear_attn_block__memory_aug_recurrent_mem_tr__prompt_kernel_fp39:
    s_cmp_ge_u32 s64, 56
    s_cselect_b32 s24, 8, 12
    s_add_u32 s24, s24, s64
    s_cmp_le_u32 s24, s40
    s_cbranch_scc1 interleave_layers__linear_attn_block__memory_aug_recurrent_mem_tr__prompt_kernel_p_x
    s_cmp_lt_u32 s40, 64
    s_cbranch_scc0 interleave_layers__linear_attn_block__memory_aug_recurrent_mem_tr__prompt_kernel_pg40
    s_cmp_eq_u32 s58, 1
    s_cbranch_scc1 interleave_layers__linear_attn_block__memory_aug_recurrent_mem_tr__prompt_kernel_p_seg
    s_branch interleave_layers__linear_attn_block__memory_aug_recurrent_mem_tr__prompt_kernel_p_pubA
interleave_layers__linear_attn_block__memory_aug_recurrent_mem_tr__prompt_kernel_pg40:
    s_cmp_ge_u32 s64, 64
    s_cbranch_scc1 interleave_layers__linear_attn_block__memory_aug_recurrent_mem_tr__prompt_kernel_p_done
interleave_layers__linear_attn_block__memory_aug_recurrent_mem_tr__prompt_kernel_p_x:
    s_add_u32 s63, s64, 1
    s_cmp_ge_i32 s69, s63
    s_cbranch_scc1 interleave_layers__linear_attn_block__memory_aug_recurrent_mem_tr__prompt_kernel_x_en_ok
    s_mov_b32 s61, 0
interleave_layers__linear_attn_block__memory_aug_recurrent_mem_tr__prompt_kernel_x_en:
    buffer_load_dword v253, v252, s[8:11], 0 offen sc1
    s_waitcnt vmcnt(0)
    v_readlane_b32 s69, v253, 0
    v_readlane_b32 s24, v253, 1
    s_min_i32 s69, s69, s24
    v_readlane_b32 s24, v253, 2
    s_min_i32 s69, s69, s24
    v_readlane_b32 s24, v253, 3
    s_min_i32 s69, s69, s24
    v_readlane_b32 s24, v253, 4
    s_min_i32 s69, s69, s24
    v_readlane_b32 s24, v253, 5
    s_min_i32 s69, s69, s24
    v_readlane_b32 s24, v253, 6
    s_min_i32 s69, s69, s24
    v_readlane_b32 s24, v253, 7
    s_min_i32 s69, s69, s24
    s_cmp_ge_i32 s69, s63
    s_cbranch_scc1 interleave_layers__linear_attn_block__memory_aug_recurrent_mem_tr__prompt_kernel_x_en_ok
    s_add_u32 s61, s61, 1
    s_cmp_ge_u32 s61, s60
    s_cbranch_scc1 interleave_layers__linear_attn_block__memory_aug_recurrent_mem_tr__prompt_kernel_x_en_to
    s_sleep 2
    s_branch interleave_layers__linear_attn_block__memory_aug_recurrent_mem_tr__prompt_kernel_x_en
interleave_layers__linear_attn_block__memory_aug_recurrent_mem_tr__prompt_kernel_x_en_to:
    s_mov_b32 s60, 1
interleave_layers__linear_attn_block__memory_aug_recurrent_mem_tr__prompt_kernel_x_en_ok:
    s_lshl_b32 s95, s92, 6
    s_add_u32 s95, s95, s64
    s_add_u32 s95, s95, 1
    s_cmp_ge_i32 s59, s95
    s_cbranch_scc1 interleave_layers__linear_attn_block__memory_aug_recurrent_mem_tr__prompt_kernel_x_ec_ok
    s_and_b32 s24, s2, 7
    s_lshl_b32 s24, s24, 7
    s_add_u32 s24, s24, 23109632
    v_and_b32 v254, 3, v1
    v_lshl_add_u32 v254, v254, 2, s24
    s_mov_b32 s61, 0
interleave_layers__linear_attn_block__memory_aug_recurrent_mem_tr__prompt_kernel_x_ec:
    buffer_load_dword v253, v254, s[8:11], 0 offen sc1
    s_waitcnt vmcnt(0)
    v_readlane_b32 s59, v253, 0
    v_readlane_b32 s24, v253, 1
    s_min_i32 s59, s59, s24
    v_readlane_b32 s24, v253, 2
    s_min_i32 s59, s59, s24
    s_cmp_ge_i32 s59, s95
    s_cbranch_scc1 interleave_layers__linear_attn_block__memory_aug_recurrent_mem_tr__prompt_kernel_x_ec_ok
    s_add_u32 s61, s61, 1
    s_cmp_ge_u32 s61, s60
    s_cbranch_scc1 interleave_layers__linear_attn_block__memory_aug_recurrent_mem_tr__prompt_kernel_x_ec_to
    s_sleep 2
    s_branch interleave_layers__linear_attn_block__memory_aug_recurrent_mem_tr__prompt_kernel_x_ec
interleave_layers__linear_attn_block__memory_aug_recurrent_mem_tr__prompt_kernel_x_ec_to:
    s_mov_b32 s60, 1
interleave_layers__linear_attn_block__memory_aug_recurrent_mem_tr__prompt_kernel_x_ec_ok:
    s_add_u32 s52, s65, 32768
    buffer_load_dwordx4 v[16:19], v240, s[8:11], s65 offen offset:0 sc1
    buffer_load_dwordx4 v[20:23], v240, s[8:11], s65 offen offset:1024 sc1
    buffer_load_dwordx4 v[24:27], v240, s[8:11], s65 offen offset:2048 sc1
    buffer_load_dwordx4 v[28:31], v240, s[8:11], s65 offen offset:3072 sc1
    buffer_load_dwordx4 v[32:35], v241, s[8:11], s65 offen offset:0 sc1
    buffer_load_dwordx4 v[36:39], v241, s[8:11], s65 offen offset:1024 sc1
    buffer_load_dwordx4 v[40:43], v241, s[8:11], s65 offen offset:2048 sc1
    buffer_load_dwordx4 v[44:47], v241, s[8:11], s65 offen offset:3072 sc1
    buffer_load_dwordx4 v[48:51], v240, s[8:11], s52 offen offset:0 sc1
    buffer_load_dwordx4 v[52:55], v240, s[8:11], s52 offen offset:1024 sc1
    buffer_load_dwordx4 v[56:59], v240, s[8:11], s52 offen offset:2048 sc1
    buffer_load_dwordx4 v[60:63], v240, s[8:11], s52 offen offset:3072 sc1
    buffer_load_dwordx4 v[64:67], v241, s[8:11], s52 offen offset:0 sc1
    buffer_load_dwordx4 v[68:71], v241, s[8:11], s52 offen offset:1024 sc1
    buffer_load_dwordx4 v[72:75], v241, s[8:11], s52 offen offset:2048 sc1
    buffer_load_dwordx4 v[76:79], v241, s[8:11], s52 offen offset:3072 sc1
    s_add_u32 s24, s68, s73
    buffer_load_dwordx4 v[196:199], v219, s[8:11], s24 offen sc1
    s_lshl_b32 s77, s92, 6
    s_add_u32 s77, s77, s64
    s_add_u32 s77, s77, 1
    s_cmp_ge_i32 s76, s77
    s_cbranch_scc1 interleave_layers__linear_attn_block__memory_aug_recurrent_mem_tr__prompt_kernel_x_cs_ok
    s_and_b32 s24, s2, 7
    s_lshl_b32 s24, s24, 7
    s_add_u32 s24, s24, 23111680
    v_mov_b32 v254, s24
    s_mov_b32 s61, 0
interleave_layers__linear_attn_block__memory_aug_recurrent_mem_tr__prompt_kernel_x_cs:
    buffer_load_dword v253, v254, s[8:11], 0 offen sc1
    s_waitcnt vmcnt(0)
    v_readlane_b32 s76, v253, 0
    s_cmp_ge_i32 s76, s77
    s_cbranch_scc1 interleave_layers__linear_attn_block__memory_aug_recurrent_mem_tr__prompt_kernel_x_cs_ok
    s_add_u32 s61, s61, 1
    s_cmp_ge_u32 s61, s60
    s_cbranch_scc1 interleave_layers__linear_attn_block__memory_aug_recurrent_mem_tr__prompt_kernel_x_cs_to
    s_sleep 16
    s_branch interleave_layers__linear_attn_block__memory_aug_recurrent_mem_tr__prompt_kernel_x_cs
interleave_layers__linear_attn_block__memory_aug_recurrent_mem_tr__prompt_kernel_x_cs_to:
    s_mov_b32 s60, 1
interleave_layers__linear_attn_block__memory_aug_recurrent_mem_tr__prompt_kernel_x_cs_ok:
    s_add_u32 s53, s66, 16384
    s_mov_b32 s61, 0
interleave_layers__linear_attn_block__memory_aug_recurrent_mem_tr__prompt_kernel_x_p1:
    buffer_load_dwordx4 v[80:83], v212, s[8:11], s67 offen offset:0 sc1
    buffer_load_dwordx4 v[84:87], v212, s[8:11], s67 offen offset:1024 sc1
    buffer_load_dwordx4 v[88:91], v212, s[8:11], s67 offen offset:2048 sc1
    buffer_load_dwordx4 v[92:95], v212, s[8:11], s67 offen offset:3072 sc1
    buffer_load_dwordx4 v[96:99], v213, s[8:11], s67 offen offset:0 sc1
    buffer_load_dwordx4 v[100:103], v213, s[8:11], s67 offen offset:1024 sc1
    buffer_load_dwordx4 v[104:107], v213, s[8:11], s67 offen offset:2048 sc1
    buffer_load_dwordx4 v[108:111], v213, s[8:11], s67 offen offset:3072 sc1
    buffer_load_dwordx4 v[112:115], v214, s[8:11], s67 offen offset:0 sc1
    buffer_load_dwordx4 v[116:119], v214, s[8:11], s67 offen offset:1024 sc1
    buffer_load_dwordx4 v[120:123], v214, s[8:11], s67 offen offset:2048 sc1
    buffer_load_dwordx4 v[124:127], v214, s[8:11], s67 offen offset:3072 sc1
    buffer_load_dwordx4 v[128:131], v215, s[8:11], s67 offen offset:0 sc1
    buffer_load_dwordx4 v[132:135], v215, s[8:11], s67 offen offset:1024 sc1
    buffer_load_dwordx4 v[136:139], v215, s[8:11], s67 offen offset:2048 sc1
    buffer_load_dwordx4 v[140:143], v215, s[8:11], s67 offen offset:3072 sc1
    buffer_load_dwordx4 v[144:147], v216, s[8:11], s67 offen offset:0 sc1
    buffer_load_dwordx4 v[148:151], v216, s[8:11], s67 offen offset:1024 sc1
    buffer_load_dwordx4 v[152:155], v216, s[8:11], s67 offen offset:2048 sc1
    buffer_load_dwordx4 v[156:159], v216, s[8:11], s67 offen offset:3072 sc1
    buffer_load_dwordx4 v[160:163], v242, s[8:11], s66 offen offset:0 sc1
    buffer_load_dwordx4 v[164:167], v242, s[8:11], s66 offen offset:1024 sc1
    buffer_load_dwordx4 v[168:171], v242, s[8:11], s53 offen offset:0 sc1
    buffer_load_dwordx4 v[172:175], v242, s[8:11], s53 offen offset:1024 sc1
    s_waitcnt vmcnt(0)
    v_max3_u32 v192, v80, v81, v82
    v_max3_u32 v192, v192, v83, v84
    v_max3_u32 v192, v192, v85, v86
    v_max3_u32 v192, v192, v87, v88
    v_max3_u32 v192, v192, v89, v90
    v_max3_u32 v192, v192, v91, v92
    v_max3_u32 v192, v192, v93, v94
    v_max3_u32 v192, v192, v95, v96
    v_max3_u32 v192, v192, v97, v98
    v_max3_u32 v192, v192, v99, v100
    v_max3_u32 v192, v192, v101, v102
    v_max3_u32 v192, v192, v103, v104
    v_max3_u32 v192, v192, v105, v106
    v_max3_u32 v192, v192, v107, v108
    v_max3_u32 v192, v192, v109, v110
    v_max3_u32 v192, v192, v111, v112
    v_max3_u32 v192, v192, v113, v114
    v_max3_u32 v192, v192, v115, v116
    v_max3_u32 v192, v192, v117, v118
    v_max3_u32 v192, v192, v119, v120
    v_max3_u32 v192, v192, v121, v122
    v_max3_u32 v192, v192, v123, v124
    v_max3_u32 v192, v192, v125, v126
    v_max3_u32 v192, v192, v127, v128
    v_max3_u32 v192, v192, v129, v130
    v_max3_u32 v192, v192, v131, v132
    v_max3_u32 v192, v192, v133, v134
    v_max3_u32 v192, v192, v135, v136
    v_max3_u32 v192, v192, v137, v138
    v_max3_u32 v192, v192, v139, v140
    v_max3_u32 v192, v192, v141, v142
    v_max3_u32 v192, v192, v143, v144
    v_max3_u32 v192, v192, v145, v146
    v_max3_u32 v192, v192, v147, v148
    v_max3_u32 v192, v192, v149, v150
    v_max3_u32 v192, v192, v151, v152
    v_max3_u32 v192, v192, v153, v154
    v_max3_u32 v192, v192, v155, v156
    v_max3_u32 v192, v192, v157, v158
    v_max3_u32 v192, v192, v159, v160
    v_max3_u32 v192, v192, v161, v162
    v_max3_u32 v192, v192, v163, v164
    v_max3_u32 v192, v192, v165, v166
    v_max3_u32 v192, v192, v167, v168
    v_max3_u32 v192, v192, v169, v170
    v_max3_u32 v192, v192, v171, v172
    v_max3_u32 v192, v192, v173, v174
    v_max_u32 v192, v192, v175
    v_cmp_eq_u32 vcc, -1, v192
    s_add_u32 s61, s61, 1
    s_cbranch_vccz interleave_layers__linear_attn_block__memory_aug_recurrent_mem_tr__prompt_kernel_x_p1_out
    s_cmp_ge_u32 s61, s60
    s_cbranch_scc1 interleave_layers__linear_attn_block__memory_aug_recurrent_mem_tr__prompt_kernel_x_p1_to
    s_sleep 2
    s_branch interleave_layers__linear_attn_block__memory_aug_recurrent_mem_tr__prompt_kernel_x_p1
interleave_layers__linear_attn_block__memory_aug_recurrent_mem_tr__prompt_kernel_x_p1_to:
    s_mov_b32 s60, 1
interleave_layers__linear_attn_block__memory_aug_recurrent_mem_tr__prompt_kernel_x_p1_out:
    v_mfma_f32_16x16x32_bf16 v[176:179], v[16:19], v[80:83], 0
    v_mfma_f32_16x16x32_bf16 v[180:183], v[16:19], v[84:87], 0
    v_mfma_f32_16x16x32_bf16 v[184:187], v[48:51], v[80:83], 0
    v_mfma_f32_16x16x32_bf16 v[188:191], v[48:51], v[84:87], 0
    v_mfma_f32_16x16x32_bf16 v[176:179], v[20:23], v[88:91], v[176:179]
    v_mfma_f32_16x16x32_bf16 v[180:183], v[20:23], v[92:95], v[180:183]
    v_mfma_f32_16x16x32_bf16 v[184:187], v[52:55], v[88:91], v[184:187]
    v_mfma_f32_16x16x32_bf16 v[188:191], v[52:55], v[92:95], v[188:191]
    v_mfma_f32_16x16x32_bf16 v[176:179], v[24:27], v[96:99], v[176:179]
    v_mfma_f32_16x16x32_bf16 v[180:183], v[24:27], v[100:103], v[180:183]
    v_mfma_f32_16x16x32_bf16 v[184:187], v[56:59], v[96:99], v[184:187]
    v_mfma_f32_16x16x32_bf16 v[188:191], v[56:59], v[100:103], v[188:191]
    v_mfma_f32_16x16x32_bf16 v[176:179], v[28:31], v[104:107], v[176:179]
    v_mfma_f32_16x16x32_bf16 v[180:183], v[28:31], v[108:111], v[180:183]
    v_mfma_f32_16x16x32_bf16 v[184:187], v[60:63], v[104:107], v[184:187]
    v_mfma_f32_16x16x32_bf16 v[188:191], v[60:63], v[108:111], v[188:191]
    v_mfma_f32_16x16x32_bf16 v[176:179], v[32:35], v[112:115], v[176:179]
    v_mfma_f32_16x16x32_bf16 v[180:183], v[32:35], v[116:119], v[180:183]
    v_mfma_f32_16x16x32_bf16 v[184:187], v[64:67], v[112:115], v[184:187]
    v_mfma_f32_16x16x32_bf16 v[188:191], v[64:67], v[116:119], v[188:191]
    v_mfma_f32_16x16x32_bf16 v[176:179], v[36:39], v[120:123], v[176:179]
    v_mfma_f32_16x16x32_bf16 v[180:183], v[36:39], v[124:127], v[180:183]
    v_mfma_f32_16x16x32_bf16 v[184:187], v[68:71], v[120:123], v[184:187]
    v_mfma_f32_16x16x32_bf16 v[188:191], v[68:71], v[124:127], v[188:191]
    v_mfma_f32_16x16x32_bf16 v[176:179], v[40:43], v[128:131], v[176:179]
    v_mfma_f32_16x16x32_bf16 v[180:183], v[40:43], v[132:135], v[180:183]
    v_mfma_f32_16x16x32_bf16 v[184:187], v[72:75], v[128:131], v[184:187]
    v_mfma_f32_16x16x32_bf16 v[188:191], v[72:75], v[132:135], v[188:191]
    v_mfma_f32_16x16x32_bf16 v[176:179], v[44:47], v[136:139], v[176:179]
    v_mfma_f32_16x16x32_bf16 v[180:183], v[44:47], v[140:143], v[180:183]
    v_mfma_f32_16x16x32_bf16 v[184:187], v[76:79], v[136:139], v[184:187]
    v_mfma_f32_16x16x32_bf16 v[188:191], v[76:79], v[140:143], v[188:191]
    v_mfma_f32_16x16x32_bf16 v[176:179], v[160:163], v[144:147], v[176:179]
    v_mfma_f32_16x16x32_bf16 v[180:183], v[160:163], v[148:151], v[180:183]
    v_mfma_f32_16x16x32_bf16 v[184:187], v[168:171], v[144:147], v[184:187]
    v_mfma_f32_16x16x32_bf16 v[188:191], v[168:171], v[148:151], v[188:191]
    v_mfma_f32_16x16x32_bf16 v[176:179], v[164:167], v[152:155], v[176:179]
    v_mfma_f32_16x16x32_bf16 v[180:183], v[164:167], v[156:159], v[180:183]
    v_mfma_f32_16x16x32_bf16 v[184:187], v[172:175], v[152:155], v[184:187]
    v_mfma_f32_16x16x32_bf16 v[188:191], v[172:175], v[156:159], v[188:191]
    s_nop 4
    ds_write_b128 v217, v[176:179] offset:0
    ds_write_b128 v217, v[180:183] offset:1024
    ds_write_b128 v217, v[184:187] offset:2048
    ds_write_b128 v217, v[188:191] offset:3072
    s_waitcnt lgkmcnt(0)
    s_barrier
    s_cmp_ge_u32 s3, 2
    s_cbranch_scc1 interleave_layers__linear_attn_block__memory_aug_recurrent_mem_tr__prompt_kernel_xs41
    ds_read_b128 v[16:19], v218 offset:0
    ds_read_b128 v[20:23], v218 offset:4096
    ds_read_b128 v[24:27], v218 offset:8192
    ds_read_b128 v[28:31], v218 offset:12288
    ds_read_b128 v[32:35], v218 offset:2048
    ds_read_b128 v[36:39], v218 offset:6144
    ds_read_b128 v[40:43], v218 offset:10240
    ds_read_b128 v[44:47], v218 offset:14336
    s_waitcnt lgkmcnt(4)
    v_pk_add_f32 v[16:17], v[16:17], v[20:21]
    v_pk_add_f32 v[24:25], v[24:25], v[28:29]
    v_pk_add_f32 v[18:19], v[18:19], v[22:23]
    v_pk_add_f32 v[26:27], v[26:27], v[30:31]
    v_pk_add_f32 v[16:17], v[16:17], v[24:25]
    v_pk_add_f32 v[18:19], v[18:19], v[26:27]
    v_cvt_pk_bf16_f32 v20, v16, v17
    v_cvt_pk_bf16_f32 v21, v18, v19
    v_lshlrev_b32 v16, 16, v20
    v_and_b32 v17, 0xffff0000, v20
    v_lshlrev_b32 v22, 16, v196
    v_and_b32 v23, 0xffff0000, v196
    v_pk_add_f32 v[16:17], v[16:17], v[22:23]
    v_cvt_pk_bf16_f32 v48, v16, v17
    v_lshlrev_b32 v16, 16, v21
    v_and_b32 v17, 0xffff0000, v21
    v_lshlrev_b32 v22, 16, v197
    v_and_b32 v23, 0xffff0000, v197
    v_pk_add_f32 v[16:17], v[16:17], v[22:23]
    v_cvt_pk_bf16_f32 v49, v16, v17
    s_waitcnt lgkmcnt(0)
    v_pk_add_f32 v[32:33], v[32:33], v[36:37]
    v_pk_add_f32 v[40:41], v[40:41], v[44:45]
    v_pk_add_f32 v[34:35], v[34:35], v[38:39]
    v_pk_add_f32 v[42:43], v[42:43], v[46:47]
    v_pk_add_f32 v[32:33], v[32:33], v[40:41]
    v_pk_add_f32 v[34:35], v[34:35], v[42:43]
    v_cvt_pk_bf16_f32 v36, v32, v33
    v_cvt_pk_bf16_f32 v37, v34, v35
    v_lshlrev_b32 v32, 16, v36
    v_and_b32 v33, 0xffff0000, v36
    v_lshlrev_b32 v38, 16, v198
    v_and_b32 v39, 0xffff0000, v198
    v_pk_add_f32 v[32:33], v[32:33], v[38:39]
    v_cvt_pk_bf16_f32 v50, v32, v33
    v_lshlrev_b32 v32, 16, v37
    v_and_b32 v33, 0xffff0000, v37
    v_lshlrev_b32 v38, 16, v199
    v_and_b32 v39, 0xffff0000, v199
    v_pk_add_f32 v[32:33], v[32:33], v[38:39]
    v_cvt_pk_bf16_f32 v51, v32, v33
    s_cmp_eq_u32 s92, 0
    s_cbranch_scc0 interleave_layers__linear_attn_block__memory_aug_recurrent_mem_tr__prompt_kernel_xo42
    s_add_u32 s24, s68, 4194304
    buffer_store_dwordx4 v[48:51], v219, s[8:11], s24 offen sc1
    s_branch interleave_layers__linear_attn_block__memory_aug_recurrent_mem_tr__prompt_kernel_xs41
interleave_layers__linear_attn_block__memory_aug_recurrent_mem_tr__prompt_kernel_xo42:
    buffer_store_dwordx2 v[48:49], v243, s[12:15], s68 offen
    buffer_store_dwordx2 v[50:51], v243, s[12:15], s68 offen offset:32
interleave_layers__linear_attn_block__memory_aug_recurrent_mem_tr__prompt_kernel_xs41:
    s_lshr_b32 s25, s64, 2
    s_add_u32 s25, s25, 1
    s_cmp_eq_u32 s92, 0
    s_cselect_b32 s79, s25, -1
    s_cmp_lt_u32 s40, 64
    s_cbranch_scc1 interleave_layers__linear_attn_block__memory_aug_recurrent_mem_tr__prompt_kernel_xp43
    s_waitcnt vmcnt(0)
    s_barrier
    s_cmp_ge_i32 s79, 0
    s_cselect_b32 s24, 0, 2146435072
    v_or_b32 v246, s24, v245
    v_mov_b32 v247, s79
    buffer_store_dword v247, v246, s[8:11], 0 offen sc1
    s_mov_b32 s79, -1
interleave_layers__linear_attn_block__memory_aug_recurrent_mem_tr__prompt_kernel_xp43:
    s_add_u32 s64, s64, 4
    s_add_u32 s65, s65, 5242880
    s_add_u32 s66, s66, 4194304
    s_add_u32 s67, s67, 4194304
    s_add_u32 s68, s68, 163840
    s_branch interleave_layers__linear_attn_block__memory_aug_recurrent_mem_tr__prompt_kernel_p_next
interleave_layers__linear_attn_block__memory_aug_recurrent_mem_tr__prompt_kernel_p_done:
    s_cmp_eq_u32 s92, 0
    s_cbranch_scc0 interleave_layers__linear_attn_block__memory_aug_recurrent_mem_tr__prompt_kernel_end
    s_mov_b32 s92, 1
    s_branch interleave_layers__linear_attn_block__memory_aug_recurrent_mem_tr__prompt_kernel_p_layer
interleave_layers__linear_attn_block__memory_aug_recurrent_mem_tr__prompt_kernel_roleO:
    s_sub_u32 s44, s2, 200
    s_load_dwordx2 s[6:7], s[0:1], 64
    s_waitcnt lgkmcnt(0)
    s_mov_b32 s12, s6
    s_mov_b32 s13, s7
    s_mov_b32 s14, 7864320
    s_mov_b32 s15, 0x00020000
    v_add_u32 v8, 0, v0
    s_mov_b32 s24, 3277
    v_mul_lo_u32 v9, v8, s24
    v_lshrrev_b32 v9, 18, v9
    v_mul_u32_u24 v10, 80, v9
    v_sub_u32 v10, v8, v10
    v_mul_u32_u24 v16, 1312, v9
    v_lshl_add_u32 v16, v10, 4, v16
    v_add_u32 v8, 256, v0
    s_mov_b32 s24, 3277
    v_mul_lo_u32 v9, v8, s24
    v_lshrrev_b32 v9, 18, v9
    v_mul_u32_u24 v10, 80, v9
    v_sub_u32 v10, v8, v10
    v_mul_u32_u24 v17, 1312, v9
    v_lshl_add_u32 v17, v10, 4, v17
    v_add_u32 v8, 512, v0
    s_mov_b32 s24, 3277
    v_mul_lo_u32 v9, v8, s24
    v_lshrrev_b32 v9, 18, v9
    v_mul_u32_u24 v10, 80, v9
    v_sub_u32 v10, v8, v10
    v_mul_u32_u24 v18, 1312, v9
    v_lshl_add_u32 v18, v10, 4, v18
    v_add_u32 v8, 768, v0
    s_mov_b32 s24, 3277
    v_mul_lo_u32 v9, v8, s24
    v_lshrrev_b32 v9, 18, v9
    v_mul_u32_u24 v10, 80, v9
    v_sub_u32 v10, v8, v10
    v_mul_u32_u24 v19, 1312, v9
    v_lshl_add_u32 v19, v10, 4, v19
    v_add_u32 v8, 1024, v0
    s_mov_b32 s24, 3277
    v_mul_lo_u32 v9, v8, s24
    v_lshrrev_b32 v9, 18, v9
    v_mul_u32_u24 v10, 80, v9
    v_sub_u32 v10, v8, v10
    v_mul_u32_u24 v20, 1312, v9
    v_lshl_add_u32 v20, v10, 4, v20
    v_add_u32 v8, 1280, v0
    s_mov_b32 s24, 3277
    v_mul_lo_u32 v9, v8, s24
    v_lshrrev_b32 v9, 18, v9
    v_mul_u32_u24 v10, 80, v9
    v_sub_u32 v10, v8, v10
    v_mul_u32_u24 v21, 1312, v9
    v_lshl_add_u32 v21, v10, 4, v21
    v_add_u32 v8, 1536, v0
    s_mov_b32 s24, 3277
    v_mul_lo_u32 v9, v8, s24
    v_lshrrev_b32 v9, 18, v9
    v_mul_u32_u24 v10, 80, v9
    v_sub_u32 v10, v8, v10
    v_mul_u32_u24 v22, 1312, v9
    v_lshl_add_u32 v22, v10, 4, v22
    v_add_u32 v8, 1792, v0
    s_mov_b32 s24, 3277
    v_mul_lo_u32 v9, v8, s24
    v_lshrrev_b32 v9, 18, v9
    v_mul_u32_u24 v10, 80, v9
    v_sub_u32 v10, v8, v10
    v_mul_u32_u24 v23, 1312, v9
    v_lshl_add_u32 v23, v10, 4, v23
    v_add_u32 v8, 2048, v0
    s_mov_b32 s24, 3277
    v_mul_lo_u32 v9, v8, s24
    v_lshrrev_b32 v9, 18, v9
    v_mul_u32_u24 v10, 80, v9
    v_sub_u32 v10, v8, v10
    v_mul_u32_u24 v24, 1312, v9
    v_lshl_add_u32 v24, v10, 4, v24
    v_add_u32 v8, 2304, v0
    s_mov_b32 s24, 3277
    v_mul_lo_u32 v9, v8, s24
    v_lshrrev_b32 v9, 18, v9
    v_mul_u32_u24 v10, 80, v9
    v_sub_u32 v10, v8, v10
    v_mul_u32_u24 v25, 1312, v9
    v_lshl_add_u32 v25, v10, 4, v25
    v_add_u32 v8, 2560, v0
    s_mov_b32 s24, 3277
    v_mul_lo_u32 v9, v8, s24
    v_lshrrev_b32 v9, 18, v9
    v_mul_u32_u24 v10, 80, v9
    v_sub_u32 v10, v8, v10
    v_mul_u32_u24 v26, 1312, v9
    v_lshl_add_u32 v26, v10, 4, v26
    v_add_u32 v8, 2816, v0
    s_mov_b32 s24, 3277
    v_mul_lo_u32 v9, v8, s24
    v_lshrrev_b32 v9, 18, v9
    v_mul_u32_u24 v10, 80, v9
    v_sub_u32 v10, v8, v10
    v_mul_u32_u24 v27, 1312, v9
    v_lshl_add_u32 v27, v10, 4, v27
    v_add_u32 v8, 3072, v0
    s_mov_b32 s24, 3277
    v_mul_lo_u32 v9, v8, s24
    v_lshrrev_b32 v9, 18, v9
    v_mul_u32_u24 v10, 80, v9
    v_sub_u32 v10, v8, v10
    v_mul_u32_u24 v28, 1312, v9
    v_lshl_add_u32 v28, v10, 4, v28
    v_add_u32 v8, 3328, v0
    s_mov_b32 s24, 3277
    v_mul_lo_u32 v9, v8, s24
    v_lshrrev_b32 v9, 18, v9
    v_mul_u32_u24 v10, 80, v9
    v_sub_u32 v10, v8, v10
    v_mul_u32_u24 v29, 1312, v9
    v_lshl_add_u32 v29, v10, 4, v29
    v_add_u32 v8, 3584, v0
    s_mov_b32 s24, 3277
    v_mul_lo_u32 v9, v8, s24
    v_lshrrev_b32 v9, 18, v9
    v_mul_u32_u24 v10, 80, v9
    v_sub_u32 v10, v8, v10
    v_mul_u32_u24 v30, 1312, v9
    v_lshl_add_u32 v30, v10, 4, v30
    v_add_u32 v8, 3840, v0
    s_mov_b32 s24, 3277
    v_mul_lo_u32 v9, v8, s24
    v_lshrrev_b32 v9, 18, v9
    v_mul_u32_u24 v10, 80, v9
    v_sub_u32 v10, v8, v10
    v_mul_u32_u24 v31, 1312, v9
    v_lshl_add_u32 v31, v10, 4, v31
    v_add_u32 v8, 4096, v0
    s_mov_b32 s24, 3277
    v_mul_lo_u32 v9, v8, s24
    v_lshrrev_b32 v9, 18, v9
    v_mul_u32_u24 v10, 80, v9
    v_sub_u32 v10, v8, v10
    v_mul_u32_u24 v32, 1312, v9
    v_lshl_add_u32 v32, v10, 4, v32
    v_add_u32 v8, 4352, v0
    s_mov_b32 s24, 3277
    v_mul_lo_u32 v9, v8, s24
    v_lshrrev_b32 v9, 18, v9
    v_mul_u32_u24 v10, 80, v9
    v_sub_u32 v10, v8, v10
    v_mul_u32_u24 v33, 1312, v9
    v_lshl_add_u32 v33, v10, 4, v33
    v_add_u32 v8, 4608, v0
    s_mov_b32 s24, 3277
    v_mul_lo_u32 v9, v8, s24
    v_lshrrev_b32 v9, 18, v9
    v_mul_u32_u24 v10, 80, v9
    v_sub_u32 v10, v8, v10
    v_mul_u32_u24 v34, 1312, v9
    v_lshl_add_u32 v34, v10, 4, v34
    v_add_u32 v8, 4864, v0
    s_mov_b32 s24, 3277
    v_mul_lo_u32 v9, v8, s24
    v_lshrrev_b32 v9, 18, v9
    v_mul_u32_u24 v10, 80, v9
    v_sub_u32 v10, v8, v10
    v_mul_u32_u24 v35, 1312, v9
    v_lshl_add_u32 v35, v10, 4, v35
    v_add_u32 v8, 5120, v0
    s_mov_b32 s24, 3277
    v_mul_lo_u32 v9, v8, s24
    v_lshrrev_b32 v9, 18, v9
    v_mul_u32_u24 v10, 80, v9
    v_sub_u32 v10, v8, v10
    v_mul_u32_u24 v36, 1312, v9
    v_lshl_add_u32 v36, v10, 4, v36
    v_add_u32 v8, 5376, v0
    s_mov_b32 s24, 3277
    v_mul_lo_u32 v9, v8, s24
    v_lshrrev_b32 v9, 18, v9
    v_mul_u32_u24 v10, 80, v9
    v_sub_u32 v10, v8, v10
    v_mul_u32_u24 v37, 1312, v9
    v_lshl_add_u32 v37, v10, 4, v37
    v_add_u32 v8, 5632, v0
    s_mov_b32 s24, 3277
    v_mul_lo_u32 v9, v8, s24
    v_lshrrev_b32 v9, 18, v9
    v_mul_u32_u24 v10, 80, v9
    v_sub_u32 v10, v8, v10
    v_mul_u32_u24 v38, 1312, v9
    v_lshl_add_u32 v38, v10, 4, v38
    v_add_u32 v8, 5888, v0
    s_mov_b32 s24, 3277
    v_mul_lo_u32 v9, v8, s24
    v_lshrrev_b32 v9, 18, v9
    v_mul_u32_u24 v10, 80, v9
    v_sub_u32 v10, v8, v10
    v_mul_u32_u24 v39, 1312, v9
    v_lshl_add_u32 v39, v10, 4, v39
    v_add_u32 v8, 6144, v0
    s_mov_b32 s24, 3277
    v_mul_lo_u32 v9, v8, s24
    v_lshrrev_b32 v9, 18, v9
    v_mul_u32_u24 v10, 80, v9
    v_sub_u32 v10, v8, v10
    v_mul_u32_u24 v40, 1312, v9
    v_lshl_add_u32 v40, v10, 4, v40
    v_add_u32 v8, 6400, v0
    s_mov_b32 s24, 3277
    v_mul_lo_u32 v9, v8, s24
    v_lshrrev_b32 v9, 18, v9
    v_mul_u32_u24 v10, 80, v9
    v_sub_u32 v10, v8, v10
    v_mul_u32_u24 v41, 1312, v9
    v_lshl_add_u32 v41, v10, 4, v41
    v_add_u32 v8, 6656, v0
    s_mov_b32 s24, 3277
    v_mul_lo_u32 v9, v8, s24
    v_lshrrev_b32 v9, 18, v9
    v_mul_u32_u24 v10, 80, v9
    v_sub_u32 v10, v8, v10
    v_mul_u32_u24 v42, 1312, v9
    v_lshl_add_u32 v42, v10, 4, v42
    v_add_u32 v8, 6912, v0
    s_mov_b32 s24, 3277
    v_mul_lo_u32 v9, v8, s24
    v_lshrrev_b32 v9, 18, v9
    v_mul_u32_u24 v10, 80, v9
    v_sub_u32 v10, v8, v10
    v_mul_u32_u24 v43, 1312, v9
    v_lshl_add_u32 v43, v10, 4, v43
    v_add_u32 v8, 7168, v0
    s_mov_b32 s24, 3277
    v_mul_lo_u32 v9, v8, s24
    v_lshrrev_b32 v9, 18, v9
    v_mul_u32_u24 v10, 80, v9
    v_sub_u32 v10, v8, v10
    v_mul_u32_u24 v44, 1312, v9
    v_lshl_add_u32 v44, v10, 4, v44
    v_add_u32 v8, 7424, v0
    s_mov_b32 s24, 3277
    v_mul_lo_u32 v9, v8, s24
    v_lshrrev_b32 v9, 18, v9
    v_mul_u32_u24 v10, 80, v9
    v_sub_u32 v10, v8, v10
    v_mul_u32_u24 v45, 1312, v9
    v_lshl_add_u32 v45, v10, 4, v45
    v_lshlrev_b32 v4, 4, v0
    s_mul_i32 s45, s44, 245760
    s_add_u32 s46, s45, 0
    buffer_load_dwordx4 v[48:51], v4, s[12:15], s46 offen
    s_add_u32 s46, s45, 4096
    buffer_load_dwordx4 v[52:55], v4, s[12:15], s46 offen
    s_add_u32 s46, s45, 8192
    buffer_load_dwordx4 v[56:59], v4, s[12:15], s46 offen
    s_add_u32 s46, s45, 12288
    buffer_load_dwordx4 v[60:63], v4, s[12:15], s46 offen
    s_add_u32 s46, s45, 16384
    buffer_load_dwordx4 v[64:67], v4, s[12:15], s46 offen
    s_add_u32 s46, s45, 20480
    buffer_load_dwordx4 v[68:71], v4, s[12:15], s46 offen
    s_add_u32 s46, s45, 24576
    buffer_load_dwordx4 v[72:75], v4, s[12:15], s46 offen
    s_add_u32 s46, s45, 28672
    buffer_load_dwordx4 v[76:79], v4, s[12:15], s46 offen
    s_add_u32 s46, s45, 32768
    buffer_load_dwordx4 v[80:83], v4, s[12:15], s46 offen
    s_add_u32 s46, s45, 36864
    buffer_load_dwordx4 v[84:87], v4, s[12:15], s46 offen
    s_add_u32 s46, s45, 40960
    buffer_load_dwordx4 v[88:91], v4, s[12:15], s46 offen
    s_add_u32 s46, s45, 45056
    buffer_load_dwordx4 v[92:95], v4, s[12:15], s46 offen
    s_add_u32 s46, s45, 49152
    buffer_load_dwordx4 v[96:99], v4, s[12:15], s46 offen
    s_add_u32 s46, s45, 53248
    buffer_load_dwordx4 v[100:103], v4, s[12:15], s46 offen
    s_add_u32 s46, s45, 57344
    buffer_load_dwordx4 v[104:107], v4, s[12:15], s46 offen
    s_add_u32 s46, s45, 61440
    buffer_load_dwordx4 v[108:111], v4, s[12:15], s46 offen
    s_add_u32 s46, s45, 65536
    buffer_load_dwordx4 v[112:115], v4, s[12:15], s46 offen
    s_add_u32 s46, s45, 69632
    buffer_load_dwordx4 v[116:119], v4, s[12:15], s46 offen
    s_add_u32 s46, s45, 73728
    buffer_load_dwordx4 v[120:123], v4, s[12:15], s46 offen
    s_add_u32 s46, s45, 77824
    buffer_load_dwordx4 v[124:127], v4, s[12:15], s46 offen
    s_add_u32 s46, s45, 81920
    buffer_load_dwordx4 v[128:131], v4, s[12:15], s46 offen
    s_add_u32 s46, s45, 86016
    buffer_load_dwordx4 v[132:135], v4, s[12:15], s46 offen
    s_add_u32 s46, s45, 90112
    buffer_load_dwordx4 v[136:139], v4, s[12:15], s46 offen
    s_add_u32 s46, s45, 94208
    buffer_load_dwordx4 v[140:143], v4, s[12:15], s46 offen
    s_add_u32 s46, s45, 98304
    buffer_load_dwordx4 v[144:147], v4, s[12:15], s46 offen
    s_add_u32 s46, s45, 102400
    buffer_load_dwordx4 v[148:151], v4, s[12:15], s46 offen
    s_add_u32 s46, s45, 106496
    buffer_load_dwordx4 v[152:155], v4, s[12:15], s46 offen
    s_add_u32 s46, s45, 110592
    buffer_load_dwordx4 v[156:159], v4, s[12:15], s46 offen
    s_add_u32 s46, s45, 114688
    buffer_load_dwordx4 v[160:163], v4, s[12:15], s46 offen
    s_add_u32 s46, s45, 118784
    buffer_load_dwordx4 v[164:167], v4, s[12:15], s46 offen
    s_add_u32 s46, s45, 122880
    buffer_load_dwordx4 v[168:171], v4, s[12:15], s46 offen
    s_add_u32 s46, s45, 126976
    buffer_load_dwordx4 v[172:175], v4, s[12:15], s46 offen
    s_add_u32 s46, s45, 131072
    buffer_load_dwordx4 v[176:179], v4, s[12:15], s46 offen
    s_add_u32 s46, s45, 135168
    buffer_load_dwordx4 v[180:183], v4, s[12:15], s46 offen
    s_add_u32 s46, s45, 139264
    buffer_load_dwordx4 v[184:187], v4, s[12:15], s46 offen
    s_add_u32 s46, s45, 143360
    buffer_load_dwordx4 v[188:191], v4, s[12:15], s46 offen
    s_add_u32 s46, s45, 147456
    buffer_load_dwordx4 v[192:195], v4, s[12:15], s46 offen
    s_add_u32 s46, s45, 151552
    buffer_load_dwordx4 v[196:199], v4, s[12:15], s46 offen
    s_add_u32 s46, s45, 155648
    buffer_load_dwordx4 v[200:203], v4, s[12:15], s46 offen
    s_add_u32 s46, s45, 159744
    buffer_load_dwordx4 v[204:207], v4, s[12:15], s46 offen
    s_add_u32 s46, s45, 163840
    buffer_load_dwordx4 v[208:211], v4, s[12:15], s46 offen
    s_add_u32 s46, s45, 167936
    buffer_load_dwordx4 v[212:215], v4, s[12:15], s46 offen
    s_add_u32 s46, s45, 172032
    buffer_load_dwordx4 v[216:219], v4, s[12:15], s46 offen
    s_add_u32 s46, s45, 176128
    buffer_load_dwordx4 v[220:223], v4, s[12:15], s46 offen
    s_add_u32 s46, s45, 180224
    buffer_load_dwordx4 v[224:227], v4, s[12:15], s46 offen
    s_add_u32 s46, s45, 184320
    buffer_load_dwordx4 v[228:231], v4, s[12:15], s46 offen
    s_add_u32 s46, s45, 188416
    buffer_load_dwordx4 v[232:235], v4, s[12:15], s46 offen
    s_add_u32 s46, s45, 192512
    buffer_load_dwordx4 v[236:239], v4, s[12:15], s46 offen
    s_add_u32 s46, s45, 196608
    buffer_load_dwordx4 v[240:243], v4, s[12:15], s46 offen
    s_add_u32 s46, s45, 200704
    buffer_load_dwordx4 v[244:247], v4, s[12:15], s46 offen
    s_add_u32 s46, s45, 204800
    buffer_load_dwordx4 v[248:251], v4, s[12:15], s46 offen
    s_add_u32 s46, s45, 208896
    buffer_load_dwordx4 v[252:255], v4, s[12:15], s46 offen
    v_lshrrev_b32 v8, 2, v2
    v_lshl_add_u32 v8, v3, 2, v8
    v_mul_u32_u24 v5, 1312, v8
    v_and_b32 v8, 3, v2
    v_lshl_add_u32 v5, v8, 3, v5
    s_mul_i32 s24, s3, 320
    v_add_u32 v5, s24, v5
    v_add_u32 v6, 62976, v5
    s_waitcnt vmcnt(22)
    ds_write_b128 v16, v[48:51]
    ds_write_b128 v17, v[52:55]
    ds_write_b128 v18, v[56:59]
    ds_write_b128 v19, v[60:63]
    ds_write_b128 v20, v[64:67]
    ds_write_b128 v21, v[68:71]
    ds_write_b128 v22, v[72:75]
    ds_write_b128 v23, v[76:79]
    ds_write_b128 v24, v[80:83]
    ds_write_b128 v25, v[84:87]
    ds_write_b128 v26, v[88:91]
    ds_write_b128 v27, v[92:95]
    ds_write_b128 v28, v[96:99]
    ds_write_b128 v29, v[100:103]
    ds_write_b128 v30, v[104:107]
    ds_write_b128 v31, v[108:111]
    ds_write_b128 v32, v[112:115]
    ds_write_b128 v33, v[116:119]
    ds_write_b128 v34, v[120:123]
    ds_write_b128 v35, v[124:127]
    ds_write_b128 v36, v[128:131]
    ds_write_b128 v37, v[132:135]
    ds_write_b128 v38, v[136:139]
    ds_write_b128 v39, v[140:143]
    ds_write_b128 v40, v[144:147]
    ds_write_b128 v41, v[148:151]
    ds_write_b128 v42, v[152:155]
    ds_write_b128 v43, v[156:159]
    ds_write_b128 v44, v[160:163]
    ds_write_b128 v45, v[164:167]
    s_waitcnt lgkmcnt(0)
    s_add_u32 s46, s45, 212992
    buffer_load_dwordx4 v[48:51], v4, s[12:15], s46 offen
    s_add_u32 s46, s45, 217088
    buffer_load_dwordx4 v[52:55], v4, s[12:15], s46 offen
    s_add_u32 s46, s45, 221184
    buffer_load_dwordx4 v[56:59], v4, s[12:15], s46 offen
    s_add_u32 s46, s45, 225280
    buffer_load_dwordx4 v[60:63], v4, s[12:15], s46 offen
    s_add_u32 s46, s45, 229376
    buffer_load_dwordx4 v[64:67], v4, s[12:15], s46 offen
    s_add_u32 s46, s45, 233472
    buffer_load_dwordx4 v[68:71], v4, s[12:15], s46 offen
    s_add_u32 s46, s45, 237568
    buffer_load_dwordx4 v[72:75], v4, s[12:15], s46 offen
    s_add_u32 s46, s45, 241664
    buffer_load_dwordx4 v[76:79], v4, s[12:15], s46 offen
    s_barrier
    ds_read_b64_tr_b16 a[0:1], v5 offset:0
    ds_read_b64_tr_b16 a[2:3], v5 offset:20992
    ds_read_b64_tr_b16 a[4:5], v6 offset:0
    ds_read_b64_tr_b16 a[6:7], v6 offset:20992
    ds_read_b64_tr_b16 a[16:17], v5 offset:41984
    ds_read_b64_tr_b16 a[18:19], v6 offset:41984
    ds_read_b64_tr_b16 a[24:25], v5 offset:32
    ds_read_b64_tr_b16 a[26:27], v5 offset:21024
    ds_read_b64_tr_b16 a[28:29], v6 offset:32
    ds_read_b64_tr_b16 a[30:31], v6 offset:21024
    ds_read_b64_tr_b16 a[40:41], v5 offset:42016
    ds_read_b64_tr_b16 a[42:43], v6 offset:42016
    ds_read_b64_tr_b16 a[48:49], v5 offset:64
    ds_read_b64_tr_b16 a[50:51], v5 offset:21056
    ds_read_b64_tr_b16 a[52:53], v6 offset:64
    ds_read_b64_tr_b16 a[54:55], v6 offset:21056
    ds_read_b64_tr_b16 a[64:65], v5 offset:42048
    ds_read_b64_tr_b16 a[66:67], v6 offset:42048
    ds_read_b64_tr_b16 a[72:73], v5 offset:96
    ds_read_b64_tr_b16 a[74:75], v5 offset:21088
    ds_read_b64_tr_b16 a[76:77], v6 offset:96
    ds_read_b64_tr_b16 a[78:79], v6 offset:21088
    ds_read_b64_tr_b16 a[88:89], v5 offset:42080
    ds_read_b64_tr_b16 a[90:91], v6 offset:42080
    ds_read_b64_tr_b16 a[96:97], v5 offset:128
    ds_read_b64_tr_b16 a[98:99], v5 offset:21120
    ds_read_b64_tr_b16 a[100:101], v6 offset:128
    ds_read_b64_tr_b16 a[102:103], v6 offset:21120
    ds_read_b64_tr_b16 a[112:113], v5 offset:42112
    ds_read_b64_tr_b16 a[114:115], v6 offset:42112
    ds_read_b64_tr_b16 a[120:121], v5 offset:160
    ds_read_b64_tr_b16 a[122:123], v5 offset:21152
    ds_read_b64_tr_b16 a[124:125], v6 offset:160
    ds_read_b64_tr_b16 a[126:127], v6 offset:21152
    ds_read_b64_tr_b16 a[136:137], v5 offset:42144
    ds_read_b64_tr_b16 a[138:139], v6 offset:42144
    ds_read_b64_tr_b16 a[144:145], v5 offset:192
    ds_read_b64_tr_b16 a[146:147], v5 offset:21184
    ds_read_b64_tr_b16 a[148:149], v6 offset:192
    ds_read_b64_tr_b16 a[150:151], v6 offset:21184
    ds_read_b64_tr_b16 a[160:161], v5 offset:42176
    ds_read_b64_tr_b16 a[162:163], v6 offset:42176
    ds_read_b64_tr_b16 a[168:169], v5 offset:224
    ds_read_b64_tr_b16 a[170:171], v5 offset:21216
    ds_read_b64_tr_b16 a[172:173], v6 offset:224
    ds_read_b64_tr_b16 a[174:175], v6 offset:21216
    ds_read_b64_tr_b16 a[184:185], v5 offset:42208
    ds_read_b64_tr_b16 a[186:187], v6 offset:42208
    ds_read_b64_tr_b16 a[192:193], v5 offset:256
    ds_read_b64_tr_b16 a[194:195], v5 offset:21248
    ds_read_b64_tr_b16 a[196:197], v6 offset:256
    ds_read_b64_tr_b16 a[198:199], v6 offset:21248
    ds_read_b64_tr_b16 a[208:209], v5 offset:42240
    ds_read_b64_tr_b16 a[210:211], v6 offset:42240
    ds_read_b64_tr_b16 a[216:217], v5 offset:288
    ds_read_b64_tr_b16 a[218:219], v5 offset:21280
    ds_read_b64_tr_b16 a[220:221], v6 offset:288
    ds_read_b64_tr_b16 a[222:223], v6 offset:21280
    ds_read_b64_tr_b16 a[232:233], v5 offset:42272
    ds_read_b64_tr_b16 a[234:235], v6 offset:42272
    s_waitcnt lgkmcnt(0)
    s_barrier
    s_waitcnt vmcnt(0)
    ds_write_b128 v16, v[168:171]
    ds_write_b128 v17, v[172:175]
    ds_write_b128 v18, v[176:179]
    ds_write_b128 v19, v[180:183]
    ds_write_b128 v20, v[184:187]
    ds_write_b128 v21, v[188:191]
    ds_write_b128 v22, v[192:195]
    ds_write_b128 v23, v[196:199]
    ds_write_b128 v24, v[200:203]
    ds_write_b128 v25, v[204:207]
    ds_write_b128 v26, v[208:211]
    ds_write_b128 v27, v[212:215]
    ds_write_b128 v28, v[216:219]
    ds_write_b128 v29, v[220:223]
    ds_write_b128 v30, v[224:227]
    ds_write_b128 v31, v[228:231]
    ds_write_b128 v32, v[232:235]
    ds_write_b128 v33, v[236:239]
    ds_write_b128 v34, v[240:243]
    ds_write_b128 v35, v[244:247]
    ds_write_b128 v36, v[248:251]
    ds_write_b128 v37, v[252:255]
    ds_write_b128 v38, v[48:51]
    ds_write_b128 v39, v[52:55]
    ds_write_b128 v40, v[56:59]
    ds_write_b128 v41, v[60:63]
    ds_write_b128 v42, v[64:67]
    ds_write_b128 v43, v[68:71]
    ds_write_b128 v44, v[72:75]
    ds_write_b128 v45, v[76:79]
    s_waitcnt lgkmcnt(0)
    s_barrier
    ds_read_b64_tr_b16 a[8:9], v5 offset:0
    ds_read_b64_tr_b16 a[10:11], v5 offset:20992
    ds_read_b64_tr_b16 a[12:13], v6 offset:0
    ds_read_b64_tr_b16 a[14:15], v6 offset:20992
    ds_read_b64_tr_b16 a[20:21], v5 offset:41984
    ds_read_b64_tr_b16 a[22:23], v6 offset:41984
    ds_read_b64_tr_b16 a[32:33], v5 offset:32
    ds_read_b64_tr_b16 a[34:35], v5 offset:21024
    ds_read_b64_tr_b16 a[36:37], v6 offset:32
    ds_read_b64_tr_b16 a[38:39], v6 offset:21024
    ds_read_b64_tr_b16 a[44:45], v5 offset:42016
    ds_read_b64_tr_b16 a[46:47], v6 offset:42016
    ds_read_b64_tr_b16 a[56:57], v5 offset:64
    ds_read_b64_tr_b16 a[58:59], v5 offset:21056
    ds_read_b64_tr_b16 a[60:61], v6 offset:64
    ds_read_b64_tr_b16 a[62:63], v6 offset:21056
    ds_read_b64_tr_b16 a[68:69], v5 offset:42048
    ds_read_b64_tr_b16 a[70:71], v6 offset:42048
    ds_read_b64_tr_b16 a[80:81], v5 offset:96
    ds_read_b64_tr_b16 a[82:83], v5 offset:21088
    ds_read_b64_tr_b16 a[84:85], v6 offset:96
    ds_read_b64_tr_b16 a[86:87], v6 offset:21088
    ds_read_b64_tr_b16 a[92:93], v5 offset:42080
    ds_read_b64_tr_b16 a[94:95], v6 offset:42080
    ds_read_b64_tr_b16 a[104:105], v5 offset:128
    ds_read_b64_tr_b16 a[106:107], v5 offset:21120
    ds_read_b64_tr_b16 a[108:109], v6 offset:128
    ds_read_b64_tr_b16 a[110:111], v6 offset:21120
    ds_read_b64_tr_b16 a[116:117], v5 offset:42112
    ds_read_b64_tr_b16 a[118:119], v6 offset:42112
    ds_read_b64_tr_b16 a[128:129], v5 offset:160
    ds_read_b64_tr_b16 a[130:131], v5 offset:21152
    ds_read_b64_tr_b16 a[132:133], v6 offset:160
    ds_read_b64_tr_b16 a[134:135], v6 offset:21152
    ds_read_b64_tr_b16 a[140:141], v5 offset:42144
    ds_read_b64_tr_b16 a[142:143], v6 offset:42144
    ds_read_b64_tr_b16 a[152:153], v5 offset:192
    ds_read_b64_tr_b16 a[154:155], v5 offset:21184
    ds_read_b64_tr_b16 a[156:157], v6 offset:192
    ds_read_b64_tr_b16 a[158:159], v6 offset:21184
    ds_read_b64_tr_b16 a[164:165], v5 offset:42176
    ds_read_b64_tr_b16 a[166:167], v6 offset:42176
    ds_read_b64_tr_b16 a[176:177], v5 offset:224
    ds_read_b64_tr_b16 a[178:179], v5 offset:21216
    ds_read_b64_tr_b16 a[180:181], v6 offset:224
    ds_read_b64_tr_b16 a[182:183], v6 offset:21216
    ds_read_b64_tr_b16 a[188:189], v5 offset:42208
    ds_read_b64_tr_b16 a[190:191], v6 offset:42208
    ds_read_b64_tr_b16 a[200:201], v5 offset:256
    ds_read_b64_tr_b16 a[202:203], v5 offset:21248
    ds_read_b64_tr_b16 a[204:205], v6 offset:256
    ds_read_b64_tr_b16 a[206:207], v6 offset:21248
    ds_read_b64_tr_b16 a[212:213], v5 offset:42240
    ds_read_b64_tr_b16 a[214:215], v6 offset:42240
    ds_read_b64_tr_b16 a[224:225], v5 offset:288
    ds_read_b64_tr_b16 a[226:227], v5 offset:21280
    ds_read_b64_tr_b16 a[228:229], v6 offset:288
    ds_read_b64_tr_b16 a[230:231], v6 offset:21280
    ds_read_b64_tr_b16 a[236:237], v5 offset:42272
    ds_read_b64_tr_b16 a[238:239], v6 offset:42272
    s_waitcnt lgkmcnt(0)
    s_barrier
    v_lshlrev_b32 v5, 4, v1
    s_mul_i32 s24, s44, 12288
    v_add_u32 v6, s24, v5
    v_add_u32 v7, 4096, v6
    v_add_u32 v8, 8192, v6
    s_mul_i32 s24, s3, 327680
    s_lshl_b32 s25, s44, 10
    s_add_u32 s24, s24, s25
    v_add_u32 v9, s24, v5
interleave_layers__linear_attn_block__memory_aug_recurrent_mem_tr__prompt_kernel_o_layer:
    s_mov_b32 s93, 0
    s_lshl_b32 s24, s93, 12
    s_and_b32 s24, s24, 0x2000
    s_xor_b32 s24, s24, s36
    s_lshl_b32 s93, s93, 20
    s_add_u32 s93, s93, s24
    s_add_u32 s93, s93, 117440512
    s_mul_i32 s94, s92, 16384
    s_add_u32 s94, s94, 23068672
    s_mov_b32 s24, 12288
    s_lshl_b32 s25, s44, 7
    s_add_u32 s24, s24, s25
    s_add_u32 s24, s24, s94
    v_mov_b32 v14, s24
    v_mov_b32 v15, 2146435072
    v_cmp_eq_u32 vcc, 0, v1
    s_nop 1
    v_cndmask_b32 v14, v15, v14, vcc
    s_lshl_b32 s24, s44, 7
    s_add_u32 s24, s24, 8192
    s_add_u32 s24, s24, s94
    v_mov_b32 v10, s24
    s_mov_b32 s41, 33554432
    s_mov_b32 s43, 184549376
    s_mov_b32 s40, 0
    s_mov_b32 s62, -1
    s_mov_b32 s63, 1
    s_cmp_ge_i32 s62, s63
    s_cbranch_scc1 interleave_layers__linear_attn_block__memory_aug_recurrent_mem_tr__prompt_kernel_o_en0_ok
    s_mov_b32 s61, 0
interleave_layers__linear_attn_block__memory_aug_recurrent_mem_tr__prompt_kernel_o_en0:
    buffer_load_dword v11, v10, s[8:11], 0 offen sc1
    s_waitcnt vmcnt(0)
    v_readlane_b32 s62, v11, 0
    s_cmp_ge_i32 s62, s63
    s_cbranch_scc1 interleave_layers__linear_attn_block__memory_aug_recurrent_mem_tr__prompt_kernel_o_en0_ok
    s_add_u32 s61, s61, 1
    s_cmp_ge_u32 s61, s60
    s_cbranch_scc1 interleave_layers__linear_attn_block__memory_aug_recurrent_mem_tr__prompt_kernel_o_en0_to
    s_sleep 2
    s_branch interleave_layers__linear_attn_block__memory_aug_recurrent_mem_tr__prompt_kernel_o_en0
interleave_layers__linear_attn_block__memory_aug_recurrent_mem_tr__prompt_kernel_o_en0_to:
    s_mov_b32 s60, 1
interleave_layers__linear_attn_block__memory_aug_recurrent_mem_tr__prompt_kernel_o_en0_ok:
    buffer_load_dwordx4 v[16:19], v6, s[8:11], s41 offen offset:0 sc1
    buffer_load_dwordx4 v[20:23], v6, s[8:11], s41 offen offset:1024 sc1
    buffer_load_dwordx4 v[24:27], v6, s[8:11], s41 offen offset:2048 sc1
    buffer_load_dwordx4 v[28:31], v6, s[8:11], s41 offen offset:3072 sc1
    buffer_load_dwordx4 v[32:35], v7, s[8:11], s41 offen offset:0 sc1
    buffer_load_dwordx4 v[36:39], v7, s[8:11], s41 offen offset:1024 sc1
    buffer_load_dwordx4 v[40:43], v7, s[8:11], s41 offen offset:2048 sc1
    buffer_load_dwordx4 v[44:47], v7, s[8:11], s41 offen offset:3072 sc1
    buffer_load_dwordx4 v[48:51], v8, s[8:11], s41 offen offset:0 sc1
    buffer_load_dwordx4 v[52:55], v8, s[8:11], s41 offen offset:1024 sc1
    buffer_load_dwordx4 v[56:59], v8, s[8:11], s41 offen offset:2048 sc1
    buffer_load_dwordx4 v[60:63], v8, s[8:11], s41 offen offset:3072 sc1
    s_add_u32 s41, s41, 393216
    s_waitcnt vmcnt(0)
interleave_layers__linear_attn_block__memory_aug_recurrent_mem_tr__prompt_kernel_o_seg:
    v_swap_b32 v26, v36
    v_swap_b32 v27, v37
    v_swap_b32 v50, v60
    v_swap_b32 v51, v61
    buffer_load_dword v232, v10, s[8:11], 0 offen sc1
    v_mfma_f32_16x16x32_bf16 v[112:115], v[16:19], a[0:3], 0
    v_mfma_f32_16x16x32_bf16 v[116:119], v[20:23], a[0:3], 0
    v_mfma_f32_16x16x32_bf16 v[120:123], v[16:19], a[24:27], 0
    v_mfma_f32_16x16x32_bf16 v[124:127], v[20:23], a[24:27], 0
    v_mfma_f32_16x16x32_bf16 v[128:131], v[16:19], a[48:51], 0
    v_mfma_f32_16x16x32_bf16 v[132:135], v[20:23], a[48:51], 0
    v_mfma_f32_16x16x32_bf16 v[136:139], v[16:19], a[72:75], 0
    v_mfma_f32_16x16x32_bf16 v[140:143], v[20:23], a[72:75], 0
    v_mfma_f32_16x16x32_bf16 v[144:147], v[16:19], a[96:99], 0
    v_mfma_f32_16x16x32_bf16 v[148:151], v[20:23], a[96:99], 0
    v_mfma_f32_16x16x32_bf16 v[152:155], v[16:19], a[120:123], 0
    v_mfma_f32_16x16x32_bf16 v[156:159], v[20:23], a[120:123], 0
    v_mfma_f32_16x16x32_bf16 v[160:163], v[16:19], a[144:147], 0
    v_mfma_f32_16x16x32_bf16 v[164:167], v[20:23], a[144:147], 0
    v_mfma_f32_16x16x32_bf16 v[168:171], v[16:19], a[168:171], 0
    v_mfma_f32_16x16x32_bf16 v[172:175], v[20:23], a[168:171], 0
    v_mfma_f32_16x16x32_bf16 v[176:179], v[16:19], a[192:195], 0
    v_mfma_f32_16x16x32_bf16 v[180:183], v[20:23], a[192:195], 0
    v_mfma_f32_16x16x32_bf16 v[184:187], v[16:19], a[216:219], 0
    v_mfma_f32_16x16x32_bf16 v[188:191], v[20:23], a[216:219], 0
    v_mfma_f32_16x16x32_bf16 v[112:115], v[28:31], a[4:7], v[112:115]
    v_mfma_f32_16x16x32_bf16 v[116:119], v[32:35], a[4:7], v[116:119]
    v_mfma_f32_16x16x32_bf16 v[120:123], v[28:31], a[28:31], v[120:123]
    v_mfma_f32_16x16x32_bf16 v[124:127], v[32:35], a[28:31], v[124:127]
    v_mfma_f32_16x16x32_bf16 v[128:131], v[28:31], a[52:55], v[128:131]
    v_mfma_f32_16x16x32_bf16 v[132:135], v[32:35], a[52:55], v[132:135]
    v_mfma_f32_16x16x32_bf16 v[136:139], v[28:31], a[76:79], v[136:139]
    v_mfma_f32_16x16x32_bf16 v[140:143], v[32:35], a[76:79], v[140:143]
    v_mfma_f32_16x16x32_bf16 v[144:147], v[28:31], a[100:103], v[144:147]
    v_mfma_f32_16x16x32_bf16 v[148:151], v[32:35], a[100:103], v[148:151]
    v_mfma_f32_16x16x32_bf16 v[152:155], v[28:31], a[124:127], v[152:155]
    v_mfma_f32_16x16x32_bf16 v[156:159], v[32:35], a[124:127], v[156:159]
    v_mfma_f32_16x16x32_bf16 v[160:163], v[28:31], a[148:151], v[160:163]
    v_mfma_f32_16x16x32_bf16 v[164:167], v[32:35], a[148:151], v[164:167]
    v_mfma_f32_16x16x32_bf16 v[168:171], v[28:31], a[172:175], v[168:171]
    v_mfma_f32_16x16x32_bf16 v[172:175], v[32:35], a[172:175], v[172:175]
    v_mfma_f32_16x16x32_bf16 v[176:179], v[28:31], a[196:199], v[176:179]
    v_mfma_f32_16x16x32_bf16 v[180:183], v[32:35], a[196:199], v[180:183]
    v_mfma_f32_16x16x32_bf16 v[184:187], v[28:31], a[220:223], v[184:187]
    v_mfma_f32_16x16x32_bf16 v[188:191], v[32:35], a[220:223], v[188:191]
    v_mfma_f32_16x16x32_bf16 v[112:115], v[40:43], a[8:11], v[112:115]
    v_mfma_f32_16x16x32_bf16 v[116:119], v[44:47], a[8:11], v[116:119]
    v_mfma_f32_16x16x32_bf16 v[120:123], v[40:43], a[32:35], v[120:123]
    v_mfma_f32_16x16x32_bf16 v[124:127], v[44:47], a[32:35], v[124:127]
    v_mfma_f32_16x16x32_bf16 v[128:131], v[40:43], a[56:59], v[128:131]
    v_mfma_f32_16x16x32_bf16 v[132:135], v[44:47], a[56:59], v[132:135]
    v_mfma_f32_16x16x32_bf16 v[136:139], v[40:43], a[80:83], v[136:139]
    v_mfma_f32_16x16x32_bf16 v[140:143], v[44:47], a[80:83], v[140:143]
    v_mfma_f32_16x16x32_bf16 v[144:147], v[40:43], a[104:107], v[144:147]
    v_mfma_f32_16x16x32_bf16 v[148:151], v[44:47], a[104:107], v[148:151]
    v_mfma_f32_16x16x32_bf16 v[152:155], v[40:43], a[128:131], v[152:155]
    v_mfma_f32_16x16x32_bf16 v[156:159], v[44:47], a[128:131], v[156:159]
    v_mfma_f32_16x16x32_bf16 v[160:163], v[40:43], a[152:155], v[160:163]
    v_mfma_f32_16x16x32_bf16 v[164:167], v[44:47], a[152:155], v[164:167]
    v_mfma_f32_16x16x32_bf16 v[168:171], v[40:43], a[176:179], v[168:171]
    v_mfma_f32_16x16x32_bf16 v[172:175], v[44:47], a[176:179], v[172:175]
    v_mfma_f32_16x16x32_bf16 v[176:179], v[40:43], a[200:203], v[176:179]
    v_mfma_f32_16x16x32_bf16 v[180:183], v[44:47], a[200:203], v[180:183]
    v_mfma_f32_16x16x32_bf16 v[184:187], v[40:43], a[224:227], v[184:187]
    v_mfma_f32_16x16x32_bf16 v[188:191], v[44:47], a[224:227], v[188:191]
    s_waitcnt vmcnt(0)
    v_readfirstlane_b32 s24, v232
    s_max_i32 s62, s62, s24
    s_add_u32 s63, s40, 2
    s_min_u32 s63, s63, 64
    s_cmp_ge_i32 s62, s63
    s_cselect_b32 s24, 1, 0
    s_lshl_b32 s25, s3, 4
    s_add_u32 s25, s25, 0
    v_mov_b32 v12, s25
    v_mov_b32 v13, s24
    ds_write_b32 v12, v13
    v_mov_b32 v12, 0
    s_waitcnt lgkmcnt(0)
    s_barrier
    ds_read_b32 v13, v12
    s_cmp_eq_u32 s3, 0
    s_cbranch_scc0 interleave_layers__linear_attn_block__memory_aug_recurrent_mem_tr__prompt_kernel_fp45
    v_mov_b32 v15, s40
    buffer_store_dword v15, v14, s[8:11], 0 offen sc1
interleave_layers__linear_attn_block__memory_aug_recurrent_mem_tr__prompt_kernel_fp45:
    s_waitcnt lgkmcnt(0)
    v_readfirstlane_b32 s58, v13
    s_cmp_eq_u32 s58, 1
    s_cbranch_scc0 interleave_layers__linear_attn_block__memory_aug_recurrent_mem_tr__prompt_kernel_of44
    s_max_i32 s62, s62, s63
    buffer_load_dwordx4 v[64:67], v6, s[8:11], s41 offen offset:0 sc1
    buffer_load_dwordx4 v[68:71], v6, s[8:11], s41 offen offset:1024 sc1
    buffer_load_dwordx4 v[72:75], v6, s[8:11], s41 offen offset:2048 sc1
    buffer_load_dwordx4 v[76:79], v6, s[8:11], s41 offen offset:3072 sc1
    buffer_load_dwordx4 v[80:83], v7, s[8:11], s41 offen offset:0 sc1
    buffer_load_dwordx4 v[84:87], v7, s[8:11], s41 offen offset:1024 sc1
    buffer_load_dwordx4 v[88:91], v7, s[8:11], s41 offen offset:2048 sc1
    buffer_load_dwordx4 v[92:95], v7, s[8:11], s41 offen offset:3072 sc1
    buffer_load_dwordx4 v[96:99], v8, s[8:11], s41 offen offset:0 sc1
    buffer_load_dwordx4 v[100:103], v8, s[8:11], s41 offen offset:1024 sc1
    buffer_load_dwordx4 v[104:107], v8, s[8:11], s41 offen offset:2048 sc1
    buffer_load_dwordx4 v[108:111], v8, s[8:11], s41 offen offset:3072 sc1
    s_add_u32 s41, s41, 393216
interleave_layers__linear_attn_block__memory_aug_recurrent_mem_tr__prompt_kernel_of44:
    v_mfma_f32_16x16x32_bf16 v[112:115], v[52:55], a[12:15], v[112:115]
    v_mfma_f32_16x16x32_bf16 v[116:119], v[56:59], a[12:15], v[116:119]
    v_mfma_f32_16x16x32_bf16 v[120:123], v[52:55], a[36:39], v[120:123]
    v_mfma_f32_16x16x32_bf16 v[124:127], v[56:59], a[36:39], v[124:127]
    v_mfma_f32_16x16x32_bf16 v[128:131], v[52:55], a[60:63], v[128:131]
    v_mfma_f32_16x16x32_bf16 v[132:135], v[56:59], a[60:63], v[132:135]
    v_mfma_f32_16x16x32_bf16 v[136:139], v[52:55], a[84:87], v[136:139]
    v_mfma_f32_16x16x32_bf16 v[140:143], v[56:59], a[84:87], v[140:143]
    v_mfma_f32_16x16x32_bf16 v[144:147], v[52:55], a[108:111], v[144:147]
    v_mfma_f32_16x16x32_bf16 v[148:151], v[56:59], a[108:111], v[148:151]
    v_mfma_f32_16x16x32_bf16 v[152:155], v[52:55], a[132:135], v[152:155]
    v_mfma_f32_16x16x32_bf16 v[156:159], v[56:59], a[132:135], v[156:159]
    v_mfma_f32_16x16x32_bf16 v[160:163], v[52:55], a[156:159], v[160:163]
    v_mfma_f32_16x16x32_bf16 v[164:167], v[56:59], a[156:159], v[164:167]
    v_mfma_f32_16x16x32_bf16 v[168:171], v[52:55], a[180:183], v[168:171]
    v_mfma_f32_16x16x32_bf16 v[172:175], v[56:59], a[180:183], v[172:175]
    v_mfma_f32_16x16x32_bf16 v[176:179], v[52:55], a[204:207], v[176:179]
    v_mfma_f32_16x16x32_bf16 v[180:183], v[56:59], a[204:207], v[180:183]
    v_mfma_f32_16x16x32_bf16 v[184:187], v[52:55], a[228:231], v[184:187]
    v_mfma_f32_16x16x32_bf16 v[188:191], v[56:59], a[228:231], v[188:191]
    v_mfma_f32_16x16x32_bf16 v[112:115], v[24:27], a[16:19], v[112:115]
    v_mfma_f32_16x16x32_bf16 v[116:119], v[36:39], a[16:19], v[116:119]
    v_mfma_f32_16x16x32_bf16 v[120:123], v[24:27], a[40:43], v[120:123]
    v_mfma_f32_16x16x32_bf16 v[124:127], v[36:39], a[40:43], v[124:127]
    v_mfma_f32_16x16x32_bf16 v[128:131], v[24:27], a[64:67], v[128:131]
    v_mfma_f32_16x16x32_bf16 v[132:135], v[36:39], a[64:67], v[132:135]
    v_mfma_f32_16x16x32_bf16 v[136:139], v[24:27], a[88:91], v[136:139]
    v_mfma_f32_16x16x32_bf16 v[140:143], v[36:39], a[88:91], v[140:143]
    v_mfma_f32_16x16x32_bf16 v[144:147], v[24:27], a[112:115], v[144:147]
    v_mfma_f32_16x16x32_bf16 v[148:151], v[36:39], a[112:115], v[148:151]
    v_mfma_f32_16x16x32_bf16 v[152:155], v[24:27], a[136:139], v[152:155]
    v_mfma_f32_16x16x32_bf16 v[156:159], v[36:39], a[136:139], v[156:159]
    v_mfma_f32_16x16x32_bf16 v[160:163], v[24:27], a[160:163], v[160:163]
    v_mfma_f32_16x16x32_bf16 v[164:167], v[36:39], a[160:163], v[164:167]
    v_mfma_f32_16x16x32_bf16 v[168:171], v[24:27], a[184:187], v[168:171]
    v_mfma_f32_16x16x32_bf16 v[172:175], v[36:39], a[184:187], v[172:175]
    v_mfma_f32_16x16x32_bf16 v[176:179], v[24:27], a[208:211], v[176:179]
    v_mfma_f32_16x16x32_bf16 v[180:183], v[36:39], a[208:211], v[180:183]
    v_mfma_f32_16x16x32_bf16 v[184:187], v[24:27], a[232:235], v[184:187]
    v_mfma_f32_16x16x32_bf16 v[188:191], v[36:39], a[232:235], v[188:191]
    buffer_load_dword v233, v10, s[8:11], 0 offen sc1
    v_mfma_f32_16x16x32_bf16 v[112:115], v[48:51], a[20:23], v[112:115]
    v_mfma_f32_16x16x32_bf16 v[116:119], v[60:63], a[20:23], v[116:119]
    v_mfma_f32_16x16x32_bf16 v[120:123], v[48:51], a[44:47], v[120:123]
    v_mfma_f32_16x16x32_bf16 v[124:127], v[60:63], a[44:47], v[124:127]
    v_mfma_f32_16x16x32_bf16 v[128:131], v[48:51], a[68:71], v[128:131]
    v_mfma_f32_16x16x32_bf16 v[132:135], v[60:63], a[68:71], v[132:135]
    v_mfma_f32_16x16x32_bf16 v[136:139], v[48:51], a[92:95], v[136:139]
    v_mfma_f32_16x16x32_bf16 v[140:143], v[60:63], a[92:95], v[140:143]
    v_mfma_f32_16x16x32_bf16 v[144:147], v[48:51], a[116:119], v[144:147]
    v_mfma_f32_16x16x32_bf16 v[148:151], v[60:63], a[116:119], v[148:151]
    v_mfma_f32_16x16x32_bf16 v[152:155], v[48:51], a[140:143], v[152:155]
    v_mfma_f32_16x16x32_bf16 v[156:159], v[60:63], a[140:143], v[156:159]
    v_mfma_f32_16x16x32_bf16 v[160:163], v[48:51], a[164:167], v[160:163]
    v_mfma_f32_16x16x32_bf16 v[164:167], v[60:63], a[164:167], v[164:167]
    v_mfma_f32_16x16x32_bf16 v[168:171], v[48:51], a[188:191], v[168:171]
    v_mfma_f32_16x16x32_bf16 v[172:175], v[60:63], a[188:191], v[172:175]
    v_mfma_f32_16x16x32_bf16 v[176:179], v[48:51], a[212:215], v[176:179]
    v_mfma_f32_16x16x32_bf16 v[180:183], v[60:63], a[212:215], v[180:183]
    v_mfma_f32_16x16x32_bf16 v[184:187], v[48:51], a[236:239], v[184:187]
    v_mfma_f32_16x16x32_bf16 v[188:191], v[60:63], a[236:239], v[188:191]
    s_mov_b32 s46, s43
    v_cvt_pk_bf16_f32 v192, v112, v113
    v_cvt_pk_bf16_f32 v193, v114, v115
    v_cvt_pk_bf16_f32 v194, v116, v117
    v_cvt_pk_bf16_f32 v195, v118, v119
    buffer_store_dwordx4 v[192:195], v9, s[8:11], s46 offen sc1
    s_add_u32 s46, s46, 32768
    v_cvt_pk_bf16_f32 v196, v120, v121
    v_cvt_pk_bf16_f32 v197, v122, v123
    v_cvt_pk_bf16_f32 v198, v124, v125
    v_cvt_pk_bf16_f32 v199, v126, v127
    buffer_store_dwordx4 v[196:199], v9, s[8:11], s46 offen sc1
    s_add_u32 s46, s46, 32768
    v_cvt_pk_bf16_f32 v200, v128, v129
    v_cvt_pk_bf16_f32 v201, v130, v131
    v_cvt_pk_bf16_f32 v202, v132, v133
    v_cvt_pk_bf16_f32 v203, v134, v135
    buffer_store_dwordx4 v[200:203], v9, s[8:11], s46 offen sc1
    s_add_u32 s46, s46, 32768
    v_cvt_pk_bf16_f32 v204, v136, v137
    v_cvt_pk_bf16_f32 v205, v138, v139
    v_cvt_pk_bf16_f32 v206, v140, v141
    v_cvt_pk_bf16_f32 v207, v142, v143
    buffer_store_dwordx4 v[204:207], v9, s[8:11], s46 offen sc1
    s_add_u32 s46, s46, 32768
    v_cvt_pk_bf16_f32 v208, v144, v145
    v_cvt_pk_bf16_f32 v209, v146, v147
    v_cvt_pk_bf16_f32 v210, v148, v149
    v_cvt_pk_bf16_f32 v211, v150, v151
    buffer_store_dwordx4 v[208:211], v9, s[8:11], s46 offen sc1
    s_add_u32 s46, s46, 32768
    v_cvt_pk_bf16_f32 v212, v152, v153
    v_cvt_pk_bf16_f32 v213, v154, v155
    v_cvt_pk_bf16_f32 v214, v156, v157
    v_cvt_pk_bf16_f32 v215, v158, v159
    buffer_store_dwordx4 v[212:215], v9, s[8:11], s46 offen sc1
    s_add_u32 s46, s46, 32768
    v_cvt_pk_bf16_f32 v216, v160, v161
    v_cvt_pk_bf16_f32 v217, v162, v163
    v_cvt_pk_bf16_f32 v218, v164, v165
    v_cvt_pk_bf16_f32 v219, v166, v167
    buffer_store_dwordx4 v[216:219], v9, s[8:11], s46 offen sc1
    s_add_u32 s46, s46, 32768
    v_cvt_pk_bf16_f32 v220, v168, v169
    v_cvt_pk_bf16_f32 v221, v170, v171
    v_cvt_pk_bf16_f32 v222, v172, v173
    v_cvt_pk_bf16_f32 v223, v174, v175
    buffer_store_dwordx4 v[220:223], v9, s[8:11], s46 offen sc1
    s_add_u32 s46, s46, 32768
    v_cvt_pk_bf16_f32 v224, v176, v177
    v_cvt_pk_bf16_f32 v225, v178, v179
    v_cvt_pk_bf16_f32 v226, v180, v181
    v_cvt_pk_bf16_f32 v227, v182, v183
    buffer_store_dwordx4 v[224:227], v9, s[8:11], s46 offen sc1
    s_add_u32 s46, s46, 32768
    v_cvt_pk_bf16_f32 v228, v184, v185
    v_cvt_pk_bf16_f32 v229, v186, v187
    v_cvt_pk_bf16_f32 v230, v188, v189
    v_cvt_pk_bf16_f32 v231, v190, v191
    buffer_store_dwordx4 v[228:231], v9, s[8:11], s46 offen sc1
    s_cmp_eq_u32 s58, 1
    s_cbranch_scc1 interleave_layers__linear_attn_block__memory_aug_recurrent_mem_tr__prompt_kernel_of46
    s_waitcnt vmcnt(10)
    v_readfirstlane_b32 s24, v233
    s_max_i32 s62, s62, s24
    s_add_u32 s63, s40, 2
    s_min_u32 s63, s63, 64
    s_cmp_ge_i32 s62, s63
    s_cbranch_scc0 interleave_layers__linear_attn_block__memory_aug_recurrent_mem_tr__prompt_kernel_oo47
    buffer_load_dwordx4 v[64:67], v6, s[8:11], s41 offen offset:0 sc1
    buffer_load_dwordx4 v[68:71], v6, s[8:11], s41 offen offset:1024 sc1
    buffer_load_dwordx4 v[72:75], v6, s[8:11], s41 offen offset:2048 sc1
    buffer_load_dwordx4 v[76:79], v6, s[8:11], s41 offen offset:3072 sc1
    buffer_load_dwordx4 v[80:83], v7, s[8:11], s41 offen offset:0 sc1
    buffer_load_dwordx4 v[84:87], v7, s[8:11], s41 offen offset:1024 sc1
    buffer_load_dwordx4 v[88:91], v7, s[8:11], s41 offen offset:2048 sc1
    buffer_load_dwordx4 v[92:95], v7, s[8:11], s41 offen offset:3072 sc1
    buffer_load_dwordx4 v[96:99], v8, s[8:11], s41 offen offset:0 sc1
    buffer_load_dwordx4 v[100:103], v8, s[8:11], s41 offen offset:1024 sc1
    buffer_load_dwordx4 v[104:107], v8, s[8:11], s41 offen offset:2048 sc1
    buffer_load_dwordx4 v[108:111], v8, s[8:11], s41 offen offset:3072 sc1
    s_add_u32 s41, s41, 393216
    s_waitcnt vmcnt(12)
    s_barrier
    s_add_u32 s24, s40, 1
    s_cmp_eq_u32 s3, 0
    s_cbranch_scc0 interleave_layers__linear_attn_block__memory_aug_recurrent_mem_tr__prompt_kernel_fp48
    v_mov_b32 v15, s24
    buffer_store_dword v15, v14, s[8:11], 0 offen sc1
interleave_layers__linear_attn_block__memory_aug_recurrent_mem_tr__prompt_kernel_fp48:
    s_waitcnt vmcnt(0)
    s_branch interleave_layers__linear_attn_block__memory_aug_recurrent_mem_tr__prompt_kernel_of46
interleave_layers__linear_attn_block__memory_aug_recurrent_mem_tr__prompt_kernel_oo47:
    s_waitcnt vmcnt(0)
    s_barrier
    s_add_u32 s24, s40, 1
    s_cmp_eq_u32 s3, 0
    s_cbranch_scc0 interleave_layers__linear_attn_block__memory_aug_recurrent_mem_tr__prompt_kernel_fp49
    v_mov_b32 v15, s24
    buffer_store_dword v15, v14, s[8:11], 0 offen sc1
interleave_layers__linear_attn_block__memory_aug_recurrent_mem_tr__prompt_kernel_fp49:
    s_add_u32 s63, s40, 2
    s_min_u32 s63, s63, 64
    s_cmp_ge_i32 s62, s63
    s_cbranch_scc1 interleave_layers__linear_attn_block__memory_aug_recurrent_mem_tr__prompt_kernel_o_en3_ok
    s_mov_b32 s61, 0
interleave_layers__linear_attn_block__memory_aug_recurrent_mem_tr__prompt_kernel_o_en3:
    buffer_load_dword v11, v10, s[8:11], 0 offen sc1
    s_waitcnt vmcnt(0)
    v_readlane_b32 s62, v11, 0
    s_cmp_ge_i32 s62, s63
    s_cbranch_scc1 interleave_layers__linear_attn_block__memory_aug_recurrent_mem_tr__prompt_kernel_o_en3_ok
    s_add_u32 s61, s61, 1
    s_cmp_ge_u32 s61, s60
    s_cbranch_scc1 interleave_layers__linear_attn_block__memory_aug_recurrent_mem_tr__prompt_kernel_o_en3_to
    s_sleep 2
    s_branch interleave_layers__linear_attn_block__memory_aug_recurrent_mem_tr__prompt_kernel_o_en3
interleave_layers__linear_attn_block__memory_aug_recurrent_mem_tr__prompt_kernel_o_en3_to:
    s_mov_b32 s60, 1
interleave_layers__linear_attn_block__memory_aug_recurrent_mem_tr__prompt_kernel_o_en3_ok:
    buffer_load_dwordx4 v[64:67], v6, s[8:11], s41 offen offset:0 sc1
    buffer_load_dwordx4 v[68:71], v6, s[8:11], s41 offen offset:1024 sc1
    buffer_load_dwordx4 v[72:75], v6, s[8:11], s41 offen offset:2048 sc1
    buffer_load_dwordx4 v[76:79], v6, s[8:11], s41 offen offset:3072 sc1
    buffer_load_dwordx4 v[80:83], v7, s[8:11], s41 offen offset:0 sc1
    buffer_load_dwordx4 v[84:87], v7, s[8:11], s41 offen offset:1024 sc1
    buffer_load_dwordx4 v[88:91], v7, s[8:11], s41 offen offset:2048 sc1
    buffer_load_dwordx4 v[92:95], v7, s[8:11], s41 offen offset:3072 sc1
    buffer_load_dwordx4 v[96:99], v8, s[8:11], s41 offen offset:0 sc1
    buffer_load_dwordx4 v[100:103], v8, s[8:11], s41 offen offset:1024 sc1
    buffer_load_dwordx4 v[104:107], v8, s[8:11], s41 offen offset:2048 sc1
    buffer_load_dwordx4 v[108:111], v8, s[8:11], s41 offen offset:3072 sc1
    s_add_u32 s41, s41, 393216
    s_waitcnt vmcnt(0)
interleave_layers__linear_attn_block__memory_aug_recurrent_mem_tr__prompt_kernel_of46:
    s_waitcnt vmcnt(10)
    s_add_u32 s40, s40, 1
    s_add_u32 s43, s43, 1310720
    v_swap_b32 v74, v84
    v_swap_b32 v75, v85
    v_swap_b32 v98, v108
    v_swap_b32 v99, v109
    buffer_load_dword v232, v10, s[8:11], 0 offen sc1
    v_mfma_f32_16x16x32_bf16 v[112:115], v[64:67], a[0:3], 0
    v_mfma_f32_16x16x32_bf16 v[116:119], v[68:71], a[0:3], 0
    v_mfma_f32_16x16x32_bf16 v[120:123], v[64:67], a[24:27], 0
    v_mfma_f32_16x16x32_bf16 v[124:127], v[68:71], a[24:27], 0
    v_mfma_f32_16x16x32_bf16 v[128:131], v[64:67], a[48:51], 0
    v_mfma_f32_16x16x32_bf16 v[132:135], v[68:71], a[48:51], 0
    v_mfma_f32_16x16x32_bf16 v[136:139], v[64:67], a[72:75], 0
    v_mfma_f32_16x16x32_bf16 v[140:143], v[68:71], a[72:75], 0
    v_mfma_f32_16x16x32_bf16 v[144:147], v[64:67], a[96:99], 0
    v_mfma_f32_16x16x32_bf16 v[148:151], v[68:71], a[96:99], 0
    v_mfma_f32_16x16x32_bf16 v[152:155], v[64:67], a[120:123], 0
    v_mfma_f32_16x16x32_bf16 v[156:159], v[68:71], a[120:123], 0
    v_mfma_f32_16x16x32_bf16 v[160:163], v[64:67], a[144:147], 0
    v_mfma_f32_16x16x32_bf16 v[164:167], v[68:71], a[144:147], 0
    v_mfma_f32_16x16x32_bf16 v[168:171], v[64:67], a[168:171], 0
    v_mfma_f32_16x16x32_bf16 v[172:175], v[68:71], a[168:171], 0
    v_mfma_f32_16x16x32_bf16 v[176:179], v[64:67], a[192:195], 0
    v_mfma_f32_16x16x32_bf16 v[180:183], v[68:71], a[192:195], 0
    v_mfma_f32_16x16x32_bf16 v[184:187], v[64:67], a[216:219], 0
    v_mfma_f32_16x16x32_bf16 v[188:191], v[68:71], a[216:219], 0
    v_mfma_f32_16x16x32_bf16 v[112:115], v[76:79], a[4:7], v[112:115]
    v_mfma_f32_16x16x32_bf16 v[116:119], v[80:83], a[4:7], v[116:119]
    v_mfma_f32_16x16x32_bf16 v[120:123], v[76:79], a[28:31], v[120:123]
    v_mfma_f32_16x16x32_bf16 v[124:127], v[80:83], a[28:31], v[124:127]
    v_mfma_f32_16x16x32_bf16 v[128:131], v[76:79], a[52:55], v[128:131]
    v_mfma_f32_16x16x32_bf16 v[132:135], v[80:83], a[52:55], v[132:135]
    v_mfma_f32_16x16x32_bf16 v[136:139], v[76:79], a[76:79], v[136:139]
    v_mfma_f32_16x16x32_bf16 v[140:143], v[80:83], a[76:79], v[140:143]
    v_mfma_f32_16x16x32_bf16 v[144:147], v[76:79], a[100:103], v[144:147]
    v_mfma_f32_16x16x32_bf16 v[148:151], v[80:83], a[100:103], v[148:151]
    v_mfma_f32_16x16x32_bf16 v[152:155], v[76:79], a[124:127], v[152:155]
    v_mfma_f32_16x16x32_bf16 v[156:159], v[80:83], a[124:127], v[156:159]
    v_mfma_f32_16x16x32_bf16 v[160:163], v[76:79], a[148:151], v[160:163]
    v_mfma_f32_16x16x32_bf16 v[164:167], v[80:83], a[148:151], v[164:167]
    v_mfma_f32_16x16x32_bf16 v[168:171], v[76:79], a[172:175], v[168:171]
    v_mfma_f32_16x16x32_bf16 v[172:175], v[80:83], a[172:175], v[172:175]
    v_mfma_f32_16x16x32_bf16 v[176:179], v[76:79], a[196:199], v[176:179]
    v_mfma_f32_16x16x32_bf16 v[180:183], v[80:83], a[196:199], v[180:183]
    v_mfma_f32_16x16x32_bf16 v[184:187], v[76:79], a[220:223], v[184:187]
    v_mfma_f32_16x16x32_bf16 v[188:191], v[80:83], a[220:223], v[188:191]
    v_mfma_f32_16x16x32_bf16 v[112:115], v[88:91], a[8:11], v[112:115]
    v_mfma_f32_16x16x32_bf16 v[116:119], v[92:95], a[8:11], v[116:119]
    v_mfma_f32_16x16x32_bf16 v[120:123], v[88:91], a[32:35], v[120:123]
    v_mfma_f32_16x16x32_bf16 v[124:127], v[92:95], a[32:35], v[124:127]
    v_mfma_f32_16x16x32_bf16 v[128:131], v[88:91], a[56:59], v[128:131]
    v_mfma_f32_16x16x32_bf16 v[132:135], v[92:95], a[56:59], v[132:135]
    v_mfma_f32_16x16x32_bf16 v[136:139], v[88:91], a[80:83], v[136:139]
    v_mfma_f32_16x16x32_bf16 v[140:143], v[92:95], a[80:83], v[140:143]
    v_mfma_f32_16x16x32_bf16 v[144:147], v[88:91], a[104:107], v[144:147]
    v_mfma_f32_16x16x32_bf16 v[148:151], v[92:95], a[104:107], v[148:151]
    v_mfma_f32_16x16x32_bf16 v[152:155], v[88:91], a[128:131], v[152:155]
    v_mfma_f32_16x16x32_bf16 v[156:159], v[92:95], a[128:131], v[156:159]
    v_mfma_f32_16x16x32_bf16 v[160:163], v[88:91], a[152:155], v[160:163]
    v_mfma_f32_16x16x32_bf16 v[164:167], v[92:95], a[152:155], v[164:167]
    v_mfma_f32_16x16x32_bf16 v[168:171], v[88:91], a[176:179], v[168:171]
    v_mfma_f32_16x16x32_bf16 v[172:175], v[92:95], a[176:179], v[172:175]
    v_mfma_f32_16x16x32_bf16 v[176:179], v[88:91], a[200:203], v[176:179]
    v_mfma_f32_16x16x32_bf16 v[180:183], v[92:95], a[200:203], v[180:183]
    v_mfma_f32_16x16x32_bf16 v[184:187], v[88:91], a[224:227], v[184:187]
    v_mfma_f32_16x16x32_bf16 v[188:191], v[92:95], a[224:227], v[188:191]
    s_waitcnt vmcnt(0)
    v_readfirstlane_b32 s24, v232
    s_max_i32 s62, s62, s24
    s_add_u32 s63, s40, 2
    s_min_u32 s63, s63, 64
    s_cmp_ge_i32 s62, s63
    s_cselect_b32 s24, 1, 0
    s_lshl_b32 s25, s3, 4
    s_add_u32 s25, s25, 4
    v_mov_b32 v12, s25
    v_mov_b32 v13, s24
    ds_write_b32 v12, v13
    v_mov_b32 v12, 4
    s_waitcnt lgkmcnt(0)
    s_barrier
    ds_read_b32 v13, v12
    s_cmp_eq_u32 s3, 0
    s_cbranch_scc0 interleave_layers__linear_attn_block__memory_aug_recurrent_mem_tr__prompt_kernel_fp51
    v_mov_b32 v15, s40
    buffer_store_dword v15, v14, s[8:11], 0 offen sc1
interleave_layers__linear_attn_block__memory_aug_recurrent_mem_tr__prompt_kernel_fp51:
    s_waitcnt lgkmcnt(0)
    v_readfirstlane_b32 s58, v13
    s_cmp_eq_u32 s58, 1
    s_cbranch_scc0 interleave_layers__linear_attn_block__memory_aug_recurrent_mem_tr__prompt_kernel_of50
    s_max_i32 s62, s62, s63
    buffer_load_dwordx4 v[16:19], v6, s[8:11], s41 offen offset:0 sc1
    buffer_load_dwordx4 v[20:23], v6, s[8:11], s41 offen offset:1024 sc1
    buffer_load_dwordx4 v[24:27], v6, s[8:11], s41 offen offset:2048 sc1
    buffer_load_dwordx4 v[28:31], v6, s[8:11], s41 offen offset:3072 sc1
    buffer_load_dwordx4 v[32:35], v7, s[8:11], s41 offen offset:0 sc1
    buffer_load_dwordx4 v[36:39], v7, s[8:11], s41 offen offset:1024 sc1
    buffer_load_dwordx4 v[40:43], v7, s[8:11], s41 offen offset:2048 sc1
    buffer_load_dwordx4 v[44:47], v7, s[8:11], s41 offen offset:3072 sc1
    buffer_load_dwordx4 v[48:51], v8, s[8:11], s41 offen offset:0 sc1
    buffer_load_dwordx4 v[52:55], v8, s[8:11], s41 offen offset:1024 sc1
    buffer_load_dwordx4 v[56:59], v8, s[8:11], s41 offen offset:2048 sc1
    buffer_load_dwordx4 v[60:63], v8, s[8:11], s41 offen offset:3072 sc1
    s_add_u32 s41, s41, 393216
interleave_layers__linear_attn_block__memory_aug_recurrent_mem_tr__prompt_kernel_of50:
    v_mfma_f32_16x16x32_bf16 v[112:115], v[100:103], a[12:15], v[112:115]
    v_mfma_f32_16x16x32_bf16 v[116:119], v[104:107], a[12:15], v[116:119]
    v_mfma_f32_16x16x32_bf16 v[120:123], v[100:103], a[36:39], v[120:123]
    v_mfma_f32_16x16x32_bf16 v[124:127], v[104:107], a[36:39], v[124:127]
    v_mfma_f32_16x16x32_bf16 v[128:131], v[100:103], a[60:63], v[128:131]
    v_mfma_f32_16x16x32_bf16 v[132:135], v[104:107], a[60:63], v[132:135]
    v_mfma_f32_16x16x32_bf16 v[136:139], v[100:103], a[84:87], v[136:139]
    v_mfma_f32_16x16x32_bf16 v[140:143], v[104:107], a[84:87], v[140:143]
    v_mfma_f32_16x16x32_bf16 v[144:147], v[100:103], a[108:111], v[144:147]
    v_mfma_f32_16x16x32_bf16 v[148:151], v[104:107], a[108:111], v[148:151]
    v_mfma_f32_16x16x32_bf16 v[152:155], v[100:103], a[132:135], v[152:155]
    v_mfma_f32_16x16x32_bf16 v[156:159], v[104:107], a[132:135], v[156:159]
    v_mfma_f32_16x16x32_bf16 v[160:163], v[100:103], a[156:159], v[160:163]
    v_mfma_f32_16x16x32_bf16 v[164:167], v[104:107], a[156:159], v[164:167]
    v_mfma_f32_16x16x32_bf16 v[168:171], v[100:103], a[180:183], v[168:171]
    v_mfma_f32_16x16x32_bf16 v[172:175], v[104:107], a[180:183], v[172:175]
    v_mfma_f32_16x16x32_bf16 v[176:179], v[100:103], a[204:207], v[176:179]
    v_mfma_f32_16x16x32_bf16 v[180:183], v[104:107], a[204:207], v[180:183]
    v_mfma_f32_16x16x32_bf16 v[184:187], v[100:103], a[228:231], v[184:187]
    v_mfma_f32_16x16x32_bf16 v[188:191], v[104:107], a[228:231], v[188:191]
    v_mfma_f32_16x16x32_bf16 v[112:115], v[72:75], a[16:19], v[112:115]
    v_mfma_f32_16x16x32_bf16 v[116:119], v[84:87], a[16:19], v[116:119]
    v_mfma_f32_16x16x32_bf16 v[120:123], v[72:75], a[40:43], v[120:123]
    v_mfma_f32_16x16x32_bf16 v[124:127], v[84:87], a[40:43], v[124:127]
    v_mfma_f32_16x16x32_bf16 v[128:131], v[72:75], a[64:67], v[128:131]
    v_mfma_f32_16x16x32_bf16 v[132:135], v[84:87], a[64:67], v[132:135]
    v_mfma_f32_16x16x32_bf16 v[136:139], v[72:75], a[88:91], v[136:139]
    v_mfma_f32_16x16x32_bf16 v[140:143], v[84:87], a[88:91], v[140:143]
    v_mfma_f32_16x16x32_bf16 v[144:147], v[72:75], a[112:115], v[144:147]
    v_mfma_f32_16x16x32_bf16 v[148:151], v[84:87], a[112:115], v[148:151]
    v_mfma_f32_16x16x32_bf16 v[152:155], v[72:75], a[136:139], v[152:155]
    v_mfma_f32_16x16x32_bf16 v[156:159], v[84:87], a[136:139], v[156:159]
    v_mfma_f32_16x16x32_bf16 v[160:163], v[72:75], a[160:163], v[160:163]
    v_mfma_f32_16x16x32_bf16 v[164:167], v[84:87], a[160:163], v[164:167]
    v_mfma_f32_16x16x32_bf16 v[168:171], v[72:75], a[184:187], v[168:171]
    v_mfma_f32_16x16x32_bf16 v[172:175], v[84:87], a[184:187], v[172:175]
    v_mfma_f32_16x16x32_bf16 v[176:179], v[72:75], a[208:211], v[176:179]
    v_mfma_f32_16x16x32_bf16 v[180:183], v[84:87], a[208:211], v[180:183]
    v_mfma_f32_16x16x32_bf16 v[184:187], v[72:75], a[232:235], v[184:187]
    v_mfma_f32_16x16x32_bf16 v[188:191], v[84:87], a[232:235], v[188:191]
    buffer_load_dword v233, v10, s[8:11], 0 offen sc1
    v_mfma_f32_16x16x32_bf16 v[112:115], v[96:99], a[20:23], v[112:115]
    v_mfma_f32_16x16x32_bf16 v[116:119], v[108:111], a[20:23], v[116:119]
    v_mfma_f32_16x16x32_bf16 v[120:123], v[96:99], a[44:47], v[120:123]
    v_mfma_f32_16x16x32_bf16 v[124:127], v[108:111], a[44:47], v[124:127]
    v_mfma_f32_16x16x32_bf16 v[128:131], v[96:99], a[68:71], v[128:131]
    v_mfma_f32_16x16x32_bf16 v[132:135], v[108:111], a[68:71], v[132:135]
    v_mfma_f32_16x16x32_bf16 v[136:139], v[96:99], a[92:95], v[136:139]
    v_mfma_f32_16x16x32_bf16 v[140:143], v[108:111], a[92:95], v[140:143]
    v_mfma_f32_16x16x32_bf16 v[144:147], v[96:99], a[116:119], v[144:147]
    v_mfma_f32_16x16x32_bf16 v[148:151], v[108:111], a[116:119], v[148:151]
    v_mfma_f32_16x16x32_bf16 v[152:155], v[96:99], a[140:143], v[152:155]
    v_mfma_f32_16x16x32_bf16 v[156:159], v[108:111], a[140:143], v[156:159]
    v_mfma_f32_16x16x32_bf16 v[160:163], v[96:99], a[164:167], v[160:163]
    v_mfma_f32_16x16x32_bf16 v[164:167], v[108:111], a[164:167], v[164:167]
    v_mfma_f32_16x16x32_bf16 v[168:171], v[96:99], a[188:191], v[168:171]
    v_mfma_f32_16x16x32_bf16 v[172:175], v[108:111], a[188:191], v[172:175]
    v_mfma_f32_16x16x32_bf16 v[176:179], v[96:99], a[212:215], v[176:179]
    v_mfma_f32_16x16x32_bf16 v[180:183], v[108:111], a[212:215], v[180:183]
    v_mfma_f32_16x16x32_bf16 v[184:187], v[96:99], a[236:239], v[184:187]
    v_mfma_f32_16x16x32_bf16 v[188:191], v[108:111], a[236:239], v[188:191]
    s_mov_b32 s46, s43
    v_cvt_pk_bf16_f32 v192, v112, v113
    v_cvt_pk_bf16_f32 v193, v114, v115
    v_cvt_pk_bf16_f32 v194, v116, v117
    v_cvt_pk_bf16_f32 v195, v118, v119
    buffer_store_dwordx4 v[192:195], v9, s[8:11], s46 offen sc1
    s_add_u32 s46, s46, 32768
    v_cvt_pk_bf16_f32 v196, v120, v121
    v_cvt_pk_bf16_f32 v197, v122, v123
    v_cvt_pk_bf16_f32 v198, v124, v125
    v_cvt_pk_bf16_f32 v199, v126, v127
    buffer_store_dwordx4 v[196:199], v9, s[8:11], s46 offen sc1
    s_add_u32 s46, s46, 32768
    v_cvt_pk_bf16_f32 v200, v128, v129
    v_cvt_pk_bf16_f32 v201, v130, v131
    v_cvt_pk_bf16_f32 v202, v132, v133
    v_cvt_pk_bf16_f32 v203, v134, v135
    buffer_store_dwordx4 v[200:203], v9, s[8:11], s46 offen sc1
    s_add_u32 s46, s46, 32768
    v_cvt_pk_bf16_f32 v204, v136, v137
    v_cvt_pk_bf16_f32 v205, v138, v139
    v_cvt_pk_bf16_f32 v206, v140, v141
    v_cvt_pk_bf16_f32 v207, v142, v143
    buffer_store_dwordx4 v[204:207], v9, s[8:11], s46 offen sc1
    s_add_u32 s46, s46, 32768
    v_cvt_pk_bf16_f32 v208, v144, v145
    v_cvt_pk_bf16_f32 v209, v146, v147
    v_cvt_pk_bf16_f32 v210, v148, v149
    v_cvt_pk_bf16_f32 v211, v150, v151
    buffer_store_dwordx4 v[208:211], v9, s[8:11], s46 offen sc1
    s_add_u32 s46, s46, 32768
    v_cvt_pk_bf16_f32 v212, v152, v153
    v_cvt_pk_bf16_f32 v213, v154, v155
    v_cvt_pk_bf16_f32 v214, v156, v157
    v_cvt_pk_bf16_f32 v215, v158, v159
    buffer_store_dwordx4 v[212:215], v9, s[8:11], s46 offen sc1
    s_add_u32 s46, s46, 32768
    v_cvt_pk_bf16_f32 v216, v160, v161
    v_cvt_pk_bf16_f32 v217, v162, v163
    v_cvt_pk_bf16_f32 v218, v164, v165
    v_cvt_pk_bf16_f32 v219, v166, v167
    buffer_store_dwordx4 v[216:219], v9, s[8:11], s46 offen sc1
    s_add_u32 s46, s46, 32768
    v_cvt_pk_bf16_f32 v220, v168, v169
    v_cvt_pk_bf16_f32 v221, v170, v171
    v_cvt_pk_bf16_f32 v222, v172, v173
    v_cvt_pk_bf16_f32 v223, v174, v175
    buffer_store_dwordx4 v[220:223], v9, s[8:11], s46 offen sc1
    s_add_u32 s46, s46, 32768
    v_cvt_pk_bf16_f32 v224, v176, v177
    v_cvt_pk_bf16_f32 v225, v178, v179
    v_cvt_pk_bf16_f32 v226, v180, v181
    v_cvt_pk_bf16_f32 v227, v182, v183
    buffer_store_dwordx4 v[224:227], v9, s[8:11], s46 offen sc1
    s_add_u32 s46, s46, 32768
    v_cvt_pk_bf16_f32 v228, v184, v185
    v_cvt_pk_bf16_f32 v229, v186, v187
    v_cvt_pk_bf16_f32 v230, v188, v189
    v_cvt_pk_bf16_f32 v231, v190, v191
    buffer_store_dwordx4 v[228:231], v9, s[8:11], s46 offen sc1
    s_cmp_eq_u32 s58, 1
    s_cbranch_scc1 interleave_layers__linear_attn_block__memory_aug_recurrent_mem_tr__prompt_kernel_of52
    s_waitcnt vmcnt(10)
    v_readfirstlane_b32 s24, v233
    s_max_i32 s62, s62, s24
    s_add_u32 s63, s40, 2
    s_min_u32 s63, s63, 64
    s_cmp_ge_i32 s62, s63
    s_cbranch_scc0 interleave_layers__linear_attn_block__memory_aug_recurrent_mem_tr__prompt_kernel_oo53
    buffer_load_dwordx4 v[16:19], v6, s[8:11], s41 offen offset:0 sc1
    buffer_load_dwordx4 v[20:23], v6, s[8:11], s41 offen offset:1024 sc1
    buffer_load_dwordx4 v[24:27], v6, s[8:11], s41 offen offset:2048 sc1
    buffer_load_dwordx4 v[28:31], v6, s[8:11], s41 offen offset:3072 sc1
    buffer_load_dwordx4 v[32:35], v7, s[8:11], s41 offen offset:0 sc1
    buffer_load_dwordx4 v[36:39], v7, s[8:11], s41 offen offset:1024 sc1
    buffer_load_dwordx4 v[40:43], v7, s[8:11], s41 offen offset:2048 sc1
    buffer_load_dwordx4 v[44:47], v7, s[8:11], s41 offen offset:3072 sc1
    buffer_load_dwordx4 v[48:51], v8, s[8:11], s41 offen offset:0 sc1
    buffer_load_dwordx4 v[52:55], v8, s[8:11], s41 offen offset:1024 sc1
    buffer_load_dwordx4 v[56:59], v8, s[8:11], s41 offen offset:2048 sc1
    buffer_load_dwordx4 v[60:63], v8, s[8:11], s41 offen offset:3072 sc1
    s_add_u32 s41, s41, 393216
    s_waitcnt vmcnt(12)
    s_barrier
    s_add_u32 s24, s40, 1
    s_cmp_eq_u32 s3, 0
    s_cbranch_scc0 interleave_layers__linear_attn_block__memory_aug_recurrent_mem_tr__prompt_kernel_fp54
    v_mov_b32 v15, s24
    buffer_store_dword v15, v14, s[8:11], 0 offen sc1
interleave_layers__linear_attn_block__memory_aug_recurrent_mem_tr__prompt_kernel_fp54:
    s_waitcnt vmcnt(0)
    s_branch interleave_layers__linear_attn_block__memory_aug_recurrent_mem_tr__prompt_kernel_of52
interleave_layers__linear_attn_block__memory_aug_recurrent_mem_tr__prompt_kernel_oo53:
    s_waitcnt vmcnt(0)
    s_barrier
    s_add_u32 s24, s40, 1
    s_cmp_eq_u32 s3, 0
    s_cbranch_scc0 interleave_layers__linear_attn_block__memory_aug_recurrent_mem_tr__prompt_kernel_fp55
    v_mov_b32 v15, s24
    buffer_store_dword v15, v14, s[8:11], 0 offen sc1
interleave_layers__linear_attn_block__memory_aug_recurrent_mem_tr__prompt_kernel_fp55:
    s_add_u32 s63, s40, 2
    s_min_u32 s63, s63, 64
    s_cmp_ge_i32 s62, s63
    s_cbranch_scc1 interleave_layers__linear_attn_block__memory_aug_recurrent_mem_tr__prompt_kernel_o_en4_ok
    s_mov_b32 s61, 0
interleave_layers__linear_attn_block__memory_aug_recurrent_mem_tr__prompt_kernel_o_en4:
    buffer_load_dword v11, v10, s[8:11], 0 offen sc1
    s_waitcnt vmcnt(0)
    v_readlane_b32 s62, v11, 0
    s_cmp_ge_i32 s62, s63
    s_cbranch_scc1 interleave_layers__linear_attn_block__memory_aug_recurrent_mem_tr__prompt_kernel_o_en4_ok
    s_add_u32 s61, s61, 1
    s_cmp_ge_u32 s61, s60
    s_cbranch_scc1 interleave_layers__linear_attn_block__memory_aug_recurrent_mem_tr__prompt_kernel_o_en4_to
    s_sleep 2
    s_branch interleave_layers__linear_attn_block__memory_aug_recurrent_mem_tr__prompt_kernel_o_en4
interleave_layers__linear_attn_block__memory_aug_recurrent_mem_tr__prompt_kernel_o_en4_to:
    s_mov_b32 s60, 1
interleave_layers__linear_attn_block__memory_aug_recurrent_mem_tr__prompt_kernel_o_en4_ok:
    buffer_load_dwordx4 v[16:19], v6, s[8:11], s41 offen offset:0 sc1
    buffer_load_dwordx4 v[20:23], v6, s[8:11], s41 offen offset:1024 sc1
    buffer_load_dwordx4 v[24:27], v6, s[8:11], s41 offen offset:2048 sc1
    buffer_load_dwordx4 v[28:31], v6, s[8:11], s41 offen offset:3072 sc1
    buffer_load_dwordx4 v[32:35], v7, s[8:11], s41 offen offset:0 sc1
    buffer_load_dwordx4 v[36:39], v7, s[8:11], s41 offen offset:1024 sc1
    buffer_load_dwordx4 v[40:43], v7, s[8:11], s41 offen offset:2048 sc1
    buffer_load_dwordx4 v[44:47], v7, s[8:11], s41 offen offset:3072 sc1
    buffer_load_dwordx4 v[48:51], v8, s[8:11], s41 offen offset:0 sc1
    buffer_load_dwordx4 v[52:55], v8, s[8:11], s41 offen offset:1024 sc1
    buffer_load_dwordx4 v[56:59], v8, s[8:11], s41 offen offset:2048 sc1
    buffer_load_dwordx4 v[60:63], v8, s[8:11], s41 offen offset:3072 sc1
    s_add_u32 s41, s41, 393216
    s_waitcnt vmcnt(0)
interleave_layers__linear_attn_block__memory_aug_recurrent_mem_tr__prompt_kernel_of52:
    s_waitcnt vmcnt(10)
    s_add_u32 s40, s40, 1
    s_add_u32 s43, s43, 1310720
    s_cmp_lt_u32 s40, 64
    s_cbranch_scc1 interleave_layers__linear_attn_block__memory_aug_recurrent_mem_tr__prompt_kernel_o_seg
    s_waitcnt vmcnt(0)
    s_barrier
    s_cmp_eq_u32 s3, 0
    s_cbranch_scc0 interleave_layers__linear_attn_block__memory_aug_recurrent_mem_tr__prompt_kernel_fp56
    v_mov_b32 v15, s40
    buffer_store_dword v15, v14, s[8:11], 0 offen sc1
interleave_layers__linear_attn_block__memory_aug_recurrent_mem_tr__prompt_kernel_fp56:
    s_cmp_eq_u32 s92, 0
    s_cbranch_scc0 interleave_layers__linear_attn_block__memory_aug_recurrent_mem_tr__prompt_kernel_end
    s_mov_b32 s92, 1
    s_branch interleave_layers__linear_attn_block__memory_aug_recurrent_mem_tr__prompt_kernel_o_layer
interleave_layers__linear_attn_block__memory_aug_recurrent_mem_tr__prompt_kernel_end:
    s_endpgm
.section .rodata,"a"
.p2align 6
.amdhsa_kernel interleave_layers__linear_attn_block__memory_aug_recurrent_mem_tr__prompt_kernel
  .amdhsa_next_free_vgpr 512
  .amdhsa_next_free_sgpr 100
  .amdhsa_accum_offset 256
  .amdhsa_group_segment_fixed_size 0
  .amdhsa_kernarg_size 104
  .amdhsa_user_sgpr_count 2
  .amdhsa_user_sgpr_kernarg_segment_ptr 1
  .amdhsa_system_sgpr_workgroup_id_x 1
.end_amdhsa_kernel
```
